```python
import torch

def _softmax(x, axis=-1):
    return torch.softmax(x, dim=axis)

def _gelu(x):
    return torch.nn.functional.gelu(x, approximate='tanh')

def _silu(x):
    return torch.nn.functional.silu(x)

def _sigmoid(x):
    return torch.sigmoid(x)

def _layernorm(x, axis=-1, eps=1e-05):
    m = x.mean(dim=axis, keepdim=True)
    v = x.var(dim=axis, keepdim=True, unbiased=False)
    return (x - m) / torch.sqrt(v + eps)

def _scatter_add(tgt, idx, src, axis=0):
    return tgt.clone().index_add_(axis, idx, src)

def _segment_sum(src, seg, n):
    out = torch.zeros((n,) + src.shape[1:], dtype=src.dtype)
    return out.index_add_(0, seg, src)

def _pad(x, pw):
    flat = tuple((v for pair in reversed(pw) for v in pair))
    return torch.nn.functional.pad(x, flat)
kernel_name = 'standalone__window_attn_davit__vision'

def setup_inputs():

    _w = lambda a: (lambda t: t.to(torch.bfloat16) if t.is_floating_point() else t)(torch.as_tensor(a))
    HW = 512
    C0 = 192
    ws = 7
    nh = 4
    H = W = max(HW // ws * ws, ws)
    C = max(C0 // nh * nh, nh)
    k = 3
    return {'x': _w((lambda *s: torch.randn(*s, dtype=torch.bfloat16) * 1.6)(1, H, W, C)), 'dw_pe': _w((lambda *s: torch.randn(*s, dtype=torch.bfloat16) * 1.6)(k, k, C) * 0.1), 'w_qkv': _w((lambda *s: torch.randn(*s, dtype=torch.bfloat16) * 1.6)(C, 3 * C) * C ** (-0.5)), 'w_o': _w((lambda *s: torch.randn(*s, dtype=torch.bfloat16) * 0.4)(C, C) * C ** (-0.5))}

def reference(x, dw_pe, w_qkv, w_o):
    B, H, W, C = x.shape
    ws = 7
    nh = 4
    dh = C // nh
    kk = dw_pe.shape[0]
    pad = kk // 2
    xp = _pad(x, ((0, 0), (pad, pad), (pad, pad), (0, 0)))
    pe = torch.zeros_like(x)
    for i in range(kk):
        for j in range(kk):
            pe = pe + xp[:, i:i + H, j:j + W, :] * dw_pe[i, j][None, None, None, :]
    x0 = x + pe
    h = _layernorm(x0, axis=-1)
    hw = h.reshape(B, H // ws, ws, W // ws, ws, C)
    hw = (lambda x, *d: x.permute(*d))(hw, 0, 1, 3, 2, 4, 5)
    hw = hw.reshape(-1, ws * ws, C)
    qkv = (hw @ w_qkv).reshape(-1, ws * ws, 3, nh, dh)
    q = qkv[:, :, 0].clone()
    k = qkv[:, :, 1].clone()
    v = qkv[:, :, 2].clone()
    scale = dh ** (-0.5)
    attn = torch.einsum('wnhd,wmhd->whnm', q, k) * scale
    attn = _softmax(attn, axis=-1)
    out = torch.einsum('whnm,wmhd->wnhd', attn, v)
    out = out.reshape(-1, ws * ws, C) @ w_o
    out = out.reshape(B, H // ws, W // ws, ws, ws, C)
    out = (lambda x, *d: x.permute(*d))(out, 0, 1, 3, 2, 4, 5)
    out = out.reshape(B, H, W, C)
    return x0 + out
```

```asm
; @launch grid=(256,1,1) block=(256,1,1) lds=163840
.amdgcn_target "amdgcn-amd-amdhsa--gfx950"
.text
.globl standalone__window_attn_davit__vision_kernel
.p2align 8
.type standalone__window_attn_davit__vision_kernel,@function
standalone__window_attn_davit__vision_kernel:
s_cmp_ge_u32 s2, 256
s_cbranch_scc1 L_end
v_lshrrev_b32 v1, 6, v0
s_mov_b32 s53, s2
s_mov_b32 s47, 0
v_readfirstlane_b32 s32, v1
s_nop 3
L_start:
s_load_dwordx8 s[56:63], s[0:1], 0
s_load_dwordx2 s[64:65], s[0:1], 32
s_load_dwordx2 s[66:67], s[0:1], 48
s_getpc_b64 s[68:69]
L_pc:
v_mbcnt_lo_u32_b32 v0, -1, 0
v_mbcnt_hi_u32_b32 v0, -1, v0
s_lshl_b32 s41, s32, 13
v_lshlrev_b32 v1, 7, v0
v_add_u32 v1, s41, v1
s_add_u32 s70, s68, L_tab-L_pc
s_addc_u32 s71, s69, 0
v_lshlrev_b32 v2, 4, v0
global_load_dwordx4 v[194:197], v2, s[70:71] offset:0
global_load_dwordx4 v[198:201], v2, s[70:71] offset:1024
global_load_dwordx4 v[202:205], v2, s[70:71] offset:2048
global_load_dwordx4 v[210:213], v2, s[70:71] offset:3072
v_add_u32 v2, 4096, v2
global_load_dwordx4 v[214:217], v2, s[70:71] offset:0
global_load_dwordx4 v[218:221], v2, s[70:71] offset:1024
global_load_dwordx4 v[36:39], v2, s[70:71] offset:2048
global_load_dwordx4 v[40:43], v2, s[70:71] offset:3072
v_add_u32 v2, 4096, v2
global_load_dwordx4 v[44:47], v2, s[70:71] offset:0
global_load_dwordx4 v[48:51], v2, s[70:71] offset:1024
global_load_dwordx4 v[52:55], v2, s[70:71] offset:2048
global_load_dwordx4 v[56:59], v2, s[70:71] offset:3072
s_lshl_b32 s42, s32, 10
s_add_u32 s42, s42, 4096
v_add_u32 v2, s42, v2
global_load_dwordx4 v[206:209], v2, s[70:71]
global_load_dword v223, v1, s[68:69]
v_add_u32 v1, 32768, v1
global_load_dword v223, v1, s[68:69]
s_waitcnt lgkmcnt(0)
s_sub_u32 s4, s56, 196608
s_subb_u32 s5, s57, 0
s_mov_b32 s6, 100467072
s_mov_b32 s7, 131072
s_mov_b32 s20, s58
s_mov_b32 s21, s59
s_mov_b32 s22, 3456
s_mov_b32 s23, 131072
s_mov_b32 s12, s60
s_mov_b32 s13, s61
s_mov_b32 s14, 221184
s_mov_b32 s15, 131072
s_mov_b32 s16, s62
s_mov_b32 s17, s63
s_mov_b32 s18, 73728
s_mov_b32 s19, 131072
s_mov_b32 s8, s64
s_mov_b32 s9, s65
s_mov_b32 s10, 100270464
s_mov_b32 s11, 131072
s_mov_b32 s24, s66
s_mov_b32 s25, s67
s_mov_b32 s26, 6291456
s_mov_b32 s27, 131072
s_and_b32 s41, s53, 7
s_lshr_b32 s42, s53, 3
s_mul_i32 s43, s41, 666
s_add_u32 s34, s43, 667
s_min_u32 s41, s41, 1
s_add_u32 s43, s43, s41
s_add_u32 s33, s43, s42
s_mov_b32 s35, s33
s_mov_b32 s72, 402653183
s_mov_b32 s48, 1001040555
s_mov_b32 s49, 925353388
s_lshl_b32 s45, s32, 10
s_mul_i32 s50, s53, 24576
s_mul_i32 s41, s32, 6144
s_add_u32 s50, s50, s41
s_mul_i32 s54, s32, 96
s_mul_i32 s55, s32, 36864
s_add_u32 s40, s54, 384
s_add_u32 m0, s55, 0
s_waitcnt vmcnt(8)
buffer_load_dwordx4 v36, s[12:15], s40 offen lds
s_add_u32 m0, s55, 1024
s_nop 0
buffer_load_dwordx4 v37, s[12:15], s40 offen lds
s_add_u32 m0, s55, 2048
s_nop 0
buffer_load_dwordx4 v38, s[12:15], s40 offen lds
s_add_u32 s40, s54, 37248
s_add_u32 m0, s55, 3072
s_nop 0
buffer_load_dwordx4 v36, s[12:15], s40 offen lds
s_add_u32 m0, s55, 4096
s_nop 0
buffer_load_dwordx4 v37, s[12:15], s40 offen lds
s_add_u32 m0, s55, 5120
s_nop 0
buffer_load_dwordx4 v38, s[12:15], s40 offen lds
s_add_u32 s40, s54, 74112
s_add_u32 m0, s55, 6144
s_nop 0
buffer_load_dwordx4 v36, s[12:15], s40 offen lds
s_add_u32 m0, s55, 7168
s_nop 0
buffer_load_dwordx4 v37, s[12:15], s40 offen lds
s_add_u32 m0, s55, 8192
s_nop 0
buffer_load_dwordx4 v38, s[12:15], s40 offen lds
s_add_u32 s40, s54, 110976
s_add_u32 m0, s55, 9216
s_nop 0
buffer_load_dwordx4 v36, s[12:15], s40 offen lds
s_add_u32 m0, s55, 10240
s_nop 0
buffer_load_dwordx4 v37, s[12:15], s40 offen lds
s_add_u32 m0, s55, 11264
s_nop 0
buffer_load_dwordx4 v38, s[12:15], s40 offen lds
s_add_u32 s40, s54, 147840
s_add_u32 m0, s55, 12288
s_nop 0
buffer_load_dwordx4 v36, s[12:15], s40 offen lds
s_add_u32 m0, s55, 13312
s_nop 0
buffer_load_dwordx4 v37, s[12:15], s40 offen lds
s_add_u32 m0, s55, 14336
s_nop 0
buffer_load_dwordx4 v38, s[12:15], s40 offen lds
s_add_u32 s40, s54, 184704
s_add_u32 m0, s55, 15360
s_nop 0
buffer_load_dwordx4 v36, s[12:15], s40 offen lds
s_add_u32 m0, s55, 16384
s_nop 0
buffer_load_dwordx4 v37, s[12:15], s40 offen lds
s_add_u32 m0, s55, 17408
s_nop 0
buffer_load_dwordx4 v38, s[12:15], s40 offen lds
s_add_u32 s40, s54, 0
s_add_u32 m0, s55, 18432
s_nop 0
buffer_load_dwordx4 v36, s[12:15], s40 offen lds
s_add_u32 m0, s55, 19456
s_nop 0
buffer_load_dwordx4 v37, s[12:15], s40 offen lds
s_add_u32 m0, s55, 20480
s_nop 0
buffer_load_dwordx4 v38, s[12:15], s40 offen lds
s_add_u32 s40, s54, 36864
s_add_u32 m0, s55, 21504
s_nop 0
buffer_load_dwordx4 v36, s[12:15], s40 offen lds
s_add_u32 m0, s55, 22528
s_nop 0
buffer_load_dwordx4 v37, s[12:15], s40 offen lds
s_add_u32 m0, s55, 23552
s_nop 0
buffer_load_dwordx4 v38, s[12:15], s40 offen lds
s_add_u32 s40, s54, 73728
s_add_u32 m0, s55, 24576
s_nop 0
buffer_load_dwordx4 v36, s[12:15], s40 offen lds
s_add_u32 m0, s55, 25600
s_nop 0
buffer_load_dwordx4 v37, s[12:15], s40 offen lds
s_add_u32 m0, s55, 26624
s_nop 0
buffer_load_dwordx4 v38, s[12:15], s40 offen lds
s_add_u32 s40, s54, 110592
s_add_u32 m0, s55, 27648
s_nop 0
buffer_load_dwordx4 v36, s[12:15], s40 offen lds
s_add_u32 m0, s55, 28672
s_nop 0
buffer_load_dwordx4 v37, s[12:15], s40 offen lds
s_add_u32 m0, s55, 29696
s_nop 0
buffer_load_dwordx4 v38, s[12:15], s40 offen lds
s_add_u32 s40, s54, 147456
s_add_u32 m0, s55, 30720
s_nop 0
buffer_load_dwordx4 v36, s[12:15], s40 offen lds
s_add_u32 m0, s55, 31744
s_nop 0
buffer_load_dwordx4 v37, s[12:15], s40 offen lds
s_add_u32 m0, s55, 32768
s_nop 0
buffer_load_dwordx4 v38, s[12:15], s40 offen lds
s_add_u32 s40, s54, 184320
s_add_u32 m0, s55, 33792
s_nop 0
buffer_load_dwordx4 v36, s[12:15], s40 offen lds
s_add_u32 m0, s55, 34816
s_nop 0
buffer_load_dwordx4 v37, s[12:15], s40 offen lds
s_add_u32 m0, s55, 35840
s_nop 0
buffer_load_dwordx4 v38, s[12:15], s40 offen lds
v_add_u32 v39, s55, v39
s_waitcnt vmcnt(41)
buffer_load_ushort v60, v44, s[20:23], s54 offen
buffer_load_ushort v61, v45, s[20:23], s54 offen
buffer_load_ushort v62, v46, s[20:23], s54 offen
buffer_load_ushort v63, v47, s[20:23], s54 offen
buffer_load_ushort v64, v48, s[20:23], s54 offen
buffer_load_ushort v65, v44, s[20:23], s54 offen offset:32
buffer_load_ushort v66, v45, s[20:23], s54 offen offset:32
buffer_load_ushort v67, v46, s[20:23], s54 offen offset:32
buffer_load_ushort v68, v47, s[20:23], s54 offen offset:32
buffer_load_ushort v69, v48, s[20:23], s54 offen offset:32
buffer_load_ushort v70, v44, s[20:23], s54 offen offset:64
buffer_load_ushort v71, v45, s[20:23], s54 offen offset:64
buffer_load_ushort v192, v46, s[20:23], s54 offen offset:64
buffer_load_ushort v193, v47, s[20:23], s54 offen offset:64
buffer_load_ushort v220, v48, s[20:23], s54 offen offset:64
v_lshlrev_b32 v3, 5, v43
s_add_u32 s41, s33, 0
v_add_u32 v3, s41, v3
s_mov_b32 s42, 58835169
v_mul_hi_u32 v4, v3, s42
v_mul_u32_u24 v2, 73, v4
v_sub_u32 v2, v3, v2
v_mul_u32_u24 v2, 2688, v2
s_mov_b32 s42, 1373568
v_mul_lo_u32 v4, v4, s42
s_mul_i32 s42, s32, 96
v_add3_u32 v2, v2, v4, s42
v_cmp_gt_u32 vcc, s34, v3
v_mov_b32 v4, 1879048192
s_nop 0
v_cndmask_b32 v2, v4, v2, vcc
s_waitcnt vmcnt(55)
v_add_u32 v5, v2, v53
buffer_load_dwordx4 v[76:79], v5, s[4:7], 0 offen
buffer_load_dwordx4 v[80:83], v5, s[4:7], 0 offen offset:16
buffer_load_dwordx4 v[96:99], v5, s[4:7], 0 offen offset:32
buffer_load_dwordx4 v[100:103], v5, s[4:7], 0 offen offset:48
buffer_load_dwordx4 v[116:119], v5, s[4:7], 0 offen offset:64
buffer_load_dwordx4 v[120:123], v5, s[4:7], 0 offen offset:80
v_add_u32 v5, v2, v54
buffer_load_dwordx4 v[84:87], v5, s[4:7], 0 offen
buffer_load_dwordx4 v[88:91], v5, s[4:7], 0 offen offset:16
buffer_load_dwordx4 v[104:107], v5, s[4:7], 0 offen offset:32
buffer_load_dwordx4 v[108:111], v5, s[4:7], 0 offen offset:48
buffer_load_dwordx4 v[124:127], v5, s[4:7], 0 offen offset:64
buffer_load_dwordx4 v[128:131], v5, s[4:7], 0 offen offset:80
v_add_u32 v5, v2, v55
buffer_load_dwordx4 v[72:75], v5, s[4:7], 0 offen
buffer_load_dwordx4 v[92:95], v5, s[4:7], 0 offen offset:32
buffer_load_dwordx4 v[112:115], v5, s[4:7], 0 offen offset:64
v_lshlrev_b32 v3, 5, v43
s_add_u32 s41, s33, 512
v_add_u32 v3, s41, v3
s_mov_b32 s42, 58835169
v_mul_hi_u32 v4, v3, s42
v_mul_u32_u24 v2, 73, v4
v_sub_u32 v2, v3, v2
v_mul_u32_u24 v2, 2688, v2
s_mov_b32 s42, 1373568
v_mul_lo_u32 v4, v4, s42
s_mul_i32 s42, s32, 96
v_add3_u32 v2, v2, v4, s42
v_cmp_gt_u32 vcc, s34, v3
v_mov_b32 v4, 1879048192
s_nop 0
v_cndmask_b32 v2, v4, v2, vcc
v_add_u32 v5, v2, v53
buffer_load_dwordx4 v[136:139], v5, s[4:7], 0 offen
buffer_load_dwordx4 v[140:143], v5, s[4:7], 0 offen offset:16
buffer_load_dwordx4 v[156:159], v5, s[4:7], 0 offen offset:32
buffer_load_dwordx4 v[160:163], v5, s[4:7], 0 offen offset:48
buffer_load_dwordx4 v[176:179], v5, s[4:7], 0 offen offset:64
buffer_load_dwordx4 v[180:183], v5, s[4:7], 0 offen offset:80
v_add_u32 v5, v2, v54
buffer_load_dwordx4 v[144:147], v5, s[4:7], 0 offen
buffer_load_dwordx4 v[148:151], v5, s[4:7], 0 offen offset:16
buffer_load_dwordx4 v[164:167], v5, s[4:7], 0 offen offset:32
buffer_load_dwordx4 v[168:171], v5, s[4:7], 0 offen offset:48
buffer_load_dwordx4 v[184:187], v5, s[4:7], 0 offen offset:64
buffer_load_dwordx4 v[188:191], v5, s[4:7], 0 offen offset:80
v_add_u32 v5, v2, v55
buffer_load_dwordx4 v[132:135], v5, s[4:7], 0 offen
buffer_load_dwordx4 v[152:155], v5, s[4:7], 0 offen offset:32
buffer_load_dwordx4 v[172:175], v5, s[4:7], 0 offen offset:64
v_add_u32 v194, s54, v194
v_add_u32 v195, s54, v195
v_add_u32 v196, s54, v196
v_add_u32 v197, s54, v197
v_add_u32 v198, s54, v198
v_add_u32 v199, s54, v199
v_add_u32 v200, s54, v200
v_add_u32 v201, s54, v201
v_add_u32 v202, s54, v202
v_add_u32 v203, s54, v203
v_add_u32 v204, s54, v204
v_add_u32 v205, s54, v205
v_add_u32 v217, s54, v217
v_add_u32 v211, s45, v211
s_lshr_b32 s41, s32, 1
s_lshl_b32 s41, s41, 10
s_and_b32 s42, s32, 1
s_lshl_b32 s42, s42, 3
s_add_u32 s41, s41, s42
v_add_u32 v212, s41, v212
s_lshl_b32 s41, s32, 2
v_add_u32 v213, s41, v213
s_lshl_b32 s41, s32, 9
v_add_u32 v214, s41, v214
v_add_u32 v215, s41, v215
s_lshl_b32 s41, s32, 7
v_add_u32 v216, s41, v216
s_mul_i32 s41, s32, 4752
v_add_u32 v218, s41, v218
s_waitcnt vmcnt(62)
v_mov_b32 v222, v209
ds_read_b64_tr_b16 a[0:1], v39
ds_read_b64_tr_b16 a[24:25], v39 offset:32
ds_read_b64_tr_b16 a[48:49], v39 offset:64
ds_read_b64_tr_b16 a[2:3], v39 offset:1536
ds_read_b64_tr_b16 a[26:27], v39 offset:1568
ds_read_b64_tr_b16 a[50:51], v39 offset:1600
ds_read_b64_tr_b16 a[16:17], v39 offset:3072
ds_read_b64_tr_b16 a[40:41], v39 offset:3104
ds_read_b64_tr_b16 a[64:65], v39 offset:3136
s_waitcnt vmcnt(62)
ds_read_b64_tr_b16 a[4:5], v39 offset:4608
ds_read_b64_tr_b16 a[28:29], v39 offset:4640
ds_read_b64_tr_b16 a[52:53], v39 offset:4672
ds_read_b64_tr_b16 a[6:7], v39 offset:6144
ds_read_b64_tr_b16 a[30:31], v39 offset:6176
ds_read_b64_tr_b16 a[54:55], v39 offset:6208
ds_read_b64_tr_b16 a[18:19], v39 offset:7680
ds_read_b64_tr_b16 a[42:43], v39 offset:7712
ds_read_b64_tr_b16 a[66:67], v39 offset:7744
ds_read_b64_tr_b16 a[8:9], v39 offset:9216
ds_read_b64_tr_b16 a[32:33], v39 offset:9248
ds_read_b64_tr_b16 a[56:57], v39 offset:9280
s_waitcnt vmcnt(62)
ds_read_b64_tr_b16 a[10:11], v39 offset:10752
ds_read_b64_tr_b16 a[34:35], v39 offset:10784
ds_read_b64_tr_b16 a[58:59], v39 offset:10816
ds_read_b64_tr_b16 a[20:21], v39 offset:12288
ds_read_b64_tr_b16 a[44:45], v39 offset:12320
ds_read_b64_tr_b16 a[68:69], v39 offset:12352
ds_read_b64_tr_b16 a[12:13], v39 offset:13824
ds_read_b64_tr_b16 a[36:37], v39 offset:13856
ds_read_b64_tr_b16 a[60:61], v39 offset:13888
ds_read_b64_tr_b16 a[14:15], v39 offset:15360
ds_read_b64_tr_b16 a[38:39], v39 offset:15392
ds_read_b64_tr_b16 a[62:63], v39 offset:15424
s_waitcnt vmcnt(62)
ds_read_b64_tr_b16 a[22:23], v39 offset:16896
ds_read_b64_tr_b16 a[46:47], v39 offset:16928
ds_read_b64_tr_b16 a[70:71], v39 offset:16960
s_add_u32 s40, s54, 768
s_add_u32 m0, s55, 0
s_waitcnt lgkmcnt(0)
buffer_load_dwordx4 v36, s[12:15], s40 offen lds
s_add_u32 m0, s55, 1024
s_nop 0
buffer_load_dwordx4 v37, s[12:15], s40 offen lds
s_add_u32 m0, s55, 2048
s_nop 0
buffer_load_dwordx4 v38, s[12:15], s40 offen lds
s_add_u32 s40, s54, 37632
s_add_u32 m0, s55, 3072
s_nop 0
buffer_load_dwordx4 v36, s[12:15], s40 offen lds
s_add_u32 m0, s55, 4096
s_nop 0
buffer_load_dwordx4 v37, s[12:15], s40 offen lds
s_add_u32 m0, s55, 5120
s_nop 0
buffer_load_dwordx4 v38, s[12:15], s40 offen lds
s_add_u32 s40, s54, 74496
s_add_u32 m0, s55, 6144
s_nop 0
buffer_load_dwordx4 v36, s[12:15], s40 offen lds
s_add_u32 m0, s55, 7168
s_nop 0
buffer_load_dwordx4 v37, s[12:15], s40 offen lds
s_add_u32 m0, s55, 8192
s_nop 0
buffer_load_dwordx4 v38, s[12:15], s40 offen lds
s_add_u32 s40, s54, 111360
s_add_u32 m0, s55, 9216
s_nop 0
buffer_load_dwordx4 v36, s[12:15], s40 offen lds
s_add_u32 m0, s55, 10240
s_nop 0
buffer_load_dwordx4 v37, s[12:15], s40 offen lds
s_add_u32 m0, s55, 11264
s_nop 0
buffer_load_dwordx4 v38, s[12:15], s40 offen lds
s_add_u32 s40, s54, 148224
s_add_u32 m0, s55, 12288
s_nop 0
buffer_load_dwordx4 v36, s[12:15], s40 offen lds
s_add_u32 m0, s55, 13312
s_nop 0
buffer_load_dwordx4 v37, s[12:15], s40 offen lds
s_add_u32 m0, s55, 14336
s_nop 0
buffer_load_dwordx4 v38, s[12:15], s40 offen lds
s_add_u32 s40, s54, 185088
s_add_u32 m0, s55, 15360
s_nop 0
buffer_load_dwordx4 v36, s[12:15], s40 offen lds
s_add_u32 m0, s55, 16384
s_nop 0
buffer_load_dwordx4 v37, s[12:15], s40 offen lds
s_add_u32 m0, s55, 17408
s_nop 0
buffer_load_dwordx4 v38, s[12:15], s40 offen lds
s_mov_b32 s43, 1045773205
s_waitcnt vmcnt(62)
ds_read_b64_tr_b16 v[0:1], v39 offset:18432
ds_read_b64_tr_b16 v[2:3], v39 offset:18464
ds_read_b64_tr_b16 v[4:5], v39 offset:18496
ds_read_b64_tr_b16 v[6:7], v39 offset:19968
ds_read_b64_tr_b16 v[8:9], v39 offset:20000
ds_read_b64_tr_b16 v[10:11], v39 offset:20032
ds_read_b64_tr_b16 v[12:13], v39 offset:21504
ds_read_b64_tr_b16 v[14:15], v39 offset:21536
ds_read_b64_tr_b16 v[16:17], v39 offset:21568
ds_read_b64_tr_b16 v[18:19], v39 offset:23040
ds_read_b64_tr_b16 v[20:21], v39 offset:23072
ds_read_b64_tr_b16 v[22:23], v39 offset:23104
s_waitcnt vmcnt(62) lgkmcnt(11)
ds_read_b64_tr_b16 v[24:25], v39 offset:24576
ds_read_b64_tr_b16 v[26:27], v39 offset:24608
ds_read_b64_tr_b16 v[28:29], v39 offset:24640
ds_read_b64_tr_b16 v[30:31], v39 offset:26112
ds_read_b64_tr_b16 v[32:33], v39 offset:26144
ds_read_b64_tr_b16 v[34:35], v39 offset:26176
v_lshlrev_b32 v221, 16, v0
v_and_b32 v0, 4294901760, v0
v_mul_f32 v221, s43, v221
v_mul_f32 v0, s43, v0
v_cvt_pk_bf16_f32 v0, v221, v0
v_accvgpr_write_b32 a216, v0
v_lshlrev_b32 v221, 16, v1
v_and_b32 v1, 4294901760, v1
v_mul_f32 v221, s43, v221
v_mul_f32 v1, s43, v1
v_cvt_pk_bf16_f32 v1, v221, v1
v_accvgpr_write_b32 a217, v1
s_waitcnt lgkmcnt(14)
v_lshlrev_b32 v221, 16, v2
v_and_b32 v2, 4294901760, v2
v_mul_f32 v221, s43, v221
v_mul_f32 v2, s43, v2
v_cvt_pk_bf16_f32 v2, v221, v2
v_accvgpr_write_b32 a240, v2
v_lshlrev_b32 v221, 16, v3
v_and_b32 v3, 4294901760, v3
v_mul_f32 v221, s43, v221
v_mul_f32 v3, s43, v3
v_cvt_pk_bf16_f32 v3, v221, v3
v_accvgpr_write_b32 a241, v3
s_waitcnt lgkmcnt(14)
v_lshlrev_b32 v221, 16, v4
v_and_b32 v4, 4294901760, v4
v_mul_f32 v221, s43, v221
v_mul_f32 v4, s43, v4
v_cvt_pk_bf16_f32 v232, v221, v4
v_lshlrev_b32 v221, 16, v5
v_and_b32 v5, 4294901760, v5
v_mul_f32 v221, s43, v221
v_mul_f32 v5, s43, v5
v_cvt_pk_bf16_f32 v233, v221, v5
s_waitcnt lgkmcnt(14)
v_lshlrev_b32 v221, 16, v6
v_and_b32 v6, 4294901760, v6
v_mul_f32 v221, s43, v221
v_mul_f32 v6, s43, v6
v_cvt_pk_bf16_f32 v6, v221, v6
v_accvgpr_write_b32 a218, v6
v_lshlrev_b32 v221, 16, v7
v_and_b32 v7, 4294901760, v7
v_mul_f32 v221, s43, v221
v_mul_f32 v7, s43, v7
v_cvt_pk_bf16_f32 v7, v221, v7
v_accvgpr_write_b32 a219, v7
s_waitcnt lgkmcnt(13)
v_lshlrev_b32 v221, 16, v8
v_and_b32 v8, 4294901760, v8
v_mul_f32 v221, s43, v221
v_mul_f32 v8, s43, v8
v_cvt_pk_bf16_f32 v8, v221, v8
v_accvgpr_write_b32 a242, v8
v_lshlrev_b32 v221, 16, v9
v_and_b32 v9, 4294901760, v9
v_mul_f32 v221, s43, v221
v_mul_f32 v9, s43, v9
v_cvt_pk_bf16_f32 v9, v221, v9
v_accvgpr_write_b32 a243, v9
s_waitcnt lgkmcnt(12)
v_lshlrev_b32 v221, 16, v10
v_and_b32 v10, 4294901760, v10
v_mul_f32 v221, s43, v221
v_mul_f32 v10, s43, v10
v_cvt_pk_bf16_f32 v234, v221, v10
v_lshlrev_b32 v221, 16, v11
v_and_b32 v11, 4294901760, v11
v_mul_f32 v221, s43, v221
v_mul_f32 v11, s43, v11
v_cvt_pk_bf16_f32 v235, v221, v11
s_waitcnt lgkmcnt(11)
v_lshlrev_b32 v221, 16, v12
v_and_b32 v12, 4294901760, v12
v_mul_f32 v221, s43, v221
v_mul_f32 v12, s43, v12
v_cvt_pk_bf16_f32 v12, v221, v12
v_accvgpr_write_b32 a232, v12
v_lshlrev_b32 v221, 16, v13
v_and_b32 v13, 4294901760, v13
v_mul_f32 v221, s43, v221
v_mul_f32 v13, s43, v13
v_cvt_pk_bf16_f32 v13, v221, v13
v_accvgpr_write_b32 a233, v13
s_waitcnt lgkmcnt(10)
v_lshlrev_b32 v221, 16, v14
v_and_b32 v14, 4294901760, v14
v_mul_f32 v221, s43, v221
v_mul_f32 v14, s43, v14
v_cvt_pk_bf16_f32 v224, v221, v14
v_lshlrev_b32 v221, 16, v15
v_and_b32 v15, 4294901760, v15
v_mul_f32 v221, s43, v221
v_mul_f32 v15, s43, v15
v_cvt_pk_bf16_f32 v225, v221, v15
s_waitcnt lgkmcnt(9)
v_lshlrev_b32 v221, 16, v16
v_and_b32 v16, 4294901760, v16
v_mul_f32 v221, s43, v221
v_mul_f32 v16, s43, v16
v_cvt_pk_bf16_f32 v248, v221, v16
v_lshlrev_b32 v221, 16, v17
v_and_b32 v17, 4294901760, v17
v_mul_f32 v221, s43, v221
v_mul_f32 v17, s43, v17
v_cvt_pk_bf16_f32 v249, v221, v17
s_waitcnt lgkmcnt(8)
v_lshlrev_b32 v221, 16, v18
v_and_b32 v18, 4294901760, v18
v_mul_f32 v221, s43, v221
v_mul_f32 v18, s43, v18
v_cvt_pk_bf16_f32 v18, v221, v18
v_accvgpr_write_b32 a220, v18
v_lshlrev_b32 v221, 16, v19
v_and_b32 v19, 4294901760, v19
v_mul_f32 v221, s43, v221
v_mul_f32 v19, s43, v19
v_cvt_pk_bf16_f32 v19, v221, v19
v_accvgpr_write_b32 a221, v19
s_waitcnt lgkmcnt(7)
v_lshlrev_b32 v221, 16, v20
v_and_b32 v20, 4294901760, v20
v_mul_f32 v221, s43, v221
v_mul_f32 v20, s43, v20
v_cvt_pk_bf16_f32 v20, v221, v20
v_accvgpr_write_b32 a244, v20
v_lshlrev_b32 v221, 16, v21
v_and_b32 v21, 4294901760, v21
v_mul_f32 v221, s43, v221
v_mul_f32 v21, s43, v21
v_cvt_pk_bf16_f32 v21, v221, v21
v_accvgpr_write_b32 a245, v21
s_waitcnt lgkmcnt(6)
v_lshlrev_b32 v221, 16, v22
v_and_b32 v22, 4294901760, v22
v_mul_f32 v221, s43, v221
v_mul_f32 v22, s43, v22
v_cvt_pk_bf16_f32 v236, v221, v22
v_lshlrev_b32 v221, 16, v23
v_and_b32 v23, 4294901760, v23
v_mul_f32 v221, s43, v221
v_mul_f32 v23, s43, v23
v_cvt_pk_bf16_f32 v237, v221, v23
s_waitcnt lgkmcnt(5)
v_lshlrev_b32 v221, 16, v24
v_and_b32 v24, 4294901760, v24
v_mul_f32 v221, s43, v221
v_mul_f32 v24, s43, v24
v_cvt_pk_bf16_f32 v24, v221, v24
v_accvgpr_write_b32 a222, v24
v_lshlrev_b32 v221, 16, v25
v_and_b32 v25, 4294901760, v25
v_mul_f32 v221, s43, v221
v_mul_f32 v25, s43, v25
v_cvt_pk_bf16_f32 v25, v221, v25
v_accvgpr_write_b32 a223, v25
s_waitcnt lgkmcnt(4)
v_lshlrev_b32 v221, 16, v26
v_and_b32 v26, 4294901760, v26
v_mul_f32 v221, s43, v221
v_mul_f32 v26, s43, v26
v_cvt_pk_bf16_f32 v26, v221, v26
v_accvgpr_write_b32 a246, v26
v_lshlrev_b32 v221, 16, v27
v_and_b32 v27, 4294901760, v27
v_mul_f32 v221, s43, v221
v_mul_f32 v27, s43, v27
v_cvt_pk_bf16_f32 v27, v221, v27
v_accvgpr_write_b32 a247, v27
s_waitcnt lgkmcnt(3)
v_lshlrev_b32 v221, 16, v28
v_and_b32 v28, 4294901760, v28
v_mul_f32 v221, s43, v221
v_mul_f32 v28, s43, v28
v_cvt_pk_bf16_f32 v238, v221, v28
v_lshlrev_b32 v221, 16, v29
v_and_b32 v29, 4294901760, v29
v_mul_f32 v221, s43, v221
v_mul_f32 v29, s43, v29
v_cvt_pk_bf16_f32 v239, v221, v29
s_waitcnt lgkmcnt(2)
v_lshlrev_b32 v221, 16, v30
v_and_b32 v30, 4294901760, v30
v_mul_f32 v221, s43, v221
v_mul_f32 v30, s43, v30
v_cvt_pk_bf16_f32 v30, v221, v30
v_accvgpr_write_b32 a234, v30
v_lshlrev_b32 v221, 16, v31
v_and_b32 v31, 4294901760, v31
v_mul_f32 v221, s43, v221
v_mul_f32 v31, s43, v31
v_cvt_pk_bf16_f32 v31, v221, v31
v_accvgpr_write_b32 a235, v31
s_waitcnt lgkmcnt(1)
v_lshlrev_b32 v221, 16, v32
v_and_b32 v32, 4294901760, v32
v_mul_f32 v221, s43, v221
v_mul_f32 v32, s43, v32
v_cvt_pk_bf16_f32 v226, v221, v32
v_lshlrev_b32 v221, 16, v33
v_and_b32 v33, 4294901760, v33
v_mul_f32 v221, s43, v221
v_mul_f32 v33, s43, v33
v_cvt_pk_bf16_f32 v227, v221, v33
s_waitcnt lgkmcnt(0)
v_lshlrev_b32 v221, 16, v34
v_and_b32 v34, 4294901760, v34
v_mul_f32 v221, s43, v221
v_mul_f32 v34, s43, v34
v_cvt_pk_bf16_f32 v250, v221, v34
v_lshlrev_b32 v221, 16, v35
v_and_b32 v35, 4294901760, v35
v_mul_f32 v221, s43, v221
v_mul_f32 v35, s43, v35
v_cvt_pk_bf16_f32 v251, v221, v35
s_waitcnt vmcnt(62)
ds_read_b64_tr_b16 v[0:1], v39 offset:27648
ds_read_b64_tr_b16 v[2:3], v39 offset:27680
ds_read_b64_tr_b16 v[4:5], v39 offset:27712
ds_read_b64_tr_b16 v[6:7], v39 offset:29184
ds_read_b64_tr_b16 v[8:9], v39 offset:29216
ds_read_b64_tr_b16 v[10:11], v39 offset:29248
ds_read_b64_tr_b16 v[12:13], v39 offset:30720
ds_read_b64_tr_b16 v[14:15], v39 offset:30752
ds_read_b64_tr_b16 v[16:17], v39 offset:30784
ds_read_b64_tr_b16 v[18:19], v39 offset:32256
ds_read_b64_tr_b16 v[20:21], v39 offset:32288
ds_read_b64_tr_b16 v[22:23], v39 offset:32320
s_waitcnt vmcnt(62)
ds_read_b64_tr_b16 v[24:25], v39 offset:33792
ds_read_b64_tr_b16 v[26:27], v39 offset:33824
ds_read_b64_tr_b16 v[28:29], v39 offset:33856
ds_read_b64_tr_b16 v[30:31], v39 offset:35328
ds_read_b64_tr_b16 v[32:33], v39 offset:35360
ds_read_b64_tr_b16 v[34:35], v39 offset:35392
s_add_u32 s40, s54, 0
s_add_u32 m0, s55, 18432
s_waitcnt lgkmcnt(0)
buffer_load_dwordx4 v40, s[16:19], s40 offen lds
s_add_u32 m0, s55, 19456
s_nop 0
buffer_load_dwordx4 v41, s[16:19], s40 offen lds
s_add_u32 m0, s55, 20480
s_nop 0
buffer_load_dwordx4 v42, s[16:19], s40 offen lds
s_add_u32 s40, s54, 12288
s_add_u32 m0, s55, 21504
s_nop 0
buffer_load_dwordx4 v40, s[16:19], s40 offen lds
s_add_u32 m0, s55, 22528
s_nop 0
buffer_load_dwordx4 v41, s[16:19], s40 offen lds
s_add_u32 m0, s55, 23552
s_nop 0
buffer_load_dwordx4 v42, s[16:19], s40 offen lds
s_add_u32 s40, s54, 24576
s_add_u32 m0, s55, 24576
s_nop 0
buffer_load_dwordx4 v40, s[16:19], s40 offen lds
s_add_u32 m0, s55, 25600
s_nop 0
buffer_load_dwordx4 v41, s[16:19], s40 offen lds
s_add_u32 m0, s55, 26624
s_nop 0
buffer_load_dwordx4 v42, s[16:19], s40 offen lds
s_add_u32 s40, s54, 36864
s_add_u32 m0, s55, 27648
s_nop 0
buffer_load_dwordx4 v40, s[16:19], s40 offen lds
s_add_u32 m0, s55, 28672
s_nop 0
buffer_load_dwordx4 v41, s[16:19], s40 offen lds
s_add_u32 m0, s55, 29696
s_nop 0
buffer_load_dwordx4 v42, s[16:19], s40 offen lds
s_add_u32 s40, s54, 49152
s_add_u32 m0, s55, 30720
s_nop 0
buffer_load_dwordx4 v40, s[16:19], s40 offen lds
s_add_u32 m0, s55, 31744
s_nop 0
buffer_load_dwordx4 v41, s[16:19], s40 offen lds
s_add_u32 m0, s55, 32768
s_nop 0
buffer_load_dwordx4 v42, s[16:19], s40 offen lds
s_add_u32 s40, s54, 61440
s_add_u32 m0, s55, 33792
s_nop 0
buffer_load_dwordx4 v40, s[16:19], s40 offen lds
s_add_u32 m0, s55, 34816
s_nop 0
buffer_load_dwordx4 v41, s[16:19], s40 offen lds
s_add_u32 m0, s55, 35840
s_nop 0
buffer_load_dwordx4 v42, s[16:19], s40 offen lds
v_lshlrev_b32 v221, 16, v0
v_and_b32 v0, 4294901760, v0
v_mul_f32 v221, s43, v221
v_mul_f32 v0, s43, v0
v_cvt_pk_bf16_f32 v0, v221, v0
v_accvgpr_write_b32 a224, v0
v_lshlrev_b32 v221, 16, v1
v_and_b32 v1, 4294901760, v1
v_mul_f32 v221, s43, v221
v_mul_f32 v1, s43, v1
v_cvt_pk_bf16_f32 v1, v221, v1
v_accvgpr_write_b32 a225, v1
v_lshlrev_b32 v221, 16, v2
v_and_b32 v2, 4294901760, v2
v_mul_f32 v221, s43, v221
v_mul_f32 v2, s43, v2
v_cvt_pk_bf16_f32 v2, v221, v2
v_accvgpr_write_b32 a248, v2
v_lshlrev_b32 v221, 16, v3
v_and_b32 v3, 4294901760, v3
v_mul_f32 v221, s43, v221
v_mul_f32 v3, s43, v3
v_cvt_pk_bf16_f32 v3, v221, v3
v_accvgpr_write_b32 a249, v3
v_lshlrev_b32 v221, 16, v4
v_and_b32 v4, 4294901760, v4
v_mul_f32 v221, s43, v221
v_mul_f32 v4, s43, v4
v_cvt_pk_bf16_f32 v240, v221, v4
v_lshlrev_b32 v221, 16, v5
v_and_b32 v5, 4294901760, v5
v_mul_f32 v221, s43, v221
v_mul_f32 v5, s43, v5
v_cvt_pk_bf16_f32 v241, v221, v5
v_lshlrev_b32 v221, 16, v6
v_and_b32 v6, 4294901760, v6
v_mul_f32 v221, s43, v221
v_mul_f32 v6, s43, v6
v_cvt_pk_bf16_f32 v6, v221, v6
v_accvgpr_write_b32 a226, v6
v_lshlrev_b32 v221, 16, v7
v_and_b32 v7, 4294901760, v7
v_mul_f32 v221, s43, v221
v_mul_f32 v7, s43, v7
v_cvt_pk_bf16_f32 v7, v221, v7
v_accvgpr_write_b32 a227, v7
v_lshlrev_b32 v221, 16, v8
v_and_b32 v8, 4294901760, v8
v_mul_f32 v221, s43, v221
v_mul_f32 v8, s43, v8
v_cvt_pk_bf16_f32 v8, v221, v8
v_accvgpr_write_b32 a250, v8
v_lshlrev_b32 v221, 16, v9
v_and_b32 v9, 4294901760, v9
v_mul_f32 v221, s43, v221
v_mul_f32 v9, s43, v9
v_cvt_pk_bf16_f32 v9, v221, v9
v_accvgpr_write_b32 a251, v9
v_lshlrev_b32 v221, 16, v10
v_and_b32 v10, 4294901760, v10
v_mul_f32 v221, s43, v221
v_mul_f32 v10, s43, v10
v_cvt_pk_bf16_f32 v242, v221, v10
v_lshlrev_b32 v221, 16, v11
v_and_b32 v11, 4294901760, v11
v_mul_f32 v221, s43, v221
v_mul_f32 v11, s43, v11
v_cvt_pk_bf16_f32 v243, v221, v11
v_lshlrev_b32 v221, 16, v12
v_and_b32 v12, 4294901760, v12
v_mul_f32 v221, s43, v221
v_mul_f32 v12, s43, v12
v_cvt_pk_bf16_f32 v12, v221, v12
v_accvgpr_write_b32 a236, v12
v_lshlrev_b32 v221, 16, v13
v_and_b32 v13, 4294901760, v13
v_mul_f32 v221, s43, v221
v_mul_f32 v13, s43, v13
v_cvt_pk_bf16_f32 v13, v221, v13
v_accvgpr_write_b32 a237, v13
v_lshlrev_b32 v221, 16, v14
v_and_b32 v14, 4294901760, v14
v_mul_f32 v221, s43, v221
v_mul_f32 v14, s43, v14
v_cvt_pk_bf16_f32 v228, v221, v14
v_lshlrev_b32 v221, 16, v15
v_and_b32 v15, 4294901760, v15
v_mul_f32 v221, s43, v221
v_mul_f32 v15, s43, v15
v_cvt_pk_bf16_f32 v229, v221, v15
v_lshlrev_b32 v221, 16, v16
v_and_b32 v16, 4294901760, v16
v_mul_f32 v221, s43, v221
v_mul_f32 v16, s43, v16
v_cvt_pk_bf16_f32 v252, v221, v16
v_lshlrev_b32 v221, 16, v17
v_and_b32 v17, 4294901760, v17
v_mul_f32 v221, s43, v221
v_mul_f32 v17, s43, v17
v_cvt_pk_bf16_f32 v253, v221, v17
v_lshlrev_b32 v221, 16, v18
v_and_b32 v18, 4294901760, v18
v_mul_f32 v221, s43, v221
v_mul_f32 v18, s43, v18
v_cvt_pk_bf16_f32 v18, v221, v18
v_accvgpr_write_b32 a228, v18
v_lshlrev_b32 v221, 16, v19
v_and_b32 v19, 4294901760, v19
v_mul_f32 v221, s43, v221
v_mul_f32 v19, s43, v19
v_cvt_pk_bf16_f32 v19, v221, v19
v_accvgpr_write_b32 a229, v19
v_lshlrev_b32 v221, 16, v20
v_and_b32 v20, 4294901760, v20
v_mul_f32 v221, s43, v221
v_mul_f32 v20, s43, v20
v_cvt_pk_bf16_f32 v20, v221, v20
v_accvgpr_write_b32 a252, v20
v_lshlrev_b32 v221, 16, v21
v_and_b32 v21, 4294901760, v21
v_mul_f32 v221, s43, v221
v_mul_f32 v21, s43, v21
v_cvt_pk_bf16_f32 v21, v221, v21
v_accvgpr_write_b32 a253, v21
v_lshlrev_b32 v221, 16, v22
v_and_b32 v22, 4294901760, v22
v_mul_f32 v221, s43, v221
v_mul_f32 v22, s43, v22
v_cvt_pk_bf16_f32 v244, v221, v22
v_lshlrev_b32 v221, 16, v23
v_and_b32 v23, 4294901760, v23
v_mul_f32 v221, s43, v221
v_mul_f32 v23, s43, v23
v_cvt_pk_bf16_f32 v245, v221, v23
v_lshlrev_b32 v221, 16, v24
v_and_b32 v24, 4294901760, v24
v_mul_f32 v221, s43, v221
v_mul_f32 v24, s43, v24
v_cvt_pk_bf16_f32 v24, v221, v24
v_accvgpr_write_b32 a230, v24
v_lshlrev_b32 v221, 16, v25
v_and_b32 v25, 4294901760, v25
v_mul_f32 v221, s43, v221
v_mul_f32 v25, s43, v25
v_cvt_pk_bf16_f32 v25, v221, v25
v_accvgpr_write_b32 a231, v25
v_lshlrev_b32 v221, 16, v26
v_and_b32 v26, 4294901760, v26
v_mul_f32 v221, s43, v221
v_mul_f32 v26, s43, v26
v_cvt_pk_bf16_f32 v26, v221, v26
v_accvgpr_write_b32 a254, v26
v_lshlrev_b32 v221, 16, v27
v_and_b32 v27, 4294901760, v27
v_mul_f32 v221, s43, v221
v_mul_f32 v27, s43, v27
v_cvt_pk_bf16_f32 v27, v221, v27
v_accvgpr_write_b32 a255, v27
v_lshlrev_b32 v221, 16, v28
v_and_b32 v28, 4294901760, v28
v_mul_f32 v221, s43, v221
v_mul_f32 v28, s43, v28
v_cvt_pk_bf16_f32 v246, v221, v28
v_lshlrev_b32 v221, 16, v29
v_and_b32 v29, 4294901760, v29
v_mul_f32 v221, s43, v221
v_mul_f32 v29, s43, v29
v_cvt_pk_bf16_f32 v247, v221, v29
v_lshlrev_b32 v221, 16, v30
v_and_b32 v30, 4294901760, v30
v_mul_f32 v221, s43, v221
v_mul_f32 v30, s43, v30
v_cvt_pk_bf16_f32 v30, v221, v30
v_accvgpr_write_b32 a238, v30
v_lshlrev_b32 v221, 16, v31
v_and_b32 v31, 4294901760, v31
v_mul_f32 v221, s43, v221
v_mul_f32 v31, s43, v31
v_cvt_pk_bf16_f32 v31, v221, v31
v_accvgpr_write_b32 a239, v31
v_lshlrev_b32 v221, 16, v32
v_and_b32 v32, 4294901760, v32
v_mul_f32 v221, s43, v221
v_mul_f32 v32, s43, v32
v_cvt_pk_bf16_f32 v230, v221, v32
v_lshlrev_b32 v221, 16, v33
v_and_b32 v33, 4294901760, v33
v_mul_f32 v221, s43, v221
v_mul_f32 v33, s43, v33
v_cvt_pk_bf16_f32 v231, v221, v33
v_lshlrev_b32 v221, 16, v34
v_and_b32 v34, 4294901760, v34
v_mul_f32 v221, s43, v221
v_mul_f32 v34, s43, v34
v_cvt_pk_bf16_f32 v254, v221, v34
v_lshlrev_b32 v221, 16, v35
v_and_b32 v35, 4294901760, v35
v_mul_f32 v221, s43, v221
v_mul_f32 v35, s43, v35
v_cvt_pk_bf16_f32 v255, v221, v35
s_waitcnt vmcnt(30)
ds_read_b64_tr_b16 a[72:73], v39
ds_read_b64_tr_b16 a[96:97], v39 offset:32
ds_read_b64_tr_b16 a[120:121], v39 offset:64
ds_read_b64_tr_b16 a[74:75], v39 offset:1536
ds_read_b64_tr_b16 a[98:99], v39 offset:1568
ds_read_b64_tr_b16 a[122:123], v39 offset:1600
ds_read_b64_tr_b16 a[88:89], v39 offset:3072
ds_read_b64_tr_b16 a[112:113], v39 offset:3104
ds_read_b64_tr_b16 a[136:137], v39 offset:3136
ds_read_b64_tr_b16 a[76:77], v39 offset:4608
ds_read_b64_tr_b16 a[100:101], v39 offset:4640
ds_read_b64_tr_b16 a[124:125], v39 offset:4672
s_waitcnt vmcnt(24)
ds_read_b64_tr_b16 a[78:79], v39 offset:6144
ds_read_b64_tr_b16 a[102:103], v39 offset:6176
ds_read_b64_tr_b16 a[126:127], v39 offset:6208
ds_read_b64_tr_b16 a[90:91], v39 offset:7680
ds_read_b64_tr_b16 a[114:115], v39 offset:7712
ds_read_b64_tr_b16 a[138:139], v39 offset:7744
ds_read_b64_tr_b16 a[80:81], v39 offset:9216
ds_read_b64_tr_b16 a[104:105], v39 offset:9248
ds_read_b64_tr_b16 a[128:129], v39 offset:9280
ds_read_b64_tr_b16 a[82:83], v39 offset:10752
ds_read_b64_tr_b16 a[106:107], v39 offset:10784
ds_read_b64_tr_b16 a[130:131], v39 offset:10816
s_waitcnt vmcnt(18)
ds_read_b64_tr_b16 a[92:93], v39 offset:12288
ds_read_b64_tr_b16 a[116:117], v39 offset:12320
ds_read_b64_tr_b16 a[140:141], v39 offset:12352
ds_read_b64_tr_b16 a[84:85], v39 offset:13824
ds_read_b64_tr_b16 a[108:109], v39 offset:13856
ds_read_b64_tr_b16 a[132:133], v39 offset:13888
ds_read_b64_tr_b16 a[86:87], v39 offset:15360
ds_read_b64_tr_b16 a[110:111], v39 offset:15392
ds_read_b64_tr_b16 a[134:135], v39 offset:15424
ds_read_b64_tr_b16 a[94:95], v39 offset:16896
ds_read_b64_tr_b16 a[118:119], v39 offset:16928
ds_read_b64_tr_b16 a[142:143], v39 offset:16960
s_waitcnt vmcnt(12)
ds_read_b64_tr_b16 a[144:145], v39 offset:18432
ds_read_b64_tr_b16 a[168:169], v39 offset:18464
ds_read_b64_tr_b16 a[192:193], v39 offset:18496
ds_read_b64_tr_b16 a[146:147], v39 offset:19968
ds_read_b64_tr_b16 a[170:171], v39 offset:20000
ds_read_b64_tr_b16 a[194:195], v39 offset:20032
ds_read_b64_tr_b16 a[160:161], v39 offset:21504
ds_read_b64_tr_b16 a[184:185], v39 offset:21536
ds_read_b64_tr_b16 a[208:209], v39 offset:21568
ds_read_b64_tr_b16 a[148:149], v39 offset:23040
ds_read_b64_tr_b16 a[172:173], v39 offset:23072
ds_read_b64_tr_b16 a[196:197], v39 offset:23104
s_waitcnt vmcnt(6)
ds_read_b64_tr_b16 a[150:151], v39 offset:24576
ds_read_b64_tr_b16 a[174:175], v39 offset:24608
ds_read_b64_tr_b16 a[198:199], v39 offset:24640
ds_read_b64_tr_b16 a[162:163], v39 offset:26112
ds_read_b64_tr_b16 a[186:187], v39 offset:26144
ds_read_b64_tr_b16 a[210:211], v39 offset:26176
ds_read_b64_tr_b16 a[152:153], v39 offset:27648
ds_read_b64_tr_b16 a[176:177], v39 offset:27680
ds_read_b64_tr_b16 a[200:201], v39 offset:27712
ds_read_b64_tr_b16 a[154:155], v39 offset:29184
ds_read_b64_tr_b16 a[178:179], v39 offset:29216
ds_read_b64_tr_b16 a[202:203], v39 offset:29248
s_waitcnt vmcnt(0)
ds_read_b64_tr_b16 a[164:165], v39 offset:30720
ds_read_b64_tr_b16 a[188:189], v39 offset:30752
ds_read_b64_tr_b16 a[212:213], v39 offset:30784
ds_read_b64_tr_b16 a[156:157], v39 offset:32256
ds_read_b64_tr_b16 a[180:181], v39 offset:32288
ds_read_b64_tr_b16 a[204:205], v39 offset:32320
ds_read_b64_tr_b16 a[158:159], v39 offset:33792
ds_read_b64_tr_b16 a[182:183], v39 offset:33824
ds_read_b64_tr_b16 a[206:207], v39 offset:33856
ds_read_b64_tr_b16 a[166:167], v39 offset:35328
ds_read_b64_tr_b16 a[190:191], v39 offset:35360
ds_read_b64_tr_b16 a[214:215], v39 offset:35392
s_waitcnt lgkmcnt(0)
s_barrier
s_mul_hi_u32 s41, s35, 58835169
s_mul_i32 s42, s41, 73
s_sub_u32 s42, s35, s42
s_mul_i32 s43, s41, 1373568
s_mul_i32 s51, s42, 2688
s_add_u32 s43, s43, s51
s_cmp_lt_u32 s35, s34
s_cselect_b32 s36, s43, 1879048192
s_add_u32 s35, s35, 32
s_cmp_eq_u32 s42, 0
s_cselect_b32 s44, 536870911, s72
s_cmp_eq_u32 s42, 72
s_cselect_b32 s44, 939524095, s44
v_and_b32 v209, s44, v208
s_cmp_eq_u32 s41, 0
s_cselect_b32 s40, 1879048192, s36
s_add_u32 m0, s45, 0
s_nop 0
buffer_load_dwordx4 v209, s[4:7], s40 offen nt lds
s_add_u32 s40, s36, 196224
s_add_u32 m0, s45, 4112
s_nop 0
buffer_load_dwordx4 v209, s[4:7], s40 offen nt lds
s_add_u32 s40, s36, 392448
s_add_u32 m0, s45, 8224
s_nop 0
buffer_load_dwordx4 v209, s[4:7], s40 offen nt lds
s_add_u32 s40, s36, 588672
s_add_u32 m0, s45, 12336
s_nop 0
buffer_load_dwordx4 v209, s[4:7], s40 offen nt lds
s_add_u32 s40, s36, 784896
s_add_u32 m0, s45, 16448
s_nop 0
buffer_load_dwordx4 v209, s[4:7], s40 offen nt lds
s_add_u32 s40, s36, 981120
s_add_u32 m0, s45, 20560
s_nop 0
buffer_load_dwordx4 v209, s[4:7], s40 offen nt lds
s_add_u32 s40, s36, 1177344
s_add_u32 m0, s45, 24672
s_nop 0
buffer_load_dwordx4 v209, s[4:7], s40 offen nt lds
s_add_u32 s40, s36, 1373568
s_add_u32 m0, s45, 28784
s_nop 0
buffer_load_dwordx4 v209, s[4:7], s40 offen nt lds
s_add_u32 s40, s36, 1569792
s_add_u32 m0, s45, 32896
s_nop 0
buffer_load_dwordx4 v209, s[4:7], s40 offen nt lds
v_and_or_b32 v64, v64, v51, v52
v_lshl_or_b32 v64, v64, 16, v64
v_and_b32 v24, v64, v56
v_and_b32 v25, v64, v57
v_and_b32 v26, v64, v58
v_and_b32 v27, v64, v59
ds_write_b128 v218, v[24:27]
s_nop 0
v_mfma_f32_16x16x32_bf16 v[0:3], v[24:27], v[72:75], 0
v_mfma_f32_16x16x32_bf16 v[12:15], v[24:27], v[132:135], 0
v_and_b32 v28, v60, v49
v_and_b32 v29, v60, v50
v_and_b32 v30, v61, v49
v_and_b32 v31, v61, v50
ds_write_b128 v218, v[28:31] offset:528
s_nop 0
v_smfmac_f32_16x16x64_bf16 v[0:3], v[28:31], v[76:83], v207
v_smfmac_f32_16x16x64_bf16 v[12:15], v[28:31], v[136:143], v207
v_and_b32 v32, v62, v49
v_and_b32 v33, v62, v50
v_and_b32 v34, v63, v49
v_and_b32 v35, v63, v50
ds_write_b128 v218, v[32:35] offset:1056
s_nop 0
v_smfmac_f32_16x16x64_bf16 v[0:3], v[32:35], v[84:91], v207
v_smfmac_f32_16x16x64_bf16 v[12:15], v[32:35], v[144:151], v207
v_and_or_b32 v69, v69, v51, v52
v_lshl_or_b32 v69, v69, 16, v69
v_and_b32 v24, v69, v56
v_and_b32 v25, v69, v57
v_and_b32 v26, v69, v58
v_and_b32 v27, v69, v59
ds_write_b128 v218, v[24:27] offset:1584
s_nop 0
v_mfma_f32_16x16x32_bf16 v[4:7], v[24:27], v[92:95], 0
v_mfma_f32_16x16x32_bf16 v[16:19], v[24:27], v[152:155], 0
v_and_b32 v28, v65, v49
v_and_b32 v29, v65, v50
v_and_b32 v30, v66, v49
v_and_b32 v31, v66, v50
ds_write_b128 v218, v[28:31] offset:2112
s_nop 0
v_smfmac_f32_16x16x64_bf16 v[4:7], v[28:31], v[96:103], v207
v_smfmac_f32_16x16x64_bf16 v[16:19], v[28:31], v[156:163], v207
v_and_b32 v32, v67, v49
v_and_b32 v33, v67, v50
v_and_b32 v34, v68, v49
v_and_b32 v35, v68, v50
ds_write_b128 v218, v[32:35] offset:2640
s_nop 0
v_smfmac_f32_16x16x64_bf16 v[4:7], v[32:35], v[104:111], v207
v_smfmac_f32_16x16x64_bf16 v[16:19], v[32:35], v[164:171], v207
v_and_or_b32 v220, v220, v51, v52
v_lshl_or_b32 v220, v220, 16, v220
v_and_b32 v24, v220, v56
v_and_b32 v25, v220, v57
v_and_b32 v26, v220, v58
v_and_b32 v27, v220, v59
ds_write_b128 v218, v[24:27] offset:3168
s_nop 0
v_mfma_f32_16x16x32_bf16 v[8:11], v[24:27], v[112:115], 0
v_mfma_f32_16x16x32_bf16 v[20:23], v[24:27], v[172:175], 0
v_and_b32 v28, v70, v49
v_and_b32 v29, v70, v50
v_and_b32 v30, v71, v49
v_and_b32 v31, v71, v50
ds_write_b128 v218, v[28:31] offset:3696
s_nop 0
v_smfmac_f32_16x16x64_bf16 v[8:11], v[28:31], v[116:123], v207
v_smfmac_f32_16x16x64_bf16 v[20:23], v[28:31], v[176:183], v207
v_and_b32 v32, v192, v49
v_and_b32 v33, v192, v50
v_and_b32 v34, v193, v49
v_and_b32 v35, v193, v50
ds_write_b128 v218, v[32:35] offset:4224
s_nop 0
v_smfmac_f32_16x16x64_bf16 v[8:11], v[32:35], v[124:131], v207
v_smfmac_f32_16x16x64_bf16 v[20:23], v[32:35], v[184:191], v207
v_mov_b32 v36, 0
v_mov_b32 v37, 145088
ds_write_b32 v37, v36
v_add_f32 v118, v0, v1
v_mul_f32 v119, v0, v0
v_add_f32 v118, v118, v2
v_fmac_f32 v119, v1, v1
v_add_f32 v118, v118, v3
v_fmac_f32 v119, v2, v2
v_fmac_f32 v119, v3, v3
v_add_f32 v126, v12, v13
v_mul_f32 v127, v12, v12
v_add_f32 v126, v126, v14
v_fmac_f32 v127, v13, v13
v_add_f32 v126, v126, v15
v_fmac_f32 v127, v14, v14
v_fmac_f32 v127, v15, v15
v_add_f32 v118, v118, v4
v_fmac_f32 v119, v4, v4
v_add_f32 v118, v118, v5
v_fmac_f32 v119, v5, v5
v_add_f32 v118, v118, v6
v_fmac_f32 v119, v6, v6
v_add_f32 v118, v118, v7
v_fmac_f32 v119, v7, v7
v_add_f32 v126, v126, v16
v_fmac_f32 v127, v16, v16
v_add_f32 v126, v126, v17
v_fmac_f32 v127, v17, v17
v_add_f32 v126, v126, v18
v_fmac_f32 v127, v18, v18
v_add_f32 v126, v126, v19
v_fmac_f32 v127, v19, v19
v_add_f32 v118, v118, v8
v_fmac_f32 v119, v8, v8
v_add_f32 v118, v118, v9
v_fmac_f32 v119, v9, v9
v_add_f32 v118, v118, v10
v_fmac_f32 v119, v10, v10
v_add_f32 v118, v118, v11
v_fmac_f32 v119, v11, v11
v_add_f32 v126, v126, v20
v_fmac_f32 v127, v20, v20
v_add_f32 v126, v126, v21
v_fmac_f32 v127, v21, v21
v_add_f32 v126, v126, v22
v_fmac_f32 v127, v22, v22
v_add_f32 v126, v126, v23
v_fmac_f32 v127, v23, v23
v_permlane16_swap_b32 v118, v119
v_add_f32 v118, v118, v119
v_permlane16_swap_b32 v126, v127
v_add_f32 v126, v126, v127
s_nop 1
v_permlane32_swap_b32 v118, v126
v_add_f32 v118, v118, v126
ds_write_b32 v213, v118
s_waitcnt lgkmcnt(0)
s_barrier
ds_read_b128 v[174:177], v210 offset:55296
ds_read_b128 v[178:181], v210 offset:56320
s_waitcnt lgkmcnt(1)
v_add_f32 v174, v174, v175
s_waitcnt lgkmcnt(0)
v_add_f32 v178, v178, v179
v_add_f32 v176, v176, v177
v_add_f32 v180, v180, v181
v_add_f32 v174, v174, v176
v_add_f32 v178, v178, v180
v_mul_f32 v175, s48, v174
v_mul_f32 v178, s48, v178
v_fma_f32 v178, -v175, v175, v178
v_max_f32 v178, 0, v178
v_add_f32 v178, s49, v178
v_rsq_f32 v174, v178
s_nop 0
v_mul_f32_e64 v175, -v175, v174
ds_write_b64 v214, v[174:175]
ds_read_b64 v[118:119], v215
ds_read_b64 v[126:127], v215 offset:128
s_waitcnt lgkmcnt(1)
v_fma_f32 v108, v0, v118, v119
v_fma_f32 v109, v1, v118, v119
v_cvt_pk_bf16_f32 v90, v108, v109
v_fma_f32 v110, v2, v118, v119
v_fma_f32 v111, v3, v118, v119
v_cvt_pk_bf16_f32 v91, v110, v111
v_fma_f32 v112, v4, v118, v119
v_fma_f32 v113, v5, v118, v119
v_cvt_pk_bf16_f32 v92, v112, v113
v_fma_f32 v108, v6, v118, v119
v_fma_f32 v109, v7, v118, v119
v_cvt_pk_bf16_f32 v93, v108, v109
ds_write_b128 v211, v[90:93] offset:18432
v_fma_f32 v110, v8, v118, v119
v_fma_f32 v111, v9, v118, v119
v_cvt_pk_bf16_f32 v94, v110, v111
v_fma_f32 v112, v10, v118, v119
v_fma_f32 v113, v11, v118, v119
v_cvt_pk_bf16_f32 v95, v112, v113
ds_write_b64 v212, v[94:95] offset:18432
s_waitcnt lgkmcnt(2)
v_fma_f32 v108, v12, v126, v127
v_fma_f32 v109, v13, v126, v127
v_cvt_pk_bf16_f32 v102, v108, v109
v_fma_f32 v110, v14, v126, v127
v_fma_f32 v111, v15, v126, v127
v_cvt_pk_bf16_f32 v103, v110, v111
v_fma_f32 v112, v16, v126, v127
v_fma_f32 v113, v17, v126, v127
v_cvt_pk_bf16_f32 v104, v112, v113
v_fma_f32 v108, v18, v126, v127
v_fma_f32 v109, v19, v126, v127
v_cvt_pk_bf16_f32 v105, v108, v109
ds_write_b128 v211, v[102:105] offset:24576
v_fma_f32 v110, v20, v126, v127
v_fma_f32 v111, v21, v126, v127
v_cvt_pk_bf16_f32 v106, v110, v111
v_fma_f32 v112, v22, v126, v127
v_fma_f32 v113, v23, v126, v127
v_cvt_pk_bf16_f32 v107, v112, v113
ds_write_b64 v212, v[106:107] offset:24576
v_subrev_u32 v38, 56128, v210
buffer_store_dwordx4 v[0:3], v38, s[24:27], s50 offen
buffer_store_dwordx4 v[4:7], v38, s[24:27], s50 offen offset:1024
buffer_store_dwordx4 v[8:11], v38, s[24:27], s50 offen offset:2048
buffer_store_dwordx4 v[12:15], v38, s[24:27], s50 offen offset:3072
s_add_u32 s41, s50, 4096
buffer_store_dwordx4 v[16:19], v38, s[24:27], s41 offen
buffer_store_dwordx4 v[20:23], v38, s[24:27], s41 offen offset:1024
s_waitcnt lgkmcnt(0)
s_barrier
v_mul_u32_u24 v36, 1408, v43
v_add_u32 v37, v36, v216
v_lshrrev_b32 v38, 8, v38
v_lshlrev_b32 v38, 3, v38
s_add_u32 s41, s54, 116544
v_add3_u32 v38, v38, v36, s41
ds_read_b128 v[72:75], v210 offset:18432
ds_read_b128 v[76:79], v210 offset:19456
ds_read_b128 v[80:83], v210 offset:20480
ds_read_b128 v[84:87], v210 offset:21504
ds_read_b128 v[88:91], v210 offset:22528
ds_read_b128 v[92:95], v210 offset:23552
s_waitcnt lgkmcnt(5)
v_mfma_f32_16x16x32_bf16 v[138:141], a[216:219], v[72:75], 0
v_mfma_f32_16x16x32_bf16 v[142:145], a[240:243], v[72:75], 0
v_mfma_f32_16x16x32_bf16 v[146:149], v[232:235], v[72:75], 0
v_mfma_f32_16x16x32_bf16 v[150:153], a[0:3], v[72:75], 0
v_mfma_f32_16x16x32_bf16 v[154:157], a[24:27], v[72:75], 0
v_mfma_f32_16x16x32_bf16 v[158:161], a[48:51], v[72:75], 0
v_mfma_f32_16x16x32_bf16 v[162:165], a[72:75], v[72:75], 0
v_mfma_f32_16x16x32_bf16 v[166:169], a[96:99], v[72:75], 0
v_mfma_f32_16x16x32_bf16 v[170:173], a[120:123], v[72:75], 0
s_waitcnt lgkmcnt(4)
v_mfma_f32_16x16x32_bf16 v[138:141], a[220:223], v[76:79], v[138:141]
v_mfma_f32_16x16x32_bf16 v[142:145], a[244:247], v[76:79], v[142:145]
v_mfma_f32_16x16x32_bf16 v[146:149], v[236:239], v[76:79], v[146:149]
v_mfma_f32_16x16x32_bf16 v[150:153], a[4:7], v[76:79], v[150:153]
v_mfma_f32_16x16x32_bf16 v[154:157], a[28:31], v[76:79], v[154:157]
v_mfma_f32_16x16x32_bf16 v[158:161], a[52:55], v[76:79], v[158:161]
v_mfma_f32_16x16x32_bf16 v[162:165], a[76:79], v[76:79], v[162:165]
v_mfma_f32_16x16x32_bf16 v[166:169], a[100:103], v[76:79], v[166:169]
v_mfma_f32_16x16x32_bf16 v[170:173], a[124:127], v[76:79], v[170:173]
s_waitcnt lgkmcnt(3)
v_mfma_f32_16x16x32_bf16 v[138:141], a[224:227], v[80:83], v[138:141]
v_mfma_f32_16x16x32_bf16 v[142:145], a[248:251], v[80:83], v[142:145]
v_mfma_f32_16x16x32_bf16 v[146:149], v[240:243], v[80:83], v[146:149]
v_mfma_f32_16x16x32_bf16 v[150:153], a[8:11], v[80:83], v[150:153]
v_mfma_f32_16x16x32_bf16 v[154:157], a[32:35], v[80:83], v[154:157]
v_mfma_f32_16x16x32_bf16 v[158:161], a[56:59], v[80:83], v[158:161]
v_mfma_f32_16x16x32_bf16 v[162:165], a[80:83], v[80:83], v[162:165]
v_mfma_f32_16x16x32_bf16 v[166:169], a[104:107], v[80:83], v[166:169]
v_mfma_f32_16x16x32_bf16 v[170:173], a[128:131], v[80:83], v[170:173]
s_waitcnt lgkmcnt(2)
v_mfma_f32_16x16x32_bf16 v[138:141], a[228:231], v[84:87], v[138:141]
v_mfma_f32_16x16x32_bf16 v[142:145], a[252:255], v[84:87], v[142:145]
v_mfma_f32_16x16x32_bf16 v[146:149], v[244:247], v[84:87], v[146:149]
v_mfma_f32_16x16x32_bf16 v[150:153], a[12:15], v[84:87], v[150:153]
v_mfma_f32_16x16x32_bf16 v[154:157], a[36:39], v[84:87], v[154:157]
v_mfma_f32_16x16x32_bf16 v[158:161], a[60:63], v[84:87], v[158:161]
v_mfma_f32_16x16x32_bf16 v[162:165], a[84:87], v[84:87], v[162:165]
v_mfma_f32_16x16x32_bf16 v[166:169], a[108:111], v[84:87], v[166:169]
v_mfma_f32_16x16x32_bf16 v[170:173], a[132:135], v[84:87], v[170:173]
s_waitcnt lgkmcnt(1)
v_mfma_f32_16x16x32_bf16 v[138:141], a[232:235], v[88:91], v[138:141]
v_mfma_f32_16x16x32_bf16 v[142:145], v[224:227], v[88:91], v[142:145]
v_mfma_f32_16x16x32_bf16 v[146:149], v[248:251], v[88:91], v[146:149]
v_mfma_f32_16x16x32_bf16 v[150:153], a[16:19], v[88:91], v[150:153]
v_mfma_f32_16x16x32_bf16 v[154:157], a[40:43], v[88:91], v[154:157]
v_mfma_f32_16x16x32_bf16 v[158:161], a[64:67], v[88:91], v[158:161]
v_mfma_f32_16x16x32_bf16 v[162:165], a[88:91], v[88:91], v[162:165]
v_mfma_f32_16x16x32_bf16 v[166:169], a[112:115], v[88:91], v[166:169]
v_mfma_f32_16x16x32_bf16 v[170:173], a[136:139], v[88:91], v[170:173]
s_waitcnt lgkmcnt(0)
v_mfma_f32_16x16x32_bf16 v[138:141], a[236:239], v[92:95], v[138:141]
v_mfma_f32_16x16x32_bf16 v[142:145], v[228:231], v[92:95], v[142:145]
v_mfma_f32_16x16x32_bf16 v[146:149], v[252:255], v[92:95], v[146:149]
v_mfma_f32_16x16x32_bf16 v[150:153], a[20:23], v[92:95], v[150:153]
v_mfma_f32_16x16x32_bf16 v[154:157], a[44:47], v[92:95], v[154:157]
v_mfma_f32_16x16x32_bf16 v[158:161], a[68:71], v[92:95], v[158:161]
v_mfma_f32_16x16x32_bf16 v[162:165], a[92:95], v[92:95], v[162:165]
v_mfma_f32_16x16x32_bf16 v[166:169], a[116:119], v[92:95], v[166:169]
v_mfma_f32_16x16x32_bf16 v[170:173], a[140:143], v[92:95], v[170:173]
v_cvt_pk_bf16_f32 v96, v138, v139
v_cvt_pk_bf16_f32 v97, v140, v141
v_cvt_pk_bf16_f32 v98, v142, v143
v_cvt_pk_bf16_f32 v99, v144, v145
v_cvt_pk_bf16_f32 v100, v146, v147
v_cvt_pk_bf16_f32 v101, v148, v149
v_cvt_pk_bf16_f32 v102, v150, v151
v_cvt_pk_bf16_f32 v103, v152, v153
v_cvt_pk_bf16_f32 v104, v154, v155
v_cvt_pk_bf16_f32 v105, v156, v157
v_cvt_pk_bf16_f32 v106, v158, v159
v_cvt_pk_bf16_f32 v107, v160, v161
v_cvt_pk_bf16_f32 v108, v162, v163
v_cvt_pk_bf16_f32 v109, v164, v165
v_cvt_pk_bf16_f32 v110, v166, v167
v_cvt_pk_bf16_f32 v111, v168, v169
v_cvt_pk_bf16_f32 v112, v170, v171
v_cvt_pk_bf16_f32 v113, v172, v173
ds_write_b128 v37, v[96:99]
ds_write_b64 v37, v[100:101] offset:16
ds_write_b128 v37, v[102:105] offset:512
ds_write_b64 v37, v[106:107] offset:528
ds_write_b64 v38, v[108:109]
ds_write_b64 v38, v[110:111] offset:32
ds_write_b64 v38, v[112:113] offset:64
ds_read_b128 v[72:75], v210 offset:24576
ds_read_b128 v[76:79], v210 offset:25600
ds_read_b128 v[80:83], v210 offset:26624
ds_read_b128 v[84:87], v210 offset:27648
ds_read_b128 v[88:91], v210 offset:28672
ds_read_b128 v[92:95], v210 offset:29696
s_waitcnt lgkmcnt(5)
v_mfma_f32_16x16x32_bf16 v[138:141], a[216:219], v[72:75], 0
v_mfma_f32_16x16x32_bf16 v[142:145], a[240:243], v[72:75], 0
v_mfma_f32_16x16x32_bf16 v[146:149], v[232:235], v[72:75], 0
v_mfma_f32_16x16x32_bf16 v[150:153], a[0:3], v[72:75], 0
v_mfma_f32_16x16x32_bf16 v[154:157], a[24:27], v[72:75], 0
v_mfma_f32_16x16x32_bf16 v[158:161], a[48:51], v[72:75], 0
v_mfma_f32_16x16x32_bf16 v[162:165], a[72:75], v[72:75], 0
v_mfma_f32_16x16x32_bf16 v[166:169], a[96:99], v[72:75], 0
v_mfma_f32_16x16x32_bf16 v[170:173], a[120:123], v[72:75], 0
s_waitcnt lgkmcnt(4)
v_mfma_f32_16x16x32_bf16 v[138:141], a[220:223], v[76:79], v[138:141]
v_mfma_f32_16x16x32_bf16 v[142:145], a[244:247], v[76:79], v[142:145]
v_mfma_f32_16x16x32_bf16 v[146:149], v[236:239], v[76:79], v[146:149]
v_mfma_f32_16x16x32_bf16 v[150:153], a[4:7], v[76:79], v[150:153]
v_mfma_f32_16x16x32_bf16 v[154:157], a[28:31], v[76:79], v[154:157]
v_mfma_f32_16x16x32_bf16 v[158:161], a[52:55], v[76:79], v[158:161]
v_mfma_f32_16x16x32_bf16 v[162:165], a[76:79], v[76:79], v[162:165]
v_mfma_f32_16x16x32_bf16 v[166:169], a[100:103], v[76:79], v[166:169]
v_mfma_f32_16x16x32_bf16 v[170:173], a[124:127], v[76:79], v[170:173]
s_waitcnt lgkmcnt(3)
v_mfma_f32_16x16x32_bf16 v[138:141], a[224:227], v[80:83], v[138:141]
v_mfma_f32_16x16x32_bf16 v[142:145], a[248:251], v[80:83], v[142:145]
v_mfma_f32_16x16x32_bf16 v[146:149], v[240:243], v[80:83], v[146:149]
v_mfma_f32_16x16x32_bf16 v[150:153], a[8:11], v[80:83], v[150:153]
v_mfma_f32_16x16x32_bf16 v[154:157], a[32:35], v[80:83], v[154:157]
v_mfma_f32_16x16x32_bf16 v[158:161], a[56:59], v[80:83], v[158:161]
v_mfma_f32_16x16x32_bf16 v[162:165], a[80:83], v[80:83], v[162:165]
v_mfma_f32_16x16x32_bf16 v[166:169], a[104:107], v[80:83], v[166:169]
v_mfma_f32_16x16x32_bf16 v[170:173], a[128:131], v[80:83], v[170:173]
s_waitcnt lgkmcnt(2)
v_mfma_f32_16x16x32_bf16 v[138:141], a[228:231], v[84:87], v[138:141]
v_mfma_f32_16x16x32_bf16 v[142:145], a[252:255], v[84:87], v[142:145]
v_mfma_f32_16x16x32_bf16 v[146:149], v[244:247], v[84:87], v[146:149]
v_mfma_f32_16x16x32_bf16 v[150:153], a[12:15], v[84:87], v[150:153]
v_mfma_f32_16x16x32_bf16 v[154:157], a[36:39], v[84:87], v[154:157]
v_mfma_f32_16x16x32_bf16 v[158:161], a[60:63], v[84:87], v[158:161]
v_mfma_f32_16x16x32_bf16 v[162:165], a[84:87], v[84:87], v[162:165]
v_mfma_f32_16x16x32_bf16 v[166:169], a[108:111], v[84:87], v[166:169]
v_mfma_f32_16x16x32_bf16 v[170:173], a[132:135], v[84:87], v[170:173]
s_waitcnt lgkmcnt(1)
v_mfma_f32_16x16x32_bf16 v[138:141], a[232:235], v[88:91], v[138:141]
v_mfma_f32_16x16x32_bf16 v[142:145], v[224:227], v[88:91], v[142:145]
v_mfma_f32_16x16x32_bf16 v[146:149], v[248:251], v[88:91], v[146:149]
v_mfma_f32_16x16x32_bf16 v[150:153], a[16:19], v[88:91], v[150:153]
v_mfma_f32_16x16x32_bf16 v[154:157], a[40:43], v[88:91], v[154:157]
v_mfma_f32_16x16x32_bf16 v[158:161], a[64:67], v[88:91], v[158:161]
v_mfma_f32_16x16x32_bf16 v[162:165], a[88:91], v[88:91], v[162:165]
v_mfma_f32_16x16x32_bf16 v[166:169], a[112:115], v[88:91], v[166:169]
v_mfma_f32_16x16x32_bf16 v[170:173], a[136:139], v[88:91], v[170:173]
s_waitcnt lgkmcnt(0)
v_mfma_f32_16x16x32_bf16 v[138:141], a[236:239], v[92:95], v[138:141]
v_mfma_f32_16x16x32_bf16 v[142:145], v[228:231], v[92:95], v[142:145]
v_mfma_f32_16x16x32_bf16 v[146:149], v[252:255], v[92:95], v[146:149]
v_mfma_f32_16x16x32_bf16 v[150:153], a[20:23], v[92:95], v[150:153]
v_mfma_f32_16x16x32_bf16 v[154:157], a[44:47], v[92:95], v[154:157]
v_mfma_f32_16x16x32_bf16 v[158:161], a[68:71], v[92:95], v[158:161]
v_mfma_f32_16x16x32_bf16 v[162:165], a[92:95], v[92:95], v[162:165]
v_mfma_f32_16x16x32_bf16 v[166:169], a[116:119], v[92:95], v[166:169]
v_mfma_f32_16x16x32_bf16 v[170:173], a[140:143], v[92:95], v[170:173]
v_cvt_pk_bf16_f32 v96, v138, v139
v_cvt_pk_bf16_f32 v97, v140, v141
v_cvt_pk_bf16_f32 v98, v142, v143
v_cvt_pk_bf16_f32 v99, v144, v145
v_cvt_pk_bf16_f32 v100, v146, v147
v_cvt_pk_bf16_f32 v101, v148, v149
v_cvt_pk_bf16_f32 v102, v150, v151
v_cvt_pk_bf16_f32 v103, v152, v153
v_cvt_pk_bf16_f32 v104, v154, v155
v_cvt_pk_bf16_f32 v105, v156, v157
v_cvt_pk_bf16_f32 v106, v158, v159
v_cvt_pk_bf16_f32 v107, v160, v161
v_cvt_pk_bf16_f32 v108, v162, v163
v_cvt_pk_bf16_f32 v109, v164, v165
v_cvt_pk_bf16_f32 v110, v166, v167
v_cvt_pk_bf16_f32 v111, v168, v169
v_cvt_pk_bf16_f32 v112, v170, v171
v_cvt_pk_bf16_f32 v113, v172, v173
s_mov_b32 exec_lo, 2031647
s_mov_b32 exec_hi, 2031647
ds_write_b128 v37, v[96:99] offset:22528
ds_write_b64 v37, v[100:101] offset:22544
ds_write_b128 v37, v[102:105] offset:23040
ds_write_b64 v37, v[106:107] offset:23056
ds_write_b64 v38, v[108:109] offset:22528
ds_write_b64 v38, v[110:111] offset:22560
ds_write_b64 v38, v[112:113] offset:22592
s_mov_b64 exec, -1
v_mov_b32 v190, 1065369472
v_mov_b32 v191, 1065369472
v_mov_b32 v192, 1065369472
v_mov_b32 v193, 1065369472
v_mov_b32 v121, 0
v_mov_b32 v129, 0
v_mov_b32 v137, 0
s_waitcnt vmcnt(0) lgkmcnt(0)
s_nop 7
s_cmp_lg_u32 s47, 0
s_cbranch_scc1 L_safe
ds_read_b128 v[174:177], v218
s_barrier
ds_read_b128 v[84:87], v200
ds_read_b128 v[92:95], v201
ds_read_b128 v[100:103], v202
ds_read_b128 v[178:181], v218 offset:528
ds_read_b128 v[88:91], v194 offset:16
ds_read_b128 v[96:99], v195 offset:16
ds_read_b128 v[104:107], v196 offset:16
s_waitcnt lgkmcnt(6)
v_mfma_f32_16x16x32_bf16 v[0:3], v[174:177], v[84:87], 0
s_waitcnt lgkmcnt(5)
ds_read_b128 v[84:87], v194
v_mfma_f32_16x16x32_bf16 v[12:15], v[174:177], v[92:95], 0
s_waitcnt lgkmcnt(5)
ds_read_b128 v[92:95], v195
s_mul_hi_u32 s41, s35, 58835169
v_mfma_f32_16x16x32_bf16 v[24:27], v[174:177], v[100:103], 0
s_waitcnt lgkmcnt(1)
ds_read_b128 v[100:103], v196
ds_read_b128 v[174:177], v218 offset:1056
s_mul_i32 s42, s41, 73
s_sub_u32 s42, s35, s42
s_mul_i32 s43, s41, 1373568
s_mul_i32 s51, s42, 2688
s_add_u32 s43, s43, s51
s_cmp_lt_u32 s35, s34
v_smfmac_f32_16x16x64_bf16 v[0:3], v[178:181], v[84:91], v207
s_waitcnt lgkmcnt(2)
ds_read_b128 v[84:87], v197
ds_read_b128 v[88:91], v197 offset:16
s_cselect_b32 s37, s43, 1879048192
s_add_u32 s35, s35, 32
s_cmp_eq_u32 s42, 0
s_cselect_b32 s44, 536870911, s72
s_cmp_eq_u32 s42, 72
v_smfmac_f32_16x16x64_bf16 v[12:15], v[178:181], v[92:99], v207
s_waitcnt lgkmcnt(3)
ds_read_b128 v[92:95], v198
ds_read_b128 v[96:99], v198 offset:16
s_cselect_b32 s44, 939524095, s44
v_and_b32 v209, s44, v208
s_cmp_eq_u32 s41, 0
s_cselect_b32 s40, 1879048192, s37
s_add_u32 m0, s45, 0
v_smfmac_f32_16x16x64_bf16 v[24:27], v[178:181], v[100:107], v207
s_waitcnt lgkmcnt(2)
ds_read_b128 v[100:103], v199
ds_read_b128 v[104:107], v199 offset:16
ds_read_b128 v[178:181], v218 offset:1584
v_smfmac_f32_16x16x64_bf16 v[0:3], v[174:177], v[84:91], v207
s_waitcnt lgkmcnt(3)
ds_read_b128 v[84:87], v200 offset:32
ds_read_b128 v[88:91], v194 offset:48
v_smfmac_f32_16x16x64_bf16 v[12:15], v[174:177], v[92:99], v207
s_waitcnt lgkmcnt(3)
ds_read_b128 v[92:95], v201 offset:32
ds_read_b128 v[96:99], v195 offset:48
s_nop 0
v_add_f32 v118, v0, v1
v_mul_f32 v119, v0, v0
v_add_f32 v118, v118, v2
v_fmac_f32 v119, v1, v1
v_add_f32 v118, v118, v3
v_fmac_f32 v119, v2, v2
v_smfmac_f32_16x16x64_bf16 v[24:27], v[174:177], v[100:107], v207
s_waitcnt lgkmcnt(3)
ds_read_b128 v[100:103], v202 offset:32
ds_read_b128 v[174:177], v218 offset:2112
ds_read_b128 v[104:107], v196 offset:48
v_fmac_f32 v119, v3, v3
v_add_f32 v126, v12, v13
v_mul_f32 v127, v12, v12
v_add_f32 v126, v126, v14
v_fmac_f32 v127, v13, v13
v_mfma_f32_16x16x32_bf16 v[4:7], v[178:181], v[84:87], 0
s_waitcnt lgkmcnt(4)
ds_read_b128 v[84:87], v194 offset:32
v_add_f32 v126, v126, v15
v_fmac_f32 v127, v14, v14
v_mfma_f32_16x16x32_bf16 v[16:19], v[178:181], v[92:95], 0
s_waitcnt lgkmcnt(3)
ds_read_b128 v[92:95], v195 offset:32
v_fmac_f32 v127, v15, v15
v_add_f32 v134, v24, v25
v_mul_f32 v135, v24, v24
v_mfma_f32_16x16x32_bf16 v[28:31], v[178:181], v[100:103], 0
s_waitcnt lgkmcnt(1)
ds_read_b128 v[100:103], v196 offset:32
ds_read_b128 v[178:181], v218 offset:2640
v_add_f32 v134, v134, v26
v_fmac_f32 v135, v25, v25
v_add_f32 v134, v134, v27
v_fmac_f32 v135, v26, v26
v_fmac_f32 v135, v27, v27
v_smfmac_f32_16x16x64_bf16 v[4:7], v[174:177], v[84:91], v207
s_waitcnt lgkmcnt(2)
ds_read_b128 v[84:87], v197 offset:32
ds_read_b128 v[88:91], v197 offset:48
v_smfmac_f32_16x16x64_bf16 v[16:19], v[174:177], v[92:99], v207
s_waitcnt lgkmcnt(3)
ds_read_b128 v[92:95], v198 offset:32
ds_read_b128 v[96:99], v198 offset:48
v_smfmac_f32_16x16x64_bf16 v[28:31], v[174:177], v[100:107], v207
s_waitcnt lgkmcnt(2)
ds_read_b128 v[100:103], v199 offset:32
ds_read_b128 v[104:107], v199 offset:48
ds_read_b128 v[174:177], v218 offset:3168
v_smfmac_f32_16x16x64_bf16 v[4:7], v[178:181], v[84:91], v207
s_waitcnt lgkmcnt(3)
ds_read_b128 v[84:87], v200 offset:64
s_nop 5
v_add_f32 v118, v118, v4
v_smfmac_f32_16x16x64_bf16 v[16:19], v[178:181], v[92:99], v207
s_waitcnt lgkmcnt(2)
ds_read_b128 v[92:95], v201 offset:64
ds_read_b128 v[88:91], v194 offset:80
v_smfmac_f32_16x16x64_bf16 v[28:31], v[178:181], v[100:107], v207
s_waitcnt lgkmcnt(2)
ds_read_b128 v[100:103], v202 offset:64
ds_read_b128 v[178:181], v218 offset:3696
v_fmac_f32 v119, v4, v4
ds_read_b128 v[96:99], v195 offset:80
ds_read_b128 v[104:107], v196 offset:80
v_mfma_f32_16x16x32_bf16 v[8:11], v[174:177], v[84:87], 0
s_waitcnt lgkmcnt(5)
ds_read_b128 v[84:87], v194 offset:64
v_add_f32 v118, v118, v5
v_fmac_f32 v119, v5, v5
v_add_f32 v118, v118, v6
v_fmac_f32 v119, v6, v6
v_add_f32 v118, v118, v7
v_mfma_f32_16x16x32_bf16 v[20:23], v[174:177], v[92:95], 0
s_waitcnt lgkmcnt(4)
ds_read_b128 v[92:95], v195 offset:64
v_fmac_f32 v119, v7, v7
v_add_f32 v126, v126, v16
v_fmac_f32 v127, v16, v16
v_add_f32 v126, v126, v17
v_mfma_f32_16x16x32_bf16 v[32:35], v[174:177], v[100:103], 0
s_waitcnt lgkmcnt(1)
ds_read_b128 v[100:103], v196 offset:64
ds_read_b128 v[174:177], v218 offset:4224
v_fmac_f32 v127, v17, v17
v_add_f32 v126, v126, v18
v_fmac_f32 v127, v18, v18
v_add_f32 v126, v126, v19
v_fmac_f32 v127, v19, v19
v_add_f32 v134, v134, v28
v_smfmac_f32_16x16x64_bf16 v[8:11], v[178:181], v[84:91], v207
s_waitcnt lgkmcnt(2)
ds_read_b128 v[84:87], v197 offset:64
ds_read_b128 v[88:91], v197 offset:80
v_fmac_f32 v135, v28, v28
v_add_f32 v134, v134, v29
v_fmac_f32 v135, v29, v29
v_add_f32 v134, v134, v30
v_fmac_f32 v135, v30, v30
v_add_f32 v134, v134, v31
v_smfmac_f32_16x16x64_bf16 v[20:23], v[178:181], v[92:99], v207
ds_read_b128 v[92:95], v198 offset:64
ds_read_b128 v[96:99], v198 offset:80
v_fmac_f32 v135, v31, v31
s_waitcnt lgkmcnt(5)
v_smfmac_f32_16x16x64_bf16 v[32:35], v[178:181], v[100:107], v207
s_waitcnt lgkmcnt(2)
ds_read_b128 v[100:103], v199 offset:64
ds_read_b128 v[104:107], v199 offset:80
v_smfmac_f32_16x16x64_bf16 v[8:11], v[174:177], v[84:91], v207
s_waitcnt lgkmcnt(2)
s_nop 6
v_add_f32 v118, v118, v8
v_fmac_f32 v119, v8, v8
v_smfmac_f32_16x16x64_bf16 v[20:23], v[174:177], v[92:99], v207
s_waitcnt lgkmcnt(0)
v_add_f32 v118, v118, v9
v_fmac_f32 v119, v9, v9
v_add_f32 v118, v118, v10
v_fmac_f32 v119, v10, v10
v_add_f32 v118, v118, v11
v_fmac_f32 v119, v11, v11
s_nop 0
v_add_f32 v126, v126, v20
v_smfmac_f32_16x16x64_bf16 v[32:35], v[174:177], v[100:107], v207
v_fmac_f32 v127, v20, v20
v_add_f32 v126, v126, v21
v_fmac_f32 v127, v21, v21
v_add_f32 v126, v126, v22
v_fmac_f32 v127, v22, v22
v_add_f32 v126, v126, v23
v_fmac_f32 v127, v23, v23
s_nop 0
v_add_f32 v134, v134, v32
v_fmac_f32 v135, v32, v32
v_add_f32 v134, v134, v33
v_fmac_f32 v135, v33, v33
v_add_f32 v134, v134, v34
v_fmac_f32 v135, v34, v34
v_add_f32 v134, v134, v35
v_permlane16_swap_b32 v118, v119
v_fmac_f32 v135, v35, v35
v_add_f32 v118, v118, v119
v_permlane16_swap_b32 v126, v127
v_add_f32 v126, v126, v127
v_permlane16_swap_b32 v134, v135
v_add_f32 v134, v134, v135
v_permlane32_swap_b32 v118, v126
v_add_f32 v118, v118, v126
v_mov_b32 v135, v134
ds_write_b32 v213, v118
s_nop 0
v_permlane32_swap_b32 v134, v135
v_add_f32 v134, v134, v135
ds_write_b32 v213, v134 offset:512
s_waitcnt lgkmcnt(0)
s_barrier
ds_read_b128 v[174:177], v210 offset:55296
ds_read_b128 v[178:181], v210 offset:56320
buffer_load_dwordx4 v209, s[4:7], s40 offen nt lds
s_add_u32 s40, s37, 196224
s_add_u32 m0, s45, 4112
s_nop 0
buffer_load_dwordx4 v209, s[4:7], s40 offen nt lds
s_add_u32 s40, s37, 392448
s_add_u32 m0, s45, 8224
s_nop 0
buffer_load_dwordx4 v209, s[4:7], s40 offen nt lds
s_add_u32 s40, s37, 588672
s_add_u32 m0, s45, 12336
s_waitcnt lgkmcnt(0)
v_add_f32 v174, v174, v175
buffer_load_dwordx4 v209, s[4:7], s40 offen nt lds
s_add_u32 s40, s37, 784896
v_add_f32 v178, v178, v179
v_add_f32 v176, v176, v177
s_add_u32 m0, s45, 16448
v_add_f32 v180, v180, v181
v_add_f32 v174, v174, v176
buffer_load_dwordx4 v209, s[4:7], s40 offen nt lds
s_add_u32 s40, s37, 981120
v_add_f32 v178, v178, v180
v_mul_f32 v175, s48, v174
s_add_u32 m0, s45, 20560
s_nop 0
buffer_load_dwordx4 v209, s[4:7], s40 offen nt lds
s_add_u32 s40, s37, 1177344
v_mul_f32 v178, s48, v178
v_fma_f32 v178, -v175, v175, v178
s_add_u32 m0, s45, 24672
v_max_f32 v178, 0, v178
v_add_f32 v178, s49, v178
buffer_load_dwordx4 v209, s[4:7], s40 offen nt lds
s_add_u32 s40, s37, 1373568
v_rsq_f32 v174, v178
s_add_u32 m0, s45, 28784
v_mul_f32_e64 v175, -v175, v174
ds_write_b64 v214, v[174:175]
ds_read_b64 v[118:119], v215
ds_read_b64 v[126:127], v215 offset:128
ds_read_b64 v[134:135], v215 offset:256
buffer_load_dwordx4 v209, s[4:7], s40 offen nt lds
s_add_u32 s40, s37, 1569792
s_add_u32 m0, s45, 32896
s_nop 0
buffer_load_dwordx4 v209, s[4:7], s40 offen nt lds
s_waitcnt lgkmcnt(2)
v_fma_f32 v108, v0, v118, v119
v_fma_f32 v109, v1, v118, v119
v_cvt_pk_bf16_f32 v90, v108, v109
v_fma_f32 v110, v2, v118, v119
v_fma_f32 v111, v3, v118, v119
v_cvt_pk_bf16_f32 v91, v110, v111
v_fma_f32 v112, v4, v118, v119
v_fma_f32 v113, v5, v118, v119
v_cvt_pk_bf16_f32 v92, v112, v113
v_fma_f32 v108, v6, v118, v119
v_fma_f32 v109, v7, v118, v119
v_cvt_pk_bf16_f32 v93, v108, v109
ds_write_b128 v211, v[90:93]
v_fma_f32 v110, v8, v118, v119
v_fma_f32 v111, v9, v118, v119
v_cvt_pk_bf16_f32 v94, v110, v111
v_fma_f32 v112, v10, v118, v119
v_fma_f32 v113, v11, v118, v119
v_cvt_pk_bf16_f32 v95, v112, v113
s_waitcnt lgkmcnt(2)
v_fma_f32 v108, v12, v126, v127
ds_write_b64 v212, v[94:95]
v_fma_f32 v109, v13, v126, v127
v_cvt_pk_bf16_f32 v102, v108, v109
v_fma_f32 v110, v14, v126, v127
v_fma_f32 v111, v15, v126, v127
v_cvt_pk_bf16_f32 v103, v110, v111
v_fma_f32 v112, v16, v126, v127
v_fma_f32 v113, v17, v126, v127
v_cvt_pk_bf16_f32 v104, v112, v113
v_fma_f32 v108, v18, v126, v127
v_fma_f32 v109, v19, v126, v127
v_cvt_pk_bf16_f32 v105, v108, v109
ds_write_b128 v211, v[102:105] offset:6144
v_fma_f32 v110, v20, v126, v127
v_fma_f32 v111, v21, v126, v127
v_cvt_pk_bf16_f32 v106, v110, v111
v_fma_f32 v112, v22, v126, v127
v_fma_f32 v113, v23, v126, v127
v_cvt_pk_bf16_f32 v107, v112, v113
ds_write_b64 v212, v[106:107] offset:6144
s_waitcnt lgkmcnt(4)
v_fma_f32 v108, v24, v134, v135
v_fma_f32 v109, v25, v134, v135
v_cvt_pk_bf16_f32 v90, v108, v109
v_fma_f32 v110, v26, v134, v135
v_fma_f32 v111, v27, v134, v135
v_cvt_pk_bf16_f32 v91, v110, v111
v_fma_f32 v112, v28, v134, v135
v_fma_f32 v113, v29, v134, v135
v_cvt_pk_bf16_f32 v92, v112, v113
v_fma_f32 v108, v30, v134, v135
v_fma_f32 v109, v31, v134, v135
v_cvt_pk_bf16_f32 v93, v108, v109
ds_write_b128 v211, v[90:93] offset:12288
v_fma_f32 v110, v32, v134, v135
v_fma_f32 v111, v33, v134, v135
v_cvt_pk_bf16_f32 v94, v110, v111
v_fma_f32 v112, v34, v134, v135
v_fma_f32 v113, v35, v134, v135
v_cvt_pk_bf16_f32 v95, v112, v113
ds_write_b64 v212, v[94:95] offset:12288
s_mov_b32 s38, s36
s_waitcnt vmcnt(0) lgkmcnt(0)
s_barrier
ds_read_b128 v[174:177], v218
s_barrier
ds_read_b128 v[84:87], v200
ds_read_b128 v[92:95], v201
ds_read_b128 v[100:103], v202
ds_read_b128 v[178:181], v218 offset:528
ds_read_b128 v[88:91], v194 offset:16
ds_read_b128 v[96:99], v195 offset:16
ds_read_b128 v[104:107], v196 offset:16
ds_read_b128 v[182:185], v210
s_waitcnt lgkmcnt(7)
v_mfma_f32_16x16x32_bf16 v[36:39], v[174:177], v[84:87], 0
s_waitcnt lgkmcnt(6)
ds_read_b128 v[84:87], v194
v_mfma_f32_16x16x32_bf16 v[48:51], v[174:177], v[92:95], 0
s_waitcnt lgkmcnt(1)
ds_read_b128 v[92:95], v195
ds_read_b128 v[186:189], v210 offset:1024
v_mfma_f32_16x16x32_bf16 v[138:141], a[0:3], v[182:185], 0
v_mfma_f32_16x16x32_bf16 v[142:145], a[24:27], v[182:185], 0
v_mfma_f32_16x16x32_bf16 v[146:149], a[48:51], v[182:185], 0
v_mfma_f32_16x16x32_bf16 v[150:153], a[216:219], v[182:185], 0
v_mfma_f32_16x16x32_bf16 v[154:157], a[240:243], v[182:185], 0
v_mfma_f32_16x16x32_bf16 v[158:161], v[232:235], v[182:185], 0
v_mfma_f32_16x16x32_bf16 v[162:165], v[182:185], a[72:75], 0
v_mfma_f32_16x16x32_bf16 v[166:169], v[182:185], a[96:99], 0
v_mfma_f32_16x16x32_bf16 v[170:173], v[182:185], a[120:123], 0
s_waitcnt lgkmcnt(0)
ds_read_b128 v[182:185], v210 offset:2048
v_mfma_f32_16x16x32_bf16 v[138:141], a[4:7], v[186:189], v[138:141]
v_mfma_f32_16x16x32_bf16 v[142:145], a[28:31], v[186:189], v[142:145]
v_mfma_f32_16x16x32_bf16 v[146:149], a[52:55], v[186:189], v[146:149]
v_mfma_f32_16x16x32_bf16 v[150:153], a[220:223], v[186:189], v[150:153]
v_mfma_f32_16x16x32_bf16 v[154:157], a[244:247], v[186:189], v[154:157]
s_mul_hi_u32 s41, s35, 58835169
v_mfma_f32_16x16x32_bf16 v[60:63], v[174:177], v[100:103], 0
ds_read_b128 v[100:103], v196
ds_read_b128 v[174:177], v218 offset:1056
v_mfma_f32_16x16x32_bf16 v[158:161], v[236:239], v[186:189], v[158:161]
s_mul_i32 s42, s41, 73
s_sub_u32 s42, s35, s42
s_mul_i32 s43, s41, 1373568
v_mfma_f32_16x16x32_bf16 v[162:165], v[186:189], a[76:79], v[162:165]
s_mul_i32 s51, s42, 2688
v_mfma_f32_16x16x32_bf16 v[166:169], v[186:189], a[100:103], v[166:169]
s_add_u32 s43, s43, s51
s_cmp_lt_u32 s35, s34
v_mfma_f32_16x16x32_bf16 v[170:173], v[186:189], a[124:127], v[170:173]
ds_read_b128 v[186:189], v210 offset:3072
v_smfmac_f32_16x16x64_bf16 v[36:39], v[178:181], v[84:91], v207
s_waitcnt lgkmcnt(3)
ds_read_b128 v[84:87], v197
ds_read_b128 v[88:91], v197 offset:16
v_mfma_f32_16x16x32_bf16 v[138:141], a[8:11], v[182:185], v[138:141]
s_cselect_b32 s36, s43, 1879048192
s_add_u32 s35, s35, 32
s_cmp_eq_u32 s42, 0
v_mfma_f32_16x16x32_bf16 v[142:145], a[32:35], v[182:185], v[142:145]
s_cselect_b32 s44, 536870911, s72
s_cmp_eq_u32 s42, 72
v_smfmac_f32_16x16x64_bf16 v[48:51], v[178:181], v[92:99], v207
ds_read_b128 v[92:95], v198
ds_read_b128 v[96:99], v198 offset:16
v_mfma_f32_16x16x32_bf16 v[146:149], a[56:59], v[182:185], v[146:149]
s_cselect_b32 s44, 939524095, s44
v_and_b32 v209, s44, v208
s_cmp_eq_u32 s41, 0
v_mfma_f32_16x16x32_bf16 v[150:153], a[224:227], v[182:185], v[150:153]
s_cselect_b32 s40, 1879048192, s36
s_add_u32 m0, s45, 0
v_mfma_f32_16x16x32_bf16 v[154:157], a[248:251], v[182:185], v[154:157]
s_waitcnt lgkmcnt(6)
v_smfmac_f32_16x16x64_bf16 v[60:63], v[178:181], v[100:107], v207
ds_read_b128 v[100:103], v199
ds_read_b128 v[104:107], v199 offset:16
v_mfma_f32_16x16x32_bf16 v[158:161], v[240:243], v[182:185], v[158:161]
ds_read_b128 v[178:181], v218 offset:1584
v_mfma_f32_16x16x32_bf16 v[162:165], v[182:185], a[80:83], v[162:165]
v_mfma_f32_16x16x32_bf16 v[166:169], v[182:185], a[104:107], v[166:169]
v_mfma_f32_16x16x32_bf16 v[170:173], v[182:185], a[128:131], v[170:173]
s_waitcnt lgkmcnt(5)
ds_read_b128 v[182:185], v210 offset:4096
v_smfmac_f32_16x16x64_bf16 v[36:39], v[174:177], v[84:91], v207
ds_read_b128 v[84:87], v200 offset:32
ds_read_b128 v[88:91], v194 offset:48
v_mfma_f32_16x16x32_bf16 v[138:141], a[12:15], v[186:189], v[138:141]
v_mfma_f32_16x16x32_bf16 v[142:145], a[36:39], v[186:189], v[142:145]
s_waitcnt lgkmcnt(6)
v_smfmac_f32_16x16x64_bf16 v[48:51], v[174:177], v[92:99], v207
ds_read_b128 v[92:95], v201 offset:32
ds_read_b128 v[96:99], v195 offset:48
v_mfma_f32_16x16x32_bf16 v[146:149], a[60:63], v[186:189], v[146:149]
v_add_f32 v118, v36, v37
v_mul_f32 v119, v36, v36
v_mfma_f32_16x16x32_bf16 v[150:153], a[228:231], v[186:189], v[150:153]
v_add_f32 v118, v118, v38
v_fmac_f32 v119, v37, v37
v_mfma_f32_16x16x32_bf16 v[154:157], a[252:255], v[186:189], v[154:157]
s_waitcnt lgkmcnt(6)
v_add_f32 v118, v118, v39
v_fmac_f32 v119, v38, v38
v_smfmac_f32_16x16x64_bf16 v[60:63], v[174:177], v[100:107], v207
ds_read_b128 v[100:103], v202 offset:32
ds_read_b128 v[174:177], v218 offset:2112
v_mfma_f32_16x16x32_bf16 v[158:161], v[244:247], v[186:189], v[158:161]
ds_read_b128 v[104:107], v196 offset:48
v_fmac_f32 v119, v39, v39
v_mfma_f32_16x16x32_bf16 v[162:165], v[186:189], a[84:87], v[162:165]
v_add_f32 v126, v48, v49
v_mul_f32 v127, v48, v48
v_mfma_f32_16x16x32_bf16 v[166:169], v[186:189], a[108:111], v[166:169]
s_waitcnt lgkmcnt(6)
v_add_f32 v126, v126, v50
v_fmac_f32 v127, v49, v49
v_mfma_f32_16x16x32_bf16 v[40:43], v[178:181], v[84:87], 0
ds_read_b128 v[84:87], v194 offset:32
v_add_f32 v126, v126, v51
v_mfma_f32_16x16x32_bf16 v[170:173], v[186:189], a[132:135], v[170:173]
s_waitcnt lgkmcnt(5)
ds_read_b128 v[186:189], v210 offset:5120
v_fmac_f32 v127, v50, v50
v_mfma_f32_16x16x32_bf16 v[52:55], v[178:181], v[92:95], 0
ds_read_b128 v[92:95], v195 offset:32
v_fmac_f32 v127, v51, v51
v_mfma_f32_16x16x32_bf16 v[138:141], a[16:19], v[182:185], v[138:141]
s_waitcnt lgkmcnt(5)
v_add_f32 v134, v60, v61
v_mul_f32 v135, v60, v60
v_mfma_f32_16x16x32_bf16 v[64:67], v[178:181], v[100:103], 0
ds_read_b128 v[100:103], v196 offset:32
ds_read_b128 v[178:181], v218 offset:2640
v_mfma_f32_16x16x32_bf16 v[142:145], a[40:43], v[182:185], v[142:145]
v_add_f32 v134, v134, v62
v_fmac_f32 v135, v61, v61
v_mfma_f32_16x16x32_bf16 v[146:149], a[64:67], v[182:185], v[146:149]
v_add_f32 v134, v134, v63
v_fmac_f32 v135, v62, v62
v_mfma_f32_16x16x32_bf16 v[150:153], a[232:235], v[182:185], v[150:153]
v_fmac_f32 v135, v63, v63
v_mfma_f32_16x16x32_bf16 v[154:157], v[224:227], v[182:185], v[154:157]
s_waitcnt lgkmcnt(4)
v_smfmac_f32_16x16x64_bf16 v[40:43], v[174:177], v[84:91], v207
ds_read_b128 v[84:87], v197 offset:32
ds_read_b128 v[88:91], v197 offset:48
v_mfma_f32_16x16x32_bf16 v[158:161], v[248:251], v[182:185], v[158:161]
v_mfma_f32_16x16x32_bf16 v[162:165], v[182:185], a[88:91], v[162:165]
v_mfma_f32_16x16x32_bf16 v[166:169], v[182:185], a[112:115], v[166:169]
s_waitcnt lgkmcnt(4)
v_smfmac_f32_16x16x64_bf16 v[52:55], v[174:177], v[92:99], v207
ds_read_b128 v[92:95], v198 offset:32
ds_read_b128 v[96:99], v198 offset:48
v_mfma_f32_16x16x32_bf16 v[170:173], v[182:185], a[136:139], v[170:173]
ds_read_b128 v[182:185], v210 offset:6144
v_mfma_f32_16x16x32_bf16 v[138:141], a[20:23], v[186:189], v[138:141]
s_waitcnt lgkmcnt(6)
v_smfmac_f32_16x16x64_bf16 v[64:67], v[174:177], v[100:107], v207
ds_read_b128 v[100:103], v199 offset:32
ds_read_b128 v[104:107], v199 offset:48
v_mfma_f32_16x16x32_bf16 v[142:145], a[44:47], v[186:189], v[142:145]
ds_read_b128 v[174:177], v218 offset:3168
v_mfma_f32_16x16x32_bf16 v[146:149], a[68:71], v[186:189], v[146:149]
s_nop 0
v_cvt_pk_bf16_f32 v78, v138, v139
v_cvt_pk_bf16_f32 v79, v140, v141
v_mfma_f32_16x16x32_bf16 v[150:153], a[236:239], v[186:189], v[150:153]
v_mfma_f32_16x16x32_bf16 v[154:157], v[228:231], v[186:189], v[154:157]
s_waitcnt lgkmcnt(6)
v_cvt_pk_bf16_f32 v80, v142, v143
v_cvt_pk_bf16_f32 v81, v144, v145
v_smfmac_f32_16x16x64_bf16 v[40:43], v[178:181], v[84:91], v207
ds_read_b128 v[84:87], v200 offset:64
v_cvt_pk_bf16_f32 v82, v146, v147
v_mfma_f32_16x16x32_bf16 v[158:161], v[252:255], v[186:189], v[158:161]
v_cvt_pk_bf16_f32 v83, v148, v149
v_cvt_pk_bf16_f32 v72, v150, v151
v_mfma_f32_16x16x32_bf16 v[162:165], v[186:189], a[92:95], v[162:165]
v_cvt_pk_bf16_f32 v73, v152, v153
v_cvt_pk_bf16_f32 v74, v154, v155
v_mfma_f32_16x16x32_bf16 v[166:169], v[186:189], a[116:119], v[166:169]
s_waitcnt lgkmcnt(5)
v_cvt_pk_bf16_f32 v75, v156, v157
v_add_f32 v118, v118, v40
v_smfmac_f32_16x16x64_bf16 v[52:55], v[178:181], v[92:99], v207
ds_read_b128 v[92:95], v201 offset:64
v_cvt_pk_bf16_f32 v76, v158, v159
v_mfma_f32_16x16x32_bf16 v[170:173], v[186:189], a[140:143], v[170:173]
s_waitcnt lgkmcnt(5)
ds_read_b128 v[186:189], v210 offset:7168
v_cvt_pk_bf16_f32 v77, v160, v161
v_mfma_f32_16x16x32_bf16 v[138:141], a[0:3], v[182:185], 0
v_cvt_pk_bf16_f32 v114, v162, v163
v_cvt_pk_bf16_f32 v115, v164, v165
v_mfma_f32_16x16x32_bf16 v[142:145], a[24:27], v[182:185], 0
s_waitcnt lgkmcnt(4)
ds_read_b128 v[88:91], v194 offset:80
v_cvt_pk_bf16_f32 v122, v166, v167
v_smfmac_f32_16x16x64_bf16 v[64:67], v[178:181], v[100:107], v207
ds_read_b128 v[100:103], v202 offset:64
ds_read_b128 v[178:181], v218 offset:3696
v_mfma_f32_16x16x32_bf16 v[146:149], a[48:51], v[182:185], 0
v_cvt_pk_bf16_f32 v123, v168, v169
v_cvt_pk_bf16_f32 v130, v170, v171
v_mfma_f32_16x16x32_bf16 v[150:153], a[216:219], v[182:185], 0
v_cvt_pk_bf16_f32 v131, v172, v173
v_fmac_f32 v119, v40, v40
v_mfma_f32_16x16x32_bf16 v[154:157], a[240:243], v[182:185], 0
s_waitcnt lgkmcnt(5)
ds_read_b128 v[96:99], v195 offset:80
ds_read_b128 v[104:107], v196 offset:80
v_mfma_f32_16x16x32_bf16 v[44:47], v[174:177], v[84:87], 0
ds_read_b128 v[84:87], v194 offset:64
v_add_f32 v118, v118, v41
v_mfma_f32_16x16x32_bf16 v[158:161], v[232:235], v[182:185], 0
v_fmac_f32 v119, v41, v41
v_add_f32 v118, v118, v42
v_mfma_f32_16x16x32_bf16 v[162:165], v[182:185], a[72:75], 0
s_waitcnt lgkmcnt(7)
v_fmac_f32 v119, v42, v42
v_add_f32 v118, v118, v43
v_mfma_f32_16x16x32_bf16 v[56:59], v[174:177], v[92:95], 0
ds_read_b128 v[92:95], v195 offset:64
v_fmac_f32 v119, v43, v43
v_mfma_f32_16x16x32_bf16 v[166:169], v[182:185], a[96:99], 0
v_add_f32 v126, v126, v52
v_fmac_f32 v127, v52, v52
v_mfma_f32_16x16x32_bf16 v[170:173], v[182:185], a[120:123], 0
s_waitcnt lgkmcnt(5)
ds_read_b128 v[182:185], v210 offset:8192
v_add_f32 v126, v126, v53
v_mfma_f32_16x16x32_bf16 v[68:71], v[174:177], v[100:103], 0
ds_read_b128 v[100:103], v196 offset:64
ds_read_b128 v[174:177], v218 offset:4224
v_mfma_f32_16x16x32_bf16 v[138:141], a[4:7], v[186:189], v[138:141]
v_fmac_f32 v127, v53, v53
v_add_f32 v126, v126, v54
v_mfma_f32_16x16x32_bf16 v[142:145], a[28:31], v[186:189], v[142:145]
v_fmac_f32 v127, v54, v54
v_add_f32 v126, v126, v55
v_mfma_f32_16x16x32_bf16 v[146:149], a[52:55], v[186:189], v[146:149]
s_waitcnt lgkmcnt(4)
v_fmac_f32 v127, v55, v55
v_add_f32 v134, v134, v64
v_smfmac_f32_16x16x64_bf16 v[44:47], v[178:181], v[84:91], v207
ds_read_b128 v[84:87], v197 offset:64
ds_read_b128 v[88:91], v197 offset:80
v_mfma_f32_16x16x32_bf16 v[150:153], a[220:223], v[186:189], v[150:153]
v_fmac_f32 v135, v64, v64
v_add_f32 v134, v134, v65
v_mfma_f32_16x16x32_bf16 v[154:157], a[244:247], v[186:189], v[154:157]
v_fmac_f32 v135, v65, v65
v_add_f32 v134, v134, v66
v_mfma_f32_16x16x32_bf16 v[158:161], v[236:239], v[186:189], v[158:161]
s_waitcnt lgkmcnt(5)
v_fmac_f32 v135, v66, v66
v_add_f32 v134, v134, v67
v_smfmac_f32_16x16x64_bf16 v[56:59], v[178:181], v[92:99], v207
ds_read_b128 v[92:95], v198 offset:64
ds_read_b128 v[96:99], v198 offset:80
v_mfma_f32_16x16x32_bf16 v[162:165], v[186:189], a[76:79], v[162:165]
v_fmac_f32 v135, v67, v67
v_mfma_f32_16x16x32_bf16 v[166:169], v[186:189], a[100:103], v[166:169]
ds_read_u16 v120, v217
ds_read_u16 v128, v217 offset:32
v_mfma_f32_16x16x32_bf16 v[170:173], v[186:189], a[124:127], v[170:173]
s_mov_b32 s46, 9
.p2align 3
F_loop:
ds_read_b128 v[186:189], v210 offset:9216
ds_read_u16 v136, v217 offset:64
s_waitcnt lgkmcnt(9)
v_smfmac_f32_16x16x64_bf16 v[68:71], v[178:181], v[100:107], v207
ds_read_b128 v[100:103], v199 offset:64
ds_read_b128 v[104:107], v199 offset:80
v_mfma_f32_16x16x32_bf16 v[138:141], a[8:11], v[182:185], v[138:141]
v_add_u32 v217, 1408, v217
v_mfma_f32_16x16x32_bf16 v[142:145], a[32:35], v[182:185], v[142:145]
v_mfma_f32_16x16x32_bf16 v[146:149], a[56:59], v[182:185], v[146:149]
s_waitcnt lgkmcnt(8)
v_smfmac_f32_16x16x64_bf16 v[44:47], v[174:177], v[84:91], v207
v_mfma_f32_16x16x32_bf16 v[150:153], a[224:227], v[182:185], v[150:153]
v_mfma_f32_16x16x32_bf16 v[154:157], a[248:251], v[182:185], v[154:157]
v_mfma_f32_16x16x32_bf16 v[158:161], v[240:243], v[182:185], v[158:161]
s_waitcnt lgkmcnt(6)
s_nop 3
v_add_f32 v118, v118, v44
v_fmac_f32 v119, v44, v44
v_smfmac_f32_16x16x64_bf16 v[56:59], v[174:177], v[92:99], v207
v_add_f32 v118, v118, v45
v_fmac_f32 v119, v45, v45
v_mfma_f32_16x16x32_bf16 v[162:165], v[182:185], a[80:83], v[162:165]
v_add_f32 v118, v118, v46
v_fmac_f32 v119, v46, v46
v_mfma_f32_16x16x32_bf16 v[166:169], v[182:185], a[104:107], v[166:169]
v_add_f32 v118, v118, v47
v_fmac_f32 v119, v47, v47
v_mfma_f32_16x16x32_bf16 v[170:173], v[182:185], a[128:131], v[170:173]
s_waitcnt lgkmcnt(0)
ds_read_b128 v[182:185], v210 offset:10240
v_add_f32 v126, v126, v56
v_smfmac_f32_16x16x64_bf16 v[68:71], v[174:177], v[100:107], v207
v_fmac_f32 v127, v56, v56
v_add_f32 v126, v126, v57
v_mfma_f32_16x16x32_bf16 v[138:141], a[12:15], v[186:189], v[138:141]
v_fmac_f32 v127, v57, v57
v_add_f32 v126, v126, v58
v_mfma_f32_16x16x32_bf16 v[142:145], a[36:39], v[186:189], v[142:145]
v_fmac_f32 v127, v58, v58
v_add_f32 v126, v126, v59
v_mfma_f32_16x16x32_bf16 v[146:149], a[60:63], v[186:189], v[146:149]
v_fmac_f32 v127, v59, v59
v_add_f32 v134, v134, v68
v_mfma_f32_16x16x32_bf16 v[150:153], a[228:231], v[186:189], v[150:153]
v_fmac_f32 v135, v68, v68
v_add_f32 v134, v134, v69
v_mfma_f32_16x16x32_bf16 v[154:157], a[252:255], v[186:189], v[154:157]
v_fmac_f32 v135, v69, v69
v_add_f32 v134, v134, v70
v_mfma_f32_16x16x32_bf16 v[158:161], v[244:247], v[186:189], v[158:161]
v_fmac_f32 v135, v70, v70
v_add_f32 v134, v134, v71
v_mfma_f32_16x16x32_bf16 v[162:165], v[186:189], a[84:87], v[162:165]
v_permlane16_swap_b32 v118, v119
v_mfma_f32_16x16x32_bf16 v[166:169], v[186:189], a[108:111], v[166:169]
v_fmac_f32 v135, v71, v71
v_add_f32 v118, v118, v119
v_mfma_f32_16x16x32_bf16 v[170:173], v[186:189], a[132:135], v[170:173]
s_waitcnt lgkmcnt(0)
ds_read_b128 v[186:189], v210 offset:11264
v_permlane16_swap_b32 v126, v127
v_mfma_f32_16x16x32_bf16 v[138:141], a[16:19], v[182:185], v[138:141]
v_add_f32 v126, v126, v127
v_permlane16_swap_b32 v134, v135
v_mfma_f32_16x16x32_bf16 v[142:145], a[40:43], v[182:185], v[142:145]
v_add_f32 v134, v134, v135
v_permlane32_swap_b32 v118, v126
v_mfma_f32_16x16x32_bf16 v[146:149], a[64:67], v[182:185], v[146:149]
v_add_f32 v118, v118, v126
v_mov_b32 v135, v134
v_mfma_f32_16x16x32_bf16 v[150:153], a[232:235], v[182:185], v[150:153]
ds_write_b32 v213, v118
v_mfma_f32_16x16x32_bf16 v[154:157], v[224:227], v[182:185], v[154:157]
v_permlane32_swap_b32 v134, v135
v_mfma_f32_16x16x32_bf16 v[158:161], v[248:251], v[182:185], v[158:161]
v_add_f32 v134, v134, v135
v_mfma_f32_16x16x32_bf16 v[162:165], v[182:185], a[88:91], v[162:165]
ds_write_b32 v213, v134 offset:512
v_mfma_f32_16x16x32_bf16 v[166:169], v[182:185], a[112:115], v[166:169]
v_mfma_f32_16x16x32_bf16 v[170:173], v[182:185], a[136:139], v[170:173]
s_waitcnt lgkmcnt(2)
ds_read_b128 v[182:185], v210 offset:12288
v_mfma_f32_16x16x32_bf16 v[138:141], a[20:23], v[186:189], v[138:141]
v_mfma_f32_16x16x32_bf16 v[142:145], a[44:47], v[186:189], v[142:145]
v_mfma_f32_16x16x32_bf16 v[146:149], a[68:71], v[186:189], v[146:149]
v_mfma_f32_16x16x32_bf16 v[150:153], a[236:239], v[186:189], v[150:153]
s_nop 4
v_cvt_pk_bf16_f32 v96, v138, v139
v_cvt_pk_bf16_f32 v97, v140, v141
v_mfma_f32_16x16x32_bf16 v[154:157], v[228:231], v[186:189], v[154:157]
s_waitcnt lgkmcnt(1)
v_cvt_pk_bf16_f32 v98, v142, v143
v_cvt_pk_bf16_f32 v99, v144, v145
v_mfma_f32_16x16x32_bf16 v[158:161], v[252:255], v[186:189], v[158:161]
s_barrier
ds_read_b128 v[174:177], v210 offset:55296
v_mfma_f32_16x16x32_bf16 v[162:165], v[186:189], a[92:95], v[162:165]
ds_read_b128 v[178:181], v210 offset:56320
buffer_load_dwordx4 v209, s[4:7], s40 offen nt lds
v_mfma_f32_16x16x32_bf16 v[166:169], v[186:189], a[116:119], v[166:169]
s_add_u32 s40, s36, 196224
v_cvt_pk_bf16_f32 v100, v146, v147
v_cvt_pk_bf16_f32 v101, v148, v149
v_mfma_f32_16x16x32_bf16 v[170:173], v[186:189], a[140:143], v[170:173]
s_add_u32 m0, s45, 4112
ds_read_b128 v[186:189], v210 offset:13312
v_cvt_pk_bf16_f32 v84, v150, v151
s_waitcnt lgkmcnt(3)
v_mfma_f32_16x16x32_bf16 v[138:141], a[0:3], v[182:185], 0
v_cvt_pk_bf16_f32 v85, v152, v153
v_cvt_pk_bf16_f32 v86, v154, v155
v_mfma_f32_16x16x32_bf16 v[142:145], a[24:27], v[182:185], 0
buffer_load_dwordx4 v209, s[4:7], s40 offen nt lds
v_mfma_f32_16x16x32_bf16 v[146:149], a[48:51], v[182:185], 0
s_add_u32 s40, s36, 392448
v_cvt_pk_bf16_f32 v87, v156, v157
v_cvt_pk_bf16_f32 v88, v158, v159
v_mfma_f32_16x16x32_bf16 v[150:153], a[216:219], v[182:185], 0
s_add_u32 m0, s45, 8224
v_cvt_pk_bf16_f32 v89, v160, v161
v_cvt_pk_bf16_f32 v116, v162, v163
v_mfma_f32_16x16x32_bf16 v[154:157], a[240:243], v[182:185], 0
v_cvt_pk_bf16_f32 v117, v164, v165
v_cvt_pk_bf16_f32 v124, v166, v167
v_mfma_f32_16x16x32_bf16 v[158:161], v[232:235], v[182:185], 0
s_waitcnt lgkmcnt(2)
buffer_load_dwordx4 v209, s[4:7], s40 offen nt lds
v_mfma_f32_16x16x32_bf16 v[162:165], v[182:185], a[72:75], 0
s_add_u32 s40, s36, 588672
v_cvt_pk_bf16_f32 v125, v168, v169
v_cvt_pk_bf16_f32 v132, v170, v171
v_mfma_f32_16x16x32_bf16 v[166:169], v[182:185], a[96:99], 0
s_add_u32 m0, s45, 12336
v_cvt_pk_bf16_f32 v133, v172, v173
v_add_f32 v174, v174, v175
v_mfma_f32_16x16x32_bf16 v[170:173], v[182:185], a[120:123], 0
s_waitcnt lgkmcnt(0)
buffer_load_dwordx4 v209, s[4:7], s40 offen nt lds
v_mfma_f32_16x16x32_bf16 v[138:141], a[4:7], v[186:189], v[138:141]
s_add_u32 s40, s36, 784896
v_add_f32 v178, v178, v179
v_add_f32 v176, v176, v177
v_mfma_f32_16x16x32_bf16 v[142:145], a[28:31], v[186:189], v[142:145]
s_add_u32 m0, s45, 16448
v_add_f32 v180, v180, v181
v_add_f32 v174, v174, v176
v_mfma_f32_16x16x32_bf16 v[146:149], a[52:55], v[186:189], v[146:149]
buffer_load_dwordx4 v209, s[4:7], s40 offen nt lds
v_mfma_f32_16x16x32_bf16 v[150:153], a[220:223], v[186:189], v[150:153]
s_add_u32 s40, s36, 981120
v_add_f32 v178, v178, v180
v_mul_f32 v175, s48, v174
v_mfma_f32_16x16x32_bf16 v[154:157], a[244:247], v[186:189], v[154:157]
s_add_u32 m0, s45, 20560
ds_read_b128 v[182:185], v210 offset:14336
buffer_load_dwordx4 v209, s[4:7], s40 offen nt lds
v_mfma_f32_16x16x32_bf16 v[158:161], v[236:239], v[186:189], v[158:161]
s_add_u32 s40, s36, 1177344
v_mul_f32 v178, s48, v178
v_fma_f32 v178, -v175, v175, v178
v_mfma_f32_16x16x32_bf16 v[162:165], v[186:189], a[76:79], v[162:165]
s_add_u32 m0, s45, 24672
v_max_f32 v178, 0, v178
v_add_f32 v178, s49, v178
v_mfma_f32_16x16x32_bf16 v[166:169], v[186:189], a[100:103], v[166:169]
s_waitcnt lgkmcnt(0)
buffer_load_dwordx4 v209, s[4:7], s40 offen nt lds
v_mfma_f32_16x16x32_bf16 v[170:173], v[186:189], a[124:127], v[170:173]
s_add_u32 s40, s36, 1373568
v_rsq_f32 v174, v178
s_add_u32 m0, s45, 28784
v_mul_f32_e64 v175, -v175, v174
ds_write_b64 v214, v[174:175]
v_mfma_f32_16x16x32_bf16 v[138:141], a[8:11], v[182:185], v[138:141]
ds_read_b64 v[118:119], v215
ds_read_b64 v[126:127], v215 offset:128
v_mfma_f32_16x16x32_bf16 v[142:145], a[32:35], v[182:185], v[142:145]
ds_read_b64 v[134:135], v215 offset:256
buffer_load_dwordx4 v209, s[4:7], s40 offen nt lds
v_mfma_f32_16x16x32_bf16 v[146:149], a[56:59], v[182:185], v[146:149]
s_add_u32 s40, s36, 1569792
ds_read_b128 v[186:189], v210 offset:15360
s_add_u32 m0, s45, 32896
v_mfma_f32_16x16x32_bf16 v[150:153], a[224:227], v[182:185], v[150:153]
buffer_load_dwordx4 v209, s[4:7], s40 offen nt lds
v_mfma_f32_16x16x32_bf16 v[154:157], a[248:251], v[182:185], v[154:157]
v_mov_b32 v181, 0
v_mfma_f32_16x16x32_bf16 v[158:161], v[240:243], v[182:185], v[158:161]
s_waitcnt lgkmcnt(3)
v_fma_f32 v108, v36, v118, v119
v_fma_f32 v109, v37, v118, v119
v_mfma_f32_16x16x32_bf16 v[162:165], v[182:185], a[80:83], v[162:165]
v_cvt_pk_bf16_f32 v90, v108, v109
v_fma_f32 v110, v38, v118, v119
v_mfma_f32_16x16x32_bf16 v[166:169], v[182:185], a[104:107], v[166:169]
v_fma_f32 v111, v39, v118, v119
v_cvt_pk_bf16_f32 v91, v110, v111
v_mfma_f32_16x16x32_bf16 v[170:173], v[182:185], a[128:131], v[170:173]
s_waitcnt lgkmcnt(0)
v_fma_f32 v112, v40, v118, v119
v_fma_f32 v113, v41, v118, v119
v_mfma_f32_16x16x32_bf16 v[138:141], a[12:15], v[186:189], v[138:141]
v_cvt_pk_bf16_f32 v92, v112, v113
v_fma_f32 v108, v42, v118, v119
v_mfma_f32_16x16x32_bf16 v[142:145], a[36:39], v[186:189], v[142:145]
v_fma_f32 v109, v43, v118, v119
v_cvt_pk_bf16_f32 v93, v108, v109
v_mfma_f32_16x16x32_bf16 v[146:149], a[60:63], v[186:189], v[146:149]
ds_write_b128 v211, v[90:93] offset:18432
v_mfma_f32_16x16x32_bf16 v[150:153], a[228:231], v[186:189], v[150:153]
ds_read_b128 v[182:185], v210 offset:16384
v_fma_f32 v110, v44, v118, v119
v_mfma_f32_16x16x32_bf16 v[154:157], a[252:255], v[186:189], v[154:157]
v_fma_f32 v111, v45, v118, v119
v_cvt_pk_bf16_f32 v94, v110, v111
v_mfma_f32_16x16x32_bf16 v[158:161], v[244:247], v[186:189], v[158:161]
v_fma_f32 v112, v46, v118, v119
v_fma_f32 v113, v47, v118, v119
v_mfma_f32_16x16x32_bf16 v[162:165], v[186:189], a[84:87], v[162:165]
v_cvt_pk_bf16_f32 v95, v112, v113
v_fma_f32 v108, v48, v126, v127
v_mfma_f32_16x16x32_bf16 v[166:169], v[186:189], a[108:111], v[166:169]
ds_write_b64 v212, v[94:95] offset:18432
v_mfma_f32_16x16x32_bf16 v[170:173], v[186:189], a[132:135], v[170:173]
v_fma_f32 v109, v49, v126, v127
v_cvt_pk_bf16_f32 v102, v108, v109
v_fma_f32 v110, v50, v126, v127
v_fma_f32 v111, v51, v126, v127
v_cvt_pk_bf16_f32 v103, v110, v111
v_fma_f32 v112, v52, v126, v127
v_fma_f32 v113, v53, v126, v127
v_cvt_pk_bf16_f32 v104, v112, v113
v_fma_f32 v108, v54, v126, v127
v_fma_f32 v109, v55, v126, v127
s_waitcnt lgkmcnt(1)
v_mfma_f32_16x16x32_bf16 v[138:141], a[16:19], v[182:185], v[138:141]
ds_read_b128 v[186:189], v210 offset:17408
v_cvt_pk_bf16_f32 v105, v108, v109
v_mfma_f32_16x16x32_bf16 v[142:145], a[40:43], v[182:185], v[142:145]
ds_write_b128 v211, v[102:105] offset:24576
v_mfma_f32_16x16x32_bf16 v[146:149], a[64:67], v[182:185], v[146:149]
v_fma_f32 v110, v56, v126, v127
v_fma_f32 v111, v57, v126, v127
v_mfma_f32_16x16x32_bf16 v[150:153], a[232:235], v[182:185], v[150:153]
v_cvt_pk_bf16_f32 v106, v110, v111
v_fma_f32 v112, v58, v126, v127
v_mfma_f32_16x16x32_bf16 v[154:157], v[224:227], v[182:185], v[154:157]
v_fma_f32 v113, v59, v126, v127
v_cvt_pk_bf16_f32 v107, v112, v113
v_mfma_f32_16x16x32_bf16 v[158:161], v[248:251], v[182:185], v[158:161]
ds_write_b64 v212, v[106:107] offset:24576
v_mfma_f32_16x16x32_bf16 v[162:165], v[182:185], a[88:91], v[162:165]
v_fma_f32 v108, v60, v134, v135
v_fma_f32 v109, v61, v134, v135
v_mfma_f32_16x16x32_bf16 v[166:169], v[182:185], a[112:115], v[166:169]
v_cvt_pk_bf16_f32 v90, v108, v109
v_fma_f32 v110, v62, v134, v135
v_mfma_f32_16x16x32_bf16 v[170:173], v[182:185], a[136:139], v[170:173]
s_waitcnt lgkmcnt(2)
v_fma_f32 v111, v63, v134, v135
v_cvt_pk_bf16_f32 v91, v110, v111
v_mfma_f32_16x16x32_bf16 v[138:141], a[20:23], v[186:189], v[138:141]
v_fma_f32 v112, v64, v134, v135
v_fma_f32 v113, v65, v134, v135
v_mfma_f32_16x16x32_bf16 v[142:145], a[44:47], v[186:189], v[142:145]
v_cvt_pk_bf16_f32 v92, v112, v113
v_fma_f32 v108, v66, v134, v135
v_mfma_f32_16x16x32_bf16 v[146:149], a[68:71], v[186:189], v[146:149]
v_fma_f32 v109, v67, v134, v135
v_cvt_pk_bf16_f32 v93, v108, v109
v_mfma_f32_16x16x32_bf16 v[150:153], a[236:239], v[186:189], v[150:153]
ds_write_b128 v211, v[90:93] offset:30720
v_mfma_f32_16x16x32_bf16 v[154:157], v[228:231], v[186:189], v[154:157]
v_fma_f32 v110, v68, v134, v135
v_fma_f32 v111, v69, v134, v135
v_mfma_f32_16x16x32_bf16 v[158:161], v[252:255], v[186:189], v[158:161]
v_cvt_pk_bf16_f32 v94, v110, v111
v_fma_f32 v112, v70, v134, v135
v_mfma_f32_16x16x32_bf16 v[162:165], v[186:189], a[92:95], v[162:165]
ds_read_b128 v[108:111], v216 offset:512
v_fma_f32 v113, v71, v134, v135
v_mfma_f32_16x16x32_bf16 v[166:169], v[186:189], a[116:119], v[166:169]
v_cvt_pk_bf16_f32 v95, v112, v113
v_cvt_pk_bf16_f32 v102, v138, v139
v_mfma_f32_16x16x32_bf16 v[170:173], v[186:189], a[140:143], v[170:173]
ds_read_b64 v[112:113], v216 offset:528
ds_write_b64 v212, v[94:95] offset:30720
v_cvt_pk_bf16_f32 v103, v140, v141
v_mfma_f32_16x16x32_bf16 v[138:141], v[78:81], v[72:75], 0
v_cvt_pk_bf16_f32 v104, v142, v143
v_cvt_pk_bf16_f32 v105, v144, v145
v_mfma_f32_16x16x32_bf16 v[142:145], v[96:99], v[72:75], 0
v_cvt_pk_bf16_f32 v106, v146, v147
v_cvt_pk_bf16_f32 v107, v148, v149
v_mfma_f32_16x16x32_bf16 v[146:149], v[102:105], v[72:75], 0
s_waitcnt lgkmcnt(2)
v_cvt_pk_bf16_f32 v90, v150, v151
v_cvt_pk_bf16_f32 v91, v152, v153
v_mfma_f32_16x16x32_bf16 v[150:153], v[108:111], v[72:75], v[206:209]
ds_read_b128 v[72:75], v216
v_cvt_pk_bf16_f32 v92, v154, v155
v_mfma_f32_16x16x16_bf16 v[138:141], v[82:83], v[76:77], v[138:141]
v_cvt_pk_bf16_f32 v93, v156, v157
v_cvt_pk_bf16_f32 v94, v158, v159
v_mfma_f32_16x16x16_bf16 v[142:145], v[100:101], v[76:77], v[142:145]
s_waitcnt lgkmcnt(2)
v_cvt_pk_bf16_f32 v95, v160, v161
v_cvt_pk_bf16_f32 v118, v162, v163
v_mfma_f32_16x16x16_bf16 v[150:153], v[112:113], v[76:77], v[150:153]
v_cvt_pk_bf16_f32 v119, v164, v165
v_cvt_pk_bf16_f32 v126, v166, v167
v_mfma_f32_16x16x16_bf16 v[146:149], v[106:107], v[76:77], v[146:149]
ds_read_b64 v[76:77], v216 offset:16
v_cvt_pk_bf16_f32 v127, v168, v169
v_mfma_f32_16x16x32_bf16 v[154:157], v[78:81], v[84:87], 0
v_cvt_pk_bf16_f32 v134, v170, v171
v_cvt_pk_bf16_f32 v135, v172, v173
v_mfma_f32_16x16x32_bf16 v[158:161], v[96:99], v[84:87], 0
v_exp_f32 v138, v138
v_mfma_f32_16x16x32_bf16 v[166:169], v[108:111], v[84:87], v[206:209]
v_exp_f32 v139, v139
v_mfma_f32_16x16x32_bf16 v[162:165], v[102:105], v[84:87], 0
v_exp_f32 v140, v140
v_mfma_f32_16x16x16_bf16 v[154:157], v[82:83], v[88:89], v[154:157]
v_exp_f32 v141, v141
v_mfma_f32_16x16x16_bf16 v[158:161], v[100:101], v[88:89], v[158:161]
v_exp_f32 v142, v142
v_mfma_f32_16x16x16_bf16 v[166:169], v[112:113], v[88:89], v[166:169]
v_exp_f32 v143, v143
v_mfma_f32_16x16x16_bf16 v[162:165], v[106:107], v[88:89], v[162:165]
v_exp_f32 v144, v144
v_exp_f32 v145, v145
v_exp_f32 v150, v150
v_exp_f32 v146, v146
v_exp_f32 v147, v147
v_exp_f32 v148, v148
v_exp_f32 v149, v149
v_cvt_pk_bf16_f32 v174, v138, v139
v_cvt_pk_bf16_f32 v175, v140, v141
v_cvt_pk_bf16_f32 v176, v142, v143
v_cvt_pk_bf16_f32 v177, v144, v145
v_cvt_pk_bf16_f32 v178, v146, v147
v_cvt_pk_bf16_f32 v179, v148, v149
v_mfma_f32_16x16x32_bf16 v[138:141], v[114:117], v[174:177], 0
v_cvt_pk_bf16_f32 v180, v150, 0
v_exp_f32 v154, v154
v_mfma_f32_16x16x32_bf16 v[150:153], v[190:193], v[174:177], 0
v_exp_f32 v155, v155
v_mfma_f32_16x16x32_bf16 v[142:145], v[122:125], v[174:177], 0
v_exp_f32 v156, v156
v_mfma_f32_16x16x32_bf16 v[146:149], v[130:133], v[174:177], 0
v_exp_f32 v157, v157
v_mfma_f32_16x16x32_bf16 v[150:153], v[190:193], v[178:181], v[150:153]
v_exp_f32 v158, v158
v_mfma_f32_16x16x32_bf16 v[138:141], v[118:121], v[178:181], v[138:141]
v_exp_f32 v159, v159
v_mfma_f32_16x16x32_bf16 v[142:145], v[126:129], v[178:181], v[142:145]
v_exp_f32 v160, v160
v_mfma_f32_16x16x32_bf16 v[146:149], v[134:137], v[178:181], v[146:149]
v_exp_f32 v161, v161
v_exp_f32 v166, v166
v_exp_f32 v162, v162
v_exp_f32 v163, v163
v_exp_f32 v164, v164
v_exp_f32 v165, v165
v_cvt_pk_bf16_f32 v174, v154, v155
v_cvt_pk_bf16_f32 v175, v156, v157
v_cvt_pk_bf16_f32 v176, v158, v159
v_cvt_pk_bf16_f32 v177, v160, v161
v_cvt_pk_bf16_f32 v178, v162, v163
v_cvt_pk_bf16_f32 v179, v164, v165
v_mfma_f32_16x16x32_bf16 v[154:157], v[114:117], v[174:177], 0
s_mov_b32 s39, s37
v_cvt_pk_bf16_f32 v180, v166, 0
v_rcp_f32 v151, v150
v_mfma_f32_16x16x32_bf16 v[166:169], v[190:193], v[174:177], 0
v_max3_u32 v219, v219, v150, v151
v_mul_f32 v138, v138, v151
v_mfma_f32_16x16x32_bf16 v[158:161], v[122:125], v[174:177], 0
v_mul_f32 v139, v139, v151
v_cvt_pk_bf16_f32 v138, v138, v139
v_mfma_f32_16x16x32_bf16 v[162:165], v[130:133], v[174:177], 0
v_mul_f32 v140, v140, v151
v_mul_f32 v141, v141, v151
v_mfma_f32_16x16x32_bf16 v[166:169], v[190:193], v[178:181], v[166:169]
v_cvt_pk_bf16_f32 v139, v140, v141
v_mul_f32 v142, v142, v151
v_mfma_f32_16x16x32_bf16 v[154:157], v[118:121], v[178:181], v[154:157]
v_mul_f32 v143, v143, v151
v_cvt_pk_bf16_f32 v140, v142, v143
v_mfma_f32_16x16x32_bf16 v[158:161], v[126:129], v[178:181], v[158:161]
v_mul_f32 v144, v144, v151
v_mul_f32 v145, v145, v151
v_mfma_f32_16x16x32_bf16 v[162:165], v[134:137], v[178:181], v[162:165]
v_cvt_pk_bf16_f32 v141, v144, v145
v_mul_f32 v146, v146, v151
v_mul_f32 v147, v147, v151
v_cvt_pk_bf16_f32 v142, v146, v147
v_mul_f32 v148, v148, v151
v_mul_f32 v149, v149, v151
v_mfma_f32_16x16x32_bf16 v[150:153], v[108:111], v[90:93], v[206:209]
ds_write_b128 v211, v[138:141] offset:36864
v_mfma_f32_16x16x32_bf16 v[138:141], v[78:81], v[90:93], 0
v_cvt_pk_bf16_f32 v143, v148, v149
v_rcp_f32 v167, v166
v_mfma_f32_16x16x32_bf16 v[146:149], v[102:105], v[90:93], 0
ds_write_b64 v212, v[142:143] offset:36864
v_mfma_f32_16x16x32_bf16 v[142:145], v[96:99], v[90:93], 0
v_max3_u32 v219, v219, v166, v167
v_mul_f32 v154, v154, v167
v_mfma_f32_16x16x16_bf16 v[138:141], v[82:83], v[94:95], v[138:141]
v_mul_f32 v155, v155, v167
v_cvt_pk_bf16_f32 v154, v154, v155
v_mfma_f32_16x16x16_bf16 v[150:153], v[112:113], v[94:95], v[150:153]
v_mul_f32 v156, v156, v167
v_mul_f32 v157, v157, v167
v_mfma_f32_16x16x16_bf16 v[142:145], v[100:101], v[94:95], v[142:145]
v_cvt_pk_bf16_f32 v155, v156, v157
v_mul_f32 v158, v158, v167
v_mfma_f32_16x16x16_bf16 v[146:149], v[106:107], v[94:95], v[146:149]
v_mul_f32 v159, v159, v167
v_cvt_pk_bf16_f32 v156, v158, v159
v_mul_f32 v160, v160, v167
v_mul_f32 v161, v161, v167
v_cvt_pk_bf16_f32 v157, v160, v161
v_mul_f32 v162, v162, v167
v_mul_f32 v163, v163, v167
v_cvt_pk_bf16_f32 v158, v162, v163
v_mul_f32 v164, v164, v167
v_mul_f32 v165, v165, v167
s_waitcnt lgkmcnt(3)
v_mfma_f32_16x16x32_bf16 v[166:169], v[108:111], v[72:75], v[206:209]
ds_write_b128 v211, v[154:157] offset:43008
v_mfma_f32_16x16x32_bf16 v[154:157], v[78:81], v[72:75], 0
v_cvt_pk_bf16_f32 v159, v164, v165
v_exp_f32 v138, v138
v_mfma_f32_16x16x32_bf16 v[162:165], v[102:105], v[72:75], 0
ds_write_b64 v212, v[158:159] offset:43008
v_mfma_f32_16x16x32_bf16 v[158:161], v[96:99], v[72:75], 0
s_waitcnt lgkmcnt(4)
v_exp_f32 v139, v139
v_mfma_f32_16x16x16_bf16 v[154:157], v[82:83], v[76:77], v[154:157]
v_exp_f32 v140, v140
v_mfma_f32_16x16x16_bf16 v[166:169], v[112:113], v[76:77], v[166:169]
v_exp_f32 v141, v141
v_mfma_f32_16x16x16_bf16 v[162:165], v[106:107], v[76:77], v[162:165]
v_exp_f32 v142, v142
v_mfma_f32_16x16x16_bf16 v[158:161], v[100:101], v[76:77], v[158:161]
s_waitcnt lgkmcnt(0)
v_exp_f32 v143, v143
v_exp_f32 v144, v144
v_exp_f32 v145, v145
v_exp_f32 v150, v150
v_exp_f32 v146, v146
v_exp_f32 v147, v147
s_barrier
ds_read_b128 v[170:173], v210 offset:36864
ds_read_b128 v[182:185], v210 offset:37888
ds_read_b128 v[186:189], v210 offset:38912
v_exp_f32 v148, v148
v_exp_f32 v149, v149
v_cvt_pk_bf16_f32 v174, v138, v139
v_cvt_pk_bf16_f32 v175, v140, v141
v_cvt_pk_bf16_f32 v176, v142, v143
v_cvt_pk_bf16_f32 v177, v144, v145
v_cvt_pk_bf16_f32 v178, v146, v147
v_cvt_pk_bf16_f32 v179, v148, v149
v_mfma_f32_16x16x32_bf16 v[138:141], v[114:117], v[174:177], 0
v_cvt_pk_bf16_f32 v180, v150, 0
v_exp_f32 v154, v154
v_mfma_f32_16x16x32_bf16 v[150:153], v[190:193], v[174:177], 0
v_exp_f32 v155, v155
v_mfma_f32_16x16x32_bf16 v[142:145], v[122:125], v[174:177], 0
s_waitcnt lgkmcnt(2)
v_exp_f32 v156, v156
v_mfma_f32_16x16x32_bf16 v[0:3], a[144:147], v[170:173], v[0:3]
v_exp_f32 v157, v157
v_mfma_f32_16x16x32_bf16 v[4:7], a[168:171], v[170:173], v[4:7]
v_exp_f32 v158, v158
v_mfma_f32_16x16x32_bf16 v[8:11], a[192:195], v[170:173], v[8:11]
s_waitcnt lgkmcnt(1)
ds_read_b128 v[170:173], v210 offset:39936
v_exp_f32 v159, v159
v_mfma_f32_16x16x32_bf16 v[0:3], a[148:151], v[182:185], v[0:3]
v_exp_f32 v160, v160
v_mfma_f32_16x16x32_bf16 v[4:7], a[172:175], v[182:185], v[4:7]
v_exp_f32 v161, v161
v_mfma_f32_16x16x32_bf16 v[8:11], a[196:199], v[182:185], v[8:11]
s_waitcnt lgkmcnt(1)
ds_read_b128 v[182:185], v210 offset:40960
v_exp_f32 v166, v166
v_mfma_f32_16x16x32_bf16 v[0:3], a[152:155], v[186:189], v[0:3]
v_exp_f32 v162, v162
v_mfma_f32_16x16x32_bf16 v[4:7], a[176:179], v[186:189], v[4:7]
v_exp_f32 v163, v163
v_mfma_f32_16x16x32_bf16 v[8:11], a[200:203], v[186:189], v[8:11]
s_waitcnt lgkmcnt(1)
ds_read_b128 v[186:189], v210 offset:41984
v_exp_f32 v164, v164
v_mfma_f32_16x16x32_bf16 v[0:3], a[156:159], v[170:173], v[0:3]
v_exp_f32 v165, v165
v_mfma_f32_16x16x32_bf16 v[4:7], a[180:183], v[170:173], v[4:7]
v_mfma_f32_16x16x32_bf16 v[8:11], a[204:207], v[170:173], v[8:11]
s_waitcnt lgkmcnt(1)
ds_read_b128 v[170:173], v210 offset:43008
v_mfma_f32_16x16x32_bf16 v[0:3], a[160:163], v[182:185], v[0:3]
v_mfma_f32_16x16x32_bf16 v[4:7], a[184:187], v[182:185], v[4:7]
v_mfma_f32_16x16x32_bf16 v[8:11], a[208:211], v[182:185], v[8:11]
ds_read_b128 v[182:185], v210 offset:44032
v_mfma_f32_16x16x32_bf16 v[146:149], v[130:133], v[174:177], 0
s_waitcnt lgkmcnt(2)
v_cvt_pk_bf16_f32 v174, v154, v155
v_cvt_pk_bf16_f32 v175, v156, v157
v_mfma_f32_16x16x32_bf16 v[0:3], a[164:167], v[186:189], v[0:3]
v_cvt_pk_bf16_f32 v176, v158, v159
v_cvt_pk_bf16_f32 v177, v160, v161
v_mfma_f32_16x16x32_bf16 v[150:153], v[190:193], v[178:181], v[150:153]
v_mfma_f32_16x16x32_bf16 v[138:141], v[118:121], v[178:181], v[138:141]
v_mfma_f32_16x16x32_bf16 v[4:7], a[188:191], v[186:189], v[4:7]
s_nop 2
v_cvt_pk_bf16_f32 v0, v0, v1
v_cvt_pk_bf16_f32 v1, v2, v3
v_mfma_f32_16x16x32_bf16 v[142:145], v[126:129], v[178:181], v[142:145]
buffer_store_dwordx2 v[0:1], v203, s[8:11], s38 offen
v_mfma_f32_16x16x32_bf16 v[8:11], a[212:215], v[186:189], v[8:11]
ds_read_b128 v[186:189], v210 offset:45056
v_rcp_f32 v151, v150
v_mfma_f32_16x16x32_bf16 v[146:149], v[134:137], v[178:181], v[146:149]
s_waitcnt lgkmcnt(2)
v_cvt_pk_bf16_f32 v4, v4, v5
v_cvt_pk_bf16_f32 v5, v6, v7
v_mfma_f32_16x16x32_bf16 v[12:15], a[144:147], v[170:173], v[12:15]
buffer_store_dwordx2 v[4:5], v203, s[8:11], s38 offen offset:32
v_mfma_f32_16x16x32_bf16 v[16:19], a[168:171], v[170:173], v[16:19]
v_cvt_pk_bf16_f32 v8, v8, v9
v_cvt_pk_bf16_f32 v9, v10, v11
v_mfma_f32_16x16x32_bf16 v[20:23], a[192:195], v[170:173], v[20:23]
s_waitcnt lgkmcnt(1)
ds_read_b128 v[170:173], v210 offset:46080
buffer_store_dwordx2 v[8:9], v203, s[8:11], s38 offen offset:64
v_mfma_f32_16x16x32_bf16 v[12:15], a[148:151], v[182:185], v[12:15]
v_cvt_pk_bf16_f32 v178, v162, v163
v_cvt_pk_bf16_f32 v179, v164, v165
v_mfma_f32_16x16x32_bf16 v[16:19], a[172:175], v[182:185], v[16:19]
v_cvt_pk_bf16_f32 v180, v166, 0
v_max3_u32 v219, v219, v150, v151
v_mfma_f32_16x16x32_bf16 v[20:23], a[196:199], v[182:185], v[20:23]
s_waitcnt lgkmcnt(1)
ds_read_b128 v[182:185], v210 offset:47104
v_mul_f32 v138, v138, v151
v_mfma_f32_16x16x32_bf16 v[12:15], a[152:155], v[186:189], v[12:15]
v_mul_f32 v139, v139, v151
v_cvt_pk_bf16_f32 v138, v138, v139
v_mfma_f32_16x16x32_bf16 v[16:19], a[176:179], v[186:189], v[16:19]
v_mul_f32 v140, v140, v151
v_mul_f32 v141, v141, v151
v_mfma_f32_16x16x32_bf16 v[20:23], a[200:203], v[186:189], v[20:23]
s_waitcnt lgkmcnt(1)
ds_read_b128 v[186:189], v210 offset:48128
v_cvt_pk_bf16_f32 v139, v140, v141
v_mfma_f32_16x16x32_bf16 v[12:15], a[156:159], v[170:173], v[12:15]
v_mul_f32 v142, v142, v151
v_mul_f32 v143, v143, v151
v_mfma_f32_16x16x32_bf16 v[16:19], a[180:183], v[170:173], v[16:19]
v_cvt_pk_bf16_f32 v140, v142, v143
v_mul_f32 v144, v144, v151
v_mfma_f32_16x16x32_bf16 v[20:23], a[204:207], v[170:173], v[20:23]
s_waitcnt lgkmcnt(1)
v_mul_f32 v145, v145, v151
v_cvt_pk_bf16_f32 v141, v144, v145
v_mfma_f32_16x16x32_bf16 v[12:15], a[160:163], v[182:185], v[12:15]
ds_write_b128 v211, v[138:141] offset:49152
v_mfma_f32_16x16x32_bf16 v[16:19], a[184:187], v[182:185], v[16:19]
v_mul_f32 v146, v146, v151
v_mul_f32 v147, v147, v151
v_mfma_f32_16x16x32_bf16 v[166:169], v[190:193], v[174:177], 0
v_cvt_pk_bf16_f32 v142, v146, v147
v_mul_f32 v148, v148, v151
v_mfma_f32_16x16x32_bf16 v[20:23], a[208:211], v[182:185], v[20:23]
v_mul_f32 v149, v149, v151
v_cvt_pk_bf16_f32 v143, v148, v149
v_mfma_f32_16x16x32_bf16 v[154:157], v[114:117], v[174:177], 0
ds_write_b64 v212, v[142:143] offset:49152
v_mfma_f32_16x16x32_bf16 v[158:161], v[122:125], v[174:177], 0
v_mfma_f32_16x16x32_bf16 v[162:165], v[130:133], v[174:177], 0
s_waitcnt lgkmcnt(2)
ds_read_b128 v[174:177], v218
v_mfma_f32_16x16x32_bf16 v[12:15], a[164:167], v[186:189], v[12:15]
v_mfma_f32_16x16x32_bf16 v[166:169], v[190:193], v[178:181], v[166:169]
v_mfma_f32_16x16x32_bf16 v[154:157], v[118:121], v[178:181], v[154:157]
v_mfma_f32_16x16x32_bf16 v[16:19], a[188:191], v[186:189], v[16:19]
s_nop 4
v_cvt_pk_bf16_f32 v12, v12, v13
v_cvt_pk_bf16_f32 v13, v14, v15
v_mfma_f32_16x16x32_bf16 v[158:161], v[126:129], v[178:181], v[158:161]
s_waitcnt lgkmcnt(1)
v_rcp_f32 v167, v166
v_mfma_f32_16x16x32_bf16 v[20:23], a[212:215], v[186:189], v[20:23]
s_barrier
ds_read_b128 v[170:173], v210 offset:49152
v_mfma_f32_16x16x32_bf16 v[162:165], v[134:137], v[178:181], v[162:165]
ds_read_b128 v[182:185], v210 offset:50176
buffer_store_dwordx2 v[12:13], v204, s[8:11], s38 offen
v_max3_u32 v219, v219, v166, v167
v_mul_f32 v154, v154, v167
v_mul_f32 v155, v155, v167
v_cvt_pk_bf16_f32 v154, v154, v155
v_mul_f32 v156, v156, v167
v_mul_f32 v157, v157, v167
v_cvt_pk_bf16_f32 v155, v156, v157
v_mul_f32 v158, v158, v167
v_mul_f32 v159, v159, v167
v_cvt_pk_bf16_f32 v156, v158, v159
v_mul_f32 v160, v160, v167
v_mul_f32 v161, v161, v167
v_cvt_pk_bf16_f32 v157, v160, v161
v_mul_f32 v162, v162, v167
v_mul_f32 v163, v163, v167
v_cvt_pk_bf16_f32 v158, v162, v163
v_mul_f32 v164, v164, v167
v_mul_f32 v165, v165, v167
v_cvt_pk_bf16_f32 v159, v164, v165
s_waitcnt lgkmcnt(1)
v_mfma_f32_16x16x32_bf16 v[24:27], a[144:147], v[170:173], v[24:27]
ds_write_b128 v216, v[154:157]
v_mfma_f32_16x16x32_bf16 v[28:31], a[168:171], v[170:173], v[28:31]
ds_write_b64 v216, v[158:159] offset:16
v_mfma_f32_16x16x32_bf16 v[32:35], a[192:195], v[170:173], v[32:35]
s_waitcnt lgkmcnt(2)
ds_read_b128 v[186:189], v210 offset:51200
ds_read_b128 v[170:173], v210 offset:52224
v_mfma_f32_16x16x32_bf16 v[24:27], a[148:151], v[182:185], v[24:27]
v_add_u32 v216, 1408, v216
v_cvt_pk_bf16_f32 v16, v16, v17
v_mfma_f32_16x16x32_bf16 v[28:31], a[172:175], v[182:185], v[28:31]
v_cvt_pk_bf16_f32 v17, v18, v19
v_cvt_pk_bf16_f32 v20, v20, v21
v_mfma_f32_16x16x32_bf16 v[32:35], a[196:199], v[182:185], v[32:35]
s_waitcnt vmcnt(4)
buffer_store_dwordx2 v[16:17], v204, s[8:11], s38 offen offset:32
ds_read_b128 v[182:185], v210 offset:53248
v_cvt_pk_bf16_f32 v21, v22, v23
s_barrier
buffer_store_dwordx2 v[20:21], v204, s[8:11], s38 offen offset:64
ds_read_b128 v[84:87], v200
ds_read_b128 v[92:95], v201
ds_read_b128 v[100:103], v202
ds_read_b128 v[178:181], v218 offset:528
ds_read_b128 v[88:91], v194 offset:16
ds_read_b128 v[96:99], v195 offset:16
ds_read_b128 v[104:107], v196 offset:16
s_waitcnt lgkmcnt(9)
v_mfma_f32_16x16x32_bf16 v[24:27], a[152:155], v[186:189], v[24:27]
v_mfma_f32_16x16x32_bf16 v[28:31], a[176:179], v[186:189], v[28:31]
v_mfma_f32_16x16x32_bf16 v[32:35], a[200:203], v[186:189], v[32:35]
s_waitcnt lgkmcnt(8)
ds_read_b128 v[186:189], v210 offset:54272
v_mfma_f32_16x16x32_bf16 v[24:27], a[156:159], v[170:173], v[24:27]
v_mfma_f32_16x16x32_bf16 v[28:31], a[180:183], v[170:173], v[28:31]
v_mfma_f32_16x16x32_bf16 v[32:35], a[204:207], v[170:173], v[32:35]
s_waitcnt lgkmcnt(8)
v_mfma_f32_16x16x32_bf16 v[24:27], a[160:163], v[182:185], v[24:27]
v_mfma_f32_16x16x32_bf16 v[28:31], a[184:187], v[182:185], v[28:31]
v_mfma_f32_16x16x32_bf16 v[32:35], a[208:211], v[182:185], v[32:35]
s_waitcnt lgkmcnt(7)
ds_read_b128 v[182:185], v210 offset:18432
v_mfma_f32_16x16x32_bf16 v[0:3], v[174:177], v[84:87], 0
s_waitcnt lgkmcnt(7)
ds_read_b128 v[84:87], v194
v_mfma_f32_16x16x32_bf16 v[12:15], v[174:177], v[92:95], 0
s_waitcnt lgkmcnt(2)
ds_read_b128 v[92:95], v195
v_mfma_f32_16x16x32_bf16 v[24:27], a[164:167], v[186:189], v[24:27]
v_mfma_f32_16x16x32_bf16 v[28:31], a[188:191], v[186:189], v[28:31]
v_mfma_f32_16x16x32_bf16 v[32:35], a[212:215], v[186:189], v[32:35]
s_waitcnt lgkmcnt(2)
ds_read_b128 v[186:189], v210 offset:19456
s_nop 3
v_cvt_pk_bf16_f32 v24, v24, v25
v_cvt_pk_bf16_f32 v25, v26, v27
v_mfma_f32_16x16x32_bf16 v[138:141], a[0:3], v[182:185], 0
buffer_store_dwordx2 v[24:25], v205, s[8:11], s38 offen
v_mfma_f32_16x16x32_bf16 v[142:145], a[24:27], v[182:185], 0
v_cvt_pk_bf16_f32 v28, v28, v29
v_cvt_pk_bf16_f32 v29, v30, v31
v_mfma_f32_16x16x32_bf16 v[146:149], a[48:51], v[182:185], 0
buffer_store_dwordx2 v[28:29], v205, s[8:11], s38 offen offset:32
v_mfma_f32_16x16x32_bf16 v[150:153], a[216:219], v[182:185], 0
v_cvt_pk_bf16_f32 v32, v32, v33
v_cvt_pk_bf16_f32 v33, v34, v35
v_mfma_f32_16x16x32_bf16 v[154:157], a[240:243], v[182:185], 0
buffer_store_dwordx2 v[32:33], v205, s[8:11], s38 offen offset:64
v_mfma_f32_16x16x32_bf16 v[158:161], v[232:235], v[182:185], 0
v_mfma_f32_16x16x32_bf16 v[162:165], v[182:185], a[72:75], 0
v_mfma_f32_16x16x32_bf16 v[166:169], v[182:185], a[96:99], 0
v_mfma_f32_16x16x32_bf16 v[170:173], v[182:185], a[120:123], 0
s_waitcnt lgkmcnt(0)
ds_read_b128 v[182:185], v210 offset:20480
v_mfma_f32_16x16x32_bf16 v[138:141], a[4:7], v[186:189], v[138:141]
v_mfma_f32_16x16x32_bf16 v[142:145], a[28:31], v[186:189], v[142:145]
v_mfma_f32_16x16x32_bf16 v[146:149], a[52:55], v[186:189], v[146:149]
v_mfma_f32_16x16x32_bf16 v[150:153], a[220:223], v[186:189], v[150:153]
v_mfma_f32_16x16x32_bf16 v[154:157], a[244:247], v[186:189], v[154:157]
s_mul_hi_u32 s41, s35, 58835169
v_mfma_f32_16x16x32_bf16 v[24:27], v[174:177], v[100:103], 0
ds_read_b128 v[100:103], v196
ds_read_b128 v[174:177], v218 offset:1056
v_mfma_f32_16x16x32_bf16 v[158:161], v[236:239], v[186:189], v[158:161]
s_mul_i32 s42, s41, 73
s_sub_u32 s42, s35, s42
s_mul_i32 s43, s41, 1373568
v_mfma_f32_16x16x32_bf16 v[162:165], v[186:189], a[76:79], v[162:165]
s_mul_i32 s51, s42, 2688
v_mfma_f32_16x16x32_bf16 v[166:169], v[186:189], a[100:103], v[166:169]
s_add_u32 s43, s43, s51
s_cmp_lt_u32 s35, s34
v_mfma_f32_16x16x32_bf16 v[170:173], v[186:189], a[124:127], v[170:173]
ds_read_b128 v[186:189], v210 offset:21504
v_smfmac_f32_16x16x64_bf16 v[0:3], v[178:181], v[84:91], v207
s_waitcnt lgkmcnt(3)
ds_read_b128 v[84:87], v197
ds_read_b128 v[88:91], v197 offset:16
v_mfma_f32_16x16x32_bf16 v[138:141], a[8:11], v[182:185], v[138:141]
s_cselect_b32 s37, s43, 1879048192
s_add_u32 s35, s35, 32
s_cmp_eq_u32 s42, 0
v_mfma_f32_16x16x32_bf16 v[142:145], a[32:35], v[182:185], v[142:145]
s_cselect_b32 s44, 536870911, s72
s_cmp_eq_u32 s42, 72
v_smfmac_f32_16x16x64_bf16 v[12:15], v[178:181], v[92:99], v207
ds_read_b128 v[92:95], v198
ds_read_b128 v[96:99], v198 offset:16
v_mfma_f32_16x16x32_bf16 v[146:149], a[56:59], v[182:185], v[146:149]
s_cselect_b32 s44, 939524095, s44
v_and_b32 v209, s44, v208
s_cmp_eq_u32 s41, 0
v_mfma_f32_16x16x32_bf16 v[150:153], a[224:227], v[182:185], v[150:153]
s_cselect_b32 s40, 1879048192, s37
s_add_u32 m0, s45, 0
v_mfma_f32_16x16x32_bf16 v[154:157], a[248:251], v[182:185], v[154:157]
s_waitcnt lgkmcnt(6)
v_smfmac_f32_16x16x64_bf16 v[24:27], v[178:181], v[100:107], v207
ds_read_b128 v[100:103], v199
ds_read_b128 v[104:107], v199 offset:16
v_mfma_f32_16x16x32_bf16 v[158:161], v[240:243], v[182:185], v[158:161]
ds_read_b128 v[178:181], v218 offset:1584
v_mfma_f32_16x16x32_bf16 v[162:165], v[182:185], a[80:83], v[162:165]
v_mfma_f32_16x16x32_bf16 v[166:169], v[182:185], a[104:107], v[166:169]
v_mfma_f32_16x16x32_bf16 v[170:173], v[182:185], a[128:131], v[170:173]
s_waitcnt lgkmcnt(5)
ds_read_b128 v[182:185], v210 offset:22528
v_smfmac_f32_16x16x64_bf16 v[0:3], v[174:177], v[84:91], v207
ds_read_b128 v[84:87], v200 offset:32
ds_read_b128 v[88:91], v194 offset:48
v_mfma_f32_16x16x32_bf16 v[138:141], a[12:15], v[186:189], v[138:141]
v_mfma_f32_16x16x32_bf16 v[142:145], a[36:39], v[186:189], v[142:145]
s_waitcnt lgkmcnt(6)
v_smfmac_f32_16x16x64_bf16 v[12:15], v[174:177], v[92:99], v207
ds_read_b128 v[92:95], v201 offset:32
ds_read_b128 v[96:99], v195 offset:48
v_mfma_f32_16x16x32_bf16 v[146:149], a[60:63], v[186:189], v[146:149]
v_add_f32 v118, v0, v1
v_mul_f32 v119, v0, v0
v_mfma_f32_16x16x32_bf16 v[150:153], a[228:231], v[186:189], v[150:153]
v_add_f32 v118, v118, v2
v_fmac_f32 v119, v1, v1
v_mfma_f32_16x16x32_bf16 v[154:157], a[252:255], v[186:189], v[154:157]
s_waitcnt lgkmcnt(6)
v_add_f32 v118, v118, v3
v_fmac_f32 v119, v2, v2
v_smfmac_f32_16x16x64_bf16 v[24:27], v[174:177], v[100:107], v207
ds_read_b128 v[100:103], v202 offset:32
ds_read_b128 v[174:177], v218 offset:2112
v_mfma_f32_16x16x32_bf16 v[158:161], v[244:247], v[186:189], v[158:161]
ds_read_b128 v[104:107], v196 offset:48
v_fmac_f32 v119, v3, v3
v_mfma_f32_16x16x32_bf16 v[162:165], v[186:189], a[84:87], v[162:165]
v_add_f32 v126, v12, v13
v_mul_f32 v127, v12, v12
v_mfma_f32_16x16x32_bf16 v[166:169], v[186:189], a[108:111], v[166:169]
s_waitcnt lgkmcnt(6)
v_add_f32 v126, v126, v14
v_fmac_f32 v127, v13, v13
v_mfma_f32_16x16x32_bf16 v[4:7], v[178:181], v[84:87], 0
ds_read_b128 v[84:87], v194 offset:32
v_add_f32 v126, v126, v15
v_mfma_f32_16x16x32_bf16 v[170:173], v[186:189], a[132:135], v[170:173]
s_waitcnt lgkmcnt(5)
ds_read_b128 v[186:189], v210 offset:23552
v_fmac_f32 v127, v14, v14
v_mfma_f32_16x16x32_bf16 v[16:19], v[178:181], v[92:95], 0
ds_read_b128 v[92:95], v195 offset:32
v_fmac_f32 v127, v15, v15
v_mfma_f32_16x16x32_bf16 v[138:141], a[16:19], v[182:185], v[138:141]
s_waitcnt lgkmcnt(5)
v_add_f32 v134, v24, v25
v_mul_f32 v135, v24, v24
v_mfma_f32_16x16x32_bf16 v[28:31], v[178:181], v[100:103], 0
ds_read_b128 v[100:103], v196 offset:32
ds_read_b128 v[178:181], v218 offset:2640
v_mfma_f32_16x16x32_bf16 v[142:145], a[40:43], v[182:185], v[142:145]
v_add_f32 v134, v134, v26
v_fmac_f32 v135, v25, v25
v_mfma_f32_16x16x32_bf16 v[146:149], a[64:67], v[182:185], v[146:149]
v_add_f32 v134, v134, v27
v_fmac_f32 v135, v26, v26
v_mfma_f32_16x16x32_bf16 v[150:153], a[232:235], v[182:185], v[150:153]
v_fmac_f32 v135, v27, v27
v_mfma_f32_16x16x32_bf16 v[154:157], v[224:227], v[182:185], v[154:157]
s_waitcnt lgkmcnt(4)
v_smfmac_f32_16x16x64_bf16 v[4:7], v[174:177], v[84:91], v207
ds_read_b128 v[84:87], v197 offset:32
ds_read_b128 v[88:91], v197 offset:48
v_mfma_f32_16x16x32_bf16 v[158:161], v[248:251], v[182:185], v[158:161]
v_mfma_f32_16x16x32_bf16 v[162:165], v[182:185], a[88:91], v[162:165]
v_mfma_f32_16x16x32_bf16 v[166:169], v[182:185], a[112:115], v[166:169]
s_waitcnt lgkmcnt(4)
v_smfmac_f32_16x16x64_bf16 v[16:19], v[174:177], v[92:99], v207
ds_read_b128 v[92:95], v198 offset:32
ds_read_b128 v[96:99], v198 offset:48
v_mfma_f32_16x16x32_bf16 v[170:173], v[182:185], a[136:139], v[170:173]
ds_read_b128 v[182:185], v210 offset:24576
v_mfma_f32_16x16x32_bf16 v[138:141], a[20:23], v[186:189], v[138:141]
s_waitcnt lgkmcnt(6)
v_smfmac_f32_16x16x64_bf16 v[28:31], v[174:177], v[100:107], v207
ds_read_b128 v[100:103], v199 offset:32
ds_read_b128 v[104:107], v199 offset:48
v_mfma_f32_16x16x32_bf16 v[142:145], a[44:47], v[186:189], v[142:145]
ds_read_b128 v[174:177], v218 offset:3168
v_mfma_f32_16x16x32_bf16 v[146:149], a[68:71], v[186:189], v[146:149]
s_nop 0
v_cvt_pk_bf16_f32 v78, v138, v139
v_cvt_pk_bf16_f32 v79, v140, v141
v_mfma_f32_16x16x32_bf16 v[150:153], a[236:239], v[186:189], v[150:153]
v_mfma_f32_16x16x32_bf16 v[154:157], v[228:231], v[186:189], v[154:157]
s_waitcnt lgkmcnt(6)
v_cvt_pk_bf16_f32 v80, v142, v143
v_cvt_pk_bf16_f32 v81, v144, v145
v_smfmac_f32_16x16x64_bf16 v[4:7], v[178:181], v[84:91], v207
ds_read_b128 v[84:87], v200 offset:64
v_cvt_pk_bf16_f32 v82, v146, v147
v_mfma_f32_16x16x32_bf16 v[158:161], v[252:255], v[186:189], v[158:161]
v_cvt_pk_bf16_f32 v83, v148, v149
v_cvt_pk_bf16_f32 v72, v150, v151
v_mfma_f32_16x16x32_bf16 v[162:165], v[186:189], a[92:95], v[162:165]
v_cvt_pk_bf16_f32 v73, v152, v153
v_cvt_pk_bf16_f32 v74, v154, v155
v_mfma_f32_16x16x32_bf16 v[166:169], v[186:189], a[116:119], v[166:169]
s_waitcnt lgkmcnt(5)
v_cvt_pk_bf16_f32 v75, v156, v157
v_add_f32 v118, v118, v4
v_smfmac_f32_16x16x64_bf16 v[16:19], v[178:181], v[92:99], v207
ds_read_b128 v[92:95], v201 offset:64
v_cvt_pk_bf16_f32 v76, v158, v159
v_mfma_f32_16x16x32_bf16 v[170:173], v[186:189], a[140:143], v[170:173]
s_waitcnt lgkmcnt(5)
ds_read_b128 v[186:189], v210 offset:25600
v_cvt_pk_bf16_f32 v77, v160, v161
v_mfma_f32_16x16x32_bf16 v[138:141], a[0:3], v[182:185], 0
v_cvt_pk_bf16_f32 v114, v162, v163
v_cvt_pk_bf16_f32 v115, v164, v165
v_mfma_f32_16x16x32_bf16 v[142:145], a[24:27], v[182:185], 0
s_waitcnt lgkmcnt(4)
ds_read_b128 v[88:91], v194 offset:80
v_cvt_pk_bf16_f32 v122, v166, v167
v_smfmac_f32_16x16x64_bf16 v[28:31], v[178:181], v[100:107], v207
ds_read_b128 v[100:103], v202 offset:64
ds_read_b128 v[178:181], v218 offset:3696
v_mfma_f32_16x16x32_bf16 v[146:149], a[48:51], v[182:185], 0
v_cvt_pk_bf16_f32 v123, v168, v169
v_cvt_pk_bf16_f32 v130, v170, v171
v_mfma_f32_16x16x32_bf16 v[150:153], a[216:219], v[182:185], 0
v_cvt_pk_bf16_f32 v131, v172, v173
v_fmac_f32 v119, v4, v4
v_mfma_f32_16x16x32_bf16 v[154:157], a[240:243], v[182:185], 0
s_waitcnt lgkmcnt(5)
ds_read_b128 v[96:99], v195 offset:80
ds_read_b128 v[104:107], v196 offset:80
v_mfma_f32_16x16x32_bf16 v[8:11], v[174:177], v[84:87], 0
ds_read_b128 v[84:87], v194 offset:64
v_add_f32 v118, v118, v5
v_mfma_f32_16x16x32_bf16 v[158:161], v[232:235], v[182:185], 0
v_fmac_f32 v119, v5, v5
v_add_f32 v118, v118, v6
v_mfma_f32_16x16x32_bf16 v[162:165], v[182:185], a[72:75], 0
s_waitcnt lgkmcnt(7)
v_fmac_f32 v119, v6, v6
v_add_f32 v118, v118, v7
v_mfma_f32_16x16x32_bf16 v[20:23], v[174:177], v[92:95], 0
ds_read_b128 v[92:95], v195 offset:64
v_fmac_f32 v119, v7, v7
v_mfma_f32_16x16x32_bf16 v[166:169], v[182:185], a[96:99], 0
v_add_f32 v126, v126, v16
v_fmac_f32 v127, v16, v16
v_mfma_f32_16x16x32_bf16 v[170:173], v[182:185], a[120:123], 0
s_waitcnt lgkmcnt(5)
ds_read_b128 v[182:185], v210 offset:26624
v_add_f32 v126, v126, v17
v_mfma_f32_16x16x32_bf16 v[32:35], v[174:177], v[100:103], 0
ds_read_b128 v[100:103], v196 offset:64
ds_read_b128 v[174:177], v218 offset:4224
v_mfma_f32_16x16x32_bf16 v[138:141], a[4:7], v[186:189], v[138:141]
v_fmac_f32 v127, v17, v17
v_add_f32 v126, v126, v18
v_mfma_f32_16x16x32_bf16 v[142:145], a[28:31], v[186:189], v[142:145]
v_fmac_f32 v127, v18, v18
v_add_f32 v126, v126, v19
v_mfma_f32_16x16x32_bf16 v[146:149], a[52:55], v[186:189], v[146:149]
s_waitcnt lgkmcnt(4)
v_fmac_f32 v127, v19, v19
v_add_f32 v134, v134, v28
v_smfmac_f32_16x16x64_bf16 v[8:11], v[178:181], v[84:91], v207
ds_read_b128 v[84:87], v197 offset:64
ds_read_b128 v[88:91], v197 offset:80
v_mfma_f32_16x16x32_bf16 v[150:153], a[220:223], v[186:189], v[150:153]
v_fmac_f32 v135, v28, v28
v_add_f32 v134, v134, v29
v_mfma_f32_16x16x32_bf16 v[154:157], a[244:247], v[186:189], v[154:157]
v_fmac_f32 v135, v29, v29
v_add_f32 v134, v134, v30
v_mfma_f32_16x16x32_bf16 v[158:161], v[236:239], v[186:189], v[158:161]
s_waitcnt lgkmcnt(5)
v_fmac_f32 v135, v30, v30
v_add_f32 v134, v134, v31
v_smfmac_f32_16x16x64_bf16 v[20:23], v[178:181], v[92:99], v207
ds_read_b128 v[92:95], v198 offset:64
ds_read_b128 v[96:99], v198 offset:80
v_mfma_f32_16x16x32_bf16 v[162:165], v[186:189], a[76:79], v[162:165]
v_fmac_f32 v135, v31, v31
v_mfma_f32_16x16x32_bf16 v[166:169], v[186:189], a[100:103], v[166:169]
ds_read_u16 v120, v217
ds_read_u16 v128, v217 offset:32
v_mfma_f32_16x16x32_bf16 v[170:173], v[186:189], a[124:127], v[170:173]
ds_read_b128 v[186:189], v210 offset:27648
ds_read_u16 v136, v217 offset:64
s_waitcnt lgkmcnt(9)
v_smfmac_f32_16x16x64_bf16 v[32:35], v[178:181], v[100:107], v207
ds_read_b128 v[100:103], v199 offset:64
ds_read_b128 v[104:107], v199 offset:80
v_mfma_f32_16x16x32_bf16 v[138:141], a[8:11], v[182:185], v[138:141]
v_add_u32 v217, 1408, v217
v_mfma_f32_16x16x32_bf16 v[142:145], a[32:35], v[182:185], v[142:145]
v_mfma_f32_16x16x32_bf16 v[146:149], a[56:59], v[182:185], v[146:149]
s_waitcnt lgkmcnt(8)
v_smfmac_f32_16x16x64_bf16 v[8:11], v[174:177], v[84:91], v207
v_mfma_f32_16x16x32_bf16 v[150:153], a[224:227], v[182:185], v[150:153]
v_mfma_f32_16x16x32_bf16 v[154:157], a[248:251], v[182:185], v[154:157]
v_mfma_f32_16x16x32_bf16 v[158:161], v[240:243], v[182:185], v[158:161]
s_waitcnt lgkmcnt(6)
s_nop 3
v_add_f32 v118, v118, v8
v_fmac_f32 v119, v8, v8
v_smfmac_f32_16x16x64_bf16 v[20:23], v[174:177], v[92:99], v207
v_add_f32 v118, v118, v9
v_fmac_f32 v119, v9, v9
v_mfma_f32_16x16x32_bf16 v[162:165], v[182:185], a[80:83], v[162:165]
v_add_f32 v118, v118, v10
v_fmac_f32 v119, v10, v10
v_mfma_f32_16x16x32_bf16 v[166:169], v[182:185], a[104:107], v[166:169]
v_add_f32 v118, v118, v11
v_fmac_f32 v119, v11, v11
v_mfma_f32_16x16x32_bf16 v[170:173], v[182:185], a[128:131], v[170:173]
s_waitcnt lgkmcnt(0)
ds_read_b128 v[182:185], v210 offset:28672
v_add_f32 v126, v126, v20
v_smfmac_f32_16x16x64_bf16 v[32:35], v[174:177], v[100:107], v207
v_fmac_f32 v127, v20, v20
v_add_f32 v126, v126, v21
v_mfma_f32_16x16x32_bf16 v[138:141], a[12:15], v[186:189], v[138:141]
v_fmac_f32 v127, v21, v21
v_add_f32 v126, v126, v22
v_mfma_f32_16x16x32_bf16 v[142:145], a[36:39], v[186:189], v[142:145]
v_fmac_f32 v127, v22, v22
v_add_f32 v126, v126, v23
v_mfma_f32_16x16x32_bf16 v[146:149], a[60:63], v[186:189], v[146:149]
v_fmac_f32 v127, v23, v23
v_add_f32 v134, v134, v32
v_mfma_f32_16x16x32_bf16 v[150:153], a[228:231], v[186:189], v[150:153]
v_fmac_f32 v135, v32, v32
v_add_f32 v134, v134, v33
v_mfma_f32_16x16x32_bf16 v[154:157], a[252:255], v[186:189], v[154:157]
v_fmac_f32 v135, v33, v33
v_add_f32 v134, v134, v34
v_mfma_f32_16x16x32_bf16 v[158:161], v[244:247], v[186:189], v[158:161]
v_fmac_f32 v135, v34, v34
v_add_f32 v134, v134, v35
v_mfma_f32_16x16x32_bf16 v[162:165], v[186:189], a[84:87], v[162:165]
v_permlane16_swap_b32 v118, v119
v_mfma_f32_16x16x32_bf16 v[166:169], v[186:189], a[108:111], v[166:169]
v_fmac_f32 v135, v35, v35
v_add_f32 v118, v118, v119
v_mfma_f32_16x16x32_bf16 v[170:173], v[186:189], a[132:135], v[170:173]
s_waitcnt lgkmcnt(0)
ds_read_b128 v[186:189], v210 offset:29696
v_permlane16_swap_b32 v126, v127
v_mfma_f32_16x16x32_bf16 v[138:141], a[16:19], v[182:185], v[138:141]
v_add_f32 v126, v126, v127
v_permlane16_swap_b32 v134, v135
v_mfma_f32_16x16x32_bf16 v[142:145], a[40:43], v[182:185], v[142:145]
v_add_f32 v134, v134, v135
v_permlane32_swap_b32 v118, v126
v_mfma_f32_16x16x32_bf16 v[146:149], a[64:67], v[182:185], v[146:149]
v_add_f32 v118, v118, v126
v_mov_b32 v135, v134
v_mfma_f32_16x16x32_bf16 v[150:153], a[232:235], v[182:185], v[150:153]
ds_write_b32 v213, v118
v_mfma_f32_16x16x32_bf16 v[154:157], v[224:227], v[182:185], v[154:157]
v_permlane32_swap_b32 v134, v135
v_mfma_f32_16x16x32_bf16 v[158:161], v[248:251], v[182:185], v[158:161]
v_add_f32 v134, v134, v135
v_mfma_f32_16x16x32_bf16 v[162:165], v[182:185], a[88:91], v[162:165]
ds_write_b32 v213, v134 offset:512
v_mfma_f32_16x16x32_bf16 v[166:169], v[182:185], a[112:115], v[166:169]
v_mfma_f32_16x16x32_bf16 v[170:173], v[182:185], a[136:139], v[170:173]
s_waitcnt lgkmcnt(2)
ds_read_b128 v[182:185], v210 offset:30720
v_mfma_f32_16x16x32_bf16 v[138:141], a[20:23], v[186:189], v[138:141]
v_mfma_f32_16x16x32_bf16 v[142:145], a[44:47], v[186:189], v[142:145]
v_mfma_f32_16x16x32_bf16 v[146:149], a[68:71], v[186:189], v[146:149]
v_mfma_f32_16x16x32_bf16 v[150:153], a[236:239], v[186:189], v[150:153]
s_nop 4
v_cvt_pk_bf16_f32 v96, v138, v139
v_cvt_pk_bf16_f32 v97, v140, v141
v_mfma_f32_16x16x32_bf16 v[154:157], v[228:231], v[186:189], v[154:157]
s_waitcnt lgkmcnt(1)
v_cvt_pk_bf16_f32 v98, v142, v143
v_cvt_pk_bf16_f32 v99, v144, v145
v_mfma_f32_16x16x32_bf16 v[158:161], v[252:255], v[186:189], v[158:161]
s_barrier
ds_read_b128 v[174:177], v210 offset:55296
v_mfma_f32_16x16x32_bf16 v[162:165], v[186:189], a[92:95], v[162:165]
ds_read_b128 v[178:181], v210 offset:56320
buffer_load_dwordx4 v209, s[4:7], s40 offen nt lds
v_mfma_f32_16x16x32_bf16 v[166:169], v[186:189], a[116:119], v[166:169]
s_add_u32 s40, s37, 196224
v_cvt_pk_bf16_f32 v100, v146, v147
v_cvt_pk_bf16_f32 v101, v148, v149
v_mfma_f32_16x16x32_bf16 v[170:173], v[186:189], a[140:143], v[170:173]
s_add_u32 m0, s45, 4112
ds_read_b128 v[186:189], v210 offset:31744
v_cvt_pk_bf16_f32 v84, v150, v151
s_waitcnt lgkmcnt(3)
v_mfma_f32_16x16x32_bf16 v[138:141], a[0:3], v[182:185], 0
v_cvt_pk_bf16_f32 v85, v152, v153
v_cvt_pk_bf16_f32 v86, v154, v155
v_mfma_f32_16x16x32_bf16 v[142:145], a[24:27], v[182:185], 0
buffer_load_dwordx4 v209, s[4:7], s40 offen nt lds
v_mfma_f32_16x16x32_bf16 v[146:149], a[48:51], v[182:185], 0
s_add_u32 s40, s37, 392448
v_cvt_pk_bf16_f32 v87, v156, v157
v_cvt_pk_bf16_f32 v88, v158, v159
v_mfma_f32_16x16x32_bf16 v[150:153], a[216:219], v[182:185], 0
s_add_u32 m0, s45, 8224
v_cvt_pk_bf16_f32 v89, v160, v161
v_cvt_pk_bf16_f32 v116, v162, v163
v_mfma_f32_16x16x32_bf16 v[154:157], a[240:243], v[182:185], 0
v_cvt_pk_bf16_f32 v117, v164, v165
v_cvt_pk_bf16_f32 v124, v166, v167
v_mfma_f32_16x16x32_bf16 v[158:161], v[232:235], v[182:185], 0
s_waitcnt lgkmcnt(2)
buffer_load_dwordx4 v209, s[4:7], s40 offen nt lds
v_mfma_f32_16x16x32_bf16 v[162:165], v[182:185], a[72:75], 0
s_add_u32 s40, s37, 588672
v_cvt_pk_bf16_f32 v125, v168, v169
v_cvt_pk_bf16_f32 v132, v170, v171
v_mfma_f32_16x16x32_bf16 v[166:169], v[182:185], a[96:99], 0
s_add_u32 m0, s45, 12336
v_cvt_pk_bf16_f32 v133, v172, v173
v_add_f32 v174, v174, v175
v_mfma_f32_16x16x32_bf16 v[170:173], v[182:185], a[120:123], 0
s_waitcnt lgkmcnt(0)
buffer_load_dwordx4 v209, s[4:7], s40 offen nt lds
v_mfma_f32_16x16x32_bf16 v[138:141], a[4:7], v[186:189], v[138:141]
s_add_u32 s40, s37, 784896
v_add_f32 v178, v178, v179
v_add_f32 v176, v176, v177
v_mfma_f32_16x16x32_bf16 v[142:145], a[28:31], v[186:189], v[142:145]
s_add_u32 m0, s45, 16448
v_add_f32 v180, v180, v181
v_add_f32 v174, v174, v176
v_mfma_f32_16x16x32_bf16 v[146:149], a[52:55], v[186:189], v[146:149]
buffer_load_dwordx4 v209, s[4:7], s40 offen nt lds
v_mfma_f32_16x16x32_bf16 v[150:153], a[220:223], v[186:189], v[150:153]
s_add_u32 s40, s37, 981120
v_add_f32 v178, v178, v180
v_mul_f32 v175, s48, v174
v_mfma_f32_16x16x32_bf16 v[154:157], a[244:247], v[186:189], v[154:157]
s_add_u32 m0, s45, 20560
ds_read_b128 v[182:185], v210 offset:32768
buffer_load_dwordx4 v209, s[4:7], s40 offen nt lds
v_mfma_f32_16x16x32_bf16 v[158:161], v[236:239], v[186:189], v[158:161]
s_add_u32 s40, s37, 1177344
v_mul_f32 v178, s48, v178
v_fma_f32 v178, -v175, v175, v178
v_mfma_f32_16x16x32_bf16 v[162:165], v[186:189], a[76:79], v[162:165]
s_add_u32 m0, s45, 24672
v_max_f32 v178, 0, v178
v_add_f32 v178, s49, v178
v_mfma_f32_16x16x32_bf16 v[166:169], v[186:189], a[100:103], v[166:169]
s_waitcnt lgkmcnt(0)
buffer_load_dwordx4 v209, s[4:7], s40 offen nt lds
v_mfma_f32_16x16x32_bf16 v[170:173], v[186:189], a[124:127], v[170:173]
s_add_u32 s40, s37, 1373568
v_rsq_f32 v174, v178
s_add_u32 m0, s45, 28784
v_mul_f32_e64 v175, -v175, v174
ds_write_b64 v214, v[174:175]
v_mfma_f32_16x16x32_bf16 v[138:141], a[8:11], v[182:185], v[138:141]
ds_read_b64 v[118:119], v215
ds_read_b64 v[126:127], v215 offset:128
v_mfma_f32_16x16x32_bf16 v[142:145], a[32:35], v[182:185], v[142:145]
ds_read_b64 v[134:135], v215 offset:256
buffer_load_dwordx4 v209, s[4:7], s40 offen nt lds
v_mfma_f32_16x16x32_bf16 v[146:149], a[56:59], v[182:185], v[146:149]
s_add_u32 s40, s37, 1569792
ds_read_b128 v[186:189], v210 offset:33792
s_add_u32 m0, s45, 32896
v_mfma_f32_16x16x32_bf16 v[150:153], a[224:227], v[182:185], v[150:153]
buffer_load_dwordx4 v209, s[4:7], s40 offen nt lds
v_mfma_f32_16x16x32_bf16 v[154:157], a[248:251], v[182:185], v[154:157]
v_mov_b32 v181, 0
v_mfma_f32_16x16x32_bf16 v[158:161], v[240:243], v[182:185], v[158:161]
s_waitcnt lgkmcnt(3)
v_fma_f32 v108, v0, v118, v119
v_fma_f32 v109, v1, v118, v119
v_mfma_f32_16x16x32_bf16 v[162:165], v[182:185], a[80:83], v[162:165]
v_cvt_pk_bf16_f32 v90, v108, v109
v_fma_f32 v110, v2, v118, v119
v_mfma_f32_16x16x32_bf16 v[166:169], v[182:185], a[104:107], v[166:169]
v_fma_f32 v111, v3, v118, v119
v_cvt_pk_bf16_f32 v91, v110, v111
v_mfma_f32_16x16x32_bf16 v[170:173], v[182:185], a[128:131], v[170:173]
s_waitcnt lgkmcnt(0)
v_fma_f32 v112, v4, v118, v119
v_fma_f32 v113, v5, v118, v119
v_mfma_f32_16x16x32_bf16 v[138:141], a[12:15], v[186:189], v[138:141]
v_cvt_pk_bf16_f32 v92, v112, v113
v_fma_f32 v108, v6, v118, v119
v_mfma_f32_16x16x32_bf16 v[142:145], a[36:39], v[186:189], v[142:145]
v_fma_f32 v109, v7, v118, v119
v_cvt_pk_bf16_f32 v93, v108, v109
v_mfma_f32_16x16x32_bf16 v[146:149], a[60:63], v[186:189], v[146:149]
ds_write_b128 v211, v[90:93]
v_mfma_f32_16x16x32_bf16 v[150:153], a[228:231], v[186:189], v[150:153]
ds_read_b128 v[182:185], v210 offset:34816
v_fma_f32 v110, v8, v118, v119
v_mfma_f32_16x16x32_bf16 v[154:157], a[252:255], v[186:189], v[154:157]
v_fma_f32 v111, v9, v118, v119
v_cvt_pk_bf16_f32 v94, v110, v111
v_mfma_f32_16x16x32_bf16 v[158:161], v[244:247], v[186:189], v[158:161]
v_fma_f32 v112, v10, v118, v119
v_fma_f32 v113, v11, v118, v119
v_mfma_f32_16x16x32_bf16 v[162:165], v[186:189], a[84:87], v[162:165]
v_cvt_pk_bf16_f32 v95, v112, v113
v_fma_f32 v108, v12, v126, v127
v_mfma_f32_16x16x32_bf16 v[166:169], v[186:189], a[108:111], v[166:169]
ds_write_b64 v212, v[94:95]
v_mfma_f32_16x16x32_bf16 v[170:173], v[186:189], a[132:135], v[170:173]
v_fma_f32 v109, v13, v126, v127
v_cvt_pk_bf16_f32 v102, v108, v109
v_fma_f32 v110, v14, v126, v127
v_fma_f32 v111, v15, v126, v127
v_cvt_pk_bf16_f32 v103, v110, v111
v_fma_f32 v112, v16, v126, v127
v_fma_f32 v113, v17, v126, v127
v_cvt_pk_bf16_f32 v104, v112, v113
v_fma_f32 v108, v18, v126, v127
v_fma_f32 v109, v19, v126, v127
s_waitcnt lgkmcnt(1)
v_mfma_f32_16x16x32_bf16 v[138:141], a[16:19], v[182:185], v[138:141]
ds_read_b128 v[186:189], v210 offset:35840
v_cvt_pk_bf16_f32 v105, v108, v109
v_mfma_f32_16x16x32_bf16 v[142:145], a[40:43], v[182:185], v[142:145]
ds_write_b128 v211, v[102:105] offset:6144
v_mfma_f32_16x16x32_bf16 v[146:149], a[64:67], v[182:185], v[146:149]
v_fma_f32 v110, v20, v126, v127
v_fma_f32 v111, v21, v126, v127
v_mfma_f32_16x16x32_bf16 v[150:153], a[232:235], v[182:185], v[150:153]
v_cvt_pk_bf16_f32 v106, v110, v111
v_fma_f32 v112, v22, v126, v127
v_mfma_f32_16x16x32_bf16 v[154:157], v[224:227], v[182:185], v[154:157]
v_fma_f32 v113, v23, v126, v127
v_cvt_pk_bf16_f32 v107, v112, v113
v_mfma_f32_16x16x32_bf16 v[158:161], v[248:251], v[182:185], v[158:161]
ds_write_b64 v212, v[106:107] offset:6144
v_mfma_f32_16x16x32_bf16 v[162:165], v[182:185], a[88:91], v[162:165]
v_fma_f32 v108, v24, v134, v135
v_fma_f32 v109, v25, v134, v135
v_mfma_f32_16x16x32_bf16 v[166:169], v[182:185], a[112:115], v[166:169]
v_cvt_pk_bf16_f32 v90, v108, v109
v_fma_f32 v110, v26, v134, v135
v_mfma_f32_16x16x32_bf16 v[170:173], v[182:185], a[136:139], v[170:173]
s_waitcnt lgkmcnt(2)
v_fma_f32 v111, v27, v134, v135
v_cvt_pk_bf16_f32 v91, v110, v111
v_mfma_f32_16x16x32_bf16 v[138:141], a[20:23], v[186:189], v[138:141]
v_fma_f32 v112, v28, v134, v135
v_fma_f32 v113, v29, v134, v135
v_mfma_f32_16x16x32_bf16 v[142:145], a[44:47], v[186:189], v[142:145]
v_cvt_pk_bf16_f32 v92, v112, v113
v_fma_f32 v108, v30, v134, v135
v_mfma_f32_16x16x32_bf16 v[146:149], a[68:71], v[186:189], v[146:149]
v_fma_f32 v109, v31, v134, v135
v_cvt_pk_bf16_f32 v93, v108, v109
v_mfma_f32_16x16x32_bf16 v[150:153], a[236:239], v[186:189], v[150:153]
ds_write_b128 v211, v[90:93] offset:12288
v_mfma_f32_16x16x32_bf16 v[154:157], v[228:231], v[186:189], v[154:157]
v_fma_f32 v110, v32, v134, v135
v_fma_f32 v111, v33, v134, v135
v_mfma_f32_16x16x32_bf16 v[158:161], v[252:255], v[186:189], v[158:161]
v_cvt_pk_bf16_f32 v94, v110, v111
v_fma_f32 v112, v34, v134, v135
v_mfma_f32_16x16x32_bf16 v[162:165], v[186:189], a[92:95], v[162:165]
ds_read_b128 v[108:111], v216 offset:512
v_fma_f32 v113, v35, v134, v135
v_mfma_f32_16x16x32_bf16 v[166:169], v[186:189], a[116:119], v[166:169]
v_cvt_pk_bf16_f32 v95, v112, v113
v_cvt_pk_bf16_f32 v102, v138, v139
v_mfma_f32_16x16x32_bf16 v[170:173], v[186:189], a[140:143], v[170:173]
ds_read_b64 v[112:113], v216 offset:528
ds_write_b64 v212, v[94:95] offset:12288
v_cvt_pk_bf16_f32 v103, v140, v141
v_mfma_f32_16x16x32_bf16 v[138:141], v[78:81], v[72:75], 0
v_cvt_pk_bf16_f32 v104, v142, v143
v_cvt_pk_bf16_f32 v105, v144, v145
v_mfma_f32_16x16x32_bf16 v[142:145], v[96:99], v[72:75], 0
v_cvt_pk_bf16_f32 v106, v146, v147
v_cvt_pk_bf16_f32 v107, v148, v149
v_mfma_f32_16x16x32_bf16 v[146:149], v[102:105], v[72:75], 0
s_waitcnt lgkmcnt(2)
v_cvt_pk_bf16_f32 v90, v150, v151
v_cvt_pk_bf16_f32 v91, v152, v153
v_mfma_f32_16x16x32_bf16 v[150:153], v[108:111], v[72:75], v[206:209]
ds_read_b128 v[72:75], v216
v_cvt_pk_bf16_f32 v92, v154, v155
v_mfma_f32_16x16x16_bf16 v[138:141], v[82:83], v[76:77], v[138:141]
v_cvt_pk_bf16_f32 v93, v156, v157
v_cvt_pk_bf16_f32 v94, v158, v159
v_mfma_f32_16x16x16_bf16 v[142:145], v[100:101], v[76:77], v[142:145]
s_waitcnt lgkmcnt(2)
v_cvt_pk_bf16_f32 v95, v160, v161
v_cvt_pk_bf16_f32 v118, v162, v163
v_mfma_f32_16x16x16_bf16 v[150:153], v[112:113], v[76:77], v[150:153]
v_cvt_pk_bf16_f32 v119, v164, v165
v_cvt_pk_bf16_f32 v126, v166, v167
v_mfma_f32_16x16x16_bf16 v[146:149], v[106:107], v[76:77], v[146:149]
ds_read_b64 v[76:77], v216 offset:16
v_cvt_pk_bf16_f32 v127, v168, v169
v_mfma_f32_16x16x32_bf16 v[154:157], v[78:81], v[84:87], 0
v_cvt_pk_bf16_f32 v134, v170, v171
v_cvt_pk_bf16_f32 v135, v172, v173
v_mfma_f32_16x16x32_bf16 v[158:161], v[96:99], v[84:87], 0
v_exp_f32 v138, v138
v_mfma_f32_16x16x32_bf16 v[166:169], v[108:111], v[84:87], v[206:209]
v_exp_f32 v139, v139
v_mfma_f32_16x16x32_bf16 v[162:165], v[102:105], v[84:87], 0
v_exp_f32 v140, v140
v_mfma_f32_16x16x16_bf16 v[154:157], v[82:83], v[88:89], v[154:157]
v_exp_f32 v141, v141
v_mfma_f32_16x16x16_bf16 v[158:161], v[100:101], v[88:89], v[158:161]
v_exp_f32 v142, v142
v_mfma_f32_16x16x16_bf16 v[166:169], v[112:113], v[88:89], v[166:169]
v_exp_f32 v143, v143
v_mfma_f32_16x16x16_bf16 v[162:165], v[106:107], v[88:89], v[162:165]
v_exp_f32 v144, v144
v_exp_f32 v145, v145
v_exp_f32 v150, v150
v_exp_f32 v146, v146
v_exp_f32 v147, v147
v_exp_f32 v148, v148
v_exp_f32 v149, v149
v_cvt_pk_bf16_f32 v174, v138, v139
v_cvt_pk_bf16_f32 v175, v140, v141
v_cvt_pk_bf16_f32 v176, v142, v143
v_cvt_pk_bf16_f32 v177, v144, v145
v_cvt_pk_bf16_f32 v178, v146, v147
v_cvt_pk_bf16_f32 v179, v148, v149
v_mfma_f32_16x16x32_bf16 v[138:141], v[114:117], v[174:177], 0
v_cvt_pk_bf16_f32 v180, v150, 0
v_exp_f32 v154, v154
v_mfma_f32_16x16x32_bf16 v[150:153], v[190:193], v[174:177], 0
v_exp_f32 v155, v155
v_mfma_f32_16x16x32_bf16 v[142:145], v[122:125], v[174:177], 0
v_exp_f32 v156, v156
v_mfma_f32_16x16x32_bf16 v[146:149], v[130:133], v[174:177], 0
v_exp_f32 v157, v157
v_mfma_f32_16x16x32_bf16 v[150:153], v[190:193], v[178:181], v[150:153]
v_exp_f32 v158, v158
v_mfma_f32_16x16x32_bf16 v[138:141], v[118:121], v[178:181], v[138:141]
v_exp_f32 v159, v159
v_mfma_f32_16x16x32_bf16 v[142:145], v[126:129], v[178:181], v[142:145]
v_exp_f32 v160, v160
v_mfma_f32_16x16x32_bf16 v[146:149], v[134:137], v[178:181], v[146:149]
v_exp_f32 v161, v161
v_exp_f32 v166, v166
v_exp_f32 v162, v162
v_exp_f32 v163, v163
v_exp_f32 v164, v164
v_exp_f32 v165, v165
v_cvt_pk_bf16_f32 v174, v154, v155
v_cvt_pk_bf16_f32 v175, v156, v157
v_cvt_pk_bf16_f32 v176, v158, v159
v_cvt_pk_bf16_f32 v177, v160, v161
v_cvt_pk_bf16_f32 v178, v162, v163
v_cvt_pk_bf16_f32 v179, v164, v165
v_mfma_f32_16x16x32_bf16 v[154:157], v[114:117], v[174:177], 0
s_mov_b32 s38, s36
v_cvt_pk_bf16_f32 v180, v166, 0
v_rcp_f32 v151, v150
v_mfma_f32_16x16x32_bf16 v[166:169], v[190:193], v[174:177], 0
v_max3_u32 v219, v219, v150, v151
v_mul_f32 v138, v138, v151
v_mfma_f32_16x16x32_bf16 v[158:161], v[122:125], v[174:177], 0
v_mul_f32 v139, v139, v151
v_cvt_pk_bf16_f32 v138, v138, v139
v_mfma_f32_16x16x32_bf16 v[162:165], v[130:133], v[174:177], 0
v_mul_f32 v140, v140, v151
v_mul_f32 v141, v141, v151
v_mfma_f32_16x16x32_bf16 v[166:169], v[190:193], v[178:181], v[166:169]
v_cvt_pk_bf16_f32 v139, v140, v141
v_mul_f32 v142, v142, v151
v_mfma_f32_16x16x32_bf16 v[154:157], v[118:121], v[178:181], v[154:157]
v_mul_f32 v143, v143, v151
v_cvt_pk_bf16_f32 v140, v142, v143
v_mfma_f32_16x16x32_bf16 v[158:161], v[126:129], v[178:181], v[158:161]
v_mul_f32 v144, v144, v151
v_mul_f32 v145, v145, v151
v_mfma_f32_16x16x32_bf16 v[162:165], v[134:137], v[178:181], v[162:165]
v_cvt_pk_bf16_f32 v141, v144, v145
v_mul_f32 v146, v146, v151
v_mul_f32 v147, v147, v151
v_cvt_pk_bf16_f32 v142, v146, v147
v_mul_f32 v148, v148, v151
v_mul_f32 v149, v149, v151
v_mfma_f32_16x16x32_bf16 v[150:153], v[108:111], v[90:93], v[206:209]
ds_write_b128 v211, v[138:141] offset:36864
v_mfma_f32_16x16x32_bf16 v[138:141], v[78:81], v[90:93], 0
v_cvt_pk_bf16_f32 v143, v148, v149
v_rcp_f32 v167, v166
v_mfma_f32_16x16x32_bf16 v[146:149], v[102:105], v[90:93], 0
ds_write_b64 v212, v[142:143] offset:36864
v_mfma_f32_16x16x32_bf16 v[142:145], v[96:99], v[90:93], 0
v_max3_u32 v219, v219, v166, v167
v_mul_f32 v154, v154, v167
v_mfma_f32_16x16x16_bf16 v[138:141], v[82:83], v[94:95], v[138:141]
v_mul_f32 v155, v155, v167
v_cvt_pk_bf16_f32 v154, v154, v155
v_mfma_f32_16x16x16_bf16 v[150:153], v[112:113], v[94:95], v[150:153]
v_mul_f32 v156, v156, v167
v_mul_f32 v157, v157, v167
v_mfma_f32_16x16x16_bf16 v[142:145], v[100:101], v[94:95], v[142:145]
v_cvt_pk_bf16_f32 v155, v156, v157
v_mul_f32 v158, v158, v167
v_mfma_f32_16x16x16_bf16 v[146:149], v[106:107], v[94:95], v[146:149]
v_mul_f32 v159, v159, v167
v_cvt_pk_bf16_f32 v156, v158, v159
v_mul_f32 v160, v160, v167
v_mul_f32 v161, v161, v167
v_cvt_pk_bf16_f32 v157, v160, v161
v_mul_f32 v162, v162, v167
v_mul_f32 v163, v163, v167
v_cvt_pk_bf16_f32 v158, v162, v163
v_mul_f32 v164, v164, v167
v_mul_f32 v165, v165, v167
s_waitcnt lgkmcnt(3)
v_mfma_f32_16x16x32_bf16 v[166:169], v[108:111], v[72:75], v[206:209]
ds_write_b128 v211, v[154:157] offset:43008
v_mfma_f32_16x16x32_bf16 v[154:157], v[78:81], v[72:75], 0
v_cvt_pk_bf16_f32 v159, v164, v165
v_exp_f32 v138, v138
v_mfma_f32_16x16x32_bf16 v[162:165], v[102:105], v[72:75], 0
ds_write_b64 v212, v[158:159] offset:43008
v_mfma_f32_16x16x32_bf16 v[158:161], v[96:99], v[72:75], 0
s_waitcnt lgkmcnt(4)
v_exp_f32 v139, v139
v_mfma_f32_16x16x16_bf16 v[154:157], v[82:83], v[76:77], v[154:157]
v_exp_f32 v140, v140
v_mfma_f32_16x16x16_bf16 v[166:169], v[112:113], v[76:77], v[166:169]
v_exp_f32 v141, v141
v_mfma_f32_16x16x16_bf16 v[162:165], v[106:107], v[76:77], v[162:165]
v_exp_f32 v142, v142
v_mfma_f32_16x16x16_bf16 v[158:161], v[100:101], v[76:77], v[158:161]
s_waitcnt lgkmcnt(0)
v_exp_f32 v143, v143
v_exp_f32 v144, v144
v_exp_f32 v145, v145
v_exp_f32 v150, v150
v_exp_f32 v146, v146
v_exp_f32 v147, v147
s_barrier
ds_read_b128 v[170:173], v210 offset:36864
ds_read_b128 v[182:185], v210 offset:37888
ds_read_b128 v[186:189], v210 offset:38912
v_exp_f32 v148, v148
v_exp_f32 v149, v149
v_cvt_pk_bf16_f32 v174, v138, v139
v_cvt_pk_bf16_f32 v175, v140, v141
v_cvt_pk_bf16_f32 v176, v142, v143
v_cvt_pk_bf16_f32 v177, v144, v145
v_cvt_pk_bf16_f32 v178, v146, v147
v_cvt_pk_bf16_f32 v179, v148, v149
v_mfma_f32_16x16x32_bf16 v[138:141], v[114:117], v[174:177], 0
v_cvt_pk_bf16_f32 v180, v150, 0
v_exp_f32 v154, v154
v_mfma_f32_16x16x32_bf16 v[150:153], v[190:193], v[174:177], 0
v_exp_f32 v155, v155
v_mfma_f32_16x16x32_bf16 v[142:145], v[122:125], v[174:177], 0
s_waitcnt lgkmcnt(2)
v_exp_f32 v156, v156
v_mfma_f32_16x16x32_bf16 v[36:39], a[144:147], v[170:173], v[36:39]
v_exp_f32 v157, v157
v_mfma_f32_16x16x32_bf16 v[40:43], a[168:171], v[170:173], v[40:43]
v_exp_f32 v158, v158
v_mfma_f32_16x16x32_bf16 v[44:47], a[192:195], v[170:173], v[44:47]
s_waitcnt lgkmcnt(1)
ds_read_b128 v[170:173], v210 offset:39936
v_exp_f32 v159, v159
v_mfma_f32_16x16x32_bf16 v[36:39], a[148:151], v[182:185], v[36:39]
v_exp_f32 v160, v160
v_mfma_f32_16x16x32_bf16 v[40:43], a[172:175], v[182:185], v[40:43]
v_exp_f32 v161, v161
v_mfma_f32_16x16x32_bf16 v[44:47], a[196:199], v[182:185], v[44:47]
s_waitcnt lgkmcnt(1)
ds_read_b128 v[182:185], v210 offset:40960
v_exp_f32 v166, v166
v_mfma_f32_16x16x32_bf16 v[36:39], a[152:155], v[186:189], v[36:39]
v_exp_f32 v162, v162
v_mfma_f32_16x16x32_bf16 v[40:43], a[176:179], v[186:189], v[40:43]
v_exp_f32 v163, v163
v_mfma_f32_16x16x32_bf16 v[44:47], a[200:203], v[186:189], v[44:47]
s_waitcnt lgkmcnt(1)
ds_read_b128 v[186:189], v210 offset:41984
v_exp_f32 v164, v164
v_mfma_f32_16x16x32_bf16 v[36:39], a[156:159], v[170:173], v[36:39]
v_exp_f32 v165, v165
v_mfma_f32_16x16x32_bf16 v[40:43], a[180:183], v[170:173], v[40:43]
v_mfma_f32_16x16x32_bf16 v[44:47], a[204:207], v[170:173], v[44:47]
s_waitcnt lgkmcnt(1)
ds_read_b128 v[170:173], v210 offset:43008
v_mfma_f32_16x16x32_bf16 v[36:39], a[160:163], v[182:185], v[36:39]
v_mfma_f32_16x16x32_bf16 v[40:43], a[184:187], v[182:185], v[40:43]
v_mfma_f32_16x16x32_bf16 v[44:47], a[208:211], v[182:185], v[44:47]
ds_read_b128 v[182:185], v210 offset:44032
v_mfma_f32_16x16x32_bf16 v[146:149], v[130:133], v[174:177], 0
s_waitcnt lgkmcnt(2)
v_cvt_pk_bf16_f32 v174, v154, v155
v_cvt_pk_bf16_f32 v175, v156, v157
v_mfma_f32_16x16x32_bf16 v[36:39], a[164:167], v[186:189], v[36:39]
v_cvt_pk_bf16_f32 v176, v158, v159
v_cvt_pk_bf16_f32 v177, v160, v161
v_mfma_f32_16x16x32_bf16 v[150:153], v[190:193], v[178:181], v[150:153]
v_mfma_f32_16x16x32_bf16 v[138:141], v[118:121], v[178:181], v[138:141]
v_mfma_f32_16x16x32_bf16 v[40:43], a[188:191], v[186:189], v[40:43]
s_nop 2
v_cvt_pk_bf16_f32 v36, v36, v37
v_cvt_pk_bf16_f32 v37, v38, v39
v_mfma_f32_16x16x32_bf16 v[142:145], v[126:129], v[178:181], v[142:145]
buffer_store_dwordx2 v[36:37], v203, s[8:11], s39 offen
v_mfma_f32_16x16x32_bf16 v[44:47], a[212:215], v[186:189], v[44:47]
ds_read_b128 v[186:189], v210 offset:45056
v_rcp_f32 v151, v150
v_mfma_f32_16x16x32_bf16 v[146:149], v[134:137], v[178:181], v[146:149]
s_waitcnt lgkmcnt(2)
v_cvt_pk_bf16_f32 v40, v40, v41
v_cvt_pk_bf16_f32 v41, v42, v43
v_mfma_f32_16x16x32_bf16 v[48:51], a[144:147], v[170:173], v[48:51]
buffer_store_dwordx2 v[40:41], v203, s[8:11], s39 offen offset:32
v_mfma_f32_16x16x32_bf16 v[52:55], a[168:171], v[170:173], v[52:55]
v_cvt_pk_bf16_f32 v44, v44, v45
v_cvt_pk_bf16_f32 v45, v46, v47
v_mfma_f32_16x16x32_bf16 v[56:59], a[192:195], v[170:173], v[56:59]
s_waitcnt lgkmcnt(1)
ds_read_b128 v[170:173], v210 offset:46080
buffer_store_dwordx2 v[44:45], v203, s[8:11], s39 offen offset:64
v_mfma_f32_16x16x32_bf16 v[48:51], a[148:151], v[182:185], v[48:51]
v_cvt_pk_bf16_f32 v178, v162, v163
v_cvt_pk_bf16_f32 v179, v164, v165
v_mfma_f32_16x16x32_bf16 v[52:55], a[172:175], v[182:185], v[52:55]
v_cvt_pk_bf16_f32 v180, v166, 0
v_max3_u32 v219, v219, v150, v151
v_mfma_f32_16x16x32_bf16 v[56:59], a[196:199], v[182:185], v[56:59]
s_waitcnt lgkmcnt(1)
ds_read_b128 v[182:185], v210 offset:47104
v_mul_f32 v138, v138, v151
v_mfma_f32_16x16x32_bf16 v[48:51], a[152:155], v[186:189], v[48:51]
v_mul_f32 v139, v139, v151
v_cvt_pk_bf16_f32 v138, v138, v139
v_mfma_f32_16x16x32_bf16 v[52:55], a[176:179], v[186:189], v[52:55]
v_mul_f32 v140, v140, v151
v_mul_f32 v141, v141, v151
v_mfma_f32_16x16x32_bf16 v[56:59], a[200:203], v[186:189], v[56:59]
s_waitcnt lgkmcnt(1)
ds_read_b128 v[186:189], v210 offset:48128
v_cvt_pk_bf16_f32 v139, v140, v141
v_mfma_f32_16x16x32_bf16 v[48:51], a[156:159], v[170:173], v[48:51]
v_mul_f32 v142, v142, v151
v_mul_f32 v143, v143, v151
v_mfma_f32_16x16x32_bf16 v[52:55], a[180:183], v[170:173], v[52:55]
v_cvt_pk_bf16_f32 v140, v142, v143
v_mul_f32 v144, v144, v151
v_mfma_f32_16x16x32_bf16 v[56:59], a[204:207], v[170:173], v[56:59]
s_waitcnt lgkmcnt(1)
v_mul_f32 v145, v145, v151
v_cvt_pk_bf16_f32 v141, v144, v145
v_mfma_f32_16x16x32_bf16 v[48:51], a[160:163], v[182:185], v[48:51]
ds_write_b128 v211, v[138:141] offset:49152
v_mfma_f32_16x16x32_bf16 v[52:55], a[184:187], v[182:185], v[52:55]
v_mul_f32 v146, v146, v151
v_mul_f32 v147, v147, v151
v_mfma_f32_16x16x32_bf16 v[166:169], v[190:193], v[174:177], 0
v_cvt_pk_bf16_f32 v142, v146, v147
v_mul_f32 v148, v148, v151
v_mfma_f32_16x16x32_bf16 v[56:59], a[208:211], v[182:185], v[56:59]
v_mul_f32 v149, v149, v151
v_cvt_pk_bf16_f32 v143, v148, v149
v_mfma_f32_16x16x32_bf16 v[154:157], v[114:117], v[174:177], 0
ds_write_b64 v212, v[142:143] offset:49152
v_mfma_f32_16x16x32_bf16 v[158:161], v[122:125], v[174:177], 0
v_mfma_f32_16x16x32_bf16 v[162:165], v[130:133], v[174:177], 0
s_waitcnt lgkmcnt(2)
ds_read_b128 v[174:177], v218
v_mfma_f32_16x16x32_bf16 v[48:51], a[164:167], v[186:189], v[48:51]
v_mfma_f32_16x16x32_bf16 v[166:169], v[190:193], v[178:181], v[166:169]
v_mfma_f32_16x16x32_bf16 v[154:157], v[118:121], v[178:181], v[154:157]
v_mfma_f32_16x16x32_bf16 v[52:55], a[188:191], v[186:189], v[52:55]
s_nop 4
v_cvt_pk_bf16_f32 v48, v48, v49
v_cvt_pk_bf16_f32 v49, v50, v51
v_mfma_f32_16x16x32_bf16 v[158:161], v[126:129], v[178:181], v[158:161]
s_waitcnt lgkmcnt(1)
v_rcp_f32 v167, v166
v_mfma_f32_16x16x32_bf16 v[56:59], a[212:215], v[186:189], v[56:59]
s_barrier
ds_read_b128 v[170:173], v210 offset:49152
v_mfma_f32_16x16x32_bf16 v[162:165], v[134:137], v[178:181], v[162:165]
ds_read_b128 v[182:185], v210 offset:50176
buffer_store_dwordx2 v[48:49], v204, s[8:11], s39 offen
v_max3_u32 v219, v219, v166, v167
v_mul_f32 v154, v154, v167
v_mul_f32 v155, v155, v167
v_cvt_pk_bf16_f32 v154, v154, v155
v_mul_f32 v156, v156, v167
v_mul_f32 v157, v157, v167
v_cvt_pk_bf16_f32 v155, v156, v157
v_mul_f32 v158, v158, v167
v_mul_f32 v159, v159, v167
v_cvt_pk_bf16_f32 v156, v158, v159
v_mul_f32 v160, v160, v167
v_mul_f32 v161, v161, v167
v_cvt_pk_bf16_f32 v157, v160, v161
v_mul_f32 v162, v162, v167
v_mul_f32 v163, v163, v167
v_cvt_pk_bf16_f32 v158, v162, v163
v_mul_f32 v164, v164, v167
v_mul_f32 v165, v165, v167
v_cvt_pk_bf16_f32 v159, v164, v165
s_waitcnt lgkmcnt(1)
v_mfma_f32_16x16x32_bf16 v[60:63], a[144:147], v[170:173], v[60:63]
ds_write_b128 v216, v[154:157]
v_mfma_f32_16x16x32_bf16 v[64:67], a[168:171], v[170:173], v[64:67]
ds_write_b64 v216, v[158:159] offset:16
v_mfma_f32_16x16x32_bf16 v[68:71], a[192:195], v[170:173], v[68:71]
s_waitcnt lgkmcnt(2)
ds_read_b128 v[186:189], v210 offset:51200
ds_read_b128 v[170:173], v210 offset:52224
v_mfma_f32_16x16x32_bf16 v[60:63], a[148:151], v[182:185], v[60:63]
v_add_u32 v216, 1408, v216
v_cvt_pk_bf16_f32 v52, v52, v53
v_mfma_f32_16x16x32_bf16 v[64:67], a[172:175], v[182:185], v[64:67]
v_cvt_pk_bf16_f32 v53, v54, v55
v_cvt_pk_bf16_f32 v56, v56, v57
v_mfma_f32_16x16x32_bf16 v[68:71], a[196:199], v[182:185], v[68:71]
s_waitcnt vmcnt(4)
buffer_store_dwordx2 v[52:53], v204, s[8:11], s39 offen offset:32
ds_read_b128 v[182:185], v210 offset:53248
v_cvt_pk_bf16_f32 v57, v58, v59
s_barrier
buffer_store_dwordx2 v[56:57], v204, s[8:11], s39 offen offset:64
ds_read_b128 v[84:87], v200
ds_read_b128 v[92:95], v201
ds_read_b128 v[100:103], v202
ds_read_b128 v[178:181], v218 offset:528
ds_read_b128 v[88:91], v194 offset:16
ds_read_b128 v[96:99], v195 offset:16
ds_read_b128 v[104:107], v196 offset:16
s_waitcnt lgkmcnt(9)
v_mfma_f32_16x16x32_bf16 v[60:63], a[152:155], v[186:189], v[60:63]
v_mfma_f32_16x16x32_bf16 v[64:67], a[176:179], v[186:189], v[64:67]
v_mfma_f32_16x16x32_bf16 v[68:71], a[200:203], v[186:189], v[68:71]
s_waitcnt lgkmcnt(8)
ds_read_b128 v[186:189], v210 offset:54272
v_mfma_f32_16x16x32_bf16 v[60:63], a[156:159], v[170:173], v[60:63]
v_mfma_f32_16x16x32_bf16 v[64:67], a[180:183], v[170:173], v[64:67]
v_mfma_f32_16x16x32_bf16 v[68:71], a[204:207], v[170:173], v[68:71]
s_waitcnt lgkmcnt(8)
v_mfma_f32_16x16x32_bf16 v[60:63], a[160:163], v[182:185], v[60:63]
v_mfma_f32_16x16x32_bf16 v[64:67], a[184:187], v[182:185], v[64:67]
v_mfma_f32_16x16x32_bf16 v[68:71], a[208:211], v[182:185], v[68:71]
s_waitcnt lgkmcnt(7)
ds_read_b128 v[182:185], v210
v_mfma_f32_16x16x32_bf16 v[36:39], v[174:177], v[84:87], 0
s_waitcnt lgkmcnt(7)
ds_read_b128 v[84:87], v194
v_mfma_f32_16x16x32_bf16 v[48:51], v[174:177], v[92:95], 0
s_waitcnt lgkmcnt(2)
ds_read_b128 v[92:95], v195
v_mfma_f32_16x16x32_bf16 v[60:63], a[164:167], v[186:189], v[60:63]
v_mfma_f32_16x16x32_bf16 v[64:67], a[188:191], v[186:189], v[64:67]
v_mfma_f32_16x16x32_bf16 v[68:71], a[212:215], v[186:189], v[68:71]
s_waitcnt lgkmcnt(2)
ds_read_b128 v[186:189], v210 offset:1024
s_nop 3
v_cvt_pk_bf16_f32 v60, v60, v61
v_cvt_pk_bf16_f32 v61, v62, v63
v_mfma_f32_16x16x32_bf16 v[138:141], a[0:3], v[182:185], 0
buffer_store_dwordx2 v[60:61], v205, s[8:11], s39 offen
v_mfma_f32_16x16x32_bf16 v[142:145], a[24:27], v[182:185], 0
v_cvt_pk_bf16_f32 v64, v64, v65
v_cvt_pk_bf16_f32 v65, v66, v67
v_mfma_f32_16x16x32_bf16 v[146:149], a[48:51], v[182:185], 0
buffer_store_dwordx2 v[64:65], v205, s[8:11], s39 offen offset:32
v_mfma_f32_16x16x32_bf16 v[150:153], a[216:219], v[182:185], 0
v_cvt_pk_bf16_f32 v68, v68, v69
v_cvt_pk_bf16_f32 v69, v70, v71
v_mfma_f32_16x16x32_bf16 v[154:157], a[240:243], v[182:185], 0
buffer_store_dwordx2 v[68:69], v205, s[8:11], s39 offen offset:64
v_mfma_f32_16x16x32_bf16 v[158:161], v[232:235], v[182:185], 0
v_mfma_f32_16x16x32_bf16 v[162:165], v[182:185], a[72:75], 0
v_mfma_f32_16x16x32_bf16 v[166:169], v[182:185], a[96:99], 0
v_mfma_f32_16x16x32_bf16 v[170:173], v[182:185], a[120:123], 0
s_waitcnt lgkmcnt(0)
ds_read_b128 v[182:185], v210 offset:2048
v_mfma_f32_16x16x32_bf16 v[138:141], a[4:7], v[186:189], v[138:141]
v_mfma_f32_16x16x32_bf16 v[142:145], a[28:31], v[186:189], v[142:145]
v_mfma_f32_16x16x32_bf16 v[146:149], a[52:55], v[186:189], v[146:149]
v_mfma_f32_16x16x32_bf16 v[150:153], a[220:223], v[186:189], v[150:153]
v_mfma_f32_16x16x32_bf16 v[154:157], a[244:247], v[186:189], v[154:157]
s_mul_hi_u32 s41, s35, 58835169
v_mfma_f32_16x16x32_bf16 v[60:63], v[174:177], v[100:103], 0
ds_read_b128 v[100:103], v196
ds_read_b128 v[174:177], v218 offset:1056
v_mfma_f32_16x16x32_bf16 v[158:161], v[236:239], v[186:189], v[158:161]
s_mul_i32 s42, s41, 73
s_sub_u32 s42, s35, s42
s_mul_i32 s43, s41, 1373568
v_mfma_f32_16x16x32_bf16 v[162:165], v[186:189], a[76:79], v[162:165]
s_mul_i32 s51, s42, 2688
v_mfma_f32_16x16x32_bf16 v[166:169], v[186:189], a[100:103], v[166:169]
s_add_u32 s43, s43, s51
s_cmp_lt_u32 s35, s34
v_mfma_f32_16x16x32_bf16 v[170:173], v[186:189], a[124:127], v[170:173]
ds_read_b128 v[186:189], v210 offset:3072
v_smfmac_f32_16x16x64_bf16 v[36:39], v[178:181], v[84:91], v207
s_waitcnt lgkmcnt(3)
ds_read_b128 v[84:87], v197
ds_read_b128 v[88:91], v197 offset:16
v_mfma_f32_16x16x32_bf16 v[138:141], a[8:11], v[182:185], v[138:141]
s_cselect_b32 s36, s43, 1879048192
s_add_u32 s35, s35, 32
s_cmp_eq_u32 s42, 0
v_mfma_f32_16x16x32_bf16 v[142:145], a[32:35], v[182:185], v[142:145]
s_cselect_b32 s44, 536870911, s72
s_cmp_eq_u32 s42, 72
v_smfmac_f32_16x16x64_bf16 v[48:51], v[178:181], v[92:99], v207
ds_read_b128 v[92:95], v198
ds_read_b128 v[96:99], v198 offset:16
v_mfma_f32_16x16x32_bf16 v[146:149], a[56:59], v[182:185], v[146:149]
s_cselect_b32 s44, 939524095, s44
v_and_b32 v209, s44, v208
s_cmp_eq_u32 s41, 0
v_mfma_f32_16x16x32_bf16 v[150:153], a[224:227], v[182:185], v[150:153]
s_cselect_b32 s40, 1879048192, s36
s_add_u32 m0, s45, 0
v_mfma_f32_16x16x32_bf16 v[154:157], a[248:251], v[182:185], v[154:157]
s_waitcnt lgkmcnt(6)
v_smfmac_f32_16x16x64_bf16 v[60:63], v[178:181], v[100:107], v207
ds_read_b128 v[100:103], v199
ds_read_b128 v[104:107], v199 offset:16
v_mfma_f32_16x16x32_bf16 v[158:161], v[240:243], v[182:185], v[158:161]
ds_read_b128 v[178:181], v218 offset:1584
v_mfma_f32_16x16x32_bf16 v[162:165], v[182:185], a[80:83], v[162:165]
v_mfma_f32_16x16x32_bf16 v[166:169], v[182:185], a[104:107], v[166:169]
v_mfma_f32_16x16x32_bf16 v[170:173], v[182:185], a[128:131], v[170:173]
s_waitcnt lgkmcnt(5)
ds_read_b128 v[182:185], v210 offset:4096
v_smfmac_f32_16x16x64_bf16 v[36:39], v[174:177], v[84:91], v207
ds_read_b128 v[84:87], v200 offset:32
ds_read_b128 v[88:91], v194 offset:48
v_mfma_f32_16x16x32_bf16 v[138:141], a[12:15], v[186:189], v[138:141]
v_mfma_f32_16x16x32_bf16 v[142:145], a[36:39], v[186:189], v[142:145]
s_waitcnt lgkmcnt(6)
v_smfmac_f32_16x16x64_bf16 v[48:51], v[174:177], v[92:99], v207
ds_read_b128 v[92:95], v201 offset:32
ds_read_b128 v[96:99], v195 offset:48
v_mfma_f32_16x16x32_bf16 v[146:149], a[60:63], v[186:189], v[146:149]
v_add_f32 v118, v36, v37
v_mul_f32 v119, v36, v36
v_mfma_f32_16x16x32_bf16 v[150:153], a[228:231], v[186:189], v[150:153]
v_add_f32 v118, v118, v38
v_fmac_f32 v119, v37, v37
v_mfma_f32_16x16x32_bf16 v[154:157], a[252:255], v[186:189], v[154:157]
s_waitcnt lgkmcnt(6)
v_add_f32 v118, v118, v39
v_fmac_f32 v119, v38, v38
v_smfmac_f32_16x16x64_bf16 v[60:63], v[174:177], v[100:107], v207
ds_read_b128 v[100:103], v202 offset:32
ds_read_b128 v[174:177], v218 offset:2112
v_mfma_f32_16x16x32_bf16 v[158:161], v[244:247], v[186:189], v[158:161]
ds_read_b128 v[104:107], v196 offset:48
v_fmac_f32 v119, v39, v39
v_mfma_f32_16x16x32_bf16 v[162:165], v[186:189], a[84:87], v[162:165]
v_add_f32 v126, v48, v49
v_mul_f32 v127, v48, v48
v_mfma_f32_16x16x32_bf16 v[166:169], v[186:189], a[108:111], v[166:169]
s_waitcnt lgkmcnt(6)
v_add_f32 v126, v126, v50
v_fmac_f32 v127, v49, v49
v_mfma_f32_16x16x32_bf16 v[40:43], v[178:181], v[84:87], 0
ds_read_b128 v[84:87], v194 offset:32
v_add_f32 v126, v126, v51
v_mfma_f32_16x16x32_bf16 v[170:173], v[186:189], a[132:135], v[170:173]
s_waitcnt lgkmcnt(5)
ds_read_b128 v[186:189], v210 offset:5120
v_fmac_f32 v127, v50, v50
v_mfma_f32_16x16x32_bf16 v[52:55], v[178:181], v[92:95], 0
ds_read_b128 v[92:95], v195 offset:32
v_fmac_f32 v127, v51, v51
v_mfma_f32_16x16x32_bf16 v[138:141], a[16:19], v[182:185], v[138:141]
s_waitcnt lgkmcnt(5)
v_add_f32 v134, v60, v61
v_mul_f32 v135, v60, v60
v_mfma_f32_16x16x32_bf16 v[64:67], v[178:181], v[100:103], 0
ds_read_b128 v[100:103], v196 offset:32
ds_read_b128 v[178:181], v218 offset:2640
v_mfma_f32_16x16x32_bf16 v[142:145], a[40:43], v[182:185], v[142:145]
v_add_f32 v134, v134, v62
v_fmac_f32 v135, v61, v61
v_mfma_f32_16x16x32_bf16 v[146:149], a[64:67], v[182:185], v[146:149]
v_add_f32 v134, v134, v63
v_fmac_f32 v135, v62, v62
v_mfma_f32_16x16x32_bf16 v[150:153], a[232:235], v[182:185], v[150:153]
v_fmac_f32 v135, v63, v63
v_mfma_f32_16x16x32_bf16 v[154:157], v[224:227], v[182:185], v[154:157]
s_waitcnt lgkmcnt(4)
v_smfmac_f32_16x16x64_bf16 v[40:43], v[174:177], v[84:91], v207
ds_read_b128 v[84:87], v197 offset:32
ds_read_b128 v[88:91], v197 offset:48
v_mfma_f32_16x16x32_bf16 v[158:161], v[248:251], v[182:185], v[158:161]
v_mfma_f32_16x16x32_bf16 v[162:165], v[182:185], a[88:91], v[162:165]
v_mfma_f32_16x16x32_bf16 v[166:169], v[182:185], a[112:115], v[166:169]
s_waitcnt lgkmcnt(4)
v_smfmac_f32_16x16x64_bf16 v[52:55], v[174:177], v[92:99], v207
ds_read_b128 v[92:95], v198 offset:32
ds_read_b128 v[96:99], v198 offset:48
v_mfma_f32_16x16x32_bf16 v[170:173], v[182:185], a[136:139], v[170:173]
ds_read_b128 v[182:185], v210 offset:6144
v_mfma_f32_16x16x32_bf16 v[138:141], a[20:23], v[186:189], v[138:141]
s_waitcnt lgkmcnt(6)
v_smfmac_f32_16x16x64_bf16 v[64:67], v[174:177], v[100:107], v207
ds_read_b128 v[100:103], v199 offset:32
ds_read_b128 v[104:107], v199 offset:48
v_mfma_f32_16x16x32_bf16 v[142:145], a[44:47], v[186:189], v[142:145]
ds_read_b128 v[174:177], v218 offset:3168
v_mfma_f32_16x16x32_bf16 v[146:149], a[68:71], v[186:189], v[146:149]
s_nop 0
v_cvt_pk_bf16_f32 v78, v138, v139
v_cvt_pk_bf16_f32 v79, v140, v141
v_mfma_f32_16x16x32_bf16 v[150:153], a[236:239], v[186:189], v[150:153]
v_mfma_f32_16x16x32_bf16 v[154:157], v[228:231], v[186:189], v[154:157]
s_waitcnt lgkmcnt(6)
v_cvt_pk_bf16_f32 v80, v142, v143
v_cvt_pk_bf16_f32 v81, v144, v145
v_smfmac_f32_16x16x64_bf16 v[40:43], v[178:181], v[84:91], v207
ds_read_b128 v[84:87], v200 offset:64
v_cvt_pk_bf16_f32 v82, v146, v147
v_mfma_f32_16x16x32_bf16 v[158:161], v[252:255], v[186:189], v[158:161]
v_cvt_pk_bf16_f32 v83, v148, v149
v_cvt_pk_bf16_f32 v72, v150, v151
v_mfma_f32_16x16x32_bf16 v[162:165], v[186:189], a[92:95], v[162:165]
v_cvt_pk_bf16_f32 v73, v152, v153
v_cvt_pk_bf16_f32 v74, v154, v155
v_mfma_f32_16x16x32_bf16 v[166:169], v[186:189], a[116:119], v[166:169]
s_waitcnt lgkmcnt(5)
v_cvt_pk_bf16_f32 v75, v156, v157
v_add_f32 v118, v118, v40
v_smfmac_f32_16x16x64_bf16 v[52:55], v[178:181], v[92:99], v207
ds_read_b128 v[92:95], v201 offset:64
v_cvt_pk_bf16_f32 v76, v158, v159
v_mfma_f32_16x16x32_bf16 v[170:173], v[186:189], a[140:143], v[170:173]
s_waitcnt lgkmcnt(5)
ds_read_b128 v[186:189], v210 offset:7168
v_cvt_pk_bf16_f32 v77, v160, v161
v_mfma_f32_16x16x32_bf16 v[138:141], a[0:3], v[182:185], 0
v_cvt_pk_bf16_f32 v114, v162, v163
v_cvt_pk_bf16_f32 v115, v164, v165
v_mfma_f32_16x16x32_bf16 v[142:145], a[24:27], v[182:185], 0
s_waitcnt lgkmcnt(4)
ds_read_b128 v[88:91], v194 offset:80
v_cvt_pk_bf16_f32 v122, v166, v167
v_smfmac_f32_16x16x64_bf16 v[64:67], v[178:181], v[100:107], v207
ds_read_b128 v[100:103], v202 offset:64
ds_read_b128 v[178:181], v218 offset:3696
v_mfma_f32_16x16x32_bf16 v[146:149], a[48:51], v[182:185], 0
v_cvt_pk_bf16_f32 v123, v168, v169
v_cvt_pk_bf16_f32 v130, v170, v171
v_mfma_f32_16x16x32_bf16 v[150:153], a[216:219], v[182:185], 0
v_cvt_pk_bf16_f32 v131, v172, v173
v_fmac_f32 v119, v40, v40
v_mfma_f32_16x16x32_bf16 v[154:157], a[240:243], v[182:185], 0
s_waitcnt lgkmcnt(5)
ds_read_b128 v[96:99], v195 offset:80
ds_read_b128 v[104:107], v196 offset:80
v_mfma_f32_16x16x32_bf16 v[44:47], v[174:177], v[84:87], 0
ds_read_b128 v[84:87], v194 offset:64
v_add_f32 v118, v118, v41
v_mfma_f32_16x16x32_bf16 v[158:161], v[232:235], v[182:185], 0
v_fmac_f32 v119, v41, v41
v_add_f32 v118, v118, v42
v_mfma_f32_16x16x32_bf16 v[162:165], v[182:185], a[72:75], 0
s_waitcnt lgkmcnt(7)
v_fmac_f32 v119, v42, v42
v_add_f32 v118, v118, v43
v_mfma_f32_16x16x32_bf16 v[56:59], v[174:177], v[92:95], 0
ds_read_b128 v[92:95], v195 offset:64
v_fmac_f32 v119, v43, v43
v_mfma_f32_16x16x32_bf16 v[166:169], v[182:185], a[96:99], 0
v_add_f32 v126, v126, v52
v_fmac_f32 v127, v52, v52
v_mfma_f32_16x16x32_bf16 v[170:173], v[182:185], a[120:123], 0
s_waitcnt lgkmcnt(5)
ds_read_b128 v[182:185], v210 offset:8192
v_add_f32 v126, v126, v53
v_mfma_f32_16x16x32_bf16 v[68:71], v[174:177], v[100:103], 0
ds_read_b128 v[100:103], v196 offset:64
ds_read_b128 v[174:177], v218 offset:4224
v_mfma_f32_16x16x32_bf16 v[138:141], a[4:7], v[186:189], v[138:141]
v_fmac_f32 v127, v53, v53
v_add_f32 v126, v126, v54
v_mfma_f32_16x16x32_bf16 v[142:145], a[28:31], v[186:189], v[142:145]
v_fmac_f32 v127, v54, v54
v_add_f32 v126, v126, v55
v_mfma_f32_16x16x32_bf16 v[146:149], a[52:55], v[186:189], v[146:149]
s_waitcnt lgkmcnt(4)
v_fmac_f32 v127, v55, v55
v_add_f32 v134, v134, v64
v_smfmac_f32_16x16x64_bf16 v[44:47], v[178:181], v[84:91], v207
ds_read_b128 v[84:87], v197 offset:64
ds_read_b128 v[88:91], v197 offset:80
v_mfma_f32_16x16x32_bf16 v[150:153], a[220:223], v[186:189], v[150:153]
v_fmac_f32 v135, v64, v64
v_add_f32 v134, v134, v65
v_mfma_f32_16x16x32_bf16 v[154:157], a[244:247], v[186:189], v[154:157]
v_fmac_f32 v135, v65, v65
v_add_f32 v134, v134, v66
v_mfma_f32_16x16x32_bf16 v[158:161], v[236:239], v[186:189], v[158:161]
s_waitcnt lgkmcnt(5)
v_fmac_f32 v135, v66, v66
v_add_f32 v134, v134, v67
v_smfmac_f32_16x16x64_bf16 v[56:59], v[178:181], v[92:99], v207
ds_read_b128 v[92:95], v198 offset:64
ds_read_b128 v[96:99], v198 offset:80
v_mfma_f32_16x16x32_bf16 v[162:165], v[186:189], a[76:79], v[162:165]
v_fmac_f32 v135, v67, v67
v_mfma_f32_16x16x32_bf16 v[166:169], v[186:189], a[100:103], v[166:169]
ds_read_u16 v120, v217
ds_read_u16 v128, v217 offset:32
v_mfma_f32_16x16x32_bf16 v[170:173], v[186:189], a[124:127], v[170:173]
s_sub_u32 s46, s46, 1
s_cmp_lg_u32 s46, 0
s_cbranch_scc1 F_loop
ds_read_b128 v[186:189], v210 offset:9216
ds_read_u16 v136, v217 offset:64
s_waitcnt lgkmcnt(9)
v_smfmac_f32_16x16x64_bf16 v[68:71], v[178:181], v[100:107], v207
ds_read_b128 v[100:103], v199 offset:64
ds_read_b128 v[104:107], v199 offset:80
v_mfma_f32_16x16x32_bf16 v[138:141], a[8:11], v[182:185], v[138:141]
v_add_u32 v217, 1408, v217
v_mfma_f32_16x16x32_bf16 v[142:145], a[32:35], v[182:185], v[142:145]
v_mfma_f32_16x16x32_bf16 v[146:149], a[56:59], v[182:185], v[146:149]
s_waitcnt lgkmcnt(8)
v_smfmac_f32_16x16x64_bf16 v[44:47], v[174:177], v[84:91], v207
v_mfma_f32_16x16x32_bf16 v[150:153], a[224:227], v[182:185], v[150:153]
v_mfma_f32_16x16x32_bf16 v[154:157], a[248:251], v[182:185], v[154:157]
v_mfma_f32_16x16x32_bf16 v[158:161], v[240:243], v[182:185], v[158:161]
s_waitcnt lgkmcnt(6)
s_nop 3
v_add_f32 v118, v118, v44
v_fmac_f32 v119, v44, v44
v_smfmac_f32_16x16x64_bf16 v[56:59], v[174:177], v[92:99], v207
v_add_f32 v118, v118, v45
v_fmac_f32 v119, v45, v45
v_mfma_f32_16x16x32_bf16 v[162:165], v[182:185], a[80:83], v[162:165]
v_add_f32 v118, v118, v46
v_fmac_f32 v119, v46, v46
v_mfma_f32_16x16x32_bf16 v[166:169], v[182:185], a[104:107], v[166:169]
v_add_f32 v118, v118, v47
v_fmac_f32 v119, v47, v47
v_mfma_f32_16x16x32_bf16 v[170:173], v[182:185], a[128:131], v[170:173]
s_waitcnt lgkmcnt(0)
ds_read_b128 v[182:185], v210 offset:10240
v_add_f32 v126, v126, v56
v_smfmac_f32_16x16x64_bf16 v[68:71], v[174:177], v[100:107], v207
v_fmac_f32 v127, v56, v56
v_add_f32 v126, v126, v57
v_mfma_f32_16x16x32_bf16 v[138:141], a[12:15], v[186:189], v[138:141]
v_fmac_f32 v127, v57, v57
v_add_f32 v126, v126, v58
v_mfma_f32_16x16x32_bf16 v[142:145], a[36:39], v[186:189], v[142:145]
v_fmac_f32 v127, v58, v58
v_add_f32 v126, v126, v59
v_mfma_f32_16x16x32_bf16 v[146:149], a[60:63], v[186:189], v[146:149]
v_fmac_f32 v127, v59, v59
v_add_f32 v134, v134, v68
v_mfma_f32_16x16x32_bf16 v[150:153], a[228:231], v[186:189], v[150:153]
v_fmac_f32 v135, v68, v68
v_add_f32 v134, v134, v69
v_mfma_f32_16x16x32_bf16 v[154:157], a[252:255], v[186:189], v[154:157]
v_fmac_f32 v135, v69, v69
v_add_f32 v134, v134, v70
v_mfma_f32_16x16x32_bf16 v[158:161], v[244:247], v[186:189], v[158:161]
v_fmac_f32 v135, v70, v70
v_add_f32 v134, v134, v71
v_mfma_f32_16x16x32_bf16 v[162:165], v[186:189], a[84:87], v[162:165]
v_permlane16_swap_b32 v118, v119
v_mfma_f32_16x16x32_bf16 v[166:169], v[186:189], a[108:111], v[166:169]
v_fmac_f32 v135, v71, v71
v_add_f32 v118, v118, v119
v_mfma_f32_16x16x32_bf16 v[170:173], v[186:189], a[132:135], v[170:173]
s_waitcnt lgkmcnt(0)
ds_read_b128 v[186:189], v210 offset:11264
v_permlane16_swap_b32 v126, v127
v_mfma_f32_16x16x32_bf16 v[138:141], a[16:19], v[182:185], v[138:141]
v_add_f32 v126, v126, v127
v_permlane16_swap_b32 v134, v135
v_mfma_f32_16x16x32_bf16 v[142:145], a[40:43], v[182:185], v[142:145]
v_add_f32 v134, v134, v135
v_permlane32_swap_b32 v118, v126
v_mfma_f32_16x16x32_bf16 v[146:149], a[64:67], v[182:185], v[146:149]
v_add_f32 v118, v118, v126
v_mov_b32 v135, v134
v_mfma_f32_16x16x32_bf16 v[150:153], a[232:235], v[182:185], v[150:153]
ds_write_b32 v213, v118
v_mfma_f32_16x16x32_bf16 v[154:157], v[224:227], v[182:185], v[154:157]
v_permlane32_swap_b32 v134, v135
v_mfma_f32_16x16x32_bf16 v[158:161], v[248:251], v[182:185], v[158:161]
v_add_f32 v134, v134, v135
v_mfma_f32_16x16x32_bf16 v[162:165], v[182:185], a[88:91], v[162:165]
ds_write_b32 v213, v134 offset:512
v_mfma_f32_16x16x32_bf16 v[166:169], v[182:185], a[112:115], v[166:169]
v_mfma_f32_16x16x32_bf16 v[170:173], v[182:185], a[136:139], v[170:173]
s_waitcnt lgkmcnt(2)
ds_read_b128 v[182:185], v210 offset:12288
v_mfma_f32_16x16x32_bf16 v[138:141], a[20:23], v[186:189], v[138:141]
v_mfma_f32_16x16x32_bf16 v[142:145], a[44:47], v[186:189], v[142:145]
v_mfma_f32_16x16x32_bf16 v[146:149], a[68:71], v[186:189], v[146:149]
v_mfma_f32_16x16x32_bf16 v[150:153], a[236:239], v[186:189], v[150:153]
s_nop 4
v_cvt_pk_bf16_f32 v96, v138, v139
v_cvt_pk_bf16_f32 v97, v140, v141
v_mfma_f32_16x16x32_bf16 v[154:157], v[228:231], v[186:189], v[154:157]
s_waitcnt lgkmcnt(1)
v_cvt_pk_bf16_f32 v98, v142, v143
v_cvt_pk_bf16_f32 v99, v144, v145
v_mfma_f32_16x16x32_bf16 v[158:161], v[252:255], v[186:189], v[158:161]
s_barrier
ds_read_b128 v[174:177], v210 offset:55296
v_mfma_f32_16x16x32_bf16 v[162:165], v[186:189], a[92:95], v[162:165]
ds_read_b128 v[178:181], v210 offset:56320
buffer_load_dwordx4 v209, s[4:7], s40 offen nt lds
v_mfma_f32_16x16x32_bf16 v[166:169], v[186:189], a[116:119], v[166:169]
s_add_u32 s40, s36, 196224
v_cvt_pk_bf16_f32 v100, v146, v147
v_cvt_pk_bf16_f32 v101, v148, v149
v_mfma_f32_16x16x32_bf16 v[170:173], v[186:189], a[140:143], v[170:173]
s_add_u32 m0, s45, 4112
ds_read_b128 v[186:189], v210 offset:13312
v_cvt_pk_bf16_f32 v84, v150, v151
s_waitcnt lgkmcnt(3)
v_mfma_f32_16x16x32_bf16 v[138:141], a[0:3], v[182:185], 0
v_cvt_pk_bf16_f32 v85, v152, v153
v_cvt_pk_bf16_f32 v86, v154, v155
v_mfma_f32_16x16x32_bf16 v[142:145], a[24:27], v[182:185], 0
buffer_load_dwordx4 v209, s[4:7], s40 offen nt lds
v_mfma_f32_16x16x32_bf16 v[146:149], a[48:51], v[182:185], 0
s_add_u32 s40, s36, 392448
v_cvt_pk_bf16_f32 v87, v156, v157
v_cvt_pk_bf16_f32 v88, v158, v159
v_mfma_f32_16x16x32_bf16 v[150:153], a[216:219], v[182:185], 0
s_add_u32 m0, s45, 8224
v_cvt_pk_bf16_f32 v89, v160, v161
v_cvt_pk_bf16_f32 v116, v162, v163
v_mfma_f32_16x16x32_bf16 v[154:157], a[240:243], v[182:185], 0
v_cvt_pk_bf16_f32 v117, v164, v165
v_cvt_pk_bf16_f32 v124, v166, v167
v_mfma_f32_16x16x32_bf16 v[158:161], v[232:235], v[182:185], 0
s_waitcnt lgkmcnt(2)
buffer_load_dwordx4 v209, s[4:7], s40 offen nt lds
v_mfma_f32_16x16x32_bf16 v[162:165], v[182:185], a[72:75], 0
s_add_u32 s40, s36, 588672
v_cvt_pk_bf16_f32 v125, v168, v169
v_cvt_pk_bf16_f32 v132, v170, v171
v_mfma_f32_16x16x32_bf16 v[166:169], v[182:185], a[96:99], 0
s_add_u32 m0, s45, 12336
v_cvt_pk_bf16_f32 v133, v172, v173
v_add_f32 v174, v174, v175
v_mfma_f32_16x16x32_bf16 v[170:173], v[182:185], a[120:123], 0
s_waitcnt lgkmcnt(0)
buffer_load_dwordx4 v209, s[4:7], s40 offen nt lds
v_mfma_f32_16x16x32_bf16 v[138:141], a[4:7], v[186:189], v[138:141]
s_add_u32 s40, s36, 784896
v_add_f32 v178, v178, v179
v_add_f32 v176, v176, v177
v_mfma_f32_16x16x32_bf16 v[142:145], a[28:31], v[186:189], v[142:145]
s_add_u32 m0, s45, 16448
v_add_f32 v180, v180, v181
v_add_f32 v174, v174, v176
v_mfma_f32_16x16x32_bf16 v[146:149], a[52:55], v[186:189], v[146:149]
buffer_load_dwordx4 v209, s[4:7], s40 offen nt lds
v_mfma_f32_16x16x32_bf16 v[150:153], a[220:223], v[186:189], v[150:153]
s_add_u32 s40, s36, 981120
v_add_f32 v178, v178, v180
v_mul_f32 v175, s48, v174
v_mfma_f32_16x16x32_bf16 v[154:157], a[244:247], v[186:189], v[154:157]
s_add_u32 m0, s45, 20560
ds_read_b128 v[182:185], v210 offset:14336
buffer_load_dwordx4 v209, s[4:7], s40 offen nt lds
v_mfma_f32_16x16x32_bf16 v[158:161], v[236:239], v[186:189], v[158:161]
s_add_u32 s40, s36, 1177344
v_mul_f32 v178, s48, v178
v_fma_f32 v178, -v175, v175, v178
v_mfma_f32_16x16x32_bf16 v[162:165], v[186:189], a[76:79], v[162:165]
s_add_u32 m0, s45, 24672
v_max_f32 v178, 0, v178
v_add_f32 v178, s49, v178
v_mfma_f32_16x16x32_bf16 v[166:169], v[186:189], a[100:103], v[166:169]
s_waitcnt lgkmcnt(0)
buffer_load_dwordx4 v209, s[4:7], s40 offen nt lds
v_mfma_f32_16x16x32_bf16 v[170:173], v[186:189], a[124:127], v[170:173]
s_add_u32 s40, s36, 1373568
v_rsq_f32 v174, v178
s_add_u32 m0, s45, 28784
v_mul_f32_e64 v175, -v175, v174
ds_write_b64 v214, v[174:175]
v_mfma_f32_16x16x32_bf16 v[138:141], a[8:11], v[182:185], v[138:141]
ds_read_b64 v[118:119], v215
ds_read_b64 v[126:127], v215 offset:128
v_mfma_f32_16x16x32_bf16 v[142:145], a[32:35], v[182:185], v[142:145]
ds_read_b64 v[134:135], v215 offset:256
buffer_load_dwordx4 v209, s[4:7], s40 offen nt lds
v_mfma_f32_16x16x32_bf16 v[146:149], a[56:59], v[182:185], v[146:149]
s_add_u32 s40, s36, 1569792
ds_read_b128 v[186:189], v210 offset:15360
s_add_u32 m0, s45, 32896
v_mfma_f32_16x16x32_bf16 v[150:153], a[224:227], v[182:185], v[150:153]
buffer_load_dwordx4 v209, s[4:7], s40 offen nt lds
v_mfma_f32_16x16x32_bf16 v[154:157], a[248:251], v[182:185], v[154:157]
v_mov_b32 v181, 0
v_mfma_f32_16x16x32_bf16 v[158:161], v[240:243], v[182:185], v[158:161]
s_waitcnt lgkmcnt(3)
v_fma_f32 v108, v36, v118, v119
v_fma_f32 v109, v37, v118, v119
v_mfma_f32_16x16x32_bf16 v[162:165], v[182:185], a[80:83], v[162:165]
v_cvt_pk_bf16_f32 v90, v108, v109
v_fma_f32 v110, v38, v118, v119
v_mfma_f32_16x16x32_bf16 v[166:169], v[182:185], a[104:107], v[166:169]
v_fma_f32 v111, v39, v118, v119
v_cvt_pk_bf16_f32 v91, v110, v111
v_mfma_f32_16x16x32_bf16 v[170:173], v[182:185], a[128:131], v[170:173]
s_waitcnt lgkmcnt(0)
v_fma_f32 v112, v40, v118, v119
v_fma_f32 v113, v41, v118, v119
v_mfma_f32_16x16x32_bf16 v[138:141], a[12:15], v[186:189], v[138:141]
v_cvt_pk_bf16_f32 v92, v112, v113
v_fma_f32 v108, v42, v118, v119
v_mfma_f32_16x16x32_bf16 v[142:145], a[36:39], v[186:189], v[142:145]
v_fma_f32 v109, v43, v118, v119
v_cvt_pk_bf16_f32 v93, v108, v109
v_mfma_f32_16x16x32_bf16 v[146:149], a[60:63], v[186:189], v[146:149]
ds_write_b128 v211, v[90:93] offset:18432
v_mfma_f32_16x16x32_bf16 v[150:153], a[228:231], v[186:189], v[150:153]
ds_read_b128 v[182:185], v210 offset:16384
v_fma_f32 v110, v44, v118, v119
v_mfma_f32_16x16x32_bf16 v[154:157], a[252:255], v[186:189], v[154:157]
v_fma_f32 v111, v45, v118, v119
v_cvt_pk_bf16_f32 v94, v110, v111
v_mfma_f32_16x16x32_bf16 v[158:161], v[244:247], v[186:189], v[158:161]
v_fma_f32 v112, v46, v118, v119
v_fma_f32 v113, v47, v118, v119
v_mfma_f32_16x16x32_bf16 v[162:165], v[186:189], a[84:87], v[162:165]
v_cvt_pk_bf16_f32 v95, v112, v113
v_fma_f32 v108, v48, v126, v127
v_mfma_f32_16x16x32_bf16 v[166:169], v[186:189], a[108:111], v[166:169]
ds_write_b64 v212, v[94:95] offset:18432
v_mfma_f32_16x16x32_bf16 v[170:173], v[186:189], a[132:135], v[170:173]
v_fma_f32 v109, v49, v126, v127
v_cvt_pk_bf16_f32 v102, v108, v109
v_fma_f32 v110, v50, v126, v127
v_fma_f32 v111, v51, v126, v127
v_cvt_pk_bf16_f32 v103, v110, v111
v_fma_f32 v112, v52, v126, v127
v_fma_f32 v113, v53, v126, v127
v_cvt_pk_bf16_f32 v104, v112, v113
v_fma_f32 v108, v54, v126, v127
v_fma_f32 v109, v55, v126, v127
s_waitcnt lgkmcnt(1)
v_mfma_f32_16x16x32_bf16 v[138:141], a[16:19], v[182:185], v[138:141]
ds_read_b128 v[186:189], v210 offset:17408
v_cvt_pk_bf16_f32 v105, v108, v109
v_mfma_f32_16x16x32_bf16 v[142:145], a[40:43], v[182:185], v[142:145]
ds_write_b128 v211, v[102:105] offset:24576
v_mfma_f32_16x16x32_bf16 v[146:149], a[64:67], v[182:185], v[146:149]
v_fma_f32 v110, v56, v126, v127
v_fma_f32 v111, v57, v126, v127
v_mfma_f32_16x16x32_bf16 v[150:153], a[232:235], v[182:185], v[150:153]
v_cvt_pk_bf16_f32 v106, v110, v111
v_fma_f32 v112, v58, v126, v127
v_mfma_f32_16x16x32_bf16 v[154:157], v[224:227], v[182:185], v[154:157]
v_fma_f32 v113, v59, v126, v127
v_cvt_pk_bf16_f32 v107, v112, v113
v_mfma_f32_16x16x32_bf16 v[158:161], v[248:251], v[182:185], v[158:161]
ds_write_b64 v212, v[106:107] offset:24576
v_mfma_f32_16x16x32_bf16 v[162:165], v[182:185], a[88:91], v[162:165]
v_fma_f32 v108, v60, v134, v135
v_fma_f32 v109, v61, v134, v135
v_mfma_f32_16x16x32_bf16 v[166:169], v[182:185], a[112:115], v[166:169]
v_cvt_pk_bf16_f32 v90, v108, v109
v_fma_f32 v110, v62, v134, v135
v_mfma_f32_16x16x32_bf16 v[170:173], v[182:185], a[136:139], v[170:173]
s_waitcnt lgkmcnt(2)
v_fma_f32 v111, v63, v134, v135
v_cvt_pk_bf16_f32 v91, v110, v111
v_mfma_f32_16x16x32_bf16 v[138:141], a[20:23], v[186:189], v[138:141]
v_fma_f32 v112, v64, v134, v135
v_fma_f32 v113, v65, v134, v135
v_mfma_f32_16x16x32_bf16 v[142:145], a[44:47], v[186:189], v[142:145]
v_cvt_pk_bf16_f32 v92, v112, v113
v_fma_f32 v108, v66, v134, v135
v_mfma_f32_16x16x32_bf16 v[146:149], a[68:71], v[186:189], v[146:149]
v_fma_f32 v109, v67, v134, v135
v_cvt_pk_bf16_f32 v93, v108, v109
v_mfma_f32_16x16x32_bf16 v[150:153], a[236:239], v[186:189], v[150:153]
ds_write_b128 v211, v[90:93] offset:30720
v_mfma_f32_16x16x32_bf16 v[154:157], v[228:231], v[186:189], v[154:157]
v_fma_f32 v110, v68, v134, v135
v_fma_f32 v111, v69, v134, v135
v_mfma_f32_16x16x32_bf16 v[158:161], v[252:255], v[186:189], v[158:161]
v_cvt_pk_bf16_f32 v94, v110, v111
v_fma_f32 v112, v70, v134, v135
v_mfma_f32_16x16x32_bf16 v[162:165], v[186:189], a[92:95], v[162:165]
ds_read_b128 v[108:111], v216 offset:512
v_fma_f32 v113, v71, v134, v135
v_mfma_f32_16x16x32_bf16 v[166:169], v[186:189], a[116:119], v[166:169]
v_cvt_pk_bf16_f32 v95, v112, v113
v_cvt_pk_bf16_f32 v102, v138, v139
v_mfma_f32_16x16x32_bf16 v[170:173], v[186:189], a[140:143], v[170:173]
ds_read_b64 v[112:113], v216 offset:528
ds_write_b64 v212, v[94:95] offset:30720
v_cvt_pk_bf16_f32 v103, v140, v141
v_mfma_f32_16x16x32_bf16 v[138:141], v[78:81], v[72:75], 0
v_cvt_pk_bf16_f32 v104, v142, v143
v_cvt_pk_bf16_f32 v105, v144, v145
v_mfma_f32_16x16x32_bf16 v[142:145], v[96:99], v[72:75], 0
v_cvt_pk_bf16_f32 v106, v146, v147
v_cvt_pk_bf16_f32 v107, v148, v149
v_mfma_f32_16x16x32_bf16 v[146:149], v[102:105], v[72:75], 0
s_waitcnt lgkmcnt(2)
v_cvt_pk_bf16_f32 v90, v150, v151
v_cvt_pk_bf16_f32 v91, v152, v153
v_mfma_f32_16x16x32_bf16 v[150:153], v[108:111], v[72:75], v[206:209]
ds_read_b128 v[72:75], v216
v_cvt_pk_bf16_f32 v92, v154, v155
v_mfma_f32_16x16x16_bf16 v[138:141], v[82:83], v[76:77], v[138:141]
v_cvt_pk_bf16_f32 v93, v156, v157
v_cvt_pk_bf16_f32 v94, v158, v159
v_mfma_f32_16x16x16_bf16 v[142:145], v[100:101], v[76:77], v[142:145]
s_waitcnt lgkmcnt(2)
v_cvt_pk_bf16_f32 v95, v160, v161
v_cvt_pk_bf16_f32 v118, v162, v163
v_mfma_f32_16x16x16_bf16 v[150:153], v[112:113], v[76:77], v[150:153]
v_cvt_pk_bf16_f32 v119, v164, v165
v_cvt_pk_bf16_f32 v126, v166, v167
v_mfma_f32_16x16x16_bf16 v[146:149], v[106:107], v[76:77], v[146:149]
ds_read_b64 v[76:77], v216 offset:16
v_cvt_pk_bf16_f32 v127, v168, v169
v_mfma_f32_16x16x32_bf16 v[154:157], v[78:81], v[84:87], 0
v_cvt_pk_bf16_f32 v134, v170, v171
v_cvt_pk_bf16_f32 v135, v172, v173
v_mfma_f32_16x16x32_bf16 v[158:161], v[96:99], v[84:87], 0
v_exp_f32 v138, v138
v_mfma_f32_16x16x32_bf16 v[166:169], v[108:111], v[84:87], v[206:209]
v_exp_f32 v139, v139
v_mfma_f32_16x16x32_bf16 v[162:165], v[102:105], v[84:87], 0
v_exp_f32 v140, v140
v_mfma_f32_16x16x16_bf16 v[154:157], v[82:83], v[88:89], v[154:157]
v_exp_f32 v141, v141
v_mfma_f32_16x16x16_bf16 v[158:161], v[100:101], v[88:89], v[158:161]
v_exp_f32 v142, v142
v_mfma_f32_16x16x16_bf16 v[166:169], v[112:113], v[88:89], v[166:169]
v_exp_f32 v143, v143
v_mfma_f32_16x16x16_bf16 v[162:165], v[106:107], v[88:89], v[162:165]
v_exp_f32 v144, v144
v_exp_f32 v145, v145
v_exp_f32 v150, v150
v_exp_f32 v146, v146
v_exp_f32 v147, v147
v_exp_f32 v148, v148
v_exp_f32 v149, v149
v_cvt_pk_bf16_f32 v174, v138, v139
v_cvt_pk_bf16_f32 v175, v140, v141
v_cvt_pk_bf16_f32 v176, v142, v143
v_cvt_pk_bf16_f32 v177, v144, v145
v_cvt_pk_bf16_f32 v178, v146, v147
v_cvt_pk_bf16_f32 v179, v148, v149
v_mfma_f32_16x16x32_bf16 v[138:141], v[114:117], v[174:177], 0
v_cvt_pk_bf16_f32 v180, v150, 0
v_exp_f32 v154, v154
v_mfma_f32_16x16x32_bf16 v[150:153], v[190:193], v[174:177], 0
v_exp_f32 v155, v155
v_mfma_f32_16x16x32_bf16 v[142:145], v[122:125], v[174:177], 0
v_exp_f32 v156, v156
v_mfma_f32_16x16x32_bf16 v[146:149], v[130:133], v[174:177], 0
v_exp_f32 v157, v157
v_mfma_f32_16x16x32_bf16 v[150:153], v[190:193], v[178:181], v[150:153]
v_exp_f32 v158, v158
v_mfma_f32_16x16x32_bf16 v[138:141], v[118:121], v[178:181], v[138:141]
v_exp_f32 v159, v159
v_mfma_f32_16x16x32_bf16 v[142:145], v[126:129], v[178:181], v[142:145]
v_exp_f32 v160, v160
v_mfma_f32_16x16x32_bf16 v[146:149], v[134:137], v[178:181], v[146:149]
v_exp_f32 v161, v161
v_exp_f32 v166, v166
v_exp_f32 v162, v162
v_exp_f32 v163, v163
v_exp_f32 v164, v164
v_exp_f32 v165, v165
v_cvt_pk_bf16_f32 v174, v154, v155
v_cvt_pk_bf16_f32 v175, v156, v157
v_cvt_pk_bf16_f32 v176, v158, v159
v_cvt_pk_bf16_f32 v177, v160, v161
v_cvt_pk_bf16_f32 v178, v162, v163
v_cvt_pk_bf16_f32 v179, v164, v165
v_mfma_f32_16x16x32_bf16 v[154:157], v[114:117], v[174:177], 0
s_mov_b32 s39, s37
v_cvt_pk_bf16_f32 v180, v166, 0
v_rcp_f32 v151, v150
v_mfma_f32_16x16x32_bf16 v[166:169], v[190:193], v[174:177], 0
v_max3_u32 v219, v219, v150, v151
v_mul_f32 v138, v138, v151
v_mfma_f32_16x16x32_bf16 v[158:161], v[122:125], v[174:177], 0
v_mul_f32 v139, v139, v151
v_cvt_pk_bf16_f32 v138, v138, v139
v_mfma_f32_16x16x32_bf16 v[162:165], v[130:133], v[174:177], 0
v_mul_f32 v140, v140, v151
v_mul_f32 v141, v141, v151
v_mfma_f32_16x16x32_bf16 v[166:169], v[190:193], v[178:181], v[166:169]
v_cvt_pk_bf16_f32 v139, v140, v141
v_mul_f32 v142, v142, v151
v_mfma_f32_16x16x32_bf16 v[154:157], v[118:121], v[178:181], v[154:157]
v_mul_f32 v143, v143, v151
v_cvt_pk_bf16_f32 v140, v142, v143
v_mfma_f32_16x16x32_bf16 v[158:161], v[126:129], v[178:181], v[158:161]
v_mul_f32 v144, v144, v151
v_mul_f32 v145, v145, v151
v_mfma_f32_16x16x32_bf16 v[162:165], v[134:137], v[178:181], v[162:165]
v_cvt_pk_bf16_f32 v141, v144, v145
v_mul_f32 v146, v146, v151
v_mul_f32 v147, v147, v151
v_cvt_pk_bf16_f32 v142, v146, v147
v_mul_f32 v148, v148, v151
v_mul_f32 v149, v149, v151
v_mfma_f32_16x16x32_bf16 v[150:153], v[108:111], v[90:93], v[206:209]
ds_write_b128 v211, v[138:141] offset:36864
v_mfma_f32_16x16x32_bf16 v[138:141], v[78:81], v[90:93], 0
v_cvt_pk_bf16_f32 v143, v148, v149
v_rcp_f32 v167, v166
v_mfma_f32_16x16x32_bf16 v[146:149], v[102:105], v[90:93], 0
ds_write_b64 v212, v[142:143] offset:36864
v_mfma_f32_16x16x32_bf16 v[142:145], v[96:99], v[90:93], 0
v_max3_u32 v219, v219, v166, v167
v_mul_f32 v154, v154, v167
v_mfma_f32_16x16x16_bf16 v[138:141], v[82:83], v[94:95], v[138:141]
v_mul_f32 v155, v155, v167
v_cvt_pk_bf16_f32 v154, v154, v155
v_mfma_f32_16x16x16_bf16 v[150:153], v[112:113], v[94:95], v[150:153]
v_mul_f32 v156, v156, v167
v_mul_f32 v157, v157, v167
v_mfma_f32_16x16x16_bf16 v[142:145], v[100:101], v[94:95], v[142:145]
v_cvt_pk_bf16_f32 v155, v156, v157
v_mul_f32 v158, v158, v167
v_mfma_f32_16x16x16_bf16 v[146:149], v[106:107], v[94:95], v[146:149]
v_mul_f32 v159, v159, v167
v_cvt_pk_bf16_f32 v156, v158, v159
v_mul_f32 v160, v160, v167
v_mul_f32 v161, v161, v167
v_cvt_pk_bf16_f32 v157, v160, v161
v_mul_f32 v162, v162, v167
v_mul_f32 v163, v163, v167
v_cvt_pk_bf16_f32 v158, v162, v163
v_mul_f32 v164, v164, v167
v_mul_f32 v165, v165, v167
s_waitcnt lgkmcnt(3)
v_mfma_f32_16x16x32_bf16 v[166:169], v[108:111], v[72:75], v[206:209]
ds_write_b128 v211, v[154:157] offset:43008
v_mfma_f32_16x16x32_bf16 v[154:157], v[78:81], v[72:75], 0
v_cvt_pk_bf16_f32 v159, v164, v165
v_exp_f32 v138, v138
v_mfma_f32_16x16x32_bf16 v[162:165], v[102:105], v[72:75], 0
ds_write_b64 v212, v[158:159] offset:43008
v_mfma_f32_16x16x32_bf16 v[158:161], v[96:99], v[72:75], 0
s_waitcnt lgkmcnt(4)
v_exp_f32 v139, v139
v_mfma_f32_16x16x16_bf16 v[154:157], v[82:83], v[76:77], v[154:157]
v_exp_f32 v140, v140
v_mfma_f32_16x16x16_bf16 v[166:169], v[112:113], v[76:77], v[166:169]
v_exp_f32 v141, v141
v_mfma_f32_16x16x16_bf16 v[162:165], v[106:107], v[76:77], v[162:165]
v_exp_f32 v142, v142
v_mfma_f32_16x16x16_bf16 v[158:161], v[100:101], v[76:77], v[158:161]
s_waitcnt lgkmcnt(0)
v_exp_f32 v143, v143
v_exp_f32 v144, v144
v_exp_f32 v145, v145
v_exp_f32 v150, v150
v_exp_f32 v146, v146
v_exp_f32 v147, v147
s_barrier
ds_read_b128 v[170:173], v210 offset:36864
ds_read_b128 v[182:185], v210 offset:37888
ds_read_b128 v[186:189], v210 offset:38912
v_exp_f32 v148, v148
v_exp_f32 v149, v149
v_cvt_pk_bf16_f32 v174, v138, v139
v_cvt_pk_bf16_f32 v175, v140, v141
v_cvt_pk_bf16_f32 v176, v142, v143
v_cvt_pk_bf16_f32 v177, v144, v145
v_cvt_pk_bf16_f32 v178, v146, v147
v_cvt_pk_bf16_f32 v179, v148, v149
v_mfma_f32_16x16x32_bf16 v[138:141], v[114:117], v[174:177], 0
v_cvt_pk_bf16_f32 v180, v150, 0
v_exp_f32 v154, v154
v_mfma_f32_16x16x32_bf16 v[150:153], v[190:193], v[174:177], 0
v_exp_f32 v155, v155
v_mfma_f32_16x16x32_bf16 v[142:145], v[122:125], v[174:177], 0
s_waitcnt lgkmcnt(2)
v_exp_f32 v156, v156
v_mfma_f32_16x16x32_bf16 v[0:3], a[144:147], v[170:173], v[0:3]
v_exp_f32 v157, v157
v_mfma_f32_16x16x32_bf16 v[4:7], a[168:171], v[170:173], v[4:7]
v_exp_f32 v158, v158
v_mfma_f32_16x16x32_bf16 v[8:11], a[192:195], v[170:173], v[8:11]
s_waitcnt lgkmcnt(1)
ds_read_b128 v[170:173], v210 offset:39936
v_exp_f32 v159, v159
v_mfma_f32_16x16x32_bf16 v[0:3], a[148:151], v[182:185], v[0:3]
v_exp_f32 v160, v160
v_mfma_f32_16x16x32_bf16 v[4:7], a[172:175], v[182:185], v[4:7]
v_exp_f32 v161, v161
v_mfma_f32_16x16x32_bf16 v[8:11], a[196:199], v[182:185], v[8:11]
s_waitcnt lgkmcnt(1)
ds_read_b128 v[182:185], v210 offset:40960
v_exp_f32 v166, v166
v_mfma_f32_16x16x32_bf16 v[0:3], a[152:155], v[186:189], v[0:3]
v_exp_f32 v162, v162
v_mfma_f32_16x16x32_bf16 v[4:7], a[176:179], v[186:189], v[4:7]
v_exp_f32 v163, v163
v_mfma_f32_16x16x32_bf16 v[8:11], a[200:203], v[186:189], v[8:11]
s_waitcnt lgkmcnt(1)
ds_read_b128 v[186:189], v210 offset:41984
v_exp_f32 v164, v164
v_mfma_f32_16x16x32_bf16 v[0:3], a[156:159], v[170:173], v[0:3]
v_exp_f32 v165, v165
v_mfma_f32_16x16x32_bf16 v[4:7], a[180:183], v[170:173], v[4:7]
v_mfma_f32_16x16x32_bf16 v[8:11], a[204:207], v[170:173], v[8:11]
s_waitcnt lgkmcnt(1)
ds_read_b128 v[170:173], v210 offset:43008
v_mfma_f32_16x16x32_bf16 v[0:3], a[160:163], v[182:185], v[0:3]
v_mfma_f32_16x16x32_bf16 v[4:7], a[184:187], v[182:185], v[4:7]
v_mfma_f32_16x16x32_bf16 v[8:11], a[208:211], v[182:185], v[8:11]
ds_read_b128 v[182:185], v210 offset:44032
v_mfma_f32_16x16x32_bf16 v[146:149], v[130:133], v[174:177], 0
s_waitcnt lgkmcnt(2)
v_cvt_pk_bf16_f32 v174, v154, v155
v_cvt_pk_bf16_f32 v175, v156, v157
v_mfma_f32_16x16x32_bf16 v[0:3], a[164:167], v[186:189], v[0:3]
v_cvt_pk_bf16_f32 v176, v158, v159
v_cvt_pk_bf16_f32 v177, v160, v161
v_mfma_f32_16x16x32_bf16 v[150:153], v[190:193], v[178:181], v[150:153]
v_mfma_f32_16x16x32_bf16 v[138:141], v[118:121], v[178:181], v[138:141]
v_mfma_f32_16x16x32_bf16 v[4:7], a[188:191], v[186:189], v[4:7]
s_nop 2
v_cvt_pk_bf16_f32 v0, v0, v1
v_cvt_pk_bf16_f32 v1, v2, v3
v_mfma_f32_16x16x32_bf16 v[142:145], v[126:129], v[178:181], v[142:145]
buffer_store_dwordx2 v[0:1], v203, s[8:11], s38 offen
v_mfma_f32_16x16x32_bf16 v[8:11], a[212:215], v[186:189], v[8:11]
ds_read_b128 v[186:189], v210 offset:45056
v_rcp_f32 v151, v150
v_mfma_f32_16x16x32_bf16 v[146:149], v[134:137], v[178:181], v[146:149]
s_waitcnt lgkmcnt(2)
v_cvt_pk_bf16_f32 v4, v4, v5
v_cvt_pk_bf16_f32 v5, v6, v7
v_mfma_f32_16x16x32_bf16 v[12:15], a[144:147], v[170:173], v[12:15]
buffer_store_dwordx2 v[4:5], v203, s[8:11], s38 offen offset:32
v_mfma_f32_16x16x32_bf16 v[16:19], a[168:171], v[170:173], v[16:19]
v_cvt_pk_bf16_f32 v8, v8, v9
v_cvt_pk_bf16_f32 v9, v10, v11
v_mfma_f32_16x16x32_bf16 v[20:23], a[192:195], v[170:173], v[20:23]
s_waitcnt lgkmcnt(1)
ds_read_b128 v[170:173], v210 offset:46080
buffer_store_dwordx2 v[8:9], v203, s[8:11], s38 offen offset:64
v_mfma_f32_16x16x32_bf16 v[12:15], a[148:151], v[182:185], v[12:15]
v_cvt_pk_bf16_f32 v178, v162, v163
v_cvt_pk_bf16_f32 v179, v164, v165
v_mfma_f32_16x16x32_bf16 v[16:19], a[172:175], v[182:185], v[16:19]
v_cvt_pk_bf16_f32 v180, v166, 0
v_max3_u32 v219, v219, v150, v151
v_mfma_f32_16x16x32_bf16 v[20:23], a[196:199], v[182:185], v[20:23]
s_waitcnt lgkmcnt(1)
ds_read_b128 v[182:185], v210 offset:47104
v_mul_f32 v138, v138, v151
v_mfma_f32_16x16x32_bf16 v[12:15], a[152:155], v[186:189], v[12:15]
v_mul_f32 v139, v139, v151
v_cvt_pk_bf16_f32 v138, v138, v139
v_mfma_f32_16x16x32_bf16 v[16:19], a[176:179], v[186:189], v[16:19]
v_mul_f32 v140, v140, v151
v_mul_f32 v141, v141, v151
v_mfma_f32_16x16x32_bf16 v[20:23], a[200:203], v[186:189], v[20:23]
s_waitcnt lgkmcnt(1)
ds_read_b128 v[186:189], v210 offset:48128
v_cvt_pk_bf16_f32 v139, v140, v141
v_mfma_f32_16x16x32_bf16 v[12:15], a[156:159], v[170:173], v[12:15]
v_mul_f32 v142, v142, v151
v_mul_f32 v143, v143, v151
v_mfma_f32_16x16x32_bf16 v[16:19], a[180:183], v[170:173], v[16:19]
v_cvt_pk_bf16_f32 v140, v142, v143
v_mul_f32 v144, v144, v151
v_mfma_f32_16x16x32_bf16 v[20:23], a[204:207], v[170:173], v[20:23]
s_waitcnt lgkmcnt(1)
v_mul_f32 v145, v145, v151
v_cvt_pk_bf16_f32 v141, v144, v145
v_mfma_f32_16x16x32_bf16 v[12:15], a[160:163], v[182:185], v[12:15]
ds_write_b128 v211, v[138:141] offset:49152
v_mfma_f32_16x16x32_bf16 v[16:19], a[184:187], v[182:185], v[16:19]
v_mul_f32 v146, v146, v151
v_mul_f32 v147, v147, v151
v_mfma_f32_16x16x32_bf16 v[166:169], v[190:193], v[174:177], 0
v_cvt_pk_bf16_f32 v142, v146, v147
v_mul_f32 v148, v148, v151
v_mfma_f32_16x16x32_bf16 v[20:23], a[208:211], v[182:185], v[20:23]
v_mul_f32 v149, v149, v151
v_cvt_pk_bf16_f32 v143, v148, v149
v_mfma_f32_16x16x32_bf16 v[154:157], v[114:117], v[174:177], 0
ds_write_b64 v212, v[142:143] offset:49152
v_mfma_f32_16x16x32_bf16 v[158:161], v[122:125], v[174:177], 0
v_mfma_f32_16x16x32_bf16 v[162:165], v[130:133], v[174:177], 0
s_waitcnt lgkmcnt(2)
ds_read_b128 v[174:177], v218
v_mfma_f32_16x16x32_bf16 v[12:15], a[164:167], v[186:189], v[12:15]
v_mfma_f32_16x16x32_bf16 v[166:169], v[190:193], v[178:181], v[166:169]
v_mfma_f32_16x16x32_bf16 v[154:157], v[118:121], v[178:181], v[154:157]
v_mfma_f32_16x16x32_bf16 v[16:19], a[188:191], v[186:189], v[16:19]
s_nop 4
v_cvt_pk_bf16_f32 v12, v12, v13
v_cvt_pk_bf16_f32 v13, v14, v15
v_mfma_f32_16x16x32_bf16 v[158:161], v[126:129], v[178:181], v[158:161]
s_waitcnt lgkmcnt(1)
v_rcp_f32 v167, v166
v_mfma_f32_16x16x32_bf16 v[20:23], a[212:215], v[186:189], v[20:23]
s_barrier
ds_read_b128 v[170:173], v210 offset:49152
v_mfma_f32_16x16x32_bf16 v[162:165], v[134:137], v[178:181], v[162:165]
ds_read_b128 v[182:185], v210 offset:50176
buffer_store_dwordx2 v[12:13], v204, s[8:11], s38 offen
v_max3_u32 v219, v219, v166, v167
v_mul_f32 v154, v154, v167
v_mul_f32 v155, v155, v167
v_cvt_pk_bf16_f32 v154, v154, v155
v_mul_f32 v156, v156, v167
v_mul_f32 v157, v157, v167
v_cvt_pk_bf16_f32 v155, v156, v157
v_mul_f32 v158, v158, v167
v_mul_f32 v159, v159, v167
v_cvt_pk_bf16_f32 v156, v158, v159
v_mul_f32 v160, v160, v167
v_mul_f32 v161, v161, v167
v_cvt_pk_bf16_f32 v157, v160, v161
v_mul_f32 v162, v162, v167
v_mul_f32 v163, v163, v167
v_cvt_pk_bf16_f32 v158, v162, v163
v_mul_f32 v164, v164, v167
v_mul_f32 v165, v165, v167
v_cvt_pk_bf16_f32 v159, v164, v165
s_waitcnt lgkmcnt(1)
v_mfma_f32_16x16x32_bf16 v[24:27], a[144:147], v[170:173], v[24:27]
ds_write_b128 v216, v[154:157]
v_mfma_f32_16x16x32_bf16 v[28:31], a[168:171], v[170:173], v[28:31]
ds_write_b64 v216, v[158:159] offset:16
v_mfma_f32_16x16x32_bf16 v[32:35], a[192:195], v[170:173], v[32:35]
s_waitcnt lgkmcnt(2)
ds_read_b128 v[186:189], v210 offset:51200
ds_read_b128 v[170:173], v210 offset:52224
v_mfma_f32_16x16x32_bf16 v[24:27], a[148:151], v[182:185], v[24:27]
v_add_u32 v216, 1408, v216
v_cvt_pk_bf16_f32 v16, v16, v17
v_mfma_f32_16x16x32_bf16 v[28:31], a[172:175], v[182:185], v[28:31]
v_cvt_pk_bf16_f32 v17, v18, v19
v_cvt_pk_bf16_f32 v20, v20, v21
v_mfma_f32_16x16x32_bf16 v[32:35], a[196:199], v[182:185], v[32:35]
s_waitcnt vmcnt(4)
buffer_store_dwordx2 v[16:17], v204, s[8:11], s38 offen offset:32
ds_read_b128 v[182:185], v210 offset:53248
v_cvt_pk_bf16_f32 v21, v22, v23
s_barrier
buffer_store_dwordx2 v[20:21], v204, s[8:11], s38 offen offset:64
ds_read_b128 v[84:87], v200
ds_read_b128 v[92:95], v201
ds_read_b128 v[100:103], v202
ds_read_b128 v[178:181], v218 offset:528
ds_read_b128 v[88:91], v194 offset:16
ds_read_b128 v[96:99], v195 offset:16
ds_read_b128 v[104:107], v196 offset:16
s_waitcnt lgkmcnt(9)
v_mfma_f32_16x16x32_bf16 v[24:27], a[152:155], v[186:189], v[24:27]
v_mfma_f32_16x16x32_bf16 v[28:31], a[176:179], v[186:189], v[28:31]
v_mfma_f32_16x16x32_bf16 v[32:35], a[200:203], v[186:189], v[32:35]
s_waitcnt lgkmcnt(8)
ds_read_b128 v[186:189], v210 offset:54272
v_mfma_f32_16x16x32_bf16 v[24:27], a[156:159], v[170:173], v[24:27]
v_mfma_f32_16x16x32_bf16 v[28:31], a[180:183], v[170:173], v[28:31]
v_mfma_f32_16x16x32_bf16 v[32:35], a[204:207], v[170:173], v[32:35]
s_waitcnt lgkmcnt(8)
v_mfma_f32_16x16x32_bf16 v[24:27], a[160:163], v[182:185], v[24:27]
v_mfma_f32_16x16x32_bf16 v[28:31], a[184:187], v[182:185], v[28:31]
v_mfma_f32_16x16x32_bf16 v[32:35], a[208:211], v[182:185], v[32:35]
s_waitcnt lgkmcnt(7)
ds_read_b128 v[182:185], v210 offset:18432
v_mfma_f32_16x16x32_bf16 v[0:3], v[174:177], v[84:87], 0
s_waitcnt lgkmcnt(7)
ds_read_b128 v[84:87], v194
v_mfma_f32_16x16x32_bf16 v[12:15], v[174:177], v[92:95], 0
s_waitcnt lgkmcnt(2)
ds_read_b128 v[92:95], v195
v_mfma_f32_16x16x32_bf16 v[24:27], a[164:167], v[186:189], v[24:27]
v_mfma_f32_16x16x32_bf16 v[28:31], a[188:191], v[186:189], v[28:31]
v_mfma_f32_16x16x32_bf16 v[32:35], a[212:215], v[186:189], v[32:35]
s_waitcnt lgkmcnt(2)
ds_read_b128 v[186:189], v210 offset:19456
s_nop 3
v_cvt_pk_bf16_f32 v24, v24, v25
v_cvt_pk_bf16_f32 v25, v26, v27
v_mfma_f32_16x16x32_bf16 v[138:141], a[0:3], v[182:185], 0
buffer_store_dwordx2 v[24:25], v205, s[8:11], s38 offen
v_mfma_f32_16x16x32_bf16 v[142:145], a[24:27], v[182:185], 0
v_cvt_pk_bf16_f32 v28, v28, v29
v_cvt_pk_bf16_f32 v29, v30, v31
v_mfma_f32_16x16x32_bf16 v[146:149], a[48:51], v[182:185], 0
buffer_store_dwordx2 v[28:29], v205, s[8:11], s38 offen offset:32
v_mfma_f32_16x16x32_bf16 v[150:153], a[216:219], v[182:185], 0
v_cvt_pk_bf16_f32 v32, v32, v33
v_cvt_pk_bf16_f32 v33, v34, v35
v_mfma_f32_16x16x32_bf16 v[154:157], a[240:243], v[182:185], 0
buffer_store_dwordx2 v[32:33], v205, s[8:11], s38 offen offset:64
v_mfma_f32_16x16x32_bf16 v[158:161], v[232:235], v[182:185], 0
v_mfma_f32_16x16x32_bf16 v[162:165], v[182:185], a[72:75], 0
v_mfma_f32_16x16x32_bf16 v[166:169], v[182:185], a[96:99], 0
v_mfma_f32_16x16x32_bf16 v[170:173], v[182:185], a[120:123], 0
s_waitcnt lgkmcnt(0)
ds_read_b128 v[182:185], v210 offset:20480
v_mfma_f32_16x16x32_bf16 v[138:141], a[4:7], v[186:189], v[138:141]
v_mfma_f32_16x16x32_bf16 v[142:145], a[28:31], v[186:189], v[142:145]
v_mfma_f32_16x16x32_bf16 v[146:149], a[52:55], v[186:189], v[146:149]
v_mfma_f32_16x16x32_bf16 v[150:153], a[220:223], v[186:189], v[150:153]
v_mfma_f32_16x16x32_bf16 v[154:157], a[244:247], v[186:189], v[154:157]
v_mfma_f32_16x16x32_bf16 v[24:27], v[174:177], v[100:103], 0
ds_read_b128 v[100:103], v196
ds_read_b128 v[174:177], v218 offset:1056
v_mfma_f32_16x16x32_bf16 v[158:161], v[236:239], v[186:189], v[158:161]
v_mfma_f32_16x16x32_bf16 v[162:165], v[186:189], a[76:79], v[162:165]
v_mfma_f32_16x16x32_bf16 v[166:169], v[186:189], a[100:103], v[166:169]
v_mfma_f32_16x16x32_bf16 v[170:173], v[186:189], a[124:127], v[170:173]
ds_read_b128 v[186:189], v210 offset:21504
v_smfmac_f32_16x16x64_bf16 v[0:3], v[178:181], v[84:91], v207
s_waitcnt lgkmcnt(3)
ds_read_b128 v[84:87], v197
ds_read_b128 v[88:91], v197 offset:16
v_mfma_f32_16x16x32_bf16 v[138:141], a[8:11], v[182:185], v[138:141]
v_mfma_f32_16x16x32_bf16 v[142:145], a[32:35], v[182:185], v[142:145]
v_smfmac_f32_16x16x64_bf16 v[12:15], v[178:181], v[92:99], v207
ds_read_b128 v[92:95], v198
ds_read_b128 v[96:99], v198 offset:16
v_mfma_f32_16x16x32_bf16 v[146:149], a[56:59], v[182:185], v[146:149]
v_mfma_f32_16x16x32_bf16 v[150:153], a[224:227], v[182:185], v[150:153]
v_mfma_f32_16x16x32_bf16 v[154:157], a[248:251], v[182:185], v[154:157]
s_waitcnt lgkmcnt(6)
v_smfmac_f32_16x16x64_bf16 v[24:27], v[178:181], v[100:107], v207
ds_read_b128 v[100:103], v199
ds_read_b128 v[104:107], v199 offset:16
v_mfma_f32_16x16x32_bf16 v[158:161], v[240:243], v[182:185], v[158:161]
ds_read_b128 v[178:181], v218 offset:1584
v_mfma_f32_16x16x32_bf16 v[162:165], v[182:185], a[80:83], v[162:165]
v_mfma_f32_16x16x32_bf16 v[166:169], v[182:185], a[104:107], v[166:169]
v_mfma_f32_16x16x32_bf16 v[170:173], v[182:185], a[128:131], v[170:173]
s_waitcnt lgkmcnt(5)
ds_read_b128 v[182:185], v210 offset:22528
v_smfmac_f32_16x16x64_bf16 v[0:3], v[174:177], v[84:91], v207
ds_read_b128 v[84:87], v200 offset:32
ds_read_b128 v[88:91], v194 offset:48
v_mfma_f32_16x16x32_bf16 v[138:141], a[12:15], v[186:189], v[138:141]
v_mfma_f32_16x16x32_bf16 v[142:145], a[36:39], v[186:189], v[142:145]
s_waitcnt lgkmcnt(6)
v_smfmac_f32_16x16x64_bf16 v[12:15], v[174:177], v[92:99], v207
ds_read_b128 v[92:95], v201 offset:32
ds_read_b128 v[96:99], v195 offset:48
v_mfma_f32_16x16x32_bf16 v[146:149], a[60:63], v[186:189], v[146:149]
v_add_f32 v118, v0, v1
v_mul_f32 v119, v0, v0
v_mfma_f32_16x16x32_bf16 v[150:153], a[228:231], v[186:189], v[150:153]
v_add_f32 v118, v118, v2
v_fmac_f32 v119, v1, v1
v_mfma_f32_16x16x32_bf16 v[154:157], a[252:255], v[186:189], v[154:157]
s_waitcnt lgkmcnt(6)
v_add_f32 v118, v118, v3
v_fmac_f32 v119, v2, v2
v_smfmac_f32_16x16x64_bf16 v[24:27], v[174:177], v[100:107], v207
ds_read_b128 v[100:103], v202 offset:32
ds_read_b128 v[174:177], v218 offset:2112
v_mfma_f32_16x16x32_bf16 v[158:161], v[244:247], v[186:189], v[158:161]
ds_read_b128 v[104:107], v196 offset:48
v_fmac_f32 v119, v3, v3
v_mfma_f32_16x16x32_bf16 v[162:165], v[186:189], a[84:87], v[162:165]
v_add_f32 v126, v12, v13
v_mul_f32 v127, v12, v12
v_mfma_f32_16x16x32_bf16 v[166:169], v[186:189], a[108:111], v[166:169]
s_waitcnt lgkmcnt(6)
v_add_f32 v126, v126, v14
v_fmac_f32 v127, v13, v13
v_mfma_f32_16x16x32_bf16 v[4:7], v[178:181], v[84:87], 0
ds_read_b128 v[84:87], v194 offset:32
v_add_f32 v126, v126, v15
v_mfma_f32_16x16x32_bf16 v[170:173], v[186:189], a[132:135], v[170:173]
s_waitcnt lgkmcnt(5)
ds_read_b128 v[186:189], v210 offset:23552
v_fmac_f32 v127, v14, v14
v_mfma_f32_16x16x32_bf16 v[16:19], v[178:181], v[92:95], 0
ds_read_b128 v[92:95], v195 offset:32
v_fmac_f32 v127, v15, v15
v_mfma_f32_16x16x32_bf16 v[138:141], a[16:19], v[182:185], v[138:141]
s_waitcnt lgkmcnt(5)
v_add_f32 v134, v24, v25
v_mul_f32 v135, v24, v24
v_mfma_f32_16x16x32_bf16 v[28:31], v[178:181], v[100:103], 0
ds_read_b128 v[100:103], v196 offset:32
ds_read_b128 v[178:181], v218 offset:2640
v_mfma_f32_16x16x32_bf16 v[142:145], a[40:43], v[182:185], v[142:145]
v_add_f32 v134, v134, v26
v_fmac_f32 v135, v25, v25
v_mfma_f32_16x16x32_bf16 v[146:149], a[64:67], v[182:185], v[146:149]
v_add_f32 v134, v134, v27
v_fmac_f32 v135, v26, v26
v_mfma_f32_16x16x32_bf16 v[150:153], a[232:235], v[182:185], v[150:153]
v_fmac_f32 v135, v27, v27
v_mfma_f32_16x16x32_bf16 v[154:157], v[224:227], v[182:185], v[154:157]
s_waitcnt lgkmcnt(4)
v_smfmac_f32_16x16x64_bf16 v[4:7], v[174:177], v[84:91], v207
ds_read_b128 v[84:87], v197 offset:32
ds_read_b128 v[88:91], v197 offset:48
v_mfma_f32_16x16x32_bf16 v[158:161], v[248:251], v[182:185], v[158:161]
v_mfma_f32_16x16x32_bf16 v[162:165], v[182:185], a[88:91], v[162:165]
v_mfma_f32_16x16x32_bf16 v[166:169], v[182:185], a[112:115], v[166:169]
s_waitcnt lgkmcnt(4)
v_smfmac_f32_16x16x64_bf16 v[16:19], v[174:177], v[92:99], v207
ds_read_b128 v[92:95], v198 offset:32
ds_read_b128 v[96:99], v198 offset:48
v_mfma_f32_16x16x32_bf16 v[170:173], v[182:185], a[136:139], v[170:173]
ds_read_b128 v[182:185], v210 offset:24576
v_mfma_f32_16x16x32_bf16 v[138:141], a[20:23], v[186:189], v[138:141]
s_waitcnt lgkmcnt(6)
v_smfmac_f32_16x16x64_bf16 v[28:31], v[174:177], v[100:107], v207
ds_read_b128 v[100:103], v199 offset:32
ds_read_b128 v[104:107], v199 offset:48
v_mfma_f32_16x16x32_bf16 v[142:145], a[44:47], v[186:189], v[142:145]
ds_read_b128 v[174:177], v218 offset:3168
v_mfma_f32_16x16x32_bf16 v[146:149], a[68:71], v[186:189], v[146:149]
s_nop 0
v_cvt_pk_bf16_f32 v78, v138, v139
v_cvt_pk_bf16_f32 v79, v140, v141
v_mfma_f32_16x16x32_bf16 v[150:153], a[236:239], v[186:189], v[150:153]
v_mfma_f32_16x16x32_bf16 v[154:157], v[228:231], v[186:189], v[154:157]
s_waitcnt lgkmcnt(6)
v_cvt_pk_bf16_f32 v80, v142, v143
v_cvt_pk_bf16_f32 v81, v144, v145
v_smfmac_f32_16x16x64_bf16 v[4:7], v[178:181], v[84:91], v207
ds_read_b128 v[84:87], v200 offset:64
v_cvt_pk_bf16_f32 v82, v146, v147
v_mfma_f32_16x16x32_bf16 v[158:161], v[252:255], v[186:189], v[158:161]
v_cvt_pk_bf16_f32 v83, v148, v149
v_cvt_pk_bf16_f32 v72, v150, v151
v_mfma_f32_16x16x32_bf16 v[162:165], v[186:189], a[92:95], v[162:165]
v_cvt_pk_bf16_f32 v73, v152, v153
v_cvt_pk_bf16_f32 v74, v154, v155
v_mfma_f32_16x16x32_bf16 v[166:169], v[186:189], a[116:119], v[166:169]
s_waitcnt lgkmcnt(5)
v_cvt_pk_bf16_f32 v75, v156, v157
v_add_f32 v118, v118, v4
v_smfmac_f32_16x16x64_bf16 v[16:19], v[178:181], v[92:99], v207
ds_read_b128 v[92:95], v201 offset:64
v_cvt_pk_bf16_f32 v76, v158, v159
v_mfma_f32_16x16x32_bf16 v[170:173], v[186:189], a[140:143], v[170:173]
s_waitcnt lgkmcnt(5)
ds_read_b128 v[186:189], v210 offset:25600
v_cvt_pk_bf16_f32 v77, v160, v161
v_mfma_f32_16x16x32_bf16 v[138:141], a[0:3], v[182:185], 0
v_cvt_pk_bf16_f32 v114, v162, v163
v_cvt_pk_bf16_f32 v115, v164, v165
v_mfma_f32_16x16x32_bf16 v[142:145], a[24:27], v[182:185], 0
s_waitcnt lgkmcnt(4)
ds_read_b128 v[88:91], v194 offset:80
v_cvt_pk_bf16_f32 v122, v166, v167
v_smfmac_f32_16x16x64_bf16 v[28:31], v[178:181], v[100:107], v207
ds_read_b128 v[100:103], v202 offset:64
ds_read_b128 v[178:181], v218 offset:3696
v_mfma_f32_16x16x32_bf16 v[146:149], a[48:51], v[182:185], 0
v_cvt_pk_bf16_f32 v123, v168, v169
v_cvt_pk_bf16_f32 v130, v170, v171
v_mfma_f32_16x16x32_bf16 v[150:153], a[216:219], v[182:185], 0
v_cvt_pk_bf16_f32 v131, v172, v173
v_fmac_f32 v119, v4, v4
v_mfma_f32_16x16x32_bf16 v[154:157], a[240:243], v[182:185], 0
s_waitcnt lgkmcnt(5)
ds_read_b128 v[96:99], v195 offset:80
ds_read_b128 v[104:107], v196 offset:80
v_mfma_f32_16x16x32_bf16 v[8:11], v[174:177], v[84:87], 0
ds_read_b128 v[84:87], v194 offset:64
v_add_f32 v118, v118, v5
v_mfma_f32_16x16x32_bf16 v[158:161], v[232:235], v[182:185], 0
v_fmac_f32 v119, v5, v5
v_add_f32 v118, v118, v6
v_mfma_f32_16x16x32_bf16 v[162:165], v[182:185], a[72:75], 0
s_waitcnt lgkmcnt(7)
v_fmac_f32 v119, v6, v6
v_add_f32 v118, v118, v7
v_mfma_f32_16x16x32_bf16 v[20:23], v[174:177], v[92:95], 0
ds_read_b128 v[92:95], v195 offset:64
v_fmac_f32 v119, v7, v7
v_mfma_f32_16x16x32_bf16 v[166:169], v[182:185], a[96:99], 0
v_add_f32 v126, v126, v16
v_fmac_f32 v127, v16, v16
v_mfma_f32_16x16x32_bf16 v[170:173], v[182:185], a[120:123], 0
s_waitcnt lgkmcnt(5)
ds_read_b128 v[182:185], v210 offset:26624
v_add_f32 v126, v126, v17
v_mfma_f32_16x16x32_bf16 v[32:35], v[174:177], v[100:103], 0
ds_read_b128 v[100:103], v196 offset:64
ds_read_b128 v[174:177], v218 offset:4224
v_mfma_f32_16x16x32_bf16 v[138:141], a[4:7], v[186:189], v[138:141]
v_fmac_f32 v127, v17, v17
v_add_f32 v126, v126, v18
v_mfma_f32_16x16x32_bf16 v[142:145], a[28:31], v[186:189], v[142:145]
v_fmac_f32 v127, v18, v18
v_add_f32 v126, v126, v19
v_mfma_f32_16x16x32_bf16 v[146:149], a[52:55], v[186:189], v[146:149]
s_waitcnt lgkmcnt(4)
v_fmac_f32 v127, v19, v19
v_add_f32 v134, v134, v28
v_smfmac_f32_16x16x64_bf16 v[8:11], v[178:181], v[84:91], v207
ds_read_b128 v[84:87], v197 offset:64
ds_read_b128 v[88:91], v197 offset:80
v_mfma_f32_16x16x32_bf16 v[150:153], a[220:223], v[186:189], v[150:153]
v_fmac_f32 v135, v28, v28
v_add_f32 v134, v134, v29
v_mfma_f32_16x16x32_bf16 v[154:157], a[244:247], v[186:189], v[154:157]
v_fmac_f32 v135, v29, v29
v_add_f32 v134, v134, v30
v_mfma_f32_16x16x32_bf16 v[158:161], v[236:239], v[186:189], v[158:161]
s_waitcnt lgkmcnt(5)
v_fmac_f32 v135, v30, v30
v_add_f32 v134, v134, v31
v_smfmac_f32_16x16x64_bf16 v[20:23], v[178:181], v[92:99], v207
ds_read_b128 v[92:95], v198 offset:64
ds_read_b128 v[96:99], v198 offset:80
v_mfma_f32_16x16x32_bf16 v[162:165], v[186:189], a[76:79], v[162:165]
v_fmac_f32 v135, v31, v31
v_mfma_f32_16x16x32_bf16 v[166:169], v[186:189], a[100:103], v[166:169]
ds_read_u16 v120, v217
ds_read_u16 v128, v217 offset:32
v_mfma_f32_16x16x32_bf16 v[170:173], v[186:189], a[124:127], v[170:173]
ds_read_b128 v[186:189], v210 offset:27648
ds_read_u16 v136, v217 offset:64
s_waitcnt lgkmcnt(9)
v_smfmac_f32_16x16x64_bf16 v[32:35], v[178:181], v[100:107], v207
ds_read_b128 v[100:103], v199 offset:64
ds_read_b128 v[104:107], v199 offset:80
v_mfma_f32_16x16x32_bf16 v[138:141], a[8:11], v[182:185], v[138:141]
v_add_u32 v217, 1408, v217
v_mfma_f32_16x16x32_bf16 v[142:145], a[32:35], v[182:185], v[142:145]
v_mfma_f32_16x16x32_bf16 v[146:149], a[56:59], v[182:185], v[146:149]
s_waitcnt lgkmcnt(8)
v_smfmac_f32_16x16x64_bf16 v[8:11], v[174:177], v[84:91], v207
v_mfma_f32_16x16x32_bf16 v[150:153], a[224:227], v[182:185], v[150:153]
v_mfma_f32_16x16x32_bf16 v[154:157], a[248:251], v[182:185], v[154:157]
v_mfma_f32_16x16x32_bf16 v[158:161], v[240:243], v[182:185], v[158:161]
s_waitcnt lgkmcnt(6)
s_nop 3
v_add_f32 v118, v118, v8
v_fmac_f32 v119, v8, v8
v_smfmac_f32_16x16x64_bf16 v[20:23], v[174:177], v[92:99], v207
v_add_f32 v118, v118, v9
v_fmac_f32 v119, v9, v9
v_mfma_f32_16x16x32_bf16 v[162:165], v[182:185], a[80:83], v[162:165]
v_add_f32 v118, v118, v10
v_fmac_f32 v119, v10, v10
v_mfma_f32_16x16x32_bf16 v[166:169], v[182:185], a[104:107], v[166:169]
v_add_f32 v118, v118, v11
v_fmac_f32 v119, v11, v11
v_mfma_f32_16x16x32_bf16 v[170:173], v[182:185], a[128:131], v[170:173]
s_waitcnt lgkmcnt(0)
ds_read_b128 v[182:185], v210 offset:28672
v_add_f32 v126, v126, v20
v_smfmac_f32_16x16x64_bf16 v[32:35], v[174:177], v[100:107], v207
v_fmac_f32 v127, v20, v20
v_add_f32 v126, v126, v21
v_mfma_f32_16x16x32_bf16 v[138:141], a[12:15], v[186:189], v[138:141]
v_fmac_f32 v127, v21, v21
v_add_f32 v126, v126, v22
v_mfma_f32_16x16x32_bf16 v[142:145], a[36:39], v[186:189], v[142:145]
v_fmac_f32 v127, v22, v22
v_add_f32 v126, v126, v23
v_mfma_f32_16x16x32_bf16 v[146:149], a[60:63], v[186:189], v[146:149]
v_fmac_f32 v127, v23, v23
v_add_f32 v134, v134, v32
v_mfma_f32_16x16x32_bf16 v[150:153], a[228:231], v[186:189], v[150:153]
v_fmac_f32 v135, v32, v32
v_add_f32 v134, v134, v33
v_mfma_f32_16x16x32_bf16 v[154:157], a[252:255], v[186:189], v[154:157]
v_fmac_f32 v135, v33, v33
v_add_f32 v134, v134, v34
v_mfma_f32_16x16x32_bf16 v[158:161], v[244:247], v[186:189], v[158:161]
v_fmac_f32 v135, v34, v34
v_add_f32 v134, v134, v35
v_mfma_f32_16x16x32_bf16 v[162:165], v[186:189], a[84:87], v[162:165]
v_permlane16_swap_b32 v118, v119
v_mfma_f32_16x16x32_bf16 v[166:169], v[186:189], a[108:111], v[166:169]
v_fmac_f32 v135, v35, v35
v_add_f32 v118, v118, v119
v_mfma_f32_16x16x32_bf16 v[170:173], v[186:189], a[132:135], v[170:173]
s_waitcnt lgkmcnt(0)
ds_read_b128 v[186:189], v210 offset:29696
v_permlane16_swap_b32 v126, v127
v_mfma_f32_16x16x32_bf16 v[138:141], a[16:19], v[182:185], v[138:141]
v_add_f32 v126, v126, v127
v_permlane16_swap_b32 v134, v135
v_mfma_f32_16x16x32_bf16 v[142:145], a[40:43], v[182:185], v[142:145]
v_add_f32 v134, v134, v135
v_permlane32_swap_b32 v118, v126
v_mfma_f32_16x16x32_bf16 v[146:149], a[64:67], v[182:185], v[146:149]
v_add_f32 v118, v118, v126
v_mov_b32 v135, v134
v_mfma_f32_16x16x32_bf16 v[150:153], a[232:235], v[182:185], v[150:153]
ds_write_b32 v213, v118
v_mfma_f32_16x16x32_bf16 v[154:157], v[224:227], v[182:185], v[154:157]
v_permlane32_swap_b32 v134, v135
v_mfma_f32_16x16x32_bf16 v[158:161], v[248:251], v[182:185], v[158:161]
v_add_f32 v134, v134, v135
v_mfma_f32_16x16x32_bf16 v[162:165], v[182:185], a[88:91], v[162:165]
ds_write_b32 v213, v134 offset:512
v_mfma_f32_16x16x32_bf16 v[166:169], v[182:185], a[112:115], v[166:169]
v_mfma_f32_16x16x32_bf16 v[170:173], v[182:185], a[136:139], v[170:173]
s_waitcnt lgkmcnt(2)
ds_read_b128 v[182:185], v210 offset:30720
v_mfma_f32_16x16x32_bf16 v[138:141], a[20:23], v[186:189], v[138:141]
v_mfma_f32_16x16x32_bf16 v[142:145], a[44:47], v[186:189], v[142:145]
v_mfma_f32_16x16x32_bf16 v[146:149], a[68:71], v[186:189], v[146:149]
v_mfma_f32_16x16x32_bf16 v[150:153], a[236:239], v[186:189], v[150:153]
s_nop 4
v_cvt_pk_bf16_f32 v96, v138, v139
v_cvt_pk_bf16_f32 v97, v140, v141
v_mfma_f32_16x16x32_bf16 v[154:157], v[228:231], v[186:189], v[154:157]
s_waitcnt lgkmcnt(1)
v_cvt_pk_bf16_f32 v98, v142, v143
v_cvt_pk_bf16_f32 v99, v144, v145
v_mfma_f32_16x16x32_bf16 v[158:161], v[252:255], v[186:189], v[158:161]
s_barrier
ds_read_b128 v[174:177], v210 offset:55296
v_mfma_f32_16x16x32_bf16 v[162:165], v[186:189], a[92:95], v[162:165]
ds_read_b128 v[178:181], v210 offset:56320
v_mfma_f32_16x16x32_bf16 v[166:169], v[186:189], a[116:119], v[166:169]
v_cvt_pk_bf16_f32 v100, v146, v147
v_cvt_pk_bf16_f32 v101, v148, v149
v_mfma_f32_16x16x32_bf16 v[170:173], v[186:189], a[140:143], v[170:173]
s_waitcnt lgkmcnt(2)
ds_read_b128 v[186:189], v210 offset:31744
v_cvt_pk_bf16_f32 v84, v150, v151
v_mfma_f32_16x16x32_bf16 v[138:141], a[0:3], v[182:185], 0
v_cvt_pk_bf16_f32 v85, v152, v153
v_cvt_pk_bf16_f32 v86, v154, v155
v_mfma_f32_16x16x32_bf16 v[142:145], a[24:27], v[182:185], 0
v_mfma_f32_16x16x32_bf16 v[146:149], a[48:51], v[182:185], 0
v_cvt_pk_bf16_f32 v87, v156, v157
v_cvt_pk_bf16_f32 v88, v158, v159
v_mfma_f32_16x16x32_bf16 v[150:153], a[216:219], v[182:185], 0
v_cvt_pk_bf16_f32 v89, v160, v161
v_cvt_pk_bf16_f32 v116, v162, v163
v_mfma_f32_16x16x32_bf16 v[154:157], a[240:243], v[182:185], 0
v_cvt_pk_bf16_f32 v117, v164, v165
v_cvt_pk_bf16_f32 v124, v166, v167
v_mfma_f32_16x16x32_bf16 v[158:161], v[232:235], v[182:185], 0
v_mfma_f32_16x16x32_bf16 v[162:165], v[182:185], a[72:75], 0
v_cvt_pk_bf16_f32 v125, v168, v169
v_cvt_pk_bf16_f32 v132, v170, v171
v_mfma_f32_16x16x32_bf16 v[166:169], v[182:185], a[96:99], 0
s_waitcnt lgkmcnt(2)
v_cvt_pk_bf16_f32 v133, v172, v173
v_add_f32 v174, v174, v175
v_mfma_f32_16x16x32_bf16 v[170:173], v[182:185], a[120:123], 0
s_waitcnt lgkmcnt(0)
v_mfma_f32_16x16x32_bf16 v[138:141], a[4:7], v[186:189], v[138:141]
v_add_f32 v178, v178, v179
v_add_f32 v176, v176, v177
v_mfma_f32_16x16x32_bf16 v[142:145], a[28:31], v[186:189], v[142:145]
v_add_f32 v180, v180, v181
v_add_f32 v174, v174, v176
v_mfma_f32_16x16x32_bf16 v[146:149], a[52:55], v[186:189], v[146:149]
v_mfma_f32_16x16x32_bf16 v[150:153], a[220:223], v[186:189], v[150:153]
v_add_f32 v178, v178, v180
v_mul_f32 v175, s48, v174
v_mfma_f32_16x16x32_bf16 v[154:157], a[244:247], v[186:189], v[154:157]
ds_read_b128 v[182:185], v210 offset:32768
v_mfma_f32_16x16x32_bf16 v[158:161], v[236:239], v[186:189], v[158:161]
v_mul_f32 v178, s48, v178
v_fma_f32 v178, -v175, v175, v178
v_mfma_f32_16x16x32_bf16 v[162:165], v[186:189], a[76:79], v[162:165]
v_max_f32 v178, 0, v178
v_add_f32 v178, s49, v178
v_mfma_f32_16x16x32_bf16 v[166:169], v[186:189], a[100:103], v[166:169]
v_mfma_f32_16x16x32_bf16 v[170:173], v[186:189], a[124:127], v[170:173]
s_waitcnt lgkmcnt(0)
v_rsq_f32 v174, v178
s_nop 0
v_mul_f32_e64 v175, -v175, v174
ds_write_b64 v214, v[174:175]
v_mfma_f32_16x16x32_bf16 v[138:141], a[8:11], v[182:185], v[138:141]
ds_read_b64 v[118:119], v215
ds_read_b64 v[126:127], v215 offset:128
v_mfma_f32_16x16x32_bf16 v[142:145], a[32:35], v[182:185], v[142:145]
ds_read_b64 v[134:135], v215 offset:256
v_mfma_f32_16x16x32_bf16 v[146:149], a[56:59], v[182:185], v[146:149]
ds_read_b128 v[186:189], v210 offset:33792
v_mfma_f32_16x16x32_bf16 v[150:153], a[224:227], v[182:185], v[150:153]
v_mfma_f32_16x16x32_bf16 v[154:157], a[248:251], v[182:185], v[154:157]
v_mov_b32 v181, 0
v_mfma_f32_16x16x32_bf16 v[158:161], v[240:243], v[182:185], v[158:161]
s_waitcnt lgkmcnt(3)
v_fma_f32 v108, v0, v118, v119
v_fma_f32 v109, v1, v118, v119
v_mfma_f32_16x16x32_bf16 v[162:165], v[182:185], a[80:83], v[162:165]
v_cvt_pk_bf16_f32 v90, v108, v109
v_fma_f32 v110, v2, v118, v119
v_mfma_f32_16x16x32_bf16 v[166:169], v[182:185], a[104:107], v[166:169]
v_fma_f32 v111, v3, v118, v119
v_cvt_pk_bf16_f32 v91, v110, v111
v_mfma_f32_16x16x32_bf16 v[170:173], v[182:185], a[128:131], v[170:173]
s_waitcnt lgkmcnt(0)
v_fma_f32 v112, v4, v118, v119
v_fma_f32 v113, v5, v118, v119
v_mfma_f32_16x16x32_bf16 v[138:141], a[12:15], v[186:189], v[138:141]
v_cvt_pk_bf16_f32 v92, v112, v113
v_fma_f32 v108, v6, v118, v119
v_mfma_f32_16x16x32_bf16 v[142:145], a[36:39], v[186:189], v[142:145]
v_fma_f32 v109, v7, v118, v119
v_cvt_pk_bf16_f32 v93, v108, v109
v_mfma_f32_16x16x32_bf16 v[146:149], a[60:63], v[186:189], v[146:149]
ds_write_b128 v211, v[90:93]
v_mfma_f32_16x16x32_bf16 v[150:153], a[228:231], v[186:189], v[150:153]
ds_read_b128 v[182:185], v210 offset:34816
v_fma_f32 v110, v8, v118, v119
v_mfma_f32_16x16x32_bf16 v[154:157], a[252:255], v[186:189], v[154:157]
v_fma_f32 v111, v9, v118, v119
v_cvt_pk_bf16_f32 v94, v110, v111
v_mfma_f32_16x16x32_bf16 v[158:161], v[244:247], v[186:189], v[158:161]
v_fma_f32 v112, v10, v118, v119
v_fma_f32 v113, v11, v118, v119
v_mfma_f32_16x16x32_bf16 v[162:165], v[186:189], a[84:87], v[162:165]
v_cvt_pk_bf16_f32 v95, v112, v113
v_fma_f32 v108, v12, v126, v127
v_mfma_f32_16x16x32_bf16 v[166:169], v[186:189], a[108:111], v[166:169]
ds_write_b64 v212, v[94:95]
v_mfma_f32_16x16x32_bf16 v[170:173], v[186:189], a[132:135], v[170:173]
v_fma_f32 v109, v13, v126, v127
v_cvt_pk_bf16_f32 v102, v108, v109
v_fma_f32 v110, v14, v126, v127
v_fma_f32 v111, v15, v126, v127
v_cvt_pk_bf16_f32 v103, v110, v111
v_fma_f32 v112, v16, v126, v127
v_fma_f32 v113, v17, v126, v127
v_cvt_pk_bf16_f32 v104, v112, v113
v_fma_f32 v108, v18, v126, v127
v_fma_f32 v109, v19, v126, v127
s_waitcnt lgkmcnt(1)
v_mfma_f32_16x16x32_bf16 v[138:141], a[16:19], v[182:185], v[138:141]
ds_read_b128 v[186:189], v210 offset:35840
v_cvt_pk_bf16_f32 v105, v108, v109
v_mfma_f32_16x16x32_bf16 v[142:145], a[40:43], v[182:185], v[142:145]
ds_write_b128 v211, v[102:105] offset:6144
v_mfma_f32_16x16x32_bf16 v[146:149], a[64:67], v[182:185], v[146:149]
v_fma_f32 v110, v20, v126, v127
v_fma_f32 v111, v21, v126, v127
v_mfma_f32_16x16x32_bf16 v[150:153], a[232:235], v[182:185], v[150:153]
v_cvt_pk_bf16_f32 v106, v110, v111
v_fma_f32 v112, v22, v126, v127
v_mfma_f32_16x16x32_bf16 v[154:157], v[224:227], v[182:185], v[154:157]
v_fma_f32 v113, v23, v126, v127
v_cvt_pk_bf16_f32 v107, v112, v113
v_mfma_f32_16x16x32_bf16 v[158:161], v[248:251], v[182:185], v[158:161]
ds_write_b64 v212, v[106:107] offset:6144
v_mfma_f32_16x16x32_bf16 v[162:165], v[182:185], a[88:91], v[162:165]
v_fma_f32 v108, v24, v134, v135
v_fma_f32 v109, v25, v134, v135
v_mfma_f32_16x16x32_bf16 v[166:169], v[182:185], a[112:115], v[166:169]
v_cvt_pk_bf16_f32 v90, v108, v109
v_fma_f32 v110, v26, v134, v135
v_mfma_f32_16x16x32_bf16 v[170:173], v[182:185], a[136:139], v[170:173]
s_waitcnt lgkmcnt(2)
v_fma_f32 v111, v27, v134, v135
v_cvt_pk_bf16_f32 v91, v110, v111
v_mfma_f32_16x16x32_bf16 v[138:141], a[20:23], v[186:189], v[138:141]
v_fma_f32 v112, v28, v134, v135
v_fma_f32 v113, v29, v134, v135
v_mfma_f32_16x16x32_bf16 v[142:145], a[44:47], v[186:189], v[142:145]
v_cvt_pk_bf16_f32 v92, v112, v113
v_fma_f32 v108, v30, v134, v135
v_mfma_f32_16x16x32_bf16 v[146:149], a[68:71], v[186:189], v[146:149]
v_fma_f32 v109, v31, v134, v135
v_cvt_pk_bf16_f32 v93, v108, v109
v_mfma_f32_16x16x32_bf16 v[150:153], a[236:239], v[186:189], v[150:153]
ds_write_b128 v211, v[90:93] offset:12288
v_mfma_f32_16x16x32_bf16 v[154:157], v[228:231], v[186:189], v[154:157]
v_fma_f32 v110, v32, v134, v135
v_fma_f32 v111, v33, v134, v135
v_mfma_f32_16x16x32_bf16 v[158:161], v[252:255], v[186:189], v[158:161]
v_cvt_pk_bf16_f32 v94, v110, v111
v_fma_f32 v112, v34, v134, v135
v_mfma_f32_16x16x32_bf16 v[162:165], v[186:189], a[92:95], v[162:165]
ds_read_b128 v[108:111], v216 offset:512
v_fma_f32 v113, v35, v134, v135
v_mfma_f32_16x16x32_bf16 v[166:169], v[186:189], a[116:119], v[166:169]
v_cvt_pk_bf16_f32 v95, v112, v113
v_cvt_pk_bf16_f32 v102, v138, v139
v_mfma_f32_16x16x32_bf16 v[170:173], v[186:189], a[140:143], v[170:173]
ds_read_b64 v[112:113], v216 offset:528
ds_write_b64 v212, v[94:95] offset:12288
v_cvt_pk_bf16_f32 v103, v140, v141
v_mfma_f32_16x16x32_bf16 v[138:141], v[78:81], v[72:75], 0
v_cvt_pk_bf16_f32 v104, v142, v143
v_cvt_pk_bf16_f32 v105, v144, v145
v_mfma_f32_16x16x32_bf16 v[142:145], v[96:99], v[72:75], 0
v_cvt_pk_bf16_f32 v106, v146, v147
v_cvt_pk_bf16_f32 v107, v148, v149
v_mfma_f32_16x16x32_bf16 v[146:149], v[102:105], v[72:75], 0
s_waitcnt lgkmcnt(2)
v_cvt_pk_bf16_f32 v90, v150, v151
v_cvt_pk_bf16_f32 v91, v152, v153
v_mfma_f32_16x16x32_bf16 v[150:153], v[108:111], v[72:75], v[206:209]
ds_read_b128 v[72:75], v216
v_cvt_pk_bf16_f32 v92, v154, v155
v_mfma_f32_16x16x16_bf16 v[138:141], v[82:83], v[76:77], v[138:141]
v_cvt_pk_bf16_f32 v93, v156, v157
v_cvt_pk_bf16_f32 v94, v158, v159
v_mfma_f32_16x16x16_bf16 v[142:145], v[100:101], v[76:77], v[142:145]
s_waitcnt lgkmcnt(2)
v_cvt_pk_bf16_f32 v95, v160, v161
v_cvt_pk_bf16_f32 v118, v162, v163
v_mfma_f32_16x16x16_bf16 v[150:153], v[112:113], v[76:77], v[150:153]
v_cvt_pk_bf16_f32 v119, v164, v165
v_cvt_pk_bf16_f32 v126, v166, v167
v_mfma_f32_16x16x16_bf16 v[146:149], v[106:107], v[76:77], v[146:149]
ds_read_b64 v[76:77], v216 offset:16
v_cvt_pk_bf16_f32 v127, v168, v169
v_mfma_f32_16x16x32_bf16 v[154:157], v[78:81], v[84:87], 0
v_cvt_pk_bf16_f32 v134, v170, v171
v_cvt_pk_bf16_f32 v135, v172, v173
v_mfma_f32_16x16x32_bf16 v[158:161], v[96:99], v[84:87], 0
v_exp_f32 v138, v138
v_mfma_f32_16x16x32_bf16 v[166:169], v[108:111], v[84:87], v[206:209]
v_exp_f32 v139, v139
v_mfma_f32_16x16x32_bf16 v[162:165], v[102:105], v[84:87], 0
v_exp_f32 v140, v140
v_mfma_f32_16x16x16_bf16 v[154:157], v[82:83], v[88:89], v[154:157]
v_exp_f32 v141, v141
v_mfma_f32_16x16x16_bf16 v[158:161], v[100:101], v[88:89], v[158:161]
v_exp_f32 v142, v142
v_mfma_f32_16x16x16_bf16 v[166:169], v[112:113], v[88:89], v[166:169]
v_exp_f32 v143, v143
v_mfma_f32_16x16x16_bf16 v[162:165], v[106:107], v[88:89], v[162:165]
v_exp_f32 v144, v144
v_exp_f32 v145, v145
v_exp_f32 v150, v150
v_exp_f32 v146, v146
v_exp_f32 v147, v147
v_exp_f32 v148, v148
v_exp_f32 v149, v149
v_cvt_pk_bf16_f32 v174, v138, v139
v_cvt_pk_bf16_f32 v175, v140, v141
v_cvt_pk_bf16_f32 v176, v142, v143
v_cvt_pk_bf16_f32 v177, v144, v145
v_cvt_pk_bf16_f32 v178, v146, v147
v_cvt_pk_bf16_f32 v179, v148, v149
v_mfma_f32_16x16x32_bf16 v[138:141], v[114:117], v[174:177], 0
v_cvt_pk_bf16_f32 v180, v150, 0
v_exp_f32 v154, v154
v_mfma_f32_16x16x32_bf16 v[150:153], v[190:193], v[174:177], 0
v_exp_f32 v155, v155
v_mfma_f32_16x16x32_bf16 v[142:145], v[122:125], v[174:177], 0
v_exp_f32 v156, v156
v_mfma_f32_16x16x32_bf16 v[146:149], v[130:133], v[174:177], 0
v_exp_f32 v157, v157
v_mfma_f32_16x16x32_bf16 v[150:153], v[190:193], v[178:181], v[150:153]
v_exp_f32 v158, v158
v_mfma_f32_16x16x32_bf16 v[138:141], v[118:121], v[178:181], v[138:141]
v_exp_f32 v159, v159
v_mfma_f32_16x16x32_bf16 v[142:145], v[126:129], v[178:181], v[142:145]
v_exp_f32 v160, v160
v_mfma_f32_16x16x32_bf16 v[146:149], v[134:137], v[178:181], v[146:149]
v_exp_f32 v161, v161
v_exp_f32 v166, v166
v_exp_f32 v162, v162
v_exp_f32 v163, v163
v_exp_f32 v164, v164
v_exp_f32 v165, v165
v_cvt_pk_bf16_f32 v174, v154, v155
v_cvt_pk_bf16_f32 v175, v156, v157
v_cvt_pk_bf16_f32 v176, v158, v159
v_cvt_pk_bf16_f32 v177, v160, v161
v_cvt_pk_bf16_f32 v178, v162, v163
v_cvt_pk_bf16_f32 v179, v164, v165
v_mfma_f32_16x16x32_bf16 v[154:157], v[114:117], v[174:177], 0
s_mov_b32 s38, s36
v_cvt_pk_bf16_f32 v180, v166, 0
v_rcp_f32 v151, v150
v_mfma_f32_16x16x32_bf16 v[166:169], v[190:193], v[174:177], 0
v_max3_u32 v219, v219, v150, v151
v_mul_f32 v138, v138, v151
v_mfma_f32_16x16x32_bf16 v[158:161], v[122:125], v[174:177], 0
v_mul_f32 v139, v139, v151
v_cvt_pk_bf16_f32 v138, v138, v139
v_mfma_f32_16x16x32_bf16 v[162:165], v[130:133], v[174:177], 0
v_mul_f32 v140, v140, v151
v_mul_f32 v141, v141, v151
v_mfma_f32_16x16x32_bf16 v[166:169], v[190:193], v[178:181], v[166:169]
v_cvt_pk_bf16_f32 v139, v140, v141
v_mul_f32 v142, v142, v151
v_mfma_f32_16x16x32_bf16 v[154:157], v[118:121], v[178:181], v[154:157]
v_mul_f32 v143, v143, v151
v_cvt_pk_bf16_f32 v140, v142, v143
v_mfma_f32_16x16x32_bf16 v[158:161], v[126:129], v[178:181], v[158:161]
v_mul_f32 v144, v144, v151
v_mul_f32 v145, v145, v151
v_mfma_f32_16x16x32_bf16 v[162:165], v[134:137], v[178:181], v[162:165]
v_cvt_pk_bf16_f32 v141, v144, v145
v_mul_f32 v146, v146, v151
v_mul_f32 v147, v147, v151
v_cvt_pk_bf16_f32 v142, v146, v147
v_mul_f32 v148, v148, v151
v_mul_f32 v149, v149, v151
v_mfma_f32_16x16x32_bf16 v[150:153], v[108:111], v[90:93], v[206:209]
ds_write_b128 v211, v[138:141] offset:36864
v_mfma_f32_16x16x32_bf16 v[138:141], v[78:81], v[90:93], 0
v_cvt_pk_bf16_f32 v143, v148, v149
v_rcp_f32 v167, v166
v_mfma_f32_16x16x32_bf16 v[146:149], v[102:105], v[90:93], 0
ds_write_b64 v212, v[142:143] offset:36864
v_mfma_f32_16x16x32_bf16 v[142:145], v[96:99], v[90:93], 0
v_max3_u32 v219, v219, v166, v167
v_mul_f32 v154, v154, v167
v_mfma_f32_16x16x16_bf16 v[138:141], v[82:83], v[94:95], v[138:141]
v_mul_f32 v155, v155, v167
v_cvt_pk_bf16_f32 v154, v154, v155
v_mfma_f32_16x16x16_bf16 v[150:153], v[112:113], v[94:95], v[150:153]
v_mul_f32 v156, v156, v167
v_mul_f32 v157, v157, v167
v_mfma_f32_16x16x16_bf16 v[142:145], v[100:101], v[94:95], v[142:145]
v_cvt_pk_bf16_f32 v155, v156, v157
v_mul_f32 v158, v158, v167
v_mfma_f32_16x16x16_bf16 v[146:149], v[106:107], v[94:95], v[146:149]
v_mul_f32 v159, v159, v167
v_cvt_pk_bf16_f32 v156, v158, v159
v_mul_f32 v160, v160, v167
v_mul_f32 v161, v161, v167
v_cvt_pk_bf16_f32 v157, v160, v161
v_mul_f32 v162, v162, v167
v_mul_f32 v163, v163, v167
v_cvt_pk_bf16_f32 v158, v162, v163
v_mul_f32 v164, v164, v167
v_mul_f32 v165, v165, v167
s_waitcnt lgkmcnt(3)
v_mfma_f32_16x16x32_bf16 v[166:169], v[108:111], v[72:75], v[206:209]
ds_write_b128 v211, v[154:157] offset:43008
v_mfma_f32_16x16x32_bf16 v[154:157], v[78:81], v[72:75], 0
v_cvt_pk_bf16_f32 v159, v164, v165
v_exp_f32 v138, v138
v_mfma_f32_16x16x32_bf16 v[162:165], v[102:105], v[72:75], 0
ds_write_b64 v212, v[158:159] offset:43008
v_mfma_f32_16x16x32_bf16 v[158:161], v[96:99], v[72:75], 0
s_waitcnt lgkmcnt(4)
v_exp_f32 v139, v139
v_mfma_f32_16x16x16_bf16 v[154:157], v[82:83], v[76:77], v[154:157]
v_exp_f32 v140, v140
v_mfma_f32_16x16x16_bf16 v[166:169], v[112:113], v[76:77], v[166:169]
v_exp_f32 v141, v141
v_mfma_f32_16x16x16_bf16 v[162:165], v[106:107], v[76:77], v[162:165]
v_exp_f32 v142, v142
v_mfma_f32_16x16x16_bf16 v[158:161], v[100:101], v[76:77], v[158:161]
s_waitcnt lgkmcnt(0)
v_exp_f32 v143, v143
v_exp_f32 v144, v144
v_exp_f32 v145, v145
v_exp_f32 v150, v150
v_exp_f32 v146, v146
v_exp_f32 v147, v147
s_barrier
ds_read_b128 v[170:173], v210 offset:36864
ds_read_b128 v[182:185], v210 offset:37888
ds_read_b128 v[186:189], v210 offset:38912
v_exp_f32 v148, v148
v_exp_f32 v149, v149
v_cvt_pk_bf16_f32 v174, v138, v139
v_cvt_pk_bf16_f32 v175, v140, v141
v_cvt_pk_bf16_f32 v176, v142, v143
v_cvt_pk_bf16_f32 v177, v144, v145
v_cvt_pk_bf16_f32 v178, v146, v147
v_cvt_pk_bf16_f32 v179, v148, v149
v_mfma_f32_16x16x32_bf16 v[138:141], v[114:117], v[174:177], 0
v_cvt_pk_bf16_f32 v180, v150, 0
v_exp_f32 v154, v154
v_mfma_f32_16x16x32_bf16 v[150:153], v[190:193], v[174:177], 0
v_exp_f32 v155, v155
v_mfma_f32_16x16x32_bf16 v[142:145], v[122:125], v[174:177], 0
s_waitcnt lgkmcnt(2)
v_exp_f32 v156, v156
v_mfma_f32_16x16x32_bf16 v[36:39], a[144:147], v[170:173], v[36:39]
v_exp_f32 v157, v157
v_mfma_f32_16x16x32_bf16 v[40:43], a[168:171], v[170:173], v[40:43]
v_exp_f32 v158, v158
v_mfma_f32_16x16x32_bf16 v[44:47], a[192:195], v[170:173], v[44:47]
s_waitcnt lgkmcnt(1)
ds_read_b128 v[170:173], v210 offset:39936
v_exp_f32 v159, v159
v_mfma_f32_16x16x32_bf16 v[36:39], a[148:151], v[182:185], v[36:39]
v_exp_f32 v160, v160
v_mfma_f32_16x16x32_bf16 v[40:43], a[172:175], v[182:185], v[40:43]
v_exp_f32 v161, v161
v_mfma_f32_16x16x32_bf16 v[44:47], a[196:199], v[182:185], v[44:47]
s_waitcnt lgkmcnt(1)
ds_read_b128 v[182:185], v210 offset:40960
v_exp_f32 v166, v166
v_mfma_f32_16x16x32_bf16 v[36:39], a[152:155], v[186:189], v[36:39]
v_exp_f32 v162, v162
v_mfma_f32_16x16x32_bf16 v[40:43], a[176:179], v[186:189], v[40:43]
v_exp_f32 v163, v163
v_mfma_f32_16x16x32_bf16 v[44:47], a[200:203], v[186:189], v[44:47]
s_waitcnt lgkmcnt(1)
ds_read_b128 v[186:189], v210 offset:41984
v_exp_f32 v164, v164
v_mfma_f32_16x16x32_bf16 v[36:39], a[156:159], v[170:173], v[36:39]
v_exp_f32 v165, v165
v_mfma_f32_16x16x32_bf16 v[40:43], a[180:183], v[170:173], v[40:43]
v_mfma_f32_16x16x32_bf16 v[44:47], a[204:207], v[170:173], v[44:47]
s_waitcnt lgkmcnt(1)
ds_read_b128 v[170:173], v210 offset:43008
v_mfma_f32_16x16x32_bf16 v[36:39], a[160:163], v[182:185], v[36:39]
v_mfma_f32_16x16x32_bf16 v[40:43], a[184:187], v[182:185], v[40:43]
v_mfma_f32_16x16x32_bf16 v[44:47], a[208:211], v[182:185], v[44:47]
ds_read_b128 v[182:185], v210 offset:44032
v_mfma_f32_16x16x32_bf16 v[146:149], v[130:133], v[174:177], 0
s_waitcnt lgkmcnt(2)
v_cvt_pk_bf16_f32 v174, v154, v155
v_cvt_pk_bf16_f32 v175, v156, v157
v_mfma_f32_16x16x32_bf16 v[36:39], a[164:167], v[186:189], v[36:39]
v_cvt_pk_bf16_f32 v176, v158, v159
v_cvt_pk_bf16_f32 v177, v160, v161
v_mfma_f32_16x16x32_bf16 v[150:153], v[190:193], v[178:181], v[150:153]
v_mfma_f32_16x16x32_bf16 v[138:141], v[118:121], v[178:181], v[138:141]
v_mfma_f32_16x16x32_bf16 v[40:43], a[188:191], v[186:189], v[40:43]
s_nop 2
v_cvt_pk_bf16_f32 v36, v36, v37
v_cvt_pk_bf16_f32 v37, v38, v39
v_mfma_f32_16x16x32_bf16 v[142:145], v[126:129], v[178:181], v[142:145]
buffer_store_dwordx2 v[36:37], v203, s[8:11], s39 offen
v_mfma_f32_16x16x32_bf16 v[44:47], a[212:215], v[186:189], v[44:47]
ds_read_b128 v[186:189], v210 offset:45056
v_rcp_f32 v151, v150
v_mfma_f32_16x16x32_bf16 v[146:149], v[134:137], v[178:181], v[146:149]
s_waitcnt lgkmcnt(2)
v_cvt_pk_bf16_f32 v40, v40, v41
v_cvt_pk_bf16_f32 v41, v42, v43
v_mfma_f32_16x16x32_bf16 v[48:51], a[144:147], v[170:173], v[48:51]
buffer_store_dwordx2 v[40:41], v203, s[8:11], s39 offen offset:32
v_mfma_f32_16x16x32_bf16 v[52:55], a[168:171], v[170:173], v[52:55]
v_cvt_pk_bf16_f32 v44, v44, v45
v_cvt_pk_bf16_f32 v45, v46, v47
v_mfma_f32_16x16x32_bf16 v[56:59], a[192:195], v[170:173], v[56:59]
s_waitcnt lgkmcnt(1)
ds_read_b128 v[170:173], v210 offset:46080
buffer_store_dwordx2 v[44:45], v203, s[8:11], s39 offen offset:64
v_mfma_f32_16x16x32_bf16 v[48:51], a[148:151], v[182:185], v[48:51]
v_cvt_pk_bf16_f32 v178, v162, v163
v_cvt_pk_bf16_f32 v179, v164, v165
v_mfma_f32_16x16x32_bf16 v[52:55], a[172:175], v[182:185], v[52:55]
v_cvt_pk_bf16_f32 v180, v166, 0
v_max3_u32 v219, v219, v150, v151
v_mfma_f32_16x16x32_bf16 v[56:59], a[196:199], v[182:185], v[56:59]
s_waitcnt lgkmcnt(1)
ds_read_b128 v[182:185], v210 offset:47104
v_mul_f32 v138, v138, v151
v_mfma_f32_16x16x32_bf16 v[48:51], a[152:155], v[186:189], v[48:51]
v_mul_f32 v139, v139, v151
v_cvt_pk_bf16_f32 v138, v138, v139
v_mfma_f32_16x16x32_bf16 v[52:55], a[176:179], v[186:189], v[52:55]
v_mul_f32 v140, v140, v151
v_mul_f32 v141, v141, v151
v_mfma_f32_16x16x32_bf16 v[56:59], a[200:203], v[186:189], v[56:59]
s_waitcnt lgkmcnt(1)
ds_read_b128 v[186:189], v210 offset:48128
v_cvt_pk_bf16_f32 v139, v140, v141
v_mfma_f32_16x16x32_bf16 v[48:51], a[156:159], v[170:173], v[48:51]
v_mul_f32 v142, v142, v151
v_mul_f32 v143, v143, v151
v_mfma_f32_16x16x32_bf16 v[52:55], a[180:183], v[170:173], v[52:55]
v_cvt_pk_bf16_f32 v140, v142, v143
v_mul_f32 v144, v144, v151
v_mfma_f32_16x16x32_bf16 v[56:59], a[204:207], v[170:173], v[56:59]
s_waitcnt lgkmcnt(1)
v_mul_f32 v145, v145, v151
v_cvt_pk_bf16_f32 v141, v144, v145
v_mfma_f32_16x16x32_bf16 v[48:51], a[160:163], v[182:185], v[48:51]
ds_write_b128 v211, v[138:141] offset:49152
v_mfma_f32_16x16x32_bf16 v[52:55], a[184:187], v[182:185], v[52:55]
v_mul_f32 v146, v146, v151
v_mul_f32 v147, v147, v151
v_mfma_f32_16x16x32_bf16 v[166:169], v[190:193], v[174:177], 0
v_cvt_pk_bf16_f32 v142, v146, v147
v_mul_f32 v148, v148, v151
v_mfma_f32_16x16x32_bf16 v[56:59], a[208:211], v[182:185], v[56:59]
v_mul_f32 v149, v149, v151
v_cvt_pk_bf16_f32 v143, v148, v149
v_mfma_f32_16x16x32_bf16 v[154:157], v[114:117], v[174:177], 0
ds_write_b64 v212, v[142:143] offset:49152
v_mfma_f32_16x16x32_bf16 v[158:161], v[122:125], v[174:177], 0
v_mfma_f32_16x16x32_bf16 v[162:165], v[130:133], v[174:177], 0
s_waitcnt lgkmcnt(2)
v_mfma_f32_16x16x32_bf16 v[48:51], a[164:167], v[186:189], v[48:51]
v_mfma_f32_16x16x32_bf16 v[166:169], v[190:193], v[178:181], v[166:169]
v_mfma_f32_16x16x32_bf16 v[154:157], v[118:121], v[178:181], v[154:157]
v_mfma_f32_16x16x32_bf16 v[52:55], a[188:191], v[186:189], v[52:55]
s_nop 4
v_cvt_pk_bf16_f32 v48, v48, v49
v_cvt_pk_bf16_f32 v49, v50, v51
v_mfma_f32_16x16x32_bf16 v[158:161], v[126:129], v[178:181], v[158:161]
s_waitcnt lgkmcnt(0)
v_rcp_f32 v167, v166
v_mfma_f32_16x16x32_bf16 v[56:59], a[212:215], v[186:189], v[56:59]
s_barrier
ds_read_b128 v[170:173], v210 offset:49152
v_mfma_f32_16x16x32_bf16 v[162:165], v[134:137], v[178:181], v[162:165]
ds_read_b128 v[182:185], v210 offset:50176
buffer_store_dwordx2 v[48:49], v204, s[8:11], s39 offen
v_max3_u32 v219, v219, v166, v167
v_mul_f32 v154, v154, v167
v_mul_f32 v155, v155, v167
v_cvt_pk_bf16_f32 v154, v154, v155
v_mul_f32 v156, v156, v167
v_mul_f32 v157, v157, v167
v_cvt_pk_bf16_f32 v155, v156, v157
v_mul_f32 v158, v158, v167
v_mul_f32 v159, v159, v167
v_cvt_pk_bf16_f32 v156, v158, v159
v_mul_f32 v160, v160, v167
v_mul_f32 v161, v161, v167
v_cvt_pk_bf16_f32 v157, v160, v161
v_mul_f32 v162, v162, v167
v_mul_f32 v163, v163, v167
v_cvt_pk_bf16_f32 v158, v162, v163
v_mul_f32 v164, v164, v167
v_mul_f32 v165, v165, v167
v_cvt_pk_bf16_f32 v159, v164, v165
s_waitcnt lgkmcnt(1)
v_mfma_f32_16x16x32_bf16 v[60:63], a[144:147], v[170:173], v[60:63]
ds_write_b128 v216, v[154:157]
v_mfma_f32_16x16x32_bf16 v[64:67], a[168:171], v[170:173], v[64:67]
ds_write_b64 v216, v[158:159] offset:16
v_mfma_f32_16x16x32_bf16 v[68:71], a[192:195], v[170:173], v[68:71]
s_waitcnt lgkmcnt(2)
ds_read_b128 v[186:189], v210 offset:51200
ds_read_b128 v[170:173], v210 offset:52224
v_mfma_f32_16x16x32_bf16 v[60:63], a[148:151], v[182:185], v[60:63]
v_add_u32 v216, 1408, v216
v_cvt_pk_bf16_f32 v52, v52, v53
v_mfma_f32_16x16x32_bf16 v[64:67], a[172:175], v[182:185], v[64:67]
v_cvt_pk_bf16_f32 v53, v54, v55
v_cvt_pk_bf16_f32 v56, v56, v57
v_mfma_f32_16x16x32_bf16 v[68:71], a[196:199], v[182:185], v[68:71]
s_waitcnt lgkmcnt(1)
buffer_store_dwordx2 v[52:53], v204, s[8:11], s39 offen offset:32
ds_read_b128 v[182:185], v210 offset:53248
v_cvt_pk_bf16_f32 v57, v58, v59
buffer_store_dwordx2 v[56:57], v204, s[8:11], s39 offen offset:64
v_mfma_f32_16x16x32_bf16 v[60:63], a[152:155], v[186:189], v[60:63]
v_mfma_f32_16x16x32_bf16 v[64:67], a[176:179], v[186:189], v[64:67]
v_mfma_f32_16x16x32_bf16 v[68:71], a[200:203], v[186:189], v[68:71]
s_waitcnt lgkmcnt(1)
ds_read_b128 v[186:189], v210 offset:54272
v_mfma_f32_16x16x32_bf16 v[60:63], a[156:159], v[170:173], v[60:63]
v_mfma_f32_16x16x32_bf16 v[64:67], a[180:183], v[170:173], v[64:67]
v_mfma_f32_16x16x32_bf16 v[68:71], a[204:207], v[170:173], v[68:71]
s_waitcnt lgkmcnt(1)
v_mfma_f32_16x16x32_bf16 v[60:63], a[160:163], v[182:185], v[60:63]
v_mfma_f32_16x16x32_bf16 v[64:67], a[184:187], v[182:185], v[64:67]
v_mfma_f32_16x16x32_bf16 v[68:71], a[208:211], v[182:185], v[68:71]
s_waitcnt lgkmcnt(0)
ds_read_b128 v[182:185], v210
v_mfma_f32_16x16x32_bf16 v[60:63], a[164:167], v[186:189], v[60:63]
v_mfma_f32_16x16x32_bf16 v[64:67], a[188:191], v[186:189], v[64:67]
v_mfma_f32_16x16x32_bf16 v[68:71], a[212:215], v[186:189], v[68:71]
s_waitcnt lgkmcnt(0)
ds_read_b128 v[186:189], v210 offset:1024
s_nop 3
v_cvt_pk_bf16_f32 v60, v60, v61
v_cvt_pk_bf16_f32 v61, v62, v63
v_mfma_f32_16x16x32_bf16 v[138:141], a[0:3], v[182:185], 0
buffer_store_dwordx2 v[60:61], v205, s[8:11], s39 offen
v_mfma_f32_16x16x32_bf16 v[142:145], a[24:27], v[182:185], 0
v_cvt_pk_bf16_f32 v64, v64, v65
v_cvt_pk_bf16_f32 v65, v66, v67
v_mfma_f32_16x16x32_bf16 v[146:149], a[48:51], v[182:185], 0
buffer_store_dwordx2 v[64:65], v205, s[8:11], s39 offen offset:32
v_mfma_f32_16x16x32_bf16 v[150:153], a[216:219], v[182:185], 0
v_cvt_pk_bf16_f32 v68, v68, v69
v_cvt_pk_bf16_f32 v69, v70, v71
v_mfma_f32_16x16x32_bf16 v[154:157], a[240:243], v[182:185], 0
buffer_store_dwordx2 v[68:69], v205, s[8:11], s39 offen offset:64
v_mfma_f32_16x16x32_bf16 v[158:161], v[232:235], v[182:185], 0
v_mfma_f32_16x16x32_bf16 v[162:165], v[182:185], a[72:75], 0
v_mfma_f32_16x16x32_bf16 v[166:169], v[182:185], a[96:99], 0
v_mfma_f32_16x16x32_bf16 v[170:173], v[182:185], a[120:123], 0
s_waitcnt lgkmcnt(0)
ds_read_b128 v[182:185], v210 offset:2048
v_mfma_f32_16x16x32_bf16 v[138:141], a[4:7], v[186:189], v[138:141]
v_mfma_f32_16x16x32_bf16 v[142:145], a[28:31], v[186:189], v[142:145]
v_mfma_f32_16x16x32_bf16 v[146:149], a[52:55], v[186:189], v[146:149]
v_mfma_f32_16x16x32_bf16 v[150:153], a[220:223], v[186:189], v[150:153]
v_mfma_f32_16x16x32_bf16 v[154:157], a[244:247], v[186:189], v[154:157]
v_mfma_f32_16x16x32_bf16 v[158:161], v[236:239], v[186:189], v[158:161]
v_mfma_f32_16x16x32_bf16 v[162:165], v[186:189], a[76:79], v[162:165]
v_mfma_f32_16x16x32_bf16 v[166:169], v[186:189], a[100:103], v[166:169]
v_mfma_f32_16x16x32_bf16 v[170:173], v[186:189], a[124:127], v[170:173]
s_waitcnt lgkmcnt(0)
ds_read_b128 v[186:189], v210 offset:3072
v_mfma_f32_16x16x32_bf16 v[138:141], a[8:11], v[182:185], v[138:141]
v_mfma_f32_16x16x32_bf16 v[142:145], a[32:35], v[182:185], v[142:145]
v_mfma_f32_16x16x32_bf16 v[146:149], a[56:59], v[182:185], v[146:149]
v_mfma_f32_16x16x32_bf16 v[150:153], a[224:227], v[182:185], v[150:153]
v_mfma_f32_16x16x32_bf16 v[154:157], a[248:251], v[182:185], v[154:157]
v_mfma_f32_16x16x32_bf16 v[158:161], v[240:243], v[182:185], v[158:161]
v_mfma_f32_16x16x32_bf16 v[162:165], v[182:185], a[80:83], v[162:165]
v_mfma_f32_16x16x32_bf16 v[166:169], v[182:185], a[104:107], v[166:169]
v_mfma_f32_16x16x32_bf16 v[170:173], v[182:185], a[128:131], v[170:173]
s_waitcnt lgkmcnt(0)
ds_read_b128 v[182:185], v210 offset:4096
v_mfma_f32_16x16x32_bf16 v[138:141], a[12:15], v[186:189], v[138:141]
v_mfma_f32_16x16x32_bf16 v[142:145], a[36:39], v[186:189], v[142:145]
v_mfma_f32_16x16x32_bf16 v[146:149], a[60:63], v[186:189], v[146:149]
v_mfma_f32_16x16x32_bf16 v[150:153], a[228:231], v[186:189], v[150:153]
v_mfma_f32_16x16x32_bf16 v[154:157], a[252:255], v[186:189], v[154:157]
v_mfma_f32_16x16x32_bf16 v[158:161], v[244:247], v[186:189], v[158:161]
v_mfma_f32_16x16x32_bf16 v[162:165], v[186:189], a[84:87], v[162:165]
v_mfma_f32_16x16x32_bf16 v[166:169], v[186:189], a[108:111], v[166:169]
v_mfma_f32_16x16x32_bf16 v[170:173], v[186:189], a[132:135], v[170:173]
s_waitcnt lgkmcnt(0)
ds_read_b128 v[186:189], v210 offset:5120
v_mfma_f32_16x16x32_bf16 v[138:141], a[16:19], v[182:185], v[138:141]
v_mfma_f32_16x16x32_bf16 v[142:145], a[40:43], v[182:185], v[142:145]
v_mfma_f32_16x16x32_bf16 v[146:149], a[64:67], v[182:185], v[146:149]
v_mfma_f32_16x16x32_bf16 v[150:153], a[232:235], v[182:185], v[150:153]
v_mfma_f32_16x16x32_bf16 v[154:157], v[224:227], v[182:185], v[154:157]
v_mfma_f32_16x16x32_bf16 v[158:161], v[248:251], v[182:185], v[158:161]
v_mfma_f32_16x16x32_bf16 v[162:165], v[182:185], a[88:91], v[162:165]
v_mfma_f32_16x16x32_bf16 v[166:169], v[182:185], a[112:115], v[166:169]
v_mfma_f32_16x16x32_bf16 v[170:173], v[182:185], a[136:139], v[170:173]
s_waitcnt lgkmcnt(0)
ds_read_b128 v[182:185], v210 offset:6144
v_mfma_f32_16x16x32_bf16 v[138:141], a[20:23], v[186:189], v[138:141]
v_mfma_f32_16x16x32_bf16 v[142:145], a[44:47], v[186:189], v[142:145]
v_mfma_f32_16x16x32_bf16 v[146:149], a[68:71], v[186:189], v[146:149]
s_nop 5
v_cvt_pk_bf16_f32 v78, v138, v139
v_cvt_pk_bf16_f32 v79, v140, v141
v_mfma_f32_16x16x32_bf16 v[150:153], a[236:239], v[186:189], v[150:153]
v_mfma_f32_16x16x32_bf16 v[154:157], v[228:231], v[186:189], v[154:157]
v_cvt_pk_bf16_f32 v80, v142, v143
v_cvt_pk_bf16_f32 v81, v144, v145
v_cvt_pk_bf16_f32 v82, v146, v147
v_mfma_f32_16x16x32_bf16 v[158:161], v[252:255], v[186:189], v[158:161]
v_cvt_pk_bf16_f32 v83, v148, v149
s_nop 1
v_cvt_pk_bf16_f32 v72, v150, v151
v_mfma_f32_16x16x32_bf16 v[162:165], v[186:189], a[92:95], v[162:165]
v_cvt_pk_bf16_f32 v73, v152, v153
v_cvt_pk_bf16_f32 v74, v154, v155
v_mfma_f32_16x16x32_bf16 v[166:169], v[186:189], a[116:119], v[166:169]
v_cvt_pk_bf16_f32 v75, v156, v157
v_cvt_pk_bf16_f32 v76, v158, v159
v_mfma_f32_16x16x32_bf16 v[170:173], v[186:189], a[140:143], v[170:173]
s_waitcnt lgkmcnt(0)
ds_read_b128 v[186:189], v210 offset:7168
v_cvt_pk_bf16_f32 v77, v160, v161
v_mfma_f32_16x16x32_bf16 v[138:141], a[0:3], v[182:185], 0
v_cvt_pk_bf16_f32 v114, v162, v163
v_cvt_pk_bf16_f32 v115, v164, v165
v_mfma_f32_16x16x32_bf16 v[142:145], a[24:27], v[182:185], 0
v_cvt_pk_bf16_f32 v122, v166, v167
v_mfma_f32_16x16x32_bf16 v[146:149], a[48:51], v[182:185], 0
v_cvt_pk_bf16_f32 v123, v168, v169
v_cvt_pk_bf16_f32 v130, v170, v171
v_mfma_f32_16x16x32_bf16 v[150:153], a[216:219], v[182:185], 0
v_cvt_pk_bf16_f32 v131, v172, v173
v_mfma_f32_16x16x32_bf16 v[154:157], a[240:243], v[182:185], 0
v_mfma_f32_16x16x32_bf16 v[158:161], v[232:235], v[182:185], 0
v_mfma_f32_16x16x32_bf16 v[162:165], v[182:185], a[72:75], 0
v_mfma_f32_16x16x32_bf16 v[166:169], v[182:185], a[96:99], 0
v_mfma_f32_16x16x32_bf16 v[170:173], v[182:185], a[120:123], 0
s_waitcnt lgkmcnt(0)
ds_read_b128 v[182:185], v210 offset:8192
v_mfma_f32_16x16x32_bf16 v[138:141], a[4:7], v[186:189], v[138:141]
v_mfma_f32_16x16x32_bf16 v[142:145], a[28:31], v[186:189], v[142:145]
v_mfma_f32_16x16x32_bf16 v[146:149], a[52:55], v[186:189], v[146:149]
v_mfma_f32_16x16x32_bf16 v[150:153], a[220:223], v[186:189], v[150:153]
v_mfma_f32_16x16x32_bf16 v[154:157], a[244:247], v[186:189], v[154:157]
v_mfma_f32_16x16x32_bf16 v[158:161], v[236:239], v[186:189], v[158:161]
v_mfma_f32_16x16x32_bf16 v[162:165], v[186:189], a[76:79], v[162:165]
v_mfma_f32_16x16x32_bf16 v[166:169], v[186:189], a[100:103], v[166:169]
ds_read_u16 v120, v217
ds_read_u16 v128, v217 offset:32
v_mfma_f32_16x16x32_bf16 v[170:173], v[186:189], a[124:127], v[170:173]
ds_read_b128 v[186:189], v210 offset:9216
ds_read_u16 v136, v217 offset:64
s_waitcnt lgkmcnt(4)
v_mfma_f32_16x16x32_bf16 v[138:141], a[8:11], v[182:185], v[138:141]
v_add_u32 v217, 1408, v217
v_mfma_f32_16x16x32_bf16 v[142:145], a[32:35], v[182:185], v[142:145]
v_mfma_f32_16x16x32_bf16 v[146:149], a[56:59], v[182:185], v[146:149]
v_mfma_f32_16x16x32_bf16 v[150:153], a[224:227], v[182:185], v[150:153]
v_mfma_f32_16x16x32_bf16 v[154:157], a[248:251], v[182:185], v[154:157]
v_mfma_f32_16x16x32_bf16 v[158:161], v[240:243], v[182:185], v[158:161]
v_mfma_f32_16x16x32_bf16 v[162:165], v[182:185], a[80:83], v[162:165]
v_mfma_f32_16x16x32_bf16 v[166:169], v[182:185], a[104:107], v[166:169]
v_mfma_f32_16x16x32_bf16 v[170:173], v[182:185], a[128:131], v[170:173]
s_waitcnt lgkmcnt(1)
ds_read_b128 v[182:185], v210 offset:10240
v_mfma_f32_16x16x32_bf16 v[138:141], a[12:15], v[186:189], v[138:141]
v_mfma_f32_16x16x32_bf16 v[142:145], a[36:39], v[186:189], v[142:145]
v_mfma_f32_16x16x32_bf16 v[146:149], a[60:63], v[186:189], v[146:149]
v_mfma_f32_16x16x32_bf16 v[150:153], a[228:231], v[186:189], v[150:153]
v_mfma_f32_16x16x32_bf16 v[154:157], a[252:255], v[186:189], v[154:157]
v_mfma_f32_16x16x32_bf16 v[158:161], v[244:247], v[186:189], v[158:161]
v_mfma_f32_16x16x32_bf16 v[162:165], v[186:189], a[84:87], v[162:165]
v_mfma_f32_16x16x32_bf16 v[166:169], v[186:189], a[108:111], v[166:169]
v_mfma_f32_16x16x32_bf16 v[170:173], v[186:189], a[132:135], v[170:173]
s_waitcnt lgkmcnt(0)
ds_read_b128 v[186:189], v210 offset:11264
v_mfma_f32_16x16x32_bf16 v[138:141], a[16:19], v[182:185], v[138:141]
v_mfma_f32_16x16x32_bf16 v[142:145], a[40:43], v[182:185], v[142:145]
v_mfma_f32_16x16x32_bf16 v[146:149], a[64:67], v[182:185], v[146:149]
v_mfma_f32_16x16x32_bf16 v[150:153], a[232:235], v[182:185], v[150:153]
v_mfma_f32_16x16x32_bf16 v[154:157], v[224:227], v[182:185], v[154:157]
v_mfma_f32_16x16x32_bf16 v[158:161], v[248:251], v[182:185], v[158:161]
v_mfma_f32_16x16x32_bf16 v[162:165], v[182:185], a[88:91], v[162:165]
v_mfma_f32_16x16x32_bf16 v[166:169], v[182:185], a[112:115], v[166:169]
v_mfma_f32_16x16x32_bf16 v[170:173], v[182:185], a[136:139], v[170:173]
s_waitcnt lgkmcnt(0)
ds_read_b128 v[182:185], v210 offset:12288
v_mfma_f32_16x16x32_bf16 v[138:141], a[20:23], v[186:189], v[138:141]
v_mfma_f32_16x16x32_bf16 v[142:145], a[44:47], v[186:189], v[142:145]
v_mfma_f32_16x16x32_bf16 v[146:149], a[68:71], v[186:189], v[146:149]
v_mfma_f32_16x16x32_bf16 v[150:153], a[236:239], v[186:189], v[150:153]
s_nop 4
v_cvt_pk_bf16_f32 v96, v138, v139
v_cvt_pk_bf16_f32 v97, v140, v141
v_mfma_f32_16x16x32_bf16 v[154:157], v[228:231], v[186:189], v[154:157]
v_cvt_pk_bf16_f32 v98, v142, v143
v_cvt_pk_bf16_f32 v99, v144, v145
v_mfma_f32_16x16x32_bf16 v[158:161], v[252:255], v[186:189], v[158:161]
s_barrier
v_mfma_f32_16x16x32_bf16 v[162:165], v[186:189], a[92:95], v[162:165]
v_mfma_f32_16x16x32_bf16 v[166:169], v[186:189], a[116:119], v[166:169]
v_cvt_pk_bf16_f32 v100, v146, v147
v_cvt_pk_bf16_f32 v101, v148, v149
v_mfma_f32_16x16x32_bf16 v[170:173], v[186:189], a[140:143], v[170:173]
s_waitcnt lgkmcnt(0)
ds_read_b128 v[186:189], v210 offset:13312
v_cvt_pk_bf16_f32 v84, v150, v151
v_mfma_f32_16x16x32_bf16 v[138:141], a[0:3], v[182:185], 0
v_cvt_pk_bf16_f32 v85, v152, v153
v_cvt_pk_bf16_f32 v86, v154, v155
v_mfma_f32_16x16x32_bf16 v[142:145], a[24:27], v[182:185], 0
v_mfma_f32_16x16x32_bf16 v[146:149], a[48:51], v[182:185], 0
v_cvt_pk_bf16_f32 v87, v156, v157
v_cvt_pk_bf16_f32 v88, v158, v159
v_mfma_f32_16x16x32_bf16 v[150:153], a[216:219], v[182:185], 0
v_cvt_pk_bf16_f32 v89, v160, v161
v_cvt_pk_bf16_f32 v116, v162, v163
v_mfma_f32_16x16x32_bf16 v[154:157], a[240:243], v[182:185], 0
v_cvt_pk_bf16_f32 v117, v164, v165
v_cvt_pk_bf16_f32 v124, v166, v167
v_mfma_f32_16x16x32_bf16 v[158:161], v[232:235], v[182:185], 0
v_mfma_f32_16x16x32_bf16 v[162:165], v[182:185], a[72:75], 0
v_cvt_pk_bf16_f32 v125, v168, v169
v_cvt_pk_bf16_f32 v132, v170, v171
v_mfma_f32_16x16x32_bf16 v[166:169], v[182:185], a[96:99], 0
v_cvt_pk_bf16_f32 v133, v172, v173
v_mfma_f32_16x16x32_bf16 v[170:173], v[182:185], a[120:123], 0
s_waitcnt lgkmcnt(0)
v_mfma_f32_16x16x32_bf16 v[138:141], a[4:7], v[186:189], v[138:141]
v_mfma_f32_16x16x32_bf16 v[142:145], a[28:31], v[186:189], v[142:145]
v_mfma_f32_16x16x32_bf16 v[146:149], a[52:55], v[186:189], v[146:149]
v_mfma_f32_16x16x32_bf16 v[150:153], a[220:223], v[186:189], v[150:153]
v_mfma_f32_16x16x32_bf16 v[154:157], a[244:247], v[186:189], v[154:157]
ds_read_b128 v[182:185], v210 offset:14336
v_mfma_f32_16x16x32_bf16 v[158:161], v[236:239], v[186:189], v[158:161]
v_mfma_f32_16x16x32_bf16 v[162:165], v[186:189], a[76:79], v[162:165]
v_mfma_f32_16x16x32_bf16 v[166:169], v[186:189], a[100:103], v[166:169]
v_mfma_f32_16x16x32_bf16 v[170:173], v[186:189], a[124:127], v[170:173]
s_waitcnt lgkmcnt(0)
v_mfma_f32_16x16x32_bf16 v[138:141], a[8:11], v[182:185], v[138:141]
v_mfma_f32_16x16x32_bf16 v[142:145], a[32:35], v[182:185], v[142:145]
v_mfma_f32_16x16x32_bf16 v[146:149], a[56:59], v[182:185], v[146:149]
ds_read_b128 v[186:189], v210 offset:15360
v_mfma_f32_16x16x32_bf16 v[150:153], a[224:227], v[182:185], v[150:153]
v_mfma_f32_16x16x32_bf16 v[154:157], a[248:251], v[182:185], v[154:157]
v_mov_b32 v181, 0
v_mfma_f32_16x16x32_bf16 v[158:161], v[240:243], v[182:185], v[158:161]
v_mfma_f32_16x16x32_bf16 v[162:165], v[182:185], a[80:83], v[162:165]
v_mfma_f32_16x16x32_bf16 v[166:169], v[182:185], a[104:107], v[166:169]
v_mfma_f32_16x16x32_bf16 v[170:173], v[182:185], a[128:131], v[170:173]
s_waitcnt lgkmcnt(0)
v_mfma_f32_16x16x32_bf16 v[138:141], a[12:15], v[186:189], v[138:141]
v_mfma_f32_16x16x32_bf16 v[142:145], a[36:39], v[186:189], v[142:145]
v_mfma_f32_16x16x32_bf16 v[146:149], a[60:63], v[186:189], v[146:149]
v_mfma_f32_16x16x32_bf16 v[150:153], a[228:231], v[186:189], v[150:153]
ds_read_b128 v[182:185], v210 offset:16384
v_mfma_f32_16x16x32_bf16 v[154:157], a[252:255], v[186:189], v[154:157]
v_mfma_f32_16x16x32_bf16 v[158:161], v[244:247], v[186:189], v[158:161]
v_mfma_f32_16x16x32_bf16 v[162:165], v[186:189], a[84:87], v[162:165]
v_mfma_f32_16x16x32_bf16 v[166:169], v[186:189], a[108:111], v[166:169]
v_mfma_f32_16x16x32_bf16 v[170:173], v[186:189], a[132:135], v[170:173]
s_waitcnt lgkmcnt(0)
v_mfma_f32_16x16x32_bf16 v[138:141], a[16:19], v[182:185], v[138:141]
ds_read_b128 v[186:189], v210 offset:17408
v_mfma_f32_16x16x32_bf16 v[142:145], a[40:43], v[182:185], v[142:145]
v_mfma_f32_16x16x32_bf16 v[146:149], a[64:67], v[182:185], v[146:149]
v_mfma_f32_16x16x32_bf16 v[150:153], a[232:235], v[182:185], v[150:153]
v_mfma_f32_16x16x32_bf16 v[154:157], v[224:227], v[182:185], v[154:157]
v_mfma_f32_16x16x32_bf16 v[158:161], v[248:251], v[182:185], v[158:161]
v_mfma_f32_16x16x32_bf16 v[162:165], v[182:185], a[88:91], v[162:165]
v_mfma_f32_16x16x32_bf16 v[166:169], v[182:185], a[112:115], v[166:169]
v_mfma_f32_16x16x32_bf16 v[170:173], v[182:185], a[136:139], v[170:173]
s_waitcnt lgkmcnt(0)
v_mfma_f32_16x16x32_bf16 v[138:141], a[20:23], v[186:189], v[138:141]
v_mfma_f32_16x16x32_bf16 v[142:145], a[44:47], v[186:189], v[142:145]
v_mfma_f32_16x16x32_bf16 v[146:149], a[68:71], v[186:189], v[146:149]
v_mfma_f32_16x16x32_bf16 v[150:153], a[236:239], v[186:189], v[150:153]
v_mfma_f32_16x16x32_bf16 v[154:157], v[228:231], v[186:189], v[154:157]
v_mfma_f32_16x16x32_bf16 v[158:161], v[252:255], v[186:189], v[158:161]
v_mfma_f32_16x16x32_bf16 v[162:165], v[186:189], a[92:95], v[162:165]
ds_read_b128 v[108:111], v216 offset:512
v_mfma_f32_16x16x32_bf16 v[166:169], v[186:189], a[116:119], v[166:169]
v_cvt_pk_bf16_f32 v102, v138, v139
v_mfma_f32_16x16x32_bf16 v[170:173], v[186:189], a[140:143], v[170:173]
ds_read_b64 v[112:113], v216 offset:528
v_cvt_pk_bf16_f32 v103, v140, v141
v_mfma_f32_16x16x32_bf16 v[138:141], v[78:81], v[72:75], 0
v_cvt_pk_bf16_f32 v104, v142, v143
v_cvt_pk_bf16_f32 v105, v144, v145
v_mfma_f32_16x16x32_bf16 v[142:145], v[96:99], v[72:75], 0
v_cvt_pk_bf16_f32 v106, v146, v147
v_cvt_pk_bf16_f32 v107, v148, v149
v_mfma_f32_16x16x32_bf16 v[146:149], v[102:105], v[72:75], 0
s_waitcnt lgkmcnt(1)
v_cvt_pk_bf16_f32 v90, v150, v151
v_cvt_pk_bf16_f32 v91, v152, v153
v_mfma_f32_16x16x32_bf16 v[150:153], v[108:111], v[72:75], v[206:209]
ds_read_b128 v[72:75], v216
v_cvt_pk_bf16_f32 v92, v154, v155
v_mfma_f32_16x16x16_bf16 v[138:141], v[82:83], v[76:77], v[138:141]
v_cvt_pk_bf16_f32 v93, v156, v157
v_cvt_pk_bf16_f32 v94, v158, v159
v_mfma_f32_16x16x16_bf16 v[142:145], v[100:101], v[76:77], v[142:145]
s_waitcnt lgkmcnt(1)
v_cvt_pk_bf16_f32 v95, v160, v161
v_cvt_pk_bf16_f32 v118, v162, v163
v_mfma_f32_16x16x16_bf16 v[150:153], v[112:113], v[76:77], v[150:153]
v_cvt_pk_bf16_f32 v119, v164, v165
v_cvt_pk_bf16_f32 v126, v166, v167
v_mfma_f32_16x16x16_bf16 v[146:149], v[106:107], v[76:77], v[146:149]
ds_read_b64 v[76:77], v216 offset:16
v_cvt_pk_bf16_f32 v127, v168, v169
v_mfma_f32_16x16x32_bf16 v[154:157], v[78:81], v[84:87], 0
v_cvt_pk_bf16_f32 v134, v170, v171
v_cvt_pk_bf16_f32 v135, v172, v173
v_mfma_f32_16x16x32_bf16 v[158:161], v[96:99], v[84:87], 0
v_exp_f32 v138, v138
v_mfma_f32_16x16x32_bf16 v[166:169], v[108:111], v[84:87], v[206:209]
v_exp_f32 v139, v139
v_mfma_f32_16x16x32_bf16 v[162:165], v[102:105], v[84:87], 0
v_exp_f32 v140, v140
v_mfma_f32_16x16x16_bf16 v[154:157], v[82:83], v[88:89], v[154:157]
v_exp_f32 v141, v141
v_mfma_f32_16x16x16_bf16 v[158:161], v[100:101], v[88:89], v[158:161]
v_exp_f32 v142, v142
v_mfma_f32_16x16x16_bf16 v[166:169], v[112:113], v[88:89], v[166:169]
v_exp_f32 v143, v143
v_mfma_f32_16x16x16_bf16 v[162:165], v[106:107], v[88:89], v[162:165]
v_exp_f32 v144, v144
v_exp_f32 v145, v145
v_exp_f32 v150, v150
v_exp_f32 v146, v146
v_exp_f32 v147, v147
v_exp_f32 v148, v148
v_exp_f32 v149, v149
v_cvt_pk_bf16_f32 v174, v138, v139
v_cvt_pk_bf16_f32 v175, v140, v141
v_cvt_pk_bf16_f32 v176, v142, v143
v_cvt_pk_bf16_f32 v177, v144, v145
v_cvt_pk_bf16_f32 v178, v146, v147
v_cvt_pk_bf16_f32 v179, v148, v149
v_mfma_f32_16x16x32_bf16 v[138:141], v[114:117], v[174:177], 0
v_cvt_pk_bf16_f32 v180, v150, 0
v_exp_f32 v154, v154
v_mfma_f32_16x16x32_bf16 v[150:153], v[190:193], v[174:177], 0
v_exp_f32 v155, v155
v_mfma_f32_16x16x32_bf16 v[142:145], v[122:125], v[174:177], 0
v_exp_f32 v156, v156
v_mfma_f32_16x16x32_bf16 v[146:149], v[130:133], v[174:177], 0
v_exp_f32 v157, v157
v_mfma_f32_16x16x32_bf16 v[150:153], v[190:193], v[178:181], v[150:153]
v_exp_f32 v158, v158
v_mfma_f32_16x16x32_bf16 v[138:141], v[118:121], v[178:181], v[138:141]
v_exp_f32 v159, v159
v_mfma_f32_16x16x32_bf16 v[142:145], v[126:129], v[178:181], v[142:145]
v_exp_f32 v160, v160
v_mfma_f32_16x16x32_bf16 v[146:149], v[134:137], v[178:181], v[146:149]
v_exp_f32 v161, v161
v_exp_f32 v166, v166
v_exp_f32 v162, v162
v_exp_f32 v163, v163
v_exp_f32 v164, v164
v_exp_f32 v165, v165
v_cvt_pk_bf16_f32 v174, v154, v155
v_cvt_pk_bf16_f32 v175, v156, v157
v_cvt_pk_bf16_f32 v176, v158, v159
v_cvt_pk_bf16_f32 v177, v160, v161
v_cvt_pk_bf16_f32 v178, v162, v163
v_cvt_pk_bf16_f32 v179, v164, v165
v_mfma_f32_16x16x32_bf16 v[154:157], v[114:117], v[174:177], 0
v_cvt_pk_bf16_f32 v180, v166, 0
v_rcp_f32 v151, v150
v_mfma_f32_16x16x32_bf16 v[166:169], v[190:193], v[174:177], 0
v_max3_u32 v219, v219, v150, v151
v_mul_f32 v138, v138, v151
v_mfma_f32_16x16x32_bf16 v[158:161], v[122:125], v[174:177], 0
v_mul_f32 v139, v139, v151
v_cvt_pk_bf16_f32 v138, v138, v139
v_mfma_f32_16x16x32_bf16 v[162:165], v[130:133], v[174:177], 0
v_mul_f32 v140, v140, v151
v_mul_f32 v141, v141, v151
v_mfma_f32_16x16x32_bf16 v[166:169], v[190:193], v[178:181], v[166:169]
v_cvt_pk_bf16_f32 v139, v140, v141
v_mul_f32 v142, v142, v151
v_mfma_f32_16x16x32_bf16 v[154:157], v[118:121], v[178:181], v[154:157]
v_mul_f32 v143, v143, v151
v_cvt_pk_bf16_f32 v140, v142, v143
v_mfma_f32_16x16x32_bf16 v[158:161], v[126:129], v[178:181], v[158:161]
v_mul_f32 v144, v144, v151
v_mul_f32 v145, v145, v151
v_mfma_f32_16x16x32_bf16 v[162:165], v[134:137], v[178:181], v[162:165]
v_cvt_pk_bf16_f32 v141, v144, v145
v_mul_f32 v146, v146, v151
v_mul_f32 v147, v147, v151
v_cvt_pk_bf16_f32 v142, v146, v147
v_mul_f32 v148, v148, v151
v_mul_f32 v149, v149, v151
v_mfma_f32_16x16x32_bf16 v[150:153], v[108:111], v[90:93], v[206:209]
ds_write_b128 v211, v[138:141] offset:36864
v_mfma_f32_16x16x32_bf16 v[138:141], v[78:81], v[90:93], 0
v_cvt_pk_bf16_f32 v143, v148, v149
v_rcp_f32 v167, v166
v_mfma_f32_16x16x32_bf16 v[146:149], v[102:105], v[90:93], 0
ds_write_b64 v212, v[142:143] offset:36864
v_mfma_f32_16x16x32_bf16 v[142:145], v[96:99], v[90:93], 0
v_max3_u32 v219, v219, v166, v167
v_mul_f32 v154, v154, v167
v_mfma_f32_16x16x16_bf16 v[138:141], v[82:83], v[94:95], v[138:141]
v_mul_f32 v155, v155, v167
v_cvt_pk_bf16_f32 v154, v154, v155
v_mfma_f32_16x16x16_bf16 v[150:153], v[112:113], v[94:95], v[150:153]
v_mul_f32 v156, v156, v167
v_mul_f32 v157, v157, v167
v_mfma_f32_16x16x16_bf16 v[142:145], v[100:101], v[94:95], v[142:145]
v_cvt_pk_bf16_f32 v155, v156, v157
v_mul_f32 v158, v158, v167
v_mfma_f32_16x16x16_bf16 v[146:149], v[106:107], v[94:95], v[146:149]
v_mul_f32 v159, v159, v167
v_cvt_pk_bf16_f32 v156, v158, v159
v_mul_f32 v160, v160, v167
v_mul_f32 v161, v161, v167
v_cvt_pk_bf16_f32 v157, v160, v161
v_mul_f32 v162, v162, v167
v_mul_f32 v163, v163, v167
v_cvt_pk_bf16_f32 v158, v162, v163
v_mul_f32 v164, v164, v167
v_mul_f32 v165, v165, v167
s_waitcnt lgkmcnt(3)
v_mfma_f32_16x16x32_bf16 v[166:169], v[108:111], v[72:75], v[206:209]
ds_write_b128 v211, v[154:157] offset:43008
v_mfma_f32_16x16x32_bf16 v[154:157], v[78:81], v[72:75], 0
v_cvt_pk_bf16_f32 v159, v164, v165
v_exp_f32 v138, v138
v_mfma_f32_16x16x32_bf16 v[162:165], v[102:105], v[72:75], 0
ds_write_b64 v212, v[158:159] offset:43008
v_mfma_f32_16x16x32_bf16 v[158:161], v[96:99], v[72:75], 0
s_waitcnt lgkmcnt(4)
v_exp_f32 v139, v139
v_mfma_f32_16x16x16_bf16 v[154:157], v[82:83], v[76:77], v[154:157]
v_exp_f32 v140, v140
v_mfma_f32_16x16x16_bf16 v[166:169], v[112:113], v[76:77], v[166:169]
v_exp_f32 v141, v141
v_mfma_f32_16x16x16_bf16 v[162:165], v[106:107], v[76:77], v[162:165]
v_exp_f32 v142, v142
v_mfma_f32_16x16x16_bf16 v[158:161], v[100:101], v[76:77], v[158:161]
s_waitcnt lgkmcnt(0)
v_exp_f32 v143, v143
v_exp_f32 v144, v144
v_exp_f32 v145, v145
v_exp_f32 v150, v150
v_exp_f32 v146, v146
v_exp_f32 v147, v147
s_barrier
ds_read_b128 v[170:173], v210 offset:36864
ds_read_b128 v[182:185], v210 offset:37888
ds_read_b128 v[186:189], v210 offset:38912
v_exp_f32 v148, v148
v_exp_f32 v149, v149
v_cvt_pk_bf16_f32 v174, v138, v139
v_cvt_pk_bf16_f32 v175, v140, v141
v_cvt_pk_bf16_f32 v176, v142, v143
v_cvt_pk_bf16_f32 v177, v144, v145
v_cvt_pk_bf16_f32 v178, v146, v147
v_cvt_pk_bf16_f32 v179, v148, v149
v_mfma_f32_16x16x32_bf16 v[138:141], v[114:117], v[174:177], 0
v_cvt_pk_bf16_f32 v180, v150, 0
v_exp_f32 v154, v154
v_mfma_f32_16x16x32_bf16 v[150:153], v[190:193], v[174:177], 0
v_exp_f32 v155, v155
v_mfma_f32_16x16x32_bf16 v[142:145], v[122:125], v[174:177], 0
s_waitcnt lgkmcnt(2)
v_exp_f32 v156, v156
v_mfma_f32_16x16x32_bf16 v[0:3], a[144:147], v[170:173], v[0:3]
v_exp_f32 v157, v157
v_mfma_f32_16x16x32_bf16 v[4:7], a[168:171], v[170:173], v[4:7]
v_exp_f32 v158, v158
v_mfma_f32_16x16x32_bf16 v[8:11], a[192:195], v[170:173], v[8:11]
s_waitcnt lgkmcnt(1)
ds_read_b128 v[170:173], v210 offset:39936
v_exp_f32 v159, v159
v_mfma_f32_16x16x32_bf16 v[0:3], a[148:151], v[182:185], v[0:3]
v_exp_f32 v160, v160
v_mfma_f32_16x16x32_bf16 v[4:7], a[172:175], v[182:185], v[4:7]
v_exp_f32 v161, v161
v_mfma_f32_16x16x32_bf16 v[8:11], a[196:199], v[182:185], v[8:11]
s_waitcnt lgkmcnt(1)
ds_read_b128 v[182:185], v210 offset:40960
v_exp_f32 v166, v166
v_mfma_f32_16x16x32_bf16 v[0:3], a[152:155], v[186:189], v[0:3]
v_exp_f32 v162, v162
v_mfma_f32_16x16x32_bf16 v[4:7], a[176:179], v[186:189], v[4:7]
v_exp_f32 v163, v163
v_mfma_f32_16x16x32_bf16 v[8:11], a[200:203], v[186:189], v[8:11]
s_waitcnt lgkmcnt(1)
ds_read_b128 v[186:189], v210 offset:41984
v_exp_f32 v164, v164
v_mfma_f32_16x16x32_bf16 v[0:3], a[156:159], v[170:173], v[0:3]
v_exp_f32 v165, v165
v_mfma_f32_16x16x32_bf16 v[4:7], a[180:183], v[170:173], v[4:7]
v_mfma_f32_16x16x32_bf16 v[8:11], a[204:207], v[170:173], v[8:11]
s_waitcnt lgkmcnt(1)
ds_read_b128 v[170:173], v210 offset:43008
v_mfma_f32_16x16x32_bf16 v[0:3], a[160:163], v[182:185], v[0:3]
v_mfma_f32_16x16x32_bf16 v[4:7], a[184:187], v[182:185], v[4:7]
v_mfma_f32_16x16x32_bf16 v[8:11], a[208:211], v[182:185], v[8:11]
ds_read_b128 v[182:185], v210 offset:44032
v_mfma_f32_16x16x32_bf16 v[146:149], v[130:133], v[174:177], 0
s_waitcnt lgkmcnt(2)
v_cvt_pk_bf16_f32 v174, v154, v155
v_cvt_pk_bf16_f32 v175, v156, v157
v_mfma_f32_16x16x32_bf16 v[0:3], a[164:167], v[186:189], v[0:3]
v_cvt_pk_bf16_f32 v176, v158, v159
v_cvt_pk_bf16_f32 v177, v160, v161
v_mfma_f32_16x16x32_bf16 v[150:153], v[190:193], v[178:181], v[150:153]
v_mfma_f32_16x16x32_bf16 v[138:141], v[118:121], v[178:181], v[138:141]
v_mfma_f32_16x16x32_bf16 v[4:7], a[188:191], v[186:189], v[4:7]
s_nop 2
v_cvt_pk_bf16_f32 v0, v0, v1
v_cvt_pk_bf16_f32 v1, v2, v3
v_mfma_f32_16x16x32_bf16 v[142:145], v[126:129], v[178:181], v[142:145]
buffer_store_dwordx2 v[0:1], v203, s[8:11], s38 offen
v_mfma_f32_16x16x32_bf16 v[8:11], a[212:215], v[186:189], v[8:11]
ds_read_b128 v[186:189], v210 offset:45056
v_rcp_f32 v151, v150
v_mfma_f32_16x16x32_bf16 v[146:149], v[134:137], v[178:181], v[146:149]
s_waitcnt lgkmcnt(2)
v_cvt_pk_bf16_f32 v4, v4, v5
v_cvt_pk_bf16_f32 v5, v6, v7
v_mfma_f32_16x16x32_bf16 v[12:15], a[144:147], v[170:173], v[12:15]
buffer_store_dwordx2 v[4:5], v203, s[8:11], s38 offen offset:32
v_mfma_f32_16x16x32_bf16 v[16:19], a[168:171], v[170:173], v[16:19]
v_cvt_pk_bf16_f32 v8, v8, v9
v_cvt_pk_bf16_f32 v9, v10, v11
v_mfma_f32_16x16x32_bf16 v[20:23], a[192:195], v[170:173], v[20:23]
s_waitcnt lgkmcnt(1)
ds_read_b128 v[170:173], v210 offset:46080
buffer_store_dwordx2 v[8:9], v203, s[8:11], s38 offen offset:64
v_mfma_f32_16x16x32_bf16 v[12:15], a[148:151], v[182:185], v[12:15]
v_cvt_pk_bf16_f32 v178, v162, v163
v_cvt_pk_bf16_f32 v179, v164, v165
v_mfma_f32_16x16x32_bf16 v[16:19], a[172:175], v[182:185], v[16:19]
v_cvt_pk_bf16_f32 v180, v166, 0
v_max3_u32 v219, v219, v150, v151
v_mfma_f32_16x16x32_bf16 v[20:23], a[196:199], v[182:185], v[20:23]
s_waitcnt lgkmcnt(1)
ds_read_b128 v[182:185], v210 offset:47104
v_mul_f32 v138, v138, v151
v_mfma_f32_16x16x32_bf16 v[12:15], a[152:155], v[186:189], v[12:15]
v_mul_f32 v139, v139, v151
v_cvt_pk_bf16_f32 v138, v138, v139
v_mfma_f32_16x16x32_bf16 v[16:19], a[176:179], v[186:189], v[16:19]
v_mul_f32 v140, v140, v151
v_mul_f32 v141, v141, v151
v_mfma_f32_16x16x32_bf16 v[20:23], a[200:203], v[186:189], v[20:23]
s_waitcnt lgkmcnt(1)
ds_read_b128 v[186:189], v210 offset:48128
v_cvt_pk_bf16_f32 v139, v140, v141
v_mfma_f32_16x16x32_bf16 v[12:15], a[156:159], v[170:173], v[12:15]
v_mul_f32 v142, v142, v151
v_mul_f32 v143, v143, v151
v_mfma_f32_16x16x32_bf16 v[16:19], a[180:183], v[170:173], v[16:19]
v_cvt_pk_bf16_f32 v140, v142, v143
v_mul_f32 v144, v144, v151
v_mfma_f32_16x16x32_bf16 v[20:23], a[204:207], v[170:173], v[20:23]
s_waitcnt lgkmcnt(1)
v_mul_f32 v145, v145, v151
v_cvt_pk_bf16_f32 v141, v144, v145
v_mfma_f32_16x16x32_bf16 v[12:15], a[160:163], v[182:185], v[12:15]
ds_write_b128 v211, v[138:141] offset:49152
v_mfma_f32_16x16x32_bf16 v[16:19], a[184:187], v[182:185], v[16:19]
v_mul_f32 v146, v146, v151
v_mul_f32 v147, v147, v151
v_mfma_f32_16x16x32_bf16 v[166:169], v[190:193], v[174:177], 0
v_cvt_pk_bf16_f32 v142, v146, v147
v_mul_f32 v148, v148, v151
v_mfma_f32_16x16x32_bf16 v[20:23], a[208:211], v[182:185], v[20:23]
v_mul_f32 v149, v149, v151
v_cvt_pk_bf16_f32 v143, v148, v149
v_mfma_f32_16x16x32_bf16 v[154:157], v[114:117], v[174:177], 0
ds_write_b64 v212, v[142:143] offset:49152
v_mfma_f32_16x16x32_bf16 v[158:161], v[122:125], v[174:177], 0
v_mfma_f32_16x16x32_bf16 v[162:165], v[130:133], v[174:177], 0
s_waitcnt lgkmcnt(2)
v_mfma_f32_16x16x32_bf16 v[12:15], a[164:167], v[186:189], v[12:15]
v_mfma_f32_16x16x32_bf16 v[166:169], v[190:193], v[178:181], v[166:169]
v_mfma_f32_16x16x32_bf16 v[154:157], v[118:121], v[178:181], v[154:157]
v_mfma_f32_16x16x32_bf16 v[16:19], a[188:191], v[186:189], v[16:19]
s_nop 4
v_cvt_pk_bf16_f32 v12, v12, v13
v_cvt_pk_bf16_f32 v13, v14, v15
v_mfma_f32_16x16x32_bf16 v[158:161], v[126:129], v[178:181], v[158:161]
s_waitcnt lgkmcnt(0)
v_rcp_f32 v167, v166
v_mfma_f32_16x16x32_bf16 v[20:23], a[212:215], v[186:189], v[20:23]
s_barrier
ds_read_b128 v[170:173], v210 offset:49152
v_mfma_f32_16x16x32_bf16 v[162:165], v[134:137], v[178:181], v[162:165]
ds_read_b128 v[182:185], v210 offset:50176
buffer_store_dwordx2 v[12:13], v204, s[8:11], s38 offen
v_max3_u32 v219, v219, v166, v167
v_mul_f32 v154, v154, v167
v_mul_f32 v155, v155, v167
v_cvt_pk_bf16_f32 v154, v154, v155
v_mul_f32 v156, v156, v167
v_mul_f32 v157, v157, v167
v_cvt_pk_bf16_f32 v155, v156, v157
v_mul_f32 v158, v158, v167
v_mul_f32 v159, v159, v167
v_cvt_pk_bf16_f32 v156, v158, v159
v_mul_f32 v160, v160, v167
v_mul_f32 v161, v161, v167
v_cvt_pk_bf16_f32 v157, v160, v161
v_mul_f32 v162, v162, v167
v_mul_f32 v163, v163, v167
v_cvt_pk_bf16_f32 v158, v162, v163
v_mul_f32 v164, v164, v167
v_mul_f32 v165, v165, v167
v_cvt_pk_bf16_f32 v159, v164, v165
s_waitcnt lgkmcnt(1)
v_mfma_f32_16x16x32_bf16 v[24:27], a[144:147], v[170:173], v[24:27]
ds_write_b128 v216, v[154:157]
v_mfma_f32_16x16x32_bf16 v[28:31], a[168:171], v[170:173], v[28:31]
ds_write_b64 v216, v[158:159] offset:16
v_mfma_f32_16x16x32_bf16 v[32:35], a[192:195], v[170:173], v[32:35]
s_waitcnt lgkmcnt(2)
ds_read_b128 v[186:189], v210 offset:51200
ds_read_b128 v[170:173], v210 offset:52224
v_mfma_f32_16x16x32_bf16 v[24:27], a[148:151], v[182:185], v[24:27]
v_add_u32 v216, 1408, v216
v_cvt_pk_bf16_f32 v16, v16, v17
v_mfma_f32_16x16x32_bf16 v[28:31], a[172:175], v[182:185], v[28:31]
v_cvt_pk_bf16_f32 v17, v18, v19
v_cvt_pk_bf16_f32 v20, v20, v21
v_mfma_f32_16x16x32_bf16 v[32:35], a[196:199], v[182:185], v[32:35]
s_waitcnt lgkmcnt(1)
buffer_store_dwordx2 v[16:17], v204, s[8:11], s38 offen offset:32
ds_read_b128 v[182:185], v210 offset:53248
v_cvt_pk_bf16_f32 v21, v22, v23
buffer_store_dwordx2 v[20:21], v204, s[8:11], s38 offen offset:64
v_mfma_f32_16x16x32_bf16 v[24:27], a[152:155], v[186:189], v[24:27]
v_mfma_f32_16x16x32_bf16 v[28:31], a[176:179], v[186:189], v[28:31]
v_mfma_f32_16x16x32_bf16 v[32:35], a[200:203], v[186:189], v[32:35]
s_waitcnt lgkmcnt(1)
ds_read_b128 v[186:189], v210 offset:54272
v_mfma_f32_16x16x32_bf16 v[24:27], a[156:159], v[170:173], v[24:27]
v_mfma_f32_16x16x32_bf16 v[28:31], a[180:183], v[170:173], v[28:31]
v_mfma_f32_16x16x32_bf16 v[32:35], a[204:207], v[170:173], v[32:35]
s_waitcnt lgkmcnt(1)
v_mfma_f32_16x16x32_bf16 v[24:27], a[160:163], v[182:185], v[24:27]
v_mfma_f32_16x16x32_bf16 v[28:31], a[184:187], v[182:185], v[28:31]
v_mfma_f32_16x16x32_bf16 v[32:35], a[208:211], v[182:185], v[32:35]
s_waitcnt lgkmcnt(0)
v_mfma_f32_16x16x32_bf16 v[24:27], a[164:167], v[186:189], v[24:27]
v_mfma_f32_16x16x32_bf16 v[28:31], a[188:191], v[186:189], v[28:31]
v_mfma_f32_16x16x32_bf16 v[32:35], a[212:215], v[186:189], v[32:35]
s_nop 5
v_cvt_pk_bf16_f32 v24, v24, v25
v_cvt_pk_bf16_f32 v25, v26, v27
buffer_store_dwordx2 v[24:25], v205, s[8:11], s38 offen
v_cvt_pk_bf16_f32 v28, v28, v29
v_cvt_pk_bf16_f32 v29, v30, v31
buffer_store_dwordx2 v[28:29], v205, s[8:11], s38 offen offset:32
v_cvt_pk_bf16_f32 v32, v32, v33
v_cvt_pk_bf16_f32 v33, v34, v35
buffer_store_dwordx2 v[32:33], v205, s[8:11], s38 offen offset:64
L_epi:
s_nop 7
v_subrev_u32 v40, 56128, v210
buffer_load_dwordx4 v[72:75], v40, s[24:27], s50 offen
buffer_load_dwordx4 v[76:79], v40, s[24:27], s50 offen offset:1024
buffer_load_dwordx4 v[80:83], v40, s[24:27], s50 offen offset:2048
buffer_load_dwordx4 v[84:87], v40, s[24:27], s50 offen offset:3072
s_add_u32 s41, s50, 4096
buffer_load_dwordx4 v[88:91], v40, s[24:27], s41 offen
buffer_load_dwordx4 v[92:95], v40, s[24:27], s41 offen offset:1024
v_cmp_lt_u32 vcc, 1602224128, v219
v_mov_b32 v41, 145088
v_mov_b32 v42, 1
s_cbranch_vccz L_noflag
ds_write_b32 v41, v42
L_noflag:
s_waitcnt lgkmcnt(0)
s_barrier
ds_read_b32 v42, v41
v_lshrrev_b32 v43, 4, v40
v_and_b32 v43, 15, v43
v_lshrrev_b32 v44, 8, v40
v_mul_u32_u24 v45, 1408, v43
v_lshl_add_u32 v45, v44, 5, v45
v_add_u32 v45, 115520, v45
s_waitcnt lgkmcnt(0)
v_readfirstlane_b32 s43, v42
s_nop 0
s_cmp_lg_u32 s43, 0
s_cbranch_scc1 L_redo
ds_read_b128 v[100:103], v45
ds_read_b128 v[104:107], v45 offset:128
ds_read_b128 v[108:111], v45 offset:256
ds_read_b128 v[112:115], v45 offset:384
ds_read_b64 v[116:117], v45 offset:16
ds_read_b64 v[118:119], v45 offset:144
ds_read_b64 v[120:121], v45 offset:272
ds_read_b64 v[122:123], v45 offset:400
v_lshlrev_b32 v48, 5, v43
s_add_u32 s41, s33, 0
v_add_u32 v48, s41, v48
s_mov_b32 s42, 58835169
v_mul_hi_u32 v49, v48, s42
v_mul_u32_u24 v46, 73, v49
v_sub_u32 v46, v48, v46
v_mul_u32_u24 v46, 2688, v46
s_mov_b32 s42, 1373568
v_mul_lo_u32 v49, v49, s42
s_mul_i32 s42, s32, 96
v_add3_u32 v46, v46, v49, s42
v_cmp_gt_u32 vcc, s34, v48
v_mov_b32 v49, 1879048192
s_nop 0
v_cndmask_b32 v46, v49, v46, vcc
v_lshl_add_u32 v46, v44, 3, v46
v_add_u32 v46, 785664, v46
ds_read_b128 v[124:127], v45 offset:22528
ds_read_b128 v[128:131], v45 offset:22656
ds_read_b128 v[132:135], v45 offset:22784
ds_read_b128 v[136:139], v45 offset:22912
ds_read_b64 v[140:141], v45 offset:22544
ds_read_b64 v[142:143], v45 offset:22672
ds_read_b64 v[144:145], v45 offset:22800
ds_read_b64 v[146:147], v45 offset:22928
v_lshlrev_b32 v48, 5, v43
s_add_u32 s41, s33, 512
v_add_u32 v48, s41, v48
s_mov_b32 s42, 58835169
v_mul_hi_u32 v49, v48, s42
v_mul_u32_u24 v47, 73, v49
v_sub_u32 v47, v48, v47
v_mul_u32_u24 v47, 2688, v47
s_mov_b32 s42, 1373568
v_mul_lo_u32 v49, v49, s42
s_mul_i32 s42, s32, 96
v_add3_u32 v47, v47, v49, s42
v_cmp_gt_u32 vcc, s34, v48
v_mov_b32 v49, 1879048192
s_nop 0
v_cndmask_b32 v47, v49, v47, vcc
v_lshl_add_u32 v47, v44, 3, v47
v_add_u32 v47, 785664, v47
s_waitcnt vmcnt(5) lgkmcnt(14)
v_mfma_f32_16x16x32_bf16 v[72:75], a[144:147], v[100:103], v[72:75]
s_waitcnt vmcnt(4)
v_mfma_f32_16x16x32_bf16 v[76:79], a[168:171], v[100:103], v[76:79]
s_waitcnt vmcnt(3)
v_mfma_f32_16x16x32_bf16 v[80:83], a[192:195], v[100:103], v[80:83]
s_waitcnt lgkmcnt(14)
v_mfma_f32_16x16x32_bf16 v[72:75], a[148:151], v[104:107], v[72:75]
v_mfma_f32_16x16x32_bf16 v[76:79], a[172:175], v[104:107], v[76:79]
v_mfma_f32_16x16x32_bf16 v[80:83], a[196:199], v[104:107], v[80:83]
s_waitcnt lgkmcnt(13)
v_mfma_f32_16x16x32_bf16 v[72:75], a[152:155], v[108:111], v[72:75]
v_mfma_f32_16x16x32_bf16 v[76:79], a[176:179], v[108:111], v[76:79]
v_mfma_f32_16x16x32_bf16 v[80:83], a[200:203], v[108:111], v[80:83]
s_waitcnt lgkmcnt(12)
v_mfma_f32_16x16x32_bf16 v[72:75], a[156:159], v[112:115], v[72:75]
v_mfma_f32_16x16x32_bf16 v[76:79], a[180:183], v[112:115], v[76:79]
v_mfma_f32_16x16x32_bf16 v[80:83], a[204:207], v[112:115], v[80:83]
s_waitcnt lgkmcnt(10)
v_mfma_f32_16x16x32_bf16 v[72:75], a[160:163], v[116:119], v[72:75]
v_mfma_f32_16x16x32_bf16 v[76:79], a[184:187], v[116:119], v[76:79]
v_mfma_f32_16x16x32_bf16 v[80:83], a[208:211], v[116:119], v[80:83]
s_waitcnt lgkmcnt(8)
v_mfma_f32_16x16x32_bf16 v[72:75], a[164:167], v[120:123], v[72:75]
v_mfma_f32_16x16x32_bf16 v[76:79], a[188:191], v[120:123], v[76:79]
v_mfma_f32_16x16x32_bf16 v[80:83], a[212:215], v[120:123], v[80:83]
s_waitcnt vmcnt(2) lgkmcnt(7)
v_mfma_f32_16x16x32_bf16 v[84:87], a[144:147], v[124:127], v[84:87]
s_waitcnt vmcnt(1)
v_mfma_f32_16x16x32_bf16 v[88:91], a[168:171], v[124:127], v[88:91]
s_waitcnt vmcnt(0)
v_mfma_f32_16x16x32_bf16 v[92:95], a[192:195], v[124:127], v[92:95]
s_waitcnt lgkmcnt(6)
v_mfma_f32_16x16x32_bf16 v[84:87], a[148:151], v[128:131], v[84:87]
v_mfma_f32_16x16x32_bf16 v[88:91], a[172:175], v[128:131], v[88:91]
v_mfma_f32_16x16x32_bf16 v[92:95], a[196:199], v[128:131], v[92:95]
s_waitcnt lgkmcnt(5)
v_mfma_f32_16x16x32_bf16 v[84:87], a[152:155], v[132:135], v[84:87]
v_mfma_f32_16x16x32_bf16 v[88:91], a[176:179], v[132:135], v[88:91]
v_mfma_f32_16x16x32_bf16 v[92:95], a[200:203], v[132:135], v[92:95]
s_waitcnt lgkmcnt(4)
v_mfma_f32_16x16x32_bf16 v[84:87], a[156:159], v[136:139], v[84:87]
v_mfma_f32_16x16x32_bf16 v[88:91], a[180:183], v[136:139], v[88:91]
v_mfma_f32_16x16x32_bf16 v[92:95], a[204:207], v[136:139], v[92:95]
s_waitcnt lgkmcnt(2)
v_mfma_f32_16x16x32_bf16 v[84:87], a[160:163], v[140:143], v[84:87]
v_mfma_f32_16x16x32_bf16 v[88:91], a[184:187], v[140:143], v[88:91]
v_mfma_f32_16x16x32_bf16 v[92:95], a[208:211], v[140:143], v[92:95]
s_waitcnt lgkmcnt(0)
v_mfma_f32_16x16x32_bf16 v[84:87], a[164:167], v[144:147], v[84:87]
v_mfma_f32_16x16x32_bf16 v[88:91], a[188:191], v[144:147], v[88:91]
v_mfma_f32_16x16x32_bf16 v[92:95], a[212:215], v[144:147], v[92:95]
v_cvt_pk_bf16_f32 v72, v72, v73
v_cvt_pk_bf16_f32 v73, v74, v75
buffer_store_dwordx2 v[72:73], v46, s[8:11], 0 offen
v_cvt_pk_bf16_f32 v76, v76, v77
v_cvt_pk_bf16_f32 v77, v78, v79
buffer_store_dwordx2 v[76:77], v46, s[8:11], 0 offen offset:32
v_cvt_pk_bf16_f32 v80, v80, v81
v_cvt_pk_bf16_f32 v81, v82, v83
buffer_store_dwordx2 v[80:81], v46, s[8:11], 0 offen offset:64
v_cvt_pk_bf16_f32 v84, v84, v85
v_cvt_pk_bf16_f32 v85, v86, v87
buffer_store_dwordx2 v[84:85], v47, s[8:11], 0 offen
v_cvt_pk_bf16_f32 v88, v88, v89
v_cvt_pk_bf16_f32 v89, v90, v91
buffer_store_dwordx2 v[88:89], v47, s[8:11], 0 offen offset:32
v_cvt_pk_bf16_f32 v92, v92, v93
v_cvt_pk_bf16_f32 v93, v94, v95
buffer_store_dwordx2 v[92:93], v47, s[8:11], 0 offen offset:64
L_end:
s_endpgm
L_redo:
s_mov_b32 s47, 1
s_waitcnt vmcnt(0) lgkmcnt(0)
s_barrier
s_branch L_start
L_safe:
ds_read_b128 v[174:177], v218
ds_read_b128 v[178:181], v218 offset:528
s_barrier
ds_read_b128 v[84:87], v200
ds_read_b128 v[92:95], v201
ds_read_b128 v[100:103], v202
ds_read_b128 v[88:91], v194 offset:16
ds_read_b128 v[96:99], v195 offset:16
ds_read_b128 v[104:107], v196 offset:16
s_waitcnt lgkmcnt(5)
v_mfma_f32_16x16x32_bf16 v[0:3], v[174:177], v[84:87], 0
s_waitcnt lgkmcnt(4)
ds_read_b128 v[84:87], v194
v_mfma_f32_16x16x32_bf16 v[12:15], v[174:177], v[92:95], 0
s_waitcnt lgkmcnt(0)
ds_read_b128 v[92:95], v195
s_nop 0
v_smfmac_f32_16x16x64_bf16 v[0:3], v[178:181], v[84:91], v207
s_waitcnt lgkmcnt(0)
s_nop 0
v_smfmac_f32_16x16x64_bf16 v[12:15], v[178:181], v[92:99], v207
v_mfma_f32_16x16x32_bf16 v[24:27], v[174:177], v[100:103], 0
ds_read_b128 v[100:103], v196
ds_read_b128 v[174:177], v218 offset:1056
ds_read_b128 v[84:87], v197
ds_read_b128 v[88:91], v197 offset:16
ds_read_b128 v[92:95], v198
ds_read_b128 v[96:99], v198 offset:16
s_mul_hi_u32 s41, s35, 58835169
s_mul_i32 s42, s41, 73
s_sub_u32 s42, s35, s42
s_mul_i32 s43, s41, 1373568
s_mul_i32 s51, s42, 2688
s_add_u32 s43, s43, s51
s_cmp_lt_u32 s35, s34
s_cselect_b32 s37, s43, 1879048192
s_add_u32 s35, s35, 32
s_cmp_eq_u32 s42, 0
s_cselect_b32 s44, 536870911, s72
s_cmp_eq_u32 s42, 72
s_cselect_b32 s44, 939524095, s44
v_and_b32 v209, s44, v208
s_cmp_eq_u32 s41, 0
s_cselect_b32 s40, 1879048192, s37
s_add_u32 m0, s45, 0
s_waitcnt lgkmcnt(5)
v_smfmac_f32_16x16x64_bf16 v[24:27], v[178:181], v[100:107], v207
s_waitcnt lgkmcnt(2)
ds_read_b128 v[100:103], v199
ds_read_b128 v[104:107], v199 offset:16
ds_read_b128 v[178:181], v218 offset:1584
v_smfmac_f32_16x16x64_bf16 v[0:3], v[174:177], v[84:91], v207
s_waitcnt lgkmcnt(3)
ds_read_b128 v[84:87], v200 offset:32
ds_read_b128 v[88:91], v194 offset:48
v_smfmac_f32_16x16x64_bf16 v[12:15], v[174:177], v[92:99], v207
s_waitcnt lgkmcnt(3)
ds_read_b128 v[92:95], v201 offset:32
ds_read_b128 v[96:99], v195 offset:48
s_nop 0
v_add_f32 v118, v0, v1
v_mul_f32 v119, v0, v0
v_add_f32 v118, v118, v2
v_fmac_f32 v119, v1, v1
v_add_f32 v118, v118, v3
v_fmac_f32 v119, v2, v2
v_smfmac_f32_16x16x64_bf16 v[24:27], v[174:177], v[100:107], v207
s_waitcnt lgkmcnt(3)
ds_read_b128 v[100:103], v202 offset:32
ds_read_b128 v[174:177], v218 offset:2112
ds_read_b128 v[104:107], v196 offset:48
v_fmac_f32 v119, v3, v3
v_add_f32 v126, v12, v13
v_mul_f32 v127, v12, v12
v_add_f32 v126, v126, v14
v_fmac_f32 v127, v13, v13
v_mfma_f32_16x16x32_bf16 v[4:7], v[178:181], v[84:87], 0
s_waitcnt lgkmcnt(4)
ds_read_b128 v[84:87], v194 offset:32
v_add_f32 v126, v126, v15
v_fmac_f32 v127, v14, v14
v_mfma_f32_16x16x32_bf16 v[16:19], v[178:181], v[92:95], 0
s_waitcnt lgkmcnt(3)
ds_read_b128 v[92:95], v195 offset:32
v_fmac_f32 v127, v15, v15
v_add_f32 v134, v24, v25
v_mul_f32 v135, v24, v24
v_mfma_f32_16x16x32_bf16 v[28:31], v[178:181], v[100:103], 0
s_waitcnt lgkmcnt(1)
ds_read_b128 v[100:103], v196 offset:32
ds_read_b128 v[178:181], v218 offset:2640
v_add_f32 v134, v134, v26
v_fmac_f32 v135, v25, v25
v_add_f32 v134, v134, v27
v_fmac_f32 v135, v26, v26
v_fmac_f32 v135, v27, v27
v_smfmac_f32_16x16x64_bf16 v[4:7], v[174:177], v[84:91], v207
s_waitcnt lgkmcnt(2)
ds_read_b128 v[84:87], v197 offset:32
ds_read_b128 v[88:91], v197 offset:48
v_smfmac_f32_16x16x64_bf16 v[16:19], v[174:177], v[92:99], v207
s_waitcnt lgkmcnt(3)
ds_read_b128 v[92:95], v198 offset:32
ds_read_b128 v[96:99], v198 offset:48
v_smfmac_f32_16x16x64_bf16 v[28:31], v[174:177], v[100:107], v207
s_waitcnt lgkmcnt(2)
ds_read_b128 v[100:103], v199 offset:32
ds_read_b128 v[104:107], v199 offset:48
ds_read_b128 v[174:177], v218 offset:3168
v_smfmac_f32_16x16x64_bf16 v[4:7], v[178:181], v[84:91], v207
s_waitcnt lgkmcnt(3)
ds_read_b128 v[84:87], v200 offset:64
s_nop 5
v_add_f32 v118, v118, v4
v_smfmac_f32_16x16x64_bf16 v[16:19], v[178:181], v[92:99], v207
s_waitcnt lgkmcnt(2)
ds_read_b128 v[92:95], v201 offset:64
ds_read_b128 v[88:91], v194 offset:80
v_smfmac_f32_16x16x64_bf16 v[28:31], v[178:181], v[100:107], v207
s_waitcnt lgkmcnt(2)
ds_read_b128 v[100:103], v202 offset:64
ds_read_b128 v[178:181], v218 offset:3696
v_fmac_f32 v119, v4, v4
ds_read_b128 v[96:99], v195 offset:80
ds_read_b128 v[104:107], v196 offset:80
v_mfma_f32_16x16x32_bf16 v[8:11], v[174:177], v[84:87], 0
s_waitcnt lgkmcnt(5)
ds_read_b128 v[84:87], v194 offset:64
v_add_f32 v118, v118, v5
v_fmac_f32 v119, v5, v5
v_add_f32 v118, v118, v6
v_fmac_f32 v119, v6, v6
v_add_f32 v118, v118, v7
v_mfma_f32_16x16x32_bf16 v[20:23], v[174:177], v[92:95], 0
s_waitcnt lgkmcnt(4)
ds_read_b128 v[92:95], v195 offset:64
v_fmac_f32 v119, v7, v7
v_add_f32 v126, v126, v16
v_fmac_f32 v127, v16, v16
v_add_f32 v126, v126, v17
v_mfma_f32_16x16x32_bf16 v[32:35], v[174:177], v[100:103], 0
s_waitcnt lgkmcnt(1)
ds_read_b128 v[100:103], v196 offset:64
ds_read_b128 v[174:177], v218 offset:4224
v_fmac_f32 v127, v17, v17
v_add_f32 v126, v126, v18
v_fmac_f32 v127, v18, v18
v_add_f32 v126, v126, v19
v_fmac_f32 v127, v19, v19
v_add_f32 v134, v134, v28
v_smfmac_f32_16x16x64_bf16 v[8:11], v[178:181], v[84:91], v207
s_waitcnt lgkmcnt(2)
ds_read_b128 v[84:87], v197 offset:64
ds_read_b128 v[88:91], v197 offset:80
v_fmac_f32 v135, v28, v28
v_add_f32 v134, v134, v29
v_fmac_f32 v135, v29, v29
v_add_f32 v134, v134, v30
v_fmac_f32 v135, v30, v30
v_add_f32 v134, v134, v31
v_smfmac_f32_16x16x64_bf16 v[20:23], v[178:181], v[92:99], v207
ds_read_b128 v[92:95], v198 offset:64
ds_read_b128 v[96:99], v198 offset:80
v_fmac_f32 v135, v31, v31
s_waitcnt lgkmcnt(5)
v_smfmac_f32_16x16x64_bf16 v[32:35], v[178:181], v[100:107], v207
s_waitcnt lgkmcnt(2)
ds_read_b128 v[100:103], v199 offset:64
ds_read_b128 v[104:107], v199 offset:80
v_smfmac_f32_16x16x64_bf16 v[8:11], v[174:177], v[84:91], v207
s_waitcnt lgkmcnt(2)
s_nop 6
v_add_f32 v118, v118, v8
v_fmac_f32 v119, v8, v8
v_smfmac_f32_16x16x64_bf16 v[20:23], v[174:177], v[92:99], v207
s_waitcnt lgkmcnt(0)
v_add_f32 v118, v118, v9
v_fmac_f32 v119, v9, v9
v_add_f32 v118, v118, v10
v_fmac_f32 v119, v10, v10
v_add_f32 v118, v118, v11
v_fmac_f32 v119, v11, v11
s_nop 0
v_add_f32 v126, v126, v20
v_smfmac_f32_16x16x64_bf16 v[32:35], v[174:177], v[100:107], v207
v_fmac_f32 v127, v20, v20
v_add_f32 v126, v126, v21
v_fmac_f32 v127, v21, v21
v_add_f32 v126, v126, v22
v_fmac_f32 v127, v22, v22
v_add_f32 v126, v126, v23
v_fmac_f32 v127, v23, v23
s_nop 0
v_add_f32 v134, v134, v32
v_fmac_f32 v135, v32, v32
v_add_f32 v134, v134, v33
v_fmac_f32 v135, v33, v33
v_add_f32 v134, v134, v34
v_fmac_f32 v135, v34, v34
v_add_f32 v134, v134, v35
v_permlane16_swap_b32 v118, v119
v_fmac_f32 v135, v35, v35
v_add_f32 v118, v118, v119
v_permlane16_swap_b32 v126, v127
v_add_f32 v126, v126, v127
v_permlane16_swap_b32 v134, v135
v_add_f32 v134, v134, v135
v_permlane32_swap_b32 v118, v126
v_add_f32 v118, v118, v126
v_mov_b32 v135, v134
ds_write_b32 v213, v118
s_nop 0
v_permlane32_swap_b32 v134, v135
v_add_f32 v134, v134, v135
ds_write_b32 v213, v134 offset:512
s_waitcnt lgkmcnt(0)
s_barrier
ds_read_b128 v[174:177], v210 offset:55296
ds_read_b128 v[178:181], v210 offset:56320
buffer_load_dwordx4 v209, s[4:7], s40 offen nt lds
s_add_u32 s40, s37, 196224
s_add_u32 m0, s45, 4112
s_nop 0
buffer_load_dwordx4 v209, s[4:7], s40 offen nt lds
s_add_u32 s40, s37, 392448
s_add_u32 m0, s45, 8224
s_nop 0
buffer_load_dwordx4 v209, s[4:7], s40 offen nt lds
s_add_u32 s40, s37, 588672
s_add_u32 m0, s45, 12336
s_waitcnt lgkmcnt(0)
v_add_f32 v174, v174, v175
buffer_load_dwordx4 v209, s[4:7], s40 offen nt lds
s_add_u32 s40, s37, 784896
v_add_f32 v178, v178, v179
v_add_f32 v176, v176, v177
s_add_u32 m0, s45, 16448
v_add_f32 v180, v180, v181
v_add_f32 v174, v174, v176
buffer_load_dwordx4 v209, s[4:7], s40 offen nt lds
s_add_u32 s40, s37, 981120
v_add_f32 v178, v178, v180
v_mul_f32 v175, s48, v174
s_add_u32 m0, s45, 20560
s_nop 0
buffer_load_dwordx4 v209, s[4:7], s40 offen nt lds
s_add_u32 s40, s37, 1177344
v_mul_f32 v178, s48, v178
v_fma_f32 v178, -v175, v175, v178
s_add_u32 m0, s45, 24672
v_max_f32 v178, 0, v178
v_add_f32 v178, s49, v178
buffer_load_dwordx4 v209, s[4:7], s40 offen nt lds
s_add_u32 s40, s37, 1373568
v_rsq_f32 v174, v178
s_add_u32 m0, s45, 28784
v_mul_f32_e64 v175, -v175, v174
ds_write_b64 v214, v[174:175]
ds_read_b64 v[118:119], v215
ds_read_b64 v[126:127], v215 offset:128
ds_read_b64 v[134:135], v215 offset:256
buffer_load_dwordx4 v209, s[4:7], s40 offen nt lds
s_add_u32 s40, s37, 1569792
s_add_u32 m0, s45, 32896
s_nop 0
buffer_load_dwordx4 v209, s[4:7], s40 offen nt lds
s_waitcnt lgkmcnt(2)
v_fma_f32 v108, v0, v118, v119
v_fma_f32 v109, v1, v118, v119
v_cvt_pk_bf16_f32 v90, v108, v109
v_fma_f32 v110, v2, v118, v119
v_fma_f32 v111, v3, v118, v119
v_cvt_pk_bf16_f32 v91, v110, v111
v_fma_f32 v112, v4, v118, v119
v_fma_f32 v113, v5, v118, v119
v_cvt_pk_bf16_f32 v92, v112, v113
v_fma_f32 v108, v6, v118, v119
v_fma_f32 v109, v7, v118, v119
v_cvt_pk_bf16_f32 v93, v108, v109
ds_write_b128 v211, v[90:93]
v_fma_f32 v110, v8, v118, v119
v_fma_f32 v111, v9, v118, v119
v_cvt_pk_bf16_f32 v94, v110, v111
v_fma_f32 v112, v10, v118, v119
v_fma_f32 v113, v11, v118, v119
v_cvt_pk_bf16_f32 v95, v112, v113
s_waitcnt lgkmcnt(2)
v_fma_f32 v108, v12, v126, v127
ds_write_b64 v212, v[94:95]
v_fma_f32 v109, v13, v126, v127
v_cvt_pk_bf16_f32 v102, v108, v109
v_fma_f32 v110, v14, v126, v127
v_fma_f32 v111, v15, v126, v127
v_cvt_pk_bf16_f32 v103, v110, v111
v_fma_f32 v112, v16, v126, v127
v_fma_f32 v113, v17, v126, v127
v_cvt_pk_bf16_f32 v104, v112, v113
v_fma_f32 v108, v18, v126, v127
v_fma_f32 v109, v19, v126, v127
v_cvt_pk_bf16_f32 v105, v108, v109
ds_write_b128 v211, v[102:105] offset:6144
v_fma_f32 v110, v20, v126, v127
v_fma_f32 v111, v21, v126, v127
v_cvt_pk_bf16_f32 v106, v110, v111
v_fma_f32 v112, v22, v126, v127
v_fma_f32 v113, v23, v126, v127
v_cvt_pk_bf16_f32 v107, v112, v113
ds_write_b64 v212, v[106:107] offset:6144
s_waitcnt lgkmcnt(4)
v_fma_f32 v108, v24, v134, v135
v_fma_f32 v109, v25, v134, v135
v_cvt_pk_bf16_f32 v90, v108, v109
v_fma_f32 v110, v26, v134, v135
v_fma_f32 v111, v27, v134, v135
v_cvt_pk_bf16_f32 v91, v110, v111
v_fma_f32 v112, v28, v134, v135
v_fma_f32 v113, v29, v134, v135
v_cvt_pk_bf16_f32 v92, v112, v113
v_fma_f32 v108, v30, v134, v135
v_fma_f32 v109, v31, v134, v135
v_cvt_pk_bf16_f32 v93, v108, v109
ds_write_b128 v211, v[90:93] offset:12288
v_fma_f32 v110, v32, v134, v135
v_fma_f32 v111, v33, v134, v135
v_cvt_pk_bf16_f32 v94, v110, v111
v_fma_f32 v112, v34, v134, v135
v_fma_f32 v113, v35, v134, v135
v_cvt_pk_bf16_f32 v95, v112, v113
ds_write_b64 v212, v[94:95] offset:12288
s_mov_b32 s38, s36
s_waitcnt vmcnt(0) lgkmcnt(0)
s_barrier
ds_read_b128 v[174:177], v218
ds_read_b128 v[178:181], v218 offset:528
s_barrier
ds_read_b128 v[84:87], v200
ds_read_b128 v[92:95], v201
ds_read_b128 v[100:103], v202
ds_read_b128 v[88:91], v194 offset:16
ds_read_b128 v[96:99], v195 offset:16
ds_read_b128 v[104:107], v196 offset:16
s_waitcnt lgkmcnt(5)
v_mfma_f32_16x16x32_bf16 v[36:39], v[174:177], v[84:87], 0
s_waitcnt lgkmcnt(4)
ds_read_b128 v[84:87], v194
v_mfma_f32_16x16x32_bf16 v[48:51], v[174:177], v[92:95], 0
s_waitcnt lgkmcnt(0)
ds_read_b128 v[92:95], v195
ds_read_b128 v[182:185], v210
ds_read_b128 v[186:189], v210 offset:1024
v_smfmac_f32_16x16x64_bf16 v[36:39], v[178:181], v[84:91], v207
s_waitcnt lgkmcnt(2)
v_smfmac_f32_16x16x64_bf16 v[48:51], v[178:181], v[92:99], v207
v_mfma_f32_16x16x32_bf16 v[60:63], v[174:177], v[100:103], 0
s_waitcnt lgkmcnt(1)
ds_read_b128 v[100:103], v196
ds_read_b128 v[174:177], v218 offset:1056
v_mfma_f32_16x16x32_bf16 v[138:141], a[0:3], v[182:185], 0
v_mfma_f32_16x16x32_bf16 v[142:145], a[24:27], v[182:185], 0
v_mfma_f32_16x16x32_bf16 v[146:149], a[48:51], v[182:185], 0
ds_read_b128 v[84:87], v197
ds_read_b128 v[88:91], v197 offset:16
v_mfma_f32_16x16x32_bf16 v[150:153], a[216:219], v[182:185], 0
v_mfma_f32_16x16x32_bf16 v[154:157], a[240:243], v[182:185], 0
v_mfma_f32_16x16x32_bf16 v[158:161], v[232:235], v[182:185], 0
ds_read_b128 v[92:95], v198
ds_read_b128 v[96:99], v198 offset:16
v_mfma_f32_16x16x32_bf16 v[162:165], v[182:185], a[72:75], 0
v_mfma_f32_16x16x32_bf16 v[166:169], v[182:185], a[96:99], 0
v_mfma_f32_16x16x32_bf16 v[170:173], v[182:185], a[120:123], 0
s_waitcnt lgkmcnt(6)
ds_read_b128 v[182:185], v210 offset:2048
v_mfma_f32_16x16x32_bf16 v[138:141], a[4:7], v[186:189], v[138:141]
v_mfma_f32_16x16x32_bf16 v[142:145], a[28:31], v[186:189], v[142:145]
v_mfma_f32_16x16x32_bf16 v[146:149], a[52:55], v[186:189], v[146:149]
v_mfma_f32_16x16x32_bf16 v[150:153], a[220:223], v[186:189], v[150:153]
v_mfma_f32_16x16x32_bf16 v[154:157], a[244:247], v[186:189], v[154:157]
s_mul_hi_u32 s41, s35, 58835169
s_mul_i32 s42, s41, 73
v_mfma_f32_16x16x32_bf16 v[158:161], v[236:239], v[186:189], v[158:161]
s_sub_u32 s42, s35, s42
s_mul_i32 s43, s41, 1373568
v_mfma_f32_16x16x32_bf16 v[162:165], v[186:189], a[76:79], v[162:165]
s_mul_i32 s51, s42, 2688
v_mfma_f32_16x16x32_bf16 v[166:169], v[186:189], a[100:103], v[166:169]
s_add_u32 s43, s43, s51
s_cmp_lt_u32 s35, s34
v_mfma_f32_16x16x32_bf16 v[170:173], v[186:189], a[124:127], v[170:173]
s_cselect_b32 s36, s43, 1879048192
ds_read_b128 v[186:189], v210 offset:3072
s_add_u32 s35, s35, 32
s_waitcnt lgkmcnt(1)
v_mfma_f32_16x16x32_bf16 v[138:141], a[8:11], v[182:185], v[138:141]
s_cmp_eq_u32 s42, 0
s_cselect_b32 s44, 536870911, s72
s_cmp_eq_u32 s42, 72
v_mfma_f32_16x16x32_bf16 v[142:145], a[32:35], v[182:185], v[142:145]
s_cselect_b32 s44, 939524095, s44
v_and_b32 v209, s44, v208
v_mfma_f32_16x16x32_bf16 v[146:149], a[56:59], v[182:185], v[146:149]
s_cmp_eq_u32 s41, 0
v_mfma_f32_16x16x32_bf16 v[150:153], a[224:227], v[182:185], v[150:153]
s_cselect_b32 s40, 1879048192, s36
s_add_u32 m0, s45, 0
v_mfma_f32_16x16x32_bf16 v[154:157], a[248:251], v[182:185], v[154:157]
v_smfmac_f32_16x16x64_bf16 v[60:63], v[178:181], v[100:107], v207
ds_read_b128 v[100:103], v199
ds_read_b128 v[104:107], v199 offset:16
v_mfma_f32_16x16x32_bf16 v[158:161], v[240:243], v[182:185], v[158:161]
ds_read_b128 v[178:181], v218 offset:1584
v_mfma_f32_16x16x32_bf16 v[162:165], v[182:185], a[80:83], v[162:165]
v_mfma_f32_16x16x32_bf16 v[166:169], v[182:185], a[104:107], v[166:169]
v_mfma_f32_16x16x32_bf16 v[170:173], v[182:185], a[128:131], v[170:173]
ds_read_b128 v[182:185], v210 offset:4096
v_smfmac_f32_16x16x64_bf16 v[36:39], v[174:177], v[84:91], v207
s_waitcnt lgkmcnt(4)
ds_read_b128 v[84:87], v200 offset:32
ds_read_b128 v[88:91], v194 offset:48
v_mfma_f32_16x16x32_bf16 v[138:141], a[12:15], v[186:189], v[138:141]
v_mfma_f32_16x16x32_bf16 v[142:145], a[36:39], v[186:189], v[142:145]
v_smfmac_f32_16x16x64_bf16 v[48:51], v[174:177], v[92:99], v207
ds_read_b128 v[92:95], v201 offset:32
ds_read_b128 v[96:99], v195 offset:48
v_mfma_f32_16x16x32_bf16 v[146:149], a[60:63], v[186:189], v[146:149]
v_add_f32 v118, v36, v37
v_mul_f32 v119, v36, v36
v_mfma_f32_16x16x32_bf16 v[150:153], a[228:231], v[186:189], v[150:153]
v_add_f32 v118, v118, v38
v_fmac_f32 v119, v37, v37
v_mfma_f32_16x16x32_bf16 v[154:157], a[252:255], v[186:189], v[154:157]
s_waitcnt lgkmcnt(6)
v_add_f32 v118, v118, v39
v_fmac_f32 v119, v38, v38
v_smfmac_f32_16x16x64_bf16 v[60:63], v[174:177], v[100:107], v207
ds_read_b128 v[100:103], v202 offset:32
ds_read_b128 v[174:177], v218 offset:2112
v_mfma_f32_16x16x32_bf16 v[158:161], v[244:247], v[186:189], v[158:161]
ds_read_b128 v[104:107], v196 offset:48
v_fmac_f32 v119, v39, v39
v_mfma_f32_16x16x32_bf16 v[162:165], v[186:189], a[84:87], v[162:165]
v_add_f32 v126, v48, v49
v_mul_f32 v127, v48, v48
v_mfma_f32_16x16x32_bf16 v[166:169], v[186:189], a[108:111], v[166:169]
s_waitcnt lgkmcnt(6)
v_add_f32 v126, v126, v50
v_fmac_f32 v127, v49, v49
v_mfma_f32_16x16x32_bf16 v[40:43], v[178:181], v[84:87], 0
ds_read_b128 v[84:87], v194 offset:32
v_add_f32 v126, v126, v51
v_mfma_f32_16x16x32_bf16 v[170:173], v[186:189], a[132:135], v[170:173]
s_waitcnt lgkmcnt(5)
ds_read_b128 v[186:189], v210 offset:5120
v_fmac_f32 v127, v50, v50
v_mfma_f32_16x16x32_bf16 v[52:55], v[178:181], v[92:95], 0
ds_read_b128 v[92:95], v195 offset:32
v_fmac_f32 v127, v51, v51
v_mfma_f32_16x16x32_bf16 v[138:141], a[16:19], v[182:185], v[138:141]
s_waitcnt lgkmcnt(5)
v_add_f32 v134, v60, v61
v_mul_f32 v135, v60, v60
v_mfma_f32_16x16x32_bf16 v[64:67], v[178:181], v[100:103], 0
ds_read_b128 v[100:103], v196 offset:32
ds_read_b128 v[178:181], v218 offset:2640
v_mfma_f32_16x16x32_bf16 v[142:145], a[40:43], v[182:185], v[142:145]
v_add_f32 v134, v134, v62
v_fmac_f32 v135, v61, v61
v_mfma_f32_16x16x32_bf16 v[146:149], a[64:67], v[182:185], v[146:149]
v_add_f32 v134, v134, v63
v_fmac_f32 v135, v62, v62
v_mfma_f32_16x16x32_bf16 v[150:153], a[232:235], v[182:185], v[150:153]
v_fmac_f32 v135, v63, v63
v_mfma_f32_16x16x32_bf16 v[154:157], v[224:227], v[182:185], v[154:157]
s_waitcnt lgkmcnt(4)
v_smfmac_f32_16x16x64_bf16 v[40:43], v[174:177], v[84:91], v207
ds_read_b128 v[84:87], v197 offset:32
ds_read_b128 v[88:91], v197 offset:48
v_mfma_f32_16x16x32_bf16 v[158:161], v[248:251], v[182:185], v[158:161]
v_mfma_f32_16x16x32_bf16 v[162:165], v[182:185], a[88:91], v[162:165]
v_mfma_f32_16x16x32_bf16 v[166:169], v[182:185], a[112:115], v[166:169]
s_waitcnt lgkmcnt(4)
v_smfmac_f32_16x16x64_bf16 v[52:55], v[174:177], v[92:99], v207
ds_read_b128 v[92:95], v198 offset:32
ds_read_b128 v[96:99], v198 offset:48
v_mfma_f32_16x16x32_bf16 v[170:173], v[182:185], a[136:139], v[170:173]
ds_read_b128 v[182:185], v210 offset:6144
v_mfma_f32_16x16x32_bf16 v[138:141], a[20:23], v[186:189], v[138:141]
s_waitcnt lgkmcnt(6)
v_smfmac_f32_16x16x64_bf16 v[64:67], v[174:177], v[100:107], v207
ds_read_b128 v[100:103], v199 offset:32
ds_read_b128 v[104:107], v199 offset:48
v_mfma_f32_16x16x32_bf16 v[142:145], a[44:47], v[186:189], v[142:145]
ds_read_b128 v[174:177], v218 offset:3168
v_mfma_f32_16x16x32_bf16 v[146:149], a[68:71], v[186:189], v[146:149]
s_nop 0
v_cvt_pk_bf16_f32 v78, v138, v139
v_cvt_pk_bf16_f32 v79, v140, v141
v_mfma_f32_16x16x32_bf16 v[150:153], a[236:239], v[186:189], v[150:153]
v_mfma_f32_16x16x32_bf16 v[154:157], v[228:231], v[186:189], v[154:157]
s_waitcnt lgkmcnt(6)
v_cvt_pk_bf16_f32 v80, v142, v143
v_cvt_pk_bf16_f32 v81, v144, v145
v_smfmac_f32_16x16x64_bf16 v[40:43], v[178:181], v[84:91], v207
ds_read_b128 v[84:87], v200 offset:64
v_cvt_pk_bf16_f32 v82, v146, v147
v_mfma_f32_16x16x32_bf16 v[158:161], v[252:255], v[186:189], v[158:161]
v_cvt_pk_bf16_f32 v83, v148, v149
v_cvt_pk_bf16_f32 v72, v150, v151
v_mfma_f32_16x16x32_bf16 v[162:165], v[186:189], a[92:95], v[162:165]
v_cvt_pk_bf16_f32 v73, v152, v153
v_cvt_pk_bf16_f32 v74, v154, v155
v_mfma_f32_16x16x32_bf16 v[166:169], v[186:189], a[116:119], v[166:169]
s_waitcnt lgkmcnt(5)
v_cvt_pk_bf16_f32 v75, v156, v157
v_add_f32 v118, v118, v40
v_smfmac_f32_16x16x64_bf16 v[52:55], v[178:181], v[92:99], v207
ds_read_b128 v[92:95], v201 offset:64
v_cvt_pk_bf16_f32 v76, v158, v159
v_mfma_f32_16x16x32_bf16 v[170:173], v[186:189], a[140:143], v[170:173]
s_waitcnt lgkmcnt(5)
ds_read_b128 v[186:189], v210 offset:7168
v_cvt_pk_bf16_f32 v77, v160, v161
v_mfma_f32_16x16x32_bf16 v[138:141], a[0:3], v[182:185], 0
v_cvt_pk_bf16_f32 v114, v162, v163
v_cvt_pk_bf16_f32 v115, v164, v165
v_mfma_f32_16x16x32_bf16 v[142:145], a[24:27], v[182:185], 0
s_waitcnt lgkmcnt(4)
ds_read_b128 v[88:91], v194 offset:80
v_cvt_pk_bf16_f32 v122, v166, v167
v_smfmac_f32_16x16x64_bf16 v[64:67], v[178:181], v[100:107], v207
ds_read_b128 v[100:103], v202 offset:64
ds_read_b128 v[178:181], v218 offset:3696
v_mfma_f32_16x16x32_bf16 v[146:149], a[48:51], v[182:185], 0
v_cvt_pk_bf16_f32 v123, v168, v169
v_cvt_pk_bf16_f32 v130, v170, v171
v_mfma_f32_16x16x32_bf16 v[150:153], a[216:219], v[182:185], 0
v_cvt_pk_bf16_f32 v131, v172, v173
v_fmac_f32 v119, v40, v40
v_mfma_f32_16x16x32_bf16 v[154:157], a[240:243], v[182:185], 0
s_waitcnt lgkmcnt(5)
ds_read_b128 v[96:99], v195 offset:80
ds_read_b128 v[104:107], v196 offset:80
v_mfma_f32_16x16x32_bf16 v[44:47], v[174:177], v[84:87], 0
ds_read_b128 v[84:87], v194 offset:64
v_add_f32 v118, v118, v41
v_mfma_f32_16x16x32_bf16 v[158:161], v[232:235], v[182:185], 0
v_fmac_f32 v119, v41, v41
v_add_f32 v118, v118, v42
v_mfma_f32_16x16x32_bf16 v[162:165], v[182:185], a[72:75], 0
s_waitcnt lgkmcnt(7)
v_fmac_f32 v119, v42, v42
v_add_f32 v118, v118, v43
v_mfma_f32_16x16x32_bf16 v[56:59], v[174:177], v[92:95], 0
ds_read_b128 v[92:95], v195 offset:64
v_fmac_f32 v119, v43, v43
v_mfma_f32_16x16x32_bf16 v[166:169], v[182:185], a[96:99], 0
v_add_f32 v126, v126, v52
v_fmac_f32 v127, v52, v52
v_mfma_f32_16x16x32_bf16 v[170:173], v[182:185], a[120:123], 0
s_waitcnt lgkmcnt(5)
ds_read_b128 v[182:185], v210 offset:8192
v_add_f32 v126, v126, v53
v_mfma_f32_16x16x32_bf16 v[68:71], v[174:177], v[100:103], 0
ds_read_b128 v[100:103], v196 offset:64
ds_read_b128 v[174:177], v218 offset:4224
v_mfma_f32_16x16x32_bf16 v[138:141], a[4:7], v[186:189], v[138:141]
v_fmac_f32 v127, v53, v53
v_add_f32 v126, v126, v54
v_mfma_f32_16x16x32_bf16 v[142:145], a[28:31], v[186:189], v[142:145]
v_fmac_f32 v127, v54, v54
v_add_f32 v126, v126, v55
v_mfma_f32_16x16x32_bf16 v[146:149], a[52:55], v[186:189], v[146:149]
s_waitcnt lgkmcnt(4)
v_fmac_f32 v127, v55, v55
v_add_f32 v134, v134, v64
v_smfmac_f32_16x16x64_bf16 v[44:47], v[178:181], v[84:91], v207
ds_read_b128 v[84:87], v197 offset:64
ds_read_b128 v[88:91], v197 offset:80
v_mfma_f32_16x16x32_bf16 v[150:153], a[220:223], v[186:189], v[150:153]
v_fmac_f32 v135, v64, v64
v_add_f32 v134, v134, v65
v_mfma_f32_16x16x32_bf16 v[154:157], a[244:247], v[186:189], v[154:157]
v_fmac_f32 v135, v65, v65
v_add_f32 v134, v134, v66
v_mfma_f32_16x16x32_bf16 v[158:161], v[236:239], v[186:189], v[158:161]
s_waitcnt lgkmcnt(5)
v_fmac_f32 v135, v66, v66
v_add_f32 v134, v134, v67
v_smfmac_f32_16x16x64_bf16 v[56:59], v[178:181], v[92:99], v207
ds_read_b128 v[92:95], v198 offset:64
ds_read_b128 v[96:99], v198 offset:80
v_mfma_f32_16x16x32_bf16 v[162:165], v[186:189], a[76:79], v[162:165]
v_fmac_f32 v135, v67, v67
v_mfma_f32_16x16x32_bf16 v[166:169], v[186:189], a[100:103], v[166:169]
ds_read_u16 v120, v217
ds_read_u16 v128, v217 offset:32
v_mfma_f32_16x16x32_bf16 v[170:173], v[186:189], a[124:127], v[170:173]
s_mov_b32 s46, 9
.p2align 3
G_loop:
ds_read_b128 v[186:189], v210 offset:9216
ds_read_u16 v136, v217 offset:64
s_waitcnt lgkmcnt(9)
v_smfmac_f32_16x16x64_bf16 v[68:71], v[178:181], v[100:107], v207
ds_read_b128 v[100:103], v199 offset:64
ds_read_b128 v[104:107], v199 offset:80
v_mfma_f32_16x16x32_bf16 v[138:141], a[8:11], v[182:185], v[138:141]
v_add_u32 v217, 1408, v217
v_mfma_f32_16x16x32_bf16 v[142:145], a[32:35], v[182:185], v[142:145]
v_mfma_f32_16x16x32_bf16 v[146:149], a[56:59], v[182:185], v[146:149]
s_waitcnt lgkmcnt(8)
v_smfmac_f32_16x16x64_bf16 v[44:47], v[174:177], v[84:91], v207
v_mfma_f32_16x16x32_bf16 v[150:153], a[224:227], v[182:185], v[150:153]
v_mfma_f32_16x16x32_bf16 v[154:157], a[248:251], v[182:185], v[154:157]
v_mfma_f32_16x16x32_bf16 v[158:161], v[240:243], v[182:185], v[158:161]
s_waitcnt lgkmcnt(6)
s_nop 3
v_add_f32 v118, v118, v44
v_fmac_f32 v119, v44, v44
v_smfmac_f32_16x16x64_bf16 v[56:59], v[174:177], v[92:99], v207
v_add_f32 v118, v118, v45
v_fmac_f32 v119, v45, v45
v_mfma_f32_16x16x32_bf16 v[162:165], v[182:185], a[80:83], v[162:165]
v_add_f32 v118, v118, v46
v_fmac_f32 v119, v46, v46
v_mfma_f32_16x16x32_bf16 v[166:169], v[182:185], a[104:107], v[166:169]
v_add_f32 v118, v118, v47
v_fmac_f32 v119, v47, v47
v_mfma_f32_16x16x32_bf16 v[170:173], v[182:185], a[128:131], v[170:173]
s_waitcnt lgkmcnt(0)
ds_read_b128 v[182:185], v210 offset:10240
v_add_f32 v126, v126, v56
v_smfmac_f32_16x16x64_bf16 v[68:71], v[174:177], v[100:107], v207
v_fmac_f32 v127, v56, v56
v_add_f32 v126, v126, v57
v_mfma_f32_16x16x32_bf16 v[138:141], a[12:15], v[186:189], v[138:141]
v_fmac_f32 v127, v57, v57
v_add_f32 v126, v126, v58
v_mfma_f32_16x16x32_bf16 v[142:145], a[36:39], v[186:189], v[142:145]
v_fmac_f32 v127, v58, v58
v_add_f32 v126, v126, v59
v_mfma_f32_16x16x32_bf16 v[146:149], a[60:63], v[186:189], v[146:149]
v_fmac_f32 v127, v59, v59
v_add_f32 v134, v134, v68
v_mfma_f32_16x16x32_bf16 v[150:153], a[228:231], v[186:189], v[150:153]
v_fmac_f32 v135, v68, v68
v_add_f32 v134, v134, v69
v_mfma_f32_16x16x32_bf16 v[154:157], a[252:255], v[186:189], v[154:157]
v_fmac_f32 v135, v69, v69
v_add_f32 v134, v134, v70
v_mfma_f32_16x16x32_bf16 v[158:161], v[244:247], v[186:189], v[158:161]
v_fmac_f32 v135, v70, v70
v_add_f32 v134, v134, v71
v_mfma_f32_16x16x32_bf16 v[162:165], v[186:189], a[84:87], v[162:165]
v_permlane16_swap_b32 v118, v119
v_mfma_f32_16x16x32_bf16 v[166:169], v[186:189], a[108:111], v[166:169]
v_fmac_f32 v135, v71, v71
v_add_f32 v118, v118, v119
v_mfma_f32_16x16x32_bf16 v[170:173], v[186:189], a[132:135], v[170:173]
s_waitcnt lgkmcnt(0)
ds_read_b128 v[186:189], v210 offset:11264
v_permlane16_swap_b32 v126, v127
v_mfma_f32_16x16x32_bf16 v[138:141], a[16:19], v[182:185], v[138:141]
v_add_f32 v126, v126, v127
v_permlane16_swap_b32 v134, v135
v_mfma_f32_16x16x32_bf16 v[142:145], a[40:43], v[182:185], v[142:145]
v_add_f32 v134, v134, v135
v_permlane32_swap_b32 v118, v126
v_mfma_f32_16x16x32_bf16 v[146:149], a[64:67], v[182:185], v[146:149]
v_add_f32 v118, v118, v126
v_mov_b32 v135, v134
v_mfma_f32_16x16x32_bf16 v[150:153], a[232:235], v[182:185], v[150:153]
ds_write_b32 v213, v118
v_mfma_f32_16x16x32_bf16 v[154:157], v[224:227], v[182:185], v[154:157]
v_permlane32_swap_b32 v134, v135
v_mfma_f32_16x16x32_bf16 v[158:161], v[248:251], v[182:185], v[158:161]
v_add_f32 v134, v134, v135
v_mfma_f32_16x16x32_bf16 v[162:165], v[182:185], a[88:91], v[162:165]
ds_write_b32 v213, v134 offset:512
v_mfma_f32_16x16x32_bf16 v[166:169], v[182:185], a[112:115], v[166:169]
v_mfma_f32_16x16x32_bf16 v[170:173], v[182:185], a[136:139], v[170:173]
s_waitcnt lgkmcnt(2)
ds_read_b128 v[182:185], v210 offset:12288
v_mfma_f32_16x16x32_bf16 v[138:141], a[20:23], v[186:189], v[138:141]
v_mfma_f32_16x16x32_bf16 v[142:145], a[44:47], v[186:189], v[142:145]
v_mfma_f32_16x16x32_bf16 v[146:149], a[68:71], v[186:189], v[146:149]
v_mfma_f32_16x16x32_bf16 v[150:153], a[236:239], v[186:189], v[150:153]
s_nop 4
v_cvt_pk_bf16_f32 v96, v138, v139
v_cvt_pk_bf16_f32 v97, v140, v141
v_mfma_f32_16x16x32_bf16 v[154:157], v[228:231], v[186:189], v[154:157]
s_waitcnt lgkmcnt(1)
v_cvt_pk_bf16_f32 v98, v142, v143
v_cvt_pk_bf16_f32 v99, v144, v145
v_mfma_f32_16x16x32_bf16 v[158:161], v[252:255], v[186:189], v[158:161]
s_barrier
ds_read_b128 v[174:177], v210 offset:55296
v_mfma_f32_16x16x32_bf16 v[162:165], v[186:189], a[92:95], v[162:165]
ds_read_b128 v[178:181], v210 offset:56320
buffer_load_dwordx4 v209, s[4:7], s40 offen nt lds
v_mfma_f32_16x16x32_bf16 v[166:169], v[186:189], a[116:119], v[166:169]
s_add_u32 s40, s36, 196224
v_cvt_pk_bf16_f32 v100, v146, v147
v_cvt_pk_bf16_f32 v101, v148, v149
v_mfma_f32_16x16x32_bf16 v[170:173], v[186:189], a[140:143], v[170:173]
s_add_u32 m0, s45, 4112
ds_read_b128 v[186:189], v210 offset:13312
v_cvt_pk_bf16_f32 v84, v150, v151
s_waitcnt lgkmcnt(3)
v_mfma_f32_16x16x32_bf16 v[138:141], a[0:3], v[182:185], 0
v_cvt_pk_bf16_f32 v85, v152, v153
v_cvt_pk_bf16_f32 v86, v154, v155
v_mfma_f32_16x16x32_bf16 v[142:145], a[24:27], v[182:185], 0
buffer_load_dwordx4 v209, s[4:7], s40 offen nt lds
v_mfma_f32_16x16x32_bf16 v[146:149], a[48:51], v[182:185], 0
s_add_u32 s40, s36, 392448
v_cvt_pk_bf16_f32 v87, v156, v157
v_cvt_pk_bf16_f32 v88, v158, v159
v_mfma_f32_16x16x32_bf16 v[150:153], a[216:219], v[182:185], 0
s_add_u32 m0, s45, 8224
v_cvt_pk_bf16_f32 v89, v160, v161
v_cvt_pk_bf16_f32 v116, v162, v163
v_mfma_f32_16x16x32_bf16 v[154:157], a[240:243], v[182:185], 0
v_cvt_pk_bf16_f32 v117, v164, v165
v_cvt_pk_bf16_f32 v124, v166, v167
v_mfma_f32_16x16x32_bf16 v[158:161], v[232:235], v[182:185], 0
s_waitcnt lgkmcnt(2)
buffer_load_dwordx4 v209, s[4:7], s40 offen nt lds
v_mfma_f32_16x16x32_bf16 v[162:165], v[182:185], a[72:75], 0
s_add_u32 s40, s36, 588672
v_cvt_pk_bf16_f32 v125, v168, v169
v_cvt_pk_bf16_f32 v132, v170, v171
v_mfma_f32_16x16x32_bf16 v[166:169], v[182:185], a[96:99], 0
s_add_u32 m0, s45, 12336
v_cvt_pk_bf16_f32 v133, v172, v173
v_add_f32 v174, v174, v175
v_mfma_f32_16x16x32_bf16 v[170:173], v[182:185], a[120:123], 0
s_waitcnt lgkmcnt(0)
buffer_load_dwordx4 v209, s[4:7], s40 offen nt lds
v_mfma_f32_16x16x32_bf16 v[138:141], a[4:7], v[186:189], v[138:141]
s_add_u32 s40, s36, 784896
v_add_f32 v178, v178, v179
v_add_f32 v176, v176, v177
v_mfma_f32_16x16x32_bf16 v[142:145], a[28:31], v[186:189], v[142:145]
s_add_u32 m0, s45, 16448
v_add_f32 v180, v180, v181
v_add_f32 v174, v174, v176
v_mfma_f32_16x16x32_bf16 v[146:149], a[52:55], v[186:189], v[146:149]
buffer_load_dwordx4 v209, s[4:7], s40 offen nt lds
v_mfma_f32_16x16x32_bf16 v[150:153], a[220:223], v[186:189], v[150:153]
s_add_u32 s40, s36, 981120
v_add_f32 v178, v178, v180
v_mul_f32 v175, s48, v174
v_mfma_f32_16x16x32_bf16 v[154:157], a[244:247], v[186:189], v[154:157]
s_add_u32 m0, s45, 20560
ds_read_b128 v[182:185], v210 offset:14336
buffer_load_dwordx4 v209, s[4:7], s40 offen nt lds
v_mfma_f32_16x16x32_bf16 v[158:161], v[236:239], v[186:189], v[158:161]
s_add_u32 s40, s36, 1177344
v_mul_f32 v178, s48, v178
v_fma_f32 v178, -v175, v175, v178
v_mfma_f32_16x16x32_bf16 v[162:165], v[186:189], a[76:79], v[162:165]
s_add_u32 m0, s45, 24672
v_max_f32 v178, 0, v178
v_add_f32 v178, s49, v178
v_mfma_f32_16x16x32_bf16 v[166:169], v[186:189], a[100:103], v[166:169]
s_waitcnt lgkmcnt(0)
buffer_load_dwordx4 v209, s[4:7], s40 offen nt lds
v_mfma_f32_16x16x32_bf16 v[170:173], v[186:189], a[124:127], v[170:173]
s_add_u32 s40, s36, 1373568
v_rsq_f32 v174, v178
s_add_u32 m0, s45, 28784
v_mul_f32_e64 v175, -v175, v174
ds_write_b64 v214, v[174:175]
v_mfma_f32_16x16x32_bf16 v[138:141], a[8:11], v[182:185], v[138:141]
ds_read_b64 v[118:119], v215
ds_read_b64 v[126:127], v215 offset:128
v_mfma_f32_16x16x32_bf16 v[142:145], a[32:35], v[182:185], v[142:145]
ds_read_b64 v[134:135], v215 offset:256
buffer_load_dwordx4 v209, s[4:7], s40 offen nt lds
v_mfma_f32_16x16x32_bf16 v[146:149], a[56:59], v[182:185], v[146:149]
s_add_u32 s40, s36, 1569792
ds_read_b128 v[186:189], v210 offset:15360
s_add_u32 m0, s45, 32896
v_mfma_f32_16x16x32_bf16 v[150:153], a[224:227], v[182:185], v[150:153]
buffer_load_dwordx4 v209, s[4:7], s40 offen nt lds
v_mfma_f32_16x16x32_bf16 v[154:157], a[248:251], v[182:185], v[154:157]
v_mov_b32 v181, 0
v_mfma_f32_16x16x32_bf16 v[158:161], v[240:243], v[182:185], v[158:161]
s_waitcnt lgkmcnt(3)
v_fma_f32 v108, v36, v118, v119
v_fma_f32 v109, v37, v118, v119
v_mfma_f32_16x16x32_bf16 v[162:165], v[182:185], a[80:83], v[162:165]
v_cvt_pk_bf16_f32 v90, v108, v109
v_fma_f32 v110, v38, v118, v119
v_mfma_f32_16x16x32_bf16 v[166:169], v[182:185], a[104:107], v[166:169]
v_fma_f32 v111, v39, v118, v119
v_cvt_pk_bf16_f32 v91, v110, v111
v_mfma_f32_16x16x32_bf16 v[170:173], v[182:185], a[128:131], v[170:173]
s_waitcnt lgkmcnt(0)
v_fma_f32 v112, v40, v118, v119
v_fma_f32 v113, v41, v118, v119
v_mfma_f32_16x16x32_bf16 v[138:141], a[12:15], v[186:189], v[138:141]
v_cvt_pk_bf16_f32 v92, v112, v113
v_fma_f32 v108, v42, v118, v119
v_mfma_f32_16x16x32_bf16 v[142:145], a[36:39], v[186:189], v[142:145]
v_fma_f32 v109, v43, v118, v119
v_cvt_pk_bf16_f32 v93, v108, v109
v_mfma_f32_16x16x32_bf16 v[146:149], a[60:63], v[186:189], v[146:149]
ds_write_b128 v211, v[90:93] offset:18432
v_mfma_f32_16x16x32_bf16 v[150:153], a[228:231], v[186:189], v[150:153]
ds_read_b128 v[182:185], v210 offset:16384
v_fma_f32 v110, v44, v118, v119
v_mfma_f32_16x16x32_bf16 v[154:157], a[252:255], v[186:189], v[154:157]
v_fma_f32 v111, v45, v118, v119
v_cvt_pk_bf16_f32 v94, v110, v111
v_mfma_f32_16x16x32_bf16 v[158:161], v[244:247], v[186:189], v[158:161]
v_fma_f32 v112, v46, v118, v119
v_fma_f32 v113, v47, v118, v119
v_mfma_f32_16x16x32_bf16 v[162:165], v[186:189], a[84:87], v[162:165]
v_cvt_pk_bf16_f32 v95, v112, v113
v_fma_f32 v108, v48, v126, v127
v_mfma_f32_16x16x32_bf16 v[166:169], v[186:189], a[108:111], v[166:169]
ds_write_b64 v212, v[94:95] offset:18432
v_mfma_f32_16x16x32_bf16 v[170:173], v[186:189], a[132:135], v[170:173]
v_fma_f32 v109, v49, v126, v127
v_cvt_pk_bf16_f32 v102, v108, v109
v_fma_f32 v110, v50, v126, v127
v_fma_f32 v111, v51, v126, v127
v_cvt_pk_bf16_f32 v103, v110, v111
v_fma_f32 v112, v52, v126, v127
v_fma_f32 v113, v53, v126, v127
v_cvt_pk_bf16_f32 v104, v112, v113
v_fma_f32 v108, v54, v126, v127
v_fma_f32 v109, v55, v126, v127
s_waitcnt lgkmcnt(1)
v_mfma_f32_16x16x32_bf16 v[138:141], a[16:19], v[182:185], v[138:141]
ds_read_b128 v[186:189], v210 offset:17408
v_cvt_pk_bf16_f32 v105, v108, v109
v_mfma_f32_16x16x32_bf16 v[142:145], a[40:43], v[182:185], v[142:145]
ds_write_b128 v211, v[102:105] offset:24576
v_mfma_f32_16x16x32_bf16 v[146:149], a[64:67], v[182:185], v[146:149]
v_fma_f32 v110, v56, v126, v127
v_fma_f32 v111, v57, v126, v127
v_mfma_f32_16x16x32_bf16 v[150:153], a[232:235], v[182:185], v[150:153]
v_cvt_pk_bf16_f32 v106, v110, v111
v_fma_f32 v112, v58, v126, v127
v_mfma_f32_16x16x32_bf16 v[154:157], v[224:227], v[182:185], v[154:157]
v_fma_f32 v113, v59, v126, v127
v_cvt_pk_bf16_f32 v107, v112, v113
v_mfma_f32_16x16x32_bf16 v[158:161], v[248:251], v[182:185], v[158:161]
ds_write_b64 v212, v[106:107] offset:24576
v_mfma_f32_16x16x32_bf16 v[162:165], v[182:185], a[88:91], v[162:165]
v_fma_f32 v108, v60, v134, v135
v_fma_f32 v109, v61, v134, v135
v_mfma_f32_16x16x32_bf16 v[166:169], v[182:185], a[112:115], v[166:169]
v_cvt_pk_bf16_f32 v90, v108, v109
v_fma_f32 v110, v62, v134, v135
v_mfma_f32_16x16x32_bf16 v[170:173], v[182:185], a[136:139], v[170:173]
s_waitcnt lgkmcnt(2)
v_fma_f32 v111, v63, v134, v135
v_cvt_pk_bf16_f32 v91, v110, v111
v_mfma_f32_16x16x32_bf16 v[138:141], a[20:23], v[186:189], v[138:141]
v_fma_f32 v112, v64, v134, v135
v_fma_f32 v113, v65, v134, v135
v_mfma_f32_16x16x32_bf16 v[142:145], a[44:47], v[186:189], v[142:145]
v_cvt_pk_bf16_f32 v92, v112, v113
v_fma_f32 v108, v66, v134, v135
v_mfma_f32_16x16x32_bf16 v[146:149], a[68:71], v[186:189], v[146:149]
v_fma_f32 v109, v67, v134, v135
v_cvt_pk_bf16_f32 v93, v108, v109
v_mfma_f32_16x16x32_bf16 v[150:153], a[236:239], v[186:189], v[150:153]
ds_write_b128 v211, v[90:93] offset:30720
v_mfma_f32_16x16x32_bf16 v[154:157], v[228:231], v[186:189], v[154:157]
v_fma_f32 v110, v68, v134, v135
v_fma_f32 v111, v69, v134, v135
v_mfma_f32_16x16x32_bf16 v[158:161], v[252:255], v[186:189], v[158:161]
v_cvt_pk_bf16_f32 v94, v110, v111
v_fma_f32 v112, v70, v134, v135
v_mfma_f32_16x16x32_bf16 v[162:165], v[186:189], a[92:95], v[162:165]
ds_read_b128 v[108:111], v216 offset:512
v_fma_f32 v113, v71, v134, v135
v_mfma_f32_16x16x32_bf16 v[166:169], v[186:189], a[116:119], v[166:169]
v_cvt_pk_bf16_f32 v95, v112, v113
v_cvt_pk_bf16_f32 v102, v138, v139
v_mfma_f32_16x16x32_bf16 v[170:173], v[186:189], a[140:143], v[170:173]
ds_read_b64 v[112:113], v216 offset:528
ds_write_b64 v212, v[94:95] offset:30720
v_cvt_pk_bf16_f32 v103, v140, v141
v_mfma_f32_16x16x32_bf16 v[138:141], v[78:81], v[72:75], 0
v_cvt_pk_bf16_f32 v104, v142, v143
v_cvt_pk_bf16_f32 v105, v144, v145
v_mfma_f32_16x16x32_bf16 v[142:145], v[96:99], v[72:75], 0
v_cvt_pk_bf16_f32 v106, v146, v147
v_cvt_pk_bf16_f32 v107, v148, v149
v_mfma_f32_16x16x32_bf16 v[146:149], v[102:105], v[72:75], 0
s_waitcnt lgkmcnt(2)
v_cvt_pk_bf16_f32 v90, v150, v151
v_cvt_pk_bf16_f32 v91, v152, v153
v_mfma_f32_16x16x32_bf16 v[150:153], v[108:111], v[72:75], v[206:209]
ds_read_b128 v[72:75], v216
v_cvt_pk_bf16_f32 v92, v154, v155
v_mfma_f32_16x16x16_bf16 v[138:141], v[82:83], v[76:77], v[138:141]
v_cvt_pk_bf16_f32 v93, v156, v157
v_cvt_pk_bf16_f32 v94, v158, v159
v_mfma_f32_16x16x16_bf16 v[142:145], v[100:101], v[76:77], v[142:145]
s_waitcnt lgkmcnt(2)
v_cvt_pk_bf16_f32 v95, v160, v161
v_cvt_pk_bf16_f32 v118, v162, v163
v_mfma_f32_16x16x16_bf16 v[150:153], v[112:113], v[76:77], v[150:153]
v_cvt_pk_bf16_f32 v119, v164, v165
v_cvt_pk_bf16_f32 v126, v166, v167
v_mfma_f32_16x16x16_bf16 v[146:149], v[106:107], v[76:77], v[146:149]
ds_read_b64 v[76:77], v216 offset:16
v_cvt_pk_bf16_f32 v127, v168, v169
v_mfma_f32_16x16x32_bf16 v[154:157], v[78:81], v[84:87], 0
v_cvt_pk_bf16_f32 v134, v170, v171
v_cvt_pk_bf16_f32 v135, v172, v173
v_mfma_f32_16x16x32_bf16 v[158:161], v[96:99], v[84:87], 0
v_max3_f32 v220, v138, v139, v140
v_max3_f32 v220, v220, v141, v142
v_mfma_f32_16x16x32_bf16 v[166:169], v[108:111], v[84:87], v[206:209]
v_max3_f32 v220, v220, v143, v144
v_max3_f32 v220, v220, v145, v146
v_mfma_f32_16x16x32_bf16 v[162:165], v[102:105], v[84:87], 0
v_max3_f32 v220, v220, v147, v148
v_max3_f32 v220, v220, v149, v150
v_mfma_f32_16x16x16_bf16 v[154:157], v[82:83], v[88:89], v[154:157]
v_mov_b32 v221, v220
v_mfma_f32_16x16x16_bf16 v[158:161], v[100:101], v[88:89], v[158:161]
s_nop 0
v_permlane16_swap_b32 v220, v221
v_mfma_f32_16x16x16_bf16 v[166:169], v[112:113], v[88:89], v[166:169]
v_max_f32 v220, v220, v221
v_mov_b32 v221, v220
v_mfma_f32_16x16x16_bf16 v[162:165], v[106:107], v[88:89], v[162:165]
s_nop 0
v_permlane32_swap_b32 v220, v221
v_max_f32 v220, v220, v221
v_sub_f32 v138, v138, v220
v_sub_f32 v139, v139, v220
v_sub_f32 v140, v140, v220
v_sub_f32 v141, v141, v220
v_sub_f32 v142, v142, v220
v_sub_f32 v143, v143, v220
v_sub_f32 v144, v144, v220
v_sub_f32 v145, v145, v220
v_sub_f32 v150, v150, v220
v_sub_f32 v146, v146, v220
v_sub_f32 v147, v147, v220
v_sub_f32 v148, v148, v220
v_sub_f32 v149, v149, v220
v_exp_f32 v138, v138
v_exp_f32 v139, v139
v_exp_f32 v140, v140
v_exp_f32 v141, v141
v_exp_f32 v142, v142
v_exp_f32 v143, v143
v_exp_f32 v144, v144
v_exp_f32 v145, v145
v_exp_f32 v150, v150
v_exp_f32 v146, v146
v_exp_f32 v147, v147
v_exp_f32 v148, v148
v_exp_f32 v149, v149
v_cvt_pk_bf16_f32 v174, v138, v139
v_cvt_pk_bf16_f32 v175, v140, v141
v_cvt_pk_bf16_f32 v176, v142, v143
v_cvt_pk_bf16_f32 v177, v144, v145
v_cvt_pk_bf16_f32 v178, v146, v147
v_cvt_pk_bf16_f32 v179, v148, v149
v_mfma_f32_16x16x32_bf16 v[138:141], v[114:117], v[174:177], 0
v_cvt_pk_bf16_f32 v180, v150, 0
v_max3_f32 v220, v154, v155, v156
v_mfma_f32_16x16x32_bf16 v[150:153], v[190:193], v[174:177], 0
v_max3_f32 v220, v220, v157, v158
v_max3_f32 v220, v220, v159, v160
v_mfma_f32_16x16x32_bf16 v[142:145], v[122:125], v[174:177], 0
v_max3_f32 v220, v220, v161, v162
v_max3_f32 v220, v220, v163, v164
v_mfma_f32_16x16x32_bf16 v[146:149], v[130:133], v[174:177], 0
v_max3_f32 v220, v220, v165, v166
v_mov_b32 v221, v220
v_mfma_f32_16x16x32_bf16 v[150:153], v[190:193], v[178:181], v[150:153]
s_nop 0
v_permlane16_swap_b32 v220, v221
v_mfma_f32_16x16x32_bf16 v[138:141], v[118:121], v[178:181], v[138:141]
v_max_f32 v220, v220, v221
v_mov_b32 v221, v220
v_mfma_f32_16x16x32_bf16 v[142:145], v[126:129], v[178:181], v[142:145]
s_nop 0
v_permlane32_swap_b32 v220, v221
v_mfma_f32_16x16x32_bf16 v[146:149], v[134:137], v[178:181], v[146:149]
v_max_f32 v220, v220, v221
v_sub_f32 v154, v154, v220
v_sub_f32 v155, v155, v220
v_sub_f32 v156, v156, v220
v_sub_f32 v157, v157, v220
v_sub_f32 v158, v158, v220
v_sub_f32 v159, v159, v220
v_sub_f32 v160, v160, v220
v_sub_f32 v161, v161, v220
v_sub_f32 v166, v166, v220
v_sub_f32 v162, v162, v220
v_sub_f32 v163, v163, v220
v_sub_f32 v164, v164, v220
v_sub_f32 v165, v165, v220
v_exp_f32 v154, v154
v_exp_f32 v155, v155
v_exp_f32 v156, v156
v_exp_f32 v157, v157
v_exp_f32 v158, v158
v_exp_f32 v159, v159
v_exp_f32 v160, v160
v_exp_f32 v161, v161
v_exp_f32 v166, v166
v_exp_f32 v162, v162
v_exp_f32 v163, v163
v_exp_f32 v164, v164
v_exp_f32 v165, v165
v_cvt_pk_bf16_f32 v174, v154, v155
v_cvt_pk_bf16_f32 v175, v156, v157
v_cvt_pk_bf16_f32 v176, v158, v159
v_cvt_pk_bf16_f32 v177, v160, v161
v_cvt_pk_bf16_f32 v178, v162, v163
v_cvt_pk_bf16_f32 v179, v164, v165
v_mfma_f32_16x16x32_bf16 v[154:157], v[114:117], v[174:177], 0
s_mov_b32 s39, s37
v_cvt_pk_bf16_f32 v180, v166, 0
v_rcp_f32 v151, v150
v_mfma_f32_16x16x32_bf16 v[166:169], v[190:193], v[174:177], 0
v_mul_f32 v138, v138, v151
v_mul_f32 v139, v139, v151
v_mfma_f32_16x16x32_bf16 v[158:161], v[122:125], v[174:177], 0
v_cvt_pk_bf16_f32 v138, v138, v139
v_mul_f32 v140, v140, v151
v_mfma_f32_16x16x32_bf16 v[162:165], v[130:133], v[174:177], 0
v_mul_f32 v141, v141, v151
v_cvt_pk_bf16_f32 v139, v140, v141
v_mfma_f32_16x16x32_bf16 v[166:169], v[190:193], v[178:181], v[166:169]
v_mul_f32 v142, v142, v151
v_mul_f32 v143, v143, v151
v_mfma_f32_16x16x32_bf16 v[154:157], v[118:121], v[178:181], v[154:157]
v_cvt_pk_bf16_f32 v140, v142, v143
v_mul_f32 v144, v144, v151
v_mfma_f32_16x16x32_bf16 v[158:161], v[126:129], v[178:181], v[158:161]
v_mul_f32 v145, v145, v151
v_cvt_pk_bf16_f32 v141, v144, v145
v_mfma_f32_16x16x32_bf16 v[162:165], v[134:137], v[178:181], v[162:165]
ds_write_b128 v211, v[138:141] offset:36864
v_mfma_f32_16x16x32_bf16 v[138:141], v[78:81], v[90:93], 0
v_mul_f32 v146, v146, v151
v_mul_f32 v147, v147, v151
v_cvt_pk_bf16_f32 v142, v146, v147
v_mul_f32 v148, v148, v151
v_mul_f32 v149, v149, v151
v_mfma_f32_16x16x32_bf16 v[150:153], v[108:111], v[90:93], v[206:209]
v_cvt_pk_bf16_f32 v143, v148, v149
v_rcp_f32 v167, v166
v_mfma_f32_16x16x32_bf16 v[146:149], v[102:105], v[90:93], 0
ds_write_b64 v212, v[142:143] offset:36864
v_mfma_f32_16x16x32_bf16 v[142:145], v[96:99], v[90:93], 0
v_mul_f32 v154, v154, v167
v_mul_f32 v155, v155, v167
v_mfma_f32_16x16x16_bf16 v[138:141], v[82:83], v[94:95], v[138:141]
v_cvt_pk_bf16_f32 v154, v154, v155
v_mul_f32 v156, v156, v167
v_mfma_f32_16x16x16_bf16 v[150:153], v[112:113], v[94:95], v[150:153]
v_mul_f32 v157, v157, v167
v_cvt_pk_bf16_f32 v155, v156, v157
v_mfma_f32_16x16x16_bf16 v[142:145], v[100:101], v[94:95], v[142:145]
v_mul_f32 v158, v158, v167
v_mul_f32 v159, v159, v167
v_mfma_f32_16x16x16_bf16 v[146:149], v[106:107], v[94:95], v[146:149]
s_waitcnt lgkmcnt(3)
v_cvt_pk_bf16_f32 v156, v158, v159
v_mul_f32 v160, v160, v167
v_mul_f32 v161, v161, v167
v_cvt_pk_bf16_f32 v157, v160, v161
v_mul_f32 v162, v162, v167
v_mul_f32 v163, v163, v167
v_cvt_pk_bf16_f32 v158, v162, v163
v_mul_f32 v164, v164, v167
v_mul_f32 v165, v165, v167
v_mfma_f32_16x16x32_bf16 v[166:169], v[108:111], v[72:75], v[206:209]
ds_write_b128 v211, v[154:157] offset:43008
v_mfma_f32_16x16x32_bf16 v[154:157], v[78:81], v[72:75], 0
v_cvt_pk_bf16_f32 v159, v164, v165
v_max3_f32 v220, v138, v139, v140
v_mfma_f32_16x16x32_bf16 v[162:165], v[102:105], v[72:75], 0
ds_write_b64 v212, v[158:159] offset:43008
v_mfma_f32_16x16x32_bf16 v[158:161], v[96:99], v[72:75], 0
s_waitcnt lgkmcnt(4)
v_max3_f32 v220, v220, v141, v142
v_max3_f32 v220, v220, v143, v144
v_mfma_f32_16x16x16_bf16 v[154:157], v[82:83], v[76:77], v[154:157]
v_max3_f32 v220, v220, v145, v146
v_max3_f32 v220, v220, v147, v148
v_mfma_f32_16x16x16_bf16 v[166:169], v[112:113], v[76:77], v[166:169]
v_max3_f32 v220, v220, v149, v150
v_mov_b32 v221, v220
v_mfma_f32_16x16x16_bf16 v[158:161], v[100:101], v[76:77], v[158:161]
s_nop 0
v_permlane16_swap_b32 v220, v221
v_mfma_f32_16x16x16_bf16 v[162:165], v[106:107], v[76:77], v[162:165]
v_max_f32 v220, v220, v221
v_mov_b32 v221, v220
s_nop 1
v_permlane32_swap_b32 v220, v221
v_max_f32 v220, v220, v221
v_sub_f32 v138, v138, v220
v_sub_f32 v139, v139, v220
v_sub_f32 v140, v140, v220
v_sub_f32 v141, v141, v220
v_sub_f32 v142, v142, v220
v_sub_f32 v143, v143, v220
v_sub_f32 v144, v144, v220
v_sub_f32 v145, v145, v220
v_sub_f32 v150, v150, v220
v_sub_f32 v146, v146, v220
v_sub_f32 v147, v147, v220
v_sub_f32 v148, v148, v220
v_sub_f32 v149, v149, v220
v_exp_f32 v138, v138
s_waitcnt lgkmcnt(0)
s_barrier
ds_read_b128 v[170:173], v210 offset:36864
ds_read_b128 v[182:185], v210 offset:37888
ds_read_b128 v[186:189], v210 offset:38912
v_exp_f32 v139, v139
v_exp_f32 v140, v140
v_exp_f32 v141, v141
v_exp_f32 v142, v142
v_exp_f32 v143, v143
v_exp_f32 v144, v144
v_exp_f32 v145, v145
v_exp_f32 v150, v150
v_exp_f32 v146, v146
v_exp_f32 v147, v147
v_exp_f32 v148, v148
s_waitcnt lgkmcnt(2)
v_mfma_f32_16x16x32_bf16 v[0:3], a[144:147], v[170:173], v[0:3]
v_exp_f32 v149, v149
v_mfma_f32_16x16x32_bf16 v[4:7], a[168:171], v[170:173], v[4:7]
v_cvt_pk_bf16_f32 v174, v138, v139
v_cvt_pk_bf16_f32 v175, v140, v141
v_mfma_f32_16x16x32_bf16 v[8:11], a[192:195], v[170:173], v[8:11]
s_waitcnt lgkmcnt(1)
ds_read_b128 v[170:173], v210 offset:39936
v_cvt_pk_bf16_f32 v176, v142, v143
v_mfma_f32_16x16x32_bf16 v[0:3], a[148:151], v[182:185], v[0:3]
v_cvt_pk_bf16_f32 v177, v144, v145
v_cvt_pk_bf16_f32 v178, v146, v147
v_mfma_f32_16x16x32_bf16 v[4:7], a[172:175], v[182:185], v[4:7]
v_cvt_pk_bf16_f32 v179, v148, v149
v_cvt_pk_bf16_f32 v180, v150, 0
v_mfma_f32_16x16x32_bf16 v[8:11], a[196:199], v[182:185], v[8:11]
s_waitcnt lgkmcnt(1)
ds_read_b128 v[182:185], v210 offset:40960
v_max3_f32 v220, v154, v155, v156
v_mfma_f32_16x16x32_bf16 v[0:3], a[152:155], v[186:189], v[0:3]
v_max3_f32 v220, v220, v157, v158
v_max3_f32 v220, v220, v159, v160
v_mfma_f32_16x16x32_bf16 v[4:7], a[176:179], v[186:189], v[4:7]
v_max3_f32 v220, v220, v161, v162
v_max3_f32 v220, v220, v163, v164
v_mfma_f32_16x16x32_bf16 v[8:11], a[200:203], v[186:189], v[8:11]
s_waitcnt lgkmcnt(1)
ds_read_b128 v[186:189], v210 offset:41984
v_max3_f32 v220, v220, v165, v166
v_mfma_f32_16x16x32_bf16 v[0:3], a[156:159], v[170:173], v[0:3]
v_mov_b32 v221, v220
v_mfma_f32_16x16x32_bf16 v[4:7], a[180:183], v[170:173], v[4:7]
s_nop 0
v_permlane16_swap_b32 v220, v221
v_mfma_f32_16x16x32_bf16 v[8:11], a[204:207], v[170:173], v[8:11]
s_waitcnt lgkmcnt(1)
ds_read_b128 v[170:173], v210 offset:43008
v_max_f32 v220, v220, v221
v_mfma_f32_16x16x32_bf16 v[0:3], a[160:163], v[182:185], v[0:3]
v_mov_b32 v221, v220
v_mfma_f32_16x16x32_bf16 v[4:7], a[184:187], v[182:185], v[4:7]
s_nop 0
v_permlane32_swap_b32 v220, v221
v_mfma_f32_16x16x32_bf16 v[8:11], a[208:211], v[182:185], v[8:11]
ds_read_b128 v[182:185], v210 offset:44032
v_max_f32 v220, v220, v221
v_mfma_f32_16x16x32_bf16 v[150:153], v[190:193], v[174:177], 0
v_sub_f32 v154, v154, v220
v_sub_f32 v155, v155, v220
v_mfma_f32_16x16x32_bf16 v[138:141], v[114:117], v[174:177], 0
v_sub_f32 v156, v156, v220
v_sub_f32 v157, v157, v220
v_mfma_f32_16x16x32_bf16 v[142:145], v[122:125], v[174:177], 0
v_sub_f32 v158, v158, v220
v_sub_f32 v159, v159, v220
v_mfma_f32_16x16x32_bf16 v[146:149], v[130:133], v[174:177], 0
s_waitcnt lgkmcnt(2)
v_sub_f32 v160, v160, v220
v_sub_f32 v161, v161, v220
v_mfma_f32_16x16x32_bf16 v[0:3], a[164:167], v[186:189], v[0:3]
v_sub_f32 v166, v166, v220
v_sub_f32 v162, v162, v220
v_mfma_f32_16x16x32_bf16 v[150:153], v[190:193], v[178:181], v[150:153]
v_sub_f32 v163, v163, v220
v_sub_f32 v164, v164, v220
v_mfma_f32_16x16x32_bf16 v[138:141], v[118:121], v[178:181], v[138:141]
v_sub_f32 v165, v165, v220
v_exp_f32 v154, v154
v_mfma_f32_16x16x32_bf16 v[4:7], a[188:191], v[186:189], v[4:7]
v_cvt_pk_bf16_f32 v0, v0, v1
v_cvt_pk_bf16_f32 v1, v2, v3
v_mfma_f32_16x16x32_bf16 v[142:145], v[126:129], v[178:181], v[142:145]
buffer_store_dwordx2 v[0:1], v203, s[8:11], s38 offen
v_mfma_f32_16x16x32_bf16 v[8:11], a[212:215], v[186:189], v[8:11]
ds_read_b128 v[186:189], v210 offset:45056
v_exp_f32 v155, v155
v_mfma_f32_16x16x32_bf16 v[146:149], v[134:137], v[178:181], v[146:149]
s_waitcnt lgkmcnt(2)
v_cvt_pk_bf16_f32 v4, v4, v5
v_cvt_pk_bf16_f32 v5, v6, v7
v_mfma_f32_16x16x32_bf16 v[12:15], a[144:147], v[170:173], v[12:15]
buffer_store_dwordx2 v[4:5], v203, s[8:11], s38 offen offset:32
v_mfma_f32_16x16x32_bf16 v[16:19], a[168:171], v[170:173], v[16:19]
v_cvt_pk_bf16_f32 v8, v8, v9
v_exp_f32 v156, v156
v_mfma_f32_16x16x32_bf16 v[20:23], a[192:195], v[170:173], v[20:23]
s_waitcnt lgkmcnt(1)
ds_read_b128 v[170:173], v210 offset:46080
v_cvt_pk_bf16_f32 v9, v10, v11
v_mfma_f32_16x16x32_bf16 v[12:15], a[148:151], v[182:185], v[12:15]
buffer_store_dwordx2 v[8:9], v203, s[8:11], s38 offen offset:64
v_mfma_f32_16x16x32_bf16 v[16:19], a[172:175], v[182:185], v[16:19]
v_exp_f32 v157, v157
v_mfma_f32_16x16x32_bf16 v[20:23], a[196:199], v[182:185], v[20:23]
s_waitcnt lgkmcnt(1)
ds_read_b128 v[182:185], v210 offset:47104
v_exp_f32 v158, v158
v_mfma_f32_16x16x32_bf16 v[12:15], a[152:155], v[186:189], v[12:15]
v_exp_f32 v159, v159
v_mfma_f32_16x16x32_bf16 v[16:19], a[176:179], v[186:189], v[16:19]
v_exp_f32 v160, v160
v_mfma_f32_16x16x32_bf16 v[20:23], a[200:203], v[186:189], v[20:23]
s_waitcnt lgkmcnt(1)
ds_read_b128 v[186:189], v210 offset:48128
v_exp_f32 v161, v161
v_mfma_f32_16x16x32_bf16 v[12:15], a[156:159], v[170:173], v[12:15]
v_exp_f32 v166, v166
v_mfma_f32_16x16x32_bf16 v[16:19], a[180:183], v[170:173], v[16:19]
v_exp_f32 v162, v162
v_mfma_f32_16x16x32_bf16 v[20:23], a[204:207], v[170:173], v[20:23]
s_waitcnt lgkmcnt(1)
v_exp_f32 v163, v163
v_mfma_f32_16x16x32_bf16 v[12:15], a[160:163], v[182:185], v[12:15]
v_exp_f32 v164, v164
v_mfma_f32_16x16x32_bf16 v[16:19], a[184:187], v[182:185], v[16:19]
v_exp_f32 v165, v165
v_mfma_f32_16x16x32_bf16 v[20:23], a[208:211], v[182:185], v[20:23]
s_waitcnt lgkmcnt(0)
v_cvt_pk_bf16_f32 v174, v154, v155
v_cvt_pk_bf16_f32 v175, v156, v157
v_mfma_f32_16x16x32_bf16 v[12:15], a[164:167], v[186:189], v[12:15]
v_cvt_pk_bf16_f32 v176, v158, v159
v_cvt_pk_bf16_f32 v177, v160, v161
v_mfma_f32_16x16x32_bf16 v[16:19], a[188:191], v[186:189], v[16:19]
v_cvt_pk_bf16_f32 v178, v162, v163
v_cvt_pk_bf16_f32 v179, v164, v165
v_mfma_f32_16x16x32_bf16 v[154:157], v[114:117], v[174:177], 0
v_cvt_pk_bf16_f32 v180, v166, 0
v_rcp_f32 v151, v150
v_mfma_f32_16x16x32_bf16 v[166:169], v[190:193], v[174:177], 0
v_mul_f32 v138, v138, v151
v_mul_f32 v139, v139, v151
v_mfma_f32_16x16x32_bf16 v[158:161], v[122:125], v[174:177], 0
v_cvt_pk_bf16_f32 v138, v138, v139
v_mul_f32 v140, v140, v151
v_mfma_f32_16x16x32_bf16 v[162:165], v[130:133], v[174:177], 0
v_mul_f32 v141, v141, v151
v_cvt_pk_bf16_f32 v139, v140, v141
v_mfma_f32_16x16x32_bf16 v[166:169], v[190:193], v[178:181], v[166:169]
v_mul_f32 v142, v142, v151
v_mul_f32 v143, v143, v151
v_mfma_f32_16x16x32_bf16 v[154:157], v[118:121], v[178:181], v[154:157]
v_cvt_pk_bf16_f32 v140, v142, v143
v_mul_f32 v144, v144, v151
v_mfma_f32_16x16x32_bf16 v[158:161], v[126:129], v[178:181], v[158:161]
v_mul_f32 v145, v145, v151
v_cvt_pk_bf16_f32 v141, v144, v145
v_mfma_f32_16x16x32_bf16 v[20:23], a[212:215], v[186:189], v[20:23]
ds_write_b128 v211, v[138:141] offset:49152
v_mfma_f32_16x16x32_bf16 v[162:165], v[134:137], v[178:181], v[162:165]
v_mul_f32 v146, v146, v151
v_mul_f32 v147, v147, v151
v_cvt_pk_bf16_f32 v142, v146, v147
v_mul_f32 v148, v148, v151
v_mul_f32 v149, v149, v151
v_cvt_pk_bf16_f32 v143, v148, v149
v_rcp_f32 v167, v166
ds_write_b64 v212, v[142:143] offset:49152
v_mul_f32 v154, v154, v167
v_mul_f32 v155, v155, v167
v_cvt_pk_bf16_f32 v154, v154, v155
v_mul_f32 v156, v156, v167
v_mul_f32 v157, v157, v167
v_cvt_pk_bf16_f32 v155, v156, v157
v_mul_f32 v158, v158, v167
v_mul_f32 v159, v159, v167
v_cvt_pk_bf16_f32 v156, v158, v159
v_mul_f32 v160, v160, v167
v_mul_f32 v161, v161, v167
v_cvt_pk_bf16_f32 v157, v160, v161
v_mul_f32 v162, v162, v167
v_mul_f32 v163, v163, v167
v_cvt_pk_bf16_f32 v158, v162, v163
v_mul_f32 v164, v164, v167
v_mul_f32 v165, v165, v167
v_cvt_pk_bf16_f32 v159, v164, v165
v_cvt_pk_bf16_f32 v12, v12, v13
v_cvt_pk_bf16_f32 v13, v14, v15
v_cvt_pk_bf16_f32 v16, v16, v17
v_cvt_pk_bf16_f32 v17, v18, v19
v_cvt_pk_bf16_f32 v20, v20, v21
ds_write_b128 v216, v[154:157]
ds_write_b64 v216, v[158:159] offset:16
buffer_store_dwordx2 v[12:13], v204, s[8:11], s38 offen
buffer_store_dwordx2 v[16:17], v204, s[8:11], s38 offen offset:32
v_add_u32 v216, 1408, v216
v_cvt_pk_bf16_f32 v21, v22, v23
s_waitcnt vmcnt(5) lgkmcnt(2)
s_barrier
ds_read_b128 v[170:173], v210 offset:49152
ds_read_b128 v[182:185], v210 offset:50176
ds_read_b128 v[186:189], v210 offset:51200
buffer_store_dwordx2 v[20:21], v204, s[8:11], s38 offen offset:64
ds_read_b128 v[174:177], v218
ds_read_b128 v[178:181], v218 offset:528
s_barrier
ds_read_b128 v[84:87], v200
ds_read_b128 v[92:95], v201
ds_read_b128 v[100:103], v202
ds_read_b128 v[88:91], v194 offset:16
ds_read_b128 v[96:99], v195 offset:16
ds_read_b128 v[104:107], v196 offset:16
s_waitcnt lgkmcnt(10)
v_mfma_f32_16x16x32_bf16 v[24:27], a[144:147], v[170:173], v[24:27]
v_mfma_f32_16x16x32_bf16 v[28:31], a[168:171], v[170:173], v[28:31]
v_mfma_f32_16x16x32_bf16 v[32:35], a[192:195], v[170:173], v[32:35]
s_waitcnt lgkmcnt(9)
ds_read_b128 v[170:173], v210 offset:52224
v_mfma_f32_16x16x32_bf16 v[24:27], a[148:151], v[182:185], v[24:27]
v_mfma_f32_16x16x32_bf16 v[28:31], a[172:175], v[182:185], v[28:31]
v_mfma_f32_16x16x32_bf16 v[32:35], a[196:199], v[182:185], v[32:35]
s_waitcnt lgkmcnt(9)
ds_read_b128 v[182:185], v210 offset:53248
v_mfma_f32_16x16x32_bf16 v[24:27], a[152:155], v[186:189], v[24:27]
v_mfma_f32_16x16x32_bf16 v[28:31], a[176:179], v[186:189], v[28:31]
v_mfma_f32_16x16x32_bf16 v[32:35], a[200:203], v[186:189], v[32:35]
s_waitcnt lgkmcnt(7)
ds_read_b128 v[186:189], v210 offset:54272
v_mfma_f32_16x16x32_bf16 v[0:3], v[174:177], v[84:87], 0
s_waitcnt lgkmcnt(7)
ds_read_b128 v[84:87], v194
v_mfma_f32_16x16x32_bf16 v[12:15], v[174:177], v[92:95], 0
s_waitcnt lgkmcnt(3)
ds_read_b128 v[92:95], v195
v_mfma_f32_16x16x32_bf16 v[24:27], a[156:159], v[170:173], v[24:27]
v_mfma_f32_16x16x32_bf16 v[28:31], a[180:183], v[170:173], v[28:31]
v_mfma_f32_16x16x32_bf16 v[32:35], a[204:207], v[170:173], v[32:35]
s_waitcnt lgkmcnt(3)
v_mfma_f32_16x16x32_bf16 v[24:27], a[160:163], v[182:185], v[24:27]
v_mfma_f32_16x16x32_bf16 v[28:31], a[184:187], v[182:185], v[28:31]
v_mfma_f32_16x16x32_bf16 v[32:35], a[208:211], v[182:185], v[32:35]
s_waitcnt lgkmcnt(2)
ds_read_b128 v[182:185], v210 offset:18432
v_mfma_f32_16x16x32_bf16 v[24:27], a[164:167], v[186:189], v[24:27]
v_mfma_f32_16x16x32_bf16 v[28:31], a[188:191], v[186:189], v[28:31]
v_mfma_f32_16x16x32_bf16 v[32:35], a[212:215], v[186:189], v[32:35]
s_waitcnt lgkmcnt(2)
ds_read_b128 v[186:189], v210 offset:19456
v_smfmac_f32_16x16x64_bf16 v[0:3], v[178:181], v[84:91], v207
s_waitcnt lgkmcnt(2)
s_nop 1
v_cvt_pk_bf16_f32 v24, v24, v25
v_cvt_pk_bf16_f32 v25, v26, v27
v_smfmac_f32_16x16x64_bf16 v[12:15], v[178:181], v[92:99], v207
buffer_store_dwordx2 v[24:25], v205, s[8:11], s38 offen
v_mfma_f32_16x16x32_bf16 v[24:27], v[174:177], v[100:103], 0
s_waitcnt lgkmcnt(1)
ds_read_b128 v[100:103], v196
ds_read_b128 v[174:177], v218 offset:1056
v_mfma_f32_16x16x32_bf16 v[138:141], a[0:3], v[182:185], 0
v_cvt_pk_bf16_f32 v28, v28, v29
v_cvt_pk_bf16_f32 v29, v30, v31
v_mfma_f32_16x16x32_bf16 v[142:145], a[24:27], v[182:185], 0
buffer_store_dwordx2 v[28:29], v205, s[8:11], s38 offen offset:32
v_mfma_f32_16x16x32_bf16 v[146:149], a[48:51], v[182:185], 0
ds_read_b128 v[84:87], v197
ds_read_b128 v[88:91], v197 offset:16
v_mfma_f32_16x16x32_bf16 v[150:153], a[216:219], v[182:185], 0
v_cvt_pk_bf16_f32 v32, v32, v33
v_cvt_pk_bf16_f32 v33, v34, v35
v_mfma_f32_16x16x32_bf16 v[154:157], a[240:243], v[182:185], 0
buffer_store_dwordx2 v[32:33], v205, s[8:11], s38 offen offset:64
v_mfma_f32_16x16x32_bf16 v[158:161], v[232:235], v[182:185], 0
ds_read_b128 v[92:95], v198
ds_read_b128 v[96:99], v198 offset:16
v_mfma_f32_16x16x32_bf16 v[162:165], v[182:185], a[72:75], 0
v_mfma_f32_16x16x32_bf16 v[166:169], v[182:185], a[96:99], 0
v_mfma_f32_16x16x32_bf16 v[170:173], v[182:185], a[120:123], 0
s_waitcnt lgkmcnt(6)
ds_read_b128 v[182:185], v210 offset:20480
v_mfma_f32_16x16x32_bf16 v[138:141], a[4:7], v[186:189], v[138:141]
v_mfma_f32_16x16x32_bf16 v[142:145], a[28:31], v[186:189], v[142:145]
v_mfma_f32_16x16x32_bf16 v[146:149], a[52:55], v[186:189], v[146:149]
v_mfma_f32_16x16x32_bf16 v[150:153], a[220:223], v[186:189], v[150:153]
v_mfma_f32_16x16x32_bf16 v[154:157], a[244:247], v[186:189], v[154:157]
s_mul_hi_u32 s41, s35, 58835169
s_mul_i32 s42, s41, 73
v_mfma_f32_16x16x32_bf16 v[158:161], v[236:239], v[186:189], v[158:161]
s_sub_u32 s42, s35, s42
s_mul_i32 s43, s41, 1373568
v_mfma_f32_16x16x32_bf16 v[162:165], v[186:189], a[76:79], v[162:165]
s_mul_i32 s51, s42, 2688
v_mfma_f32_16x16x32_bf16 v[166:169], v[186:189], a[100:103], v[166:169]
s_add_u32 s43, s43, s51
s_cmp_lt_u32 s35, s34
v_mfma_f32_16x16x32_bf16 v[170:173], v[186:189], a[124:127], v[170:173]
s_cselect_b32 s37, s43, 1879048192
ds_read_b128 v[186:189], v210 offset:21504
s_add_u32 s35, s35, 32
s_waitcnt lgkmcnt(1)
v_mfma_f32_16x16x32_bf16 v[138:141], a[8:11], v[182:185], v[138:141]
s_cmp_eq_u32 s42, 0
s_cselect_b32 s44, 536870911, s72
s_cmp_eq_u32 s42, 72
v_mfma_f32_16x16x32_bf16 v[142:145], a[32:35], v[182:185], v[142:145]
s_cselect_b32 s44, 939524095, s44
v_and_b32 v209, s44, v208
v_mfma_f32_16x16x32_bf16 v[146:149], a[56:59], v[182:185], v[146:149]
s_cmp_eq_u32 s41, 0
v_mfma_f32_16x16x32_bf16 v[150:153], a[224:227], v[182:185], v[150:153]
s_cselect_b32 s40, 1879048192, s37
s_add_u32 m0, s45, 0
v_mfma_f32_16x16x32_bf16 v[154:157], a[248:251], v[182:185], v[154:157]
v_smfmac_f32_16x16x64_bf16 v[24:27], v[178:181], v[100:107], v207
ds_read_b128 v[100:103], v199
ds_read_b128 v[104:107], v199 offset:16
v_mfma_f32_16x16x32_bf16 v[158:161], v[240:243], v[182:185], v[158:161]
ds_read_b128 v[178:181], v218 offset:1584
v_mfma_f32_16x16x32_bf16 v[162:165], v[182:185], a[80:83], v[162:165]
v_mfma_f32_16x16x32_bf16 v[166:169], v[182:185], a[104:107], v[166:169]
v_mfma_f32_16x16x32_bf16 v[170:173], v[182:185], a[128:131], v[170:173]
ds_read_b128 v[182:185], v210 offset:22528
v_smfmac_f32_16x16x64_bf16 v[0:3], v[174:177], v[84:91], v207
s_waitcnt lgkmcnt(4)
ds_read_b128 v[84:87], v200 offset:32
ds_read_b128 v[88:91], v194 offset:48
v_mfma_f32_16x16x32_bf16 v[138:141], a[12:15], v[186:189], v[138:141]
v_mfma_f32_16x16x32_bf16 v[142:145], a[36:39], v[186:189], v[142:145]
v_smfmac_f32_16x16x64_bf16 v[12:15], v[174:177], v[92:99], v207
ds_read_b128 v[92:95], v201 offset:32
ds_read_b128 v[96:99], v195 offset:48
v_mfma_f32_16x16x32_bf16 v[146:149], a[60:63], v[186:189], v[146:149]
v_add_f32 v118, v0, v1
v_mul_f32 v119, v0, v0
v_mfma_f32_16x16x32_bf16 v[150:153], a[228:231], v[186:189], v[150:153]
v_add_f32 v118, v118, v2
v_fmac_f32 v119, v1, v1
v_mfma_f32_16x16x32_bf16 v[154:157], a[252:255], v[186:189], v[154:157]
s_waitcnt lgkmcnt(6)
v_add_f32 v118, v118, v3
v_fmac_f32 v119, v2, v2
v_smfmac_f32_16x16x64_bf16 v[24:27], v[174:177], v[100:107], v207
ds_read_b128 v[100:103], v202 offset:32
ds_read_b128 v[174:177], v218 offset:2112
v_mfma_f32_16x16x32_bf16 v[158:161], v[244:247], v[186:189], v[158:161]
ds_read_b128 v[104:107], v196 offset:48
v_fmac_f32 v119, v3, v3
v_mfma_f32_16x16x32_bf16 v[162:165], v[186:189], a[84:87], v[162:165]
v_add_f32 v126, v12, v13
v_mul_f32 v127, v12, v12
v_mfma_f32_16x16x32_bf16 v[166:169], v[186:189], a[108:111], v[166:169]
s_waitcnt lgkmcnt(6)
v_add_f32 v126, v126, v14
v_fmac_f32 v127, v13, v13
v_mfma_f32_16x16x32_bf16 v[4:7], v[178:181], v[84:87], 0
ds_read_b128 v[84:87], v194 offset:32
v_add_f32 v126, v126, v15
v_mfma_f32_16x16x32_bf16 v[170:173], v[186:189], a[132:135], v[170:173]
s_waitcnt lgkmcnt(5)
ds_read_b128 v[186:189], v210 offset:23552
v_fmac_f32 v127, v14, v14
v_mfma_f32_16x16x32_bf16 v[16:19], v[178:181], v[92:95], 0
ds_read_b128 v[92:95], v195 offset:32
v_fmac_f32 v127, v15, v15
v_mfma_f32_16x16x32_bf16 v[138:141], a[16:19], v[182:185], v[138:141]
s_waitcnt lgkmcnt(5)
v_add_f32 v134, v24, v25
v_mul_f32 v135, v24, v24
v_mfma_f32_16x16x32_bf16 v[28:31], v[178:181], v[100:103], 0
ds_read_b128 v[100:103], v196 offset:32
ds_read_b128 v[178:181], v218 offset:2640
v_mfma_f32_16x16x32_bf16 v[142:145], a[40:43], v[182:185], v[142:145]
v_add_f32 v134, v134, v26
v_fmac_f32 v135, v25, v25
v_mfma_f32_16x16x32_bf16 v[146:149], a[64:67], v[182:185], v[146:149]
v_add_f32 v134, v134, v27
v_fmac_f32 v135, v26, v26
v_mfma_f32_16x16x32_bf16 v[150:153], a[232:235], v[182:185], v[150:153]
v_fmac_f32 v135, v27, v27
v_mfma_f32_16x16x32_bf16 v[154:157], v[224:227], v[182:185], v[154:157]
s_waitcnt lgkmcnt(4)
v_smfmac_f32_16x16x64_bf16 v[4:7], v[174:177], v[84:91], v207
ds_read_b128 v[84:87], v197 offset:32
ds_read_b128 v[88:91], v197 offset:48
v_mfma_f32_16x16x32_bf16 v[158:161], v[248:251], v[182:185], v[158:161]
v_mfma_f32_16x16x32_bf16 v[162:165], v[182:185], a[88:91], v[162:165]
v_mfma_f32_16x16x32_bf16 v[166:169], v[182:185], a[112:115], v[166:169]
s_waitcnt lgkmcnt(4)
v_smfmac_f32_16x16x64_bf16 v[16:19], v[174:177], v[92:99], v207
ds_read_b128 v[92:95], v198 offset:32
ds_read_b128 v[96:99], v198 offset:48
v_mfma_f32_16x16x32_bf16 v[170:173], v[182:185], a[136:139], v[170:173]
ds_read_b128 v[182:185], v210 offset:24576
v_mfma_f32_16x16x32_bf16 v[138:141], a[20:23], v[186:189], v[138:141]
s_waitcnt lgkmcnt(6)
v_smfmac_f32_16x16x64_bf16 v[28:31], v[174:177], v[100:107], v207
ds_read_b128 v[100:103], v199 offset:32
ds_read_b128 v[104:107], v199 offset:48
v_mfma_f32_16x16x32_bf16 v[142:145], a[44:47], v[186:189], v[142:145]
ds_read_b128 v[174:177], v218 offset:3168
v_mfma_f32_16x16x32_bf16 v[146:149], a[68:71], v[186:189], v[146:149]
s_nop 0
v_cvt_pk_bf16_f32 v78, v138, v139
v_cvt_pk_bf16_f32 v79, v140, v141
v_mfma_f32_16x16x32_bf16 v[150:153], a[236:239], v[186:189], v[150:153]
v_mfma_f32_16x16x32_bf16 v[154:157], v[228:231], v[186:189], v[154:157]
s_waitcnt lgkmcnt(6)
v_cvt_pk_bf16_f32 v80, v142, v143
v_cvt_pk_bf16_f32 v81, v144, v145
v_smfmac_f32_16x16x64_bf16 v[4:7], v[178:181], v[84:91], v207
ds_read_b128 v[84:87], v200 offset:64
v_cvt_pk_bf16_f32 v82, v146, v147
v_mfma_f32_16x16x32_bf16 v[158:161], v[252:255], v[186:189], v[158:161]
v_cvt_pk_bf16_f32 v83, v148, v149
v_cvt_pk_bf16_f32 v72, v150, v151
v_mfma_f32_16x16x32_bf16 v[162:165], v[186:189], a[92:95], v[162:165]
v_cvt_pk_bf16_f32 v73, v152, v153
v_cvt_pk_bf16_f32 v74, v154, v155
v_mfma_f32_16x16x32_bf16 v[166:169], v[186:189], a[116:119], v[166:169]
s_waitcnt lgkmcnt(5)
v_cvt_pk_bf16_f32 v75, v156, v157
v_add_f32 v118, v118, v4
v_smfmac_f32_16x16x64_bf16 v[16:19], v[178:181], v[92:99], v207
ds_read_b128 v[92:95], v201 offset:64
v_cvt_pk_bf16_f32 v76, v158, v159
v_mfma_f32_16x16x32_bf16 v[170:173], v[186:189], a[140:143], v[170:173]
s_waitcnt lgkmcnt(5)
ds_read_b128 v[186:189], v210 offset:25600
v_cvt_pk_bf16_f32 v77, v160, v161
v_mfma_f32_16x16x32_bf16 v[138:141], a[0:3], v[182:185], 0
v_cvt_pk_bf16_f32 v114, v162, v163
v_cvt_pk_bf16_f32 v115, v164, v165
v_mfma_f32_16x16x32_bf16 v[142:145], a[24:27], v[182:185], 0
s_waitcnt lgkmcnt(4)
ds_read_b128 v[88:91], v194 offset:80
v_cvt_pk_bf16_f32 v122, v166, v167
v_smfmac_f32_16x16x64_bf16 v[28:31], v[178:181], v[100:107], v207
ds_read_b128 v[100:103], v202 offset:64
ds_read_b128 v[178:181], v218 offset:3696
v_mfma_f32_16x16x32_bf16 v[146:149], a[48:51], v[182:185], 0
v_cvt_pk_bf16_f32 v123, v168, v169
v_cvt_pk_bf16_f32 v130, v170, v171
v_mfma_f32_16x16x32_bf16 v[150:153], a[216:219], v[182:185], 0
v_cvt_pk_bf16_f32 v131, v172, v173
v_fmac_f32 v119, v4, v4
v_mfma_f32_16x16x32_bf16 v[154:157], a[240:243], v[182:185], 0
s_waitcnt lgkmcnt(5)
ds_read_b128 v[96:99], v195 offset:80
ds_read_b128 v[104:107], v196 offset:80
v_mfma_f32_16x16x32_bf16 v[8:11], v[174:177], v[84:87], 0
ds_read_b128 v[84:87], v194 offset:64
v_add_f32 v118, v118, v5
v_mfma_f32_16x16x32_bf16 v[158:161], v[232:235], v[182:185], 0
v_fmac_f32 v119, v5, v5
v_add_f32 v118, v118, v6
v_mfma_f32_16x16x32_bf16 v[162:165], v[182:185], a[72:75], 0
s_waitcnt lgkmcnt(7)
v_fmac_f32 v119, v6, v6
v_add_f32 v118, v118, v7
v_mfma_f32_16x16x32_bf16 v[20:23], v[174:177], v[92:95], 0
ds_read_b128 v[92:95], v195 offset:64
v_fmac_f32 v119, v7, v7
v_mfma_f32_16x16x32_bf16 v[166:169], v[182:185], a[96:99], 0
v_add_f32 v126, v126, v16
v_fmac_f32 v127, v16, v16
v_mfma_f32_16x16x32_bf16 v[170:173], v[182:185], a[120:123], 0
s_waitcnt lgkmcnt(5)
ds_read_b128 v[182:185], v210 offset:26624
v_add_f32 v126, v126, v17
v_mfma_f32_16x16x32_bf16 v[32:35], v[174:177], v[100:103], 0
ds_read_b128 v[100:103], v196 offset:64
ds_read_b128 v[174:177], v218 offset:4224
v_mfma_f32_16x16x32_bf16 v[138:141], a[4:7], v[186:189], v[138:141]
v_fmac_f32 v127, v17, v17
v_add_f32 v126, v126, v18
v_mfma_f32_16x16x32_bf16 v[142:145], a[28:31], v[186:189], v[142:145]
v_fmac_f32 v127, v18, v18
v_add_f32 v126, v126, v19
v_mfma_f32_16x16x32_bf16 v[146:149], a[52:55], v[186:189], v[146:149]
s_waitcnt lgkmcnt(4)
v_fmac_f32 v127, v19, v19
v_add_f32 v134, v134, v28
v_smfmac_f32_16x16x64_bf16 v[8:11], v[178:181], v[84:91], v207
ds_read_b128 v[84:87], v197 offset:64
ds_read_b128 v[88:91], v197 offset:80
v_mfma_f32_16x16x32_bf16 v[150:153], a[220:223], v[186:189], v[150:153]
v_fmac_f32 v135, v28, v28
v_add_f32 v134, v134, v29
v_mfma_f32_16x16x32_bf16 v[154:157], a[244:247], v[186:189], v[154:157]
v_fmac_f32 v135, v29, v29
v_add_f32 v134, v134, v30
v_mfma_f32_16x16x32_bf16 v[158:161], v[236:239], v[186:189], v[158:161]
s_waitcnt lgkmcnt(5)
v_fmac_f32 v135, v30, v30
v_add_f32 v134, v134, v31
v_smfmac_f32_16x16x64_bf16 v[20:23], v[178:181], v[92:99], v207
ds_read_b128 v[92:95], v198 offset:64
ds_read_b128 v[96:99], v198 offset:80
v_mfma_f32_16x16x32_bf16 v[162:165], v[186:189], a[76:79], v[162:165]
v_fmac_f32 v135, v31, v31
v_mfma_f32_16x16x32_bf16 v[166:169], v[186:189], a[100:103], v[166:169]
ds_read_u16 v120, v217
ds_read_u16 v128, v217 offset:32
v_mfma_f32_16x16x32_bf16 v[170:173], v[186:189], a[124:127], v[170:173]
ds_read_b128 v[186:189], v210 offset:27648
ds_read_u16 v136, v217 offset:64
s_waitcnt lgkmcnt(9)
v_smfmac_f32_16x16x64_bf16 v[32:35], v[178:181], v[100:107], v207
ds_read_b128 v[100:103], v199 offset:64
ds_read_b128 v[104:107], v199 offset:80
v_mfma_f32_16x16x32_bf16 v[138:141], a[8:11], v[182:185], v[138:141]
v_add_u32 v217, 1408, v217
v_mfma_f32_16x16x32_bf16 v[142:145], a[32:35], v[182:185], v[142:145]
v_mfma_f32_16x16x32_bf16 v[146:149], a[56:59], v[182:185], v[146:149]
s_waitcnt lgkmcnt(8)
v_smfmac_f32_16x16x64_bf16 v[8:11], v[174:177], v[84:91], v207
v_mfma_f32_16x16x32_bf16 v[150:153], a[224:227], v[182:185], v[150:153]
v_mfma_f32_16x16x32_bf16 v[154:157], a[248:251], v[182:185], v[154:157]
v_mfma_f32_16x16x32_bf16 v[158:161], v[240:243], v[182:185], v[158:161]
s_waitcnt lgkmcnt(6)
s_nop 3
v_add_f32 v118, v118, v8
v_fmac_f32 v119, v8, v8
v_smfmac_f32_16x16x64_bf16 v[20:23], v[174:177], v[92:99], v207
v_add_f32 v118, v118, v9
v_fmac_f32 v119, v9, v9
v_mfma_f32_16x16x32_bf16 v[162:165], v[182:185], a[80:83], v[162:165]
v_add_f32 v118, v118, v10
v_fmac_f32 v119, v10, v10
v_mfma_f32_16x16x32_bf16 v[166:169], v[182:185], a[104:107], v[166:169]
v_add_f32 v118, v118, v11
v_fmac_f32 v119, v11, v11
v_mfma_f32_16x16x32_bf16 v[170:173], v[182:185], a[128:131], v[170:173]
s_waitcnt lgkmcnt(0)
ds_read_b128 v[182:185], v210 offset:28672
v_add_f32 v126, v126, v20
v_smfmac_f32_16x16x64_bf16 v[32:35], v[174:177], v[100:107], v207
v_fmac_f32 v127, v20, v20
v_add_f32 v126, v126, v21
v_mfma_f32_16x16x32_bf16 v[138:141], a[12:15], v[186:189], v[138:141]
v_fmac_f32 v127, v21, v21
v_add_f32 v126, v126, v22
v_mfma_f32_16x16x32_bf16 v[142:145], a[36:39], v[186:189], v[142:145]
v_fmac_f32 v127, v22, v22
v_add_f32 v126, v126, v23
v_mfma_f32_16x16x32_bf16 v[146:149], a[60:63], v[186:189], v[146:149]
v_fmac_f32 v127, v23, v23
v_add_f32 v134, v134, v32
v_mfma_f32_16x16x32_bf16 v[150:153], a[228:231], v[186:189], v[150:153]
v_fmac_f32 v135, v32, v32
v_add_f32 v134, v134, v33
v_mfma_f32_16x16x32_bf16 v[154:157], a[252:255], v[186:189], v[154:157]
v_fmac_f32 v135, v33, v33
v_add_f32 v134, v134, v34
v_mfma_f32_16x16x32_bf16 v[158:161], v[244:247], v[186:189], v[158:161]
v_fmac_f32 v135, v34, v34
v_add_f32 v134, v134, v35
v_mfma_f32_16x16x32_bf16 v[162:165], v[186:189], a[84:87], v[162:165]
v_permlane16_swap_b32 v118, v119
v_mfma_f32_16x16x32_bf16 v[166:169], v[186:189], a[108:111], v[166:169]
v_fmac_f32 v135, v35, v35
v_add_f32 v118, v118, v119
v_mfma_f32_16x16x32_bf16 v[170:173], v[186:189], a[132:135], v[170:173]
s_waitcnt lgkmcnt(0)
ds_read_b128 v[186:189], v210 offset:29696
v_permlane16_swap_b32 v126, v127
v_mfma_f32_16x16x32_bf16 v[138:141], a[16:19], v[182:185], v[138:141]
v_add_f32 v126, v126, v127
v_permlane16_swap_b32 v134, v135
v_mfma_f32_16x16x32_bf16 v[142:145], a[40:43], v[182:185], v[142:145]
v_add_f32 v134, v134, v135
v_permlane32_swap_b32 v118, v126
v_mfma_f32_16x16x32_bf16 v[146:149], a[64:67], v[182:185], v[146:149]
v_add_f32 v118, v118, v126
v_mov_b32 v135, v134
v_mfma_f32_16x16x32_bf16 v[150:153], a[232:235], v[182:185], v[150:153]
ds_write_b32 v213, v118
v_mfma_f32_16x16x32_bf16 v[154:157], v[224:227], v[182:185], v[154:157]
v_permlane32_swap_b32 v134, v135
v_mfma_f32_16x16x32_bf16 v[158:161], v[248:251], v[182:185], v[158:161]
v_add_f32 v134, v134, v135
v_mfma_f32_16x16x32_bf16 v[162:165], v[182:185], a[88:91], v[162:165]
ds_write_b32 v213, v134 offset:512
v_mfma_f32_16x16x32_bf16 v[166:169], v[182:185], a[112:115], v[166:169]
v_mfma_f32_16x16x32_bf16 v[170:173], v[182:185], a[136:139], v[170:173]
s_waitcnt lgkmcnt(2)
ds_read_b128 v[182:185], v210 offset:30720
v_mfma_f32_16x16x32_bf16 v[138:141], a[20:23], v[186:189], v[138:141]
v_mfma_f32_16x16x32_bf16 v[142:145], a[44:47], v[186:189], v[142:145]
v_mfma_f32_16x16x32_bf16 v[146:149], a[68:71], v[186:189], v[146:149]
v_mfma_f32_16x16x32_bf16 v[150:153], a[236:239], v[186:189], v[150:153]
s_nop 4
v_cvt_pk_bf16_f32 v96, v138, v139
v_cvt_pk_bf16_f32 v97, v140, v141
v_mfma_f32_16x16x32_bf16 v[154:157], v[228:231], v[186:189], v[154:157]
s_waitcnt lgkmcnt(1)
v_cvt_pk_bf16_f32 v98, v142, v143
v_cvt_pk_bf16_f32 v99, v144, v145
v_mfma_f32_16x16x32_bf16 v[158:161], v[252:255], v[186:189], v[158:161]
s_barrier
ds_read_b128 v[174:177], v210 offset:55296
v_mfma_f32_16x16x32_bf16 v[162:165], v[186:189], a[92:95], v[162:165]
ds_read_b128 v[178:181], v210 offset:56320
buffer_load_dwordx4 v209, s[4:7], s40 offen nt lds
v_mfma_f32_16x16x32_bf16 v[166:169], v[186:189], a[116:119], v[166:169]
s_add_u32 s40, s37, 196224
v_cvt_pk_bf16_f32 v100, v146, v147
v_cvt_pk_bf16_f32 v101, v148, v149
v_mfma_f32_16x16x32_bf16 v[170:173], v[186:189], a[140:143], v[170:173]
s_add_u32 m0, s45, 4112
ds_read_b128 v[186:189], v210 offset:31744
v_cvt_pk_bf16_f32 v84, v150, v151
s_waitcnt lgkmcnt(3)
v_mfma_f32_16x16x32_bf16 v[138:141], a[0:3], v[182:185], 0
v_cvt_pk_bf16_f32 v85, v152, v153
v_cvt_pk_bf16_f32 v86, v154, v155
v_mfma_f32_16x16x32_bf16 v[142:145], a[24:27], v[182:185], 0
buffer_load_dwordx4 v209, s[4:7], s40 offen nt lds
v_mfma_f32_16x16x32_bf16 v[146:149], a[48:51], v[182:185], 0
s_add_u32 s40, s37, 392448
v_cvt_pk_bf16_f32 v87, v156, v157
v_cvt_pk_bf16_f32 v88, v158, v159
v_mfma_f32_16x16x32_bf16 v[150:153], a[216:219], v[182:185], 0
s_add_u32 m0, s45, 8224
v_cvt_pk_bf16_f32 v89, v160, v161
v_cvt_pk_bf16_f32 v116, v162, v163
v_mfma_f32_16x16x32_bf16 v[154:157], a[240:243], v[182:185], 0
v_cvt_pk_bf16_f32 v117, v164, v165
v_cvt_pk_bf16_f32 v124, v166, v167
v_mfma_f32_16x16x32_bf16 v[158:161], v[232:235], v[182:185], 0
s_waitcnt lgkmcnt(2)
buffer_load_dwordx4 v209, s[4:7], s40 offen nt lds
v_mfma_f32_16x16x32_bf16 v[162:165], v[182:185], a[72:75], 0
s_add_u32 s40, s37, 588672
v_cvt_pk_bf16_f32 v125, v168, v169
v_cvt_pk_bf16_f32 v132, v170, v171
v_mfma_f32_16x16x32_bf16 v[166:169], v[182:185], a[96:99], 0
s_add_u32 m0, s45, 12336
v_cvt_pk_bf16_f32 v133, v172, v173
v_add_f32 v174, v174, v175
v_mfma_f32_16x16x32_bf16 v[170:173], v[182:185], a[120:123], 0
s_waitcnt lgkmcnt(0)
buffer_load_dwordx4 v209, s[4:7], s40 offen nt lds
v_mfma_f32_16x16x32_bf16 v[138:141], a[4:7], v[186:189], v[138:141]
s_add_u32 s40, s37, 784896
v_add_f32 v178, v178, v179
v_add_f32 v176, v176, v177
v_mfma_f32_16x16x32_bf16 v[142:145], a[28:31], v[186:189], v[142:145]
s_add_u32 m0, s45, 16448
v_add_f32 v180, v180, v181
v_add_f32 v174, v174, v176
v_mfma_f32_16x16x32_bf16 v[146:149], a[52:55], v[186:189], v[146:149]
buffer_load_dwordx4 v209, s[4:7], s40 offen nt lds
v_mfma_f32_16x16x32_bf16 v[150:153], a[220:223], v[186:189], v[150:153]
s_add_u32 s40, s37, 981120
v_add_f32 v178, v178, v180
v_mul_f32 v175, s48, v174
v_mfma_f32_16x16x32_bf16 v[154:157], a[244:247], v[186:189], v[154:157]
s_add_u32 m0, s45, 20560
ds_read_b128 v[182:185], v210 offset:32768
buffer_load_dwordx4 v209, s[4:7], s40 offen nt lds
v_mfma_f32_16x16x32_bf16 v[158:161], v[236:239], v[186:189], v[158:161]
s_add_u32 s40, s37, 1177344
v_mul_f32 v178, s48, v178
v_fma_f32 v178, -v175, v175, v178
v_mfma_f32_16x16x32_bf16 v[162:165], v[186:189], a[76:79], v[162:165]
s_add_u32 m0, s45, 24672
v_max_f32 v178, 0, v178
v_add_f32 v178, s49, v178
v_mfma_f32_16x16x32_bf16 v[166:169], v[186:189], a[100:103], v[166:169]
s_waitcnt lgkmcnt(0)
buffer_load_dwordx4 v209, s[4:7], s40 offen nt lds
v_mfma_f32_16x16x32_bf16 v[170:173], v[186:189], a[124:127], v[170:173]
s_add_u32 s40, s37, 1373568
v_rsq_f32 v174, v178
s_add_u32 m0, s45, 28784
v_mul_f32_e64 v175, -v175, v174
ds_write_b64 v214, v[174:175]
v_mfma_f32_16x16x32_bf16 v[138:141], a[8:11], v[182:185], v[138:141]
ds_read_b64 v[118:119], v215
ds_read_b64 v[126:127], v215 offset:128
v_mfma_f32_16x16x32_bf16 v[142:145], a[32:35], v[182:185], v[142:145]
ds_read_b64 v[134:135], v215 offset:256
buffer_load_dwordx4 v209, s[4:7], s40 offen nt lds
v_mfma_f32_16x16x32_bf16 v[146:149], a[56:59], v[182:185], v[146:149]
s_add_u32 s40, s37, 1569792
ds_read_b128 v[186:189], v210 offset:33792
s_add_u32 m0, s45, 32896
v_mfma_f32_16x16x32_bf16 v[150:153], a[224:227], v[182:185], v[150:153]
buffer_load_dwordx4 v209, s[4:7], s40 offen nt lds
v_mfma_f32_16x16x32_bf16 v[154:157], a[248:251], v[182:185], v[154:157]
v_mov_b32 v181, 0
v_mfma_f32_16x16x32_bf16 v[158:161], v[240:243], v[182:185], v[158:161]
s_waitcnt lgkmcnt(3)
v_fma_f32 v108, v0, v118, v119
v_fma_f32 v109, v1, v118, v119
v_mfma_f32_16x16x32_bf16 v[162:165], v[182:185], a[80:83], v[162:165]
v_cvt_pk_bf16_f32 v90, v108, v109
v_fma_f32 v110, v2, v118, v119
v_mfma_f32_16x16x32_bf16 v[166:169], v[182:185], a[104:107], v[166:169]
v_fma_f32 v111, v3, v118, v119
v_cvt_pk_bf16_f32 v91, v110, v111
v_mfma_f32_16x16x32_bf16 v[170:173], v[182:185], a[128:131], v[170:173]
s_waitcnt lgkmcnt(0)
v_fma_f32 v112, v4, v118, v119
v_fma_f32 v113, v5, v118, v119
v_mfma_f32_16x16x32_bf16 v[138:141], a[12:15], v[186:189], v[138:141]
v_cvt_pk_bf16_f32 v92, v112, v113
v_fma_f32 v108, v6, v118, v119
v_mfma_f32_16x16x32_bf16 v[142:145], a[36:39], v[186:189], v[142:145]
v_fma_f32 v109, v7, v118, v119
v_cvt_pk_bf16_f32 v93, v108, v109
v_mfma_f32_16x16x32_bf16 v[146:149], a[60:63], v[186:189], v[146:149]
ds_write_b128 v211, v[90:93]
v_mfma_f32_16x16x32_bf16 v[150:153], a[228:231], v[186:189], v[150:153]
ds_read_b128 v[182:185], v210 offset:34816
v_fma_f32 v110, v8, v118, v119
v_mfma_f32_16x16x32_bf16 v[154:157], a[252:255], v[186:189], v[154:157]
v_fma_f32 v111, v9, v118, v119
v_cvt_pk_bf16_f32 v94, v110, v111
v_mfma_f32_16x16x32_bf16 v[158:161], v[244:247], v[186:189], v[158:161]
v_fma_f32 v112, v10, v118, v119
v_fma_f32 v113, v11, v118, v119
v_mfma_f32_16x16x32_bf16 v[162:165], v[186:189], a[84:87], v[162:165]
v_cvt_pk_bf16_f32 v95, v112, v113
v_fma_f32 v108, v12, v126, v127
v_mfma_f32_16x16x32_bf16 v[166:169], v[186:189], a[108:111], v[166:169]
ds_write_b64 v212, v[94:95]
v_mfma_f32_16x16x32_bf16 v[170:173], v[186:189], a[132:135], v[170:173]
v_fma_f32 v109, v13, v126, v127
v_cvt_pk_bf16_f32 v102, v108, v109
v_fma_f32 v110, v14, v126, v127
v_fma_f32 v111, v15, v126, v127
v_cvt_pk_bf16_f32 v103, v110, v111
v_fma_f32 v112, v16, v126, v127
v_fma_f32 v113, v17, v126, v127
v_cvt_pk_bf16_f32 v104, v112, v113
v_fma_f32 v108, v18, v126, v127
v_fma_f32 v109, v19, v126, v127
s_waitcnt lgkmcnt(1)
v_mfma_f32_16x16x32_bf16 v[138:141], a[16:19], v[182:185], v[138:141]
ds_read_b128 v[186:189], v210 offset:35840
v_cvt_pk_bf16_f32 v105, v108, v109
v_mfma_f32_16x16x32_bf16 v[142:145], a[40:43], v[182:185], v[142:145]
ds_write_b128 v211, v[102:105] offset:6144
v_mfma_f32_16x16x32_bf16 v[146:149], a[64:67], v[182:185], v[146:149]
v_fma_f32 v110, v20, v126, v127
v_fma_f32 v111, v21, v126, v127
v_mfma_f32_16x16x32_bf16 v[150:153], a[232:235], v[182:185], v[150:153]
v_cvt_pk_bf16_f32 v106, v110, v111
v_fma_f32 v112, v22, v126, v127
v_mfma_f32_16x16x32_bf16 v[154:157], v[224:227], v[182:185], v[154:157]
v_fma_f32 v113, v23, v126, v127
v_cvt_pk_bf16_f32 v107, v112, v113
v_mfma_f32_16x16x32_bf16 v[158:161], v[248:251], v[182:185], v[158:161]
ds_write_b64 v212, v[106:107] offset:6144
v_mfma_f32_16x16x32_bf16 v[162:165], v[182:185], a[88:91], v[162:165]
v_fma_f32 v108, v24, v134, v135
v_fma_f32 v109, v25, v134, v135
v_mfma_f32_16x16x32_bf16 v[166:169], v[182:185], a[112:115], v[166:169]
v_cvt_pk_bf16_f32 v90, v108, v109
v_fma_f32 v110, v26, v134, v135
v_mfma_f32_16x16x32_bf16 v[170:173], v[182:185], a[136:139], v[170:173]
s_waitcnt lgkmcnt(2)
v_fma_f32 v111, v27, v134, v135
v_cvt_pk_bf16_f32 v91, v110, v111
v_mfma_f32_16x16x32_bf16 v[138:141], a[20:23], v[186:189], v[138:141]
v_fma_f32 v112, v28, v134, v135
v_fma_f32 v113, v29, v134, v135
v_mfma_f32_16x16x32_bf16 v[142:145], a[44:47], v[186:189], v[142:145]
v_cvt_pk_bf16_f32 v92, v112, v113
v_fma_f32 v108, v30, v134, v135
v_mfma_f32_16x16x32_bf16 v[146:149], a[68:71], v[186:189], v[146:149]
v_fma_f32 v109, v31, v134, v135
v_cvt_pk_bf16_f32 v93, v108, v109
v_mfma_f32_16x16x32_bf16 v[150:153], a[236:239], v[186:189], v[150:153]
ds_write_b128 v211, v[90:93] offset:12288
v_mfma_f32_16x16x32_bf16 v[154:157], v[228:231], v[186:189], v[154:157]
v_fma_f32 v110, v32, v134, v135
v_fma_f32 v111, v33, v134, v135
v_mfma_f32_16x16x32_bf16 v[158:161], v[252:255], v[186:189], v[158:161]
v_cvt_pk_bf16_f32 v94, v110, v111
v_fma_f32 v112, v34, v134, v135
v_mfma_f32_16x16x32_bf16 v[162:165], v[186:189], a[92:95], v[162:165]
ds_read_b128 v[108:111], v216 offset:512
v_fma_f32 v113, v35, v134, v135
v_mfma_f32_16x16x32_bf16 v[166:169], v[186:189], a[116:119], v[166:169]
v_cvt_pk_bf16_f32 v95, v112, v113
v_cvt_pk_bf16_f32 v102, v138, v139
v_mfma_f32_16x16x32_bf16 v[170:173], v[186:189], a[140:143], v[170:173]
ds_read_b64 v[112:113], v216 offset:528
ds_write_b64 v212, v[94:95] offset:12288
v_cvt_pk_bf16_f32 v103, v140, v141
v_mfma_f32_16x16x32_bf16 v[138:141], v[78:81], v[72:75], 0
v_cvt_pk_bf16_f32 v104, v142, v143
v_cvt_pk_bf16_f32 v105, v144, v145
v_mfma_f32_16x16x32_bf16 v[142:145], v[96:99], v[72:75], 0
v_cvt_pk_bf16_f32 v106, v146, v147
v_cvt_pk_bf16_f32 v107, v148, v149
v_mfma_f32_16x16x32_bf16 v[146:149], v[102:105], v[72:75], 0
s_waitcnt lgkmcnt(2)
v_cvt_pk_bf16_f32 v90, v150, v151
v_cvt_pk_bf16_f32 v91, v152, v153
v_mfma_f32_16x16x32_bf16 v[150:153], v[108:111], v[72:75], v[206:209]
ds_read_b128 v[72:75], v216
v_cvt_pk_bf16_f32 v92, v154, v155
v_mfma_f32_16x16x16_bf16 v[138:141], v[82:83], v[76:77], v[138:141]
v_cvt_pk_bf16_f32 v93, v156, v157
v_cvt_pk_bf16_f32 v94, v158, v159
v_mfma_f32_16x16x16_bf16 v[142:145], v[100:101], v[76:77], v[142:145]
s_waitcnt lgkmcnt(2)
v_cvt_pk_bf16_f32 v95, v160, v161
v_cvt_pk_bf16_f32 v118, v162, v163
v_mfma_f32_16x16x16_bf16 v[150:153], v[112:113], v[76:77], v[150:153]
v_cvt_pk_bf16_f32 v119, v164, v165
v_cvt_pk_bf16_f32 v126, v166, v167
v_mfma_f32_16x16x16_bf16 v[146:149], v[106:107], v[76:77], v[146:149]
ds_read_b64 v[76:77], v216 offset:16
v_cvt_pk_bf16_f32 v127, v168, v169
v_mfma_f32_16x16x32_bf16 v[154:157], v[78:81], v[84:87], 0
v_cvt_pk_bf16_f32 v134, v170, v171
v_cvt_pk_bf16_f32 v135, v172, v173
v_mfma_f32_16x16x32_bf16 v[158:161], v[96:99], v[84:87], 0
v_max3_f32 v220, v138, v139, v140
v_max3_f32 v220, v220, v141, v142
v_mfma_f32_16x16x32_bf16 v[166:169], v[108:111], v[84:87], v[206:209]
v_max3_f32 v220, v220, v143, v144
v_max3_f32 v220, v220, v145, v146
v_mfma_f32_16x16x32_bf16 v[162:165], v[102:105], v[84:87], 0
v_max3_f32 v220, v220, v147, v148
v_max3_f32 v220, v220, v149, v150
v_mfma_f32_16x16x16_bf16 v[154:157], v[82:83], v[88:89], v[154:157]
v_mov_b32 v221, v220
v_mfma_f32_16x16x16_bf16 v[158:161], v[100:101], v[88:89], v[158:161]
s_nop 0
v_permlane16_swap_b32 v220, v221
v_mfma_f32_16x16x16_bf16 v[166:169], v[112:113], v[88:89], v[166:169]
v_max_f32 v220, v220, v221
v_mov_b32 v221, v220
v_mfma_f32_16x16x16_bf16 v[162:165], v[106:107], v[88:89], v[162:165]
s_nop 0
v_permlane32_swap_b32 v220, v221
v_max_f32 v220, v220, v221
v_sub_f32 v138, v138, v220
v_sub_f32 v139, v139, v220
v_sub_f32 v140, v140, v220
v_sub_f32 v141, v141, v220
v_sub_f32 v142, v142, v220
v_sub_f32 v143, v143, v220
v_sub_f32 v144, v144, v220
v_sub_f32 v145, v145, v220
v_sub_f32 v150, v150, v220
v_sub_f32 v146, v146, v220
v_sub_f32 v147, v147, v220
v_sub_f32 v148, v148, v220
v_sub_f32 v149, v149, v220
v_exp_f32 v138, v138
v_exp_f32 v139, v139
v_exp_f32 v140, v140
v_exp_f32 v141, v141
v_exp_f32 v142, v142
v_exp_f32 v143, v143
v_exp_f32 v144, v144
v_exp_f32 v145, v145
v_exp_f32 v150, v150
v_exp_f32 v146, v146
v_exp_f32 v147, v147
v_exp_f32 v148, v148
v_exp_f32 v149, v149
v_cvt_pk_bf16_f32 v174, v138, v139
v_cvt_pk_bf16_f32 v175, v140, v141
v_cvt_pk_bf16_f32 v176, v142, v143
v_cvt_pk_bf16_f32 v177, v144, v145
v_cvt_pk_bf16_f32 v178, v146, v147
v_cvt_pk_bf16_f32 v179, v148, v149
v_mfma_f32_16x16x32_bf16 v[138:141], v[114:117], v[174:177], 0
v_cvt_pk_bf16_f32 v180, v150, 0
v_max3_f32 v220, v154, v155, v156
v_mfma_f32_16x16x32_bf16 v[150:153], v[190:193], v[174:177], 0
v_max3_f32 v220, v220, v157, v158
v_max3_f32 v220, v220, v159, v160
v_mfma_f32_16x16x32_bf16 v[142:145], v[122:125], v[174:177], 0
v_max3_f32 v220, v220, v161, v162
v_max3_f32 v220, v220, v163, v164
v_mfma_f32_16x16x32_bf16 v[146:149], v[130:133], v[174:177], 0
v_max3_f32 v220, v220, v165, v166
v_mov_b32 v221, v220
v_mfma_f32_16x16x32_bf16 v[150:153], v[190:193], v[178:181], v[150:153]
s_nop 0
v_permlane16_swap_b32 v220, v221
v_mfma_f32_16x16x32_bf16 v[138:141], v[118:121], v[178:181], v[138:141]
v_max_f32 v220, v220, v221
v_mov_b32 v221, v220
v_mfma_f32_16x16x32_bf16 v[142:145], v[126:129], v[178:181], v[142:145]
s_nop 0
v_permlane32_swap_b32 v220, v221
v_mfma_f32_16x16x32_bf16 v[146:149], v[134:137], v[178:181], v[146:149]
v_max_f32 v220, v220, v221
v_sub_f32 v154, v154, v220
v_sub_f32 v155, v155, v220
v_sub_f32 v156, v156, v220
v_sub_f32 v157, v157, v220
v_sub_f32 v158, v158, v220
v_sub_f32 v159, v159, v220
v_sub_f32 v160, v160, v220
v_sub_f32 v161, v161, v220
v_sub_f32 v166, v166, v220
v_sub_f32 v162, v162, v220
v_sub_f32 v163, v163, v220
v_sub_f32 v164, v164, v220
v_sub_f32 v165, v165, v220
v_exp_f32 v154, v154
v_exp_f32 v155, v155
v_exp_f32 v156, v156
v_exp_f32 v157, v157
v_exp_f32 v158, v158
v_exp_f32 v159, v159
v_exp_f32 v160, v160
v_exp_f32 v161, v161
v_exp_f32 v166, v166
v_exp_f32 v162, v162
v_exp_f32 v163, v163
v_exp_f32 v164, v164
v_exp_f32 v165, v165
v_cvt_pk_bf16_f32 v174, v154, v155
v_cvt_pk_bf16_f32 v175, v156, v157
v_cvt_pk_bf16_f32 v176, v158, v159
v_cvt_pk_bf16_f32 v177, v160, v161
v_cvt_pk_bf16_f32 v178, v162, v163
v_cvt_pk_bf16_f32 v179, v164, v165
v_mfma_f32_16x16x32_bf16 v[154:157], v[114:117], v[174:177], 0
s_mov_b32 s38, s36
v_cvt_pk_bf16_f32 v180, v166, 0
v_rcp_f32 v151, v150
v_mfma_f32_16x16x32_bf16 v[166:169], v[190:193], v[174:177], 0
v_mul_f32 v138, v138, v151
v_mul_f32 v139, v139, v151
v_mfma_f32_16x16x32_bf16 v[158:161], v[122:125], v[174:177], 0
v_cvt_pk_bf16_f32 v138, v138, v139
v_mul_f32 v140, v140, v151
v_mfma_f32_16x16x32_bf16 v[162:165], v[130:133], v[174:177], 0
v_mul_f32 v141, v141, v151
v_cvt_pk_bf16_f32 v139, v140, v141
v_mfma_f32_16x16x32_bf16 v[166:169], v[190:193], v[178:181], v[166:169]
v_mul_f32 v142, v142, v151
v_mul_f32 v143, v143, v151
v_mfma_f32_16x16x32_bf16 v[154:157], v[118:121], v[178:181], v[154:157]
v_cvt_pk_bf16_f32 v140, v142, v143
v_mul_f32 v144, v144, v151
v_mfma_f32_16x16x32_bf16 v[158:161], v[126:129], v[178:181], v[158:161]
v_mul_f32 v145, v145, v151
v_cvt_pk_bf16_f32 v141, v144, v145
v_mfma_f32_16x16x32_bf16 v[162:165], v[134:137], v[178:181], v[162:165]
ds_write_b128 v211, v[138:141] offset:36864
v_mfma_f32_16x16x32_bf16 v[138:141], v[78:81], v[90:93], 0
v_mul_f32 v146, v146, v151
v_mul_f32 v147, v147, v151
v_cvt_pk_bf16_f32 v142, v146, v147
v_mul_f32 v148, v148, v151
v_mul_f32 v149, v149, v151
v_mfma_f32_16x16x32_bf16 v[150:153], v[108:111], v[90:93], v[206:209]
v_cvt_pk_bf16_f32 v143, v148, v149
v_rcp_f32 v167, v166
v_mfma_f32_16x16x32_bf16 v[146:149], v[102:105], v[90:93], 0
ds_write_b64 v212, v[142:143] offset:36864
v_mfma_f32_16x16x32_bf16 v[142:145], v[96:99], v[90:93], 0
v_mul_f32 v154, v154, v167
v_mul_f32 v155, v155, v167
v_mfma_f32_16x16x16_bf16 v[138:141], v[82:83], v[94:95], v[138:141]
v_cvt_pk_bf16_f32 v154, v154, v155
v_mul_f32 v156, v156, v167
v_mfma_f32_16x16x16_bf16 v[150:153], v[112:113], v[94:95], v[150:153]
v_mul_f32 v157, v157, v167
v_cvt_pk_bf16_f32 v155, v156, v157
v_mfma_f32_16x16x16_bf16 v[142:145], v[100:101], v[94:95], v[142:145]
v_mul_f32 v158, v158, v167
v_mul_f32 v159, v159, v167
v_mfma_f32_16x16x16_bf16 v[146:149], v[106:107], v[94:95], v[146:149]
s_waitcnt lgkmcnt(3)
v_cvt_pk_bf16_f32 v156, v158, v159
v_mul_f32 v160, v160, v167
v_mul_f32 v161, v161, v167
v_cvt_pk_bf16_f32 v157, v160, v161
v_mul_f32 v162, v162, v167
v_mul_f32 v163, v163, v167
v_cvt_pk_bf16_f32 v158, v162, v163
v_mul_f32 v164, v164, v167
v_mul_f32 v165, v165, v167
v_mfma_f32_16x16x32_bf16 v[166:169], v[108:111], v[72:75], v[206:209]
ds_write_b128 v211, v[154:157] offset:43008
v_mfma_f32_16x16x32_bf16 v[154:157], v[78:81], v[72:75], 0
v_cvt_pk_bf16_f32 v159, v164, v165
v_max3_f32 v220, v138, v139, v140
v_mfma_f32_16x16x32_bf16 v[162:165], v[102:105], v[72:75], 0
ds_write_b64 v212, v[158:159] offset:43008
v_mfma_f32_16x16x32_bf16 v[158:161], v[96:99], v[72:75], 0
s_waitcnt lgkmcnt(4)
v_max3_f32 v220, v220, v141, v142
v_max3_f32 v220, v220, v143, v144
v_mfma_f32_16x16x16_bf16 v[154:157], v[82:83], v[76:77], v[154:157]
v_max3_f32 v220, v220, v145, v146
v_max3_f32 v220, v220, v147, v148
v_mfma_f32_16x16x16_bf16 v[166:169], v[112:113], v[76:77], v[166:169]
v_max3_f32 v220, v220, v149, v150
v_mov_b32 v221, v220
v_mfma_f32_16x16x16_bf16 v[158:161], v[100:101], v[76:77], v[158:161]
s_nop 0
v_permlane16_swap_b32 v220, v221
v_mfma_f32_16x16x16_bf16 v[162:165], v[106:107], v[76:77], v[162:165]
v_max_f32 v220, v220, v221
v_mov_b32 v221, v220
s_nop 1
v_permlane32_swap_b32 v220, v221
v_max_f32 v220, v220, v221
v_sub_f32 v138, v138, v220
v_sub_f32 v139, v139, v220
v_sub_f32 v140, v140, v220
v_sub_f32 v141, v141, v220
v_sub_f32 v142, v142, v220
v_sub_f32 v143, v143, v220
v_sub_f32 v144, v144, v220
v_sub_f32 v145, v145, v220
v_sub_f32 v150, v150, v220
v_sub_f32 v146, v146, v220
v_sub_f32 v147, v147, v220
v_sub_f32 v148, v148, v220
v_sub_f32 v149, v149, v220
v_exp_f32 v138, v138
s_waitcnt lgkmcnt(0)
s_barrier
ds_read_b128 v[170:173], v210 offset:36864
ds_read_b128 v[182:185], v210 offset:37888
ds_read_b128 v[186:189], v210 offset:38912
v_exp_f32 v139, v139
v_exp_f32 v140, v140
v_exp_f32 v141, v141
v_exp_f32 v142, v142
v_exp_f32 v143, v143
v_exp_f32 v144, v144
v_exp_f32 v145, v145
v_exp_f32 v150, v150
v_exp_f32 v146, v146
v_exp_f32 v147, v147
v_exp_f32 v148, v148
s_waitcnt lgkmcnt(2)
v_mfma_f32_16x16x32_bf16 v[36:39], a[144:147], v[170:173], v[36:39]
v_exp_f32 v149, v149
v_mfma_f32_16x16x32_bf16 v[40:43], a[168:171], v[170:173], v[40:43]
v_cvt_pk_bf16_f32 v174, v138, v139
v_cvt_pk_bf16_f32 v175, v140, v141
v_mfma_f32_16x16x32_bf16 v[44:47], a[192:195], v[170:173], v[44:47]
s_waitcnt lgkmcnt(1)
ds_read_b128 v[170:173], v210 offset:39936
v_cvt_pk_bf16_f32 v176, v142, v143
v_mfma_f32_16x16x32_bf16 v[36:39], a[148:151], v[182:185], v[36:39]
v_cvt_pk_bf16_f32 v177, v144, v145
v_cvt_pk_bf16_f32 v178, v146, v147
v_mfma_f32_16x16x32_bf16 v[40:43], a[172:175], v[182:185], v[40:43]
v_cvt_pk_bf16_f32 v179, v148, v149
v_cvt_pk_bf16_f32 v180, v150, 0
v_mfma_f32_16x16x32_bf16 v[44:47], a[196:199], v[182:185], v[44:47]
s_waitcnt lgkmcnt(1)
ds_read_b128 v[182:185], v210 offset:40960
v_max3_f32 v220, v154, v155, v156
v_mfma_f32_16x16x32_bf16 v[36:39], a[152:155], v[186:189], v[36:39]
v_max3_f32 v220, v220, v157, v158
v_max3_f32 v220, v220, v159, v160
v_mfma_f32_16x16x32_bf16 v[40:43], a[176:179], v[186:189], v[40:43]
v_max3_f32 v220, v220, v161, v162
v_max3_f32 v220, v220, v163, v164
v_mfma_f32_16x16x32_bf16 v[44:47], a[200:203], v[186:189], v[44:47]
s_waitcnt lgkmcnt(1)
ds_read_b128 v[186:189], v210 offset:41984
v_max3_f32 v220, v220, v165, v166
v_mfma_f32_16x16x32_bf16 v[36:39], a[156:159], v[170:173], v[36:39]
v_mov_b32 v221, v220
v_mfma_f32_16x16x32_bf16 v[40:43], a[180:183], v[170:173], v[40:43]
s_nop 0
v_permlane16_swap_b32 v220, v221
v_mfma_f32_16x16x32_bf16 v[44:47], a[204:207], v[170:173], v[44:47]
s_waitcnt lgkmcnt(1)
ds_read_b128 v[170:173], v210 offset:43008
v_max_f32 v220, v220, v221
v_mfma_f32_16x16x32_bf16 v[36:39], a[160:163], v[182:185], v[36:39]
v_mov_b32 v221, v220
v_mfma_f32_16x16x32_bf16 v[40:43], a[184:187], v[182:185], v[40:43]
s_nop 0
v_permlane32_swap_b32 v220, v221
v_mfma_f32_16x16x32_bf16 v[44:47], a[208:211], v[182:185], v[44:47]
ds_read_b128 v[182:185], v210 offset:44032
v_max_f32 v220, v220, v221
v_mfma_f32_16x16x32_bf16 v[150:153], v[190:193], v[174:177], 0
v_sub_f32 v154, v154, v220
v_sub_f32 v155, v155, v220
v_mfma_f32_16x16x32_bf16 v[138:141], v[114:117], v[174:177], 0
v_sub_f32 v156, v156, v220
v_sub_f32 v157, v157, v220
v_mfma_f32_16x16x32_bf16 v[142:145], v[122:125], v[174:177], 0
v_sub_f32 v158, v158, v220
v_sub_f32 v159, v159, v220
v_mfma_f32_16x16x32_bf16 v[146:149], v[130:133], v[174:177], 0
s_waitcnt lgkmcnt(2)
v_sub_f32 v160, v160, v220
v_sub_f32 v161, v161, v220
v_mfma_f32_16x16x32_bf16 v[36:39], a[164:167], v[186:189], v[36:39]
v_sub_f32 v166, v166, v220
v_sub_f32 v162, v162, v220
v_mfma_f32_16x16x32_bf16 v[150:153], v[190:193], v[178:181], v[150:153]
v_sub_f32 v163, v163, v220
v_sub_f32 v164, v164, v220
v_mfma_f32_16x16x32_bf16 v[138:141], v[118:121], v[178:181], v[138:141]
v_sub_f32 v165, v165, v220
v_exp_f32 v154, v154
v_mfma_f32_16x16x32_bf16 v[40:43], a[188:191], v[186:189], v[40:43]
v_cvt_pk_bf16_f32 v36, v36, v37
v_cvt_pk_bf16_f32 v37, v38, v39
v_mfma_f32_16x16x32_bf16 v[142:145], v[126:129], v[178:181], v[142:145]
buffer_store_dwordx2 v[36:37], v203, s[8:11], s39 offen
v_mfma_f32_16x16x32_bf16 v[44:47], a[212:215], v[186:189], v[44:47]
ds_read_b128 v[186:189], v210 offset:45056
v_exp_f32 v155, v155
v_mfma_f32_16x16x32_bf16 v[146:149], v[134:137], v[178:181], v[146:149]
s_waitcnt lgkmcnt(2)
v_cvt_pk_bf16_f32 v40, v40, v41
v_cvt_pk_bf16_f32 v41, v42, v43
v_mfma_f32_16x16x32_bf16 v[48:51], a[144:147], v[170:173], v[48:51]
buffer_store_dwordx2 v[40:41], v203, s[8:11], s39 offen offset:32
v_mfma_f32_16x16x32_bf16 v[52:55], a[168:171], v[170:173], v[52:55]
v_cvt_pk_bf16_f32 v44, v44, v45
v_exp_f32 v156, v156
v_mfma_f32_16x16x32_bf16 v[56:59], a[192:195], v[170:173], v[56:59]
s_waitcnt lgkmcnt(1)
ds_read_b128 v[170:173], v210 offset:46080
v_cvt_pk_bf16_f32 v45, v46, v47
v_mfma_f32_16x16x32_bf16 v[48:51], a[148:151], v[182:185], v[48:51]
buffer_store_dwordx2 v[44:45], v203, s[8:11], s39 offen offset:64
v_mfma_f32_16x16x32_bf16 v[52:55], a[172:175], v[182:185], v[52:55]
v_exp_f32 v157, v157
v_mfma_f32_16x16x32_bf16 v[56:59], a[196:199], v[182:185], v[56:59]
s_waitcnt lgkmcnt(1)
ds_read_b128 v[182:185], v210 offset:47104
v_exp_f32 v158, v158
v_mfma_f32_16x16x32_bf16 v[48:51], a[152:155], v[186:189], v[48:51]
v_exp_f32 v159, v159
v_mfma_f32_16x16x32_bf16 v[52:55], a[176:179], v[186:189], v[52:55]
v_exp_f32 v160, v160
v_mfma_f32_16x16x32_bf16 v[56:59], a[200:203], v[186:189], v[56:59]
s_waitcnt lgkmcnt(1)
ds_read_b128 v[186:189], v210 offset:48128
v_exp_f32 v161, v161
v_mfma_f32_16x16x32_bf16 v[48:51], a[156:159], v[170:173], v[48:51]
v_exp_f32 v166, v166
v_mfma_f32_16x16x32_bf16 v[52:55], a[180:183], v[170:173], v[52:55]
v_exp_f32 v162, v162
v_mfma_f32_16x16x32_bf16 v[56:59], a[204:207], v[170:173], v[56:59]
s_waitcnt lgkmcnt(1)
v_exp_f32 v163, v163
v_mfma_f32_16x16x32_bf16 v[48:51], a[160:163], v[182:185], v[48:51]
v_exp_f32 v164, v164
v_mfma_f32_16x16x32_bf16 v[52:55], a[184:187], v[182:185], v[52:55]
v_exp_f32 v165, v165
v_mfma_f32_16x16x32_bf16 v[56:59], a[208:211], v[182:185], v[56:59]
s_waitcnt lgkmcnt(0)
v_cvt_pk_bf16_f32 v174, v154, v155
v_cvt_pk_bf16_f32 v175, v156, v157
v_mfma_f32_16x16x32_bf16 v[48:51], a[164:167], v[186:189], v[48:51]
v_cvt_pk_bf16_f32 v176, v158, v159
v_cvt_pk_bf16_f32 v177, v160, v161
v_mfma_f32_16x16x32_bf16 v[52:55], a[188:191], v[186:189], v[52:55]
v_cvt_pk_bf16_f32 v178, v162, v163
v_cvt_pk_bf16_f32 v179, v164, v165
v_mfma_f32_16x16x32_bf16 v[154:157], v[114:117], v[174:177], 0
v_cvt_pk_bf16_f32 v180, v166, 0
v_rcp_f32 v151, v150
v_mfma_f32_16x16x32_bf16 v[166:169], v[190:193], v[174:177], 0
v_mul_f32 v138, v138, v151
v_mul_f32 v139, v139, v151
v_mfma_f32_16x16x32_bf16 v[158:161], v[122:125], v[174:177], 0
v_cvt_pk_bf16_f32 v138, v138, v139
v_mul_f32 v140, v140, v151
v_mfma_f32_16x16x32_bf16 v[162:165], v[130:133], v[174:177], 0
v_mul_f32 v141, v141, v151
v_cvt_pk_bf16_f32 v139, v140, v141
v_mfma_f32_16x16x32_bf16 v[166:169], v[190:193], v[178:181], v[166:169]
v_mul_f32 v142, v142, v151
v_mul_f32 v143, v143, v151
v_mfma_f32_16x16x32_bf16 v[154:157], v[118:121], v[178:181], v[154:157]
v_cvt_pk_bf16_f32 v140, v142, v143
v_mul_f32 v144, v144, v151
v_mfma_f32_16x16x32_bf16 v[158:161], v[126:129], v[178:181], v[158:161]
v_mul_f32 v145, v145, v151
v_cvt_pk_bf16_f32 v141, v144, v145
v_mfma_f32_16x16x32_bf16 v[56:59], a[212:215], v[186:189], v[56:59]
ds_write_b128 v211, v[138:141] offset:49152
v_mfma_f32_16x16x32_bf16 v[162:165], v[134:137], v[178:181], v[162:165]
v_mul_f32 v146, v146, v151
v_mul_f32 v147, v147, v151
v_cvt_pk_bf16_f32 v142, v146, v147
v_mul_f32 v148, v148, v151
v_mul_f32 v149, v149, v151
v_cvt_pk_bf16_f32 v143, v148, v149
v_rcp_f32 v167, v166
ds_write_b64 v212, v[142:143] offset:49152
v_mul_f32 v154, v154, v167
v_mul_f32 v155, v155, v167
v_cvt_pk_bf16_f32 v154, v154, v155
v_mul_f32 v156, v156, v167
v_mul_f32 v157, v157, v167
v_cvt_pk_bf16_f32 v155, v156, v157
v_mul_f32 v158, v158, v167
v_mul_f32 v159, v159, v167
v_cvt_pk_bf16_f32 v156, v158, v159
v_mul_f32 v160, v160, v167
v_mul_f32 v161, v161, v167
v_cvt_pk_bf16_f32 v157, v160, v161
v_mul_f32 v162, v162, v167
v_mul_f32 v163, v163, v167
v_cvt_pk_bf16_f32 v158, v162, v163
v_mul_f32 v164, v164, v167
v_mul_f32 v165, v165, v167
v_cvt_pk_bf16_f32 v159, v164, v165
v_cvt_pk_bf16_f32 v48, v48, v49
v_cvt_pk_bf16_f32 v49, v50, v51
v_cvt_pk_bf16_f32 v52, v52, v53
v_cvt_pk_bf16_f32 v53, v54, v55
v_cvt_pk_bf16_f32 v56, v56, v57
ds_write_b128 v216, v[154:157]
ds_write_b64 v216, v[158:159] offset:16
buffer_store_dwordx2 v[48:49], v204, s[8:11], s39 offen
buffer_store_dwordx2 v[52:53], v204, s[8:11], s39 offen offset:32
v_add_u32 v216, 1408, v216
v_cvt_pk_bf16_f32 v57, v58, v59
s_waitcnt vmcnt(5) lgkmcnt(2)
s_barrier
ds_read_b128 v[170:173], v210 offset:49152
ds_read_b128 v[182:185], v210 offset:50176
ds_read_b128 v[186:189], v210 offset:51200
buffer_store_dwordx2 v[56:57], v204, s[8:11], s39 offen offset:64
ds_read_b128 v[174:177], v218
ds_read_b128 v[178:181], v218 offset:528
s_barrier
ds_read_b128 v[84:87], v200
ds_read_b128 v[92:95], v201
ds_read_b128 v[100:103], v202
ds_read_b128 v[88:91], v194 offset:16
ds_read_b128 v[96:99], v195 offset:16
ds_read_b128 v[104:107], v196 offset:16
s_waitcnt lgkmcnt(10)
v_mfma_f32_16x16x32_bf16 v[60:63], a[144:147], v[170:173], v[60:63]
v_mfma_f32_16x16x32_bf16 v[64:67], a[168:171], v[170:173], v[64:67]
v_mfma_f32_16x16x32_bf16 v[68:71], a[192:195], v[170:173], v[68:71]
s_waitcnt lgkmcnt(9)
ds_read_b128 v[170:173], v210 offset:52224
v_mfma_f32_16x16x32_bf16 v[60:63], a[148:151], v[182:185], v[60:63]
v_mfma_f32_16x16x32_bf16 v[64:67], a[172:175], v[182:185], v[64:67]
v_mfma_f32_16x16x32_bf16 v[68:71], a[196:199], v[182:185], v[68:71]
s_waitcnt lgkmcnt(9)
ds_read_b128 v[182:185], v210 offset:53248
v_mfma_f32_16x16x32_bf16 v[60:63], a[152:155], v[186:189], v[60:63]
v_mfma_f32_16x16x32_bf16 v[64:67], a[176:179], v[186:189], v[64:67]
v_mfma_f32_16x16x32_bf16 v[68:71], a[200:203], v[186:189], v[68:71]
s_waitcnt lgkmcnt(7)
ds_read_b128 v[186:189], v210 offset:54272
v_mfma_f32_16x16x32_bf16 v[36:39], v[174:177], v[84:87], 0
s_waitcnt lgkmcnt(7)
ds_read_b128 v[84:87], v194
v_mfma_f32_16x16x32_bf16 v[48:51], v[174:177], v[92:95], 0
s_waitcnt lgkmcnt(3)
ds_read_b128 v[92:95], v195
v_mfma_f32_16x16x32_bf16 v[60:63], a[156:159], v[170:173], v[60:63]
v_mfma_f32_16x16x32_bf16 v[64:67], a[180:183], v[170:173], v[64:67]
v_mfma_f32_16x16x32_bf16 v[68:71], a[204:207], v[170:173], v[68:71]
s_waitcnt lgkmcnt(3)
v_mfma_f32_16x16x32_bf16 v[60:63], a[160:163], v[182:185], v[60:63]
v_mfma_f32_16x16x32_bf16 v[64:67], a[184:187], v[182:185], v[64:67]
v_mfma_f32_16x16x32_bf16 v[68:71], a[208:211], v[182:185], v[68:71]
s_waitcnt lgkmcnt(2)
ds_read_b128 v[182:185], v210
v_mfma_f32_16x16x32_bf16 v[60:63], a[164:167], v[186:189], v[60:63]
v_mfma_f32_16x16x32_bf16 v[64:67], a[188:191], v[186:189], v[64:67]
v_mfma_f32_16x16x32_bf16 v[68:71], a[212:215], v[186:189], v[68:71]
s_waitcnt lgkmcnt(2)
ds_read_b128 v[186:189], v210 offset:1024
v_smfmac_f32_16x16x64_bf16 v[36:39], v[178:181], v[84:91], v207
s_waitcnt lgkmcnt(2)
s_nop 1
v_cvt_pk_bf16_f32 v60, v60, v61
v_cvt_pk_bf16_f32 v61, v62, v63
v_smfmac_f32_16x16x64_bf16 v[48:51], v[178:181], v[92:99], v207
buffer_store_dwordx2 v[60:61], v205, s[8:11], s39 offen
v_mfma_f32_16x16x32_bf16 v[60:63], v[174:177], v[100:103], 0
s_waitcnt lgkmcnt(1)
ds_read_b128 v[100:103], v196
ds_read_b128 v[174:177], v218 offset:1056
v_mfma_f32_16x16x32_bf16 v[138:141], a[0:3], v[182:185], 0
v_cvt_pk_bf16_f32 v64, v64, v65
v_cvt_pk_bf16_f32 v65, v66, v67
v_mfma_f32_16x16x32_bf16 v[142:145], a[24:27], v[182:185], 0
buffer_store_dwordx2 v[64:65], v205, s[8:11], s39 offen offset:32
v_mfma_f32_16x16x32_bf16 v[146:149], a[48:51], v[182:185], 0
ds_read_b128 v[84:87], v197
ds_read_b128 v[88:91], v197 offset:16
v_mfma_f32_16x16x32_bf16 v[150:153], a[216:219], v[182:185], 0
v_cvt_pk_bf16_f32 v68, v68, v69
v_cvt_pk_bf16_f32 v69, v70, v71
v_mfma_f32_16x16x32_bf16 v[154:157], a[240:243], v[182:185], 0
buffer_store_dwordx2 v[68:69], v205, s[8:11], s39 offen offset:64
v_mfma_f32_16x16x32_bf16 v[158:161], v[232:235], v[182:185], 0
ds_read_b128 v[92:95], v198
ds_read_b128 v[96:99], v198 offset:16
v_mfma_f32_16x16x32_bf16 v[162:165], v[182:185], a[72:75], 0
v_mfma_f32_16x16x32_bf16 v[166:169], v[182:185], a[96:99], 0
v_mfma_f32_16x16x32_bf16 v[170:173], v[182:185], a[120:123], 0
s_waitcnt lgkmcnt(6)
ds_read_b128 v[182:185], v210 offset:2048
v_mfma_f32_16x16x32_bf16 v[138:141], a[4:7], v[186:189], v[138:141]
v_mfma_f32_16x16x32_bf16 v[142:145], a[28:31], v[186:189], v[142:145]
v_mfma_f32_16x16x32_bf16 v[146:149], a[52:55], v[186:189], v[146:149]
v_mfma_f32_16x16x32_bf16 v[150:153], a[220:223], v[186:189], v[150:153]
v_mfma_f32_16x16x32_bf16 v[154:157], a[244:247], v[186:189], v[154:157]
s_mul_hi_u32 s41, s35, 58835169
s_mul_i32 s42, s41, 73
v_mfma_f32_16x16x32_bf16 v[158:161], v[236:239], v[186:189], v[158:161]
s_sub_u32 s42, s35, s42
s_mul_i32 s43, s41, 1373568
v_mfma_f32_16x16x32_bf16 v[162:165], v[186:189], a[76:79], v[162:165]
s_mul_i32 s51, s42, 2688
v_mfma_f32_16x16x32_bf16 v[166:169], v[186:189], a[100:103], v[166:169]
s_add_u32 s43, s43, s51
s_cmp_lt_u32 s35, s34
v_mfma_f32_16x16x32_bf16 v[170:173], v[186:189], a[124:127], v[170:173]
s_cselect_b32 s36, s43, 1879048192
ds_read_b128 v[186:189], v210 offset:3072
s_add_u32 s35, s35, 32
s_waitcnt lgkmcnt(1)
v_mfma_f32_16x16x32_bf16 v[138:141], a[8:11], v[182:185], v[138:141]
s_cmp_eq_u32 s42, 0
s_cselect_b32 s44, 536870911, s72
s_cmp_eq_u32 s42, 72
v_mfma_f32_16x16x32_bf16 v[142:145], a[32:35], v[182:185], v[142:145]
s_cselect_b32 s44, 939524095, s44
v_and_b32 v209, s44, v208
v_mfma_f32_16x16x32_bf16 v[146:149], a[56:59], v[182:185], v[146:149]
s_cmp_eq_u32 s41, 0
v_mfma_f32_16x16x32_bf16 v[150:153], a[224:227], v[182:185], v[150:153]
s_cselect_b32 s40, 1879048192, s36
s_add_u32 m0, s45, 0
v_mfma_f32_16x16x32_bf16 v[154:157], a[248:251], v[182:185], v[154:157]
v_smfmac_f32_16x16x64_bf16 v[60:63], v[178:181], v[100:107], v207
ds_read_b128 v[100:103], v199
ds_read_b128 v[104:107], v199 offset:16
v_mfma_f32_16x16x32_bf16 v[158:161], v[240:243], v[182:185], v[158:161]
ds_read_b128 v[178:181], v218 offset:1584
v_mfma_f32_16x16x32_bf16 v[162:165], v[182:185], a[80:83], v[162:165]
v_mfma_f32_16x16x32_bf16 v[166:169], v[182:185], a[104:107], v[166:169]
v_mfma_f32_16x16x32_bf16 v[170:173], v[182:185], a[128:131], v[170:173]
ds_read_b128 v[182:185], v210 offset:4096
v_smfmac_f32_16x16x64_bf16 v[36:39], v[174:177], v[84:91], v207
s_waitcnt lgkmcnt(4)
ds_read_b128 v[84:87], v200 offset:32
ds_read_b128 v[88:91], v194 offset:48
v_mfma_f32_16x16x32_bf16 v[138:141], a[12:15], v[186:189], v[138:141]
v_mfma_f32_16x16x32_bf16 v[142:145], a[36:39], v[186:189], v[142:145]
v_smfmac_f32_16x16x64_bf16 v[48:51], v[174:177], v[92:99], v207
ds_read_b128 v[92:95], v201 offset:32
ds_read_b128 v[96:99], v195 offset:48
v_mfma_f32_16x16x32_bf16 v[146:149], a[60:63], v[186:189], v[146:149]
v_add_f32 v118, v36, v37
v_mul_f32 v119, v36, v36
v_mfma_f32_16x16x32_bf16 v[150:153], a[228:231], v[186:189], v[150:153]
v_add_f32 v118, v118, v38
v_fmac_f32 v119, v37, v37
v_mfma_f32_16x16x32_bf16 v[154:157], a[252:255], v[186:189], v[154:157]
s_waitcnt lgkmcnt(6)
v_add_f32 v118, v118, v39
v_fmac_f32 v119, v38, v38
v_smfmac_f32_16x16x64_bf16 v[60:63], v[174:177], v[100:107], v207
ds_read_b128 v[100:103], v202 offset:32
ds_read_b128 v[174:177], v218 offset:2112
v_mfma_f32_16x16x32_bf16 v[158:161], v[244:247], v[186:189], v[158:161]
ds_read_b128 v[104:107], v196 offset:48
v_fmac_f32 v119, v39, v39
v_mfma_f32_16x16x32_bf16 v[162:165], v[186:189], a[84:87], v[162:165]
v_add_f32 v126, v48, v49
v_mul_f32 v127, v48, v48
v_mfma_f32_16x16x32_bf16 v[166:169], v[186:189], a[108:111], v[166:169]
s_waitcnt lgkmcnt(6)
v_add_f32 v126, v126, v50
v_fmac_f32 v127, v49, v49
v_mfma_f32_16x16x32_bf16 v[40:43], v[178:181], v[84:87], 0
ds_read_b128 v[84:87], v194 offset:32
v_add_f32 v126, v126, v51
v_mfma_f32_16x16x32_bf16 v[170:173], v[186:189], a[132:135], v[170:173]
s_waitcnt lgkmcnt(5)
ds_read_b128 v[186:189], v210 offset:5120
v_fmac_f32 v127, v50, v50
v_mfma_f32_16x16x32_bf16 v[52:55], v[178:181], v[92:95], 0
ds_read_b128 v[92:95], v195 offset:32
v_fmac_f32 v127, v51, v51
v_mfma_f32_16x16x32_bf16 v[138:141], a[16:19], v[182:185], v[138:141]
s_waitcnt lgkmcnt(5)
v_add_f32 v134, v60, v61
v_mul_f32 v135, v60, v60
v_mfma_f32_16x16x32_bf16 v[64:67], v[178:181], v[100:103], 0
ds_read_b128 v[100:103], v196 offset:32
ds_read_b128 v[178:181], v218 offset:2640
v_mfma_f32_16x16x32_bf16 v[142:145], a[40:43], v[182:185], v[142:145]
v_add_f32 v134, v134, v62
v_fmac_f32 v135, v61, v61
v_mfma_f32_16x16x32_bf16 v[146:149], a[64:67], v[182:185], v[146:149]
v_add_f32 v134, v134, v63
v_fmac_f32 v135, v62, v62
v_mfma_f32_16x16x32_bf16 v[150:153], a[232:235], v[182:185], v[150:153]
v_fmac_f32 v135, v63, v63
v_mfma_f32_16x16x32_bf16 v[154:157], v[224:227], v[182:185], v[154:157]
s_waitcnt lgkmcnt(4)
v_smfmac_f32_16x16x64_bf16 v[40:43], v[174:177], v[84:91], v207
ds_read_b128 v[84:87], v197 offset:32
ds_read_b128 v[88:91], v197 offset:48
v_mfma_f32_16x16x32_bf16 v[158:161], v[248:251], v[182:185], v[158:161]
v_mfma_f32_16x16x32_bf16 v[162:165], v[182:185], a[88:91], v[162:165]
v_mfma_f32_16x16x32_bf16 v[166:169], v[182:185], a[112:115], v[166:169]
s_waitcnt lgkmcnt(4)
v_smfmac_f32_16x16x64_bf16 v[52:55], v[174:177], v[92:99], v207
ds_read_b128 v[92:95], v198 offset:32
ds_read_b128 v[96:99], v198 offset:48
v_mfma_f32_16x16x32_bf16 v[170:173], v[182:185], a[136:139], v[170:173]
ds_read_b128 v[182:185], v210 offset:6144
v_mfma_f32_16x16x32_bf16 v[138:141], a[20:23], v[186:189], v[138:141]
s_waitcnt lgkmcnt(6)
v_smfmac_f32_16x16x64_bf16 v[64:67], v[174:177], v[100:107], v207
ds_read_b128 v[100:103], v199 offset:32
ds_read_b128 v[104:107], v199 offset:48
v_mfma_f32_16x16x32_bf16 v[142:145], a[44:47], v[186:189], v[142:145]
ds_read_b128 v[174:177], v218 offset:3168
v_mfma_f32_16x16x32_bf16 v[146:149], a[68:71], v[186:189], v[146:149]
s_nop 0
v_cvt_pk_bf16_f32 v78, v138, v139
v_cvt_pk_bf16_f32 v79, v140, v141
v_mfma_f32_16x16x32_bf16 v[150:153], a[236:239], v[186:189], v[150:153]
v_mfma_f32_16x16x32_bf16 v[154:157], v[228:231], v[186:189], v[154:157]
s_waitcnt lgkmcnt(6)
v_cvt_pk_bf16_f32 v80, v142, v143
v_cvt_pk_bf16_f32 v81, v144, v145
v_smfmac_f32_16x16x64_bf16 v[40:43], v[178:181], v[84:91], v207
ds_read_b128 v[84:87], v200 offset:64
v_cvt_pk_bf16_f32 v82, v146, v147
v_mfma_f32_16x16x32_bf16 v[158:161], v[252:255], v[186:189], v[158:161]
v_cvt_pk_bf16_f32 v83, v148, v149
v_cvt_pk_bf16_f32 v72, v150, v151
v_mfma_f32_16x16x32_bf16 v[162:165], v[186:189], a[92:95], v[162:165]
v_cvt_pk_bf16_f32 v73, v152, v153
v_cvt_pk_bf16_f32 v74, v154, v155
v_mfma_f32_16x16x32_bf16 v[166:169], v[186:189], a[116:119], v[166:169]
s_waitcnt lgkmcnt(5)
v_cvt_pk_bf16_f32 v75, v156, v157
v_add_f32 v118, v118, v40
v_smfmac_f32_16x16x64_bf16 v[52:55], v[178:181], v[92:99], v207
ds_read_b128 v[92:95], v201 offset:64
v_cvt_pk_bf16_f32 v76, v158, v159
v_mfma_f32_16x16x32_bf16 v[170:173], v[186:189], a[140:143], v[170:173]
s_waitcnt lgkmcnt(5)
ds_read_b128 v[186:189], v210 offset:7168
v_cvt_pk_bf16_f32 v77, v160, v161
v_mfma_f32_16x16x32_bf16 v[138:141], a[0:3], v[182:185], 0
v_cvt_pk_bf16_f32 v114, v162, v163
v_cvt_pk_bf16_f32 v115, v164, v165
v_mfma_f32_16x16x32_bf16 v[142:145], a[24:27], v[182:185], 0
s_waitcnt lgkmcnt(4)
ds_read_b128 v[88:91], v194 offset:80
v_cvt_pk_bf16_f32 v122, v166, v167
v_smfmac_f32_16x16x64_bf16 v[64:67], v[178:181], v[100:107], v207
ds_read_b128 v[100:103], v202 offset:64
ds_read_b128 v[178:181], v218 offset:3696
v_mfma_f32_16x16x32_bf16 v[146:149], a[48:51], v[182:185], 0
v_cvt_pk_bf16_f32 v123, v168, v169
v_cvt_pk_bf16_f32 v130, v170, v171
v_mfma_f32_16x16x32_bf16 v[150:153], a[216:219], v[182:185], 0
v_cvt_pk_bf16_f32 v131, v172, v173
v_fmac_f32 v119, v40, v40
v_mfma_f32_16x16x32_bf16 v[154:157], a[240:243], v[182:185], 0
s_waitcnt lgkmcnt(5)
ds_read_b128 v[96:99], v195 offset:80
ds_read_b128 v[104:107], v196 offset:80
v_mfma_f32_16x16x32_bf16 v[44:47], v[174:177], v[84:87], 0
ds_read_b128 v[84:87], v194 offset:64
v_add_f32 v118, v118, v41
v_mfma_f32_16x16x32_bf16 v[158:161], v[232:235], v[182:185], 0
v_fmac_f32 v119, v41, v41
v_add_f32 v118, v118, v42
v_mfma_f32_16x16x32_bf16 v[162:165], v[182:185], a[72:75], 0
s_waitcnt lgkmcnt(7)
v_fmac_f32 v119, v42, v42
v_add_f32 v118, v118, v43
v_mfma_f32_16x16x32_bf16 v[56:59], v[174:177], v[92:95], 0
ds_read_b128 v[92:95], v195 offset:64
v_fmac_f32 v119, v43, v43
v_mfma_f32_16x16x32_bf16 v[166:169], v[182:185], a[96:99], 0
v_add_f32 v126, v126, v52
v_fmac_f32 v127, v52, v52
v_mfma_f32_16x16x32_bf16 v[170:173], v[182:185], a[120:123], 0
s_waitcnt lgkmcnt(5)
ds_read_b128 v[182:185], v210 offset:8192
v_add_f32 v126, v126, v53
v_mfma_f32_16x16x32_bf16 v[68:71], v[174:177], v[100:103], 0
ds_read_b128 v[100:103], v196 offset:64
ds_read_b128 v[174:177], v218 offset:4224
v_mfma_f32_16x16x32_bf16 v[138:141], a[4:7], v[186:189], v[138:141]
v_fmac_f32 v127, v53, v53
v_add_f32 v126, v126, v54
v_mfma_f32_16x16x32_bf16 v[142:145], a[28:31], v[186:189], v[142:145]
v_fmac_f32 v127, v54, v54
v_add_f32 v126, v126, v55
v_mfma_f32_16x16x32_bf16 v[146:149], a[52:55], v[186:189], v[146:149]
s_waitcnt lgkmcnt(4)
v_fmac_f32 v127, v55, v55
v_add_f32 v134, v134, v64
v_smfmac_f32_16x16x64_bf16 v[44:47], v[178:181], v[84:91], v207
ds_read_b128 v[84:87], v197 offset:64
ds_read_b128 v[88:91], v197 offset:80
v_mfma_f32_16x16x32_bf16 v[150:153], a[220:223], v[186:189], v[150:153]
v_fmac_f32 v135, v64, v64
v_add_f32 v134, v134, v65
v_mfma_f32_16x16x32_bf16 v[154:157], a[244:247], v[186:189], v[154:157]
v_fmac_f32 v135, v65, v65
v_add_f32 v134, v134, v66
v_mfma_f32_16x16x32_bf16 v[158:161], v[236:239], v[186:189], v[158:161]
s_waitcnt lgkmcnt(5)
v_fmac_f32 v135, v66, v66
v_add_f32 v134, v134, v67
v_smfmac_f32_16x16x64_bf16 v[56:59], v[178:181], v[92:99], v207
ds_read_b128 v[92:95], v198 offset:64
ds_read_b128 v[96:99], v198 offset:80
v_mfma_f32_16x16x32_bf16 v[162:165], v[186:189], a[76:79], v[162:165]
v_fmac_f32 v135, v67, v67
v_mfma_f32_16x16x32_bf16 v[166:169], v[186:189], a[100:103], v[166:169]
ds_read_u16 v120, v217
ds_read_u16 v128, v217 offset:32
v_mfma_f32_16x16x32_bf16 v[170:173], v[186:189], a[124:127], v[170:173]
s_sub_u32 s46, s46, 1
s_cmp_lg_u32 s46, 0
s_cbranch_scc1 G_loop
ds_read_b128 v[186:189], v210 offset:9216
ds_read_u16 v136, v217 offset:64
s_waitcnt lgkmcnt(9)
v_smfmac_f32_16x16x64_bf16 v[68:71], v[178:181], v[100:107], v207
ds_read_b128 v[100:103], v199 offset:64
ds_read_b128 v[104:107], v199 offset:80
v_mfma_f32_16x16x32_bf16 v[138:141], a[8:11], v[182:185], v[138:141]
v_add_u32 v217, 1408, v217
v_mfma_f32_16x16x32_bf16 v[142:145], a[32:35], v[182:185], v[142:145]
v_mfma_f32_16x16x32_bf16 v[146:149], a[56:59], v[182:185], v[146:149]
s_waitcnt lgkmcnt(8)
v_smfmac_f32_16x16x64_bf16 v[44:47], v[174:177], v[84:91], v207
v_mfma_f32_16x16x32_bf16 v[150:153], a[224:227], v[182:185], v[150:153]
v_mfma_f32_16x16x32_bf16 v[154:157], a[248:251], v[182:185], v[154:157]
v_mfma_f32_16x16x32_bf16 v[158:161], v[240:243], v[182:185], v[158:161]
s_waitcnt lgkmcnt(6)
s_nop 3
v_add_f32 v118, v118, v44
v_fmac_f32 v119, v44, v44
v_smfmac_f32_16x16x64_bf16 v[56:59], v[174:177], v[92:99], v207
v_add_f32 v118, v118, v45
v_fmac_f32 v119, v45, v45
v_mfma_f32_16x16x32_bf16 v[162:165], v[182:185], a[80:83], v[162:165]
v_add_f32 v118, v118, v46
v_fmac_f32 v119, v46, v46
v_mfma_f32_16x16x32_bf16 v[166:169], v[182:185], a[104:107], v[166:169]
v_add_f32 v118, v118, v47
v_fmac_f32 v119, v47, v47
v_mfma_f32_16x16x32_bf16 v[170:173], v[182:185], a[128:131], v[170:173]
s_waitcnt lgkmcnt(0)
ds_read_b128 v[182:185], v210 offset:10240
v_add_f32 v126, v126, v56
v_smfmac_f32_16x16x64_bf16 v[68:71], v[174:177], v[100:107], v207
v_fmac_f32 v127, v56, v56
v_add_f32 v126, v126, v57
v_mfma_f32_16x16x32_bf16 v[138:141], a[12:15], v[186:189], v[138:141]
v_fmac_f32 v127, v57, v57
v_add_f32 v126, v126, v58
v_mfma_f32_16x16x32_bf16 v[142:145], a[36:39], v[186:189], v[142:145]
v_fmac_f32 v127, v58, v58
v_add_f32 v126, v126, v59
v_mfma_f32_16x16x32_bf16 v[146:149], a[60:63], v[186:189], v[146:149]
v_fmac_f32 v127, v59, v59
v_add_f32 v134, v134, v68
v_mfma_f32_16x16x32_bf16 v[150:153], a[228:231], v[186:189], v[150:153]
v_fmac_f32 v135, v68, v68
v_add_f32 v134, v134, v69
v_mfma_f32_16x16x32_bf16 v[154:157], a[252:255], v[186:189], v[154:157]
v_fmac_f32 v135, v69, v69
v_add_f32 v134, v134, v70
v_mfma_f32_16x16x32_bf16 v[158:161], v[244:247], v[186:189], v[158:161]
v_fmac_f32 v135, v70, v70
v_add_f32 v134, v134, v71
v_mfma_f32_16x16x32_bf16 v[162:165], v[186:189], a[84:87], v[162:165]
v_permlane16_swap_b32 v118, v119
v_mfma_f32_16x16x32_bf16 v[166:169], v[186:189], a[108:111], v[166:169]
v_fmac_f32 v135, v71, v71
v_add_f32 v118, v118, v119
v_mfma_f32_16x16x32_bf16 v[170:173], v[186:189], a[132:135], v[170:173]
s_waitcnt lgkmcnt(0)
ds_read_b128 v[186:189], v210 offset:11264
v_permlane16_swap_b32 v126, v127
v_mfma_f32_16x16x32_bf16 v[138:141], a[16:19], v[182:185], v[138:141]
v_add_f32 v126, v126, v127
v_permlane16_swap_b32 v134, v135
v_mfma_f32_16x16x32_bf16 v[142:145], a[40:43], v[182:185], v[142:145]
v_add_f32 v134, v134, v135
v_permlane32_swap_b32 v118, v126
v_mfma_f32_16x16x32_bf16 v[146:149], a[64:67], v[182:185], v[146:149]
v_add_f32 v118, v118, v126
v_mov_b32 v135, v134
v_mfma_f32_16x16x32_bf16 v[150:153], a[232:235], v[182:185], v[150:153]
ds_write_b32 v213, v118
v_mfma_f32_16x16x32_bf16 v[154:157], v[224:227], v[182:185], v[154:157]
v_permlane32_swap_b32 v134, v135
v_mfma_f32_16x16x32_bf16 v[158:161], v[248:251], v[182:185], v[158:161]
v_add_f32 v134, v134, v135
v_mfma_f32_16x16x32_bf16 v[162:165], v[182:185], a[88:91], v[162:165]
ds_write_b32 v213, v134 offset:512
v_mfma_f32_16x16x32_bf16 v[166:169], v[182:185], a[112:115], v[166:169]
v_mfma_f32_16x16x32_bf16 v[170:173], v[182:185], a[136:139], v[170:173]
s_waitcnt lgkmcnt(2)
ds_read_b128 v[182:185], v210 offset:12288
v_mfma_f32_16x16x32_bf16 v[138:141], a[20:23], v[186:189], v[138:141]
v_mfma_f32_16x16x32_bf16 v[142:145], a[44:47], v[186:189], v[142:145]
v_mfma_f32_16x16x32_bf16 v[146:149], a[68:71], v[186:189], v[146:149]
v_mfma_f32_16x16x32_bf16 v[150:153], a[236:239], v[186:189], v[150:153]
s_nop 4
v_cvt_pk_bf16_f32 v96, v138, v139
v_cvt_pk_bf16_f32 v97, v140, v141
v_mfma_f32_16x16x32_bf16 v[154:157], v[228:231], v[186:189], v[154:157]
s_waitcnt lgkmcnt(1)
v_cvt_pk_bf16_f32 v98, v142, v143
v_cvt_pk_bf16_f32 v99, v144, v145
v_mfma_f32_16x16x32_bf16 v[158:161], v[252:255], v[186:189], v[158:161]
s_barrier
ds_read_b128 v[174:177], v210 offset:55296
v_mfma_f32_16x16x32_bf16 v[162:165], v[186:189], a[92:95], v[162:165]
ds_read_b128 v[178:181], v210 offset:56320
buffer_load_dwordx4 v209, s[4:7], s40 offen nt lds
v_mfma_f32_16x16x32_bf16 v[166:169], v[186:189], a[116:119], v[166:169]
s_add_u32 s40, s36, 196224
v_cvt_pk_bf16_f32 v100, v146, v147
v_cvt_pk_bf16_f32 v101, v148, v149
v_mfma_f32_16x16x32_bf16 v[170:173], v[186:189], a[140:143], v[170:173]
s_add_u32 m0, s45, 4112
ds_read_b128 v[186:189], v210 offset:13312
v_cvt_pk_bf16_f32 v84, v150, v151
s_waitcnt lgkmcnt(3)
v_mfma_f32_16x16x32_bf16 v[138:141], a[0:3], v[182:185], 0
v_cvt_pk_bf16_f32 v85, v152, v153
v_cvt_pk_bf16_f32 v86, v154, v155
v_mfma_f32_16x16x32_bf16 v[142:145], a[24:27], v[182:185], 0
buffer_load_dwordx4 v209, s[4:7], s40 offen nt lds
v_mfma_f32_16x16x32_bf16 v[146:149], a[48:51], v[182:185], 0
s_add_u32 s40, s36, 392448
v_cvt_pk_bf16_f32 v87, v156, v157
v_cvt_pk_bf16_f32 v88, v158, v159
v_mfma_f32_16x16x32_bf16 v[150:153], a[216:219], v[182:185], 0
s_add_u32 m0, s45, 8224
v_cvt_pk_bf16_f32 v89, v160, v161
v_cvt_pk_bf16_f32 v116, v162, v163
v_mfma_f32_16x16x32_bf16 v[154:157], a[240:243], v[182:185], 0
v_cvt_pk_bf16_f32 v117, v164, v165
v_cvt_pk_bf16_f32 v124, v166, v167
v_mfma_f32_16x16x32_bf16 v[158:161], v[232:235], v[182:185], 0
s_waitcnt lgkmcnt(2)
buffer_load_dwordx4 v209, s[4:7], s40 offen nt lds
v_mfma_f32_16x16x32_bf16 v[162:165], v[182:185], a[72:75], 0
s_add_u32 s40, s36, 588672
v_cvt_pk_bf16_f32 v125, v168, v169
v_cvt_pk_bf16_f32 v132, v170, v171
v_mfma_f32_16x16x32_bf16 v[166:169], v[182:185], a[96:99], 0
s_add_u32 m0, s45, 12336
v_cvt_pk_bf16_f32 v133, v172, v173
v_add_f32 v174, v174, v175
v_mfma_f32_16x16x32_bf16 v[170:173], v[182:185], a[120:123], 0
s_waitcnt lgkmcnt(0)
buffer_load_dwordx4 v209, s[4:7], s40 offen nt lds
v_mfma_f32_16x16x32_bf16 v[138:141], a[4:7], v[186:189], v[138:141]
s_add_u32 s40, s36, 784896
v_add_f32 v178, v178, v179
v_add_f32 v176, v176, v177
v_mfma_f32_16x16x32_bf16 v[142:145], a[28:31], v[186:189], v[142:145]
s_add_u32 m0, s45, 16448
v_add_f32 v180, v180, v181
v_add_f32 v174, v174, v176
v_mfma_f32_16x16x32_bf16 v[146:149], a[52:55], v[186:189], v[146:149]
buffer_load_dwordx4 v209, s[4:7], s40 offen nt lds
v_mfma_f32_16x16x32_bf16 v[150:153], a[220:223], v[186:189], v[150:153]
s_add_u32 s40, s36, 981120
v_add_f32 v178, v178, v180
v_mul_f32 v175, s48, v174
v_mfma_f32_16x16x32_bf16 v[154:157], a[244:247], v[186:189], v[154:157]
s_add_u32 m0, s45, 20560
ds_read_b128 v[182:185], v210 offset:14336
buffer_load_dwordx4 v209, s[4:7], s40 offen nt lds
v_mfma_f32_16x16x32_bf16 v[158:161], v[236:239], v[186:189], v[158:161]
s_add_u32 s40, s36, 1177344
v_mul_f32 v178, s48, v178
v_fma_f32 v178, -v175, v175, v178
v_mfma_f32_16x16x32_bf16 v[162:165], v[186:189], a[76:79], v[162:165]
s_add_u32 m0, s45, 24672
v_max_f32 v178, 0, v178
v_add_f32 v178, s49, v178
v_mfma_f32_16x16x32_bf16 v[166:169], v[186:189], a[100:103], v[166:169]
s_waitcnt lgkmcnt(0)
buffer_load_dwordx4 v209, s[4:7], s40 offen nt lds
v_mfma_f32_16x16x32_bf16 v[170:173], v[186:189], a[124:127], v[170:173]
s_add_u32 s40, s36, 1373568
v_rsq_f32 v174, v178
s_add_u32 m0, s45, 28784
v_mul_f32_e64 v175, -v175, v174
ds_write_b64 v214, v[174:175]
v_mfma_f32_16x16x32_bf16 v[138:141], a[8:11], v[182:185], v[138:141]
ds_read_b64 v[118:119], v215
ds_read_b64 v[126:127], v215 offset:128
v_mfma_f32_16x16x32_bf16 v[142:145], a[32:35], v[182:185], v[142:145]
ds_read_b64 v[134:135], v215 offset:256
buffer_load_dwordx4 v209, s[4:7], s40 offen nt lds
v_mfma_f32_16x16x32_bf16 v[146:149], a[56:59], v[182:185], v[146:149]
s_add_u32 s40, s36, 1569792
ds_read_b128 v[186:189], v210 offset:15360
s_add_u32 m0, s45, 32896
v_mfma_f32_16x16x32_bf16 v[150:153], a[224:227], v[182:185], v[150:153]
buffer_load_dwordx4 v209, s[4:7], s40 offen nt lds
v_mfma_f32_16x16x32_bf16 v[154:157], a[248:251], v[182:185], v[154:157]
v_mov_b32 v181, 0
v_mfma_f32_16x16x32_bf16 v[158:161], v[240:243], v[182:185], v[158:161]
s_waitcnt lgkmcnt(3)
v_fma_f32 v108, v36, v118, v119
v_fma_f32 v109, v37, v118, v119
v_mfma_f32_16x16x32_bf16 v[162:165], v[182:185], a[80:83], v[162:165]
v_cvt_pk_bf16_f32 v90, v108, v109
v_fma_f32 v110, v38, v118, v119
v_mfma_f32_16x16x32_bf16 v[166:169], v[182:185], a[104:107], v[166:169]
v_fma_f32 v111, v39, v118, v119
v_cvt_pk_bf16_f32 v91, v110, v111
v_mfma_f32_16x16x32_bf16 v[170:173], v[182:185], a[128:131], v[170:173]
s_waitcnt lgkmcnt(0)
v_fma_f32 v112, v40, v118, v119
v_fma_f32 v113, v41, v118, v119
v_mfma_f32_16x16x32_bf16 v[138:141], a[12:15], v[186:189], v[138:141]
v_cvt_pk_bf16_f32 v92, v112, v113
v_fma_f32 v108, v42, v118, v119
v_mfma_f32_16x16x32_bf16 v[142:145], a[36:39], v[186:189], v[142:145]
v_fma_f32 v109, v43, v118, v119
v_cvt_pk_bf16_f32 v93, v108, v109
v_mfma_f32_16x16x32_bf16 v[146:149], a[60:63], v[186:189], v[146:149]
ds_write_b128 v211, v[90:93] offset:18432
v_mfma_f32_16x16x32_bf16 v[150:153], a[228:231], v[186:189], v[150:153]
ds_read_b128 v[182:185], v210 offset:16384
v_fma_f32 v110, v44, v118, v119
v_mfma_f32_16x16x32_bf16 v[154:157], a[252:255], v[186:189], v[154:157]
v_fma_f32 v111, v45, v118, v119
v_cvt_pk_bf16_f32 v94, v110, v111
v_mfma_f32_16x16x32_bf16 v[158:161], v[244:247], v[186:189], v[158:161]
v_fma_f32 v112, v46, v118, v119
v_fma_f32 v113, v47, v118, v119
v_mfma_f32_16x16x32_bf16 v[162:165], v[186:189], a[84:87], v[162:165]
v_cvt_pk_bf16_f32 v95, v112, v113
v_fma_f32 v108, v48, v126, v127
v_mfma_f32_16x16x32_bf16 v[166:169], v[186:189], a[108:111], v[166:169]
ds_write_b64 v212, v[94:95] offset:18432
v_mfma_f32_16x16x32_bf16 v[170:173], v[186:189], a[132:135], v[170:173]
v_fma_f32 v109, v49, v126, v127
v_cvt_pk_bf16_f32 v102, v108, v109
v_fma_f32 v110, v50, v126, v127
v_fma_f32 v111, v51, v126, v127
v_cvt_pk_bf16_f32 v103, v110, v111
v_fma_f32 v112, v52, v126, v127
v_fma_f32 v113, v53, v126, v127
v_cvt_pk_bf16_f32 v104, v112, v113
v_fma_f32 v108, v54, v126, v127
v_fma_f32 v109, v55, v126, v127
s_waitcnt lgkmcnt(1)
v_mfma_f32_16x16x32_bf16 v[138:141], a[16:19], v[182:185], v[138:141]
ds_read_b128 v[186:189], v210 offset:17408
v_cvt_pk_bf16_f32 v105, v108, v109
v_mfma_f32_16x16x32_bf16 v[142:145], a[40:43], v[182:185], v[142:145]
ds_write_b128 v211, v[102:105] offset:24576
v_mfma_f32_16x16x32_bf16 v[146:149], a[64:67], v[182:185], v[146:149]
v_fma_f32 v110, v56, v126, v127
v_fma_f32 v111, v57, v126, v127
v_mfma_f32_16x16x32_bf16 v[150:153], a[232:235], v[182:185], v[150:153]
v_cvt_pk_bf16_f32 v106, v110, v111
v_fma_f32 v112, v58, v126, v127
v_mfma_f32_16x16x32_bf16 v[154:157], v[224:227], v[182:185], v[154:157]
v_fma_f32 v113, v59, v126, v127
v_cvt_pk_bf16_f32 v107, v112, v113
v_mfma_f32_16x16x32_bf16 v[158:161], v[248:251], v[182:185], v[158:161]
ds_write_b64 v212, v[106:107] offset:24576
v_mfma_f32_16x16x32_bf16 v[162:165], v[182:185], a[88:91], v[162:165]
v_fma_f32 v108, v60, v134, v135
v_fma_f32 v109, v61, v134, v135
v_mfma_f32_16x16x32_bf16 v[166:169], v[182:185], a[112:115], v[166:169]
v_cvt_pk_bf16_f32 v90, v108, v109
v_fma_f32 v110, v62, v134, v135
v_mfma_f32_16x16x32_bf16 v[170:173], v[182:185], a[136:139], v[170:173]
s_waitcnt lgkmcnt(2)
v_fma_f32 v111, v63, v134, v135
v_cvt_pk_bf16_f32 v91, v110, v111
v_mfma_f32_16x16x32_bf16 v[138:141], a[20:23], v[186:189], v[138:141]
v_fma_f32 v112, v64, v134, v135
v_fma_f32 v113, v65, v134, v135
v_mfma_f32_16x16x32_bf16 v[142:145], a[44:47], v[186:189], v[142:145]
v_cvt_pk_bf16_f32 v92, v112, v113
v_fma_f32 v108, v66, v134, v135
v_mfma_f32_16x16x32_bf16 v[146:149], a[68:71], v[186:189], v[146:149]
v_fma_f32 v109, v67, v134, v135
v_cvt_pk_bf16_f32 v93, v108, v109
v_mfma_f32_16x16x32_bf16 v[150:153], a[236:239], v[186:189], v[150:153]
ds_write_b128 v211, v[90:93] offset:30720
v_mfma_f32_16x16x32_bf16 v[154:157], v[228:231], v[186:189], v[154:157]
v_fma_f32 v110, v68, v134, v135
v_fma_f32 v111, v69, v134, v135
v_mfma_f32_16x16x32_bf16 v[158:161], v[252:255], v[186:189], v[158:161]
v_cvt_pk_bf16_f32 v94, v110, v111
v_fma_f32 v112, v70, v134, v135
v_mfma_f32_16x16x32_bf16 v[162:165], v[186:189], a[92:95], v[162:165]
ds_read_b128 v[108:111], v216 offset:512
v_fma_f32 v113, v71, v134, v135
v_mfma_f32_16x16x32_bf16 v[166:169], v[186:189], a[116:119], v[166:169]
v_cvt_pk_bf16_f32 v95, v112, v113
v_cvt_pk_bf16_f32 v102, v138, v139
v_mfma_f32_16x16x32_bf16 v[170:173], v[186:189], a[140:143], v[170:173]
ds_read_b64 v[112:113], v216 offset:528
ds_write_b64 v212, v[94:95] offset:30720
v_cvt_pk_bf16_f32 v103, v140, v141
v_mfma_f32_16x16x32_bf16 v[138:141], v[78:81], v[72:75], 0
v_cvt_pk_bf16_f32 v104, v142, v143
v_cvt_pk_bf16_f32 v105, v144, v145
v_mfma_f32_16x16x32_bf16 v[142:145], v[96:99], v[72:75], 0
v_cvt_pk_bf16_f32 v106, v146, v147
v_cvt_pk_bf16_f32 v107, v148, v149
v_mfma_f32_16x16x32_bf16 v[146:149], v[102:105], v[72:75], 0
s_waitcnt lgkmcnt(2)
v_cvt_pk_bf16_f32 v90, v150, v151
v_cvt_pk_bf16_f32 v91, v152, v153
v_mfma_f32_16x16x32_bf16 v[150:153], v[108:111], v[72:75], v[206:209]
ds_read_b128 v[72:75], v216
v_cvt_pk_bf16_f32 v92, v154, v155
v_mfma_f32_16x16x16_bf16 v[138:141], v[82:83], v[76:77], v[138:141]
v_cvt_pk_bf16_f32 v93, v156, v157
v_cvt_pk_bf16_f32 v94, v158, v159
v_mfma_f32_16x16x16_bf16 v[142:145], v[100:101], v[76:77], v[142:145]
s_waitcnt lgkmcnt(2)
v_cvt_pk_bf16_f32 v95, v160, v161
v_cvt_pk_bf16_f32 v118, v162, v163
v_mfma_f32_16x16x16_bf16 v[150:153], v[112:113], v[76:77], v[150:153]
v_cvt_pk_bf16_f32 v119, v164, v165
v_cvt_pk_bf16_f32 v126, v166, v167
v_mfma_f32_16x16x16_bf16 v[146:149], v[106:107], v[76:77], v[146:149]
ds_read_b64 v[76:77], v216 offset:16
v_cvt_pk_bf16_f32 v127, v168, v169
v_mfma_f32_16x16x32_bf16 v[154:157], v[78:81], v[84:87], 0
v_cvt_pk_bf16_f32 v134, v170, v171
v_cvt_pk_bf16_f32 v135, v172, v173
v_mfma_f32_16x16x32_bf16 v[158:161], v[96:99], v[84:87], 0
v_max3_f32 v220, v138, v139, v140
v_max3_f32 v220, v220, v141, v142
v_mfma_f32_16x16x32_bf16 v[166:169], v[108:111], v[84:87], v[206:209]
v_max3_f32 v220, v220, v143, v144
v_max3_f32 v220, v220, v145, v146
v_mfma_f32_16x16x32_bf16 v[162:165], v[102:105], v[84:87], 0
v_max3_f32 v220, v220, v147, v148
v_max3_f32 v220, v220, v149, v150
v_mfma_f32_16x16x16_bf16 v[154:157], v[82:83], v[88:89], v[154:157]
v_mov_b32 v221, v220
v_mfma_f32_16x16x16_bf16 v[158:161], v[100:101], v[88:89], v[158:161]
s_nop 0
v_permlane16_swap_b32 v220, v221
v_mfma_f32_16x16x16_bf16 v[166:169], v[112:113], v[88:89], v[166:169]
v_max_f32 v220, v220, v221
v_mov_b32 v221, v220
v_mfma_f32_16x16x16_bf16 v[162:165], v[106:107], v[88:89], v[162:165]
s_nop 0
v_permlane32_swap_b32 v220, v221
v_max_f32 v220, v220, v221
v_sub_f32 v138, v138, v220
v_sub_f32 v139, v139, v220
v_sub_f32 v140, v140, v220
v_sub_f32 v141, v141, v220
v_sub_f32 v142, v142, v220
v_sub_f32 v143, v143, v220
v_sub_f32 v144, v144, v220
v_sub_f32 v145, v145, v220
v_sub_f32 v150, v150, v220
v_sub_f32 v146, v146, v220
v_sub_f32 v147, v147, v220
v_sub_f32 v148, v148, v220
v_sub_f32 v149, v149, v220
v_exp_f32 v138, v138
v_exp_f32 v139, v139
v_exp_f32 v140, v140
v_exp_f32 v141, v141
v_exp_f32 v142, v142
v_exp_f32 v143, v143
v_exp_f32 v144, v144
v_exp_f32 v145, v145
v_exp_f32 v150, v150
v_exp_f32 v146, v146
v_exp_f32 v147, v147
v_exp_f32 v148, v148
v_exp_f32 v149, v149
v_cvt_pk_bf16_f32 v174, v138, v139
v_cvt_pk_bf16_f32 v175, v140, v141
v_cvt_pk_bf16_f32 v176, v142, v143
v_cvt_pk_bf16_f32 v177, v144, v145
v_cvt_pk_bf16_f32 v178, v146, v147
v_cvt_pk_bf16_f32 v179, v148, v149
v_mfma_f32_16x16x32_bf16 v[138:141], v[114:117], v[174:177], 0
v_cvt_pk_bf16_f32 v180, v150, 0
v_max3_f32 v220, v154, v155, v156
v_mfma_f32_16x16x32_bf16 v[150:153], v[190:193], v[174:177], 0
v_max3_f32 v220, v220, v157, v158
v_max3_f32 v220, v220, v159, v160
v_mfma_f32_16x16x32_bf16 v[142:145], v[122:125], v[174:177], 0
v_max3_f32 v220, v220, v161, v162
v_max3_f32 v220, v220, v163, v164
v_mfma_f32_16x16x32_bf16 v[146:149], v[130:133], v[174:177], 0
v_max3_f32 v220, v220, v165, v166
v_mov_b32 v221, v220
v_mfma_f32_16x16x32_bf16 v[150:153], v[190:193], v[178:181], v[150:153]
s_nop 0
v_permlane16_swap_b32 v220, v221
v_mfma_f32_16x16x32_bf16 v[138:141], v[118:121], v[178:181], v[138:141]
v_max_f32 v220, v220, v221
v_mov_b32 v221, v220
v_mfma_f32_16x16x32_bf16 v[142:145], v[126:129], v[178:181], v[142:145]
s_nop 0
v_permlane32_swap_b32 v220, v221
v_mfma_f32_16x16x32_bf16 v[146:149], v[134:137], v[178:181], v[146:149]
v_max_f32 v220, v220, v221
v_sub_f32 v154, v154, v220
v_sub_f32 v155, v155, v220
v_sub_f32 v156, v156, v220
v_sub_f32 v157, v157, v220
v_sub_f32 v158, v158, v220
v_sub_f32 v159, v159, v220
v_sub_f32 v160, v160, v220
v_sub_f32 v161, v161, v220
v_sub_f32 v166, v166, v220
v_sub_f32 v162, v162, v220
v_sub_f32 v163, v163, v220
v_sub_f32 v164, v164, v220
v_sub_f32 v165, v165, v220
v_exp_f32 v154, v154
v_exp_f32 v155, v155
v_exp_f32 v156, v156
v_exp_f32 v157, v157
v_exp_f32 v158, v158
v_exp_f32 v159, v159
v_exp_f32 v160, v160
v_exp_f32 v161, v161
v_exp_f32 v166, v166
v_exp_f32 v162, v162
v_exp_f32 v163, v163
v_exp_f32 v164, v164
v_exp_f32 v165, v165
v_cvt_pk_bf16_f32 v174, v154, v155
v_cvt_pk_bf16_f32 v175, v156, v157
v_cvt_pk_bf16_f32 v176, v158, v159
v_cvt_pk_bf16_f32 v177, v160, v161
v_cvt_pk_bf16_f32 v178, v162, v163
v_cvt_pk_bf16_f32 v179, v164, v165
v_mfma_f32_16x16x32_bf16 v[154:157], v[114:117], v[174:177], 0
s_mov_b32 s39, s37
v_cvt_pk_bf16_f32 v180, v166, 0
v_rcp_f32 v151, v150
v_mfma_f32_16x16x32_bf16 v[166:169], v[190:193], v[174:177], 0
v_mul_f32 v138, v138, v151
v_mul_f32 v139, v139, v151
v_mfma_f32_16x16x32_bf16 v[158:161], v[122:125], v[174:177], 0
v_cvt_pk_bf16_f32 v138, v138, v139
v_mul_f32 v140, v140, v151
v_mfma_f32_16x16x32_bf16 v[162:165], v[130:133], v[174:177], 0
v_mul_f32 v141, v141, v151
v_cvt_pk_bf16_f32 v139, v140, v141
v_mfma_f32_16x16x32_bf16 v[166:169], v[190:193], v[178:181], v[166:169]
v_mul_f32 v142, v142, v151
v_mul_f32 v143, v143, v151
v_mfma_f32_16x16x32_bf16 v[154:157], v[118:121], v[178:181], v[154:157]
v_cvt_pk_bf16_f32 v140, v142, v143
v_mul_f32 v144, v144, v151
v_mfma_f32_16x16x32_bf16 v[158:161], v[126:129], v[178:181], v[158:161]
v_mul_f32 v145, v145, v151
v_cvt_pk_bf16_f32 v141, v144, v145
v_mfma_f32_16x16x32_bf16 v[162:165], v[134:137], v[178:181], v[162:165]
ds_write_b128 v211, v[138:141] offset:36864
v_mfma_f32_16x16x32_bf16 v[138:141], v[78:81], v[90:93], 0
v_mul_f32 v146, v146, v151
v_mul_f32 v147, v147, v151
v_cvt_pk_bf16_f32 v142, v146, v147
v_mul_f32 v148, v148, v151
v_mul_f32 v149, v149, v151
v_mfma_f32_16x16x32_bf16 v[150:153], v[108:111], v[90:93], v[206:209]
v_cvt_pk_bf16_f32 v143, v148, v149
v_rcp_f32 v167, v166
v_mfma_f32_16x16x32_bf16 v[146:149], v[102:105], v[90:93], 0
ds_write_b64 v212, v[142:143] offset:36864
v_mfma_f32_16x16x32_bf16 v[142:145], v[96:99], v[90:93], 0
v_mul_f32 v154, v154, v167
v_mul_f32 v155, v155, v167
v_mfma_f32_16x16x16_bf16 v[138:141], v[82:83], v[94:95], v[138:141]
v_cvt_pk_bf16_f32 v154, v154, v155
v_mul_f32 v156, v156, v167
v_mfma_f32_16x16x16_bf16 v[150:153], v[112:113], v[94:95], v[150:153]
v_mul_f32 v157, v157, v167
v_cvt_pk_bf16_f32 v155, v156, v157
v_mfma_f32_16x16x16_bf16 v[142:145], v[100:101], v[94:95], v[142:145]
v_mul_f32 v158, v158, v167
v_mul_f32 v159, v159, v167
v_mfma_f32_16x16x16_bf16 v[146:149], v[106:107], v[94:95], v[146:149]
s_waitcnt lgkmcnt(3)
v_cvt_pk_bf16_f32 v156, v158, v159
v_mul_f32 v160, v160, v167
v_mul_f32 v161, v161, v167
v_cvt_pk_bf16_f32 v157, v160, v161
v_mul_f32 v162, v162, v167
v_mul_f32 v163, v163, v167
v_cvt_pk_bf16_f32 v158, v162, v163
v_mul_f32 v164, v164, v167
v_mul_f32 v165, v165, v167
v_mfma_f32_16x16x32_bf16 v[166:169], v[108:111], v[72:75], v[206:209]
ds_write_b128 v211, v[154:157] offset:43008
v_mfma_f32_16x16x32_bf16 v[154:157], v[78:81], v[72:75], 0
v_cvt_pk_bf16_f32 v159, v164, v165
v_max3_f32 v220, v138, v139, v140
v_mfma_f32_16x16x32_bf16 v[162:165], v[102:105], v[72:75], 0
ds_write_b64 v212, v[158:159] offset:43008
v_mfma_f32_16x16x32_bf16 v[158:161], v[96:99], v[72:75], 0
s_waitcnt lgkmcnt(4)
v_max3_f32 v220, v220, v141, v142
v_max3_f32 v220, v220, v143, v144
v_mfma_f32_16x16x16_bf16 v[154:157], v[82:83], v[76:77], v[154:157]
v_max3_f32 v220, v220, v145, v146
v_max3_f32 v220, v220, v147, v148
v_mfma_f32_16x16x16_bf16 v[166:169], v[112:113], v[76:77], v[166:169]
v_max3_f32 v220, v220, v149, v150
v_mov_b32 v221, v220
v_mfma_f32_16x16x16_bf16 v[158:161], v[100:101], v[76:77], v[158:161]
s_nop 0
v_permlane16_swap_b32 v220, v221
v_mfma_f32_16x16x16_bf16 v[162:165], v[106:107], v[76:77], v[162:165]
v_max_f32 v220, v220, v221
v_mov_b32 v221, v220
s_nop 1
v_permlane32_swap_b32 v220, v221
v_max_f32 v220, v220, v221
v_sub_f32 v138, v138, v220
v_sub_f32 v139, v139, v220
v_sub_f32 v140, v140, v220
v_sub_f32 v141, v141, v220
v_sub_f32 v142, v142, v220
v_sub_f32 v143, v143, v220
v_sub_f32 v144, v144, v220
v_sub_f32 v145, v145, v220
v_sub_f32 v150, v150, v220
v_sub_f32 v146, v146, v220
v_sub_f32 v147, v147, v220
v_sub_f32 v148, v148, v220
v_sub_f32 v149, v149, v220
v_exp_f32 v138, v138
s_waitcnt lgkmcnt(0)
s_barrier
ds_read_b128 v[170:173], v210 offset:36864
ds_read_b128 v[182:185], v210 offset:37888
ds_read_b128 v[186:189], v210 offset:38912
v_exp_f32 v139, v139
v_exp_f32 v140, v140
v_exp_f32 v141, v141
v_exp_f32 v142, v142
v_exp_f32 v143, v143
v_exp_f32 v144, v144
v_exp_f32 v145, v145
v_exp_f32 v150, v150
v_exp_f32 v146, v146
v_exp_f32 v147, v147
v_exp_f32 v148, v148
s_waitcnt lgkmcnt(2)
v_mfma_f32_16x16x32_bf16 v[0:3], a[144:147], v[170:173], v[0:3]
v_exp_f32 v149, v149
v_mfma_f32_16x16x32_bf16 v[4:7], a[168:171], v[170:173], v[4:7]
v_cvt_pk_bf16_f32 v174, v138, v139
v_cvt_pk_bf16_f32 v175, v140, v141
v_mfma_f32_16x16x32_bf16 v[8:11], a[192:195], v[170:173], v[8:11]
s_waitcnt lgkmcnt(1)
ds_read_b128 v[170:173], v210 offset:39936
v_cvt_pk_bf16_f32 v176, v142, v143
v_mfma_f32_16x16x32_bf16 v[0:3], a[148:151], v[182:185], v[0:3]
v_cvt_pk_bf16_f32 v177, v144, v145
v_cvt_pk_bf16_f32 v178, v146, v147
v_mfma_f32_16x16x32_bf16 v[4:7], a[172:175], v[182:185], v[4:7]
v_cvt_pk_bf16_f32 v179, v148, v149
v_cvt_pk_bf16_f32 v180, v150, 0
v_mfma_f32_16x16x32_bf16 v[8:11], a[196:199], v[182:185], v[8:11]
s_waitcnt lgkmcnt(1)
ds_read_b128 v[182:185], v210 offset:40960
v_max3_f32 v220, v154, v155, v156
v_mfma_f32_16x16x32_bf16 v[0:3], a[152:155], v[186:189], v[0:3]
v_max3_f32 v220, v220, v157, v158
v_max3_f32 v220, v220, v159, v160
v_mfma_f32_16x16x32_bf16 v[4:7], a[176:179], v[186:189], v[4:7]
v_max3_f32 v220, v220, v161, v162
v_max3_f32 v220, v220, v163, v164
v_mfma_f32_16x16x32_bf16 v[8:11], a[200:203], v[186:189], v[8:11]
s_waitcnt lgkmcnt(1)
ds_read_b128 v[186:189], v210 offset:41984
v_max3_f32 v220, v220, v165, v166
v_mfma_f32_16x16x32_bf16 v[0:3], a[156:159], v[170:173], v[0:3]
v_mov_b32 v221, v220
v_mfma_f32_16x16x32_bf16 v[4:7], a[180:183], v[170:173], v[4:7]
s_nop 0
v_permlane16_swap_b32 v220, v221
v_mfma_f32_16x16x32_bf16 v[8:11], a[204:207], v[170:173], v[8:11]
s_waitcnt lgkmcnt(1)
ds_read_b128 v[170:173], v210 offset:43008
v_max_f32 v220, v220, v221
v_mfma_f32_16x16x32_bf16 v[0:3], a[160:163], v[182:185], v[0:3]
v_mov_b32 v221, v220
v_mfma_f32_16x16x32_bf16 v[4:7], a[184:187], v[182:185], v[4:7]
s_nop 0
v_permlane32_swap_b32 v220, v221
v_mfma_f32_16x16x32_bf16 v[8:11], a[208:211], v[182:185], v[8:11]
ds_read_b128 v[182:185], v210 offset:44032
v_max_f32 v220, v220, v221
v_mfma_f32_16x16x32_bf16 v[150:153], v[190:193], v[174:177], 0
v_sub_f32 v154, v154, v220
v_sub_f32 v155, v155, v220
v_mfma_f32_16x16x32_bf16 v[138:141], v[114:117], v[174:177], 0
v_sub_f32 v156, v156, v220
v_sub_f32 v157, v157, v220
v_mfma_f32_16x16x32_bf16 v[142:145], v[122:125], v[174:177], 0
v_sub_f32 v158, v158, v220
v_sub_f32 v159, v159, v220
v_mfma_f32_16x16x32_bf16 v[146:149], v[130:133], v[174:177], 0
s_waitcnt lgkmcnt(2)
v_sub_f32 v160, v160, v220
v_sub_f32 v161, v161, v220
v_mfma_f32_16x16x32_bf16 v[0:3], a[164:167], v[186:189], v[0:3]
v_sub_f32 v166, v166, v220
v_sub_f32 v162, v162, v220
v_mfma_f32_16x16x32_bf16 v[150:153], v[190:193], v[178:181], v[150:153]
v_sub_f32 v163, v163, v220
v_sub_f32 v164, v164, v220
v_mfma_f32_16x16x32_bf16 v[138:141], v[118:121], v[178:181], v[138:141]
v_sub_f32 v165, v165, v220
v_exp_f32 v154, v154
v_mfma_f32_16x16x32_bf16 v[4:7], a[188:191], v[186:189], v[4:7]
v_cvt_pk_bf16_f32 v0, v0, v1
v_cvt_pk_bf16_f32 v1, v2, v3
v_mfma_f32_16x16x32_bf16 v[142:145], v[126:129], v[178:181], v[142:145]
buffer_store_dwordx2 v[0:1], v203, s[8:11], s38 offen
v_mfma_f32_16x16x32_bf16 v[8:11], a[212:215], v[186:189], v[8:11]
ds_read_b128 v[186:189], v210 offset:45056
v_exp_f32 v155, v155
v_mfma_f32_16x16x32_bf16 v[146:149], v[134:137], v[178:181], v[146:149]
s_waitcnt lgkmcnt(2)
v_cvt_pk_bf16_f32 v4, v4, v5
v_cvt_pk_bf16_f32 v5, v6, v7
v_mfma_f32_16x16x32_bf16 v[12:15], a[144:147], v[170:173], v[12:15]
buffer_store_dwordx2 v[4:5], v203, s[8:11], s38 offen offset:32
v_mfma_f32_16x16x32_bf16 v[16:19], a[168:171], v[170:173], v[16:19]
v_cvt_pk_bf16_f32 v8, v8, v9
v_exp_f32 v156, v156
v_mfma_f32_16x16x32_bf16 v[20:23], a[192:195], v[170:173], v[20:23]
s_waitcnt lgkmcnt(1)
ds_read_b128 v[170:173], v210 offset:46080
v_cvt_pk_bf16_f32 v9, v10, v11
v_mfma_f32_16x16x32_bf16 v[12:15], a[148:151], v[182:185], v[12:15]
buffer_store_dwordx2 v[8:9], v203, s[8:11], s38 offen offset:64
v_mfma_f32_16x16x32_bf16 v[16:19], a[172:175], v[182:185], v[16:19]
v_exp_f32 v157, v157
v_mfma_f32_16x16x32_bf16 v[20:23], a[196:199], v[182:185], v[20:23]
s_waitcnt lgkmcnt(1)
ds_read_b128 v[182:185], v210 offset:47104
v_exp_f32 v158, v158
v_mfma_f32_16x16x32_bf16 v[12:15], a[152:155], v[186:189], v[12:15]
v_exp_f32 v159, v159
v_mfma_f32_16x16x32_bf16 v[16:19], a[176:179], v[186:189], v[16:19]
v_exp_f32 v160, v160
v_mfma_f32_16x16x32_bf16 v[20:23], a[200:203], v[186:189], v[20:23]
s_waitcnt lgkmcnt(1)
ds_read_b128 v[186:189], v210 offset:48128
v_exp_f32 v161, v161
v_mfma_f32_16x16x32_bf16 v[12:15], a[156:159], v[170:173], v[12:15]
v_exp_f32 v166, v166
v_mfma_f32_16x16x32_bf16 v[16:19], a[180:183], v[170:173], v[16:19]
v_exp_f32 v162, v162
v_mfma_f32_16x16x32_bf16 v[20:23], a[204:207], v[170:173], v[20:23]
s_waitcnt lgkmcnt(1)
v_exp_f32 v163, v163
v_mfma_f32_16x16x32_bf16 v[12:15], a[160:163], v[182:185], v[12:15]
v_exp_f32 v164, v164
v_mfma_f32_16x16x32_bf16 v[16:19], a[184:187], v[182:185], v[16:19]
v_exp_f32 v165, v165
v_mfma_f32_16x16x32_bf16 v[20:23], a[208:211], v[182:185], v[20:23]
s_waitcnt lgkmcnt(0)
v_cvt_pk_bf16_f32 v174, v154, v155
v_cvt_pk_bf16_f32 v175, v156, v157
v_mfma_f32_16x16x32_bf16 v[12:15], a[164:167], v[186:189], v[12:15]
v_cvt_pk_bf16_f32 v176, v158, v159
v_cvt_pk_bf16_f32 v177, v160, v161
v_mfma_f32_16x16x32_bf16 v[16:19], a[188:191], v[186:189], v[16:19]
v_cvt_pk_bf16_f32 v178, v162, v163
v_cvt_pk_bf16_f32 v179, v164, v165
v_mfma_f32_16x16x32_bf16 v[154:157], v[114:117], v[174:177], 0
v_cvt_pk_bf16_f32 v180, v166, 0
v_rcp_f32 v151, v150
v_mfma_f32_16x16x32_bf16 v[166:169], v[190:193], v[174:177], 0
v_mul_f32 v138, v138, v151
v_mul_f32 v139, v139, v151
v_mfma_f32_16x16x32_bf16 v[158:161], v[122:125], v[174:177], 0
v_cvt_pk_bf16_f32 v138, v138, v139
v_mul_f32 v140, v140, v151
v_mfma_f32_16x16x32_bf16 v[162:165], v[130:133], v[174:177], 0
v_mul_f32 v141, v141, v151
v_cvt_pk_bf16_f32 v139, v140, v141
v_mfma_f32_16x16x32_bf16 v[166:169], v[190:193], v[178:181], v[166:169]
v_mul_f32 v142, v142, v151
v_mul_f32 v143, v143, v151
v_mfma_f32_16x16x32_bf16 v[154:157], v[118:121], v[178:181], v[154:157]
v_cvt_pk_bf16_f32 v140, v142, v143
v_mul_f32 v144, v144, v151
v_mfma_f32_16x16x32_bf16 v[158:161], v[126:129], v[178:181], v[158:161]
v_mul_f32 v145, v145, v151
v_cvt_pk_bf16_f32 v141, v144, v145
v_mfma_f32_16x16x32_bf16 v[20:23], a[212:215], v[186:189], v[20:23]
ds_write_b128 v211, v[138:141] offset:49152
v_mfma_f32_16x16x32_bf16 v[162:165], v[134:137], v[178:181], v[162:165]
v_mul_f32 v146, v146, v151
v_mul_f32 v147, v147, v151
v_cvt_pk_bf16_f32 v142, v146, v147
v_mul_f32 v148, v148, v151
v_mul_f32 v149, v149, v151
v_cvt_pk_bf16_f32 v143, v148, v149
v_rcp_f32 v167, v166
ds_write_b64 v212, v[142:143] offset:49152
v_mul_f32 v154, v154, v167
v_mul_f32 v155, v155, v167
v_cvt_pk_bf16_f32 v154, v154, v155
v_mul_f32 v156, v156, v167
v_mul_f32 v157, v157, v167
v_cvt_pk_bf16_f32 v155, v156, v157
v_mul_f32 v158, v158, v167
v_mul_f32 v159, v159, v167
v_cvt_pk_bf16_f32 v156, v158, v159
v_mul_f32 v160, v160, v167
v_mul_f32 v161, v161, v167
v_cvt_pk_bf16_f32 v157, v160, v161
v_mul_f32 v162, v162, v167
v_mul_f32 v163, v163, v167
v_cvt_pk_bf16_f32 v158, v162, v163
v_mul_f32 v164, v164, v167
v_mul_f32 v165, v165, v167
v_cvt_pk_bf16_f32 v159, v164, v165
v_cvt_pk_bf16_f32 v12, v12, v13
v_cvt_pk_bf16_f32 v13, v14, v15
v_cvt_pk_bf16_f32 v16, v16, v17
v_cvt_pk_bf16_f32 v17, v18, v19
v_cvt_pk_bf16_f32 v20, v20, v21
ds_write_b128 v216, v[154:157]
ds_write_b64 v216, v[158:159] offset:16
buffer_store_dwordx2 v[12:13], v204, s[8:11], s38 offen
buffer_store_dwordx2 v[16:17], v204, s[8:11], s38 offen offset:32
v_add_u32 v216, 1408, v216
v_cvt_pk_bf16_f32 v21, v22, v23
s_waitcnt vmcnt(5) lgkmcnt(2)
s_barrier
ds_read_b128 v[170:173], v210 offset:49152
ds_read_b128 v[182:185], v210 offset:50176
ds_read_b128 v[186:189], v210 offset:51200
buffer_store_dwordx2 v[20:21], v204, s[8:11], s38 offen offset:64
ds_read_b128 v[174:177], v218
ds_read_b128 v[178:181], v218 offset:528
s_barrier
ds_read_b128 v[84:87], v200
ds_read_b128 v[92:95], v201
ds_read_b128 v[100:103], v202
ds_read_b128 v[88:91], v194 offset:16
ds_read_b128 v[96:99], v195 offset:16
ds_read_b128 v[104:107], v196 offset:16
s_waitcnt lgkmcnt(10)
v_mfma_f32_16x16x32_bf16 v[24:27], a[144:147], v[170:173], v[24:27]
v_mfma_f32_16x16x32_bf16 v[28:31], a[168:171], v[170:173], v[28:31]
v_mfma_f32_16x16x32_bf16 v[32:35], a[192:195], v[170:173], v[32:35]
s_waitcnt lgkmcnt(9)
ds_read_b128 v[170:173], v210 offset:52224
v_mfma_f32_16x16x32_bf16 v[24:27], a[148:151], v[182:185], v[24:27]
v_mfma_f32_16x16x32_bf16 v[28:31], a[172:175], v[182:185], v[28:31]
v_mfma_f32_16x16x32_bf16 v[32:35], a[196:199], v[182:185], v[32:35]
s_waitcnt lgkmcnt(9)
ds_read_b128 v[182:185], v210 offset:53248
v_mfma_f32_16x16x32_bf16 v[24:27], a[152:155], v[186:189], v[24:27]
v_mfma_f32_16x16x32_bf16 v[28:31], a[176:179], v[186:189], v[28:31]
v_mfma_f32_16x16x32_bf16 v[32:35], a[200:203], v[186:189], v[32:35]
s_waitcnt lgkmcnt(7)
ds_read_b128 v[186:189], v210 offset:54272
v_mfma_f32_16x16x32_bf16 v[0:3], v[174:177], v[84:87], 0
s_waitcnt lgkmcnt(7)
ds_read_b128 v[84:87], v194
v_mfma_f32_16x16x32_bf16 v[12:15], v[174:177], v[92:95], 0
s_waitcnt lgkmcnt(3)
ds_read_b128 v[92:95], v195
v_mfma_f32_16x16x32_bf16 v[24:27], a[156:159], v[170:173], v[24:27]
v_mfma_f32_16x16x32_bf16 v[28:31], a[180:183], v[170:173], v[28:31]
v_mfma_f32_16x16x32_bf16 v[32:35], a[204:207], v[170:173], v[32:35]
s_waitcnt lgkmcnt(3)
v_mfma_f32_16x16x32_bf16 v[24:27], a[160:163], v[182:185], v[24:27]
v_mfma_f32_16x16x32_bf16 v[28:31], a[184:187], v[182:185], v[28:31]
v_mfma_f32_16x16x32_bf16 v[32:35], a[208:211], v[182:185], v[32:35]
s_waitcnt lgkmcnt(2)
ds_read_b128 v[182:185], v210 offset:18432
v_mfma_f32_16x16x32_bf16 v[24:27], a[164:167], v[186:189], v[24:27]
v_mfma_f32_16x16x32_bf16 v[28:31], a[188:191], v[186:189], v[28:31]
v_mfma_f32_16x16x32_bf16 v[32:35], a[212:215], v[186:189], v[32:35]
s_waitcnt lgkmcnt(2)
ds_read_b128 v[186:189], v210 offset:19456
v_smfmac_f32_16x16x64_bf16 v[0:3], v[178:181], v[84:91], v207
s_waitcnt lgkmcnt(2)
s_nop 1
v_cvt_pk_bf16_f32 v24, v24, v25
v_cvt_pk_bf16_f32 v25, v26, v27
v_smfmac_f32_16x16x64_bf16 v[12:15], v[178:181], v[92:99], v207
buffer_store_dwordx2 v[24:25], v205, s[8:11], s38 offen
v_mfma_f32_16x16x32_bf16 v[24:27], v[174:177], v[100:103], 0
s_waitcnt lgkmcnt(1)
ds_read_b128 v[100:103], v196
ds_read_b128 v[174:177], v218 offset:1056
v_mfma_f32_16x16x32_bf16 v[138:141], a[0:3], v[182:185], 0
v_cvt_pk_bf16_f32 v28, v28, v29
v_cvt_pk_bf16_f32 v29, v30, v31
v_mfma_f32_16x16x32_bf16 v[142:145], a[24:27], v[182:185], 0
buffer_store_dwordx2 v[28:29], v205, s[8:11], s38 offen offset:32
v_mfma_f32_16x16x32_bf16 v[146:149], a[48:51], v[182:185], 0
ds_read_b128 v[84:87], v197
ds_read_b128 v[88:91], v197 offset:16
v_mfma_f32_16x16x32_bf16 v[150:153], a[216:219], v[182:185], 0
v_cvt_pk_bf16_f32 v32, v32, v33
v_cvt_pk_bf16_f32 v33, v34, v35
v_mfma_f32_16x16x32_bf16 v[154:157], a[240:243], v[182:185], 0
buffer_store_dwordx2 v[32:33], v205, s[8:11], s38 offen offset:64
v_mfma_f32_16x16x32_bf16 v[158:161], v[232:235], v[182:185], 0
ds_read_b128 v[92:95], v198
ds_read_b128 v[96:99], v198 offset:16
v_mfma_f32_16x16x32_bf16 v[162:165], v[182:185], a[72:75], 0
v_mfma_f32_16x16x32_bf16 v[166:169], v[182:185], a[96:99], 0
v_mfma_f32_16x16x32_bf16 v[170:173], v[182:185], a[120:123], 0
s_waitcnt lgkmcnt(6)
ds_read_b128 v[182:185], v210 offset:20480
v_mfma_f32_16x16x32_bf16 v[138:141], a[4:7], v[186:189], v[138:141]
v_mfma_f32_16x16x32_bf16 v[142:145], a[28:31], v[186:189], v[142:145]
v_mfma_f32_16x16x32_bf16 v[146:149], a[52:55], v[186:189], v[146:149]
v_mfma_f32_16x16x32_bf16 v[150:153], a[220:223], v[186:189], v[150:153]
v_mfma_f32_16x16x32_bf16 v[154:157], a[244:247], v[186:189], v[154:157]
v_mfma_f32_16x16x32_bf16 v[158:161], v[236:239], v[186:189], v[158:161]
v_mfma_f32_16x16x32_bf16 v[162:165], v[186:189], a[76:79], v[162:165]
v_mfma_f32_16x16x32_bf16 v[166:169], v[186:189], a[100:103], v[166:169]
v_mfma_f32_16x16x32_bf16 v[170:173], v[186:189], a[124:127], v[170:173]
s_waitcnt lgkmcnt(0)
ds_read_b128 v[186:189], v210 offset:21504
v_mfma_f32_16x16x32_bf16 v[138:141], a[8:11], v[182:185], v[138:141]
v_mfma_f32_16x16x32_bf16 v[142:145], a[32:35], v[182:185], v[142:145]
v_mfma_f32_16x16x32_bf16 v[146:149], a[56:59], v[182:185], v[146:149]
v_mfma_f32_16x16x32_bf16 v[150:153], a[224:227], v[182:185], v[150:153]
v_mfma_f32_16x16x32_bf16 v[154:157], a[248:251], v[182:185], v[154:157]
v_smfmac_f32_16x16x64_bf16 v[24:27], v[178:181], v[100:107], v207
ds_read_b128 v[100:103], v199
ds_read_b128 v[104:107], v199 offset:16
v_mfma_f32_16x16x32_bf16 v[158:161], v[240:243], v[182:185], v[158:161]
ds_read_b128 v[178:181], v218 offset:1584
v_mfma_f32_16x16x32_bf16 v[162:165], v[182:185], a[80:83], v[162:165]
v_mfma_f32_16x16x32_bf16 v[166:169], v[182:185], a[104:107], v[166:169]
v_mfma_f32_16x16x32_bf16 v[170:173], v[182:185], a[128:131], v[170:173]
ds_read_b128 v[182:185], v210 offset:22528
v_smfmac_f32_16x16x64_bf16 v[0:3], v[174:177], v[84:91], v207
s_waitcnt lgkmcnt(4)
ds_read_b128 v[84:87], v200 offset:32
ds_read_b128 v[88:91], v194 offset:48
v_mfma_f32_16x16x32_bf16 v[138:141], a[12:15], v[186:189], v[138:141]
v_mfma_f32_16x16x32_bf16 v[142:145], a[36:39], v[186:189], v[142:145]
v_smfmac_f32_16x16x64_bf16 v[12:15], v[174:177], v[92:99], v207
ds_read_b128 v[92:95], v201 offset:32
ds_read_b128 v[96:99], v195 offset:48
v_mfma_f32_16x16x32_bf16 v[146:149], a[60:63], v[186:189], v[146:149]
v_add_f32 v118, v0, v1
v_mul_f32 v119, v0, v0
v_mfma_f32_16x16x32_bf16 v[150:153], a[228:231], v[186:189], v[150:153]
v_add_f32 v118, v118, v2
v_fmac_f32 v119, v1, v1
v_mfma_f32_16x16x32_bf16 v[154:157], a[252:255], v[186:189], v[154:157]
s_waitcnt lgkmcnt(6)
v_add_f32 v118, v118, v3
v_fmac_f32 v119, v2, v2
v_smfmac_f32_16x16x64_bf16 v[24:27], v[174:177], v[100:107], v207
ds_read_b128 v[100:103], v202 offset:32
ds_read_b128 v[174:177], v218 offset:2112
v_mfma_f32_16x16x32_bf16 v[158:161], v[244:247], v[186:189], v[158:161]
ds_read_b128 v[104:107], v196 offset:48
v_fmac_f32 v119, v3, v3
v_mfma_f32_16x16x32_bf16 v[162:165], v[186:189], a[84:87], v[162:165]
v_add_f32 v126, v12, v13
v_mul_f32 v127, v12, v12
v_mfma_f32_16x16x32_bf16 v[166:169], v[186:189], a[108:111], v[166:169]
s_waitcnt lgkmcnt(6)
v_add_f32 v126, v126, v14
v_fmac_f32 v127, v13, v13
v_mfma_f32_16x16x32_bf16 v[4:7], v[178:181], v[84:87], 0
ds_read_b128 v[84:87], v194 offset:32
v_add_f32 v126, v126, v15
v_mfma_f32_16x16x32_bf16 v[170:173], v[186:189], a[132:135], v[170:173]
s_waitcnt lgkmcnt(5)
ds_read_b128 v[186:189], v210 offset:23552
v_fmac_f32 v127, v14, v14
v_mfma_f32_16x16x32_bf16 v[16:19], v[178:181], v[92:95], 0
ds_read_b128 v[92:95], v195 offset:32
v_fmac_f32 v127, v15, v15
v_mfma_f32_16x16x32_bf16 v[138:141], a[16:19], v[182:185], v[138:141]
s_waitcnt lgkmcnt(5)
v_add_f32 v134, v24, v25
v_mul_f32 v135, v24, v24
v_mfma_f32_16x16x32_bf16 v[28:31], v[178:181], v[100:103], 0
ds_read_b128 v[100:103], v196 offset:32
ds_read_b128 v[178:181], v218 offset:2640
v_mfma_f32_16x16x32_bf16 v[142:145], a[40:43], v[182:185], v[142:145]
v_add_f32 v134, v134, v26
v_fmac_f32 v135, v25, v25
v_mfma_f32_16x16x32_bf16 v[146:149], a[64:67], v[182:185], v[146:149]
v_add_f32 v134, v134, v27
v_fmac_f32 v135, v26, v26
v_mfma_f32_16x16x32_bf16 v[150:153], a[232:235], v[182:185], v[150:153]
v_fmac_f32 v135, v27, v27
v_mfma_f32_16x16x32_bf16 v[154:157], v[224:227], v[182:185], v[154:157]
s_waitcnt lgkmcnt(4)
v_smfmac_f32_16x16x64_bf16 v[4:7], v[174:177], v[84:91], v207
ds_read_b128 v[84:87], v197 offset:32
ds_read_b128 v[88:91], v197 offset:48
v_mfma_f32_16x16x32_bf16 v[158:161], v[248:251], v[182:185], v[158:161]
v_mfma_f32_16x16x32_bf16 v[162:165], v[182:185], a[88:91], v[162:165]
v_mfma_f32_16x16x32_bf16 v[166:169], v[182:185], a[112:115], v[166:169]
s_waitcnt lgkmcnt(4)
v_smfmac_f32_16x16x64_bf16 v[16:19], v[174:177], v[92:99], v207
ds_read_b128 v[92:95], v198 offset:32
ds_read_b128 v[96:99], v198 offset:48
v_mfma_f32_16x16x32_bf16 v[170:173], v[182:185], a[136:139], v[170:173]
ds_read_b128 v[182:185], v210 offset:24576
v_mfma_f32_16x16x32_bf16 v[138:141], a[20:23], v[186:189], v[138:141]
s_waitcnt lgkmcnt(6)
v_smfmac_f32_16x16x64_bf16 v[28:31], v[174:177], v[100:107], v207
ds_read_b128 v[100:103], v199 offset:32
ds_read_b128 v[104:107], v199 offset:48
v_mfma_f32_16x16x32_bf16 v[142:145], a[44:47], v[186:189], v[142:145]
ds_read_b128 v[174:177], v218 offset:3168
v_mfma_f32_16x16x32_bf16 v[146:149], a[68:71], v[186:189], v[146:149]
s_nop 0
v_cvt_pk_bf16_f32 v78, v138, v139
v_cvt_pk_bf16_f32 v79, v140, v141
v_mfma_f32_16x16x32_bf16 v[150:153], a[236:239], v[186:189], v[150:153]
v_mfma_f32_16x16x32_bf16 v[154:157], v[228:231], v[186:189], v[154:157]
s_waitcnt lgkmcnt(6)
v_cvt_pk_bf16_f32 v80, v142, v143
v_cvt_pk_bf16_f32 v81, v144, v145
v_smfmac_f32_16x16x64_bf16 v[4:7], v[178:181], v[84:91], v207
ds_read_b128 v[84:87], v200 offset:64
v_cvt_pk_bf16_f32 v82, v146, v147
v_mfma_f32_16x16x32_bf16 v[158:161], v[252:255], v[186:189], v[158:161]
v_cvt_pk_bf16_f32 v83, v148, v149
v_cvt_pk_bf16_f32 v72, v150, v151
v_mfma_f32_16x16x32_bf16 v[162:165], v[186:189], a[92:95], v[162:165]
v_cvt_pk_bf16_f32 v73, v152, v153
v_cvt_pk_bf16_f32 v74, v154, v155
v_mfma_f32_16x16x32_bf16 v[166:169], v[186:189], a[116:119], v[166:169]
s_waitcnt lgkmcnt(5)
v_cvt_pk_bf16_f32 v75, v156, v157
v_add_f32 v118, v118, v4
v_smfmac_f32_16x16x64_bf16 v[16:19], v[178:181], v[92:99], v207
ds_read_b128 v[92:95], v201 offset:64
v_cvt_pk_bf16_f32 v76, v158, v159
v_mfma_f32_16x16x32_bf16 v[170:173], v[186:189], a[140:143], v[170:173]
s_waitcnt lgkmcnt(5)
ds_read_b128 v[186:189], v210 offset:25600
v_cvt_pk_bf16_f32 v77, v160, v161
v_mfma_f32_16x16x32_bf16 v[138:141], a[0:3], v[182:185], 0
v_cvt_pk_bf16_f32 v114, v162, v163
v_cvt_pk_bf16_f32 v115, v164, v165
v_mfma_f32_16x16x32_bf16 v[142:145], a[24:27], v[182:185], 0
s_waitcnt lgkmcnt(4)
ds_read_b128 v[88:91], v194 offset:80
v_cvt_pk_bf16_f32 v122, v166, v167
v_smfmac_f32_16x16x64_bf16 v[28:31], v[178:181], v[100:107], v207
ds_read_b128 v[100:103], v202 offset:64
ds_read_b128 v[178:181], v218 offset:3696
v_mfma_f32_16x16x32_bf16 v[146:149], a[48:51], v[182:185], 0
v_cvt_pk_bf16_f32 v123, v168, v169
v_cvt_pk_bf16_f32 v130, v170, v171
v_mfma_f32_16x16x32_bf16 v[150:153], a[216:219], v[182:185], 0
v_cvt_pk_bf16_f32 v131, v172, v173
v_fmac_f32 v119, v4, v4
v_mfma_f32_16x16x32_bf16 v[154:157], a[240:243], v[182:185], 0
s_waitcnt lgkmcnt(5)
ds_read_b128 v[96:99], v195 offset:80
ds_read_b128 v[104:107], v196 offset:80
v_mfma_f32_16x16x32_bf16 v[8:11], v[174:177], v[84:87], 0
ds_read_b128 v[84:87], v194 offset:64
v_add_f32 v118, v118, v5
v_mfma_f32_16x16x32_bf16 v[158:161], v[232:235], v[182:185], 0
v_fmac_f32 v119, v5, v5
v_add_f32 v118, v118, v6
v_mfma_f32_16x16x32_bf16 v[162:165], v[182:185], a[72:75], 0
s_waitcnt lgkmcnt(7)
v_fmac_f32 v119, v6, v6
v_add_f32 v118, v118, v7
v_mfma_f32_16x16x32_bf16 v[20:23], v[174:177], v[92:95], 0
ds_read_b128 v[92:95], v195 offset:64
v_fmac_f32 v119, v7, v7
v_mfma_f32_16x16x32_bf16 v[166:169], v[182:185], a[96:99], 0
v_add_f32 v126, v126, v16
v_fmac_f32 v127, v16, v16
v_mfma_f32_16x16x32_bf16 v[170:173], v[182:185], a[120:123], 0
s_waitcnt lgkmcnt(5)
ds_read_b128 v[182:185], v210 offset:26624
v_add_f32 v126, v126, v17
v_mfma_f32_16x16x32_bf16 v[32:35], v[174:177], v[100:103], 0
ds_read_b128 v[100:103], v196 offset:64
ds_read_b128 v[174:177], v218 offset:4224
v_mfma_f32_16x16x32_bf16 v[138:141], a[4:7], v[186:189], v[138:141]
v_fmac_f32 v127, v17, v17
v_add_f32 v126, v126, v18
v_mfma_f32_16x16x32_bf16 v[142:145], a[28:31], v[186:189], v[142:145]
v_fmac_f32 v127, v18, v18
v_add_f32 v126, v126, v19
v_mfma_f32_16x16x32_bf16 v[146:149], a[52:55], v[186:189], v[146:149]
s_waitcnt lgkmcnt(4)
v_fmac_f32 v127, v19, v19
v_add_f32 v134, v134, v28
v_smfmac_f32_16x16x64_bf16 v[8:11], v[178:181], v[84:91], v207
ds_read_b128 v[84:87], v197 offset:64
ds_read_b128 v[88:91], v197 offset:80
v_mfma_f32_16x16x32_bf16 v[150:153], a[220:223], v[186:189], v[150:153]
v_fmac_f32 v135, v28, v28
v_add_f32 v134, v134, v29
v_mfma_f32_16x16x32_bf16 v[154:157], a[244:247], v[186:189], v[154:157]
v_fmac_f32 v135, v29, v29
v_add_f32 v134, v134, v30
v_mfma_f32_16x16x32_bf16 v[158:161], v[236:239], v[186:189], v[158:161]
s_waitcnt lgkmcnt(5)
v_fmac_f32 v135, v30, v30
v_add_f32 v134, v134, v31
v_smfmac_f32_16x16x64_bf16 v[20:23], v[178:181], v[92:99], v207
ds_read_b128 v[92:95], v198 offset:64
ds_read_b128 v[96:99], v198 offset:80
v_mfma_f32_16x16x32_bf16 v[162:165], v[186:189], a[76:79], v[162:165]
v_fmac_f32 v135, v31, v31
v_mfma_f32_16x16x32_bf16 v[166:169], v[186:189], a[100:103], v[166:169]
ds_read_u16 v120, v217
ds_read_u16 v128, v217 offset:32
v_mfma_f32_16x16x32_bf16 v[170:173], v[186:189], a[124:127], v[170:173]
ds_read_b128 v[186:189], v210 offset:27648
ds_read_u16 v136, v217 offset:64
s_waitcnt lgkmcnt(9)
v_smfmac_f32_16x16x64_bf16 v[32:35], v[178:181], v[100:107], v207
ds_read_b128 v[100:103], v199 offset:64
ds_read_b128 v[104:107], v199 offset:80
v_mfma_f32_16x16x32_bf16 v[138:141], a[8:11], v[182:185], v[138:141]
v_add_u32 v217, 1408, v217
v_mfma_f32_16x16x32_bf16 v[142:145], a[32:35], v[182:185], v[142:145]
v_mfma_f32_16x16x32_bf16 v[146:149], a[56:59], v[182:185], v[146:149]
s_waitcnt lgkmcnt(8)
v_smfmac_f32_16x16x64_bf16 v[8:11], v[174:177], v[84:91], v207
v_mfma_f32_16x16x32_bf16 v[150:153], a[224:227], v[182:185], v[150:153]
v_mfma_f32_16x16x32_bf16 v[154:157], a[248:251], v[182:185], v[154:157]
v_mfma_f32_16x16x32_bf16 v[158:161], v[240:243], v[182:185], v[158:161]
s_waitcnt lgkmcnt(6)
s_nop 3
v_add_f32 v118, v118, v8
v_fmac_f32 v119, v8, v8
v_smfmac_f32_16x16x64_bf16 v[20:23], v[174:177], v[92:99], v207
v_add_f32 v118, v118, v9
v_fmac_f32 v119, v9, v9
v_mfma_f32_16x16x32_bf16 v[162:165], v[182:185], a[80:83], v[162:165]
v_add_f32 v118, v118, v10
v_fmac_f32 v119, v10, v10
v_mfma_f32_16x16x32_bf16 v[166:169], v[182:185], a[104:107], v[166:169]
v_add_f32 v118, v118, v11
v_fmac_f32 v119, v11, v11
v_mfma_f32_16x16x32_bf16 v[170:173], v[182:185], a[128:131], v[170:173]
s_waitcnt lgkmcnt(0)
ds_read_b128 v[182:185], v210 offset:28672
v_add_f32 v126, v126, v20
v_smfmac_f32_16x16x64_bf16 v[32:35], v[174:177], v[100:107], v207
v_fmac_f32 v127, v20, v20
v_add_f32 v126, v126, v21
v_mfma_f32_16x16x32_bf16 v[138:141], a[12:15], v[186:189], v[138:141]
v_fmac_f32 v127, v21, v21
v_add_f32 v126, v126, v22
v_mfma_f32_16x16x32_bf16 v[142:145], a[36:39], v[186:189], v[142:145]
v_fmac_f32 v127, v22, v22
v_add_f32 v126, v126, v23
v_mfma_f32_16x16x32_bf16 v[146:149], a[60:63], v[186:189], v[146:149]
v_fmac_f32 v127, v23, v23
v_add_f32 v134, v134, v32
v_mfma_f32_16x16x32_bf16 v[150:153], a[228:231], v[186:189], v[150:153]
v_fmac_f32 v135, v32, v32
v_add_f32 v134, v134, v33
v_mfma_f32_16x16x32_bf16 v[154:157], a[252:255], v[186:189], v[154:157]
v_fmac_f32 v135, v33, v33
v_add_f32 v134, v134, v34
v_mfma_f32_16x16x32_bf16 v[158:161], v[244:247], v[186:189], v[158:161]
v_fmac_f32 v135, v34, v34
v_add_f32 v134, v134, v35
v_mfma_f32_16x16x32_bf16 v[162:165], v[186:189], a[84:87], v[162:165]
v_permlane16_swap_b32 v118, v119
v_mfma_f32_16x16x32_bf16 v[166:169], v[186:189], a[108:111], v[166:169]
v_fmac_f32 v135, v35, v35
v_add_f32 v118, v118, v119
v_mfma_f32_16x16x32_bf16 v[170:173], v[186:189], a[132:135], v[170:173]
s_waitcnt lgkmcnt(0)
ds_read_b128 v[186:189], v210 offset:29696
v_permlane16_swap_b32 v126, v127
v_mfma_f32_16x16x32_bf16 v[138:141], a[16:19], v[182:185], v[138:141]
v_add_f32 v126, v126, v127
v_permlane16_swap_b32 v134, v135
v_mfma_f32_16x16x32_bf16 v[142:145], a[40:43], v[182:185], v[142:145]
v_add_f32 v134, v134, v135
v_permlane32_swap_b32 v118, v126
v_mfma_f32_16x16x32_bf16 v[146:149], a[64:67], v[182:185], v[146:149]
v_add_f32 v118, v118, v126
v_mov_b32 v135, v134
v_mfma_f32_16x16x32_bf16 v[150:153], a[232:235], v[182:185], v[150:153]
ds_write_b32 v213, v118
v_mfma_f32_16x16x32_bf16 v[154:157], v[224:227], v[182:185], v[154:157]
v_permlane32_swap_b32 v134, v135
v_mfma_f32_16x16x32_bf16 v[158:161], v[248:251], v[182:185], v[158:161]
v_add_f32 v134, v134, v135
v_mfma_f32_16x16x32_bf16 v[162:165], v[182:185], a[88:91], v[162:165]
ds_write_b32 v213, v134 offset:512
v_mfma_f32_16x16x32_bf16 v[166:169], v[182:185], a[112:115], v[166:169]
v_mfma_f32_16x16x32_bf16 v[170:173], v[182:185], a[136:139], v[170:173]
s_waitcnt lgkmcnt(2)
ds_read_b128 v[182:185], v210 offset:30720
v_mfma_f32_16x16x32_bf16 v[138:141], a[20:23], v[186:189], v[138:141]
v_mfma_f32_16x16x32_bf16 v[142:145], a[44:47], v[186:189], v[142:145]
v_mfma_f32_16x16x32_bf16 v[146:149], a[68:71], v[186:189], v[146:149]
v_mfma_f32_16x16x32_bf16 v[150:153], a[236:239], v[186:189], v[150:153]
s_nop 4
v_cvt_pk_bf16_f32 v96, v138, v139
v_cvt_pk_bf16_f32 v97, v140, v141
v_mfma_f32_16x16x32_bf16 v[154:157], v[228:231], v[186:189], v[154:157]
s_waitcnt lgkmcnt(1)
v_cvt_pk_bf16_f32 v98, v142, v143
v_cvt_pk_bf16_f32 v99, v144, v145
v_mfma_f32_16x16x32_bf16 v[158:161], v[252:255], v[186:189], v[158:161]
s_barrier
ds_read_b128 v[174:177], v210 offset:55296
v_mfma_f32_16x16x32_bf16 v[162:165], v[186:189], a[92:95], v[162:165]
ds_read_b128 v[178:181], v210 offset:56320
v_mfma_f32_16x16x32_bf16 v[166:169], v[186:189], a[116:119], v[166:169]
v_cvt_pk_bf16_f32 v100, v146, v147
v_cvt_pk_bf16_f32 v101, v148, v149
v_mfma_f32_16x16x32_bf16 v[170:173], v[186:189], a[140:143], v[170:173]
s_waitcnt lgkmcnt(2)
ds_read_b128 v[186:189], v210 offset:31744
v_cvt_pk_bf16_f32 v84, v150, v151
v_mfma_f32_16x16x32_bf16 v[138:141], a[0:3], v[182:185], 0
v_cvt_pk_bf16_f32 v85, v152, v153
v_cvt_pk_bf16_f32 v86, v154, v155
v_mfma_f32_16x16x32_bf16 v[142:145], a[24:27], v[182:185], 0
v_mfma_f32_16x16x32_bf16 v[146:149], a[48:51], v[182:185], 0
v_cvt_pk_bf16_f32 v87, v156, v157
v_cvt_pk_bf16_f32 v88, v158, v159
v_mfma_f32_16x16x32_bf16 v[150:153], a[216:219], v[182:185], 0
v_cvt_pk_bf16_f32 v89, v160, v161
v_cvt_pk_bf16_f32 v116, v162, v163
v_mfma_f32_16x16x32_bf16 v[154:157], a[240:243], v[182:185], 0
v_cvt_pk_bf16_f32 v117, v164, v165
v_cvt_pk_bf16_f32 v124, v166, v167
v_mfma_f32_16x16x32_bf16 v[158:161], v[232:235], v[182:185], 0
v_mfma_f32_16x16x32_bf16 v[162:165], v[182:185], a[72:75], 0
v_cvt_pk_bf16_f32 v125, v168, v169
v_cvt_pk_bf16_f32 v132, v170, v171
v_mfma_f32_16x16x32_bf16 v[166:169], v[182:185], a[96:99], 0
s_waitcnt lgkmcnt(2)
v_cvt_pk_bf16_f32 v133, v172, v173
v_add_f32 v174, v174, v175
v_mfma_f32_16x16x32_bf16 v[170:173], v[182:185], a[120:123], 0
s_waitcnt lgkmcnt(0)
v_mfma_f32_16x16x32_bf16 v[138:141], a[4:7], v[186:189], v[138:141]
v_add_f32 v178, v178, v179
v_add_f32 v176, v176, v177
v_mfma_f32_16x16x32_bf16 v[142:145], a[28:31], v[186:189], v[142:145]
v_add_f32 v180, v180, v181
v_add_f32 v174, v174, v176
v_mfma_f32_16x16x32_bf16 v[146:149], a[52:55], v[186:189], v[146:149]
v_mfma_f32_16x16x32_bf16 v[150:153], a[220:223], v[186:189], v[150:153]
v_add_f32 v178, v178, v180
v_mul_f32 v175, s48, v174
v_mfma_f32_16x16x32_bf16 v[154:157], a[244:247], v[186:189], v[154:157]
ds_read_b128 v[182:185], v210 offset:32768
v_mfma_f32_16x16x32_bf16 v[158:161], v[236:239], v[186:189], v[158:161]
v_mul_f32 v178, s48, v178
v_fma_f32 v178, -v175, v175, v178
v_mfma_f32_16x16x32_bf16 v[162:165], v[186:189], a[76:79], v[162:165]
v_max_f32 v178, 0, v178
v_add_f32 v178, s49, v178
v_mfma_f32_16x16x32_bf16 v[166:169], v[186:189], a[100:103], v[166:169]
v_mfma_f32_16x16x32_bf16 v[170:173], v[186:189], a[124:127], v[170:173]
s_waitcnt lgkmcnt(0)
v_rsq_f32 v174, v178
s_nop 0
v_mul_f32_e64 v175, -v175, v174
ds_write_b64 v214, v[174:175]
v_mfma_f32_16x16x32_bf16 v[138:141], a[8:11], v[182:185], v[138:141]
ds_read_b64 v[118:119], v215
ds_read_b64 v[126:127], v215 offset:128
v_mfma_f32_16x16x32_bf16 v[142:145], a[32:35], v[182:185], v[142:145]
ds_read_b64 v[134:135], v215 offset:256
v_mfma_f32_16x16x32_bf16 v[146:149], a[56:59], v[182:185], v[146:149]
ds_read_b128 v[186:189], v210 offset:33792
v_mfma_f32_16x16x32_bf16 v[150:153], a[224:227], v[182:185], v[150:153]
v_mfma_f32_16x16x32_bf16 v[154:157], a[248:251], v[182:185], v[154:157]
v_mov_b32 v181, 0
v_mfma_f32_16x16x32_bf16 v[158:161], v[240:243], v[182:185], v[158:161]
s_waitcnt lgkmcnt(3)
v_fma_f32 v108, v0, v118, v119
v_fma_f32 v109, v1, v118, v119
v_mfma_f32_16x16x32_bf16 v[162:165], v[182:185], a[80:83], v[162:165]
v_cvt_pk_bf16_f32 v90, v108, v109
v_fma_f32 v110, v2, v118, v119
v_mfma_f32_16x16x32_bf16 v[166:169], v[182:185], a[104:107], v[166:169]
v_fma_f32 v111, v3, v118, v119
v_cvt_pk_bf16_f32 v91, v110, v111
v_mfma_f32_16x16x32_bf16 v[170:173], v[182:185], a[128:131], v[170:173]
s_waitcnt lgkmcnt(0)
v_fma_f32 v112, v4, v118, v119
v_fma_f32 v113, v5, v118, v119
v_mfma_f32_16x16x32_bf16 v[138:141], a[12:15], v[186:189], v[138:141]
v_cvt_pk_bf16_f32 v92, v112, v113
v_fma_f32 v108, v6, v118, v119
v_mfma_f32_16x16x32_bf16 v[142:145], a[36:39], v[186:189], v[142:145]
v_fma_f32 v109, v7, v118, v119
v_cvt_pk_bf16_f32 v93, v108, v109
v_mfma_f32_16x16x32_bf16 v[146:149], a[60:63], v[186:189], v[146:149]
ds_write_b128 v211, v[90:93]
v_mfma_f32_16x16x32_bf16 v[150:153], a[228:231], v[186:189], v[150:153]
ds_read_b128 v[182:185], v210 offset:34816
v_fma_f32 v110, v8, v118, v119
v_mfma_f32_16x16x32_bf16 v[154:157], a[252:255], v[186:189], v[154:157]
v_fma_f32 v111, v9, v118, v119
v_cvt_pk_bf16_f32 v94, v110, v111
v_mfma_f32_16x16x32_bf16 v[158:161], v[244:247], v[186:189], v[158:161]
v_fma_f32 v112, v10, v118, v119
v_fma_f32 v113, v11, v118, v119
v_mfma_f32_16x16x32_bf16 v[162:165], v[186:189], a[84:87], v[162:165]
v_cvt_pk_bf16_f32 v95, v112, v113
v_fma_f32 v108, v12, v126, v127
v_mfma_f32_16x16x32_bf16 v[166:169], v[186:189], a[108:111], v[166:169]
ds_write_b64 v212, v[94:95]
v_mfma_f32_16x16x32_bf16 v[170:173], v[186:189], a[132:135], v[170:173]
v_fma_f32 v109, v13, v126, v127
v_cvt_pk_bf16_f32 v102, v108, v109
v_fma_f32 v110, v14, v126, v127
v_fma_f32 v111, v15, v126, v127
v_cvt_pk_bf16_f32 v103, v110, v111
v_fma_f32 v112, v16, v126, v127
v_fma_f32 v113, v17, v126, v127
v_cvt_pk_bf16_f32 v104, v112, v113
v_fma_f32 v108, v18, v126, v127
v_fma_f32 v109, v19, v126, v127
s_waitcnt lgkmcnt(1)
v_mfma_f32_16x16x32_bf16 v[138:141], a[16:19], v[182:185], v[138:141]
ds_read_b128 v[186:189], v210 offset:35840
v_cvt_pk_bf16_f32 v105, v108, v109
v_mfma_f32_16x16x32_bf16 v[142:145], a[40:43], v[182:185], v[142:145]
ds_write_b128 v211, v[102:105] offset:6144
v_mfma_f32_16x16x32_bf16 v[146:149], a[64:67], v[182:185], v[146:149]
v_fma_f32 v110, v20, v126, v127
v_fma_f32 v111, v21, v126, v127
v_mfma_f32_16x16x32_bf16 v[150:153], a[232:235], v[182:185], v[150:153]
v_cvt_pk_bf16_f32 v106, v110, v111
v_fma_f32 v112, v22, v126, v127
v_mfma_f32_16x16x32_bf16 v[154:157], v[224:227], v[182:185], v[154:157]
v_fma_f32 v113, v23, v126, v127
v_cvt_pk_bf16_f32 v107, v112, v113
v_mfma_f32_16x16x32_bf16 v[158:161], v[248:251], v[182:185], v[158:161]
ds_write_b64 v212, v[106:107] offset:6144
v_mfma_f32_16x16x32_bf16 v[162:165], v[182:185], a[88:91], v[162:165]
v_fma_f32 v108, v24, v134, v135
v_fma_f32 v109, v25, v134, v135
v_mfma_f32_16x16x32_bf16 v[166:169], v[182:185], a[112:115], v[166:169]
v_cvt_pk_bf16_f32 v90, v108, v109
v_fma_f32 v110, v26, v134, v135
v_mfma_f32_16x16x32_bf16 v[170:173], v[182:185], a[136:139], v[170:173]
s_waitcnt lgkmcnt(2)
v_fma_f32 v111, v27, v134, v135
v_cvt_pk_bf16_f32 v91, v110, v111
v_mfma_f32_16x16x32_bf16 v[138:141], a[20:23], v[186:189], v[138:141]
v_fma_f32 v112, v28, v134, v135
v_fma_f32 v113, v29, v134, v135
v_mfma_f32_16x16x32_bf16 v[142:145], a[44:47], v[186:189], v[142:145]
v_cvt_pk_bf16_f32 v92, v112, v113
v_fma_f32 v108, v30, v134, v135
v_mfma_f32_16x16x32_bf16 v[146:149], a[68:71], v[186:189], v[146:149]
v_fma_f32 v109, v31, v134, v135
v_cvt_pk_bf16_f32 v93, v108, v109
v_mfma_f32_16x16x32_bf16 v[150:153], a[236:239], v[186:189], v[150:153]
ds_write_b128 v211, v[90:93] offset:12288
v_mfma_f32_16x16x32_bf16 v[154:157], v[228:231], v[186:189], v[154:157]
v_fma_f32 v110, v32, v134, v135
v_fma_f32 v111, v33, v134, v135
v_mfma_f32_16x16x32_bf16 v[158:161], v[252:255], v[186:189], v[158:161]
v_cvt_pk_bf16_f32 v94, v110, v111
v_fma_f32 v112, v34, v134, v135
v_mfma_f32_16x16x32_bf16 v[162:165], v[186:189], a[92:95], v[162:165]
ds_read_b128 v[108:111], v216 offset:512
v_fma_f32 v113, v35, v134, v135
v_mfma_f32_16x16x32_bf16 v[166:169], v[186:189], a[116:119], v[166:169]
v_cvt_pk_bf16_f32 v95, v112, v113
v_cvt_pk_bf16_f32 v102, v138, v139
v_mfma_f32_16x16x32_bf16 v[170:173], v[186:189], a[140:143], v[170:173]
ds_read_b64 v[112:113], v216 offset:528
ds_write_b64 v212, v[94:95] offset:12288
v_cvt_pk_bf16_f32 v103, v140, v141
v_mfma_f32_16x16x32_bf16 v[138:141], v[78:81], v[72:75], 0
v_cvt_pk_bf16_f32 v104, v142, v143
v_cvt_pk_bf16_f32 v105, v144, v145
v_mfma_f32_16x16x32_bf16 v[142:145], v[96:99], v[72:75], 0
v_cvt_pk_bf16_f32 v106, v146, v147
v_cvt_pk_bf16_f32 v107, v148, v149
v_mfma_f32_16x16x32_bf16 v[146:149], v[102:105], v[72:75], 0
s_waitcnt lgkmcnt(2)
v_cvt_pk_bf16_f32 v90, v150, v151
v_cvt_pk_bf16_f32 v91, v152, v153
v_mfma_f32_16x16x32_bf16 v[150:153], v[108:111], v[72:75], v[206:209]
ds_read_b128 v[72:75], v216
v_cvt_pk_bf16_f32 v92, v154, v155
v_mfma_f32_16x16x16_bf16 v[138:141], v[82:83], v[76:77], v[138:141]
v_cvt_pk_bf16_f32 v93, v156, v157
v_cvt_pk_bf16_f32 v94, v158, v159
v_mfma_f32_16x16x16_bf16 v[142:145], v[100:101], v[76:77], v[142:145]
s_waitcnt lgkmcnt(2)
v_cvt_pk_bf16_f32 v95, v160, v161
v_cvt_pk_bf16_f32 v118, v162, v163
v_mfma_f32_16x16x16_bf16 v[150:153], v[112:113], v[76:77], v[150:153]
v_cvt_pk_bf16_f32 v119, v164, v165
v_cvt_pk_bf16_f32 v126, v166, v167
v_mfma_f32_16x16x16_bf16 v[146:149], v[106:107], v[76:77], v[146:149]
ds_read_b64 v[76:77], v216 offset:16
v_cvt_pk_bf16_f32 v127, v168, v169
v_mfma_f32_16x16x32_bf16 v[154:157], v[78:81], v[84:87], 0
v_cvt_pk_bf16_f32 v134, v170, v171
v_cvt_pk_bf16_f32 v135, v172, v173
v_mfma_f32_16x16x32_bf16 v[158:161], v[96:99], v[84:87], 0
v_max3_f32 v220, v138, v139, v140
v_max3_f32 v220, v220, v141, v142
v_mfma_f32_16x16x32_bf16 v[166:169], v[108:111], v[84:87], v[206:209]
v_max3_f32 v220, v220, v143, v144
v_max3_f32 v220, v220, v145, v146
v_mfma_f32_16x16x32_bf16 v[162:165], v[102:105], v[84:87], 0
v_max3_f32 v220, v220, v147, v148
v_max3_f32 v220, v220, v149, v150
v_mfma_f32_16x16x16_bf16 v[154:157], v[82:83], v[88:89], v[154:157]
v_mov_b32 v221, v220
v_mfma_f32_16x16x16_bf16 v[158:161], v[100:101], v[88:89], v[158:161]
s_nop 0
v_permlane16_swap_b32 v220, v221
v_mfma_f32_16x16x16_bf16 v[166:169], v[112:113], v[88:89], v[166:169]
v_max_f32 v220, v220, v221
v_mov_b32 v221, v220
v_mfma_f32_16x16x16_bf16 v[162:165], v[106:107], v[88:89], v[162:165]
s_nop 0
v_permlane32_swap_b32 v220, v221
v_max_f32 v220, v220, v221
v_sub_f32 v138, v138, v220
v_sub_f32 v139, v139, v220
v_sub_f32 v140, v140, v220
v_sub_f32 v141, v141, v220
v_sub_f32 v142, v142, v220
v_sub_f32 v143, v143, v220
v_sub_f32 v144, v144, v220
v_sub_f32 v145, v145, v220
v_sub_f32 v150, v150, v220
v_sub_f32 v146, v146, v220
v_sub_f32 v147, v147, v220
v_sub_f32 v148, v148, v220
v_sub_f32 v149, v149, v220
v_exp_f32 v138, v138
v_exp_f32 v139, v139
v_exp_f32 v140, v140
v_exp_f32 v141, v141
v_exp_f32 v142, v142
v_exp_f32 v143, v143
v_exp_f32 v144, v144
v_exp_f32 v145, v145
v_exp_f32 v150, v150
v_exp_f32 v146, v146
v_exp_f32 v147, v147
v_exp_f32 v148, v148
v_exp_f32 v149, v149
v_cvt_pk_bf16_f32 v174, v138, v139
v_cvt_pk_bf16_f32 v175, v140, v141
v_cvt_pk_bf16_f32 v176, v142, v143
v_cvt_pk_bf16_f32 v177, v144, v145
v_cvt_pk_bf16_f32 v178, v146, v147
v_cvt_pk_bf16_f32 v179, v148, v149
v_mfma_f32_16x16x32_bf16 v[138:141], v[114:117], v[174:177], 0
v_cvt_pk_bf16_f32 v180, v150, 0
v_max3_f32 v220, v154, v155, v156
v_mfma_f32_16x16x32_bf16 v[150:153], v[190:193], v[174:177], 0
v_max3_f32 v220, v220, v157, v158
v_max3_f32 v220, v220, v159, v160
v_mfma_f32_16x16x32_bf16 v[142:145], v[122:125], v[174:177], 0
v_max3_f32 v220, v220, v161, v162
v_max3_f32 v220, v220, v163, v164
v_mfma_f32_16x16x32_bf16 v[146:149], v[130:133], v[174:177], 0
v_max3_f32 v220, v220, v165, v166
v_mov_b32 v221, v220
v_mfma_f32_16x16x32_bf16 v[150:153], v[190:193], v[178:181], v[150:153]
s_nop 0
v_permlane16_swap_b32 v220, v221
v_mfma_f32_16x16x32_bf16 v[138:141], v[118:121], v[178:181], v[138:141]
v_max_f32 v220, v220, v221
v_mov_b32 v221, v220
v_mfma_f32_16x16x32_bf16 v[142:145], v[126:129], v[178:181], v[142:145]
s_nop 0
v_permlane32_swap_b32 v220, v221
v_mfma_f32_16x16x32_bf16 v[146:149], v[134:137], v[178:181], v[146:149]
v_max_f32 v220, v220, v221
v_sub_f32 v154, v154, v220
v_sub_f32 v155, v155, v220
v_sub_f32 v156, v156, v220
v_sub_f32 v157, v157, v220
v_sub_f32 v158, v158, v220
v_sub_f32 v159, v159, v220
v_sub_f32 v160, v160, v220
v_sub_f32 v161, v161, v220
v_sub_f32 v166, v166, v220
v_sub_f32 v162, v162, v220
v_sub_f32 v163, v163, v220
v_sub_f32 v164, v164, v220
v_sub_f32 v165, v165, v220
v_exp_f32 v154, v154
v_exp_f32 v155, v155
v_exp_f32 v156, v156
v_exp_f32 v157, v157
v_exp_f32 v158, v158
v_exp_f32 v159, v159
v_exp_f32 v160, v160
v_exp_f32 v161, v161
v_exp_f32 v166, v166
v_exp_f32 v162, v162
v_exp_f32 v163, v163
v_exp_f32 v164, v164
v_exp_f32 v165, v165
v_cvt_pk_bf16_f32 v174, v154, v155
v_cvt_pk_bf16_f32 v175, v156, v157
v_cvt_pk_bf16_f32 v176, v158, v159
v_cvt_pk_bf16_f32 v177, v160, v161
v_cvt_pk_bf16_f32 v178, v162, v163
v_cvt_pk_bf16_f32 v179, v164, v165
v_mfma_f32_16x16x32_bf16 v[154:157], v[114:117], v[174:177], 0
s_mov_b32 s38, s36
v_cvt_pk_bf16_f32 v180, v166, 0
v_rcp_f32 v151, v150
v_mfma_f32_16x16x32_bf16 v[166:169], v[190:193], v[174:177], 0
v_mul_f32 v138, v138, v151
v_mul_f32 v139, v139, v151
v_mfma_f32_16x16x32_bf16 v[158:161], v[122:125], v[174:177], 0
v_cvt_pk_bf16_f32 v138, v138, v139
v_mul_f32 v140, v140, v151
v_mfma_f32_16x16x32_bf16 v[162:165], v[130:133], v[174:177], 0
v_mul_f32 v141, v141, v151
v_cvt_pk_bf16_f32 v139, v140, v141
v_mfma_f32_16x16x32_bf16 v[166:169], v[190:193], v[178:181], v[166:169]
v_mul_f32 v142, v142, v151
v_mul_f32 v143, v143, v151
v_mfma_f32_16x16x32_bf16 v[154:157], v[118:121], v[178:181], v[154:157]
v_cvt_pk_bf16_f32 v140, v142, v143
v_mul_f32 v144, v144, v151
v_mfma_f32_16x16x32_bf16 v[158:161], v[126:129], v[178:181], v[158:161]
v_mul_f32 v145, v145, v151
v_cvt_pk_bf16_f32 v141, v144, v145
v_mfma_f32_16x16x32_bf16 v[162:165], v[134:137], v[178:181], v[162:165]
ds_write_b128 v211, v[138:141] offset:36864
v_mfma_f32_16x16x32_bf16 v[138:141], v[78:81], v[90:93], 0
v_mul_f32 v146, v146, v151
v_mul_f32 v147, v147, v151
v_cvt_pk_bf16_f32 v142, v146, v147
v_mul_f32 v148, v148, v151
v_mul_f32 v149, v149, v151
v_mfma_f32_16x16x32_bf16 v[150:153], v[108:111], v[90:93], v[206:209]
v_cvt_pk_bf16_f32 v143, v148, v149
v_rcp_f32 v167, v166
v_mfma_f32_16x16x32_bf16 v[146:149], v[102:105], v[90:93], 0
ds_write_b64 v212, v[142:143] offset:36864
v_mfma_f32_16x16x32_bf16 v[142:145], v[96:99], v[90:93], 0
v_mul_f32 v154, v154, v167
v_mul_f32 v155, v155, v167
v_mfma_f32_16x16x16_bf16 v[138:141], v[82:83], v[94:95], v[138:141]
v_cvt_pk_bf16_f32 v154, v154, v155
v_mul_f32 v156, v156, v167
v_mfma_f32_16x16x16_bf16 v[150:153], v[112:113], v[94:95], v[150:153]
v_mul_f32 v157, v157, v167
v_cvt_pk_bf16_f32 v155, v156, v157
v_mfma_f32_16x16x16_bf16 v[142:145], v[100:101], v[94:95], v[142:145]
v_mul_f32 v158, v158, v167
v_mul_f32 v159, v159, v167
v_mfma_f32_16x16x16_bf16 v[146:149], v[106:107], v[94:95], v[146:149]
s_waitcnt lgkmcnt(3)
v_cvt_pk_bf16_f32 v156, v158, v159
v_mul_f32 v160, v160, v167
v_mul_f32 v161, v161, v167
v_cvt_pk_bf16_f32 v157, v160, v161
v_mul_f32 v162, v162, v167
v_mul_f32 v163, v163, v167
v_cvt_pk_bf16_f32 v158, v162, v163
v_mul_f32 v164, v164, v167
v_mul_f32 v165, v165, v167
v_mfma_f32_16x16x32_bf16 v[166:169], v[108:111], v[72:75], v[206:209]
ds_write_b128 v211, v[154:157] offset:43008
v_mfma_f32_16x16x32_bf16 v[154:157], v[78:81], v[72:75], 0
v_cvt_pk_bf16_f32 v159, v164, v165
v_max3_f32 v220, v138, v139, v140
v_mfma_f32_16x16x32_bf16 v[162:165], v[102:105], v[72:75], 0
ds_write_b64 v212, v[158:159] offset:43008
v_mfma_f32_16x16x32_bf16 v[158:161], v[96:99], v[72:75], 0
s_waitcnt lgkmcnt(4)
v_max3_f32 v220, v220, v141, v142
v_max3_f32 v220, v220, v143, v144
v_mfma_f32_16x16x16_bf16 v[154:157], v[82:83], v[76:77], v[154:157]
v_max3_f32 v220, v220, v145, v146
v_max3_f32 v220, v220, v147, v148
v_mfma_f32_16x16x16_bf16 v[166:169], v[112:113], v[76:77], v[166:169]
v_max3_f32 v220, v220, v149, v150
v_mov_b32 v221, v220
v_mfma_f32_16x16x16_bf16 v[158:161], v[100:101], v[76:77], v[158:161]
s_nop 0
v_permlane16_swap_b32 v220, v221
v_mfma_f32_16x16x16_bf16 v[162:165], v[106:107], v[76:77], v[162:165]
v_max_f32 v220, v220, v221
v_mov_b32 v221, v220
s_nop 1
v_permlane32_swap_b32 v220, v221
v_max_f32 v220, v220, v221
v_sub_f32 v138, v138, v220
v_sub_f32 v139, v139, v220
v_sub_f32 v140, v140, v220
v_sub_f32 v141, v141, v220
v_sub_f32 v142, v142, v220
v_sub_f32 v143, v143, v220
v_sub_f32 v144, v144, v220
v_sub_f32 v145, v145, v220
v_sub_f32 v150, v150, v220
v_sub_f32 v146, v146, v220
v_sub_f32 v147, v147, v220
v_sub_f32 v148, v148, v220
v_sub_f32 v149, v149, v220
v_exp_f32 v138, v138
s_waitcnt lgkmcnt(0)
s_barrier
ds_read_b128 v[170:173], v210 offset:36864
ds_read_b128 v[182:185], v210 offset:37888
ds_read_b128 v[186:189], v210 offset:38912
v_exp_f32 v139, v139
v_exp_f32 v140, v140
v_exp_f32 v141, v141
v_exp_f32 v142, v142
v_exp_f32 v143, v143
v_exp_f32 v144, v144
v_exp_f32 v145, v145
v_exp_f32 v150, v150
v_exp_f32 v146, v146
v_exp_f32 v147, v147
v_exp_f32 v148, v148
s_waitcnt lgkmcnt(2)
v_mfma_f32_16x16x32_bf16 v[36:39], a[144:147], v[170:173], v[36:39]
v_exp_f32 v149, v149
v_mfma_f32_16x16x32_bf16 v[40:43], a[168:171], v[170:173], v[40:43]
v_cvt_pk_bf16_f32 v174, v138, v139
v_cvt_pk_bf16_f32 v175, v140, v141
v_mfma_f32_16x16x32_bf16 v[44:47], a[192:195], v[170:173], v[44:47]
s_waitcnt lgkmcnt(1)
ds_read_b128 v[170:173], v210 offset:39936
v_cvt_pk_bf16_f32 v176, v142, v143
v_mfma_f32_16x16x32_bf16 v[36:39], a[148:151], v[182:185], v[36:39]
v_cvt_pk_bf16_f32 v177, v144, v145
v_cvt_pk_bf16_f32 v178, v146, v147
v_mfma_f32_16x16x32_bf16 v[40:43], a[172:175], v[182:185], v[40:43]
v_cvt_pk_bf16_f32 v179, v148, v149
v_cvt_pk_bf16_f32 v180, v150, 0
v_mfma_f32_16x16x32_bf16 v[44:47], a[196:199], v[182:185], v[44:47]
s_waitcnt lgkmcnt(1)
ds_read_b128 v[182:185], v210 offset:40960
v_max3_f32 v220, v154, v155, v156
v_mfma_f32_16x16x32_bf16 v[36:39], a[152:155], v[186:189], v[36:39]
v_max3_f32 v220, v220, v157, v158
v_max3_f32 v220, v220, v159, v160
v_mfma_f32_16x16x32_bf16 v[40:43], a[176:179], v[186:189], v[40:43]
v_max3_f32 v220, v220, v161, v162
v_max3_f32 v220, v220, v163, v164
v_mfma_f32_16x16x32_bf16 v[44:47], a[200:203], v[186:189], v[44:47]
s_waitcnt lgkmcnt(1)
ds_read_b128 v[186:189], v210 offset:41984
v_max3_f32 v220, v220, v165, v166
v_mfma_f32_16x16x32_bf16 v[36:39], a[156:159], v[170:173], v[36:39]
v_mov_b32 v221, v220
v_mfma_f32_16x16x32_bf16 v[40:43], a[180:183], v[170:173], v[40:43]
s_nop 0
v_permlane16_swap_b32 v220, v221
v_mfma_f32_16x16x32_bf16 v[44:47], a[204:207], v[170:173], v[44:47]
s_waitcnt lgkmcnt(1)
ds_read_b128 v[170:173], v210 offset:43008
v_max_f32 v220, v220, v221
v_mfma_f32_16x16x32_bf16 v[36:39], a[160:163], v[182:185], v[36:39]
v_mov_b32 v221, v220
v_mfma_f32_16x16x32_bf16 v[40:43], a[184:187], v[182:185], v[40:43]
s_nop 0
v_permlane32_swap_b32 v220, v221
v_mfma_f32_16x16x32_bf16 v[44:47], a[208:211], v[182:185], v[44:47]
ds_read_b128 v[182:185], v210 offset:44032
v_max_f32 v220, v220, v221
v_mfma_f32_16x16x32_bf16 v[150:153], v[190:193], v[174:177], 0
v_sub_f32 v154, v154, v220
v_sub_f32 v155, v155, v220
v_mfma_f32_16x16x32_bf16 v[138:141], v[114:117], v[174:177], 0
v_sub_f32 v156, v156, v220
v_sub_f32 v157, v157, v220
v_mfma_f32_16x16x32_bf16 v[142:145], v[122:125], v[174:177], 0
v_sub_f32 v158, v158, v220
v_sub_f32 v159, v159, v220
v_mfma_f32_16x16x32_bf16 v[146:149], v[130:133], v[174:177], 0
s_waitcnt lgkmcnt(2)
v_sub_f32 v160, v160, v220
v_sub_f32 v161, v161, v220
v_mfma_f32_16x16x32_bf16 v[36:39], a[164:167], v[186:189], v[36:39]
v_sub_f32 v166, v166, v220
v_sub_f32 v162, v162, v220
v_mfma_f32_16x16x32_bf16 v[150:153], v[190:193], v[178:181], v[150:153]
v_sub_f32 v163, v163, v220
v_sub_f32 v164, v164, v220
v_mfma_f32_16x16x32_bf16 v[138:141], v[118:121], v[178:181], v[138:141]
v_sub_f32 v165, v165, v220
v_exp_f32 v154, v154
v_mfma_f32_16x16x32_bf16 v[40:43], a[188:191], v[186:189], v[40:43]
v_cvt_pk_bf16_f32 v36, v36, v37
v_cvt_pk_bf16_f32 v37, v38, v39
v_mfma_f32_16x16x32_bf16 v[142:145], v[126:129], v[178:181], v[142:145]
buffer_store_dwordx2 v[36:37], v203, s[8:11], s39 offen
v_mfma_f32_16x16x32_bf16 v[44:47], a[212:215], v[186:189], v[44:47]
ds_read_b128 v[186:189], v210 offset:45056
v_exp_f32 v155, v155
v_mfma_f32_16x16x32_bf16 v[146:149], v[134:137], v[178:181], v[146:149]
s_waitcnt lgkmcnt(2)
v_cvt_pk_bf16_f32 v40, v40, v41
v_cvt_pk_bf16_f32 v41, v42, v43
v_mfma_f32_16x16x32_bf16 v[48:51], a[144:147], v[170:173], v[48:51]
buffer_store_dwordx2 v[40:41], v203, s[8:11], s39 offen offset:32
v_mfma_f32_16x16x32_bf16 v[52:55], a[168:171], v[170:173], v[52:55]
v_cvt_pk_bf16_f32 v44, v44, v45
v_exp_f32 v156, v156
v_mfma_f32_16x16x32_bf16 v[56:59], a[192:195], v[170:173], v[56:59]
s_waitcnt lgkmcnt(1)
ds_read_b128 v[170:173], v210 offset:46080
v_cvt_pk_bf16_f32 v45, v46, v47
v_mfma_f32_16x16x32_bf16 v[48:51], a[148:151], v[182:185], v[48:51]
buffer_store_dwordx2 v[44:45], v203, s[8:11], s39 offen offset:64
v_mfma_f32_16x16x32_bf16 v[52:55], a[172:175], v[182:185], v[52:55]
v_exp_f32 v157, v157
v_mfma_f32_16x16x32_bf16 v[56:59], a[196:199], v[182:185], v[56:59]
s_waitcnt lgkmcnt(1)
ds_read_b128 v[182:185], v210 offset:47104
v_exp_f32 v158, v158
v_mfma_f32_16x16x32_bf16 v[48:51], a[152:155], v[186:189], v[48:51]
v_exp_f32 v159, v159
v_mfma_f32_16x16x32_bf16 v[52:55], a[176:179], v[186:189], v[52:55]
v_exp_f32 v160, v160
v_mfma_f32_16x16x32_bf16 v[56:59], a[200:203], v[186:189], v[56:59]
s_waitcnt lgkmcnt(1)
ds_read_b128 v[186:189], v210 offset:48128
v_exp_f32 v161, v161
v_mfma_f32_16x16x32_bf16 v[48:51], a[156:159], v[170:173], v[48:51]
v_exp_f32 v166, v166
v_mfma_f32_16x16x32_bf16 v[52:55], a[180:183], v[170:173], v[52:55]
v_exp_f32 v162, v162
v_mfma_f32_16x16x32_bf16 v[56:59], a[204:207], v[170:173], v[56:59]
s_waitcnt lgkmcnt(1)
v_exp_f32 v163, v163
v_mfma_f32_16x16x32_bf16 v[48:51], a[160:163], v[182:185], v[48:51]
v_exp_f32 v164, v164
v_mfma_f32_16x16x32_bf16 v[52:55], a[184:187], v[182:185], v[52:55]
v_exp_f32 v165, v165
v_mfma_f32_16x16x32_bf16 v[56:59], a[208:211], v[182:185], v[56:59]
s_waitcnt lgkmcnt(0)
v_cvt_pk_bf16_f32 v174, v154, v155
v_cvt_pk_bf16_f32 v175, v156, v157
v_mfma_f32_16x16x32_bf16 v[48:51], a[164:167], v[186:189], v[48:51]
v_cvt_pk_bf16_f32 v176, v158, v159
v_cvt_pk_bf16_f32 v177, v160, v161
v_mfma_f32_16x16x32_bf16 v[52:55], a[188:191], v[186:189], v[52:55]
v_cvt_pk_bf16_f32 v178, v162, v163
v_cvt_pk_bf16_f32 v179, v164, v165
v_mfma_f32_16x16x32_bf16 v[154:157], v[114:117], v[174:177], 0
v_cvt_pk_bf16_f32 v180, v166, 0
v_rcp_f32 v151, v150
v_mfma_f32_16x16x32_bf16 v[166:169], v[190:193], v[174:177], 0
v_mul_f32 v138, v138, v151
v_mul_f32 v139, v139, v151
v_mfma_f32_16x16x32_bf16 v[158:161], v[122:125], v[174:177], 0
v_cvt_pk_bf16_f32 v138, v138, v139
v_mul_f32 v140, v140, v151
v_mfma_f32_16x16x32_bf16 v[162:165], v[130:133], v[174:177], 0
v_mul_f32 v141, v141, v151
v_cvt_pk_bf16_f32 v139, v140, v141
v_mfma_f32_16x16x32_bf16 v[166:169], v[190:193], v[178:181], v[166:169]
v_mul_f32 v142, v142, v151
v_mul_f32 v143, v143, v151
v_mfma_f32_16x16x32_bf16 v[154:157], v[118:121], v[178:181], v[154:157]
v_cvt_pk_bf16_f32 v140, v142, v143
v_mul_f32 v144, v144, v151
v_mfma_f32_16x16x32_bf16 v[158:161], v[126:129], v[178:181], v[158:161]
v_mul_f32 v145, v145, v151
v_cvt_pk_bf16_f32 v141, v144, v145
v_mfma_f32_16x16x32_bf16 v[56:59], a[212:215], v[186:189], v[56:59]
ds_write_b128 v211, v[138:141] offset:49152
v_mfma_f32_16x16x32_bf16 v[162:165], v[134:137], v[178:181], v[162:165]
v_mul_f32 v146, v146, v151
v_mul_f32 v147, v147, v151
v_cvt_pk_bf16_f32 v142, v146, v147
v_mul_f32 v148, v148, v151
v_mul_f32 v149, v149, v151
v_cvt_pk_bf16_f32 v143, v148, v149
v_rcp_f32 v167, v166
ds_write_b64 v212, v[142:143] offset:49152
v_mul_f32 v154, v154, v167
v_mul_f32 v155, v155, v167
v_cvt_pk_bf16_f32 v154, v154, v155
v_mul_f32 v156, v156, v167
v_mul_f32 v157, v157, v167
v_cvt_pk_bf16_f32 v155, v156, v157
v_mul_f32 v158, v158, v167
v_mul_f32 v159, v159, v167
v_cvt_pk_bf16_f32 v156, v158, v159
v_mul_f32 v160, v160, v167
v_mul_f32 v161, v161, v167
v_cvt_pk_bf16_f32 v157, v160, v161
v_mul_f32 v162, v162, v167
v_mul_f32 v163, v163, v167
v_cvt_pk_bf16_f32 v158, v162, v163
v_mul_f32 v164, v164, v167
v_mul_f32 v165, v165, v167
v_cvt_pk_bf16_f32 v159, v164, v165
v_cvt_pk_bf16_f32 v48, v48, v49
v_cvt_pk_bf16_f32 v49, v50, v51
v_cvt_pk_bf16_f32 v52, v52, v53
v_cvt_pk_bf16_f32 v53, v54, v55
v_cvt_pk_bf16_f32 v56, v56, v57
ds_write_b128 v216, v[154:157]
ds_write_b64 v216, v[158:159] offset:16
buffer_store_dwordx2 v[48:49], v204, s[8:11], s39 offen
buffer_store_dwordx2 v[52:53], v204, s[8:11], s39 offen offset:32
v_add_u32 v216, 1408, v216
v_cvt_pk_bf16_f32 v57, v58, v59
s_waitcnt lgkmcnt(2)
s_barrier
ds_read_b128 v[170:173], v210 offset:49152
ds_read_b128 v[182:185], v210 offset:50176
ds_read_b128 v[186:189], v210 offset:51200
buffer_store_dwordx2 v[56:57], v204, s[8:11], s39 offen offset:64
s_waitcnt lgkmcnt(2)
v_mfma_f32_16x16x32_bf16 v[60:63], a[144:147], v[170:173], v[60:63]
v_mfma_f32_16x16x32_bf16 v[64:67], a[168:171], v[170:173], v[64:67]
v_mfma_f32_16x16x32_bf16 v[68:71], a[192:195], v[170:173], v[68:71]
s_waitcnt lgkmcnt(1)
ds_read_b128 v[170:173], v210 offset:52224
v_mfma_f32_16x16x32_bf16 v[60:63], a[148:151], v[182:185], v[60:63]
v_mfma_f32_16x16x32_bf16 v[64:67], a[172:175], v[182:185], v[64:67]
v_mfma_f32_16x16x32_bf16 v[68:71], a[196:199], v[182:185], v[68:71]
s_waitcnt lgkmcnt(1)
ds_read_b128 v[182:185], v210 offset:53248
v_mfma_f32_16x16x32_bf16 v[60:63], a[152:155], v[186:189], v[60:63]
v_mfma_f32_16x16x32_bf16 v[64:67], a[176:179], v[186:189], v[64:67]
v_mfma_f32_16x16x32_bf16 v[68:71], a[200:203], v[186:189], v[68:71]
s_waitcnt lgkmcnt(1)
ds_read_b128 v[186:189], v210 offset:54272
v_mfma_f32_16x16x32_bf16 v[60:63], a[156:159], v[170:173], v[60:63]
v_mfma_f32_16x16x32_bf16 v[64:67], a[180:183], v[170:173], v[64:67]
v_mfma_f32_16x16x32_bf16 v[68:71], a[204:207], v[170:173], v[68:71]
s_waitcnt lgkmcnt(1)
v_mfma_f32_16x16x32_bf16 v[60:63], a[160:163], v[182:185], v[60:63]
v_mfma_f32_16x16x32_bf16 v[64:67], a[184:187], v[182:185], v[64:67]
v_mfma_f32_16x16x32_bf16 v[68:71], a[208:211], v[182:185], v[68:71]
s_waitcnt lgkmcnt(0)
ds_read_b128 v[182:185], v210
v_mfma_f32_16x16x32_bf16 v[60:63], a[164:167], v[186:189], v[60:63]
v_mfma_f32_16x16x32_bf16 v[64:67], a[188:191], v[186:189], v[64:67]
v_mfma_f32_16x16x32_bf16 v[68:71], a[212:215], v[186:189], v[68:71]
s_waitcnt lgkmcnt(0)
ds_read_b128 v[186:189], v210 offset:1024
s_nop 3
v_cvt_pk_bf16_f32 v60, v60, v61
v_cvt_pk_bf16_f32 v61, v62, v63
buffer_store_dwordx2 v[60:61], v205, s[8:11], s39 offen
v_mfma_f32_16x16x32_bf16 v[138:141], a[0:3], v[182:185], 0
v_cvt_pk_bf16_f32 v64, v64, v65
v_cvt_pk_bf16_f32 v65, v66, v67
v_mfma_f32_16x16x32_bf16 v[142:145], a[24:27], v[182:185], 0
buffer_store_dwordx2 v[64:65], v205, s[8:11], s39 offen offset:32
v_mfma_f32_16x16x32_bf16 v[146:149], a[48:51], v[182:185], 0
v_mfma_f32_16x16x32_bf16 v[150:153], a[216:219], v[182:185], 0
v_cvt_pk_bf16_f32 v68, v68, v69
v_cvt_pk_bf16_f32 v69, v70, v71
v_mfma_f32_16x16x32_bf16 v[154:157], a[240:243], v[182:185], 0
buffer_store_dwordx2 v[68:69], v205, s[8:11], s39 offen offset:64
v_mfma_f32_16x16x32_bf16 v[158:161], v[232:235], v[182:185], 0
v_mfma_f32_16x16x32_bf16 v[162:165], v[182:185], a[72:75], 0
v_mfma_f32_16x16x32_bf16 v[166:169], v[182:185], a[96:99], 0
v_mfma_f32_16x16x32_bf16 v[170:173], v[182:185], a[120:123], 0
s_waitcnt lgkmcnt(0)
ds_read_b128 v[182:185], v210 offset:2048
v_mfma_f32_16x16x32_bf16 v[138:141], a[4:7], v[186:189], v[138:141]
v_mfma_f32_16x16x32_bf16 v[142:145], a[28:31], v[186:189], v[142:145]
v_mfma_f32_16x16x32_bf16 v[146:149], a[52:55], v[186:189], v[146:149]
v_mfma_f32_16x16x32_bf16 v[150:153], a[220:223], v[186:189], v[150:153]
v_mfma_f32_16x16x32_bf16 v[154:157], a[244:247], v[186:189], v[154:157]
v_mfma_f32_16x16x32_bf16 v[158:161], v[236:239], v[186:189], v[158:161]
v_mfma_f32_16x16x32_bf16 v[162:165], v[186:189], a[76:79], v[162:165]
v_mfma_f32_16x16x32_bf16 v[166:169], v[186:189], a[100:103], v[166:169]
v_mfma_f32_16x16x32_bf16 v[170:173], v[186:189], a[124:127], v[170:173]
s_waitcnt lgkmcnt(0)
ds_read_b128 v[186:189], v210 offset:3072
v_mfma_f32_16x16x32_bf16 v[138:141], a[8:11], v[182:185], v[138:141]
v_mfma_f32_16x16x32_bf16 v[142:145], a[32:35], v[182:185], v[142:145]
v_mfma_f32_16x16x32_bf16 v[146:149], a[56:59], v[182:185], v[146:149]
v_mfma_f32_16x16x32_bf16 v[150:153], a[224:227], v[182:185], v[150:153]
v_mfma_f32_16x16x32_bf16 v[154:157], a[248:251], v[182:185], v[154:157]
v_mfma_f32_16x16x32_bf16 v[158:161], v[240:243], v[182:185], v[158:161]
v_mfma_f32_16x16x32_bf16 v[162:165], v[182:185], a[80:83], v[162:165]
v_mfma_f32_16x16x32_bf16 v[166:169], v[182:185], a[104:107], v[166:169]
v_mfma_f32_16x16x32_bf16 v[170:173], v[182:185], a[128:131], v[170:173]
s_waitcnt lgkmcnt(0)
ds_read_b128 v[182:185], v210 offset:4096
v_mfma_f32_16x16x32_bf16 v[138:141], a[12:15], v[186:189], v[138:141]
v_mfma_f32_16x16x32_bf16 v[142:145], a[36:39], v[186:189], v[142:145]
v_mfma_f32_16x16x32_bf16 v[146:149], a[60:63], v[186:189], v[146:149]
v_mfma_f32_16x16x32_bf16 v[150:153], a[228:231], v[186:189], v[150:153]
v_mfma_f32_16x16x32_bf16 v[154:157], a[252:255], v[186:189], v[154:157]
v_mfma_f32_16x16x32_bf16 v[158:161], v[244:247], v[186:189], v[158:161]
v_mfma_f32_16x16x32_bf16 v[162:165], v[186:189], a[84:87], v[162:165]
v_mfma_f32_16x16x32_bf16 v[166:169], v[186:189], a[108:111], v[166:169]
v_mfma_f32_16x16x32_bf16 v[170:173], v[186:189], a[132:135], v[170:173]
s_waitcnt lgkmcnt(0)
ds_read_b128 v[186:189], v210 offset:5120
v_mfma_f32_16x16x32_bf16 v[138:141], a[16:19], v[182:185], v[138:141]
v_mfma_f32_16x16x32_bf16 v[142:145], a[40:43], v[182:185], v[142:145]
v_mfma_f32_16x16x32_bf16 v[146:149], a[64:67], v[182:185], v[146:149]
v_mfma_f32_16x16x32_bf16 v[150:153], a[232:235], v[182:185], v[150:153]
v_mfma_f32_16x16x32_bf16 v[154:157], v[224:227], v[182:185], v[154:157]
v_mfma_f32_16x16x32_bf16 v[158:161], v[248:251], v[182:185], v[158:161]
v_mfma_f32_16x16x32_bf16 v[162:165], v[182:185], a[88:91], v[162:165]
v_mfma_f32_16x16x32_bf16 v[166:169], v[182:185], a[112:115], v[166:169]
v_mfma_f32_16x16x32_bf16 v[170:173], v[182:185], a[136:139], v[170:173]
s_waitcnt lgkmcnt(0)
ds_read_b128 v[182:185], v210 offset:6144
v_mfma_f32_16x16x32_bf16 v[138:141], a[20:23], v[186:189], v[138:141]
v_mfma_f32_16x16x32_bf16 v[142:145], a[44:47], v[186:189], v[142:145]
v_mfma_f32_16x16x32_bf16 v[146:149], a[68:71], v[186:189], v[146:149]
s_nop 5
v_cvt_pk_bf16_f32 v78, v138, v139
v_cvt_pk_bf16_f32 v79, v140, v141
v_mfma_f32_16x16x32_bf16 v[150:153], a[236:239], v[186:189], v[150:153]
v_mfma_f32_16x16x32_bf16 v[154:157], v[228:231], v[186:189], v[154:157]
v_cvt_pk_bf16_f32 v80, v142, v143
v_cvt_pk_bf16_f32 v81, v144, v145
v_cvt_pk_bf16_f32 v82, v146, v147
v_mfma_f32_16x16x32_bf16 v[158:161], v[252:255], v[186:189], v[158:161]
v_cvt_pk_bf16_f32 v83, v148, v149
s_nop 1
v_cvt_pk_bf16_f32 v72, v150, v151
v_mfma_f32_16x16x32_bf16 v[162:165], v[186:189], a[92:95], v[162:165]
v_cvt_pk_bf16_f32 v73, v152, v153
v_cvt_pk_bf16_f32 v74, v154, v155
v_mfma_f32_16x16x32_bf16 v[166:169], v[186:189], a[116:119], v[166:169]
v_cvt_pk_bf16_f32 v75, v156, v157
v_cvt_pk_bf16_f32 v76, v158, v159
v_mfma_f32_16x16x32_bf16 v[170:173], v[186:189], a[140:143], v[170:173]
s_waitcnt lgkmcnt(0)
ds_read_b128 v[186:189], v210 offset:7168
v_cvt_pk_bf16_f32 v77, v160, v161
v_mfma_f32_16x16x32_bf16 v[138:141], a[0:3], v[182:185], 0
v_cvt_pk_bf16_f32 v114, v162, v163
v_cvt_pk_bf16_f32 v115, v164, v165
v_mfma_f32_16x16x32_bf16 v[142:145], a[24:27], v[182:185], 0
v_cvt_pk_bf16_f32 v122, v166, v167
v_mfma_f32_16x16x32_bf16 v[146:149], a[48:51], v[182:185], 0
v_cvt_pk_bf16_f32 v123, v168, v169
v_cvt_pk_bf16_f32 v130, v170, v171
v_mfma_f32_16x16x32_bf16 v[150:153], a[216:219], v[182:185], 0
v_cvt_pk_bf16_f32 v131, v172, v173
v_mfma_f32_16x16x32_bf16 v[154:157], a[240:243], v[182:185], 0
v_mfma_f32_16x16x32_bf16 v[158:161], v[232:235], v[182:185], 0
v_mfma_f32_16x16x32_bf16 v[162:165], v[182:185], a[72:75], 0
v_mfma_f32_16x16x32_bf16 v[166:169], v[182:185], a[96:99], 0
v_mfma_f32_16x16x32_bf16 v[170:173], v[182:185], a[120:123], 0
s_waitcnt lgkmcnt(0)
ds_read_b128 v[182:185], v210 offset:8192
v_mfma_f32_16x16x32_bf16 v[138:141], a[4:7], v[186:189], v[138:141]
v_mfma_f32_16x16x32_bf16 v[142:145], a[28:31], v[186:189], v[142:145]
v_mfma_f32_16x16x32_bf16 v[146:149], a[52:55], v[186:189], v[146:149]
v_mfma_f32_16x16x32_bf16 v[150:153], a[220:223], v[186:189], v[150:153]
v_mfma_f32_16x16x32_bf16 v[154:157], a[244:247], v[186:189], v[154:157]
v_mfma_f32_16x16x32_bf16 v[158:161], v[236:239], v[186:189], v[158:161]
v_mfma_f32_16x16x32_bf16 v[162:165], v[186:189], a[76:79], v[162:165]
v_mfma_f32_16x16x32_bf16 v[166:169], v[186:189], a[100:103], v[166:169]
ds_read_u16 v120, v217
ds_read_u16 v128, v217 offset:32
v_mfma_f32_16x16x32_bf16 v[170:173], v[186:189], a[124:127], v[170:173]
ds_read_b128 v[186:189], v210 offset:9216
ds_read_u16 v136, v217 offset:64
s_waitcnt lgkmcnt(4)
v_mfma_f32_16x16x32_bf16 v[138:141], a[8:11], v[182:185], v[138:141]
v_add_u32 v217, 1408, v217
v_mfma_f32_16x16x32_bf16 v[142:145], a[32:35], v[182:185], v[142:145]
v_mfma_f32_16x16x32_bf16 v[146:149], a[56:59], v[182:185], v[146:149]
v_mfma_f32_16x16x32_bf16 v[150:153], a[224:227], v[182:185], v[150:153]
v_mfma_f32_16x16x32_bf16 v[154:157], a[248:251], v[182:185], v[154:157]
v_mfma_f32_16x16x32_bf16 v[158:161], v[240:243], v[182:185], v[158:161]
v_mfma_f32_16x16x32_bf16 v[162:165], v[182:185], a[80:83], v[162:165]
v_mfma_f32_16x16x32_bf16 v[166:169], v[182:185], a[104:107], v[166:169]
v_mfma_f32_16x16x32_bf16 v[170:173], v[182:185], a[128:131], v[170:173]
s_waitcnt lgkmcnt(1)
ds_read_b128 v[182:185], v210 offset:10240
v_mfma_f32_16x16x32_bf16 v[138:141], a[12:15], v[186:189], v[138:141]
v_mfma_f32_16x16x32_bf16 v[142:145], a[36:39], v[186:189], v[142:145]
v_mfma_f32_16x16x32_bf16 v[146:149], a[60:63], v[186:189], v[146:149]
v_mfma_f32_16x16x32_bf16 v[150:153], a[228:231], v[186:189], v[150:153]
v_mfma_f32_16x16x32_bf16 v[154:157], a[252:255], v[186:189], v[154:157]
v_mfma_f32_16x16x32_bf16 v[158:161], v[244:247], v[186:189], v[158:161]
v_mfma_f32_16x16x32_bf16 v[162:165], v[186:189], a[84:87], v[162:165]
v_mfma_f32_16x16x32_bf16 v[166:169], v[186:189], a[108:111], v[166:169]
v_mfma_f32_16x16x32_bf16 v[170:173], v[186:189], a[132:135], v[170:173]
s_waitcnt lgkmcnt(0)
ds_read_b128 v[186:189], v210 offset:11264
v_mfma_f32_16x16x32_bf16 v[138:141], a[16:19], v[182:185], v[138:141]
v_mfma_f32_16x16x32_bf16 v[142:145], a[40:43], v[182:185], v[142:145]
v_mfma_f32_16x16x32_bf16 v[146:149], a[64:67], v[182:185], v[146:149]
v_mfma_f32_16x16x32_bf16 v[150:153], a[232:235], v[182:185], v[150:153]
v_mfma_f32_16x16x32_bf16 v[154:157], v[224:227], v[182:185], v[154:157]
v_mfma_f32_16x16x32_bf16 v[158:161], v[248:251], v[182:185], v[158:161]
v_mfma_f32_16x16x32_bf16 v[162:165], v[182:185], a[88:91], v[162:165]
v_mfma_f32_16x16x32_bf16 v[166:169], v[182:185], a[112:115], v[166:169]
v_mfma_f32_16x16x32_bf16 v[170:173], v[182:185], a[136:139], v[170:173]
s_waitcnt lgkmcnt(0)
ds_read_b128 v[182:185], v210 offset:12288
v_mfma_f32_16x16x32_bf16 v[138:141], a[20:23], v[186:189], v[138:141]
v_mfma_f32_16x16x32_bf16 v[142:145], a[44:47], v[186:189], v[142:145]
v_mfma_f32_16x16x32_bf16 v[146:149], a[68:71], v[186:189], v[146:149]
v_mfma_f32_16x16x32_bf16 v[150:153], a[236:239], v[186:189], v[150:153]
s_nop 4
v_cvt_pk_bf16_f32 v96, v138, v139
v_cvt_pk_bf16_f32 v97, v140, v141
v_mfma_f32_16x16x32_bf16 v[154:157], v[228:231], v[186:189], v[154:157]
v_cvt_pk_bf16_f32 v98, v142, v143
v_cvt_pk_bf16_f32 v99, v144, v145
v_mfma_f32_16x16x32_bf16 v[158:161], v[252:255], v[186:189], v[158:161]
s_barrier
v_mfma_f32_16x16x32_bf16 v[162:165], v[186:189], a[92:95], v[162:165]
v_mfma_f32_16x16x32_bf16 v[166:169], v[186:189], a[116:119], v[166:169]
v_cvt_pk_bf16_f32 v100, v146, v147
v_cvt_pk_bf16_f32 v101, v148, v149
v_mfma_f32_16x16x32_bf16 v[170:173], v[186:189], a[140:143], v[170:173]
s_waitcnt lgkmcnt(0)
ds_read_b128 v[186:189], v210 offset:13312
v_cvt_pk_bf16_f32 v84, v150, v151
v_mfma_f32_16x16x32_bf16 v[138:141], a[0:3], v[182:185], 0
v_cvt_pk_bf16_f32 v85, v152, v153
v_cvt_pk_bf16_f32 v86, v154, v155
v_mfma_f32_16x16x32_bf16 v[142:145], a[24:27], v[182:185], 0
v_mfma_f32_16x16x32_bf16 v[146:149], a[48:51], v[182:185], 0
v_cvt_pk_bf16_f32 v87, v156, v157
v_cvt_pk_bf16_f32 v88, v158, v159
v_mfma_f32_16x16x32_bf16 v[150:153], a[216:219], v[182:185], 0
v_cvt_pk_bf16_f32 v89, v160, v161
v_cvt_pk_bf16_f32 v116, v162, v163
v_mfma_f32_16x16x32_bf16 v[154:157], a[240:243], v[182:185], 0
v_cvt_pk_bf16_f32 v117, v164, v165
v_cvt_pk_bf16_f32 v124, v166, v167
v_mfma_f32_16x16x32_bf16 v[158:161], v[232:235], v[182:185], 0
v_mfma_f32_16x16x32_bf16 v[162:165], v[182:185], a[72:75], 0
v_cvt_pk_bf16_f32 v125, v168, v169
v_cvt_pk_bf16_f32 v132, v170, v171
v_mfma_f32_16x16x32_bf16 v[166:169], v[182:185], a[96:99], 0
v_cvt_pk_bf16_f32 v133, v172, v173
v_mfma_f32_16x16x32_bf16 v[170:173], v[182:185], a[120:123], 0
s_waitcnt lgkmcnt(0)
v_mfma_f32_16x16x32_bf16 v[138:141], a[4:7], v[186:189], v[138:141]
v_mfma_f32_16x16x32_bf16 v[142:145], a[28:31], v[186:189], v[142:145]
v_mfma_f32_16x16x32_bf16 v[146:149], a[52:55], v[186:189], v[146:149]
v_mfma_f32_16x16x32_bf16 v[150:153], a[220:223], v[186:189], v[150:153]
v_mfma_f32_16x16x32_bf16 v[154:157], a[244:247], v[186:189], v[154:157]
ds_read_b128 v[182:185], v210 offset:14336
v_mfma_f32_16x16x32_bf16 v[158:161], v[236:239], v[186:189], v[158:161]
v_mfma_f32_16x16x32_bf16 v[162:165], v[186:189], a[76:79], v[162:165]
v_mfma_f32_16x16x32_bf16 v[166:169], v[186:189], a[100:103], v[166:169]
v_mfma_f32_16x16x32_bf16 v[170:173], v[186:189], a[124:127], v[170:173]
s_waitcnt lgkmcnt(0)
v_mfma_f32_16x16x32_bf16 v[138:141], a[8:11], v[182:185], v[138:141]
v_mfma_f32_16x16x32_bf16 v[142:145], a[32:35], v[182:185], v[142:145]
v_mfma_f32_16x16x32_bf16 v[146:149], a[56:59], v[182:185], v[146:149]
ds_read_b128 v[186:189], v210 offset:15360
v_mfma_f32_16x16x32_bf16 v[150:153], a[224:227], v[182:185], v[150:153]
v_mfma_f32_16x16x32_bf16 v[154:157], a[248:251], v[182:185], v[154:157]
v_mov_b32 v181, 0
v_mfma_f32_16x16x32_bf16 v[158:161], v[240:243], v[182:185], v[158:161]
v_mfma_f32_16x16x32_bf16 v[162:165], v[182:185], a[80:83], v[162:165]
v_mfma_f32_16x16x32_bf16 v[166:169], v[182:185], a[104:107], v[166:169]
v_mfma_f32_16x16x32_bf16 v[170:173], v[182:185], a[128:131], v[170:173]
s_waitcnt lgkmcnt(0)
v_mfma_f32_16x16x32_bf16 v[138:141], a[12:15], v[186:189], v[138:141]
v_mfma_f32_16x16x32_bf16 v[142:145], a[36:39], v[186:189], v[142:145]
v_mfma_f32_16x16x32_bf16 v[146:149], a[60:63], v[186:189], v[146:149]
v_mfma_f32_16x16x32_bf16 v[150:153], a[228:231], v[186:189], v[150:153]
ds_read_b128 v[182:185], v210 offset:16384
v_mfma_f32_16x16x32_bf16 v[154:157], a[252:255], v[186:189], v[154:157]
v_mfma_f32_16x16x32_bf16 v[158:161], v[244:247], v[186:189], v[158:161]
v_mfma_f32_16x16x32_bf16 v[162:165], v[186:189], a[84:87], v[162:165]
v_mfma_f32_16x16x32_bf16 v[166:169], v[186:189], a[108:111], v[166:169]
v_mfma_f32_16x16x32_bf16 v[170:173], v[186:189], a[132:135], v[170:173]
s_waitcnt lgkmcnt(0)
v_mfma_f32_16x16x32_bf16 v[138:141], a[16:19], v[182:185], v[138:141]
ds_read_b128 v[186:189], v210 offset:17408
v_mfma_f32_16x16x32_bf16 v[142:145], a[40:43], v[182:185], v[142:145]
v_mfma_f32_16x16x32_bf16 v[146:149], a[64:67], v[182:185], v[146:149]
v_mfma_f32_16x16x32_bf16 v[150:153], a[232:235], v[182:185], v[150:153]
v_mfma_f32_16x16x32_bf16 v[154:157], v[224:227], v[182:185], v[154:157]
v_mfma_f32_16x16x32_bf16 v[158:161], v[248:251], v[182:185], v[158:161]
v_mfma_f32_16x16x32_bf16 v[162:165], v[182:185], a[88:91], v[162:165]
v_mfma_f32_16x16x32_bf16 v[166:169], v[182:185], a[112:115], v[166:169]
v_mfma_f32_16x16x32_bf16 v[170:173], v[182:185], a[136:139], v[170:173]
s_waitcnt lgkmcnt(0)
v_mfma_f32_16x16x32_bf16 v[138:141], a[20:23], v[186:189], v[138:141]
v_mfma_f32_16x16x32_bf16 v[142:145], a[44:47], v[186:189], v[142:145]
v_mfma_f32_16x16x32_bf16 v[146:149], a[68:71], v[186:189], v[146:149]
v_mfma_f32_16x16x32_bf16 v[150:153], a[236:239], v[186:189], v[150:153]
v_mfma_f32_16x16x32_bf16 v[154:157], v[228:231], v[186:189], v[154:157]
v_mfma_f32_16x16x32_bf16 v[158:161], v[252:255], v[186:189], v[158:161]
v_mfma_f32_16x16x32_bf16 v[162:165], v[186:189], a[92:95], v[162:165]
ds_read_b128 v[108:111], v216 offset:512
v_mfma_f32_16x16x32_bf16 v[166:169], v[186:189], a[116:119], v[166:169]
v_cvt_pk_bf16_f32 v102, v138, v139
v_mfma_f32_16x16x32_bf16 v[170:173], v[186:189], a[140:143], v[170:173]
ds_read_b64 v[112:113], v216 offset:528
v_cvt_pk_bf16_f32 v103, v140, v141
v_mfma_f32_16x16x32_bf16 v[138:141], v[78:81], v[72:75], 0
v_cvt_pk_bf16_f32 v104, v142, v143
v_cvt_pk_bf16_f32 v105, v144, v145
v_mfma_f32_16x16x32_bf16 v[142:145], v[96:99], v[72:75], 0
v_cvt_pk_bf16_f32 v106, v146, v147
v_cvt_pk_bf16_f32 v107, v148, v149
v_mfma_f32_16x16x32_bf16 v[146:149], v[102:105], v[72:75], 0
s_waitcnt lgkmcnt(1)
v_cvt_pk_bf16_f32 v90, v150, v151
v_cvt_pk_bf16_f32 v91, v152, v153
v_mfma_f32_16x16x32_bf16 v[150:153], v[108:111], v[72:75], v[206:209]
ds_read_b128 v[72:75], v216
v_cvt_pk_bf16_f32 v92, v154, v155
v_mfma_f32_16x16x16_bf16 v[138:141], v[82:83], v[76:77], v[138:141]
v_cvt_pk_bf16_f32 v93, v156, v157
v_cvt_pk_bf16_f32 v94, v158, v159
v_mfma_f32_16x16x16_bf16 v[142:145], v[100:101], v[76:77], v[142:145]
s_waitcnt lgkmcnt(1)
v_cvt_pk_bf16_f32 v95, v160, v161
v_cvt_pk_bf16_f32 v118, v162, v163
v_mfma_f32_16x16x16_bf16 v[150:153], v[112:113], v[76:77], v[150:153]
v_cvt_pk_bf16_f32 v119, v164, v165
v_cvt_pk_bf16_f32 v126, v166, v167
v_mfma_f32_16x16x16_bf16 v[146:149], v[106:107], v[76:77], v[146:149]
ds_read_b64 v[76:77], v216 offset:16
v_cvt_pk_bf16_f32 v127, v168, v169
v_mfma_f32_16x16x32_bf16 v[154:157], v[78:81], v[84:87], 0
v_cvt_pk_bf16_f32 v134, v170, v171
v_cvt_pk_bf16_f32 v135, v172, v173
v_mfma_f32_16x16x32_bf16 v[158:161], v[96:99], v[84:87], 0
v_max3_f32 v220, v138, v139, v140
v_max3_f32 v220, v220, v141, v142
v_mfma_f32_16x16x32_bf16 v[166:169], v[108:111], v[84:87], v[206:209]
v_max3_f32 v220, v220, v143, v144
v_max3_f32 v220, v220, v145, v146
v_mfma_f32_16x16x32_bf16 v[162:165], v[102:105], v[84:87], 0
v_max3_f32 v220, v220, v147, v148
v_max3_f32 v220, v220, v149, v150
v_mfma_f32_16x16x16_bf16 v[154:157], v[82:83], v[88:89], v[154:157]
v_mov_b32 v221, v220
v_mfma_f32_16x16x16_bf16 v[158:161], v[100:101], v[88:89], v[158:161]
s_nop 0
v_permlane16_swap_b32 v220, v221
v_mfma_f32_16x16x16_bf16 v[166:169], v[112:113], v[88:89], v[166:169]
v_max_f32 v220, v220, v221
v_mov_b32 v221, v220
v_mfma_f32_16x16x16_bf16 v[162:165], v[106:107], v[88:89], v[162:165]
s_nop 0
v_permlane32_swap_b32 v220, v221
v_max_f32 v220, v220, v221
v_sub_f32 v138, v138, v220
v_sub_f32 v139, v139, v220
v_sub_f32 v140, v140, v220
v_sub_f32 v141, v141, v220
v_sub_f32 v142, v142, v220
v_sub_f32 v143, v143, v220
v_sub_f32 v144, v144, v220
v_sub_f32 v145, v145, v220
v_sub_f32 v150, v150, v220
v_sub_f32 v146, v146, v220
v_sub_f32 v147, v147, v220
v_sub_f32 v148, v148, v220
v_sub_f32 v149, v149, v220
v_exp_f32 v138, v138
v_exp_f32 v139, v139
v_exp_f32 v140, v140
v_exp_f32 v141, v141
v_exp_f32 v142, v142
v_exp_f32 v143, v143
v_exp_f32 v144, v144
v_exp_f32 v145, v145
v_exp_f32 v150, v150
v_exp_f32 v146, v146
v_exp_f32 v147, v147
v_exp_f32 v148, v148
v_exp_f32 v149, v149
v_cvt_pk_bf16_f32 v174, v138, v139
v_cvt_pk_bf16_f32 v175, v140, v141
v_cvt_pk_bf16_f32 v176, v142, v143
v_cvt_pk_bf16_f32 v177, v144, v145
v_cvt_pk_bf16_f32 v178, v146, v147
v_cvt_pk_bf16_f32 v179, v148, v149
v_mfma_f32_16x16x32_bf16 v[138:141], v[114:117], v[174:177], 0
v_cvt_pk_bf16_f32 v180, v150, 0
v_max3_f32 v220, v154, v155, v156
v_mfma_f32_16x16x32_bf16 v[150:153], v[190:193], v[174:177], 0
v_max3_f32 v220, v220, v157, v158
v_max3_f32 v220, v220, v159, v160
v_mfma_f32_16x16x32_bf16 v[142:145], v[122:125], v[174:177], 0
v_max3_f32 v220, v220, v161, v162
v_max3_f32 v220, v220, v163, v164
v_mfma_f32_16x16x32_bf16 v[146:149], v[130:133], v[174:177], 0
v_max3_f32 v220, v220, v165, v166
v_mov_b32 v221, v220
v_mfma_f32_16x16x32_bf16 v[150:153], v[190:193], v[178:181], v[150:153]
s_nop 0
v_permlane16_swap_b32 v220, v221
v_mfma_f32_16x16x32_bf16 v[138:141], v[118:121], v[178:181], v[138:141]
v_max_f32 v220, v220, v221
v_mov_b32 v221, v220
v_mfma_f32_16x16x32_bf16 v[142:145], v[126:129], v[178:181], v[142:145]
s_nop 0
v_permlane32_swap_b32 v220, v221
v_mfma_f32_16x16x32_bf16 v[146:149], v[134:137], v[178:181], v[146:149]
v_max_f32 v220, v220, v221
v_sub_f32 v154, v154, v220
v_sub_f32 v155, v155, v220
v_sub_f32 v156, v156, v220
v_sub_f32 v157, v157, v220
v_sub_f32 v158, v158, v220
v_sub_f32 v159, v159, v220
v_sub_f32 v160, v160, v220
v_sub_f32 v161, v161, v220
v_sub_f32 v166, v166, v220
v_sub_f32 v162, v162, v220
v_sub_f32 v163, v163, v220
v_sub_f32 v164, v164, v220
v_sub_f32 v165, v165, v220
v_exp_f32 v154, v154
v_exp_f32 v155, v155
v_exp_f32 v156, v156
v_exp_f32 v157, v157
v_exp_f32 v158, v158
v_exp_f32 v159, v159
v_exp_f32 v160, v160
v_exp_f32 v161, v161
v_exp_f32 v166, v166
v_exp_f32 v162, v162
v_exp_f32 v163, v163
v_exp_f32 v164, v164
v_exp_f32 v165, v165
v_cvt_pk_bf16_f32 v174, v154, v155
v_cvt_pk_bf16_f32 v175, v156, v157
v_cvt_pk_bf16_f32 v176, v158, v159
v_cvt_pk_bf16_f32 v177, v160, v161
v_cvt_pk_bf16_f32 v178, v162, v163
v_cvt_pk_bf16_f32 v179, v164, v165
v_mfma_f32_16x16x32_bf16 v[154:157], v[114:117], v[174:177], 0
v_cvt_pk_bf16_f32 v180, v166, 0
v_rcp_f32 v151, v150
v_mfma_f32_16x16x32_bf16 v[166:169], v[190:193], v[174:177], 0
v_mul_f32 v138, v138, v151
v_mul_f32 v139, v139, v151
v_mfma_f32_16x16x32_bf16 v[158:161], v[122:125], v[174:177], 0
v_cvt_pk_bf16_f32 v138, v138, v139
v_mul_f32 v140, v140, v151
v_mfma_f32_16x16x32_bf16 v[162:165], v[130:133], v[174:177], 0
v_mul_f32 v141, v141, v151
v_cvt_pk_bf16_f32 v139, v140, v141
v_mfma_f32_16x16x32_bf16 v[166:169], v[190:193], v[178:181], v[166:169]
v_mul_f32 v142, v142, v151
v_mul_f32 v143, v143, v151
v_mfma_f32_16x16x32_bf16 v[154:157], v[118:121], v[178:181], v[154:157]
v_cvt_pk_bf16_f32 v140, v142, v143
v_mul_f32 v144, v144, v151
v_mfma_f32_16x16x32_bf16 v[158:161], v[126:129], v[178:181], v[158:161]
v_mul_f32 v145, v145, v151
v_cvt_pk_bf16_f32 v141, v144, v145
v_mfma_f32_16x16x32_bf16 v[162:165], v[134:137], v[178:181], v[162:165]
ds_write_b128 v211, v[138:141] offset:36864
v_mfma_f32_16x16x32_bf16 v[138:141], v[78:81], v[90:93], 0
v_mul_f32 v146, v146, v151
v_mul_f32 v147, v147, v151
v_cvt_pk_bf16_f32 v142, v146, v147
v_mul_f32 v148, v148, v151
v_mul_f32 v149, v149, v151
v_mfma_f32_16x16x32_bf16 v[150:153], v[108:111], v[90:93], v[206:209]
v_cvt_pk_bf16_f32 v143, v148, v149
v_rcp_f32 v167, v166
v_mfma_f32_16x16x32_bf16 v[146:149], v[102:105], v[90:93], 0
ds_write_b64 v212, v[142:143] offset:36864
v_mfma_f32_16x16x32_bf16 v[142:145], v[96:99], v[90:93], 0
v_mul_f32 v154, v154, v167
v_mul_f32 v155, v155, v167
v_mfma_f32_16x16x16_bf16 v[138:141], v[82:83], v[94:95], v[138:141]
v_cvt_pk_bf16_f32 v154, v154, v155
v_mul_f32 v156, v156, v167
v_mfma_f32_16x16x16_bf16 v[150:153], v[112:113], v[94:95], v[150:153]
v_mul_f32 v157, v157, v167
v_cvt_pk_bf16_f32 v155, v156, v157
v_mfma_f32_16x16x16_bf16 v[142:145], v[100:101], v[94:95], v[142:145]
v_mul_f32 v158, v158, v167
v_mul_f32 v159, v159, v167
v_mfma_f32_16x16x16_bf16 v[146:149], v[106:107], v[94:95], v[146:149]
s_waitcnt lgkmcnt(3)
v_cvt_pk_bf16_f32 v156, v158, v159
v_mul_f32 v160, v160, v167
v_mul_f32 v161, v161, v167
v_cvt_pk_bf16_f32 v157, v160, v161
v_mul_f32 v162, v162, v167
v_mul_f32 v163, v163, v167
v_cvt_pk_bf16_f32 v158, v162, v163
v_mul_f32 v164, v164, v167
v_mul_f32 v165, v165, v167
v_mfma_f32_16x16x32_bf16 v[166:169], v[108:111], v[72:75], v[206:209]
ds_write_b128 v211, v[154:157] offset:43008
v_mfma_f32_16x16x32_bf16 v[154:157], v[78:81], v[72:75], 0
v_cvt_pk_bf16_f32 v159, v164, v165
v_max3_f32 v220, v138, v139, v140
v_mfma_f32_16x16x32_bf16 v[162:165], v[102:105], v[72:75], 0
ds_write_b64 v212, v[158:159] offset:43008
v_mfma_f32_16x16x32_bf16 v[158:161], v[96:99], v[72:75], 0
s_waitcnt lgkmcnt(4)
v_max3_f32 v220, v220, v141, v142
v_max3_f32 v220, v220, v143, v144
v_mfma_f32_16x16x16_bf16 v[154:157], v[82:83], v[76:77], v[154:157]
v_max3_f32 v220, v220, v145, v146
v_max3_f32 v220, v220, v147, v148
v_mfma_f32_16x16x16_bf16 v[166:169], v[112:113], v[76:77], v[166:169]
v_max3_f32 v220, v220, v149, v150
v_mov_b32 v221, v220
v_mfma_f32_16x16x16_bf16 v[158:161], v[100:101], v[76:77], v[158:161]
s_nop 0
v_permlane16_swap_b32 v220, v221
v_mfma_f32_16x16x16_bf16 v[162:165], v[106:107], v[76:77], v[162:165]
v_max_f32 v220, v220, v221
v_mov_b32 v221, v220
s_nop 1
v_permlane32_swap_b32 v220, v221
v_max_f32 v220, v220, v221
v_sub_f32 v138, v138, v220
v_sub_f32 v139, v139, v220
v_sub_f32 v140, v140, v220
v_sub_f32 v141, v141, v220
v_sub_f32 v142, v142, v220
v_sub_f32 v143, v143, v220
v_sub_f32 v144, v144, v220
v_sub_f32 v145, v145, v220
v_sub_f32 v150, v150, v220
v_sub_f32 v146, v146, v220
v_sub_f32 v147, v147, v220
v_sub_f32 v148, v148, v220
v_sub_f32 v149, v149, v220
v_exp_f32 v138, v138
s_waitcnt lgkmcnt(0)
s_barrier
ds_read_b128 v[170:173], v210 offset:36864
ds_read_b128 v[182:185], v210 offset:37888
ds_read_b128 v[186:189], v210 offset:38912
v_exp_f32 v139, v139
v_exp_f32 v140, v140
v_exp_f32 v141, v141
v_exp_f32 v142, v142
v_exp_f32 v143, v143
v_exp_f32 v144, v144
v_exp_f32 v145, v145
v_exp_f32 v150, v150
v_exp_f32 v146, v146
v_exp_f32 v147, v147
v_exp_f32 v148, v148
s_waitcnt lgkmcnt(2)
v_mfma_f32_16x16x32_bf16 v[0:3], a[144:147], v[170:173], v[0:3]
v_exp_f32 v149, v149
v_mfma_f32_16x16x32_bf16 v[4:7], a[168:171], v[170:173], v[4:7]
v_cvt_pk_bf16_f32 v174, v138, v139
v_cvt_pk_bf16_f32 v175, v140, v141
v_mfma_f32_16x16x32_bf16 v[8:11], a[192:195], v[170:173], v[8:11]
s_waitcnt lgkmcnt(1)
ds_read_b128 v[170:173], v210 offset:39936
v_cvt_pk_bf16_f32 v176, v142, v143
v_mfma_f32_16x16x32_bf16 v[0:3], a[148:151], v[182:185], v[0:3]
v_cvt_pk_bf16_f32 v177, v144, v145
v_cvt_pk_bf16_f32 v178, v146, v147
v_mfma_f32_16x16x32_bf16 v[4:7], a[172:175], v[182:185], v[4:7]
v_cvt_pk_bf16_f32 v179, v148, v149
v_cvt_pk_bf16_f32 v180, v150, 0
v_mfma_f32_16x16x32_bf16 v[8:11], a[196:199], v[182:185], v[8:11]
s_waitcnt lgkmcnt(1)
ds_read_b128 v[182:185], v210 offset:40960
v_max3_f32 v220, v154, v155, v156
v_mfma_f32_16x16x32_bf16 v[0:3], a[152:155], v[186:189], v[0:3]
v_max3_f32 v220, v220, v157, v158
v_max3_f32 v220, v220, v159, v160
v_mfma_f32_16x16x32_bf16 v[4:7], a[176:179], v[186:189], v[4:7]
v_max3_f32 v220, v220, v161, v162
v_max3_f32 v220, v220, v163, v164
v_mfma_f32_16x16x32_bf16 v[8:11], a[200:203], v[186:189], v[8:11]
s_waitcnt lgkmcnt(1)
ds_read_b128 v[186:189], v210 offset:41984
v_max3_f32 v220, v220, v165, v166
v_mfma_f32_16x16x32_bf16 v[0:3], a[156:159], v[170:173], v[0:3]
v_mov_b32 v221, v220
v_mfma_f32_16x16x32_bf16 v[4:7], a[180:183], v[170:173], v[4:7]
s_nop 0
v_permlane16_swap_b32 v220, v221
v_mfma_f32_16x16x32_bf16 v[8:11], a[204:207], v[170:173], v[8:11]
s_waitcnt lgkmcnt(1)
ds_read_b128 v[170:173], v210 offset:43008
v_max_f32 v220, v220, v221
v_mfma_f32_16x16x32_bf16 v[0:3], a[160:163], v[182:185], v[0:3]
v_mov_b32 v221, v220
v_mfma_f32_16x16x32_bf16 v[4:7], a[184:187], v[182:185], v[4:7]
s_nop 0
v_permlane32_swap_b32 v220, v221
v_mfma_f32_16x16x32_bf16 v[8:11], a[208:211], v[182:185], v[8:11]
ds_read_b128 v[182:185], v210 offset:44032
v_max_f32 v220, v220, v221
v_mfma_f32_16x16x32_bf16 v[150:153], v[190:193], v[174:177], 0
v_sub_f32 v154, v154, v220
v_sub_f32 v155, v155, v220
v_mfma_f32_16x16x32_bf16 v[138:141], v[114:117], v[174:177], 0
v_sub_f32 v156, v156, v220
v_sub_f32 v157, v157, v220
v_mfma_f32_16x16x32_bf16 v[142:145], v[122:125], v[174:177], 0
v_sub_f32 v158, v158, v220
v_sub_f32 v159, v159, v220
v_mfma_f32_16x16x32_bf16 v[146:149], v[130:133], v[174:177], 0
s_waitcnt lgkmcnt(2)
v_sub_f32 v160, v160, v220
v_sub_f32 v161, v161, v220
v_mfma_f32_16x16x32_bf16 v[0:3], a[164:167], v[186:189], v[0:3]
v_sub_f32 v166, v166, v220
v_sub_f32 v162, v162, v220
v_mfma_f32_16x16x32_bf16 v[150:153], v[190:193], v[178:181], v[150:153]
v_sub_f32 v163, v163, v220
v_sub_f32 v164, v164, v220
v_mfma_f32_16x16x32_bf16 v[138:141], v[118:121], v[178:181], v[138:141]
v_sub_f32 v165, v165, v220
v_exp_f32 v154, v154
v_mfma_f32_16x16x32_bf16 v[4:7], a[188:191], v[186:189], v[4:7]
v_cvt_pk_bf16_f32 v0, v0, v1
v_cvt_pk_bf16_f32 v1, v2, v3
v_mfma_f32_16x16x32_bf16 v[142:145], v[126:129], v[178:181], v[142:145]
buffer_store_dwordx2 v[0:1], v203, s[8:11], s38 offen
v_mfma_f32_16x16x32_bf16 v[8:11], a[212:215], v[186:189], v[8:11]
ds_read_b128 v[186:189], v210 offset:45056
v_exp_f32 v155, v155
v_mfma_f32_16x16x32_bf16 v[146:149], v[134:137], v[178:181], v[146:149]
s_waitcnt lgkmcnt(2)
v_cvt_pk_bf16_f32 v4, v4, v5
v_cvt_pk_bf16_f32 v5, v6, v7
v_mfma_f32_16x16x32_bf16 v[12:15], a[144:147], v[170:173], v[12:15]
buffer_store_dwordx2 v[4:5], v203, s[8:11], s38 offen offset:32
v_mfma_f32_16x16x32_bf16 v[16:19], a[168:171], v[170:173], v[16:19]
v_cvt_pk_bf16_f32 v8, v8, v9
v_exp_f32 v156, v156
v_mfma_f32_16x16x32_bf16 v[20:23], a[192:195], v[170:173], v[20:23]
s_waitcnt lgkmcnt(1)
ds_read_b128 v[170:173], v210 offset:46080
v_cvt_pk_bf16_f32 v9, v10, v11
v_mfma_f32_16x16x32_bf16 v[12:15], a[148:151], v[182:185], v[12:15]
buffer_store_dwordx2 v[8:9], v203, s[8:11], s38 offen offset:64
v_mfma_f32_16x16x32_bf16 v[16:19], a[172:175], v[182:185], v[16:19]
v_exp_f32 v157, v157
v_mfma_f32_16x16x32_bf16 v[20:23], a[196:199], v[182:185], v[20:23]
s_waitcnt lgkmcnt(1)
ds_read_b128 v[182:185], v210 offset:47104
v_exp_f32 v158, v158
v_mfma_f32_16x16x32_bf16 v[12:15], a[152:155], v[186:189], v[12:15]
v_exp_f32 v159, v159
v_mfma_f32_16x16x32_bf16 v[16:19], a[176:179], v[186:189], v[16:19]
v_exp_f32 v160, v160
v_mfma_f32_16x16x32_bf16 v[20:23], a[200:203], v[186:189], v[20:23]
s_waitcnt lgkmcnt(1)
ds_read_b128 v[186:189], v210 offset:48128
v_exp_f32 v161, v161
v_mfma_f32_16x16x32_bf16 v[12:15], a[156:159], v[170:173], v[12:15]
v_exp_f32 v166, v166
v_mfma_f32_16x16x32_bf16 v[16:19], a[180:183], v[170:173], v[16:19]
v_exp_f32 v162, v162
v_mfma_f32_16x16x32_bf16 v[20:23], a[204:207], v[170:173], v[20:23]
s_waitcnt lgkmcnt(1)
v_exp_f32 v163, v163
v_mfma_f32_16x16x32_bf16 v[12:15], a[160:163], v[182:185], v[12:15]
v_exp_f32 v164, v164
v_mfma_f32_16x16x32_bf16 v[16:19], a[184:187], v[182:185], v[16:19]
v_exp_f32 v165, v165
v_mfma_f32_16x16x32_bf16 v[20:23], a[208:211], v[182:185], v[20:23]
s_waitcnt lgkmcnt(0)
v_cvt_pk_bf16_f32 v174, v154, v155
v_cvt_pk_bf16_f32 v175, v156, v157
v_mfma_f32_16x16x32_bf16 v[12:15], a[164:167], v[186:189], v[12:15]
v_cvt_pk_bf16_f32 v176, v158, v159
v_cvt_pk_bf16_f32 v177, v160, v161
v_mfma_f32_16x16x32_bf16 v[16:19], a[188:191], v[186:189], v[16:19]
v_cvt_pk_bf16_f32 v178, v162, v163
v_cvt_pk_bf16_f32 v179, v164, v165
v_mfma_f32_16x16x32_bf16 v[154:157], v[114:117], v[174:177], 0
v_cvt_pk_bf16_f32 v180, v166, 0
v_rcp_f32 v151, v150
v_mfma_f32_16x16x32_bf16 v[166:169], v[190:193], v[174:177], 0
v_mul_f32 v138, v138, v151
v_mul_f32 v139, v139, v151
v_mfma_f32_16x16x32_bf16 v[158:161], v[122:125], v[174:177], 0
v_cvt_pk_bf16_f32 v138, v138, v139
v_mul_f32 v140, v140, v151
v_mfma_f32_16x16x32_bf16 v[162:165], v[130:133], v[174:177], 0
v_mul_f32 v141, v141, v151
v_cvt_pk_bf16_f32 v139, v140, v141
v_mfma_f32_16x16x32_bf16 v[166:169], v[190:193], v[178:181], v[166:169]
v_mul_f32 v142, v142, v151
v_mul_f32 v143, v143, v151
v_mfma_f32_16x16x32_bf16 v[154:157], v[118:121], v[178:181], v[154:157]
v_cvt_pk_bf16_f32 v140, v142, v143
v_mul_f32 v144, v144, v151
v_mfma_f32_16x16x32_bf16 v[158:161], v[126:129], v[178:181], v[158:161]
v_mul_f32 v145, v145, v151
v_cvt_pk_bf16_f32 v141, v144, v145
v_mfma_f32_16x16x32_bf16 v[20:23], a[212:215], v[186:189], v[20:23]
ds_write_b128 v211, v[138:141] offset:49152
v_mfma_f32_16x16x32_bf16 v[162:165], v[134:137], v[178:181], v[162:165]
v_mul_f32 v146, v146, v151
v_mul_f32 v147, v147, v151
v_cvt_pk_bf16_f32 v142, v146, v147
v_mul_f32 v148, v148, v151
v_mul_f32 v149, v149, v151
v_cvt_pk_bf16_f32 v143, v148, v149
v_rcp_f32 v167, v166
ds_write_b64 v212, v[142:143] offset:49152
v_mul_f32 v154, v154, v167
v_mul_f32 v155, v155, v167
v_cvt_pk_bf16_f32 v154, v154, v155
v_mul_f32 v156, v156, v167
v_mul_f32 v157, v157, v167
v_cvt_pk_bf16_f32 v155, v156, v157
v_mul_f32 v158, v158, v167
v_mul_f32 v159, v159, v167
v_cvt_pk_bf16_f32 v156, v158, v159
v_mul_f32 v160, v160, v167
v_mul_f32 v161, v161, v167
v_cvt_pk_bf16_f32 v157, v160, v161
v_mul_f32 v162, v162, v167
v_mul_f32 v163, v163, v167
v_cvt_pk_bf16_f32 v158, v162, v163
v_mul_f32 v164, v164, v167
v_mul_f32 v165, v165, v167
v_cvt_pk_bf16_f32 v159, v164, v165
v_cvt_pk_bf16_f32 v12, v12, v13
v_cvt_pk_bf16_f32 v13, v14, v15
v_cvt_pk_bf16_f32 v16, v16, v17
v_cvt_pk_bf16_f32 v17, v18, v19
v_cvt_pk_bf16_f32 v20, v20, v21
ds_write_b128 v216, v[154:157]
ds_write_b64 v216, v[158:159] offset:16
buffer_store_dwordx2 v[12:13], v204, s[8:11], s38 offen
buffer_store_dwordx2 v[16:17], v204, s[8:11], s38 offen offset:32
v_add_u32 v216, 1408, v216
v_cvt_pk_bf16_f32 v21, v22, v23
s_waitcnt lgkmcnt(2)
s_barrier
ds_read_b128 v[170:173], v210 offset:49152
ds_read_b128 v[182:185], v210 offset:50176
ds_read_b128 v[186:189], v210 offset:51200
buffer_store_dwordx2 v[20:21], v204, s[8:11], s38 offen offset:64
s_waitcnt lgkmcnt(2)
v_mfma_f32_16x16x32_bf16 v[24:27], a[144:147], v[170:173], v[24:27]
v_mfma_f32_16x16x32_bf16 v[28:31], a[168:171], v[170:173], v[28:31]
v_mfma_f32_16x16x32_bf16 v[32:35], a[192:195], v[170:173], v[32:35]
s_waitcnt lgkmcnt(1)
ds_read_b128 v[170:173], v210 offset:52224
v_mfma_f32_16x16x32_bf16 v[24:27], a[148:151], v[182:185], v[24:27]
v_mfma_f32_16x16x32_bf16 v[28:31], a[172:175], v[182:185], v[28:31]
v_mfma_f32_16x16x32_bf16 v[32:35], a[196:199], v[182:185], v[32:35]
s_waitcnt lgkmcnt(1)
ds_read_b128 v[182:185], v210 offset:53248
v_mfma_f32_16x16x32_bf16 v[24:27], a[152:155], v[186:189], v[24:27]
v_mfma_f32_16x16x32_bf16 v[28:31], a[176:179], v[186:189], v[28:31]
v_mfma_f32_16x16x32_bf16 v[32:35], a[200:203], v[186:189], v[32:35]
s_waitcnt lgkmcnt(1)
ds_read_b128 v[186:189], v210 offset:54272
v_mfma_f32_16x16x32_bf16 v[24:27], a[156:159], v[170:173], v[24:27]
v_mfma_f32_16x16x32_bf16 v[28:31], a[180:183], v[170:173], v[28:31]
v_mfma_f32_16x16x32_bf16 v[32:35], a[204:207], v[170:173], v[32:35]
s_waitcnt lgkmcnt(1)
v_mfma_f32_16x16x32_bf16 v[24:27], a[160:163], v[182:185], v[24:27]
v_mfma_f32_16x16x32_bf16 v[28:31], a[184:187], v[182:185], v[28:31]
v_mfma_f32_16x16x32_bf16 v[32:35], a[208:211], v[182:185], v[32:35]
s_waitcnt lgkmcnt(0)
v_mfma_f32_16x16x32_bf16 v[24:27], a[164:167], v[186:189], v[24:27]
v_mfma_f32_16x16x32_bf16 v[28:31], a[188:191], v[186:189], v[28:31]
v_mfma_f32_16x16x32_bf16 v[32:35], a[212:215], v[186:189], v[32:35]
s_nop 5
v_cvt_pk_bf16_f32 v24, v24, v25
v_cvt_pk_bf16_f32 v25, v26, v27
buffer_store_dwordx2 v[24:25], v205, s[8:11], s38 offen
v_cvt_pk_bf16_f32 v28, v28, v29
v_cvt_pk_bf16_f32 v29, v30, v31
buffer_store_dwordx2 v[28:29], v205, s[8:11], s38 offen offset:32
v_cvt_pk_bf16_f32 v32, v32, v33
v_cvt_pk_bf16_f32 v33, v34, v35
buffer_store_dwordx2 v[32:33], v205, s[8:11], s38 offen offset:64
s_branch L_epi
.p2align 6
.type L_tab,@object
L_tab:
.long 0x0,0x3800,0x5500,0x190,0x320,0x2020,0x5820,0x4b0,0x640,0x2340,0x4040,0x7d0,0x960,0x2660,0x6060,0xaf0
.long 0x1010,0x4810,0x6510,0x11a0,0x1330,0x3030,0x6830,0x14c0,0x1650,0x3350,0x5050,0x17e0,0x1970,0x3670,0x5370,0x1b00
.long 0x190,0x3990,0x5690,0x320,0x4b0,0x21b0,0x59b0,0x640,0x7d0,0x24d0,0x41d0,0x960,0x27f0,0x44f0,0x61f0,0x2980
.long 0x2980,0x4680,0x6380,0x2b10,0x11a0,0x49a0,0x66a0,0x1330,0x14c0,0x31c0,0x69c0,0x1650,0x17e0,0x34e0,0x51e0,0x1970
.long 0x320,0x3b20,0x5820,0x1010,0x640,0x2340,0x5b40,0x1330,0x960,0x2660,0x4360,0x1650,0xc80,0x2980,0x6380,0x1970
.long 0x1330,0x4b30,0x6830,0x2020,0x1650,0x3350,0x6b50,0x2340,0x1970,0x3670,0x5370,0x2660,0x1c90,0x3990,0x5690,0x2980
.long 0x4b0,0x3cb0,0x59b0,0x11a0,0x7d0,0x24d0,0x5cd0,0x14c0,0xaf0,0x27f0,0x44f0,0x17e0,0x2b10,0x4810,0x6510,0x3800
.long 0x2ca0,0x49a0,0x66a0,0x3990,0x14c0,0x4cc0,0x69c0,0x21b0,0x17e0,0x34e0,0x6ce0,0x24d0,0x1b00,0x3800,0x5500,0x27f0
.long 0x2020,0x5820,0x7520,0x1330,0x2340,0x4040,0x7840,0x1650,0x2660,0x4360,0x6060,0x1970,0x2980,0x4680,0x8080,0x1c90
.long 0x3030,0x6830,0x8530,0x2340,0x3350,0x5050,0x8850,0x2660,0x3670,0x5370,0x7070,0x2980,0x3990,0x5690,0x7390,0x2ca0
.long 0x21b0,0x59b0,0x76b0,0x14c0,0x24d0,0x41d0,0x79d0,0x17e0,0x27f0,0x44f0,0x61f0,0x1b00,0x4810,0x6510,0x8210,0x3b20
.long 0x49a0,0x66a0,0x83a0,0x3cb0,0x31c0,0x69c0,0x86c0,0x24d0,0x34e0,0x51e0,0x89e0,0x27f0,0x3800,0x5500,0x7200,0x2b10
.long 0x2340,0x5b40,0x7840,0x21b0,0x2660,0x4360,0x7b60,0x24d0,0x2980,0x4680,0x6380,0x27f0,0x2ca0,0x49a0,0x83a0,0x2b10
.long 0x3350,0x6b50,0x8850,0x31c0,0x3670,0x5370,0x8b70,0x34e0,0x3990,0x5690,0x7390,0x3800,0x3cb0,0x59b0,0x76b0,0x3b20
.long 0x24d0,0x5cd0,0x79d0,0x2340,0x27f0,0x44f0,0x7cf0,0x2660,0x2b10,0x4810,0x6510,0x2980,0x4b30,0x6830,0x8530,0x49a0
.long 0x4cc0,0x69c0,0x86c0,0x4b30,0x34e0,0x6ce0,0x89e0,0x3350,0x3800,0x5500,0x8d00,0x3670,0x3b20,0x5820,0x7520,0x3990
.long 0x3990,0x5690,0x11a0,0x49a0,0x21b0,0x59b0,0x14c0,0x31c0,0x24d0,0x41d0,0x17e0,0x34e0,0x27f0,0x61f0,0x1b00,0x3800
.long 0x49a0,0x66a0,0x21b0,0x59b0,0x31c0,0x69c0,0x24d0,0x41d0,0x34e0,0x51e0,0x27f0,0x44f0,0x3800,0x5500,0x2b10,0x4810
.long 0x3b20,0x5820,0x1330,0x4b30,0x2340,0x5b40,0x1650,0x3350,0x2660,0x4360,0x1970,0x3670,0x4680,0x6380,0x3990,0x5690
.long 0x4810,0x6510,0x3b20,0x5820,0x4b30,0x6830,0x2340,0x5b40,0x3350,0x6b50,0x2660,0x4360,0x3670,0x5370,0x2980,0x4680
.long 0x4810,0x6510,0x11a0,0x49a0,0x3030,0x6830,0x14c0,0x31c0,0x3350,0x5050,0x17e0,0x34e0,0x3670,0x7070,0x1b00,0x3800
.long 0x5820,0x7520,0x21b0,0x59b0,0x4040,0x7840,0x24d0,0x41d0,0x4360,0x6060,0x27f0,0x44f0,0x4680,0x6380,0x2b10,0x4810
.long 0x49a0,0x66a0,0x1330,0x4b30,0x31c0,0x69c0,0x1650,0x3350,0x34e0,0x51e0,0x1970,0x3670,0x5500,0x7200,0x3990,0x5690
.long 0x5690,0x7390,0x3b20,0x5820,0x59b0,0x76b0,0x2340,0x5b40,0x41d0,0x79d0,0x2660,0x4360,0x44f0,0x61f0,0x2980,0x4680
.long 0x4b30,0x6830,0x11b0,0x49b0,0x3350,0x6b50,0x14d0,0x31d0,0x3670,0x5370,0x17f0,0x34f0,0x3990,0x7390,0x1b10,0x3810
.long 0x5b40,0x7840,0x21c0,0x59c0,0x4360,0x7b60,0x24e0,0x41e0,0x4680,0x6380,0x2800,0x4500,0x49a0,0x66a0,0x2b20,0x4820
.long 0x4cc0,0x69c0,0x1340,0x4b40,0x34e0,0x6ce0,0x1660,0x3360,0x3800,0x5500,0x1980,0x3680,0x5820,0x7520,0x39a0,0x56a0
.long 0x59b0,0x76b0,0x3b30,0x5830,0x5cd0,0x79d0,0x2350,0x5b50,0x44f0,0x7cf0,0x2670,0x4370,0x4810,0x6510,0x2990,0x4690
.long 0x59b0,0x76b0,0x11b0,0x49b0,0x41d0,0x79d0,0x14d0,0x31d0,0x44f0,0x61f0,0x17f0,0x34f0,0x4810,0x8210,0x1b10,0x3810
.long 0x69c0,0x86c0,0x21c0,0x59c0,0x51e0,0x89e0,0x24e0,0x41e0,0x5500,0x7200,0x2800,0x4500,0x5820,0x7520,0x2b20,0x4820
.long 0x5b40,0x7840,0x1340,0x4b40,0x4360,0x7b60,0x1660,0x3360,0x4680,0x6380,0x1980,0x3680,0x66a0,0x83a0,0x39a0,0x56a0
.long 0x6830,0x8530,0x3b30,0x5830,0x6b50,0x8850,0x2350,0x5b50,0x5370,0x8b70,0x2670,0x4370,0x5690,0x7390,0x2990,0x4690
.long 0x66a0,0x0,0x90300,0xefd00,0x69c0,0x300,0x5fd00,0xf0000,0x51e0,0x600,0x60000,0xbfa00,0x7200,0x900,0x60300,0x11f700
.long 0x76b0,0x2fe80,0xc0180,0x11fb80,0x79d0,0x30180,0x8fb80,0x11fe80,0x61f0,0x30480,0x8fe80,0xef880,0x6510,0x30780,0x90180,0xefb80
.long 0x6830,0x180,0x90480,0xefe80,0x6b50,0x480,0x5fe80,0xf0180,0x5370,0x780,0x60180,0xbfb80,0x7390,0x60480,0xbfe80,0x11f880
.long 0x7520,0x60600,0xc0000,0x11fa00,0x7840,0x30000,0xc0300,0x11fd00,0x7b60,0x30300,0x8fd00,0x120000,0x6380,0x30600,0x90000,0xefa00
.long 0x66a0,0x8,0x90308,0xefd08,0x69c0,0x308,0x5fd08,0xf0008,0x51e0,0x608,0x60008,0xbfa08,0x7200,0x908,0x60308,0x11f708
.long 0x76b0,0x2fe88,0xc0188,0x11fb88,0x79d0,0x30188,0x8fb88,0x11fe88,0x61f0,0x30488,0x8fe88,0xef888,0x6510,0x30788,0x90188,0xefb88
.long 0x6830,0x188,0x90488,0xefe88,0x6b50,0x488,0x5fe88,0xf0188,0x5370,0x788,0x60188,0xbfb88,0x7390,0x60488,0xbfe88,0x11f888
.long 0x7520,0x60608,0xc0008,0x11fa08,0x7840,0x30008,0xc0308,0x11fd08,0x7b60,0x30308,0x8fd08,0x120008,0x6380,0x30608,0x90008,0xefa08
.long 0x66b0,0x10,0x90310,0xefd10,0x69d0,0x310,0x5fd10,0xf0010,0x51f0,0x610,0x60010,0xbfa10,0x7210,0x910,0x60310,0x11f710
.long 0x76c0,0x2fe90,0xc0190,0x11fb90,0x79e0,0x30190,0x8fb90,0x11fe90,0x6200,0x30490,0x8fe90,0xef890,0x6520,0x30790,0x90190,0xefb90
.long 0x6840,0x190,0x90490,0xefe90,0x6b60,0x490,0x5fe90,0xf0190,0x5380,0x790,0x60190,0xbfb90,0x73a0,0x60490,0xbfe90,0x11f890
.long 0x7530,0x60610,0xc0010,0x11fa10,0x7850,0x30010,0xc0310,0x11fd10,0x7b70,0x30310,0x8fd10,0x120010,0x6390,0x30610,0x90010,0xefa10
.long 0x66b0,0x18,0x90318,0xefd18,0x69d0,0x318,0x5fd18,0xf0018,0x51f0,0x618,0x60018,0xbfa18,0x7210,0x918,0x60318,0x11f718
.long 0x76c0,0x2fe98,0xc0198,0x11fb98,0x79e0,0x30198,0x8fb98,0x11fe98,0x6200,0x30498,0x8fe98,0xef898,0x6520,0x30798,0x90198,0xefb98
.long 0x6840,0x198,0x90498,0xefe98,0x6b60,0x498,0x5fe98,0xf0198,0x5380,0x798,0x60198,0xbfb98,0x73a0,0x60498,0xbfe98,0x11f898
.long 0x7530,0x60618,0xc0018,0x11fa18,0x7850,0x30018,0xc0318,0x11fd18,0x7b70,0x30318,0x8fd18,0x120018,0x6390,0x30618,0x90018,0xefa18
.long 0xdb40,0xdb40,0xeb40,0x1b340,0xdb50,0xdb50,0xeb50,0x1b350,0xdb60,0xdb60,0xeb60,0x1b360,0xdb70,0xdb70,0xeb70,0x1b370
.long 0xdb80,0xdb80,0xeb80,0x1b380,0xdb90,0xdb90,0xeb90,0x1b390,0xdba0,0xdba0,0xeba0,0x1b3a0,0xdbb0,0xdbb0,0xebb0,0x1b3b0
.long 0xdbc0,0xdbc0,0xebc0,0x1b3c0,0xdbd0,0xdbd0,0xebd0,0x1b3d0,0xdbe0,0xdbe0,0xebe0,0x1b3e0,0xdbf0,0xdbf0,0xebf0,0x1b3f0
.long 0xdc00,0xdc00,0xec00,0x1b400,0xdc10,0xdc10,0xec10,0x1b410,0xdc20,0xdc20,0xec20,0x1b420,0xdc30,0xdc30,0xec30,0x1b430
.long 0xdc40,0xdc40,0xec40,0x1b740,0xdc50,0xdc50,0xec50,0x1b750,0xdc60,0xdc60,0xec60,0x1b760,0xdc70,0xdc70,0xec70,0x1b770
.long 0xdc80,0xdc80,0xec80,0x1b780,0xdc90,0xdc90,0xec90,0x1b790,0xdca0,0xdca0,0xeca0,0x1b7a0,0xdcb0,0xdcb0,0xecb0,0x1b7b0
.long 0xdcc0,0xdcc0,0xecc0,0x1b7c0,0xdcd0,0xdcd0,0xecd0,0x1b7d0,0xdce0,0xdce0,0xece0,0x1b7e0,0xdcf0,0xdcf0,0xecf0,0x1b7f0
.long 0xdd00,0xdd00,0xed00,0x1b800,0xdd10,0xdd10,0xed10,0x1b810,0xdd20,0xdd20,0xed20,0x1b820,0xdd30,0xdd30,0xed30,0x1b830
.long 0xdd40,0xdd40,0xed40,0x1b440,0xdd50,0xdd50,0xed50,0x1b450,0xdd60,0xdd60,0xed60,0x1b460,0xdd70,0xdd70,0xed70,0x1b470
.long 0xdd80,0xdd80,0xed80,0x1b480,0xdd90,0xdd90,0xed90,0x1b490,0xdda0,0xdda0,0xeda0,0x1b4a0,0xddb0,0xddb0,0xedb0,0x1b4b0
.long 0xddc0,0xddc0,0xedc0,0x1b4c0,0xddd0,0xddd0,0xedd0,0x1b4d0,0xdde0,0xdde0,0xede0,0x1b4e0,0xddf0,0xddf0,0xedf0,0x1b4f0
.long 0xde00,0xde00,0xee00,0x1b500,0xde10,0xde10,0xee10,0x1b510,0xde20,0xde20,0xee20,0x1b520,0xde30,0xde30,0xee30,0x1b530
.long 0xde40,0xde40,0xee40,0x1b840,0xde50,0xde50,0xee50,0x1b850,0xde60,0xde60,0xee60,0x1b860,0xde70,0xde70,0xee70,0x1b870
.long 0xde80,0xde80,0xee80,0x1b880,0xde90,0xde90,0xee90,0x1b890,0xdea0,0xdea0,0xeea0,0x1b8a0,0xdeb0,0xdeb0,0xeeb0,0x1b8b0
.long 0xdec0,0xdec0,0xeec0,0x1b8c0,0xded0,0xded0,0xeed0,0x1b8d0,0xdee0,0xdee0,0xeee0,0x1b8e0,0xdef0,0xdef0,0xeef0,0x1b8f0
.long 0xdf00,0xdf00,0xef00,0x1b900,0xdf10,0xdf10,0xef10,0x1b910,0xdf20,0xdf20,0xef20,0x1b920,0xdf30,0xdf30,0xef30,0x1b930
.long 0x1bb40,0x1bb40,0x1c340,0x1c740,0x1bb48,0x1bb48,0x1c340,0x1c742,0x1bb50,0x1bb50,0x1c340,0x1c744,0x1bb58,0x1bb58,0x1c340,0x1c746
.long 0x1bb60,0x1bb60,0x1c340,0x1c748,0x1bb68,0x1bb68,0x1c340,0x1c74a,0x1bb70,0x1bb70,0x1c340,0x1c74c,0x1bb78,0x1bb78,0x1c340,0x1c74e
.long 0x1bb80,0x1bb80,0x1c340,0x1c750,0x1bb88,0x1bb88,0x1c340,0x1c752,0x1bb90,0x1bb90,0x1c340,0x1c754,0x1bb98,0x1bb98,0x1c340,0x1c756
.long 0x1bba0,0x1bba0,0x1c340,0x1c758,0x1bba8,0x1bba8,0x1c340,0x1c75a,0x1bbb0,0x1bbb0,0x1c340,0x1c75c,0x1bbb8,0x1bbb8,0x1c340,0x1c75e
.long 0x1bbc0,0x1bb40,0x1c360,0x1c740,0x1bbc8,0x1bb48,0x1c360,0x1c742,0x1bbd0,0x1bb50,0x1c360,0x1c744,0x1bbd8,0x1bb58,0x1c360,0x1c746
.long 0x1bbe0,0x1bb60,0x1c360,0x1c748,0x1bbe8,0x1bb68,0x1c360,0x1c74a,0x1bbf0,0x1bb70,0x1c360,0x1c74c,0x1bbf8,0x1bb78,0x1c360,0x1c74e
.long 0x1bc00,0x1bb80,0x1c360,0x1c750,0x1bc08,0x1bb88,0x1c360,0x1c752,0x1bc10,0x1bb90,0x1c360,0x1c754,0x1bc18,0x1bb98,0x1c360,0x1c756
.long 0x1bc20,0x1bba0,0x1c360,0x1c758,0x1bc28,0x1bba8,0x1c360,0x1c75a,0x1bc30,0x1bbb0,0x1c360,0x1c75c,0x1bc38,0x1bbb8,0x1c360,0x1c75e
.long 0x1bc40,0x1bb40,0x1c380,0x1c740,0x1bc48,0x1bb48,0x1c380,0x1c742,0x1bc50,0x1bb50,0x1c380,0x1c744,0x1bc58,0x1bb58,0x1c380,0x1c746
.long 0x1bc60,0x1bb60,0x1c380,0x1c748,0x1bc68,0x1bb68,0x1c380,0x1c74a,0x1bc70,0x1bb70,0x1c380,0x1c74c,0x1bc78,0x1bb78,0x1c380,0x1c74e
.long 0x1bc80,0x1bb80,0x1c380,0x1c750,0x1bc88,0x1bb88,0x1c380,0x1c752,0x1bc90,0x1bb90,0x1c380,0x1c754,0x1bc98,0x1bb98,0x1c380,0x1c756
.long 0x1bca0,0x1bba0,0x1c380,0x1c758,0x1bca8,0x1bba8,0x1c380,0x1c75a,0x1bcb0,0x1bbb0,0x1c380,0x1c75c,0x1bcb8,0x1bbb8,0x1c380,0x1c75e
.long 0x1bcc0,0x1bb40,0x1c3a0,0x1c740,0x1bcc8,0x1bb48,0x1c3a0,0x1c742,0x1bcd0,0x1bb50,0x1c3a0,0x1c744,0x1bcd8,0x1bb58,0x1c3a0,0x1c746
.long 0x1bce0,0x1bb60,0x1c3a0,0x1c748,0x1bce8,0x1bb68,0x1c3a0,0x1c74a,0x1bcf0,0x1bb70,0x1c3a0,0x1c74c,0x1bcf8,0x1bb78,0x1c3a0,0x1c74e
.long 0x1bd00,0x1bb80,0x1c3a0,0x1c750,0x1bd08,0x1bb88,0x1c3a0,0x1c752,0x1bd10,0x1bb90,0x1c3a0,0x1c754,0x1bd18,0x1bb98,0x1c3a0,0x1c756
.long 0x1bd20,0x1bba0,0x1c3a0,0x1c758,0x1bd28,0x1bba8,0x1c3a0,0x1c75a,0x1bd30,0x1bbb0,0x1c3a0,0x1c75c,0x1bd38,0x1bbb8,0x1c3a0,0x1c75e
.long 0x9100,0x0,0x0,0x0,0x9110,0x0,0x0,0x0,0x9120,0x0,0x0,0x0,0x9130,0x0,0x0,0x0
.long 0x9140,0x0,0x0,0x0,0x9150,0x0,0x0,0x0,0x9160,0x0,0x0,0x0,0x9170,0x0,0x0,0x0
.long 0x9300,0x0,0x0,0x0,0x9300,0x0,0x0,0x0,0x9300,0x0,0x0,0x0,0x9300,0x0,0x0,0x0
.long 0x9300,0x0,0x0,0x0,0x9300,0x0,0x0,0x0,0x9300,0x0,0x0,0x0,0x9300,0x0,0x0,0x0
.long 0x9200,0x0,0x0,0x0,0x9210,0x0,0x0,0x0,0x9220,0x0,0x0,0x0,0x9230,0x0,0x0,0x0
.long 0x9240,0x0,0x0,0x0,0x9250,0x0,0x0,0x0,0x9260,0x0,0x0,0x0,0x9270,0x0,0x0,0x0
.long 0x9300,0x0,0x0,0x0,0x9300,0x0,0x0,0x0,0x9300,0x0,0x0,0x0,0x9300,0x0,0x0,0x0
.long 0x9300,0x0,0x0,0x0,0x9300,0x0,0x0,0x0,0x9300,0x0,0x0,0x0,0x9300,0x0,0x0,0x0
.long 0x9300,0x0,0x0,0x0,0x9300,0x0,0x0,0x0,0x9300,0x0,0x0,0x0,0x9300,0x0,0x0,0x0
.long 0x9300,0x0,0x0,0x0,0x9300,0x0,0x0,0x0,0x9300,0x0,0x0,0x0,0x9300,0x0,0x0,0x0
.long 0x9180,0x0,0x0,0x0,0x9190,0x0,0x0,0x0,0x91a0,0x0,0x0,0x0,0x91b0,0x0,0x0,0x0
.long 0x91c0,0x0,0x0,0x0,0x91d0,0x0,0x0,0x0,0x91e0,0x0,0x0,0x0,0x91f0,0x0,0x0,0x0
.long 0x9300,0x0,0x0,0x0,0x9300,0x0,0x0,0x0,0x9300,0x0,0x0,0x0,0x9300,0x0,0x0,0x0
.long 0x9300,0x0,0x0,0x0,0x9300,0x0,0x0,0x0,0x9300,0x0,0x0,0x0,0x9300,0x0,0x0,0x0
.long 0x9280,0x0,0x0,0x0,0x9290,0x0,0x0,0x0,0x92a0,0x0,0x0,0x0,0x92b0,0x0,0x0,0x0
.long 0x92c0,0x0,0x0,0x0,0x92d0,0x0,0x0,0x0,0x92e0,0x0,0x0,0x0,0x92f0,0x0,0x0,0x0
.long 0x0,0x2d40,0x5ea0,0x0,0x10,0x2d50,0x5eb0,0x8,0x20,0x3180,0x5ec0,0x10,0x30,0x3190,0x5ed0,0x18
.long 0x40,0x31a0,0x6300,0x60,0x50,0x31b0,0x6310,0x68,0x480,0x31c0,0x6320,0x70,0x490,0x31d0,0x6330,0x78
.long 0x4a0,0x3600,0x6340,0xc0,0x4b0,0x3610,0x6350,0xc8,0x4c0,0x3620,0x6780,0xd0,0x4d0,0x3630,0x6790,0xd8
.long 0x900,0x3640,0x67a0,0x120,0x910,0x3650,0x67b0,0x128,0x920,0x3a80,0x67c0,0x130,0x930,0x3a90,0x67d0,0x138
.long 0x940,0x3aa0,0x6c00,0x180,0x950,0x3ab0,0x6c10,0x188,0xd80,0x3ac0,0x6c20,0x190,0xd90,0x3ad0,0x6c30,0x198
.long 0xda0,0x3f00,0x6c40,0x1e0,0xdb0,0x3f10,0x6c50,0x1e8,0xdc0,0x3f20,0x7080,0x1f0,0xdd0,0x3f30,0x7090,0x1f8
.long 0x1200,0x3f40,0x70a0,0x240,0x1210,0x3f50,0x70b0,0x248,0x1220,0x4380,0x70c0,0x250,0x1230,0x4390,0x70d0,0x258
.long 0x1240,0x43a0,0x7500,0x2a0,0x1250,0x43b0,0x7510,0x2a8,0x1680,0x43c0,0x7520,0x2b0,0x1690,0x43d0,0x7530,0x2b8
.long 0x16a0,0x4800,0x7540,0x300,0x16b0,0x4810,0x7550,0x308,0x16c0,0x4820,0x7980,0x310,0x16d0,0x4830,0x7990,0x318
.long 0x1b00,0x4840,0x79a0,0x360,0x1b10,0x4850,0x79b0,0x368,0x1b20,0x4c80,0x79c0,0x370,0x1b30,0x4c90,0x79d0,0x378
.long 0x1b40,0x4ca0,0x7e00,0x3c0,0x1b50,0x4cb0,0x7e10,0x3c8,0x1f80,0x4cc0,0x7e20,0x3d0,0x1f90,0x4cd0,0x7e30,0x3d8
.long 0x1fa0,0x5100,0x7e40,0x420,0x1fb0,0x5110,0x7e50,0x428,0x1fc0,0x5120,0x8280,0x430,0x1fd0,0x5130,0x8290,0x438
.long 0x2400,0x5140,0x82a0,0x480,0x2410,0x5150,0x82b0,0x488,0x2420,0x5580,0x82c0,0x490,0x2430,0x5590,0x82d0,0x498
.long 0x2440,0x55a0,0x8700,0x4e0,0x2450,0x55b0,0x8710,0x4e8,0x2880,0x55c0,0x8720,0x4f0,0x2890,0x55d0,0x8730,0x4f8
.long 0x28a0,0x5a00,0x8740,0x540,0x28b0,0x5a10,0x8750,0x548,0x28c0,0x5a20,0x8b80,0x550,0x28d0,0x5a30,0x8b90,0x558
.long 0x2d00,0x5a40,0x8ba0,0x5a0,0x2d10,0x5a50,0x8bb0,0x5a8,0x2d20,0x5e80,0x8bc0,0x5b0,0x2d30,0x5e90,0x8bd0,0x5b8
.long 0x0,0xf40,0x1fa0,0x0,0x10,0xf50,0x1fb0,0x1,0x20,0x1080,0x1fc0,0x2,0x30,0x1090,0x1fd0,0x3
.long 0x40,0x10a0,0x2100,0x4,0x50,0x10b0,0x2110,0x5,0x180,0x10c0,0x2120,0x6,0x190,0x10d0,0x2130,0x7
.long 0x1a0,0x1200,0x2140,0x8,0x1b0,0x1210,0x2150,0x9,0x1c0,0x1220,0x2280,0xa,0x1d0,0x1230,0x2290,0xb
.long 0x300,0x1240,0x22a0,0xc,0x310,0x1250,0x22b0,0xd,0x320,0x1380,0x22c0,0xe,0x330,0x1390,0x22d0,0xf
.long 0x340,0x13a0,0x2400,0x0,0x350,0x13b0,0x2410,0x1,0x480,0x13c0,0x2420,0x2,0x490,0x13d0,0x2430,0x3
.long 0x4a0,0x1500,0x2440,0x4,0x4b0,0x1510,0x2450,0x5,0x4c0,0x1520,0x2580,0x6,0x4d0,0x1530,0x2590,0x7
.long 0x600,0x1540,0x25a0,0x8,0x610,0x1550,0x25b0,0x9,0x620,0x1680,0x25c0,0xa,0x630,0x1690,0x25d0,0xb
.long 0x640,0x16a0,0x2700,0xc,0x650,0x16b0,0x2710,0xd,0x780,0x16c0,0x2720,0xe,0x790,0x16d0,0x2730,0xf
.long 0x7a0,0x1800,0x2740,0x0,0x7b0,0x1810,0x2750,0x1,0x7c0,0x1820,0x2880,0x2,0x7d0,0x1830,0x2890,0x3
.long 0x900,0x1840,0x28a0,0x4,0x910,0x1850,0x28b0,0x5,0x920,0x1980,0x28c0,0x6,0x930,0x1990,0x28d0,0x7
.long 0x940,0x19a0,0x2a00,0x8,0x950,0x19b0,0x2a10,0x9,0xa80,0x19c0,0x2a20,0xa,0xa90,0x19d0,0x2a30,0xb
.long 0xaa0,0x1b00,0x2a40,0xc,0xab0,0x1b10,0x2a50,0xd,0xac0,0x1b20,0x2b80,0xe,0xad0,0x1b30,0x2b90,0xf
.long 0xc00,0x1b40,0x2ba0,0x0,0xc10,0x1b50,0x2bb0,0x1,0xc20,0x1c80,0x2bc0,0x2,0xc30,0x1c90,0x2bd0,0x3
.long 0xc40,0x1ca0,0x2d00,0x4,0xc50,0x1cb0,0x2d10,0x5,0xd80,0x1cc0,0x2d20,0x6,0xd90,0x1cd0,0x2d30,0x7
.long 0xda0,0x1e00,0x2d40,0x8,0xdb0,0x1e10,0x2d50,0x9,0xdc0,0x1e20,0x2e80,0xa,0xdd0,0x1e30,0x2e90,0xb
.long 0xf00,0x1e40,0x2ea0,0xc,0xf10,0x1e50,0x2eb0,0xd,0xf20,0x1f80,0x2ec0,0xe,0xf30,0x1f90,0x2ed0,0xf
.long 0x0,0x300,0x180,0x480,0x2,0x302,0x182,0x482,0x4,0x304,0x184,0x484,0x6,0x306,0x186,0x486
.long 0x8,0x308,0x188,0x488,0xa,0x30a,0x18a,0x48a,0xc,0x30c,0x18c,0x48c,0xe,0x30e,0x18e,0x48e
.long 0x10,0x310,0x190,0x490,0x12,0x312,0x192,0x492,0x14,0x314,0x194,0x494,0x16,0x316,0x196,0x496
.long 0x18,0x318,0x198,0x498,0x1a,0x31a,0x19a,0x49a,0x1c,0x31c,0x19c,0x49c,0x1e,0x31e,0x19e,0x49e
.long 0x900,0xc00,0x780,0xa80,0x902,0xc02,0x782,0xa82,0x904,0xc04,0x784,0xa84,0x906,0xc06,0x786,0xa86
.long 0x908,0xc08,0x788,0xa88,0x90a,0xc0a,0x78a,0xa8a,0x90c,0xc0c,0x78c,0xa8c,0x90e,0xc0e,0x78e,0xa8e
.long 0x910,0xc10,0x790,0xa90,0x912,0xc12,0x792,0xa92,0x914,0xc14,0x794,0xa94,0x916,0xc16,0x796,0xa96
.long 0x918,0xc18,0x798,0xa98,0x91a,0xc1a,0x79a,0xa9a,0x91c,0xc1c,0x79c,0xa9c,0x91e,0xc1e,0x79e,0xa9e
.long 0x0,0x300,0x180,0x480,0x2,0x302,0x182,0x482,0x4,0x304,0x184,0x484,0x6,0x306,0x186,0x486
.long 0x8,0x308,0x188,0x488,0xa,0x30a,0x18a,0x48a,0xc,0x30c,0x18c,0x48c,0xe,0x30e,0x18e,0x48e
.long 0x10,0x310,0x190,0x490,0x12,0x312,0x192,0x492,0x14,0x314,0x194,0x494,0x16,0x316,0x196,0x496
.long 0x18,0x318,0x198,0x498,0x1a,0x31a,0x19a,0x49a,0x1c,0x31c,0x19c,0x49c,0x1e,0x31e,0x19e,0x49e
.long 0x900,0xc00,0x780,0xa80,0x902,0xc02,0x782,0xa82,0x904,0xc04,0x784,0xa84,0x906,0xc06,0x786,0xa86
.long 0x908,0xc08,0x788,0xa88,0x90a,0xc0a,0x78a,0xa8a,0x90c,0xc0c,0x78c,0xa8c,0x90e,0xc0e,0x78e,0xa8e
.long 0x910,0xc10,0x790,0xa90,0x912,0xc12,0x792,0xa92,0x914,0xc14,0x794,0xa94,0x916,0xc16,0x796,0xa96
.long 0x918,0xc18,0x798,0xa98,0x91a,0xc1a,0x79a,0xa9a,0x91c,0xc1c,0x79c,0xa9c,0x91e,0xc1e,0x79e,0xa9e
.long 0x600,0xffffffff,0x0,0xffff,0x602,0xffffffff,0x0,0xffff,0x604,0xffffffff,0x0,0xffff,0x606,0xffffffff,0x0,0xffff
.long 0x608,0x0,0xffffffff,0xffff,0x60a,0x0,0xffffffff,0xffff,0x60c,0x0,0xffffffff,0xffff,0x60e,0x0,0xffffffff,0xffff
.long 0x610,0x0,0x0,0xffff,0x612,0x0,0x0,0xffff,0x614,0x0,0x0,0xffff,0x616,0x0,0x0,0xffff
.long 0x618,0x0,0x0,0xffff,0x61a,0x0,0x0,0xffff,0x61c,0x0,0x0,0xffff,0x61e,0x0,0x0,0xffff
.long 0x600,0xffffffff,0x0,0x0,0x602,0xffffffff,0x0,0x0,0x604,0xffffffff,0x0,0x0,0x606,0xffffffff,0x0,0x0
.long 0x608,0x0,0xffffffff,0x0,0x60a,0x0,0xffffffff,0x0,0x60c,0x0,0xffffffff,0x0,0x60e,0x0,0xffffffff,0x0
.long 0x610,0x0,0x0,0x0,0x612,0x0,0x0,0x0,0x614,0x0,0x0,0x0,0x616,0x0,0x0,0x0
.long 0x618,0x0,0x0,0x0,0x61a,0x0,0x0,0x0,0x61c,0x0,0x0,0x0,0x61e,0x0,0x0,0x0
.long 0x600,0x0,0x0,0xffff,0x602,0x0,0x0,0xffff,0x604,0x0,0x0,0xffff,0x606,0x0,0x0,0xffff
.long 0x608,0x0,0x0,0xffff,0x60a,0x0,0x0,0xffff,0x60c,0x0,0x0,0xffff,0x60e,0x0,0x0,0xffff
.long 0x610,0xffffffff,0x0,0xffff,0x612,0xffffffff,0x0,0xffff,0x614,0xffffffff,0x0,0xffff,0x616,0xffffffff,0x0,0xffff
.long 0x618,0x0,0xffffffff,0xffff,0x61a,0x0,0xffffffff,0xffff,0x61c,0x0,0xffffffff,0xffff,0x61e,0x0,0xffffffff,0xffff
.long 0x600,0x0,0x0,0x0,0x602,0x0,0x0,0x0,0x604,0x0,0x0,0x0,0x606,0x0,0x0,0x0
.long 0x608,0x0,0x0,0x0,0x60a,0x0,0x0,0x0,0x60c,0x0,0x0,0x0,0x60e,0x0,0x0,0x0
.long 0x610,0xffffffff,0x0,0x0,0x612,0xffffffff,0x0,0x0,0x614,0xffffffff,0x0,0x0,0x616,0xffffffff,0x0,0x0
.long 0x618,0x0,0xffffffff,0x0,0x61a,0x0,0xffffffff,0x0,0x61c,0x0,0xffffffff,0x0,0x61e,0x0,0xffffffff,0x0
.long 0x0,0xbfd00,0xbfe80,0xefd00,0x0,0xbfd00,0xbfe80,0xefd00,0x0,0xbfd00,0xbfe80,0xefd00,0x0,0xbfd00,0xbfe80,0xefd00
.long 0x0,0xbfd00,0xbfe80,0xefd00,0x0,0xbfd00,0xbfe80,0xefd00,0x0,0xbfd00,0xbfe80,0xefd00,0x0,0xbfd00,0xbfe80,0xefd00
.long 0x0,0xbfd00,0xbfe80,0xefd00,0x0,0xbfd00,0xbfe80,0xefd00,0x0,0xbfd00,0xbfe80,0xefd00,0x0,0xbfd00,0xbfe80,0xefd00
.long 0x0,0xbfd00,0xbfe80,0xefd00,0x0,0xbfd00,0xbfe80,0xefd00,0x0,0xbfd00,0xbfe80,0xefd00,0x0,0xbfd00,0xbfe80,0xefd00
.long 0x3f80,0xc0000,0xefb80,0xefd00,0x3f80,0xc0000,0xefb80,0xefd00,0x3f80,0xc0000,0xefb80,0xefd00,0x3f80,0xc0000,0xefb80,0xefd00
.long 0x3f80,0xc0000,0xefb80,0xefd00,0x3f80,0xc0000,0xefb80,0xefd00,0x3f80,0xc0000,0xefb80,0xefd00,0x3f80,0xc0000,0xefb80,0xefd00
.long 0x3f80,0xc0000,0xefb80,0xefd00,0x3f80,0xc0000,0xefb80,0xefd00,0x3f80,0xc0000,0xefb80,0xefd00,0x3f80,0xc0000,0xefb80,0xefd00
.long 0x3f80,0xc0000,0xefb80,0xefd00,0x3f80,0xc0000,0xefb80,0xefd00,0x3f80,0xc0000,0xefb80,0xefd00,0x3f80,0xc0000,0xefb80,0xefd00
.long 0x0,0x11fa00,0xefe80,0xefd10,0x0,0x11fa00,0xefe80,0xefd10,0x0,0x11fa00,0xefe80,0xefd10,0x0,0x11fa00,0xefe80,0xefd10
.long 0x0,0x11fa00,0xefe80,0xefd10,0x0,0x11fa00,0xefe80,0xefd10,0x0,0x11fa00,0xefe80,0xefd10,0x0,0x11fa00,0xefe80,0xefd10
.long 0x0,0x11fa00,0xefe80,0xefd10,0x0,0x11fa00,0xefe80,0xefd10,0x0,0x11fa00,0xefe80,0xefd10,0x0,0x11fa00,0xefe80,0xefd10
.long 0x0,0x11fa00,0xefe80,0xefd10,0x0,0x11fa00,0xefe80,0xefd10,0x0,0x11fa00,0xefe80,0xefd10,0x0,0x11fa00,0xefe80,0xefd10
.long 0x3f80,0x11fd00,0x11fb80,0xefd10,0x3f80,0x11fd00,0x11fb80,0xefd10,0x3f80,0x11fd00,0x11fb80,0xefd10,0x3f80,0x11fd00,0x11fb80,0xefd10
.long 0x3f80,0x11fd00,0x11fb80,0xefd10,0x3f80,0x11fd00,0x11fb80,0xefd10,0x3f80,0x11fd00,0x11fb80,0xefd10,0x3f80,0x11fd00,0x11fb80,0xefd10
.long 0x3f80,0x11fd00,0x11fb80,0xefd10,0x3f80,0x11fd00,0x11fb80,0xefd10,0x3f80,0x11fd00,0x11fb80,0xefd10,0x3f80,0x11fd00,0x11fb80,0xefd10
.long 0x3f80,0x11fd00,0x11fb80,0xefd10,0x3f80,0x11fd00,0x11fb80,0xefd10,0x3f80,0x11fd00,0x11fb80,0xefd10,0x3f80,0x11fd00,0x11fb80,0xefd10
.long 0xffff,0x0,0x0,0x0,0xffff0000,0x0,0x0,0x0,0x0,0xffff,0x0,0x0,0x0,0xffff0000,0x0,0x0
.long 0x0,0x0,0xffff,0x0,0x0,0x0,0xffff0000,0x0,0x0,0x0,0x0,0xffff,0x0,0x0,0x0,0xffff0000
.long 0x0,0x0,0x0,0x0,0x0,0x0,0x0,0x0,0x0,0x0,0x0,0x0,0x0,0x0,0x0,0x0
.long 0x0,0x0,0x0,0x0,0x0,0x0,0x0,0x0,0x0,0x0,0x0,0x0,0x0,0x0,0x0,0x0
.long 0xffff,0x0,0x0,0x0,0xffff0000,0x0,0x0,0x0,0x0,0xffff,0x0,0x0,0x0,0xffff0000,0x0,0x0
.long 0x0,0x0,0xffff,0x0,0x0,0x0,0xffff0000,0x0,0x0,0x0,0x0,0xffff,0x0,0x0,0x0,0xffff0000
.long 0x0,0x0,0x0,0x0,0x0,0x0,0x0,0x0,0x0,0x0,0x0,0x0,0x0,0x0,0x0,0x0
.long 0x0,0x0,0x0,0x0,0x0,0x0,0x0,0x0,0x0,0x0,0x0,0x0,0x0,0x0,0x0,0x0
.long 0x0,0x0,0x0,0x0,0x0,0x0,0x0,0x0,0x0,0x0,0x0,0x0,0x0,0x0,0x0,0x0
.long 0x0,0x0,0x0,0x0,0x0,0x0,0x0,0x0,0x0,0x0,0x0,0x0,0x0,0x0,0x0,0x0
.long 0xffff,0x0,0x0,0x0,0xffff0000,0x0,0x0,0x0,0x0,0xffff,0x0,0x0,0x0,0xffff0000,0x0,0x0
.long 0x0,0x0,0xffff,0x0,0x0,0x0,0xffff0000,0x0,0x0,0x0,0x0,0xffff,0x0,0x0,0x0,0xffff0000
.long 0x0,0x0,0x0,0x0,0x0,0x0,0x0,0x0,0x0,0x0,0x0,0x0,0x0,0x0,0x0,0x0
.long 0x0,0x0,0x0,0x0,0x0,0x0,0x0,0x0,0x0,0x0,0x0,0x0,0x0,0x0,0x0,0x0
.long 0xffff,0x0,0x0,0x0,0xffff0000,0x0,0x0,0x0,0x0,0xffff,0x0,0x0,0x0,0xffff0000,0x0,0x0
.long 0x0,0x0,0xffff,0x0,0x0,0x0,0xffff0000,0x0,0x0,0x0,0x0,0xffff,0x0,0x0,0x0,0xffff0000
.long 0x0,0x0,0x8000000,0x0,0x0,0x55555555,0x8000010,0x80,0x0,0xaaaaaaaa,0x8000020,0x100,0x0,0xffffffff,0x8000030,0x180
.long 0x0,0x0,0x8000040,0x200,0x0,0x55555555,0x8000050,0x280,0x0,0xaaaaaaaa,0x8000060,0x300,0x0,0xffffffff,0x8000070,0x380
.long 0x0,0x0,0x8000080,0x400,0x0,0x55555555,0x8000090,0x480,0x0,0xaaaaaaaa,0x80000a0,0x500,0x0,0xffffffff,0x80000b0,0x580
.long 0x0,0x0,0x80000c0,0x600,0x0,0x55555555,0x80000d0,0x680,0x0,0xaaaaaaaa,0x80000e0,0x700,0x0,0xffffffff,0x80000f0,0x780
.long 0xff800000,0x0,0x8000100,0x800,0xff800000,0x55555555,0x8000110,0x880,0xff800000,0xaaaaaaaa,0x8000120,0x900,0xff800000,0xffffffff,0x8000130,0x980
.long 0xff800000,0x0,0x8000140,0xa00,0xff800000,0x55555555,0x8000150,0xa80,0xff800000,0xaaaaaaaa,0x8000160,0xb00,0xff800000,0xffffffff,0x8000170,0xb80
.long 0xff800000,0x0,0x10000000,0xc00,0xff800000,0x55555555,0x180,0xc80,0xff800000,0xaaaaaaaa,0x190,0xd00,0xff800000,0xffffffff,0x1a0,0x2fe80
.long 0xff800000,0x0,0x1b0,0x2ff00,0xff800000,0x55555555,0x1c0,0x2ff80,0xff800000,0xaaaaaaaa,0x1d0,0x30000,0xff800000,0xffffffff,0x1e0,0x30080
.long 0xff800000,0x0,0x1f0,0x30100,0xff800000,0x55555555,0x200,0x30180,0xff800000,0xaaaaaaaa,0x210,0x30200,0xff800000,0xffffffff,0x220,0x30280
.long 0xff800000,0x0,0x230,0x30300,0xff800000,0x55555555,0x240,0x30380,0xff800000,0xaaaaaaaa,0x250,0x30400,0xff800000,0xffffffff,0x260,0x30480
.long 0xff800000,0x0,0x270,0x30500,0xff800000,0x55555555,0x280,0x30580,0xff800000,0xaaaaaaaa,0x290,0x30600,0xff800000,0xffffffff,0x2a0,0x30680
.long 0xff800000,0x0,0x2b0,0x30700,0xff800000,0x55555555,0x2c0,0x30780,0xff800000,0xaaaaaaaa,0x2d0,0x30800,0xff800000,0xffffffff,0x2e0,0x30880
.long 0xff800000,0x0,0x2f0,0x30900,0xff800000,0x55555555,0x10000000,0x30980,0xff800000,0xaaaaaaaa,0x300,0x30a00,0xff800000,0xffffffff,0x310,0x30a80
.long 0xff800000,0x0,0x320,0x30b00,0xff800000,0x55555555,0x330,0x30b80,0xff800000,0xaaaaaaaa,0x340,0x5fd00,0xff800000,0xffffffff,0x350,0x5fd80
.long 0xff800000,0x0,0x360,0x5fe00,0xff800000,0x55555555,0x370,0x5fe80,0xff800000,0xaaaaaaaa,0x380,0x5ff00,0xff800000,0xffffffff,0x390,0x5ff80
.long 0xff800000,0x0,0x3a0,0x60000,0xff800000,0x55555555,0x3b0,0x60080,0xff800000,0xaaaaaaaa,0x3c0,0x60100,0xff800000,0xffffffff,0x3d0,0x60180
.long 0x0,0x0,0x3e0,0x60200,0x0,0x55555555,0x3f0,0x60280,0x0,0xaaaaaaaa,0x400,0x60300,0x0,0xffffffff,0x410,0x60380
.long 0x0,0x0,0x420,0x60400,0x0,0x55555555,0x430,0x60480,0x0,0xaaaaaaaa,0x440,0x60500,0x0,0xffffffff,0x450,0x60580
.long 0x0,0x0,0x460,0x60600,0x0,0x55555555,0x470,0x60680,0x0,0xaaaaaaaa,0x10000000,0x60700,0x0,0xffffffff,0x480,0x60780
.long 0x0,0x0,0x490,0x60800,0x0,0x55555555,0x4a0,0x60880,0x0,0xaaaaaaaa,0x4b0,0x60900,0x0,0xffffffff,0x4c0,0x60980
.long 0xff800000,0x0,0x4d0,0x60a00,0xff800000,0x55555555,0x4e0,0x8fb80,0xff800000,0xaaaaaaaa,0x4f0,0x8fc00,0xff800000,0xffffffff,0x500,0x8fc80
.long 0xff800000,0x0,0x510,0x8fd00,0xff800000,0x55555555,0x520,0x8fd80,0xff800000,0xaaaaaaaa,0x530,0x8fe00,0xff800000,0xffffffff,0x540,0x8fe80
.long 0xff800000,0x0,0x550,0x8ff00,0xff800000,0x55555555,0x560,0x8ff80,0xff800000,0xaaaaaaaa,0x570,0x90000,0xff800000,0xffffffff,0x580,0x90080
.long 0xff800000,0x0,0x590,0x90100,0xff800000,0x55555555,0x5a0,0x90180,0xff800000,0xaaaaaaaa,0x5b0,0x90200,0xff800000,0xffffffff,0x5c0,0x90280
.long 0xff800000,0x0,0x5d0,0x90300,0xff800000,0x55555555,0x5e0,0x90380,0xff800000,0xaaaaaaaa,0x5f0,0x90400,0xff800000,0xffffffff,0x10000000,0x90480
.long 0xff800000,0x0,0x600,0x90500,0xff800000,0x55555555,0x610,0x90580,0xff800000,0xaaaaaaaa,0x620,0x90600,0xff800000,0xffffffff,0x630,0x90680
.long 0xff800000,0x0,0x640,0x90700,0xff800000,0x55555555,0x650,0x90780,0xff800000,0xaaaaaaaa,0x660,0x90800,0xff800000,0xffffffff,0x670,0x90880
.long 0xff800000,0x0,0x680,0xbfa00,0xff800000,0x55555555,0x690,0xbfa80,0xff800000,0xaaaaaaaa,0x6a0,0xbfb00,0xff800000,0xffffffff,0x6b0,0xbfb80
.long 0xff800000,0x0,0x6c0,0xbfc00,0xff800000,0x55555555,0x6d0,0xbfc80,0xff800000,0xaaaaaaaa,0x6e0,0xbfd00,0xff800000,0xffffffff,0x6f0,0xbfd80
.long 0xff800000,0x0,0x700,0xbfe00,0xff800000,0x55555555,0x710,0xbfe80,0xff800000,0xaaaaaaaa,0x720,0xbff00,0xff800000,0xffffffff,0x730,0xbff80
.long 0xff800000,0x0,0x740,0xc0000,0xff800000,0x55555555,0x750,0xc0080,0xff800000,0xaaaaaaaa,0x760,0xc0100,0xff800000,0xffffffff,0x770,0xc0180
.long 0xff800000,0x0,0x10000000,0xc0200,0xff800000,0x55555555,0x780,0xc0280,0xff800000,0xaaaaaaaa,0x790,0xc0300,0xff800000,0xffffffff,0x7a0,0xc0380
.long 0x0,0x0,0x7b0,0xc0400,0x0,0x55555555,0x7c0,0xc0480,0x0,0xaaaaaaaa,0x7d0,0xc0500,0x0,0xffffffff,0x7e0,0xc0580
.long 0x0,0x0,0x7f0,0xc0600,0x0,0x55555555,0x800,0xc0680,0x0,0xaaaaaaaa,0x810,0xc0700,0x0,0xffffffff,0x820,0xef880
.long 0x0,0x0,0x830,0xef900,0x0,0x55555555,0x840,0xef980,0x0,0xaaaaaaaa,0x850,0xefa00,0x0,0xffffffff,0x860,0xefa80
.long 0x0,0x0,0x870,0xefb00,0x0,0x55555555,0x880,0xefb80,0x0,0xaaaaaaaa,0x890,0xefc00,0x0,0xffffffff,0x8a0,0xefc80
.long 0xff800000,0x0,0x8b0,0xefd00,0xff800000,0x55555555,0x8c0,0xefd80,0xff800000,0xaaaaaaaa,0x8d0,0xefe00,0xff800000,0xffffffff,0x8e0,0xefe80
.long 0xff800000,0x0,0x8f0,0xeff00,0xff800000,0x55555555,0x10000000,0xeff80,0xff800000,0xaaaaaaaa,0x900,0xf0000,0xff800000,0xffffffff,0x910,0xf0080
.long 0xff800000,0x0,0x920,0xf0100,0xff800000,0x55555555,0x930,0xf0180,0xff800000,0xaaaaaaaa,0x940,0xf0200,0xff800000,0xffffffff,0x950,0xf0280
.long 0xff800000,0x0,0x960,0xf0300,0xff800000,0x55555555,0x970,0xf0380,0xff800000,0xaaaaaaaa,0x980,0xf0400,0xff800000,0xffffffff,0x990,0xf0480
.long 0xff800000,0x0,0x9a0,0xf0500,0xff800000,0x55555555,0x9b0,0xf0580,0xff800000,0xaaaaaaaa,0x9c0,0x11f700,0xff800000,0xffffffff,0x9d0,0x11f780
.long 0xff800000,0x0,0x9e0,0x11f800,0xff800000,0x55555555,0x9f0,0x11f880,0xff800000,0xaaaaaaaa,0xa00,0x11f900,0xff800000,0xffffffff,0xa10,0x11f980
.long 0xff800000,0x0,0xa20,0x11fa00,0xff800000,0x55555555,0xa30,0x11fa80,0xff800000,0xaaaaaaaa,0xa40,0x11fb00,0xff800000,0xffffffff,0xa50,0x11fb80
.long 0xff800000,0x0,0xa60,0x11fc00,0xff800000,0x55555555,0xa70,0x11fc80,0xff800000,0xaaaaaaaa,0x10000000,0x11fd00,0xff800000,0xffffffff,0xa80,0x11fd80
.long 0xff800000,0x0,0xa90,0x11fe00,0xff800000,0x55555555,0xaa0,0x11fe80,0xff800000,0xaaaaaaaa,0xab0,0x11ff00,0xff800000,0xffffffff,0xac0,0x11ff80
.long 0xff800000,0x0,0xad0,0x120000,0xff800000,0x55555555,0xae0,0x120080,0xff800000,0xaaaaaaaa,0xaf0,0x120100,0xff800000,0xffffffff,0xb00,0x120180
.long 0xff800000,0x0,0xb10,0x120200,0xff800000,0x55555555,0xb20,0x120280,0xff800000,0xaaaaaaaa,0xb30,0x120300,0xff800000,0xffffffff,0xb40,0x120380
.long 0xff800000,0x0,0xb50,0x120400,0xff800000,0x55555555,0xb60,0x14f580,0xff800000,0xaaaaaaaa,0xb70,0x14f600,0xff800000,0xffffffff,0xb80,0x14f680
.long 0x0,0x0,0xb90,0x14f700,0x0,0x55555555,0xba0,0x14f780,0x0,0xaaaaaaaa,0xbb0,0x14f800,0x0,0xffffffff,0xbc0,0x14f880
.long 0x0,0x0,0xbd0,0x14f900,0x0,0x55555555,0xbe0,0x14f980,0x0,0xaaaaaaaa,0xbf0,0x14fa00,0x0,0xffffffff,0x10000000,0x14fa80
.long 0x0,0x0,0x20000c00,0x14fb00,0x0,0x55555555,0x20000c10,0x14fb80,0x0,0xaaaaaaaa,0x20000c20,0x14fc00,0x0,0xffffffff,0x20000c30,0x14fc80
.long 0x0,0x0,0x20000c40,0x14fd00,0x0,0x55555555,0x20000c50,0x14fd80,0x0,0xaaaaaaaa,0x20000c60,0x14fe00,0x0,0xffffffff,0x20000c70,0x14fe80
.long 0xff800000,0x0,0x20000c80,0x14ff00,0xff800000,0x55555555,0x20000c90,0x14ff80,0xff800000,0xaaaaaaaa,0x20000ca0,0x150000,0xff800000,0xffffffff,0x20000cb0,0x150080
.long 0xff800000,0x0,0x20000cc0,0x150100,0xff800000,0x55555555,0x20000cd0,0x150180,0xff800000,0xaaaaaaaa,0x20000ce0,0x150200,0xff800000,0xffffffff,0x20000cf0,0x150280
.long 0xff800000,0x0,0x20000d00,0x17f400,0xff800000,0x55555555,0x20000d10,0x17f480,0xff800000,0xaaaaaaaa,0x20000d20,0x17f500,0xff800000,0xffffffff,0x20000d30,0x17f580
.long 0xff800000,0x0,0x20000d40,0x17f600,0xff800000,0x55555555,0x20000d50,0x17f680,0xff800000,0xaaaaaaaa,0x20000d60,0x17f700,0xff800000,0xffffffff,0x20000d70,0x17f780
.long 0xff800000,0x0,0x10000000,0x17f800,0xff800000,0x55555555,0x10000000,0x17f880,0xff800000,0xaaaaaaaa,0x10000000,0x17f900,0xff800000,0xffffffff,0x10000000,0x17f980
.long 0xff800000,0x0,0x10000000,0x17fa00,0xff800000,0x55555555,0x10000000,0x17fa80,0xff800000,0xaaaaaaaa,0x10000000,0x17fb00,0xff800000,0xffffffff,0x10000000,0x17fb80
.long 0xff800000,0x0,0x10000000,0x17fc00,0xff800000,0x55555555,0x10000000,0x17fc80,0xff800000,0xaaaaaaaa,0x10000000,0x17fd00,0xff800000,0xffffffff,0x10000000,0x17fd80
.long 0xff800000,0x0,0x10000000,0x17fe00,0xff800000,0x55555555,0x10000000,0x17fe80,0xff800000,0xaaaaaaaa,0x10000000,0x17ff00,0xff800000,0xffffffff,0x10000000,0x17ff80
.long 0xff800000,0x0,0x10000000,0x180000,0xff800000,0x55555555,0x10000000,0x180080,0xff800000,0xaaaaaaaa,0x10000000,0x180100,0xff800000,0xffffffff,0x10000000,0x10000000
.long 0xff800000,0x0,0x10000000,0x10000000,0xff800000,0x55555555,0x10000000,0x10000000,0xff800000,0xaaaaaaaa,0x10000000,0x10000000,0xff800000,0xffffffff,0x10000000,0x10000000
.long 0xff800000,0x0,0x10000000,0x10000000,0xff800000,0x55555555,0x10000000,0x10000000,0xff800000,0xaaaaaaaa,0x10000000,0x10000000,0xff800000,0xffffffff,0x10000000,0x10000000
.long 0xff800000,0x0,0x10000000,0x10000000,0xff800000,0x55555555,0x10000000,0x10000000,0xff800000,0xaaaaaaaa,0x10000000,0x10000000,0xff800000,0xffffffff,0x10000000,0x10000000
.size L_tab, 16384
.section .rodata,"a"
.p2align 6
.amdhsa_kernel standalone__window_attn_davit__vision_kernel
  .amdhsa_next_free_vgpr 512
  .amdhsa_next_free_sgpr 96
  .amdhsa_accum_offset 256
  .amdhsa_group_segment_fixed_size 0
  .amdhsa_kernarg_size 56
  .amdhsa_user_sgpr_count 2
  .amdhsa_user_sgpr_kernarg_segment_ptr 1
  .amdhsa_system_sgpr_workgroup_id_x 1
.end_amdhsa_kernel
```

```asm
; @launch grid=(256,1,1) block=(256,1,1) lds=163840
.amdgcn_target "amdgcn-amd-amdhsa--gfx950"
.text
.globl standalone__window_attn_davit__vision_kernel
.p2align 8
.type standalone__window_attn_davit__vision_kernel,@function
standalone__window_attn_davit__vision_kernel:
s_cmp_ge_u32 s2, 256
s_cbranch_scc1 L_end
v_lshrrev_b32 v1, 6, v0
s_mov_b32 s53, s2
s_mov_b32 s47, 0
v_readfirstlane_b32 s32, v1
s_nop 3
L_start:

s_load_dwordx8 s[56:63], s[0:1], 0
s_load_dwordx2 s[64:65], s[0:1], 32
s_load_dwordx2 s[66:67], s[0:1], 48
s_getpc_b64 s[68:69]
L_pc:
v_mbcnt_lo_u32_b32 v0, -1, 0
v_mbcnt_hi_u32_b32 v0, -1, v0
s_add_u32 s70, s68, L_tab-L_pc
s_addc_u32 s71, s69, 0
s_lshl_b32 s45, s32, 10
v_lshl_add_u32 v1, v0, 4, s45
s_add_u32 m0, s45, 143616
s_nop 0
global_load_lds_dwordx4 v1, s[70:71]
v_add_u32 v1, 4096, v1
s_add_u32 m0, s45, 147712
s_nop 0
global_load_lds_dwordx4 v1, s[70:71]
v_add_u32 v1, 4096, v1
s_add_u32 m0, s45, 151808
s_nop 0
global_load_lds_dwordx4 v1, s[70:71]
s_lshr_b32 s42, s53, 3
s_and_b32 s41, s42, 1
s_lshl_b32 s41, s41, 2
s_add_u32 s41, s41, s32
s_lshl_b32 s41, s41, 13
v_lshlrev_b32 v2, 7, v0
v_add_u32 v3, s41, v2
s_cmp_lt_u32 s42, 4
s_cbranch_scc0 L_nopf
global_load_dword v255, v3, s[68:69]
L_nopf:
s_and_b32 s41, s53, 7
s_mul_i32 s43, s41, 666
s_add_u32 s34, s43, 667
s_min_u32 s41, s41, 1
s_add_u32 s43, s43, s41
s_add_u32 s33, s43, s42
s_mov_b32 s35, s33
s_mov_b32 s72, 402653183
s_mul_i32 s54, s32, 96
s_mul_i32 s55, s32, 3072
s_mul_hi_u32 s41, s33, 58835169
s_mul_i32 s28, s41, 73
s_sub_u32 s28, s33, s28
s_mul_i32 s29, s41, 1373568
s_mul_i32 s41, s28, 2688
s_add_u32 s29, s29, s41
v_add_u32 v4, 0, v0
v_mul_u32_u24 v5, 171, v4
v_lshrrev_b32 v5, 10, v5
v_mul_u32_u24 v6, 6, v5
v_sub_u32 v6, v4, v6
v_lshlrev_b32 v6, 4, v6
v_mul_u32_u24 v7, 1152, v5
v_add_u32 v72, v7, v6
v_mul_u32_u24 v7, 384, v5
v_add_u32 v75, v7, v6
v_add_u32 v4, 64, v0
v_mul_u32_u24 v5, 171, v4
v_lshrrev_b32 v5, 10, v5
v_mul_u32_u24 v6, 6, v5
v_sub_u32 v6, v4, v6
v_lshlrev_b32 v6, 4, v6
v_mul_u32_u24 v7, 1152, v5
v_add_u32 v73, v7, v6
v_mul_u32_u24 v7, 384, v5
v_add_u32 v76, v7, v6
v_add_u32 v4, 128, v0
v_mul_u32_u24 v5, 171, v4
v_lshrrev_b32 v5, 10, v5
v_mul_u32_u24 v6, 6, v5
v_sub_u32 v6, v4, v6
v_lshlrev_b32 v6, 4, v6
v_mul_u32_u24 v7, 1152, v5
v_add_u32 v74, v7, v6
v_mul_u32_u24 v7, 384, v5
v_add_u32 v77, v7, v6
s_mul_i32 s41, s32, 54
v_add_u32 v4, s41, v0
v_mul_u32_u24 v5, 911, v4
v_lshrrev_b32 v5, 16, v5
v_mul_u32_u24 v6, 72, v5
v_sub_u32 v6, v4, v6
s_mov_b32 s43, 196224
v_mul_lo_u32 v5, v5, s43
v_lshl_add_u32 v8, v6, 4, v5
s_lshl_b32 s41, s32, 6
v_add_u32 v4, s41, v0
v_mul_u32_u24 v5, 2428, v4
v_lshrrev_b32 v5, 16, v5
v_mul_u32_u24 v6, 27, v5
v_sub_u32 v6, v4, v6
v_mul_lo_u32 v5, v5, s43
v_lshl_add_u32 v9, v6, 7, v5
s_waitcnt lgkmcnt(0)
s_mov_b32 s12, s60
s_mov_b32 s13, s61
s_mov_b32 s14, 221184
s_mov_b32 s15, 131072
s_mov_b32 s16, s62
s_mov_b32 s17, s63
s_mov_b32 s18, 73728
s_mov_b32 s19, 131072
s_lshl_b32 s41, s42, 13
s_cmp_eq_u32 s32, 0
s_cbranch_scc0 L_nopf2
buffer_load_dword v255, v2, s[12:15], s41 offen
L_nopf2:
s_and_b32 s41, s41, 131071
s_cmp_eq_u32 s32, 1
s_cbranch_scc0 L_nopf3
buffer_load_dword v255, v2, s[16:19], s41 offen
L_nopf3:
s_sub_u32 s4, s56, 196608
s_subb_u32 s5, s57, 0
s_mov_b32 s6, 100467072
s_mov_b32 s7, 131072
s_mov_b32 s20, s58
s_mov_b32 s21, s59
s_mov_b32 s22, 3456
s_mov_b32 s23, 131072
s_mov_b32 exec_hi, 4194303
s_mul_i32 s30, s32, 864
s_add_u32 m0, s30, 155904
s_nop 0
buffer_load_dwordx4 v75, s[20:23], s54 offen lds
s_add_u32 s40, s29, 785664
s_add_u32 m0, s30, 0
s_add_u32 s28, s28, 32
s_cmp_ge_u32 s28, 73
buffer_load_dwordx4 v8, s[4:7], s40 offen lds
s_cselect_b32 s41, 73, 0
s_cselect_b32 s43, 1177344, 0
s_sub_u32 s28, s28, s41
s_add_u32 s40, s40, s43
s_add_u32 s40, s40, 86016
s_add_u32 m0, s30, 3472
s_add_u32 s28, s28, 32
s_cmp_ge_u32 s28, 73
buffer_load_dwordx4 v8, s[4:7], s40 offen lds
s_cselect_b32 s41, 73, 0
s_cselect_b32 s43, 1177344, 0
s_sub_u32 s28, s28, s41
s_add_u32 s40, s40, s43
s_add_u32 s40, s40, 86016
s_add_u32 m0, s30, 6944
s_add_u32 s28, s28, 32
s_cmp_ge_u32 s28, 73
buffer_load_dwordx4 v8, s[4:7], s40 offen lds
s_cselect_b32 s41, 73, 0
s_cselect_b32 s43, 1177344, 0
s_sub_u32 s28, s28, s41
s_add_u32 s40, s40, s43
s_add_u32 s40, s40, 86016
s_add_u32 m0, s30, 10416
s_add_u32 s28, s28, 32
s_cmp_ge_u32 s28, 73
buffer_load_dwordx4 v8, s[4:7], s40 offen lds
s_cselect_b32 s41, 73, 0
s_cselect_b32 s43, 1177344, 0
s_sub_u32 s28, s28, s41
s_add_u32 s40, s40, s43
s_add_u32 s40, s40, 86016
s_add_u32 m0, s30, 13888
s_add_u32 s28, s28, 32
s_cmp_ge_u32 s28, 73
buffer_load_dwordx4 v8, s[4:7], s40 offen lds
s_cselect_b32 s41, 73, 0
s_cselect_b32 s43, 1177344, 0
s_sub_u32 s28, s28, s41
s_add_u32 s40, s40, s43
s_add_u32 s40, s40, 86016
s_add_u32 m0, s30, 17360
s_add_u32 s28, s28, 32
s_cmp_ge_u32 s28, 73
buffer_load_dwordx4 v8, s[4:7], s40 offen lds
s_cselect_b32 s41, 73, 0
s_cselect_b32 s43, 1177344, 0
s_sub_u32 s28, s28, s41
s_add_u32 s40, s40, s43
s_add_u32 s40, s40, 86016
s_add_u32 m0, s30, 20832
s_add_u32 s28, s28, 32
s_cmp_ge_u32 s28, 73
buffer_load_dwordx4 v8, s[4:7], s40 offen lds
s_cselect_b32 s41, 73, 0
s_cselect_b32 s43, 1177344, 0
s_sub_u32 s28, s28, s41
s_add_u32 s40, s40, s43
s_add_u32 s40, s40, 86016
s_add_u32 m0, s30, 24304
s_add_u32 s28, s28, 32
s_cmp_ge_u32 s28, 73
buffer_load_dwordx4 v8, s[4:7], s40 offen lds
s_cselect_b32 s41, 73, 0
s_cselect_b32 s43, 1177344, 0
s_sub_u32 s28, s28, s41
s_add_u32 s40, s40, s43
s_add_u32 s40, s40, 86016
s_add_u32 m0, s30, 27776
s_add_u32 s28, s28, 32
s_cmp_ge_u32 s28, 73
buffer_load_dwordx4 v8, s[4:7], s40 offen lds
s_cselect_b32 s41, 73, 0
s_cselect_b32 s43, 1177344, 0
s_sub_u32 s28, s28, s41
s_add_u32 s40, s40, s43
s_add_u32 s40, s40, 86016
s_add_u32 m0, s30, 31248
s_add_u32 s28, s28, 32
s_cmp_ge_u32 s28, 73
buffer_load_dwordx4 v8, s[4:7], s40 offen lds
s_cselect_b32 s41, 73, 0
s_cselect_b32 s43, 1177344, 0
s_sub_u32 s28, s28, s41
s_add_u32 s40, s40, s43
s_add_u32 s40, s40, 86016
s_add_u32 m0, s30, 34720
s_add_u32 s28, s28, 32
s_cmp_ge_u32 s28, 73
buffer_load_dwordx4 v8, s[4:7], s40 offen lds
s_cselect_b32 s41, 73, 0
s_cselect_b32 s43, 1177344, 0
s_sub_u32 s28, s28, s41
s_add_u32 s40, s40, s43
s_add_u32 s40, s40, 86016
s_add_u32 m0, s30, 38192
s_add_u32 s28, s28, 32
s_cmp_ge_u32 s28, 73
buffer_load_dwordx4 v8, s[4:7], s40 offen lds
s_cselect_b32 s41, 73, 0
s_cselect_b32 s43, 1177344, 0
s_sub_u32 s28, s28, s41
s_add_u32 s40, s40, s43
s_add_u32 s40, s40, 86016
s_add_u32 m0, s30, 41664
s_add_u32 s28, s28, 32
s_cmp_ge_u32 s28, 73
buffer_load_dwordx4 v8, s[4:7], s40 offen lds
s_cselect_b32 s41, 73, 0
s_cselect_b32 s43, 1177344, 0
s_sub_u32 s28, s28, s41
s_add_u32 s40, s40, s43
s_add_u32 s40, s40, 86016
s_add_u32 m0, s30, 45136
s_add_u32 s28, s28, 32
s_cmp_ge_u32 s28, 73
buffer_load_dwordx4 v8, s[4:7], s40 offen lds
s_cselect_b32 s41, 73, 0
s_cselect_b32 s43, 1177344, 0
s_sub_u32 s28, s28, s41
s_add_u32 s40, s40, s43
s_add_u32 s40, s40, 86016
s_add_u32 m0, s30, 48608
s_add_u32 s28, s28, 32
s_cmp_ge_u32 s28, 73
buffer_load_dwordx4 v8, s[4:7], s40 offen lds
s_cselect_b32 s41, 73, 0
s_cselect_b32 s43, 1177344, 0
s_sub_u32 s28, s28, s41
s_add_u32 s40, s40, s43
s_add_u32 s40, s40, 86016
s_add_u32 m0, s30, 52080
s_add_u32 s28, s28, 32
s_cmp_ge_u32 s28, 73
buffer_load_dwordx4 v8, s[4:7], s40 offen lds
s_cselect_b32 s41, 73, 0
s_cselect_b32 s43, 1177344, 0
s_sub_u32 s28, s28, s41
s_add_u32 s40, s40, s43
s_add_u32 s40, s40, 86016
s_add_u32 m0, s30, 55552
s_add_u32 s28, s28, 32
s_cmp_ge_u32 s28, 73
buffer_load_dwordx4 v8, s[4:7], s40 offen lds
s_cselect_b32 s41, 73, 0
s_cselect_b32 s43, 1177344, 0
s_sub_u32 s28, s28, s41
s_add_u32 s40, s40, s43
s_add_u32 s40, s40, 86016
s_add_u32 m0, s30, 59024
s_add_u32 s28, s28, 32
s_cmp_ge_u32 s28, 73
buffer_load_dwordx4 v8, s[4:7], s40 offen lds
s_cselect_b32 s41, 73, 0
s_cselect_b32 s43, 1177344, 0
s_sub_u32 s28, s28, s41
s_add_u32 s40, s40, s43
s_add_u32 s40, s40, 86016
s_add_u32 m0, s30, 62496
s_add_u32 s28, s28, 32
s_cmp_ge_u32 s28, 73
buffer_load_dwordx4 v8, s[4:7], s40 offen lds
s_cselect_b32 s41, 73, 0
s_cselect_b32 s43, 1177344, 0
s_sub_u32 s28, s28, s41
s_add_u32 s40, s40, s43
s_add_u32 s40, s40, 86016
s_add_u32 m0, s30, 65968
s_add_u32 s28, s28, 32
s_cmp_ge_u32 s28, 73
buffer_load_dwordx4 v8, s[4:7], s40 offen lds
s_cselect_b32 s41, 73, 0
s_cselect_b32 s43, 1177344, 0
s_sub_u32 s28, s28, s41
s_add_u32 s40, s40, s43
s_add_u32 s40, s40, 86016
s_add_u32 s41, s33, 640
s_cmp_lt_u32 s41, s34
s_cselect_b32 s40, s40, 1879048192
s_add_u32 m0, s30, 69440
s_nop 0
buffer_load_dwordx4 v8, s[4:7], s40 offen lds
s_mov_b64 exec, -1
s_max_u32 s41, s29, 196608
buffer_load_dword v255, v9, s[4:7], s41 offen nt
s_add_u32 m0, s55, 94464
s_add_u32 s29, s54, 384
buffer_load_dwordx4 v72, s[12:15], s29 offen lds
s_add_u32 m0, s55, 95488
s_add_u32 s29, s54, 384
buffer_load_dwordx4 v73, s[12:15], s29 offen lds
s_add_u32 m0, s55, 96512
s_add_u32 s29, s54, 384
buffer_load_dwordx4 v74, s[12:15], s29 offen lds
s_add_u32 m0, s55, 106752
s_add_u32 s29, s54, 37248
buffer_load_dwordx4 v72, s[12:15], s29 offen lds
s_add_u32 m0, s55, 107776
s_add_u32 s29, s54, 37248
buffer_load_dwordx4 v73, s[12:15], s29 offen lds
s_add_u32 m0, s55, 108800
s_add_u32 s29, s54, 37248
buffer_load_dwordx4 v74, s[12:15], s29 offen lds
s_add_u32 m0, s55, 119040
s_add_u32 s29, s54, 74112
buffer_load_dwordx4 v72, s[12:15], s29 offen lds
s_add_u32 m0, s55, 120064
s_add_u32 s29, s54, 74112
buffer_load_dwordx4 v73, s[12:15], s29 offen lds
s_add_u32 m0, s55, 121088
s_add_u32 s29, s54, 74112
buffer_load_dwordx4 v74, s[12:15], s29 offen lds
s_add_u32 m0, s55, 131328
s_add_u32 s29, s54, 110976
buffer_load_dwordx4 v72, s[12:15], s29 offen lds
s_add_u32 m0, s55, 132352
s_add_u32 s29, s54, 110976
buffer_load_dwordx4 v73, s[12:15], s29 offen lds
s_add_u32 m0, s55, 133376
s_add_u32 s29, s54, 110976
buffer_load_dwordx4 v74, s[12:15], s29 offen lds
s_add_u32 m0, s55, 78080
s_add_u32 s29, s54, 147840
buffer_load_dwordx4 v72, s[12:15], s29 offen lds
s_add_u32 m0, s55, 79104
s_add_u32 s29, s54, 147840
buffer_load_dwordx4 v73, s[12:15], s29 offen lds
s_add_u32 m0, s55, 80128
s_add_u32 s29, s54, 147840
buffer_load_dwordx4 v74, s[12:15], s29 offen lds
s_mov_b32 s8, s64
s_mov_b32 s9, s65
s_mov_b32 s10, 100270464
s_mov_b32 s11, 131072
s_mov_b32 s24, s66
s_mov_b32 s25, s67
s_mov_b32 s26, 6291456
s_mov_b32 s27, 131072
s_mov_b32 s48, 1001040555
s_mov_b32 s73, 1020061065
s_mov_b32 s49, 944335852
s_mov_b32 s3, 1074544643
s_mul_i32 s50, s53, 24576
s_mul_i32 s41, s32, 6144
s_add_u32 s50, s50, s41
v_mul_u32_u24 v5, 2622, v4
v_lshrrev_b32 v5, 16, v5
v_mul_u32_u24 v6, 25, v5
v_sub_u32 v6, v4, v6
v_mul_u32_u24 v7, 384, v5
v_lshl_add_u32 v7, v6, 4, v7
v_cmp_eq_u32 vcc, 0, v5
v_or_b32 v10, 134217728, v7
s_nop 0
v_cndmask_b32 v7, v7, v10, vcc
v_cmp_eq_u32 vcc, 8, v5
v_or_b32 v10, 536870912, v7
s_nop 0
v_cndmask_b32 v7, v7, v10, vcc
v_cmp_lt_u32 vcc, 8, v5
v_or_b32 v10, 268435456, v7
s_nop 0
v_cndmask_b32 v7, v7, v10, vcc
v_cmp_eq_u32 vcc, 24, v6
v_or_b32 v10, 268435456, v7
s_nop 0
v_cndmask_b32 v7, v7, v10, vcc
v_lshlrev_b32 v11, 4, v0
v_add_u32 v11, 143616, v11
s_waitcnt vmcnt(37)
s_barrier
ds_read_b128 v[194:197], v11
ds_read_b128 v[198:201], v11 offset:1024
ds_read_b128 v[202:205], v11 offset:2048
ds_read_b128 v[206:209], v11 offset:3072
ds_read_b128 v[210:213], v11 offset:4096
ds_read_b128 v[214:217], v11 offset:5120
ds_read_b128 v[78:81], v11 offset:6144
ds_read_b128 v[82:85], v11 offset:7168
ds_read_b128 v[138:141], v11 offset:8192
ds_read_b128 v[142:145], v11 offset:9216
ds_read_b128 v[146:149], v11 offset:10240
s_waitcnt lgkmcnt(7)
v_add_u32 v219, s45, v208
v_mov_b32 v208, v7
s_waitcnt lgkmcnt(2)
v_add_u32 v138, s30, v138
v_add_u32 v139, s30, v139
v_add_u32 v140, s30, v140
ds_read_u16 v150, v138
ds_read_u16 v151, v138 offset:192
ds_read_u16 v152, v139
ds_read_u16 v153, v139 offset:192
ds_read_u16 v154, v140
ds_read_u16 v155, v138 offset:32
ds_read_u16 v156, v138 offset:224
ds_read_u16 v157, v139 offset:32
ds_read_u16 v158, v139 offset:224
ds_read_u16 v159, v140 offset:32
ds_read_u16 v160, v138 offset:64
ds_read_u16 v161, v138 offset:256
ds_read_u16 v162, v139 offset:64
ds_read_u16 v163, v139 offset:256
ds_read_u16 v164, v140 offset:64
v_add_u32 v194, s54, v194
v_add_u32 v195, s54, v195
v_add_u32 v196, s54, v196
v_add_u32 v197, s54, v197
v_add_u32 v198, s54, v198
v_add_u32 v199, s54, v199
v_add_u32 v200, s54, v200
v_add_u32 v201, s54, v201
v_add_u32 v202, s54, v202
v_add_u32 v203, s54, v203
v_add_u32 v204, s54, v204
v_add_u32 v205, s54, v205
v_add_u32 v216, s54, v216
v_add_u32 v79, s54, v79
v_add_u32 v80, s54, v80
v_add_u32 v81, s54, v81
v_add_u32 v83, s54, v83
v_add_u32 v211, s45, v211
v_add_u32 v78, s55, v78
s_lshr_b32 s41, s32, 1
s_lshl_b32 s41, s41, 10
s_and_b32 s42, s32, 1
s_lshl_b32 s42, s42, 3
s_add_u32 s41, s41, s42
v_add_u32 v212, s41, v212
s_lshl_b32 s41, s32, 2
v_add_u32 v209, s41, v209
s_lshl_b32 s41, s32, 7
v_add_u32 v215, s41, v215
v_add_u32 v214, s41, v214
v_add_u32 v82, s41, v82
s_mul_i32 s41, s32, 4752
v_add_u32 v217, s41, v217
s_waitcnt lgkmcnt(0)
v_and_or_b32 v154, v154, v144, v145
v_lshl_or_b32 v154, v154, 16, v154
v_and_b32 v0, v154, v146
v_and_b32 v1, v154, v147
v_and_b32 v2, v154, v148
v_and_b32 v3, v154, v149
v_and_b32 v4, v150, v142
v_and_b32 v5, v150, v143
v_and_b32 v6, v151, v142
v_and_b32 v7, v151, v143
v_and_b32 v8, v152, v142
v_and_b32 v9, v152, v143
v_and_b32 v10, v153, v142
v_and_b32 v11, v153, v143
v_and_or_b32 v159, v159, v144, v145
v_lshl_or_b32 v159, v159, 16, v159
v_and_b32 v12, v159, v146
v_and_b32 v13, v159, v147
v_and_b32 v14, v159, v148
v_and_b32 v15, v159, v149
v_and_b32 v16, v155, v142
v_and_b32 v17, v155, v143
v_and_b32 v18, v156, v142
v_and_b32 v19, v156, v143
v_and_b32 v20, v157, v142
v_and_b32 v21, v157, v143
v_and_b32 v22, v158, v142
v_and_b32 v23, v158, v143
v_and_or_b32 v164, v164, v144, v145
v_lshl_or_b32 v164, v164, 16, v164
v_and_b32 v24, v164, v146
v_and_b32 v25, v164, v147
v_and_b32 v26, v164, v148
v_and_b32 v27, v164, v149
v_and_b32 v28, v160, v142
v_and_b32 v29, v160, v143
v_and_b32 v30, v161, v142
v_and_b32 v31, v161, v143
v_and_b32 v32, v162, v142
v_and_b32 v33, v162, v143
v_and_b32 v34, v163, v142
v_and_b32 v35, v163, v143
v_mov_b32 v190, 1065369472
v_mov_b32 v191, 1065369472
v_mov_b32 v192, 1065369472
v_mov_b32 v193, 1065369472
v_mov_b32 v218, 0
v_mov_b32 v220, 162624
s_waitcnt vmcnt(16) lgkmcnt(0)
s_barrier
s_waitcnt vmcnt(9)
ds_read_b64_tr_b16 a[0:1], v78 offset:16384
ds_read_b64_tr_b16 a[24:25], v78 offset:16416
ds_read_b64_tr_b16 a[48:49], v78 offset:16448
ds_read_b64_tr_b16 a[2:3], v78 offset:17920
ds_read_b64_tr_b16 a[26:27], v78 offset:17952
ds_read_b64_tr_b16 a[50:51], v78 offset:17984
ds_read_b64_tr_b16 a[16:17], v78 offset:28672
ds_read_b64_tr_b16 a[40:41], v78 offset:28704
ds_read_b64_tr_b16 a[64:65], v78 offset:28736
ds_read_b128 v[84:87], v81
ds_read_b128 v[92:95], v81 offset:55552
s_mul_hi_u32 s41, s35, 58835169
s_mul_i32 s42, s41, 73
s_sub_u32 s42, s35, s42
s_mul_i32 s43, s41, 1373568
s_mul_i32 s51, s42, 2688
s_add_u32 s43, s43, s51
s_cmp_lt_u32 s35, s34
s_cselect_b32 s36, s43, 1879048192
s_add_u32 s35, s35, 32
s_cmp_eq_u32 s42, 0
s_cselect_b32 s44, 536870911, s72
s_cmp_eq_u32 s42, 72
s_cselect_b32 s44, 939524095, s44
s_cmp_eq_u32 s41, 0
s_cselect_b32 s40, 1879048192, s36
ds_read_b64_tr_b16 a[4:5], v78 offset:30208
ds_read_b64_tr_b16 a[28:29], v78 offset:30240
v_and_b32 v180, s44, v208
s_waitcnt lgkmcnt(7)
s_add_u32 m0, s55, 94464
s_add_u32 s29, s54, 184704
buffer_load_dwordx4 v72, s[12:15], s29 offen lds
ds_read_b64_tr_b16 a[52:53], v78 offset:30272
s_add_u32 m0, s55, 95488
s_add_u32 s29, s54, 184704
buffer_load_dwordx4 v73, s[12:15], s29 offen lds
ds_read_b128 v[100:103], v79
s_waitcnt lgkmcnt(5)
v_mfma_f32_16x16x32_bf16 v[36:39], v[0:3], v[84:87], 0
s_waitcnt vmcnt(9) lgkmcnt(4)
ds_read_b128 v[104:107], v79 offset:16
ds_read_b128 v[84:87], v79 offset:55552
v_mfma_f32_16x16x32_bf16 v[48:51], v[0:3], v[92:95], 0
s_add_u32 s28, s50, 4096
ds_read_b128 v[88:91], v79 offset:55568
s_add_u32 m0, s55, 96512
s_add_u32 s29, s54, 184704
buffer_load_dwordx4 v74, s[12:15], s29 offen lds
ds_read_b64_tr_b16 a[6:7], v78 offset:40960
ds_read_b64_tr_b16 a[30:31], v78 offset:40992
ds_read_b64_tr_b16 a[54:55], v78 offset:41024
ds_read_b128 v[92:95], v80
ds_read_b128 v[96:99], v80 offset:16
ds_write_b32 v220, v218
v_subrev_u32 v60, 37120, v210
ds_write_b128 v217, v[0:3]
s_waitcnt lgkmcnt(9)
v_smfmac_f32_16x16x64_bf16 v[36:39], v[4:7], v[100:107], v213
s_add_u32 m0, s55, 106752
s_add_u32 s29, s54, 0
buffer_load_dwordx4 v72, s[12:15], s29 offen lds
s_waitcnt lgkmcnt(7)
v_smfmac_f32_16x16x64_bf16 v[48:51], v[4:7], v[84:91], v213
s_waitcnt vmcnt(10)
ds_read_b64_tr_b16 a[18:19], v78 offset:42496
ds_read_b64_tr_b16 a[42:43], v78 offset:42528
ds_read_b64_tr_b16 a[66:67], v78 offset:42560
ds_read_b128 v[100:103], v80 offset:55552
s_add_u32 m0, s55, 107776
s_add_u32 s29, s54, 0
buffer_load_dwordx4 v73, s[12:15], s29 offen lds
ds_read_b128 v[104:107], v80 offset:55568
s_waitcnt lgkmcnt(7)
v_smfmac_f32_16x16x64_bf16 v[36:39], v[8:11], v[92:99], v213
ds_read_b128 v[84:87], v81 offset:32
ds_read_b128 v[92:95], v81 offset:55584
ds_read_b128 v[88:91], v79 offset:55600
s_nop 3
buffer_store_dwordx4 v[36:39], v60, s[24:27], s50 offen
ds_read_b128 v[96:99], v80 offset:48
s_waitcnt vmcnt(10)
ds_read_b64_tr_b16 a[8:9], v78 offset:53248
ds_read_b64_tr_b16 a[32:33], v78 offset:53280
ds_read_b64_tr_b16 a[56:57], v78 offset:53312
v_add_f32 v118, v36, v37
v_mul_f32 v119, v36, v36
v_add_f32 v118, v118, v38
v_fmac_f32 v119, v37, v37
v_add_f32 v118, v118, v39
v_fmac_f32 v119, v38, v38
v_fmac_f32 v119, v39, v39
s_waitcnt lgkmcnt(7)
v_smfmac_f32_16x16x64_bf16 v[48:51], v[8:11], v[100:107], v213
s_waitcnt vmcnt(9)
s_add_u32 m0, s55, 108800
s_add_u32 s29, s54, 0
buffer_load_dwordx4 v74, s[12:15], s29 offen lds
ds_read_b64_tr_b16 a[10:11], v78 offset:54784
s_waitcnt lgkmcnt(7)
v_mfma_f32_16x16x32_bf16 v[40:43], v[12:15], v[84:87], 0
s_waitcnt lgkmcnt(6)
ds_read_b64_tr_b16 a[34:35], v78 offset:54816
ds_read_b64_tr_b16 a[58:59], v78 offset:54848
v_mfma_f32_16x16x32_bf16 v[52:55], v[12:15], v[92:95], 0
ds_read_b128 v[100:103], v79 offset:32
ds_read_b128 v[104:107], v79 offset:48
ds_read_b128 v[84:87], v79 offset:55584
ds_read_b128 v[92:95], v80 offset:32
ds_write_b128 v217, v[4:7] offset:528
s_add_u32 m0, s55, 119040
s_add_u32 s29, s54, 36864
buffer_load_dwordx4 v72, s[12:15], s29 offen lds
buffer_store_dwordx4 v[48:51], v60, s[24:27], s50 offen offset:3072
ds_write_b128 v217, v[8:11] offset:1056
v_add_f32 v126, v48, v49
v_mul_f32 v127, v48, v48
v_add_f32 v126, v126, v50
v_fmac_f32 v127, v49, v49
v_add_f32 v126, v126, v51
v_fmac_f32 v127, v50, v50
s_waitcnt lgkmcnt(4)
v_smfmac_f32_16x16x64_bf16 v[40:43], v[16:19], v[100:107], v213
s_waitcnt vmcnt(10) lgkmcnt(3)
ds_read_b64_tr_b16 a[20:21], v78
ds_read_b64_tr_b16 a[44:45], v78 offset:32
v_smfmac_f32_16x16x64_bf16 v[52:55], v[16:19], v[84:91], v213
s_waitcnt lgkmcnt(4)
ds_read_b64_tr_b16 a[68:69], v78 offset:64
ds_read_b128 v[100:103], v80 offset:55584
v_smfmac_f32_16x16x64_bf16 v[40:43], v[20:23], v[92:99], v213
s_add_u32 m0, s55, 120064
s_add_u32 s29, s54, 36864
buffer_load_dwordx4 v73, s[12:15], s29 offen lds
ds_read_b128 v[104:107], v80 offset:55600
ds_read_b128 v[84:87], v81 offset:64
v_fmac_f32 v127, v51, v51
s_waitcnt vmcnt(10)
ds_read_b64_tr_b16 a[12:13], v78 offset:1536
s_nop 0
buffer_store_dwordx4 v[40:43], v60, s[24:27], s50 offen offset:1024
ds_read_b64_tr_b16 a[36:37], v78 offset:1568
ds_read_b64_tr_b16 a[60:61], v78 offset:1600
ds_read_b128 v[92:95], v81 offset:55616
v_add_f32 v118, v118, v40
v_fmac_f32 v119, v40, v40
v_add_f32 v118, v118, v41
v_fmac_f32 v119, v41, v41
v_add_f32 v118, v118, v42
v_fmac_f32 v119, v42, v42
v_add_f32 v118, v118, v43
v_fmac_f32 v119, v43, v43
ds_read_b128 v[88:91], v79 offset:55632
ds_read_b128 v[96:99], v80 offset:80
ds_write_b128 v217, v[12:15] offset:1584
s_add_u32 m0, s55, 121088
s_add_u32 s29, s54, 36864
buffer_load_dwordx4 v74, s[12:15], s29 offen lds
s_waitcnt lgkmcnt(8)
v_smfmac_f32_16x16x64_bf16 v[52:55], v[20:23], v[100:107], v213
s_waitcnt vmcnt(10) lgkmcnt(7)
ds_read_b64_tr_b16 a[14:15], v78 offset:16384
v_mfma_f32_16x16x32_bf16 v[44:47], v[24:27], v[84:87], 0
ds_read_b64_tr_b16 a[38:39], v78 offset:16416
ds_read_b64_tr_b16 a[62:63], v78 offset:16448
ds_read_b128 v[100:103], v79 offset:64
buffer_store_dwordx4 v[52:55], v60, s[24:27], s28 offen
ds_read_b128 v[104:107], v79 offset:80
s_waitcnt lgkmcnt(8)
v_mfma_f32_16x16x32_bf16 v[56:59], v[24:27], v[92:95], 0
ds_read_b128 v[84:87], v79 offset:55616
v_add_f32 v126, v126, v52
s_waitcnt vmcnt(10)
ds_read_b64_tr_b16 a[22:23], v78 offset:17920
ds_read_b64_tr_b16 a[46:47], v78 offset:17952
ds_read_b64_tr_b16 a[70:71], v78 offset:17984
v_fmac_f32 v127, v52, v52
v_add_f32 v126, v126, v53
v_fmac_f32 v127, v53, v53
s_add_u32 m0, s55, 131328
s_add_u32 s29, s54, 73728
buffer_load_dwordx4 v72, s[12:15], s29 offen lds
ds_read_b128 v[92:95], v80 offset:64
ds_write_b128 v217, v[16:19] offset:2112
v_add_f32 v126, v126, v54
v_fmac_f32 v127, v54, v54
v_add_f32 v126, v126, v55
v_fmac_f32 v127, v55, v55
s_waitcnt lgkmcnt(6)
v_smfmac_f32_16x16x64_bf16 v[44:47], v[28:31], v[100:107], v213
s_add_u32 m0, s55, 132352
s_add_u32 s29, s54, 73728
buffer_load_dwordx4 v73, s[12:15], s29 offen lds
s_waitcnt lgkmcnt(5)
v_smfmac_f32_16x16x64_bf16 v[56:59], v[28:31], v[84:91], v213
s_waitcnt vmcnt(10)
ds_read_b64_tr_b16 a[216:217], v78 offset:28672
ds_read_b64_tr_b16 a[240:241], v78 offset:28704
ds_read_b64_tr_b16 v[232:233], v78 offset:28736
ds_read_b128 v[100:103], v80 offset:55616
ds_read_b128 v[104:107], v80 offset:55632
ds_write_b128 v217, v[20:23] offset:2640
s_waitcnt lgkmcnt(7)
v_smfmac_f32_16x16x64_bf16 v[44:47], v[32:35], v[92:99], v213
s_add_u32 m0, s55, 133376
s_add_u32 s29, s54, 73728
buffer_load_dwordx4 v74, s[12:15], s29 offen lds
ds_write_b128 v217, v[24:27] offset:3168
s_nop 4
buffer_store_dwordx4 v[44:47], v60, s[24:27], s50 offen offset:2048
v_add_f32 v118, v118, v44
v_fmac_f32 v119, v44, v44
v_add_f32 v118, v118, v45
v_fmac_f32 v119, v45, v45
v_add_f32 v118, v118, v46
v_fmac_f32 v119, v46, v46
v_add_f32 v118, v118, v47
s_waitcnt lgkmcnt(2)
v_smfmac_f32_16x16x64_bf16 v[56:59], v[32:35], v[100:107], v213
ds_write_b128 v217, v[28:31] offset:3696
v_fmac_f32 v119, v47, v47
s_add_u32 m0, s55, 78080
s_add_u32 s29, s54, 110592
buffer_load_dwordx4 v72, s[12:15], s29 offen lds
s_nop 3
buffer_store_dwordx4 v[56:59], v60, s[24:27], s28 offen offset:1024
ds_write_b128 v217, v[32:35] offset:4224
v_add_f32 v126, v126, v56
v_fmac_f32 v127, v56, v56
v_add_f32 v126, v126, v57
v_fmac_f32 v127, v57, v57
v_add_f32 v126, v126, v58
v_fmac_f32 v127, v58, v58
v_add_f32 v126, v126, v59
v_permlane16_swap_b32 v118, v119
v_fmac_f32 v127, v59, v59
v_add_f32 v118, v118, v119
s_nop 0
v_permlane16_swap_b32 v126, v127
v_add_f32 v126, v126, v127
s_nop 1
v_permlane32_swap_b32 v118, v126
s_add_u32 m0, s55, 79104
s_add_u32 s29, s54, 110592
buffer_load_dwordx4 v73, s[12:15], s29 offen lds
v_add_f32 v118, v118, v126
ds_write_b32 v209, v118
s_add_u32 m0, s55, 80128
s_add_u32 s29, s54, 110592
buffer_load_dwordx4 v74, s[12:15], s29 offen lds
s_waitcnt lgkmcnt(0)
s_barrier
ds_read_b128 v[102:105], v210 offset:55296
ds_read_b128 v[106:109], v210 offset:56320
s_add_u32 m0, s45, 0
s_nop 0
buffer_load_dwordx4 v180, s[4:7], s40 offen nt lds
s_add_u32 m0, s45, 4112
s_add_u32 s40, s36, 196224
buffer_load_dwordx4 v180, s[4:7], s40 offen nt lds
s_add_u32 m0, s45, 8224
s_add_u32 s40, s36, 392448
buffer_load_dwordx4 v180, s[4:7], s40 offen nt lds
s_waitcnt lgkmcnt(1)
v_add_f32 v102, v102, v103
v_add_f32 v104, v104, v105
v_add_f32 v102, v102, v104
v_mul_f32 v103, s48, v102
v_mul_f32 v104, s73, v102
s_waitcnt lgkmcnt(0)
v_add_f32 v106, v106, v107
v_add_f32 v108, v108, v109
v_add_f32 v106, v106, v108
v_mul_f32 v106, s73, v106
v_fma_f32 v106, -v103, v104, v106
v_max_f32 v106, 0, v106
v_add_f32 v106, s49, v106
v_rsq_f32 v102, v106
s_nop 0
v_mul_f32_e64 v103, -v103, v102
s_add_u32 m0, s45, 12336
s_add_u32 s40, s36, 588672
buffer_load_dwordx4 v180, s[4:7], s40 offen nt lds
ds_write_b64 v211, v[102:103] offset:36864
s_add_u32 m0, s45, 16448
s_add_u32 s40, s36, 784896
buffer_load_dwordx4 v180, s[4:7], s40 offen nt lds
ds_read_b64 v[118:119], v219
ds_read_b64 v[126:127], v219 offset:256
s_add_u32 m0, s45, 20560
s_add_u32 s40, s36, 981120
buffer_load_dwordx4 v180, s[4:7], s40 offen nt lds
s_waitcnt lgkmcnt(1)
v_fma_f32 v220, v36, v118, v119
v_fma_f32 v221, v37, v118, v119
v_cvt_pk_bf16_f32 v90, v220, v221
v_fma_f32 v222, v38, v118, v119
v_fma_f32 v223, v39, v118, v119
v_cvt_pk_bf16_f32 v91, v222, v223
v_fma_f32 v220, v40, v118, v119
v_fma_f32 v221, v41, v118, v119
v_cvt_pk_bf16_f32 v92, v220, v221
v_fma_f32 v222, v42, v118, v119
v_fma_f32 v223, v43, v118, v119
v_cvt_pk_bf16_f32 v93, v222, v223
v_fma_f32 v220, v44, v118, v119
v_fma_f32 v221, v45, v118, v119
v_cvt_pk_bf16_f32 v94, v220, v221
v_fma_f32 v222, v46, v118, v119
v_fma_f32 v223, v47, v118, v119
v_cvt_pk_bf16_f32 v95, v222, v223
s_waitcnt lgkmcnt(0)
v_fma_f32 v220, v48, v126, v127
v_fma_f32 v221, v49, v126, v127
v_cvt_pk_bf16_f32 v174, v220, v221
v_fma_f32 v222, v50, v126, v127
v_fma_f32 v223, v51, v126, v127
v_cvt_pk_bf16_f32 v175, v222, v223
v_fma_f32 v220, v52, v126, v127
v_fma_f32 v221, v53, v126, v127
v_cvt_pk_bf16_f32 v176, v220, v221
v_fma_f32 v222, v54, v126, v127
s_add_u32 m0, s55, 94464
s_add_u32 s29, s54, 147456
buffer_load_dwordx4 v72, s[12:15], s29 offen lds
s_add_u32 m0, s45, 24672
s_add_u32 s40, s36, 1177344
buffer_load_dwordx4 v180, s[4:7], s40 offen nt lds
ds_write_b128 v211, v[90:93] offset:18432
s_add_u32 m0, s45, 28784
s_add_u32 s40, s36, 1373568
buffer_load_dwordx4 v180, s[4:7], s40 offen nt lds
v_fma_f32 v223, v55, v126, v127
v_cvt_pk_bf16_f32 v177, v222, v223
v_fma_f32 v220, v56, v126, v127
v_fma_f32 v221, v57, v126, v127
v_cvt_pk_bf16_f32 v178, v220, v221
v_fma_f32 v222, v58, v126, v127
v_fma_f32 v223, v59, v126, v127
v_cvt_pk_bf16_f32 v179, v222, v223
s_add_u32 m0, s45, 32896
s_add_u32 s40, s36, 1569792
buffer_load_dwordx4 v180, s[4:7], s40 offen nt lds
ds_write_b64 v212, v[94:95] offset:18432
s_mul_hi_u32 s41, s35, 58835169
s_mul_i32 s42, s41, 73
s_sub_u32 s42, s35, s42
s_mul_i32 s43, s41, 1373568
s_mul_i32 s51, s42, 2688
s_add_u32 s43, s43, s51
s_cmp_lt_u32 s35, s34
s_cselect_b32 s37, s43, 1879048192
s_add_u32 s35, s35, 32
s_cmp_eq_u32 s42, 0
s_cselect_b32 s44, 536870911, s72
s_cmp_eq_u32 s42, 72
s_cselect_b32 s44, 939524095, s44
s_cmp_eq_u32 s41, 0
s_cselect_b32 s40, 1879048192, s37
ds_write_b128 v211, v[174:177] offset:24576
ds_write_b64 v212, v[178:179] offset:24576
s_add_u32 m0, s55, 95488
s_add_u32 s29, s54, 147456
buffer_load_dwordx4 v73, s[12:15], s29 offen lds
ds_read_b128 v[174:177], v217
ds_read_b128 v[178:181], v217 offset:528
s_add_u32 m0, s55, 96512
s_add_u32 s29, s54, 147456
buffer_load_dwordx4 v74, s[12:15], s29 offen lds
s_waitcnt vmcnt(26)
ds_read_b64_tr_b16 a[218:219], v78 offset:30208
ds_read_b64_tr_b16 a[242:243], v78 offset:30240
ds_read_b64_tr_b16 v[234:235], v78 offset:30272
s_waitcnt lgkmcnt(0)
s_add_u32 m0, s55, 106752
s_add_u32 s29, s54, 184320
buffer_load_dwordx4 v72, s[12:15], s29 offen lds
s_add_u32 m0, s55, 107776
s_add_u32 s29, s54, 184320
buffer_load_dwordx4 v73, s[12:15], s29 offen lds
s_waitcnt vmcnt(25)
ds_read_b64_tr_b16 a[232:233], v78 offset:40960
ds_read_b64_tr_b16 v[224:225], v78 offset:40992
ds_read_b64_tr_b16 v[248:249], v78 offset:41024
s_add_u32 m0, s55, 108800
s_add_u32 s29, s54, 184320
buffer_load_dwordx4 v74, s[12:15], s29 offen lds
s_waitcnt vmcnt(24)
ds_read_b64_tr_b16 a[220:221], v78 offset:42496
ds_read_b64_tr_b16 a[244:245], v78 offset:42528
ds_read_b64_tr_b16 v[236:237], v78 offset:42560
s_waitcnt lgkmcnt(0)
s_add_u32 m0, s55, 119040
s_add_u32 s29, s54, 768
buffer_load_dwordx4 v72, s[12:15], s29 offen lds
s_add_u32 m0, s55, 120064
s_add_u32 s29, s54, 768
buffer_load_dwordx4 v73, s[12:15], s29 offen lds
s_add_u32 m0, s55, 121088
s_add_u32 s29, s54, 768
buffer_load_dwordx4 v74, s[12:15], s29 offen lds
s_waitcnt vmcnt(23)
ds_read_b64_tr_b16 a[222:223], v78 offset:53248
ds_read_b64_tr_b16 a[246:247], v78 offset:53280
ds_read_b64_tr_b16 v[238:239], v78 offset:53312
ds_read_b64_tr_b16 a[234:235], v78 offset:54784
ds_read_b64_tr_b16 v[226:227], v78 offset:54816
ds_read_b64_tr_b16 v[250:251], v78 offset:54848
s_waitcnt lgkmcnt(0)
s_add_u32 m0, s55, 131328
s_add_u32 s29, s54, 37632
buffer_load_dwordx4 v72, s[12:15], s29 offen lds
s_add_u32 m0, s55, 132352
s_add_u32 s29, s54, 37632
buffer_load_dwordx4 v73, s[12:15], s29 offen lds
s_add_u32 m0, s55, 133376
s_add_u32 s29, s54, 37632
buffer_load_dwordx4 v74, s[12:15], s29 offen lds
s_waitcnt vmcnt(7)
ds_read_b64_tr_b16 a[224:225], v78
ds_read_b64_tr_b16 a[248:249], v78 offset:32
ds_read_b64_tr_b16 v[240:241], v78 offset:64
ds_read_b64_tr_b16 a[226:227], v78 offset:1536
ds_read_b64_tr_b16 a[250:251], v78 offset:1568
ds_read_b64_tr_b16 v[242:243], v78 offset:1600
ds_read_b64_tr_b16 a[228:229], v78 offset:17920
ds_read_b64_tr_b16 a[252:253], v78 offset:17952
ds_read_b64_tr_b16 v[244:245], v78 offset:17984
ds_read_b64_tr_b16 a[236:237], v78 offset:16384
ds_read_b64_tr_b16 v[228:229], v78 offset:16416
ds_read_b64_tr_b16 v[252:253], v78 offset:16448
ds_read_b64_tr_b16 a[230:231], v78 offset:28672
s_barrier
ds_read_b64_tr_b16 a[254:255], v78 offset:28704
ds_read_b64_tr_b16 v[246:247], v78 offset:28736
s_waitcnt vmcnt(6)
ds_read_b64_tr_b16 a[238:239], v78 offset:30208
ds_read_b64_tr_b16 v[230:231], v78 offset:30240
ds_read_b64_tr_b16 v[254:255], v78 offset:30272
s_waitcnt lgkmcnt(12)
s_add_u32 m0, s55, 78080
s_add_u32 s29, s54, 74496
buffer_load_dwordx4 v72, s[12:15], s29 offen lds
s_add_u32 m0, s55, 79104
s_add_u32 s29, s54, 74496
buffer_load_dwordx4 v73, s[12:15], s29 offen lds
s_add_u32 m0, s55, 80128
s_add_u32 s29, s54, 74496
buffer_load_dwordx4 v74, s[12:15], s29 offen lds
ds_read_b128 v[84:87], v200
s_waitcnt lgkmcnt(7)
s_add_u32 m0, s55, 94464
s_add_u32 s29, s54, 111360
buffer_load_dwordx4 v72, s[12:15], s29 offen lds
s_waitcnt vmcnt(8)
ds_read_b64_tr_b16 a[72:73], v78 offset:40960
ds_read_b64_tr_b16 a[96:97], v78 offset:40992
ds_read_b64_tr_b16 a[120:121], v78 offset:41024
ds_read_b128 v[92:95], v201
ds_read_b128 v[100:103], v202
ds_read_b128 v[88:91], v194 offset:16
ds_read_b128 v[96:99], v195 offset:16
ds_read_b128 v[104:107], v196 offset:16
s_add_u32 m0, s55, 95488
s_add_u32 s29, s54, 111360
buffer_load_dwordx4 v73, s[12:15], s29 offen lds
s_waitcnt lgkmcnt(8)
v_mfma_f32_16x16x32_bf16 v[0:3], v[174:177], v[84:87], 0
s_waitcnt vmcnt(8)
ds_read_b64_tr_b16 a[74:75], v78 offset:42496
ds_read_b64_tr_b16 a[98:99], v78 offset:42528
ds_read_b64_tr_b16 a[122:123], v78 offset:42560
ds_read_b128 v[84:87], v194
ds_read_b128 v[182:185], v210 offset:18432
s_waitcnt lgkmcnt(9)
v_mfma_f32_16x16x32_bf16 v[12:15], v[174:177], v[92:95], 0
ds_read_b128 v[92:95], v195
s_waitcnt lgkmcnt(9)
v_mfma_f32_16x16x32_bf16 v[24:27], v[174:177], v[100:103], 0
s_add_u32 m0, s55, 96512
s_add_u32 s29, s54, 111360
buffer_load_dwordx4 v74, s[12:15], s29 offen lds
ds_read_b128 v[100:103], v196
ds_read_b128 v[174:177], v217 offset:1056
ds_read_b128 v[186:189], v210 offset:24576
s_add_u32 m0, s55, 106752
s_add_u32 s29, s54, 148224
buffer_load_dwordx4 v72, s[12:15], s29 offen lds
s_waitcnt vmcnt(8) lgkmcnt(5)
ds_read_b64_tr_b16 a[88:89], v78 offset:53248
ds_read_b64_tr_b16 a[112:113], v78 offset:53280
v_smfmac_f32_16x16x64_bf16 v[0:3], v[178:181], v[84:91], v213
s_waitcnt lgkmcnt(6)
ds_read_b64_tr_b16 a[136:137], v78 offset:53312
ds_read_b128 v[84:87], v197
v_mfma_f32_16x16x32_bf16 v[138:141], a[0:3], v[182:185], 0
ds_read_b128 v[88:91], v197 offset:16
s_waitcnt lgkmcnt(8)
v_smfmac_f32_16x16x64_bf16 v[12:15], v[178:181], v[92:99], v213
s_waitcnt lgkmcnt(7)
s_add_u32 m0, s55, 107776
s_add_u32 s29, s54, 148224
buffer_load_dwordx4 v73, s[12:15], s29 offen lds
v_smfmac_f32_16x16x64_bf16 v[24:27], v[178:181], v[100:107], v213
s_waitcnt vmcnt(8)
ds_read_b64_tr_b16 a[76:77], v78 offset:54784
ds_read_b64_tr_b16 a[100:101], v78 offset:54816
v_mfma_f32_16x16x32_bf16 v[142:145], a[24:27], v[182:185], 0
ds_read_b64_tr_b16 a[124:125], v78 offset:54848
ds_read_b128 v[92:95], v198
v_mfma_f32_16x16x32_bf16 v[146:149], a[48:51], v[182:185], 0
s_waitcnt lgkmcnt(9)
ds_read_b128 v[96:99], v198 offset:16
ds_read_b128 v[100:103], v199
v_mfma_f32_16x16x32_bf16 v[150:153], a[0:3], v[186:189], 0
s_add_u32 m0, s55, 108800
s_add_u32 s29, s54, 148224
buffer_load_dwordx4 v74, s[12:15], s29 offen lds
v_mfma_f32_16x16x32_bf16 v[154:157], a[24:27], v[186:189], 0
s_waitcnt lgkmcnt(6)
ds_read_b128 v[104:107], v199 offset:16
ds_read_b128 v[178:181], v217 offset:1584
v_smfmac_f32_16x16x64_bf16 v[0:3], v[174:177], v[84:91], v213
ds_read_b128 v[84:87], v200 offset:32
ds_read_b128 v[88:91], v194 offset:48
v_mfma_f32_16x16x32_bf16 v[158:161], a[48:51], v[186:189], 0
ds_read_b128 v[182:185], v210 offset:19456
ds_read_b128 v[186:189], v210 offset:25600
s_add_u32 m0, s55, 119040
s_add_u32 s29, s54, 185088
buffer_load_dwordx4 v72, s[12:15], s29 offen lds
s_waitcnt lgkmcnt(7)
v_smfmac_f32_16x16x64_bf16 v[12:15], v[174:177], v[92:99], v213
ds_read_b128 v[92:95], v201 offset:32
ds_read_b128 v[96:99], v195 offset:48
v_add_f32 v118, v0, v1
v_mul_f32 v119, v0, v0
v_add_f32 v118, v118, v2
s_waitcnt lgkmcnt(7)
v_smfmac_f32_16x16x64_bf16 v[24:27], v[174:177], v[100:107], v213
ds_read_b128 v[100:103], v202 offset:32
ds_read_b128 v[174:177], v217 offset:2112
ds_read_b128 v[104:107], v196 offset:48
s_add_u32 m0, s55, 120064
s_add_u32 s29, s54, 185088
buffer_load_dwordx4 v73, s[12:15], s29 offen lds
s_waitcnt lgkmcnt(8)
v_mfma_f32_16x16x32_bf16 v[4:7], v[178:181], v[84:87], 0
s_waitcnt lgkmcnt(6)
ds_read_b128 v[84:87], v194 offset:32
v_fmac_f32 v119, v1, v1
v_mfma_f32_16x16x32_bf16 v[138:141], a[4:7], v[182:185], v[138:141]
v_add_f32 v118, v118, v3
v_fmac_f32 v119, v2, v2
v_mfma_f32_16x16x32_bf16 v[142:145], a[28:31], v[182:185], v[142:145]
s_waitcnt lgkmcnt(5)
v_fmac_f32 v119, v3, v3
v_add_f32 v126, v12, v13
v_mfma_f32_16x16x32_bf16 v[16:19], v[178:181], v[92:95], 0
s_add_u32 m0, s55, 121088
s_add_u32 s29, s54, 185088
buffer_load_dwordx4 v74, s[12:15], s29 offen lds
v_mfma_f32_16x16x32_bf16 v[146:149], a[52:55], v[182:185], v[146:149]
s_waitcnt vmcnt(10) lgkmcnt(3)
ds_read_b64_tr_b16 a[78:79], v78
ds_read_b64_tr_b16 a[102:103], v78 offset:32
v_mfma_f32_16x16x32_bf16 v[28:31], v[178:181], v[100:103], 0
ds_read_b64_tr_b16 a[126:127], v78 offset:64
ds_read_b128 v[92:95], v195 offset:32
v_mfma_f32_16x16x32_bf16 v[150:153], a[4:7], v[186:189], v[150:153]
ds_read_b128 v[100:103], v196 offset:32
ds_read_b128 v[178:181], v217 offset:2640
v_mfma_f32_16x16x32_bf16 v[154:157], a[28:31], v[186:189], v[154:157]
s_waitcnt vmcnt(9) lgkmcnt(6)
ds_read_b64_tr_b16 a[90:91], v78 offset:1536
ds_read_b64_tr_b16 a[114:115], v78 offset:1568
v_smfmac_f32_16x16x64_bf16 v[4:7], v[174:177], v[84:91], v213
ds_read_b64_tr_b16 a[138:139], v78 offset:1600
s_add_u32 m0, s55, 131328
s_add_u32 s29, s54, 0
buffer_load_dwordx4 v75, s[16:19], s29 offen lds
v_mfma_f32_16x16x32_bf16 v[158:161], a[52:55], v[186:189], v[158:161]
ds_read_b128 v[84:87], v197 offset:32
ds_read_b128 v[88:91], v197 offset:48
ds_read_b128 v[182:185], v210 offset:20480
ds_read_b128 v[186:189], v210 offset:26624
v_mul_f32 v127, v12, v12
v_add_f32 v126, v126, v14
v_fmac_f32 v127, v13, v13
s_waitcnt lgkmcnt(9)
v_smfmac_f32_16x16x64_bf16 v[16:19], v[174:177], v[92:99], v213
s_waitcnt lgkmcnt(8)
s_add_u32 m0, s55, 132352
s_add_u32 s29, s54, 0
buffer_load_dwordx4 v76, s[16:19], s29 offen lds
v_smfmac_f32_16x16x64_bf16 v[28:31], v[174:177], v[100:107], v213
ds_read_b128 v[92:95], v198 offset:32
ds_read_b128 v[96:99], v198 offset:48
ds_read_b128 v[100:103], v199 offset:32
ds_read_b128 v[104:107], v199 offset:48
v_add_f32 v126, v126, v15
v_fmac_f32 v127, v14, v14
s_waitcnt vmcnt(9)
s_add_u32 m0, s55, 133376
s_add_u32 s29, s54, 0
buffer_load_dwordx4 v77, s[16:19], s29 offen lds
ds_read_b64_tr_b16 a[80:81], v78 offset:16384
s_waitcnt lgkmcnt(7)
v_smfmac_f32_16x16x64_bf16 v[4:7], v[178:181], v[84:91], v213
s_waitcnt lgkmcnt(6)
ds_read_b64_tr_b16 a[104:105], v78 offset:16416
ds_read_b64_tr_b16 a[128:129], v78 offset:16448
v_mfma_f32_16x16x32_bf16 v[138:141], a[8:11], v[182:185], v[138:141]
ds_read_b128 v[174:177], v217 offset:3168
ds_read_b128 v[84:87], v200 offset:64
v_mfma_f32_16x16x32_bf16 v[142:145], a[32:35], v[182:185], v[142:145]
s_waitcnt vmcnt(9)
ds_read_b64_tr_b16 a[82:83], v78 offset:17920
ds_read_b64_tr_b16 a[106:107], v78 offset:17952
v_mfma_f32_16x16x32_bf16 v[146:149], a[56:59], v[182:185], v[146:149]
s_waitcnt lgkmcnt(9)
ds_read_b64_tr_b16 a[130:131], v78 offset:17984
s_add_u32 m0, s55, 78080
s_add_u32 s29, s54, 12288
buffer_load_dwordx4 v75, s[16:19], s29 offen lds
v_smfmac_f32_16x16x64_bf16 v[16:19], v[178:181], v[92:99], v213
s_waitcnt lgkmcnt(8)
ds_read_b128 v[92:95], v201 offset:64
ds_read_b128 v[88:91], v194 offset:80
v_smfmac_f32_16x16x64_bf16 v[28:31], v[178:181], v[100:107], v213
ds_read_b128 v[100:103], v202 offset:64
ds_read_b128 v[178:181], v217 offset:3696
v_mfma_f32_16x16x32_bf16 v[150:153], a[8:11], v[186:189], v[150:153]
s_add_u32 m0, s55, 79104
s_add_u32 s29, s54, 12288
buffer_load_dwordx4 v76, s[16:19], s29 offen lds
v_mfma_f32_16x16x32_bf16 v[154:157], a[32:35], v[186:189], v[154:157]
s_waitcnt lgkmcnt(7)
ds_read_b128 v[96:99], v195 offset:80
ds_read_b128 v[104:107], v196 offset:80
v_mfma_f32_16x16x32_bf16 v[8:11], v[174:177], v[84:87], 0
ds_read_b128 v[84:87], v194 offset:64
ds_read_b128 v[182:185], v210 offset:21504
v_mfma_f32_16x16x32_bf16 v[158:161], a[56:59], v[186:189], v[158:161]
s_waitcnt lgkmcnt(7)
ds_read_b128 v[186:189], v210 offset:27648
v_fmac_f32 v127, v15, v15
v_mfma_f32_16x16x32_bf16 v[20:23], v[174:177], v[92:95], 0
s_waitcnt vmcnt(9)
s_add_u32 m0, s55, 80128
s_add_u32 s29, s54, 12288
buffer_load_dwordx4 v77, s[16:19], s29 offen lds
ds_read_b64_tr_b16 a[92:93], v78 offset:28672
ds_read_b64_tr_b16 a[116:117], v78 offset:28704
ds_read_b64_tr_b16 a[140:141], v78 offset:28736
s_waitcnt lgkmcnt(9)
v_mfma_f32_16x16x32_bf16 v[32:35], v[174:177], v[100:103], 0
ds_read_b128 v[92:95], v195 offset:64
ds_read_b128 v[100:103], v196 offset:64
v_add_f32 v134, v24, v25
v_mul_f32 v135, v24, v24
v_add_f32 v134, v134, v26
v_fmac_f32 v135, v25, v25
s_waitcnt vmcnt(9)
s_add_u32 m0, s55, 94464
s_add_u32 s29, s54, 24576
buffer_load_dwordx4 v75, s[16:19], s29 offen lds
ds_read_b64_tr_b16 a[84:85], v78 offset:30208
s_waitcnt lgkmcnt(8)
v_smfmac_f32_16x16x64_bf16 v[8:11], v[178:181], v[84:91], v213
s_waitcnt lgkmcnt(7)
ds_read_b64_tr_b16 a[108:109], v78 offset:30240
ds_read_b64_tr_b16 a[132:133], v78 offset:30272
v_mfma_f32_16x16x32_bf16 v[138:141], a[12:15], v[182:185], v[138:141]
ds_read_b128 v[174:177], v217 offset:4224
ds_read_b128 v[84:87], v197 offset:64
v_mfma_f32_16x16x32_bf16 v[142:145], a[36:39], v[182:185], v[142:145]
ds_read_b128 v[88:91], v197 offset:80
s_add_u32 m0, s55, 95488
s_add_u32 s29, s54, 24576
buffer_load_dwordx4 v76, s[16:19], s29 offen lds
v_mfma_f32_16x16x32_bf16 v[146:149], a[60:63], v[182:185], v[146:149]
s_waitcnt lgkmcnt(7)
ds_read_b128 v[182:185], v210 offset:22528
v_add_f32 v134, v134, v27
v_smfmac_f32_16x16x64_bf16 v[20:23], v[178:181], v[92:99], v213
s_waitcnt lgkmcnt(7)
ds_read_b128 v[92:95], v198 offset:64
ds_read_b128 v[96:99], v198 offset:80
v_smfmac_f32_16x16x64_bf16 v[32:35], v[178:181], v[100:107], v213
ds_read_b128 v[100:103], v199 offset:64
ds_read_b128 v[104:107], v199 offset:80
v_mfma_f32_16x16x32_bf16 v[150:153], a[12:15], v[186:189], v[150:153]
s_add_u32 m0, s55, 96512
s_add_u32 s29, s54, 24576
buffer_load_dwordx4 v77, s[16:19], s29 offen lds
v_mfma_f32_16x16x32_bf16 v[154:157], a[36:39], v[186:189], v[154:157]
s_waitcnt vmcnt(10) lgkmcnt(5)
ds_read_b64_tr_b16 a[86:87], v78 offset:40960
ds_read_b64_tr_b16 a[110:111], v78 offset:40992
v_smfmac_f32_16x16x64_bf16 v[8:11], v[174:177], v[84:91], v213
ds_read_b64_tr_b16 a[134:135], v78 offset:41024
v_fmac_f32 v135, v26, v26
v_mfma_f32_16x16x32_bf16 v[158:161], a[60:63], v[186:189], v[158:161]
s_waitcnt lgkmcnt(7)
ds_read_b128 v[186:189], v210 offset:28672
v_fmac_f32 v135, v27, v27
v_mfma_f32_16x16x32_bf16 v[138:141], a[16:19], v[182:185], v[138:141]
s_waitcnt vmcnt(9) lgkmcnt(6)
ds_read_b64_tr_b16 a[94:95], v78 offset:42496
ds_read_b64_tr_b16 a[118:119], v78 offset:42528
v_smfmac_f32_16x16x64_bf16 v[20:23], v[174:177], v[92:99], v213
ds_read_b64_tr_b16 a[142:143], v78 offset:42560
s_add_u32 m0, s55, 106752
s_add_u32 s29, s54, 36864
buffer_load_dwordx4 v75, s[16:19], s29 offen lds
v_mfma_f32_16x16x32_bf16 v[142:145], a[40:43], v[182:185], v[142:145]
s_waitcnt lgkmcnt(7)
v_add_f32 v118, v118, v4
v_fmac_f32 v119, v4, v4
v_smfmac_f32_16x16x64_bf16 v[32:35], v[174:177], v[100:107], v213
v_add_f32 v118, v118, v5
v_fmac_f32 v119, v5, v5
v_mfma_f32_16x16x32_bf16 v[146:149], a[64:67], v[182:185], v[146:149]
s_waitcnt lgkmcnt(3)
s_add_u32 m0, s55, 107776
s_add_u32 s29, s54, 36864
buffer_load_dwordx4 v76, s[16:19], s29 offen lds
v_mfma_f32_16x16x32_bf16 v[150:153], a[16:19], v[186:189], v[150:153]
ds_read_b128 v[182:185], v210 offset:23552
v_add_f32 v118, v118, v6
v_mfma_f32_16x16x32_bf16 v[154:157], a[40:43], v[186:189], v[154:157]
v_fmac_f32 v119, v6, v6
v_add_f32 v118, v118, v7
v_mfma_f32_16x16x32_bf16 v[158:161], a[64:67], v[186:189], v[158:161]
ds_read_b128 v[186:189], v210 offset:29696
s_waitcnt vmcnt(9)
s_add_u32 m0, s55, 108800
s_add_u32 s29, s54, 36864
buffer_load_dwordx4 v77, s[16:19], s29 offen lds
ds_read_b64_tr_b16 a[144:145], v78 offset:53248
ds_read_b64_tr_b16 a[168:169], v78 offset:53280
ds_read_b64_tr_b16 a[192:193], v78 offset:53312
v_fmac_f32 v119, v7, v7
v_add_f32 v126, v126, v16
v_fmac_f32 v127, v16, v16
v_add_f32 v126, v126, v17
v_fmac_f32 v127, v17, v17
s_waitcnt lgkmcnt(4)
v_mfma_f32_16x16x32_bf16 v[138:141], a[20:23], v[182:185], v[138:141]
v_add_f32 v126, v126, v18
v_fmac_f32 v127, v18, v18
v_mfma_f32_16x16x32_bf16 v[142:145], a[44:47], v[182:185], v[142:145]
s_waitcnt vmcnt(9)
ds_read_b64_tr_b16 a[146:147], v78 offset:54784
ds_read_b64_tr_b16 a[170:171], v78 offset:54816
v_mfma_f32_16x16x32_bf16 v[146:149], a[68:71], v[182:185], v[146:149]
s_waitcnt lgkmcnt(5)
ds_read_b64_tr_b16 a[194:195], v78 offset:54848
s_add_u32 m0, s55, 119040
s_add_u32 s29, s54, 49152
buffer_load_dwordx4 v75, s[16:19], s29 offen lds
v_mfma_f32_16x16x32_bf16 v[150:153], a[20:23], v[186:189], v[150:153]
ds_read_b128 v[182:185], v210 offset:18432
v_add_f32 v126, v126, v19
v_mfma_f32_16x16x32_bf16 v[154:157], a[44:47], v[186:189], v[154:157]
v_fmac_f32 v127, v19, v19
v_add_f32 v134, v134, v28
v_mfma_f32_16x16x32_bf16 v[158:161], a[68:71], v[186:189], v[158:161]
s_add_u32 m0, s55, 120064
s_add_u32 s29, s54, 49152
buffer_load_dwordx4 v76, s[16:19], s29 offen lds
ds_read_b128 v[186:189], v210 offset:24576
v_fmac_f32 v135, v28, v28
v_add_f32 v134, v134, v29
v_fmac_f32 v135, v29, v29
v_add_f32 v134, v134, v30
v_fmac_f32 v135, v30, v30
v_add_f32 v134, v134, v31
v_fmac_f32 v135, v31, v31
v_add_f32 v118, v118, v8
s_waitcnt vmcnt(9)
s_add_u32 m0, s55, 121088
s_add_u32 s29, s54, 49152
buffer_load_dwordx4 v77, s[16:19], s29 offen lds
ds_read_b64_tr_b16 a[160:161], v78
ds_read_b64_tr_b16 a[184:185], v78 offset:32
ds_read_b64_tr_b16 a[208:209], v78 offset:64
v_fmac_f32 v119, v8, v8
v_add_f32 v118, v118, v9
v_fmac_f32 v119, v9, v9
v_add_f32 v118, v118, v10
v_fmac_f32 v119, v10, v10
v_add_f32 v118, v118, v11
v_fmac_f32 v119, v11, v11
v_add_f32 v126, v126, v20
s_waitcnt vmcnt(9) lgkmcnt(5)
s_add_u32 m0, s55, 131328
s_add_u32 s29, s54, 61440
buffer_load_dwordx4 v75, s[16:19], s29 offen lds
ds_read_b64_tr_b16 a[148:149], v78 offset:1536
ds_read_b64_tr_b16 a[172:173], v78 offset:1568
ds_read_b64_tr_b16 a[196:197], v78 offset:1600
v_fmac_f32 v127, v20, v20
v_add_f32 v126, v126, v21
v_fmac_f32 v127, v21, v21
v_add_f32 v126, v126, v22
v_fmac_f32 v127, v22, v22
v_add_f32 v126, v126, v23
v_fmac_f32 v127, v23, v23
v_add_f32 v134, v134, v32
s_add_u32 m0, s55, 132352
s_add_u32 s29, s54, 61440
buffer_load_dwordx4 v76, s[16:19], s29 offen lds
v_fmac_f32 v135, v32, v32
v_add_f32 v134, v134, v33
v_fmac_f32 v135, v33, v33
v_add_f32 v134, v134, v34
v_fmac_f32 v135, v34, v34
v_add_f32 v134, v134, v35
v_permlane16_swap_b32 v118, v119
v_fmac_f32 v135, v35, v35
v_add_f32 v118, v118, v119
v_permlane16_swap_b32 v126, v127
s_waitcnt vmcnt(9)
s_add_u32 m0, s55, 133376
s_add_u32 s29, s54, 61440
buffer_load_dwordx4 v77, s[16:19], s29 offen lds
ds_read_b64_tr_b16 a[150:151], v78 offset:16384
ds_read_b64_tr_b16 a[174:175], v78 offset:16416
ds_read_b64_tr_b16 a[198:199], v78 offset:16448
v_add_f32 v126, v126, v127
v_permlane16_swap_b32 v134, v135
v_add_f32 v134, v134, v135
v_permlane32_swap_b32 v118, v126
v_add_f32 v118, v118, v126
v_mov_b32 v135, v134
v_and_b32 v180, s44, v208
ds_write_b32 v209, v118
s_waitcnt vmcnt(9) lgkmcnt(11)
ds_read_b64_tr_b16 a[162:163], v78 offset:17920
v_permlane32_swap_b32 v134, v135
v_add_f32 v134, v134, v135
v_cvt_pk_bf16_f32 v48, v138, v139
v_cvt_pk_bf16_f32 v49, v140, v141
v_mfma_f32_16x16x32_bf16 v[138:141], a[216:219], v[182:185], 0
ds_read_b64_tr_b16 a[186:187], v78 offset:17952
ds_read_b64_tr_b16 a[210:211], v78 offset:17984
ds_write_b32 v209, v134 offset:512
v_cvt_pk_bf16_f32 v50, v142, v143
v_cvt_pk_bf16_f32 v51, v144, v145
v_mfma_f32_16x16x32_bf16 v[142:145], a[240:243], v[182:185], 0
v_cvt_pk_bf16_f32 v52, v146, v147
v_cvt_pk_bf16_f32 v53, v148, v149
v_mfma_f32_16x16x32_bf16 v[146:149], v[232:235], v[182:185], 0
s_waitcnt lgkmcnt(14)
ds_read_b128 v[182:185], v210 offset:19456
v_cvt_pk_bf16_f32 v54, v150, v151
v_cvt_pk_bf16_f32 v55, v152, v153
v_mfma_f32_16x16x32_bf16 v[150:153], a[216:219], v[186:189], 0
v_cvt_pk_bf16_f32 v56, v154, v155
v_cvt_pk_bf16_f32 v57, v156, v157
v_mfma_f32_16x16x32_bf16 v[154:157], a[240:243], v[186:189], 0
s_waitcnt vmcnt(7)
ds_read_b64_tr_b16 a[152:153], v78 offset:28672
ds_read_b64_tr_b16 a[176:177], v78 offset:28704
ds_read_b64_tr_b16 a[200:201], v78 offset:28736
v_cvt_pk_bf16_f32 v58, v158, v159
v_cvt_pk_bf16_f32 v59, v160, v161
v_mfma_f32_16x16x32_bf16 v[158:161], v[232:235], v[186:189], 0
s_waitcnt lgkmcnt(4)
ds_read_b128 v[186:189], v210 offset:25600
s_barrier
ds_read_b128 v[102:105], v210 offset:55296
ds_read_b128 v[106:109], v210 offset:56320
s_add_u32 m0, s45, 0
s_nop 0
buffer_load_dwordx4 v180, s[4:7], s40 offen nt lds
s_waitcnt lgkmcnt(6)
v_mfma_f32_16x16x32_bf16 v[138:141], a[220:223], v[182:185], v[138:141]
s_waitcnt vmcnt(7)
ds_read_b64_tr_b16 a[154:155], v78 offset:30208
ds_read_b64_tr_b16 a[178:179], v78 offset:30240
v_mfma_f32_16x16x32_bf16 v[142:145], a[244:247], v[182:185], v[142:145]
ds_read_b64_tr_b16 a[202:203], v78 offset:30272
s_add_u32 m0, s45, 4112
s_add_u32 s40, s37, 196224
buffer_load_dwordx4 v180, s[4:7], s40 offen nt lds
v_mfma_f32_16x16x32_bf16 v[146:149], v[236:239], v[182:185], v[146:149]
s_waitcnt lgkmcnt(5)
s_add_u32 m0, s45, 8224
s_add_u32 s40, s37, 392448
buffer_load_dwordx4 v180, s[4:7], s40 offen nt lds
v_mfma_f32_16x16x32_bf16 v[150:153], a[220:223], v[186:189], v[150:153]
s_add_u32 m0, s45, 12336
s_add_u32 s40, s37, 588672
buffer_load_dwordx4 v180, s[4:7], s40 offen nt lds
v_mfma_f32_16x16x32_bf16 v[154:157], a[244:247], v[186:189], v[154:157]
s_add_u32 m0, s45, 16448
s_add_u32 s40, s37, 784896
buffer_load_dwordx4 v180, s[4:7], s40 offen nt lds
v_mfma_f32_16x16x32_bf16 v[158:161], v[236:239], v[186:189], v[158:161]
s_add_u32 m0, s45, 20560
s_add_u32 s40, s37, 981120
buffer_load_dwordx4 v180, s[4:7], s40 offen nt lds
s_add_u32 m0, s45, 24672
s_add_u32 s40, s37, 1177344
buffer_load_dwordx4 v180, s[4:7], s40 offen nt lds
s_waitcnt vmcnt(11) lgkmcnt(3)
ds_read_b64_tr_b16 a[164:165], v78 offset:40960
ds_read_b64_tr_b16 a[188:189], v78 offset:40992
ds_read_b64_tr_b16 a[212:213], v78 offset:41024
s_add_u32 m0, s45, 28784
s_add_u32 s40, s37, 1373568
buffer_load_dwordx4 v180, s[4:7], s40 offen nt lds
ds_read_b128 v[182:185], v210 offset:20480
ds_read_b128 v[186:189], v210 offset:26624
v_add_f32 v102, v102, v103
v_add_f32 v106, v106, v107
v_add_f32 v104, v104, v105
v_add_f32 v108, v108, v109
v_add_f32 v102, v102, v104
s_waitcnt vmcnt(11)
ds_read_b64_tr_b16 a[156:157], v78 offset:42496
ds_read_b64_tr_b16 a[180:181], v78 offset:42528
ds_read_b64_tr_b16 a[204:205], v78 offset:42560
s_add_u32 m0, s45, 32896
s_add_u32 s40, s37, 1569792
buffer_load_dwordx4 v180, s[4:7], s40 offen nt lds
v_add_f32 v106, v106, v108
v_mul_f32 v103, s48, v102
v_mul_f32 v104, s73, v102
v_mul_f32 v106, s73, v106
v_fma_f32 v106, -v103, v104, v106
v_max_f32 v106, 0, v106
v_add_f32 v106, s49, v106
v_rsq_f32 v102, v106
s_waitcnt lgkmcnt(4)
v_mfma_f32_16x16x32_bf16 v[138:141], a[224:227], v[182:185], v[138:141]
v_mul_f32_e64 v103, -v103, v102
v_mfma_f32_16x16x32_bf16 v[142:145], a[248:251], v[182:185], v[142:145]
ds_write_b64 v211, v[102:103] offset:36864
v_mfma_f32_16x16x32_bf16 v[146:149], v[240:243], v[182:185], v[146:149]
s_waitcnt lgkmcnt(4)
v_mfma_f32_16x16x32_bf16 v[150:153], a[224:227], v[186:189], v[150:153]
ds_read_b64 v[118:119], v219
ds_read_b64 v[126:127], v219 offset:256
v_mfma_f32_16x16x32_bf16 v[154:157], a[248:251], v[186:189], v[154:157]
s_waitcnt vmcnt(10)
ds_read_b64_tr_b16 a[158:159], v78 offset:53248
ds_read_b64_tr_b16 a[182:183], v78 offset:53280
v_mfma_f32_16x16x32_bf16 v[158:161], v[240:243], v[186:189], v[158:161]
ds_read_b64_tr_b16 a[206:207], v78 offset:53312
ds_read_b64 v[134:135], v219 offset:512
ds_read_b128 v[182:185], v210 offset:21504
ds_read_b128 v[186:189], v210 offset:27648
s_waitcnt vmcnt(9) lgkmcnt(7)
ds_read_b64_tr_b16 a[166:167], v78 offset:54784
ds_read_b64_tr_b16 a[190:191], v78 offset:54816
ds_read_b64_tr_b16 a[214:215], v78 offset:54848
v_fma_f32 v220, v0, v118, v119
v_fma_f32 v221, v1, v118, v119
v_cvt_pk_bf16_f32 v90, v220, v221
v_fma_f32 v222, v2, v118, v119
v_fma_f32 v223, v3, v118, v119
v_cvt_pk_bf16_f32 v91, v222, v223
v_fma_f32 v220, v4, v118, v119
v_fma_f32 v221, v5, v118, v119
v_cvt_pk_bf16_f32 v92, v220, v221
v_fma_f32 v222, v6, v118, v119
v_fma_f32 v223, v7, v118, v119
v_cvt_pk_bf16_f32 v93, v222, v223
v_fma_f32 v220, v8, v118, v119
v_fma_f32 v221, v9, v118, v119
s_waitcnt lgkmcnt(4)
v_mfma_f32_16x16x32_bf16 v[138:141], a[228:231], v[182:185], v[138:141]
ds_write_b128 v211, v[90:93]
v_mfma_f32_16x16x32_bf16 v[142:145], a[252:255], v[182:185], v[142:145]
v_cvt_pk_bf16_f32 v94, v220, v221
v_fma_f32 v222, v10, v118, v119
v_mfma_f32_16x16x32_bf16 v[146:149], v[244:247], v[182:185], v[146:149]
s_waitcnt lgkmcnt(4)
v_fma_f32 v223, v11, v118, v119
v_cvt_pk_bf16_f32 v95, v222, v223
v_mfma_f32_16x16x32_bf16 v[150:153], a[228:231], v[186:189], v[150:153]
ds_write_b64 v212, v[94:95]
v_mfma_f32_16x16x32_bf16 v[154:157], a[252:255], v[186:189], v[154:157]
v_fma_f32 v220, v12, v126, v127
v_fma_f32 v221, v13, v126, v127
v_mfma_f32_16x16x32_bf16 v[158:161], v[244:247], v[186:189], v[158:161]
ds_read_b128 v[182:185], v210 offset:22528
ds_read_b128 v[186:189], v210 offset:28672
v_cvt_pk_bf16_f32 v174, v220, v221
v_fma_f32 v222, v14, v126, v127
v_fma_f32 v223, v15, v126, v127
v_cvt_pk_bf16_f32 v175, v222, v223
v_fma_f32 v220, v16, v126, v127
v_fma_f32 v221, v17, v126, v127
v_cvt_pk_bf16_f32 v176, v220, v221
v_fma_f32 v222, v18, v126, v127
v_fma_f32 v223, v19, v126, v127
v_cvt_pk_bf16_f32 v177, v222, v223
v_fma_f32 v220, v20, v126, v127
v_fma_f32 v221, v21, v126, v127
v_cvt_pk_bf16_f32 v178, v220, v221
v_fma_f32 v222, v22, v126, v127
v_fma_f32 v223, v23, v126, v127
v_cvt_pk_bf16_f32 v179, v222, v223
v_fma_f32 v220, v24, v134, v135
v_fma_f32 v221, v25, v134, v135
v_cvt_pk_bf16_f32 v90, v220, v221
v_fma_f32 v222, v26, v134, v135
v_fma_f32 v223, v27, v134, v135
v_cvt_pk_bf16_f32 v91, v222, v223
s_waitcnt lgkmcnt(1)
v_mfma_f32_16x16x32_bf16 v[138:141], a[232:235], v[182:185], v[138:141]
ds_write_b128 v211, v[174:177] offset:6144
v_mfma_f32_16x16x32_bf16 v[142:145], v[224:227], v[182:185], v[142:145]
v_fma_f32 v220, v28, v134, v135
v_fma_f32 v221, v29, v134, v135
v_mfma_f32_16x16x32_bf16 v[146:149], v[248:251], v[182:185], v[146:149]
s_waitcnt lgkmcnt(1)
v_cvt_pk_bf16_f32 v92, v220, v221
v_fma_f32 v222, v30, v134, v135
v_mfma_f32_16x16x32_bf16 v[150:153], a[232:235], v[186:189], v[150:153]
ds_write_b64 v212, v[178:179] offset:6144
v_mfma_f32_16x16x32_bf16 v[154:157], v[224:227], v[186:189], v[154:157]
v_fma_f32 v223, v31, v134, v135
v_cvt_pk_bf16_f32 v93, v222, v223
v_mfma_f32_16x16x32_bf16 v[158:161], v[248:251], v[186:189], v[158:161]
ds_write_b128 v211, v[90:93] offset:12288
v_fma_f32 v220, v32, v134, v135
v_fma_f32 v221, v33, v134, v135
v_cvt_pk_bf16_f32 v94, v220, v221
v_fma_f32 v222, v34, v134, v135
v_fma_f32 v223, v35, v134, v135
v_cvt_pk_bf16_f32 v95, v222, v223
ds_write_b64 v212, v[94:95] offset:12288
ds_read_b128 v[182:185], v210 offset:23552
ds_read_b128 v[186:189], v210 offset:29696
s_waitcnt lgkmcnt(2)
s_barrier
ds_write_b128 v82, v[48:51] offset:512
s_waitcnt lgkmcnt(2)
v_mfma_f32_16x16x32_bf16 v[138:141], a[236:239], v[182:185], v[138:141]
v_mfma_f32_16x16x32_bf16 v[142:145], v[228:231], v[182:185], v[142:145]
ds_write_b64 v82, v[52:53] offset:528
v_mfma_f32_16x16x32_bf16 v[146:149], v[252:255], v[182:185], v[146:149]
s_waitcnt lgkmcnt(2)
v_cvt_pk_bf16_f32 v36, v138, v139
v_cvt_pk_bf16_f32 v37, v140, v141
v_mfma_f32_16x16x32_bf16 v[150:153], a[236:239], v[186:189], v[150:153]
ds_read_b128 v[182:185], v210 offset:18432
ds_write_b128 v82, v[54:57] offset:23040
v_mfma_f32_16x16x32_bf16 v[154:157], v[228:231], v[186:189], v[154:157]
v_cvt_pk_bf16_f32 v38, v142, v143
v_cvt_pk_bf16_f32 v39, v144, v145
v_mfma_f32_16x16x32_bf16 v[158:161], v[252:255], v[186:189], v[158:161]
v_cvt_pk_bf16_f32 v40, v146, v147
v_cvt_pk_bf16_f32 v41, v148, v149
v_cvt_pk_bf16_f32 v42, v150, v151
v_cvt_pk_bf16_f32 v43, v152, v153
v_cvt_pk_bf16_f32 v44, v154, v155
v_cvt_pk_bf16_f32 v45, v156, v157
s_nop 0
v_cvt_pk_bf16_f32 v46, v158, v159
v_cvt_pk_bf16_f32 v47, v160, v161
s_waitcnt lgkmcnt(1)
v_mfma_f32_16x16x32_bf16 v[138:141], a[72:75], v[182:185], 0
ds_read_b128 v[186:189], v210 offset:24576
ds_write_b128 v82, v[36:39]
v_mfma_f32_16x16x32_bf16 v[142:145], a[96:99], v[182:185], 0
v_mfma_f32_16x16x32_bf16 v[146:149], a[120:123], v[182:185], 0
ds_read_b128 v[182:185], v210 offset:19456
ds_write_b64 v82, v[40:41] offset:16
s_waitcnt lgkmcnt(3)
v_mfma_f32_16x16x32_bf16 v[150:153], a[72:75], v[186:189], 0
ds_write_b128 v82, v[42:45] offset:22528
v_mfma_f32_16x16x32_bf16 v[154:157], a[96:99], v[186:189], 0
v_mfma_f32_16x16x32_bf16 v[158:161], a[120:123], v[186:189], 0
ds_read_b128 v[186:189], v210 offset:25600
ds_write_b64 v82, v[46:47] offset:22544
s_waitcnt lgkmcnt(4)
v_mfma_f32_16x16x32_bf16 v[138:141], a[76:79], v[182:185], v[138:141]
ds_write_b64 v82, v[58:59] offset:23056
v_mfma_f32_16x16x32_bf16 v[142:145], a[100:103], v[182:185], v[142:145]
v_mfma_f32_16x16x32_bf16 v[146:149], a[124:127], v[182:185], v[146:149]
ds_read_b128 v[182:185], v210 offset:20480
s_waitcnt lgkmcnt(3)
v_mfma_f32_16x16x32_bf16 v[150:153], a[76:79], v[186:189], v[150:153]
v_mfma_f32_16x16x32_bf16 v[154:157], a[100:103], v[186:189], v[154:157]
v_mfma_f32_16x16x32_bf16 v[158:161], a[124:127], v[186:189], v[158:161]
ds_read_b128 v[186:189], v210 offset:26624
s_waitcnt lgkmcnt(1)
v_mfma_f32_16x16x32_bf16 v[138:141], a[80:83], v[182:185], v[138:141]
v_mfma_f32_16x16x32_bf16 v[142:145], a[104:107], v[182:185], v[142:145]
v_mfma_f32_16x16x32_bf16 v[146:149], a[128:131], v[182:185], v[146:149]
ds_read_b128 v[182:185], v210 offset:21504
s_waitcnt lgkmcnt(1)
v_mfma_f32_16x16x32_bf16 v[150:153], a[80:83], v[186:189], v[150:153]
v_mfma_f32_16x16x32_bf16 v[154:157], a[104:107], v[186:189], v[154:157]
v_mfma_f32_16x16x32_bf16 v[158:161], a[128:131], v[186:189], v[158:161]
ds_read_b128 v[186:189], v210 offset:27648
s_waitcnt lgkmcnt(1)
v_mfma_f32_16x16x32_bf16 v[138:141], a[84:87], v[182:185], v[138:141]
v_mfma_f32_16x16x32_bf16 v[142:145], a[108:111], v[182:185], v[142:145]
v_mfma_f32_16x16x32_bf16 v[146:149], a[132:135], v[182:185], v[146:149]
ds_read_b128 v[182:185], v210 offset:22528
s_waitcnt lgkmcnt(1)
v_mfma_f32_16x16x32_bf16 v[150:153], a[84:87], v[186:189], v[150:153]
v_mfma_f32_16x16x32_bf16 v[154:157], a[108:111], v[186:189], v[154:157]
v_mfma_f32_16x16x32_bf16 v[158:161], a[132:135], v[186:189], v[158:161]
ds_read_b128 v[186:189], v210 offset:28672
s_waitcnt lgkmcnt(1)
v_mfma_f32_16x16x32_bf16 v[138:141], a[88:91], v[182:185], v[138:141]
v_mfma_f32_16x16x32_bf16 v[142:145], a[112:115], v[182:185], v[142:145]
v_mfma_f32_16x16x32_bf16 v[146:149], a[136:139], v[182:185], v[146:149]
ds_read_b128 v[182:185], v210 offset:23552
s_waitcnt lgkmcnt(1)
v_mfma_f32_16x16x32_bf16 v[150:153], a[88:91], v[186:189], v[150:153]
v_mfma_f32_16x16x32_bf16 v[154:157], a[112:115], v[186:189], v[154:157]
v_mfma_f32_16x16x32_bf16 v[158:161], a[136:139], v[186:189], v[158:161]
ds_read_b128 v[186:189], v210 offset:29696
s_waitcnt lgkmcnt(1)
v_mfma_f32_16x16x32_bf16 v[138:141], a[92:95], v[182:185], v[138:141]
v_mfma_f32_16x16x32_bf16 v[142:145], a[116:119], v[182:185], v[142:145]
v_mfma_f32_16x16x32_bf16 v[146:149], a[140:143], v[182:185], v[146:149]
v_cvt_pk_bf16_f32 v60, v138, v139
v_cvt_pk_bf16_f32 v61, v140, v141
s_waitcnt lgkmcnt(0)
v_mfma_f32_16x16x32_bf16 v[150:153], a[92:95], v[186:189], v[150:153]
ds_write_b64 v83, v[60:61]
v_mfma_f32_16x16x32_bf16 v[154:157], a[116:119], v[186:189], v[154:157]
v_cvt_pk_bf16_f32 v62, v142, v143
v_cvt_pk_bf16_f32 v63, v144, v145
v_mfma_f32_16x16x32_bf16 v[158:161], a[140:143], v[186:189], v[158:161]
ds_write_b64 v83, v[62:63] offset:32
v_cvt_pk_bf16_f32 v64, v146, v147
v_cvt_pk_bf16_f32 v65, v148, v149
v_cvt_pk_bf16_f32 v66, v150, v151
v_cvt_pk_bf16_f32 v67, v152, v153
v_cvt_pk_bf16_f32 v68, v154, v155
v_cvt_pk_bf16_f32 v69, v156, v157
v_cvt_pk_bf16_f32 v70, v158, v159
v_cvt_pk_bf16_f32 v71, v160, v161
ds_write_b64 v83, v[64:65] offset:64
ds_write_b64 v83, v[66:67] offset:22528
ds_write_b64 v83, v[68:69] offset:22560
ds_write_b64 v83, v[70:71] offset:22592
s_waitcnt vmcnt(0) lgkmcnt(0)
s_nop 7
s_cmp_lg_u32 s47, 0
s_cbranch_scc1 L_safe
ds_read_b128 v[174:177], v217
ds_read_b128 v[178:181], v217 offset:528
s_barrier
ds_read_b128 v[84:87], v200
ds_read_b128 v[92:95], v201
ds_read_b128 v[100:103], v202
ds_read_b128 v[88:91], v194 offset:16
ds_read_b128 v[96:99], v195 offset:16
s_mul_hi_u32 s41, s35, 58835169
ds_read_b128 v[104:107], v196 offset:16
s_mul_i32 s42, s41, 73
ds_read_b64 v[112:113], v215 offset:528
s_sub_u32 s42, s35, s42
s_mul_i32 s43, s41, 1373568
s_mul_i32 s51, s42, 2688
s_add_u32 s43, s43, s51
s_mov_b32 s38, s36
s_waitcnt lgkmcnt(6)
v_mfma_f32_16x16x32_bf16 v[36:39], v[174:177], v[84:87], 0
ds_read_b128 v[84:87], v194
s_waitcnt lgkmcnt(6)
v_mfma_f32_16x16x32_bf16 v[48:51], v[174:177], v[92:95], 0
s_cmp_lt_u32 s35, s34
ds_read_b128 v[92:95], v195
s_cselect_b32 s36, s43, 1879048192
s_add_u32 s35, s35, 32
s_cmp_eq_u32 s42, 0
s_cselect_b32 s44, 536870911, s72
s_cmp_eq_u32 s42, 72
s_cselect_b32 s44, 939524095, s44
s_cmp_eq_u32 s41, 0
s_cselect_b32 s40, 1879048192, s36
s_add_u32 m0, s45, 0
ds_read_b128 v[182:185], v210
s_waitcnt lgkmcnt(2)
v_smfmac_f32_16x16x64_bf16 v[36:39], v[178:181], v[84:91], v213
ds_read_b128 v[84:87], v197
ds_read_b128 v[88:91], v197 offset:16
v_mfma_f32_16x16x32_bf16 v[60:63], v[174:177], v[100:103], 0
s_waitcnt lgkmcnt(3)
ds_read_b128 v[100:103], v196
ds_read_b128 v[174:177], v217 offset:1056
v_smfmac_f32_16x16x64_bf16 v[48:51], v[178:181], v[92:99], v213
ds_read_b128 v[92:95], v198
ds_read_b128 v[96:99], v198 offset:16
s_waitcnt lgkmcnt(6)
v_mfma_f32_16x16x32_bf16 v[138:141], a[0:3], v[182:185], 0
ds_read_b128 v[186:189], v210 offset:1024
v_mfma_f32_16x16x32_bf16 v[142:145], a[24:27], v[182:185], 0
v_mfma_f32_16x16x32_bf16 v[146:149], a[48:51], v[182:185], 0
s_waitcnt lgkmcnt(4)
v_smfmac_f32_16x16x64_bf16 v[60:63], v[178:181], v[100:107], v213
ds_read_b128 v[100:103], v199
ds_read_b128 v[104:107], v199 offset:16
s_waitcnt lgkmcnt(5)
v_smfmac_f32_16x16x64_bf16 v[36:39], v[174:177], v[84:91], v213
ds_read_b128 v[84:87], v200 offset:32
ds_read_b128 v[178:181], v217 offset:1584
v_mfma_f32_16x16x32_bf16 v[150:153], a[216:219], v[182:185], 0
ds_read_b128 v[88:91], v194 offset:48
s_waitcnt lgkmcnt(6)
v_smfmac_f32_16x16x64_bf16 v[48:51], v[174:177], v[92:99], v213
ds_read_b128 v[92:95], v201 offset:32
ds_read_b128 v[96:99], v195 offset:48
v_mfma_f32_16x16x32_bf16 v[154:157], a[240:243], v[182:185], 0
v_mul_f32 v119, v36, v36
v_add_f32 v118, v36, v37
v_mfma_f32_16x16x32_bf16 v[158:161], v[232:235], v[182:185], 0
v_mul_f32 v127, v48, v48
v_add_f32 v126, v48, v49
v_mfma_f32_16x16x32_bf16 v[162:165], v[182:185], a[72:75], 0
v_fmac_f32 v119, v37, v37
v_fmac_f32 v127, v49, v49
v_mfma_f32_16x16x32_bf16 v[166:169], v[182:185], a[96:99], 0
s_waitcnt lgkmcnt(5)
v_add_f32 v118, v118, v38
v_add_f32 v126, v126, v50
v_smfmac_f32_16x16x64_bf16 v[60:63], v[174:177], v[100:107], v213
ds_read_b128 v[100:103], v202 offset:32
ds_read_b128 v[174:177], v217 offset:2112
v_mfma_f32_16x16x32_bf16 v[170:173], v[182:185], a[120:123], 0
s_waitcnt lgkmcnt(5)
ds_read_b128 v[104:107], v196 offset:48
ds_read_b128 v[182:185], v210 offset:2048
v_mfma_f32_16x16x32_bf16 v[40:43], v[178:181], v[84:87], 0
ds_read_b128 v[84:87], v194 offset:32
v_mul_f32 v135, v60, v60
v_mfma_f32_16x16x32_bf16 v[138:141], a[4:7], v[186:189], v[138:141]
v_add_f32 v134, v60, v61
s_waitcnt lgkmcnt(6)
v_mfma_f32_16x16x32_bf16 v[52:55], v[178:181], v[92:95], 0
ds_read_b128 v[92:95], v195 offset:32
v_fmac_f32 v135, v61, v61
v_mfma_f32_16x16x32_bf16 v[142:145], a[28:31], v[186:189], v[142:145]
v_add_f32 v134, v134, v62
v_fmac_f32 v135, v62, v62
s_waitcnt lgkmcnt(5)
v_mfma_f32_16x16x32_bf16 v[64:67], v[178:181], v[100:103], 0
ds_read_b128 v[100:103], v196 offset:32
ds_read_b128 v[178:181], v217 offset:2640
v_mfma_f32_16x16x32_bf16 v[146:149], a[52:55], v[186:189], v[146:149]
v_fmac_f32 v119, v38, v38
v_fmac_f32 v127, v50, v50
v_mfma_f32_16x16x32_bf16 v[150:153], a[220:223], v[186:189], v[150:153]
v_add_f32 v134, v134, v63
v_fmac_f32 v135, v63, v63
v_mfma_f32_16x16x32_bf16 v[154:157], a[244:247], v[186:189], v[154:157]
s_waitcnt lgkmcnt(3)
v_add_f32 v118, v118, v39
v_add_f32 v126, v126, v51
v_smfmac_f32_16x16x64_bf16 v[40:43], v[174:177], v[84:91], v213
s_waitcnt lgkmcnt(2)
ds_read_b128 v[84:87], v197 offset:32
ds_read_b128 v[88:91], v197 offset:48
v_smfmac_f32_16x16x64_bf16 v[52:55], v[174:177], v[92:99], v213
ds_read_b128 v[92:95], v198 offset:32
ds_read_b128 v[96:99], v198 offset:48
v_mfma_f32_16x16x32_bf16 v[158:161], v[236:239], v[186:189], v[158:161]
s_waitcnt lgkmcnt(5)
v_fmac_f32 v119, v39, v39
v_fmac_f32 v127, v51, v51
v_smfmac_f32_16x16x64_bf16 v[64:67], v[174:177], v[100:107], v213
ds_read_b128 v[100:103], v199 offset:32
ds_read_b128 v[104:107], v199 offset:48
v_mfma_f32_16x16x32_bf16 v[162:165], v[186:189], a[76:79], v[162:165]
ds_read_b128 v[174:177], v217 offset:3168
v_mfma_f32_16x16x32_bf16 v[166:169], v[186:189], a[100:103], v[166:169]
v_mfma_f32_16x16x32_bf16 v[170:173], v[186:189], a[124:127], v[170:173]
ds_read_b128 v[186:189], v210 offset:3072
s_waitcnt lgkmcnt(6)
v_smfmac_f32_16x16x64_bf16 v[40:43], v[178:181], v[84:91], v213
ds_read_b128 v[84:87], v200 offset:64
ds_read_b128 v[88:91], v194 offset:80
v_mfma_f32_16x16x32_bf16 v[138:141], a[8:11], v[182:185], v[138:141]
s_nop 3
v_add_f32 v118, v118, v40
s_waitcnt lgkmcnt(6)
v_smfmac_f32_16x16x64_bf16 v[52:55], v[178:181], v[92:99], v213
ds_read_b128 v[92:95], v201 offset:64
ds_read_b128 v[96:99], v195 offset:80
v_mfma_f32_16x16x32_bf16 v[142:145], a[32:35], v[182:185], v[142:145]
s_waitcnt lgkmcnt(6)
v_fmac_f32 v119, v40, v40
v_add_f32 v118, v118, v41
v_smfmac_f32_16x16x64_bf16 v[64:67], v[178:181], v[100:107], v213
ds_read_b128 v[100:103], v202 offset:64
ds_read_b128 v[178:181], v217 offset:3696
v_mfma_f32_16x16x32_bf16 v[146:149], a[56:59], v[182:185], v[146:149]
ds_read_b128 v[104:107], v196 offset:80
v_add_f32 v126, v126, v52
v_mfma_f32_16x16x32_bf16 v[150:153], a[224:227], v[182:185], v[150:153]
s_waitcnt lgkmcnt(6)
v_add_f32 v134, v134, v64
v_fmac_f32 v135, v64, v64
v_mfma_f32_16x16x32_bf16 v[44:47], v[174:177], v[84:87], 0
ds_read_b128 v[84:87], v194 offset:64
v_fmac_f32 v127, v52, v52
v_mfma_f32_16x16x32_bf16 v[154:157], a[248:251], v[182:185], v[154:157]
s_waitcnt lgkmcnt(5)
v_add_f32 v134, v134, v65
v_fmac_f32 v135, v65, v65
v_mfma_f32_16x16x32_bf16 v[56:59], v[174:177], v[92:95], 0
ds_read_b128 v[92:95], v195 offset:64
v_fmac_f32 v119, v41, v41
v_mfma_f32_16x16x32_bf16 v[158:161], v[240:243], v[182:185], v[158:161]
s_waitcnt lgkmcnt(4)
v_add_f32 v126, v126, v53
v_fmac_f32 v127, v53, v53
v_mfma_f32_16x16x32_bf16 v[68:71], v[174:177], v[100:103], 0
ds_read_b128 v[100:103], v196 offset:64
ds_read_b128 v[174:177], v217 offset:4224
v_mfma_f32_16x16x32_bf16 v[162:165], v[182:185], a[80:83], v[162:165]
v_add_f32 v134, v134, v66
v_fmac_f32 v135, v66, v66
v_mfma_f32_16x16x32_bf16 v[166:169], v[182:185], a[104:107], v[166:169]
s_waitcnt lgkmcnt(3)
v_add_f32 v118, v118, v42
v_fmac_f32 v119, v42, v42
v_smfmac_f32_16x16x64_bf16 v[44:47], v[178:181], v[84:91], v213
ds_read_b128 v[84:87], v197 offset:64
ds_read_b128 v[88:91], v197 offset:80
v_mfma_f32_16x16x32_bf16 v[170:173], v[182:185], a[128:131], v[170:173]
s_waitcnt lgkmcnt(4)
ds_read_b128 v[182:185], v210 offset:4096
v_add_f32 v126, v126, v54
v_smfmac_f32_16x16x64_bf16 v[56:59], v[178:181], v[92:99], v213
ds_read_b128 v[92:95], v198 offset:64
ds_read_b128 v[96:99], v198 offset:80
v_mfma_f32_16x16x32_bf16 v[138:141], a[12:15], v[186:189], v[138:141]
s_waitcnt lgkmcnt(6)
v_fmac_f32 v127, v54, v54
v_add_f32 v134, v134, v67
v_smfmac_f32_16x16x64_bf16 v[68:71], v[178:181], v[100:107], v213
ds_read_b128 v[100:103], v199 offset:64
ds_read_b128 v[104:107], v199 offset:80
v_mfma_f32_16x16x32_bf16 v[142:145], a[36:39], v[186:189], v[142:145]
v_fmac_f32 v135, v67, v67
v_add_f32 v118, v118, v43
v_mfma_f32_16x16x32_bf16 v[146:149], a[60:63], v[186:189], v[146:149]
v_fmac_f32 v119, v43, v43
v_add_f32 v126, v126, v55
v_mfma_f32_16x16x32_bf16 v[150:153], a[228:231], v[186:189], v[150:153]
s_waitcnt lgkmcnt(5)
v_fmac_f32 v127, v55, v55
v_and_b32 v180, s44, v208
v_smfmac_f32_16x16x64_bf16 v[44:47], v[174:177], v[84:91], v213
v_mfma_f32_16x16x32_bf16 v[154:157], a[252:255], v[186:189], v[154:157]
v_mov_b32 v181, 0
s_waitcnt lgkmcnt(2)
v_smfmac_f32_16x16x64_bf16 v[56:59], v[174:177], v[92:99], v213
v_add_f32 v118, v118, v44
v_fmac_f32 v119, v44, v44
v_mfma_f32_16x16x32_bf16 v[158:161], v[244:247], v[186:189], v[158:161]
v_add_f32 v118, v118, v45
v_fmac_f32 v119, v45, v45
s_waitcnt lgkmcnt(0)
v_smfmac_f32_16x16x64_bf16 v[68:71], v[174:177], v[100:107], v213
v_add_f32 v126, v126, v56
v_fmac_f32 v127, v56, v56
v_mfma_f32_16x16x32_bf16 v[162:165], v[186:189], a[84:87], v[162:165]
v_add_f32 v126, v126, v57
v_fmac_f32 v127, v57, v57
v_mfma_f32_16x16x32_bf16 v[166:169], v[186:189], a[108:111], v[166:169]
v_add_f32 v134, v134, v68
v_fmac_f32 v135, v68, v68
v_mfma_f32_16x16x32_bf16 v[170:173], v[186:189], a[132:135], v[170:173]
ds_read_b128 v[186:189], v210 offset:5120
v_add_f32 v134, v134, v69
v_mfma_f32_16x16x32_bf16 v[138:141], a[16:19], v[182:185], v[138:141]
v_fmac_f32 v135, v69, v69
v_add_f32 v134, v134, v70
v_mfma_f32_16x16x32_bf16 v[142:145], a[40:43], v[182:185], v[142:145]
v_fmac_f32 v135, v70, v70
v_add_f32 v118, v118, v46
v_mfma_f32_16x16x32_bf16 v[146:149], a[64:67], v[182:185], v[146:149]
v_fmac_f32 v119, v46, v46
v_add_f32 v126, v126, v58
v_mfma_f32_16x16x32_bf16 v[150:153], a[232:235], v[182:185], v[150:153]
v_fmac_f32 v127, v58, v58
v_add_f32 v134, v134, v71
v_mfma_f32_16x16x32_bf16 v[154:157], v[224:227], v[182:185], v[154:157]
v_fmac_f32 v135, v71, v71
v_add_f32 v118, v118, v47
v_mfma_f32_16x16x32_bf16 v[158:161], v[248:251], v[182:185], v[158:161]
v_fmac_f32 v119, v47, v47
v_add_f32 v126, v126, v59
v_mfma_f32_16x16x32_bf16 v[162:165], v[182:185], a[88:91], v[162:165]
v_fmac_f32 v127, v59, v59
v_mfma_f32_16x16x32_bf16 v[166:169], v[182:185], a[112:115], v[166:169]
v_permlane16_swap_b32 v134, v135
v_mfma_f32_16x16x32_bf16 v[170:173], v[182:185], a[136:139], v[170:173]
s_waitcnt lgkmcnt(0)
ds_read_b128 v[182:185], v210 offset:6144
v_add_f32 v134, v134, v135
v_mfma_f32_16x16x32_bf16 v[138:141], a[20:23], v[186:189], v[138:141]
v_permlane16_swap_b32 v118, v119
v_mfma_f32_16x16x32_bf16 v[142:145], a[44:47], v[186:189], v[142:145]
v_permlane16_swap_b32 v126, v127
v_mfma_f32_16x16x32_bf16 v[146:149], a[68:71], v[186:189], v[146:149]
v_cvt_pk_bf16_f32 v78, v138, v139
v_cvt_pk_bf16_f32 v79, v140, v141
v_mfma_f32_16x16x32_bf16 v[150:153], a[236:239], v[186:189], v[150:153]
v_cvt_pk_bf16_f32 v80, v142, v143
v_cvt_pk_bf16_f32 v81, v144, v145
v_mfma_f32_16x16x32_bf16 v[154:157], v[228:231], v[186:189], v[154:157]
v_cvt_pk_bf16_f32 v82, v146, v147
v_cvt_pk_bf16_f32 v83, v148, v149
v_mfma_f32_16x16x32_bf16 v[158:161], v[252:255], v[186:189], v[158:161]
v_cvt_pk_bf16_f32 v72, v150, v151
v_cvt_pk_bf16_f32 v73, v152, v153
v_mfma_f32_16x16x32_bf16 v[162:165], v[186:189], a[92:95], v[162:165]
v_cvt_pk_bf16_f32 v74, v154, v155
v_cvt_pk_bf16_f32 v75, v156, v157
v_mfma_f32_16x16x32_bf16 v[166:169], v[186:189], a[116:119], v[166:169]
v_cvt_pk_bf16_f32 v76, v158, v159
v_cvt_pk_bf16_f32 v77, v160, v161
v_mfma_f32_16x16x32_bf16 v[170:173], v[186:189], a[140:143], v[170:173]
s_waitcnt lgkmcnt(0)
ds_read_b128 v[186:189], v210 offset:7168
v_cvt_pk_bf16_f32 v114, v162, v163
v_mfma_f32_16x16x32_bf16 v[138:141], a[0:3], v[182:185], 0
v_cvt_pk_bf16_f32 v115, v164, v165
v_cvt_pk_bf16_f32 v122, v166, v167
v_mfma_f32_16x16x32_bf16 v[142:145], a[24:27], v[182:185], 0
v_cvt_pk_bf16_f32 v123, v168, v169
v_cvt_pk_bf16_f32 v130, v170, v171
v_mfma_f32_16x16x32_bf16 v[146:149], a[48:51], v[182:185], 0
v_cvt_pk_bf16_f32 v131, v172, v173
v_mov_b32 v135, v134
v_mfma_f32_16x16x32_bf16 v[150:153], a[216:219], v[182:185], 0
v_add_f32 v118, v118, v119
v_add_f32 v126, v126, v127
v_mfma_f32_16x16x32_bf16 v[154:157], a[240:243], v[182:185], 0
v_permlane32_swap_b32 v134, v135
v_mfma_f32_16x16x32_bf16 v[158:161], v[232:235], v[182:185], 0
v_permlane32_swap_b32 v118, v126
v_mfma_f32_16x16x32_bf16 v[162:165], v[182:185], a[72:75], 0
v_add_f32 v134, v134, v135
v_add_f32 v118, v118, v126
v_mfma_f32_16x16x32_bf16 v[166:169], v[182:185], a[96:99], 0
ds_write_b32 v209, v134 offset:512
v_mfma_f32_16x16x32_bf16 v[170:173], v[182:185], a[120:123], 0
s_waitcnt lgkmcnt(1)
ds_read_b128 v[182:185], v210 offset:8192
ds_write_b32 v209, v118
v_mfma_f32_16x16x32_bf16 v[138:141], a[4:7], v[186:189], v[138:141]
v_mfma_f32_16x16x32_bf16 v[142:145], a[28:31], v[186:189], v[142:145]
v_mfma_f32_16x16x32_bf16 v[146:149], a[52:55], v[186:189], v[146:149]
v_mfma_f32_16x16x32_bf16 v[150:153], a[220:223], v[186:189], v[150:153]
v_mfma_f32_16x16x32_bf16 v[154:157], a[244:247], v[186:189], v[154:157]
v_mfma_f32_16x16x32_bf16 v[158:161], v[236:239], v[186:189], v[158:161]
s_waitcnt lgkmcnt(0)
s_barrier
v_mfma_f32_16x16x32_bf16 v[162:165], v[186:189], a[76:79], v[162:165]
ds_read_b128 v[106:109], v210 offset:56320
ds_read_b128 v[102:105], v210 offset:55296
v_mfma_f32_16x16x32_bf16 v[166:169], v[186:189], a[100:103], v[166:169]
buffer_load_dwordx4 v180, s[4:7], s40 offen nt lds
v_mfma_f32_16x16x32_bf16 v[170:173], v[186:189], a[124:127], v[170:173]
s_add_u32 m0, s45, 4112
ds_read_b128 v[186:189], v210 offset:9216
s_add_u32 s40, s36, 196224
v_mfma_f32_16x16x32_bf16 v[138:141], a[8:11], v[182:185], v[138:141]
buffer_load_dwordx4 v180, s[4:7], s40 offen nt lds
v_mfma_f32_16x16x32_bf16 v[142:145], a[32:35], v[182:185], v[142:145]
s_add_u32 m0, s45, 8224
s_add_u32 s40, s36, 392448
buffer_load_dwordx4 v180, s[4:7], s40 offen nt lds
v_mfma_f32_16x16x32_bf16 v[146:149], a[56:59], v[182:185], v[146:149]
s_add_u32 m0, s45, 12336
s_add_u32 s40, s36, 588672
buffer_load_dwordx4 v180, s[4:7], s40 offen nt lds
v_mfma_f32_16x16x32_bf16 v[150:153], a[224:227], v[182:185], v[150:153]
s_waitcnt lgkmcnt(2)
v_add_f32 v106, v106, v107
v_add_f32 v108, v108, v109
v_mfma_f32_16x16x32_bf16 v[154:157], a[248:251], v[182:185], v[154:157]
s_waitcnt lgkmcnt(1)
v_add_f32 v106, v106, v108
v_add_f32 v102, v102, v103
v_mfma_f32_16x16x32_bf16 v[158:161], v[240:243], v[182:185], v[158:161]
s_add_u32 m0, s45, 16448
ds_read_b128 v[108:111], v215 offset:512
v_add_f32 v104, v104, v105
v_mfma_f32_16x16x32_bf16 v[162:165], v[182:185], a[80:83], v[162:165]
s_add_u32 s40, s36, 784896
v_add_f32 v102, v102, v104
v_mul_f32 v106, s73, v106
v_mfma_f32_16x16x32_bf16 v[166:169], v[182:185], a[104:107], v[166:169]
v_mul_f32 v103, s48, v102
v_mul_f32 v104, s73, v102
v_mfma_f32_16x16x32_bf16 v[170:173], v[182:185], a[128:131], v[170:173]
s_waitcnt lgkmcnt(1)
ds_read_b128 v[182:185], v210 offset:10240
v_fma_f32 v106, -v103, v104, v106
v_mfma_f32_16x16x32_bf16 v[138:141], a[12:15], v[186:189], v[138:141]
v_max_f32 v106, 0, v106
v_add_f32 v106, s49, v106
v_mfma_f32_16x16x32_bf16 v[142:145], a[36:39], v[186:189], v[142:145]
v_rsq_f32 v102, v106
v_mfma_f32_16x16x32_bf16 v[146:149], a[60:63], v[186:189], v[146:149]
v_mul_f32_e64 v103, -v103, v102
v_mfma_f32_16x16x32_bf16 v[150:153], a[228:231], v[186:189], v[150:153]
ds_write_b64 v211, v[102:103] offset:36864
v_mfma_f32_16x16x32_bf16 v[154:157], a[252:255], v[186:189], v[154:157]
s_waitcnt lgkmcnt(1)
buffer_load_dwordx4 v180, s[4:7], s40 offen nt lds
v_mfma_f32_16x16x32_bf16 v[158:161], v[244:247], v[186:189], v[158:161]
s_add_u32 m0, s45, 20560
ds_read_b64 v[118:119], v219
ds_read_b64 v[126:127], v219 offset:256
v_mfma_f32_16x16x32_bf16 v[162:165], v[186:189], a[84:87], v[162:165]
s_add_u32 s40, s36, 981120
ds_read_b64 v[134:135], v219 offset:512
buffer_load_dwordx4 v180, s[4:7], s40 offen nt lds
v_mfma_f32_16x16x32_bf16 v[166:169], v[186:189], a[108:111], v[166:169]
s_add_u32 m0, s45, 24672
s_add_u32 s40, s36, 1177344
buffer_load_dwordx4 v180, s[4:7], s40 offen nt lds
v_mfma_f32_16x16x32_bf16 v[170:173], v[186:189], a[132:135], v[170:173]
s_add_u32 m0, s45, 28784
ds_read_b128 v[186:189], v210 offset:11264
s_add_u32 s40, s36, 1373568
v_mfma_f32_16x16x32_bf16 v[138:141], a[16:19], v[182:185], v[138:141]
buffer_load_dwordx4 v180, s[4:7], s40 offen nt lds
v_mfma_f32_16x16x32_bf16 v[142:145], a[40:43], v[182:185], v[142:145]
s_waitcnt lgkmcnt(3)
v_fma_f32 v220, v36, v118, v119
v_fma_f32 v221, v37, v118, v119
v_mfma_f32_16x16x32_bf16 v[146:149], a[64:67], v[182:185], v[146:149]
s_add_u32 m0, s45, 32896
v_fma_f32 v222, v38, v118, v119
v_fma_f32 v223, v39, v118, v119
v_mfma_f32_16x16x32_bf16 v[150:153], a[232:235], v[182:185], v[150:153]
s_add_u32 s40, s36, 1569792
v_cvt_pk_bf16_f32 v90, v220, v221
v_cvt_pk_bf16_f32 v91, v222, v223
v_mfma_f32_16x16x32_bf16 v[154:157], v[224:227], v[182:185], v[154:157]
v_fma_f32 v220, v40, v118, v119
v_fma_f32 v221, v41, v118, v119
v_mfma_f32_16x16x32_bf16 v[158:161], v[248:251], v[182:185], v[158:161]
v_fma_f32 v222, v42, v118, v119
v_fma_f32 v223, v43, v118, v119
v_mfma_f32_16x16x32_bf16 v[162:165], v[182:185], a[88:91], v[162:165]
v_cvt_pk_bf16_f32 v92, v220, v221
v_cvt_pk_bf16_f32 v93, v222, v223
v_mfma_f32_16x16x32_bf16 v[166:169], v[182:185], a[112:115], v[166:169]
ds_write_b128 v211, v[90:93] offset:18432
v_mfma_f32_16x16x32_bf16 v[170:173], v[182:185], a[136:139], v[170:173]
s_waitcnt lgkmcnt(1)
v_fma_f32 v220, v44, v118, v119
v_fma_f32 v221, v45, v118, v119
v_mfma_f32_16x16x32_bf16 v[138:141], a[20:23], v[186:189], v[138:141]
ds_read_b128 v[182:185], v210 offset:12288
v_mfma_f32_16x16x32_bf16 v[142:145], a[44:47], v[186:189], v[142:145]
v_fma_f32 v222, v46, v118, v119
v_fma_f32 v223, v47, v118, v119
v_mfma_f32_16x16x32_bf16 v[146:149], a[68:71], v[186:189], v[146:149]
v_cvt_pk_bf16_f32 v96, v138, v139
v_cvt_pk_bf16_f32 v97, v140, v141
v_mfma_f32_16x16x32_bf16 v[150:153], a[236:239], v[186:189], v[150:153]
v_cvt_pk_bf16_f32 v98, v142, v143
v_cvt_pk_bf16_f32 v99, v144, v145
v_mfma_f32_16x16x32_bf16 v[154:157], v[228:231], v[186:189], v[154:157]
v_cvt_pk_bf16_f32 v100, v146, v147
v_cvt_pk_bf16_f32 v101, v148, v149
v_mfma_f32_16x16x32_bf16 v[158:161], v[252:255], v[186:189], v[158:161]
v_cvt_pk_bf16_f32 v84, v150, v151
v_cvt_pk_bf16_f32 v85, v152, v153
v_mfma_f32_16x16x32_bf16 v[162:165], v[186:189], a[92:95], v[162:165]
v_cvt_pk_bf16_f32 v86, v154, v155
v_cvt_pk_bf16_f32 v87, v156, v157
v_mfma_f32_16x16x32_bf16 v[166:169], v[186:189], a[116:119], v[166:169]
v_cvt_pk_bf16_f32 v88, v158, v159
v_cvt_pk_bf16_f32 v89, v160, v161
v_mfma_f32_16x16x32_bf16 v[170:173], v[186:189], a[140:143], v[170:173]
s_waitcnt lgkmcnt(0)
ds_read_b128 v[186:189], v210 offset:13312
v_cvt_pk_bf16_f32 v116, v162, v163
v_mfma_f32_16x16x32_bf16 v[138:141], a[0:3], v[182:185], 0
v_cvt_pk_bf16_f32 v124, v166, v167
v_cvt_pk_bf16_f32 v125, v168, v169
v_mfma_f32_16x16x32_bf16 v[142:145], a[24:27], v[182:185], 0
v_cvt_pk_bf16_f32 v117, v164, v165
v_cvt_pk_bf16_f32 v94, v220, v221
v_mfma_f32_16x16x32_bf16 v[150:153], v[108:111], v[72:75], v[206:209]
v_cvt_pk_bf16_f32 v95, v222, v223
v_fma_f32 v220, v48, v126, v127
v_mfma_f32_16x16x32_bf16 v[146:149], a[48:51], v[182:185], 0
ds_read_b128 v[182:185], v210 offset:14336
ds_write_b64 v212, v[94:95] offset:18432
v_mfma_f32_16x16x16_bf16 v[150:153], v[112:113], v[76:77], v[150:153]
s_waitcnt lgkmcnt(2)
v_fma_f32 v221, v49, v126, v127
v_fma_f32 v222, v50, v126, v127
v_mfma_f32_16x16x32_bf16 v[138:141], a[4:7], v[186:189], v[138:141]
v_fma_f32 v223, v51, v126, v127
v_cvt_pk_bf16_f32 v174, v220, v221
v_mfma_f32_16x16x32_bf16 v[142:145], a[28:31], v[186:189], v[142:145]
v_cvt_pk_bf16_f32 v175, v222, v223
v_fma_f32 v220, v52, v126, v127
v_mfma_f32_16x16x32_bf16 v[146:149], a[52:55], v[186:189], v[146:149]
ds_read_b128 v[186:189], v210 offset:15360
v_fma_f32 v221, v53, v126, v127
v_mfma_f32_16x16x32_bf16 v[154:157], v[78:81], v[84:87], 0
s_waitcnt lgkmcnt(2)
v_fma_f32 v222, v54, v126, v127
v_fma_f32 v223, v55, v126, v127
v_mfma_f32_16x16x32_bf16 v[138:141], a[8:11], v[182:185], v[138:141]
v_cvt_pk_bf16_f32 v176, v220, v221
v_cvt_pk_bf16_f32 v177, v222, v223
v_mfma_f32_16x16x32_bf16 v[142:145], a[32:35], v[182:185], v[142:145]
v_fma_f32 v220, v56, v126, v127
v_fma_f32 v221, v57, v126, v127
v_mfma_f32_16x16x32_bf16 v[158:161], v[96:99], v[84:87], 0
v_fma_f32 v222, v58, v126, v127
v_fma_f32 v223, v59, v126, v127
v_mfma_f32_16x16x32_bf16 v[146:149], a[56:59], v[182:185], v[146:149]
ds_read_b128 v[182:185], v210 offset:16384
v_cvt_pk_bf16_f32 v178, v220, v221
v_mfma_f32_16x16x32_bf16 v[166:169], v[108:111], v[84:87], v[206:209]
s_waitcnt lgkmcnt(1)
v_cvt_pk_bf16_f32 v179, v222, v223
v_fma_f32 v220, v60, v134, v135
v_mfma_f32_16x16x32_bf16 v[138:141], a[12:15], v[186:189], v[138:141]
v_fma_f32 v221, v61, v134, v135
v_fma_f32 v222, v62, v134, v135
v_mfma_f32_16x16x32_bf16 v[142:145], a[36:39], v[186:189], v[142:145]
v_fma_f32 v223, v63, v134, v135
v_cvt_pk_bf16_f32 v90, v220, v221
v_mfma_f32_16x16x32_bf16 v[146:149], a[60:63], v[186:189], v[146:149]
ds_read_b128 v[186:189], v210 offset:17408
v_cvt_pk_bf16_f32 v91, v222, v223
v_mfma_f32_16x16x16_bf16 v[154:157], v[82:83], v[88:89], v[154:157]
v_fma_f32 v220, v64, v134, v135
v_fma_f32 v221, v65, v134, v135
v_mfma_f32_16x16x16_bf16 v[158:161], v[100:101], v[88:89], v[158:161]
s_waitcnt lgkmcnt(1)
v_fma_f32 v222, v66, v134, v135
v_fma_f32 v223, v67, v134, v135
v_mfma_f32_16x16x32_bf16 v[138:141], a[16:19], v[182:185], v[138:141]
v_cvt_pk_bf16_f32 v92, v220, v221
v_cvt_pk_bf16_f32 v93, v222, v223
v_mfma_f32_16x16x32_bf16 v[142:145], a[40:43], v[182:185], v[142:145]
ds_write_b128 v211, v[90:93] offset:30720
v_mfma_f32_16x16x16_bf16 v[166:169], v[112:113], v[88:89], v[166:169]
v_fma_f32 v220, v68, v134, v135
v_fma_f32 v221, v69, v134, v135
v_mfma_f32_16x16x32_bf16 v[146:149], a[64:67], v[182:185], v[146:149]
s_waitcnt lgkmcnt(1)
v_fma_f32 v222, v70, v134, v135
v_fma_f32 v223, v71, v134, v135
v_mfma_f32_16x16x32_bf16 v[138:141], a[20:23], v[186:189], v[138:141]
ds_read_b128 v[182:185], v210 offset:12288
v_cvt_pk_bf16_f32 v132, v170, v171
v_mfma_f32_16x16x32_bf16 v[142:145], a[44:47], v[186:189], v[142:145]
v_cvt_pk_bf16_f32 v133, v172, v173
v_cvt_pk_bf16_f32 v94, v220, v221
v_mfma_f32_16x16x32_bf16 v[146:149], a[68:71], v[186:189], v[146:149]
v_cvt_pk_bf16_f32 v102, v138, v139
v_cvt_pk_bf16_f32 v103, v140, v141
v_mfma_f32_16x16x32_bf16 v[138:141], v[78:81], v[72:75], 0
v_cvt_pk_bf16_f32 v104, v142, v143
v_cvt_pk_bf16_f32 v105, v144, v145
v_mfma_f32_16x16x32_bf16 v[142:145], v[96:99], v[72:75], 0
v_cvt_pk_bf16_f32 v106, v146, v147
v_cvt_pk_bf16_f32 v107, v148, v149
v_mfma_f32_16x16x32_bf16 v[146:149], v[102:105], v[72:75], 0
ds_read_b128 v[186:189], v210 offset:13312
v_cvt_pk_bf16_f32 v95, v222, v223
v_mfma_f32_16x16x16_bf16 v[138:141], v[82:83], v[76:77], v[138:141]
buffer_load_dwordx4 v180, s[4:7], s40 offen nt lds
v_mfma_f32_16x16x16_bf16 v[142:145], v[100:101], v[76:77], v[142:145]
ds_write_b128 v211, v[174:177] offset:24576
v_mfma_f32_16x16x16_bf16 v[146:149], v[106:107], v[76:77], v[146:149]
v_exp_f32 v138, v138
v_mfma_f32_16x16x32_bf16 v[162:165], v[102:105], v[84:87], 0
s_waitcnt lgkmcnt(2)
v_exp_f32 v139, v139
v_mfma_f32_16x16x32_bf16 v[118:121], v[182:185], a[72:75], 0
v_exp_f32 v140, v140
v_mfma_f32_16x16x16_bf16 v[162:165], v[106:107], v[88:89], v[162:165]
v_exp_f32 v141, v141
v_mfma_f32_16x16x32_bf16 v[126:129], v[182:185], a[96:99], 0
v_exp_f32 v142, v142
v_mfma_f32_16x16x32_bf16 v[134:137], v[182:185], a[120:123], 0
v_exp_f32 v143, v143
v_mfma_f32_16x16x32_bf16 v[90:93], a[216:219], v[182:185], 0
v_exp_f32 v144, v144
v_mfma_f32_16x16x32_bf16 v[170:173], a[240:243], v[182:185], 0
v_exp_f32 v145, v145
v_mfma_f32_16x16x32_bf16 v[220:223], v[232:235], v[182:185], 0
s_waitcnt lgkmcnt(1)
ds_read_b128 v[182:185], v210 offset:14336
v_cvt_pk_bf16_f32 v174, v138, v139
v_mfma_f32_16x16x32_bf16 v[118:121], v[186:189], a[76:79], v[118:121]
v_exp_f32 v150, v150
v_mfma_f32_16x16x32_bf16 v[126:129], v[186:189], a[100:103], v[126:129]
v_cvt_pk_bf16_f32 v175, v140, v141
v_cvt_pk_bf16_f32 v176, v142, v143
v_mfma_f32_16x16x32_bf16 v[134:137], v[186:189], a[124:127], v[134:137]
v_cvt_pk_bf16_f32 v177, v144, v145
v_cvt_pk_bf16_f32 v180, v150, 0
v_mfma_f32_16x16x32_bf16 v[90:93], a[220:223], v[186:189], v[90:93]
ds_write_b64 v212, v[178:179] offset:24576
v_mfma_f32_16x16x32_bf16 v[170:173], a[244:247], v[186:189], v[170:173]
v_exp_f32 v146, v146
v_mfma_f32_16x16x32_bf16 v[220:223], v[236:239], v[186:189], v[220:223]
s_waitcnt lgkmcnt(1)
ds_read_b128 v[186:189], v210 offset:15360
ds_read_b128 v[72:75], v215
v_mfma_f32_16x16x32_bf16 v[118:121], v[182:185], a[80:83], v[118:121]
v_exp_f32 v147, v147
v_mfma_f32_16x16x32_bf16 v[126:129], v[182:185], a[104:107], v[126:129]
v_exp_f32 v148, v148
v_mfma_f32_16x16x32_bf16 v[134:137], v[182:185], a[128:131], v[134:137]
v_exp_f32 v149, v149
v_mfma_f32_16x16x32_bf16 v[90:93], a[224:227], v[182:185], v[90:93]
v_cvt_pk_bf16_f32 v178, v146, v147
v_cvt_pk_bf16_f32 v179, v148, v149
v_mfma_f32_16x16x32_bf16 v[170:173], a[248:251], v[182:185], v[170:173]
ds_write_b64 v212, v[94:95] offset:30720
v_mfma_f32_16x16x32_bf16 v[220:223], v[240:243], v[182:185], v[220:223]
s_waitcnt lgkmcnt(2)
v_exp_f32 v154, v154
v_mfma_f32_16x16x32_bf16 v[118:121], v[186:189], a[84:87], v[118:121]
ds_read_b128 v[182:185], v210 offset:16384
ds_read_b64 v[76:77], v215 offset:16
v_mfma_f32_16x16x32_bf16 v[126:129], v[186:189], a[108:111], v[126:129]
v_exp_f32 v155, v155
v_mfma_f32_16x16x32_bf16 v[134:137], v[186:189], a[132:135], v[134:137]
v_exp_f32 v156, v156
v_mfma_f32_16x16x32_bf16 v[90:93], a[228:231], v[186:189], v[90:93]
v_exp_f32 v157, v157
v_mfma_f32_16x16x32_bf16 v[170:173], a[252:255], v[186:189], v[170:173]
v_exp_f32 v158, v158
v_mfma_f32_16x16x32_bf16 v[220:223], v[244:247], v[186:189], v[220:223]
ds_read_b128 v[186:189], v210 offset:17408
v_exp_f32 v159, v159
v_mfma_f32_16x16x32_bf16 v[150:153], v[190:193], v[174:177], 0
s_waitcnt lgkmcnt(2)
v_exp_f32 v160, v160
v_mfma_f32_16x16x32_bf16 v[118:121], v[182:185], a[88:91], v[118:121]
v_exp_f32 v161, v161
v_mfma_f32_16x16x32_bf16 v[126:129], v[182:185], a[112:115], v[126:129]
v_exp_f32 v166, v166
v_mfma_f32_16x16x32_bf16 v[134:137], v[182:185], a[136:139], v[134:137]
v_exp_f32 v162, v162
v_mfma_f32_16x16x32_bf16 v[90:93], a[232:235], v[182:185], v[90:93]
v_exp_f32 v163, v163
v_mfma_f32_16x16x32_bf16 v[170:173], v[224:227], v[182:185], v[170:173]
v_exp_f32 v164, v164
v_mfma_f32_16x16x32_bf16 v[220:223], v[248:251], v[182:185], v[220:223]
s_waitcnt lgkmcnt(0)
v_exp_f32 v165, v165
v_mfma_f32_16x16x32_bf16 v[118:121], v[186:189], a[92:95], v[118:121]
v_mfma_f32_16x16x32_bf16 v[126:129], v[186:189], a[116:119], v[126:129]
v_mfma_f32_16x16x32_bf16 v[134:137], v[186:189], a[140:143], v[134:137]
v_cvt_pk_bf16_f32 v118, v118, v119
v_cvt_pk_bf16_f32 v119, v120, v121
v_mfma_f32_16x16x32_bf16 v[90:93], a[236:239], v[186:189], v[90:93]
ds_read_u16 v120, v216
v_cvt_pk_bf16_f32 v126, v126, v127
v_mfma_f32_16x16x32_bf16 v[170:173], v[228:231], v[186:189], v[170:173]
v_cvt_pk_bf16_f32 v127, v128, v129
v_cvt_pk_bf16_f32 v134, v134, v135
v_mfma_f32_16x16x32_bf16 v[220:223], v[252:255], v[186:189], v[220:223]
ds_read_u16 v128, v216 offset:32
v_cvt_pk_bf16_f32 v90, v90, v91
v_mfma_f32_16x16x32_bf16 v[138:141], v[114:117], v[174:177], 0
v_cvt_pk_bf16_f32 v91, v92, v93
v_cvt_pk_bf16_f32 v92, v170, v171
v_mfma_f32_16x16x32_bf16 v[142:145], v[122:125], v[174:177], 0
v_cvt_pk_bf16_f32 v93, v172, v173
v_cvt_pk_bf16_f32 v135, v136, v137
v_mfma_f32_16x16x32_bf16 v[146:149], v[130:133], v[174:177], 0
ds_read_u16 v136, v216 offset:64
v_mov_b32 v121, 0
v_mfma_f32_16x16x32_bf16 v[150:153], v[190:193], v[178:181], v[150:153]
s_waitcnt lgkmcnt(2)
v_mov_b32 v129, 0
v_cvt_pk_bf16_f32 v94, v220, v221
v_mfma_f32_16x16x32_bf16 v[138:141], v[118:121], v[178:181], v[138:141]
s_waitcnt lgkmcnt(1)
v_cvt_pk_bf16_f32 v95, v222, v223
v_mov_b32 v137, 0
v_mfma_f32_16x16x32_bf16 v[142:145], v[126:129], v[178:181], v[142:145]
v_rcp_f32 v151, v150
s_nop 0
v_max3_u32 v218, v218, v150, v151
v_mul_f32 v151, s3, v151
v_mul_f32 v138, v138, v151
v_mul_f32 v139, v139, v151
v_mul_f32 v140, v140, v151
v_mul_f32 v141, v141, v151
v_cvt_pk_bf16_f32 v138, v138, v139
v_mul_f32 v142, v142, v151
s_waitcnt lgkmcnt(0)
v_mfma_f32_16x16x32_bf16 v[146:149], v[134:137], v[178:181], v[146:149]
v_mul_f32 v143, v143, v151
v_mul_f32 v144, v144, v151
v_mul_f32 v145, v145, v151
v_cvt_pk_bf16_f32 v139, v140, v141
v_cvt_pk_bf16_f32 v140, v142, v143
v_cvt_pk_bf16_f32 v141, v144, v145
v_cvt_pk_bf16_f32 v174, v154, v155
v_mul_f32 v146, v146, v151
v_mul_f32 v147, v147, v151
v_mul_f32 v148, v148, v151
v_mul_f32 v149, v149, v151
v_mfma_f32_16x16x32_bf16 v[150:153], v[108:111], v[90:93], v[206:209]
ds_write_b128 v211, v[138:141] offset:36864
v_mfma_f32_16x16x32_bf16 v[138:141], v[78:81], v[90:93], 0
v_cvt_pk_bf16_f32 v142, v146, v147
v_cvt_pk_bf16_f32 v143, v148, v149
v_mfma_f32_16x16x32_bf16 v[146:149], v[102:105], v[90:93], 0
v_cvt_pk_bf16_f32 v175, v156, v157
v_cvt_pk_bf16_f32 v176, v158, v159
v_mfma_f32_16x16x16_bf16 v[138:141], v[82:83], v[94:95], v[138:141]
ds_write_b64 v212, v[142:143] offset:36864
v_mfma_f32_16x16x32_bf16 v[142:145], v[96:99], v[90:93], 0
v_cvt_pk_bf16_f32 v177, v160, v161
v_cvt_pk_bf16_f32 v180, v166, 0
v_mfma_f32_16x16x16_bf16 v[150:153], v[112:113], v[94:95], v[150:153]
v_cvt_pk_bf16_f32 v178, v162, v163
v_cvt_pk_bf16_f32 v179, v164, v165
v_mfma_f32_16x16x32_bf16 v[166:169], v[190:193], v[174:177], 0
v_exp_f32 v138, v138
v_mfma_f32_16x16x32_bf16 v[154:157], v[114:117], v[174:177], 0
v_exp_f32 v139, v139
v_mfma_f32_16x16x32_bf16 v[158:161], v[122:125], v[174:177], 0
v_exp_f32 v140, v140
v_mfma_f32_16x16x32_bf16 v[162:165], v[130:133], v[174:177], 0
v_exp_f32 v141, v141
v_mfma_f32_16x16x16_bf16 v[142:145], v[100:101], v[94:95], v[142:145]
v_exp_f32 v150, v150
v_mfma_f32_16x16x32_bf16 v[166:169], v[190:193], v[178:181], v[166:169]
v_cvt_pk_bf16_f32 v174, v138, v139
v_cvt_pk_bf16_f32 v175, v140, v141
v_mfma_f32_16x16x32_bf16 v[154:157], v[118:121], v[178:181], v[154:157]
v_exp_f32 v142, v142
v_mfma_f32_16x16x32_bf16 v[158:161], v[126:129], v[178:181], v[158:161]
v_rcp_f32 v167, v166
v_mfma_f32_16x16x32_bf16 v[162:165], v[134:137], v[178:181], v[162:165]
v_max3_u32 v218, v218, v166, v167
v_mul_f32 v167, s3, v167
v_mfma_f32_16x16x16_bf16 v[146:149], v[106:107], v[94:95], v[146:149]
v_mul_f32 v154, v154, v167
v_mul_f32 v155, v155, v167
v_mul_f32 v156, v156, v167
v_mul_f32 v157, v157, v167
v_cvt_pk_bf16_f32 v154, v154, v155
v_mul_f32 v158, v158, v167
v_mul_f32 v159, v159, v167
v_mul_f32 v160, v160, v167
v_mul_f32 v161, v161, v167
v_cvt_pk_bf16_f32 v155, v156, v157
v_cvt_pk_bf16_f32 v156, v158, v159
v_cvt_pk_bf16_f32 v157, v160, v161
v_mul_f32 v162, v162, v167
v_mul_f32 v163, v163, v167
v_mul_f32 v164, v164, v167
v_mul_f32 v165, v165, v167
v_mfma_f32_16x16x32_bf16 v[166:169], v[72:75], v[108:111], v[206:209]
ds_write_b128 v211, v[154:157] offset:43008
v_mfma_f32_16x16x32_bf16 v[154:157], v[72:75], v[78:81], 0
v_cvt_pk_bf16_f32 v158, v162, v163
v_cvt_pk_bf16_f32 v159, v164, v165
v_mfma_f32_16x16x32_bf16 v[162:165], v[72:75], v[102:105], 0
v_exp_f32 v143, v143
v_mfma_f32_16x16x16_bf16 v[154:157], v[76:77], v[82:83], v[154:157]
ds_write_b64 v212, v[158:159] offset:43008
v_mfma_f32_16x16x32_bf16 v[158:161], v[72:75], v[96:99], 0
v_exp_f32 v144, v144
v_mfma_f32_16x16x16_bf16 v[162:165], v[76:77], v[106:107], v[162:165]
v_exp_f32 v145, v145
v_mfma_f32_16x16x16_bf16 v[158:161], v[76:77], v[100:101], v[158:161]
v_cvt_pk_bf16_f32 v176, v142, v143
v_cvt_pk_bf16_f32 v177, v144, v145
v_mfma_f32_16x16x16_bf16 v[166:169], v[76:77], v[112:113], v[166:169]
v_cvt_pk_bf16_f32 v180, v150, 0
v_exp_f32 v146, v146
v_mfma_f32_16x16x32_bf16 v[150:153], v[190:193], v[174:177], 0
v_exp_f32 v147, v147
v_mfma_f32_16x16x32_bf16 v[138:141], v[114:117], v[174:177], 0
s_waitcnt lgkmcnt(0)
v_exp_f32 v148, v148
v_mfma_f32_16x16x32_bf16 v[142:145], v[122:125], v[174:177], 0
s_barrier
ds_read_b128 v[170:173], v210 offset:36864
v_exp_f32 v149, v149
v_mov_b32_dpp v154, v158 quad_perm:[0,1,2,3] row_mask:0x2 bank_mask:0xf
v_cvt_pk_bf16_f32 v178, v146, v147
v_cvt_pk_bf16_f32 v179, v148, v149
v_mfma_f32_16x16x32_bf16 v[146:149], v[130:133], v[174:177], 0
v_mov_b32_dpp v154, v162 quad_perm:[0,1,2,3] row_mask:0x4 bank_mask:0xf
v_mfma_f32_16x16x32_bf16 v[150:153], v[190:193], v[178:181], v[150:153]
ds_read_b128 v[182:185], v210 offset:37888
v_mov_b32_dpp v154, v167 quad_perm:[0,1,2,3] row_mask:0x8 bank_mask:0xf
v_mfma_f32_16x16x32_bf16 v[138:141], v[118:121], v[178:181], v[138:141]
v_exp_f32 v154, v154
v_mfma_f32_16x16x32_bf16 v[142:145], v[126:129], v[178:181], v[142:145]
v_cvt_pk_bf16_f32 v154, v154, 0
v_rcp_f32 v151, v150
v_mfma_f32_16x16x32_bf16 v[146:149], v[134:137], v[178:181], v[146:149]
s_waitcnt lgkmcnt(1)
ds_write_b16 v214, v154
v_mfma_f32_16x16x32_bf16 v[0:3], a[144:147], v[170:173], v[0:3]
ds_read_b128 v[84:87], v215
ds_read_b128 v[88:91], v215 offset:16
v_mfma_f32_16x16x32_bf16 v[4:7], a[168:171], v[170:173], v[4:7]
ds_read_b128 v[186:189], v210 offset:38912
ds_read_b128 v[174:177], v217
v_mfma_f32_16x16x32_bf16 v[8:11], a[192:195], v[170:173], v[8:11]
s_waitcnt lgkmcnt(5)
ds_read_b128 v[170:173], v210 offset:39936
ds_read_b128 v[178:181], v217 offset:528
v_mfma_f32_16x16x32_bf16 v[0:3], a[148:151], v[182:185], v[0:3]
v_mfma_f32_16x16x32_bf16 v[4:7], a[172:175], v[182:185], v[4:7]
v_mfma_f32_16x16x32_bf16 v[8:11], a[196:199], v[182:185], v[8:11]
ds_read_b128 v[182:185], v210 offset:40960
s_waitcnt lgkmcnt(6)
v_mfma_f32_16x16x32_bf16 v[166:169], v[84:87], v[190:193], 0
v_mfma_f32_16x16x32_bf16 v[154:157], v[84:87], v[114:117], 0
v_mfma_f32_16x16x32_bf16 v[158:161], v[84:87], v[122:125], 0
v_mfma_f32_16x16x32_bf16 v[162:165], v[84:87], v[130:133], 0
s_waitcnt lgkmcnt(5)
v_mfma_f32_16x16x32_bf16 v[166:169], v[88:91], v[190:193], v[166:169]
s_waitcnt lgkmcnt(4)
v_mfma_f32_16x16x32_bf16 v[0:3], a[152:155], v[186:189], v[0:3]
v_mfma_f32_16x16x32_bf16 v[154:157], v[88:91], v[118:121], v[154:157]
v_rcp_f32 v167, v166
v_mfma_f32_16x16x32_bf16 v[4:7], a[176:179], v[186:189], v[4:7]
v_max3_u32 v218, v218, v166, v167
v_max3_u32 v218, v218, v150, v151
v_mfma_f32_16x16x32_bf16 v[158:161], v[88:91], v[126:129], v[158:161]
v_mul_f32 v151, s3, v151
v_mul_f32 v138, v138, v151
v_mfma_f32_16x16x32_bf16 v[8:11], a[200:203], v[186:189], v[8:11]
ds_read_b128 v[186:189], v210 offset:41984
v_mul_f32 v139, v139, v151
v_mfma_f32_16x16x32_bf16 v[162:165], v[88:91], v[134:137], v[162:165]
s_waitcnt lgkmcnt(3)
v_mul_f32 v140, v140, v151
v_mul_f32 v141, v141, v151
v_mfma_f32_16x16x32_bf16 v[0:3], a[156:159], v[170:173], v[0:3]
v_cvt_pk_bf16_f32 v138, v138, v139
v_mul_f32 v142, v142, v151
v_mfma_f32_16x16x32_bf16 v[4:7], a[180:183], v[170:173], v[4:7]
v_mul_f32 v143, v143, v151
v_mul_f32 v144, v144, v151
v_mfma_f32_16x16x32_bf16 v[8:11], a[204:207], v[170:173], v[8:11]
s_waitcnt lgkmcnt(1)
ds_read_b128 v[170:173], v210 offset:43008
v_mul_f32 v145, v145, v151
v_mfma_f32_16x16x32_bf16 v[0:3], a[160:163], v[182:185], v[0:3]
v_cvt_pk_bf16_f32 v139, v140, v141
v_cvt_pk_bf16_f32 v140, v142, v143
v_mfma_f32_16x16x32_bf16 v[4:7], a[184:187], v[182:185], v[4:7]
v_cvt_pk_bf16_f32 v141, v144, v145
v_mul_f32 v146, v146, v151
v_mfma_f32_16x16x32_bf16 v[8:11], a[208:211], v[182:185], v[8:11]
s_waitcnt lgkmcnt(1)
ds_read_b128 v[182:185], v210 offset:44032
ds_write_b128 v211, v[138:141] offset:49152
v_mfma_f32_16x16x32_bf16 v[0:3], a[164:167], v[186:189], v[0:3]
v_mul_f32 v147, v147, v151
v_mul_f32 v148, v148, v151
v_mfma_f32_16x16x32_bf16 v[4:7], a[188:191], v[186:189], v[4:7]
v_mul_f32 v149, v149, v151
v_cvt_pk_bf16_f32 v142, v146, v147
v_mfma_f32_16x16x32_bf16 v[8:11], a[212:215], v[186:189], v[8:11]
s_waitcnt lgkmcnt(2)
ds_read_b128 v[186:189], v210 offset:45056
v_cvt_pk_bf16_f32 v143, v148, v149
v_mfma_f32_16x16x32_bf16 v[12:15], a[144:147], v[170:173], v[12:15]
ds_write_b64 v212, v[142:143] offset:49152
v_mfma_f32_16x16x32_bf16 v[16:19], a[168:171], v[170:173], v[16:19]
v_cvt_pk_bf16_f32 v72, v0, v1
v_cvt_pk_bf16_f32 v73, v2, v3
v_mfma_f32_16x16x32_bf16 v[20:23], a[192:195], v[170:173], v[20:23]
s_waitcnt lgkmcnt(3)
ds_read_b128 v[170:173], v210 offset:46080
buffer_store_dwordx2 v[72:73], v203, s[8:11], s38 offen
v_cvt_pk_bf16_f32 v74, v4, v5
v_mfma_f32_16x16x32_bf16 v[12:15], a[148:151], v[182:185], v[12:15]
v_cvt_pk_bf16_f32 v75, v6, v7
v_mov_b32_dpp v154, v158 quad_perm:[0,1,2,3] row_mask:0x2 bank_mask:0xf
v_mfma_f32_16x16x32_bf16 v[16:19], a[172:175], v[182:185], v[16:19]
v_mul_f32 v167, s3, v167
v_mov_b32_dpp v154, v162 quad_perm:[0,1,2,3] row_mask:0x4 bank_mask:0xf
v_mfma_f32_16x16x32_bf16 v[20:23], a[196:199], v[182:185], v[20:23]
s_waitcnt lgkmcnt(2)
ds_read_b128 v[182:185], v210 offset:47104
v_mul_f32 v154, v154, v167
v_mfma_f32_16x16x32_bf16 v[12:15], a[152:155], v[186:189], v[12:15]
v_cvt_pk_bf16_f32 v154, v154, 0
v_cvt_pk_bf16_f32 v76, v8, v9
v_mfma_f32_16x16x32_bf16 v[16:19], a[176:179], v[186:189], v[16:19]
s_waitcnt vmcnt(1) lgkmcnt(1)
ds_write_b16 v214, v154
v_mfma_f32_16x16x32_bf16 v[20:23], a[200:203], v[186:189], v[20:23]
s_barrier
v_mfma_f32_16x16x32_bf16 v[12:15], a[156:159], v[170:173], v[12:15]
ds_read_b128 v[186:189], v210 offset:48128
ds_read_b128 v[84:87], v200
v_mfma_f32_16x16x32_bf16 v[16:19], a[180:183], v[170:173], v[16:19]
ds_read_b128 v[92:95], v201
ds_read_b128 v[100:103], v202
v_mfma_f32_16x16x32_bf16 v[20:23], a[204:207], v[170:173], v[20:23]
s_waitcnt lgkmcnt(5)
ds_read_b128 v[170:173], v210 offset:49152
ds_read_b128 v[88:91], v194 offset:16
v_mfma_f32_16x16x32_bf16 v[12:15], a[160:163], v[182:185], v[12:15]
ds_read_b128 v[96:99], v195 offset:16
buffer_store_dwordx2 v[74:75], v203, s[8:11], s38 offen offset:32
v_cvt_pk_bf16_f32 v77, v10, v11
v_mfma_f32_16x16x32_bf16 v[16:19], a[184:187], v[182:185], v[16:19]
s_mul_hi_u32 s41, s35, 58835169
ds_read_b128 v[104:107], v196 offset:16
v_add_u32 v215, 1408, v215
v_mfma_f32_16x16x32_bf16 v[20:23], a[208:211], v[182:185], v[20:23]
s_waitcnt lgkmcnt(7)
ds_read_b128 v[182:185], v210 offset:50176
s_mul_i32 s42, s41, 73
v_mfma_f32_16x16x32_bf16 v[12:15], a[164:167], v[186:189], v[12:15]
s_waitcnt lgkmcnt(7)
ds_read_b64 v[112:113], v215 offset:528
s_sub_u32 s42, s35, s42
v_mfma_f32_16x16x32_bf16 v[16:19], a[188:191], v[186:189], v[16:19]
s_mul_i32 s43, s41, 1373568
s_mul_i32 s51, s42, 2688
s_add_u32 s43, s43, s51
v_mfma_f32_16x16x32_bf16 v[20:23], a[212:215], v[186:189], v[20:23]
s_mov_b32 s39, s37
ds_read_b128 v[186:189], v210 offset:51200
v_cvt_pk_bf16_f32 v78, v12, v13
v_mfma_f32_16x16x32_bf16 v[0:3], v[174:177], v[84:87], 0
s_waitcnt lgkmcnt(6)
ds_read_b128 v[84:87], v194
v_cvt_pk_bf16_f32 v79, v14, v15
v_mfma_f32_16x16x32_bf16 v[12:15], v[174:177], v[92:95], 0
s_cmp_lt_u32 s35, s34
ds_read_b128 v[92:95], v195
v_cvt_pk_bf16_f32 v80, v16, v17
v_mfma_f32_16x16x32_bf16 v[24:27], a[144:147], v[170:173], v[24:27]
s_cselect_b32 s37, s43, 1879048192
v_cvt_pk_bf16_f32 v81, v18, v19
v_cvt_pk_bf16_f32 v82, v20, v21
v_mfma_f32_16x16x32_bf16 v[28:31], a[168:171], v[170:173], v[28:31]
s_add_u32 s35, s35, 32
v_cvt_pk_bf16_f32 v83, v22, v23
s_cmp_eq_u32 s42, 0
v_mfma_f32_16x16x32_bf16 v[32:35], a[192:195], v[170:173], v[32:35]
s_waitcnt lgkmcnt(4)
ds_read_b128 v[170:173], v210 offset:52224
s_cselect_b32 s44, 536870911, s72
v_mfma_f32_16x16x32_bf16 v[24:27], a[148:151], v[182:185], v[24:27]
s_cmp_eq_u32 s42, 72
buffer_store_dwordx2 v[76:77], v203, s[8:11], s38 offen offset:64
s_cselect_b32 s44, 939524095, s44
v_mfma_f32_16x16x32_bf16 v[28:31], a[172:175], v[182:185], v[28:31]
s_cmp_eq_u32 s41, 0
s_cselect_b32 s40, 1879048192, s37
v_mfma_f32_16x16x32_bf16 v[32:35], a[196:199], v[182:185], v[32:35]
s_waitcnt lgkmcnt(3)
ds_read_b128 v[182:185], v210 offset:53248
s_add_u32 m0, s45, 0
v_mfma_f32_16x16x32_bf16 v[24:27], a[152:155], v[186:189], v[24:27]
v_mfma_f32_16x16x32_bf16 v[28:31], a[176:179], v[186:189], v[28:31]
v_mfma_f32_16x16x32_bf16 v[32:35], a[200:203], v[186:189], v[32:35]
ds_read_b128 v[186:189], v210 offset:54272
s_waitcnt lgkmcnt(2)
v_mfma_f32_16x16x32_bf16 v[24:27], a[156:159], v[170:173], v[24:27]
v_mfma_f32_16x16x32_bf16 v[28:31], a[180:183], v[170:173], v[28:31]
v_mfma_f32_16x16x32_bf16 v[32:35], a[204:207], v[170:173], v[32:35]
s_waitcnt lgkmcnt(1)
v_mfma_f32_16x16x32_bf16 v[24:27], a[160:163], v[182:185], v[24:27]
v_mfma_f32_16x16x32_bf16 v[28:31], a[184:187], v[182:185], v[28:31]
v_mfma_f32_16x16x32_bf16 v[32:35], a[208:211], v[182:185], v[32:35]
ds_read_b128 v[182:185], v210 offset:18432
s_waitcnt lgkmcnt(1)
v_mfma_f32_16x16x32_bf16 v[24:27], a[164:167], v[186:189], v[24:27]
v_smfmac_f32_16x16x64_bf16 v[0:3], v[178:181], v[84:91], v213
ds_read_b128 v[84:87], v197
ds_read_b128 v[88:91], v197 offset:16
v_mfma_f32_16x16x32_bf16 v[28:31], a[188:191], v[186:189], v[28:31]
v_cvt_pk_bf16_f32 v116, v24, v25
v_cvt_pk_bf16_f32 v117, v26, v27
v_mfma_f32_16x16x32_bf16 v[24:27], v[174:177], v[100:103], 0
ds_read_b128 v[100:103], v196
ds_read_b128 v[174:177], v217 offset:1056
v_mfma_f32_16x16x32_bf16 v[32:35], a[212:215], v[186:189], v[32:35]
v_cvt_pk_bf16_f32 v124, v28, v29
v_cvt_pk_bf16_f32 v125, v30, v31
v_smfmac_f32_16x16x64_bf16 v[12:15], v[178:181], v[92:99], v213
s_waitcnt lgkmcnt(4)
ds_read_b128 v[92:95], v198
ds_read_b128 v[96:99], v198 offset:16
v_mfma_f32_16x16x32_bf16 v[138:141], a[0:3], v[182:185], 0
ds_read_b128 v[186:189], v210 offset:19456
v_cvt_pk_bf16_f32 v132, v32, v33
v_mfma_f32_16x16x32_bf16 v[142:145], a[24:27], v[182:185], 0
v_cvt_pk_bf16_f32 v133, v34, v35
v_mfma_f32_16x16x32_bf16 v[146:149], a[48:51], v[182:185], 0
buffer_store_dwordx2 v[78:79], v204, s[8:11], s38 offen
s_waitcnt lgkmcnt(4)
v_smfmac_f32_16x16x64_bf16 v[24:27], v[178:181], v[100:107], v213
s_waitcnt lgkmcnt(3)
ds_read_b128 v[100:103], v199
ds_read_b128 v[104:107], v199 offset:16
v_smfmac_f32_16x16x64_bf16 v[0:3], v[174:177], v[84:91], v213
ds_read_b128 v[84:87], v200 offset:32
ds_read_b128 v[178:181], v217 offset:1584
v_mfma_f32_16x16x32_bf16 v[150:153], a[216:219], v[182:185], 0
ds_read_b128 v[88:91], v194 offset:48
s_waitcnt lgkmcnt(6)
v_smfmac_f32_16x16x64_bf16 v[12:15], v[174:177], v[92:99], v213
ds_read_b128 v[92:95], v201 offset:32
ds_read_b128 v[96:99], v195 offset:48
v_mfma_f32_16x16x32_bf16 v[154:157], a[240:243], v[182:185], 0
v_mul_f32 v119, v0, v0
v_add_f32 v118, v0, v1
v_mfma_f32_16x16x32_bf16 v[158:161], v[232:235], v[182:185], 0
v_mul_f32 v127, v12, v12
v_add_f32 v126, v12, v13
v_mfma_f32_16x16x32_bf16 v[162:165], v[182:185], a[72:75], 0
v_fmac_f32 v119, v1, v1
v_fmac_f32 v127, v13, v13
v_mfma_f32_16x16x32_bf16 v[166:169], v[182:185], a[96:99], 0
s_waitcnt lgkmcnt(5)
v_add_f32 v118, v118, v2
v_add_f32 v126, v126, v14
v_smfmac_f32_16x16x64_bf16 v[24:27], v[174:177], v[100:107], v213
ds_read_b128 v[100:103], v202 offset:32
ds_read_b128 v[174:177], v217 offset:2112
v_mfma_f32_16x16x32_bf16 v[170:173], v[182:185], a[120:123], 0
s_waitcnt lgkmcnt(5)
ds_read_b128 v[104:107], v196 offset:48
ds_read_b128 v[182:185], v210 offset:20480
v_mfma_f32_16x16x32_bf16 v[4:7], v[178:181], v[84:87], 0
ds_read_b128 v[84:87], v194 offset:32
v_mul_f32 v135, v24, v24
v_mfma_f32_16x16x32_bf16 v[138:141], a[4:7], v[186:189], v[138:141]
s_waitcnt lgkmcnt(6)
buffer_store_dwordx2 v[80:81], v204, s[8:11], s38 offen offset:32
v_add_f32 v134, v24, v25
v_mfma_f32_16x16x32_bf16 v[16:19], v[178:181], v[92:95], 0
ds_read_b128 v[92:95], v195 offset:32
v_fmac_f32 v135, v25, v25
v_mfma_f32_16x16x32_bf16 v[142:145], a[28:31], v[186:189], v[142:145]
s_waitcnt lgkmcnt(5)
v_add_f32 v134, v134, v26
v_fmac_f32 v135, v26, v26
v_mfma_f32_16x16x32_bf16 v[28:31], v[178:181], v[100:103], 0
ds_read_b128 v[100:103], v196 offset:32
ds_read_b128 v[178:181], v217 offset:2640
v_mfma_f32_16x16x32_bf16 v[146:149], a[52:55], v[186:189], v[146:149]
v_fmac_f32 v119, v2, v2
v_fmac_f32 v127, v14, v14
v_mfma_f32_16x16x32_bf16 v[150:153], a[220:223], v[186:189], v[150:153]
v_add_f32 v134, v134, v27
v_fmac_f32 v135, v27, v27
v_mfma_f32_16x16x32_bf16 v[154:157], a[244:247], v[186:189], v[154:157]
s_waitcnt lgkmcnt(3)
v_add_f32 v118, v118, v3
v_add_f32 v126, v126, v15
v_smfmac_f32_16x16x64_bf16 v[4:7], v[174:177], v[84:91], v213
s_waitcnt lgkmcnt(2)
ds_read_b128 v[84:87], v197 offset:32
ds_read_b128 v[88:91], v197 offset:48
v_smfmac_f32_16x16x64_bf16 v[16:19], v[174:177], v[92:99], v213
ds_read_b128 v[92:95], v198 offset:32
ds_read_b128 v[96:99], v198 offset:48
v_mfma_f32_16x16x32_bf16 v[158:161], v[236:239], v[186:189], v[158:161]
s_waitcnt lgkmcnt(5)
v_fmac_f32 v119, v3, v3
v_fmac_f32 v127, v15, v15
v_smfmac_f32_16x16x64_bf16 v[28:31], v[174:177], v[100:107], v213
ds_read_b128 v[100:103], v199 offset:32
ds_read_b128 v[104:107], v199 offset:48
v_mfma_f32_16x16x32_bf16 v[162:165], v[186:189], a[76:79], v[162:165]
ds_read_b128 v[174:177], v217 offset:3168
v_mfma_f32_16x16x32_bf16 v[166:169], v[186:189], a[100:103], v[166:169]
v_mfma_f32_16x16x32_bf16 v[170:173], v[186:189], a[124:127], v[170:173]
ds_read_b128 v[186:189], v210 offset:21504
s_waitcnt lgkmcnt(6)
v_smfmac_f32_16x16x64_bf16 v[4:7], v[178:181], v[84:91], v213
ds_read_b128 v[84:87], v200 offset:64
ds_read_b128 v[88:91], v194 offset:80
v_mfma_f32_16x16x32_bf16 v[138:141], a[8:11], v[182:185], v[138:141]
s_waitcnt lgkmcnt(6)
buffer_store_dwordx2 v[82:83], v204, s[8:11], s38 offen offset:64
s_nop 1
v_add_f32 v118, v118, v4
v_smfmac_f32_16x16x64_bf16 v[16:19], v[178:181], v[92:99], v213
ds_read_b128 v[92:95], v201 offset:64
ds_read_b128 v[96:99], v195 offset:80
v_mfma_f32_16x16x32_bf16 v[142:145], a[32:35], v[182:185], v[142:145]
s_waitcnt lgkmcnt(6)
v_fmac_f32 v119, v4, v4
v_add_f32 v118, v118, v5
v_smfmac_f32_16x16x64_bf16 v[28:31], v[178:181], v[100:107], v213
ds_read_b128 v[100:103], v202 offset:64
ds_read_b128 v[178:181], v217 offset:3696
v_mfma_f32_16x16x32_bf16 v[146:149], a[56:59], v[182:185], v[146:149]
ds_read_b128 v[104:107], v196 offset:80
v_add_f32 v126, v126, v16
v_mfma_f32_16x16x32_bf16 v[150:153], a[224:227], v[182:185], v[150:153]
s_waitcnt lgkmcnt(6)
v_add_f32 v134, v134, v28
v_fmac_f32 v135, v28, v28
v_mfma_f32_16x16x32_bf16 v[8:11], v[174:177], v[84:87], 0
ds_read_b128 v[84:87], v194 offset:64
v_fmac_f32 v127, v16, v16
v_mfma_f32_16x16x32_bf16 v[154:157], a[248:251], v[182:185], v[154:157]
s_waitcnt lgkmcnt(5)
v_add_f32 v134, v134, v29
v_fmac_f32 v135, v29, v29
v_mfma_f32_16x16x32_bf16 v[20:23], v[174:177], v[92:95], 0
ds_read_b128 v[92:95], v195 offset:64
v_fmac_f32 v119, v5, v5
v_mfma_f32_16x16x32_bf16 v[158:161], v[240:243], v[182:185], v[158:161]
s_waitcnt lgkmcnt(4)
v_add_f32 v126, v126, v17
v_fmac_f32 v127, v17, v17
v_mfma_f32_16x16x32_bf16 v[32:35], v[174:177], v[100:103], 0
ds_read_b128 v[100:103], v196 offset:64
ds_read_b128 v[174:177], v217 offset:4224
v_mfma_f32_16x16x32_bf16 v[162:165], v[182:185], a[80:83], v[162:165]
v_add_f32 v134, v134, v30
v_fmac_f32 v135, v30, v30
v_mfma_f32_16x16x32_bf16 v[166:169], v[182:185], a[104:107], v[166:169]
s_waitcnt lgkmcnt(3)
v_add_f32 v118, v118, v6
v_fmac_f32 v119, v6, v6
v_smfmac_f32_16x16x64_bf16 v[8:11], v[178:181], v[84:91], v213
ds_read_b128 v[84:87], v197 offset:64
ds_read_b128 v[88:91], v197 offset:80
v_mfma_f32_16x16x32_bf16 v[170:173], v[182:185], a[128:131], v[170:173]
s_waitcnt lgkmcnt(4)
ds_read_b128 v[182:185], v210 offset:22528
v_add_f32 v126, v126, v18
v_smfmac_f32_16x16x64_bf16 v[20:23], v[178:181], v[92:99], v213
ds_read_b128 v[92:95], v198 offset:64
ds_read_b128 v[96:99], v198 offset:80
v_mfma_f32_16x16x32_bf16 v[138:141], a[12:15], v[186:189], v[138:141]
s_waitcnt lgkmcnt(6)
v_fmac_f32 v127, v18, v18
v_add_f32 v134, v134, v31
v_smfmac_f32_16x16x64_bf16 v[32:35], v[178:181], v[100:107], v213
ds_read_b128 v[100:103], v199 offset:64
ds_read_b128 v[104:107], v199 offset:80
v_mfma_f32_16x16x32_bf16 v[142:145], a[36:39], v[186:189], v[142:145]
v_fmac_f32 v135, v31, v31
v_add_f32 v118, v118, v7
v_mfma_f32_16x16x32_bf16 v[146:149], a[60:63], v[186:189], v[146:149]
v_fmac_f32 v119, v7, v7
v_add_f32 v126, v126, v19
v_mfma_f32_16x16x32_bf16 v[150:153], a[228:231], v[186:189], v[150:153]
s_waitcnt lgkmcnt(5)
v_fmac_f32 v127, v19, v19
v_and_b32 v180, s44, v208
v_smfmac_f32_16x16x64_bf16 v[8:11], v[174:177], v[84:91], v213
buffer_store_dwordx2 v[116:117], v205, s[8:11], s38 offen
v_add_u32 v216, 1408, v216
v_mfma_f32_16x16x32_bf16 v[154:157], a[252:255], v[186:189], v[154:157]
v_mov_b32 v181, 0
s_waitcnt lgkmcnt(2)
v_smfmac_f32_16x16x64_bf16 v[20:23], v[174:177], v[92:99], v213
v_add_f32 v118, v118, v8
v_fmac_f32 v119, v8, v8
v_mfma_f32_16x16x32_bf16 v[158:161], v[244:247], v[186:189], v[158:161]
s_waitcnt lgkmcnt(0)
v_add_f32 v118, v118, v9
v_fmac_f32 v119, v9, v9
v_smfmac_f32_16x16x64_bf16 v[32:35], v[174:177], v[100:107], v213
v_add_f32 v126, v126, v20
v_fmac_f32 v127, v20, v20
v_mfma_f32_16x16x32_bf16 v[162:165], v[186:189], a[84:87], v[162:165]
v_add_f32 v126, v126, v21
v_fmac_f32 v127, v21, v21
v_mfma_f32_16x16x32_bf16 v[166:169], v[186:189], a[108:111], v[166:169]
v_add_f32 v134, v134, v32
v_fmac_f32 v135, v32, v32
v_mfma_f32_16x16x32_bf16 v[170:173], v[186:189], a[132:135], v[170:173]
ds_read_b128 v[186:189], v210 offset:23552
v_add_f32 v134, v134, v33
v_mfma_f32_16x16x32_bf16 v[138:141], a[16:19], v[182:185], v[138:141]
v_fmac_f32 v135, v33, v33
v_add_f32 v134, v134, v34
v_mfma_f32_16x16x32_bf16 v[142:145], a[40:43], v[182:185], v[142:145]
v_fmac_f32 v135, v34, v34
v_add_f32 v118, v118, v10
v_mfma_f32_16x16x32_bf16 v[146:149], a[64:67], v[182:185], v[146:149]
v_fmac_f32 v119, v10, v10
v_add_f32 v126, v126, v22
v_mfma_f32_16x16x32_bf16 v[150:153], a[232:235], v[182:185], v[150:153]
v_fmac_f32 v127, v22, v22
v_add_f32 v134, v134, v35
v_mfma_f32_16x16x32_bf16 v[154:157], v[224:227], v[182:185], v[154:157]
v_fmac_f32 v135, v35, v35
v_add_f32 v118, v118, v11
v_mfma_f32_16x16x32_bf16 v[158:161], v[248:251], v[182:185], v[158:161]
v_fmac_f32 v119, v11, v11
v_add_f32 v126, v126, v23
v_mfma_f32_16x16x32_bf16 v[162:165], v[182:185], a[88:91], v[162:165]
v_fmac_f32 v127, v23, v23
v_add_u32 v214, 1408, v214
v_mfma_f32_16x16x32_bf16 v[166:169], v[182:185], a[112:115], v[166:169]
v_permlane16_swap_b32 v134, v135
v_mfma_f32_16x16x32_bf16 v[170:173], v[182:185], a[136:139], v[170:173]
s_waitcnt lgkmcnt(0)
ds_read_b128 v[182:185], v210 offset:24576
v_add_f32 v134, v134, v135
v_mfma_f32_16x16x32_bf16 v[138:141], a[20:23], v[186:189], v[138:141]
v_permlane16_swap_b32 v118, v119
v_mfma_f32_16x16x32_bf16 v[142:145], a[44:47], v[186:189], v[142:145]
v_permlane16_swap_b32 v126, v127
v_mfma_f32_16x16x32_bf16 v[146:149], a[68:71], v[186:189], v[146:149]
v_cvt_pk_bf16_f32 v78, v138, v139
v_cvt_pk_bf16_f32 v79, v140, v141
v_mfma_f32_16x16x32_bf16 v[150:153], a[236:239], v[186:189], v[150:153]
v_cvt_pk_bf16_f32 v80, v142, v143
v_cvt_pk_bf16_f32 v81, v144, v145
v_mfma_f32_16x16x32_bf16 v[154:157], v[228:231], v[186:189], v[154:157]
v_cvt_pk_bf16_f32 v82, v146, v147
v_cvt_pk_bf16_f32 v83, v148, v149
v_mfma_f32_16x16x32_bf16 v[158:161], v[252:255], v[186:189], v[158:161]
v_cvt_pk_bf16_f32 v72, v150, v151
v_cvt_pk_bf16_f32 v73, v152, v153
v_mfma_f32_16x16x32_bf16 v[162:165], v[186:189], a[92:95], v[162:165]
v_cvt_pk_bf16_f32 v74, v154, v155
v_cvt_pk_bf16_f32 v75, v156, v157
v_mfma_f32_16x16x32_bf16 v[166:169], v[186:189], a[116:119], v[166:169]
v_cvt_pk_bf16_f32 v76, v158, v159
v_cvt_pk_bf16_f32 v77, v160, v161
v_mfma_f32_16x16x32_bf16 v[170:173], v[186:189], a[140:143], v[170:173]
s_waitcnt lgkmcnt(0)
ds_read_b128 v[186:189], v210 offset:25600
v_cvt_pk_bf16_f32 v114, v162, v163
v_mfma_f32_16x16x32_bf16 v[138:141], a[0:3], v[182:185], 0
v_cvt_pk_bf16_f32 v115, v164, v165
v_cvt_pk_bf16_f32 v122, v166, v167
v_mfma_f32_16x16x32_bf16 v[142:145], a[24:27], v[182:185], 0
v_cvt_pk_bf16_f32 v123, v168, v169
v_cvt_pk_bf16_f32 v130, v170, v171
v_mfma_f32_16x16x32_bf16 v[146:149], a[48:51], v[182:185], 0
v_cvt_pk_bf16_f32 v131, v172, v173
v_mov_b32 v135, v134
v_mfma_f32_16x16x32_bf16 v[150:153], a[216:219], v[182:185], 0
v_add_f32 v118, v118, v119
v_add_f32 v126, v126, v127
v_mfma_f32_16x16x32_bf16 v[154:157], a[240:243], v[182:185], 0
v_permlane32_swap_b32 v134, v135
v_mfma_f32_16x16x32_bf16 v[158:161], v[232:235], v[182:185], 0
v_permlane32_swap_b32 v118, v126
v_mfma_f32_16x16x32_bf16 v[162:165], v[182:185], a[72:75], 0
v_add_f32 v134, v134, v135
v_add_f32 v118, v118, v126
v_mfma_f32_16x16x32_bf16 v[166:169], v[182:185], a[96:99], 0
ds_write_b32 v209, v134 offset:512
v_mfma_f32_16x16x32_bf16 v[170:173], v[182:185], a[120:123], 0
s_waitcnt lgkmcnt(1)
ds_read_b128 v[182:185], v210 offset:26624
ds_write_b32 v209, v118
v_mfma_f32_16x16x32_bf16 v[138:141], a[4:7], v[186:189], v[138:141]
buffer_store_dwordx2 v[124:125], v205, s[8:11], s38 offen offset:32
v_mfma_f32_16x16x32_bf16 v[142:145], a[28:31], v[186:189], v[142:145]
v_mfma_f32_16x16x32_bf16 v[146:149], a[52:55], v[186:189], v[146:149]
v_mfma_f32_16x16x32_bf16 v[150:153], a[220:223], v[186:189], v[150:153]
v_mfma_f32_16x16x32_bf16 v[154:157], a[244:247], v[186:189], v[154:157]
v_mfma_f32_16x16x32_bf16 v[158:161], v[236:239], v[186:189], v[158:161]
s_waitcnt lgkmcnt(0)
s_barrier
v_mfma_f32_16x16x32_bf16 v[162:165], v[186:189], a[76:79], v[162:165]
ds_read_b128 v[106:109], v210 offset:56320
ds_read_b128 v[102:105], v210 offset:55296
v_mfma_f32_16x16x32_bf16 v[166:169], v[186:189], a[100:103], v[166:169]
buffer_load_dwordx4 v180, s[4:7], s40 offen nt lds
v_mfma_f32_16x16x32_bf16 v[170:173], v[186:189], a[124:127], v[170:173]
s_add_u32 m0, s45, 4112
s_mov_b32 s46, 8
.p2align 3
F_loop:
ds_read_b128 v[186:189], v210 offset:27648
s_add_u32 s40, s37, 196224
v_mfma_f32_16x16x32_bf16 v[138:141], a[8:11], v[182:185], v[138:141]
buffer_load_dwordx4 v180, s[4:7], s40 offen nt lds
v_mfma_f32_16x16x32_bf16 v[142:145], a[32:35], v[182:185], v[142:145]
s_add_u32 m0, s45, 8224
s_add_u32 s40, s37, 392448
buffer_load_dwordx4 v180, s[4:7], s40 offen nt lds
v_mfma_f32_16x16x32_bf16 v[146:149], a[56:59], v[182:185], v[146:149]
s_add_u32 m0, s45, 12336
s_add_u32 s40, s37, 588672
buffer_load_dwordx4 v180, s[4:7], s40 offen nt lds
v_mfma_f32_16x16x32_bf16 v[150:153], a[224:227], v[182:185], v[150:153]
s_waitcnt lgkmcnt(2)
v_add_f32 v106, v106, v107
v_add_f32 v108, v108, v109
v_mfma_f32_16x16x32_bf16 v[154:157], a[248:251], v[182:185], v[154:157]
s_waitcnt lgkmcnt(1)
v_add_f32 v106, v106, v108
v_add_f32 v102, v102, v103
v_mfma_f32_16x16x32_bf16 v[158:161], v[240:243], v[182:185], v[158:161]
s_add_u32 m0, s45, 16448
ds_read_b128 v[108:111], v215 offset:512
v_add_f32 v104, v104, v105
v_mfma_f32_16x16x32_bf16 v[162:165], v[182:185], a[80:83], v[162:165]
s_add_u32 s40, s37, 784896
v_add_f32 v102, v102, v104
v_mul_f32 v106, s73, v106
v_mfma_f32_16x16x32_bf16 v[166:169], v[182:185], a[104:107], v[166:169]
v_mul_f32 v103, s48, v102
v_mul_f32 v104, s73, v102
v_mfma_f32_16x16x32_bf16 v[170:173], v[182:185], a[128:131], v[170:173]
s_waitcnt lgkmcnt(1)
ds_read_b128 v[182:185], v210 offset:28672
v_fma_f32 v106, -v103, v104, v106
v_mfma_f32_16x16x32_bf16 v[138:141], a[12:15], v[186:189], v[138:141]
v_max_f32 v106, 0, v106
v_add_f32 v106, s49, v106
v_mfma_f32_16x16x32_bf16 v[142:145], a[36:39], v[186:189], v[142:145]
v_rsq_f32 v102, v106
v_mfma_f32_16x16x32_bf16 v[146:149], a[60:63], v[186:189], v[146:149]
v_mul_f32_e64 v103, -v103, v102
v_mfma_f32_16x16x32_bf16 v[150:153], a[228:231], v[186:189], v[150:153]
ds_write_b64 v211, v[102:103] offset:36864
v_mfma_f32_16x16x32_bf16 v[154:157], a[252:255], v[186:189], v[154:157]
s_waitcnt lgkmcnt(1)
buffer_load_dwordx4 v180, s[4:7], s40 offen nt lds
v_mfma_f32_16x16x32_bf16 v[158:161], v[244:247], v[186:189], v[158:161]
s_add_u32 m0, s45, 20560
ds_read_b64 v[118:119], v219
ds_read_b64 v[126:127], v219 offset:256
v_mfma_f32_16x16x32_bf16 v[162:165], v[186:189], a[84:87], v[162:165]
s_add_u32 s40, s37, 981120
ds_read_b64 v[134:135], v219 offset:512
buffer_load_dwordx4 v180, s[4:7], s40 offen nt lds
v_mfma_f32_16x16x32_bf16 v[166:169], v[186:189], a[108:111], v[166:169]
s_add_u32 m0, s45, 24672
s_add_u32 s40, s37, 1177344
buffer_load_dwordx4 v180, s[4:7], s40 offen nt lds
v_mfma_f32_16x16x32_bf16 v[170:173], v[186:189], a[132:135], v[170:173]
s_add_u32 m0, s45, 28784
ds_read_b128 v[186:189], v210 offset:29696
s_add_u32 s40, s37, 1373568
v_mfma_f32_16x16x32_bf16 v[138:141], a[16:19], v[182:185], v[138:141]
buffer_load_dwordx4 v180, s[4:7], s40 offen nt lds
v_mfma_f32_16x16x32_bf16 v[142:145], a[40:43], v[182:185], v[142:145]
s_waitcnt lgkmcnt(3)
v_fma_f32 v220, v0, v118, v119
v_fma_f32 v221, v1, v118, v119
v_mfma_f32_16x16x32_bf16 v[146:149], a[64:67], v[182:185], v[146:149]
s_add_u32 m0, s45, 32896
v_fma_f32 v222, v2, v118, v119
v_fma_f32 v223, v3, v118, v119
v_mfma_f32_16x16x32_bf16 v[150:153], a[232:235], v[182:185], v[150:153]
s_add_u32 s40, s37, 1569792
v_cvt_pk_bf16_f32 v90, v220, v221
v_cvt_pk_bf16_f32 v91, v222, v223
v_mfma_f32_16x16x32_bf16 v[154:157], v[224:227], v[182:185], v[154:157]
v_fma_f32 v220, v4, v118, v119
v_fma_f32 v221, v5, v118, v119
v_mfma_f32_16x16x32_bf16 v[158:161], v[248:251], v[182:185], v[158:161]
v_fma_f32 v222, v6, v118, v119
v_fma_f32 v223, v7, v118, v119
v_mfma_f32_16x16x32_bf16 v[162:165], v[182:185], a[88:91], v[162:165]
v_cvt_pk_bf16_f32 v92, v220, v221
v_cvt_pk_bf16_f32 v93, v222, v223
v_mfma_f32_16x16x32_bf16 v[166:169], v[182:185], a[112:115], v[166:169]
ds_write_b128 v211, v[90:93]
v_mfma_f32_16x16x32_bf16 v[170:173], v[182:185], a[136:139], v[170:173]
s_waitcnt lgkmcnt(1)
v_fma_f32 v220, v8, v118, v119
v_fma_f32 v221, v9, v118, v119
v_mfma_f32_16x16x32_bf16 v[138:141], a[20:23], v[186:189], v[138:141]
buffer_store_dwordx2 v[132:133], v205, s[8:11], s38 offen offset:64
ds_read_b128 v[182:185], v210 offset:30720
v_mfma_f32_16x16x32_bf16 v[142:145], a[44:47], v[186:189], v[142:145]
v_fma_f32 v222, v10, v118, v119
v_fma_f32 v223, v11, v118, v119
v_mfma_f32_16x16x32_bf16 v[146:149], a[68:71], v[186:189], v[146:149]
v_cvt_pk_bf16_f32 v96, v138, v139
v_cvt_pk_bf16_f32 v97, v140, v141
v_mfma_f32_16x16x32_bf16 v[150:153], a[236:239], v[186:189], v[150:153]
v_cvt_pk_bf16_f32 v98, v142, v143
v_cvt_pk_bf16_f32 v99, v144, v145
v_mfma_f32_16x16x32_bf16 v[154:157], v[228:231], v[186:189], v[154:157]
v_cvt_pk_bf16_f32 v100, v146, v147
v_cvt_pk_bf16_f32 v101, v148, v149
v_mfma_f32_16x16x32_bf16 v[158:161], v[252:255], v[186:189], v[158:161]
v_cvt_pk_bf16_f32 v84, v150, v151
v_cvt_pk_bf16_f32 v85, v152, v153
v_mfma_f32_16x16x32_bf16 v[162:165], v[186:189], a[92:95], v[162:165]
v_cvt_pk_bf16_f32 v86, v154, v155
v_cvt_pk_bf16_f32 v87, v156, v157
v_mfma_f32_16x16x32_bf16 v[166:169], v[186:189], a[116:119], v[166:169]
v_cvt_pk_bf16_f32 v88, v158, v159
v_cvt_pk_bf16_f32 v89, v160, v161
v_mfma_f32_16x16x32_bf16 v[170:173], v[186:189], a[140:143], v[170:173]
s_waitcnt lgkmcnt(0)
ds_read_b128 v[186:189], v210 offset:31744
v_cvt_pk_bf16_f32 v116, v162, v163
v_mfma_f32_16x16x32_bf16 v[138:141], a[0:3], v[182:185], 0
v_cvt_pk_bf16_f32 v124, v166, v167
v_cvt_pk_bf16_f32 v125, v168, v169
v_mfma_f32_16x16x32_bf16 v[142:145], a[24:27], v[182:185], 0
v_cvt_pk_bf16_f32 v117, v164, v165
v_cvt_pk_bf16_f32 v94, v220, v221
v_mfma_f32_16x16x32_bf16 v[150:153], v[108:111], v[72:75], v[206:209]
v_cvt_pk_bf16_f32 v95, v222, v223
v_fma_f32 v220, v12, v126, v127
v_mfma_f32_16x16x32_bf16 v[146:149], a[48:51], v[182:185], 0
ds_read_b128 v[182:185], v210 offset:32768
ds_write_b64 v212, v[94:95]
v_mfma_f32_16x16x16_bf16 v[150:153], v[112:113], v[76:77], v[150:153]
s_waitcnt lgkmcnt(2)
v_fma_f32 v221, v13, v126, v127
v_fma_f32 v222, v14, v126, v127
v_mfma_f32_16x16x32_bf16 v[138:141], a[4:7], v[186:189], v[138:141]
v_fma_f32 v223, v15, v126, v127
v_cvt_pk_bf16_f32 v174, v220, v221
v_mfma_f32_16x16x32_bf16 v[142:145], a[28:31], v[186:189], v[142:145]
v_cvt_pk_bf16_f32 v175, v222, v223
v_fma_f32 v220, v16, v126, v127
v_mfma_f32_16x16x32_bf16 v[146:149], a[52:55], v[186:189], v[146:149]
ds_read_b128 v[186:189], v210 offset:33792
v_fma_f32 v221, v17, v126, v127
v_mfma_f32_16x16x32_bf16 v[154:157], v[78:81], v[84:87], 0
s_waitcnt lgkmcnt(2)
v_fma_f32 v222, v18, v126, v127
v_fma_f32 v223, v19, v126, v127
v_mfma_f32_16x16x32_bf16 v[138:141], a[8:11], v[182:185], v[138:141]
v_cvt_pk_bf16_f32 v176, v220, v221
v_cvt_pk_bf16_f32 v177, v222, v223
v_mfma_f32_16x16x32_bf16 v[142:145], a[32:35], v[182:185], v[142:145]
v_fma_f32 v220, v20, v126, v127
v_fma_f32 v221, v21, v126, v127
v_mfma_f32_16x16x32_bf16 v[158:161], v[96:99], v[84:87], 0
v_fma_f32 v222, v22, v126, v127
v_fma_f32 v223, v23, v126, v127
v_mfma_f32_16x16x32_bf16 v[146:149], a[56:59], v[182:185], v[146:149]
ds_read_b128 v[182:185], v210 offset:34816
v_cvt_pk_bf16_f32 v178, v220, v221
v_mfma_f32_16x16x32_bf16 v[166:169], v[108:111], v[84:87], v[206:209]
s_waitcnt lgkmcnt(1)
v_cvt_pk_bf16_f32 v179, v222, v223
v_fma_f32 v220, v24, v134, v135
v_mfma_f32_16x16x32_bf16 v[138:141], a[12:15], v[186:189], v[138:141]
v_fma_f32 v221, v25, v134, v135
v_fma_f32 v222, v26, v134, v135
v_mfma_f32_16x16x32_bf16 v[142:145], a[36:39], v[186:189], v[142:145]
v_fma_f32 v223, v27, v134, v135
v_cvt_pk_bf16_f32 v90, v220, v221
v_mfma_f32_16x16x32_bf16 v[146:149], a[60:63], v[186:189], v[146:149]
ds_read_b128 v[186:189], v210 offset:35840
v_cvt_pk_bf16_f32 v91, v222, v223
v_mfma_f32_16x16x16_bf16 v[154:157], v[82:83], v[88:89], v[154:157]
v_fma_f32 v220, v28, v134, v135
v_fma_f32 v221, v29, v134, v135
v_mfma_f32_16x16x16_bf16 v[158:161], v[100:101], v[88:89], v[158:161]
s_waitcnt lgkmcnt(1)
v_fma_f32 v222, v30, v134, v135
v_fma_f32 v223, v31, v134, v135
v_mfma_f32_16x16x32_bf16 v[138:141], a[16:19], v[182:185], v[138:141]
v_cvt_pk_bf16_f32 v92, v220, v221
v_cvt_pk_bf16_f32 v93, v222, v223
v_mfma_f32_16x16x32_bf16 v[142:145], a[40:43], v[182:185], v[142:145]
ds_write_b128 v211, v[90:93] offset:12288
v_mfma_f32_16x16x16_bf16 v[166:169], v[112:113], v[88:89], v[166:169]
v_fma_f32 v220, v32, v134, v135
v_fma_f32 v221, v33, v134, v135
v_mfma_f32_16x16x32_bf16 v[146:149], a[64:67], v[182:185], v[146:149]
s_waitcnt lgkmcnt(1)
v_fma_f32 v222, v34, v134, v135
v_fma_f32 v223, v35, v134, v135
v_mfma_f32_16x16x32_bf16 v[138:141], a[20:23], v[186:189], v[138:141]
ds_read_b128 v[182:185], v210 offset:30720
v_cvt_pk_bf16_f32 v132, v170, v171
v_mfma_f32_16x16x32_bf16 v[142:145], a[44:47], v[186:189], v[142:145]
v_cvt_pk_bf16_f32 v133, v172, v173
v_cvt_pk_bf16_f32 v94, v220, v221
v_mfma_f32_16x16x32_bf16 v[146:149], a[68:71], v[186:189], v[146:149]
v_cvt_pk_bf16_f32 v102, v138, v139
v_cvt_pk_bf16_f32 v103, v140, v141
v_mfma_f32_16x16x32_bf16 v[138:141], v[78:81], v[72:75], 0
v_cvt_pk_bf16_f32 v104, v142, v143
v_cvt_pk_bf16_f32 v105, v144, v145
v_mfma_f32_16x16x32_bf16 v[142:145], v[96:99], v[72:75], 0
v_cvt_pk_bf16_f32 v106, v146, v147
v_cvt_pk_bf16_f32 v107, v148, v149
v_mfma_f32_16x16x32_bf16 v[146:149], v[102:105], v[72:75], 0
ds_read_b128 v[186:189], v210 offset:31744
v_cvt_pk_bf16_f32 v95, v222, v223
v_mfma_f32_16x16x16_bf16 v[138:141], v[82:83], v[76:77], v[138:141]
buffer_load_dwordx4 v180, s[4:7], s40 offen nt lds
v_mfma_f32_16x16x16_bf16 v[142:145], v[100:101], v[76:77], v[142:145]
ds_write_b128 v211, v[174:177] offset:6144
v_mfma_f32_16x16x16_bf16 v[146:149], v[106:107], v[76:77], v[146:149]
v_exp_f32 v138, v138
v_mfma_f32_16x16x32_bf16 v[162:165], v[102:105], v[84:87], 0
s_waitcnt lgkmcnt(2)
v_exp_f32 v139, v139
v_mfma_f32_16x16x32_bf16 v[118:121], v[182:185], a[72:75], 0
v_exp_f32 v140, v140
v_mfma_f32_16x16x16_bf16 v[162:165], v[106:107], v[88:89], v[162:165]
v_exp_f32 v141, v141
v_mfma_f32_16x16x32_bf16 v[126:129], v[182:185], a[96:99], 0
v_exp_f32 v142, v142
v_mfma_f32_16x16x32_bf16 v[134:137], v[182:185], a[120:123], 0
v_exp_f32 v143, v143
v_mfma_f32_16x16x32_bf16 v[90:93], a[216:219], v[182:185], 0
v_exp_f32 v144, v144
v_mfma_f32_16x16x32_bf16 v[170:173], a[240:243], v[182:185], 0
v_exp_f32 v145, v145
v_mfma_f32_16x16x32_bf16 v[220:223], v[232:235], v[182:185], 0
s_waitcnt lgkmcnt(1)
ds_read_b128 v[182:185], v210 offset:32768
v_cvt_pk_bf16_f32 v174, v138, v139
v_mfma_f32_16x16x32_bf16 v[118:121], v[186:189], a[76:79], v[118:121]
v_exp_f32 v150, v150
v_mfma_f32_16x16x32_bf16 v[126:129], v[186:189], a[100:103], v[126:129]
v_cvt_pk_bf16_f32 v175, v140, v141
v_cvt_pk_bf16_f32 v176, v142, v143
v_mfma_f32_16x16x32_bf16 v[134:137], v[186:189], a[124:127], v[134:137]
v_cvt_pk_bf16_f32 v177, v144, v145
v_cvt_pk_bf16_f32 v180, v150, 0
v_mfma_f32_16x16x32_bf16 v[90:93], a[220:223], v[186:189], v[90:93]
ds_write_b64 v212, v[178:179] offset:6144
v_mfma_f32_16x16x32_bf16 v[170:173], a[244:247], v[186:189], v[170:173]
v_exp_f32 v146, v146
v_mfma_f32_16x16x32_bf16 v[220:223], v[236:239], v[186:189], v[220:223]
s_waitcnt lgkmcnt(1)
ds_read_b128 v[186:189], v210 offset:33792
ds_read_b128 v[72:75], v215
v_mfma_f32_16x16x32_bf16 v[118:121], v[182:185], a[80:83], v[118:121]
v_exp_f32 v147, v147
v_mfma_f32_16x16x32_bf16 v[126:129], v[182:185], a[104:107], v[126:129]
v_exp_f32 v148, v148
v_mfma_f32_16x16x32_bf16 v[134:137], v[182:185], a[128:131], v[134:137]
v_exp_f32 v149, v149
v_mfma_f32_16x16x32_bf16 v[90:93], a[224:227], v[182:185], v[90:93]
v_cvt_pk_bf16_f32 v178, v146, v147
v_cvt_pk_bf16_f32 v179, v148, v149
v_mfma_f32_16x16x32_bf16 v[170:173], a[248:251], v[182:185], v[170:173]
ds_write_b64 v212, v[94:95] offset:12288
v_mfma_f32_16x16x32_bf16 v[220:223], v[240:243], v[182:185], v[220:223]
s_waitcnt lgkmcnt(2)
v_exp_f32 v154, v154
v_mfma_f32_16x16x32_bf16 v[118:121], v[186:189], a[84:87], v[118:121]
ds_read_b128 v[182:185], v210 offset:34816
ds_read_b64 v[76:77], v215 offset:16
v_mfma_f32_16x16x32_bf16 v[126:129], v[186:189], a[108:111], v[126:129]
v_exp_f32 v155, v155
v_mfma_f32_16x16x32_bf16 v[134:137], v[186:189], a[132:135], v[134:137]
v_exp_f32 v156, v156
v_mfma_f32_16x16x32_bf16 v[90:93], a[228:231], v[186:189], v[90:93]
v_exp_f32 v157, v157
v_mfma_f32_16x16x32_bf16 v[170:173], a[252:255], v[186:189], v[170:173]
v_exp_f32 v158, v158
v_mfma_f32_16x16x32_bf16 v[220:223], v[244:247], v[186:189], v[220:223]
ds_read_b128 v[186:189], v210 offset:35840
v_exp_f32 v159, v159
v_mfma_f32_16x16x32_bf16 v[150:153], v[190:193], v[174:177], 0
s_waitcnt lgkmcnt(2)
v_exp_f32 v160, v160
v_mfma_f32_16x16x32_bf16 v[118:121], v[182:185], a[88:91], v[118:121]
v_exp_f32 v161, v161
v_mfma_f32_16x16x32_bf16 v[126:129], v[182:185], a[112:115], v[126:129]
v_exp_f32 v166, v166
v_mfma_f32_16x16x32_bf16 v[134:137], v[182:185], a[136:139], v[134:137]
v_exp_f32 v162, v162
v_mfma_f32_16x16x32_bf16 v[90:93], a[232:235], v[182:185], v[90:93]
v_exp_f32 v163, v163
v_mfma_f32_16x16x32_bf16 v[170:173], v[224:227], v[182:185], v[170:173]
v_exp_f32 v164, v164
v_mfma_f32_16x16x32_bf16 v[220:223], v[248:251], v[182:185], v[220:223]
s_waitcnt lgkmcnt(0)
v_exp_f32 v165, v165
v_mfma_f32_16x16x32_bf16 v[118:121], v[186:189], a[92:95], v[118:121]
v_mfma_f32_16x16x32_bf16 v[126:129], v[186:189], a[116:119], v[126:129]
v_mfma_f32_16x16x32_bf16 v[134:137], v[186:189], a[140:143], v[134:137]
v_cvt_pk_bf16_f32 v118, v118, v119
v_cvt_pk_bf16_f32 v119, v120, v121
v_mfma_f32_16x16x32_bf16 v[90:93], a[236:239], v[186:189], v[90:93]
ds_read_u16 v120, v216
v_cvt_pk_bf16_f32 v126, v126, v127
v_mfma_f32_16x16x32_bf16 v[170:173], v[228:231], v[186:189], v[170:173]
v_cvt_pk_bf16_f32 v127, v128, v129
v_cvt_pk_bf16_f32 v134, v134, v135
v_mfma_f32_16x16x32_bf16 v[220:223], v[252:255], v[186:189], v[220:223]
ds_read_u16 v128, v216 offset:32
v_cvt_pk_bf16_f32 v90, v90, v91
v_mfma_f32_16x16x32_bf16 v[138:141], v[114:117], v[174:177], 0
v_cvt_pk_bf16_f32 v91, v92, v93
v_cvt_pk_bf16_f32 v92, v170, v171
v_mfma_f32_16x16x32_bf16 v[142:145], v[122:125], v[174:177], 0
v_cvt_pk_bf16_f32 v93, v172, v173
v_cvt_pk_bf16_f32 v135, v136, v137
v_mfma_f32_16x16x32_bf16 v[146:149], v[130:133], v[174:177], 0
ds_read_u16 v136, v216 offset:64
v_mov_b32 v121, 0
v_mfma_f32_16x16x32_bf16 v[150:153], v[190:193], v[178:181], v[150:153]
s_waitcnt lgkmcnt(2)
v_mov_b32 v129, 0
v_cvt_pk_bf16_f32 v94, v220, v221
v_mfma_f32_16x16x32_bf16 v[138:141], v[118:121], v[178:181], v[138:141]
s_waitcnt lgkmcnt(1)
v_cvt_pk_bf16_f32 v95, v222, v223
v_mov_b32 v137, 0
v_mfma_f32_16x16x32_bf16 v[142:145], v[126:129], v[178:181], v[142:145]
v_rcp_f32 v151, v150
s_nop 0
v_max3_u32 v218, v218, v150, v151
v_mul_f32 v151, s3, v151
v_mul_f32 v138, v138, v151
v_mul_f32 v139, v139, v151
v_mul_f32 v140, v140, v151
v_mul_f32 v141, v141, v151
v_cvt_pk_bf16_f32 v138, v138, v139
v_mul_f32 v142, v142, v151
s_waitcnt lgkmcnt(0)
v_mfma_f32_16x16x32_bf16 v[146:149], v[134:137], v[178:181], v[146:149]
v_mul_f32 v143, v143, v151
v_mul_f32 v144, v144, v151
v_mul_f32 v145, v145, v151
v_cvt_pk_bf16_f32 v139, v140, v141
v_cvt_pk_bf16_f32 v140, v142, v143
v_cvt_pk_bf16_f32 v141, v144, v145
v_cvt_pk_bf16_f32 v174, v154, v155
v_mul_f32 v146, v146, v151
v_mul_f32 v147, v147, v151
v_mul_f32 v148, v148, v151
v_mul_f32 v149, v149, v151
v_mfma_f32_16x16x32_bf16 v[150:153], v[108:111], v[90:93], v[206:209]
ds_write_b128 v211, v[138:141] offset:36864
v_mfma_f32_16x16x32_bf16 v[138:141], v[78:81], v[90:93], 0
v_cvt_pk_bf16_f32 v142, v146, v147
v_cvt_pk_bf16_f32 v143, v148, v149
v_mfma_f32_16x16x32_bf16 v[146:149], v[102:105], v[90:93], 0
v_cvt_pk_bf16_f32 v175, v156, v157
v_cvt_pk_bf16_f32 v176, v158, v159
v_mfma_f32_16x16x16_bf16 v[138:141], v[82:83], v[94:95], v[138:141]
ds_write_b64 v212, v[142:143] offset:36864
v_mfma_f32_16x16x32_bf16 v[142:145], v[96:99], v[90:93], 0
v_cvt_pk_bf16_f32 v177, v160, v161
v_cvt_pk_bf16_f32 v180, v166, 0
v_mfma_f32_16x16x16_bf16 v[150:153], v[112:113], v[94:95], v[150:153]
v_cvt_pk_bf16_f32 v178, v162, v163
v_cvt_pk_bf16_f32 v179, v164, v165
v_mfma_f32_16x16x32_bf16 v[166:169], v[190:193], v[174:177], 0
v_exp_f32 v138, v138
v_mfma_f32_16x16x32_bf16 v[154:157], v[114:117], v[174:177], 0
v_exp_f32 v139, v139
v_mfma_f32_16x16x32_bf16 v[158:161], v[122:125], v[174:177], 0
v_exp_f32 v140, v140
v_mfma_f32_16x16x32_bf16 v[162:165], v[130:133], v[174:177], 0
v_exp_f32 v141, v141
v_mfma_f32_16x16x16_bf16 v[142:145], v[100:101], v[94:95], v[142:145]
v_exp_f32 v150, v150
v_mfma_f32_16x16x32_bf16 v[166:169], v[190:193], v[178:181], v[166:169]
v_cvt_pk_bf16_f32 v174, v138, v139
v_cvt_pk_bf16_f32 v175, v140, v141
v_mfma_f32_16x16x32_bf16 v[154:157], v[118:121], v[178:181], v[154:157]
v_exp_f32 v142, v142
v_mfma_f32_16x16x32_bf16 v[158:161], v[126:129], v[178:181], v[158:161]
v_rcp_f32 v167, v166
v_mfma_f32_16x16x32_bf16 v[162:165], v[134:137], v[178:181], v[162:165]
v_max3_u32 v218, v218, v166, v167
v_mul_f32 v167, s3, v167
v_mfma_f32_16x16x16_bf16 v[146:149], v[106:107], v[94:95], v[146:149]
v_mul_f32 v154, v154, v167
v_mul_f32 v155, v155, v167
v_mul_f32 v156, v156, v167
v_mul_f32 v157, v157, v167
v_cvt_pk_bf16_f32 v154, v154, v155
v_mul_f32 v158, v158, v167
v_mul_f32 v159, v159, v167
v_mul_f32 v160, v160, v167
v_mul_f32 v161, v161, v167
v_cvt_pk_bf16_f32 v155, v156, v157
v_cvt_pk_bf16_f32 v156, v158, v159
v_cvt_pk_bf16_f32 v157, v160, v161
v_mul_f32 v162, v162, v167
v_mul_f32 v163, v163, v167
v_mul_f32 v164, v164, v167
v_mul_f32 v165, v165, v167
v_mfma_f32_16x16x32_bf16 v[166:169], v[72:75], v[108:111], v[206:209]
ds_write_b128 v211, v[154:157] offset:43008
v_mfma_f32_16x16x32_bf16 v[154:157], v[72:75], v[78:81], 0
v_cvt_pk_bf16_f32 v158, v162, v163
v_cvt_pk_bf16_f32 v159, v164, v165
v_mfma_f32_16x16x32_bf16 v[162:165], v[72:75], v[102:105], 0
v_exp_f32 v143, v143
v_mfma_f32_16x16x16_bf16 v[154:157], v[76:77], v[82:83], v[154:157]
ds_write_b64 v212, v[158:159] offset:43008
v_mfma_f32_16x16x32_bf16 v[158:161], v[72:75], v[96:99], 0
v_exp_f32 v144, v144
v_mfma_f32_16x16x16_bf16 v[162:165], v[76:77], v[106:107], v[162:165]
v_exp_f32 v145, v145
v_mfma_f32_16x16x16_bf16 v[158:161], v[76:77], v[100:101], v[158:161]
v_cvt_pk_bf16_f32 v176, v142, v143
v_cvt_pk_bf16_f32 v177, v144, v145
v_mfma_f32_16x16x16_bf16 v[166:169], v[76:77], v[112:113], v[166:169]
v_cvt_pk_bf16_f32 v180, v150, 0
v_exp_f32 v146, v146
v_mfma_f32_16x16x32_bf16 v[150:153], v[190:193], v[174:177], 0
v_exp_f32 v147, v147
v_mfma_f32_16x16x32_bf16 v[138:141], v[114:117], v[174:177], 0
s_waitcnt lgkmcnt(0)
v_exp_f32 v148, v148
v_mfma_f32_16x16x32_bf16 v[142:145], v[122:125], v[174:177], 0
s_barrier
ds_read_b128 v[170:173], v210 offset:36864
v_exp_f32 v149, v149
v_mov_b32_dpp v154, v158 quad_perm:[0,1,2,3] row_mask:0x2 bank_mask:0xf
v_cvt_pk_bf16_f32 v178, v146, v147
v_cvt_pk_bf16_f32 v179, v148, v149
v_mfma_f32_16x16x32_bf16 v[146:149], v[130:133], v[174:177], 0
v_mov_b32_dpp v154, v162 quad_perm:[0,1,2,3] row_mask:0x4 bank_mask:0xf
v_mfma_f32_16x16x32_bf16 v[150:153], v[190:193], v[178:181], v[150:153]
ds_read_b128 v[182:185], v210 offset:37888
v_mov_b32_dpp v154, v167 quad_perm:[0,1,2,3] row_mask:0x8 bank_mask:0xf
v_mfma_f32_16x16x32_bf16 v[138:141], v[118:121], v[178:181], v[138:141]
v_exp_f32 v154, v154
v_mfma_f32_16x16x32_bf16 v[142:145], v[126:129], v[178:181], v[142:145]
v_cvt_pk_bf16_f32 v154, v154, 0
v_rcp_f32 v151, v150
v_mfma_f32_16x16x32_bf16 v[146:149], v[134:137], v[178:181], v[146:149]
s_waitcnt lgkmcnt(1)
ds_write_b16 v214, v154
v_mfma_f32_16x16x32_bf16 v[36:39], a[144:147], v[170:173], v[36:39]
ds_read_b128 v[84:87], v215
ds_read_b128 v[88:91], v215 offset:16
v_mfma_f32_16x16x32_bf16 v[40:43], a[168:171], v[170:173], v[40:43]
ds_read_b128 v[186:189], v210 offset:38912
ds_read_b128 v[174:177], v217
v_mfma_f32_16x16x32_bf16 v[44:47], a[192:195], v[170:173], v[44:47]
s_waitcnt lgkmcnt(5)
ds_read_b128 v[170:173], v210 offset:39936
ds_read_b128 v[178:181], v217 offset:528
v_mfma_f32_16x16x32_bf16 v[36:39], a[148:151], v[182:185], v[36:39]
v_mfma_f32_16x16x32_bf16 v[40:43], a[172:175], v[182:185], v[40:43]
v_mfma_f32_16x16x32_bf16 v[44:47], a[196:199], v[182:185], v[44:47]
ds_read_b128 v[182:185], v210 offset:40960
s_waitcnt lgkmcnt(6)
v_mfma_f32_16x16x32_bf16 v[166:169], v[84:87], v[190:193], 0
v_mfma_f32_16x16x32_bf16 v[154:157], v[84:87], v[114:117], 0
v_mfma_f32_16x16x32_bf16 v[158:161], v[84:87], v[122:125], 0
v_mfma_f32_16x16x32_bf16 v[162:165], v[84:87], v[130:133], 0
s_waitcnt lgkmcnt(5)
v_mfma_f32_16x16x32_bf16 v[166:169], v[88:91], v[190:193], v[166:169]
s_waitcnt lgkmcnt(4)
v_mfma_f32_16x16x32_bf16 v[36:39], a[152:155], v[186:189], v[36:39]
v_mfma_f32_16x16x32_bf16 v[154:157], v[88:91], v[118:121], v[154:157]
v_rcp_f32 v167, v166
v_mfma_f32_16x16x32_bf16 v[40:43], a[176:179], v[186:189], v[40:43]
v_max3_u32 v218, v218, v166, v167
v_max3_u32 v218, v218, v150, v151
v_mfma_f32_16x16x32_bf16 v[158:161], v[88:91], v[126:129], v[158:161]
v_mul_f32 v151, s3, v151
v_mul_f32 v138, v138, v151
v_mfma_f32_16x16x32_bf16 v[44:47], a[200:203], v[186:189], v[44:47]
ds_read_b128 v[186:189], v210 offset:41984
v_mul_f32 v139, v139, v151
v_mfma_f32_16x16x32_bf16 v[162:165], v[88:91], v[134:137], v[162:165]
s_waitcnt lgkmcnt(3)
v_mul_f32 v140, v140, v151
v_mul_f32 v141, v141, v151
v_mfma_f32_16x16x32_bf16 v[36:39], a[156:159], v[170:173], v[36:39]
v_cvt_pk_bf16_f32 v138, v138, v139
v_mul_f32 v142, v142, v151
v_mfma_f32_16x16x32_bf16 v[40:43], a[180:183], v[170:173], v[40:43]
v_mul_f32 v143, v143, v151
v_mul_f32 v144, v144, v151
v_mfma_f32_16x16x32_bf16 v[44:47], a[204:207], v[170:173], v[44:47]
s_waitcnt lgkmcnt(1)
ds_read_b128 v[170:173], v210 offset:43008
v_mul_f32 v145, v145, v151
v_mfma_f32_16x16x32_bf16 v[36:39], a[160:163], v[182:185], v[36:39]
v_cvt_pk_bf16_f32 v139, v140, v141
v_cvt_pk_bf16_f32 v140, v142, v143
v_mfma_f32_16x16x32_bf16 v[40:43], a[184:187], v[182:185], v[40:43]
v_cvt_pk_bf16_f32 v141, v144, v145
v_mul_f32 v146, v146, v151
v_mfma_f32_16x16x32_bf16 v[44:47], a[208:211], v[182:185], v[44:47]
s_waitcnt lgkmcnt(1)
ds_read_b128 v[182:185], v210 offset:44032
ds_write_b128 v211, v[138:141] offset:49152
v_mfma_f32_16x16x32_bf16 v[36:39], a[164:167], v[186:189], v[36:39]
v_mul_f32 v147, v147, v151
v_mul_f32 v148, v148, v151
v_mfma_f32_16x16x32_bf16 v[40:43], a[188:191], v[186:189], v[40:43]
v_mul_f32 v149, v149, v151
v_cvt_pk_bf16_f32 v142, v146, v147
v_mfma_f32_16x16x32_bf16 v[44:47], a[212:215], v[186:189], v[44:47]
s_waitcnt lgkmcnt(2)
ds_read_b128 v[186:189], v210 offset:45056
v_cvt_pk_bf16_f32 v143, v148, v149
v_mfma_f32_16x16x32_bf16 v[48:51], a[144:147], v[170:173], v[48:51]
ds_write_b64 v212, v[142:143] offset:49152
v_mfma_f32_16x16x32_bf16 v[52:55], a[168:171], v[170:173], v[52:55]
v_cvt_pk_bf16_f32 v72, v36, v37
v_cvt_pk_bf16_f32 v73, v38, v39
v_mfma_f32_16x16x32_bf16 v[56:59], a[192:195], v[170:173], v[56:59]
s_waitcnt lgkmcnt(3)
ds_read_b128 v[170:173], v210 offset:46080
buffer_store_dwordx2 v[72:73], v203, s[8:11], s39 offen
v_cvt_pk_bf16_f32 v74, v40, v41
v_mfma_f32_16x16x32_bf16 v[48:51], a[148:151], v[182:185], v[48:51]
v_cvt_pk_bf16_f32 v75, v42, v43
v_mov_b32_dpp v154, v158 quad_perm:[0,1,2,3] row_mask:0x2 bank_mask:0xf
v_mfma_f32_16x16x32_bf16 v[52:55], a[172:175], v[182:185], v[52:55]
v_mul_f32 v167, s3, v167
v_mov_b32_dpp v154, v162 quad_perm:[0,1,2,3] row_mask:0x4 bank_mask:0xf
v_mfma_f32_16x16x32_bf16 v[56:59], a[196:199], v[182:185], v[56:59]
s_waitcnt lgkmcnt(2)
ds_read_b128 v[182:185], v210 offset:47104
v_mul_f32 v154, v154, v167
v_mfma_f32_16x16x32_bf16 v[48:51], a[152:155], v[186:189], v[48:51]
v_cvt_pk_bf16_f32 v154, v154, 0
v_cvt_pk_bf16_f32 v76, v44, v45
v_mfma_f32_16x16x32_bf16 v[52:55], a[176:179], v[186:189], v[52:55]
s_waitcnt vmcnt(1) lgkmcnt(1)
ds_write_b16 v214, v154
v_mfma_f32_16x16x32_bf16 v[56:59], a[200:203], v[186:189], v[56:59]
s_barrier
v_mfma_f32_16x16x32_bf16 v[48:51], a[156:159], v[170:173], v[48:51]
ds_read_b128 v[186:189], v210 offset:48128
ds_read_b128 v[84:87], v200
v_mfma_f32_16x16x32_bf16 v[52:55], a[180:183], v[170:173], v[52:55]
ds_read_b128 v[92:95], v201
ds_read_b128 v[100:103], v202
v_mfma_f32_16x16x32_bf16 v[56:59], a[204:207], v[170:173], v[56:59]
s_waitcnt lgkmcnt(5)
ds_read_b128 v[170:173], v210 offset:49152
ds_read_b128 v[88:91], v194 offset:16
v_mfma_f32_16x16x32_bf16 v[48:51], a[160:163], v[182:185], v[48:51]
ds_read_b128 v[96:99], v195 offset:16
buffer_store_dwordx2 v[74:75], v203, s[8:11], s39 offen offset:32
v_cvt_pk_bf16_f32 v77, v46, v47
v_mfma_f32_16x16x32_bf16 v[52:55], a[184:187], v[182:185], v[52:55]
s_mul_hi_u32 s41, s35, 58835169
ds_read_b128 v[104:107], v196 offset:16
v_add_u32 v215, 1408, v215
v_mfma_f32_16x16x32_bf16 v[56:59], a[208:211], v[182:185], v[56:59]
s_waitcnt lgkmcnt(7)
ds_read_b128 v[182:185], v210 offset:50176
s_mul_i32 s42, s41, 73
v_mfma_f32_16x16x32_bf16 v[48:51], a[164:167], v[186:189], v[48:51]
s_waitcnt lgkmcnt(7)
ds_read_b64 v[112:113], v215 offset:528
s_sub_u32 s42, s35, s42
v_mfma_f32_16x16x32_bf16 v[52:55], a[188:191], v[186:189], v[52:55]
s_mul_i32 s43, s41, 1373568
s_mul_i32 s51, s42, 2688
s_add_u32 s43, s43, s51
v_mfma_f32_16x16x32_bf16 v[56:59], a[212:215], v[186:189], v[56:59]
s_mov_b32 s38, s36
ds_read_b128 v[186:189], v210 offset:51200
v_cvt_pk_bf16_f32 v78, v48, v49
v_mfma_f32_16x16x32_bf16 v[36:39], v[174:177], v[84:87], 0
s_waitcnt lgkmcnt(6)
ds_read_b128 v[84:87], v194
v_cvt_pk_bf16_f32 v79, v50, v51
v_mfma_f32_16x16x32_bf16 v[48:51], v[174:177], v[92:95], 0
s_cmp_lt_u32 s35, s34
ds_read_b128 v[92:95], v195
v_cvt_pk_bf16_f32 v80, v52, v53
v_mfma_f32_16x16x32_bf16 v[60:63], a[144:147], v[170:173], v[60:63]
s_cselect_b32 s36, s43, 1879048192
v_cvt_pk_bf16_f32 v81, v54, v55
v_cvt_pk_bf16_f32 v82, v56, v57
v_mfma_f32_16x16x32_bf16 v[64:67], a[168:171], v[170:173], v[64:67]
s_add_u32 s35, s35, 32
v_cvt_pk_bf16_f32 v83, v58, v59
s_cmp_eq_u32 s42, 0
v_mfma_f32_16x16x32_bf16 v[68:71], a[192:195], v[170:173], v[68:71]
s_waitcnt lgkmcnt(4)
ds_read_b128 v[170:173], v210 offset:52224
s_cselect_b32 s44, 536870911, s72
v_mfma_f32_16x16x32_bf16 v[60:63], a[148:151], v[182:185], v[60:63]
s_cmp_eq_u32 s42, 72
buffer_store_dwordx2 v[76:77], v203, s[8:11], s39 offen offset:64
s_cselect_b32 s44, 939524095, s44
v_mfma_f32_16x16x32_bf16 v[64:67], a[172:175], v[182:185], v[64:67]
s_cmp_eq_u32 s41, 0
s_cselect_b32 s40, 1879048192, s36
v_mfma_f32_16x16x32_bf16 v[68:71], a[196:199], v[182:185], v[68:71]
s_waitcnt lgkmcnt(3)
ds_read_b128 v[182:185], v210 offset:53248
s_add_u32 m0, s45, 0
v_mfma_f32_16x16x32_bf16 v[60:63], a[152:155], v[186:189], v[60:63]
v_mfma_f32_16x16x32_bf16 v[64:67], a[176:179], v[186:189], v[64:67]
v_mfma_f32_16x16x32_bf16 v[68:71], a[200:203], v[186:189], v[68:71]
ds_read_b128 v[186:189], v210 offset:54272
s_waitcnt lgkmcnt(2)
v_mfma_f32_16x16x32_bf16 v[60:63], a[156:159], v[170:173], v[60:63]
v_mfma_f32_16x16x32_bf16 v[64:67], a[180:183], v[170:173], v[64:67]
v_mfma_f32_16x16x32_bf16 v[68:71], a[204:207], v[170:173], v[68:71]
s_waitcnt lgkmcnt(1)
v_mfma_f32_16x16x32_bf16 v[60:63], a[160:163], v[182:185], v[60:63]
v_mfma_f32_16x16x32_bf16 v[64:67], a[184:187], v[182:185], v[64:67]
v_mfma_f32_16x16x32_bf16 v[68:71], a[208:211], v[182:185], v[68:71]
ds_read_b128 v[182:185], v210
s_waitcnt lgkmcnt(1)
v_mfma_f32_16x16x32_bf16 v[60:63], a[164:167], v[186:189], v[60:63]
v_smfmac_f32_16x16x64_bf16 v[36:39], v[178:181], v[84:91], v213
ds_read_b128 v[84:87], v197
ds_read_b128 v[88:91], v197 offset:16
v_mfma_f32_16x16x32_bf16 v[64:67], a[188:191], v[186:189], v[64:67]
v_cvt_pk_bf16_f32 v116, v60, v61
v_cvt_pk_bf16_f32 v117, v62, v63
v_mfma_f32_16x16x32_bf16 v[60:63], v[174:177], v[100:103], 0
ds_read_b128 v[100:103], v196
ds_read_b128 v[174:177], v217 offset:1056
v_mfma_f32_16x16x32_bf16 v[68:71], a[212:215], v[186:189], v[68:71]
v_cvt_pk_bf16_f32 v124, v64, v65
v_cvt_pk_bf16_f32 v125, v66, v67
v_smfmac_f32_16x16x64_bf16 v[48:51], v[178:181], v[92:99], v213
s_waitcnt lgkmcnt(4)
ds_read_b128 v[92:95], v198
ds_read_b128 v[96:99], v198 offset:16
v_mfma_f32_16x16x32_bf16 v[138:141], a[0:3], v[182:185], 0
ds_read_b128 v[186:189], v210 offset:1024
v_cvt_pk_bf16_f32 v132, v68, v69
v_mfma_f32_16x16x32_bf16 v[142:145], a[24:27], v[182:185], 0
v_cvt_pk_bf16_f32 v133, v70, v71
v_mfma_f32_16x16x32_bf16 v[146:149], a[48:51], v[182:185], 0
buffer_store_dwordx2 v[78:79], v204, s[8:11], s39 offen
s_waitcnt lgkmcnt(4)
v_smfmac_f32_16x16x64_bf16 v[60:63], v[178:181], v[100:107], v213
s_waitcnt lgkmcnt(3)
ds_read_b128 v[100:103], v199
ds_read_b128 v[104:107], v199 offset:16
v_smfmac_f32_16x16x64_bf16 v[36:39], v[174:177], v[84:91], v213
ds_read_b128 v[84:87], v200 offset:32
ds_read_b128 v[178:181], v217 offset:1584
v_mfma_f32_16x16x32_bf16 v[150:153], a[216:219], v[182:185], 0
ds_read_b128 v[88:91], v194 offset:48
s_waitcnt lgkmcnt(6)
v_smfmac_f32_16x16x64_bf16 v[48:51], v[174:177], v[92:99], v213
ds_read_b128 v[92:95], v201 offset:32
ds_read_b128 v[96:99], v195 offset:48
v_mfma_f32_16x16x32_bf16 v[154:157], a[240:243], v[182:185], 0
v_mul_f32 v119, v36, v36
v_add_f32 v118, v36, v37
v_mfma_f32_16x16x32_bf16 v[158:161], v[232:235], v[182:185], 0
v_mul_f32 v127, v48, v48
v_add_f32 v126, v48, v49
v_mfma_f32_16x16x32_bf16 v[162:165], v[182:185], a[72:75], 0
v_fmac_f32 v119, v37, v37
v_fmac_f32 v127, v49, v49
v_mfma_f32_16x16x32_bf16 v[166:169], v[182:185], a[96:99], 0
s_waitcnt lgkmcnt(5)
v_add_f32 v118, v118, v38
v_add_f32 v126, v126, v50
v_smfmac_f32_16x16x64_bf16 v[60:63], v[174:177], v[100:107], v213
ds_read_b128 v[100:103], v202 offset:32
ds_read_b128 v[174:177], v217 offset:2112
v_mfma_f32_16x16x32_bf16 v[170:173], v[182:185], a[120:123], 0
s_waitcnt lgkmcnt(5)
ds_read_b128 v[104:107], v196 offset:48
ds_read_b128 v[182:185], v210 offset:2048
v_mfma_f32_16x16x32_bf16 v[40:43], v[178:181], v[84:87], 0
ds_read_b128 v[84:87], v194 offset:32
v_mul_f32 v135, v60, v60
v_mfma_f32_16x16x32_bf16 v[138:141], a[4:7], v[186:189], v[138:141]
s_waitcnt lgkmcnt(6)
buffer_store_dwordx2 v[80:81], v204, s[8:11], s39 offen offset:32
v_add_f32 v134, v60, v61
v_mfma_f32_16x16x32_bf16 v[52:55], v[178:181], v[92:95], 0
ds_read_b128 v[92:95], v195 offset:32
v_fmac_f32 v135, v61, v61
v_mfma_f32_16x16x32_bf16 v[142:145], a[28:31], v[186:189], v[142:145]
s_waitcnt lgkmcnt(5)
v_add_f32 v134, v134, v62
v_fmac_f32 v135, v62, v62
v_mfma_f32_16x16x32_bf16 v[64:67], v[178:181], v[100:103], 0
ds_read_b128 v[100:103], v196 offset:32
ds_read_b128 v[178:181], v217 offset:2640
v_mfma_f32_16x16x32_bf16 v[146:149], a[52:55], v[186:189], v[146:149]
v_fmac_f32 v119, v38, v38
v_fmac_f32 v127, v50, v50
v_mfma_f32_16x16x32_bf16 v[150:153], a[220:223], v[186:189], v[150:153]
v_add_f32 v134, v134, v63
v_fmac_f32 v135, v63, v63
v_mfma_f32_16x16x32_bf16 v[154:157], a[244:247], v[186:189], v[154:157]
s_waitcnt lgkmcnt(3)
v_add_f32 v118, v118, v39
v_add_f32 v126, v126, v51
v_smfmac_f32_16x16x64_bf16 v[40:43], v[174:177], v[84:91], v213
s_waitcnt lgkmcnt(2)
ds_read_b128 v[84:87], v197 offset:32
ds_read_b128 v[88:91], v197 offset:48
v_smfmac_f32_16x16x64_bf16 v[52:55], v[174:177], v[92:99], v213
ds_read_b128 v[92:95], v198 offset:32
ds_read_b128 v[96:99], v198 offset:48
v_mfma_f32_16x16x32_bf16 v[158:161], v[236:239], v[186:189], v[158:161]
s_waitcnt lgkmcnt(5)
v_fmac_f32 v119, v39, v39
v_fmac_f32 v127, v51, v51
v_smfmac_f32_16x16x64_bf16 v[64:67], v[174:177], v[100:107], v213
ds_read_b128 v[100:103], v199 offset:32
ds_read_b128 v[104:107], v199 offset:48
v_mfma_f32_16x16x32_bf16 v[162:165], v[186:189], a[76:79], v[162:165]
ds_read_b128 v[174:177], v217 offset:3168
v_mfma_f32_16x16x32_bf16 v[166:169], v[186:189], a[100:103], v[166:169]
v_mfma_f32_16x16x32_bf16 v[170:173], v[186:189], a[124:127], v[170:173]
ds_read_b128 v[186:189], v210 offset:3072
s_waitcnt lgkmcnt(6)
v_smfmac_f32_16x16x64_bf16 v[40:43], v[178:181], v[84:91], v213
ds_read_b128 v[84:87], v200 offset:64
ds_read_b128 v[88:91], v194 offset:80
v_mfma_f32_16x16x32_bf16 v[138:141], a[8:11], v[182:185], v[138:141]
s_waitcnt lgkmcnt(6)
buffer_store_dwordx2 v[82:83], v204, s[8:11], s39 offen offset:64
s_nop 1
v_add_f32 v118, v118, v40
v_smfmac_f32_16x16x64_bf16 v[52:55], v[178:181], v[92:99], v213
ds_read_b128 v[92:95], v201 offset:64
ds_read_b128 v[96:99], v195 offset:80
v_mfma_f32_16x16x32_bf16 v[142:145], a[32:35], v[182:185], v[142:145]
s_waitcnt lgkmcnt(6)
v_fmac_f32 v119, v40, v40
v_add_f32 v118, v118, v41
v_smfmac_f32_16x16x64_bf16 v[64:67], v[178:181], v[100:107], v213
ds_read_b128 v[100:103], v202 offset:64
ds_read_b128 v[178:181], v217 offset:3696
v_mfma_f32_16x16x32_bf16 v[146:149], a[56:59], v[182:185], v[146:149]
ds_read_b128 v[104:107], v196 offset:80
v_add_f32 v126, v126, v52
v_mfma_f32_16x16x32_bf16 v[150:153], a[224:227], v[182:185], v[150:153]
s_waitcnt lgkmcnt(6)
v_add_f32 v134, v134, v64
v_fmac_f32 v135, v64, v64
v_mfma_f32_16x16x32_bf16 v[44:47], v[174:177], v[84:87], 0
ds_read_b128 v[84:87], v194 offset:64
v_fmac_f32 v127, v52, v52
v_mfma_f32_16x16x32_bf16 v[154:157], a[248:251], v[182:185], v[154:157]
s_waitcnt lgkmcnt(5)
v_add_f32 v134, v134, v65
v_fmac_f32 v135, v65, v65
v_mfma_f32_16x16x32_bf16 v[56:59], v[174:177], v[92:95], 0
ds_read_b128 v[92:95], v195 offset:64
v_fmac_f32 v119, v41, v41
v_mfma_f32_16x16x32_bf16 v[158:161], v[240:243], v[182:185], v[158:161]
s_waitcnt lgkmcnt(4)
v_add_f32 v126, v126, v53
v_fmac_f32 v127, v53, v53
v_mfma_f32_16x16x32_bf16 v[68:71], v[174:177], v[100:103], 0
ds_read_b128 v[100:103], v196 offset:64
ds_read_b128 v[174:177], v217 offset:4224
v_mfma_f32_16x16x32_bf16 v[162:165], v[182:185], a[80:83], v[162:165]
v_add_f32 v134, v134, v66
v_fmac_f32 v135, v66, v66
v_mfma_f32_16x16x32_bf16 v[166:169], v[182:185], a[104:107], v[166:169]
s_waitcnt lgkmcnt(3)
v_add_f32 v118, v118, v42
v_fmac_f32 v119, v42, v42
v_smfmac_f32_16x16x64_bf16 v[44:47], v[178:181], v[84:91], v213
ds_read_b128 v[84:87], v197 offset:64
ds_read_b128 v[88:91], v197 offset:80
v_mfma_f32_16x16x32_bf16 v[170:173], v[182:185], a[128:131], v[170:173]
s_waitcnt lgkmcnt(4)
ds_read_b128 v[182:185], v210 offset:4096
v_add_f32 v126, v126, v54
v_smfmac_f32_16x16x64_bf16 v[56:59], v[178:181], v[92:99], v213
ds_read_b128 v[92:95], v198 offset:64
ds_read_b128 v[96:99], v198 offset:80
v_mfma_f32_16x16x32_bf16 v[138:141], a[12:15], v[186:189], v[138:141]
s_waitcnt lgkmcnt(6)
v_fmac_f32 v127, v54, v54
v_add_f32 v134, v134, v67
v_smfmac_f32_16x16x64_bf16 v[68:71], v[178:181], v[100:107], v213
ds_read_b128 v[100:103], v199 offset:64
ds_read_b128 v[104:107], v199 offset:80
v_mfma_f32_16x16x32_bf16 v[142:145], a[36:39], v[186:189], v[142:145]
v_fmac_f32 v135, v67, v67
v_add_f32 v118, v118, v43
v_mfma_f32_16x16x32_bf16 v[146:149], a[60:63], v[186:189], v[146:149]
v_fmac_f32 v119, v43, v43
v_add_f32 v126, v126, v55
v_mfma_f32_16x16x32_bf16 v[150:153], a[228:231], v[186:189], v[150:153]
s_waitcnt lgkmcnt(5)
v_fmac_f32 v127, v55, v55
v_and_b32 v180, s44, v208
v_smfmac_f32_16x16x64_bf16 v[44:47], v[174:177], v[84:91], v213
buffer_store_dwordx2 v[116:117], v205, s[8:11], s39 offen
v_add_u32 v216, 1408, v216
v_mfma_f32_16x16x32_bf16 v[154:157], a[252:255], v[186:189], v[154:157]
v_mov_b32 v181, 0
s_waitcnt lgkmcnt(2)
v_smfmac_f32_16x16x64_bf16 v[56:59], v[174:177], v[92:99], v213
v_add_f32 v118, v118, v44
v_fmac_f32 v119, v44, v44
v_mfma_f32_16x16x32_bf16 v[158:161], v[244:247], v[186:189], v[158:161]
s_waitcnt lgkmcnt(0)
v_add_f32 v118, v118, v45
v_fmac_f32 v119, v45, v45
v_smfmac_f32_16x16x64_bf16 v[68:71], v[174:177], v[100:107], v213
v_add_f32 v126, v126, v56
v_fmac_f32 v127, v56, v56
v_mfma_f32_16x16x32_bf16 v[162:165], v[186:189], a[84:87], v[162:165]
v_add_f32 v126, v126, v57
v_fmac_f32 v127, v57, v57
v_mfma_f32_16x16x32_bf16 v[166:169], v[186:189], a[108:111], v[166:169]
v_add_f32 v134, v134, v68
v_fmac_f32 v135, v68, v68
v_mfma_f32_16x16x32_bf16 v[170:173], v[186:189], a[132:135], v[170:173]
ds_read_b128 v[186:189], v210 offset:5120
v_add_f32 v134, v134, v69
v_mfma_f32_16x16x32_bf16 v[138:141], a[16:19], v[182:185], v[138:141]
v_fmac_f32 v135, v69, v69
v_add_f32 v134, v134, v70
v_mfma_f32_16x16x32_bf16 v[142:145], a[40:43], v[182:185], v[142:145]
v_fmac_f32 v135, v70, v70
v_add_f32 v118, v118, v46
v_mfma_f32_16x16x32_bf16 v[146:149], a[64:67], v[182:185], v[146:149]
v_fmac_f32 v119, v46, v46
v_add_f32 v126, v126, v58
v_mfma_f32_16x16x32_bf16 v[150:153], a[232:235], v[182:185], v[150:153]
v_fmac_f32 v127, v58, v58
v_add_f32 v134, v134, v71
v_mfma_f32_16x16x32_bf16 v[154:157], v[224:227], v[182:185], v[154:157]
v_fmac_f32 v135, v71, v71
v_add_f32 v118, v118, v47
v_mfma_f32_16x16x32_bf16 v[158:161], v[248:251], v[182:185], v[158:161]
v_fmac_f32 v119, v47, v47
v_add_f32 v126, v126, v59
v_mfma_f32_16x16x32_bf16 v[162:165], v[182:185], a[88:91], v[162:165]
v_fmac_f32 v127, v59, v59
v_add_u32 v214, 1408, v214
v_mfma_f32_16x16x32_bf16 v[166:169], v[182:185], a[112:115], v[166:169]
v_permlane16_swap_b32 v134, v135
v_mfma_f32_16x16x32_bf16 v[170:173], v[182:185], a[136:139], v[170:173]
s_waitcnt lgkmcnt(0)
ds_read_b128 v[182:185], v210 offset:6144
v_add_f32 v134, v134, v135
v_mfma_f32_16x16x32_bf16 v[138:141], a[20:23], v[186:189], v[138:141]
v_permlane16_swap_b32 v118, v119
v_mfma_f32_16x16x32_bf16 v[142:145], a[44:47], v[186:189], v[142:145]
v_permlane16_swap_b32 v126, v127
v_mfma_f32_16x16x32_bf16 v[146:149], a[68:71], v[186:189], v[146:149]
v_cvt_pk_bf16_f32 v78, v138, v139
v_cvt_pk_bf16_f32 v79, v140, v141
v_mfma_f32_16x16x32_bf16 v[150:153], a[236:239], v[186:189], v[150:153]
v_cvt_pk_bf16_f32 v80, v142, v143
v_cvt_pk_bf16_f32 v81, v144, v145
v_mfma_f32_16x16x32_bf16 v[154:157], v[228:231], v[186:189], v[154:157]
v_cvt_pk_bf16_f32 v82, v146, v147
v_cvt_pk_bf16_f32 v83, v148, v149
v_mfma_f32_16x16x32_bf16 v[158:161], v[252:255], v[186:189], v[158:161]
v_cvt_pk_bf16_f32 v72, v150, v151
v_cvt_pk_bf16_f32 v73, v152, v153
v_mfma_f32_16x16x32_bf16 v[162:165], v[186:189], a[92:95], v[162:165]
v_cvt_pk_bf16_f32 v74, v154, v155
v_cvt_pk_bf16_f32 v75, v156, v157
v_mfma_f32_16x16x32_bf16 v[166:169], v[186:189], a[116:119], v[166:169]
v_cvt_pk_bf16_f32 v76, v158, v159
v_cvt_pk_bf16_f32 v77, v160, v161
v_mfma_f32_16x16x32_bf16 v[170:173], v[186:189], a[140:143], v[170:173]
s_waitcnt lgkmcnt(0)
ds_read_b128 v[186:189], v210 offset:7168
v_cvt_pk_bf16_f32 v114, v162, v163
v_mfma_f32_16x16x32_bf16 v[138:141], a[0:3], v[182:185], 0
v_cvt_pk_bf16_f32 v115, v164, v165
v_cvt_pk_bf16_f32 v122, v166, v167
v_mfma_f32_16x16x32_bf16 v[142:145], a[24:27], v[182:185], 0
v_cvt_pk_bf16_f32 v123, v168, v169
v_cvt_pk_bf16_f32 v130, v170, v171
v_mfma_f32_16x16x32_bf16 v[146:149], a[48:51], v[182:185], 0
v_cvt_pk_bf16_f32 v131, v172, v173
v_mov_b32 v135, v134
v_mfma_f32_16x16x32_bf16 v[150:153], a[216:219], v[182:185], 0
v_add_f32 v118, v118, v119
v_add_f32 v126, v126, v127
v_mfma_f32_16x16x32_bf16 v[154:157], a[240:243], v[182:185], 0
v_permlane32_swap_b32 v134, v135
v_mfma_f32_16x16x32_bf16 v[158:161], v[232:235], v[182:185], 0
v_permlane32_swap_b32 v118, v126
v_mfma_f32_16x16x32_bf16 v[162:165], v[182:185], a[72:75], 0
v_add_f32 v134, v134, v135
v_add_f32 v118, v118, v126
v_mfma_f32_16x16x32_bf16 v[166:169], v[182:185], a[96:99], 0
ds_write_b32 v209, v134 offset:512
v_mfma_f32_16x16x32_bf16 v[170:173], v[182:185], a[120:123], 0
s_waitcnt lgkmcnt(1)
ds_read_b128 v[182:185], v210 offset:8192
ds_write_b32 v209, v118
v_mfma_f32_16x16x32_bf16 v[138:141], a[4:7], v[186:189], v[138:141]
buffer_store_dwordx2 v[124:125], v205, s[8:11], s39 offen offset:32
v_mfma_f32_16x16x32_bf16 v[142:145], a[28:31], v[186:189], v[142:145]
v_mfma_f32_16x16x32_bf16 v[146:149], a[52:55], v[186:189], v[146:149]
v_mfma_f32_16x16x32_bf16 v[150:153], a[220:223], v[186:189], v[150:153]
v_mfma_f32_16x16x32_bf16 v[154:157], a[244:247], v[186:189], v[154:157]
v_mfma_f32_16x16x32_bf16 v[158:161], v[236:239], v[186:189], v[158:161]
s_waitcnt lgkmcnt(0)
s_barrier
v_mfma_f32_16x16x32_bf16 v[162:165], v[186:189], a[76:79], v[162:165]
ds_read_b128 v[106:109], v210 offset:56320
ds_read_b128 v[102:105], v210 offset:55296
v_mfma_f32_16x16x32_bf16 v[166:169], v[186:189], a[100:103], v[166:169]
buffer_load_dwordx4 v180, s[4:7], s40 offen nt lds
v_mfma_f32_16x16x32_bf16 v[170:173], v[186:189], a[124:127], v[170:173]
s_add_u32 m0, s45, 4112
ds_read_b128 v[186:189], v210 offset:9216
s_add_u32 s40, s36, 196224
v_mfma_f32_16x16x32_bf16 v[138:141], a[8:11], v[182:185], v[138:141]
buffer_load_dwordx4 v180, s[4:7], s40 offen nt lds
v_mfma_f32_16x16x32_bf16 v[142:145], a[32:35], v[182:185], v[142:145]
s_add_u32 m0, s45, 8224
s_add_u32 s40, s36, 392448
buffer_load_dwordx4 v180, s[4:7], s40 offen nt lds
v_mfma_f32_16x16x32_bf16 v[146:149], a[56:59], v[182:185], v[146:149]
s_add_u32 m0, s45, 12336
s_add_u32 s40, s36, 588672
buffer_load_dwordx4 v180, s[4:7], s40 offen nt lds
v_mfma_f32_16x16x32_bf16 v[150:153], a[224:227], v[182:185], v[150:153]
s_waitcnt lgkmcnt(2)
v_add_f32 v106, v106, v107
v_add_f32 v108, v108, v109
v_mfma_f32_16x16x32_bf16 v[154:157], a[248:251], v[182:185], v[154:157]
s_waitcnt lgkmcnt(1)
v_add_f32 v106, v106, v108
v_add_f32 v102, v102, v103
v_mfma_f32_16x16x32_bf16 v[158:161], v[240:243], v[182:185], v[158:161]
s_add_u32 m0, s45, 16448
ds_read_b128 v[108:111], v215 offset:512
v_add_f32 v104, v104, v105
v_mfma_f32_16x16x32_bf16 v[162:165], v[182:185], a[80:83], v[162:165]
s_add_u32 s40, s36, 784896
v_add_f32 v102, v102, v104
v_mul_f32 v106, s73, v106
v_mfma_f32_16x16x32_bf16 v[166:169], v[182:185], a[104:107], v[166:169]
v_mul_f32 v103, s48, v102
v_mul_f32 v104, s73, v102
v_mfma_f32_16x16x32_bf16 v[170:173], v[182:185], a[128:131], v[170:173]
s_waitcnt lgkmcnt(1)
ds_read_b128 v[182:185], v210 offset:10240
v_fma_f32 v106, -v103, v104, v106
v_mfma_f32_16x16x32_bf16 v[138:141], a[12:15], v[186:189], v[138:141]
v_max_f32 v106, 0, v106
v_add_f32 v106, s49, v106
v_mfma_f32_16x16x32_bf16 v[142:145], a[36:39], v[186:189], v[142:145]
v_rsq_f32 v102, v106
v_mfma_f32_16x16x32_bf16 v[146:149], a[60:63], v[186:189], v[146:149]
v_mul_f32_e64 v103, -v103, v102
v_mfma_f32_16x16x32_bf16 v[150:153], a[228:231], v[186:189], v[150:153]
ds_write_b64 v211, v[102:103] offset:36864
v_mfma_f32_16x16x32_bf16 v[154:157], a[252:255], v[186:189], v[154:157]
s_waitcnt lgkmcnt(1)
buffer_load_dwordx4 v180, s[4:7], s40 offen nt lds
v_mfma_f32_16x16x32_bf16 v[158:161], v[244:247], v[186:189], v[158:161]
s_add_u32 m0, s45, 20560
ds_read_b64 v[118:119], v219
ds_read_b64 v[126:127], v219 offset:256
v_mfma_f32_16x16x32_bf16 v[162:165], v[186:189], a[84:87], v[162:165]
s_add_u32 s40, s36, 981120
ds_read_b64 v[134:135], v219 offset:512
buffer_load_dwordx4 v180, s[4:7], s40 offen nt lds
v_mfma_f32_16x16x32_bf16 v[166:169], v[186:189], a[108:111], v[166:169]
s_add_u32 m0, s45, 24672
s_add_u32 s40, s36, 1177344
buffer_load_dwordx4 v180, s[4:7], s40 offen nt lds
v_mfma_f32_16x16x32_bf16 v[170:173], v[186:189], a[132:135], v[170:173]
s_add_u32 m0, s45, 28784
ds_read_b128 v[186:189], v210 offset:11264
s_add_u32 s40, s36, 1373568
v_mfma_f32_16x16x32_bf16 v[138:141], a[16:19], v[182:185], v[138:141]
buffer_load_dwordx4 v180, s[4:7], s40 offen nt lds
v_mfma_f32_16x16x32_bf16 v[142:145], a[40:43], v[182:185], v[142:145]
s_waitcnt lgkmcnt(3)
v_fma_f32 v220, v36, v118, v119
v_fma_f32 v221, v37, v118, v119
v_mfma_f32_16x16x32_bf16 v[146:149], a[64:67], v[182:185], v[146:149]
s_add_u32 m0, s45, 32896
v_fma_f32 v222, v38, v118, v119
v_fma_f32 v223, v39, v118, v119
v_mfma_f32_16x16x32_bf16 v[150:153], a[232:235], v[182:185], v[150:153]
s_add_u32 s40, s36, 1569792
v_cvt_pk_bf16_f32 v90, v220, v221
v_cvt_pk_bf16_f32 v91, v222, v223
v_mfma_f32_16x16x32_bf16 v[154:157], v[224:227], v[182:185], v[154:157]
v_fma_f32 v220, v40, v118, v119
v_fma_f32 v221, v41, v118, v119
v_mfma_f32_16x16x32_bf16 v[158:161], v[248:251], v[182:185], v[158:161]
v_fma_f32 v222, v42, v118, v119
v_fma_f32 v223, v43, v118, v119
v_mfma_f32_16x16x32_bf16 v[162:165], v[182:185], a[88:91], v[162:165]
v_cvt_pk_bf16_f32 v92, v220, v221
v_cvt_pk_bf16_f32 v93, v222, v223
v_mfma_f32_16x16x32_bf16 v[166:169], v[182:185], a[112:115], v[166:169]
ds_write_b128 v211, v[90:93] offset:18432
v_mfma_f32_16x16x32_bf16 v[170:173], v[182:185], a[136:139], v[170:173]
s_waitcnt lgkmcnt(1)
v_fma_f32 v220, v44, v118, v119
v_fma_f32 v221, v45, v118, v119
v_mfma_f32_16x16x32_bf16 v[138:141], a[20:23], v[186:189], v[138:141]
buffer_store_dwordx2 v[132:133], v205, s[8:11], s39 offen offset:64
ds_read_b128 v[182:185], v210 offset:12288
v_mfma_f32_16x16x32_bf16 v[142:145], a[44:47], v[186:189], v[142:145]
v_fma_f32 v222, v46, v118, v119
v_fma_f32 v223, v47, v118, v119
v_mfma_f32_16x16x32_bf16 v[146:149], a[68:71], v[186:189], v[146:149]
v_cvt_pk_bf16_f32 v96, v138, v139
v_cvt_pk_bf16_f32 v97, v140, v141
v_mfma_f32_16x16x32_bf16 v[150:153], a[236:239], v[186:189], v[150:153]
v_cvt_pk_bf16_f32 v98, v142, v143
v_cvt_pk_bf16_f32 v99, v144, v145
v_mfma_f32_16x16x32_bf16 v[154:157], v[228:231], v[186:189], v[154:157]
v_cvt_pk_bf16_f32 v100, v146, v147
v_cvt_pk_bf16_f32 v101, v148, v149
v_mfma_f32_16x16x32_bf16 v[158:161], v[252:255], v[186:189], v[158:161]
v_cvt_pk_bf16_f32 v84, v150, v151
v_cvt_pk_bf16_f32 v85, v152, v153
v_mfma_f32_16x16x32_bf16 v[162:165], v[186:189], a[92:95], v[162:165]
v_cvt_pk_bf16_f32 v86, v154, v155
v_cvt_pk_bf16_f32 v87, v156, v157
v_mfma_f32_16x16x32_bf16 v[166:169], v[186:189], a[116:119], v[166:169]
v_cvt_pk_bf16_f32 v88, v158, v159
v_cvt_pk_bf16_f32 v89, v160, v161
v_mfma_f32_16x16x32_bf16 v[170:173], v[186:189], a[140:143], v[170:173]
s_waitcnt lgkmcnt(0)
ds_read_b128 v[186:189], v210 offset:13312
v_cvt_pk_bf16_f32 v116, v162, v163
v_mfma_f32_16x16x32_bf16 v[138:141], a[0:3], v[182:185], 0
v_cvt_pk_bf16_f32 v124, v166, v167
v_cvt_pk_bf16_f32 v125, v168, v169
v_mfma_f32_16x16x32_bf16 v[142:145], a[24:27], v[182:185], 0
v_cvt_pk_bf16_f32 v117, v164, v165
v_cvt_pk_bf16_f32 v94, v220, v221
v_mfma_f32_16x16x32_bf16 v[150:153], v[108:111], v[72:75], v[206:209]
v_cvt_pk_bf16_f32 v95, v222, v223
v_fma_f32 v220, v48, v126, v127
v_mfma_f32_16x16x32_bf16 v[146:149], a[48:51], v[182:185], 0
ds_read_b128 v[182:185], v210 offset:14336
ds_write_b64 v212, v[94:95] offset:18432
v_mfma_f32_16x16x16_bf16 v[150:153], v[112:113], v[76:77], v[150:153]
s_waitcnt lgkmcnt(2)
v_fma_f32 v221, v49, v126, v127
v_fma_f32 v222, v50, v126, v127
v_mfma_f32_16x16x32_bf16 v[138:141], a[4:7], v[186:189], v[138:141]
v_fma_f32 v223, v51, v126, v127
v_cvt_pk_bf16_f32 v174, v220, v221
v_mfma_f32_16x16x32_bf16 v[142:145], a[28:31], v[186:189], v[142:145]
v_cvt_pk_bf16_f32 v175, v222, v223
v_fma_f32 v220, v52, v126, v127
v_mfma_f32_16x16x32_bf16 v[146:149], a[52:55], v[186:189], v[146:149]
ds_read_b128 v[186:189], v210 offset:15360
v_fma_f32 v221, v53, v126, v127
v_mfma_f32_16x16x32_bf16 v[154:157], v[78:81], v[84:87], 0
s_waitcnt lgkmcnt(2)
v_fma_f32 v222, v54, v126, v127
v_fma_f32 v223, v55, v126, v127
v_mfma_f32_16x16x32_bf16 v[138:141], a[8:11], v[182:185], v[138:141]
v_cvt_pk_bf16_f32 v176, v220, v221
v_cvt_pk_bf16_f32 v177, v222, v223
v_mfma_f32_16x16x32_bf16 v[142:145], a[32:35], v[182:185], v[142:145]
v_fma_f32 v220, v56, v126, v127
v_fma_f32 v221, v57, v126, v127
v_mfma_f32_16x16x32_bf16 v[158:161], v[96:99], v[84:87], 0
v_fma_f32 v222, v58, v126, v127
v_fma_f32 v223, v59, v126, v127
v_mfma_f32_16x16x32_bf16 v[146:149], a[56:59], v[182:185], v[146:149]
ds_read_b128 v[182:185], v210 offset:16384
v_cvt_pk_bf16_f32 v178, v220, v221
v_mfma_f32_16x16x32_bf16 v[166:169], v[108:111], v[84:87], v[206:209]
s_waitcnt lgkmcnt(1)
v_cvt_pk_bf16_f32 v179, v222, v223
v_fma_f32 v220, v60, v134, v135
v_mfma_f32_16x16x32_bf16 v[138:141], a[12:15], v[186:189], v[138:141]
v_fma_f32 v221, v61, v134, v135
v_fma_f32 v222, v62, v134, v135
v_mfma_f32_16x16x32_bf16 v[142:145], a[36:39], v[186:189], v[142:145]
v_fma_f32 v223, v63, v134, v135
v_cvt_pk_bf16_f32 v90, v220, v221
v_mfma_f32_16x16x32_bf16 v[146:149], a[60:63], v[186:189], v[146:149]
ds_read_b128 v[186:189], v210 offset:17408
v_cvt_pk_bf16_f32 v91, v222, v223
v_mfma_f32_16x16x16_bf16 v[154:157], v[82:83], v[88:89], v[154:157]
v_fma_f32 v220, v64, v134, v135
v_fma_f32 v221, v65, v134, v135
v_mfma_f32_16x16x16_bf16 v[158:161], v[100:101], v[88:89], v[158:161]
s_waitcnt lgkmcnt(1)
v_fma_f32 v222, v66, v134, v135
v_fma_f32 v223, v67, v134, v135
v_mfma_f32_16x16x32_bf16 v[138:141], a[16:19], v[182:185], v[138:141]
v_cvt_pk_bf16_f32 v92, v220, v221
v_cvt_pk_bf16_f32 v93, v222, v223
v_mfma_f32_16x16x32_bf16 v[142:145], a[40:43], v[182:185], v[142:145]
ds_write_b128 v211, v[90:93] offset:30720
v_mfma_f32_16x16x16_bf16 v[166:169], v[112:113], v[88:89], v[166:169]
v_fma_f32 v220, v68, v134, v135
v_fma_f32 v221, v69, v134, v135
v_mfma_f32_16x16x32_bf16 v[146:149], a[64:67], v[182:185], v[146:149]
s_waitcnt lgkmcnt(1)
v_fma_f32 v222, v70, v134, v135
v_fma_f32 v223, v71, v134, v135
v_mfma_f32_16x16x32_bf16 v[138:141], a[20:23], v[186:189], v[138:141]
ds_read_b128 v[182:185], v210 offset:12288
v_cvt_pk_bf16_f32 v132, v170, v171
v_mfma_f32_16x16x32_bf16 v[142:145], a[44:47], v[186:189], v[142:145]
v_cvt_pk_bf16_f32 v133, v172, v173
v_cvt_pk_bf16_f32 v94, v220, v221
v_mfma_f32_16x16x32_bf16 v[146:149], a[68:71], v[186:189], v[146:149]
v_cvt_pk_bf16_f32 v102, v138, v139
v_cvt_pk_bf16_f32 v103, v140, v141
v_mfma_f32_16x16x32_bf16 v[138:141], v[78:81], v[72:75], 0
v_cvt_pk_bf16_f32 v104, v142, v143
v_cvt_pk_bf16_f32 v105, v144, v145
v_mfma_f32_16x16x32_bf16 v[142:145], v[96:99], v[72:75], 0
v_cvt_pk_bf16_f32 v106, v146, v147
v_cvt_pk_bf16_f32 v107, v148, v149
v_mfma_f32_16x16x32_bf16 v[146:149], v[102:105], v[72:75], 0
ds_read_b128 v[186:189], v210 offset:13312
v_cvt_pk_bf16_f32 v95, v222, v223
v_mfma_f32_16x16x16_bf16 v[138:141], v[82:83], v[76:77], v[138:141]
buffer_load_dwordx4 v180, s[4:7], s40 offen nt lds
v_mfma_f32_16x16x16_bf16 v[142:145], v[100:101], v[76:77], v[142:145]
ds_write_b128 v211, v[174:177] offset:24576
v_mfma_f32_16x16x16_bf16 v[146:149], v[106:107], v[76:77], v[146:149]
v_exp_f32 v138, v138
v_mfma_f32_16x16x32_bf16 v[162:165], v[102:105], v[84:87], 0
s_waitcnt lgkmcnt(2)
v_exp_f32 v139, v139
v_mfma_f32_16x16x32_bf16 v[118:121], v[182:185], a[72:75], 0
v_exp_f32 v140, v140
v_mfma_f32_16x16x16_bf16 v[162:165], v[106:107], v[88:89], v[162:165]
v_exp_f32 v141, v141
v_mfma_f32_16x16x32_bf16 v[126:129], v[182:185], a[96:99], 0
v_exp_f32 v142, v142
v_mfma_f32_16x16x32_bf16 v[134:137], v[182:185], a[120:123], 0
v_exp_f32 v143, v143
v_mfma_f32_16x16x32_bf16 v[90:93], a[216:219], v[182:185], 0
v_exp_f32 v144, v144
v_mfma_f32_16x16x32_bf16 v[170:173], a[240:243], v[182:185], 0
v_exp_f32 v145, v145
v_mfma_f32_16x16x32_bf16 v[220:223], v[232:235], v[182:185], 0
s_waitcnt lgkmcnt(1)
ds_read_b128 v[182:185], v210 offset:14336
v_cvt_pk_bf16_f32 v174, v138, v139
v_mfma_f32_16x16x32_bf16 v[118:121], v[186:189], a[76:79], v[118:121]
v_exp_f32 v150, v150
v_mfma_f32_16x16x32_bf16 v[126:129], v[186:189], a[100:103], v[126:129]
v_cvt_pk_bf16_f32 v175, v140, v141
v_cvt_pk_bf16_f32 v176, v142, v143
v_mfma_f32_16x16x32_bf16 v[134:137], v[186:189], a[124:127], v[134:137]
v_cvt_pk_bf16_f32 v177, v144, v145
v_cvt_pk_bf16_f32 v180, v150, 0
v_mfma_f32_16x16x32_bf16 v[90:93], a[220:223], v[186:189], v[90:93]
ds_write_b64 v212, v[178:179] offset:24576
v_mfma_f32_16x16x32_bf16 v[170:173], a[244:247], v[186:189], v[170:173]
v_exp_f32 v146, v146
v_mfma_f32_16x16x32_bf16 v[220:223], v[236:239], v[186:189], v[220:223]
s_waitcnt lgkmcnt(1)
ds_read_b128 v[186:189], v210 offset:15360
ds_read_b128 v[72:75], v215
v_mfma_f32_16x16x32_bf16 v[118:121], v[182:185], a[80:83], v[118:121]
v_exp_f32 v147, v147
v_mfma_f32_16x16x32_bf16 v[126:129], v[182:185], a[104:107], v[126:129]
v_exp_f32 v148, v148
v_mfma_f32_16x16x32_bf16 v[134:137], v[182:185], a[128:131], v[134:137]
v_exp_f32 v149, v149
v_mfma_f32_16x16x32_bf16 v[90:93], a[224:227], v[182:185], v[90:93]
v_cvt_pk_bf16_f32 v178, v146, v147
v_cvt_pk_bf16_f32 v179, v148, v149
v_mfma_f32_16x16x32_bf16 v[170:173], a[248:251], v[182:185], v[170:173]
ds_write_b64 v212, v[94:95] offset:30720
v_mfma_f32_16x16x32_bf16 v[220:223], v[240:243], v[182:185], v[220:223]
s_waitcnt lgkmcnt(2)
v_exp_f32 v154, v154
v_mfma_f32_16x16x32_bf16 v[118:121], v[186:189], a[84:87], v[118:121]
ds_read_b128 v[182:185], v210 offset:16384
ds_read_b64 v[76:77], v215 offset:16
v_mfma_f32_16x16x32_bf16 v[126:129], v[186:189], a[108:111], v[126:129]
v_exp_f32 v155, v155
v_mfma_f32_16x16x32_bf16 v[134:137], v[186:189], a[132:135], v[134:137]
v_exp_f32 v156, v156
v_mfma_f32_16x16x32_bf16 v[90:93], a[228:231], v[186:189], v[90:93]
v_exp_f32 v157, v157
v_mfma_f32_16x16x32_bf16 v[170:173], a[252:255], v[186:189], v[170:173]
v_exp_f32 v158, v158
v_mfma_f32_16x16x32_bf16 v[220:223], v[244:247], v[186:189], v[220:223]
ds_read_b128 v[186:189], v210 offset:17408
v_exp_f32 v159, v159
v_mfma_f32_16x16x32_bf16 v[150:153], v[190:193], v[174:177], 0
s_waitcnt lgkmcnt(2)
v_exp_f32 v160, v160
v_mfma_f32_16x16x32_bf16 v[118:121], v[182:185], a[88:91], v[118:121]
v_exp_f32 v161, v161
v_mfma_f32_16x16x32_bf16 v[126:129], v[182:185], a[112:115], v[126:129]
v_exp_f32 v166, v166
v_mfma_f32_16x16x32_bf16 v[134:137], v[182:185], a[136:139], v[134:137]
v_exp_f32 v162, v162
v_mfma_f32_16x16x32_bf16 v[90:93], a[232:235], v[182:185], v[90:93]
v_exp_f32 v163, v163
v_mfma_f32_16x16x32_bf16 v[170:173], v[224:227], v[182:185], v[170:173]
v_exp_f32 v164, v164
v_mfma_f32_16x16x32_bf16 v[220:223], v[248:251], v[182:185], v[220:223]
s_waitcnt lgkmcnt(0)
v_exp_f32 v165, v165
v_mfma_f32_16x16x32_bf16 v[118:121], v[186:189], a[92:95], v[118:121]
v_mfma_f32_16x16x32_bf16 v[126:129], v[186:189], a[116:119], v[126:129]
v_mfma_f32_16x16x32_bf16 v[134:137], v[186:189], a[140:143], v[134:137]
v_cvt_pk_bf16_f32 v118, v118, v119
v_cvt_pk_bf16_f32 v119, v120, v121
v_mfma_f32_16x16x32_bf16 v[90:93], a[236:239], v[186:189], v[90:93]
ds_read_u16 v120, v216
v_cvt_pk_bf16_f32 v126, v126, v127
v_mfma_f32_16x16x32_bf16 v[170:173], v[228:231], v[186:189], v[170:173]
v_cvt_pk_bf16_f32 v127, v128, v129
v_cvt_pk_bf16_f32 v134, v134, v135
v_mfma_f32_16x16x32_bf16 v[220:223], v[252:255], v[186:189], v[220:223]
ds_read_u16 v128, v216 offset:32
v_cvt_pk_bf16_f32 v90, v90, v91
v_mfma_f32_16x16x32_bf16 v[138:141], v[114:117], v[174:177], 0
v_cvt_pk_bf16_f32 v91, v92, v93
v_cvt_pk_bf16_f32 v92, v170, v171
v_mfma_f32_16x16x32_bf16 v[142:145], v[122:125], v[174:177], 0
v_cvt_pk_bf16_f32 v93, v172, v173
v_cvt_pk_bf16_f32 v135, v136, v137
v_mfma_f32_16x16x32_bf16 v[146:149], v[130:133], v[174:177], 0
ds_read_u16 v136, v216 offset:64
v_mov_b32 v121, 0
v_mfma_f32_16x16x32_bf16 v[150:153], v[190:193], v[178:181], v[150:153]
s_waitcnt lgkmcnt(2)
v_mov_b32 v129, 0
v_cvt_pk_bf16_f32 v94, v220, v221
v_mfma_f32_16x16x32_bf16 v[138:141], v[118:121], v[178:181], v[138:141]
s_waitcnt lgkmcnt(1)
v_cvt_pk_bf16_f32 v95, v222, v223
v_mov_b32 v137, 0
v_mfma_f32_16x16x32_bf16 v[142:145], v[126:129], v[178:181], v[142:145]
v_rcp_f32 v151, v150
s_nop 0
v_max3_u32 v218, v218, v150, v151
v_mul_f32 v151, s3, v151
v_mul_f32 v138, v138, v151
v_mul_f32 v139, v139, v151
v_mul_f32 v140, v140, v151
v_mul_f32 v141, v141, v151
v_cvt_pk_bf16_f32 v138, v138, v139
v_mul_f32 v142, v142, v151
s_waitcnt lgkmcnt(0)
v_mfma_f32_16x16x32_bf16 v[146:149], v[134:137], v[178:181], v[146:149]
v_mul_f32 v143, v143, v151
v_mul_f32 v144, v144, v151
v_mul_f32 v145, v145, v151
v_cvt_pk_bf16_f32 v139, v140, v141
v_cvt_pk_bf16_f32 v140, v142, v143
v_cvt_pk_bf16_f32 v141, v144, v145
v_cvt_pk_bf16_f32 v174, v154, v155
v_mul_f32 v146, v146, v151
v_mul_f32 v147, v147, v151
v_mul_f32 v148, v148, v151
v_mul_f32 v149, v149, v151
v_mfma_f32_16x16x32_bf16 v[150:153], v[108:111], v[90:93], v[206:209]
ds_write_b128 v211, v[138:141] offset:36864
v_mfma_f32_16x16x32_bf16 v[138:141], v[78:81], v[90:93], 0
v_cvt_pk_bf16_f32 v142, v146, v147
v_cvt_pk_bf16_f32 v143, v148, v149
v_mfma_f32_16x16x32_bf16 v[146:149], v[102:105], v[90:93], 0
v_cvt_pk_bf16_f32 v175, v156, v157
v_cvt_pk_bf16_f32 v176, v158, v159
v_mfma_f32_16x16x16_bf16 v[138:141], v[82:83], v[94:95], v[138:141]
ds_write_b64 v212, v[142:143] offset:36864
v_mfma_f32_16x16x32_bf16 v[142:145], v[96:99], v[90:93], 0
v_cvt_pk_bf16_f32 v177, v160, v161
v_cvt_pk_bf16_f32 v180, v166, 0
v_mfma_f32_16x16x16_bf16 v[150:153], v[112:113], v[94:95], v[150:153]
v_cvt_pk_bf16_f32 v178, v162, v163
v_cvt_pk_bf16_f32 v179, v164, v165
v_mfma_f32_16x16x32_bf16 v[166:169], v[190:193], v[174:177], 0
v_exp_f32 v138, v138
v_mfma_f32_16x16x32_bf16 v[154:157], v[114:117], v[174:177], 0
v_exp_f32 v139, v139
v_mfma_f32_16x16x32_bf16 v[158:161], v[122:125], v[174:177], 0
v_exp_f32 v140, v140
v_mfma_f32_16x16x32_bf16 v[162:165], v[130:133], v[174:177], 0
v_exp_f32 v141, v141
v_mfma_f32_16x16x16_bf16 v[142:145], v[100:101], v[94:95], v[142:145]
v_exp_f32 v150, v150
v_mfma_f32_16x16x32_bf16 v[166:169], v[190:193], v[178:181], v[166:169]
v_cvt_pk_bf16_f32 v174, v138, v139
v_cvt_pk_bf16_f32 v175, v140, v141
v_mfma_f32_16x16x32_bf16 v[154:157], v[118:121], v[178:181], v[154:157]
v_exp_f32 v142, v142
v_mfma_f32_16x16x32_bf16 v[158:161], v[126:129], v[178:181], v[158:161]
v_rcp_f32 v167, v166
v_mfma_f32_16x16x32_bf16 v[162:165], v[134:137], v[178:181], v[162:165]
v_max3_u32 v218, v218, v166, v167
v_mul_f32 v167, s3, v167
v_mfma_f32_16x16x16_bf16 v[146:149], v[106:107], v[94:95], v[146:149]
v_mul_f32 v154, v154, v167
v_mul_f32 v155, v155, v167
v_mul_f32 v156, v156, v167
v_mul_f32 v157, v157, v167
v_cvt_pk_bf16_f32 v154, v154, v155
v_mul_f32 v158, v158, v167
v_mul_f32 v159, v159, v167
v_mul_f32 v160, v160, v167
v_mul_f32 v161, v161, v167
v_cvt_pk_bf16_f32 v155, v156, v157
v_cvt_pk_bf16_f32 v156, v158, v159
v_cvt_pk_bf16_f32 v157, v160, v161
v_mul_f32 v162, v162, v167
v_mul_f32 v163, v163, v167
v_mul_f32 v164, v164, v167
v_mul_f32 v165, v165, v167
v_mfma_f32_16x16x32_bf16 v[166:169], v[72:75], v[108:111], v[206:209]
ds_write_b128 v211, v[154:157] offset:43008
v_mfma_f32_16x16x32_bf16 v[154:157], v[72:75], v[78:81], 0
v_cvt_pk_bf16_f32 v158, v162, v163
v_cvt_pk_bf16_f32 v159, v164, v165
v_mfma_f32_16x16x32_bf16 v[162:165], v[72:75], v[102:105], 0
v_exp_f32 v143, v143
v_mfma_f32_16x16x16_bf16 v[154:157], v[76:77], v[82:83], v[154:157]
ds_write_b64 v212, v[158:159] offset:43008
v_mfma_f32_16x16x32_bf16 v[158:161], v[72:75], v[96:99], 0
v_exp_f32 v144, v144
v_mfma_f32_16x16x16_bf16 v[162:165], v[76:77], v[106:107], v[162:165]
v_exp_f32 v145, v145
v_mfma_f32_16x16x16_bf16 v[158:161], v[76:77], v[100:101], v[158:161]
v_cvt_pk_bf16_f32 v176, v142, v143
v_cvt_pk_bf16_f32 v177, v144, v145
v_mfma_f32_16x16x16_bf16 v[166:169], v[76:77], v[112:113], v[166:169]
v_cvt_pk_bf16_f32 v180, v150, 0
v_exp_f32 v146, v146
v_mfma_f32_16x16x32_bf16 v[150:153], v[190:193], v[174:177], 0
v_exp_f32 v147, v147
v_mfma_f32_16x16x32_bf16 v[138:141], v[114:117], v[174:177], 0
s_waitcnt lgkmcnt(0)
v_exp_f32 v148, v148
v_mfma_f32_16x16x32_bf16 v[142:145], v[122:125], v[174:177], 0
s_barrier
ds_read_b128 v[170:173], v210 offset:36864
v_exp_f32 v149, v149
v_mov_b32_dpp v154, v158 quad_perm:[0,1,2,3] row_mask:0x2 bank_mask:0xf
v_cvt_pk_bf16_f32 v178, v146, v147
v_cvt_pk_bf16_f32 v179, v148, v149
v_mfma_f32_16x16x32_bf16 v[146:149], v[130:133], v[174:177], 0
v_mov_b32_dpp v154, v162 quad_perm:[0,1,2,3] row_mask:0x4 bank_mask:0xf
v_mfma_f32_16x16x32_bf16 v[150:153], v[190:193], v[178:181], v[150:153]
ds_read_b128 v[182:185], v210 offset:37888
v_mov_b32_dpp v154, v167 quad_perm:[0,1,2,3] row_mask:0x8 bank_mask:0xf
v_mfma_f32_16x16x32_bf16 v[138:141], v[118:121], v[178:181], v[138:141]
v_exp_f32 v154, v154
v_mfma_f32_16x16x32_bf16 v[142:145], v[126:129], v[178:181], v[142:145]
v_cvt_pk_bf16_f32 v154, v154, 0
v_rcp_f32 v151, v150
v_mfma_f32_16x16x32_bf16 v[146:149], v[134:137], v[178:181], v[146:149]
s_waitcnt lgkmcnt(1)
ds_write_b16 v214, v154
v_mfma_f32_16x16x32_bf16 v[0:3], a[144:147], v[170:173], v[0:3]
ds_read_b128 v[84:87], v215
ds_read_b128 v[88:91], v215 offset:16
v_mfma_f32_16x16x32_bf16 v[4:7], a[168:171], v[170:173], v[4:7]
ds_read_b128 v[186:189], v210 offset:38912
ds_read_b128 v[174:177], v217
v_mfma_f32_16x16x32_bf16 v[8:11], a[192:195], v[170:173], v[8:11]
s_waitcnt lgkmcnt(5)
ds_read_b128 v[170:173], v210 offset:39936
ds_read_b128 v[178:181], v217 offset:528
v_mfma_f32_16x16x32_bf16 v[0:3], a[148:151], v[182:185], v[0:3]
v_mfma_f32_16x16x32_bf16 v[4:7], a[172:175], v[182:185], v[4:7]
v_mfma_f32_16x16x32_bf16 v[8:11], a[196:199], v[182:185], v[8:11]
ds_read_b128 v[182:185], v210 offset:40960
s_waitcnt lgkmcnt(6)
v_mfma_f32_16x16x32_bf16 v[166:169], v[84:87], v[190:193], 0
v_mfma_f32_16x16x32_bf16 v[154:157], v[84:87], v[114:117], 0
v_mfma_f32_16x16x32_bf16 v[158:161], v[84:87], v[122:125], 0
v_mfma_f32_16x16x32_bf16 v[162:165], v[84:87], v[130:133], 0
s_waitcnt lgkmcnt(5)
v_mfma_f32_16x16x32_bf16 v[166:169], v[88:91], v[190:193], v[166:169]
s_waitcnt lgkmcnt(4)
v_mfma_f32_16x16x32_bf16 v[0:3], a[152:155], v[186:189], v[0:3]
v_mfma_f32_16x16x32_bf16 v[154:157], v[88:91], v[118:121], v[154:157]
v_rcp_f32 v167, v166
v_mfma_f32_16x16x32_bf16 v[4:7], a[176:179], v[186:189], v[4:7]
v_max3_u32 v218, v218, v166, v167
v_max3_u32 v218, v218, v150, v151
v_mfma_f32_16x16x32_bf16 v[158:161], v[88:91], v[126:129], v[158:161]
v_mul_f32 v151, s3, v151
v_mul_f32 v138, v138, v151
v_mfma_f32_16x16x32_bf16 v[8:11], a[200:203], v[186:189], v[8:11]
ds_read_b128 v[186:189], v210 offset:41984
v_mul_f32 v139, v139, v151
v_mfma_f32_16x16x32_bf16 v[162:165], v[88:91], v[134:137], v[162:165]
s_waitcnt lgkmcnt(3)
v_mul_f32 v140, v140, v151
v_mul_f32 v141, v141, v151
v_mfma_f32_16x16x32_bf16 v[0:3], a[156:159], v[170:173], v[0:3]
v_cvt_pk_bf16_f32 v138, v138, v139
v_mul_f32 v142, v142, v151
v_mfma_f32_16x16x32_bf16 v[4:7], a[180:183], v[170:173], v[4:7]
v_mul_f32 v143, v143, v151
v_mul_f32 v144, v144, v151
v_mfma_f32_16x16x32_bf16 v[8:11], a[204:207], v[170:173], v[8:11]
s_waitcnt lgkmcnt(1)
ds_read_b128 v[170:173], v210 offset:43008
v_mul_f32 v145, v145, v151
v_mfma_f32_16x16x32_bf16 v[0:3], a[160:163], v[182:185], v[0:3]
v_cvt_pk_bf16_f32 v139, v140, v141
v_cvt_pk_bf16_f32 v140, v142, v143
v_mfma_f32_16x16x32_bf16 v[4:7], a[184:187], v[182:185], v[4:7]
v_cvt_pk_bf16_f32 v141, v144, v145
v_mul_f32 v146, v146, v151
v_mfma_f32_16x16x32_bf16 v[8:11], a[208:211], v[182:185], v[8:11]
s_waitcnt lgkmcnt(1)
ds_read_b128 v[182:185], v210 offset:44032
ds_write_b128 v211, v[138:141] offset:49152
v_mfma_f32_16x16x32_bf16 v[0:3], a[164:167], v[186:189], v[0:3]
v_mul_f32 v147, v147, v151
v_mul_f32 v148, v148, v151
v_mfma_f32_16x16x32_bf16 v[4:7], a[188:191], v[186:189], v[4:7]
v_mul_f32 v149, v149, v151
v_cvt_pk_bf16_f32 v142, v146, v147
v_mfma_f32_16x16x32_bf16 v[8:11], a[212:215], v[186:189], v[8:11]
s_waitcnt lgkmcnt(2)
ds_read_b128 v[186:189], v210 offset:45056
v_cvt_pk_bf16_f32 v143, v148, v149
v_mfma_f32_16x16x32_bf16 v[12:15], a[144:147], v[170:173], v[12:15]
ds_write_b64 v212, v[142:143] offset:49152
v_mfma_f32_16x16x32_bf16 v[16:19], a[168:171], v[170:173], v[16:19]
v_cvt_pk_bf16_f32 v72, v0, v1
v_cvt_pk_bf16_f32 v73, v2, v3
v_mfma_f32_16x16x32_bf16 v[20:23], a[192:195], v[170:173], v[20:23]
s_waitcnt lgkmcnt(3)
ds_read_b128 v[170:173], v210 offset:46080
buffer_store_dwordx2 v[72:73], v203, s[8:11], s38 offen
v_cvt_pk_bf16_f32 v74, v4, v5
v_mfma_f32_16x16x32_bf16 v[12:15], a[148:151], v[182:185], v[12:15]
v_cvt_pk_bf16_f32 v75, v6, v7
v_mov_b32_dpp v154, v158 quad_perm:[0,1,2,3] row_mask:0x2 bank_mask:0xf
v_mfma_f32_16x16x32_bf16 v[16:19], a[172:175], v[182:185], v[16:19]
v_mul_f32 v167, s3, v167
v_mov_b32_dpp v154, v162 quad_perm:[0,1,2,3] row_mask:0x4 bank_mask:0xf
v_mfma_f32_16x16x32_bf16 v[20:23], a[196:199], v[182:185], v[20:23]
s_waitcnt lgkmcnt(2)
ds_read_b128 v[182:185], v210 offset:47104
v_mul_f32 v154, v154, v167
v_mfma_f32_16x16x32_bf16 v[12:15], a[152:155], v[186:189], v[12:15]
v_cvt_pk_bf16_f32 v154, v154, 0
v_cvt_pk_bf16_f32 v76, v8, v9
v_mfma_f32_16x16x32_bf16 v[16:19], a[176:179], v[186:189], v[16:19]
s_waitcnt vmcnt(1) lgkmcnt(1)
ds_write_b16 v214, v154
v_mfma_f32_16x16x32_bf16 v[20:23], a[200:203], v[186:189], v[20:23]
s_barrier
v_mfma_f32_16x16x32_bf16 v[12:15], a[156:159], v[170:173], v[12:15]
ds_read_b128 v[186:189], v210 offset:48128
ds_read_b128 v[84:87], v200
v_mfma_f32_16x16x32_bf16 v[16:19], a[180:183], v[170:173], v[16:19]
ds_read_b128 v[92:95], v201
ds_read_b128 v[100:103], v202
v_mfma_f32_16x16x32_bf16 v[20:23], a[204:207], v[170:173], v[20:23]
s_waitcnt lgkmcnt(5)
ds_read_b128 v[170:173], v210 offset:49152
ds_read_b128 v[88:91], v194 offset:16
v_mfma_f32_16x16x32_bf16 v[12:15], a[160:163], v[182:185], v[12:15]
ds_read_b128 v[96:99], v195 offset:16
buffer_store_dwordx2 v[74:75], v203, s[8:11], s38 offen offset:32
v_cvt_pk_bf16_f32 v77, v10, v11
v_mfma_f32_16x16x32_bf16 v[16:19], a[184:187], v[182:185], v[16:19]
s_mul_hi_u32 s41, s35, 58835169
ds_read_b128 v[104:107], v196 offset:16
v_add_u32 v215, 1408, v215
v_mfma_f32_16x16x32_bf16 v[20:23], a[208:211], v[182:185], v[20:23]
s_waitcnt lgkmcnt(7)
ds_read_b128 v[182:185], v210 offset:50176
s_mul_i32 s42, s41, 73
v_mfma_f32_16x16x32_bf16 v[12:15], a[164:167], v[186:189], v[12:15]
s_waitcnt lgkmcnt(7)
ds_read_b64 v[112:113], v215 offset:528
s_sub_u32 s42, s35, s42
v_mfma_f32_16x16x32_bf16 v[16:19], a[188:191], v[186:189], v[16:19]
s_mul_i32 s43, s41, 1373568
s_mul_i32 s51, s42, 2688
s_add_u32 s43, s43, s51
v_mfma_f32_16x16x32_bf16 v[20:23], a[212:215], v[186:189], v[20:23]
s_mov_b32 s39, s37
ds_read_b128 v[186:189], v210 offset:51200
v_cvt_pk_bf16_f32 v78, v12, v13
v_mfma_f32_16x16x32_bf16 v[0:3], v[174:177], v[84:87], 0
s_waitcnt lgkmcnt(6)
ds_read_b128 v[84:87], v194
v_cvt_pk_bf16_f32 v79, v14, v15
v_mfma_f32_16x16x32_bf16 v[12:15], v[174:177], v[92:95], 0
s_cmp_lt_u32 s35, s34
ds_read_b128 v[92:95], v195
v_cvt_pk_bf16_f32 v80, v16, v17
v_mfma_f32_16x16x32_bf16 v[24:27], a[144:147], v[170:173], v[24:27]
s_cselect_b32 s37, s43, 1879048192
v_cvt_pk_bf16_f32 v81, v18, v19
v_cvt_pk_bf16_f32 v82, v20, v21
v_mfma_f32_16x16x32_bf16 v[28:31], a[168:171], v[170:173], v[28:31]
s_add_u32 s35, s35, 32
v_cvt_pk_bf16_f32 v83, v22, v23
s_cmp_eq_u32 s42, 0
v_mfma_f32_16x16x32_bf16 v[32:35], a[192:195], v[170:173], v[32:35]
s_waitcnt lgkmcnt(4)
ds_read_b128 v[170:173], v210 offset:52224
s_cselect_b32 s44, 536870911, s72
v_mfma_f32_16x16x32_bf16 v[24:27], a[148:151], v[182:185], v[24:27]
s_cmp_eq_u32 s42, 72
buffer_store_dwordx2 v[76:77], v203, s[8:11], s38 offen offset:64
s_cselect_b32 s44, 939524095, s44
v_mfma_f32_16x16x32_bf16 v[28:31], a[172:175], v[182:185], v[28:31]
s_cmp_eq_u32 s41, 0
s_cselect_b32 s40, 1879048192, s37
v_mfma_f32_16x16x32_bf16 v[32:35], a[196:199], v[182:185], v[32:35]
s_waitcnt lgkmcnt(3)
ds_read_b128 v[182:185], v210 offset:53248
s_add_u32 m0, s45, 0
v_mfma_f32_16x16x32_bf16 v[24:27], a[152:155], v[186:189], v[24:27]
v_mfma_f32_16x16x32_bf16 v[28:31], a[176:179], v[186:189], v[28:31]
v_mfma_f32_16x16x32_bf16 v[32:35], a[200:203], v[186:189], v[32:35]
ds_read_b128 v[186:189], v210 offset:54272
s_waitcnt lgkmcnt(2)
v_mfma_f32_16x16x32_bf16 v[24:27], a[156:159], v[170:173], v[24:27]
v_mfma_f32_16x16x32_bf16 v[28:31], a[180:183], v[170:173], v[28:31]
v_mfma_f32_16x16x32_bf16 v[32:35], a[204:207], v[170:173], v[32:35]
s_waitcnt lgkmcnt(1)
v_mfma_f32_16x16x32_bf16 v[24:27], a[160:163], v[182:185], v[24:27]
v_mfma_f32_16x16x32_bf16 v[28:31], a[184:187], v[182:185], v[28:31]
v_mfma_f32_16x16x32_bf16 v[32:35], a[208:211], v[182:185], v[32:35]
ds_read_b128 v[182:185], v210 offset:18432
s_waitcnt lgkmcnt(1)
v_mfma_f32_16x16x32_bf16 v[24:27], a[164:167], v[186:189], v[24:27]
v_smfmac_f32_16x16x64_bf16 v[0:3], v[178:181], v[84:91], v213
ds_read_b128 v[84:87], v197
ds_read_b128 v[88:91], v197 offset:16
v_mfma_f32_16x16x32_bf16 v[28:31], a[188:191], v[186:189], v[28:31]
v_cvt_pk_bf16_f32 v116, v24, v25
v_cvt_pk_bf16_f32 v117, v26, v27
v_mfma_f32_16x16x32_bf16 v[24:27], v[174:177], v[100:103], 0
ds_read_b128 v[100:103], v196
ds_read_b128 v[174:177], v217 offset:1056
v_mfma_f32_16x16x32_bf16 v[32:35], a[212:215], v[186:189], v[32:35]
v_cvt_pk_bf16_f32 v124, v28, v29
v_cvt_pk_bf16_f32 v125, v30, v31
v_smfmac_f32_16x16x64_bf16 v[12:15], v[178:181], v[92:99], v213
s_waitcnt lgkmcnt(4)
ds_read_b128 v[92:95], v198
ds_read_b128 v[96:99], v198 offset:16
v_mfma_f32_16x16x32_bf16 v[138:141], a[0:3], v[182:185], 0
ds_read_b128 v[186:189], v210 offset:19456
v_cvt_pk_bf16_f32 v132, v32, v33
v_mfma_f32_16x16x32_bf16 v[142:145], a[24:27], v[182:185], 0
v_cvt_pk_bf16_f32 v133, v34, v35
v_mfma_f32_16x16x32_bf16 v[146:149], a[48:51], v[182:185], 0
buffer_store_dwordx2 v[78:79], v204, s[8:11], s38 offen
s_waitcnt lgkmcnt(4)
v_smfmac_f32_16x16x64_bf16 v[24:27], v[178:181], v[100:107], v213
s_waitcnt lgkmcnt(3)
ds_read_b128 v[100:103], v199
ds_read_b128 v[104:107], v199 offset:16
v_smfmac_f32_16x16x64_bf16 v[0:3], v[174:177], v[84:91], v213
ds_read_b128 v[84:87], v200 offset:32
ds_read_b128 v[178:181], v217 offset:1584
v_mfma_f32_16x16x32_bf16 v[150:153], a[216:219], v[182:185], 0
ds_read_b128 v[88:91], v194 offset:48
s_waitcnt lgkmcnt(6)
v_smfmac_f32_16x16x64_bf16 v[12:15], v[174:177], v[92:99], v213
ds_read_b128 v[92:95], v201 offset:32
ds_read_b128 v[96:99], v195 offset:48
v_mfma_f32_16x16x32_bf16 v[154:157], a[240:243], v[182:185], 0
v_mul_f32 v119, v0, v0
v_add_f32 v118, v0, v1
v_mfma_f32_16x16x32_bf16 v[158:161], v[232:235], v[182:185], 0
v_mul_f32 v127, v12, v12
v_add_f32 v126, v12, v13
v_mfma_f32_16x16x32_bf16 v[162:165], v[182:185], a[72:75], 0
v_fmac_f32 v119, v1, v1
v_fmac_f32 v127, v13, v13
v_mfma_f32_16x16x32_bf16 v[166:169], v[182:185], a[96:99], 0
s_waitcnt lgkmcnt(5)
v_add_f32 v118, v118, v2
v_add_f32 v126, v126, v14
v_smfmac_f32_16x16x64_bf16 v[24:27], v[174:177], v[100:107], v213
ds_read_b128 v[100:103], v202 offset:32
ds_read_b128 v[174:177], v217 offset:2112
v_mfma_f32_16x16x32_bf16 v[170:173], v[182:185], a[120:123], 0
s_waitcnt lgkmcnt(5)
ds_read_b128 v[104:107], v196 offset:48
ds_read_b128 v[182:185], v210 offset:20480
v_mfma_f32_16x16x32_bf16 v[4:7], v[178:181], v[84:87], 0
ds_read_b128 v[84:87], v194 offset:32
v_mul_f32 v135, v24, v24
v_mfma_f32_16x16x32_bf16 v[138:141], a[4:7], v[186:189], v[138:141]
s_waitcnt lgkmcnt(6)
buffer_store_dwordx2 v[80:81], v204, s[8:11], s38 offen offset:32
v_add_f32 v134, v24, v25
v_mfma_f32_16x16x32_bf16 v[16:19], v[178:181], v[92:95], 0
ds_read_b128 v[92:95], v195 offset:32
v_fmac_f32 v135, v25, v25
v_mfma_f32_16x16x32_bf16 v[142:145], a[28:31], v[186:189], v[142:145]
s_waitcnt lgkmcnt(5)
v_add_f32 v134, v134, v26
v_fmac_f32 v135, v26, v26
v_mfma_f32_16x16x32_bf16 v[28:31], v[178:181], v[100:103], 0
ds_read_b128 v[100:103], v196 offset:32
ds_read_b128 v[178:181], v217 offset:2640
v_mfma_f32_16x16x32_bf16 v[146:149], a[52:55], v[186:189], v[146:149]
v_fmac_f32 v119, v2, v2
v_fmac_f32 v127, v14, v14
v_mfma_f32_16x16x32_bf16 v[150:153], a[220:223], v[186:189], v[150:153]
v_add_f32 v134, v134, v27
v_fmac_f32 v135, v27, v27
v_mfma_f32_16x16x32_bf16 v[154:157], a[244:247], v[186:189], v[154:157]
s_waitcnt lgkmcnt(3)
v_add_f32 v118, v118, v3
v_add_f32 v126, v126, v15
v_smfmac_f32_16x16x64_bf16 v[4:7], v[174:177], v[84:91], v213
s_waitcnt lgkmcnt(2)
ds_read_b128 v[84:87], v197 offset:32
ds_read_b128 v[88:91], v197 offset:48
v_smfmac_f32_16x16x64_bf16 v[16:19], v[174:177], v[92:99], v213
ds_read_b128 v[92:95], v198 offset:32
ds_read_b128 v[96:99], v198 offset:48
v_mfma_f32_16x16x32_bf16 v[158:161], v[236:239], v[186:189], v[158:161]
s_waitcnt lgkmcnt(5)
v_fmac_f32 v119, v3, v3
v_fmac_f32 v127, v15, v15
v_smfmac_f32_16x16x64_bf16 v[28:31], v[174:177], v[100:107], v213
ds_read_b128 v[100:103], v199 offset:32
ds_read_b128 v[104:107], v199 offset:48
v_mfma_f32_16x16x32_bf16 v[162:165], v[186:189], a[76:79], v[162:165]
ds_read_b128 v[174:177], v217 offset:3168
v_mfma_f32_16x16x32_bf16 v[166:169], v[186:189], a[100:103], v[166:169]
v_mfma_f32_16x16x32_bf16 v[170:173], v[186:189], a[124:127], v[170:173]
ds_read_b128 v[186:189], v210 offset:21504
s_waitcnt lgkmcnt(6)
v_smfmac_f32_16x16x64_bf16 v[4:7], v[178:181], v[84:91], v213
ds_read_b128 v[84:87], v200 offset:64
ds_read_b128 v[88:91], v194 offset:80
v_mfma_f32_16x16x32_bf16 v[138:141], a[8:11], v[182:185], v[138:141]
s_waitcnt lgkmcnt(6)
buffer_store_dwordx2 v[82:83], v204, s[8:11], s38 offen offset:64
s_nop 1
v_add_f32 v118, v118, v4
v_smfmac_f32_16x16x64_bf16 v[16:19], v[178:181], v[92:99], v213
ds_read_b128 v[92:95], v201 offset:64
ds_read_b128 v[96:99], v195 offset:80
v_mfma_f32_16x16x32_bf16 v[142:145], a[32:35], v[182:185], v[142:145]
s_waitcnt lgkmcnt(6)
v_fmac_f32 v119, v4, v4
v_add_f32 v118, v118, v5
v_smfmac_f32_16x16x64_bf16 v[28:31], v[178:181], v[100:107], v213
ds_read_b128 v[100:103], v202 offset:64
ds_read_b128 v[178:181], v217 offset:3696
v_mfma_f32_16x16x32_bf16 v[146:149], a[56:59], v[182:185], v[146:149]
ds_read_b128 v[104:107], v196 offset:80
v_add_f32 v126, v126, v16
v_mfma_f32_16x16x32_bf16 v[150:153], a[224:227], v[182:185], v[150:153]
s_waitcnt lgkmcnt(6)
v_add_f32 v134, v134, v28
v_fmac_f32 v135, v28, v28
v_mfma_f32_16x16x32_bf16 v[8:11], v[174:177], v[84:87], 0
ds_read_b128 v[84:87], v194 offset:64
v_fmac_f32 v127, v16, v16
v_mfma_f32_16x16x32_bf16 v[154:157], a[248:251], v[182:185], v[154:157]
s_waitcnt lgkmcnt(5)
v_add_f32 v134, v134, v29
v_fmac_f32 v135, v29, v29
v_mfma_f32_16x16x32_bf16 v[20:23], v[174:177], v[92:95], 0
ds_read_b128 v[92:95], v195 offset:64
v_fmac_f32 v119, v5, v5
v_mfma_f32_16x16x32_bf16 v[158:161], v[240:243], v[182:185], v[158:161]
s_waitcnt lgkmcnt(4)
v_add_f32 v126, v126, v17
v_fmac_f32 v127, v17, v17
v_mfma_f32_16x16x32_bf16 v[32:35], v[174:177], v[100:103], 0
ds_read_b128 v[100:103], v196 offset:64
ds_read_b128 v[174:177], v217 offset:4224
v_mfma_f32_16x16x32_bf16 v[162:165], v[182:185], a[80:83], v[162:165]
v_add_f32 v134, v134, v30
v_fmac_f32 v135, v30, v30
v_mfma_f32_16x16x32_bf16 v[166:169], v[182:185], a[104:107], v[166:169]
s_waitcnt lgkmcnt(3)
v_add_f32 v118, v118, v6
v_fmac_f32 v119, v6, v6
v_smfmac_f32_16x16x64_bf16 v[8:11], v[178:181], v[84:91], v213
ds_read_b128 v[84:87], v197 offset:64
ds_read_b128 v[88:91], v197 offset:80
v_mfma_f32_16x16x32_bf16 v[170:173], v[182:185], a[128:131], v[170:173]
s_waitcnt lgkmcnt(4)
ds_read_b128 v[182:185], v210 offset:22528
v_add_f32 v126, v126, v18
v_smfmac_f32_16x16x64_bf16 v[20:23], v[178:181], v[92:99], v213
ds_read_b128 v[92:95], v198 offset:64
ds_read_b128 v[96:99], v198 offset:80
v_mfma_f32_16x16x32_bf16 v[138:141], a[12:15], v[186:189], v[138:141]
s_waitcnt lgkmcnt(6)
v_fmac_f32 v127, v18, v18
v_add_f32 v134, v134, v31
v_smfmac_f32_16x16x64_bf16 v[32:35], v[178:181], v[100:107], v213
ds_read_b128 v[100:103], v199 offset:64
ds_read_b128 v[104:107], v199 offset:80
v_mfma_f32_16x16x32_bf16 v[142:145], a[36:39], v[186:189], v[142:145]
v_fmac_f32 v135, v31, v31
v_add_f32 v118, v118, v7
v_mfma_f32_16x16x32_bf16 v[146:149], a[60:63], v[186:189], v[146:149]
v_fmac_f32 v119, v7, v7
v_add_f32 v126, v126, v19
v_mfma_f32_16x16x32_bf16 v[150:153], a[228:231], v[186:189], v[150:153]
s_waitcnt lgkmcnt(5)
v_fmac_f32 v127, v19, v19
v_and_b32 v180, s44, v208
v_smfmac_f32_16x16x64_bf16 v[8:11], v[174:177], v[84:91], v213
buffer_store_dwordx2 v[116:117], v205, s[8:11], s38 offen
v_add_u32 v216, 1408, v216
v_mfma_f32_16x16x32_bf16 v[154:157], a[252:255], v[186:189], v[154:157]
v_mov_b32 v181, 0
s_waitcnt lgkmcnt(2)
v_smfmac_f32_16x16x64_bf16 v[20:23], v[174:177], v[92:99], v213
v_add_f32 v118, v118, v8
v_fmac_f32 v119, v8, v8
v_mfma_f32_16x16x32_bf16 v[158:161], v[244:247], v[186:189], v[158:161]
s_waitcnt lgkmcnt(0)
v_add_f32 v118, v118, v9
v_fmac_f32 v119, v9, v9
v_smfmac_f32_16x16x64_bf16 v[32:35], v[174:177], v[100:107], v213
v_add_f32 v126, v126, v20
v_fmac_f32 v127, v20, v20
v_mfma_f32_16x16x32_bf16 v[162:165], v[186:189], a[84:87], v[162:165]
v_add_f32 v126, v126, v21
v_fmac_f32 v127, v21, v21
v_mfma_f32_16x16x32_bf16 v[166:169], v[186:189], a[108:111], v[166:169]
v_add_f32 v134, v134, v32
v_fmac_f32 v135, v32, v32
v_mfma_f32_16x16x32_bf16 v[170:173], v[186:189], a[132:135], v[170:173]
ds_read_b128 v[186:189], v210 offset:23552
v_add_f32 v134, v134, v33
v_mfma_f32_16x16x32_bf16 v[138:141], a[16:19], v[182:185], v[138:141]
v_fmac_f32 v135, v33, v33
v_add_f32 v134, v134, v34
v_mfma_f32_16x16x32_bf16 v[142:145], a[40:43], v[182:185], v[142:145]
v_fmac_f32 v135, v34, v34
v_add_f32 v118, v118, v10
v_mfma_f32_16x16x32_bf16 v[146:149], a[64:67], v[182:185], v[146:149]
v_fmac_f32 v119, v10, v10
v_add_f32 v126, v126, v22
v_mfma_f32_16x16x32_bf16 v[150:153], a[232:235], v[182:185], v[150:153]
v_fmac_f32 v127, v22, v22
v_add_f32 v134, v134, v35
v_mfma_f32_16x16x32_bf16 v[154:157], v[224:227], v[182:185], v[154:157]
v_fmac_f32 v135, v35, v35
v_add_f32 v118, v118, v11
v_mfma_f32_16x16x32_bf16 v[158:161], v[248:251], v[182:185], v[158:161]
v_fmac_f32 v119, v11, v11
v_add_f32 v126, v126, v23
v_mfma_f32_16x16x32_bf16 v[162:165], v[182:185], a[88:91], v[162:165]
v_fmac_f32 v127, v23, v23
v_add_u32 v214, 1408, v214
v_mfma_f32_16x16x32_bf16 v[166:169], v[182:185], a[112:115], v[166:169]
v_permlane16_swap_b32 v134, v135
v_mfma_f32_16x16x32_bf16 v[170:173], v[182:185], a[136:139], v[170:173]
s_waitcnt lgkmcnt(0)
ds_read_b128 v[182:185], v210 offset:24576
v_add_f32 v134, v134, v135
v_mfma_f32_16x16x32_bf16 v[138:141], a[20:23], v[186:189], v[138:141]
v_permlane16_swap_b32 v118, v119
v_mfma_f32_16x16x32_bf16 v[142:145], a[44:47], v[186:189], v[142:145]
v_permlane16_swap_b32 v126, v127
v_mfma_f32_16x16x32_bf16 v[146:149], a[68:71], v[186:189], v[146:149]
v_cvt_pk_bf16_f32 v78, v138, v139
v_cvt_pk_bf16_f32 v79, v140, v141
v_mfma_f32_16x16x32_bf16 v[150:153], a[236:239], v[186:189], v[150:153]
v_cvt_pk_bf16_f32 v80, v142, v143
v_cvt_pk_bf16_f32 v81, v144, v145
v_mfma_f32_16x16x32_bf16 v[154:157], v[228:231], v[186:189], v[154:157]
v_cvt_pk_bf16_f32 v82, v146, v147
v_cvt_pk_bf16_f32 v83, v148, v149
v_mfma_f32_16x16x32_bf16 v[158:161], v[252:255], v[186:189], v[158:161]
v_cvt_pk_bf16_f32 v72, v150, v151
v_cvt_pk_bf16_f32 v73, v152, v153
v_mfma_f32_16x16x32_bf16 v[162:165], v[186:189], a[92:95], v[162:165]
v_cvt_pk_bf16_f32 v74, v154, v155
v_cvt_pk_bf16_f32 v75, v156, v157
v_mfma_f32_16x16x32_bf16 v[166:169], v[186:189], a[116:119], v[166:169]
v_cvt_pk_bf16_f32 v76, v158, v159
v_cvt_pk_bf16_f32 v77, v160, v161
v_mfma_f32_16x16x32_bf16 v[170:173], v[186:189], a[140:143], v[170:173]
s_waitcnt lgkmcnt(0)
ds_read_b128 v[186:189], v210 offset:25600
v_cvt_pk_bf16_f32 v114, v162, v163
v_mfma_f32_16x16x32_bf16 v[138:141], a[0:3], v[182:185], 0
v_cvt_pk_bf16_f32 v115, v164, v165
v_cvt_pk_bf16_f32 v122, v166, v167
v_mfma_f32_16x16x32_bf16 v[142:145], a[24:27], v[182:185], 0
v_cvt_pk_bf16_f32 v123, v168, v169
v_cvt_pk_bf16_f32 v130, v170, v171
v_mfma_f32_16x16x32_bf16 v[146:149], a[48:51], v[182:185], 0
v_cvt_pk_bf16_f32 v131, v172, v173
v_mov_b32 v135, v134
v_mfma_f32_16x16x32_bf16 v[150:153], a[216:219], v[182:185], 0
v_add_f32 v118, v118, v119
v_add_f32 v126, v126, v127
v_mfma_f32_16x16x32_bf16 v[154:157], a[240:243], v[182:185], 0
v_permlane32_swap_b32 v134, v135
v_mfma_f32_16x16x32_bf16 v[158:161], v[232:235], v[182:185], 0
v_permlane32_swap_b32 v118, v126
v_mfma_f32_16x16x32_bf16 v[162:165], v[182:185], a[72:75], 0
v_add_f32 v134, v134, v135
v_add_f32 v118, v118, v126
v_mfma_f32_16x16x32_bf16 v[166:169], v[182:185], a[96:99], 0
ds_write_b32 v209, v134 offset:512
v_mfma_f32_16x16x32_bf16 v[170:173], v[182:185], a[120:123], 0
s_waitcnt lgkmcnt(1)
ds_read_b128 v[182:185], v210 offset:26624
ds_write_b32 v209, v118
v_mfma_f32_16x16x32_bf16 v[138:141], a[4:7], v[186:189], v[138:141]
buffer_store_dwordx2 v[124:125], v205, s[8:11], s38 offen offset:32
v_mfma_f32_16x16x32_bf16 v[142:145], a[28:31], v[186:189], v[142:145]
v_mfma_f32_16x16x32_bf16 v[146:149], a[52:55], v[186:189], v[146:149]
v_mfma_f32_16x16x32_bf16 v[150:153], a[220:223], v[186:189], v[150:153]
v_mfma_f32_16x16x32_bf16 v[154:157], a[244:247], v[186:189], v[154:157]
v_mfma_f32_16x16x32_bf16 v[158:161], v[236:239], v[186:189], v[158:161]
s_waitcnt lgkmcnt(0)
s_barrier
v_mfma_f32_16x16x32_bf16 v[162:165], v[186:189], a[76:79], v[162:165]
ds_read_b128 v[106:109], v210 offset:56320
ds_read_b128 v[102:105], v210 offset:55296
v_mfma_f32_16x16x32_bf16 v[166:169], v[186:189], a[100:103], v[166:169]
buffer_load_dwordx4 v180, s[4:7], s40 offen nt lds
v_mfma_f32_16x16x32_bf16 v[170:173], v[186:189], a[124:127], v[170:173]
s_add_u32 m0, s45, 4112
s_sub_u32 s46, s46, 1
s_cmp_lg_u32 s46, 0
s_cbranch_scc1 F_loop

ds_read_b128 v[186:189], v210 offset:27648
s_add_u32 s40, s37, 196224
v_mfma_f32_16x16x32_bf16 v[138:141], a[8:11], v[182:185], v[138:141]
buffer_load_dwordx4 v180, s[4:7], s40 offen nt lds
v_mfma_f32_16x16x32_bf16 v[142:145], a[32:35], v[182:185], v[142:145]
s_add_u32 m0, s45, 8224
s_add_u32 s40, s37, 392448
buffer_load_dwordx4 v180, s[4:7], s40 offen nt lds
v_mfma_f32_16x16x32_bf16 v[146:149], a[56:59], v[182:185], v[146:149]
s_add_u32 m0, s45, 12336
s_add_u32 s40, s37, 588672
buffer_load_dwordx4 v180, s[4:7], s40 offen nt lds
v_mfma_f32_16x16x32_bf16 v[150:153], a[224:227], v[182:185], v[150:153]
s_waitcnt lgkmcnt(2)
v_add_f32 v106, v106, v107
v_add_f32 v108, v108, v109
v_mfma_f32_16x16x32_bf16 v[154:157], a[248:251], v[182:185], v[154:157]
s_waitcnt lgkmcnt(1)
v_add_f32 v106, v106, v108
v_add_f32 v102, v102, v103
v_mfma_f32_16x16x32_bf16 v[158:161], v[240:243], v[182:185], v[158:161]
s_add_u32 m0, s45, 16448
ds_read_b128 v[108:111], v215 offset:512
v_add_f32 v104, v104, v105
v_mfma_f32_16x16x32_bf16 v[162:165], v[182:185], a[80:83], v[162:165]
s_add_u32 s40, s37, 784896
v_add_f32 v102, v102, v104
v_mul_f32 v106, s73, v106
v_mfma_f32_16x16x32_bf16 v[166:169], v[182:185], a[104:107], v[166:169]
v_mul_f32 v103, s48, v102
v_mul_f32 v104, s73, v102
v_mfma_f32_16x16x32_bf16 v[170:173], v[182:185], a[128:131], v[170:173]
s_waitcnt lgkmcnt(1)
ds_read_b128 v[182:185], v210 offset:28672
v_fma_f32 v106, -v103, v104, v106
v_mfma_f32_16x16x32_bf16 v[138:141], a[12:15], v[186:189], v[138:141]
v_max_f32 v106, 0, v106
v_add_f32 v106, s49, v106
v_mfma_f32_16x16x32_bf16 v[142:145], a[36:39], v[186:189], v[142:145]
v_rsq_f32 v102, v106
v_mfma_f32_16x16x32_bf16 v[146:149], a[60:63], v[186:189], v[146:149]
v_mul_f32_e64 v103, -v103, v102
v_mfma_f32_16x16x32_bf16 v[150:153], a[228:231], v[186:189], v[150:153]
ds_write_b64 v211, v[102:103] offset:36864
v_mfma_f32_16x16x32_bf16 v[154:157], a[252:255], v[186:189], v[154:157]
s_waitcnt lgkmcnt(1)
buffer_load_dwordx4 v180, s[4:7], s40 offen nt lds
v_mfma_f32_16x16x32_bf16 v[158:161], v[244:247], v[186:189], v[158:161]
s_add_u32 m0, s45, 20560
ds_read_b64 v[118:119], v219
ds_read_b64 v[126:127], v219 offset:256
v_mfma_f32_16x16x32_bf16 v[162:165], v[186:189], a[84:87], v[162:165]
s_add_u32 s40, s37, 981120
ds_read_b64 v[134:135], v219 offset:512
buffer_load_dwordx4 v180, s[4:7], s40 offen nt lds
v_mfma_f32_16x16x32_bf16 v[166:169], v[186:189], a[108:111], v[166:169]
s_add_u32 m0, s45, 24672
s_add_u32 s40, s37, 1177344
buffer_load_dwordx4 v180, s[4:7], s40 offen nt lds
v_mfma_f32_16x16x32_bf16 v[170:173], v[186:189], a[132:135], v[170:173]
s_add_u32 m0, s45, 28784
ds_read_b128 v[186:189], v210 offset:29696
s_add_u32 s40, s37, 1373568
v_mfma_f32_16x16x32_bf16 v[138:141], a[16:19], v[182:185], v[138:141]
buffer_load_dwordx4 v180, s[4:7], s40 offen nt lds
v_mfma_f32_16x16x32_bf16 v[142:145], a[40:43], v[182:185], v[142:145]
s_waitcnt lgkmcnt(3)
v_fma_f32 v220, v0, v118, v119
v_fma_f32 v221, v1, v118, v119
v_mfma_f32_16x16x32_bf16 v[146:149], a[64:67], v[182:185], v[146:149]
s_add_u32 m0, s45, 32896
v_fma_f32 v222, v2, v118, v119
v_fma_f32 v223, v3, v118, v119
v_mfma_f32_16x16x32_bf16 v[150:153], a[232:235], v[182:185], v[150:153]
s_add_u32 s40, s37, 1569792
v_cvt_pk_bf16_f32 v90, v220, v221
v_cvt_pk_bf16_f32 v91, v222, v223
v_mfma_f32_16x16x32_bf16 v[154:157], v[224:227], v[182:185], v[154:157]
v_fma_f32 v220, v4, v118, v119
v_fma_f32 v221, v5, v118, v119
v_mfma_f32_16x16x32_bf16 v[158:161], v[248:251], v[182:185], v[158:161]
v_fma_f32 v222, v6, v118, v119
v_fma_f32 v223, v7, v118, v119
v_mfma_f32_16x16x32_bf16 v[162:165], v[182:185], a[88:91], v[162:165]
v_cvt_pk_bf16_f32 v92, v220, v221
v_cvt_pk_bf16_f32 v93, v222, v223
v_mfma_f32_16x16x32_bf16 v[166:169], v[182:185], a[112:115], v[166:169]
ds_write_b128 v211, v[90:93]
v_mfma_f32_16x16x32_bf16 v[170:173], v[182:185], a[136:139], v[170:173]
s_waitcnt lgkmcnt(1)
v_fma_f32 v220, v8, v118, v119
v_fma_f32 v221, v9, v118, v119
v_mfma_f32_16x16x32_bf16 v[138:141], a[20:23], v[186:189], v[138:141]
buffer_store_dwordx2 v[132:133], v205, s[8:11], s38 offen offset:64
ds_read_b128 v[182:185], v210 offset:30720
v_mfma_f32_16x16x32_bf16 v[142:145], a[44:47], v[186:189], v[142:145]
v_fma_f32 v222, v10, v118, v119
v_fma_f32 v223, v11, v118, v119
v_mfma_f32_16x16x32_bf16 v[146:149], a[68:71], v[186:189], v[146:149]
v_cvt_pk_bf16_f32 v96, v138, v139
v_cvt_pk_bf16_f32 v97, v140, v141
v_mfma_f32_16x16x32_bf16 v[150:153], a[236:239], v[186:189], v[150:153]
v_cvt_pk_bf16_f32 v98, v142, v143
v_cvt_pk_bf16_f32 v99, v144, v145
v_mfma_f32_16x16x32_bf16 v[154:157], v[228:231], v[186:189], v[154:157]
v_cvt_pk_bf16_f32 v100, v146, v147
v_cvt_pk_bf16_f32 v101, v148, v149
v_mfma_f32_16x16x32_bf16 v[158:161], v[252:255], v[186:189], v[158:161]
v_cvt_pk_bf16_f32 v84, v150, v151
v_cvt_pk_bf16_f32 v85, v152, v153
v_mfma_f32_16x16x32_bf16 v[162:165], v[186:189], a[92:95], v[162:165]
v_cvt_pk_bf16_f32 v86, v154, v155
v_cvt_pk_bf16_f32 v87, v156, v157
v_mfma_f32_16x16x32_bf16 v[166:169], v[186:189], a[116:119], v[166:169]
v_cvt_pk_bf16_f32 v88, v158, v159
v_cvt_pk_bf16_f32 v89, v160, v161
v_mfma_f32_16x16x32_bf16 v[170:173], v[186:189], a[140:143], v[170:173]
s_waitcnt lgkmcnt(0)
ds_read_b128 v[186:189], v210 offset:31744
v_cvt_pk_bf16_f32 v116, v162, v163
v_mfma_f32_16x16x32_bf16 v[138:141], a[0:3], v[182:185], 0
v_cvt_pk_bf16_f32 v124, v166, v167
v_cvt_pk_bf16_f32 v125, v168, v169
v_mfma_f32_16x16x32_bf16 v[142:145], a[24:27], v[182:185], 0
v_cvt_pk_bf16_f32 v117, v164, v165
v_cvt_pk_bf16_f32 v94, v220, v221
v_mfma_f32_16x16x32_bf16 v[150:153], v[108:111], v[72:75], v[206:209]
v_cvt_pk_bf16_f32 v95, v222, v223
v_fma_f32 v220, v12, v126, v127
v_mfma_f32_16x16x32_bf16 v[146:149], a[48:51], v[182:185], 0
ds_read_b128 v[182:185], v210 offset:32768
ds_write_b64 v212, v[94:95]
v_mfma_f32_16x16x16_bf16 v[150:153], v[112:113], v[76:77], v[150:153]
s_waitcnt lgkmcnt(2)
v_fma_f32 v221, v13, v126, v127
v_fma_f32 v222, v14, v126, v127
v_mfma_f32_16x16x32_bf16 v[138:141], a[4:7], v[186:189], v[138:141]
v_fma_f32 v223, v15, v126, v127
v_cvt_pk_bf16_f32 v174, v220, v221
v_mfma_f32_16x16x32_bf16 v[142:145], a[28:31], v[186:189], v[142:145]
v_cvt_pk_bf16_f32 v175, v222, v223
v_fma_f32 v220, v16, v126, v127
v_mfma_f32_16x16x32_bf16 v[146:149], a[52:55], v[186:189], v[146:149]
ds_read_b128 v[186:189], v210 offset:33792
v_fma_f32 v221, v17, v126, v127
v_mfma_f32_16x16x32_bf16 v[154:157], v[78:81], v[84:87], 0
s_waitcnt lgkmcnt(2)
v_fma_f32 v222, v18, v126, v127
v_fma_f32 v223, v19, v126, v127
v_mfma_f32_16x16x32_bf16 v[138:141], a[8:11], v[182:185], v[138:141]
v_cvt_pk_bf16_f32 v176, v220, v221
v_cvt_pk_bf16_f32 v177, v222, v223
v_mfma_f32_16x16x32_bf16 v[142:145], a[32:35], v[182:185], v[142:145]
v_fma_f32 v220, v20, v126, v127
v_fma_f32 v221, v21, v126, v127
v_mfma_f32_16x16x32_bf16 v[158:161], v[96:99], v[84:87], 0
v_fma_f32 v222, v22, v126, v127
v_fma_f32 v223, v23, v126, v127
v_mfma_f32_16x16x32_bf16 v[146:149], a[56:59], v[182:185], v[146:149]
ds_read_b128 v[182:185], v210 offset:34816
v_cvt_pk_bf16_f32 v178, v220, v221
v_mfma_f32_16x16x32_bf16 v[166:169], v[108:111], v[84:87], v[206:209]
s_waitcnt lgkmcnt(1)
v_cvt_pk_bf16_f32 v179, v222, v223
v_fma_f32 v220, v24, v134, v135
v_mfma_f32_16x16x32_bf16 v[138:141], a[12:15], v[186:189], v[138:141]
v_fma_f32 v221, v25, v134, v135
v_fma_f32 v222, v26, v134, v135
v_mfma_f32_16x16x32_bf16 v[142:145], a[36:39], v[186:189], v[142:145]
v_fma_f32 v223, v27, v134, v135
v_cvt_pk_bf16_f32 v90, v220, v221
v_mfma_f32_16x16x32_bf16 v[146:149], a[60:63], v[186:189], v[146:149]
ds_read_b128 v[186:189], v210 offset:35840
v_cvt_pk_bf16_f32 v91, v222, v223
v_mfma_f32_16x16x16_bf16 v[154:157], v[82:83], v[88:89], v[154:157]
v_fma_f32 v220, v28, v134, v135
v_fma_f32 v221, v29, v134, v135
v_mfma_f32_16x16x16_bf16 v[158:161], v[100:101], v[88:89], v[158:161]
s_waitcnt lgkmcnt(1)
v_fma_f32 v222, v30, v134, v135
v_fma_f32 v223, v31, v134, v135
v_mfma_f32_16x16x32_bf16 v[138:141], a[16:19], v[182:185], v[138:141]
v_cvt_pk_bf16_f32 v92, v220, v221
v_cvt_pk_bf16_f32 v93, v222, v223
v_mfma_f32_16x16x32_bf16 v[142:145], a[40:43], v[182:185], v[142:145]
ds_write_b128 v211, v[90:93] offset:12288
v_mfma_f32_16x16x16_bf16 v[166:169], v[112:113], v[88:89], v[166:169]
v_fma_f32 v220, v32, v134, v135
v_fma_f32 v221, v33, v134, v135
v_mfma_f32_16x16x32_bf16 v[146:149], a[64:67], v[182:185], v[146:149]
s_waitcnt lgkmcnt(1)
v_fma_f32 v222, v34, v134, v135
v_fma_f32 v223, v35, v134, v135
v_mfma_f32_16x16x32_bf16 v[138:141], a[20:23], v[186:189], v[138:141]
ds_read_b128 v[182:185], v210 offset:30720
v_cvt_pk_bf16_f32 v132, v170, v171
v_mfma_f32_16x16x32_bf16 v[142:145], a[44:47], v[186:189], v[142:145]
v_cvt_pk_bf16_f32 v133, v172, v173
v_cvt_pk_bf16_f32 v94, v220, v221
v_mfma_f32_16x16x32_bf16 v[146:149], a[68:71], v[186:189], v[146:149]
v_cvt_pk_bf16_f32 v102, v138, v139
v_cvt_pk_bf16_f32 v103, v140, v141
v_mfma_f32_16x16x32_bf16 v[138:141], v[78:81], v[72:75], 0
v_cvt_pk_bf16_f32 v104, v142, v143
v_cvt_pk_bf16_f32 v105, v144, v145
v_mfma_f32_16x16x32_bf16 v[142:145], v[96:99], v[72:75], 0
v_cvt_pk_bf16_f32 v106, v146, v147
v_cvt_pk_bf16_f32 v107, v148, v149
v_mfma_f32_16x16x32_bf16 v[146:149], v[102:105], v[72:75], 0
ds_read_b128 v[186:189], v210 offset:31744
v_cvt_pk_bf16_f32 v95, v222, v223
v_mfma_f32_16x16x16_bf16 v[138:141], v[82:83], v[76:77], v[138:141]
buffer_load_dwordx4 v180, s[4:7], s40 offen nt lds
v_mfma_f32_16x16x16_bf16 v[142:145], v[100:101], v[76:77], v[142:145]
ds_write_b128 v211, v[174:177] offset:6144
v_mfma_f32_16x16x16_bf16 v[146:149], v[106:107], v[76:77], v[146:149]
v_exp_f32 v138, v138
v_mfma_f32_16x16x32_bf16 v[162:165], v[102:105], v[84:87], 0
s_waitcnt lgkmcnt(2)
v_exp_f32 v139, v139
v_mfma_f32_16x16x32_bf16 v[118:121], v[182:185], a[72:75], 0
v_exp_f32 v140, v140
v_mfma_f32_16x16x16_bf16 v[162:165], v[106:107], v[88:89], v[162:165]
v_exp_f32 v141, v141
v_mfma_f32_16x16x32_bf16 v[126:129], v[182:185], a[96:99], 0
v_exp_f32 v142, v142
v_mfma_f32_16x16x32_bf16 v[134:137], v[182:185], a[120:123], 0
v_exp_f32 v143, v143
v_mfma_f32_16x16x32_bf16 v[90:93], a[216:219], v[182:185], 0
v_exp_f32 v144, v144
v_mfma_f32_16x16x32_bf16 v[170:173], a[240:243], v[182:185], 0
v_exp_f32 v145, v145
v_mfma_f32_16x16x32_bf16 v[220:223], v[232:235], v[182:185], 0
s_waitcnt lgkmcnt(1)
ds_read_b128 v[182:185], v210 offset:32768
v_cvt_pk_bf16_f32 v174, v138, v139
v_mfma_f32_16x16x32_bf16 v[118:121], v[186:189], a[76:79], v[118:121]
v_exp_f32 v150, v150
v_mfma_f32_16x16x32_bf16 v[126:129], v[186:189], a[100:103], v[126:129]
v_cvt_pk_bf16_f32 v175, v140, v141
v_cvt_pk_bf16_f32 v176, v142, v143
v_mfma_f32_16x16x32_bf16 v[134:137], v[186:189], a[124:127], v[134:137]
v_cvt_pk_bf16_f32 v177, v144, v145
v_cvt_pk_bf16_f32 v180, v150, 0
v_mfma_f32_16x16x32_bf16 v[90:93], a[220:223], v[186:189], v[90:93]
ds_write_b64 v212, v[178:179] offset:6144
v_mfma_f32_16x16x32_bf16 v[170:173], a[244:247], v[186:189], v[170:173]
v_exp_f32 v146, v146
v_mfma_f32_16x16x32_bf16 v[220:223], v[236:239], v[186:189], v[220:223]
s_waitcnt lgkmcnt(1)
ds_read_b128 v[186:189], v210 offset:33792
ds_read_b128 v[72:75], v215
v_mfma_f32_16x16x32_bf16 v[118:121], v[182:185], a[80:83], v[118:121]
v_exp_f32 v147, v147
v_mfma_f32_16x16x32_bf16 v[126:129], v[182:185], a[104:107], v[126:129]
v_exp_f32 v148, v148
v_mfma_f32_16x16x32_bf16 v[134:137], v[182:185], a[128:131], v[134:137]
v_exp_f32 v149, v149
v_mfma_f32_16x16x32_bf16 v[90:93], a[224:227], v[182:185], v[90:93]
v_cvt_pk_bf16_f32 v178, v146, v147
v_cvt_pk_bf16_f32 v179, v148, v149
v_mfma_f32_16x16x32_bf16 v[170:173], a[248:251], v[182:185], v[170:173]
ds_write_b64 v212, v[94:95] offset:12288
v_mfma_f32_16x16x32_bf16 v[220:223], v[240:243], v[182:185], v[220:223]
s_waitcnt lgkmcnt(2)
v_exp_f32 v154, v154
v_mfma_f32_16x16x32_bf16 v[118:121], v[186:189], a[84:87], v[118:121]
ds_read_b128 v[182:185], v210 offset:34816
ds_read_b64 v[76:77], v215 offset:16
v_mfma_f32_16x16x32_bf16 v[126:129], v[186:189], a[108:111], v[126:129]
v_exp_f32 v155, v155
v_mfma_f32_16x16x32_bf16 v[134:137], v[186:189], a[132:135], v[134:137]
v_exp_f32 v156, v156
v_mfma_f32_16x16x32_bf16 v[90:93], a[228:231], v[186:189], v[90:93]
v_exp_f32 v157, v157
v_mfma_f32_16x16x32_bf16 v[170:173], a[252:255], v[186:189], v[170:173]
v_exp_f32 v158, v158
v_mfma_f32_16x16x32_bf16 v[220:223], v[244:247], v[186:189], v[220:223]
ds_read_b128 v[186:189], v210 offset:35840
v_exp_f32 v159, v159
v_mfma_f32_16x16x32_bf16 v[150:153], v[190:193], v[174:177], 0
s_waitcnt lgkmcnt(2)
v_exp_f32 v160, v160
v_mfma_f32_16x16x32_bf16 v[118:121], v[182:185], a[88:91], v[118:121]
v_exp_f32 v161, v161
v_mfma_f32_16x16x32_bf16 v[126:129], v[182:185], a[112:115], v[126:129]
v_exp_f32 v166, v166
v_mfma_f32_16x16x32_bf16 v[134:137], v[182:185], a[136:139], v[134:137]
v_exp_f32 v162, v162
v_mfma_f32_16x16x32_bf16 v[90:93], a[232:235], v[182:185], v[90:93]
v_exp_f32 v163, v163
v_mfma_f32_16x16x32_bf16 v[170:173], v[224:227], v[182:185], v[170:173]
v_exp_f32 v164, v164
v_mfma_f32_16x16x32_bf16 v[220:223], v[248:251], v[182:185], v[220:223]
s_waitcnt lgkmcnt(0)
v_exp_f32 v165, v165
v_mfma_f32_16x16x32_bf16 v[118:121], v[186:189], a[92:95], v[118:121]
v_mfma_f32_16x16x32_bf16 v[126:129], v[186:189], a[116:119], v[126:129]
v_mfma_f32_16x16x32_bf16 v[134:137], v[186:189], a[140:143], v[134:137]
v_cvt_pk_bf16_f32 v118, v118, v119
v_cvt_pk_bf16_f32 v119, v120, v121
v_mfma_f32_16x16x32_bf16 v[90:93], a[236:239], v[186:189], v[90:93]
ds_read_u16 v120, v216
v_cvt_pk_bf16_f32 v126, v126, v127
v_mfma_f32_16x16x32_bf16 v[170:173], v[228:231], v[186:189], v[170:173]
v_cvt_pk_bf16_f32 v127, v128, v129
v_cvt_pk_bf16_f32 v134, v134, v135
v_mfma_f32_16x16x32_bf16 v[220:223], v[252:255], v[186:189], v[220:223]
ds_read_u16 v128, v216 offset:32
v_cvt_pk_bf16_f32 v90, v90, v91
v_mfma_f32_16x16x32_bf16 v[138:141], v[114:117], v[174:177], 0
v_cvt_pk_bf16_f32 v91, v92, v93
v_cvt_pk_bf16_f32 v92, v170, v171
v_mfma_f32_16x16x32_bf16 v[142:145], v[122:125], v[174:177], 0
v_cvt_pk_bf16_f32 v93, v172, v173
v_cvt_pk_bf16_f32 v135, v136, v137
v_mfma_f32_16x16x32_bf16 v[146:149], v[130:133], v[174:177], 0
ds_read_u16 v136, v216 offset:64
v_mov_b32 v121, 0
v_mfma_f32_16x16x32_bf16 v[150:153], v[190:193], v[178:181], v[150:153]
s_waitcnt lgkmcnt(2)
v_mov_b32 v129, 0
v_cvt_pk_bf16_f32 v94, v220, v221
v_mfma_f32_16x16x32_bf16 v[138:141], v[118:121], v[178:181], v[138:141]
s_waitcnt lgkmcnt(1)
v_cvt_pk_bf16_f32 v95, v222, v223
v_mov_b32 v137, 0
v_mfma_f32_16x16x32_bf16 v[142:145], v[126:129], v[178:181], v[142:145]
v_rcp_f32 v151, v150
s_nop 0
v_max3_u32 v218, v218, v150, v151
v_mul_f32 v151, s3, v151
v_mul_f32 v138, v138, v151
v_mul_f32 v139, v139, v151
v_mul_f32 v140, v140, v151
v_mul_f32 v141, v141, v151
v_cvt_pk_bf16_f32 v138, v138, v139
v_mul_f32 v142, v142, v151
s_waitcnt lgkmcnt(0)
v_mfma_f32_16x16x32_bf16 v[146:149], v[134:137], v[178:181], v[146:149]
v_mul_f32 v143, v143, v151
v_mul_f32 v144, v144, v151
v_mul_f32 v145, v145, v151
v_cvt_pk_bf16_f32 v139, v140, v141
v_cvt_pk_bf16_f32 v140, v142, v143
v_cvt_pk_bf16_f32 v141, v144, v145
v_cvt_pk_bf16_f32 v174, v154, v155
v_mul_f32 v146, v146, v151
v_mul_f32 v147, v147, v151
v_mul_f32 v148, v148, v151
v_mul_f32 v149, v149, v151
v_mfma_f32_16x16x32_bf16 v[150:153], v[108:111], v[90:93], v[206:209]
ds_write_b128 v211, v[138:141] offset:36864
v_mfma_f32_16x16x32_bf16 v[138:141], v[78:81], v[90:93], 0
v_cvt_pk_bf16_f32 v142, v146, v147
v_cvt_pk_bf16_f32 v143, v148, v149
v_mfma_f32_16x16x32_bf16 v[146:149], v[102:105], v[90:93], 0
v_cvt_pk_bf16_f32 v175, v156, v157
v_cvt_pk_bf16_f32 v176, v158, v159
v_mfma_f32_16x16x16_bf16 v[138:141], v[82:83], v[94:95], v[138:141]
ds_write_b64 v212, v[142:143] offset:36864
v_mfma_f32_16x16x32_bf16 v[142:145], v[96:99], v[90:93], 0
v_cvt_pk_bf16_f32 v177, v160, v161
v_cvt_pk_bf16_f32 v180, v166, 0
v_mfma_f32_16x16x16_bf16 v[150:153], v[112:113], v[94:95], v[150:153]
v_cvt_pk_bf16_f32 v178, v162, v163
v_cvt_pk_bf16_f32 v179, v164, v165
v_mfma_f32_16x16x32_bf16 v[166:169], v[190:193], v[174:177], 0
v_exp_f32 v138, v138
v_mfma_f32_16x16x32_bf16 v[154:157], v[114:117], v[174:177], 0
v_exp_f32 v139, v139
v_mfma_f32_16x16x32_bf16 v[158:161], v[122:125], v[174:177], 0
v_exp_f32 v140, v140
v_mfma_f32_16x16x32_bf16 v[162:165], v[130:133], v[174:177], 0
v_exp_f32 v141, v141
v_mfma_f32_16x16x16_bf16 v[142:145], v[100:101], v[94:95], v[142:145]
v_exp_f32 v150, v150
v_mfma_f32_16x16x32_bf16 v[166:169], v[190:193], v[178:181], v[166:169]
v_cvt_pk_bf16_f32 v174, v138, v139
v_cvt_pk_bf16_f32 v175, v140, v141
v_mfma_f32_16x16x32_bf16 v[154:157], v[118:121], v[178:181], v[154:157]
v_exp_f32 v142, v142
v_mfma_f32_16x16x32_bf16 v[158:161], v[126:129], v[178:181], v[158:161]
v_rcp_f32 v167, v166
v_mfma_f32_16x16x32_bf16 v[162:165], v[134:137], v[178:181], v[162:165]
v_max3_u32 v218, v218, v166, v167
v_mul_f32 v167, s3, v167
v_mfma_f32_16x16x16_bf16 v[146:149], v[106:107], v[94:95], v[146:149]
v_mul_f32 v154, v154, v167
v_mul_f32 v155, v155, v167
v_mul_f32 v156, v156, v167
v_mul_f32 v157, v157, v167
v_cvt_pk_bf16_f32 v154, v154, v155
v_mul_f32 v158, v158, v167
v_mul_f32 v159, v159, v167
v_mul_f32 v160, v160, v167
v_mul_f32 v161, v161, v167
v_cvt_pk_bf16_f32 v155, v156, v157
v_cvt_pk_bf16_f32 v156, v158, v159
v_cvt_pk_bf16_f32 v157, v160, v161
v_mul_f32 v162, v162, v167
v_mul_f32 v163, v163, v167
v_mul_f32 v164, v164, v167
v_mul_f32 v165, v165, v167
v_mfma_f32_16x16x32_bf16 v[166:169], v[72:75], v[108:111], v[206:209]
ds_write_b128 v211, v[154:157] offset:43008
v_mfma_f32_16x16x32_bf16 v[154:157], v[72:75], v[78:81], 0
v_cvt_pk_bf16_f32 v158, v162, v163
v_cvt_pk_bf16_f32 v159, v164, v165
v_mfma_f32_16x16x32_bf16 v[162:165], v[72:75], v[102:105], 0
v_exp_f32 v143, v143
v_mfma_f32_16x16x16_bf16 v[154:157], v[76:77], v[82:83], v[154:157]
ds_write_b64 v212, v[158:159] offset:43008
v_mfma_f32_16x16x32_bf16 v[158:161], v[72:75], v[96:99], 0
v_exp_f32 v144, v144
v_mfma_f32_16x16x16_bf16 v[162:165], v[76:77], v[106:107], v[162:165]
v_exp_f32 v145, v145
v_mfma_f32_16x16x16_bf16 v[158:161], v[76:77], v[100:101], v[158:161]
v_cvt_pk_bf16_f32 v176, v142, v143
v_cvt_pk_bf16_f32 v177, v144, v145
v_mfma_f32_16x16x16_bf16 v[166:169], v[76:77], v[112:113], v[166:169]
v_cvt_pk_bf16_f32 v180, v150, 0
v_exp_f32 v146, v146
v_mfma_f32_16x16x32_bf16 v[150:153], v[190:193], v[174:177], 0
v_exp_f32 v147, v147
v_mfma_f32_16x16x32_bf16 v[138:141], v[114:117], v[174:177], 0
s_waitcnt lgkmcnt(0)
v_exp_f32 v148, v148
v_mfma_f32_16x16x32_bf16 v[142:145], v[122:125], v[174:177], 0
s_barrier
ds_read_b128 v[170:173], v210 offset:36864
v_exp_f32 v149, v149
v_mov_b32_dpp v154, v158 quad_perm:[0,1,2,3] row_mask:0x2 bank_mask:0xf
v_cvt_pk_bf16_f32 v178, v146, v147
v_cvt_pk_bf16_f32 v179, v148, v149
v_mfma_f32_16x16x32_bf16 v[146:149], v[130:133], v[174:177], 0
v_mov_b32_dpp v154, v162 quad_perm:[0,1,2,3] row_mask:0x4 bank_mask:0xf
v_mfma_f32_16x16x32_bf16 v[150:153], v[190:193], v[178:181], v[150:153]
ds_read_b128 v[182:185], v210 offset:37888
v_mov_b32_dpp v154, v167 quad_perm:[0,1,2,3] row_mask:0x8 bank_mask:0xf
v_mfma_f32_16x16x32_bf16 v[138:141], v[118:121], v[178:181], v[138:141]
v_exp_f32 v154, v154
v_mfma_f32_16x16x32_bf16 v[142:145], v[126:129], v[178:181], v[142:145]
v_cvt_pk_bf16_f32 v154, v154, 0
v_rcp_f32 v151, v150
v_mfma_f32_16x16x32_bf16 v[146:149], v[134:137], v[178:181], v[146:149]
s_waitcnt lgkmcnt(1)
ds_write_b16 v214, v154
v_mfma_f32_16x16x32_bf16 v[36:39], a[144:147], v[170:173], v[36:39]
ds_read_b128 v[84:87], v215
ds_read_b128 v[88:91], v215 offset:16
v_mfma_f32_16x16x32_bf16 v[40:43], a[168:171], v[170:173], v[40:43]
ds_read_b128 v[186:189], v210 offset:38912
ds_read_b128 v[174:177], v217
v_mfma_f32_16x16x32_bf16 v[44:47], a[192:195], v[170:173], v[44:47]
s_waitcnt lgkmcnt(5)
ds_read_b128 v[170:173], v210 offset:39936
ds_read_b128 v[178:181], v217 offset:528
v_mfma_f32_16x16x32_bf16 v[36:39], a[148:151], v[182:185], v[36:39]
v_mfma_f32_16x16x32_bf16 v[40:43], a[172:175], v[182:185], v[40:43]
v_mfma_f32_16x16x32_bf16 v[44:47], a[196:199], v[182:185], v[44:47]
ds_read_b128 v[182:185], v210 offset:40960
s_waitcnt lgkmcnt(6)
v_mfma_f32_16x16x32_bf16 v[166:169], v[84:87], v[190:193], 0
v_mfma_f32_16x16x32_bf16 v[154:157], v[84:87], v[114:117], 0
v_mfma_f32_16x16x32_bf16 v[158:161], v[84:87], v[122:125], 0
v_mfma_f32_16x16x32_bf16 v[162:165], v[84:87], v[130:133], 0
s_waitcnt lgkmcnt(5)
v_mfma_f32_16x16x32_bf16 v[166:169], v[88:91], v[190:193], v[166:169]
s_waitcnt lgkmcnt(4)
v_mfma_f32_16x16x32_bf16 v[36:39], a[152:155], v[186:189], v[36:39]
v_mfma_f32_16x16x32_bf16 v[154:157], v[88:91], v[118:121], v[154:157]
v_rcp_f32 v167, v166
v_mfma_f32_16x16x32_bf16 v[40:43], a[176:179], v[186:189], v[40:43]
v_max3_u32 v218, v218, v166, v167
v_max3_u32 v218, v218, v150, v151
v_mfma_f32_16x16x32_bf16 v[158:161], v[88:91], v[126:129], v[158:161]
v_mul_f32 v151, s3, v151
v_mul_f32 v138, v138, v151
v_mfma_f32_16x16x32_bf16 v[44:47], a[200:203], v[186:189], v[44:47]
ds_read_b128 v[186:189], v210 offset:41984
v_mul_f32 v139, v139, v151
v_mfma_f32_16x16x32_bf16 v[162:165], v[88:91], v[134:137], v[162:165]
s_waitcnt lgkmcnt(3)
v_mul_f32 v140, v140, v151
v_mul_f32 v141, v141, v151
v_mfma_f32_16x16x32_bf16 v[36:39], a[156:159], v[170:173], v[36:39]
v_cvt_pk_bf16_f32 v138, v138, v139
v_mul_f32 v142, v142, v151
v_mfma_f32_16x16x32_bf16 v[40:43], a[180:183], v[170:173], v[40:43]
v_mul_f32 v143, v143, v151
v_mul_f32 v144, v144, v151
v_mfma_f32_16x16x32_bf16 v[44:47], a[204:207], v[170:173], v[44:47]
s_waitcnt lgkmcnt(1)
ds_read_b128 v[170:173], v210 offset:43008
v_mul_f32 v145, v145, v151
v_mfma_f32_16x16x32_bf16 v[36:39], a[160:163], v[182:185], v[36:39]
v_cvt_pk_bf16_f32 v139, v140, v141
v_cvt_pk_bf16_f32 v140, v142, v143
v_mfma_f32_16x16x32_bf16 v[40:43], a[184:187], v[182:185], v[40:43]
v_cvt_pk_bf16_f32 v141, v144, v145
v_mul_f32 v146, v146, v151
v_mfma_f32_16x16x32_bf16 v[44:47], a[208:211], v[182:185], v[44:47]
s_waitcnt lgkmcnt(1)
ds_read_b128 v[182:185], v210 offset:44032
ds_write_b128 v211, v[138:141] offset:49152
v_mfma_f32_16x16x32_bf16 v[36:39], a[164:167], v[186:189], v[36:39]
v_mul_f32 v147, v147, v151
v_mul_f32 v148, v148, v151
v_mfma_f32_16x16x32_bf16 v[40:43], a[188:191], v[186:189], v[40:43]
v_mul_f32 v149, v149, v151
v_cvt_pk_bf16_f32 v142, v146, v147
v_mfma_f32_16x16x32_bf16 v[44:47], a[212:215], v[186:189], v[44:47]
s_waitcnt lgkmcnt(2)
ds_read_b128 v[186:189], v210 offset:45056
v_cvt_pk_bf16_f32 v143, v148, v149
v_mfma_f32_16x16x32_bf16 v[48:51], a[144:147], v[170:173], v[48:51]
ds_write_b64 v212, v[142:143] offset:49152
v_mfma_f32_16x16x32_bf16 v[52:55], a[168:171], v[170:173], v[52:55]
v_cvt_pk_bf16_f32 v72, v36, v37
v_cvt_pk_bf16_f32 v73, v38, v39
v_mfma_f32_16x16x32_bf16 v[56:59], a[192:195], v[170:173], v[56:59]
s_waitcnt lgkmcnt(3)
ds_read_b128 v[170:173], v210 offset:46080
buffer_store_dwordx2 v[72:73], v203, s[8:11], s39 offen
v_cvt_pk_bf16_f32 v74, v40, v41
v_mfma_f32_16x16x32_bf16 v[48:51], a[148:151], v[182:185], v[48:51]
v_cvt_pk_bf16_f32 v75, v42, v43
v_mov_b32_dpp v154, v158 quad_perm:[0,1,2,3] row_mask:0x2 bank_mask:0xf
v_mfma_f32_16x16x32_bf16 v[52:55], a[172:175], v[182:185], v[52:55]
v_mul_f32 v167, s3, v167
v_mov_b32_dpp v154, v162 quad_perm:[0,1,2,3] row_mask:0x4 bank_mask:0xf
v_mfma_f32_16x16x32_bf16 v[56:59], a[196:199], v[182:185], v[56:59]
s_waitcnt lgkmcnt(2)
ds_read_b128 v[182:185], v210 offset:47104
v_mul_f32 v154, v154, v167
v_mfma_f32_16x16x32_bf16 v[48:51], a[152:155], v[186:189], v[48:51]
v_cvt_pk_bf16_f32 v154, v154, 0
v_cvt_pk_bf16_f32 v76, v44, v45
v_mfma_f32_16x16x32_bf16 v[52:55], a[176:179], v[186:189], v[52:55]
s_waitcnt vmcnt(1) lgkmcnt(1)
ds_write_b16 v214, v154
v_mfma_f32_16x16x32_bf16 v[56:59], a[200:203], v[186:189], v[56:59]
s_barrier
v_mfma_f32_16x16x32_bf16 v[48:51], a[156:159], v[170:173], v[48:51]
ds_read_b128 v[186:189], v210 offset:48128
ds_read_b128 v[84:87], v200
v_mfma_f32_16x16x32_bf16 v[52:55], a[180:183], v[170:173], v[52:55]
ds_read_b128 v[92:95], v201
ds_read_b128 v[100:103], v202
v_mfma_f32_16x16x32_bf16 v[56:59], a[204:207], v[170:173], v[56:59]
s_waitcnt lgkmcnt(5)
ds_read_b128 v[170:173], v210 offset:49152
ds_read_b128 v[88:91], v194 offset:16
v_mfma_f32_16x16x32_bf16 v[48:51], a[160:163], v[182:185], v[48:51]
ds_read_b128 v[96:99], v195 offset:16
buffer_store_dwordx2 v[74:75], v203, s[8:11], s39 offen offset:32
v_cvt_pk_bf16_f32 v77, v46, v47
v_mfma_f32_16x16x32_bf16 v[52:55], a[184:187], v[182:185], v[52:55]
s_mul_hi_u32 s41, s35, 58835169
ds_read_b128 v[104:107], v196 offset:16
v_add_u32 v215, 1408, v215
v_mfma_f32_16x16x32_bf16 v[56:59], a[208:211], v[182:185], v[56:59]
s_waitcnt lgkmcnt(7)
ds_read_b128 v[182:185], v210 offset:50176
s_mul_i32 s42, s41, 73
v_mfma_f32_16x16x32_bf16 v[48:51], a[164:167], v[186:189], v[48:51]
s_waitcnt lgkmcnt(7)
ds_read_b64 v[112:113], v215 offset:528
s_sub_u32 s42, s35, s42
v_mfma_f32_16x16x32_bf16 v[52:55], a[188:191], v[186:189], v[52:55]
s_mul_i32 s43, s41, 1373568
s_mul_i32 s51, s42, 2688
s_add_u32 s43, s43, s51
v_mfma_f32_16x16x32_bf16 v[56:59], a[212:215], v[186:189], v[56:59]
s_mov_b32 s38, s36
ds_read_b128 v[186:189], v210 offset:51200
v_cvt_pk_bf16_f32 v78, v48, v49
v_mfma_f32_16x16x32_bf16 v[36:39], v[174:177], v[84:87], 0
s_waitcnt lgkmcnt(6)
ds_read_b128 v[84:87], v194
v_cvt_pk_bf16_f32 v79, v50, v51
v_mfma_f32_16x16x32_bf16 v[48:51], v[174:177], v[92:95], 0
s_cmp_lt_u32 s35, s34
ds_read_b128 v[92:95], v195
v_cvt_pk_bf16_f32 v80, v52, v53
v_mfma_f32_16x16x32_bf16 v[60:63], a[144:147], v[170:173], v[60:63]
s_cselect_b32 s36, s43, 1879048192
v_cvt_pk_bf16_f32 v81, v54, v55
v_cvt_pk_bf16_f32 v82, v56, v57
v_mfma_f32_16x16x32_bf16 v[64:67], a[168:171], v[170:173], v[64:67]
s_add_u32 s35, s35, 32
v_cvt_pk_bf16_f32 v83, v58, v59
s_cmp_eq_u32 s42, 0
v_mfma_f32_16x16x32_bf16 v[68:71], a[192:195], v[170:173], v[68:71]
s_waitcnt lgkmcnt(4)
ds_read_b128 v[170:173], v210 offset:52224
s_cselect_b32 s44, 536870911, s72
v_mfma_f32_16x16x32_bf16 v[60:63], a[148:151], v[182:185], v[60:63]
s_cmp_eq_u32 s42, 72
buffer_store_dwordx2 v[76:77], v203, s[8:11], s39 offen offset:64
s_cselect_b32 s44, 939524095, s44
v_mfma_f32_16x16x32_bf16 v[64:67], a[172:175], v[182:185], v[64:67]
s_cmp_eq_u32 s41, 0
s_cselect_b32 s40, 1879048192, s36
v_mfma_f32_16x16x32_bf16 v[68:71], a[196:199], v[182:185], v[68:71]
s_waitcnt lgkmcnt(3)
ds_read_b128 v[182:185], v210 offset:53248
s_add_u32 m0, s45, 0
v_mfma_f32_16x16x32_bf16 v[60:63], a[152:155], v[186:189], v[60:63]
v_mfma_f32_16x16x32_bf16 v[64:67], a[176:179], v[186:189], v[64:67]
v_mfma_f32_16x16x32_bf16 v[68:71], a[200:203], v[186:189], v[68:71]
ds_read_b128 v[186:189], v210 offset:54272
s_waitcnt lgkmcnt(2)
v_mfma_f32_16x16x32_bf16 v[60:63], a[156:159], v[170:173], v[60:63]
v_mfma_f32_16x16x32_bf16 v[64:67], a[180:183], v[170:173], v[64:67]
v_mfma_f32_16x16x32_bf16 v[68:71], a[204:207], v[170:173], v[68:71]
s_waitcnt lgkmcnt(1)
v_mfma_f32_16x16x32_bf16 v[60:63], a[160:163], v[182:185], v[60:63]
v_mfma_f32_16x16x32_bf16 v[64:67], a[184:187], v[182:185], v[64:67]
v_mfma_f32_16x16x32_bf16 v[68:71], a[208:211], v[182:185], v[68:71]
ds_read_b128 v[182:185], v210
s_waitcnt lgkmcnt(1)
v_mfma_f32_16x16x32_bf16 v[60:63], a[164:167], v[186:189], v[60:63]
v_smfmac_f32_16x16x64_bf16 v[36:39], v[178:181], v[84:91], v213
ds_read_b128 v[84:87], v197
ds_read_b128 v[88:91], v197 offset:16
v_mfma_f32_16x16x32_bf16 v[64:67], a[188:191], v[186:189], v[64:67]
v_cvt_pk_bf16_f32 v116, v60, v61
v_cvt_pk_bf16_f32 v117, v62, v63
v_mfma_f32_16x16x32_bf16 v[60:63], v[174:177], v[100:103], 0
ds_read_b128 v[100:103], v196
ds_read_b128 v[174:177], v217 offset:1056
v_mfma_f32_16x16x32_bf16 v[68:71], a[212:215], v[186:189], v[68:71]
v_cvt_pk_bf16_f32 v124, v64, v65
v_cvt_pk_bf16_f32 v125, v66, v67
v_smfmac_f32_16x16x64_bf16 v[48:51], v[178:181], v[92:99], v213
s_waitcnt lgkmcnt(4)
ds_read_b128 v[92:95], v198
ds_read_b128 v[96:99], v198 offset:16
v_mfma_f32_16x16x32_bf16 v[138:141], a[0:3], v[182:185], 0
ds_read_b128 v[186:189], v210 offset:1024
v_cvt_pk_bf16_f32 v132, v68, v69
v_mfma_f32_16x16x32_bf16 v[142:145], a[24:27], v[182:185], 0
v_cvt_pk_bf16_f32 v133, v70, v71
v_mfma_f32_16x16x32_bf16 v[146:149], a[48:51], v[182:185], 0
buffer_store_dwordx2 v[78:79], v204, s[8:11], s39 offen
s_waitcnt lgkmcnt(4)
v_smfmac_f32_16x16x64_bf16 v[60:63], v[178:181], v[100:107], v213
s_waitcnt lgkmcnt(3)
ds_read_b128 v[100:103], v199
ds_read_b128 v[104:107], v199 offset:16
v_smfmac_f32_16x16x64_bf16 v[36:39], v[174:177], v[84:91], v213
ds_read_b128 v[84:87], v200 offset:32
ds_read_b128 v[178:181], v217 offset:1584
v_mfma_f32_16x16x32_bf16 v[150:153], a[216:219], v[182:185], 0
ds_read_b128 v[88:91], v194 offset:48
s_waitcnt lgkmcnt(6)
v_smfmac_f32_16x16x64_bf16 v[48:51], v[174:177], v[92:99], v213
ds_read_b128 v[92:95], v201 offset:32
ds_read_b128 v[96:99], v195 offset:48
v_mfma_f32_16x16x32_bf16 v[154:157], a[240:243], v[182:185], 0
v_mul_f32 v119, v36, v36
v_add_f32 v118, v36, v37
v_mfma_f32_16x16x32_bf16 v[158:161], v[232:235], v[182:185], 0
v_mul_f32 v127, v48, v48
v_add_f32 v126, v48, v49
v_mfma_f32_16x16x32_bf16 v[162:165], v[182:185], a[72:75], 0
v_fmac_f32 v119, v37, v37
v_fmac_f32 v127, v49, v49
v_mfma_f32_16x16x32_bf16 v[166:169], v[182:185], a[96:99], 0
s_waitcnt lgkmcnt(5)
v_add_f32 v118, v118, v38
v_add_f32 v126, v126, v50
v_smfmac_f32_16x16x64_bf16 v[60:63], v[174:177], v[100:107], v213
ds_read_b128 v[100:103], v202 offset:32
ds_read_b128 v[174:177], v217 offset:2112
v_mfma_f32_16x16x32_bf16 v[170:173], v[182:185], a[120:123], 0
s_waitcnt lgkmcnt(5)
ds_read_b128 v[104:107], v196 offset:48
ds_read_b128 v[182:185], v210 offset:2048
v_mfma_f32_16x16x32_bf16 v[40:43], v[178:181], v[84:87], 0
ds_read_b128 v[84:87], v194 offset:32
v_mul_f32 v135, v60, v60
v_mfma_f32_16x16x32_bf16 v[138:141], a[4:7], v[186:189], v[138:141]
s_waitcnt lgkmcnt(6)
buffer_store_dwordx2 v[80:81], v204, s[8:11], s39 offen offset:32
v_add_f32 v134, v60, v61
v_mfma_f32_16x16x32_bf16 v[52:55], v[178:181], v[92:95], 0
ds_read_b128 v[92:95], v195 offset:32
v_fmac_f32 v135, v61, v61
v_mfma_f32_16x16x32_bf16 v[142:145], a[28:31], v[186:189], v[142:145]
s_waitcnt lgkmcnt(5)
v_add_f32 v134, v134, v62
v_fmac_f32 v135, v62, v62
v_mfma_f32_16x16x32_bf16 v[64:67], v[178:181], v[100:103], 0
ds_read_b128 v[100:103], v196 offset:32
ds_read_b128 v[178:181], v217 offset:2640
v_mfma_f32_16x16x32_bf16 v[146:149], a[52:55], v[186:189], v[146:149]
v_fmac_f32 v119, v38, v38
v_fmac_f32 v127, v50, v50
v_mfma_f32_16x16x32_bf16 v[150:153], a[220:223], v[186:189], v[150:153]
v_add_f32 v134, v134, v63
v_fmac_f32 v135, v63, v63
v_mfma_f32_16x16x32_bf16 v[154:157], a[244:247], v[186:189], v[154:157]
s_waitcnt lgkmcnt(3)
v_add_f32 v118, v118, v39
v_add_f32 v126, v126, v51
v_smfmac_f32_16x16x64_bf16 v[40:43], v[174:177], v[84:91], v213
s_waitcnt lgkmcnt(2)
ds_read_b128 v[84:87], v197 offset:32
ds_read_b128 v[88:91], v197 offset:48
v_smfmac_f32_16x16x64_bf16 v[52:55], v[174:177], v[92:99], v213
ds_read_b128 v[92:95], v198 offset:32
ds_read_b128 v[96:99], v198 offset:48
v_mfma_f32_16x16x32_bf16 v[158:161], v[236:239], v[186:189], v[158:161]
s_waitcnt lgkmcnt(5)
v_fmac_f32 v119, v39, v39
v_fmac_f32 v127, v51, v51
v_smfmac_f32_16x16x64_bf16 v[64:67], v[174:177], v[100:107], v213
ds_read_b128 v[100:103], v199 offset:32
ds_read_b128 v[104:107], v199 offset:48
v_mfma_f32_16x16x32_bf16 v[162:165], v[186:189], a[76:79], v[162:165]
ds_read_b128 v[174:177], v217 offset:3168
v_mfma_f32_16x16x32_bf16 v[166:169], v[186:189], a[100:103], v[166:169]
v_mfma_f32_16x16x32_bf16 v[170:173], v[186:189], a[124:127], v[170:173]
ds_read_b128 v[186:189], v210 offset:3072
s_waitcnt lgkmcnt(6)
v_smfmac_f32_16x16x64_bf16 v[40:43], v[178:181], v[84:91], v213
ds_read_b128 v[84:87], v200 offset:64
ds_read_b128 v[88:91], v194 offset:80
v_mfma_f32_16x16x32_bf16 v[138:141], a[8:11], v[182:185], v[138:141]
s_waitcnt lgkmcnt(6)
buffer_store_dwordx2 v[82:83], v204, s[8:11], s39 offen offset:64
s_nop 1
v_add_f32 v118, v118, v40
v_smfmac_f32_16x16x64_bf16 v[52:55], v[178:181], v[92:99], v213
ds_read_b128 v[92:95], v201 offset:64
ds_read_b128 v[96:99], v195 offset:80
v_mfma_f32_16x16x32_bf16 v[142:145], a[32:35], v[182:185], v[142:145]
s_waitcnt lgkmcnt(6)
v_fmac_f32 v119, v40, v40
v_add_f32 v118, v118, v41
v_smfmac_f32_16x16x64_bf16 v[64:67], v[178:181], v[100:107], v213
ds_read_b128 v[100:103], v202 offset:64
ds_read_b128 v[178:181], v217 offset:3696
v_mfma_f32_16x16x32_bf16 v[146:149], a[56:59], v[182:185], v[146:149]
ds_read_b128 v[104:107], v196 offset:80
v_add_f32 v126, v126, v52
v_mfma_f32_16x16x32_bf16 v[150:153], a[224:227], v[182:185], v[150:153]
s_waitcnt lgkmcnt(6)
v_add_f32 v134, v134, v64
v_fmac_f32 v135, v64, v64
v_mfma_f32_16x16x32_bf16 v[44:47], v[174:177], v[84:87], 0
ds_read_b128 v[84:87], v194 offset:64
v_fmac_f32 v127, v52, v52
v_mfma_f32_16x16x32_bf16 v[154:157], a[248:251], v[182:185], v[154:157]
s_waitcnt lgkmcnt(5)
v_add_f32 v134, v134, v65
v_fmac_f32 v135, v65, v65
v_mfma_f32_16x16x32_bf16 v[56:59], v[174:177], v[92:95], 0
ds_read_b128 v[92:95], v195 offset:64
v_fmac_f32 v119, v41, v41
v_mfma_f32_16x16x32_bf16 v[158:161], v[240:243], v[182:185], v[158:161]
s_waitcnt lgkmcnt(4)
v_add_f32 v126, v126, v53
v_fmac_f32 v127, v53, v53
v_mfma_f32_16x16x32_bf16 v[68:71], v[174:177], v[100:103], 0
ds_read_b128 v[100:103], v196 offset:64
ds_read_b128 v[174:177], v217 offset:4224
v_mfma_f32_16x16x32_bf16 v[162:165], v[182:185], a[80:83], v[162:165]
v_add_f32 v134, v134, v66
v_fmac_f32 v135, v66, v66
v_mfma_f32_16x16x32_bf16 v[166:169], v[182:185], a[104:107], v[166:169]
s_waitcnt lgkmcnt(3)
v_add_f32 v118, v118, v42
v_fmac_f32 v119, v42, v42
v_smfmac_f32_16x16x64_bf16 v[44:47], v[178:181], v[84:91], v213
ds_read_b128 v[84:87], v197 offset:64
ds_read_b128 v[88:91], v197 offset:80
v_mfma_f32_16x16x32_bf16 v[170:173], v[182:185], a[128:131], v[170:173]
s_waitcnt lgkmcnt(4)
ds_read_b128 v[182:185], v210 offset:4096
v_add_f32 v126, v126, v54
v_smfmac_f32_16x16x64_bf16 v[56:59], v[178:181], v[92:99], v213
ds_read_b128 v[92:95], v198 offset:64
ds_read_b128 v[96:99], v198 offset:80
v_mfma_f32_16x16x32_bf16 v[138:141], a[12:15], v[186:189], v[138:141]
s_waitcnt lgkmcnt(6)
v_fmac_f32 v127, v54, v54
v_add_f32 v134, v134, v67
v_smfmac_f32_16x16x64_bf16 v[68:71], v[178:181], v[100:107], v213
ds_read_b128 v[100:103], v199 offset:64
ds_read_b128 v[104:107], v199 offset:80
v_mfma_f32_16x16x32_bf16 v[142:145], a[36:39], v[186:189], v[142:145]
v_fmac_f32 v135, v67, v67
v_add_f32 v118, v118, v43
v_mfma_f32_16x16x32_bf16 v[146:149], a[60:63], v[186:189], v[146:149]
v_fmac_f32 v119, v43, v43
v_add_f32 v126, v126, v55
v_mfma_f32_16x16x32_bf16 v[150:153], a[228:231], v[186:189], v[150:153]
s_waitcnt lgkmcnt(5)
v_fmac_f32 v127, v55, v55
v_and_b32 v180, s44, v208
v_smfmac_f32_16x16x64_bf16 v[44:47], v[174:177], v[84:91], v213
buffer_store_dwordx2 v[116:117], v205, s[8:11], s39 offen
v_add_u32 v216, 1408, v216
v_mfma_f32_16x16x32_bf16 v[154:157], a[252:255], v[186:189], v[154:157]
v_mov_b32 v181, 0
s_waitcnt lgkmcnt(2)
v_smfmac_f32_16x16x64_bf16 v[56:59], v[174:177], v[92:99], v213
v_add_f32 v118, v118, v44
v_fmac_f32 v119, v44, v44
v_mfma_f32_16x16x32_bf16 v[158:161], v[244:247], v[186:189], v[158:161]
s_waitcnt lgkmcnt(0)
v_add_f32 v118, v118, v45
v_fmac_f32 v119, v45, v45
v_smfmac_f32_16x16x64_bf16 v[68:71], v[174:177], v[100:107], v213
v_add_f32 v126, v126, v56
v_fmac_f32 v127, v56, v56
v_mfma_f32_16x16x32_bf16 v[162:165], v[186:189], a[84:87], v[162:165]
v_add_f32 v126, v126, v57
v_fmac_f32 v127, v57, v57
v_mfma_f32_16x16x32_bf16 v[166:169], v[186:189], a[108:111], v[166:169]
v_add_f32 v134, v134, v68
v_fmac_f32 v135, v68, v68
v_mfma_f32_16x16x32_bf16 v[170:173], v[186:189], a[132:135], v[170:173]
ds_read_b128 v[186:189], v210 offset:5120
v_add_f32 v134, v134, v69
v_mfma_f32_16x16x32_bf16 v[138:141], a[16:19], v[182:185], v[138:141]
v_fmac_f32 v135, v69, v69
v_add_f32 v134, v134, v70
v_mfma_f32_16x16x32_bf16 v[142:145], a[40:43], v[182:185], v[142:145]
v_fmac_f32 v135, v70, v70
v_add_f32 v118, v118, v46
v_mfma_f32_16x16x32_bf16 v[146:149], a[64:67], v[182:185], v[146:149]
v_fmac_f32 v119, v46, v46
v_add_f32 v126, v126, v58
v_mfma_f32_16x16x32_bf16 v[150:153], a[232:235], v[182:185], v[150:153]
v_fmac_f32 v127, v58, v58
v_add_f32 v134, v134, v71
v_mfma_f32_16x16x32_bf16 v[154:157], v[224:227], v[182:185], v[154:157]
v_fmac_f32 v135, v71, v71
v_add_f32 v118, v118, v47
v_mfma_f32_16x16x32_bf16 v[158:161], v[248:251], v[182:185], v[158:161]
v_fmac_f32 v119, v47, v47
v_add_f32 v126, v126, v59
v_mfma_f32_16x16x32_bf16 v[162:165], v[182:185], a[88:91], v[162:165]
v_fmac_f32 v127, v59, v59
v_add_u32 v214, 1408, v214
v_mfma_f32_16x16x32_bf16 v[166:169], v[182:185], a[112:115], v[166:169]
v_permlane16_swap_b32 v134, v135
v_mfma_f32_16x16x32_bf16 v[170:173], v[182:185], a[136:139], v[170:173]
s_waitcnt lgkmcnt(0)
ds_read_b128 v[182:185], v210 offset:6144
v_add_f32 v134, v134, v135
v_mfma_f32_16x16x32_bf16 v[138:141], a[20:23], v[186:189], v[138:141]
v_permlane16_swap_b32 v118, v119
v_mfma_f32_16x16x32_bf16 v[142:145], a[44:47], v[186:189], v[142:145]
v_permlane16_swap_b32 v126, v127
v_mfma_f32_16x16x32_bf16 v[146:149], a[68:71], v[186:189], v[146:149]
v_cvt_pk_bf16_f32 v78, v138, v139
v_cvt_pk_bf16_f32 v79, v140, v141
v_mfma_f32_16x16x32_bf16 v[150:153], a[236:239], v[186:189], v[150:153]
v_cvt_pk_bf16_f32 v80, v142, v143
v_cvt_pk_bf16_f32 v81, v144, v145
v_mfma_f32_16x16x32_bf16 v[154:157], v[228:231], v[186:189], v[154:157]
v_cvt_pk_bf16_f32 v82, v146, v147
v_cvt_pk_bf16_f32 v83, v148, v149
v_mfma_f32_16x16x32_bf16 v[158:161], v[252:255], v[186:189], v[158:161]
v_cvt_pk_bf16_f32 v72, v150, v151
v_cvt_pk_bf16_f32 v73, v152, v153
v_mfma_f32_16x16x32_bf16 v[162:165], v[186:189], a[92:95], v[162:165]
v_cvt_pk_bf16_f32 v74, v154, v155
v_cvt_pk_bf16_f32 v75, v156, v157
v_mfma_f32_16x16x32_bf16 v[166:169], v[186:189], a[116:119], v[166:169]
v_cvt_pk_bf16_f32 v76, v158, v159
v_cvt_pk_bf16_f32 v77, v160, v161
v_mfma_f32_16x16x32_bf16 v[170:173], v[186:189], a[140:143], v[170:173]
s_waitcnt lgkmcnt(0)
ds_read_b128 v[186:189], v210 offset:7168
v_cvt_pk_bf16_f32 v114, v162, v163
v_mfma_f32_16x16x32_bf16 v[138:141], a[0:3], v[182:185], 0
v_cvt_pk_bf16_f32 v115, v164, v165
v_cvt_pk_bf16_f32 v122, v166, v167
v_mfma_f32_16x16x32_bf16 v[142:145], a[24:27], v[182:185], 0
v_cvt_pk_bf16_f32 v123, v168, v169
v_cvt_pk_bf16_f32 v130, v170, v171
v_mfma_f32_16x16x32_bf16 v[146:149], a[48:51], v[182:185], 0
v_cvt_pk_bf16_f32 v131, v172, v173
v_mov_b32 v135, v134
v_mfma_f32_16x16x32_bf16 v[150:153], a[216:219], v[182:185], 0
v_add_f32 v118, v118, v119
v_add_f32 v126, v126, v127
v_mfma_f32_16x16x32_bf16 v[154:157], a[240:243], v[182:185], 0
v_permlane32_swap_b32 v134, v135
v_mfma_f32_16x16x32_bf16 v[158:161], v[232:235], v[182:185], 0
v_permlane32_swap_b32 v118, v126
v_mfma_f32_16x16x32_bf16 v[162:165], v[182:185], a[72:75], 0
v_add_f32 v134, v134, v135
v_add_f32 v118, v118, v126
v_mfma_f32_16x16x32_bf16 v[166:169], v[182:185], a[96:99], 0
ds_write_b32 v209, v134 offset:512
v_mfma_f32_16x16x32_bf16 v[170:173], v[182:185], a[120:123], 0
s_waitcnt lgkmcnt(1)
ds_read_b128 v[182:185], v210 offset:8192
ds_write_b32 v209, v118
v_mfma_f32_16x16x32_bf16 v[138:141], a[4:7], v[186:189], v[138:141]
buffer_store_dwordx2 v[124:125], v205, s[8:11], s39 offen offset:32
v_mfma_f32_16x16x32_bf16 v[142:145], a[28:31], v[186:189], v[142:145]
v_mfma_f32_16x16x32_bf16 v[146:149], a[52:55], v[186:189], v[146:149]
v_mfma_f32_16x16x32_bf16 v[150:153], a[220:223], v[186:189], v[150:153]
v_mfma_f32_16x16x32_bf16 v[154:157], a[244:247], v[186:189], v[154:157]
v_mfma_f32_16x16x32_bf16 v[158:161], v[236:239], v[186:189], v[158:161]
s_waitcnt lgkmcnt(0)
s_barrier
v_mfma_f32_16x16x32_bf16 v[162:165], v[186:189], a[76:79], v[162:165]
ds_read_b128 v[106:109], v210 offset:56320
ds_read_b128 v[102:105], v210 offset:55296
v_mfma_f32_16x16x32_bf16 v[166:169], v[186:189], a[100:103], v[166:169]
buffer_load_dwordx4 v180, s[4:7], s40 offen nt lds
v_mfma_f32_16x16x32_bf16 v[170:173], v[186:189], a[124:127], v[170:173]
s_add_u32 m0, s45, 4112
ds_read_b128 v[186:189], v210 offset:9216
s_add_u32 s40, s36, 196224
v_mfma_f32_16x16x32_bf16 v[138:141], a[8:11], v[182:185], v[138:141]
buffer_load_dwordx4 v180, s[4:7], s40 offen nt lds
v_mfma_f32_16x16x32_bf16 v[142:145], a[32:35], v[182:185], v[142:145]
s_add_u32 m0, s45, 8224
s_add_u32 s40, s36, 392448
buffer_load_dwordx4 v180, s[4:7], s40 offen nt lds
v_mfma_f32_16x16x32_bf16 v[146:149], a[56:59], v[182:185], v[146:149]
s_add_u32 m0, s45, 12336
s_add_u32 s40, s36, 588672
buffer_load_dwordx4 v180, s[4:7], s40 offen nt lds
v_mfma_f32_16x16x32_bf16 v[150:153], a[224:227], v[182:185], v[150:153]
s_waitcnt lgkmcnt(2)
v_add_f32 v106, v106, v107
v_add_f32 v108, v108, v109
v_mfma_f32_16x16x32_bf16 v[154:157], a[248:251], v[182:185], v[154:157]
s_waitcnt lgkmcnt(1)
v_add_f32 v106, v106, v108
v_add_f32 v102, v102, v103
v_mfma_f32_16x16x32_bf16 v[158:161], v[240:243], v[182:185], v[158:161]
s_add_u32 m0, s45, 16448
ds_read_b128 v[108:111], v215 offset:512
v_add_f32 v104, v104, v105
v_mfma_f32_16x16x32_bf16 v[162:165], v[182:185], a[80:83], v[162:165]
s_add_u32 s40, s36, 784896
v_add_f32 v102, v102, v104
v_mul_f32 v106, s73, v106
v_mfma_f32_16x16x32_bf16 v[166:169], v[182:185], a[104:107], v[166:169]
v_mul_f32 v103, s48, v102
v_mul_f32 v104, s73, v102
v_mfma_f32_16x16x32_bf16 v[170:173], v[182:185], a[128:131], v[170:173]
s_waitcnt lgkmcnt(1)
ds_read_b128 v[182:185], v210 offset:10240
v_fma_f32 v106, -v103, v104, v106
v_mfma_f32_16x16x32_bf16 v[138:141], a[12:15], v[186:189], v[138:141]
v_max_f32 v106, 0, v106
v_add_f32 v106, s49, v106
v_mfma_f32_16x16x32_bf16 v[142:145], a[36:39], v[186:189], v[142:145]
v_rsq_f32 v102, v106
v_mfma_f32_16x16x32_bf16 v[146:149], a[60:63], v[186:189], v[146:149]
v_mul_f32_e64 v103, -v103, v102
v_mfma_f32_16x16x32_bf16 v[150:153], a[228:231], v[186:189], v[150:153]
ds_write_b64 v211, v[102:103] offset:36864
v_mfma_f32_16x16x32_bf16 v[154:157], a[252:255], v[186:189], v[154:157]
s_waitcnt lgkmcnt(1)
buffer_load_dwordx4 v180, s[4:7], s40 offen nt lds
v_mfma_f32_16x16x32_bf16 v[158:161], v[244:247], v[186:189], v[158:161]
s_add_u32 m0, s45, 20560
ds_read_b64 v[118:119], v219
ds_read_b64 v[126:127], v219 offset:256
v_mfma_f32_16x16x32_bf16 v[162:165], v[186:189], a[84:87], v[162:165]
s_add_u32 s40, s36, 981120
ds_read_b64 v[134:135], v219 offset:512
buffer_load_dwordx4 v180, s[4:7], s40 offen nt lds
v_mfma_f32_16x16x32_bf16 v[166:169], v[186:189], a[108:111], v[166:169]
s_add_u32 m0, s45, 24672
s_add_u32 s40, s36, 1177344
buffer_load_dwordx4 v180, s[4:7], s40 offen nt lds
v_mfma_f32_16x16x32_bf16 v[170:173], v[186:189], a[132:135], v[170:173]
s_add_u32 m0, s45, 28784
ds_read_b128 v[186:189], v210 offset:11264
s_add_u32 s40, s36, 1373568
v_mfma_f32_16x16x32_bf16 v[138:141], a[16:19], v[182:185], v[138:141]
buffer_load_dwordx4 v180, s[4:7], s40 offen nt lds
v_mfma_f32_16x16x32_bf16 v[142:145], a[40:43], v[182:185], v[142:145]
s_waitcnt lgkmcnt(3)
v_fma_f32 v220, v36, v118, v119
v_fma_f32 v221, v37, v118, v119
v_mfma_f32_16x16x32_bf16 v[146:149], a[64:67], v[182:185], v[146:149]
s_add_u32 m0, s45, 32896
v_fma_f32 v222, v38, v118, v119
v_fma_f32 v223, v39, v118, v119
v_mfma_f32_16x16x32_bf16 v[150:153], a[232:235], v[182:185], v[150:153]
s_add_u32 s40, s36, 1569792
v_cvt_pk_bf16_f32 v90, v220, v221
v_cvt_pk_bf16_f32 v91, v222, v223
v_mfma_f32_16x16x32_bf16 v[154:157], v[224:227], v[182:185], v[154:157]
v_fma_f32 v220, v40, v118, v119
v_fma_f32 v221, v41, v118, v119
v_mfma_f32_16x16x32_bf16 v[158:161], v[248:251], v[182:185], v[158:161]
v_fma_f32 v222, v42, v118, v119
v_fma_f32 v223, v43, v118, v119
v_mfma_f32_16x16x32_bf16 v[162:165], v[182:185], a[88:91], v[162:165]
v_cvt_pk_bf16_f32 v92, v220, v221
v_cvt_pk_bf16_f32 v93, v222, v223
v_mfma_f32_16x16x32_bf16 v[166:169], v[182:185], a[112:115], v[166:169]
ds_write_b128 v211, v[90:93] offset:18432
v_mfma_f32_16x16x32_bf16 v[170:173], v[182:185], a[136:139], v[170:173]
s_waitcnt lgkmcnt(1)
v_fma_f32 v220, v44, v118, v119
v_fma_f32 v221, v45, v118, v119
v_mfma_f32_16x16x32_bf16 v[138:141], a[20:23], v[186:189], v[138:141]
buffer_store_dwordx2 v[132:133], v205, s[8:11], s39 offen offset:64
ds_read_b128 v[182:185], v210 offset:12288
v_mfma_f32_16x16x32_bf16 v[142:145], a[44:47], v[186:189], v[142:145]
v_fma_f32 v222, v46, v118, v119
v_fma_f32 v223, v47, v118, v119
v_mfma_f32_16x16x32_bf16 v[146:149], a[68:71], v[186:189], v[146:149]
v_cvt_pk_bf16_f32 v96, v138, v139
v_cvt_pk_bf16_f32 v97, v140, v141
v_mfma_f32_16x16x32_bf16 v[150:153], a[236:239], v[186:189], v[150:153]
v_cvt_pk_bf16_f32 v98, v142, v143
v_cvt_pk_bf16_f32 v99, v144, v145
v_mfma_f32_16x16x32_bf16 v[154:157], v[228:231], v[186:189], v[154:157]
v_cvt_pk_bf16_f32 v100, v146, v147
v_cvt_pk_bf16_f32 v101, v148, v149
v_mfma_f32_16x16x32_bf16 v[158:161], v[252:255], v[186:189], v[158:161]
v_cvt_pk_bf16_f32 v84, v150, v151
v_cvt_pk_bf16_f32 v85, v152, v153
v_mfma_f32_16x16x32_bf16 v[162:165], v[186:189], a[92:95], v[162:165]
v_cvt_pk_bf16_f32 v86, v154, v155
v_cvt_pk_bf16_f32 v87, v156, v157
v_mfma_f32_16x16x32_bf16 v[166:169], v[186:189], a[116:119], v[166:169]
v_cvt_pk_bf16_f32 v88, v158, v159
v_cvt_pk_bf16_f32 v89, v160, v161
v_mfma_f32_16x16x32_bf16 v[170:173], v[186:189], a[140:143], v[170:173]
s_waitcnt lgkmcnt(0)
ds_read_b128 v[186:189], v210 offset:13312
v_cvt_pk_bf16_f32 v116, v162, v163
v_mfma_f32_16x16x32_bf16 v[138:141], a[0:3], v[182:185], 0
v_cvt_pk_bf16_f32 v124, v166, v167
v_cvt_pk_bf16_f32 v125, v168, v169
v_mfma_f32_16x16x32_bf16 v[142:145], a[24:27], v[182:185], 0
v_cvt_pk_bf16_f32 v117, v164, v165
v_cvt_pk_bf16_f32 v94, v220, v221
v_mfma_f32_16x16x32_bf16 v[150:153], v[108:111], v[72:75], v[206:209]
v_cvt_pk_bf16_f32 v95, v222, v223
v_fma_f32 v220, v48, v126, v127
v_mfma_f32_16x16x32_bf16 v[146:149], a[48:51], v[182:185], 0
ds_read_b128 v[182:185], v210 offset:14336
ds_write_b64 v212, v[94:95] offset:18432
v_mfma_f32_16x16x16_bf16 v[150:153], v[112:113], v[76:77], v[150:153]
s_waitcnt lgkmcnt(2)
v_fma_f32 v221, v49, v126, v127
v_fma_f32 v222, v50, v126, v127
v_mfma_f32_16x16x32_bf16 v[138:141], a[4:7], v[186:189], v[138:141]
v_fma_f32 v223, v51, v126, v127
v_cvt_pk_bf16_f32 v174, v220, v221
v_mfma_f32_16x16x32_bf16 v[142:145], a[28:31], v[186:189], v[142:145]
v_cvt_pk_bf16_f32 v175, v222, v223
v_fma_f32 v220, v52, v126, v127
v_mfma_f32_16x16x32_bf16 v[146:149], a[52:55], v[186:189], v[146:149]
ds_read_b128 v[186:189], v210 offset:15360
v_fma_f32 v221, v53, v126, v127
v_mfma_f32_16x16x32_bf16 v[154:157], v[78:81], v[84:87], 0
s_waitcnt lgkmcnt(2)
v_fma_f32 v222, v54, v126, v127
v_fma_f32 v223, v55, v126, v127
v_mfma_f32_16x16x32_bf16 v[138:141], a[8:11], v[182:185], v[138:141]
v_cvt_pk_bf16_f32 v176, v220, v221
v_cvt_pk_bf16_f32 v177, v222, v223
v_mfma_f32_16x16x32_bf16 v[142:145], a[32:35], v[182:185], v[142:145]
v_fma_f32 v220, v56, v126, v127
v_fma_f32 v221, v57, v126, v127
v_mfma_f32_16x16x32_bf16 v[158:161], v[96:99], v[84:87], 0
v_fma_f32 v222, v58, v126, v127
v_fma_f32 v223, v59, v126, v127
v_mfma_f32_16x16x32_bf16 v[146:149], a[56:59], v[182:185], v[146:149]
ds_read_b128 v[182:185], v210 offset:16384
v_cvt_pk_bf16_f32 v178, v220, v221
v_mfma_f32_16x16x32_bf16 v[166:169], v[108:111], v[84:87], v[206:209]
s_waitcnt lgkmcnt(1)
v_cvt_pk_bf16_f32 v179, v222, v223
v_fma_f32 v220, v60, v134, v135
v_mfma_f32_16x16x32_bf16 v[138:141], a[12:15], v[186:189], v[138:141]
v_fma_f32 v221, v61, v134, v135
v_fma_f32 v222, v62, v134, v135
v_mfma_f32_16x16x32_bf16 v[142:145], a[36:39], v[186:189], v[142:145]
v_fma_f32 v223, v63, v134, v135
v_cvt_pk_bf16_f32 v90, v220, v221
v_mfma_f32_16x16x32_bf16 v[146:149], a[60:63], v[186:189], v[146:149]
ds_read_b128 v[186:189], v210 offset:17408
v_cvt_pk_bf16_f32 v91, v222, v223
v_mfma_f32_16x16x16_bf16 v[154:157], v[82:83], v[88:89], v[154:157]
v_fma_f32 v220, v64, v134, v135
v_fma_f32 v221, v65, v134, v135
v_mfma_f32_16x16x16_bf16 v[158:161], v[100:101], v[88:89], v[158:161]
s_waitcnt lgkmcnt(1)
v_fma_f32 v222, v66, v134, v135
v_fma_f32 v223, v67, v134, v135
v_mfma_f32_16x16x32_bf16 v[138:141], a[16:19], v[182:185], v[138:141]
v_cvt_pk_bf16_f32 v92, v220, v221
v_cvt_pk_bf16_f32 v93, v222, v223
v_mfma_f32_16x16x32_bf16 v[142:145], a[40:43], v[182:185], v[142:145]
ds_write_b128 v211, v[90:93] offset:30720
v_mfma_f32_16x16x16_bf16 v[166:169], v[112:113], v[88:89], v[166:169]
v_fma_f32 v220, v68, v134, v135
v_fma_f32 v221, v69, v134, v135
v_mfma_f32_16x16x32_bf16 v[146:149], a[64:67], v[182:185], v[146:149]
s_waitcnt lgkmcnt(1)
v_fma_f32 v222, v70, v134, v135
v_fma_f32 v223, v71, v134, v135
v_mfma_f32_16x16x32_bf16 v[138:141], a[20:23], v[186:189], v[138:141]
ds_read_b128 v[182:185], v210 offset:12288
v_cvt_pk_bf16_f32 v132, v170, v171
v_mfma_f32_16x16x32_bf16 v[142:145], a[44:47], v[186:189], v[142:145]
v_cvt_pk_bf16_f32 v133, v172, v173
v_cvt_pk_bf16_f32 v94, v220, v221
v_mfma_f32_16x16x32_bf16 v[146:149], a[68:71], v[186:189], v[146:149]
v_cvt_pk_bf16_f32 v102, v138, v139
v_cvt_pk_bf16_f32 v103, v140, v141
v_mfma_f32_16x16x32_bf16 v[138:141], v[78:81], v[72:75], 0
v_cvt_pk_bf16_f32 v104, v142, v143
v_cvt_pk_bf16_f32 v105, v144, v145
v_mfma_f32_16x16x32_bf16 v[142:145], v[96:99], v[72:75], 0
v_cvt_pk_bf16_f32 v106, v146, v147
v_cvt_pk_bf16_f32 v107, v148, v149
v_mfma_f32_16x16x32_bf16 v[146:149], v[102:105], v[72:75], 0
ds_read_b128 v[186:189], v210 offset:13312
v_cvt_pk_bf16_f32 v95, v222, v223
v_mfma_f32_16x16x16_bf16 v[138:141], v[82:83], v[76:77], v[138:141]
buffer_load_dwordx4 v180, s[4:7], s40 offen nt lds
v_mfma_f32_16x16x16_bf16 v[142:145], v[100:101], v[76:77], v[142:145]
ds_write_b128 v211, v[174:177] offset:24576
v_mfma_f32_16x16x16_bf16 v[146:149], v[106:107], v[76:77], v[146:149]
v_exp_f32 v138, v138
v_mfma_f32_16x16x32_bf16 v[162:165], v[102:105], v[84:87], 0
s_waitcnt lgkmcnt(2)
v_exp_f32 v139, v139
v_mfma_f32_16x16x32_bf16 v[118:121], v[182:185], a[72:75], 0
v_exp_f32 v140, v140
v_mfma_f32_16x16x16_bf16 v[162:165], v[106:107], v[88:89], v[162:165]
v_exp_f32 v141, v141
v_mfma_f32_16x16x32_bf16 v[126:129], v[182:185], a[96:99], 0
v_exp_f32 v142, v142
v_mfma_f32_16x16x32_bf16 v[134:137], v[182:185], a[120:123], 0
v_exp_f32 v143, v143
v_mfma_f32_16x16x32_bf16 v[90:93], a[216:219], v[182:185], 0
v_exp_f32 v144, v144
v_mfma_f32_16x16x32_bf16 v[170:173], a[240:243], v[182:185], 0
v_exp_f32 v145, v145
v_mfma_f32_16x16x32_bf16 v[220:223], v[232:235], v[182:185], 0
s_waitcnt lgkmcnt(1)
ds_read_b128 v[182:185], v210 offset:14336
v_cvt_pk_bf16_f32 v174, v138, v139
v_mfma_f32_16x16x32_bf16 v[118:121], v[186:189], a[76:79], v[118:121]
v_exp_f32 v150, v150
v_mfma_f32_16x16x32_bf16 v[126:129], v[186:189], a[100:103], v[126:129]
v_cvt_pk_bf16_f32 v175, v140, v141
v_cvt_pk_bf16_f32 v176, v142, v143
v_mfma_f32_16x16x32_bf16 v[134:137], v[186:189], a[124:127], v[134:137]
v_cvt_pk_bf16_f32 v177, v144, v145
v_cvt_pk_bf16_f32 v180, v150, 0
v_mfma_f32_16x16x32_bf16 v[90:93], a[220:223], v[186:189], v[90:93]
ds_write_b64 v212, v[178:179] offset:24576
v_mfma_f32_16x16x32_bf16 v[170:173], a[244:247], v[186:189], v[170:173]
v_exp_f32 v146, v146
v_mfma_f32_16x16x32_bf16 v[220:223], v[236:239], v[186:189], v[220:223]
s_waitcnt lgkmcnt(1)
ds_read_b128 v[186:189], v210 offset:15360
ds_read_b128 v[72:75], v215
v_mfma_f32_16x16x32_bf16 v[118:121], v[182:185], a[80:83], v[118:121]
v_exp_f32 v147, v147
v_mfma_f32_16x16x32_bf16 v[126:129], v[182:185], a[104:107], v[126:129]
v_exp_f32 v148, v148
v_mfma_f32_16x16x32_bf16 v[134:137], v[182:185], a[128:131], v[134:137]
v_exp_f32 v149, v149
v_mfma_f32_16x16x32_bf16 v[90:93], a[224:227], v[182:185], v[90:93]
v_cvt_pk_bf16_f32 v178, v146, v147
v_cvt_pk_bf16_f32 v179, v148, v149
v_mfma_f32_16x16x32_bf16 v[170:173], a[248:251], v[182:185], v[170:173]
ds_write_b64 v212, v[94:95] offset:30720
v_mfma_f32_16x16x32_bf16 v[220:223], v[240:243], v[182:185], v[220:223]
s_waitcnt lgkmcnt(2)
v_exp_f32 v154, v154
v_mfma_f32_16x16x32_bf16 v[118:121], v[186:189], a[84:87], v[118:121]
ds_read_b128 v[182:185], v210 offset:16384
ds_read_b64 v[76:77], v215 offset:16
v_mfma_f32_16x16x32_bf16 v[126:129], v[186:189], a[108:111], v[126:129]
v_exp_f32 v155, v155
v_mfma_f32_16x16x32_bf16 v[134:137], v[186:189], a[132:135], v[134:137]
v_exp_f32 v156, v156
v_mfma_f32_16x16x32_bf16 v[90:93], a[228:231], v[186:189], v[90:93]
v_exp_f32 v157, v157
v_mfma_f32_16x16x32_bf16 v[170:173], a[252:255], v[186:189], v[170:173]
v_exp_f32 v158, v158
v_mfma_f32_16x16x32_bf16 v[220:223], v[244:247], v[186:189], v[220:223]
ds_read_b128 v[186:189], v210 offset:17408
v_exp_f32 v159, v159
v_mfma_f32_16x16x32_bf16 v[150:153], v[190:193], v[174:177], 0
s_waitcnt lgkmcnt(2)
v_exp_f32 v160, v160
v_mfma_f32_16x16x32_bf16 v[118:121], v[182:185], a[88:91], v[118:121]
v_exp_f32 v161, v161
v_mfma_f32_16x16x32_bf16 v[126:129], v[182:185], a[112:115], v[126:129]
v_exp_f32 v166, v166
v_mfma_f32_16x16x32_bf16 v[134:137], v[182:185], a[136:139], v[134:137]
v_exp_f32 v162, v162
v_mfma_f32_16x16x32_bf16 v[90:93], a[232:235], v[182:185], v[90:93]
v_exp_f32 v163, v163
v_mfma_f32_16x16x32_bf16 v[170:173], v[224:227], v[182:185], v[170:173]
v_exp_f32 v164, v164
v_mfma_f32_16x16x32_bf16 v[220:223], v[248:251], v[182:185], v[220:223]
s_waitcnt lgkmcnt(0)
v_exp_f32 v165, v165
v_mfma_f32_16x16x32_bf16 v[118:121], v[186:189], a[92:95], v[118:121]
v_mfma_f32_16x16x32_bf16 v[126:129], v[186:189], a[116:119], v[126:129]
v_mfma_f32_16x16x32_bf16 v[134:137], v[186:189], a[140:143], v[134:137]
v_cvt_pk_bf16_f32 v118, v118, v119
v_cvt_pk_bf16_f32 v119, v120, v121
v_mfma_f32_16x16x32_bf16 v[90:93], a[236:239], v[186:189], v[90:93]
ds_read_u16 v120, v216
v_cvt_pk_bf16_f32 v126, v126, v127
v_mfma_f32_16x16x32_bf16 v[170:173], v[228:231], v[186:189], v[170:173]
v_cvt_pk_bf16_f32 v127, v128, v129
v_cvt_pk_bf16_f32 v134, v134, v135
v_mfma_f32_16x16x32_bf16 v[220:223], v[252:255], v[186:189], v[220:223]
ds_read_u16 v128, v216 offset:32
v_cvt_pk_bf16_f32 v90, v90, v91
v_mfma_f32_16x16x32_bf16 v[138:141], v[114:117], v[174:177], 0
v_cvt_pk_bf16_f32 v91, v92, v93
v_cvt_pk_bf16_f32 v92, v170, v171
v_mfma_f32_16x16x32_bf16 v[142:145], v[122:125], v[174:177], 0
v_cvt_pk_bf16_f32 v93, v172, v173
v_cvt_pk_bf16_f32 v135, v136, v137
v_mfma_f32_16x16x32_bf16 v[146:149], v[130:133], v[174:177], 0
ds_read_u16 v136, v216 offset:64
v_mov_b32 v121, 0
v_mfma_f32_16x16x32_bf16 v[150:153], v[190:193], v[178:181], v[150:153]
s_waitcnt lgkmcnt(2)
v_mov_b32 v129, 0
v_cvt_pk_bf16_f32 v94, v220, v221
v_mfma_f32_16x16x32_bf16 v[138:141], v[118:121], v[178:181], v[138:141]
s_waitcnt lgkmcnt(1)
v_cvt_pk_bf16_f32 v95, v222, v223
v_mov_b32 v137, 0
v_mfma_f32_16x16x32_bf16 v[142:145], v[126:129], v[178:181], v[142:145]
v_rcp_f32 v151, v150
s_nop 0
v_max3_u32 v218, v218, v150, v151
v_mul_f32 v151, s3, v151
v_mul_f32 v138, v138, v151
v_mul_f32 v139, v139, v151
v_mul_f32 v140, v140, v151
v_mul_f32 v141, v141, v151
v_cvt_pk_bf16_f32 v138, v138, v139
v_mul_f32 v142, v142, v151
s_waitcnt lgkmcnt(0)
v_mfma_f32_16x16x32_bf16 v[146:149], v[134:137], v[178:181], v[146:149]
v_mul_f32 v143, v143, v151
v_mul_f32 v144, v144, v151
v_mul_f32 v145, v145, v151
v_cvt_pk_bf16_f32 v139, v140, v141
v_cvt_pk_bf16_f32 v140, v142, v143
v_cvt_pk_bf16_f32 v141, v144, v145
v_cvt_pk_bf16_f32 v174, v154, v155
v_mul_f32 v146, v146, v151
v_mul_f32 v147, v147, v151
v_mul_f32 v148, v148, v151
v_mul_f32 v149, v149, v151
v_mfma_f32_16x16x32_bf16 v[150:153], v[108:111], v[90:93], v[206:209]
ds_write_b128 v211, v[138:141] offset:36864
v_mfma_f32_16x16x32_bf16 v[138:141], v[78:81], v[90:93], 0
v_cvt_pk_bf16_f32 v142, v146, v147
v_cvt_pk_bf16_f32 v143, v148, v149
v_mfma_f32_16x16x32_bf16 v[146:149], v[102:105], v[90:93], 0
v_cvt_pk_bf16_f32 v175, v156, v157
v_cvt_pk_bf16_f32 v176, v158, v159
v_mfma_f32_16x16x16_bf16 v[138:141], v[82:83], v[94:95], v[138:141]
ds_write_b64 v212, v[142:143] offset:36864
v_mfma_f32_16x16x32_bf16 v[142:145], v[96:99], v[90:93], 0
v_cvt_pk_bf16_f32 v177, v160, v161
v_cvt_pk_bf16_f32 v180, v166, 0
v_mfma_f32_16x16x16_bf16 v[150:153], v[112:113], v[94:95], v[150:153]
v_cvt_pk_bf16_f32 v178, v162, v163
v_cvt_pk_bf16_f32 v179, v164, v165
v_mfma_f32_16x16x32_bf16 v[166:169], v[190:193], v[174:177], 0
v_exp_f32 v138, v138
v_mfma_f32_16x16x32_bf16 v[154:157], v[114:117], v[174:177], 0
v_exp_f32 v139, v139
v_mfma_f32_16x16x32_bf16 v[158:161], v[122:125], v[174:177], 0
v_exp_f32 v140, v140
v_mfma_f32_16x16x32_bf16 v[162:165], v[130:133], v[174:177], 0
v_exp_f32 v141, v141
v_mfma_f32_16x16x16_bf16 v[142:145], v[100:101], v[94:95], v[142:145]
v_exp_f32 v150, v150
v_mfma_f32_16x16x32_bf16 v[166:169], v[190:193], v[178:181], v[166:169]
v_cvt_pk_bf16_f32 v174, v138, v139
v_cvt_pk_bf16_f32 v175, v140, v141
v_mfma_f32_16x16x32_bf16 v[154:157], v[118:121], v[178:181], v[154:157]
v_exp_f32 v142, v142
v_mfma_f32_16x16x32_bf16 v[158:161], v[126:129], v[178:181], v[158:161]
v_rcp_f32 v167, v166
v_mfma_f32_16x16x32_bf16 v[162:165], v[134:137], v[178:181], v[162:165]
v_max3_u32 v218, v218, v166, v167
v_mul_f32 v167, s3, v167
v_mfma_f32_16x16x16_bf16 v[146:149], v[106:107], v[94:95], v[146:149]
v_mul_f32 v154, v154, v167
v_mul_f32 v155, v155, v167
v_mul_f32 v156, v156, v167
v_mul_f32 v157, v157, v167
v_cvt_pk_bf16_f32 v154, v154, v155
v_mul_f32 v158, v158, v167
v_mul_f32 v159, v159, v167
v_mul_f32 v160, v160, v167
v_mul_f32 v161, v161, v167
v_cvt_pk_bf16_f32 v155, v156, v157
v_cvt_pk_bf16_f32 v156, v158, v159
v_cvt_pk_bf16_f32 v157, v160, v161
v_mul_f32 v162, v162, v167
v_mul_f32 v163, v163, v167
v_mul_f32 v164, v164, v167
v_mul_f32 v165, v165, v167
v_mfma_f32_16x16x32_bf16 v[166:169], v[72:75], v[108:111], v[206:209]
ds_write_b128 v211, v[154:157] offset:43008
v_mfma_f32_16x16x32_bf16 v[154:157], v[72:75], v[78:81], 0
v_cvt_pk_bf16_f32 v158, v162, v163
v_cvt_pk_bf16_f32 v159, v164, v165
v_mfma_f32_16x16x32_bf16 v[162:165], v[72:75], v[102:105], 0
v_exp_f32 v143, v143
v_mfma_f32_16x16x16_bf16 v[154:157], v[76:77], v[82:83], v[154:157]
ds_write_b64 v212, v[158:159] offset:43008
v_mfma_f32_16x16x32_bf16 v[158:161], v[72:75], v[96:99], 0
v_exp_f32 v144, v144
v_mfma_f32_16x16x16_bf16 v[162:165], v[76:77], v[106:107], v[162:165]
v_exp_f32 v145, v145
v_mfma_f32_16x16x16_bf16 v[158:161], v[76:77], v[100:101], v[158:161]
v_cvt_pk_bf16_f32 v176, v142, v143
v_cvt_pk_bf16_f32 v177, v144, v145
v_mfma_f32_16x16x16_bf16 v[166:169], v[76:77], v[112:113], v[166:169]
v_cvt_pk_bf16_f32 v180, v150, 0
v_exp_f32 v146, v146
v_mfma_f32_16x16x32_bf16 v[150:153], v[190:193], v[174:177], 0
v_exp_f32 v147, v147
v_mfma_f32_16x16x32_bf16 v[138:141], v[114:117], v[174:177], 0
s_waitcnt lgkmcnt(0)
v_exp_f32 v148, v148
v_mfma_f32_16x16x32_bf16 v[142:145], v[122:125], v[174:177], 0
s_barrier
ds_read_b128 v[170:173], v210 offset:36864
v_exp_f32 v149, v149
v_mov_b32_dpp v154, v158 quad_perm:[0,1,2,3] row_mask:0x2 bank_mask:0xf
v_cvt_pk_bf16_f32 v178, v146, v147
v_cvt_pk_bf16_f32 v179, v148, v149
v_mfma_f32_16x16x32_bf16 v[146:149], v[130:133], v[174:177], 0
v_mov_b32_dpp v154, v162 quad_perm:[0,1,2,3] row_mask:0x4 bank_mask:0xf
v_mfma_f32_16x16x32_bf16 v[150:153], v[190:193], v[178:181], v[150:153]
ds_read_b128 v[182:185], v210 offset:37888
v_mov_b32_dpp v154, v167 quad_perm:[0,1,2,3] row_mask:0x8 bank_mask:0xf
v_mfma_f32_16x16x32_bf16 v[138:141], v[118:121], v[178:181], v[138:141]
v_exp_f32 v154, v154
v_mfma_f32_16x16x32_bf16 v[142:145], v[126:129], v[178:181], v[142:145]
v_cvt_pk_bf16_f32 v154, v154, 0
v_rcp_f32 v151, v150
v_mfma_f32_16x16x32_bf16 v[146:149], v[134:137], v[178:181], v[146:149]
s_waitcnt lgkmcnt(1)
ds_write_b16 v214, v154
v_mfma_f32_16x16x32_bf16 v[0:3], a[144:147], v[170:173], v[0:3]
ds_read_b128 v[84:87], v215
ds_read_b128 v[88:91], v215 offset:16
v_mfma_f32_16x16x32_bf16 v[4:7], a[168:171], v[170:173], v[4:7]
ds_read_b128 v[186:189], v210 offset:38912
ds_read_b128 v[174:177], v217
v_mfma_f32_16x16x32_bf16 v[8:11], a[192:195], v[170:173], v[8:11]
s_waitcnt lgkmcnt(5)
ds_read_b128 v[170:173], v210 offset:39936
ds_read_b128 v[178:181], v217 offset:528
v_mfma_f32_16x16x32_bf16 v[0:3], a[148:151], v[182:185], v[0:3]
v_mfma_f32_16x16x32_bf16 v[4:7], a[172:175], v[182:185], v[4:7]
v_mfma_f32_16x16x32_bf16 v[8:11], a[196:199], v[182:185], v[8:11]
ds_read_b128 v[182:185], v210 offset:40960
s_waitcnt lgkmcnt(6)
v_mfma_f32_16x16x32_bf16 v[166:169], v[84:87], v[190:193], 0
v_mfma_f32_16x16x32_bf16 v[154:157], v[84:87], v[114:117], 0
v_mfma_f32_16x16x32_bf16 v[158:161], v[84:87], v[122:125], 0
v_mfma_f32_16x16x32_bf16 v[162:165], v[84:87], v[130:133], 0
s_waitcnt lgkmcnt(5)
v_mfma_f32_16x16x32_bf16 v[166:169], v[88:91], v[190:193], v[166:169]
s_waitcnt lgkmcnt(4)
v_mfma_f32_16x16x32_bf16 v[0:3], a[152:155], v[186:189], v[0:3]
v_mfma_f32_16x16x32_bf16 v[154:157], v[88:91], v[118:121], v[154:157]
v_rcp_f32 v167, v166
v_mfma_f32_16x16x32_bf16 v[4:7], a[176:179], v[186:189], v[4:7]
v_max3_u32 v218, v218, v166, v167
v_max3_u32 v218, v218, v150, v151
v_mfma_f32_16x16x32_bf16 v[158:161], v[88:91], v[126:129], v[158:161]
v_mul_f32 v151, s3, v151
v_mul_f32 v138, v138, v151
v_mfma_f32_16x16x32_bf16 v[8:11], a[200:203], v[186:189], v[8:11]
ds_read_b128 v[186:189], v210 offset:41984
v_mul_f32 v139, v139, v151
v_mfma_f32_16x16x32_bf16 v[162:165], v[88:91], v[134:137], v[162:165]
s_waitcnt lgkmcnt(3)
v_mul_f32 v140, v140, v151
v_mul_f32 v141, v141, v151
v_mfma_f32_16x16x32_bf16 v[0:3], a[156:159], v[170:173], v[0:3]
v_cvt_pk_bf16_f32 v138, v138, v139
v_mul_f32 v142, v142, v151
v_mfma_f32_16x16x32_bf16 v[4:7], a[180:183], v[170:173], v[4:7]
v_mul_f32 v143, v143, v151
v_mul_f32 v144, v144, v151
v_mfma_f32_16x16x32_bf16 v[8:11], a[204:207], v[170:173], v[8:11]
s_waitcnt lgkmcnt(1)
ds_read_b128 v[170:173], v210 offset:43008
v_mul_f32 v145, v145, v151
v_mfma_f32_16x16x32_bf16 v[0:3], a[160:163], v[182:185], v[0:3]
v_cvt_pk_bf16_f32 v139, v140, v141
v_cvt_pk_bf16_f32 v140, v142, v143
v_mfma_f32_16x16x32_bf16 v[4:7], a[184:187], v[182:185], v[4:7]
v_cvt_pk_bf16_f32 v141, v144, v145
v_mul_f32 v146, v146, v151
v_mfma_f32_16x16x32_bf16 v[8:11], a[208:211], v[182:185], v[8:11]
s_waitcnt lgkmcnt(1)
ds_read_b128 v[182:185], v210 offset:44032
ds_write_b128 v211, v[138:141] offset:49152
v_mfma_f32_16x16x32_bf16 v[0:3], a[164:167], v[186:189], v[0:3]
v_mul_f32 v147, v147, v151
v_mul_f32 v148, v148, v151
v_mfma_f32_16x16x32_bf16 v[4:7], a[188:191], v[186:189], v[4:7]
v_mul_f32 v149, v149, v151
v_cvt_pk_bf16_f32 v142, v146, v147
v_mfma_f32_16x16x32_bf16 v[8:11], a[212:215], v[186:189], v[8:11]
s_waitcnt lgkmcnt(2)
ds_read_b128 v[186:189], v210 offset:45056
v_cvt_pk_bf16_f32 v143, v148, v149
v_mfma_f32_16x16x32_bf16 v[12:15], a[144:147], v[170:173], v[12:15]
ds_write_b64 v212, v[142:143] offset:49152
v_mfma_f32_16x16x32_bf16 v[16:19], a[168:171], v[170:173], v[16:19]
v_cvt_pk_bf16_f32 v72, v0, v1
v_cvt_pk_bf16_f32 v73, v2, v3
v_mfma_f32_16x16x32_bf16 v[20:23], a[192:195], v[170:173], v[20:23]
s_waitcnt lgkmcnt(3)
ds_read_b128 v[170:173], v210 offset:46080
buffer_store_dwordx2 v[72:73], v203, s[8:11], s38 offen
v_cvt_pk_bf16_f32 v74, v4, v5
v_mfma_f32_16x16x32_bf16 v[12:15], a[148:151], v[182:185], v[12:15]
v_cvt_pk_bf16_f32 v75, v6, v7
v_mov_b32_dpp v154, v158 quad_perm:[0,1,2,3] row_mask:0x2 bank_mask:0xf
v_mfma_f32_16x16x32_bf16 v[16:19], a[172:175], v[182:185], v[16:19]
v_mul_f32 v167, s3, v167
v_mov_b32_dpp v154, v162 quad_perm:[0,1,2,3] row_mask:0x4 bank_mask:0xf
v_mfma_f32_16x16x32_bf16 v[20:23], a[196:199], v[182:185], v[20:23]
s_waitcnt lgkmcnt(2)
ds_read_b128 v[182:185], v210 offset:47104
v_mul_f32 v154, v154, v167
v_mfma_f32_16x16x32_bf16 v[12:15], a[152:155], v[186:189], v[12:15]
v_cvt_pk_bf16_f32 v154, v154, 0
v_cvt_pk_bf16_f32 v76, v8, v9
v_mfma_f32_16x16x32_bf16 v[16:19], a[176:179], v[186:189], v[16:19]
s_waitcnt vmcnt(1) lgkmcnt(1)
ds_write_b16 v214, v154
v_mfma_f32_16x16x32_bf16 v[20:23], a[200:203], v[186:189], v[20:23]
s_barrier
v_mfma_f32_16x16x32_bf16 v[12:15], a[156:159], v[170:173], v[12:15]
ds_read_b128 v[186:189], v210 offset:48128
ds_read_b128 v[84:87], v200
v_mfma_f32_16x16x32_bf16 v[16:19], a[180:183], v[170:173], v[16:19]
ds_read_b128 v[92:95], v201
ds_read_b128 v[100:103], v202
v_mfma_f32_16x16x32_bf16 v[20:23], a[204:207], v[170:173], v[20:23]
s_waitcnt lgkmcnt(5)
ds_read_b128 v[170:173], v210 offset:49152
ds_read_b128 v[88:91], v194 offset:16
v_mfma_f32_16x16x32_bf16 v[12:15], a[160:163], v[182:185], v[12:15]
ds_read_b128 v[96:99], v195 offset:16
buffer_store_dwordx2 v[74:75], v203, s[8:11], s38 offen offset:32
v_cvt_pk_bf16_f32 v77, v10, v11
v_mfma_f32_16x16x32_bf16 v[16:19], a[184:187], v[182:185], v[16:19]
ds_read_b128 v[104:107], v196 offset:16
v_add_u32 v215, 1408, v215
v_mfma_f32_16x16x32_bf16 v[20:23], a[208:211], v[182:185], v[20:23]
ds_read_b128 v[182:185], v210 offset:50176
s_waitcnt lgkmcnt(8)
v_mfma_f32_16x16x32_bf16 v[12:15], a[164:167], v[186:189], v[12:15]
ds_read_b64 v[112:113], v215 offset:528
v_mfma_f32_16x16x32_bf16 v[16:19], a[188:191], v[186:189], v[16:19]
s_waitcnt lgkmcnt(8)
v_mfma_f32_16x16x32_bf16 v[20:23], a[212:215], v[186:189], v[20:23]
s_mov_b32 s39, s37
ds_read_b128 v[186:189], v210 offset:51200
v_cvt_pk_bf16_f32 v78, v12, v13
v_mfma_f32_16x16x32_bf16 v[0:3], v[174:177], v[84:87], 0
s_waitcnt lgkmcnt(8)
ds_read_b128 v[84:87], v194
v_cvt_pk_bf16_f32 v79, v14, v15
v_mfma_f32_16x16x32_bf16 v[12:15], v[174:177], v[92:95], 0
s_waitcnt lgkmcnt(7)
ds_read_b128 v[92:95], v195
v_cvt_pk_bf16_f32 v80, v16, v17
v_mfma_f32_16x16x32_bf16 v[24:27], a[144:147], v[170:173], v[24:27]
v_cvt_pk_bf16_f32 v81, v18, v19
v_cvt_pk_bf16_f32 v82, v20, v21
v_mfma_f32_16x16x32_bf16 v[28:31], a[168:171], v[170:173], v[28:31]
v_cvt_pk_bf16_f32 v83, v22, v23
v_mfma_f32_16x16x32_bf16 v[32:35], a[192:195], v[170:173], v[32:35]
ds_read_b128 v[170:173], v210 offset:52224
s_waitcnt lgkmcnt(5)
v_mfma_f32_16x16x32_bf16 v[24:27], a[148:151], v[182:185], v[24:27]
buffer_store_dwordx2 v[76:77], v203, s[8:11], s38 offen offset:64
v_mfma_f32_16x16x32_bf16 v[28:31], a[172:175], v[182:185], v[28:31]
v_mfma_f32_16x16x32_bf16 v[32:35], a[196:199], v[182:185], v[32:35]
ds_read_b128 v[182:185], v210 offset:53248
s_waitcnt lgkmcnt(4)
v_mfma_f32_16x16x32_bf16 v[24:27], a[152:155], v[186:189], v[24:27]
v_mfma_f32_16x16x32_bf16 v[28:31], a[176:179], v[186:189], v[28:31]
v_mfma_f32_16x16x32_bf16 v[32:35], a[200:203], v[186:189], v[32:35]
ds_read_b128 v[186:189], v210 offset:54272
s_waitcnt lgkmcnt(2)
v_mfma_f32_16x16x32_bf16 v[24:27], a[156:159], v[170:173], v[24:27]
v_mfma_f32_16x16x32_bf16 v[28:31], a[180:183], v[170:173], v[28:31]
v_mfma_f32_16x16x32_bf16 v[32:35], a[204:207], v[170:173], v[32:35]
s_waitcnt lgkmcnt(1)
v_mfma_f32_16x16x32_bf16 v[24:27], a[160:163], v[182:185], v[24:27]
v_mfma_f32_16x16x32_bf16 v[28:31], a[184:187], v[182:185], v[28:31]
v_mfma_f32_16x16x32_bf16 v[32:35], a[208:211], v[182:185], v[32:35]
ds_read_b128 v[182:185], v210 offset:18432
s_waitcnt lgkmcnt(1)
v_mfma_f32_16x16x32_bf16 v[24:27], a[164:167], v[186:189], v[24:27]
v_smfmac_f32_16x16x64_bf16 v[0:3], v[178:181], v[84:91], v213
ds_read_b128 v[84:87], v197
ds_read_b128 v[88:91], v197 offset:16
v_mfma_f32_16x16x32_bf16 v[28:31], a[188:191], v[186:189], v[28:31]
v_cvt_pk_bf16_f32 v116, v24, v25
v_cvt_pk_bf16_f32 v117, v26, v27
v_mfma_f32_16x16x32_bf16 v[24:27], v[174:177], v[100:103], 0
ds_read_b128 v[100:103], v196
ds_read_b128 v[174:177], v217 offset:1056
v_mfma_f32_16x16x32_bf16 v[32:35], a[212:215], v[186:189], v[32:35]
v_cvt_pk_bf16_f32 v124, v28, v29
v_cvt_pk_bf16_f32 v125, v30, v31
v_smfmac_f32_16x16x64_bf16 v[12:15], v[178:181], v[92:99], v213
s_waitcnt lgkmcnt(4)
ds_read_b128 v[92:95], v198
ds_read_b128 v[96:99], v198 offset:16
v_mfma_f32_16x16x32_bf16 v[138:141], a[0:3], v[182:185], 0
ds_read_b128 v[186:189], v210 offset:19456
v_cvt_pk_bf16_f32 v132, v32, v33
v_mfma_f32_16x16x32_bf16 v[142:145], a[24:27], v[182:185], 0
v_cvt_pk_bf16_f32 v133, v34, v35
v_mfma_f32_16x16x32_bf16 v[146:149], a[48:51], v[182:185], 0
buffer_store_dwordx2 v[78:79], v204, s[8:11], s38 offen
s_waitcnt lgkmcnt(4)
v_smfmac_f32_16x16x64_bf16 v[24:27], v[178:181], v[100:107], v213
s_waitcnt lgkmcnt(3)
ds_read_b128 v[100:103], v199
ds_read_b128 v[104:107], v199 offset:16
v_smfmac_f32_16x16x64_bf16 v[0:3], v[174:177], v[84:91], v213
ds_read_b128 v[84:87], v200 offset:32
ds_read_b128 v[178:181], v217 offset:1584
v_mfma_f32_16x16x32_bf16 v[150:153], a[216:219], v[182:185], 0
ds_read_b128 v[88:91], v194 offset:48
s_waitcnt lgkmcnt(6)
v_smfmac_f32_16x16x64_bf16 v[12:15], v[174:177], v[92:99], v213
ds_read_b128 v[92:95], v201 offset:32
ds_read_b128 v[96:99], v195 offset:48
v_mfma_f32_16x16x32_bf16 v[154:157], a[240:243], v[182:185], 0
v_mul_f32 v119, v0, v0
v_add_f32 v118, v0, v1
v_mfma_f32_16x16x32_bf16 v[158:161], v[232:235], v[182:185], 0
v_mul_f32 v127, v12, v12
v_add_f32 v126, v12, v13
v_mfma_f32_16x16x32_bf16 v[162:165], v[182:185], a[72:75], 0
v_fmac_f32 v119, v1, v1
v_fmac_f32 v127, v13, v13
v_mfma_f32_16x16x32_bf16 v[166:169], v[182:185], a[96:99], 0
s_waitcnt lgkmcnt(5)
v_add_f32 v118, v118, v2
v_add_f32 v126, v126, v14
v_smfmac_f32_16x16x64_bf16 v[24:27], v[174:177], v[100:107], v213
ds_read_b128 v[100:103], v202 offset:32
ds_read_b128 v[174:177], v217 offset:2112
v_mfma_f32_16x16x32_bf16 v[170:173], v[182:185], a[120:123], 0
s_waitcnt lgkmcnt(5)
ds_read_b128 v[104:107], v196 offset:48
ds_read_b128 v[182:185], v210 offset:20480
v_mfma_f32_16x16x32_bf16 v[4:7], v[178:181], v[84:87], 0
ds_read_b128 v[84:87], v194 offset:32
v_mul_f32 v135, v24, v24
v_mfma_f32_16x16x32_bf16 v[138:141], a[4:7], v[186:189], v[138:141]
s_waitcnt lgkmcnt(6)
buffer_store_dwordx2 v[80:81], v204, s[8:11], s38 offen offset:32
v_add_f32 v134, v24, v25
v_mfma_f32_16x16x32_bf16 v[16:19], v[178:181], v[92:95], 0
ds_read_b128 v[92:95], v195 offset:32
v_fmac_f32 v135, v25, v25
v_mfma_f32_16x16x32_bf16 v[142:145], a[28:31], v[186:189], v[142:145]
s_waitcnt lgkmcnt(5)
v_add_f32 v134, v134, v26
v_fmac_f32 v135, v26, v26
v_mfma_f32_16x16x32_bf16 v[28:31], v[178:181], v[100:103], 0
ds_read_b128 v[100:103], v196 offset:32
ds_read_b128 v[178:181], v217 offset:2640
v_mfma_f32_16x16x32_bf16 v[146:149], a[52:55], v[186:189], v[146:149]
v_fmac_f32 v119, v2, v2
v_fmac_f32 v127, v14, v14
v_mfma_f32_16x16x32_bf16 v[150:153], a[220:223], v[186:189], v[150:153]
v_add_f32 v134, v134, v27
v_fmac_f32 v135, v27, v27
v_mfma_f32_16x16x32_bf16 v[154:157], a[244:247], v[186:189], v[154:157]
s_waitcnt lgkmcnt(3)
v_add_f32 v118, v118, v3
v_add_f32 v126, v126, v15
v_smfmac_f32_16x16x64_bf16 v[4:7], v[174:177], v[84:91], v213
s_waitcnt lgkmcnt(2)
ds_read_b128 v[84:87], v197 offset:32
ds_read_b128 v[88:91], v197 offset:48
v_smfmac_f32_16x16x64_bf16 v[16:19], v[174:177], v[92:99], v213
ds_read_b128 v[92:95], v198 offset:32
ds_read_b128 v[96:99], v198 offset:48
v_mfma_f32_16x16x32_bf16 v[158:161], v[236:239], v[186:189], v[158:161]
s_waitcnt lgkmcnt(5)
v_fmac_f32 v119, v3, v3
v_fmac_f32 v127, v15, v15
v_smfmac_f32_16x16x64_bf16 v[28:31], v[174:177], v[100:107], v213
ds_read_b128 v[100:103], v199 offset:32
ds_read_b128 v[104:107], v199 offset:48
v_mfma_f32_16x16x32_bf16 v[162:165], v[186:189], a[76:79], v[162:165]
ds_read_b128 v[174:177], v217 offset:3168
v_mfma_f32_16x16x32_bf16 v[166:169], v[186:189], a[100:103], v[166:169]
v_mfma_f32_16x16x32_bf16 v[170:173], v[186:189], a[124:127], v[170:173]
ds_read_b128 v[186:189], v210 offset:21504
s_waitcnt lgkmcnt(6)
v_smfmac_f32_16x16x64_bf16 v[4:7], v[178:181], v[84:91], v213
ds_read_b128 v[84:87], v200 offset:64
ds_read_b128 v[88:91], v194 offset:80
v_mfma_f32_16x16x32_bf16 v[138:141], a[8:11], v[182:185], v[138:141]
s_waitcnt lgkmcnt(6)
buffer_store_dwordx2 v[82:83], v204, s[8:11], s38 offen offset:64
s_nop 1
v_add_f32 v118, v118, v4
v_smfmac_f32_16x16x64_bf16 v[16:19], v[178:181], v[92:99], v213
ds_read_b128 v[92:95], v201 offset:64
ds_read_b128 v[96:99], v195 offset:80
v_mfma_f32_16x16x32_bf16 v[142:145], a[32:35], v[182:185], v[142:145]
s_waitcnt lgkmcnt(6)
v_fmac_f32 v119, v4, v4
v_add_f32 v118, v118, v5
v_smfmac_f32_16x16x64_bf16 v[28:31], v[178:181], v[100:107], v213
ds_read_b128 v[100:103], v202 offset:64
ds_read_b128 v[178:181], v217 offset:3696
v_mfma_f32_16x16x32_bf16 v[146:149], a[56:59], v[182:185], v[146:149]
ds_read_b128 v[104:107], v196 offset:80
v_add_f32 v126, v126, v16
v_mfma_f32_16x16x32_bf16 v[150:153], a[224:227], v[182:185], v[150:153]
s_waitcnt lgkmcnt(6)
v_add_f32 v134, v134, v28
v_fmac_f32 v135, v28, v28
v_mfma_f32_16x16x32_bf16 v[8:11], v[174:177], v[84:87], 0
ds_read_b128 v[84:87], v194 offset:64
v_fmac_f32 v127, v16, v16
v_mfma_f32_16x16x32_bf16 v[154:157], a[248:251], v[182:185], v[154:157]
s_waitcnt lgkmcnt(5)
v_add_f32 v134, v134, v29
v_fmac_f32 v135, v29, v29
v_mfma_f32_16x16x32_bf16 v[20:23], v[174:177], v[92:95], 0
ds_read_b128 v[92:95], v195 offset:64
v_fmac_f32 v119, v5, v5
v_mfma_f32_16x16x32_bf16 v[158:161], v[240:243], v[182:185], v[158:161]
s_waitcnt lgkmcnt(4)
v_add_f32 v126, v126, v17
v_fmac_f32 v127, v17, v17
v_mfma_f32_16x16x32_bf16 v[32:35], v[174:177], v[100:103], 0
ds_read_b128 v[100:103], v196 offset:64
ds_read_b128 v[174:177], v217 offset:4224
v_mfma_f32_16x16x32_bf16 v[162:165], v[182:185], a[80:83], v[162:165]
v_add_f32 v134, v134, v30
v_fmac_f32 v135, v30, v30
v_mfma_f32_16x16x32_bf16 v[166:169], v[182:185], a[104:107], v[166:169]
s_waitcnt lgkmcnt(3)
v_add_f32 v118, v118, v6
v_fmac_f32 v119, v6, v6
v_smfmac_f32_16x16x64_bf16 v[8:11], v[178:181], v[84:91], v213
ds_read_b128 v[84:87], v197 offset:64
ds_read_b128 v[88:91], v197 offset:80
v_mfma_f32_16x16x32_bf16 v[170:173], v[182:185], a[128:131], v[170:173]
s_waitcnt lgkmcnt(4)
ds_read_b128 v[182:185], v210 offset:22528
v_add_f32 v126, v126, v18
v_smfmac_f32_16x16x64_bf16 v[20:23], v[178:181], v[92:99], v213
ds_read_b128 v[92:95], v198 offset:64
ds_read_b128 v[96:99], v198 offset:80
v_mfma_f32_16x16x32_bf16 v[138:141], a[12:15], v[186:189], v[138:141]
s_waitcnt lgkmcnt(6)
v_fmac_f32 v127, v18, v18
v_add_f32 v134, v134, v31
v_smfmac_f32_16x16x64_bf16 v[32:35], v[178:181], v[100:107], v213
ds_read_b128 v[100:103], v199 offset:64
ds_read_b128 v[104:107], v199 offset:80
v_mfma_f32_16x16x32_bf16 v[142:145], a[36:39], v[186:189], v[142:145]
v_fmac_f32 v135, v31, v31
v_add_f32 v118, v118, v7
v_mfma_f32_16x16x32_bf16 v[146:149], a[60:63], v[186:189], v[146:149]
v_fmac_f32 v119, v7, v7
v_add_f32 v126, v126, v19
v_mfma_f32_16x16x32_bf16 v[150:153], a[228:231], v[186:189], v[150:153]
v_fmac_f32 v127, v19, v19
s_waitcnt lgkmcnt(5)
v_smfmac_f32_16x16x64_bf16 v[8:11], v[174:177], v[84:91], v213
buffer_store_dwordx2 v[116:117], v205, s[8:11], s38 offen
v_add_u32 v216, 1408, v216
v_mfma_f32_16x16x32_bf16 v[154:157], a[252:255], v[186:189], v[154:157]
v_mov_b32 v181, 0
s_waitcnt lgkmcnt(2)
v_smfmac_f32_16x16x64_bf16 v[20:23], v[174:177], v[92:99], v213
v_add_f32 v118, v118, v8
v_fmac_f32 v119, v8, v8
v_mfma_f32_16x16x32_bf16 v[158:161], v[244:247], v[186:189], v[158:161]
s_waitcnt lgkmcnt(0)
v_add_f32 v118, v118, v9
v_fmac_f32 v119, v9, v9
v_smfmac_f32_16x16x64_bf16 v[32:35], v[174:177], v[100:107], v213
v_add_f32 v126, v126, v20
v_fmac_f32 v127, v20, v20
v_mfma_f32_16x16x32_bf16 v[162:165], v[186:189], a[84:87], v[162:165]
v_add_f32 v126, v126, v21
v_fmac_f32 v127, v21, v21
v_mfma_f32_16x16x32_bf16 v[166:169], v[186:189], a[108:111], v[166:169]
v_add_f32 v134, v134, v32
v_fmac_f32 v135, v32, v32
v_mfma_f32_16x16x32_bf16 v[170:173], v[186:189], a[132:135], v[170:173]
ds_read_b128 v[186:189], v210 offset:23552
v_add_f32 v134, v134, v33
v_mfma_f32_16x16x32_bf16 v[138:141], a[16:19], v[182:185], v[138:141]
v_fmac_f32 v135, v33, v33
v_add_f32 v134, v134, v34
v_mfma_f32_16x16x32_bf16 v[142:145], a[40:43], v[182:185], v[142:145]
v_fmac_f32 v135, v34, v34
v_add_f32 v118, v118, v10
v_mfma_f32_16x16x32_bf16 v[146:149], a[64:67], v[182:185], v[146:149]
v_fmac_f32 v119, v10, v10
v_add_f32 v126, v126, v22
v_mfma_f32_16x16x32_bf16 v[150:153], a[232:235], v[182:185], v[150:153]
v_fmac_f32 v127, v22, v22
v_add_f32 v134, v134, v35
v_mfma_f32_16x16x32_bf16 v[154:157], v[224:227], v[182:185], v[154:157]
v_fmac_f32 v135, v35, v35
v_add_f32 v118, v118, v11
v_mfma_f32_16x16x32_bf16 v[158:161], v[248:251], v[182:185], v[158:161]
v_fmac_f32 v119, v11, v11
v_add_f32 v126, v126, v23
v_mfma_f32_16x16x32_bf16 v[162:165], v[182:185], a[88:91], v[162:165]
v_fmac_f32 v127, v23, v23
v_add_u32 v214, 1408, v214
v_mfma_f32_16x16x32_bf16 v[166:169], v[182:185], a[112:115], v[166:169]
v_permlane16_swap_b32 v134, v135
v_mfma_f32_16x16x32_bf16 v[170:173], v[182:185], a[136:139], v[170:173]
s_waitcnt lgkmcnt(0)
ds_read_b128 v[182:185], v210 offset:24576
v_add_f32 v134, v134, v135
v_mfma_f32_16x16x32_bf16 v[138:141], a[20:23], v[186:189], v[138:141]
v_permlane16_swap_b32 v118, v119
v_mfma_f32_16x16x32_bf16 v[142:145], a[44:47], v[186:189], v[142:145]
v_permlane16_swap_b32 v126, v127
v_mfma_f32_16x16x32_bf16 v[146:149], a[68:71], v[186:189], v[146:149]
v_cvt_pk_bf16_f32 v78, v138, v139
v_cvt_pk_bf16_f32 v79, v140, v141
v_mfma_f32_16x16x32_bf16 v[150:153], a[236:239], v[186:189], v[150:153]
v_cvt_pk_bf16_f32 v80, v142, v143
v_cvt_pk_bf16_f32 v81, v144, v145
v_mfma_f32_16x16x32_bf16 v[154:157], v[228:231], v[186:189], v[154:157]
v_cvt_pk_bf16_f32 v82, v146, v147
v_cvt_pk_bf16_f32 v83, v148, v149
v_mfma_f32_16x16x32_bf16 v[158:161], v[252:255], v[186:189], v[158:161]
v_cvt_pk_bf16_f32 v72, v150, v151
v_cvt_pk_bf16_f32 v73, v152, v153
v_mfma_f32_16x16x32_bf16 v[162:165], v[186:189], a[92:95], v[162:165]
v_cvt_pk_bf16_f32 v74, v154, v155
v_cvt_pk_bf16_f32 v75, v156, v157
v_mfma_f32_16x16x32_bf16 v[166:169], v[186:189], a[116:119], v[166:169]
v_cvt_pk_bf16_f32 v76, v158, v159
v_cvt_pk_bf16_f32 v77, v160, v161
v_mfma_f32_16x16x32_bf16 v[170:173], v[186:189], a[140:143], v[170:173]
s_waitcnt lgkmcnt(0)
ds_read_b128 v[186:189], v210 offset:25600
v_cvt_pk_bf16_f32 v114, v162, v163
v_mfma_f32_16x16x32_bf16 v[138:141], a[0:3], v[182:185], 0
v_cvt_pk_bf16_f32 v115, v164, v165
v_cvt_pk_bf16_f32 v122, v166, v167
v_mfma_f32_16x16x32_bf16 v[142:145], a[24:27], v[182:185], 0
v_cvt_pk_bf16_f32 v123, v168, v169
v_cvt_pk_bf16_f32 v130, v170, v171
v_mfma_f32_16x16x32_bf16 v[146:149], a[48:51], v[182:185], 0
v_cvt_pk_bf16_f32 v131, v172, v173
v_mov_b32 v135, v134
v_mfma_f32_16x16x32_bf16 v[150:153], a[216:219], v[182:185], 0
v_add_f32 v118, v118, v119
v_add_f32 v126, v126, v127
v_mfma_f32_16x16x32_bf16 v[154:157], a[240:243], v[182:185], 0
v_permlane32_swap_b32 v134, v135
v_mfma_f32_16x16x32_bf16 v[158:161], v[232:235], v[182:185], 0
v_permlane32_swap_b32 v118, v126
v_mfma_f32_16x16x32_bf16 v[162:165], v[182:185], a[72:75], 0
v_add_f32 v134, v134, v135
v_add_f32 v118, v118, v126
v_mfma_f32_16x16x32_bf16 v[166:169], v[182:185], a[96:99], 0
ds_write_b32 v209, v134 offset:512
v_mfma_f32_16x16x32_bf16 v[170:173], v[182:185], a[120:123], 0
s_waitcnt lgkmcnt(1)
ds_read_b128 v[182:185], v210 offset:26624
ds_write_b32 v209, v118
v_mfma_f32_16x16x32_bf16 v[138:141], a[4:7], v[186:189], v[138:141]
buffer_store_dwordx2 v[124:125], v205, s[8:11], s38 offen offset:32
v_mfma_f32_16x16x32_bf16 v[142:145], a[28:31], v[186:189], v[142:145]
v_mfma_f32_16x16x32_bf16 v[146:149], a[52:55], v[186:189], v[146:149]
v_mfma_f32_16x16x32_bf16 v[150:153], a[220:223], v[186:189], v[150:153]
v_mfma_f32_16x16x32_bf16 v[154:157], a[244:247], v[186:189], v[154:157]
v_mfma_f32_16x16x32_bf16 v[158:161], v[236:239], v[186:189], v[158:161]
s_waitcnt lgkmcnt(0)
s_barrier
v_mfma_f32_16x16x32_bf16 v[162:165], v[186:189], a[76:79], v[162:165]
ds_read_b128 v[106:109], v210 offset:56320
ds_read_b128 v[102:105], v210 offset:55296
v_mfma_f32_16x16x32_bf16 v[166:169], v[186:189], a[100:103], v[166:169]
v_mfma_f32_16x16x32_bf16 v[170:173], v[186:189], a[124:127], v[170:173]
ds_read_b128 v[186:189], v210 offset:27648
v_mfma_f32_16x16x32_bf16 v[138:141], a[8:11], v[182:185], v[138:141]
v_mfma_f32_16x16x32_bf16 v[142:145], a[32:35], v[182:185], v[142:145]
v_mfma_f32_16x16x32_bf16 v[146:149], a[56:59], v[182:185], v[146:149]
v_mfma_f32_16x16x32_bf16 v[150:153], a[224:227], v[182:185], v[150:153]
s_waitcnt lgkmcnt(2)
v_add_f32 v106, v106, v107
v_add_f32 v108, v108, v109
v_mfma_f32_16x16x32_bf16 v[154:157], a[248:251], v[182:185], v[154:157]
s_waitcnt lgkmcnt(1)
v_add_f32 v106, v106, v108
v_add_f32 v102, v102, v103
v_mfma_f32_16x16x32_bf16 v[158:161], v[240:243], v[182:185], v[158:161]
ds_read_b128 v[108:111], v215 offset:512
v_add_f32 v104, v104, v105
v_mfma_f32_16x16x32_bf16 v[162:165], v[182:185], a[80:83], v[162:165]
v_add_f32 v102, v102, v104
v_mul_f32 v106, s73, v106
v_mfma_f32_16x16x32_bf16 v[166:169], v[182:185], a[104:107], v[166:169]
v_mul_f32 v103, s48, v102
v_mul_f32 v104, s73, v102
v_mfma_f32_16x16x32_bf16 v[170:173], v[182:185], a[128:131], v[170:173]
s_waitcnt lgkmcnt(1)
ds_read_b128 v[182:185], v210 offset:28672
v_fma_f32 v106, -v103, v104, v106
v_mfma_f32_16x16x32_bf16 v[138:141], a[12:15], v[186:189], v[138:141]
v_max_f32 v106, 0, v106
v_add_f32 v106, s49, v106
v_mfma_f32_16x16x32_bf16 v[142:145], a[36:39], v[186:189], v[142:145]
v_rsq_f32 v102, v106
v_mfma_f32_16x16x32_bf16 v[146:149], a[60:63], v[186:189], v[146:149]
v_mul_f32_e64 v103, -v103, v102
v_mfma_f32_16x16x32_bf16 v[150:153], a[228:231], v[186:189], v[150:153]
ds_write_b64 v211, v[102:103] offset:36864
v_mfma_f32_16x16x32_bf16 v[154:157], a[252:255], v[186:189], v[154:157]
v_mfma_f32_16x16x32_bf16 v[158:161], v[244:247], v[186:189], v[158:161]
ds_read_b64 v[118:119], v219
ds_read_b64 v[126:127], v219 offset:256
v_mfma_f32_16x16x32_bf16 v[162:165], v[186:189], a[84:87], v[162:165]
ds_read_b64 v[134:135], v219 offset:512
v_mfma_f32_16x16x32_bf16 v[166:169], v[186:189], a[108:111], v[166:169]
v_mfma_f32_16x16x32_bf16 v[170:173], v[186:189], a[132:135], v[170:173]
ds_read_b128 v[186:189], v210 offset:29696
s_waitcnt lgkmcnt(5)
v_mfma_f32_16x16x32_bf16 v[138:141], a[16:19], v[182:185], v[138:141]
v_mfma_f32_16x16x32_bf16 v[142:145], a[40:43], v[182:185], v[142:145]
s_waitcnt lgkmcnt(3)
v_fma_f32 v220, v0, v118, v119
v_fma_f32 v221, v1, v118, v119
v_mfma_f32_16x16x32_bf16 v[146:149], a[64:67], v[182:185], v[146:149]
v_fma_f32 v222, v2, v118, v119
v_fma_f32 v223, v3, v118, v119
v_mfma_f32_16x16x32_bf16 v[150:153], a[232:235], v[182:185], v[150:153]
v_cvt_pk_bf16_f32 v90, v220, v221
v_cvt_pk_bf16_f32 v91, v222, v223
v_mfma_f32_16x16x32_bf16 v[154:157], v[224:227], v[182:185], v[154:157]
v_fma_f32 v220, v4, v118, v119
v_fma_f32 v221, v5, v118, v119
v_mfma_f32_16x16x32_bf16 v[158:161], v[248:251], v[182:185], v[158:161]
v_fma_f32 v222, v6, v118, v119
v_fma_f32 v223, v7, v118, v119
v_mfma_f32_16x16x32_bf16 v[162:165], v[182:185], a[88:91], v[162:165]
v_cvt_pk_bf16_f32 v92, v220, v221
v_cvt_pk_bf16_f32 v93, v222, v223
v_mfma_f32_16x16x32_bf16 v[166:169], v[182:185], a[112:115], v[166:169]
ds_write_b128 v211, v[90:93]
v_mfma_f32_16x16x32_bf16 v[170:173], v[182:185], a[136:139], v[170:173]
s_waitcnt lgkmcnt(1)
v_fma_f32 v220, v8, v118, v119
v_fma_f32 v221, v9, v118, v119
v_mfma_f32_16x16x32_bf16 v[138:141], a[20:23], v[186:189], v[138:141]
buffer_store_dwordx2 v[132:133], v205, s[8:11], s38 offen offset:64
ds_read_b128 v[182:185], v210 offset:30720
v_mfma_f32_16x16x32_bf16 v[142:145], a[44:47], v[186:189], v[142:145]
v_fma_f32 v222, v10, v118, v119
v_fma_f32 v223, v11, v118, v119
v_mfma_f32_16x16x32_bf16 v[146:149], a[68:71], v[186:189], v[146:149]
v_cvt_pk_bf16_f32 v96, v138, v139
v_cvt_pk_bf16_f32 v97, v140, v141
v_mfma_f32_16x16x32_bf16 v[150:153], a[236:239], v[186:189], v[150:153]
v_cvt_pk_bf16_f32 v98, v142, v143
v_cvt_pk_bf16_f32 v99, v144, v145
v_mfma_f32_16x16x32_bf16 v[154:157], v[228:231], v[186:189], v[154:157]
v_cvt_pk_bf16_f32 v100, v146, v147
v_cvt_pk_bf16_f32 v101, v148, v149
v_mfma_f32_16x16x32_bf16 v[158:161], v[252:255], v[186:189], v[158:161]
v_cvt_pk_bf16_f32 v84, v150, v151
v_cvt_pk_bf16_f32 v85, v152, v153
v_mfma_f32_16x16x32_bf16 v[162:165], v[186:189], a[92:95], v[162:165]
v_cvt_pk_bf16_f32 v86, v154, v155
v_cvt_pk_bf16_f32 v87, v156, v157
v_mfma_f32_16x16x32_bf16 v[166:169], v[186:189], a[116:119], v[166:169]
v_cvt_pk_bf16_f32 v88, v158, v159
v_cvt_pk_bf16_f32 v89, v160, v161
v_mfma_f32_16x16x32_bf16 v[170:173], v[186:189], a[140:143], v[170:173]
s_waitcnt lgkmcnt(0)
ds_read_b128 v[186:189], v210 offset:31744
v_cvt_pk_bf16_f32 v116, v162, v163
v_mfma_f32_16x16x32_bf16 v[138:141], a[0:3], v[182:185], 0
v_cvt_pk_bf16_f32 v124, v166, v167
v_cvt_pk_bf16_f32 v125, v168, v169
v_mfma_f32_16x16x32_bf16 v[142:145], a[24:27], v[182:185], 0
v_cvt_pk_bf16_f32 v117, v164, v165
v_cvt_pk_bf16_f32 v94, v220, v221
v_mfma_f32_16x16x32_bf16 v[150:153], v[108:111], v[72:75], v[206:209]
v_cvt_pk_bf16_f32 v95, v222, v223
v_fma_f32 v220, v12, v126, v127
v_mfma_f32_16x16x32_bf16 v[146:149], a[48:51], v[182:185], 0
ds_read_b128 v[182:185], v210 offset:32768
ds_write_b64 v212, v[94:95]
v_mfma_f32_16x16x16_bf16 v[150:153], v[112:113], v[76:77], v[150:153]
s_waitcnt lgkmcnt(2)
v_fma_f32 v221, v13, v126, v127
v_fma_f32 v222, v14, v126, v127
v_mfma_f32_16x16x32_bf16 v[138:141], a[4:7], v[186:189], v[138:141]
v_fma_f32 v223, v15, v126, v127
v_cvt_pk_bf16_f32 v174, v220, v221
v_mfma_f32_16x16x32_bf16 v[142:145], a[28:31], v[186:189], v[142:145]
v_cvt_pk_bf16_f32 v175, v222, v223
v_fma_f32 v220, v16, v126, v127
v_mfma_f32_16x16x32_bf16 v[146:149], a[52:55], v[186:189], v[146:149]
ds_read_b128 v[186:189], v210 offset:33792
v_fma_f32 v221, v17, v126, v127
v_mfma_f32_16x16x32_bf16 v[154:157], v[78:81], v[84:87], 0
s_waitcnt lgkmcnt(2)
v_fma_f32 v222, v18, v126, v127
v_fma_f32 v223, v19, v126, v127
v_mfma_f32_16x16x32_bf16 v[138:141], a[8:11], v[182:185], v[138:141]
v_cvt_pk_bf16_f32 v176, v220, v221
v_cvt_pk_bf16_f32 v177, v222, v223
v_mfma_f32_16x16x32_bf16 v[142:145], a[32:35], v[182:185], v[142:145]
v_fma_f32 v220, v20, v126, v127
v_fma_f32 v221, v21, v126, v127
v_mfma_f32_16x16x32_bf16 v[158:161], v[96:99], v[84:87], 0
v_fma_f32 v222, v22, v126, v127
v_fma_f32 v223, v23, v126, v127
v_mfma_f32_16x16x32_bf16 v[146:149], a[56:59], v[182:185], v[146:149]
ds_read_b128 v[182:185], v210 offset:34816
v_cvt_pk_bf16_f32 v178, v220, v221
v_mfma_f32_16x16x32_bf16 v[166:169], v[108:111], v[84:87], v[206:209]
s_waitcnt lgkmcnt(1)
v_cvt_pk_bf16_f32 v179, v222, v223
v_fma_f32 v220, v24, v134, v135
v_mfma_f32_16x16x32_bf16 v[138:141], a[12:15], v[186:189], v[138:141]
v_fma_f32 v221, v25, v134, v135
v_fma_f32 v222, v26, v134, v135
v_mfma_f32_16x16x32_bf16 v[142:145], a[36:39], v[186:189], v[142:145]
v_fma_f32 v223, v27, v134, v135
v_cvt_pk_bf16_f32 v90, v220, v221
v_mfma_f32_16x16x32_bf16 v[146:149], a[60:63], v[186:189], v[146:149]
ds_read_b128 v[186:189], v210 offset:35840
v_cvt_pk_bf16_f32 v91, v222, v223
v_mfma_f32_16x16x16_bf16 v[154:157], v[82:83], v[88:89], v[154:157]
v_fma_f32 v220, v28, v134, v135
v_fma_f32 v221, v29, v134, v135
v_mfma_f32_16x16x16_bf16 v[158:161], v[100:101], v[88:89], v[158:161]
s_waitcnt lgkmcnt(1)
v_fma_f32 v222, v30, v134, v135
v_fma_f32 v223, v31, v134, v135
v_mfma_f32_16x16x32_bf16 v[138:141], a[16:19], v[182:185], v[138:141]
v_cvt_pk_bf16_f32 v92, v220, v221
v_cvt_pk_bf16_f32 v93, v222, v223
v_mfma_f32_16x16x32_bf16 v[142:145], a[40:43], v[182:185], v[142:145]
ds_write_b128 v211, v[90:93] offset:12288
v_mfma_f32_16x16x16_bf16 v[166:169], v[112:113], v[88:89], v[166:169]
v_fma_f32 v220, v32, v134, v135
v_fma_f32 v221, v33, v134, v135
v_mfma_f32_16x16x32_bf16 v[146:149], a[64:67], v[182:185], v[146:149]
s_waitcnt lgkmcnt(1)
v_fma_f32 v222, v34, v134, v135
v_fma_f32 v223, v35, v134, v135
v_mfma_f32_16x16x32_bf16 v[138:141], a[20:23], v[186:189], v[138:141]
ds_read_b128 v[182:185], v210 offset:30720
v_cvt_pk_bf16_f32 v132, v170, v171
v_mfma_f32_16x16x32_bf16 v[142:145], a[44:47], v[186:189], v[142:145]
v_cvt_pk_bf16_f32 v133, v172, v173
v_cvt_pk_bf16_f32 v94, v220, v221
v_mfma_f32_16x16x32_bf16 v[146:149], a[68:71], v[186:189], v[146:149]
v_cvt_pk_bf16_f32 v102, v138, v139
v_cvt_pk_bf16_f32 v103, v140, v141
v_mfma_f32_16x16x32_bf16 v[138:141], v[78:81], v[72:75], 0
v_cvt_pk_bf16_f32 v104, v142, v143
v_cvt_pk_bf16_f32 v105, v144, v145
v_mfma_f32_16x16x32_bf16 v[142:145], v[96:99], v[72:75], 0
v_cvt_pk_bf16_f32 v106, v146, v147
v_cvt_pk_bf16_f32 v107, v148, v149
v_mfma_f32_16x16x32_bf16 v[146:149], v[102:105], v[72:75], 0
ds_read_b128 v[186:189], v210 offset:31744
v_cvt_pk_bf16_f32 v95, v222, v223
v_mfma_f32_16x16x16_bf16 v[138:141], v[82:83], v[76:77], v[138:141]
v_mfma_f32_16x16x16_bf16 v[142:145], v[100:101], v[76:77], v[142:145]
ds_write_b128 v211, v[174:177] offset:6144
v_mfma_f32_16x16x16_bf16 v[146:149], v[106:107], v[76:77], v[146:149]
v_exp_f32 v138, v138
v_mfma_f32_16x16x32_bf16 v[162:165], v[102:105], v[84:87], 0
s_waitcnt lgkmcnt(2)
v_exp_f32 v139, v139
v_mfma_f32_16x16x32_bf16 v[118:121], v[182:185], a[72:75], 0
v_exp_f32 v140, v140
v_mfma_f32_16x16x16_bf16 v[162:165], v[106:107], v[88:89], v[162:165]
v_exp_f32 v141, v141
v_mfma_f32_16x16x32_bf16 v[126:129], v[182:185], a[96:99], 0
v_exp_f32 v142, v142
v_mfma_f32_16x16x32_bf16 v[134:137], v[182:185], a[120:123], 0
v_exp_f32 v143, v143
v_mfma_f32_16x16x32_bf16 v[90:93], a[216:219], v[182:185], 0
v_exp_f32 v144, v144
v_mfma_f32_16x16x32_bf16 v[170:173], a[240:243], v[182:185], 0
v_exp_f32 v145, v145
v_mfma_f32_16x16x32_bf16 v[220:223], v[232:235], v[182:185], 0
s_waitcnt lgkmcnt(1)
ds_read_b128 v[182:185], v210 offset:32768
v_cvt_pk_bf16_f32 v174, v138, v139
v_mfma_f32_16x16x32_bf16 v[118:121], v[186:189], a[76:79], v[118:121]
v_exp_f32 v150, v150
v_mfma_f32_16x16x32_bf16 v[126:129], v[186:189], a[100:103], v[126:129]
v_cvt_pk_bf16_f32 v175, v140, v141
v_cvt_pk_bf16_f32 v176, v142, v143
v_mfma_f32_16x16x32_bf16 v[134:137], v[186:189], a[124:127], v[134:137]
v_cvt_pk_bf16_f32 v177, v144, v145
v_cvt_pk_bf16_f32 v180, v150, 0
v_mfma_f32_16x16x32_bf16 v[90:93], a[220:223], v[186:189], v[90:93]
ds_write_b64 v212, v[178:179] offset:6144
v_mfma_f32_16x16x32_bf16 v[170:173], a[244:247], v[186:189], v[170:173]
v_exp_f32 v146, v146
v_mfma_f32_16x16x32_bf16 v[220:223], v[236:239], v[186:189], v[220:223]
s_waitcnt lgkmcnt(1)
ds_read_b128 v[186:189], v210 offset:33792
ds_read_b128 v[72:75], v215
v_mfma_f32_16x16x32_bf16 v[118:121], v[182:185], a[80:83], v[118:121]
v_exp_f32 v147, v147
v_mfma_f32_16x16x32_bf16 v[126:129], v[182:185], a[104:107], v[126:129]
v_exp_f32 v148, v148
v_mfma_f32_16x16x32_bf16 v[134:137], v[182:185], a[128:131], v[134:137]
v_exp_f32 v149, v149
v_mfma_f32_16x16x32_bf16 v[90:93], a[224:227], v[182:185], v[90:93]
v_cvt_pk_bf16_f32 v178, v146, v147
v_cvt_pk_bf16_f32 v179, v148, v149
v_mfma_f32_16x16x32_bf16 v[170:173], a[248:251], v[182:185], v[170:173]
ds_write_b64 v212, v[94:95] offset:12288
v_mfma_f32_16x16x32_bf16 v[220:223], v[240:243], v[182:185], v[220:223]
s_waitcnt lgkmcnt(2)
v_exp_f32 v154, v154
v_mfma_f32_16x16x32_bf16 v[118:121], v[186:189], a[84:87], v[118:121]
ds_read_b128 v[182:185], v210 offset:34816
ds_read_b64 v[76:77], v215 offset:16
v_mfma_f32_16x16x32_bf16 v[126:129], v[186:189], a[108:111], v[126:129]
v_exp_f32 v155, v155
v_mfma_f32_16x16x32_bf16 v[134:137], v[186:189], a[132:135], v[134:137]
v_exp_f32 v156, v156
v_mfma_f32_16x16x32_bf16 v[90:93], a[228:231], v[186:189], v[90:93]
v_exp_f32 v157, v157
v_mfma_f32_16x16x32_bf16 v[170:173], a[252:255], v[186:189], v[170:173]
v_exp_f32 v158, v158
v_mfma_f32_16x16x32_bf16 v[220:223], v[244:247], v[186:189], v[220:223]
ds_read_b128 v[186:189], v210 offset:35840
v_exp_f32 v159, v159
v_mfma_f32_16x16x32_bf16 v[150:153], v[190:193], v[174:177], 0
s_waitcnt lgkmcnt(2)
v_exp_f32 v160, v160
v_mfma_f32_16x16x32_bf16 v[118:121], v[182:185], a[88:91], v[118:121]
v_exp_f32 v161, v161
v_mfma_f32_16x16x32_bf16 v[126:129], v[182:185], a[112:115], v[126:129]
v_exp_f32 v166, v166
v_mfma_f32_16x16x32_bf16 v[134:137], v[182:185], a[136:139], v[134:137]
v_exp_f32 v162, v162
v_mfma_f32_16x16x32_bf16 v[90:93], a[232:235], v[182:185], v[90:93]
v_exp_f32 v163, v163
v_mfma_f32_16x16x32_bf16 v[170:173], v[224:227], v[182:185], v[170:173]
v_exp_f32 v164, v164
v_mfma_f32_16x16x32_bf16 v[220:223], v[248:251], v[182:185], v[220:223]
s_waitcnt lgkmcnt(0)
v_exp_f32 v165, v165
v_mfma_f32_16x16x32_bf16 v[118:121], v[186:189], a[92:95], v[118:121]
v_mfma_f32_16x16x32_bf16 v[126:129], v[186:189], a[116:119], v[126:129]
v_mfma_f32_16x16x32_bf16 v[134:137], v[186:189], a[140:143], v[134:137]
v_cvt_pk_bf16_f32 v118, v118, v119
v_cvt_pk_bf16_f32 v119, v120, v121
v_mfma_f32_16x16x32_bf16 v[90:93], a[236:239], v[186:189], v[90:93]
ds_read_u16 v120, v216
v_cvt_pk_bf16_f32 v126, v126, v127
v_mfma_f32_16x16x32_bf16 v[170:173], v[228:231], v[186:189], v[170:173]
v_cvt_pk_bf16_f32 v127, v128, v129
v_cvt_pk_bf16_f32 v134, v134, v135
v_mfma_f32_16x16x32_bf16 v[220:223], v[252:255], v[186:189], v[220:223]
ds_read_u16 v128, v216 offset:32
v_cvt_pk_bf16_f32 v90, v90, v91
v_mfma_f32_16x16x32_bf16 v[138:141], v[114:117], v[174:177], 0
v_cvt_pk_bf16_f32 v91, v92, v93
v_cvt_pk_bf16_f32 v92, v170, v171
v_mfma_f32_16x16x32_bf16 v[142:145], v[122:125], v[174:177], 0
v_cvt_pk_bf16_f32 v93, v172, v173
v_cvt_pk_bf16_f32 v135, v136, v137
v_mfma_f32_16x16x32_bf16 v[146:149], v[130:133], v[174:177], 0
ds_read_u16 v136, v216 offset:64
v_mov_b32 v121, 0
v_mfma_f32_16x16x32_bf16 v[150:153], v[190:193], v[178:181], v[150:153]
s_waitcnt lgkmcnt(2)
v_mov_b32 v129, 0
v_cvt_pk_bf16_f32 v94, v220, v221
v_mfma_f32_16x16x32_bf16 v[138:141], v[118:121], v[178:181], v[138:141]
s_waitcnt lgkmcnt(1)
v_cvt_pk_bf16_f32 v95, v222, v223
v_mov_b32 v137, 0
v_mfma_f32_16x16x32_bf16 v[142:145], v[126:129], v[178:181], v[142:145]
v_rcp_f32 v151, v150
s_nop 0
v_max3_u32 v218, v218, v150, v151
v_mul_f32 v151, s3, v151
v_mul_f32 v138, v138, v151
v_mul_f32 v139, v139, v151
v_mul_f32 v140, v140, v151
v_mul_f32 v141, v141, v151
v_cvt_pk_bf16_f32 v138, v138, v139
v_mul_f32 v142, v142, v151
s_waitcnt lgkmcnt(0)
v_mfma_f32_16x16x32_bf16 v[146:149], v[134:137], v[178:181], v[146:149]
v_mul_f32 v143, v143, v151
v_mul_f32 v144, v144, v151
v_mul_f32 v145, v145, v151
v_cvt_pk_bf16_f32 v139, v140, v141
v_cvt_pk_bf16_f32 v140, v142, v143
v_cvt_pk_bf16_f32 v141, v144, v145
v_cvt_pk_bf16_f32 v174, v154, v155
v_mul_f32 v146, v146, v151
v_mul_f32 v147, v147, v151
v_mul_f32 v148, v148, v151
v_mul_f32 v149, v149, v151
v_mfma_f32_16x16x32_bf16 v[150:153], v[108:111], v[90:93], v[206:209]
ds_write_b128 v211, v[138:141] offset:36864
v_mfma_f32_16x16x32_bf16 v[138:141], v[78:81], v[90:93], 0
v_cvt_pk_bf16_f32 v142, v146, v147
v_cvt_pk_bf16_f32 v143, v148, v149
v_mfma_f32_16x16x32_bf16 v[146:149], v[102:105], v[90:93], 0
v_cvt_pk_bf16_f32 v175, v156, v157
v_cvt_pk_bf16_f32 v176, v158, v159
v_mfma_f32_16x16x16_bf16 v[138:141], v[82:83], v[94:95], v[138:141]
ds_write_b64 v212, v[142:143] offset:36864
v_mfma_f32_16x16x32_bf16 v[142:145], v[96:99], v[90:93], 0
v_cvt_pk_bf16_f32 v177, v160, v161
v_cvt_pk_bf16_f32 v180, v166, 0
v_mfma_f32_16x16x16_bf16 v[150:153], v[112:113], v[94:95], v[150:153]
v_cvt_pk_bf16_f32 v178, v162, v163
v_cvt_pk_bf16_f32 v179, v164, v165
v_mfma_f32_16x16x32_bf16 v[166:169], v[190:193], v[174:177], 0
v_exp_f32 v138, v138
v_mfma_f32_16x16x32_bf16 v[154:157], v[114:117], v[174:177], 0
v_exp_f32 v139, v139
v_mfma_f32_16x16x32_bf16 v[158:161], v[122:125], v[174:177], 0
v_exp_f32 v140, v140
v_mfma_f32_16x16x32_bf16 v[162:165], v[130:133], v[174:177], 0
v_exp_f32 v141, v141
v_mfma_f32_16x16x16_bf16 v[142:145], v[100:101], v[94:95], v[142:145]
v_exp_f32 v150, v150
v_mfma_f32_16x16x32_bf16 v[166:169], v[190:193], v[178:181], v[166:169]
v_cvt_pk_bf16_f32 v174, v138, v139
v_cvt_pk_bf16_f32 v175, v140, v141
v_mfma_f32_16x16x32_bf16 v[154:157], v[118:121], v[178:181], v[154:157]
v_exp_f32 v142, v142
v_mfma_f32_16x16x32_bf16 v[158:161], v[126:129], v[178:181], v[158:161]
v_rcp_f32 v167, v166
v_mfma_f32_16x16x32_bf16 v[162:165], v[134:137], v[178:181], v[162:165]
v_max3_u32 v218, v218, v166, v167
v_mul_f32 v167, s3, v167
v_mfma_f32_16x16x16_bf16 v[146:149], v[106:107], v[94:95], v[146:149]
v_mul_f32 v154, v154, v167
v_mul_f32 v155, v155, v167
v_mul_f32 v156, v156, v167
v_mul_f32 v157, v157, v167
v_cvt_pk_bf16_f32 v154, v154, v155
v_mul_f32 v158, v158, v167
v_mul_f32 v159, v159, v167
v_mul_f32 v160, v160, v167
v_mul_f32 v161, v161, v167
v_cvt_pk_bf16_f32 v155, v156, v157
v_cvt_pk_bf16_f32 v156, v158, v159
v_cvt_pk_bf16_f32 v157, v160, v161
v_mul_f32 v162, v162, v167
v_mul_f32 v163, v163, v167
v_mul_f32 v164, v164, v167
v_mul_f32 v165, v165, v167
v_mfma_f32_16x16x32_bf16 v[166:169], v[72:75], v[108:111], v[206:209]
ds_write_b128 v211, v[154:157] offset:43008
v_mfma_f32_16x16x32_bf16 v[154:157], v[72:75], v[78:81], 0
v_cvt_pk_bf16_f32 v158, v162, v163
v_cvt_pk_bf16_f32 v159, v164, v165
v_mfma_f32_16x16x32_bf16 v[162:165], v[72:75], v[102:105], 0
v_exp_f32 v143, v143
v_mfma_f32_16x16x16_bf16 v[154:157], v[76:77], v[82:83], v[154:157]
ds_write_b64 v212, v[158:159] offset:43008
v_mfma_f32_16x16x32_bf16 v[158:161], v[72:75], v[96:99], 0
v_exp_f32 v144, v144
v_mfma_f32_16x16x16_bf16 v[162:165], v[76:77], v[106:107], v[162:165]
v_exp_f32 v145, v145
v_mfma_f32_16x16x16_bf16 v[158:161], v[76:77], v[100:101], v[158:161]
v_cvt_pk_bf16_f32 v176, v142, v143
v_cvt_pk_bf16_f32 v177, v144, v145
v_mfma_f32_16x16x16_bf16 v[166:169], v[76:77], v[112:113], v[166:169]
v_cvt_pk_bf16_f32 v180, v150, 0
v_exp_f32 v146, v146
v_mfma_f32_16x16x32_bf16 v[150:153], v[190:193], v[174:177], 0
v_exp_f32 v147, v147
v_mfma_f32_16x16x32_bf16 v[138:141], v[114:117], v[174:177], 0
s_waitcnt lgkmcnt(0)
v_exp_f32 v148, v148
v_mfma_f32_16x16x32_bf16 v[142:145], v[122:125], v[174:177], 0
s_barrier
ds_read_b128 v[170:173], v210 offset:36864
v_exp_f32 v149, v149
v_mov_b32_dpp v154, v158 quad_perm:[0,1,2,3] row_mask:0x2 bank_mask:0xf
v_cvt_pk_bf16_f32 v178, v146, v147
v_cvt_pk_bf16_f32 v179, v148, v149
v_mfma_f32_16x16x32_bf16 v[146:149], v[130:133], v[174:177], 0
v_mov_b32_dpp v154, v162 quad_perm:[0,1,2,3] row_mask:0x4 bank_mask:0xf
v_mfma_f32_16x16x32_bf16 v[150:153], v[190:193], v[178:181], v[150:153]
ds_read_b128 v[182:185], v210 offset:37888
v_mov_b32_dpp v154, v167 quad_perm:[0,1,2,3] row_mask:0x8 bank_mask:0xf
v_mfma_f32_16x16x32_bf16 v[138:141], v[118:121], v[178:181], v[138:141]
v_exp_f32 v154, v154
v_mfma_f32_16x16x32_bf16 v[142:145], v[126:129], v[178:181], v[142:145]
v_cvt_pk_bf16_f32 v154, v154, 0
v_rcp_f32 v151, v150
v_mfma_f32_16x16x32_bf16 v[146:149], v[134:137], v[178:181], v[146:149]
s_waitcnt lgkmcnt(1)
ds_write_b16 v214, v154
v_mfma_f32_16x16x32_bf16 v[36:39], a[144:147], v[170:173], v[36:39]
ds_read_b128 v[84:87], v215
ds_read_b128 v[88:91], v215 offset:16
v_mfma_f32_16x16x32_bf16 v[40:43], a[168:171], v[170:173], v[40:43]
ds_read_b128 v[186:189], v210 offset:38912
v_mfma_f32_16x16x32_bf16 v[44:47], a[192:195], v[170:173], v[44:47]
ds_read_b128 v[170:173], v210 offset:39936
s_waitcnt lgkmcnt(5)
v_mfma_f32_16x16x32_bf16 v[36:39], a[148:151], v[182:185], v[36:39]
v_mfma_f32_16x16x32_bf16 v[40:43], a[172:175], v[182:185], v[40:43]
v_mfma_f32_16x16x32_bf16 v[44:47], a[196:199], v[182:185], v[44:47]
ds_read_b128 v[182:185], v210 offset:40960
s_waitcnt lgkmcnt(4)
v_mfma_f32_16x16x32_bf16 v[166:169], v[84:87], v[190:193], 0
v_mfma_f32_16x16x32_bf16 v[154:157], v[84:87], v[114:117], 0
v_mfma_f32_16x16x32_bf16 v[158:161], v[84:87], v[122:125], 0
v_mfma_f32_16x16x32_bf16 v[162:165], v[84:87], v[130:133], 0
s_waitcnt lgkmcnt(3)
v_mfma_f32_16x16x32_bf16 v[166:169], v[88:91], v[190:193], v[166:169]
s_waitcnt lgkmcnt(2)
v_mfma_f32_16x16x32_bf16 v[36:39], a[152:155], v[186:189], v[36:39]
v_mfma_f32_16x16x32_bf16 v[154:157], v[88:91], v[118:121], v[154:157]
v_rcp_f32 v167, v166
v_mfma_f32_16x16x32_bf16 v[40:43], a[176:179], v[186:189], v[40:43]
v_max3_u32 v218, v218, v166, v167
v_max3_u32 v218, v218, v150, v151
v_mfma_f32_16x16x32_bf16 v[158:161], v[88:91], v[126:129], v[158:161]
v_mul_f32 v151, s3, v151
v_mul_f32 v138, v138, v151
v_mfma_f32_16x16x32_bf16 v[44:47], a[200:203], v[186:189], v[44:47]
ds_read_b128 v[186:189], v210 offset:41984
v_mul_f32 v139, v139, v151
v_mfma_f32_16x16x32_bf16 v[162:165], v[88:91], v[134:137], v[162:165]
s_waitcnt lgkmcnt(2)
v_mul_f32 v140, v140, v151
v_mul_f32 v141, v141, v151
v_mfma_f32_16x16x32_bf16 v[36:39], a[156:159], v[170:173], v[36:39]
v_cvt_pk_bf16_f32 v138, v138, v139
v_mul_f32 v142, v142, v151
v_mfma_f32_16x16x32_bf16 v[40:43], a[180:183], v[170:173], v[40:43]
v_mul_f32 v143, v143, v151
v_mul_f32 v144, v144, v151
v_mfma_f32_16x16x32_bf16 v[44:47], a[204:207], v[170:173], v[44:47]
s_waitcnt lgkmcnt(1)
ds_read_b128 v[170:173], v210 offset:43008
v_mul_f32 v145, v145, v151
v_mfma_f32_16x16x32_bf16 v[36:39], a[160:163], v[182:185], v[36:39]
v_cvt_pk_bf16_f32 v139, v140, v141
v_cvt_pk_bf16_f32 v140, v142, v143
v_mfma_f32_16x16x32_bf16 v[40:43], a[184:187], v[182:185], v[40:43]
v_cvt_pk_bf16_f32 v141, v144, v145
v_mul_f32 v146, v146, v151
v_mfma_f32_16x16x32_bf16 v[44:47], a[208:211], v[182:185], v[44:47]
s_waitcnt lgkmcnt(1)
ds_read_b128 v[182:185], v210 offset:44032
ds_write_b128 v211, v[138:141] offset:49152
v_mfma_f32_16x16x32_bf16 v[36:39], a[164:167], v[186:189], v[36:39]
v_mul_f32 v147, v147, v151
v_mul_f32 v148, v148, v151
v_mfma_f32_16x16x32_bf16 v[40:43], a[188:191], v[186:189], v[40:43]
v_mul_f32 v149, v149, v151
v_cvt_pk_bf16_f32 v142, v146, v147
v_mfma_f32_16x16x32_bf16 v[44:47], a[212:215], v[186:189], v[44:47]
s_waitcnt lgkmcnt(2)
ds_read_b128 v[186:189], v210 offset:45056
v_cvt_pk_bf16_f32 v143, v148, v149
v_mfma_f32_16x16x32_bf16 v[48:51], a[144:147], v[170:173], v[48:51]
ds_write_b64 v212, v[142:143] offset:49152
v_mfma_f32_16x16x32_bf16 v[52:55], a[168:171], v[170:173], v[52:55]
v_cvt_pk_bf16_f32 v72, v36, v37
v_cvt_pk_bf16_f32 v73, v38, v39
v_mfma_f32_16x16x32_bf16 v[56:59], a[192:195], v[170:173], v[56:59]
s_waitcnt lgkmcnt(3)
ds_read_b128 v[170:173], v210 offset:46080
buffer_store_dwordx2 v[72:73], v203, s[8:11], s39 offen
v_cvt_pk_bf16_f32 v74, v40, v41
v_mfma_f32_16x16x32_bf16 v[48:51], a[148:151], v[182:185], v[48:51]
v_cvt_pk_bf16_f32 v75, v42, v43
v_mov_b32_dpp v154, v158 quad_perm:[0,1,2,3] row_mask:0x2 bank_mask:0xf
v_mfma_f32_16x16x32_bf16 v[52:55], a[172:175], v[182:185], v[52:55]
v_mul_f32 v167, s3, v167
v_mov_b32_dpp v154, v162 quad_perm:[0,1,2,3] row_mask:0x4 bank_mask:0xf
v_mfma_f32_16x16x32_bf16 v[56:59], a[196:199], v[182:185], v[56:59]
s_waitcnt lgkmcnt(2)
ds_read_b128 v[182:185], v210 offset:47104
v_mul_f32 v154, v154, v167
v_mfma_f32_16x16x32_bf16 v[48:51], a[152:155], v[186:189], v[48:51]
v_cvt_pk_bf16_f32 v154, v154, 0
v_cvt_pk_bf16_f32 v76, v44, v45
v_mfma_f32_16x16x32_bf16 v[52:55], a[176:179], v[186:189], v[52:55]
s_waitcnt lgkmcnt(1)
ds_write_b16 v214, v154
v_mfma_f32_16x16x32_bf16 v[56:59], a[200:203], v[186:189], v[56:59]
s_barrier
v_mfma_f32_16x16x32_bf16 v[48:51], a[156:159], v[170:173], v[48:51]
ds_read_b128 v[186:189], v210 offset:48128
v_mfma_f32_16x16x32_bf16 v[52:55], a[180:183], v[170:173], v[52:55]
v_mfma_f32_16x16x32_bf16 v[56:59], a[204:207], v[170:173], v[56:59]
ds_read_b128 v[170:173], v210 offset:49152
s_waitcnt lgkmcnt(3)
v_mfma_f32_16x16x32_bf16 v[48:51], a[160:163], v[182:185], v[48:51]
buffer_store_dwordx2 v[74:75], v203, s[8:11], s39 offen offset:32
v_cvt_pk_bf16_f32 v77, v46, v47
v_mfma_f32_16x16x32_bf16 v[52:55], a[184:187], v[182:185], v[52:55]
v_add_u32 v215, 1408, v215
v_mfma_f32_16x16x32_bf16 v[56:59], a[208:211], v[182:185], v[56:59]
ds_read_b128 v[182:185], v210 offset:50176
s_waitcnt lgkmcnt(2)
v_mfma_f32_16x16x32_bf16 v[48:51], a[164:167], v[186:189], v[48:51]
ds_read_b64 v[112:113], v215 offset:528
v_mfma_f32_16x16x32_bf16 v[52:55], a[188:191], v[186:189], v[52:55]
s_waitcnt lgkmcnt(2)
v_mfma_f32_16x16x32_bf16 v[56:59], a[212:215], v[186:189], v[56:59]
s_mov_b32 s38, s36
ds_read_b128 v[186:189], v210 offset:51200
v_cvt_pk_bf16_f32 v78, v48, v49
v_cvt_pk_bf16_f32 v79, v50, v51
v_cvt_pk_bf16_f32 v80, v52, v53
v_mfma_f32_16x16x32_bf16 v[60:63], a[144:147], v[170:173], v[60:63]
v_cvt_pk_bf16_f32 v81, v54, v55
v_cvt_pk_bf16_f32 v82, v56, v57
v_mfma_f32_16x16x32_bf16 v[64:67], a[168:171], v[170:173], v[64:67]
v_cvt_pk_bf16_f32 v83, v58, v59
v_mfma_f32_16x16x32_bf16 v[68:71], a[192:195], v[170:173], v[68:71]
ds_read_b128 v[170:173], v210 offset:52224
s_waitcnt lgkmcnt(3)
v_mfma_f32_16x16x32_bf16 v[60:63], a[148:151], v[182:185], v[60:63]
buffer_store_dwordx2 v[76:77], v203, s[8:11], s39 offen offset:64
v_mfma_f32_16x16x32_bf16 v[64:67], a[172:175], v[182:185], v[64:67]
v_mfma_f32_16x16x32_bf16 v[68:71], a[196:199], v[182:185], v[68:71]
ds_read_b128 v[182:185], v210 offset:53248
s_waitcnt lgkmcnt(2)
v_mfma_f32_16x16x32_bf16 v[60:63], a[152:155], v[186:189], v[60:63]
v_mfma_f32_16x16x32_bf16 v[64:67], a[176:179], v[186:189], v[64:67]
v_mfma_f32_16x16x32_bf16 v[68:71], a[200:203], v[186:189], v[68:71]
ds_read_b128 v[186:189], v210 offset:54272
s_waitcnt lgkmcnt(2)
v_mfma_f32_16x16x32_bf16 v[60:63], a[156:159], v[170:173], v[60:63]
v_mfma_f32_16x16x32_bf16 v[64:67], a[180:183], v[170:173], v[64:67]
v_mfma_f32_16x16x32_bf16 v[68:71], a[204:207], v[170:173], v[68:71]
s_waitcnt lgkmcnt(1)
v_mfma_f32_16x16x32_bf16 v[60:63], a[160:163], v[182:185], v[60:63]
v_mfma_f32_16x16x32_bf16 v[64:67], a[184:187], v[182:185], v[64:67]
v_mfma_f32_16x16x32_bf16 v[68:71], a[208:211], v[182:185], v[68:71]
ds_read_b128 v[182:185], v210
s_waitcnt lgkmcnt(1)
v_mfma_f32_16x16x32_bf16 v[60:63], a[164:167], v[186:189], v[60:63]
v_mfma_f32_16x16x32_bf16 v[64:67], a[188:191], v[186:189], v[64:67]
s_nop 3
v_cvt_pk_bf16_f32 v116, v60, v61
v_cvt_pk_bf16_f32 v117, v62, v63
v_mfma_f32_16x16x32_bf16 v[68:71], a[212:215], v[186:189], v[68:71]
v_cvt_pk_bf16_f32 v124, v64, v65
v_cvt_pk_bf16_f32 v125, v66, v67
s_waitcnt lgkmcnt(0)
v_mfma_f32_16x16x32_bf16 v[138:141], a[0:3], v[182:185], 0
ds_read_b128 v[186:189], v210 offset:1024
s_nop 0
v_cvt_pk_bf16_f32 v132, v68, v69
v_mfma_f32_16x16x32_bf16 v[142:145], a[24:27], v[182:185], 0
v_cvt_pk_bf16_f32 v133, v70, v71
v_mfma_f32_16x16x32_bf16 v[146:149], a[48:51], v[182:185], 0
buffer_store_dwordx2 v[78:79], v204, s[8:11], s39 offen
v_mfma_f32_16x16x32_bf16 v[150:153], a[216:219], v[182:185], 0
v_mfma_f32_16x16x32_bf16 v[154:157], a[240:243], v[182:185], 0
v_mfma_f32_16x16x32_bf16 v[158:161], v[232:235], v[182:185], 0
v_mfma_f32_16x16x32_bf16 v[162:165], v[182:185], a[72:75], 0
v_mfma_f32_16x16x32_bf16 v[166:169], v[182:185], a[96:99], 0
v_mfma_f32_16x16x32_bf16 v[170:173], v[182:185], a[120:123], 0
ds_read_b128 v[182:185], v210 offset:2048
s_waitcnt lgkmcnt(1)
v_mfma_f32_16x16x32_bf16 v[138:141], a[4:7], v[186:189], v[138:141]
buffer_store_dwordx2 v[80:81], v204, s[8:11], s39 offen offset:32
v_mfma_f32_16x16x32_bf16 v[142:145], a[28:31], v[186:189], v[142:145]
v_mfma_f32_16x16x32_bf16 v[146:149], a[52:55], v[186:189], v[146:149]
v_mfma_f32_16x16x32_bf16 v[150:153], a[220:223], v[186:189], v[150:153]
v_mfma_f32_16x16x32_bf16 v[154:157], a[244:247], v[186:189], v[154:157]
v_mfma_f32_16x16x32_bf16 v[158:161], v[236:239], v[186:189], v[158:161]
v_mfma_f32_16x16x32_bf16 v[162:165], v[186:189], a[76:79], v[162:165]
v_mfma_f32_16x16x32_bf16 v[166:169], v[186:189], a[100:103], v[166:169]
v_mfma_f32_16x16x32_bf16 v[170:173], v[186:189], a[124:127], v[170:173]
ds_read_b128 v[186:189], v210 offset:3072
s_waitcnt lgkmcnt(1)
v_mfma_f32_16x16x32_bf16 v[138:141], a[8:11], v[182:185], v[138:141]
buffer_store_dwordx2 v[82:83], v204, s[8:11], s39 offen offset:64
v_mfma_f32_16x16x32_bf16 v[142:145], a[32:35], v[182:185], v[142:145]
v_mfma_f32_16x16x32_bf16 v[146:149], a[56:59], v[182:185], v[146:149]
v_mfma_f32_16x16x32_bf16 v[150:153], a[224:227], v[182:185], v[150:153]
v_mfma_f32_16x16x32_bf16 v[154:157], a[248:251], v[182:185], v[154:157]
v_mfma_f32_16x16x32_bf16 v[158:161], v[240:243], v[182:185], v[158:161]
v_mfma_f32_16x16x32_bf16 v[162:165], v[182:185], a[80:83], v[162:165]
v_mfma_f32_16x16x32_bf16 v[166:169], v[182:185], a[104:107], v[166:169]
v_mfma_f32_16x16x32_bf16 v[170:173], v[182:185], a[128:131], v[170:173]
ds_read_b128 v[182:185], v210 offset:4096
s_waitcnt lgkmcnt(1)
v_mfma_f32_16x16x32_bf16 v[138:141], a[12:15], v[186:189], v[138:141]
v_mfma_f32_16x16x32_bf16 v[142:145], a[36:39], v[186:189], v[142:145]
v_mfma_f32_16x16x32_bf16 v[146:149], a[60:63], v[186:189], v[146:149]
v_mfma_f32_16x16x32_bf16 v[150:153], a[228:231], v[186:189], v[150:153]
buffer_store_dwordx2 v[116:117], v205, s[8:11], s39 offen
v_add_u32 v216, 1408, v216
v_mfma_f32_16x16x32_bf16 v[154:157], a[252:255], v[186:189], v[154:157]
v_mov_b32 v181, 0
v_mfma_f32_16x16x32_bf16 v[158:161], v[244:247], v[186:189], v[158:161]
v_mfma_f32_16x16x32_bf16 v[162:165], v[186:189], a[84:87], v[162:165]
v_mfma_f32_16x16x32_bf16 v[166:169], v[186:189], a[108:111], v[166:169]
v_mfma_f32_16x16x32_bf16 v[170:173], v[186:189], a[132:135], v[170:173]
ds_read_b128 v[186:189], v210 offset:5120
s_waitcnt lgkmcnt(1)
v_mfma_f32_16x16x32_bf16 v[138:141], a[16:19], v[182:185], v[138:141]
v_mfma_f32_16x16x32_bf16 v[142:145], a[40:43], v[182:185], v[142:145]
v_mfma_f32_16x16x32_bf16 v[146:149], a[64:67], v[182:185], v[146:149]
v_mfma_f32_16x16x32_bf16 v[150:153], a[232:235], v[182:185], v[150:153]
v_mfma_f32_16x16x32_bf16 v[154:157], v[224:227], v[182:185], v[154:157]
v_mfma_f32_16x16x32_bf16 v[158:161], v[248:251], v[182:185], v[158:161]
v_mfma_f32_16x16x32_bf16 v[162:165], v[182:185], a[88:91], v[162:165]
v_add_u32 v214, 1408, v214
v_mfma_f32_16x16x32_bf16 v[166:169], v[182:185], a[112:115], v[166:169]
v_mfma_f32_16x16x32_bf16 v[170:173], v[182:185], a[136:139], v[170:173]
ds_read_b128 v[182:185], v210 offset:6144
s_waitcnt lgkmcnt(1)
v_mfma_f32_16x16x32_bf16 v[138:141], a[20:23], v[186:189], v[138:141]
v_mfma_f32_16x16x32_bf16 v[142:145], a[44:47], v[186:189], v[142:145]
v_mfma_f32_16x16x32_bf16 v[146:149], a[68:71], v[186:189], v[146:149]
v_cvt_pk_bf16_f32 v78, v138, v139
v_cvt_pk_bf16_f32 v79, v140, v141
v_mfma_f32_16x16x32_bf16 v[150:153], a[236:239], v[186:189], v[150:153]
v_cvt_pk_bf16_f32 v80, v142, v143
v_cvt_pk_bf16_f32 v81, v144, v145
v_mfma_f32_16x16x32_bf16 v[154:157], v[228:231], v[186:189], v[154:157]
v_cvt_pk_bf16_f32 v82, v146, v147
v_cvt_pk_bf16_f32 v83, v148, v149
v_mfma_f32_16x16x32_bf16 v[158:161], v[252:255], v[186:189], v[158:161]
v_cvt_pk_bf16_f32 v72, v150, v151
v_cvt_pk_bf16_f32 v73, v152, v153
v_mfma_f32_16x16x32_bf16 v[162:165], v[186:189], a[92:95], v[162:165]
v_cvt_pk_bf16_f32 v74, v154, v155
v_cvt_pk_bf16_f32 v75, v156, v157
v_mfma_f32_16x16x32_bf16 v[166:169], v[186:189], a[116:119], v[166:169]
v_cvt_pk_bf16_f32 v76, v158, v159
v_cvt_pk_bf16_f32 v77, v160, v161
v_mfma_f32_16x16x32_bf16 v[170:173], v[186:189], a[140:143], v[170:173]
s_waitcnt lgkmcnt(0)
ds_read_b128 v[186:189], v210 offset:7168
v_cvt_pk_bf16_f32 v114, v162, v163
v_mfma_f32_16x16x32_bf16 v[138:141], a[0:3], v[182:185], 0
v_cvt_pk_bf16_f32 v115, v164, v165
v_cvt_pk_bf16_f32 v122, v166, v167
v_mfma_f32_16x16x32_bf16 v[142:145], a[24:27], v[182:185], 0
v_cvt_pk_bf16_f32 v123, v168, v169
v_cvt_pk_bf16_f32 v130, v170, v171
v_mfma_f32_16x16x32_bf16 v[146:149], a[48:51], v[182:185], 0
v_cvt_pk_bf16_f32 v131, v172, v173
v_mfma_f32_16x16x32_bf16 v[150:153], a[216:219], v[182:185], 0
v_mfma_f32_16x16x32_bf16 v[154:157], a[240:243], v[182:185], 0
v_mfma_f32_16x16x32_bf16 v[158:161], v[232:235], v[182:185], 0
v_mfma_f32_16x16x32_bf16 v[162:165], v[182:185], a[72:75], 0
v_mfma_f32_16x16x32_bf16 v[166:169], v[182:185], a[96:99], 0
v_mfma_f32_16x16x32_bf16 v[170:173], v[182:185], a[120:123], 0
ds_read_b128 v[182:185], v210 offset:8192
s_waitcnt lgkmcnt(1)
v_mfma_f32_16x16x32_bf16 v[138:141], a[4:7], v[186:189], v[138:141]
buffer_store_dwordx2 v[124:125], v205, s[8:11], s39 offen offset:32
v_mfma_f32_16x16x32_bf16 v[142:145], a[28:31], v[186:189], v[142:145]
v_mfma_f32_16x16x32_bf16 v[146:149], a[52:55], v[186:189], v[146:149]
v_mfma_f32_16x16x32_bf16 v[150:153], a[220:223], v[186:189], v[150:153]
v_mfma_f32_16x16x32_bf16 v[154:157], a[244:247], v[186:189], v[154:157]
v_mfma_f32_16x16x32_bf16 v[158:161], v[236:239], v[186:189], v[158:161]
s_barrier
v_mfma_f32_16x16x32_bf16 v[162:165], v[186:189], a[76:79], v[162:165]
v_mfma_f32_16x16x32_bf16 v[166:169], v[186:189], a[100:103], v[166:169]
v_mfma_f32_16x16x32_bf16 v[170:173], v[186:189], a[124:127], v[170:173]
ds_read_b128 v[186:189], v210 offset:9216
s_waitcnt lgkmcnt(1)
v_mfma_f32_16x16x32_bf16 v[138:141], a[8:11], v[182:185], v[138:141]
v_mfma_f32_16x16x32_bf16 v[142:145], a[32:35], v[182:185], v[142:145]
v_mfma_f32_16x16x32_bf16 v[146:149], a[56:59], v[182:185], v[146:149]
v_mfma_f32_16x16x32_bf16 v[150:153], a[224:227], v[182:185], v[150:153]
v_mfma_f32_16x16x32_bf16 v[154:157], a[248:251], v[182:185], v[154:157]
v_mfma_f32_16x16x32_bf16 v[158:161], v[240:243], v[182:185], v[158:161]
ds_read_b128 v[108:111], v215 offset:512
v_mfma_f32_16x16x32_bf16 v[162:165], v[182:185], a[80:83], v[162:165]
v_mfma_f32_16x16x32_bf16 v[166:169], v[182:185], a[104:107], v[166:169]
v_mfma_f32_16x16x32_bf16 v[170:173], v[182:185], a[128:131], v[170:173]
ds_read_b128 v[182:185], v210 offset:10240
s_waitcnt lgkmcnt(2)
v_mfma_f32_16x16x32_bf16 v[138:141], a[12:15], v[186:189], v[138:141]
v_mfma_f32_16x16x32_bf16 v[142:145], a[36:39], v[186:189], v[142:145]
v_mfma_f32_16x16x32_bf16 v[146:149], a[60:63], v[186:189], v[146:149]
v_mfma_f32_16x16x32_bf16 v[150:153], a[228:231], v[186:189], v[150:153]
v_mfma_f32_16x16x32_bf16 v[154:157], a[252:255], v[186:189], v[154:157]
v_mfma_f32_16x16x32_bf16 v[158:161], v[244:247], v[186:189], v[158:161]
v_mfma_f32_16x16x32_bf16 v[162:165], v[186:189], a[84:87], v[162:165]
v_mfma_f32_16x16x32_bf16 v[166:169], v[186:189], a[108:111], v[166:169]
v_mfma_f32_16x16x32_bf16 v[170:173], v[186:189], a[132:135], v[170:173]
ds_read_b128 v[186:189], v210 offset:11264
s_waitcnt lgkmcnt(1)
v_mfma_f32_16x16x32_bf16 v[138:141], a[16:19], v[182:185], v[138:141]
v_mfma_f32_16x16x32_bf16 v[142:145], a[40:43], v[182:185], v[142:145]
v_mfma_f32_16x16x32_bf16 v[146:149], a[64:67], v[182:185], v[146:149]
v_mfma_f32_16x16x32_bf16 v[150:153], a[232:235], v[182:185], v[150:153]
v_mfma_f32_16x16x32_bf16 v[154:157], v[224:227], v[182:185], v[154:157]
v_mfma_f32_16x16x32_bf16 v[158:161], v[248:251], v[182:185], v[158:161]
v_mfma_f32_16x16x32_bf16 v[162:165], v[182:185], a[88:91], v[162:165]
v_mfma_f32_16x16x32_bf16 v[166:169], v[182:185], a[112:115], v[166:169]
v_mfma_f32_16x16x32_bf16 v[170:173], v[182:185], a[136:139], v[170:173]
s_waitcnt lgkmcnt(0)
v_mfma_f32_16x16x32_bf16 v[138:141], a[20:23], v[186:189], v[138:141]
buffer_store_dwordx2 v[132:133], v205, s[8:11], s39 offen offset:64
ds_read_b128 v[182:185], v210 offset:12288
v_mfma_f32_16x16x32_bf16 v[142:145], a[44:47], v[186:189], v[142:145]
v_mfma_f32_16x16x32_bf16 v[146:149], a[68:71], v[186:189], v[146:149]
v_cvt_pk_bf16_f32 v96, v138, v139
v_cvt_pk_bf16_f32 v97, v140, v141
v_mfma_f32_16x16x32_bf16 v[150:153], a[236:239], v[186:189], v[150:153]
v_cvt_pk_bf16_f32 v98, v142, v143
v_cvt_pk_bf16_f32 v99, v144, v145
v_mfma_f32_16x16x32_bf16 v[154:157], v[228:231], v[186:189], v[154:157]
v_cvt_pk_bf16_f32 v100, v146, v147
v_cvt_pk_bf16_f32 v101, v148, v149
v_mfma_f32_16x16x32_bf16 v[158:161], v[252:255], v[186:189], v[158:161]
v_cvt_pk_bf16_f32 v84, v150, v151
v_cvt_pk_bf16_f32 v85, v152, v153
v_mfma_f32_16x16x32_bf16 v[162:165], v[186:189], a[92:95], v[162:165]
v_cvt_pk_bf16_f32 v86, v154, v155
v_cvt_pk_bf16_f32 v87, v156, v157
v_mfma_f32_16x16x32_bf16 v[166:169], v[186:189], a[116:119], v[166:169]
v_cvt_pk_bf16_f32 v88, v158, v159
v_cvt_pk_bf16_f32 v89, v160, v161
v_mfma_f32_16x16x32_bf16 v[170:173], v[186:189], a[140:143], v[170:173]
s_waitcnt lgkmcnt(0)
ds_read_b128 v[186:189], v210 offset:13312
v_cvt_pk_bf16_f32 v116, v162, v163
v_mfma_f32_16x16x32_bf16 v[138:141], a[0:3], v[182:185], 0
v_cvt_pk_bf16_f32 v124, v166, v167
v_cvt_pk_bf16_f32 v125, v168, v169
v_mfma_f32_16x16x32_bf16 v[142:145], a[24:27], v[182:185], 0
v_cvt_pk_bf16_f32 v117, v164, v165
v_mfma_f32_16x16x32_bf16 v[150:153], v[108:111], v[72:75], v[206:209]
v_mfma_f32_16x16x32_bf16 v[146:149], a[48:51], v[182:185], 0
ds_read_b128 v[182:185], v210 offset:14336
v_mfma_f32_16x16x16_bf16 v[150:153], v[112:113], v[76:77], v[150:153]
s_waitcnt lgkmcnt(1)
v_mfma_f32_16x16x32_bf16 v[138:141], a[4:7], v[186:189], v[138:141]
v_mfma_f32_16x16x32_bf16 v[142:145], a[28:31], v[186:189], v[142:145]
v_mfma_f32_16x16x32_bf16 v[146:149], a[52:55], v[186:189], v[146:149]
ds_read_b128 v[186:189], v210 offset:15360
v_mfma_f32_16x16x32_bf16 v[154:157], v[78:81], v[84:87], 0
s_waitcnt lgkmcnt(1)
v_mfma_f32_16x16x32_bf16 v[138:141], a[8:11], v[182:185], v[138:141]
v_mfma_f32_16x16x32_bf16 v[142:145], a[32:35], v[182:185], v[142:145]
v_mfma_f32_16x16x32_bf16 v[158:161], v[96:99], v[84:87], 0
v_mfma_f32_16x16x32_bf16 v[146:149], a[56:59], v[182:185], v[146:149]
ds_read_b128 v[182:185], v210 offset:16384
v_mfma_f32_16x16x32_bf16 v[166:169], v[108:111], v[84:87], v[206:209]
s_waitcnt lgkmcnt(1)
v_mfma_f32_16x16x32_bf16 v[138:141], a[12:15], v[186:189], v[138:141]
v_mfma_f32_16x16x32_bf16 v[142:145], a[36:39], v[186:189], v[142:145]
v_mfma_f32_16x16x32_bf16 v[146:149], a[60:63], v[186:189], v[146:149]
ds_read_b128 v[186:189], v210 offset:17408
v_mfma_f32_16x16x16_bf16 v[154:157], v[82:83], v[88:89], v[154:157]
v_mfma_f32_16x16x16_bf16 v[158:161], v[100:101], v[88:89], v[158:161]
s_waitcnt lgkmcnt(1)
v_mfma_f32_16x16x32_bf16 v[138:141], a[16:19], v[182:185], v[138:141]
v_mfma_f32_16x16x32_bf16 v[142:145], a[40:43], v[182:185], v[142:145]
v_mfma_f32_16x16x16_bf16 v[166:169], v[112:113], v[88:89], v[166:169]
v_mfma_f32_16x16x32_bf16 v[146:149], a[64:67], v[182:185], v[146:149]
s_waitcnt lgkmcnt(0)
v_mfma_f32_16x16x32_bf16 v[138:141], a[20:23], v[186:189], v[138:141]
ds_read_b128 v[182:185], v210 offset:12288
v_cvt_pk_bf16_f32 v132, v170, v171
v_mfma_f32_16x16x32_bf16 v[142:145], a[44:47], v[186:189], v[142:145]
v_cvt_pk_bf16_f32 v133, v172, v173
v_mfma_f32_16x16x32_bf16 v[146:149], a[68:71], v[186:189], v[146:149]
v_cvt_pk_bf16_f32 v102, v138, v139
v_cvt_pk_bf16_f32 v103, v140, v141
v_mfma_f32_16x16x32_bf16 v[138:141], v[78:81], v[72:75], 0
v_cvt_pk_bf16_f32 v104, v142, v143
v_cvt_pk_bf16_f32 v105, v144, v145
v_mfma_f32_16x16x32_bf16 v[142:145], v[96:99], v[72:75], 0
v_cvt_pk_bf16_f32 v106, v146, v147
v_cvt_pk_bf16_f32 v107, v148, v149
v_mfma_f32_16x16x32_bf16 v[146:149], v[102:105], v[72:75], 0
ds_read_b128 v[186:189], v210 offset:13312
v_mfma_f32_16x16x16_bf16 v[138:141], v[82:83], v[76:77], v[138:141]
v_mfma_f32_16x16x16_bf16 v[142:145], v[100:101], v[76:77], v[142:145]
v_mfma_f32_16x16x16_bf16 v[146:149], v[106:107], v[76:77], v[146:149]
v_exp_f32 v138, v138
v_mfma_f32_16x16x32_bf16 v[162:165], v[102:105], v[84:87], 0
s_waitcnt lgkmcnt(1)
v_exp_f32 v139, v139
v_mfma_f32_16x16x32_bf16 v[118:121], v[182:185], a[72:75], 0
v_exp_f32 v140, v140
v_mfma_f32_16x16x16_bf16 v[162:165], v[106:107], v[88:89], v[162:165]
v_exp_f32 v141, v141
v_mfma_f32_16x16x32_bf16 v[126:129], v[182:185], a[96:99], 0
v_exp_f32 v142, v142
v_mfma_f32_16x16x32_bf16 v[134:137], v[182:185], a[120:123], 0
v_exp_f32 v143, v143
v_mfma_f32_16x16x32_bf16 v[90:93], a[216:219], v[182:185], 0
v_exp_f32 v144, v144
v_mfma_f32_16x16x32_bf16 v[170:173], a[240:243], v[182:185], 0
v_exp_f32 v145, v145
v_mfma_f32_16x16x32_bf16 v[220:223], v[232:235], v[182:185], 0
s_waitcnt lgkmcnt(0)
ds_read_b128 v[182:185], v210 offset:14336
v_cvt_pk_bf16_f32 v174, v138, v139
v_mfma_f32_16x16x32_bf16 v[118:121], v[186:189], a[76:79], v[118:121]
v_exp_f32 v150, v150
v_mfma_f32_16x16x32_bf16 v[126:129], v[186:189], a[100:103], v[126:129]
v_cvt_pk_bf16_f32 v175, v140, v141
v_cvt_pk_bf16_f32 v176, v142, v143
v_mfma_f32_16x16x32_bf16 v[134:137], v[186:189], a[124:127], v[134:137]
v_cvt_pk_bf16_f32 v177, v144, v145
v_cvt_pk_bf16_f32 v180, v150, 0
v_mfma_f32_16x16x32_bf16 v[90:93], a[220:223], v[186:189], v[90:93]
v_mfma_f32_16x16x32_bf16 v[170:173], a[244:247], v[186:189], v[170:173]
v_exp_f32 v146, v146
v_mfma_f32_16x16x32_bf16 v[220:223], v[236:239], v[186:189], v[220:223]
s_waitcnt lgkmcnt(0)
ds_read_b128 v[186:189], v210 offset:15360
ds_read_b128 v[72:75], v215
v_mfma_f32_16x16x32_bf16 v[118:121], v[182:185], a[80:83], v[118:121]
v_exp_f32 v147, v147
v_mfma_f32_16x16x32_bf16 v[126:129], v[182:185], a[104:107], v[126:129]
v_exp_f32 v148, v148
v_mfma_f32_16x16x32_bf16 v[134:137], v[182:185], a[128:131], v[134:137]
v_exp_f32 v149, v149
v_mfma_f32_16x16x32_bf16 v[90:93], a[224:227], v[182:185], v[90:93]
v_cvt_pk_bf16_f32 v178, v146, v147
v_cvt_pk_bf16_f32 v179, v148, v149
v_mfma_f32_16x16x32_bf16 v[170:173], a[248:251], v[182:185], v[170:173]
v_mfma_f32_16x16x32_bf16 v[220:223], v[240:243], v[182:185], v[220:223]
s_waitcnt lgkmcnt(1)
v_exp_f32 v154, v154
v_mfma_f32_16x16x32_bf16 v[118:121], v[186:189], a[84:87], v[118:121]
ds_read_b128 v[182:185], v210 offset:16384
ds_read_b64 v[76:77], v215 offset:16
v_mfma_f32_16x16x32_bf16 v[126:129], v[186:189], a[108:111], v[126:129]
v_exp_f32 v155, v155
v_mfma_f32_16x16x32_bf16 v[134:137], v[186:189], a[132:135], v[134:137]
v_exp_f32 v156, v156
v_mfma_f32_16x16x32_bf16 v[90:93], a[228:231], v[186:189], v[90:93]
v_exp_f32 v157, v157
v_mfma_f32_16x16x32_bf16 v[170:173], a[252:255], v[186:189], v[170:173]
v_exp_f32 v158, v158
v_mfma_f32_16x16x32_bf16 v[220:223], v[244:247], v[186:189], v[220:223]
ds_read_b128 v[186:189], v210 offset:17408
v_exp_f32 v159, v159
v_mfma_f32_16x16x32_bf16 v[150:153], v[190:193], v[174:177], 0
s_waitcnt lgkmcnt(2)
v_exp_f32 v160, v160
v_mfma_f32_16x16x32_bf16 v[118:121], v[182:185], a[88:91], v[118:121]
v_exp_f32 v161, v161
v_mfma_f32_16x16x32_bf16 v[126:129], v[182:185], a[112:115], v[126:129]
v_exp_f32 v166, v166
v_mfma_f32_16x16x32_bf16 v[134:137], v[182:185], a[136:139], v[134:137]
v_exp_f32 v162, v162
v_mfma_f32_16x16x32_bf16 v[90:93], a[232:235], v[182:185], v[90:93]
v_exp_f32 v163, v163
v_mfma_f32_16x16x32_bf16 v[170:173], v[224:227], v[182:185], v[170:173]
v_exp_f32 v164, v164
v_mfma_f32_16x16x32_bf16 v[220:223], v[248:251], v[182:185], v[220:223]
s_waitcnt lgkmcnt(0)
v_exp_f32 v165, v165
v_mfma_f32_16x16x32_bf16 v[118:121], v[186:189], a[92:95], v[118:121]
v_mfma_f32_16x16x32_bf16 v[126:129], v[186:189], a[116:119], v[126:129]
v_mfma_f32_16x16x32_bf16 v[134:137], v[186:189], a[140:143], v[134:137]
v_cvt_pk_bf16_f32 v118, v118, v119
v_cvt_pk_bf16_f32 v119, v120, v121
v_mfma_f32_16x16x32_bf16 v[90:93], a[236:239], v[186:189], v[90:93]
ds_read_u16 v120, v216
v_cvt_pk_bf16_f32 v126, v126, v127
v_mfma_f32_16x16x32_bf16 v[170:173], v[228:231], v[186:189], v[170:173]
v_cvt_pk_bf16_f32 v127, v128, v129
v_cvt_pk_bf16_f32 v134, v134, v135
v_mfma_f32_16x16x32_bf16 v[220:223], v[252:255], v[186:189], v[220:223]
ds_read_u16 v128, v216 offset:32
v_cvt_pk_bf16_f32 v90, v90, v91
v_mfma_f32_16x16x32_bf16 v[138:141], v[114:117], v[174:177], 0
v_cvt_pk_bf16_f32 v91, v92, v93
v_cvt_pk_bf16_f32 v92, v170, v171
v_mfma_f32_16x16x32_bf16 v[142:145], v[122:125], v[174:177], 0
v_cvt_pk_bf16_f32 v93, v172, v173
v_cvt_pk_bf16_f32 v135, v136, v137
v_mfma_f32_16x16x32_bf16 v[146:149], v[130:133], v[174:177], 0
ds_read_u16 v136, v216 offset:64
v_mov_b32 v121, 0
v_mfma_f32_16x16x32_bf16 v[150:153], v[190:193], v[178:181], v[150:153]
s_waitcnt lgkmcnt(2)
v_mov_b32 v129, 0
v_cvt_pk_bf16_f32 v94, v220, v221
v_mfma_f32_16x16x32_bf16 v[138:141], v[118:121], v[178:181], v[138:141]
s_waitcnt lgkmcnt(1)
v_cvt_pk_bf16_f32 v95, v222, v223
v_mov_b32 v137, 0
v_mfma_f32_16x16x32_bf16 v[142:145], v[126:129], v[178:181], v[142:145]
v_rcp_f32 v151, v150
s_nop 0
v_max3_u32 v218, v218, v150, v151
v_mul_f32 v151, s3, v151
v_mul_f32 v138, v138, v151
v_mul_f32 v139, v139, v151
v_mul_f32 v140, v140, v151
v_mul_f32 v141, v141, v151
v_cvt_pk_bf16_f32 v138, v138, v139
v_mul_f32 v142, v142, v151
s_waitcnt lgkmcnt(0)
v_mfma_f32_16x16x32_bf16 v[146:149], v[134:137], v[178:181], v[146:149]
v_mul_f32 v143, v143, v151
v_mul_f32 v144, v144, v151
v_mul_f32 v145, v145, v151
v_cvt_pk_bf16_f32 v139, v140, v141
v_cvt_pk_bf16_f32 v140, v142, v143
v_cvt_pk_bf16_f32 v141, v144, v145
v_cvt_pk_bf16_f32 v174, v154, v155
v_mul_f32 v146, v146, v151
v_mul_f32 v147, v147, v151
v_mul_f32 v148, v148, v151
v_mul_f32 v149, v149, v151
v_mfma_f32_16x16x32_bf16 v[150:153], v[108:111], v[90:93], v[206:209]
ds_write_b128 v211, v[138:141] offset:36864
v_mfma_f32_16x16x32_bf16 v[138:141], v[78:81], v[90:93], 0
v_cvt_pk_bf16_f32 v142, v146, v147
v_cvt_pk_bf16_f32 v143, v148, v149
v_mfma_f32_16x16x32_bf16 v[146:149], v[102:105], v[90:93], 0
v_cvt_pk_bf16_f32 v175, v156, v157
v_cvt_pk_bf16_f32 v176, v158, v159
v_mfma_f32_16x16x16_bf16 v[138:141], v[82:83], v[94:95], v[138:141]
ds_write_b64 v212, v[142:143] offset:36864
v_mfma_f32_16x16x32_bf16 v[142:145], v[96:99], v[90:93], 0
v_cvt_pk_bf16_f32 v177, v160, v161
v_cvt_pk_bf16_f32 v180, v166, 0
v_mfma_f32_16x16x16_bf16 v[150:153], v[112:113], v[94:95], v[150:153]
v_cvt_pk_bf16_f32 v178, v162, v163
v_cvt_pk_bf16_f32 v179, v164, v165
v_mfma_f32_16x16x32_bf16 v[166:169], v[190:193], v[174:177], 0
v_exp_f32 v138, v138
v_mfma_f32_16x16x32_bf16 v[154:157], v[114:117], v[174:177], 0
v_exp_f32 v139, v139
v_mfma_f32_16x16x32_bf16 v[158:161], v[122:125], v[174:177], 0
v_exp_f32 v140, v140
v_mfma_f32_16x16x32_bf16 v[162:165], v[130:133], v[174:177], 0
v_exp_f32 v141, v141
v_mfma_f32_16x16x16_bf16 v[142:145], v[100:101], v[94:95], v[142:145]
v_exp_f32 v150, v150
v_mfma_f32_16x16x32_bf16 v[166:169], v[190:193], v[178:181], v[166:169]
v_cvt_pk_bf16_f32 v174, v138, v139
v_cvt_pk_bf16_f32 v175, v140, v141
v_mfma_f32_16x16x32_bf16 v[154:157], v[118:121], v[178:181], v[154:157]
v_exp_f32 v142, v142
v_mfma_f32_16x16x32_bf16 v[158:161], v[126:129], v[178:181], v[158:161]
v_rcp_f32 v167, v166
v_mfma_f32_16x16x32_bf16 v[162:165], v[134:137], v[178:181], v[162:165]
v_max3_u32 v218, v218, v166, v167
v_mul_f32 v167, s3, v167
v_mfma_f32_16x16x16_bf16 v[146:149], v[106:107], v[94:95], v[146:149]
v_mul_f32 v154, v154, v167
v_mul_f32 v155, v155, v167
v_mul_f32 v156, v156, v167
v_mul_f32 v157, v157, v167
v_cvt_pk_bf16_f32 v154, v154, v155
v_mul_f32 v158, v158, v167
v_mul_f32 v159, v159, v167
v_mul_f32 v160, v160, v167
v_mul_f32 v161, v161, v167
v_cvt_pk_bf16_f32 v155, v156, v157
v_cvt_pk_bf16_f32 v156, v158, v159
v_cvt_pk_bf16_f32 v157, v160, v161
v_mul_f32 v162, v162, v167
v_mul_f32 v163, v163, v167
v_mul_f32 v164, v164, v167
v_mul_f32 v165, v165, v167
v_mfma_f32_16x16x32_bf16 v[166:169], v[72:75], v[108:111], v[206:209]
ds_write_b128 v211, v[154:157] offset:43008
v_mfma_f32_16x16x32_bf16 v[154:157], v[72:75], v[78:81], 0
v_cvt_pk_bf16_f32 v158, v162, v163
v_cvt_pk_bf16_f32 v159, v164, v165
v_mfma_f32_16x16x32_bf16 v[162:165], v[72:75], v[102:105], 0
v_exp_f32 v143, v143
v_mfma_f32_16x16x16_bf16 v[154:157], v[76:77], v[82:83], v[154:157]
ds_write_b64 v212, v[158:159] offset:43008
v_mfma_f32_16x16x32_bf16 v[158:161], v[72:75], v[96:99], 0
v_exp_f32 v144, v144
v_mfma_f32_16x16x16_bf16 v[162:165], v[76:77], v[106:107], v[162:165]
v_exp_f32 v145, v145
v_mfma_f32_16x16x16_bf16 v[158:161], v[76:77], v[100:101], v[158:161]
v_cvt_pk_bf16_f32 v176, v142, v143
v_cvt_pk_bf16_f32 v177, v144, v145
v_mfma_f32_16x16x16_bf16 v[166:169], v[76:77], v[112:113], v[166:169]
v_cvt_pk_bf16_f32 v180, v150, 0
v_exp_f32 v146, v146
v_mfma_f32_16x16x32_bf16 v[150:153], v[190:193], v[174:177], 0
v_exp_f32 v147, v147
v_mfma_f32_16x16x32_bf16 v[138:141], v[114:117], v[174:177], 0
s_waitcnt lgkmcnt(0)
v_exp_f32 v148, v148
v_mfma_f32_16x16x32_bf16 v[142:145], v[122:125], v[174:177], 0
s_barrier
ds_read_b128 v[170:173], v210 offset:36864
v_exp_f32 v149, v149
v_mov_b32_dpp v154, v158 quad_perm:[0,1,2,3] row_mask:0x2 bank_mask:0xf
v_cvt_pk_bf16_f32 v178, v146, v147
v_cvt_pk_bf16_f32 v179, v148, v149
v_mfma_f32_16x16x32_bf16 v[146:149], v[130:133], v[174:177], 0
v_mov_b32_dpp v154, v162 quad_perm:[0,1,2,3] row_mask:0x4 bank_mask:0xf
v_mfma_f32_16x16x32_bf16 v[150:153], v[190:193], v[178:181], v[150:153]
ds_read_b128 v[182:185], v210 offset:37888
v_mov_b32_dpp v154, v167 quad_perm:[0,1,2,3] row_mask:0x8 bank_mask:0xf
v_mfma_f32_16x16x32_bf16 v[138:141], v[118:121], v[178:181], v[138:141]
v_exp_f32 v154, v154
v_mfma_f32_16x16x32_bf16 v[142:145], v[126:129], v[178:181], v[142:145]
v_cvt_pk_bf16_f32 v154, v154, 0
v_rcp_f32 v151, v150
v_mfma_f32_16x16x32_bf16 v[146:149], v[134:137], v[178:181], v[146:149]
s_waitcnt lgkmcnt(1)
ds_write_b16 v214, v154
v_mfma_f32_16x16x32_bf16 v[0:3], a[144:147], v[170:173], v[0:3]
ds_read_b128 v[84:87], v215
ds_read_b128 v[88:91], v215 offset:16
v_mfma_f32_16x16x32_bf16 v[4:7], a[168:171], v[170:173], v[4:7]
ds_read_b128 v[186:189], v210 offset:38912
v_mfma_f32_16x16x32_bf16 v[8:11], a[192:195], v[170:173], v[8:11]
ds_read_b128 v[170:173], v210 offset:39936
s_waitcnt lgkmcnt(5)
v_mfma_f32_16x16x32_bf16 v[0:3], a[148:151], v[182:185], v[0:3]
v_mfma_f32_16x16x32_bf16 v[4:7], a[172:175], v[182:185], v[4:7]
v_mfma_f32_16x16x32_bf16 v[8:11], a[196:199], v[182:185], v[8:11]
ds_read_b128 v[182:185], v210 offset:40960
s_waitcnt lgkmcnt(4)
v_mfma_f32_16x16x32_bf16 v[166:169], v[84:87], v[190:193], 0
v_mfma_f32_16x16x32_bf16 v[154:157], v[84:87], v[114:117], 0
v_mfma_f32_16x16x32_bf16 v[158:161], v[84:87], v[122:125], 0
v_mfma_f32_16x16x32_bf16 v[162:165], v[84:87], v[130:133], 0
s_waitcnt lgkmcnt(3)
v_mfma_f32_16x16x32_bf16 v[166:169], v[88:91], v[190:193], v[166:169]
s_waitcnt lgkmcnt(2)
v_mfma_f32_16x16x32_bf16 v[0:3], a[152:155], v[186:189], v[0:3]
v_mfma_f32_16x16x32_bf16 v[154:157], v[88:91], v[118:121], v[154:157]
v_rcp_f32 v167, v166
v_mfma_f32_16x16x32_bf16 v[4:7], a[176:179], v[186:189], v[4:7]
v_max3_u32 v218, v218, v166, v167
v_max3_u32 v218, v218, v150, v151
v_mfma_f32_16x16x32_bf16 v[158:161], v[88:91], v[126:129], v[158:161]
v_mul_f32 v151, s3, v151
v_mul_f32 v138, v138, v151
v_mfma_f32_16x16x32_bf16 v[8:11], a[200:203], v[186:189], v[8:11]
ds_read_b128 v[186:189], v210 offset:41984
v_mul_f32 v139, v139, v151
v_mfma_f32_16x16x32_bf16 v[162:165], v[88:91], v[134:137], v[162:165]
s_waitcnt lgkmcnt(2)
v_mul_f32 v140, v140, v151
v_mul_f32 v141, v141, v151
v_mfma_f32_16x16x32_bf16 v[0:3], a[156:159], v[170:173], v[0:3]
v_cvt_pk_bf16_f32 v138, v138, v139
v_mul_f32 v142, v142, v151
v_mfma_f32_16x16x32_bf16 v[4:7], a[180:183], v[170:173], v[4:7]
v_mul_f32 v143, v143, v151
v_mul_f32 v144, v144, v151
v_mfma_f32_16x16x32_bf16 v[8:11], a[204:207], v[170:173], v[8:11]
s_waitcnt lgkmcnt(1)
ds_read_b128 v[170:173], v210 offset:43008
v_mul_f32 v145, v145, v151
v_mfma_f32_16x16x32_bf16 v[0:3], a[160:163], v[182:185], v[0:3]
v_cvt_pk_bf16_f32 v139, v140, v141
v_cvt_pk_bf16_f32 v140, v142, v143
v_mfma_f32_16x16x32_bf16 v[4:7], a[184:187], v[182:185], v[4:7]
v_cvt_pk_bf16_f32 v141, v144, v145
v_mul_f32 v146, v146, v151
v_mfma_f32_16x16x32_bf16 v[8:11], a[208:211], v[182:185], v[8:11]
s_waitcnt lgkmcnt(1)
ds_read_b128 v[182:185], v210 offset:44032
ds_write_b128 v211, v[138:141] offset:49152
v_mfma_f32_16x16x32_bf16 v[0:3], a[164:167], v[186:189], v[0:3]
v_mul_f32 v147, v147, v151
v_mul_f32 v148, v148, v151
v_mfma_f32_16x16x32_bf16 v[4:7], a[188:191], v[186:189], v[4:7]
v_mul_f32 v149, v149, v151
v_cvt_pk_bf16_f32 v142, v146, v147
v_mfma_f32_16x16x32_bf16 v[8:11], a[212:215], v[186:189], v[8:11]
s_waitcnt lgkmcnt(2)
ds_read_b128 v[186:189], v210 offset:45056
v_cvt_pk_bf16_f32 v143, v148, v149
v_mfma_f32_16x16x32_bf16 v[12:15], a[144:147], v[170:173], v[12:15]
ds_write_b64 v212, v[142:143] offset:49152
v_mfma_f32_16x16x32_bf16 v[16:19], a[168:171], v[170:173], v[16:19]
v_cvt_pk_bf16_f32 v72, v0, v1
v_cvt_pk_bf16_f32 v73, v2, v3
v_mfma_f32_16x16x32_bf16 v[20:23], a[192:195], v[170:173], v[20:23]
s_waitcnt lgkmcnt(3)
ds_read_b128 v[170:173], v210 offset:46080
buffer_store_dwordx2 v[72:73], v203, s[8:11], s38 offen
v_cvt_pk_bf16_f32 v74, v4, v5
v_mfma_f32_16x16x32_bf16 v[12:15], a[148:151], v[182:185], v[12:15]
v_cvt_pk_bf16_f32 v75, v6, v7
v_mov_b32_dpp v154, v158 quad_perm:[0,1,2,3] row_mask:0x2 bank_mask:0xf
v_mfma_f32_16x16x32_bf16 v[16:19], a[172:175], v[182:185], v[16:19]
v_mul_f32 v167, s3, v167
v_mov_b32_dpp v154, v162 quad_perm:[0,1,2,3] row_mask:0x4 bank_mask:0xf
v_mfma_f32_16x16x32_bf16 v[20:23], a[196:199], v[182:185], v[20:23]
s_waitcnt lgkmcnt(2)
ds_read_b128 v[182:185], v210 offset:47104
v_mul_f32 v154, v154, v167
v_mfma_f32_16x16x32_bf16 v[12:15], a[152:155], v[186:189], v[12:15]
v_cvt_pk_bf16_f32 v154, v154, 0
v_cvt_pk_bf16_f32 v76, v8, v9
v_mfma_f32_16x16x32_bf16 v[16:19], a[176:179], v[186:189], v[16:19]
s_waitcnt lgkmcnt(1)
ds_write_b16 v214, v154
v_mfma_f32_16x16x32_bf16 v[20:23], a[200:203], v[186:189], v[20:23]
s_barrier
v_mfma_f32_16x16x32_bf16 v[12:15], a[156:159], v[170:173], v[12:15]
ds_read_b128 v[186:189], v210 offset:48128
v_mfma_f32_16x16x32_bf16 v[16:19], a[180:183], v[170:173], v[16:19]
v_mfma_f32_16x16x32_bf16 v[20:23], a[204:207], v[170:173], v[20:23]
ds_read_b128 v[170:173], v210 offset:49152
s_waitcnt lgkmcnt(3)
v_mfma_f32_16x16x32_bf16 v[12:15], a[160:163], v[182:185], v[12:15]
buffer_store_dwordx2 v[74:75], v203, s[8:11], s38 offen offset:32
v_cvt_pk_bf16_f32 v77, v10, v11
v_mfma_f32_16x16x32_bf16 v[16:19], a[184:187], v[182:185], v[16:19]
v_add_u32 v215, 1408, v215
v_mfma_f32_16x16x32_bf16 v[20:23], a[208:211], v[182:185], v[20:23]
ds_read_b128 v[182:185], v210 offset:50176
s_waitcnt lgkmcnt(2)
v_mfma_f32_16x16x32_bf16 v[12:15], a[164:167], v[186:189], v[12:15]
v_mfma_f32_16x16x32_bf16 v[16:19], a[188:191], v[186:189], v[16:19]
v_mfma_f32_16x16x32_bf16 v[20:23], a[212:215], v[186:189], v[20:23]
s_waitcnt lgkmcnt(1)
ds_read_b128 v[186:189], v210 offset:51200
v_cvt_pk_bf16_f32 v78, v12, v13
v_cvt_pk_bf16_f32 v79, v14, v15
v_cvt_pk_bf16_f32 v80, v16, v17
v_mfma_f32_16x16x32_bf16 v[24:27], a[144:147], v[170:173], v[24:27]
v_cvt_pk_bf16_f32 v81, v18, v19
v_cvt_pk_bf16_f32 v82, v20, v21
v_mfma_f32_16x16x32_bf16 v[28:31], a[168:171], v[170:173], v[28:31]
v_cvt_pk_bf16_f32 v83, v22, v23
v_mfma_f32_16x16x32_bf16 v[32:35], a[192:195], v[170:173], v[32:35]
ds_read_b128 v[170:173], v210 offset:52224
s_waitcnt lgkmcnt(2)
v_mfma_f32_16x16x32_bf16 v[24:27], a[148:151], v[182:185], v[24:27]
buffer_store_dwordx2 v[76:77], v203, s[8:11], s38 offen offset:64
v_mfma_f32_16x16x32_bf16 v[28:31], a[172:175], v[182:185], v[28:31]
v_mfma_f32_16x16x32_bf16 v[32:35], a[196:199], v[182:185], v[32:35]
ds_read_b128 v[182:185], v210 offset:53248
s_waitcnt lgkmcnt(2)
v_mfma_f32_16x16x32_bf16 v[24:27], a[152:155], v[186:189], v[24:27]
v_mfma_f32_16x16x32_bf16 v[28:31], a[176:179], v[186:189], v[28:31]
v_mfma_f32_16x16x32_bf16 v[32:35], a[200:203], v[186:189], v[32:35]
ds_read_b128 v[186:189], v210 offset:54272
s_waitcnt lgkmcnt(2)
v_mfma_f32_16x16x32_bf16 v[24:27], a[156:159], v[170:173], v[24:27]
v_mfma_f32_16x16x32_bf16 v[28:31], a[180:183], v[170:173], v[28:31]
v_mfma_f32_16x16x32_bf16 v[32:35], a[204:207], v[170:173], v[32:35]
s_waitcnt lgkmcnt(1)
v_mfma_f32_16x16x32_bf16 v[24:27], a[160:163], v[182:185], v[24:27]
v_mfma_f32_16x16x32_bf16 v[28:31], a[184:187], v[182:185], v[28:31]
v_mfma_f32_16x16x32_bf16 v[32:35], a[208:211], v[182:185], v[32:35]
s_waitcnt lgkmcnt(0)
v_mfma_f32_16x16x32_bf16 v[24:27], a[164:167], v[186:189], v[24:27]
v_mfma_f32_16x16x32_bf16 v[28:31], a[188:191], v[186:189], v[28:31]
s_nop 3
v_cvt_pk_bf16_f32 v116, v24, v25
v_cvt_pk_bf16_f32 v117, v26, v27
v_mfma_f32_16x16x32_bf16 v[32:35], a[212:215], v[186:189], v[32:35]
v_cvt_pk_bf16_f32 v124, v28, v29
v_cvt_pk_bf16_f32 v125, v30, v31
s_nop 4
v_cvt_pk_bf16_f32 v132, v32, v33
v_cvt_pk_bf16_f32 v133, v34, v35
buffer_store_dwordx2 v[78:79], v204, s[8:11], s38 offen
buffer_store_dwordx2 v[80:81], v204, s[8:11], s38 offen offset:32
buffer_store_dwordx2 v[82:83], v204, s[8:11], s38 offen offset:64
buffer_store_dwordx2 v[116:117], v205, s[8:11], s38 offen
v_add_u32 v216, 1408, v216
v_add_u32 v214, 1408, v214
buffer_store_dwordx2 v[124:125], v205, s[8:11], s38 offen offset:32
buffer_store_dwordx2 v[132:133], v205, s[8:11], s38 offen offset:64
L_epi:
s_nop 7
v_subrev_u32 v40, 37120, v210
buffer_load_dwordx4 v[72:75], v40, s[24:27], s50 offen
buffer_load_dwordx4 v[76:79], v40, s[24:27], s50 offen offset:1024
buffer_load_dwordx4 v[80:83], v40, s[24:27], s50 offen offset:2048
buffer_load_dwordx4 v[84:87], v40, s[24:27], s50 offen offset:3072
s_add_u32 s41, s50, 4096
buffer_load_dwordx4 v[88:91], v40, s[24:27], s41 offen
buffer_load_dwordx4 v[92:95], v40, s[24:27], s41 offen offset:1024
v_cmp_lt_u32 vcc, 1602224128, v218
v_mov_b32 v41, 162624
v_mov_b32 v42, 1
s_cbranch_vccz L_noflag
ds_write_b32 v41, v42
L_noflag:
s_waitcnt lgkmcnt(0)
s_barrier
ds_read_b32 v42, v41
v_lshrrev_b32 v43, 4, v40
v_and_b32 v43, 15, v43
v_lshrrev_b32 v44, 8, v40
v_mul_u32_u24 v45, 1408, v43
v_lshl_add_u32 v45, v44, 5, v45
v_add_u32 v45, 94464, v45
s_waitcnt lgkmcnt(0)
v_readfirstlane_b32 s43, v42
s_nop 0
s_cmp_lg_u32 s43, 0
s_cbranch_scc1 L_redo
ds_read_b128 v[100:103], v45
ds_read_b128 v[104:107], v45 offset:128
ds_read_b128 v[108:111], v45 offset:256
ds_read_b128 v[112:115], v45 offset:384
ds_read_b64 v[116:117], v45 offset:16
ds_read_b64 v[118:119], v45 offset:144
ds_read_b64 v[120:121], v45 offset:272
ds_read_b64 v[122:123], v45 offset:400
v_lshlrev_b32 v48, 5, v43
s_add_u32 s41, s33, 0
v_add_u32 v48, s41, v48
s_mov_b32 s42, 58835169
v_mul_hi_u32 v49, v48, s42
v_mul_u32_u24 v46, 73, v49
v_sub_u32 v46, v48, v46
v_mul_u32_u24 v46, 2688, v46
s_mov_b32 s42, 1373568
v_mul_lo_u32 v49, v49, s42
s_mul_i32 s42, s32, 96
v_add3_u32 v46, v46, v49, s42
v_cmp_gt_u32 vcc, s34, v48
v_mov_b32 v49, 1879048192
s_nop 0
v_cndmask_b32 v46, v49, v46, vcc
v_lshl_add_u32 v46, v44, 3, v46
v_add_u32 v46, 785664, v46
ds_read_b128 v[124:127], v45 offset:22528
ds_read_b128 v[128:131], v45 offset:22656
ds_read_b128 v[132:135], v45 offset:22784
ds_read_b128 v[136:139], v45 offset:22912
ds_read_b64 v[140:141], v45 offset:22544
ds_read_b64 v[142:143], v45 offset:22672
ds_read_b64 v[144:145], v45 offset:22800
s_waitcnt lgkmcnt(14)
ds_read_b64 v[146:147], v45 offset:22928
v_lshlrev_b32 v48, 5, v43
s_add_u32 s41, s33, 512
v_add_u32 v48, s41, v48
s_mov_b32 s42, 58835169
v_mul_hi_u32 v49, v48, s42
v_mul_u32_u24 v47, 73, v49
v_sub_u32 v47, v48, v47
v_mul_u32_u24 v47, 2688, v47
s_mov_b32 s42, 1373568
v_mul_lo_u32 v49, v49, s42
s_mul_i32 s42, s32, 96
v_add3_u32 v47, v47, v49, s42
v_cmp_gt_u32 vcc, s34, v48
v_mov_b32 v49, 1879048192
s_nop 0
v_cndmask_b32 v47, v49, v47, vcc
v_lshl_add_u32 v47, v44, 3, v47
v_add_u32 v47, 785664, v47
s_waitcnt vmcnt(5)
v_mfma_f32_16x16x32_bf16 v[72:75], a[144:147], v[100:103], v[72:75]
s_waitcnt vmcnt(4)
v_mfma_f32_16x16x32_bf16 v[76:79], a[168:171], v[100:103], v[76:79]
s_waitcnt vmcnt(3)
v_mfma_f32_16x16x32_bf16 v[80:83], a[192:195], v[100:103], v[80:83]
s_waitcnt lgkmcnt(14)
v_mfma_f32_16x16x32_bf16 v[72:75], a[148:151], v[104:107], v[72:75]
v_mfma_f32_16x16x32_bf16 v[76:79], a[172:175], v[104:107], v[76:79]
v_mfma_f32_16x16x32_bf16 v[80:83], a[196:199], v[104:107], v[80:83]
s_waitcnt lgkmcnt(13)
v_mfma_f32_16x16x32_bf16 v[72:75], a[152:155], v[108:111], v[72:75]
v_mfma_f32_16x16x32_bf16 v[76:79], a[176:179], v[108:111], v[76:79]
v_mfma_f32_16x16x32_bf16 v[80:83], a[200:203], v[108:111], v[80:83]
s_waitcnt lgkmcnt(12)
v_mfma_f32_16x16x32_bf16 v[72:75], a[156:159], v[112:115], v[72:75]
v_mfma_f32_16x16x32_bf16 v[76:79], a[180:183], v[112:115], v[76:79]
v_mfma_f32_16x16x32_bf16 v[80:83], a[204:207], v[112:115], v[80:83]
s_waitcnt lgkmcnt(10)
v_mfma_f32_16x16x32_bf16 v[72:75], a[160:163], v[116:119], v[72:75]
v_mfma_f32_16x16x32_bf16 v[76:79], a[184:187], v[116:119], v[76:79]
v_mfma_f32_16x16x32_bf16 v[80:83], a[208:211], v[116:119], v[80:83]
s_waitcnt lgkmcnt(8)
v_mfma_f32_16x16x32_bf16 v[72:75], a[164:167], v[120:123], v[72:75]
v_mfma_f32_16x16x32_bf16 v[76:79], a[188:191], v[120:123], v[76:79]
v_mfma_f32_16x16x32_bf16 v[80:83], a[212:215], v[120:123], v[80:83]
s_waitcnt vmcnt(2) lgkmcnt(7)
v_mfma_f32_16x16x32_bf16 v[84:87], a[144:147], v[124:127], v[84:87]
s_waitcnt vmcnt(1)
v_mfma_f32_16x16x32_bf16 v[88:91], a[168:171], v[124:127], v[88:91]
s_waitcnt vmcnt(0)
v_mfma_f32_16x16x32_bf16 v[92:95], a[192:195], v[124:127], v[92:95]
s_waitcnt lgkmcnt(6)
v_mfma_f32_16x16x32_bf16 v[84:87], a[148:151], v[128:131], v[84:87]
v_mfma_f32_16x16x32_bf16 v[88:91], a[172:175], v[128:131], v[88:91]
v_mfma_f32_16x16x32_bf16 v[92:95], a[196:199], v[128:131], v[92:95]
s_waitcnt lgkmcnt(5)
v_mfma_f32_16x16x32_bf16 v[84:87], a[152:155], v[132:135], v[84:87]
v_mfma_f32_16x16x32_bf16 v[88:91], a[176:179], v[132:135], v[88:91]
v_mfma_f32_16x16x32_bf16 v[92:95], a[200:203], v[132:135], v[92:95]
s_waitcnt lgkmcnt(4)
v_mfma_f32_16x16x32_bf16 v[84:87], a[156:159], v[136:139], v[84:87]
v_mfma_f32_16x16x32_bf16 v[88:91], a[180:183], v[136:139], v[88:91]
v_mfma_f32_16x16x32_bf16 v[92:95], a[204:207], v[136:139], v[92:95]
s_waitcnt lgkmcnt(2)
v_mfma_f32_16x16x32_bf16 v[84:87], a[160:163], v[140:143], v[84:87]
v_mfma_f32_16x16x32_bf16 v[88:91], a[184:187], v[140:143], v[88:91]
v_mfma_f32_16x16x32_bf16 v[92:95], a[208:211], v[140:143], v[92:95]
s_waitcnt lgkmcnt(0)
v_mfma_f32_16x16x32_bf16 v[84:87], a[164:167], v[144:147], v[84:87]
v_mfma_f32_16x16x32_bf16 v[88:91], a[188:191], v[144:147], v[88:91]
v_mfma_f32_16x16x32_bf16 v[92:95], a[212:215], v[144:147], v[92:95]
v_cvt_pk_bf16_f32 v72, v72, v73
v_cvt_pk_bf16_f32 v73, v74, v75
buffer_store_dwordx2 v[72:73], v46, s[8:11], 0 offen
v_cvt_pk_bf16_f32 v76, v76, v77
v_cvt_pk_bf16_f32 v77, v78, v79
buffer_store_dwordx2 v[76:77], v46, s[8:11], 0 offen offset:32
v_cvt_pk_bf16_f32 v80, v80, v81
v_cvt_pk_bf16_f32 v81, v82, v83
buffer_store_dwordx2 v[80:81], v46, s[8:11], 0 offen offset:64
v_cvt_pk_bf16_f32 v84, v84, v85
v_cvt_pk_bf16_f32 v85, v86, v87
buffer_store_dwordx2 v[84:85], v47, s[8:11], 0 offen
v_cvt_pk_bf16_f32 v88, v88, v89
v_cvt_pk_bf16_f32 v89, v90, v91
buffer_store_dwordx2 v[88:89], v47, s[8:11], 0 offen offset:32
v_cvt_pk_bf16_f32 v92, v92, v93
v_cvt_pk_bf16_f32 v93, v94, v95
buffer_store_dwordx2 v[92:93], v47, s[8:11], 0 offen offset:64
L_end:
s_endpgm
L_redo:
s_mov_b32 s47, 1
s_waitcnt vmcnt(0) lgkmcnt(0)
s_barrier
s_branch L_start
L_safe:
s_barrier
s_mov_b32 s38, s36
ds_read_b128 v[174:177], v217
ds_read_b128 v[84:87], v200
s_waitcnt lgkmcnt(0)
v_mfma_f32_16x16x32_bf16 v[36:39], v[174:177], v[84:87], 0
ds_read_b128 v[92:95], v201
s_waitcnt lgkmcnt(0)
v_mfma_f32_16x16x32_bf16 v[48:51], v[174:177], v[92:95], 0
ds_read_b128 v[100:103], v202
s_waitcnt lgkmcnt(0)
v_mfma_f32_16x16x32_bf16 v[60:63], v[174:177], v[100:103], 0
ds_read_b128 v[178:181], v217 offset:528
ds_read_b128 v[84:87], v194
ds_read_b128 v[88:91], v194 offset:16
s_waitcnt lgkmcnt(0)
v_smfmac_f32_16x16x64_bf16 v[36:39], v[178:181], v[84:91], v213
ds_read_b128 v[92:95], v195
ds_read_b128 v[96:99], v195 offset:16
s_waitcnt lgkmcnt(0)
v_smfmac_f32_16x16x64_bf16 v[48:51], v[178:181], v[92:99], v213
ds_read_b128 v[100:103], v196
ds_read_b128 v[104:107], v196 offset:16
s_waitcnt lgkmcnt(0)
v_smfmac_f32_16x16x64_bf16 v[60:63], v[178:181], v[100:107], v213
ds_read_b128 v[174:177], v217 offset:1056
ds_read_b128 v[84:87], v197
ds_read_b128 v[88:91], v197 offset:16
s_waitcnt lgkmcnt(0)
v_smfmac_f32_16x16x64_bf16 v[36:39], v[174:177], v[84:91], v213
ds_read_b128 v[92:95], v198
ds_read_b128 v[96:99], v198 offset:16
s_waitcnt lgkmcnt(0)
v_smfmac_f32_16x16x64_bf16 v[48:51], v[174:177], v[92:99], v213
ds_read_b128 v[100:103], v199
ds_read_b128 v[104:107], v199 offset:16
s_waitcnt lgkmcnt(0)
v_smfmac_f32_16x16x64_bf16 v[60:63], v[174:177], v[100:107], v213
ds_read_b128 v[178:181], v217 offset:1584
ds_read_b128 v[84:87], v200 offset:32
s_waitcnt lgkmcnt(0)
v_mfma_f32_16x16x32_bf16 v[40:43], v[178:181], v[84:87], 0
ds_read_b128 v[92:95], v201 offset:32
s_waitcnt lgkmcnt(0)
v_mfma_f32_16x16x32_bf16 v[52:55], v[178:181], v[92:95], 0
ds_read_b128 v[100:103], v202 offset:32
s_waitcnt lgkmcnt(0)
v_mfma_f32_16x16x32_bf16 v[64:67], v[178:181], v[100:103], 0
ds_read_b128 v[174:177], v217 offset:2112
ds_read_b128 v[84:87], v194 offset:32
ds_read_b128 v[88:91], v194 offset:48
s_waitcnt lgkmcnt(0)
v_smfmac_f32_16x16x64_bf16 v[40:43], v[174:177], v[84:91], v213
ds_read_b128 v[92:95], v195 offset:32
ds_read_b128 v[96:99], v195 offset:48
s_waitcnt lgkmcnt(0)
v_smfmac_f32_16x16x64_bf16 v[52:55], v[174:177], v[92:99], v213
ds_read_b128 v[100:103], v196 offset:32
ds_read_b128 v[104:107], v196 offset:48
s_waitcnt lgkmcnt(0)
v_smfmac_f32_16x16x64_bf16 v[64:67], v[174:177], v[100:107], v213
ds_read_b128 v[178:181], v217 offset:2640
ds_read_b128 v[84:87], v197 offset:32
ds_read_b128 v[88:91], v197 offset:48
s_waitcnt lgkmcnt(0)
v_smfmac_f32_16x16x64_bf16 v[40:43], v[178:181], v[84:91], v213
ds_read_b128 v[92:95], v198 offset:32
ds_read_b128 v[96:99], v198 offset:48
s_waitcnt lgkmcnt(0)
v_smfmac_f32_16x16x64_bf16 v[52:55], v[178:181], v[92:99], v213
ds_read_b128 v[100:103], v199 offset:32
ds_read_b128 v[104:107], v199 offset:48
s_waitcnt lgkmcnt(0)
v_smfmac_f32_16x16x64_bf16 v[64:67], v[178:181], v[100:107], v213
ds_read_b128 v[174:177], v217 offset:3168
ds_read_b128 v[84:87], v200 offset:64
s_waitcnt lgkmcnt(0)
v_mfma_f32_16x16x32_bf16 v[44:47], v[174:177], v[84:87], 0
ds_read_b128 v[92:95], v201 offset:64
s_waitcnt lgkmcnt(0)
v_mfma_f32_16x16x32_bf16 v[56:59], v[174:177], v[92:95], 0
ds_read_b128 v[100:103], v202 offset:64
s_waitcnt lgkmcnt(0)
v_mfma_f32_16x16x32_bf16 v[68:71], v[174:177], v[100:103], 0
ds_read_b128 v[178:181], v217 offset:3696
ds_read_b128 v[84:87], v194 offset:64
ds_read_b128 v[88:91], v194 offset:80
s_waitcnt lgkmcnt(0)
v_smfmac_f32_16x16x64_bf16 v[44:47], v[178:181], v[84:91], v213
ds_read_b128 v[92:95], v195 offset:64
ds_read_b128 v[96:99], v195 offset:80
s_waitcnt lgkmcnt(0)
v_smfmac_f32_16x16x64_bf16 v[56:59], v[178:181], v[92:99], v213
ds_read_b128 v[100:103], v196 offset:64
ds_read_b128 v[104:107], v196 offset:80
s_waitcnt lgkmcnt(0)
v_smfmac_f32_16x16x64_bf16 v[68:71], v[178:181], v[100:107], v213
ds_read_b128 v[174:177], v217 offset:4224
ds_read_b128 v[84:87], v197 offset:64
ds_read_b128 v[88:91], v197 offset:80
s_waitcnt lgkmcnt(0)
v_smfmac_f32_16x16x64_bf16 v[44:47], v[174:177], v[84:91], v213
ds_read_b128 v[92:95], v198 offset:64
ds_read_b128 v[96:99], v198 offset:80
s_waitcnt lgkmcnt(0)
v_smfmac_f32_16x16x64_bf16 v[56:59], v[174:177], v[92:99], v213
ds_read_b128 v[100:103], v199 offset:64
ds_read_b128 v[104:107], v199 offset:80
s_waitcnt lgkmcnt(0)
v_smfmac_f32_16x16x64_bf16 v[68:71], v[174:177], v[100:107], v213
v_add_f32 v118, v36, v37
v_mul_f32 v119, v36, v36
v_add_f32 v118, v118, v38
v_fmac_f32 v119, v37, v37
v_add_f32 v118, v118, v39
v_fmac_f32 v119, v38, v38
v_fmac_f32 v119, v39, v39
v_add_f32 v126, v48, v49
v_mul_f32 v127, v48, v48
v_add_f32 v126, v126, v50
v_fmac_f32 v127, v49, v49
v_add_f32 v126, v126, v51
v_fmac_f32 v127, v50, v50
v_fmac_f32 v127, v51, v51
v_add_f32 v134, v60, v61
v_mul_f32 v135, v60, v60
v_add_f32 v134, v134, v62
v_fmac_f32 v135, v61, v61
v_add_f32 v134, v134, v63
v_fmac_f32 v135, v62, v62
v_fmac_f32 v135, v63, v63
v_add_f32 v118, v118, v40
v_fmac_f32 v119, v40, v40
v_add_f32 v118, v118, v41
v_fmac_f32 v119, v41, v41
v_add_f32 v118, v118, v42
v_fmac_f32 v119, v42, v42
v_add_f32 v118, v118, v43
v_fmac_f32 v119, v43, v43
v_add_f32 v126, v126, v52
v_fmac_f32 v127, v52, v52
v_add_f32 v126, v126, v53
v_fmac_f32 v127, v53, v53
v_add_f32 v126, v126, v54
v_fmac_f32 v127, v54, v54
v_add_f32 v126, v126, v55
v_fmac_f32 v127, v55, v55
v_add_f32 v134, v134, v64
v_fmac_f32 v135, v64, v64
v_add_f32 v134, v134, v65
v_fmac_f32 v135, v65, v65
v_add_f32 v134, v134, v66
v_fmac_f32 v135, v66, v66
v_add_f32 v134, v134, v67
v_fmac_f32 v135, v67, v67
v_add_f32 v118, v118, v44
v_fmac_f32 v119, v44, v44
v_add_f32 v118, v118, v45
v_fmac_f32 v119, v45, v45
v_add_f32 v118, v118, v46
v_fmac_f32 v119, v46, v46
v_add_f32 v118, v118, v47
v_fmac_f32 v119, v47, v47
v_add_f32 v126, v126, v56
v_fmac_f32 v127, v56, v56
v_add_f32 v126, v126, v57
v_fmac_f32 v127, v57, v57
v_add_f32 v126, v126, v58
v_fmac_f32 v127, v58, v58
v_add_f32 v126, v126, v59
v_fmac_f32 v127, v59, v59
v_add_f32 v134, v134, v68
v_fmac_f32 v135, v68, v68
v_add_f32 v134, v134, v69
v_fmac_f32 v135, v69, v69
v_add_f32 v134, v134, v70
v_fmac_f32 v135, v70, v70
v_add_f32 v134, v134, v71
v_fmac_f32 v135, v71, v71
v_permlane16_swap_b32 v118, v119
v_add_f32 v118, v118, v119
v_permlane16_swap_b32 v126, v127
v_add_f32 v126, v126, v127
v_permlane16_swap_b32 v134, v135
v_add_f32 v134, v134, v135
v_permlane32_swap_b32 v118, v126
v_add_f32 v118, v118, v126
ds_write_b32 v209, v118
v_mov_b32 v135, v134
s_nop 1
v_permlane32_swap_b32 v134, v135
v_add_f32 v134, v134, v135
ds_write_b32 v209, v134 offset:512
s_waitcnt lgkmcnt(0)
s_barrier
s_mul_hi_u32 s41, s35, 58835169
s_mul_i32 s42, s41, 73
s_sub_u32 s42, s35, s42
s_mul_i32 s43, s41, 1373568
s_mul_i32 s51, s42, 2688
s_add_u32 s43, s43, s51
s_cmp_lt_u32 s35, s34
s_cselect_b32 s36, s43, 1879048192
s_add_u32 s35, s35, 32
s_cmp_eq_u32 s42, 0
s_cselect_b32 s44, 536870911, s72
s_cmp_eq_u32 s42, 72
s_cselect_b32 s44, 939524095, s44
s_cmp_eq_u32 s41, 0
s_cselect_b32 s40, 1879048192, s36
v_and_b32 v180, s44, v208
s_add_u32 m0, s45, 0
s_nop 0
buffer_load_dwordx4 v180, s[4:7], s40 offen nt lds
s_add_u32 m0, s45, 4112
s_add_u32 s40, s36, 196224
buffer_load_dwordx4 v180, s[4:7], s40 offen nt lds
s_add_u32 m0, s45, 8224
s_add_u32 s40, s36, 392448
buffer_load_dwordx4 v180, s[4:7], s40 offen nt lds
s_add_u32 m0, s45, 12336
s_add_u32 s40, s36, 588672
buffer_load_dwordx4 v180, s[4:7], s40 offen nt lds
s_add_u32 m0, s45, 16448
s_add_u32 s40, s36, 784896
buffer_load_dwordx4 v180, s[4:7], s40 offen nt lds
s_add_u32 m0, s45, 20560
s_add_u32 s40, s36, 981120
buffer_load_dwordx4 v180, s[4:7], s40 offen nt lds
s_add_u32 m0, s45, 24672
s_add_u32 s40, s36, 1177344
buffer_load_dwordx4 v180, s[4:7], s40 offen nt lds
s_add_u32 m0, s45, 28784
s_add_u32 s40, s36, 1373568
buffer_load_dwordx4 v180, s[4:7], s40 offen nt lds
s_add_u32 m0, s45, 32896
s_add_u32 s40, s36, 1569792
buffer_load_dwordx4 v180, s[4:7], s40 offen nt lds
ds_read_b128 v[102:105], v210 offset:55296
ds_read_b128 v[106:109], v210 offset:56320
s_waitcnt lgkmcnt(1)
v_add_f32 v102, v102, v103
s_waitcnt lgkmcnt(0)
v_add_f32 v106, v106, v107
v_add_f32 v104, v104, v105
v_add_f32 v108, v108, v109
v_add_f32 v102, v102, v104
v_add_f32 v106, v106, v108
v_mul_f32 v103, s48, v102
v_mul_f32 v104, s73, v102
v_mul_f32 v106, s73, v106
v_fma_f32 v106, -v103, v104, v106
v_max_f32 v106, 0, v106
v_add_f32 v106, s49, v106
v_rsq_f32 v102, v106
s_nop 0
v_mul_f32_e64 v103, -v103, v102
ds_write_b64 v211, v[102:103] offset:36864
ds_read_b64 v[118:119], v219
ds_read_b64 v[126:127], v219 offset:256
ds_read_b64 v[134:135], v219 offset:512
s_waitcnt lgkmcnt(2)
v_fma_f32 v220, v36, v118, v119
v_fma_f32 v221, v37, v118, v119
v_cvt_pk_bf16_f32 v90, v220, v221
v_fma_f32 v222, v38, v118, v119
v_fma_f32 v223, v39, v118, v119
v_cvt_pk_bf16_f32 v91, v222, v223
v_fma_f32 v220, v40, v118, v119
v_fma_f32 v221, v41, v118, v119
v_cvt_pk_bf16_f32 v92, v220, v221
v_fma_f32 v222, v42, v118, v119
v_fma_f32 v223, v43, v118, v119
v_cvt_pk_bf16_f32 v93, v222, v223
ds_write_b128 v211, v[90:93] offset:18432
v_fma_f32 v220, v44, v118, v119
v_fma_f32 v221, v45, v118, v119
v_cvt_pk_bf16_f32 v94, v220, v221
v_fma_f32 v222, v46, v118, v119
v_fma_f32 v223, v47, v118, v119
v_cvt_pk_bf16_f32 v95, v222, v223
s_waitcnt lgkmcnt(2)
ds_write_b64 v212, v[94:95] offset:18432
v_fma_f32 v220, v48, v126, v127
v_fma_f32 v221, v49, v126, v127
v_cvt_pk_bf16_f32 v174, v220, v221
v_fma_f32 v222, v50, v126, v127
v_fma_f32 v223, v51, v126, v127
v_cvt_pk_bf16_f32 v175, v222, v223
v_fma_f32 v220, v52, v126, v127
v_fma_f32 v221, v53, v126, v127
v_cvt_pk_bf16_f32 v176, v220, v221
v_fma_f32 v222, v54, v126, v127
v_fma_f32 v223, v55, v126, v127
v_cvt_pk_bf16_f32 v177, v222, v223
ds_write_b128 v211, v[174:177] offset:24576
v_fma_f32 v220, v56, v126, v127
v_fma_f32 v221, v57, v126, v127
v_cvt_pk_bf16_f32 v178, v220, v221
v_fma_f32 v222, v58, v126, v127
v_fma_f32 v223, v59, v126, v127
v_cvt_pk_bf16_f32 v179, v222, v223
s_waitcnt lgkmcnt(3)
ds_write_b64 v212, v[178:179] offset:24576
v_fma_f32 v220, v60, v134, v135
v_fma_f32 v221, v61, v134, v135
v_cvt_pk_bf16_f32 v90, v220, v221
v_fma_f32 v222, v62, v134, v135
v_fma_f32 v223, v63, v134, v135
v_cvt_pk_bf16_f32 v91, v222, v223
v_fma_f32 v220, v64, v134, v135
v_fma_f32 v221, v65, v134, v135
v_cvt_pk_bf16_f32 v92, v220, v221
v_fma_f32 v222, v66, v134, v135
v_fma_f32 v223, v67, v134, v135
v_cvt_pk_bf16_f32 v93, v222, v223
ds_write_b128 v211, v[90:93] offset:30720
v_fma_f32 v220, v68, v134, v135
v_fma_f32 v221, v69, v134, v135
v_cvt_pk_bf16_f32 v94, v220, v221
v_fma_f32 v222, v70, v134, v135
v_fma_f32 v223, v71, v134, v135
v_cvt_pk_bf16_f32 v95, v222, v223
ds_write_b64 v212, v[94:95] offset:30720
ds_read_b128 v[182:185], v210
s_waitcnt lgkmcnt(0)
v_mfma_f32_16x16x32_bf16 v[138:141], a[0:3], v[182:185], 0
v_mfma_f32_16x16x32_bf16 v[142:145], a[24:27], v[182:185], 0
v_mfma_f32_16x16x32_bf16 v[146:149], a[48:51], v[182:185], 0
v_mfma_f32_16x16x32_bf16 v[150:153], a[216:219], v[182:185], 0
v_mfma_f32_16x16x32_bf16 v[154:157], a[240:243], v[182:185], 0
v_mfma_f32_16x16x32_bf16 v[158:161], v[232:235], v[182:185], 0
v_mfma_f32_16x16x32_bf16 v[162:165], v[182:185], a[72:75], 0
v_mfma_f32_16x16x32_bf16 v[166:169], v[182:185], a[96:99], 0
v_mfma_f32_16x16x32_bf16 v[170:173], v[182:185], a[120:123], 0
ds_read_b128 v[186:189], v210 offset:1024
s_waitcnt lgkmcnt(0)
v_mfma_f32_16x16x32_bf16 v[138:141], a[4:7], v[186:189], v[138:141]
v_mfma_f32_16x16x32_bf16 v[142:145], a[28:31], v[186:189], v[142:145]
v_mfma_f32_16x16x32_bf16 v[146:149], a[52:55], v[186:189], v[146:149]
v_mfma_f32_16x16x32_bf16 v[150:153], a[220:223], v[186:189], v[150:153]
v_mfma_f32_16x16x32_bf16 v[154:157], a[244:247], v[186:189], v[154:157]
v_mfma_f32_16x16x32_bf16 v[158:161], v[236:239], v[186:189], v[158:161]
v_mfma_f32_16x16x32_bf16 v[162:165], v[186:189], a[76:79], v[162:165]
v_mfma_f32_16x16x32_bf16 v[166:169], v[186:189], a[100:103], v[166:169]
v_mfma_f32_16x16x32_bf16 v[170:173], v[186:189], a[124:127], v[170:173]
ds_read_b128 v[182:185], v210 offset:2048
s_waitcnt lgkmcnt(0)
v_mfma_f32_16x16x32_bf16 v[138:141], a[8:11], v[182:185], v[138:141]
v_mfma_f32_16x16x32_bf16 v[142:145], a[32:35], v[182:185], v[142:145]
v_mfma_f32_16x16x32_bf16 v[146:149], a[56:59], v[182:185], v[146:149]
v_mfma_f32_16x16x32_bf16 v[150:153], a[224:227], v[182:185], v[150:153]
v_mfma_f32_16x16x32_bf16 v[154:157], a[248:251], v[182:185], v[154:157]
v_mfma_f32_16x16x32_bf16 v[158:161], v[240:243], v[182:185], v[158:161]
v_mfma_f32_16x16x32_bf16 v[162:165], v[182:185], a[80:83], v[162:165]
v_mfma_f32_16x16x32_bf16 v[166:169], v[182:185], a[104:107], v[166:169]
v_mfma_f32_16x16x32_bf16 v[170:173], v[182:185], a[128:131], v[170:173]
ds_read_b128 v[186:189], v210 offset:3072
s_waitcnt lgkmcnt(0)
v_mfma_f32_16x16x32_bf16 v[138:141], a[12:15], v[186:189], v[138:141]
v_mfma_f32_16x16x32_bf16 v[142:145], a[36:39], v[186:189], v[142:145]
v_mfma_f32_16x16x32_bf16 v[146:149], a[60:63], v[186:189], v[146:149]
v_mfma_f32_16x16x32_bf16 v[150:153], a[228:231], v[186:189], v[150:153]
v_mfma_f32_16x16x32_bf16 v[154:157], a[252:255], v[186:189], v[154:157]
v_mfma_f32_16x16x32_bf16 v[158:161], v[244:247], v[186:189], v[158:161]
v_mfma_f32_16x16x32_bf16 v[162:165], v[186:189], a[84:87], v[162:165]
v_mfma_f32_16x16x32_bf16 v[166:169], v[186:189], a[108:111], v[166:169]
v_mfma_f32_16x16x32_bf16 v[170:173], v[186:189], a[132:135], v[170:173]
ds_read_b128 v[182:185], v210 offset:4096
s_waitcnt lgkmcnt(0)
v_mfma_f32_16x16x32_bf16 v[138:141], a[16:19], v[182:185], v[138:141]
v_mfma_f32_16x16x32_bf16 v[142:145], a[40:43], v[182:185], v[142:145]
v_mfma_f32_16x16x32_bf16 v[146:149], a[64:67], v[182:185], v[146:149]
v_mfma_f32_16x16x32_bf16 v[150:153], a[232:235], v[182:185], v[150:153]
v_mfma_f32_16x16x32_bf16 v[154:157], v[224:227], v[182:185], v[154:157]
v_mfma_f32_16x16x32_bf16 v[158:161], v[248:251], v[182:185], v[158:161]
v_mfma_f32_16x16x32_bf16 v[162:165], v[182:185], a[88:91], v[162:165]
v_mfma_f32_16x16x32_bf16 v[166:169], v[182:185], a[112:115], v[166:169]
v_mfma_f32_16x16x32_bf16 v[170:173], v[182:185], a[136:139], v[170:173]
ds_read_b128 v[186:189], v210 offset:5120
s_waitcnt lgkmcnt(0)
v_mfma_f32_16x16x32_bf16 v[138:141], a[20:23], v[186:189], v[138:141]
v_mfma_f32_16x16x32_bf16 v[142:145], a[44:47], v[186:189], v[142:145]
v_mfma_f32_16x16x32_bf16 v[146:149], a[68:71], v[186:189], v[146:149]
v_mfma_f32_16x16x32_bf16 v[150:153], a[236:239], v[186:189], v[150:153]
v_mfma_f32_16x16x32_bf16 v[154:157], v[228:231], v[186:189], v[154:157]
v_mfma_f32_16x16x32_bf16 v[158:161], v[252:255], v[186:189], v[158:161]
v_mfma_f32_16x16x32_bf16 v[162:165], v[186:189], a[92:95], v[162:165]
v_mfma_f32_16x16x32_bf16 v[166:169], v[186:189], a[116:119], v[166:169]
v_mfma_f32_16x16x32_bf16 v[170:173], v[186:189], a[140:143], v[170:173]
v_cvt_pk_bf16_f32 v78, v138, v139
v_cvt_pk_bf16_f32 v79, v140, v141
v_cvt_pk_bf16_f32 v80, v142, v143
v_cvt_pk_bf16_f32 v81, v144, v145
v_cvt_pk_bf16_f32 v82, v146, v147
v_cvt_pk_bf16_f32 v83, v148, v149
v_cvt_pk_bf16_f32 v72, v150, v151
v_cvt_pk_bf16_f32 v73, v152, v153
v_cvt_pk_bf16_f32 v74, v154, v155
v_cvt_pk_bf16_f32 v75, v156, v157
v_cvt_pk_bf16_f32 v76, v158, v159
v_cvt_pk_bf16_f32 v77, v160, v161
v_cvt_pk_bf16_f32 v114, v162, v163
v_cvt_pk_bf16_f32 v115, v164, v165
v_cvt_pk_bf16_f32 v122, v166, v167
v_cvt_pk_bf16_f32 v123, v168, v169
v_cvt_pk_bf16_f32 v130, v170, v171
v_cvt_pk_bf16_f32 v131, v172, v173
ds_read_b128 v[182:185], v210 offset:6144
s_waitcnt lgkmcnt(0)
v_mfma_f32_16x16x32_bf16 v[138:141], a[0:3], v[182:185], 0
v_mfma_f32_16x16x32_bf16 v[142:145], a[24:27], v[182:185], 0
v_mfma_f32_16x16x32_bf16 v[146:149], a[48:51], v[182:185], 0
v_mfma_f32_16x16x32_bf16 v[150:153], a[216:219], v[182:185], 0
v_mfma_f32_16x16x32_bf16 v[154:157], a[240:243], v[182:185], 0
v_mfma_f32_16x16x32_bf16 v[158:161], v[232:235], v[182:185], 0
v_mfma_f32_16x16x32_bf16 v[162:165], v[182:185], a[72:75], 0
v_mfma_f32_16x16x32_bf16 v[166:169], v[182:185], a[96:99], 0
v_mfma_f32_16x16x32_bf16 v[170:173], v[182:185], a[120:123], 0
ds_read_b128 v[186:189], v210 offset:7168
s_waitcnt lgkmcnt(0)
v_mfma_f32_16x16x32_bf16 v[138:141], a[4:7], v[186:189], v[138:141]
v_mfma_f32_16x16x32_bf16 v[142:145], a[28:31], v[186:189], v[142:145]
v_mfma_f32_16x16x32_bf16 v[146:149], a[52:55], v[186:189], v[146:149]
v_mfma_f32_16x16x32_bf16 v[150:153], a[220:223], v[186:189], v[150:153]
v_mfma_f32_16x16x32_bf16 v[154:157], a[244:247], v[186:189], v[154:157]
v_mfma_f32_16x16x32_bf16 v[158:161], v[236:239], v[186:189], v[158:161]
v_mfma_f32_16x16x32_bf16 v[162:165], v[186:189], a[76:79], v[162:165]
v_mfma_f32_16x16x32_bf16 v[166:169], v[186:189], a[100:103], v[166:169]
v_mfma_f32_16x16x32_bf16 v[170:173], v[186:189], a[124:127], v[170:173]
ds_read_b128 v[182:185], v210 offset:8192
s_waitcnt lgkmcnt(0)
v_mfma_f32_16x16x32_bf16 v[138:141], a[8:11], v[182:185], v[138:141]
v_mfma_f32_16x16x32_bf16 v[142:145], a[32:35], v[182:185], v[142:145]
v_mfma_f32_16x16x32_bf16 v[146:149], a[56:59], v[182:185], v[146:149]
v_mfma_f32_16x16x32_bf16 v[150:153], a[224:227], v[182:185], v[150:153]
v_mfma_f32_16x16x32_bf16 v[154:157], a[248:251], v[182:185], v[154:157]
v_mfma_f32_16x16x32_bf16 v[158:161], v[240:243], v[182:185], v[158:161]
v_mfma_f32_16x16x32_bf16 v[162:165], v[182:185], a[80:83], v[162:165]
v_mfma_f32_16x16x32_bf16 v[166:169], v[182:185], a[104:107], v[166:169]
v_mfma_f32_16x16x32_bf16 v[170:173], v[182:185], a[128:131], v[170:173]
ds_read_b128 v[186:189], v210 offset:9216
s_waitcnt lgkmcnt(0)
v_mfma_f32_16x16x32_bf16 v[138:141], a[12:15], v[186:189], v[138:141]
v_mfma_f32_16x16x32_bf16 v[142:145], a[36:39], v[186:189], v[142:145]
v_mfma_f32_16x16x32_bf16 v[146:149], a[60:63], v[186:189], v[146:149]
v_mfma_f32_16x16x32_bf16 v[150:153], a[228:231], v[186:189], v[150:153]
v_mfma_f32_16x16x32_bf16 v[154:157], a[252:255], v[186:189], v[154:157]
v_mfma_f32_16x16x32_bf16 v[158:161], v[244:247], v[186:189], v[158:161]
v_mfma_f32_16x16x32_bf16 v[162:165], v[186:189], a[84:87], v[162:165]
v_mfma_f32_16x16x32_bf16 v[166:169], v[186:189], a[108:111], v[166:169]
v_mfma_f32_16x16x32_bf16 v[170:173], v[186:189], a[132:135], v[170:173]
ds_read_b128 v[182:185], v210 offset:10240
s_waitcnt lgkmcnt(0)
v_mfma_f32_16x16x32_bf16 v[138:141], a[16:19], v[182:185], v[138:141]
v_mfma_f32_16x16x32_bf16 v[142:145], a[40:43], v[182:185], v[142:145]
v_mfma_f32_16x16x32_bf16 v[146:149], a[64:67], v[182:185], v[146:149]
v_mfma_f32_16x16x32_bf16 v[150:153], a[232:235], v[182:185], v[150:153]
v_mfma_f32_16x16x32_bf16 v[154:157], v[224:227], v[182:185], v[154:157]
v_mfma_f32_16x16x32_bf16 v[158:161], v[248:251], v[182:185], v[158:161]
v_mfma_f32_16x16x32_bf16 v[162:165], v[182:185], a[88:91], v[162:165]
v_mfma_f32_16x16x32_bf16 v[166:169], v[182:185], a[112:115], v[166:169]
v_mfma_f32_16x16x32_bf16 v[170:173], v[182:185], a[136:139], v[170:173]
ds_read_b128 v[186:189], v210 offset:11264
s_waitcnt lgkmcnt(0)
v_mfma_f32_16x16x32_bf16 v[138:141], a[20:23], v[186:189], v[138:141]
v_mfma_f32_16x16x32_bf16 v[142:145], a[44:47], v[186:189], v[142:145]
v_mfma_f32_16x16x32_bf16 v[146:149], a[68:71], v[186:189], v[146:149]
v_mfma_f32_16x16x32_bf16 v[150:153], a[236:239], v[186:189], v[150:153]
v_mfma_f32_16x16x32_bf16 v[154:157], v[228:231], v[186:189], v[154:157]
v_mfma_f32_16x16x32_bf16 v[158:161], v[252:255], v[186:189], v[158:161]
v_mfma_f32_16x16x32_bf16 v[162:165], v[186:189], a[92:95], v[162:165]
v_mfma_f32_16x16x32_bf16 v[166:169], v[186:189], a[116:119], v[166:169]
v_mfma_f32_16x16x32_bf16 v[170:173], v[186:189], a[140:143], v[170:173]
v_cvt_pk_bf16_f32 v96, v138, v139
v_cvt_pk_bf16_f32 v97, v140, v141
v_cvt_pk_bf16_f32 v98, v142, v143
v_cvt_pk_bf16_f32 v99, v144, v145
v_cvt_pk_bf16_f32 v100, v146, v147
v_cvt_pk_bf16_f32 v101, v148, v149
v_cvt_pk_bf16_f32 v84, v150, v151
v_cvt_pk_bf16_f32 v85, v152, v153
v_cvt_pk_bf16_f32 v86, v154, v155
v_cvt_pk_bf16_f32 v87, v156, v157
v_cvt_pk_bf16_f32 v88, v158, v159
v_cvt_pk_bf16_f32 v89, v160, v161
v_cvt_pk_bf16_f32 v116, v162, v163
v_cvt_pk_bf16_f32 v117, v164, v165
v_cvt_pk_bf16_f32 v124, v166, v167
v_cvt_pk_bf16_f32 v125, v168, v169
v_cvt_pk_bf16_f32 v132, v170, v171
v_cvt_pk_bf16_f32 v133, v172, v173
ds_read_b128 v[182:185], v210 offset:12288
s_waitcnt lgkmcnt(0)
v_mfma_f32_16x16x32_bf16 v[138:141], a[0:3], v[182:185], 0
v_mfma_f32_16x16x32_bf16 v[142:145], a[24:27], v[182:185], 0
v_mfma_f32_16x16x32_bf16 v[146:149], a[48:51], v[182:185], 0
ds_read_b128 v[186:189], v210 offset:13312
s_waitcnt lgkmcnt(0)
v_mfma_f32_16x16x32_bf16 v[138:141], a[4:7], v[186:189], v[138:141]
v_mfma_f32_16x16x32_bf16 v[142:145], a[28:31], v[186:189], v[142:145]
v_mfma_f32_16x16x32_bf16 v[146:149], a[52:55], v[186:189], v[146:149]
ds_read_b128 v[182:185], v210 offset:14336
s_waitcnt lgkmcnt(0)
v_mfma_f32_16x16x32_bf16 v[138:141], a[8:11], v[182:185], v[138:141]
v_mfma_f32_16x16x32_bf16 v[142:145], a[32:35], v[182:185], v[142:145]
v_mfma_f32_16x16x32_bf16 v[146:149], a[56:59], v[182:185], v[146:149]
ds_read_b128 v[186:189], v210 offset:15360
s_waitcnt lgkmcnt(0)
v_mfma_f32_16x16x32_bf16 v[138:141], a[12:15], v[186:189], v[138:141]
v_mfma_f32_16x16x32_bf16 v[142:145], a[36:39], v[186:189], v[142:145]
v_mfma_f32_16x16x32_bf16 v[146:149], a[60:63], v[186:189], v[146:149]
ds_read_b128 v[182:185], v210 offset:16384
s_waitcnt lgkmcnt(0)
v_mfma_f32_16x16x32_bf16 v[138:141], a[16:19], v[182:185], v[138:141]
v_mfma_f32_16x16x32_bf16 v[142:145], a[40:43], v[182:185], v[142:145]
v_mfma_f32_16x16x32_bf16 v[146:149], a[64:67], v[182:185], v[146:149]
ds_read_b128 v[186:189], v210 offset:17408
s_waitcnt lgkmcnt(0)
v_mfma_f32_16x16x32_bf16 v[138:141], a[20:23], v[186:189], v[138:141]
v_mfma_f32_16x16x32_bf16 v[142:145], a[44:47], v[186:189], v[142:145]
v_mfma_f32_16x16x32_bf16 v[146:149], a[68:71], v[186:189], v[146:149]
v_cvt_pk_bf16_f32 v102, v138, v139
v_cvt_pk_bf16_f32 v103, v140, v141
s_nop 0
v_cvt_pk_bf16_f32 v104, v142, v143
v_cvt_pk_bf16_f32 v105, v144, v145
s_nop 1
v_cvt_pk_bf16_f32 v106, v146, v147
v_cvt_pk_bf16_f32 v107, v148, v149
ds_read_b128 v[108:111], v215 offset:512
ds_read_b64 v[112:113], v215 offset:528
v_mov_b32 v181, 0
v_mfma_f32_16x16x32_bf16 v[138:141], v[78:81], v[72:75], 0
v_mfma_f32_16x16x32_bf16 v[142:145], v[96:99], v[72:75], 0
s_waitcnt lgkmcnt(1)
v_mfma_f32_16x16x32_bf16 v[150:153], v[108:111], v[72:75], v[206:209]
v_mfma_f32_16x16x32_bf16 v[146:149], v[102:105], v[72:75], 0
v_mfma_f32_16x16x16_bf16 v[138:141], v[82:83], v[76:77], v[138:141]
v_mfma_f32_16x16x16_bf16 v[142:145], v[100:101], v[76:77], v[142:145]
s_waitcnt lgkmcnt(0)
v_mfma_f32_16x16x16_bf16 v[150:153], v[112:113], v[76:77], v[150:153]
v_mfma_f32_16x16x16_bf16 v[146:149], v[106:107], v[76:77], v[146:149]
ds_read_b128 v[72:75], v215
ds_read_b64 v[76:77], v215 offset:16
v_mfma_f32_16x16x32_bf16 v[154:157], v[78:81], v[84:87], 0
v_mfma_f32_16x16x32_bf16 v[158:161], v[96:99], v[84:87], 0
v_mfma_f32_16x16x32_bf16 v[166:169], v[108:111], v[84:87], v[206:209]
v_mfma_f32_16x16x32_bf16 v[162:165], v[102:105], v[84:87], 0
v_mfma_f32_16x16x16_bf16 v[154:157], v[82:83], v[88:89], v[154:157]
v_mfma_f32_16x16x16_bf16 v[158:161], v[100:101], v[88:89], v[158:161]
v_mfma_f32_16x16x16_bf16 v[166:169], v[112:113], v[88:89], v[166:169]
v_mfma_f32_16x16x16_bf16 v[162:165], v[106:107], v[88:89], v[162:165]
ds_read_b128 v[182:185], v210 offset:12288
s_waitcnt lgkmcnt(0)
v_mfma_f32_16x16x32_bf16 v[118:121], v[182:185], a[72:75], 0
v_mfma_f32_16x16x32_bf16 v[126:129], v[182:185], a[96:99], 0
v_mfma_f32_16x16x32_bf16 v[134:137], v[182:185], a[120:123], 0
v_mfma_f32_16x16x32_bf16 v[90:93], a[216:219], v[182:185], 0
v_mfma_f32_16x16x32_bf16 v[170:173], a[240:243], v[182:185], 0
v_mfma_f32_16x16x32_bf16 v[220:223], v[232:235], v[182:185], 0
ds_read_b128 v[186:189], v210 offset:13312
s_waitcnt lgkmcnt(0)
v_mfma_f32_16x16x32_bf16 v[118:121], v[186:189], a[76:79], v[118:121]
v_mfma_f32_16x16x32_bf16 v[126:129], v[186:189], a[100:103], v[126:129]
v_mfma_f32_16x16x32_bf16 v[134:137], v[186:189], a[124:127], v[134:137]
v_mfma_f32_16x16x32_bf16 v[90:93], a[220:223], v[186:189], v[90:93]
v_mfma_f32_16x16x32_bf16 v[170:173], a[244:247], v[186:189], v[170:173]
v_mfma_f32_16x16x32_bf16 v[220:223], v[236:239], v[186:189], v[220:223]
ds_read_b128 v[182:185], v210 offset:14336
s_waitcnt lgkmcnt(0)
v_mfma_f32_16x16x32_bf16 v[118:121], v[182:185], a[80:83], v[118:121]
v_mfma_f32_16x16x32_bf16 v[126:129], v[182:185], a[104:107], v[126:129]
v_mfma_f32_16x16x32_bf16 v[134:137], v[182:185], a[128:131], v[134:137]
v_mfma_f32_16x16x32_bf16 v[90:93], a[224:227], v[182:185], v[90:93]
v_mfma_f32_16x16x32_bf16 v[170:173], a[248:251], v[182:185], v[170:173]
v_mfma_f32_16x16x32_bf16 v[220:223], v[240:243], v[182:185], v[220:223]
ds_read_b128 v[186:189], v210 offset:15360
s_waitcnt lgkmcnt(0)
v_mfma_f32_16x16x32_bf16 v[118:121], v[186:189], a[84:87], v[118:121]
v_mfma_f32_16x16x32_bf16 v[126:129], v[186:189], a[108:111], v[126:129]
v_mfma_f32_16x16x32_bf16 v[134:137], v[186:189], a[132:135], v[134:137]
v_mfma_f32_16x16x32_bf16 v[90:93], a[228:231], v[186:189], v[90:93]
v_mfma_f32_16x16x32_bf16 v[170:173], a[252:255], v[186:189], v[170:173]
v_mfma_f32_16x16x32_bf16 v[220:223], v[244:247], v[186:189], v[220:223]
ds_read_b128 v[182:185], v210 offset:16384
s_waitcnt lgkmcnt(0)
v_mfma_f32_16x16x32_bf16 v[118:121], v[182:185], a[88:91], v[118:121]
v_mfma_f32_16x16x32_bf16 v[126:129], v[182:185], a[112:115], v[126:129]
v_mfma_f32_16x16x32_bf16 v[134:137], v[182:185], a[136:139], v[134:137]
v_mfma_f32_16x16x32_bf16 v[90:93], a[232:235], v[182:185], v[90:93]
v_mfma_f32_16x16x32_bf16 v[170:173], v[224:227], v[182:185], v[170:173]
v_mfma_f32_16x16x32_bf16 v[220:223], v[248:251], v[182:185], v[220:223]
ds_read_b128 v[186:189], v210 offset:17408
s_waitcnt lgkmcnt(0)
v_mfma_f32_16x16x32_bf16 v[118:121], v[186:189], a[92:95], v[118:121]
v_mfma_f32_16x16x32_bf16 v[126:129], v[186:189], a[116:119], v[126:129]
v_mfma_f32_16x16x32_bf16 v[134:137], v[186:189], a[140:143], v[134:137]
v_mfma_f32_16x16x32_bf16 v[90:93], a[236:239], v[186:189], v[90:93]
v_mfma_f32_16x16x32_bf16 v[170:173], v[228:231], v[186:189], v[170:173]
v_mfma_f32_16x16x32_bf16 v[220:223], v[252:255], v[186:189], v[220:223]
v_cvt_pk_bf16_f32 v118, v118, v119
v_cvt_pk_bf16_f32 v119, v120, v121
ds_read_u16 v120, v216
v_mov_b32 v121, 0
v_cvt_pk_bf16_f32 v126, v126, v127
v_cvt_pk_bf16_f32 v127, v128, v129
ds_read_u16 v128, v216 offset:32
v_mov_b32 v129, 0
v_cvt_pk_bf16_f32 v134, v134, v135
v_cvt_pk_bf16_f32 v135, v136, v137
ds_read_u16 v136, v216 offset:64
v_mov_b32 v137, 0
v_add_u32 v216, 1408, v216
v_cvt_pk_bf16_f32 v90, v90, v91
v_cvt_pk_bf16_f32 v91, v92, v93
v_cvt_pk_bf16_f32 v92, v170, v171
v_cvt_pk_bf16_f32 v93, v172, v173
v_cvt_pk_bf16_f32 v94, v220, v221
v_cvt_pk_bf16_f32 v95, v222, v223
v_max3_f32 v151, v138, v139, v140
v_max3_f32 v151, v151, v141, v142
v_max3_f32 v151, v151, v143, v144
v_max3_f32 v151, v151, v145, v146
v_max3_f32 v151, v151, v147, v148
v_max3_f32 v151, v151, v149, v150
v_mov_b32 v152, v151
s_nop 1
v_permlane16_swap_b32 v151, v152
v_max_f32 v151, v151, v152
v_mov_b32 v152, v151
s_nop 1
v_permlane32_swap_b32 v151, v152
v_max_f32 v151, v151, v152
v_sub_f32 v138, v138, v151
v_sub_f32 v139, v139, v151
v_sub_f32 v140, v140, v151
v_sub_f32 v141, v141, v151
v_sub_f32 v142, v142, v151
v_sub_f32 v143, v143, v151
v_sub_f32 v144, v144, v151
v_sub_f32 v145, v145, v151
v_sub_f32 v150, v150, v151
v_sub_f32 v146, v146, v151
v_sub_f32 v147, v147, v151
v_sub_f32 v148, v148, v151
v_sub_f32 v149, v149, v151
v_exp_f32 v138, v138
v_exp_f32 v139, v139
v_exp_f32 v140, v140
v_exp_f32 v141, v141
v_exp_f32 v142, v142
v_exp_f32 v143, v143
v_exp_f32 v144, v144
v_exp_f32 v145, v145
v_exp_f32 v150, v150
v_exp_f32 v146, v146
v_exp_f32 v147, v147
v_exp_f32 v148, v148
v_exp_f32 v149, v149
v_cvt_pk_bf16_f32 v174, v138, v139
v_cvt_pk_bf16_f32 v175, v140, v141
v_cvt_pk_bf16_f32 v176, v142, v143
v_cvt_pk_bf16_f32 v177, v144, v145
v_cvt_pk_bf16_f32 v178, v146, v147
v_cvt_pk_bf16_f32 v179, v148, v149
v_cvt_pk_bf16_f32 v180, v150, 0
v_mfma_f32_16x16x32_bf16 v[150:153], v[190:193], v[174:177], 0
v_mfma_f32_16x16x32_bf16 v[138:141], v[114:117], v[174:177], 0
v_mfma_f32_16x16x32_bf16 v[142:145], v[122:125], v[174:177], 0
v_mfma_f32_16x16x32_bf16 v[146:149], v[130:133], v[174:177], 0
v_mfma_f32_16x16x32_bf16 v[150:153], v[190:193], v[178:181], v[150:153]
s_waitcnt lgkmcnt(2)
v_mfma_f32_16x16x32_bf16 v[138:141], v[118:121], v[178:181], v[138:141]
s_waitcnt lgkmcnt(1)
v_mfma_f32_16x16x32_bf16 v[142:145], v[126:129], v[178:181], v[142:145]
s_waitcnt lgkmcnt(0)
v_mfma_f32_16x16x32_bf16 v[146:149], v[134:137], v[178:181], v[146:149]
v_max3_f32 v167, v154, v155, v156
v_max3_f32 v167, v167, v157, v158
v_max3_f32 v167, v167, v159, v160
v_max3_f32 v167, v167, v161, v162
v_max3_f32 v167, v167, v163, v164
v_max3_f32 v167, v167, v165, v166
v_mov_b32 v168, v167
s_nop 1
v_permlane16_swap_b32 v167, v168
v_max_f32 v167, v167, v168
v_mov_b32 v168, v167
s_nop 1
v_permlane32_swap_b32 v167, v168
v_max_f32 v167, v167, v168
v_sub_f32 v154, v154, v167
v_sub_f32 v155, v155, v167
v_sub_f32 v156, v156, v167
v_sub_f32 v157, v157, v167
v_sub_f32 v158, v158, v167
v_sub_f32 v159, v159, v167
v_sub_f32 v160, v160, v167
v_sub_f32 v161, v161, v167
v_sub_f32 v166, v166, v167
v_sub_f32 v162, v162, v167
v_sub_f32 v163, v163, v167
v_sub_f32 v164, v164, v167
v_sub_f32 v165, v165, v167
v_exp_f32 v154, v154
v_exp_f32 v155, v155
v_exp_f32 v156, v156
v_exp_f32 v157, v157
v_exp_f32 v158, v158
v_exp_f32 v159, v159
v_exp_f32 v160, v160
v_exp_f32 v161, v161
v_exp_f32 v166, v166
v_exp_f32 v162, v162
v_exp_f32 v163, v163
v_exp_f32 v164, v164
v_exp_f32 v165, v165
v_cvt_pk_bf16_f32 v174, v154, v155
v_cvt_pk_bf16_f32 v175, v156, v157
v_cvt_pk_bf16_f32 v176, v158, v159
v_cvt_pk_bf16_f32 v177, v160, v161
v_cvt_pk_bf16_f32 v178, v162, v163
v_cvt_pk_bf16_f32 v179, v164, v165
v_cvt_pk_bf16_f32 v180, v166, 0
v_mfma_f32_16x16x32_bf16 v[166:169], v[190:193], v[174:177], 0
v_mfma_f32_16x16x32_bf16 v[154:157], v[114:117], v[174:177], 0
v_mfma_f32_16x16x32_bf16 v[158:161], v[122:125], v[174:177], 0
v_mfma_f32_16x16x32_bf16 v[162:165], v[130:133], v[174:177], 0
v_mfma_f32_16x16x32_bf16 v[166:169], v[190:193], v[178:181], v[166:169]
v_mfma_f32_16x16x32_bf16 v[154:157], v[118:121], v[178:181], v[154:157]
v_mfma_f32_16x16x32_bf16 v[158:161], v[126:129], v[178:181], v[158:161]
v_mfma_f32_16x16x32_bf16 v[162:165], v[134:137], v[178:181], v[162:165]
v_rcp_f32 v151, v150
s_nop 0
v_mul_f32 v151, s3, v151
v_mul_f32 v138, v138, v151
v_mul_f32 v139, v139, v151
v_cvt_pk_bf16_f32 v138, v138, v139
v_mul_f32 v140, v140, v151
v_mul_f32 v141, v141, v151
v_cvt_pk_bf16_f32 v139, v140, v141
v_mul_f32 v142, v142, v151
v_mul_f32 v143, v143, v151
v_cvt_pk_bf16_f32 v140, v142, v143
v_mul_f32 v144, v144, v151
v_mul_f32 v145, v145, v151
v_cvt_pk_bf16_f32 v141, v144, v145
ds_write_b128 v211, v[138:141] offset:36864
v_mul_f32 v146, v146, v151
v_mul_f32 v147, v147, v151
v_cvt_pk_bf16_f32 v142, v146, v147
v_mul_f32 v148, v148, v151
v_mul_f32 v149, v149, v151
v_cvt_pk_bf16_f32 v143, v148, v149
ds_write_b64 v212, v[142:143] offset:36864
v_mfma_f32_16x16x32_bf16 v[138:141], v[78:81], v[90:93], 0
v_mfma_f32_16x16x32_bf16 v[142:145], v[96:99], v[90:93], 0
v_mfma_f32_16x16x32_bf16 v[150:153], v[108:111], v[90:93], v[206:209]
v_mfma_f32_16x16x32_bf16 v[146:149], v[102:105], v[90:93], 0
v_mfma_f32_16x16x16_bf16 v[138:141], v[82:83], v[94:95], v[138:141]
v_mfma_f32_16x16x16_bf16 v[142:145], v[100:101], v[94:95], v[142:145]
v_mfma_f32_16x16x16_bf16 v[150:153], v[112:113], v[94:95], v[150:153]
v_mfma_f32_16x16x16_bf16 v[146:149], v[106:107], v[94:95], v[146:149]
v_rcp_f32 v167, v166
s_nop 0
v_mul_f32 v167, s3, v167
v_mul_f32 v154, v154, v167
v_mul_f32 v155, v155, v167
v_cvt_pk_bf16_f32 v154, v154, v155
v_mul_f32 v156, v156, v167
v_mul_f32 v157, v157, v167
v_cvt_pk_bf16_f32 v155, v156, v157
v_mul_f32 v158, v158, v167
v_mul_f32 v159, v159, v167
v_cvt_pk_bf16_f32 v156, v158, v159
v_mul_f32 v160, v160, v167
v_mul_f32 v161, v161, v167
v_cvt_pk_bf16_f32 v157, v160, v161
ds_write_b128 v211, v[154:157] offset:43008
v_mul_f32 v162, v162, v167
v_mul_f32 v163, v163, v167
v_cvt_pk_bf16_f32 v158, v162, v163
v_mul_f32 v164, v164, v167
v_mul_f32 v165, v165, v167
v_cvt_pk_bf16_f32 v159, v164, v165
ds_write_b64 v212, v[158:159] offset:43008
v_mfma_f32_16x16x32_bf16 v[154:157], v[72:75], v[78:81], 0
v_mfma_f32_16x16x32_bf16 v[158:161], v[72:75], v[96:99], 0
v_mfma_f32_16x16x32_bf16 v[162:165], v[72:75], v[102:105], 0
v_mfma_f32_16x16x32_bf16 v[166:169], v[72:75], v[108:111], v[206:209]
v_mfma_f32_16x16x16_bf16 v[154:157], v[76:77], v[82:83], v[154:157]
v_mfma_f32_16x16x16_bf16 v[158:161], v[76:77], v[100:101], v[158:161]
v_mfma_f32_16x16x16_bf16 v[162:165], v[76:77], v[106:107], v[162:165]
v_mfma_f32_16x16x16_bf16 v[166:169], v[76:77], v[112:113], v[166:169]
v_mov_b32_dpp v154, v158 quad_perm:[0,1,2,3] row_mask:0x2 bank_mask:0xf
s_nop 1
v_mov_b32_dpp v154, v162 quad_perm:[0,1,2,3] row_mask:0x4 bank_mask:0xf
s_nop 2
v_mov_b32_dpp v154, v167 quad_perm:[0,1,2,3] row_mask:0x8 bank_mask:0xf
v_mov_b32 v155, v154
s_nop 1
v_max_f32_dpp v155, v155, v155 row_ror:8 row_mask:0xf bank_mask:0xf
s_nop 1
v_max_f32_dpp v155, v155, v155 row_ror:4 row_mask:0xf bank_mask:0xf
s_nop 1
v_max_f32_dpp v155, v155, v155 row_ror:2 row_mask:0xf bank_mask:0xf
s_nop 1
v_max_f32_dpp v155, v155, v155 row_ror:1 row_mask:0xf bank_mask:0xf
v_mov_b32 v156, v155
s_nop 1
v_permlane16_swap_b32 v155, v156
v_max_f32 v155, v155, v156
v_mov_b32 v156, v155
s_nop 1
v_permlane32_swap_b32 v155, v156
v_max_f32 v155, v155, v156
v_sub_f32 v154, v154, v155
v_exp_f32 v154, v154
s_nop 0
v_cvt_pk_bf16_f32 v154, v154, 0
ds_write_b16 v214, v154
s_waitcnt lgkmcnt(1)
ds_read_b128 v[84:87], v215
ds_read_b128 v[88:91], v215 offset:16
v_add_u32 v215, 1408, v215
s_barrier
ds_read_b128 v[170:173], v210 offset:36864
s_waitcnt lgkmcnt(0)
v_mfma_f32_16x16x32_bf16 v[0:3], a[144:147], v[170:173], v[0:3]
v_mfma_f32_16x16x32_bf16 v[4:7], a[168:171], v[170:173], v[4:7]
v_mfma_f32_16x16x32_bf16 v[8:11], a[192:195], v[170:173], v[8:11]
ds_read_b128 v[182:185], v210 offset:37888
s_waitcnt lgkmcnt(0)
v_mfma_f32_16x16x32_bf16 v[0:3], a[148:151], v[182:185], v[0:3]
v_mfma_f32_16x16x32_bf16 v[4:7], a[172:175], v[182:185], v[4:7]
v_mfma_f32_16x16x32_bf16 v[8:11], a[196:199], v[182:185], v[8:11]
ds_read_b128 v[186:189], v210 offset:38912
s_waitcnt lgkmcnt(0)
v_mfma_f32_16x16x32_bf16 v[0:3], a[152:155], v[186:189], v[0:3]
v_mfma_f32_16x16x32_bf16 v[4:7], a[176:179], v[186:189], v[4:7]
v_mfma_f32_16x16x32_bf16 v[8:11], a[200:203], v[186:189], v[8:11]
ds_read_b128 v[170:173], v210 offset:39936
s_waitcnt lgkmcnt(0)
v_mfma_f32_16x16x32_bf16 v[0:3], a[156:159], v[170:173], v[0:3]
v_mfma_f32_16x16x32_bf16 v[4:7], a[180:183], v[170:173], v[4:7]
v_mfma_f32_16x16x32_bf16 v[8:11], a[204:207], v[170:173], v[8:11]
ds_read_b128 v[182:185], v210 offset:40960
s_waitcnt lgkmcnt(0)
v_mfma_f32_16x16x32_bf16 v[0:3], a[160:163], v[182:185], v[0:3]
v_mfma_f32_16x16x32_bf16 v[4:7], a[184:187], v[182:185], v[4:7]
v_mfma_f32_16x16x32_bf16 v[8:11], a[208:211], v[182:185], v[8:11]
ds_read_b128 v[186:189], v210 offset:41984
s_waitcnt lgkmcnt(0)
v_mfma_f32_16x16x32_bf16 v[0:3], a[164:167], v[186:189], v[0:3]
v_mfma_f32_16x16x32_bf16 v[4:7], a[188:191], v[186:189], v[4:7]
v_mfma_f32_16x16x32_bf16 v[8:11], a[212:215], v[186:189], v[8:11]
v_cvt_pk_bf16_f32 v72, v0, v1
v_cvt_pk_bf16_f32 v73, v2, v3
buffer_store_dwordx2 v[72:73], v203, s[8:11], s38 offen
v_cvt_pk_bf16_f32 v74, v4, v5
v_cvt_pk_bf16_f32 v75, v6, v7
buffer_store_dwordx2 v[74:75], v203, s[8:11], s38 offen offset:32
s_nop 0
v_cvt_pk_bf16_f32 v76, v8, v9
v_cvt_pk_bf16_f32 v77, v10, v11
buffer_store_dwordx2 v[76:77], v203, s[8:11], s38 offen offset:64
v_max3_f32 v151, v138, v139, v140
v_max3_f32 v151, v151, v141, v142
v_max3_f32 v151, v151, v143, v144
v_max3_f32 v151, v151, v145, v146
v_max3_f32 v151, v151, v147, v148
v_max3_f32 v151, v151, v149, v150
v_mov_b32 v152, v151
s_nop 1
v_permlane16_swap_b32 v151, v152
v_max_f32 v151, v151, v152
v_mov_b32 v152, v151
s_nop 1
v_permlane32_swap_b32 v151, v152
v_max_f32 v151, v151, v152
v_sub_f32 v138, v138, v151
v_sub_f32 v139, v139, v151
v_sub_f32 v140, v140, v151
v_sub_f32 v141, v141, v151
v_sub_f32 v142, v142, v151
v_sub_f32 v143, v143, v151
v_sub_f32 v144, v144, v151
v_sub_f32 v145, v145, v151
v_sub_f32 v150, v150, v151
v_sub_f32 v146, v146, v151
v_sub_f32 v147, v147, v151
v_sub_f32 v148, v148, v151
v_sub_f32 v149, v149, v151
v_exp_f32 v138, v138
v_exp_f32 v139, v139
v_exp_f32 v140, v140
v_exp_f32 v141, v141
v_exp_f32 v142, v142
v_exp_f32 v143, v143
v_exp_f32 v144, v144
v_exp_f32 v145, v145
v_exp_f32 v150, v150
v_exp_f32 v146, v146
v_exp_f32 v147, v147
v_exp_f32 v148, v148
v_exp_f32 v149, v149
v_cvt_pk_bf16_f32 v174, v138, v139
v_cvt_pk_bf16_f32 v175, v140, v141
v_cvt_pk_bf16_f32 v176, v142, v143
v_cvt_pk_bf16_f32 v177, v144, v145
v_cvt_pk_bf16_f32 v178, v146, v147
v_cvt_pk_bf16_f32 v179, v148, v149
v_cvt_pk_bf16_f32 v180, v150, 0
v_mfma_f32_16x16x32_bf16 v[150:153], v[190:193], v[174:177], 0
v_mfma_f32_16x16x32_bf16 v[138:141], v[114:117], v[174:177], 0
v_mfma_f32_16x16x32_bf16 v[142:145], v[122:125], v[174:177], 0
v_mfma_f32_16x16x32_bf16 v[146:149], v[130:133], v[174:177], 0
v_mfma_f32_16x16x32_bf16 v[150:153], v[190:193], v[178:181], v[150:153]
v_mfma_f32_16x16x32_bf16 v[138:141], v[118:121], v[178:181], v[138:141]
v_mfma_f32_16x16x32_bf16 v[142:145], v[126:129], v[178:181], v[142:145]
v_mfma_f32_16x16x32_bf16 v[146:149], v[134:137], v[178:181], v[146:149]
v_mfma_f32_16x16x32_bf16 v[166:169], v[84:87], v[190:193], 0
v_mfma_f32_16x16x32_bf16 v[154:157], v[84:87], v[114:117], 0
v_mfma_f32_16x16x32_bf16 v[158:161], v[84:87], v[122:125], 0
v_mfma_f32_16x16x32_bf16 v[162:165], v[84:87], v[130:133], 0
v_mfma_f32_16x16x32_bf16 v[166:169], v[88:91], v[190:193], v[166:169]
v_mfma_f32_16x16x32_bf16 v[154:157], v[88:91], v[118:121], v[154:157]
v_mfma_f32_16x16x32_bf16 v[158:161], v[88:91], v[126:129], v[158:161]
v_mfma_f32_16x16x32_bf16 v[162:165], v[88:91], v[134:137], v[162:165]
v_rcp_f32 v167, v166
s_nop 1
v_mov_b32_dpp v154, v158 quad_perm:[0,1,2,3] row_mask:0x2 bank_mask:0xf
s_nop 2
v_mov_b32_dpp v154, v162 quad_perm:[0,1,2,3] row_mask:0x4 bank_mask:0xf
v_mul_f32 v167, s3, v167
v_mul_f32 v154, v154, v167
v_cvt_pk_bf16_f32 v154, v154, 0
ds_write_b16 v214, v154
v_add_u32 v214, 1408, v214
ds_read_b128 v[170:173], v210 offset:43008
s_waitcnt lgkmcnt(0)
v_mfma_f32_16x16x32_bf16 v[12:15], a[144:147], v[170:173], v[12:15]
v_mfma_f32_16x16x32_bf16 v[16:19], a[168:171], v[170:173], v[16:19]
v_mfma_f32_16x16x32_bf16 v[20:23], a[192:195], v[170:173], v[20:23]
ds_read_b128 v[182:185], v210 offset:44032
s_waitcnt lgkmcnt(0)
v_mfma_f32_16x16x32_bf16 v[12:15], a[148:151], v[182:185], v[12:15]
v_mfma_f32_16x16x32_bf16 v[16:19], a[172:175], v[182:185], v[16:19]
v_mfma_f32_16x16x32_bf16 v[20:23], a[196:199], v[182:185], v[20:23]
ds_read_b128 v[186:189], v210 offset:45056
s_waitcnt lgkmcnt(0)
v_mfma_f32_16x16x32_bf16 v[12:15], a[152:155], v[186:189], v[12:15]
v_mfma_f32_16x16x32_bf16 v[16:19], a[176:179], v[186:189], v[16:19]
v_mfma_f32_16x16x32_bf16 v[20:23], a[200:203], v[186:189], v[20:23]
ds_read_b128 v[170:173], v210 offset:46080
s_waitcnt lgkmcnt(0)
v_mfma_f32_16x16x32_bf16 v[12:15], a[156:159], v[170:173], v[12:15]
v_mfma_f32_16x16x32_bf16 v[16:19], a[180:183], v[170:173], v[16:19]
v_mfma_f32_16x16x32_bf16 v[20:23], a[204:207], v[170:173], v[20:23]
ds_read_b128 v[182:185], v210 offset:47104
s_waitcnt lgkmcnt(0)
v_mfma_f32_16x16x32_bf16 v[12:15], a[160:163], v[182:185], v[12:15]
v_mfma_f32_16x16x32_bf16 v[16:19], a[184:187], v[182:185], v[16:19]
v_mfma_f32_16x16x32_bf16 v[20:23], a[208:211], v[182:185], v[20:23]
ds_read_b128 v[186:189], v210 offset:48128
s_waitcnt lgkmcnt(0)
v_mfma_f32_16x16x32_bf16 v[12:15], a[164:167], v[186:189], v[12:15]
v_mfma_f32_16x16x32_bf16 v[16:19], a[188:191], v[186:189], v[16:19]
v_mfma_f32_16x16x32_bf16 v[20:23], a[212:215], v[186:189], v[20:23]
v_cvt_pk_bf16_f32 v78, v12, v13
v_cvt_pk_bf16_f32 v79, v14, v15
buffer_store_dwordx2 v[78:79], v204, s[8:11], s38 offen
v_cvt_pk_bf16_f32 v80, v16, v17
v_cvt_pk_bf16_f32 v81, v18, v19
buffer_store_dwordx2 v[80:81], v204, s[8:11], s38 offen offset:32
s_nop 0
v_cvt_pk_bf16_f32 v82, v20, v21
v_cvt_pk_bf16_f32 v83, v22, v23
buffer_store_dwordx2 v[82:83], v204, s[8:11], s38 offen offset:64
v_rcp_f32 v151, v150
s_nop 0
v_mul_f32 v151, s3, v151
v_mul_f32 v138, v138, v151
v_mul_f32 v139, v139, v151
v_cvt_pk_bf16_f32 v138, v138, v139
v_mul_f32 v140, v140, v151
v_mul_f32 v141, v141, v151
v_cvt_pk_bf16_f32 v139, v140, v141
v_mul_f32 v142, v142, v151
v_mul_f32 v143, v143, v151
v_cvt_pk_bf16_f32 v140, v142, v143
v_mul_f32 v144, v144, v151
v_mul_f32 v145, v145, v151
v_cvt_pk_bf16_f32 v141, v144, v145
ds_write_b128 v211, v[138:141] offset:49152
v_mul_f32 v146, v146, v151
v_mul_f32 v147, v147, v151
v_cvt_pk_bf16_f32 v142, v146, v147
v_mul_f32 v148, v148, v151
v_mul_f32 v149, v149, v151
v_cvt_pk_bf16_f32 v143, v148, v149
ds_write_b64 v212, v[142:143] offset:49152
s_mov_b32 s46, 9
.p2align 3
G_loop:
s_waitcnt vmcnt(6) lgkmcnt(0)
s_barrier
ds_read_b128 v[170:173], v210 offset:49152
s_waitcnt lgkmcnt(0)
v_mfma_f32_16x16x32_bf16 v[24:27], a[144:147], v[170:173], v[24:27]
v_mfma_f32_16x16x32_bf16 v[28:31], a[168:171], v[170:173], v[28:31]
v_mfma_f32_16x16x32_bf16 v[32:35], a[192:195], v[170:173], v[32:35]
ds_read_b128 v[182:185], v210 offset:50176
s_waitcnt lgkmcnt(0)
v_mfma_f32_16x16x32_bf16 v[24:27], a[148:151], v[182:185], v[24:27]
v_mfma_f32_16x16x32_bf16 v[28:31], a[172:175], v[182:185], v[28:31]
v_mfma_f32_16x16x32_bf16 v[32:35], a[196:199], v[182:185], v[32:35]
ds_read_b128 v[186:189], v210 offset:51200
s_waitcnt lgkmcnt(0)
v_mfma_f32_16x16x32_bf16 v[24:27], a[152:155], v[186:189], v[24:27]
v_mfma_f32_16x16x32_bf16 v[28:31], a[176:179], v[186:189], v[28:31]
v_mfma_f32_16x16x32_bf16 v[32:35], a[200:203], v[186:189], v[32:35]
ds_read_b128 v[170:173], v210 offset:52224
s_waitcnt lgkmcnt(0)
v_mfma_f32_16x16x32_bf16 v[24:27], a[156:159], v[170:173], v[24:27]
v_mfma_f32_16x16x32_bf16 v[28:31], a[180:183], v[170:173], v[28:31]
v_mfma_f32_16x16x32_bf16 v[32:35], a[204:207], v[170:173], v[32:35]
ds_read_b128 v[182:185], v210 offset:53248
s_waitcnt lgkmcnt(0)
v_mfma_f32_16x16x32_bf16 v[24:27], a[160:163], v[182:185], v[24:27]
v_mfma_f32_16x16x32_bf16 v[28:31], a[184:187], v[182:185], v[28:31]
v_mfma_f32_16x16x32_bf16 v[32:35], a[208:211], v[182:185], v[32:35]
ds_read_b128 v[186:189], v210 offset:54272
s_waitcnt lgkmcnt(0)
v_mfma_f32_16x16x32_bf16 v[24:27], a[164:167], v[186:189], v[24:27]
v_mfma_f32_16x16x32_bf16 v[28:31], a[188:191], v[186:189], v[28:31]
v_mfma_f32_16x16x32_bf16 v[32:35], a[212:215], v[186:189], v[32:35]
v_cvt_pk_bf16_f32 v116, v24, v25
v_cvt_pk_bf16_f32 v117, v26, v27
buffer_store_dwordx2 v[116:117], v205, s[8:11], s38 offen
v_cvt_pk_bf16_f32 v124, v28, v29
v_cvt_pk_bf16_f32 v125, v30, v31
buffer_store_dwordx2 v[124:125], v205, s[8:11], s38 offen offset:32
s_nop 0
v_cvt_pk_bf16_f32 v132, v32, v33
v_cvt_pk_bf16_f32 v133, v34, v35
buffer_store_dwordx2 v[132:133], v205, s[8:11], s38 offen offset:64
s_mov_b32 s39, s37
ds_read_b128 v[174:177], v217
ds_read_b128 v[84:87], v200
s_waitcnt lgkmcnt(0)
v_mfma_f32_16x16x32_bf16 v[0:3], v[174:177], v[84:87], 0
ds_read_b128 v[92:95], v201
s_waitcnt lgkmcnt(0)
v_mfma_f32_16x16x32_bf16 v[12:15], v[174:177], v[92:95], 0
ds_read_b128 v[100:103], v202
s_waitcnt lgkmcnt(0)
v_mfma_f32_16x16x32_bf16 v[24:27], v[174:177], v[100:103], 0
ds_read_b128 v[178:181], v217 offset:528
ds_read_b128 v[84:87], v194
ds_read_b128 v[88:91], v194 offset:16
s_waitcnt lgkmcnt(0)
v_smfmac_f32_16x16x64_bf16 v[0:3], v[178:181], v[84:91], v213
ds_read_b128 v[92:95], v195
ds_read_b128 v[96:99], v195 offset:16
s_waitcnt lgkmcnt(0)
v_smfmac_f32_16x16x64_bf16 v[12:15], v[178:181], v[92:99], v213
ds_read_b128 v[100:103], v196
ds_read_b128 v[104:107], v196 offset:16
s_waitcnt lgkmcnt(0)
v_smfmac_f32_16x16x64_bf16 v[24:27], v[178:181], v[100:107], v213
ds_read_b128 v[174:177], v217 offset:1056
ds_read_b128 v[84:87], v197
ds_read_b128 v[88:91], v197 offset:16
s_waitcnt lgkmcnt(0)
v_smfmac_f32_16x16x64_bf16 v[0:3], v[174:177], v[84:91], v213
ds_read_b128 v[92:95], v198
ds_read_b128 v[96:99], v198 offset:16
s_waitcnt lgkmcnt(0)
v_smfmac_f32_16x16x64_bf16 v[12:15], v[174:177], v[92:99], v213
ds_read_b128 v[100:103], v199
ds_read_b128 v[104:107], v199 offset:16
s_waitcnt lgkmcnt(0)
v_smfmac_f32_16x16x64_bf16 v[24:27], v[174:177], v[100:107], v213
ds_read_b128 v[178:181], v217 offset:1584
ds_read_b128 v[84:87], v200 offset:32
s_waitcnt lgkmcnt(0)
v_mfma_f32_16x16x32_bf16 v[4:7], v[178:181], v[84:87], 0
ds_read_b128 v[92:95], v201 offset:32
s_waitcnt lgkmcnt(0)
v_mfma_f32_16x16x32_bf16 v[16:19], v[178:181], v[92:95], 0
ds_read_b128 v[100:103], v202 offset:32
s_waitcnt lgkmcnt(0)
v_mfma_f32_16x16x32_bf16 v[28:31], v[178:181], v[100:103], 0
ds_read_b128 v[174:177], v217 offset:2112
ds_read_b128 v[84:87], v194 offset:32
ds_read_b128 v[88:91], v194 offset:48
s_waitcnt lgkmcnt(0)
v_smfmac_f32_16x16x64_bf16 v[4:7], v[174:177], v[84:91], v213
ds_read_b128 v[92:95], v195 offset:32
ds_read_b128 v[96:99], v195 offset:48
s_waitcnt lgkmcnt(0)
v_smfmac_f32_16x16x64_bf16 v[16:19], v[174:177], v[92:99], v213
ds_read_b128 v[100:103], v196 offset:32
ds_read_b128 v[104:107], v196 offset:48
s_waitcnt lgkmcnt(0)
v_smfmac_f32_16x16x64_bf16 v[28:31], v[174:177], v[100:107], v213
ds_read_b128 v[178:181], v217 offset:2640
ds_read_b128 v[84:87], v197 offset:32
ds_read_b128 v[88:91], v197 offset:48
s_waitcnt lgkmcnt(0)
v_smfmac_f32_16x16x64_bf16 v[4:7], v[178:181], v[84:91], v213
ds_read_b128 v[92:95], v198 offset:32
ds_read_b128 v[96:99], v198 offset:48
s_waitcnt lgkmcnt(0)
v_smfmac_f32_16x16x64_bf16 v[16:19], v[178:181], v[92:99], v213
ds_read_b128 v[100:103], v199 offset:32
ds_read_b128 v[104:107], v199 offset:48
s_waitcnt lgkmcnt(0)
v_smfmac_f32_16x16x64_bf16 v[28:31], v[178:181], v[100:107], v213
ds_read_b128 v[174:177], v217 offset:3168
ds_read_b128 v[84:87], v200 offset:64
s_waitcnt lgkmcnt(0)
v_mfma_f32_16x16x32_bf16 v[8:11], v[174:177], v[84:87], 0
ds_read_b128 v[92:95], v201 offset:64
s_waitcnt lgkmcnt(0)
v_mfma_f32_16x16x32_bf16 v[20:23], v[174:177], v[92:95], 0
ds_read_b128 v[100:103], v202 offset:64
s_waitcnt lgkmcnt(0)
v_mfma_f32_16x16x32_bf16 v[32:35], v[174:177], v[100:103], 0
ds_read_b128 v[178:181], v217 offset:3696
ds_read_b128 v[84:87], v194 offset:64
ds_read_b128 v[88:91], v194 offset:80
s_waitcnt lgkmcnt(0)
v_smfmac_f32_16x16x64_bf16 v[8:11], v[178:181], v[84:91], v213
ds_read_b128 v[92:95], v195 offset:64
ds_read_b128 v[96:99], v195 offset:80
s_waitcnt lgkmcnt(0)
v_smfmac_f32_16x16x64_bf16 v[20:23], v[178:181], v[92:99], v213
ds_read_b128 v[100:103], v196 offset:64
ds_read_b128 v[104:107], v196 offset:80
s_waitcnt lgkmcnt(0)
v_smfmac_f32_16x16x64_bf16 v[32:35], v[178:181], v[100:107], v213
ds_read_b128 v[174:177], v217 offset:4224
ds_read_b128 v[84:87], v197 offset:64
ds_read_b128 v[88:91], v197 offset:80
s_waitcnt lgkmcnt(0)
v_smfmac_f32_16x16x64_bf16 v[8:11], v[174:177], v[84:91], v213
ds_read_b128 v[92:95], v198 offset:64
ds_read_b128 v[96:99], v198 offset:80
s_waitcnt lgkmcnt(0)
v_smfmac_f32_16x16x64_bf16 v[20:23], v[174:177], v[92:99], v213
ds_read_b128 v[100:103], v199 offset:64
ds_read_b128 v[104:107], v199 offset:80
s_waitcnt lgkmcnt(0)
v_smfmac_f32_16x16x64_bf16 v[32:35], v[174:177], v[100:107], v213
v_add_f32 v118, v0, v1
v_mul_f32 v119, v0, v0
v_add_f32 v118, v118, v2
v_fmac_f32 v119, v1, v1
v_add_f32 v118, v118, v3
v_fmac_f32 v119, v2, v2
v_fmac_f32 v119, v3, v3
v_add_f32 v126, v12, v13
v_mul_f32 v127, v12, v12
v_add_f32 v126, v126, v14
v_fmac_f32 v127, v13, v13
v_add_f32 v126, v126, v15
v_fmac_f32 v127, v14, v14
v_fmac_f32 v127, v15, v15
v_add_f32 v134, v24, v25
v_mul_f32 v135, v24, v24
v_add_f32 v134, v134, v26
v_fmac_f32 v135, v25, v25
v_add_f32 v134, v134, v27
v_fmac_f32 v135, v26, v26
v_fmac_f32 v135, v27, v27
v_add_f32 v118, v118, v4
v_fmac_f32 v119, v4, v4
v_add_f32 v118, v118, v5
v_fmac_f32 v119, v5, v5
v_add_f32 v118, v118, v6
v_fmac_f32 v119, v6, v6
v_add_f32 v118, v118, v7
v_fmac_f32 v119, v7, v7
v_add_f32 v126, v126, v16
v_fmac_f32 v127, v16, v16
v_add_f32 v126, v126, v17
v_fmac_f32 v127, v17, v17
v_add_f32 v126, v126, v18
v_fmac_f32 v127, v18, v18
v_add_f32 v126, v126, v19
v_fmac_f32 v127, v19, v19
v_add_f32 v134, v134, v28
v_fmac_f32 v135, v28, v28
v_add_f32 v134, v134, v29
v_fmac_f32 v135, v29, v29
v_add_f32 v134, v134, v30
v_fmac_f32 v135, v30, v30
v_add_f32 v134, v134, v31
v_fmac_f32 v135, v31, v31
v_add_f32 v118, v118, v8
v_fmac_f32 v119, v8, v8
v_add_f32 v118, v118, v9
v_fmac_f32 v119, v9, v9
v_add_f32 v118, v118, v10
v_fmac_f32 v119, v10, v10
v_add_f32 v118, v118, v11
v_fmac_f32 v119, v11, v11
v_add_f32 v126, v126, v20
v_fmac_f32 v127, v20, v20
v_add_f32 v126, v126, v21
v_fmac_f32 v127, v21, v21
v_add_f32 v126, v126, v22
v_fmac_f32 v127, v22, v22
v_add_f32 v126, v126, v23
v_fmac_f32 v127, v23, v23
v_add_f32 v134, v134, v32
v_fmac_f32 v135, v32, v32
v_add_f32 v134, v134, v33
v_fmac_f32 v135, v33, v33
v_add_f32 v134, v134, v34
v_fmac_f32 v135, v34, v34
v_add_f32 v134, v134, v35
v_fmac_f32 v135, v35, v35
v_permlane16_swap_b32 v118, v119
v_add_f32 v118, v118, v119
v_permlane16_swap_b32 v126, v127
v_add_f32 v126, v126, v127
v_permlane16_swap_b32 v134, v135
v_add_f32 v134, v134, v135
v_permlane32_swap_b32 v118, v126
v_add_f32 v118, v118, v126
ds_write_b32 v209, v118
v_mov_b32 v135, v134
s_nop 1
v_permlane32_swap_b32 v134, v135
v_add_f32 v134, v134, v135
ds_write_b32 v209, v134 offset:512
s_waitcnt lgkmcnt(0)
s_barrier
s_mul_hi_u32 s41, s35, 58835169
s_mul_i32 s42, s41, 73
s_sub_u32 s42, s35, s42
s_mul_i32 s43, s41, 1373568
s_mul_i32 s51, s42, 2688
s_add_u32 s43, s43, s51
s_cmp_lt_u32 s35, s34
s_cselect_b32 s37, s43, 1879048192
s_add_u32 s35, s35, 32
s_cmp_eq_u32 s42, 0
s_cselect_b32 s44, 536870911, s72
s_cmp_eq_u32 s42, 72
s_cselect_b32 s44, 939524095, s44
s_cmp_eq_u32 s41, 0
s_cselect_b32 s40, 1879048192, s37
v_and_b32 v180, s44, v208
s_add_u32 m0, s45, 0
s_nop 0
buffer_load_dwordx4 v180, s[4:7], s40 offen nt lds
s_add_u32 m0, s45, 4112
s_add_u32 s40, s37, 196224
buffer_load_dwordx4 v180, s[4:7], s40 offen nt lds
s_add_u32 m0, s45, 8224
s_add_u32 s40, s37, 392448
buffer_load_dwordx4 v180, s[4:7], s40 offen nt lds
s_add_u32 m0, s45, 12336
s_add_u32 s40, s37, 588672
buffer_load_dwordx4 v180, s[4:7], s40 offen nt lds
s_add_u32 m0, s45, 16448
s_add_u32 s40, s37, 784896
buffer_load_dwordx4 v180, s[4:7], s40 offen nt lds
s_add_u32 m0, s45, 20560
s_add_u32 s40, s37, 981120
buffer_load_dwordx4 v180, s[4:7], s40 offen nt lds
s_add_u32 m0, s45, 24672
s_add_u32 s40, s37, 1177344
buffer_load_dwordx4 v180, s[4:7], s40 offen nt lds
s_add_u32 m0, s45, 28784
s_add_u32 s40, s37, 1373568
buffer_load_dwordx4 v180, s[4:7], s40 offen nt lds
s_add_u32 m0, s45, 32896
s_add_u32 s40, s37, 1569792
buffer_load_dwordx4 v180, s[4:7], s40 offen nt lds
ds_read_b128 v[102:105], v210 offset:55296
ds_read_b128 v[106:109], v210 offset:56320
s_waitcnt lgkmcnt(1)
v_add_f32 v102, v102, v103
s_waitcnt lgkmcnt(0)
v_add_f32 v106, v106, v107
v_add_f32 v104, v104, v105
v_add_f32 v108, v108, v109
v_add_f32 v102, v102, v104
v_add_f32 v106, v106, v108
v_mul_f32 v103, s48, v102
v_mul_f32 v104, s73, v102
v_mul_f32 v106, s73, v106
v_fma_f32 v106, -v103, v104, v106
v_max_f32 v106, 0, v106
v_add_f32 v106, s49, v106
v_rsq_f32 v102, v106
s_nop 0
v_mul_f32_e64 v103, -v103, v102
ds_write_b64 v211, v[102:103] offset:36864
ds_read_b64 v[118:119], v219
ds_read_b64 v[126:127], v219 offset:256
ds_read_b64 v[134:135], v219 offset:512
s_waitcnt lgkmcnt(2)
v_fma_f32 v220, v0, v118, v119
v_fma_f32 v221, v1, v118, v119
v_cvt_pk_bf16_f32 v90, v220, v221
v_fma_f32 v222, v2, v118, v119
v_fma_f32 v223, v3, v118, v119
v_cvt_pk_bf16_f32 v91, v222, v223
v_fma_f32 v220, v4, v118, v119
v_fma_f32 v221, v5, v118, v119
v_cvt_pk_bf16_f32 v92, v220, v221
v_fma_f32 v222, v6, v118, v119
v_fma_f32 v223, v7, v118, v119
v_cvt_pk_bf16_f32 v93, v222, v223
ds_write_b128 v211, v[90:93]
v_fma_f32 v220, v8, v118, v119
v_fma_f32 v221, v9, v118, v119
v_cvt_pk_bf16_f32 v94, v220, v221
v_fma_f32 v222, v10, v118, v119
v_fma_f32 v223, v11, v118, v119
v_cvt_pk_bf16_f32 v95, v222, v223
s_waitcnt lgkmcnt(2)
ds_write_b64 v212, v[94:95]
v_fma_f32 v220, v12, v126, v127
v_fma_f32 v221, v13, v126, v127
v_cvt_pk_bf16_f32 v174, v220, v221
v_fma_f32 v222, v14, v126, v127
v_fma_f32 v223, v15, v126, v127
v_cvt_pk_bf16_f32 v175, v222, v223
v_fma_f32 v220, v16, v126, v127
v_fma_f32 v221, v17, v126, v127
v_cvt_pk_bf16_f32 v176, v220, v221
v_fma_f32 v222, v18, v126, v127
v_fma_f32 v223, v19, v126, v127
v_cvt_pk_bf16_f32 v177, v222, v223
ds_write_b128 v211, v[174:177] offset:6144
v_fma_f32 v220, v20, v126, v127
v_fma_f32 v221, v21, v126, v127
v_cvt_pk_bf16_f32 v178, v220, v221
v_fma_f32 v222, v22, v126, v127
v_fma_f32 v223, v23, v126, v127
v_cvt_pk_bf16_f32 v179, v222, v223
s_waitcnt lgkmcnt(3)
ds_write_b64 v212, v[178:179] offset:6144
v_fma_f32 v220, v24, v134, v135
v_fma_f32 v221, v25, v134, v135
v_cvt_pk_bf16_f32 v90, v220, v221
v_fma_f32 v222, v26, v134, v135
v_fma_f32 v223, v27, v134, v135
v_cvt_pk_bf16_f32 v91, v222, v223
v_fma_f32 v220, v28, v134, v135
v_fma_f32 v221, v29, v134, v135
v_cvt_pk_bf16_f32 v92, v220, v221
v_fma_f32 v222, v30, v134, v135
v_fma_f32 v223, v31, v134, v135
v_cvt_pk_bf16_f32 v93, v222, v223
ds_write_b128 v211, v[90:93] offset:12288
v_fma_f32 v220, v32, v134, v135
v_fma_f32 v221, v33, v134, v135
v_cvt_pk_bf16_f32 v94, v220, v221
v_fma_f32 v222, v34, v134, v135
v_fma_f32 v223, v35, v134, v135
v_cvt_pk_bf16_f32 v95, v222, v223
ds_write_b64 v212, v[94:95] offset:12288
ds_read_b128 v[182:185], v210 offset:18432
s_waitcnt lgkmcnt(0)
v_mfma_f32_16x16x32_bf16 v[138:141], a[0:3], v[182:185], 0
v_mfma_f32_16x16x32_bf16 v[142:145], a[24:27], v[182:185], 0
v_mfma_f32_16x16x32_bf16 v[146:149], a[48:51], v[182:185], 0
v_mfma_f32_16x16x32_bf16 v[150:153], a[216:219], v[182:185], 0
v_mfma_f32_16x16x32_bf16 v[154:157], a[240:243], v[182:185], 0
v_mfma_f32_16x16x32_bf16 v[158:161], v[232:235], v[182:185], 0
v_mfma_f32_16x16x32_bf16 v[162:165], v[182:185], a[72:75], 0
v_mfma_f32_16x16x32_bf16 v[166:169], v[182:185], a[96:99], 0
v_mfma_f32_16x16x32_bf16 v[170:173], v[182:185], a[120:123], 0
ds_read_b128 v[186:189], v210 offset:19456
s_waitcnt lgkmcnt(0)
v_mfma_f32_16x16x32_bf16 v[138:141], a[4:7], v[186:189], v[138:141]
v_mfma_f32_16x16x32_bf16 v[142:145], a[28:31], v[186:189], v[142:145]
v_mfma_f32_16x16x32_bf16 v[146:149], a[52:55], v[186:189], v[146:149]
v_mfma_f32_16x16x32_bf16 v[150:153], a[220:223], v[186:189], v[150:153]
v_mfma_f32_16x16x32_bf16 v[154:157], a[244:247], v[186:189], v[154:157]
v_mfma_f32_16x16x32_bf16 v[158:161], v[236:239], v[186:189], v[158:161]
v_mfma_f32_16x16x32_bf16 v[162:165], v[186:189], a[76:79], v[162:165]
v_mfma_f32_16x16x32_bf16 v[166:169], v[186:189], a[100:103], v[166:169]
v_mfma_f32_16x16x32_bf16 v[170:173], v[186:189], a[124:127], v[170:173]
ds_read_b128 v[182:185], v210 offset:20480
s_waitcnt lgkmcnt(0)
v_mfma_f32_16x16x32_bf16 v[138:141], a[8:11], v[182:185], v[138:141]
v_mfma_f32_16x16x32_bf16 v[142:145], a[32:35], v[182:185], v[142:145]
v_mfma_f32_16x16x32_bf16 v[146:149], a[56:59], v[182:185], v[146:149]
v_mfma_f32_16x16x32_bf16 v[150:153], a[224:227], v[182:185], v[150:153]
v_mfma_f32_16x16x32_bf16 v[154:157], a[248:251], v[182:185], v[154:157]
v_mfma_f32_16x16x32_bf16 v[158:161], v[240:243], v[182:185], v[158:161]
v_mfma_f32_16x16x32_bf16 v[162:165], v[182:185], a[80:83], v[162:165]
v_mfma_f32_16x16x32_bf16 v[166:169], v[182:185], a[104:107], v[166:169]
v_mfma_f32_16x16x32_bf16 v[170:173], v[182:185], a[128:131], v[170:173]
ds_read_b128 v[186:189], v210 offset:21504
s_waitcnt lgkmcnt(0)
v_mfma_f32_16x16x32_bf16 v[138:141], a[12:15], v[186:189], v[138:141]
v_mfma_f32_16x16x32_bf16 v[142:145], a[36:39], v[186:189], v[142:145]
v_mfma_f32_16x16x32_bf16 v[146:149], a[60:63], v[186:189], v[146:149]
v_mfma_f32_16x16x32_bf16 v[150:153], a[228:231], v[186:189], v[150:153]
v_mfma_f32_16x16x32_bf16 v[154:157], a[252:255], v[186:189], v[154:157]
v_mfma_f32_16x16x32_bf16 v[158:161], v[244:247], v[186:189], v[158:161]
v_mfma_f32_16x16x32_bf16 v[162:165], v[186:189], a[84:87], v[162:165]
v_mfma_f32_16x16x32_bf16 v[166:169], v[186:189], a[108:111], v[166:169]
v_mfma_f32_16x16x32_bf16 v[170:173], v[186:189], a[132:135], v[170:173]
ds_read_b128 v[182:185], v210 offset:22528
s_waitcnt lgkmcnt(0)
v_mfma_f32_16x16x32_bf16 v[138:141], a[16:19], v[182:185], v[138:141]
v_mfma_f32_16x16x32_bf16 v[142:145], a[40:43], v[182:185], v[142:145]
v_mfma_f32_16x16x32_bf16 v[146:149], a[64:67], v[182:185], v[146:149]
v_mfma_f32_16x16x32_bf16 v[150:153], a[232:235], v[182:185], v[150:153]
v_mfma_f32_16x16x32_bf16 v[154:157], v[224:227], v[182:185], v[154:157]
v_mfma_f32_16x16x32_bf16 v[158:161], v[248:251], v[182:185], v[158:161]
v_mfma_f32_16x16x32_bf16 v[162:165], v[182:185], a[88:91], v[162:165]
v_mfma_f32_16x16x32_bf16 v[166:169], v[182:185], a[112:115], v[166:169]
v_mfma_f32_16x16x32_bf16 v[170:173], v[182:185], a[136:139], v[170:173]
ds_read_b128 v[186:189], v210 offset:23552
s_waitcnt lgkmcnt(0)
v_mfma_f32_16x16x32_bf16 v[138:141], a[20:23], v[186:189], v[138:141]
v_mfma_f32_16x16x32_bf16 v[142:145], a[44:47], v[186:189], v[142:145]
v_mfma_f32_16x16x32_bf16 v[146:149], a[68:71], v[186:189], v[146:149]
v_mfma_f32_16x16x32_bf16 v[150:153], a[236:239], v[186:189], v[150:153]
v_mfma_f32_16x16x32_bf16 v[154:157], v[228:231], v[186:189], v[154:157]
v_mfma_f32_16x16x32_bf16 v[158:161], v[252:255], v[186:189], v[158:161]
v_mfma_f32_16x16x32_bf16 v[162:165], v[186:189], a[92:95], v[162:165]
v_mfma_f32_16x16x32_bf16 v[166:169], v[186:189], a[116:119], v[166:169]
v_mfma_f32_16x16x32_bf16 v[170:173], v[186:189], a[140:143], v[170:173]
v_cvt_pk_bf16_f32 v78, v138, v139
v_cvt_pk_bf16_f32 v79, v140, v141
v_cvt_pk_bf16_f32 v80, v142, v143
v_cvt_pk_bf16_f32 v81, v144, v145
v_cvt_pk_bf16_f32 v82, v146, v147
v_cvt_pk_bf16_f32 v83, v148, v149
v_cvt_pk_bf16_f32 v72, v150, v151
v_cvt_pk_bf16_f32 v73, v152, v153
v_cvt_pk_bf16_f32 v74, v154, v155
v_cvt_pk_bf16_f32 v75, v156, v157
v_cvt_pk_bf16_f32 v76, v158, v159
v_cvt_pk_bf16_f32 v77, v160, v161
v_cvt_pk_bf16_f32 v114, v162, v163
v_cvt_pk_bf16_f32 v115, v164, v165
v_cvt_pk_bf16_f32 v122, v166, v167
v_cvt_pk_bf16_f32 v123, v168, v169
v_cvt_pk_bf16_f32 v130, v170, v171
v_cvt_pk_bf16_f32 v131, v172, v173
ds_read_b128 v[182:185], v210 offset:24576
s_waitcnt lgkmcnt(0)
v_mfma_f32_16x16x32_bf16 v[138:141], a[0:3], v[182:185], 0
v_mfma_f32_16x16x32_bf16 v[142:145], a[24:27], v[182:185], 0
v_mfma_f32_16x16x32_bf16 v[146:149], a[48:51], v[182:185], 0
v_mfma_f32_16x16x32_bf16 v[150:153], a[216:219], v[182:185], 0
v_mfma_f32_16x16x32_bf16 v[154:157], a[240:243], v[182:185], 0
v_mfma_f32_16x16x32_bf16 v[158:161], v[232:235], v[182:185], 0
v_mfma_f32_16x16x32_bf16 v[162:165], v[182:185], a[72:75], 0
v_mfma_f32_16x16x32_bf16 v[166:169], v[182:185], a[96:99], 0
v_mfma_f32_16x16x32_bf16 v[170:173], v[182:185], a[120:123], 0
ds_read_b128 v[186:189], v210 offset:25600
s_waitcnt lgkmcnt(0)
v_mfma_f32_16x16x32_bf16 v[138:141], a[4:7], v[186:189], v[138:141]
v_mfma_f32_16x16x32_bf16 v[142:145], a[28:31], v[186:189], v[142:145]
v_mfma_f32_16x16x32_bf16 v[146:149], a[52:55], v[186:189], v[146:149]
v_mfma_f32_16x16x32_bf16 v[150:153], a[220:223], v[186:189], v[150:153]
v_mfma_f32_16x16x32_bf16 v[154:157], a[244:247], v[186:189], v[154:157]
v_mfma_f32_16x16x32_bf16 v[158:161], v[236:239], v[186:189], v[158:161]
v_mfma_f32_16x16x32_bf16 v[162:165], v[186:189], a[76:79], v[162:165]
v_mfma_f32_16x16x32_bf16 v[166:169], v[186:189], a[100:103], v[166:169]
v_mfma_f32_16x16x32_bf16 v[170:173], v[186:189], a[124:127], v[170:173]
ds_read_b128 v[182:185], v210 offset:26624
s_waitcnt lgkmcnt(0)
v_mfma_f32_16x16x32_bf16 v[138:141], a[8:11], v[182:185], v[138:141]
v_mfma_f32_16x16x32_bf16 v[142:145], a[32:35], v[182:185], v[142:145]
v_mfma_f32_16x16x32_bf16 v[146:149], a[56:59], v[182:185], v[146:149]
v_mfma_f32_16x16x32_bf16 v[150:153], a[224:227], v[182:185], v[150:153]
v_mfma_f32_16x16x32_bf16 v[154:157], a[248:251], v[182:185], v[154:157]
v_mfma_f32_16x16x32_bf16 v[158:161], v[240:243], v[182:185], v[158:161]
v_mfma_f32_16x16x32_bf16 v[162:165], v[182:185], a[80:83], v[162:165]
v_mfma_f32_16x16x32_bf16 v[166:169], v[182:185], a[104:107], v[166:169]
v_mfma_f32_16x16x32_bf16 v[170:173], v[182:185], a[128:131], v[170:173]
ds_read_b128 v[186:189], v210 offset:27648
s_waitcnt lgkmcnt(0)
v_mfma_f32_16x16x32_bf16 v[138:141], a[12:15], v[186:189], v[138:141]
v_mfma_f32_16x16x32_bf16 v[142:145], a[36:39], v[186:189], v[142:145]
v_mfma_f32_16x16x32_bf16 v[146:149], a[60:63], v[186:189], v[146:149]
v_mfma_f32_16x16x32_bf16 v[150:153], a[228:231], v[186:189], v[150:153]
v_mfma_f32_16x16x32_bf16 v[154:157], a[252:255], v[186:189], v[154:157]
v_mfma_f32_16x16x32_bf16 v[158:161], v[244:247], v[186:189], v[158:161]
v_mfma_f32_16x16x32_bf16 v[162:165], v[186:189], a[84:87], v[162:165]
v_mfma_f32_16x16x32_bf16 v[166:169], v[186:189], a[108:111], v[166:169]
v_mfma_f32_16x16x32_bf16 v[170:173], v[186:189], a[132:135], v[170:173]
ds_read_b128 v[182:185], v210 offset:28672
s_waitcnt lgkmcnt(0)
v_mfma_f32_16x16x32_bf16 v[138:141], a[16:19], v[182:185], v[138:141]
v_mfma_f32_16x16x32_bf16 v[142:145], a[40:43], v[182:185], v[142:145]
v_mfma_f32_16x16x32_bf16 v[146:149], a[64:67], v[182:185], v[146:149]
v_mfma_f32_16x16x32_bf16 v[150:153], a[232:235], v[182:185], v[150:153]
v_mfma_f32_16x16x32_bf16 v[154:157], v[224:227], v[182:185], v[154:157]
v_mfma_f32_16x16x32_bf16 v[158:161], v[248:251], v[182:185], v[158:161]
v_mfma_f32_16x16x32_bf16 v[162:165], v[182:185], a[88:91], v[162:165]
v_mfma_f32_16x16x32_bf16 v[166:169], v[182:185], a[112:115], v[166:169]
v_mfma_f32_16x16x32_bf16 v[170:173], v[182:185], a[136:139], v[170:173]
ds_read_b128 v[186:189], v210 offset:29696
s_waitcnt lgkmcnt(0)
v_mfma_f32_16x16x32_bf16 v[138:141], a[20:23], v[186:189], v[138:141]
v_mfma_f32_16x16x32_bf16 v[142:145], a[44:47], v[186:189], v[142:145]
v_mfma_f32_16x16x32_bf16 v[146:149], a[68:71], v[186:189], v[146:149]
v_mfma_f32_16x16x32_bf16 v[150:153], a[236:239], v[186:189], v[150:153]
v_mfma_f32_16x16x32_bf16 v[154:157], v[228:231], v[186:189], v[154:157]
v_mfma_f32_16x16x32_bf16 v[158:161], v[252:255], v[186:189], v[158:161]
v_mfma_f32_16x16x32_bf16 v[162:165], v[186:189], a[92:95], v[162:165]
v_mfma_f32_16x16x32_bf16 v[166:169], v[186:189], a[116:119], v[166:169]
v_mfma_f32_16x16x32_bf16 v[170:173], v[186:189], a[140:143], v[170:173]
v_cvt_pk_bf16_f32 v96, v138, v139
v_cvt_pk_bf16_f32 v97, v140, v141
v_cvt_pk_bf16_f32 v98, v142, v143
v_cvt_pk_bf16_f32 v99, v144, v145
v_cvt_pk_bf16_f32 v100, v146, v147
v_cvt_pk_bf16_f32 v101, v148, v149
v_cvt_pk_bf16_f32 v84, v150, v151
v_cvt_pk_bf16_f32 v85, v152, v153
v_cvt_pk_bf16_f32 v86, v154, v155
v_cvt_pk_bf16_f32 v87, v156, v157
v_cvt_pk_bf16_f32 v88, v158, v159
v_cvt_pk_bf16_f32 v89, v160, v161
v_cvt_pk_bf16_f32 v116, v162, v163
v_cvt_pk_bf16_f32 v117, v164, v165
v_cvt_pk_bf16_f32 v124, v166, v167
v_cvt_pk_bf16_f32 v125, v168, v169
v_cvt_pk_bf16_f32 v132, v170, v171
v_cvt_pk_bf16_f32 v133, v172, v173
ds_read_b128 v[182:185], v210 offset:30720
s_waitcnt lgkmcnt(0)
v_mfma_f32_16x16x32_bf16 v[138:141], a[0:3], v[182:185], 0
v_mfma_f32_16x16x32_bf16 v[142:145], a[24:27], v[182:185], 0
v_mfma_f32_16x16x32_bf16 v[146:149], a[48:51], v[182:185], 0
ds_read_b128 v[186:189], v210 offset:31744
s_waitcnt lgkmcnt(0)
v_mfma_f32_16x16x32_bf16 v[138:141], a[4:7], v[186:189], v[138:141]
v_mfma_f32_16x16x32_bf16 v[142:145], a[28:31], v[186:189], v[142:145]
v_mfma_f32_16x16x32_bf16 v[146:149], a[52:55], v[186:189], v[146:149]
ds_read_b128 v[182:185], v210 offset:32768
s_waitcnt lgkmcnt(0)
v_mfma_f32_16x16x32_bf16 v[138:141], a[8:11], v[182:185], v[138:141]
v_mfma_f32_16x16x32_bf16 v[142:145], a[32:35], v[182:185], v[142:145]
v_mfma_f32_16x16x32_bf16 v[146:149], a[56:59], v[182:185], v[146:149]
ds_read_b128 v[186:189], v210 offset:33792
s_waitcnt lgkmcnt(0)
v_mfma_f32_16x16x32_bf16 v[138:141], a[12:15], v[186:189], v[138:141]
v_mfma_f32_16x16x32_bf16 v[142:145], a[36:39], v[186:189], v[142:145]
v_mfma_f32_16x16x32_bf16 v[146:149], a[60:63], v[186:189], v[146:149]
ds_read_b128 v[182:185], v210 offset:34816
s_waitcnt lgkmcnt(0)
v_mfma_f32_16x16x32_bf16 v[138:141], a[16:19], v[182:185], v[138:141]
v_mfma_f32_16x16x32_bf16 v[142:145], a[40:43], v[182:185], v[142:145]
v_mfma_f32_16x16x32_bf16 v[146:149], a[64:67], v[182:185], v[146:149]
ds_read_b128 v[186:189], v210 offset:35840
s_waitcnt lgkmcnt(0)
v_mfma_f32_16x16x32_bf16 v[138:141], a[20:23], v[186:189], v[138:141]
v_mfma_f32_16x16x32_bf16 v[142:145], a[44:47], v[186:189], v[142:145]
v_mfma_f32_16x16x32_bf16 v[146:149], a[68:71], v[186:189], v[146:149]
v_cvt_pk_bf16_f32 v102, v138, v139
v_cvt_pk_bf16_f32 v103, v140, v141
s_nop 0
v_cvt_pk_bf16_f32 v104, v142, v143
v_cvt_pk_bf16_f32 v105, v144, v145
s_nop 1
v_cvt_pk_bf16_f32 v106, v146, v147
v_cvt_pk_bf16_f32 v107, v148, v149
ds_read_b128 v[108:111], v215 offset:512
ds_read_b64 v[112:113], v215 offset:528
v_mov_b32 v181, 0
v_mfma_f32_16x16x32_bf16 v[138:141], v[78:81], v[72:75], 0
v_mfma_f32_16x16x32_bf16 v[142:145], v[96:99], v[72:75], 0
s_waitcnt lgkmcnt(1)
v_mfma_f32_16x16x32_bf16 v[150:153], v[108:111], v[72:75], v[206:209]
v_mfma_f32_16x16x32_bf16 v[146:149], v[102:105], v[72:75], 0
v_mfma_f32_16x16x16_bf16 v[138:141], v[82:83], v[76:77], v[138:141]
v_mfma_f32_16x16x16_bf16 v[142:145], v[100:101], v[76:77], v[142:145]
s_waitcnt lgkmcnt(0)
v_mfma_f32_16x16x16_bf16 v[150:153], v[112:113], v[76:77], v[150:153]
v_mfma_f32_16x16x16_bf16 v[146:149], v[106:107], v[76:77], v[146:149]
ds_read_b128 v[72:75], v215
ds_read_b64 v[76:77], v215 offset:16
v_mfma_f32_16x16x32_bf16 v[154:157], v[78:81], v[84:87], 0
v_mfma_f32_16x16x32_bf16 v[158:161], v[96:99], v[84:87], 0
v_mfma_f32_16x16x32_bf16 v[166:169], v[108:111], v[84:87], v[206:209]
v_mfma_f32_16x16x32_bf16 v[162:165], v[102:105], v[84:87], 0
v_mfma_f32_16x16x16_bf16 v[154:157], v[82:83], v[88:89], v[154:157]
v_mfma_f32_16x16x16_bf16 v[158:161], v[100:101], v[88:89], v[158:161]
v_mfma_f32_16x16x16_bf16 v[166:169], v[112:113], v[88:89], v[166:169]
v_mfma_f32_16x16x16_bf16 v[162:165], v[106:107], v[88:89], v[162:165]
ds_read_b128 v[182:185], v210 offset:30720
s_waitcnt lgkmcnt(0)
v_mfma_f32_16x16x32_bf16 v[118:121], v[182:185], a[72:75], 0
v_mfma_f32_16x16x32_bf16 v[126:129], v[182:185], a[96:99], 0
v_mfma_f32_16x16x32_bf16 v[134:137], v[182:185], a[120:123], 0
v_mfma_f32_16x16x32_bf16 v[90:93], a[216:219], v[182:185], 0
v_mfma_f32_16x16x32_bf16 v[170:173], a[240:243], v[182:185], 0
v_mfma_f32_16x16x32_bf16 v[220:223], v[232:235], v[182:185], 0
ds_read_b128 v[186:189], v210 offset:31744
s_waitcnt lgkmcnt(0)
v_mfma_f32_16x16x32_bf16 v[118:121], v[186:189], a[76:79], v[118:121]
v_mfma_f32_16x16x32_bf16 v[126:129], v[186:189], a[100:103], v[126:129]
v_mfma_f32_16x16x32_bf16 v[134:137], v[186:189], a[124:127], v[134:137]
v_mfma_f32_16x16x32_bf16 v[90:93], a[220:223], v[186:189], v[90:93]
v_mfma_f32_16x16x32_bf16 v[170:173], a[244:247], v[186:189], v[170:173]
v_mfma_f32_16x16x32_bf16 v[220:223], v[236:239], v[186:189], v[220:223]
ds_read_b128 v[182:185], v210 offset:32768
s_waitcnt lgkmcnt(0)
v_mfma_f32_16x16x32_bf16 v[118:121], v[182:185], a[80:83], v[118:121]
v_mfma_f32_16x16x32_bf16 v[126:129], v[182:185], a[104:107], v[126:129]
v_mfma_f32_16x16x32_bf16 v[134:137], v[182:185], a[128:131], v[134:137]
v_mfma_f32_16x16x32_bf16 v[90:93], a[224:227], v[182:185], v[90:93]
v_mfma_f32_16x16x32_bf16 v[170:173], a[248:251], v[182:185], v[170:173]
v_mfma_f32_16x16x32_bf16 v[220:223], v[240:243], v[182:185], v[220:223]
ds_read_b128 v[186:189], v210 offset:33792
s_waitcnt lgkmcnt(0)
v_mfma_f32_16x16x32_bf16 v[118:121], v[186:189], a[84:87], v[118:121]
v_mfma_f32_16x16x32_bf16 v[126:129], v[186:189], a[108:111], v[126:129]
v_mfma_f32_16x16x32_bf16 v[134:137], v[186:189], a[132:135], v[134:137]
v_mfma_f32_16x16x32_bf16 v[90:93], a[228:231], v[186:189], v[90:93]
v_mfma_f32_16x16x32_bf16 v[170:173], a[252:255], v[186:189], v[170:173]
v_mfma_f32_16x16x32_bf16 v[220:223], v[244:247], v[186:189], v[220:223]
ds_read_b128 v[182:185], v210 offset:34816
s_waitcnt lgkmcnt(0)
v_mfma_f32_16x16x32_bf16 v[118:121], v[182:185], a[88:91], v[118:121]
v_mfma_f32_16x16x32_bf16 v[126:129], v[182:185], a[112:115], v[126:129]
v_mfma_f32_16x16x32_bf16 v[134:137], v[182:185], a[136:139], v[134:137]
v_mfma_f32_16x16x32_bf16 v[90:93], a[232:235], v[182:185], v[90:93]
v_mfma_f32_16x16x32_bf16 v[170:173], v[224:227], v[182:185], v[170:173]
v_mfma_f32_16x16x32_bf16 v[220:223], v[248:251], v[182:185], v[220:223]
ds_read_b128 v[186:189], v210 offset:35840
s_waitcnt lgkmcnt(0)
v_mfma_f32_16x16x32_bf16 v[118:121], v[186:189], a[92:95], v[118:121]
v_mfma_f32_16x16x32_bf16 v[126:129], v[186:189], a[116:119], v[126:129]
v_mfma_f32_16x16x32_bf16 v[134:137], v[186:189], a[140:143], v[134:137]
v_mfma_f32_16x16x32_bf16 v[90:93], a[236:239], v[186:189], v[90:93]
v_mfma_f32_16x16x32_bf16 v[170:173], v[228:231], v[186:189], v[170:173]
v_mfma_f32_16x16x32_bf16 v[220:223], v[252:255], v[186:189], v[220:223]
v_cvt_pk_bf16_f32 v118, v118, v119
v_cvt_pk_bf16_f32 v119, v120, v121
ds_read_u16 v120, v216
v_mov_b32 v121, 0
v_cvt_pk_bf16_f32 v126, v126, v127
v_cvt_pk_bf16_f32 v127, v128, v129
ds_read_u16 v128, v216 offset:32
v_mov_b32 v129, 0
v_cvt_pk_bf16_f32 v134, v134, v135
v_cvt_pk_bf16_f32 v135, v136, v137
ds_read_u16 v136, v216 offset:64
v_mov_b32 v137, 0
v_add_u32 v216, 1408, v216
v_cvt_pk_bf16_f32 v90, v90, v91
v_cvt_pk_bf16_f32 v91, v92, v93
v_cvt_pk_bf16_f32 v92, v170, v171
v_cvt_pk_bf16_f32 v93, v172, v173
v_cvt_pk_bf16_f32 v94, v220, v221
v_cvt_pk_bf16_f32 v95, v222, v223
v_max3_f32 v151, v138, v139, v140
v_max3_f32 v151, v151, v141, v142
v_max3_f32 v151, v151, v143, v144
v_max3_f32 v151, v151, v145, v146
v_max3_f32 v151, v151, v147, v148
v_max3_f32 v151, v151, v149, v150
v_mov_b32 v152, v151
s_nop 1
v_permlane16_swap_b32 v151, v152
v_max_f32 v151, v151, v152
v_mov_b32 v152, v151
s_nop 1
v_permlane32_swap_b32 v151, v152
v_max_f32 v151, v151, v152
v_sub_f32 v138, v138, v151
v_sub_f32 v139, v139, v151
v_sub_f32 v140, v140, v151
v_sub_f32 v141, v141, v151
v_sub_f32 v142, v142, v151
v_sub_f32 v143, v143, v151
v_sub_f32 v144, v144, v151
v_sub_f32 v145, v145, v151
v_sub_f32 v150, v150, v151
v_sub_f32 v146, v146, v151
v_sub_f32 v147, v147, v151
v_sub_f32 v148, v148, v151
v_sub_f32 v149, v149, v151
v_exp_f32 v138, v138
v_exp_f32 v139, v139
v_exp_f32 v140, v140
v_exp_f32 v141, v141
v_exp_f32 v142, v142
v_exp_f32 v143, v143
v_exp_f32 v144, v144
v_exp_f32 v145, v145
v_exp_f32 v150, v150
v_exp_f32 v146, v146
v_exp_f32 v147, v147
v_exp_f32 v148, v148
v_exp_f32 v149, v149
v_cvt_pk_bf16_f32 v174, v138, v139
v_cvt_pk_bf16_f32 v175, v140, v141
v_cvt_pk_bf16_f32 v176, v142, v143
v_cvt_pk_bf16_f32 v177, v144, v145
v_cvt_pk_bf16_f32 v178, v146, v147
v_cvt_pk_bf16_f32 v179, v148, v149
v_cvt_pk_bf16_f32 v180, v150, 0
v_mfma_f32_16x16x32_bf16 v[150:153], v[190:193], v[174:177], 0
v_mfma_f32_16x16x32_bf16 v[138:141], v[114:117], v[174:177], 0
v_mfma_f32_16x16x32_bf16 v[142:145], v[122:125], v[174:177], 0
v_mfma_f32_16x16x32_bf16 v[146:149], v[130:133], v[174:177], 0
v_mfma_f32_16x16x32_bf16 v[150:153], v[190:193], v[178:181], v[150:153]
s_waitcnt lgkmcnt(2)
v_mfma_f32_16x16x32_bf16 v[138:141], v[118:121], v[178:181], v[138:141]
s_waitcnt lgkmcnt(1)
v_mfma_f32_16x16x32_bf16 v[142:145], v[126:129], v[178:181], v[142:145]
s_waitcnt lgkmcnt(0)
v_mfma_f32_16x16x32_bf16 v[146:149], v[134:137], v[178:181], v[146:149]
v_max3_f32 v167, v154, v155, v156
v_max3_f32 v167, v167, v157, v158
v_max3_f32 v167, v167, v159, v160
v_max3_f32 v167, v167, v161, v162
v_max3_f32 v167, v167, v163, v164
v_max3_f32 v167, v167, v165, v166
v_mov_b32 v168, v167
s_nop 1
v_permlane16_swap_b32 v167, v168
v_max_f32 v167, v167, v168
v_mov_b32 v168, v167
s_nop 1
v_permlane32_swap_b32 v167, v168
v_max_f32 v167, v167, v168
v_sub_f32 v154, v154, v167
v_sub_f32 v155, v155, v167
v_sub_f32 v156, v156, v167
v_sub_f32 v157, v157, v167
v_sub_f32 v158, v158, v167
v_sub_f32 v159, v159, v167
v_sub_f32 v160, v160, v167
v_sub_f32 v161, v161, v167
v_sub_f32 v166, v166, v167
v_sub_f32 v162, v162, v167
v_sub_f32 v163, v163, v167
v_sub_f32 v164, v164, v167
v_sub_f32 v165, v165, v167
v_exp_f32 v154, v154
v_exp_f32 v155, v155
v_exp_f32 v156, v156
v_exp_f32 v157, v157
v_exp_f32 v158, v158
v_exp_f32 v159, v159
v_exp_f32 v160, v160
v_exp_f32 v161, v161
v_exp_f32 v166, v166
v_exp_f32 v162, v162
v_exp_f32 v163, v163
v_exp_f32 v164, v164
v_exp_f32 v165, v165
v_cvt_pk_bf16_f32 v174, v154, v155
v_cvt_pk_bf16_f32 v175, v156, v157
v_cvt_pk_bf16_f32 v176, v158, v159
v_cvt_pk_bf16_f32 v177, v160, v161
v_cvt_pk_bf16_f32 v178, v162, v163
v_cvt_pk_bf16_f32 v179, v164, v165
v_cvt_pk_bf16_f32 v180, v166, 0
v_mfma_f32_16x16x32_bf16 v[166:169], v[190:193], v[174:177], 0
v_mfma_f32_16x16x32_bf16 v[154:157], v[114:117], v[174:177], 0
v_mfma_f32_16x16x32_bf16 v[158:161], v[122:125], v[174:177], 0
v_mfma_f32_16x16x32_bf16 v[162:165], v[130:133], v[174:177], 0
v_mfma_f32_16x16x32_bf16 v[166:169], v[190:193], v[178:181], v[166:169]
v_mfma_f32_16x16x32_bf16 v[154:157], v[118:121], v[178:181], v[154:157]
v_mfma_f32_16x16x32_bf16 v[158:161], v[126:129], v[178:181], v[158:161]
v_mfma_f32_16x16x32_bf16 v[162:165], v[134:137], v[178:181], v[162:165]
v_rcp_f32 v151, v150
s_nop 0
v_mul_f32 v151, s3, v151
v_mul_f32 v138, v138, v151
v_mul_f32 v139, v139, v151
v_cvt_pk_bf16_f32 v138, v138, v139
v_mul_f32 v140, v140, v151
v_mul_f32 v141, v141, v151
v_cvt_pk_bf16_f32 v139, v140, v141
v_mul_f32 v142, v142, v151
v_mul_f32 v143, v143, v151
v_cvt_pk_bf16_f32 v140, v142, v143
v_mul_f32 v144, v144, v151
v_mul_f32 v145, v145, v151
v_cvt_pk_bf16_f32 v141, v144, v145
ds_write_b128 v211, v[138:141] offset:36864
v_mul_f32 v146, v146, v151
v_mul_f32 v147, v147, v151
v_cvt_pk_bf16_f32 v142, v146, v147
v_mul_f32 v148, v148, v151
v_mul_f32 v149, v149, v151
v_cvt_pk_bf16_f32 v143, v148, v149
ds_write_b64 v212, v[142:143] offset:36864
v_mfma_f32_16x16x32_bf16 v[138:141], v[78:81], v[90:93], 0
v_mfma_f32_16x16x32_bf16 v[142:145], v[96:99], v[90:93], 0
v_mfma_f32_16x16x32_bf16 v[150:153], v[108:111], v[90:93], v[206:209]
v_mfma_f32_16x16x32_bf16 v[146:149], v[102:105], v[90:93], 0
v_mfma_f32_16x16x16_bf16 v[138:141], v[82:83], v[94:95], v[138:141]
v_mfma_f32_16x16x16_bf16 v[142:145], v[100:101], v[94:95], v[142:145]
v_mfma_f32_16x16x16_bf16 v[150:153], v[112:113], v[94:95], v[150:153]
v_mfma_f32_16x16x16_bf16 v[146:149], v[106:107], v[94:95], v[146:149]
v_rcp_f32 v167, v166
s_nop 0
v_mul_f32 v167, s3, v167
v_mul_f32 v154, v154, v167
v_mul_f32 v155, v155, v167
v_cvt_pk_bf16_f32 v154, v154, v155
v_mul_f32 v156, v156, v167
v_mul_f32 v157, v157, v167
v_cvt_pk_bf16_f32 v155, v156, v157
v_mul_f32 v158, v158, v167
v_mul_f32 v159, v159, v167
v_cvt_pk_bf16_f32 v156, v158, v159
v_mul_f32 v160, v160, v167
v_mul_f32 v161, v161, v167
v_cvt_pk_bf16_f32 v157, v160, v161
ds_write_b128 v211, v[154:157] offset:43008
v_mul_f32 v162, v162, v167
v_mul_f32 v163, v163, v167
v_cvt_pk_bf16_f32 v158, v162, v163
v_mul_f32 v164, v164, v167
v_mul_f32 v165, v165, v167
v_cvt_pk_bf16_f32 v159, v164, v165
ds_write_b64 v212, v[158:159] offset:43008
v_mfma_f32_16x16x32_bf16 v[154:157], v[72:75], v[78:81], 0
v_mfma_f32_16x16x32_bf16 v[158:161], v[72:75], v[96:99], 0
v_mfma_f32_16x16x32_bf16 v[162:165], v[72:75], v[102:105], 0
v_mfma_f32_16x16x32_bf16 v[166:169], v[72:75], v[108:111], v[206:209]
v_mfma_f32_16x16x16_bf16 v[154:157], v[76:77], v[82:83], v[154:157]
v_mfma_f32_16x16x16_bf16 v[158:161], v[76:77], v[100:101], v[158:161]
v_mfma_f32_16x16x16_bf16 v[162:165], v[76:77], v[106:107], v[162:165]
v_mfma_f32_16x16x16_bf16 v[166:169], v[76:77], v[112:113], v[166:169]
v_mov_b32_dpp v154, v158 quad_perm:[0,1,2,3] row_mask:0x2 bank_mask:0xf
s_nop 1
v_mov_b32_dpp v154, v162 quad_perm:[0,1,2,3] row_mask:0x4 bank_mask:0xf
s_nop 2
v_mov_b32_dpp v154, v167 quad_perm:[0,1,2,3] row_mask:0x8 bank_mask:0xf
v_mov_b32 v155, v154
s_nop 1
v_max_f32_dpp v155, v155, v155 row_ror:8 row_mask:0xf bank_mask:0xf
s_nop 1
v_max_f32_dpp v155, v155, v155 row_ror:4 row_mask:0xf bank_mask:0xf
s_nop 1
v_max_f32_dpp v155, v155, v155 row_ror:2 row_mask:0xf bank_mask:0xf
s_nop 1
v_max_f32_dpp v155, v155, v155 row_ror:1 row_mask:0xf bank_mask:0xf
v_mov_b32 v156, v155
s_nop 1
v_permlane16_swap_b32 v155, v156
v_max_f32 v155, v155, v156
v_mov_b32 v156, v155
s_nop 1
v_permlane32_swap_b32 v155, v156
v_max_f32 v155, v155, v156
v_sub_f32 v154, v154, v155
v_exp_f32 v154, v154
s_nop 0
v_cvt_pk_bf16_f32 v154, v154, 0
ds_write_b16 v214, v154
s_waitcnt lgkmcnt(1)
ds_read_b128 v[84:87], v215
ds_read_b128 v[88:91], v215 offset:16
v_add_u32 v215, 1408, v215
s_barrier
ds_read_b128 v[170:173], v210 offset:36864
s_waitcnt lgkmcnt(0)
v_mfma_f32_16x16x32_bf16 v[36:39], a[144:147], v[170:173], v[36:39]
v_mfma_f32_16x16x32_bf16 v[40:43], a[168:171], v[170:173], v[40:43]
v_mfma_f32_16x16x32_bf16 v[44:47], a[192:195], v[170:173], v[44:47]
ds_read_b128 v[182:185], v210 offset:37888
s_waitcnt lgkmcnt(0)
v_mfma_f32_16x16x32_bf16 v[36:39], a[148:151], v[182:185], v[36:39]
v_mfma_f32_16x16x32_bf16 v[40:43], a[172:175], v[182:185], v[40:43]
v_mfma_f32_16x16x32_bf16 v[44:47], a[196:199], v[182:185], v[44:47]
ds_read_b128 v[186:189], v210 offset:38912
s_waitcnt lgkmcnt(0)
v_mfma_f32_16x16x32_bf16 v[36:39], a[152:155], v[186:189], v[36:39]
v_mfma_f32_16x16x32_bf16 v[40:43], a[176:179], v[186:189], v[40:43]
v_mfma_f32_16x16x32_bf16 v[44:47], a[200:203], v[186:189], v[44:47]
ds_read_b128 v[170:173], v210 offset:39936
s_waitcnt lgkmcnt(0)
v_mfma_f32_16x16x32_bf16 v[36:39], a[156:159], v[170:173], v[36:39]
v_mfma_f32_16x16x32_bf16 v[40:43], a[180:183], v[170:173], v[40:43]
v_mfma_f32_16x16x32_bf16 v[44:47], a[204:207], v[170:173], v[44:47]
ds_read_b128 v[182:185], v210 offset:40960
s_waitcnt lgkmcnt(0)
v_mfma_f32_16x16x32_bf16 v[36:39], a[160:163], v[182:185], v[36:39]
v_mfma_f32_16x16x32_bf16 v[40:43], a[184:187], v[182:185], v[40:43]
v_mfma_f32_16x16x32_bf16 v[44:47], a[208:211], v[182:185], v[44:47]
ds_read_b128 v[186:189], v210 offset:41984
s_waitcnt lgkmcnt(0)
v_mfma_f32_16x16x32_bf16 v[36:39], a[164:167], v[186:189], v[36:39]
v_mfma_f32_16x16x32_bf16 v[40:43], a[188:191], v[186:189], v[40:43]
v_mfma_f32_16x16x32_bf16 v[44:47], a[212:215], v[186:189], v[44:47]
v_cvt_pk_bf16_f32 v72, v36, v37
v_cvt_pk_bf16_f32 v73, v38, v39
buffer_store_dwordx2 v[72:73], v203, s[8:11], s39 offen
v_cvt_pk_bf16_f32 v74, v40, v41
v_cvt_pk_bf16_f32 v75, v42, v43
buffer_store_dwordx2 v[74:75], v203, s[8:11], s39 offen offset:32
s_nop 0
v_cvt_pk_bf16_f32 v76, v44, v45
v_cvt_pk_bf16_f32 v77, v46, v47
buffer_store_dwordx2 v[76:77], v203, s[8:11], s39 offen offset:64
v_max3_f32 v151, v138, v139, v140
v_max3_f32 v151, v151, v141, v142
v_max3_f32 v151, v151, v143, v144
v_max3_f32 v151, v151, v145, v146
v_max3_f32 v151, v151, v147, v148
v_max3_f32 v151, v151, v149, v150
v_mov_b32 v152, v151
s_nop 1
v_permlane16_swap_b32 v151, v152
v_max_f32 v151, v151, v152
v_mov_b32 v152, v151
s_nop 1
v_permlane32_swap_b32 v151, v152
v_max_f32 v151, v151, v152
v_sub_f32 v138, v138, v151
v_sub_f32 v139, v139, v151
v_sub_f32 v140, v140, v151
v_sub_f32 v141, v141, v151
v_sub_f32 v142, v142, v151
v_sub_f32 v143, v143, v151
v_sub_f32 v144, v144, v151
v_sub_f32 v145, v145, v151
v_sub_f32 v150, v150, v151
v_sub_f32 v146, v146, v151
v_sub_f32 v147, v147, v151
v_sub_f32 v148, v148, v151
v_sub_f32 v149, v149, v151
v_exp_f32 v138, v138
v_exp_f32 v139, v139
v_exp_f32 v140, v140
v_exp_f32 v141, v141
v_exp_f32 v142, v142
v_exp_f32 v143, v143
v_exp_f32 v144, v144
v_exp_f32 v145, v145
v_exp_f32 v150, v150
v_exp_f32 v146, v146
v_exp_f32 v147, v147
v_exp_f32 v148, v148
v_exp_f32 v149, v149
v_cvt_pk_bf16_f32 v174, v138, v139
v_cvt_pk_bf16_f32 v175, v140, v141
v_cvt_pk_bf16_f32 v176, v142, v143
v_cvt_pk_bf16_f32 v177, v144, v145
v_cvt_pk_bf16_f32 v178, v146, v147
v_cvt_pk_bf16_f32 v179, v148, v149
v_cvt_pk_bf16_f32 v180, v150, 0
v_mfma_f32_16x16x32_bf16 v[150:153], v[190:193], v[174:177], 0
v_mfma_f32_16x16x32_bf16 v[138:141], v[114:117], v[174:177], 0
v_mfma_f32_16x16x32_bf16 v[142:145], v[122:125], v[174:177], 0
v_mfma_f32_16x16x32_bf16 v[146:149], v[130:133], v[174:177], 0
v_mfma_f32_16x16x32_bf16 v[150:153], v[190:193], v[178:181], v[150:153]
v_mfma_f32_16x16x32_bf16 v[138:141], v[118:121], v[178:181], v[138:141]
v_mfma_f32_16x16x32_bf16 v[142:145], v[126:129], v[178:181], v[142:145]
v_mfma_f32_16x16x32_bf16 v[146:149], v[134:137], v[178:181], v[146:149]
v_mfma_f32_16x16x32_bf16 v[166:169], v[84:87], v[190:193], 0
v_mfma_f32_16x16x32_bf16 v[154:157], v[84:87], v[114:117], 0
v_mfma_f32_16x16x32_bf16 v[158:161], v[84:87], v[122:125], 0
v_mfma_f32_16x16x32_bf16 v[162:165], v[84:87], v[130:133], 0
v_mfma_f32_16x16x32_bf16 v[166:169], v[88:91], v[190:193], v[166:169]
v_mfma_f32_16x16x32_bf16 v[154:157], v[88:91], v[118:121], v[154:157]
v_mfma_f32_16x16x32_bf16 v[158:161], v[88:91], v[126:129], v[158:161]
v_mfma_f32_16x16x32_bf16 v[162:165], v[88:91], v[134:137], v[162:165]
v_rcp_f32 v167, v166
s_nop 1
v_mov_b32_dpp v154, v158 quad_perm:[0,1,2,3] row_mask:0x2 bank_mask:0xf
s_nop 2
v_mov_b32_dpp v154, v162 quad_perm:[0,1,2,3] row_mask:0x4 bank_mask:0xf
v_mul_f32 v167, s3, v167
v_mul_f32 v154, v154, v167
v_cvt_pk_bf16_f32 v154, v154, 0
ds_write_b16 v214, v154
v_add_u32 v214, 1408, v214
ds_read_b128 v[170:173], v210 offset:43008
s_waitcnt lgkmcnt(0)
v_mfma_f32_16x16x32_bf16 v[48:51], a[144:147], v[170:173], v[48:51]
v_mfma_f32_16x16x32_bf16 v[52:55], a[168:171], v[170:173], v[52:55]
v_mfma_f32_16x16x32_bf16 v[56:59], a[192:195], v[170:173], v[56:59]
ds_read_b128 v[182:185], v210 offset:44032
s_waitcnt lgkmcnt(0)
v_mfma_f32_16x16x32_bf16 v[48:51], a[148:151], v[182:185], v[48:51]
v_mfma_f32_16x16x32_bf16 v[52:55], a[172:175], v[182:185], v[52:55]
v_mfma_f32_16x16x32_bf16 v[56:59], a[196:199], v[182:185], v[56:59]
ds_read_b128 v[186:189], v210 offset:45056
s_waitcnt lgkmcnt(0)
v_mfma_f32_16x16x32_bf16 v[48:51], a[152:155], v[186:189], v[48:51]
v_mfma_f32_16x16x32_bf16 v[52:55], a[176:179], v[186:189], v[52:55]
v_mfma_f32_16x16x32_bf16 v[56:59], a[200:203], v[186:189], v[56:59]
ds_read_b128 v[170:173], v210 offset:46080
s_waitcnt lgkmcnt(0)
v_mfma_f32_16x16x32_bf16 v[48:51], a[156:159], v[170:173], v[48:51]
v_mfma_f32_16x16x32_bf16 v[52:55], a[180:183], v[170:173], v[52:55]
v_mfma_f32_16x16x32_bf16 v[56:59], a[204:207], v[170:173], v[56:59]
ds_read_b128 v[182:185], v210 offset:47104
s_waitcnt lgkmcnt(0)
v_mfma_f32_16x16x32_bf16 v[48:51], a[160:163], v[182:185], v[48:51]
v_mfma_f32_16x16x32_bf16 v[52:55], a[184:187], v[182:185], v[52:55]
v_mfma_f32_16x16x32_bf16 v[56:59], a[208:211], v[182:185], v[56:59]
ds_read_b128 v[186:189], v210 offset:48128
s_waitcnt lgkmcnt(0)
v_mfma_f32_16x16x32_bf16 v[48:51], a[164:167], v[186:189], v[48:51]
v_mfma_f32_16x16x32_bf16 v[52:55], a[188:191], v[186:189], v[52:55]
v_mfma_f32_16x16x32_bf16 v[56:59], a[212:215], v[186:189], v[56:59]
v_cvt_pk_bf16_f32 v78, v48, v49
v_cvt_pk_bf16_f32 v79, v50, v51
buffer_store_dwordx2 v[78:79], v204, s[8:11], s39 offen
v_cvt_pk_bf16_f32 v80, v52, v53
v_cvt_pk_bf16_f32 v81, v54, v55
buffer_store_dwordx2 v[80:81], v204, s[8:11], s39 offen offset:32
s_nop 0
v_cvt_pk_bf16_f32 v82, v56, v57
v_cvt_pk_bf16_f32 v83, v58, v59
buffer_store_dwordx2 v[82:83], v204, s[8:11], s39 offen offset:64
v_rcp_f32 v151, v150
s_nop 0
v_mul_f32 v151, s3, v151
v_mul_f32 v138, v138, v151
v_mul_f32 v139, v139, v151
v_cvt_pk_bf16_f32 v138, v138, v139
v_mul_f32 v140, v140, v151
v_mul_f32 v141, v141, v151
v_cvt_pk_bf16_f32 v139, v140, v141
v_mul_f32 v142, v142, v151
v_mul_f32 v143, v143, v151
v_cvt_pk_bf16_f32 v140, v142, v143
v_mul_f32 v144, v144, v151
v_mul_f32 v145, v145, v151
v_cvt_pk_bf16_f32 v141, v144, v145
ds_write_b128 v211, v[138:141] offset:49152
v_mul_f32 v146, v146, v151
v_mul_f32 v147, v147, v151
v_cvt_pk_bf16_f32 v142, v146, v147
v_mul_f32 v148, v148, v151
v_mul_f32 v149, v149, v151
v_cvt_pk_bf16_f32 v143, v148, v149
ds_write_b64 v212, v[142:143] offset:49152
s_waitcnt vmcnt(6) lgkmcnt(0)
s_barrier
ds_read_b128 v[170:173], v210 offset:49152
s_waitcnt lgkmcnt(0)
v_mfma_f32_16x16x32_bf16 v[60:63], a[144:147], v[170:173], v[60:63]
v_mfma_f32_16x16x32_bf16 v[64:67], a[168:171], v[170:173], v[64:67]
v_mfma_f32_16x16x32_bf16 v[68:71], a[192:195], v[170:173], v[68:71]
ds_read_b128 v[182:185], v210 offset:50176
s_waitcnt lgkmcnt(0)
v_mfma_f32_16x16x32_bf16 v[60:63], a[148:151], v[182:185], v[60:63]
v_mfma_f32_16x16x32_bf16 v[64:67], a[172:175], v[182:185], v[64:67]
v_mfma_f32_16x16x32_bf16 v[68:71], a[196:199], v[182:185], v[68:71]
ds_read_b128 v[186:189], v210 offset:51200
s_waitcnt lgkmcnt(0)
v_mfma_f32_16x16x32_bf16 v[60:63], a[152:155], v[186:189], v[60:63]
v_mfma_f32_16x16x32_bf16 v[64:67], a[176:179], v[186:189], v[64:67]
v_mfma_f32_16x16x32_bf16 v[68:71], a[200:203], v[186:189], v[68:71]
ds_read_b128 v[170:173], v210 offset:52224
s_waitcnt lgkmcnt(0)
v_mfma_f32_16x16x32_bf16 v[60:63], a[156:159], v[170:173], v[60:63]
v_mfma_f32_16x16x32_bf16 v[64:67], a[180:183], v[170:173], v[64:67]
v_mfma_f32_16x16x32_bf16 v[68:71], a[204:207], v[170:173], v[68:71]
ds_read_b128 v[182:185], v210 offset:53248
s_waitcnt lgkmcnt(0)
v_mfma_f32_16x16x32_bf16 v[60:63], a[160:163], v[182:185], v[60:63]
v_mfma_f32_16x16x32_bf16 v[64:67], a[184:187], v[182:185], v[64:67]
v_mfma_f32_16x16x32_bf16 v[68:71], a[208:211], v[182:185], v[68:71]
ds_read_b128 v[186:189], v210 offset:54272
s_waitcnt lgkmcnt(0)
v_mfma_f32_16x16x32_bf16 v[60:63], a[164:167], v[186:189], v[60:63]
v_mfma_f32_16x16x32_bf16 v[64:67], a[188:191], v[186:189], v[64:67]
v_mfma_f32_16x16x32_bf16 v[68:71], a[212:215], v[186:189], v[68:71]
v_cvt_pk_bf16_f32 v116, v60, v61
v_cvt_pk_bf16_f32 v117, v62, v63
buffer_store_dwordx2 v[116:117], v205, s[8:11], s39 offen
v_cvt_pk_bf16_f32 v124, v64, v65
v_cvt_pk_bf16_f32 v125, v66, v67
buffer_store_dwordx2 v[124:125], v205, s[8:11], s39 offen offset:32
s_nop 0
v_cvt_pk_bf16_f32 v132, v68, v69
v_cvt_pk_bf16_f32 v133, v70, v71
buffer_store_dwordx2 v[132:133], v205, s[8:11], s39 offen offset:64
s_mov_b32 s38, s36
ds_read_b128 v[174:177], v217
ds_read_b128 v[84:87], v200
s_waitcnt lgkmcnt(0)
v_mfma_f32_16x16x32_bf16 v[36:39], v[174:177], v[84:87], 0
ds_read_b128 v[92:95], v201
s_waitcnt lgkmcnt(0)
v_mfma_f32_16x16x32_bf16 v[48:51], v[174:177], v[92:95], 0
ds_read_b128 v[100:103], v202
s_waitcnt lgkmcnt(0)
v_mfma_f32_16x16x32_bf16 v[60:63], v[174:177], v[100:103], 0
ds_read_b128 v[178:181], v217 offset:528
ds_read_b128 v[84:87], v194
ds_read_b128 v[88:91], v194 offset:16
s_waitcnt lgkmcnt(0)
v_smfmac_f32_16x16x64_bf16 v[36:39], v[178:181], v[84:91], v213
ds_read_b128 v[92:95], v195
ds_read_b128 v[96:99], v195 offset:16
s_waitcnt lgkmcnt(0)
v_smfmac_f32_16x16x64_bf16 v[48:51], v[178:181], v[92:99], v213
ds_read_b128 v[100:103], v196
ds_read_b128 v[104:107], v196 offset:16
s_waitcnt lgkmcnt(0)
v_smfmac_f32_16x16x64_bf16 v[60:63], v[178:181], v[100:107], v213
ds_read_b128 v[174:177], v217 offset:1056
ds_read_b128 v[84:87], v197
ds_read_b128 v[88:91], v197 offset:16
s_waitcnt lgkmcnt(0)
v_smfmac_f32_16x16x64_bf16 v[36:39], v[174:177], v[84:91], v213
ds_read_b128 v[92:95], v198
ds_read_b128 v[96:99], v198 offset:16
s_waitcnt lgkmcnt(0)
v_smfmac_f32_16x16x64_bf16 v[48:51], v[174:177], v[92:99], v213
ds_read_b128 v[100:103], v199
ds_read_b128 v[104:107], v199 offset:16
s_waitcnt lgkmcnt(0)
v_smfmac_f32_16x16x64_bf16 v[60:63], v[174:177], v[100:107], v213
ds_read_b128 v[178:181], v217 offset:1584
ds_read_b128 v[84:87], v200 offset:32
s_waitcnt lgkmcnt(0)
v_mfma_f32_16x16x32_bf16 v[40:43], v[178:181], v[84:87], 0
ds_read_b128 v[92:95], v201 offset:32
s_waitcnt lgkmcnt(0)
v_mfma_f32_16x16x32_bf16 v[52:55], v[178:181], v[92:95], 0
ds_read_b128 v[100:103], v202 offset:32
s_waitcnt lgkmcnt(0)
v_mfma_f32_16x16x32_bf16 v[64:67], v[178:181], v[100:103], 0
ds_read_b128 v[174:177], v217 offset:2112
ds_read_b128 v[84:87], v194 offset:32
ds_read_b128 v[88:91], v194 offset:48
s_waitcnt lgkmcnt(0)
v_smfmac_f32_16x16x64_bf16 v[40:43], v[174:177], v[84:91], v213
ds_read_b128 v[92:95], v195 offset:32
ds_read_b128 v[96:99], v195 offset:48
s_waitcnt lgkmcnt(0)
v_smfmac_f32_16x16x64_bf16 v[52:55], v[174:177], v[92:99], v213
ds_read_b128 v[100:103], v196 offset:32
ds_read_b128 v[104:107], v196 offset:48
s_waitcnt lgkmcnt(0)
v_smfmac_f32_16x16x64_bf16 v[64:67], v[174:177], v[100:107], v213
ds_read_b128 v[178:181], v217 offset:2640
ds_read_b128 v[84:87], v197 offset:32
ds_read_b128 v[88:91], v197 offset:48
s_waitcnt lgkmcnt(0)
v_smfmac_f32_16x16x64_bf16 v[40:43], v[178:181], v[84:91], v213
ds_read_b128 v[92:95], v198 offset:32
ds_read_b128 v[96:99], v198 offset:48
s_waitcnt lgkmcnt(0)
v_smfmac_f32_16x16x64_bf16 v[52:55], v[178:181], v[92:99], v213
ds_read_b128 v[100:103], v199 offset:32
ds_read_b128 v[104:107], v199 offset:48
s_waitcnt lgkmcnt(0)
v_smfmac_f32_16x16x64_bf16 v[64:67], v[178:181], v[100:107], v213
ds_read_b128 v[174:177], v217 offset:3168
ds_read_b128 v[84:87], v200 offset:64
s_waitcnt lgkmcnt(0)
v_mfma_f32_16x16x32_bf16 v[44:47], v[174:177], v[84:87], 0
ds_read_b128 v[92:95], v201 offset:64
s_waitcnt lgkmcnt(0)
v_mfma_f32_16x16x32_bf16 v[56:59], v[174:177], v[92:95], 0
ds_read_b128 v[100:103], v202 offset:64
s_waitcnt lgkmcnt(0)
v_mfma_f32_16x16x32_bf16 v[68:71], v[174:177], v[100:103], 0
ds_read_b128 v[178:181], v217 offset:3696
ds_read_b128 v[84:87], v194 offset:64
ds_read_b128 v[88:91], v194 offset:80
s_waitcnt lgkmcnt(0)
v_smfmac_f32_16x16x64_bf16 v[44:47], v[178:181], v[84:91], v213
ds_read_b128 v[92:95], v195 offset:64
ds_read_b128 v[96:99], v195 offset:80
s_waitcnt lgkmcnt(0)
v_smfmac_f32_16x16x64_bf16 v[56:59], v[178:181], v[92:99], v213
ds_read_b128 v[100:103], v196 offset:64
ds_read_b128 v[104:107], v196 offset:80
s_waitcnt lgkmcnt(0)
v_smfmac_f32_16x16x64_bf16 v[68:71], v[178:181], v[100:107], v213
ds_read_b128 v[174:177], v217 offset:4224
ds_read_b128 v[84:87], v197 offset:64
ds_read_b128 v[88:91], v197 offset:80
s_waitcnt lgkmcnt(0)
v_smfmac_f32_16x16x64_bf16 v[44:47], v[174:177], v[84:91], v213
ds_read_b128 v[92:95], v198 offset:64
ds_read_b128 v[96:99], v198 offset:80
s_waitcnt lgkmcnt(0)
v_smfmac_f32_16x16x64_bf16 v[56:59], v[174:177], v[92:99], v213
ds_read_b128 v[100:103], v199 offset:64
ds_read_b128 v[104:107], v199 offset:80
s_waitcnt lgkmcnt(0)
v_smfmac_f32_16x16x64_bf16 v[68:71], v[174:177], v[100:107], v213
v_add_f32 v118, v36, v37
v_mul_f32 v119, v36, v36
v_add_f32 v118, v118, v38
v_fmac_f32 v119, v37, v37
v_add_f32 v118, v118, v39
v_fmac_f32 v119, v38, v38
v_fmac_f32 v119, v39, v39
v_add_f32 v126, v48, v49
v_mul_f32 v127, v48, v48
v_add_f32 v126, v126, v50
v_fmac_f32 v127, v49, v49
v_add_f32 v126, v126, v51
v_fmac_f32 v127, v50, v50
v_fmac_f32 v127, v51, v51
v_add_f32 v134, v60, v61
v_mul_f32 v135, v60, v60
v_add_f32 v134, v134, v62
v_fmac_f32 v135, v61, v61
v_add_f32 v134, v134, v63
v_fmac_f32 v135, v62, v62
v_fmac_f32 v135, v63, v63
v_add_f32 v118, v118, v40
v_fmac_f32 v119, v40, v40
v_add_f32 v118, v118, v41
v_fmac_f32 v119, v41, v41
v_add_f32 v118, v118, v42
v_fmac_f32 v119, v42, v42
v_add_f32 v118, v118, v43
v_fmac_f32 v119, v43, v43
v_add_f32 v126, v126, v52
v_fmac_f32 v127, v52, v52
v_add_f32 v126, v126, v53
v_fmac_f32 v127, v53, v53
v_add_f32 v126, v126, v54
v_fmac_f32 v127, v54, v54
v_add_f32 v126, v126, v55
v_fmac_f32 v127, v55, v55
v_add_f32 v134, v134, v64
v_fmac_f32 v135, v64, v64
v_add_f32 v134, v134, v65
v_fmac_f32 v135, v65, v65
v_add_f32 v134, v134, v66
v_fmac_f32 v135, v66, v66
v_add_f32 v134, v134, v67
v_fmac_f32 v135, v67, v67
v_add_f32 v118, v118, v44
v_fmac_f32 v119, v44, v44
v_add_f32 v118, v118, v45
v_fmac_f32 v119, v45, v45
v_add_f32 v118, v118, v46
v_fmac_f32 v119, v46, v46
v_add_f32 v118, v118, v47
v_fmac_f32 v119, v47, v47
v_add_f32 v126, v126, v56
v_fmac_f32 v127, v56, v56
v_add_f32 v126, v126, v57
v_fmac_f32 v127, v57, v57
v_add_f32 v126, v126, v58
v_fmac_f32 v127, v58, v58
v_add_f32 v126, v126, v59
v_fmac_f32 v127, v59, v59
v_add_f32 v134, v134, v68
v_fmac_f32 v135, v68, v68
v_add_f32 v134, v134, v69
v_fmac_f32 v135, v69, v69
v_add_f32 v134, v134, v70
v_fmac_f32 v135, v70, v70
v_add_f32 v134, v134, v71
v_fmac_f32 v135, v71, v71
v_permlane16_swap_b32 v118, v119
v_add_f32 v118, v118, v119
v_permlane16_swap_b32 v126, v127
v_add_f32 v126, v126, v127
v_permlane16_swap_b32 v134, v135
v_add_f32 v134, v134, v135
v_permlane32_swap_b32 v118, v126
v_add_f32 v118, v118, v126
ds_write_b32 v209, v118
v_mov_b32 v135, v134
s_nop 1
v_permlane32_swap_b32 v134, v135
v_add_f32 v134, v134, v135
ds_write_b32 v209, v134 offset:512
s_waitcnt lgkmcnt(0)
s_barrier
s_mul_hi_u32 s41, s35, 58835169
s_mul_i32 s42, s41, 73
s_sub_u32 s42, s35, s42
s_mul_i32 s43, s41, 1373568
s_mul_i32 s51, s42, 2688
s_add_u32 s43, s43, s51
s_cmp_lt_u32 s35, s34
s_cselect_b32 s36, s43, 1879048192
s_add_u32 s35, s35, 32
s_cmp_eq_u32 s42, 0
s_cselect_b32 s44, 536870911, s72
s_cmp_eq_u32 s42, 72
s_cselect_b32 s44, 939524095, s44
s_cmp_eq_u32 s41, 0
s_cselect_b32 s40, 1879048192, s36
v_and_b32 v180, s44, v208
s_add_u32 m0, s45, 0
s_nop 0
buffer_load_dwordx4 v180, s[4:7], s40 offen nt lds
s_add_u32 m0, s45, 4112
s_add_u32 s40, s36, 196224
buffer_load_dwordx4 v180, s[4:7], s40 offen nt lds
s_add_u32 m0, s45, 8224
s_add_u32 s40, s36, 392448
buffer_load_dwordx4 v180, s[4:7], s40 offen nt lds
s_add_u32 m0, s45, 12336
s_add_u32 s40, s36, 588672
buffer_load_dwordx4 v180, s[4:7], s40 offen nt lds
s_add_u32 m0, s45, 16448
s_add_u32 s40, s36, 784896
buffer_load_dwordx4 v180, s[4:7], s40 offen nt lds
s_add_u32 m0, s45, 20560
s_add_u32 s40, s36, 981120
buffer_load_dwordx4 v180, s[4:7], s40 offen nt lds
s_add_u32 m0, s45, 24672
s_add_u32 s40, s36, 1177344
buffer_load_dwordx4 v180, s[4:7], s40 offen nt lds
s_add_u32 m0, s45, 28784
s_add_u32 s40, s36, 1373568
buffer_load_dwordx4 v180, s[4:7], s40 offen nt lds
s_add_u32 m0, s45, 32896
s_add_u32 s40, s36, 1569792
buffer_load_dwordx4 v180, s[4:7], s40 offen nt lds
ds_read_b128 v[102:105], v210 offset:55296
ds_read_b128 v[106:109], v210 offset:56320
s_waitcnt lgkmcnt(1)
v_add_f32 v102, v102, v103
s_waitcnt lgkmcnt(0)
v_add_f32 v106, v106, v107
v_add_f32 v104, v104, v105
v_add_f32 v108, v108, v109
v_add_f32 v102, v102, v104
v_add_f32 v106, v106, v108
v_mul_f32 v103, s48, v102
v_mul_f32 v104, s73, v102
v_mul_f32 v106, s73, v106
v_fma_f32 v106, -v103, v104, v106
v_max_f32 v106, 0, v106
v_add_f32 v106, s49, v106
v_rsq_f32 v102, v106
s_nop 0
v_mul_f32_e64 v103, -v103, v102
ds_write_b64 v211, v[102:103] offset:36864
ds_read_b64 v[118:119], v219
ds_read_b64 v[126:127], v219 offset:256
ds_read_b64 v[134:135], v219 offset:512
s_waitcnt lgkmcnt(2)
v_fma_f32 v220, v36, v118, v119
v_fma_f32 v221, v37, v118, v119
v_cvt_pk_bf16_f32 v90, v220, v221
v_fma_f32 v222, v38, v118, v119
v_fma_f32 v223, v39, v118, v119
v_cvt_pk_bf16_f32 v91, v222, v223
v_fma_f32 v220, v40, v118, v119
v_fma_f32 v221, v41, v118, v119
v_cvt_pk_bf16_f32 v92, v220, v221
v_fma_f32 v222, v42, v118, v119
v_fma_f32 v223, v43, v118, v119
v_cvt_pk_bf16_f32 v93, v222, v223
ds_write_b128 v211, v[90:93] offset:18432
v_fma_f32 v220, v44, v118, v119
v_fma_f32 v221, v45, v118, v119
v_cvt_pk_bf16_f32 v94, v220, v221
v_fma_f32 v222, v46, v118, v119
v_fma_f32 v223, v47, v118, v119
v_cvt_pk_bf16_f32 v95, v222, v223
s_waitcnt lgkmcnt(2)
ds_write_b64 v212, v[94:95] offset:18432
v_fma_f32 v220, v48, v126, v127
v_fma_f32 v221, v49, v126, v127
v_cvt_pk_bf16_f32 v174, v220, v221
v_fma_f32 v222, v50, v126, v127
v_fma_f32 v223, v51, v126, v127
v_cvt_pk_bf16_f32 v175, v222, v223
v_fma_f32 v220, v52, v126, v127
v_fma_f32 v221, v53, v126, v127
v_cvt_pk_bf16_f32 v176, v220, v221
v_fma_f32 v222, v54, v126, v127
v_fma_f32 v223, v55, v126, v127
v_cvt_pk_bf16_f32 v177, v222, v223
ds_write_b128 v211, v[174:177] offset:24576
v_fma_f32 v220, v56, v126, v127
v_fma_f32 v221, v57, v126, v127
v_cvt_pk_bf16_f32 v178, v220, v221
v_fma_f32 v222, v58, v126, v127
v_fma_f32 v223, v59, v126, v127
v_cvt_pk_bf16_f32 v179, v222, v223
s_waitcnt lgkmcnt(3)
ds_write_b64 v212, v[178:179] offset:24576
v_fma_f32 v220, v60, v134, v135
v_fma_f32 v221, v61, v134, v135
v_cvt_pk_bf16_f32 v90, v220, v221
v_fma_f32 v222, v62, v134, v135
v_fma_f32 v223, v63, v134, v135
v_cvt_pk_bf16_f32 v91, v222, v223
v_fma_f32 v220, v64, v134, v135
v_fma_f32 v221, v65, v134, v135
v_cvt_pk_bf16_f32 v92, v220, v221
v_fma_f32 v222, v66, v134, v135
v_fma_f32 v223, v67, v134, v135
v_cvt_pk_bf16_f32 v93, v222, v223
ds_write_b128 v211, v[90:93] offset:30720
v_fma_f32 v220, v68, v134, v135
v_fma_f32 v221, v69, v134, v135
v_cvt_pk_bf16_f32 v94, v220, v221
v_fma_f32 v222, v70, v134, v135
v_fma_f32 v223, v71, v134, v135
v_cvt_pk_bf16_f32 v95, v222, v223
ds_write_b64 v212, v[94:95] offset:30720
ds_read_b128 v[182:185], v210
s_waitcnt lgkmcnt(0)
v_mfma_f32_16x16x32_bf16 v[138:141], a[0:3], v[182:185], 0
v_mfma_f32_16x16x32_bf16 v[142:145], a[24:27], v[182:185], 0
v_mfma_f32_16x16x32_bf16 v[146:149], a[48:51], v[182:185], 0
v_mfma_f32_16x16x32_bf16 v[150:153], a[216:219], v[182:185], 0
v_mfma_f32_16x16x32_bf16 v[154:157], a[240:243], v[182:185], 0
v_mfma_f32_16x16x32_bf16 v[158:161], v[232:235], v[182:185], 0
v_mfma_f32_16x16x32_bf16 v[162:165], v[182:185], a[72:75], 0
v_mfma_f32_16x16x32_bf16 v[166:169], v[182:185], a[96:99], 0
v_mfma_f32_16x16x32_bf16 v[170:173], v[182:185], a[120:123], 0
ds_read_b128 v[186:189], v210 offset:1024
s_waitcnt lgkmcnt(0)
v_mfma_f32_16x16x32_bf16 v[138:141], a[4:7], v[186:189], v[138:141]
v_mfma_f32_16x16x32_bf16 v[142:145], a[28:31], v[186:189], v[142:145]
v_mfma_f32_16x16x32_bf16 v[146:149], a[52:55], v[186:189], v[146:149]
v_mfma_f32_16x16x32_bf16 v[150:153], a[220:223], v[186:189], v[150:153]
v_mfma_f32_16x16x32_bf16 v[154:157], a[244:247], v[186:189], v[154:157]
v_mfma_f32_16x16x32_bf16 v[158:161], v[236:239], v[186:189], v[158:161]
v_mfma_f32_16x16x32_bf16 v[162:165], v[186:189], a[76:79], v[162:165]
v_mfma_f32_16x16x32_bf16 v[166:169], v[186:189], a[100:103], v[166:169]
v_mfma_f32_16x16x32_bf16 v[170:173], v[186:189], a[124:127], v[170:173]
ds_read_b128 v[182:185], v210 offset:2048
s_waitcnt lgkmcnt(0)
v_mfma_f32_16x16x32_bf16 v[138:141], a[8:11], v[182:185], v[138:141]
v_mfma_f32_16x16x32_bf16 v[142:145], a[32:35], v[182:185], v[142:145]
v_mfma_f32_16x16x32_bf16 v[146:149], a[56:59], v[182:185], v[146:149]
v_mfma_f32_16x16x32_bf16 v[150:153], a[224:227], v[182:185], v[150:153]
v_mfma_f32_16x16x32_bf16 v[154:157], a[248:251], v[182:185], v[154:157]
v_mfma_f32_16x16x32_bf16 v[158:161], v[240:243], v[182:185], v[158:161]
v_mfma_f32_16x16x32_bf16 v[162:165], v[182:185], a[80:83], v[162:165]
v_mfma_f32_16x16x32_bf16 v[166:169], v[182:185], a[104:107], v[166:169]
v_mfma_f32_16x16x32_bf16 v[170:173], v[182:185], a[128:131], v[170:173]
ds_read_b128 v[186:189], v210 offset:3072
s_waitcnt lgkmcnt(0)
v_mfma_f32_16x16x32_bf16 v[138:141], a[12:15], v[186:189], v[138:141]
v_mfma_f32_16x16x32_bf16 v[142:145], a[36:39], v[186:189], v[142:145]
v_mfma_f32_16x16x32_bf16 v[146:149], a[60:63], v[186:189], v[146:149]
v_mfma_f32_16x16x32_bf16 v[150:153], a[228:231], v[186:189], v[150:153]
v_mfma_f32_16x16x32_bf16 v[154:157], a[252:255], v[186:189], v[154:157]
v_mfma_f32_16x16x32_bf16 v[158:161], v[244:247], v[186:189], v[158:161]
v_mfma_f32_16x16x32_bf16 v[162:165], v[186:189], a[84:87], v[162:165]
v_mfma_f32_16x16x32_bf16 v[166:169], v[186:189], a[108:111], v[166:169]
v_mfma_f32_16x16x32_bf16 v[170:173], v[186:189], a[132:135], v[170:173]
ds_read_b128 v[182:185], v210 offset:4096
s_waitcnt lgkmcnt(0)
v_mfma_f32_16x16x32_bf16 v[138:141], a[16:19], v[182:185], v[138:141]
v_mfma_f32_16x16x32_bf16 v[142:145], a[40:43], v[182:185], v[142:145]
v_mfma_f32_16x16x32_bf16 v[146:149], a[64:67], v[182:185], v[146:149]
v_mfma_f32_16x16x32_bf16 v[150:153], a[232:235], v[182:185], v[150:153]
v_mfma_f32_16x16x32_bf16 v[154:157], v[224:227], v[182:185], v[154:157]
v_mfma_f32_16x16x32_bf16 v[158:161], v[248:251], v[182:185], v[158:161]
v_mfma_f32_16x16x32_bf16 v[162:165], v[182:185], a[88:91], v[162:165]
v_mfma_f32_16x16x32_bf16 v[166:169], v[182:185], a[112:115], v[166:169]
v_mfma_f32_16x16x32_bf16 v[170:173], v[182:185], a[136:139], v[170:173]
ds_read_b128 v[186:189], v210 offset:5120
s_waitcnt lgkmcnt(0)
v_mfma_f32_16x16x32_bf16 v[138:141], a[20:23], v[186:189], v[138:141]
v_mfma_f32_16x16x32_bf16 v[142:145], a[44:47], v[186:189], v[142:145]
v_mfma_f32_16x16x32_bf16 v[146:149], a[68:71], v[186:189], v[146:149]
v_mfma_f32_16x16x32_bf16 v[150:153], a[236:239], v[186:189], v[150:153]
v_mfma_f32_16x16x32_bf16 v[154:157], v[228:231], v[186:189], v[154:157]
v_mfma_f32_16x16x32_bf16 v[158:161], v[252:255], v[186:189], v[158:161]
v_mfma_f32_16x16x32_bf16 v[162:165], v[186:189], a[92:95], v[162:165]
v_mfma_f32_16x16x32_bf16 v[166:169], v[186:189], a[116:119], v[166:169]
v_mfma_f32_16x16x32_bf16 v[170:173], v[186:189], a[140:143], v[170:173]
v_cvt_pk_bf16_f32 v78, v138, v139
v_cvt_pk_bf16_f32 v79, v140, v141
v_cvt_pk_bf16_f32 v80, v142, v143
v_cvt_pk_bf16_f32 v81, v144, v145
v_cvt_pk_bf16_f32 v82, v146, v147
v_cvt_pk_bf16_f32 v83, v148, v149
v_cvt_pk_bf16_f32 v72, v150, v151
v_cvt_pk_bf16_f32 v73, v152, v153
v_cvt_pk_bf16_f32 v74, v154, v155
v_cvt_pk_bf16_f32 v75, v156, v157
v_cvt_pk_bf16_f32 v76, v158, v159
v_cvt_pk_bf16_f32 v77, v160, v161
v_cvt_pk_bf16_f32 v114, v162, v163
v_cvt_pk_bf16_f32 v115, v164, v165
v_cvt_pk_bf16_f32 v122, v166, v167
v_cvt_pk_bf16_f32 v123, v168, v169
v_cvt_pk_bf16_f32 v130, v170, v171
v_cvt_pk_bf16_f32 v131, v172, v173
ds_read_b128 v[182:185], v210 offset:6144
s_waitcnt lgkmcnt(0)
v_mfma_f32_16x16x32_bf16 v[138:141], a[0:3], v[182:185], 0
v_mfma_f32_16x16x32_bf16 v[142:145], a[24:27], v[182:185], 0
v_mfma_f32_16x16x32_bf16 v[146:149], a[48:51], v[182:185], 0
v_mfma_f32_16x16x32_bf16 v[150:153], a[216:219], v[182:185], 0
v_mfma_f32_16x16x32_bf16 v[154:157], a[240:243], v[182:185], 0
v_mfma_f32_16x16x32_bf16 v[158:161], v[232:235], v[182:185], 0
v_mfma_f32_16x16x32_bf16 v[162:165], v[182:185], a[72:75], 0
v_mfma_f32_16x16x32_bf16 v[166:169], v[182:185], a[96:99], 0
v_mfma_f32_16x16x32_bf16 v[170:173], v[182:185], a[120:123], 0
ds_read_b128 v[186:189], v210 offset:7168
s_waitcnt lgkmcnt(0)
v_mfma_f32_16x16x32_bf16 v[138:141], a[4:7], v[186:189], v[138:141]
v_mfma_f32_16x16x32_bf16 v[142:145], a[28:31], v[186:189], v[142:145]
v_mfma_f32_16x16x32_bf16 v[146:149], a[52:55], v[186:189], v[146:149]
v_mfma_f32_16x16x32_bf16 v[150:153], a[220:223], v[186:189], v[150:153]
v_mfma_f32_16x16x32_bf16 v[154:157], a[244:247], v[186:189], v[154:157]
v_mfma_f32_16x16x32_bf16 v[158:161], v[236:239], v[186:189], v[158:161]
v_mfma_f32_16x16x32_bf16 v[162:165], v[186:189], a[76:79], v[162:165]
v_mfma_f32_16x16x32_bf16 v[166:169], v[186:189], a[100:103], v[166:169]
v_mfma_f32_16x16x32_bf16 v[170:173], v[186:189], a[124:127], v[170:173]
ds_read_b128 v[182:185], v210 offset:8192
s_waitcnt lgkmcnt(0)
v_mfma_f32_16x16x32_bf16 v[138:141], a[8:11], v[182:185], v[138:141]
v_mfma_f32_16x16x32_bf16 v[142:145], a[32:35], v[182:185], v[142:145]
v_mfma_f32_16x16x32_bf16 v[146:149], a[56:59], v[182:185], v[146:149]
v_mfma_f32_16x16x32_bf16 v[150:153], a[224:227], v[182:185], v[150:153]
v_mfma_f32_16x16x32_bf16 v[154:157], a[248:251], v[182:185], v[154:157]
v_mfma_f32_16x16x32_bf16 v[158:161], v[240:243], v[182:185], v[158:161]
v_mfma_f32_16x16x32_bf16 v[162:165], v[182:185], a[80:83], v[162:165]
v_mfma_f32_16x16x32_bf16 v[166:169], v[182:185], a[104:107], v[166:169]
v_mfma_f32_16x16x32_bf16 v[170:173], v[182:185], a[128:131], v[170:173]
ds_read_b128 v[186:189], v210 offset:9216
s_waitcnt lgkmcnt(0)
v_mfma_f32_16x16x32_bf16 v[138:141], a[12:15], v[186:189], v[138:141]
v_mfma_f32_16x16x32_bf16 v[142:145], a[36:39], v[186:189], v[142:145]
v_mfma_f32_16x16x32_bf16 v[146:149], a[60:63], v[186:189], v[146:149]
v_mfma_f32_16x16x32_bf16 v[150:153], a[228:231], v[186:189], v[150:153]
v_mfma_f32_16x16x32_bf16 v[154:157], a[252:255], v[186:189], v[154:157]
v_mfma_f32_16x16x32_bf16 v[158:161], v[244:247], v[186:189], v[158:161]
v_mfma_f32_16x16x32_bf16 v[162:165], v[186:189], a[84:87], v[162:165]
v_mfma_f32_16x16x32_bf16 v[166:169], v[186:189], a[108:111], v[166:169]
v_mfma_f32_16x16x32_bf16 v[170:173], v[186:189], a[132:135], v[170:173]
ds_read_b128 v[182:185], v210 offset:10240
s_waitcnt lgkmcnt(0)
v_mfma_f32_16x16x32_bf16 v[138:141], a[16:19], v[182:185], v[138:141]
v_mfma_f32_16x16x32_bf16 v[142:145], a[40:43], v[182:185], v[142:145]
v_mfma_f32_16x16x32_bf16 v[146:149], a[64:67], v[182:185], v[146:149]
v_mfma_f32_16x16x32_bf16 v[150:153], a[232:235], v[182:185], v[150:153]
v_mfma_f32_16x16x32_bf16 v[154:157], v[224:227], v[182:185], v[154:157]
v_mfma_f32_16x16x32_bf16 v[158:161], v[248:251], v[182:185], v[158:161]
v_mfma_f32_16x16x32_bf16 v[162:165], v[182:185], a[88:91], v[162:165]
v_mfma_f32_16x16x32_bf16 v[166:169], v[182:185], a[112:115], v[166:169]
v_mfma_f32_16x16x32_bf16 v[170:173], v[182:185], a[136:139], v[170:173]
ds_read_b128 v[186:189], v210 offset:11264
s_waitcnt lgkmcnt(0)
v_mfma_f32_16x16x32_bf16 v[138:141], a[20:23], v[186:189], v[138:141]
v_mfma_f32_16x16x32_bf16 v[142:145], a[44:47], v[186:189], v[142:145]
v_mfma_f32_16x16x32_bf16 v[146:149], a[68:71], v[186:189], v[146:149]
v_mfma_f32_16x16x32_bf16 v[150:153], a[236:239], v[186:189], v[150:153]
v_mfma_f32_16x16x32_bf16 v[154:157], v[228:231], v[186:189], v[154:157]
v_mfma_f32_16x16x32_bf16 v[158:161], v[252:255], v[186:189], v[158:161]
v_mfma_f32_16x16x32_bf16 v[162:165], v[186:189], a[92:95], v[162:165]
v_mfma_f32_16x16x32_bf16 v[166:169], v[186:189], a[116:119], v[166:169]
v_mfma_f32_16x16x32_bf16 v[170:173], v[186:189], a[140:143], v[170:173]
v_cvt_pk_bf16_f32 v96, v138, v139
v_cvt_pk_bf16_f32 v97, v140, v141
v_cvt_pk_bf16_f32 v98, v142, v143
v_cvt_pk_bf16_f32 v99, v144, v145
v_cvt_pk_bf16_f32 v100, v146, v147
v_cvt_pk_bf16_f32 v101, v148, v149
v_cvt_pk_bf16_f32 v84, v150, v151
v_cvt_pk_bf16_f32 v85, v152, v153
v_cvt_pk_bf16_f32 v86, v154, v155
v_cvt_pk_bf16_f32 v87, v156, v157
v_cvt_pk_bf16_f32 v88, v158, v159
v_cvt_pk_bf16_f32 v89, v160, v161
v_cvt_pk_bf16_f32 v116, v162, v163
v_cvt_pk_bf16_f32 v117, v164, v165
v_cvt_pk_bf16_f32 v124, v166, v167
v_cvt_pk_bf16_f32 v125, v168, v169
v_cvt_pk_bf16_f32 v132, v170, v171
v_cvt_pk_bf16_f32 v133, v172, v173
ds_read_b128 v[182:185], v210 offset:12288
s_waitcnt lgkmcnt(0)
v_mfma_f32_16x16x32_bf16 v[138:141], a[0:3], v[182:185], 0
v_mfma_f32_16x16x32_bf16 v[142:145], a[24:27], v[182:185], 0
v_mfma_f32_16x16x32_bf16 v[146:149], a[48:51], v[182:185], 0
ds_read_b128 v[186:189], v210 offset:13312
s_waitcnt lgkmcnt(0)
v_mfma_f32_16x16x32_bf16 v[138:141], a[4:7], v[186:189], v[138:141]
v_mfma_f32_16x16x32_bf16 v[142:145], a[28:31], v[186:189], v[142:145]
v_mfma_f32_16x16x32_bf16 v[146:149], a[52:55], v[186:189], v[146:149]
ds_read_b128 v[182:185], v210 offset:14336
s_waitcnt lgkmcnt(0)
v_mfma_f32_16x16x32_bf16 v[138:141], a[8:11], v[182:185], v[138:141]
v_mfma_f32_16x16x32_bf16 v[142:145], a[32:35], v[182:185], v[142:145]
v_mfma_f32_16x16x32_bf16 v[146:149], a[56:59], v[182:185], v[146:149]
ds_read_b128 v[186:189], v210 offset:15360
s_waitcnt lgkmcnt(0)
v_mfma_f32_16x16x32_bf16 v[138:141], a[12:15], v[186:189], v[138:141]
v_mfma_f32_16x16x32_bf16 v[142:145], a[36:39], v[186:189], v[142:145]
v_mfma_f32_16x16x32_bf16 v[146:149], a[60:63], v[186:189], v[146:149]
ds_read_b128 v[182:185], v210 offset:16384
s_waitcnt lgkmcnt(0)
v_mfma_f32_16x16x32_bf16 v[138:141], a[16:19], v[182:185], v[138:141]
v_mfma_f32_16x16x32_bf16 v[142:145], a[40:43], v[182:185], v[142:145]
v_mfma_f32_16x16x32_bf16 v[146:149], a[64:67], v[182:185], v[146:149]
ds_read_b128 v[186:189], v210 offset:17408
s_waitcnt lgkmcnt(0)
v_mfma_f32_16x16x32_bf16 v[138:141], a[20:23], v[186:189], v[138:141]
v_mfma_f32_16x16x32_bf16 v[142:145], a[44:47], v[186:189], v[142:145]
v_mfma_f32_16x16x32_bf16 v[146:149], a[68:71], v[186:189], v[146:149]
v_cvt_pk_bf16_f32 v102, v138, v139
v_cvt_pk_bf16_f32 v103, v140, v141
s_nop 0
v_cvt_pk_bf16_f32 v104, v142, v143
v_cvt_pk_bf16_f32 v105, v144, v145
s_nop 1
v_cvt_pk_bf16_f32 v106, v146, v147
v_cvt_pk_bf16_f32 v107, v148, v149
ds_read_b128 v[108:111], v215 offset:512
ds_read_b64 v[112:113], v215 offset:528
v_mov_b32 v181, 0
v_mfma_f32_16x16x32_bf16 v[138:141], v[78:81], v[72:75], 0
v_mfma_f32_16x16x32_bf16 v[142:145], v[96:99], v[72:75], 0
s_waitcnt lgkmcnt(1)
v_mfma_f32_16x16x32_bf16 v[150:153], v[108:111], v[72:75], v[206:209]
v_mfma_f32_16x16x32_bf16 v[146:149], v[102:105], v[72:75], 0
v_mfma_f32_16x16x16_bf16 v[138:141], v[82:83], v[76:77], v[138:141]
v_mfma_f32_16x16x16_bf16 v[142:145], v[100:101], v[76:77], v[142:145]
s_waitcnt lgkmcnt(0)
v_mfma_f32_16x16x16_bf16 v[150:153], v[112:113], v[76:77], v[150:153]
v_mfma_f32_16x16x16_bf16 v[146:149], v[106:107], v[76:77], v[146:149]
ds_read_b128 v[72:75], v215
ds_read_b64 v[76:77], v215 offset:16
v_mfma_f32_16x16x32_bf16 v[154:157], v[78:81], v[84:87], 0
v_mfma_f32_16x16x32_bf16 v[158:161], v[96:99], v[84:87], 0
v_mfma_f32_16x16x32_bf16 v[166:169], v[108:111], v[84:87], v[206:209]
v_mfma_f32_16x16x32_bf16 v[162:165], v[102:105], v[84:87], 0
v_mfma_f32_16x16x16_bf16 v[154:157], v[82:83], v[88:89], v[154:157]
v_mfma_f32_16x16x16_bf16 v[158:161], v[100:101], v[88:89], v[158:161]
v_mfma_f32_16x16x16_bf16 v[166:169], v[112:113], v[88:89], v[166:169]
v_mfma_f32_16x16x16_bf16 v[162:165], v[106:107], v[88:89], v[162:165]
ds_read_b128 v[182:185], v210 offset:12288
s_waitcnt lgkmcnt(0)
v_mfma_f32_16x16x32_bf16 v[118:121], v[182:185], a[72:75], 0
v_mfma_f32_16x16x32_bf16 v[126:129], v[182:185], a[96:99], 0
v_mfma_f32_16x16x32_bf16 v[134:137], v[182:185], a[120:123], 0
v_mfma_f32_16x16x32_bf16 v[90:93], a[216:219], v[182:185], 0
v_mfma_f32_16x16x32_bf16 v[170:173], a[240:243], v[182:185], 0
v_mfma_f32_16x16x32_bf16 v[220:223], v[232:235], v[182:185], 0
ds_read_b128 v[186:189], v210 offset:13312
s_waitcnt lgkmcnt(0)
v_mfma_f32_16x16x32_bf16 v[118:121], v[186:189], a[76:79], v[118:121]
v_mfma_f32_16x16x32_bf16 v[126:129], v[186:189], a[100:103], v[126:129]
v_mfma_f32_16x16x32_bf16 v[134:137], v[186:189], a[124:127], v[134:137]
v_mfma_f32_16x16x32_bf16 v[90:93], a[220:223], v[186:189], v[90:93]
v_mfma_f32_16x16x32_bf16 v[170:173], a[244:247], v[186:189], v[170:173]
v_mfma_f32_16x16x32_bf16 v[220:223], v[236:239], v[186:189], v[220:223]
ds_read_b128 v[182:185], v210 offset:14336
s_waitcnt lgkmcnt(0)
v_mfma_f32_16x16x32_bf16 v[118:121], v[182:185], a[80:83], v[118:121]
v_mfma_f32_16x16x32_bf16 v[126:129], v[182:185], a[104:107], v[126:129]
v_mfma_f32_16x16x32_bf16 v[134:137], v[182:185], a[128:131], v[134:137]
v_mfma_f32_16x16x32_bf16 v[90:93], a[224:227], v[182:185], v[90:93]
v_mfma_f32_16x16x32_bf16 v[170:173], a[248:251], v[182:185], v[170:173]
v_mfma_f32_16x16x32_bf16 v[220:223], v[240:243], v[182:185], v[220:223]
ds_read_b128 v[186:189], v210 offset:15360
s_waitcnt lgkmcnt(0)
v_mfma_f32_16x16x32_bf16 v[118:121], v[186:189], a[84:87], v[118:121]
v_mfma_f32_16x16x32_bf16 v[126:129], v[186:189], a[108:111], v[126:129]
v_mfma_f32_16x16x32_bf16 v[134:137], v[186:189], a[132:135], v[134:137]
v_mfma_f32_16x16x32_bf16 v[90:93], a[228:231], v[186:189], v[90:93]
v_mfma_f32_16x16x32_bf16 v[170:173], a[252:255], v[186:189], v[170:173]
v_mfma_f32_16x16x32_bf16 v[220:223], v[244:247], v[186:189], v[220:223]
ds_read_b128 v[182:185], v210 offset:16384
s_waitcnt lgkmcnt(0)
v_mfma_f32_16x16x32_bf16 v[118:121], v[182:185], a[88:91], v[118:121]
v_mfma_f32_16x16x32_bf16 v[126:129], v[182:185], a[112:115], v[126:129]
v_mfma_f32_16x16x32_bf16 v[134:137], v[182:185], a[136:139], v[134:137]
v_mfma_f32_16x16x32_bf16 v[90:93], a[232:235], v[182:185], v[90:93]
v_mfma_f32_16x16x32_bf16 v[170:173], v[224:227], v[182:185], v[170:173]
v_mfma_f32_16x16x32_bf16 v[220:223], v[248:251], v[182:185], v[220:223]
ds_read_b128 v[186:189], v210 offset:17408
s_waitcnt lgkmcnt(0)
v_mfma_f32_16x16x32_bf16 v[118:121], v[186:189], a[92:95], v[118:121]
v_mfma_f32_16x16x32_bf16 v[126:129], v[186:189], a[116:119], v[126:129]
v_mfma_f32_16x16x32_bf16 v[134:137], v[186:189], a[140:143], v[134:137]
v_mfma_f32_16x16x32_bf16 v[90:93], a[236:239], v[186:189], v[90:93]
v_mfma_f32_16x16x32_bf16 v[170:173], v[228:231], v[186:189], v[170:173]
v_mfma_f32_16x16x32_bf16 v[220:223], v[252:255], v[186:189], v[220:223]
v_cvt_pk_bf16_f32 v118, v118, v119
v_cvt_pk_bf16_f32 v119, v120, v121
ds_read_u16 v120, v216
v_mov_b32 v121, 0
v_cvt_pk_bf16_f32 v126, v126, v127
v_cvt_pk_bf16_f32 v127, v128, v129
ds_read_u16 v128, v216 offset:32
v_mov_b32 v129, 0
v_cvt_pk_bf16_f32 v134, v134, v135
v_cvt_pk_bf16_f32 v135, v136, v137
ds_read_u16 v136, v216 offset:64
v_mov_b32 v137, 0
v_add_u32 v216, 1408, v216
v_cvt_pk_bf16_f32 v90, v90, v91
v_cvt_pk_bf16_f32 v91, v92, v93
v_cvt_pk_bf16_f32 v92, v170, v171
v_cvt_pk_bf16_f32 v93, v172, v173
v_cvt_pk_bf16_f32 v94, v220, v221
v_cvt_pk_bf16_f32 v95, v222, v223
v_max3_f32 v151, v138, v139, v140
v_max3_f32 v151, v151, v141, v142
v_max3_f32 v151, v151, v143, v144
v_max3_f32 v151, v151, v145, v146
v_max3_f32 v151, v151, v147, v148
v_max3_f32 v151, v151, v149, v150
v_mov_b32 v152, v151
s_nop 1
v_permlane16_swap_b32 v151, v152
v_max_f32 v151, v151, v152
v_mov_b32 v152, v151
s_nop 1
v_permlane32_swap_b32 v151, v152
v_max_f32 v151, v151, v152
v_sub_f32 v138, v138, v151
v_sub_f32 v139, v139, v151
v_sub_f32 v140, v140, v151
v_sub_f32 v141, v141, v151
v_sub_f32 v142, v142, v151
v_sub_f32 v143, v143, v151
v_sub_f32 v144, v144, v151
v_sub_f32 v145, v145, v151
v_sub_f32 v150, v150, v151
v_sub_f32 v146, v146, v151
v_sub_f32 v147, v147, v151
v_sub_f32 v148, v148, v151
v_sub_f32 v149, v149, v151
v_exp_f32 v138, v138
v_exp_f32 v139, v139
v_exp_f32 v140, v140
v_exp_f32 v141, v141
v_exp_f32 v142, v142
v_exp_f32 v143, v143
v_exp_f32 v144, v144
v_exp_f32 v145, v145
v_exp_f32 v150, v150
v_exp_f32 v146, v146
v_exp_f32 v147, v147
v_exp_f32 v148, v148
v_exp_f32 v149, v149
v_cvt_pk_bf16_f32 v174, v138, v139
v_cvt_pk_bf16_f32 v175, v140, v141
v_cvt_pk_bf16_f32 v176, v142, v143
v_cvt_pk_bf16_f32 v177, v144, v145
v_cvt_pk_bf16_f32 v178, v146, v147
v_cvt_pk_bf16_f32 v179, v148, v149
v_cvt_pk_bf16_f32 v180, v150, 0
v_mfma_f32_16x16x32_bf16 v[150:153], v[190:193], v[174:177], 0
v_mfma_f32_16x16x32_bf16 v[138:141], v[114:117], v[174:177], 0
v_mfma_f32_16x16x32_bf16 v[142:145], v[122:125], v[174:177], 0
v_mfma_f32_16x16x32_bf16 v[146:149], v[130:133], v[174:177], 0
v_mfma_f32_16x16x32_bf16 v[150:153], v[190:193], v[178:181], v[150:153]
s_waitcnt lgkmcnt(2)
v_mfma_f32_16x16x32_bf16 v[138:141], v[118:121], v[178:181], v[138:141]
s_waitcnt lgkmcnt(1)
v_mfma_f32_16x16x32_bf16 v[142:145], v[126:129], v[178:181], v[142:145]
s_waitcnt lgkmcnt(0)
v_mfma_f32_16x16x32_bf16 v[146:149], v[134:137], v[178:181], v[146:149]
v_max3_f32 v167, v154, v155, v156
v_max3_f32 v167, v167, v157, v158
v_max3_f32 v167, v167, v159, v160
v_max3_f32 v167, v167, v161, v162
v_max3_f32 v167, v167, v163, v164
v_max3_f32 v167, v167, v165, v166
v_mov_b32 v168, v167
s_nop 1
v_permlane16_swap_b32 v167, v168
v_max_f32 v167, v167, v168
v_mov_b32 v168, v167
s_nop 1
v_permlane32_swap_b32 v167, v168
v_max_f32 v167, v167, v168
v_sub_f32 v154, v154, v167
v_sub_f32 v155, v155, v167
v_sub_f32 v156, v156, v167
v_sub_f32 v157, v157, v167
v_sub_f32 v158, v158, v167
v_sub_f32 v159, v159, v167
v_sub_f32 v160, v160, v167
v_sub_f32 v161, v161, v167
v_sub_f32 v166, v166, v167
v_sub_f32 v162, v162, v167
v_sub_f32 v163, v163, v167
v_sub_f32 v164, v164, v167
v_sub_f32 v165, v165, v167
v_exp_f32 v154, v154
v_exp_f32 v155, v155
v_exp_f32 v156, v156
v_exp_f32 v157, v157
v_exp_f32 v158, v158
v_exp_f32 v159, v159
v_exp_f32 v160, v160
v_exp_f32 v161, v161
v_exp_f32 v166, v166
v_exp_f32 v162, v162
v_exp_f32 v163, v163
v_exp_f32 v164, v164
v_exp_f32 v165, v165
v_cvt_pk_bf16_f32 v174, v154, v155
v_cvt_pk_bf16_f32 v175, v156, v157
v_cvt_pk_bf16_f32 v176, v158, v159
v_cvt_pk_bf16_f32 v177, v160, v161
v_cvt_pk_bf16_f32 v178, v162, v163
v_cvt_pk_bf16_f32 v179, v164, v165
v_cvt_pk_bf16_f32 v180, v166, 0
v_mfma_f32_16x16x32_bf16 v[166:169], v[190:193], v[174:177], 0
v_mfma_f32_16x16x32_bf16 v[154:157], v[114:117], v[174:177], 0
v_mfma_f32_16x16x32_bf16 v[158:161], v[122:125], v[174:177], 0
v_mfma_f32_16x16x32_bf16 v[162:165], v[130:133], v[174:177], 0
v_mfma_f32_16x16x32_bf16 v[166:169], v[190:193], v[178:181], v[166:169]
v_mfma_f32_16x16x32_bf16 v[154:157], v[118:121], v[178:181], v[154:157]
v_mfma_f32_16x16x32_bf16 v[158:161], v[126:129], v[178:181], v[158:161]
v_mfma_f32_16x16x32_bf16 v[162:165], v[134:137], v[178:181], v[162:165]
v_rcp_f32 v151, v150
s_nop 0
v_mul_f32 v151, s3, v151
v_mul_f32 v138, v138, v151
v_mul_f32 v139, v139, v151
v_cvt_pk_bf16_f32 v138, v138, v139
v_mul_f32 v140, v140, v151
v_mul_f32 v141, v141, v151
v_cvt_pk_bf16_f32 v139, v140, v141
v_mul_f32 v142, v142, v151
v_mul_f32 v143, v143, v151
v_cvt_pk_bf16_f32 v140, v142, v143
v_mul_f32 v144, v144, v151
v_mul_f32 v145, v145, v151
v_cvt_pk_bf16_f32 v141, v144, v145
ds_write_b128 v211, v[138:141] offset:36864
v_mul_f32 v146, v146, v151
v_mul_f32 v147, v147, v151
v_cvt_pk_bf16_f32 v142, v146, v147
v_mul_f32 v148, v148, v151
v_mul_f32 v149, v149, v151
v_cvt_pk_bf16_f32 v143, v148, v149
ds_write_b64 v212, v[142:143] offset:36864
v_mfma_f32_16x16x32_bf16 v[138:141], v[78:81], v[90:93], 0
v_mfma_f32_16x16x32_bf16 v[142:145], v[96:99], v[90:93], 0
v_mfma_f32_16x16x32_bf16 v[150:153], v[108:111], v[90:93], v[206:209]
v_mfma_f32_16x16x32_bf16 v[146:149], v[102:105], v[90:93], 0
v_mfma_f32_16x16x16_bf16 v[138:141], v[82:83], v[94:95], v[138:141]
v_mfma_f32_16x16x16_bf16 v[142:145], v[100:101], v[94:95], v[142:145]
v_mfma_f32_16x16x16_bf16 v[150:153], v[112:113], v[94:95], v[150:153]
v_mfma_f32_16x16x16_bf16 v[146:149], v[106:107], v[94:95], v[146:149]
v_rcp_f32 v167, v166
s_nop 0
v_mul_f32 v167, s3, v167
v_mul_f32 v154, v154, v167
v_mul_f32 v155, v155, v167
v_cvt_pk_bf16_f32 v154, v154, v155
v_mul_f32 v156, v156, v167
v_mul_f32 v157, v157, v167
v_cvt_pk_bf16_f32 v155, v156, v157
v_mul_f32 v158, v158, v167
v_mul_f32 v159, v159, v167
v_cvt_pk_bf16_f32 v156, v158, v159
v_mul_f32 v160, v160, v167
v_mul_f32 v161, v161, v167
v_cvt_pk_bf16_f32 v157, v160, v161
ds_write_b128 v211, v[154:157] offset:43008
v_mul_f32 v162, v162, v167
v_mul_f32 v163, v163, v167
v_cvt_pk_bf16_f32 v158, v162, v163
v_mul_f32 v164, v164, v167
v_mul_f32 v165, v165, v167
v_cvt_pk_bf16_f32 v159, v164, v165
ds_write_b64 v212, v[158:159] offset:43008
v_mfma_f32_16x16x32_bf16 v[154:157], v[72:75], v[78:81], 0
v_mfma_f32_16x16x32_bf16 v[158:161], v[72:75], v[96:99], 0
v_mfma_f32_16x16x32_bf16 v[162:165], v[72:75], v[102:105], 0
v_mfma_f32_16x16x32_bf16 v[166:169], v[72:75], v[108:111], v[206:209]
v_mfma_f32_16x16x16_bf16 v[154:157], v[76:77], v[82:83], v[154:157]
v_mfma_f32_16x16x16_bf16 v[158:161], v[76:77], v[100:101], v[158:161]
v_mfma_f32_16x16x16_bf16 v[162:165], v[76:77], v[106:107], v[162:165]
v_mfma_f32_16x16x16_bf16 v[166:169], v[76:77], v[112:113], v[166:169]
v_mov_b32_dpp v154, v158 quad_perm:[0,1,2,3] row_mask:0x2 bank_mask:0xf
s_nop 1
v_mov_b32_dpp v154, v162 quad_perm:[0,1,2,3] row_mask:0x4 bank_mask:0xf
s_nop 2
v_mov_b32_dpp v154, v167 quad_perm:[0,1,2,3] row_mask:0x8 bank_mask:0xf
v_mov_b32 v155, v154
s_nop 1
v_max_f32_dpp v155, v155, v155 row_ror:8 row_mask:0xf bank_mask:0xf
s_nop 1
v_max_f32_dpp v155, v155, v155 row_ror:4 row_mask:0xf bank_mask:0xf
s_nop 1
v_max_f32_dpp v155, v155, v155 row_ror:2 row_mask:0xf bank_mask:0xf
s_nop 1
v_max_f32_dpp v155, v155, v155 row_ror:1 row_mask:0xf bank_mask:0xf
v_mov_b32 v156, v155
s_nop 1
v_permlane16_swap_b32 v155, v156
v_max_f32 v155, v155, v156
v_mov_b32 v156, v155
s_nop 1
v_permlane32_swap_b32 v155, v156
v_max_f32 v155, v155, v156
v_sub_f32 v154, v154, v155
v_exp_f32 v154, v154
s_nop 0
v_cvt_pk_bf16_f32 v154, v154, 0
ds_write_b16 v214, v154
s_waitcnt lgkmcnt(1)
ds_read_b128 v[84:87], v215
ds_read_b128 v[88:91], v215 offset:16
v_add_u32 v215, 1408, v215
s_barrier
ds_read_b128 v[170:173], v210 offset:36864
s_waitcnt lgkmcnt(0)
v_mfma_f32_16x16x32_bf16 v[0:3], a[144:147], v[170:173], v[0:3]
v_mfma_f32_16x16x32_bf16 v[4:7], a[168:171], v[170:173], v[4:7]
v_mfma_f32_16x16x32_bf16 v[8:11], a[192:195], v[170:173], v[8:11]
ds_read_b128 v[182:185], v210 offset:37888
s_waitcnt lgkmcnt(0)
v_mfma_f32_16x16x32_bf16 v[0:3], a[148:151], v[182:185], v[0:3]
v_mfma_f32_16x16x32_bf16 v[4:7], a[172:175], v[182:185], v[4:7]
v_mfma_f32_16x16x32_bf16 v[8:11], a[196:199], v[182:185], v[8:11]
ds_read_b128 v[186:189], v210 offset:38912
s_waitcnt lgkmcnt(0)
v_mfma_f32_16x16x32_bf16 v[0:3], a[152:155], v[186:189], v[0:3]
v_mfma_f32_16x16x32_bf16 v[4:7], a[176:179], v[186:189], v[4:7]
v_mfma_f32_16x16x32_bf16 v[8:11], a[200:203], v[186:189], v[8:11]
ds_read_b128 v[170:173], v210 offset:39936
s_waitcnt lgkmcnt(0)
v_mfma_f32_16x16x32_bf16 v[0:3], a[156:159], v[170:173], v[0:3]
v_mfma_f32_16x16x32_bf16 v[4:7], a[180:183], v[170:173], v[4:7]
v_mfma_f32_16x16x32_bf16 v[8:11], a[204:207], v[170:173], v[8:11]
ds_read_b128 v[182:185], v210 offset:40960
s_waitcnt lgkmcnt(0)
v_mfma_f32_16x16x32_bf16 v[0:3], a[160:163], v[182:185], v[0:3]
v_mfma_f32_16x16x32_bf16 v[4:7], a[184:187], v[182:185], v[4:7]
v_mfma_f32_16x16x32_bf16 v[8:11], a[208:211], v[182:185], v[8:11]
ds_read_b128 v[186:189], v210 offset:41984
s_waitcnt lgkmcnt(0)
v_mfma_f32_16x16x32_bf16 v[0:3], a[164:167], v[186:189], v[0:3]
v_mfma_f32_16x16x32_bf16 v[4:7], a[188:191], v[186:189], v[4:7]
v_mfma_f32_16x16x32_bf16 v[8:11], a[212:215], v[186:189], v[8:11]
v_cvt_pk_bf16_f32 v72, v0, v1
v_cvt_pk_bf16_f32 v73, v2, v3
buffer_store_dwordx2 v[72:73], v203, s[8:11], s38 offen
v_cvt_pk_bf16_f32 v74, v4, v5
v_cvt_pk_bf16_f32 v75, v6, v7
buffer_store_dwordx2 v[74:75], v203, s[8:11], s38 offen offset:32
s_nop 0
v_cvt_pk_bf16_f32 v76, v8, v9
v_cvt_pk_bf16_f32 v77, v10, v11
buffer_store_dwordx2 v[76:77], v203, s[8:11], s38 offen offset:64
v_max3_f32 v151, v138, v139, v140
v_max3_f32 v151, v151, v141, v142
v_max3_f32 v151, v151, v143, v144
v_max3_f32 v151, v151, v145, v146
v_max3_f32 v151, v151, v147, v148
v_max3_f32 v151, v151, v149, v150
v_mov_b32 v152, v151
s_nop 1
v_permlane16_swap_b32 v151, v152
v_max_f32 v151, v151, v152
v_mov_b32 v152, v151
s_nop 1
v_permlane32_swap_b32 v151, v152
v_max_f32 v151, v151, v152
v_sub_f32 v138, v138, v151
v_sub_f32 v139, v139, v151
v_sub_f32 v140, v140, v151
v_sub_f32 v141, v141, v151
v_sub_f32 v142, v142, v151
v_sub_f32 v143, v143, v151
v_sub_f32 v144, v144, v151
v_sub_f32 v145, v145, v151
v_sub_f32 v150, v150, v151
v_sub_f32 v146, v146, v151
v_sub_f32 v147, v147, v151
v_sub_f32 v148, v148, v151
v_sub_f32 v149, v149, v151
v_exp_f32 v138, v138
v_exp_f32 v139, v139
v_exp_f32 v140, v140
v_exp_f32 v141, v141
v_exp_f32 v142, v142
v_exp_f32 v143, v143
v_exp_f32 v144, v144
v_exp_f32 v145, v145
v_exp_f32 v150, v150
v_exp_f32 v146, v146
v_exp_f32 v147, v147
v_exp_f32 v148, v148
v_exp_f32 v149, v149
v_cvt_pk_bf16_f32 v174, v138, v139
v_cvt_pk_bf16_f32 v175, v140, v141
v_cvt_pk_bf16_f32 v176, v142, v143
v_cvt_pk_bf16_f32 v177, v144, v145
v_cvt_pk_bf16_f32 v178, v146, v147
v_cvt_pk_bf16_f32 v179, v148, v149
v_cvt_pk_bf16_f32 v180, v150, 0
v_mfma_f32_16x16x32_bf16 v[150:153], v[190:193], v[174:177], 0
v_mfma_f32_16x16x32_bf16 v[138:141], v[114:117], v[174:177], 0
v_mfma_f32_16x16x32_bf16 v[142:145], v[122:125], v[174:177], 0
v_mfma_f32_16x16x32_bf16 v[146:149], v[130:133], v[174:177], 0
v_mfma_f32_16x16x32_bf16 v[150:153], v[190:193], v[178:181], v[150:153]
v_mfma_f32_16x16x32_bf16 v[138:141], v[118:121], v[178:181], v[138:141]
v_mfma_f32_16x16x32_bf16 v[142:145], v[126:129], v[178:181], v[142:145]
v_mfma_f32_16x16x32_bf16 v[146:149], v[134:137], v[178:181], v[146:149]
v_mfma_f32_16x16x32_bf16 v[166:169], v[84:87], v[190:193], 0
v_mfma_f32_16x16x32_bf16 v[154:157], v[84:87], v[114:117], 0
v_mfma_f32_16x16x32_bf16 v[158:161], v[84:87], v[122:125], 0
v_mfma_f32_16x16x32_bf16 v[162:165], v[84:87], v[130:133], 0
v_mfma_f32_16x16x32_bf16 v[166:169], v[88:91], v[190:193], v[166:169]
v_mfma_f32_16x16x32_bf16 v[154:157], v[88:91], v[118:121], v[154:157]
v_mfma_f32_16x16x32_bf16 v[158:161], v[88:91], v[126:129], v[158:161]
v_mfma_f32_16x16x32_bf16 v[162:165], v[88:91], v[134:137], v[162:165]
v_rcp_f32 v167, v166
s_nop 1
v_mov_b32_dpp v154, v158 quad_perm:[0,1,2,3] row_mask:0x2 bank_mask:0xf
s_nop 2
v_mov_b32_dpp v154, v162 quad_perm:[0,1,2,3] row_mask:0x4 bank_mask:0xf
v_mul_f32 v167, s3, v167
v_mul_f32 v154, v154, v167
v_cvt_pk_bf16_f32 v154, v154, 0
ds_write_b16 v214, v154
v_add_u32 v214, 1408, v214
ds_read_b128 v[170:173], v210 offset:43008
s_waitcnt lgkmcnt(0)
v_mfma_f32_16x16x32_bf16 v[12:15], a[144:147], v[170:173], v[12:15]
v_mfma_f32_16x16x32_bf16 v[16:19], a[168:171], v[170:173], v[16:19]
v_mfma_f32_16x16x32_bf16 v[20:23], a[192:195], v[170:173], v[20:23]
ds_read_b128 v[182:185], v210 offset:44032
s_waitcnt lgkmcnt(0)
v_mfma_f32_16x16x32_bf16 v[12:15], a[148:151], v[182:185], v[12:15]
v_mfma_f32_16x16x32_bf16 v[16:19], a[172:175], v[182:185], v[16:19]
v_mfma_f32_16x16x32_bf16 v[20:23], a[196:199], v[182:185], v[20:23]
ds_read_b128 v[186:189], v210 offset:45056
s_waitcnt lgkmcnt(0)
v_mfma_f32_16x16x32_bf16 v[12:15], a[152:155], v[186:189], v[12:15]
v_mfma_f32_16x16x32_bf16 v[16:19], a[176:179], v[186:189], v[16:19]
v_mfma_f32_16x16x32_bf16 v[20:23], a[200:203], v[186:189], v[20:23]
ds_read_b128 v[170:173], v210 offset:46080
s_waitcnt lgkmcnt(0)
v_mfma_f32_16x16x32_bf16 v[12:15], a[156:159], v[170:173], v[12:15]
v_mfma_f32_16x16x32_bf16 v[16:19], a[180:183], v[170:173], v[16:19]
v_mfma_f32_16x16x32_bf16 v[20:23], a[204:207], v[170:173], v[20:23]
ds_read_b128 v[182:185], v210 offset:47104
s_waitcnt lgkmcnt(0)
v_mfma_f32_16x16x32_bf16 v[12:15], a[160:163], v[182:185], v[12:15]
v_mfma_f32_16x16x32_bf16 v[16:19], a[184:187], v[182:185], v[16:19]
v_mfma_f32_16x16x32_bf16 v[20:23], a[208:211], v[182:185], v[20:23]
ds_read_b128 v[186:189], v210 offset:48128
s_waitcnt lgkmcnt(0)
v_mfma_f32_16x16x32_bf16 v[12:15], a[164:167], v[186:189], v[12:15]
v_mfma_f32_16x16x32_bf16 v[16:19], a[188:191], v[186:189], v[16:19]
v_mfma_f32_16x16x32_bf16 v[20:23], a[212:215], v[186:189], v[20:23]
v_cvt_pk_bf16_f32 v78, v12, v13
v_cvt_pk_bf16_f32 v79, v14, v15
buffer_store_dwordx2 v[78:79], v204, s[8:11], s38 offen
v_cvt_pk_bf16_f32 v80, v16, v17
v_cvt_pk_bf16_f32 v81, v18, v19
buffer_store_dwordx2 v[80:81], v204, s[8:11], s38 offen offset:32
s_nop 0
v_cvt_pk_bf16_f32 v82, v20, v21
v_cvt_pk_bf16_f32 v83, v22, v23
buffer_store_dwordx2 v[82:83], v204, s[8:11], s38 offen offset:64
v_rcp_f32 v151, v150
s_nop 0
v_mul_f32 v151, s3, v151
v_mul_f32 v138, v138, v151
v_mul_f32 v139, v139, v151
v_cvt_pk_bf16_f32 v138, v138, v139
v_mul_f32 v140, v140, v151
v_mul_f32 v141, v141, v151
v_cvt_pk_bf16_f32 v139, v140, v141
v_mul_f32 v142, v142, v151
v_mul_f32 v143, v143, v151
v_cvt_pk_bf16_f32 v140, v142, v143
v_mul_f32 v144, v144, v151
v_mul_f32 v145, v145, v151
v_cvt_pk_bf16_f32 v141, v144, v145
ds_write_b128 v211, v[138:141] offset:49152
v_mul_f32 v146, v146, v151
v_mul_f32 v147, v147, v151
v_cvt_pk_bf16_f32 v142, v146, v147
v_mul_f32 v148, v148, v151
v_mul_f32 v149, v149, v151
v_cvt_pk_bf16_f32 v143, v148, v149
ds_write_b64 v212, v[142:143] offset:49152
s_sub_u32 s46, s46, 1
s_cmp_lg_u32 s46, 0
s_cbranch_scc1 G_loop

s_waitcnt vmcnt(6) lgkmcnt(0)
s_barrier
ds_read_b128 v[170:173], v210 offset:49152
s_waitcnt lgkmcnt(0)
v_mfma_f32_16x16x32_bf16 v[24:27], a[144:147], v[170:173], v[24:27]
v_mfma_f32_16x16x32_bf16 v[28:31], a[168:171], v[170:173], v[28:31]
v_mfma_f32_16x16x32_bf16 v[32:35], a[192:195], v[170:173], v[32:35]
ds_read_b128 v[182:185], v210 offset:50176
s_waitcnt lgkmcnt(0)
v_mfma_f32_16x16x32_bf16 v[24:27], a[148:151], v[182:185], v[24:27]
v_mfma_f32_16x16x32_bf16 v[28:31], a[172:175], v[182:185], v[28:31]
v_mfma_f32_16x16x32_bf16 v[32:35], a[196:199], v[182:185], v[32:35]
ds_read_b128 v[186:189], v210 offset:51200
s_waitcnt lgkmcnt(0)
v_mfma_f32_16x16x32_bf16 v[24:27], a[152:155], v[186:189], v[24:27]
v_mfma_f32_16x16x32_bf16 v[28:31], a[176:179], v[186:189], v[28:31]
v_mfma_f32_16x16x32_bf16 v[32:35], a[200:203], v[186:189], v[32:35]
ds_read_b128 v[170:173], v210 offset:52224
s_waitcnt lgkmcnt(0)
v_mfma_f32_16x16x32_bf16 v[24:27], a[156:159], v[170:173], v[24:27]
v_mfma_f32_16x16x32_bf16 v[28:31], a[180:183], v[170:173], v[28:31]
v_mfma_f32_16x16x32_bf16 v[32:35], a[204:207], v[170:173], v[32:35]
ds_read_b128 v[182:185], v210 offset:53248
s_waitcnt lgkmcnt(0)
v_mfma_f32_16x16x32_bf16 v[24:27], a[160:163], v[182:185], v[24:27]
v_mfma_f32_16x16x32_bf16 v[28:31], a[184:187], v[182:185], v[28:31]
v_mfma_f32_16x16x32_bf16 v[32:35], a[208:211], v[182:185], v[32:35]
ds_read_b128 v[186:189], v210 offset:54272
s_waitcnt lgkmcnt(0)
v_mfma_f32_16x16x32_bf16 v[24:27], a[164:167], v[186:189], v[24:27]
v_mfma_f32_16x16x32_bf16 v[28:31], a[188:191], v[186:189], v[28:31]
v_mfma_f32_16x16x32_bf16 v[32:35], a[212:215], v[186:189], v[32:35]
v_cvt_pk_bf16_f32 v116, v24, v25
v_cvt_pk_bf16_f32 v117, v26, v27
buffer_store_dwordx2 v[116:117], v205, s[8:11], s38 offen
v_cvt_pk_bf16_f32 v124, v28, v29
v_cvt_pk_bf16_f32 v125, v30, v31
buffer_store_dwordx2 v[124:125], v205, s[8:11], s38 offen offset:32
s_nop 0
v_cvt_pk_bf16_f32 v132, v32, v33
v_cvt_pk_bf16_f32 v133, v34, v35
buffer_store_dwordx2 v[132:133], v205, s[8:11], s38 offen offset:64
s_mov_b32 s39, s37
ds_read_b128 v[174:177], v217
ds_read_b128 v[84:87], v200
s_waitcnt lgkmcnt(0)
v_mfma_f32_16x16x32_bf16 v[0:3], v[174:177], v[84:87], 0
ds_read_b128 v[92:95], v201
s_waitcnt lgkmcnt(0)
v_mfma_f32_16x16x32_bf16 v[12:15], v[174:177], v[92:95], 0
ds_read_b128 v[100:103], v202
s_waitcnt lgkmcnt(0)
v_mfma_f32_16x16x32_bf16 v[24:27], v[174:177], v[100:103], 0
ds_read_b128 v[178:181], v217 offset:528
ds_read_b128 v[84:87], v194
ds_read_b128 v[88:91], v194 offset:16
s_waitcnt lgkmcnt(0)
v_smfmac_f32_16x16x64_bf16 v[0:3], v[178:181], v[84:91], v213
ds_read_b128 v[92:95], v195
ds_read_b128 v[96:99], v195 offset:16
s_waitcnt lgkmcnt(0)
v_smfmac_f32_16x16x64_bf16 v[12:15], v[178:181], v[92:99], v213
ds_read_b128 v[100:103], v196
ds_read_b128 v[104:107], v196 offset:16
s_waitcnt lgkmcnt(0)
v_smfmac_f32_16x16x64_bf16 v[24:27], v[178:181], v[100:107], v213
ds_read_b128 v[174:177], v217 offset:1056
ds_read_b128 v[84:87], v197
ds_read_b128 v[88:91], v197 offset:16
s_waitcnt lgkmcnt(0)
v_smfmac_f32_16x16x64_bf16 v[0:3], v[174:177], v[84:91], v213
ds_read_b128 v[92:95], v198
ds_read_b128 v[96:99], v198 offset:16
s_waitcnt lgkmcnt(0)
v_smfmac_f32_16x16x64_bf16 v[12:15], v[174:177], v[92:99], v213
ds_read_b128 v[100:103], v199
ds_read_b128 v[104:107], v199 offset:16
s_waitcnt lgkmcnt(0)
v_smfmac_f32_16x16x64_bf16 v[24:27], v[174:177], v[100:107], v213
ds_read_b128 v[178:181], v217 offset:1584
ds_read_b128 v[84:87], v200 offset:32
s_waitcnt lgkmcnt(0)
v_mfma_f32_16x16x32_bf16 v[4:7], v[178:181], v[84:87], 0
ds_read_b128 v[92:95], v201 offset:32
s_waitcnt lgkmcnt(0)
v_mfma_f32_16x16x32_bf16 v[16:19], v[178:181], v[92:95], 0
ds_read_b128 v[100:103], v202 offset:32
s_waitcnt lgkmcnt(0)
v_mfma_f32_16x16x32_bf16 v[28:31], v[178:181], v[100:103], 0
ds_read_b128 v[174:177], v217 offset:2112
ds_read_b128 v[84:87], v194 offset:32
ds_read_b128 v[88:91], v194 offset:48
s_waitcnt lgkmcnt(0)
v_smfmac_f32_16x16x64_bf16 v[4:7], v[174:177], v[84:91], v213
ds_read_b128 v[92:95], v195 offset:32
ds_read_b128 v[96:99], v195 offset:48
s_waitcnt lgkmcnt(0)
v_smfmac_f32_16x16x64_bf16 v[16:19], v[174:177], v[92:99], v213
ds_read_b128 v[100:103], v196 offset:32
ds_read_b128 v[104:107], v196 offset:48
s_waitcnt lgkmcnt(0)
v_smfmac_f32_16x16x64_bf16 v[28:31], v[174:177], v[100:107], v213
ds_read_b128 v[178:181], v217 offset:2640
ds_read_b128 v[84:87], v197 offset:32
ds_read_b128 v[88:91], v197 offset:48
s_waitcnt lgkmcnt(0)
v_smfmac_f32_16x16x64_bf16 v[4:7], v[178:181], v[84:91], v213
ds_read_b128 v[92:95], v198 offset:32
ds_read_b128 v[96:99], v198 offset:48
s_waitcnt lgkmcnt(0)
v_smfmac_f32_16x16x64_bf16 v[16:19], v[178:181], v[92:99], v213
ds_read_b128 v[100:103], v199 offset:32
ds_read_b128 v[104:107], v199 offset:48
s_waitcnt lgkmcnt(0)
v_smfmac_f32_16x16x64_bf16 v[28:31], v[178:181], v[100:107], v213
ds_read_b128 v[174:177], v217 offset:3168
ds_read_b128 v[84:87], v200 offset:64
s_waitcnt lgkmcnt(0)
v_mfma_f32_16x16x32_bf16 v[8:11], v[174:177], v[84:87], 0
ds_read_b128 v[92:95], v201 offset:64
s_waitcnt lgkmcnt(0)
v_mfma_f32_16x16x32_bf16 v[20:23], v[174:177], v[92:95], 0
ds_read_b128 v[100:103], v202 offset:64
s_waitcnt lgkmcnt(0)
v_mfma_f32_16x16x32_bf16 v[32:35], v[174:177], v[100:103], 0
ds_read_b128 v[178:181], v217 offset:3696
ds_read_b128 v[84:87], v194 offset:64
ds_read_b128 v[88:91], v194 offset:80
s_waitcnt lgkmcnt(0)
v_smfmac_f32_16x16x64_bf16 v[8:11], v[178:181], v[84:91], v213
ds_read_b128 v[92:95], v195 offset:64
ds_read_b128 v[96:99], v195 offset:80
s_waitcnt lgkmcnt(0)
v_smfmac_f32_16x16x64_bf16 v[20:23], v[178:181], v[92:99], v213
ds_read_b128 v[100:103], v196 offset:64
ds_read_b128 v[104:107], v196 offset:80
s_waitcnt lgkmcnt(0)
v_smfmac_f32_16x16x64_bf16 v[32:35], v[178:181], v[100:107], v213
ds_read_b128 v[174:177], v217 offset:4224
ds_read_b128 v[84:87], v197 offset:64
ds_read_b128 v[88:91], v197 offset:80
s_waitcnt lgkmcnt(0)
v_smfmac_f32_16x16x64_bf16 v[8:11], v[174:177], v[84:91], v213
ds_read_b128 v[92:95], v198 offset:64
ds_read_b128 v[96:99], v198 offset:80
s_waitcnt lgkmcnt(0)
v_smfmac_f32_16x16x64_bf16 v[20:23], v[174:177], v[92:99], v213
ds_read_b128 v[100:103], v199 offset:64
ds_read_b128 v[104:107], v199 offset:80
s_waitcnt lgkmcnt(0)
v_smfmac_f32_16x16x64_bf16 v[32:35], v[174:177], v[100:107], v213
v_add_f32 v118, v0, v1
v_mul_f32 v119, v0, v0
v_add_f32 v118, v118, v2
v_fmac_f32 v119, v1, v1
v_add_f32 v118, v118, v3
v_fmac_f32 v119, v2, v2
v_fmac_f32 v119, v3, v3
v_add_f32 v126, v12, v13
v_mul_f32 v127, v12, v12
v_add_f32 v126, v126, v14
v_fmac_f32 v127, v13, v13
v_add_f32 v126, v126, v15
v_fmac_f32 v127, v14, v14
v_fmac_f32 v127, v15, v15
v_add_f32 v134, v24, v25
v_mul_f32 v135, v24, v24
v_add_f32 v134, v134, v26
v_fmac_f32 v135, v25, v25
v_add_f32 v134, v134, v27
v_fmac_f32 v135, v26, v26
v_fmac_f32 v135, v27, v27
v_add_f32 v118, v118, v4
v_fmac_f32 v119, v4, v4
v_add_f32 v118, v118, v5
v_fmac_f32 v119, v5, v5
v_add_f32 v118, v118, v6
v_fmac_f32 v119, v6, v6
v_add_f32 v118, v118, v7
v_fmac_f32 v119, v7, v7
v_add_f32 v126, v126, v16
v_fmac_f32 v127, v16, v16
v_add_f32 v126, v126, v17
v_fmac_f32 v127, v17, v17
v_add_f32 v126, v126, v18
v_fmac_f32 v127, v18, v18
v_add_f32 v126, v126, v19
v_fmac_f32 v127, v19, v19
v_add_f32 v134, v134, v28
v_fmac_f32 v135, v28, v28
v_add_f32 v134, v134, v29
v_fmac_f32 v135, v29, v29
v_add_f32 v134, v134, v30
v_fmac_f32 v135, v30, v30
v_add_f32 v134, v134, v31
v_fmac_f32 v135, v31, v31
v_add_f32 v118, v118, v8
v_fmac_f32 v119, v8, v8
v_add_f32 v118, v118, v9
v_fmac_f32 v119, v9, v9
v_add_f32 v118, v118, v10
v_fmac_f32 v119, v10, v10
v_add_f32 v118, v118, v11
v_fmac_f32 v119, v11, v11
v_add_f32 v126, v126, v20
v_fmac_f32 v127, v20, v20
v_add_f32 v126, v126, v21
v_fmac_f32 v127, v21, v21
v_add_f32 v126, v126, v22
v_fmac_f32 v127, v22, v22
v_add_f32 v126, v126, v23
v_fmac_f32 v127, v23, v23
v_add_f32 v134, v134, v32
v_fmac_f32 v135, v32, v32
v_add_f32 v134, v134, v33
v_fmac_f32 v135, v33, v33
v_add_f32 v134, v134, v34
v_fmac_f32 v135, v34, v34
v_add_f32 v134, v134, v35
v_fmac_f32 v135, v35, v35
v_permlane16_swap_b32 v118, v119
v_add_f32 v118, v118, v119
v_permlane16_swap_b32 v126, v127
v_add_f32 v126, v126, v127
v_permlane16_swap_b32 v134, v135
v_add_f32 v134, v134, v135
v_permlane32_swap_b32 v118, v126
v_add_f32 v118, v118, v126
ds_write_b32 v209, v118
v_mov_b32 v135, v134
s_nop 1
v_permlane32_swap_b32 v134, v135
v_add_f32 v134, v134, v135
ds_write_b32 v209, v134 offset:512
s_waitcnt lgkmcnt(0)
s_barrier
ds_read_b128 v[102:105], v210 offset:55296
ds_read_b128 v[106:109], v210 offset:56320
s_waitcnt lgkmcnt(1)
v_add_f32 v102, v102, v103
s_waitcnt lgkmcnt(0)
v_add_f32 v106, v106, v107
v_add_f32 v104, v104, v105
v_add_f32 v108, v108, v109
v_add_f32 v102, v102, v104
v_add_f32 v106, v106, v108
v_mul_f32 v103, s48, v102
v_mul_f32 v104, s73, v102
v_mul_f32 v106, s73, v106
v_fma_f32 v106, -v103, v104, v106
v_max_f32 v106, 0, v106
v_add_f32 v106, s49, v106
v_rsq_f32 v102, v106
s_nop 0
v_mul_f32_e64 v103, -v103, v102
ds_write_b64 v211, v[102:103] offset:36864
ds_read_b64 v[118:119], v219
ds_read_b64 v[126:127], v219 offset:256
ds_read_b64 v[134:135], v219 offset:512
s_waitcnt lgkmcnt(2)
v_fma_f32 v220, v0, v118, v119
v_fma_f32 v221, v1, v118, v119
v_cvt_pk_bf16_f32 v90, v220, v221
v_fma_f32 v222, v2, v118, v119
v_fma_f32 v223, v3, v118, v119
v_cvt_pk_bf16_f32 v91, v222, v223
v_fma_f32 v220, v4, v118, v119
v_fma_f32 v221, v5, v118, v119
v_cvt_pk_bf16_f32 v92, v220, v221
v_fma_f32 v222, v6, v118, v119
v_fma_f32 v223, v7, v118, v119
v_cvt_pk_bf16_f32 v93, v222, v223
ds_write_b128 v211, v[90:93]
v_fma_f32 v220, v8, v118, v119
v_fma_f32 v221, v9, v118, v119
v_cvt_pk_bf16_f32 v94, v220, v221
v_fma_f32 v222, v10, v118, v119
v_fma_f32 v223, v11, v118, v119
v_cvt_pk_bf16_f32 v95, v222, v223
s_waitcnt lgkmcnt(2)
ds_write_b64 v212, v[94:95]
v_fma_f32 v220, v12, v126, v127
v_fma_f32 v221, v13, v126, v127
v_cvt_pk_bf16_f32 v174, v220, v221
v_fma_f32 v222, v14, v126, v127
v_fma_f32 v223, v15, v126, v127
v_cvt_pk_bf16_f32 v175, v222, v223
v_fma_f32 v220, v16, v126, v127
v_fma_f32 v221, v17, v126, v127
v_cvt_pk_bf16_f32 v176, v220, v221
v_fma_f32 v222, v18, v126, v127
v_fma_f32 v223, v19, v126, v127
v_cvt_pk_bf16_f32 v177, v222, v223
ds_write_b128 v211, v[174:177] offset:6144
v_fma_f32 v220, v20, v126, v127
v_fma_f32 v221, v21, v126, v127
v_cvt_pk_bf16_f32 v178, v220, v221
v_fma_f32 v222, v22, v126, v127
v_fma_f32 v223, v23, v126, v127
v_cvt_pk_bf16_f32 v179, v222, v223
s_waitcnt lgkmcnt(3)
ds_write_b64 v212, v[178:179] offset:6144
v_fma_f32 v220, v24, v134, v135
v_fma_f32 v221, v25, v134, v135
v_cvt_pk_bf16_f32 v90, v220, v221
v_fma_f32 v222, v26, v134, v135
v_fma_f32 v223, v27, v134, v135
v_cvt_pk_bf16_f32 v91, v222, v223
v_fma_f32 v220, v28, v134, v135
v_fma_f32 v221, v29, v134, v135
v_cvt_pk_bf16_f32 v92, v220, v221
v_fma_f32 v222, v30, v134, v135
v_fma_f32 v223, v31, v134, v135
v_cvt_pk_bf16_f32 v93, v222, v223
ds_write_b128 v211, v[90:93] offset:12288
v_fma_f32 v220, v32, v134, v135
v_fma_f32 v221, v33, v134, v135
v_cvt_pk_bf16_f32 v94, v220, v221
v_fma_f32 v222, v34, v134, v135
v_fma_f32 v223, v35, v134, v135
v_cvt_pk_bf16_f32 v95, v222, v223
ds_write_b64 v212, v[94:95] offset:12288
ds_read_b128 v[182:185], v210 offset:18432
s_waitcnt lgkmcnt(0)
v_mfma_f32_16x16x32_bf16 v[138:141], a[0:3], v[182:185], 0
v_mfma_f32_16x16x32_bf16 v[142:145], a[24:27], v[182:185], 0
v_mfma_f32_16x16x32_bf16 v[146:149], a[48:51], v[182:185], 0
v_mfma_f32_16x16x32_bf16 v[150:153], a[216:219], v[182:185], 0
v_mfma_f32_16x16x32_bf16 v[154:157], a[240:243], v[182:185], 0
v_mfma_f32_16x16x32_bf16 v[158:161], v[232:235], v[182:185], 0
v_mfma_f32_16x16x32_bf16 v[162:165], v[182:185], a[72:75], 0
v_mfma_f32_16x16x32_bf16 v[166:169], v[182:185], a[96:99], 0
v_mfma_f32_16x16x32_bf16 v[170:173], v[182:185], a[120:123], 0
ds_read_b128 v[186:189], v210 offset:19456
s_waitcnt lgkmcnt(0)
v_mfma_f32_16x16x32_bf16 v[138:141], a[4:7], v[186:189], v[138:141]
v_mfma_f32_16x16x32_bf16 v[142:145], a[28:31], v[186:189], v[142:145]
v_mfma_f32_16x16x32_bf16 v[146:149], a[52:55], v[186:189], v[146:149]
v_mfma_f32_16x16x32_bf16 v[150:153], a[220:223], v[186:189], v[150:153]
v_mfma_f32_16x16x32_bf16 v[154:157], a[244:247], v[186:189], v[154:157]
v_mfma_f32_16x16x32_bf16 v[158:161], v[236:239], v[186:189], v[158:161]
v_mfma_f32_16x16x32_bf16 v[162:165], v[186:189], a[76:79], v[162:165]
v_mfma_f32_16x16x32_bf16 v[166:169], v[186:189], a[100:103], v[166:169]
v_mfma_f32_16x16x32_bf16 v[170:173], v[186:189], a[124:127], v[170:173]
ds_read_b128 v[182:185], v210 offset:20480
s_waitcnt lgkmcnt(0)
v_mfma_f32_16x16x32_bf16 v[138:141], a[8:11], v[182:185], v[138:141]
v_mfma_f32_16x16x32_bf16 v[142:145], a[32:35], v[182:185], v[142:145]
v_mfma_f32_16x16x32_bf16 v[146:149], a[56:59], v[182:185], v[146:149]
v_mfma_f32_16x16x32_bf16 v[150:153], a[224:227], v[182:185], v[150:153]
v_mfma_f32_16x16x32_bf16 v[154:157], a[248:251], v[182:185], v[154:157]
v_mfma_f32_16x16x32_bf16 v[158:161], v[240:243], v[182:185], v[158:161]
v_mfma_f32_16x16x32_bf16 v[162:165], v[182:185], a[80:83], v[162:165]
v_mfma_f32_16x16x32_bf16 v[166:169], v[182:185], a[104:107], v[166:169]
v_mfma_f32_16x16x32_bf16 v[170:173], v[182:185], a[128:131], v[170:173]
ds_read_b128 v[186:189], v210 offset:21504
s_waitcnt lgkmcnt(0)
v_mfma_f32_16x16x32_bf16 v[138:141], a[12:15], v[186:189], v[138:141]
v_mfma_f32_16x16x32_bf16 v[142:145], a[36:39], v[186:189], v[142:145]
v_mfma_f32_16x16x32_bf16 v[146:149], a[60:63], v[186:189], v[146:149]
v_mfma_f32_16x16x32_bf16 v[150:153], a[228:231], v[186:189], v[150:153]
v_mfma_f32_16x16x32_bf16 v[154:157], a[252:255], v[186:189], v[154:157]
v_mfma_f32_16x16x32_bf16 v[158:161], v[244:247], v[186:189], v[158:161]
v_mfma_f32_16x16x32_bf16 v[162:165], v[186:189], a[84:87], v[162:165]
v_mfma_f32_16x16x32_bf16 v[166:169], v[186:189], a[108:111], v[166:169]
v_mfma_f32_16x16x32_bf16 v[170:173], v[186:189], a[132:135], v[170:173]
ds_read_b128 v[182:185], v210 offset:22528
s_waitcnt lgkmcnt(0)
v_mfma_f32_16x16x32_bf16 v[138:141], a[16:19], v[182:185], v[138:141]
v_mfma_f32_16x16x32_bf16 v[142:145], a[40:43], v[182:185], v[142:145]
v_mfma_f32_16x16x32_bf16 v[146:149], a[64:67], v[182:185], v[146:149]
v_mfma_f32_16x16x32_bf16 v[150:153], a[232:235], v[182:185], v[150:153]
v_mfma_f32_16x16x32_bf16 v[154:157], v[224:227], v[182:185], v[154:157]
v_mfma_f32_16x16x32_bf16 v[158:161], v[248:251], v[182:185], v[158:161]
v_mfma_f32_16x16x32_bf16 v[162:165], v[182:185], a[88:91], v[162:165]
v_mfma_f32_16x16x32_bf16 v[166:169], v[182:185], a[112:115], v[166:169]
v_mfma_f32_16x16x32_bf16 v[170:173], v[182:185], a[136:139], v[170:173]
ds_read_b128 v[186:189], v210 offset:23552
s_waitcnt lgkmcnt(0)
v_mfma_f32_16x16x32_bf16 v[138:141], a[20:23], v[186:189], v[138:141]
v_mfma_f32_16x16x32_bf16 v[142:145], a[44:47], v[186:189], v[142:145]
v_mfma_f32_16x16x32_bf16 v[146:149], a[68:71], v[186:189], v[146:149]
v_mfma_f32_16x16x32_bf16 v[150:153], a[236:239], v[186:189], v[150:153]
v_mfma_f32_16x16x32_bf16 v[154:157], v[228:231], v[186:189], v[154:157]
v_mfma_f32_16x16x32_bf16 v[158:161], v[252:255], v[186:189], v[158:161]
v_mfma_f32_16x16x32_bf16 v[162:165], v[186:189], a[92:95], v[162:165]
v_mfma_f32_16x16x32_bf16 v[166:169], v[186:189], a[116:119], v[166:169]
v_mfma_f32_16x16x32_bf16 v[170:173], v[186:189], a[140:143], v[170:173]
v_cvt_pk_bf16_f32 v78, v138, v139
v_cvt_pk_bf16_f32 v79, v140, v141
v_cvt_pk_bf16_f32 v80, v142, v143
v_cvt_pk_bf16_f32 v81, v144, v145
v_cvt_pk_bf16_f32 v82, v146, v147
v_cvt_pk_bf16_f32 v83, v148, v149
v_cvt_pk_bf16_f32 v72, v150, v151
v_cvt_pk_bf16_f32 v73, v152, v153
v_cvt_pk_bf16_f32 v74, v154, v155
v_cvt_pk_bf16_f32 v75, v156, v157
v_cvt_pk_bf16_f32 v76, v158, v159
v_cvt_pk_bf16_f32 v77, v160, v161
v_cvt_pk_bf16_f32 v114, v162, v163
v_cvt_pk_bf16_f32 v115, v164, v165
v_cvt_pk_bf16_f32 v122, v166, v167
v_cvt_pk_bf16_f32 v123, v168, v169
v_cvt_pk_bf16_f32 v130, v170, v171
v_cvt_pk_bf16_f32 v131, v172, v173
ds_read_b128 v[182:185], v210 offset:24576
s_waitcnt lgkmcnt(0)
v_mfma_f32_16x16x32_bf16 v[138:141], a[0:3], v[182:185], 0
v_mfma_f32_16x16x32_bf16 v[142:145], a[24:27], v[182:185], 0
v_mfma_f32_16x16x32_bf16 v[146:149], a[48:51], v[182:185], 0
v_mfma_f32_16x16x32_bf16 v[150:153], a[216:219], v[182:185], 0
v_mfma_f32_16x16x32_bf16 v[154:157], a[240:243], v[182:185], 0
v_mfma_f32_16x16x32_bf16 v[158:161], v[232:235], v[182:185], 0
v_mfma_f32_16x16x32_bf16 v[162:165], v[182:185], a[72:75], 0
v_mfma_f32_16x16x32_bf16 v[166:169], v[182:185], a[96:99], 0
v_mfma_f32_16x16x32_bf16 v[170:173], v[182:185], a[120:123], 0
ds_read_b128 v[186:189], v210 offset:25600
s_waitcnt lgkmcnt(0)
v_mfma_f32_16x16x32_bf16 v[138:141], a[4:7], v[186:189], v[138:141]
v_mfma_f32_16x16x32_bf16 v[142:145], a[28:31], v[186:189], v[142:145]
v_mfma_f32_16x16x32_bf16 v[146:149], a[52:55], v[186:189], v[146:149]
v_mfma_f32_16x16x32_bf16 v[150:153], a[220:223], v[186:189], v[150:153]
v_mfma_f32_16x16x32_bf16 v[154:157], a[244:247], v[186:189], v[154:157]
v_mfma_f32_16x16x32_bf16 v[158:161], v[236:239], v[186:189], v[158:161]
v_mfma_f32_16x16x32_bf16 v[162:165], v[186:189], a[76:79], v[162:165]
v_mfma_f32_16x16x32_bf16 v[166:169], v[186:189], a[100:103], v[166:169]
v_mfma_f32_16x16x32_bf16 v[170:173], v[186:189], a[124:127], v[170:173]
ds_read_b128 v[182:185], v210 offset:26624
s_waitcnt lgkmcnt(0)
v_mfma_f32_16x16x32_bf16 v[138:141], a[8:11], v[182:185], v[138:141]
v_mfma_f32_16x16x32_bf16 v[142:145], a[32:35], v[182:185], v[142:145]
v_mfma_f32_16x16x32_bf16 v[146:149], a[56:59], v[182:185], v[146:149]
v_mfma_f32_16x16x32_bf16 v[150:153], a[224:227], v[182:185], v[150:153]
v_mfma_f32_16x16x32_bf16 v[154:157], a[248:251], v[182:185], v[154:157]
v_mfma_f32_16x16x32_bf16 v[158:161], v[240:243], v[182:185], v[158:161]
v_mfma_f32_16x16x32_bf16 v[162:165], v[182:185], a[80:83], v[162:165]
v_mfma_f32_16x16x32_bf16 v[166:169], v[182:185], a[104:107], v[166:169]
v_mfma_f32_16x16x32_bf16 v[170:173], v[182:185], a[128:131], v[170:173]
ds_read_b128 v[186:189], v210 offset:27648
s_waitcnt lgkmcnt(0)
v_mfma_f32_16x16x32_bf16 v[138:141], a[12:15], v[186:189], v[138:141]
v_mfma_f32_16x16x32_bf16 v[142:145], a[36:39], v[186:189], v[142:145]
v_mfma_f32_16x16x32_bf16 v[146:149], a[60:63], v[186:189], v[146:149]
v_mfma_f32_16x16x32_bf16 v[150:153], a[228:231], v[186:189], v[150:153]
v_mfma_f32_16x16x32_bf16 v[154:157], a[252:255], v[186:189], v[154:157]
v_mfma_f32_16x16x32_bf16 v[158:161], v[244:247], v[186:189], v[158:161]
v_mfma_f32_16x16x32_bf16 v[162:165], v[186:189], a[84:87], v[162:165]
v_mfma_f32_16x16x32_bf16 v[166:169], v[186:189], a[108:111], v[166:169]
v_mfma_f32_16x16x32_bf16 v[170:173], v[186:189], a[132:135], v[170:173]
ds_read_b128 v[182:185], v210 offset:28672
s_waitcnt lgkmcnt(0)
v_mfma_f32_16x16x32_bf16 v[138:141], a[16:19], v[182:185], v[138:141]
v_mfma_f32_16x16x32_bf16 v[142:145], a[40:43], v[182:185], v[142:145]
v_mfma_f32_16x16x32_bf16 v[146:149], a[64:67], v[182:185], v[146:149]
v_mfma_f32_16x16x32_bf16 v[150:153], a[232:235], v[182:185], v[150:153]
v_mfma_f32_16x16x32_bf16 v[154:157], v[224:227], v[182:185], v[154:157]
v_mfma_f32_16x16x32_bf16 v[158:161], v[248:251], v[182:185], v[158:161]
v_mfma_f32_16x16x32_bf16 v[162:165], v[182:185], a[88:91], v[162:165]
v_mfma_f32_16x16x32_bf16 v[166:169], v[182:185], a[112:115], v[166:169]
v_mfma_f32_16x16x32_bf16 v[170:173], v[182:185], a[136:139], v[170:173]
ds_read_b128 v[186:189], v210 offset:29696
s_waitcnt lgkmcnt(0)
v_mfma_f32_16x16x32_bf16 v[138:141], a[20:23], v[186:189], v[138:141]
v_mfma_f32_16x16x32_bf16 v[142:145], a[44:47], v[186:189], v[142:145]
v_mfma_f32_16x16x32_bf16 v[146:149], a[68:71], v[186:189], v[146:149]
v_mfma_f32_16x16x32_bf16 v[150:153], a[236:239], v[186:189], v[150:153]
v_mfma_f32_16x16x32_bf16 v[154:157], v[228:231], v[186:189], v[154:157]
v_mfma_f32_16x16x32_bf16 v[158:161], v[252:255], v[186:189], v[158:161]
v_mfma_f32_16x16x32_bf16 v[162:165], v[186:189], a[92:95], v[162:165]
v_mfma_f32_16x16x32_bf16 v[166:169], v[186:189], a[116:119], v[166:169]
v_mfma_f32_16x16x32_bf16 v[170:173], v[186:189], a[140:143], v[170:173]
v_cvt_pk_bf16_f32 v96, v138, v139
v_cvt_pk_bf16_f32 v97, v140, v141
v_cvt_pk_bf16_f32 v98, v142, v143
v_cvt_pk_bf16_f32 v99, v144, v145
v_cvt_pk_bf16_f32 v100, v146, v147
v_cvt_pk_bf16_f32 v101, v148, v149
v_cvt_pk_bf16_f32 v84, v150, v151
v_cvt_pk_bf16_f32 v85, v152, v153
v_cvt_pk_bf16_f32 v86, v154, v155
v_cvt_pk_bf16_f32 v87, v156, v157
v_cvt_pk_bf16_f32 v88, v158, v159
v_cvt_pk_bf16_f32 v89, v160, v161
v_cvt_pk_bf16_f32 v116, v162, v163
v_cvt_pk_bf16_f32 v117, v164, v165
v_cvt_pk_bf16_f32 v124, v166, v167
v_cvt_pk_bf16_f32 v125, v168, v169
v_cvt_pk_bf16_f32 v132, v170, v171
v_cvt_pk_bf16_f32 v133, v172, v173
ds_read_b128 v[182:185], v210 offset:30720
s_waitcnt lgkmcnt(0)
v_mfma_f32_16x16x32_bf16 v[138:141], a[0:3], v[182:185], 0
v_mfma_f32_16x16x32_bf16 v[142:145], a[24:27], v[182:185], 0
v_mfma_f32_16x16x32_bf16 v[146:149], a[48:51], v[182:185], 0
ds_read_b128 v[186:189], v210 offset:31744
s_waitcnt lgkmcnt(0)
v_mfma_f32_16x16x32_bf16 v[138:141], a[4:7], v[186:189], v[138:141]
v_mfma_f32_16x16x32_bf16 v[142:145], a[28:31], v[186:189], v[142:145]
v_mfma_f32_16x16x32_bf16 v[146:149], a[52:55], v[186:189], v[146:149]
ds_read_b128 v[182:185], v210 offset:32768
s_waitcnt lgkmcnt(0)
v_mfma_f32_16x16x32_bf16 v[138:141], a[8:11], v[182:185], v[138:141]
v_mfma_f32_16x16x32_bf16 v[142:145], a[32:35], v[182:185], v[142:145]
v_mfma_f32_16x16x32_bf16 v[146:149], a[56:59], v[182:185], v[146:149]
ds_read_b128 v[186:189], v210 offset:33792
s_waitcnt lgkmcnt(0)
v_mfma_f32_16x16x32_bf16 v[138:141], a[12:15], v[186:189], v[138:141]
v_mfma_f32_16x16x32_bf16 v[142:145], a[36:39], v[186:189], v[142:145]
v_mfma_f32_16x16x32_bf16 v[146:149], a[60:63], v[186:189], v[146:149]
ds_read_b128 v[182:185], v210 offset:34816
s_waitcnt lgkmcnt(0)
v_mfma_f32_16x16x32_bf16 v[138:141], a[16:19], v[182:185], v[138:141]
v_mfma_f32_16x16x32_bf16 v[142:145], a[40:43], v[182:185], v[142:145]
v_mfma_f32_16x16x32_bf16 v[146:149], a[64:67], v[182:185], v[146:149]
ds_read_b128 v[186:189], v210 offset:35840
s_waitcnt lgkmcnt(0)
v_mfma_f32_16x16x32_bf16 v[138:141], a[20:23], v[186:189], v[138:141]
v_mfma_f32_16x16x32_bf16 v[142:145], a[44:47], v[186:189], v[142:145]
v_mfma_f32_16x16x32_bf16 v[146:149], a[68:71], v[186:189], v[146:149]
v_cvt_pk_bf16_f32 v102, v138, v139
v_cvt_pk_bf16_f32 v103, v140, v141
s_nop 0
v_cvt_pk_bf16_f32 v104, v142, v143
v_cvt_pk_bf16_f32 v105, v144, v145
s_nop 1
v_cvt_pk_bf16_f32 v106, v146, v147
v_cvt_pk_bf16_f32 v107, v148, v149
ds_read_b128 v[108:111], v215 offset:512
ds_read_b64 v[112:113], v215 offset:528
v_mov_b32 v181, 0
v_mfma_f32_16x16x32_bf16 v[138:141], v[78:81], v[72:75], 0
v_mfma_f32_16x16x32_bf16 v[142:145], v[96:99], v[72:75], 0
s_waitcnt lgkmcnt(1)
v_mfma_f32_16x16x32_bf16 v[150:153], v[108:111], v[72:75], v[206:209]
v_mfma_f32_16x16x32_bf16 v[146:149], v[102:105], v[72:75], 0
v_mfma_f32_16x16x16_bf16 v[138:141], v[82:83], v[76:77], v[138:141]
v_mfma_f32_16x16x16_bf16 v[142:145], v[100:101], v[76:77], v[142:145]
s_waitcnt lgkmcnt(0)
v_mfma_f32_16x16x16_bf16 v[150:153], v[112:113], v[76:77], v[150:153]
v_mfma_f32_16x16x16_bf16 v[146:149], v[106:107], v[76:77], v[146:149]
ds_read_b128 v[72:75], v215
ds_read_b64 v[76:77], v215 offset:16
v_mfma_f32_16x16x32_bf16 v[154:157], v[78:81], v[84:87], 0
v_mfma_f32_16x16x32_bf16 v[158:161], v[96:99], v[84:87], 0
v_mfma_f32_16x16x32_bf16 v[166:169], v[108:111], v[84:87], v[206:209]
v_mfma_f32_16x16x32_bf16 v[162:165], v[102:105], v[84:87], 0
v_mfma_f32_16x16x16_bf16 v[154:157], v[82:83], v[88:89], v[154:157]
v_mfma_f32_16x16x16_bf16 v[158:161], v[100:101], v[88:89], v[158:161]
v_mfma_f32_16x16x16_bf16 v[166:169], v[112:113], v[88:89], v[166:169]
v_mfma_f32_16x16x16_bf16 v[162:165], v[106:107], v[88:89], v[162:165]
ds_read_b128 v[182:185], v210 offset:30720
s_waitcnt lgkmcnt(0)
v_mfma_f32_16x16x32_bf16 v[118:121], v[182:185], a[72:75], 0
v_mfma_f32_16x16x32_bf16 v[126:129], v[182:185], a[96:99], 0
v_mfma_f32_16x16x32_bf16 v[134:137], v[182:185], a[120:123], 0
v_mfma_f32_16x16x32_bf16 v[90:93], a[216:219], v[182:185], 0
v_mfma_f32_16x16x32_bf16 v[170:173], a[240:243], v[182:185], 0
v_mfma_f32_16x16x32_bf16 v[220:223], v[232:235], v[182:185], 0
ds_read_b128 v[186:189], v210 offset:31744
s_waitcnt lgkmcnt(0)
v_mfma_f32_16x16x32_bf16 v[118:121], v[186:189], a[76:79], v[118:121]
v_mfma_f32_16x16x32_bf16 v[126:129], v[186:189], a[100:103], v[126:129]
v_mfma_f32_16x16x32_bf16 v[134:137], v[186:189], a[124:127], v[134:137]
v_mfma_f32_16x16x32_bf16 v[90:93], a[220:223], v[186:189], v[90:93]
v_mfma_f32_16x16x32_bf16 v[170:173], a[244:247], v[186:189], v[170:173]
v_mfma_f32_16x16x32_bf16 v[220:223], v[236:239], v[186:189], v[220:223]
ds_read_b128 v[182:185], v210 offset:32768
s_waitcnt lgkmcnt(0)
v_mfma_f32_16x16x32_bf16 v[118:121], v[182:185], a[80:83], v[118:121]
v_mfma_f32_16x16x32_bf16 v[126:129], v[182:185], a[104:107], v[126:129]
v_mfma_f32_16x16x32_bf16 v[134:137], v[182:185], a[128:131], v[134:137]
v_mfma_f32_16x16x32_bf16 v[90:93], a[224:227], v[182:185], v[90:93]
v_mfma_f32_16x16x32_bf16 v[170:173], a[248:251], v[182:185], v[170:173]
v_mfma_f32_16x16x32_bf16 v[220:223], v[240:243], v[182:185], v[220:223]
ds_read_b128 v[186:189], v210 offset:33792
s_waitcnt lgkmcnt(0)
v_mfma_f32_16x16x32_bf16 v[118:121], v[186:189], a[84:87], v[118:121]
v_mfma_f32_16x16x32_bf16 v[126:129], v[186:189], a[108:111], v[126:129]
v_mfma_f32_16x16x32_bf16 v[134:137], v[186:189], a[132:135], v[134:137]
v_mfma_f32_16x16x32_bf16 v[90:93], a[228:231], v[186:189], v[90:93]
v_mfma_f32_16x16x32_bf16 v[170:173], a[252:255], v[186:189], v[170:173]
v_mfma_f32_16x16x32_bf16 v[220:223], v[244:247], v[186:189], v[220:223]
ds_read_b128 v[182:185], v210 offset:34816
s_waitcnt lgkmcnt(0)
v_mfma_f32_16x16x32_bf16 v[118:121], v[182:185], a[88:91], v[118:121]
v_mfma_f32_16x16x32_bf16 v[126:129], v[182:185], a[112:115], v[126:129]
v_mfma_f32_16x16x32_bf16 v[134:137], v[182:185], a[136:139], v[134:137]
v_mfma_f32_16x16x32_bf16 v[90:93], a[232:235], v[182:185], v[90:93]
v_mfma_f32_16x16x32_bf16 v[170:173], v[224:227], v[182:185], v[170:173]
v_mfma_f32_16x16x32_bf16 v[220:223], v[248:251], v[182:185], v[220:223]
ds_read_b128 v[186:189], v210 offset:35840
s_waitcnt lgkmcnt(0)
v_mfma_f32_16x16x32_bf16 v[118:121], v[186:189], a[92:95], v[118:121]
v_mfma_f32_16x16x32_bf16 v[126:129], v[186:189], a[116:119], v[126:129]
v_mfma_f32_16x16x32_bf16 v[134:137], v[186:189], a[140:143], v[134:137]
v_mfma_f32_16x16x32_bf16 v[90:93], a[236:239], v[186:189], v[90:93]
v_mfma_f32_16x16x32_bf16 v[170:173], v[228:231], v[186:189], v[170:173]
v_mfma_f32_16x16x32_bf16 v[220:223], v[252:255], v[186:189], v[220:223]
v_cvt_pk_bf16_f32 v118, v118, v119
v_cvt_pk_bf16_f32 v119, v120, v121
ds_read_u16 v120, v216
v_mov_b32 v121, 0
v_cvt_pk_bf16_f32 v126, v126, v127
v_cvt_pk_bf16_f32 v127, v128, v129
ds_read_u16 v128, v216 offset:32
v_mov_b32 v129, 0
v_cvt_pk_bf16_f32 v134, v134, v135
v_cvt_pk_bf16_f32 v135, v136, v137
ds_read_u16 v136, v216 offset:64
v_mov_b32 v137, 0
v_add_u32 v216, 1408, v216
v_cvt_pk_bf16_f32 v90, v90, v91
v_cvt_pk_bf16_f32 v91, v92, v93
v_cvt_pk_bf16_f32 v92, v170, v171
v_cvt_pk_bf16_f32 v93, v172, v173
v_cvt_pk_bf16_f32 v94, v220, v221
v_cvt_pk_bf16_f32 v95, v222, v223
v_max3_f32 v151, v138, v139, v140
v_max3_f32 v151, v151, v141, v142
v_max3_f32 v151, v151, v143, v144
v_max3_f32 v151, v151, v145, v146
v_max3_f32 v151, v151, v147, v148
v_max3_f32 v151, v151, v149, v150
v_mov_b32 v152, v151
s_nop 1
v_permlane16_swap_b32 v151, v152
v_max_f32 v151, v151, v152
v_mov_b32 v152, v151
s_nop 1
v_permlane32_swap_b32 v151, v152
v_max_f32 v151, v151, v152
v_sub_f32 v138, v138, v151
v_sub_f32 v139, v139, v151
v_sub_f32 v140, v140, v151
v_sub_f32 v141, v141, v151
v_sub_f32 v142, v142, v151
v_sub_f32 v143, v143, v151
v_sub_f32 v144, v144, v151
v_sub_f32 v145, v145, v151
v_sub_f32 v150, v150, v151
v_sub_f32 v146, v146, v151
v_sub_f32 v147, v147, v151
v_sub_f32 v148, v148, v151
v_sub_f32 v149, v149, v151
v_exp_f32 v138, v138
v_exp_f32 v139, v139
v_exp_f32 v140, v140
v_exp_f32 v141, v141
v_exp_f32 v142, v142
v_exp_f32 v143, v143
v_exp_f32 v144, v144
v_exp_f32 v145, v145
v_exp_f32 v150, v150
v_exp_f32 v146, v146
v_exp_f32 v147, v147
v_exp_f32 v148, v148
v_exp_f32 v149, v149
v_cvt_pk_bf16_f32 v174, v138, v139
v_cvt_pk_bf16_f32 v175, v140, v141
v_cvt_pk_bf16_f32 v176, v142, v143
v_cvt_pk_bf16_f32 v177, v144, v145
v_cvt_pk_bf16_f32 v178, v146, v147
v_cvt_pk_bf16_f32 v179, v148, v149
v_cvt_pk_bf16_f32 v180, v150, 0
v_mfma_f32_16x16x32_bf16 v[150:153], v[190:193], v[174:177], 0
v_mfma_f32_16x16x32_bf16 v[138:141], v[114:117], v[174:177], 0
v_mfma_f32_16x16x32_bf16 v[142:145], v[122:125], v[174:177], 0
v_mfma_f32_16x16x32_bf16 v[146:149], v[130:133], v[174:177], 0
v_mfma_f32_16x16x32_bf16 v[150:153], v[190:193], v[178:181], v[150:153]
s_waitcnt lgkmcnt(2)
v_mfma_f32_16x16x32_bf16 v[138:141], v[118:121], v[178:181], v[138:141]
s_waitcnt lgkmcnt(1)
v_mfma_f32_16x16x32_bf16 v[142:145], v[126:129], v[178:181], v[142:145]
s_waitcnt lgkmcnt(0)
v_mfma_f32_16x16x32_bf16 v[146:149], v[134:137], v[178:181], v[146:149]
v_max3_f32 v167, v154, v155, v156
v_max3_f32 v167, v167, v157, v158
v_max3_f32 v167, v167, v159, v160
v_max3_f32 v167, v167, v161, v162
v_max3_f32 v167, v167, v163, v164
v_max3_f32 v167, v167, v165, v166
v_mov_b32 v168, v167
s_nop 1
v_permlane16_swap_b32 v167, v168
v_max_f32 v167, v167, v168
v_mov_b32 v168, v167
s_nop 1
v_permlane32_swap_b32 v167, v168
v_max_f32 v167, v167, v168
v_sub_f32 v154, v154, v167
v_sub_f32 v155, v155, v167
v_sub_f32 v156, v156, v167
v_sub_f32 v157, v157, v167
v_sub_f32 v158, v158, v167
v_sub_f32 v159, v159, v167
v_sub_f32 v160, v160, v167
v_sub_f32 v161, v161, v167
v_sub_f32 v166, v166, v167
v_sub_f32 v162, v162, v167
v_sub_f32 v163, v163, v167
v_sub_f32 v164, v164, v167
v_sub_f32 v165, v165, v167
v_exp_f32 v154, v154
v_exp_f32 v155, v155
v_exp_f32 v156, v156
v_exp_f32 v157, v157
v_exp_f32 v158, v158
v_exp_f32 v159, v159
v_exp_f32 v160, v160
v_exp_f32 v161, v161
v_exp_f32 v166, v166
v_exp_f32 v162, v162
v_exp_f32 v163, v163
v_exp_f32 v164, v164
v_exp_f32 v165, v165
v_cvt_pk_bf16_f32 v174, v154, v155
v_cvt_pk_bf16_f32 v175, v156, v157
v_cvt_pk_bf16_f32 v176, v158, v159
v_cvt_pk_bf16_f32 v177, v160, v161
v_cvt_pk_bf16_f32 v178, v162, v163
v_cvt_pk_bf16_f32 v179, v164, v165
v_cvt_pk_bf16_f32 v180, v166, 0
v_mfma_f32_16x16x32_bf16 v[166:169], v[190:193], v[174:177], 0
v_mfma_f32_16x16x32_bf16 v[154:157], v[114:117], v[174:177], 0
v_mfma_f32_16x16x32_bf16 v[158:161], v[122:125], v[174:177], 0
v_mfma_f32_16x16x32_bf16 v[162:165], v[130:133], v[174:177], 0
v_mfma_f32_16x16x32_bf16 v[166:169], v[190:193], v[178:181], v[166:169]
v_mfma_f32_16x16x32_bf16 v[154:157], v[118:121], v[178:181], v[154:157]
v_mfma_f32_16x16x32_bf16 v[158:161], v[126:129], v[178:181], v[158:161]
v_mfma_f32_16x16x32_bf16 v[162:165], v[134:137], v[178:181], v[162:165]
v_rcp_f32 v151, v150
s_nop 0
v_mul_f32 v151, s3, v151
v_mul_f32 v138, v138, v151
v_mul_f32 v139, v139, v151
v_cvt_pk_bf16_f32 v138, v138, v139
v_mul_f32 v140, v140, v151
v_mul_f32 v141, v141, v151
v_cvt_pk_bf16_f32 v139, v140, v141
v_mul_f32 v142, v142, v151
v_mul_f32 v143, v143, v151
v_cvt_pk_bf16_f32 v140, v142, v143
v_mul_f32 v144, v144, v151
v_mul_f32 v145, v145, v151
v_cvt_pk_bf16_f32 v141, v144, v145
ds_write_b128 v211, v[138:141] offset:36864
v_mul_f32 v146, v146, v151
v_mul_f32 v147, v147, v151
v_cvt_pk_bf16_f32 v142, v146, v147
v_mul_f32 v148, v148, v151
v_mul_f32 v149, v149, v151
v_cvt_pk_bf16_f32 v143, v148, v149
ds_write_b64 v212, v[142:143] offset:36864
v_mfma_f32_16x16x32_bf16 v[138:141], v[78:81], v[90:93], 0
v_mfma_f32_16x16x32_bf16 v[142:145], v[96:99], v[90:93], 0
v_mfma_f32_16x16x32_bf16 v[150:153], v[108:111], v[90:93], v[206:209]
v_mfma_f32_16x16x32_bf16 v[146:149], v[102:105], v[90:93], 0
v_mfma_f32_16x16x16_bf16 v[138:141], v[82:83], v[94:95], v[138:141]
v_mfma_f32_16x16x16_bf16 v[142:145], v[100:101], v[94:95], v[142:145]
v_mfma_f32_16x16x16_bf16 v[150:153], v[112:113], v[94:95], v[150:153]
v_mfma_f32_16x16x16_bf16 v[146:149], v[106:107], v[94:95], v[146:149]
v_rcp_f32 v167, v166
s_nop 0
v_mul_f32 v167, s3, v167
v_mul_f32 v154, v154, v167
v_mul_f32 v155, v155, v167
v_cvt_pk_bf16_f32 v154, v154, v155
v_mul_f32 v156, v156, v167
v_mul_f32 v157, v157, v167
v_cvt_pk_bf16_f32 v155, v156, v157
v_mul_f32 v158, v158, v167
v_mul_f32 v159, v159, v167
v_cvt_pk_bf16_f32 v156, v158, v159
v_mul_f32 v160, v160, v167
v_mul_f32 v161, v161, v167
v_cvt_pk_bf16_f32 v157, v160, v161
ds_write_b128 v211, v[154:157] offset:43008
v_mul_f32 v162, v162, v167
v_mul_f32 v163, v163, v167
v_cvt_pk_bf16_f32 v158, v162, v163
v_mul_f32 v164, v164, v167
v_mul_f32 v165, v165, v167
v_cvt_pk_bf16_f32 v159, v164, v165
ds_write_b64 v212, v[158:159] offset:43008
v_mfma_f32_16x16x32_bf16 v[154:157], v[72:75], v[78:81], 0
v_mfma_f32_16x16x32_bf16 v[158:161], v[72:75], v[96:99], 0
v_mfma_f32_16x16x32_bf16 v[162:165], v[72:75], v[102:105], 0
v_mfma_f32_16x16x32_bf16 v[166:169], v[72:75], v[108:111], v[206:209]
v_mfma_f32_16x16x16_bf16 v[154:157], v[76:77], v[82:83], v[154:157]
v_mfma_f32_16x16x16_bf16 v[158:161], v[76:77], v[100:101], v[158:161]
v_mfma_f32_16x16x16_bf16 v[162:165], v[76:77], v[106:107], v[162:165]
v_mfma_f32_16x16x16_bf16 v[166:169], v[76:77], v[112:113], v[166:169]
v_mov_b32_dpp v154, v158 quad_perm:[0,1,2,3] row_mask:0x2 bank_mask:0xf
s_nop 1
v_mov_b32_dpp v154, v162 quad_perm:[0,1,2,3] row_mask:0x4 bank_mask:0xf
s_nop 2
v_mov_b32_dpp v154, v167 quad_perm:[0,1,2,3] row_mask:0x8 bank_mask:0xf
v_mov_b32 v155, v154
s_nop 1
v_max_f32_dpp v155, v155, v155 row_ror:8 row_mask:0xf bank_mask:0xf
s_nop 1
v_max_f32_dpp v155, v155, v155 row_ror:4 row_mask:0xf bank_mask:0xf
s_nop 1
v_max_f32_dpp v155, v155, v155 row_ror:2 row_mask:0xf bank_mask:0xf
s_nop 1
v_max_f32_dpp v155, v155, v155 row_ror:1 row_mask:0xf bank_mask:0xf
v_mov_b32 v156, v155
s_nop 1
v_permlane16_swap_b32 v155, v156
v_max_f32 v155, v155, v156
v_mov_b32 v156, v155
s_nop 1
v_permlane32_swap_b32 v155, v156
v_max_f32 v155, v155, v156
v_sub_f32 v154, v154, v155
v_exp_f32 v154, v154
s_nop 0
v_cvt_pk_bf16_f32 v154, v154, 0
ds_write_b16 v214, v154
s_waitcnt lgkmcnt(1)
ds_read_b128 v[84:87], v215
ds_read_b128 v[88:91], v215 offset:16
v_add_u32 v215, 1408, v215
s_barrier
ds_read_b128 v[170:173], v210 offset:36864
s_waitcnt lgkmcnt(0)
v_mfma_f32_16x16x32_bf16 v[36:39], a[144:147], v[170:173], v[36:39]
v_mfma_f32_16x16x32_bf16 v[40:43], a[168:171], v[170:173], v[40:43]
v_mfma_f32_16x16x32_bf16 v[44:47], a[192:195], v[170:173], v[44:47]
ds_read_b128 v[182:185], v210 offset:37888
s_waitcnt lgkmcnt(0)
v_mfma_f32_16x16x32_bf16 v[36:39], a[148:151], v[182:185], v[36:39]
v_mfma_f32_16x16x32_bf16 v[40:43], a[172:175], v[182:185], v[40:43]
v_mfma_f32_16x16x32_bf16 v[44:47], a[196:199], v[182:185], v[44:47]
ds_read_b128 v[186:189], v210 offset:38912
s_waitcnt lgkmcnt(0)
v_mfma_f32_16x16x32_bf16 v[36:39], a[152:155], v[186:189], v[36:39]
v_mfma_f32_16x16x32_bf16 v[40:43], a[176:179], v[186:189], v[40:43]
v_mfma_f32_16x16x32_bf16 v[44:47], a[200:203], v[186:189], v[44:47]
ds_read_b128 v[170:173], v210 offset:39936
s_waitcnt lgkmcnt(0)
v_mfma_f32_16x16x32_bf16 v[36:39], a[156:159], v[170:173], v[36:39]
v_mfma_f32_16x16x32_bf16 v[40:43], a[180:183], v[170:173], v[40:43]
v_mfma_f32_16x16x32_bf16 v[44:47], a[204:207], v[170:173], v[44:47]
ds_read_b128 v[182:185], v210 offset:40960
s_waitcnt lgkmcnt(0)
v_mfma_f32_16x16x32_bf16 v[36:39], a[160:163], v[182:185], v[36:39]
v_mfma_f32_16x16x32_bf16 v[40:43], a[184:187], v[182:185], v[40:43]
v_mfma_f32_16x16x32_bf16 v[44:47], a[208:211], v[182:185], v[44:47]
ds_read_b128 v[186:189], v210 offset:41984
s_waitcnt lgkmcnt(0)
v_mfma_f32_16x16x32_bf16 v[36:39], a[164:167], v[186:189], v[36:39]
v_mfma_f32_16x16x32_bf16 v[40:43], a[188:191], v[186:189], v[40:43]
v_mfma_f32_16x16x32_bf16 v[44:47], a[212:215], v[186:189], v[44:47]
v_cvt_pk_bf16_f32 v72, v36, v37
v_cvt_pk_bf16_f32 v73, v38, v39
buffer_store_dwordx2 v[72:73], v203, s[8:11], s39 offen
v_cvt_pk_bf16_f32 v74, v40, v41
v_cvt_pk_bf16_f32 v75, v42, v43
buffer_store_dwordx2 v[74:75], v203, s[8:11], s39 offen offset:32
s_nop 0
v_cvt_pk_bf16_f32 v76, v44, v45
v_cvt_pk_bf16_f32 v77, v46, v47
buffer_store_dwordx2 v[76:77], v203, s[8:11], s39 offen offset:64
v_max3_f32 v151, v138, v139, v140
v_max3_f32 v151, v151, v141, v142
v_max3_f32 v151, v151, v143, v144
v_max3_f32 v151, v151, v145, v146
v_max3_f32 v151, v151, v147, v148
v_max3_f32 v151, v151, v149, v150
v_mov_b32 v152, v151
s_nop 1
v_permlane16_swap_b32 v151, v152
v_max_f32 v151, v151, v152
v_mov_b32 v152, v151
s_nop 1
v_permlane32_swap_b32 v151, v152
v_max_f32 v151, v151, v152
v_sub_f32 v138, v138, v151
v_sub_f32 v139, v139, v151
v_sub_f32 v140, v140, v151
v_sub_f32 v141, v141, v151
v_sub_f32 v142, v142, v151
v_sub_f32 v143, v143, v151
v_sub_f32 v144, v144, v151
v_sub_f32 v145, v145, v151
v_sub_f32 v150, v150, v151
v_sub_f32 v146, v146, v151
v_sub_f32 v147, v147, v151
v_sub_f32 v148, v148, v151
v_sub_f32 v149, v149, v151
v_exp_f32 v138, v138
v_exp_f32 v139, v139
v_exp_f32 v140, v140
v_exp_f32 v141, v141
v_exp_f32 v142, v142
v_exp_f32 v143, v143
v_exp_f32 v144, v144
v_exp_f32 v145, v145
v_exp_f32 v150, v150
v_exp_f32 v146, v146
v_exp_f32 v147, v147
v_exp_f32 v148, v148
v_exp_f32 v149, v149
v_cvt_pk_bf16_f32 v174, v138, v139
v_cvt_pk_bf16_f32 v175, v140, v141
v_cvt_pk_bf16_f32 v176, v142, v143
v_cvt_pk_bf16_f32 v177, v144, v145
v_cvt_pk_bf16_f32 v178, v146, v147
v_cvt_pk_bf16_f32 v179, v148, v149
v_cvt_pk_bf16_f32 v180, v150, 0
v_mfma_f32_16x16x32_bf16 v[150:153], v[190:193], v[174:177], 0
v_mfma_f32_16x16x32_bf16 v[138:141], v[114:117], v[174:177], 0
v_mfma_f32_16x16x32_bf16 v[142:145], v[122:125], v[174:177], 0
v_mfma_f32_16x16x32_bf16 v[146:149], v[130:133], v[174:177], 0
v_mfma_f32_16x16x32_bf16 v[150:153], v[190:193], v[178:181], v[150:153]
v_mfma_f32_16x16x32_bf16 v[138:141], v[118:121], v[178:181], v[138:141]
v_mfma_f32_16x16x32_bf16 v[142:145], v[126:129], v[178:181], v[142:145]
v_mfma_f32_16x16x32_bf16 v[146:149], v[134:137], v[178:181], v[146:149]
v_mfma_f32_16x16x32_bf16 v[166:169], v[84:87], v[190:193], 0
v_mfma_f32_16x16x32_bf16 v[154:157], v[84:87], v[114:117], 0
v_mfma_f32_16x16x32_bf16 v[158:161], v[84:87], v[122:125], 0
v_mfma_f32_16x16x32_bf16 v[162:165], v[84:87], v[130:133], 0
v_mfma_f32_16x16x32_bf16 v[166:169], v[88:91], v[190:193], v[166:169]
v_mfma_f32_16x16x32_bf16 v[154:157], v[88:91], v[118:121], v[154:157]
v_mfma_f32_16x16x32_bf16 v[158:161], v[88:91], v[126:129], v[158:161]
v_mfma_f32_16x16x32_bf16 v[162:165], v[88:91], v[134:137], v[162:165]
v_rcp_f32 v167, v166
s_nop 1
v_mov_b32_dpp v154, v158 quad_perm:[0,1,2,3] row_mask:0x2 bank_mask:0xf
s_nop 2
v_mov_b32_dpp v154, v162 quad_perm:[0,1,2,3] row_mask:0x4 bank_mask:0xf
v_mul_f32 v167, s3, v167
v_mul_f32 v154, v154, v167
v_cvt_pk_bf16_f32 v154, v154, 0
ds_write_b16 v214, v154
v_add_u32 v214, 1408, v214
ds_read_b128 v[170:173], v210 offset:43008
s_waitcnt lgkmcnt(0)
v_mfma_f32_16x16x32_bf16 v[48:51], a[144:147], v[170:173], v[48:51]
v_mfma_f32_16x16x32_bf16 v[52:55], a[168:171], v[170:173], v[52:55]
v_mfma_f32_16x16x32_bf16 v[56:59], a[192:195], v[170:173], v[56:59]
ds_read_b128 v[182:185], v210 offset:44032
s_waitcnt lgkmcnt(0)
v_mfma_f32_16x16x32_bf16 v[48:51], a[148:151], v[182:185], v[48:51]
v_mfma_f32_16x16x32_bf16 v[52:55], a[172:175], v[182:185], v[52:55]
v_mfma_f32_16x16x32_bf16 v[56:59], a[196:199], v[182:185], v[56:59]
ds_read_b128 v[186:189], v210 offset:45056
s_waitcnt lgkmcnt(0)
v_mfma_f32_16x16x32_bf16 v[48:51], a[152:155], v[186:189], v[48:51]
v_mfma_f32_16x16x32_bf16 v[52:55], a[176:179], v[186:189], v[52:55]
v_mfma_f32_16x16x32_bf16 v[56:59], a[200:203], v[186:189], v[56:59]
ds_read_b128 v[170:173], v210 offset:46080
s_waitcnt lgkmcnt(0)
v_mfma_f32_16x16x32_bf16 v[48:51], a[156:159], v[170:173], v[48:51]
v_mfma_f32_16x16x32_bf16 v[52:55], a[180:183], v[170:173], v[52:55]
v_mfma_f32_16x16x32_bf16 v[56:59], a[204:207], v[170:173], v[56:59]
ds_read_b128 v[182:185], v210 offset:47104
s_waitcnt lgkmcnt(0)
v_mfma_f32_16x16x32_bf16 v[48:51], a[160:163], v[182:185], v[48:51]
v_mfma_f32_16x16x32_bf16 v[52:55], a[184:187], v[182:185], v[52:55]
v_mfma_f32_16x16x32_bf16 v[56:59], a[208:211], v[182:185], v[56:59]
ds_read_b128 v[186:189], v210 offset:48128
s_waitcnt lgkmcnt(0)
v_mfma_f32_16x16x32_bf16 v[48:51], a[164:167], v[186:189], v[48:51]
v_mfma_f32_16x16x32_bf16 v[52:55], a[188:191], v[186:189], v[52:55]
v_mfma_f32_16x16x32_bf16 v[56:59], a[212:215], v[186:189], v[56:59]
v_cvt_pk_bf16_f32 v78, v48, v49
v_cvt_pk_bf16_f32 v79, v50, v51
buffer_store_dwordx2 v[78:79], v204, s[8:11], s39 offen
v_cvt_pk_bf16_f32 v80, v52, v53
v_cvt_pk_bf16_f32 v81, v54, v55
buffer_store_dwordx2 v[80:81], v204, s[8:11], s39 offen offset:32
s_nop 0
v_cvt_pk_bf16_f32 v82, v56, v57
v_cvt_pk_bf16_f32 v83, v58, v59
buffer_store_dwordx2 v[82:83], v204, s[8:11], s39 offen offset:64
v_rcp_f32 v151, v150
s_nop 0
v_mul_f32 v151, s3, v151
v_mul_f32 v138, v138, v151
v_mul_f32 v139, v139, v151
v_cvt_pk_bf16_f32 v138, v138, v139
v_mul_f32 v140, v140, v151
v_mul_f32 v141, v141, v151
v_cvt_pk_bf16_f32 v139, v140, v141
v_mul_f32 v142, v142, v151
v_mul_f32 v143, v143, v151
v_cvt_pk_bf16_f32 v140, v142, v143
v_mul_f32 v144, v144, v151
v_mul_f32 v145, v145, v151
v_cvt_pk_bf16_f32 v141, v144, v145
ds_write_b128 v211, v[138:141] offset:49152
v_mul_f32 v146, v146, v151
v_mul_f32 v147, v147, v151
v_cvt_pk_bf16_f32 v142, v146, v147
v_mul_f32 v148, v148, v151
v_mul_f32 v149, v149, v151
v_cvt_pk_bf16_f32 v143, v148, v149
ds_write_b64 v212, v[142:143] offset:49152
s_waitcnt lgkmcnt(0)
s_barrier
ds_read_b128 v[170:173], v210 offset:49152
s_waitcnt lgkmcnt(0)
v_mfma_f32_16x16x32_bf16 v[60:63], a[144:147], v[170:173], v[60:63]
v_mfma_f32_16x16x32_bf16 v[64:67], a[168:171], v[170:173], v[64:67]
v_mfma_f32_16x16x32_bf16 v[68:71], a[192:195], v[170:173], v[68:71]
ds_read_b128 v[182:185], v210 offset:50176
s_waitcnt lgkmcnt(0)
v_mfma_f32_16x16x32_bf16 v[60:63], a[148:151], v[182:185], v[60:63]
v_mfma_f32_16x16x32_bf16 v[64:67], a[172:175], v[182:185], v[64:67]
v_mfma_f32_16x16x32_bf16 v[68:71], a[196:199], v[182:185], v[68:71]
ds_read_b128 v[186:189], v210 offset:51200
s_waitcnt lgkmcnt(0)
v_mfma_f32_16x16x32_bf16 v[60:63], a[152:155], v[186:189], v[60:63]
v_mfma_f32_16x16x32_bf16 v[64:67], a[176:179], v[186:189], v[64:67]
v_mfma_f32_16x16x32_bf16 v[68:71], a[200:203], v[186:189], v[68:71]
ds_read_b128 v[170:173], v210 offset:52224
s_waitcnt lgkmcnt(0)
v_mfma_f32_16x16x32_bf16 v[60:63], a[156:159], v[170:173], v[60:63]
v_mfma_f32_16x16x32_bf16 v[64:67], a[180:183], v[170:173], v[64:67]
v_mfma_f32_16x16x32_bf16 v[68:71], a[204:207], v[170:173], v[68:71]
ds_read_b128 v[182:185], v210 offset:53248
s_waitcnt lgkmcnt(0)
v_mfma_f32_16x16x32_bf16 v[60:63], a[160:163], v[182:185], v[60:63]
v_mfma_f32_16x16x32_bf16 v[64:67], a[184:187], v[182:185], v[64:67]
v_mfma_f32_16x16x32_bf16 v[68:71], a[208:211], v[182:185], v[68:71]
ds_read_b128 v[186:189], v210 offset:54272
s_waitcnt lgkmcnt(0)
v_mfma_f32_16x16x32_bf16 v[60:63], a[164:167], v[186:189], v[60:63]
v_mfma_f32_16x16x32_bf16 v[64:67], a[188:191], v[186:189], v[64:67]
v_mfma_f32_16x16x32_bf16 v[68:71], a[212:215], v[186:189], v[68:71]
v_cvt_pk_bf16_f32 v116, v60, v61
v_cvt_pk_bf16_f32 v117, v62, v63
buffer_store_dwordx2 v[116:117], v205, s[8:11], s39 offen
v_cvt_pk_bf16_f32 v124, v64, v65
v_cvt_pk_bf16_f32 v125, v66, v67
buffer_store_dwordx2 v[124:125], v205, s[8:11], s39 offen offset:32
s_nop 0
v_cvt_pk_bf16_f32 v132, v68, v69
v_cvt_pk_bf16_f32 v133, v70, v71
buffer_store_dwordx2 v[132:133], v205, s[8:11], s39 offen offset:64
s_mov_b32 s38, s36
s_barrier
ds_read_b128 v[182:185], v210
s_waitcnt lgkmcnt(0)
v_mfma_f32_16x16x32_bf16 v[138:141], a[0:3], v[182:185], 0
v_mfma_f32_16x16x32_bf16 v[142:145], a[24:27], v[182:185], 0
v_mfma_f32_16x16x32_bf16 v[146:149], a[48:51], v[182:185], 0
v_mfma_f32_16x16x32_bf16 v[150:153], a[216:219], v[182:185], 0
v_mfma_f32_16x16x32_bf16 v[154:157], a[240:243], v[182:185], 0
v_mfma_f32_16x16x32_bf16 v[158:161], v[232:235], v[182:185], 0
v_mfma_f32_16x16x32_bf16 v[162:165], v[182:185], a[72:75], 0
v_mfma_f32_16x16x32_bf16 v[166:169], v[182:185], a[96:99], 0
v_mfma_f32_16x16x32_bf16 v[170:173], v[182:185], a[120:123], 0
ds_read_b128 v[186:189], v210 offset:1024
s_waitcnt lgkmcnt(0)
v_mfma_f32_16x16x32_bf16 v[138:141], a[4:7], v[186:189], v[138:141]
v_mfma_f32_16x16x32_bf16 v[142:145], a[28:31], v[186:189], v[142:145]
v_mfma_f32_16x16x32_bf16 v[146:149], a[52:55], v[186:189], v[146:149]
v_mfma_f32_16x16x32_bf16 v[150:153], a[220:223], v[186:189], v[150:153]
v_mfma_f32_16x16x32_bf16 v[154:157], a[244:247], v[186:189], v[154:157]
v_mfma_f32_16x16x32_bf16 v[158:161], v[236:239], v[186:189], v[158:161]
v_mfma_f32_16x16x32_bf16 v[162:165], v[186:189], a[76:79], v[162:165]
v_mfma_f32_16x16x32_bf16 v[166:169], v[186:189], a[100:103], v[166:169]
v_mfma_f32_16x16x32_bf16 v[170:173], v[186:189], a[124:127], v[170:173]
ds_read_b128 v[182:185], v210 offset:2048
s_waitcnt lgkmcnt(0)
v_mfma_f32_16x16x32_bf16 v[138:141], a[8:11], v[182:185], v[138:141]
v_mfma_f32_16x16x32_bf16 v[142:145], a[32:35], v[182:185], v[142:145]
v_mfma_f32_16x16x32_bf16 v[146:149], a[56:59], v[182:185], v[146:149]
v_mfma_f32_16x16x32_bf16 v[150:153], a[224:227], v[182:185], v[150:153]
v_mfma_f32_16x16x32_bf16 v[154:157], a[248:251], v[182:185], v[154:157]
v_mfma_f32_16x16x32_bf16 v[158:161], v[240:243], v[182:185], v[158:161]
v_mfma_f32_16x16x32_bf16 v[162:165], v[182:185], a[80:83], v[162:165]
v_mfma_f32_16x16x32_bf16 v[166:169], v[182:185], a[104:107], v[166:169]
v_mfma_f32_16x16x32_bf16 v[170:173], v[182:185], a[128:131], v[170:173]
ds_read_b128 v[186:189], v210 offset:3072
s_waitcnt lgkmcnt(0)
v_mfma_f32_16x16x32_bf16 v[138:141], a[12:15], v[186:189], v[138:141]
v_mfma_f32_16x16x32_bf16 v[142:145], a[36:39], v[186:189], v[142:145]
v_mfma_f32_16x16x32_bf16 v[146:149], a[60:63], v[186:189], v[146:149]
v_mfma_f32_16x16x32_bf16 v[150:153], a[228:231], v[186:189], v[150:153]
v_mfma_f32_16x16x32_bf16 v[154:157], a[252:255], v[186:189], v[154:157]
v_mfma_f32_16x16x32_bf16 v[158:161], v[244:247], v[186:189], v[158:161]
v_mfma_f32_16x16x32_bf16 v[162:165], v[186:189], a[84:87], v[162:165]
v_mfma_f32_16x16x32_bf16 v[166:169], v[186:189], a[108:111], v[166:169]
v_mfma_f32_16x16x32_bf16 v[170:173], v[186:189], a[132:135], v[170:173]
ds_read_b128 v[182:185], v210 offset:4096
s_waitcnt lgkmcnt(0)
v_mfma_f32_16x16x32_bf16 v[138:141], a[16:19], v[182:185], v[138:141]
v_mfma_f32_16x16x32_bf16 v[142:145], a[40:43], v[182:185], v[142:145]
v_mfma_f32_16x16x32_bf16 v[146:149], a[64:67], v[182:185], v[146:149]
v_mfma_f32_16x16x32_bf16 v[150:153], a[232:235], v[182:185], v[150:153]
v_mfma_f32_16x16x32_bf16 v[154:157], v[224:227], v[182:185], v[154:157]
v_mfma_f32_16x16x32_bf16 v[158:161], v[248:251], v[182:185], v[158:161]
v_mfma_f32_16x16x32_bf16 v[162:165], v[182:185], a[88:91], v[162:165]
v_mfma_f32_16x16x32_bf16 v[166:169], v[182:185], a[112:115], v[166:169]
v_mfma_f32_16x16x32_bf16 v[170:173], v[182:185], a[136:139], v[170:173]
ds_read_b128 v[186:189], v210 offset:5120
s_waitcnt lgkmcnt(0)
v_mfma_f32_16x16x32_bf16 v[138:141], a[20:23], v[186:189], v[138:141]
v_mfma_f32_16x16x32_bf16 v[142:145], a[44:47], v[186:189], v[142:145]
v_mfma_f32_16x16x32_bf16 v[146:149], a[68:71], v[186:189], v[146:149]
v_mfma_f32_16x16x32_bf16 v[150:153], a[236:239], v[186:189], v[150:153]
v_mfma_f32_16x16x32_bf16 v[154:157], v[228:231], v[186:189], v[154:157]
v_mfma_f32_16x16x32_bf16 v[158:161], v[252:255], v[186:189], v[158:161]
v_mfma_f32_16x16x32_bf16 v[162:165], v[186:189], a[92:95], v[162:165]
v_mfma_f32_16x16x32_bf16 v[166:169], v[186:189], a[116:119], v[166:169]
v_mfma_f32_16x16x32_bf16 v[170:173], v[186:189], a[140:143], v[170:173]
v_cvt_pk_bf16_f32 v78, v138, v139
v_cvt_pk_bf16_f32 v79, v140, v141
v_cvt_pk_bf16_f32 v80, v142, v143
v_cvt_pk_bf16_f32 v81, v144, v145
v_cvt_pk_bf16_f32 v82, v146, v147
v_cvt_pk_bf16_f32 v83, v148, v149
v_cvt_pk_bf16_f32 v72, v150, v151
v_cvt_pk_bf16_f32 v73, v152, v153
v_cvt_pk_bf16_f32 v74, v154, v155
v_cvt_pk_bf16_f32 v75, v156, v157
v_cvt_pk_bf16_f32 v76, v158, v159
v_cvt_pk_bf16_f32 v77, v160, v161
v_cvt_pk_bf16_f32 v114, v162, v163
v_cvt_pk_bf16_f32 v115, v164, v165
v_cvt_pk_bf16_f32 v122, v166, v167
v_cvt_pk_bf16_f32 v123, v168, v169
v_cvt_pk_bf16_f32 v130, v170, v171
v_cvt_pk_bf16_f32 v131, v172, v173
ds_read_b128 v[182:185], v210 offset:6144
s_waitcnt lgkmcnt(0)
v_mfma_f32_16x16x32_bf16 v[138:141], a[0:3], v[182:185], 0
v_mfma_f32_16x16x32_bf16 v[142:145], a[24:27], v[182:185], 0
v_mfma_f32_16x16x32_bf16 v[146:149], a[48:51], v[182:185], 0
v_mfma_f32_16x16x32_bf16 v[150:153], a[216:219], v[182:185], 0
v_mfma_f32_16x16x32_bf16 v[154:157], a[240:243], v[182:185], 0
v_mfma_f32_16x16x32_bf16 v[158:161], v[232:235], v[182:185], 0
v_mfma_f32_16x16x32_bf16 v[162:165], v[182:185], a[72:75], 0
v_mfma_f32_16x16x32_bf16 v[166:169], v[182:185], a[96:99], 0
v_mfma_f32_16x16x32_bf16 v[170:173], v[182:185], a[120:123], 0
ds_read_b128 v[186:189], v210 offset:7168
s_waitcnt lgkmcnt(0)
v_mfma_f32_16x16x32_bf16 v[138:141], a[4:7], v[186:189], v[138:141]
v_mfma_f32_16x16x32_bf16 v[142:145], a[28:31], v[186:189], v[142:145]
v_mfma_f32_16x16x32_bf16 v[146:149], a[52:55], v[186:189], v[146:149]
v_mfma_f32_16x16x32_bf16 v[150:153], a[220:223], v[186:189], v[150:153]
v_mfma_f32_16x16x32_bf16 v[154:157], a[244:247], v[186:189], v[154:157]
v_mfma_f32_16x16x32_bf16 v[158:161], v[236:239], v[186:189], v[158:161]
v_mfma_f32_16x16x32_bf16 v[162:165], v[186:189], a[76:79], v[162:165]
v_mfma_f32_16x16x32_bf16 v[166:169], v[186:189], a[100:103], v[166:169]
v_mfma_f32_16x16x32_bf16 v[170:173], v[186:189], a[124:127], v[170:173]
ds_read_b128 v[182:185], v210 offset:8192
s_waitcnt lgkmcnt(0)
v_mfma_f32_16x16x32_bf16 v[138:141], a[8:11], v[182:185], v[138:141]
v_mfma_f32_16x16x32_bf16 v[142:145], a[32:35], v[182:185], v[142:145]
v_mfma_f32_16x16x32_bf16 v[146:149], a[56:59], v[182:185], v[146:149]
v_mfma_f32_16x16x32_bf16 v[150:153], a[224:227], v[182:185], v[150:153]
v_mfma_f32_16x16x32_bf16 v[154:157], a[248:251], v[182:185], v[154:157]
v_mfma_f32_16x16x32_bf16 v[158:161], v[240:243], v[182:185], v[158:161]
v_mfma_f32_16x16x32_bf16 v[162:165], v[182:185], a[80:83], v[162:165]
v_mfma_f32_16x16x32_bf16 v[166:169], v[182:185], a[104:107], v[166:169]
v_mfma_f32_16x16x32_bf16 v[170:173], v[182:185], a[128:131], v[170:173]
ds_read_b128 v[186:189], v210 offset:9216
s_waitcnt lgkmcnt(0)
v_mfma_f32_16x16x32_bf16 v[138:141], a[12:15], v[186:189], v[138:141]
v_mfma_f32_16x16x32_bf16 v[142:145], a[36:39], v[186:189], v[142:145]
v_mfma_f32_16x16x32_bf16 v[146:149], a[60:63], v[186:189], v[146:149]
v_mfma_f32_16x16x32_bf16 v[150:153], a[228:231], v[186:189], v[150:153]
v_mfma_f32_16x16x32_bf16 v[154:157], a[252:255], v[186:189], v[154:157]
v_mfma_f32_16x16x32_bf16 v[158:161], v[244:247], v[186:189], v[158:161]
v_mfma_f32_16x16x32_bf16 v[162:165], v[186:189], a[84:87], v[162:165]
v_mfma_f32_16x16x32_bf16 v[166:169], v[186:189], a[108:111], v[166:169]
v_mfma_f32_16x16x32_bf16 v[170:173], v[186:189], a[132:135], v[170:173]
ds_read_b128 v[182:185], v210 offset:10240
s_waitcnt lgkmcnt(0)
v_mfma_f32_16x16x32_bf16 v[138:141], a[16:19], v[182:185], v[138:141]
v_mfma_f32_16x16x32_bf16 v[142:145], a[40:43], v[182:185], v[142:145]
v_mfma_f32_16x16x32_bf16 v[146:149], a[64:67], v[182:185], v[146:149]
v_mfma_f32_16x16x32_bf16 v[150:153], a[232:235], v[182:185], v[150:153]
v_mfma_f32_16x16x32_bf16 v[154:157], v[224:227], v[182:185], v[154:157]
v_mfma_f32_16x16x32_bf16 v[158:161], v[248:251], v[182:185], v[158:161]
v_mfma_f32_16x16x32_bf16 v[162:165], v[182:185], a[88:91], v[162:165]
v_mfma_f32_16x16x32_bf16 v[166:169], v[182:185], a[112:115], v[166:169]
v_mfma_f32_16x16x32_bf16 v[170:173], v[182:185], a[136:139], v[170:173]
ds_read_b128 v[186:189], v210 offset:11264
s_waitcnt lgkmcnt(0)
v_mfma_f32_16x16x32_bf16 v[138:141], a[20:23], v[186:189], v[138:141]
v_mfma_f32_16x16x32_bf16 v[142:145], a[44:47], v[186:189], v[142:145]
v_mfma_f32_16x16x32_bf16 v[146:149], a[68:71], v[186:189], v[146:149]
v_mfma_f32_16x16x32_bf16 v[150:153], a[236:239], v[186:189], v[150:153]
v_mfma_f32_16x16x32_bf16 v[154:157], v[228:231], v[186:189], v[154:157]
v_mfma_f32_16x16x32_bf16 v[158:161], v[252:255], v[186:189], v[158:161]
v_mfma_f32_16x16x32_bf16 v[162:165], v[186:189], a[92:95], v[162:165]
v_mfma_f32_16x16x32_bf16 v[166:169], v[186:189], a[116:119], v[166:169]
v_mfma_f32_16x16x32_bf16 v[170:173], v[186:189], a[140:143], v[170:173]
v_cvt_pk_bf16_f32 v96, v138, v139
v_cvt_pk_bf16_f32 v97, v140, v141
v_cvt_pk_bf16_f32 v98, v142, v143
v_cvt_pk_bf16_f32 v99, v144, v145
v_cvt_pk_bf16_f32 v100, v146, v147
v_cvt_pk_bf16_f32 v101, v148, v149
v_cvt_pk_bf16_f32 v84, v150, v151
v_cvt_pk_bf16_f32 v85, v152, v153
v_cvt_pk_bf16_f32 v86, v154, v155
v_cvt_pk_bf16_f32 v87, v156, v157
v_cvt_pk_bf16_f32 v88, v158, v159
v_cvt_pk_bf16_f32 v89, v160, v161
v_cvt_pk_bf16_f32 v116, v162, v163
v_cvt_pk_bf16_f32 v117, v164, v165
v_cvt_pk_bf16_f32 v124, v166, v167
v_cvt_pk_bf16_f32 v125, v168, v169
v_cvt_pk_bf16_f32 v132, v170, v171
v_cvt_pk_bf16_f32 v133, v172, v173
ds_read_b128 v[182:185], v210 offset:12288
s_waitcnt lgkmcnt(0)
v_mfma_f32_16x16x32_bf16 v[138:141], a[0:3], v[182:185], 0
v_mfma_f32_16x16x32_bf16 v[142:145], a[24:27], v[182:185], 0
v_mfma_f32_16x16x32_bf16 v[146:149], a[48:51], v[182:185], 0
ds_read_b128 v[186:189], v210 offset:13312
s_waitcnt lgkmcnt(0)
v_mfma_f32_16x16x32_bf16 v[138:141], a[4:7], v[186:189], v[138:141]
v_mfma_f32_16x16x32_bf16 v[142:145], a[28:31], v[186:189], v[142:145]
v_mfma_f32_16x16x32_bf16 v[146:149], a[52:55], v[186:189], v[146:149]
ds_read_b128 v[182:185], v210 offset:14336
s_waitcnt lgkmcnt(0)
v_mfma_f32_16x16x32_bf16 v[138:141], a[8:11], v[182:185], v[138:141]
v_mfma_f32_16x16x32_bf16 v[142:145], a[32:35], v[182:185], v[142:145]
v_mfma_f32_16x16x32_bf16 v[146:149], a[56:59], v[182:185], v[146:149]
ds_read_b128 v[186:189], v210 offset:15360
s_waitcnt lgkmcnt(0)
v_mfma_f32_16x16x32_bf16 v[138:141], a[12:15], v[186:189], v[138:141]
v_mfma_f32_16x16x32_bf16 v[142:145], a[36:39], v[186:189], v[142:145]
v_mfma_f32_16x16x32_bf16 v[146:149], a[60:63], v[186:189], v[146:149]
ds_read_b128 v[182:185], v210 offset:16384
s_waitcnt lgkmcnt(0)
v_mfma_f32_16x16x32_bf16 v[138:141], a[16:19], v[182:185], v[138:141]
v_mfma_f32_16x16x32_bf16 v[142:145], a[40:43], v[182:185], v[142:145]
v_mfma_f32_16x16x32_bf16 v[146:149], a[64:67], v[182:185], v[146:149]
ds_read_b128 v[186:189], v210 offset:17408
s_waitcnt lgkmcnt(0)
v_mfma_f32_16x16x32_bf16 v[138:141], a[20:23], v[186:189], v[138:141]
v_mfma_f32_16x16x32_bf16 v[142:145], a[44:47], v[186:189], v[142:145]
v_mfma_f32_16x16x32_bf16 v[146:149], a[68:71], v[186:189], v[146:149]
v_cvt_pk_bf16_f32 v102, v138, v139
v_cvt_pk_bf16_f32 v103, v140, v141
s_nop 0
v_cvt_pk_bf16_f32 v104, v142, v143
v_cvt_pk_bf16_f32 v105, v144, v145
s_nop 1
v_cvt_pk_bf16_f32 v106, v146, v147
v_cvt_pk_bf16_f32 v107, v148, v149
ds_read_b128 v[108:111], v215 offset:512
ds_read_b64 v[112:113], v215 offset:528
v_mov_b32 v181, 0
v_mfma_f32_16x16x32_bf16 v[138:141], v[78:81], v[72:75], 0
v_mfma_f32_16x16x32_bf16 v[142:145], v[96:99], v[72:75], 0
s_waitcnt lgkmcnt(1)
v_mfma_f32_16x16x32_bf16 v[150:153], v[108:111], v[72:75], v[206:209]
v_mfma_f32_16x16x32_bf16 v[146:149], v[102:105], v[72:75], 0
v_mfma_f32_16x16x16_bf16 v[138:141], v[82:83], v[76:77], v[138:141]
v_mfma_f32_16x16x16_bf16 v[142:145], v[100:101], v[76:77], v[142:145]
s_waitcnt lgkmcnt(0)
v_mfma_f32_16x16x16_bf16 v[150:153], v[112:113], v[76:77], v[150:153]
v_mfma_f32_16x16x16_bf16 v[146:149], v[106:107], v[76:77], v[146:149]
ds_read_b128 v[72:75], v215
ds_read_b64 v[76:77], v215 offset:16
v_mfma_f32_16x16x32_bf16 v[154:157], v[78:81], v[84:87], 0
v_mfma_f32_16x16x32_bf16 v[158:161], v[96:99], v[84:87], 0
v_mfma_f32_16x16x32_bf16 v[166:169], v[108:111], v[84:87], v[206:209]
v_mfma_f32_16x16x32_bf16 v[162:165], v[102:105], v[84:87], 0
v_mfma_f32_16x16x16_bf16 v[154:157], v[82:83], v[88:89], v[154:157]
v_mfma_f32_16x16x16_bf16 v[158:161], v[100:101], v[88:89], v[158:161]
v_mfma_f32_16x16x16_bf16 v[166:169], v[112:113], v[88:89], v[166:169]
v_mfma_f32_16x16x16_bf16 v[162:165], v[106:107], v[88:89], v[162:165]
ds_read_b128 v[182:185], v210 offset:12288
s_waitcnt lgkmcnt(0)
v_mfma_f32_16x16x32_bf16 v[118:121], v[182:185], a[72:75], 0
v_mfma_f32_16x16x32_bf16 v[126:129], v[182:185], a[96:99], 0
v_mfma_f32_16x16x32_bf16 v[134:137], v[182:185], a[120:123], 0
v_mfma_f32_16x16x32_bf16 v[90:93], a[216:219], v[182:185], 0
v_mfma_f32_16x16x32_bf16 v[170:173], a[240:243], v[182:185], 0
v_mfma_f32_16x16x32_bf16 v[220:223], v[232:235], v[182:185], 0
ds_read_b128 v[186:189], v210 offset:13312
s_waitcnt lgkmcnt(0)
v_mfma_f32_16x16x32_bf16 v[118:121], v[186:189], a[76:79], v[118:121]
v_mfma_f32_16x16x32_bf16 v[126:129], v[186:189], a[100:103], v[126:129]
v_mfma_f32_16x16x32_bf16 v[134:137], v[186:189], a[124:127], v[134:137]
v_mfma_f32_16x16x32_bf16 v[90:93], a[220:223], v[186:189], v[90:93]
v_mfma_f32_16x16x32_bf16 v[170:173], a[244:247], v[186:189], v[170:173]
v_mfma_f32_16x16x32_bf16 v[220:223], v[236:239], v[186:189], v[220:223]
ds_read_b128 v[182:185], v210 offset:14336
s_waitcnt lgkmcnt(0)
v_mfma_f32_16x16x32_bf16 v[118:121], v[182:185], a[80:83], v[118:121]
v_mfma_f32_16x16x32_bf16 v[126:129], v[182:185], a[104:107], v[126:129]
v_mfma_f32_16x16x32_bf16 v[134:137], v[182:185], a[128:131], v[134:137]
v_mfma_f32_16x16x32_bf16 v[90:93], a[224:227], v[182:185], v[90:93]
v_mfma_f32_16x16x32_bf16 v[170:173], a[248:251], v[182:185], v[170:173]
v_mfma_f32_16x16x32_bf16 v[220:223], v[240:243], v[182:185], v[220:223]
ds_read_b128 v[186:189], v210 offset:15360
s_waitcnt lgkmcnt(0)
v_mfma_f32_16x16x32_bf16 v[118:121], v[186:189], a[84:87], v[118:121]
v_mfma_f32_16x16x32_bf16 v[126:129], v[186:189], a[108:111], v[126:129]
v_mfma_f32_16x16x32_bf16 v[134:137], v[186:189], a[132:135], v[134:137]
v_mfma_f32_16x16x32_bf16 v[90:93], a[228:231], v[186:189], v[90:93]
v_mfma_f32_16x16x32_bf16 v[170:173], a[252:255], v[186:189], v[170:173]
v_mfma_f32_16x16x32_bf16 v[220:223], v[244:247], v[186:189], v[220:223]
ds_read_b128 v[182:185], v210 offset:16384
s_waitcnt lgkmcnt(0)
v_mfma_f32_16x16x32_bf16 v[118:121], v[182:185], a[88:91], v[118:121]
v_mfma_f32_16x16x32_bf16 v[126:129], v[182:185], a[112:115], v[126:129]
v_mfma_f32_16x16x32_bf16 v[134:137], v[182:185], a[136:139], v[134:137]
v_mfma_f32_16x16x32_bf16 v[90:93], a[232:235], v[182:185], v[90:93]
v_mfma_f32_16x16x32_bf16 v[170:173], v[224:227], v[182:185], v[170:173]
v_mfma_f32_16x16x32_bf16 v[220:223], v[248:251], v[182:185], v[220:223]
ds_read_b128 v[186:189], v210 offset:17408
s_waitcnt lgkmcnt(0)
v_mfma_f32_16x16x32_bf16 v[118:121], v[186:189], a[92:95], v[118:121]
v_mfma_f32_16x16x32_bf16 v[126:129], v[186:189], a[116:119], v[126:129]
v_mfma_f32_16x16x32_bf16 v[134:137], v[186:189], a[140:143], v[134:137]
v_mfma_f32_16x16x32_bf16 v[90:93], a[236:239], v[186:189], v[90:93]
v_mfma_f32_16x16x32_bf16 v[170:173], v[228:231], v[186:189], v[170:173]
v_mfma_f32_16x16x32_bf16 v[220:223], v[252:255], v[186:189], v[220:223]
v_cvt_pk_bf16_f32 v118, v118, v119
v_cvt_pk_bf16_f32 v119, v120, v121
ds_read_u16 v120, v216
v_mov_b32 v121, 0
v_cvt_pk_bf16_f32 v126, v126, v127
v_cvt_pk_bf16_f32 v127, v128, v129
ds_read_u16 v128, v216 offset:32
v_mov_b32 v129, 0
v_cvt_pk_bf16_f32 v134, v134, v135
v_cvt_pk_bf16_f32 v135, v136, v137
ds_read_u16 v136, v216 offset:64
v_mov_b32 v137, 0
v_add_u32 v216, 1408, v216
v_cvt_pk_bf16_f32 v90, v90, v91
v_cvt_pk_bf16_f32 v91, v92, v93
v_cvt_pk_bf16_f32 v92, v170, v171
v_cvt_pk_bf16_f32 v93, v172, v173
v_cvt_pk_bf16_f32 v94, v220, v221
v_cvt_pk_bf16_f32 v95, v222, v223
v_max3_f32 v151, v138, v139, v140
v_max3_f32 v151, v151, v141, v142
v_max3_f32 v151, v151, v143, v144
v_max3_f32 v151, v151, v145, v146
v_max3_f32 v151, v151, v147, v148
v_max3_f32 v151, v151, v149, v150
v_mov_b32 v152, v151
s_nop 1
v_permlane16_swap_b32 v151, v152
v_max_f32 v151, v151, v152
v_mov_b32 v152, v151
s_nop 1
v_permlane32_swap_b32 v151, v152
v_max_f32 v151, v151, v152
v_sub_f32 v138, v138, v151
v_sub_f32 v139, v139, v151
v_sub_f32 v140, v140, v151
v_sub_f32 v141, v141, v151
v_sub_f32 v142, v142, v151
v_sub_f32 v143, v143, v151
v_sub_f32 v144, v144, v151
v_sub_f32 v145, v145, v151
v_sub_f32 v150, v150, v151
v_sub_f32 v146, v146, v151
v_sub_f32 v147, v147, v151
v_sub_f32 v148, v148, v151
v_sub_f32 v149, v149, v151
v_exp_f32 v138, v138
v_exp_f32 v139, v139
v_exp_f32 v140, v140
v_exp_f32 v141, v141
v_exp_f32 v142, v142
v_exp_f32 v143, v143
v_exp_f32 v144, v144
v_exp_f32 v145, v145
v_exp_f32 v150, v150
v_exp_f32 v146, v146
v_exp_f32 v147, v147
v_exp_f32 v148, v148
v_exp_f32 v149, v149
v_cvt_pk_bf16_f32 v174, v138, v139
v_cvt_pk_bf16_f32 v175, v140, v141
v_cvt_pk_bf16_f32 v176, v142, v143
v_cvt_pk_bf16_f32 v177, v144, v145
v_cvt_pk_bf16_f32 v178, v146, v147
v_cvt_pk_bf16_f32 v179, v148, v149
v_cvt_pk_bf16_f32 v180, v150, 0
v_mfma_f32_16x16x32_bf16 v[150:153], v[190:193], v[174:177], 0
v_mfma_f32_16x16x32_bf16 v[138:141], v[114:117], v[174:177], 0
v_mfma_f32_16x16x32_bf16 v[142:145], v[122:125], v[174:177], 0
v_mfma_f32_16x16x32_bf16 v[146:149], v[130:133], v[174:177], 0
v_mfma_f32_16x16x32_bf16 v[150:153], v[190:193], v[178:181], v[150:153]
s_waitcnt lgkmcnt(2)
v_mfma_f32_16x16x32_bf16 v[138:141], v[118:121], v[178:181], v[138:141]
s_waitcnt lgkmcnt(1)
v_mfma_f32_16x16x32_bf16 v[142:145], v[126:129], v[178:181], v[142:145]
s_waitcnt lgkmcnt(0)
v_mfma_f32_16x16x32_bf16 v[146:149], v[134:137], v[178:181], v[146:149]
v_max3_f32 v167, v154, v155, v156
v_max3_f32 v167, v167, v157, v158
v_max3_f32 v167, v167, v159, v160
v_max3_f32 v167, v167, v161, v162
v_max3_f32 v167, v167, v163, v164
v_max3_f32 v167, v167, v165, v166
v_mov_b32 v168, v167
s_nop 1
v_permlane16_swap_b32 v167, v168
v_max_f32 v167, v167, v168
v_mov_b32 v168, v167
s_nop 1
v_permlane32_swap_b32 v167, v168
v_max_f32 v167, v167, v168
v_sub_f32 v154, v154, v167
v_sub_f32 v155, v155, v167
v_sub_f32 v156, v156, v167
v_sub_f32 v157, v157, v167
v_sub_f32 v158, v158, v167
v_sub_f32 v159, v159, v167
v_sub_f32 v160, v160, v167
v_sub_f32 v161, v161, v167
v_sub_f32 v166, v166, v167
v_sub_f32 v162, v162, v167
v_sub_f32 v163, v163, v167
v_sub_f32 v164, v164, v167
v_sub_f32 v165, v165, v167
v_exp_f32 v154, v154
v_exp_f32 v155, v155
v_exp_f32 v156, v156
v_exp_f32 v157, v157
v_exp_f32 v158, v158
v_exp_f32 v159, v159
v_exp_f32 v160, v160
v_exp_f32 v161, v161
v_exp_f32 v166, v166
v_exp_f32 v162, v162
v_exp_f32 v163, v163
v_exp_f32 v164, v164
v_exp_f32 v165, v165
v_cvt_pk_bf16_f32 v174, v154, v155
v_cvt_pk_bf16_f32 v175, v156, v157
v_cvt_pk_bf16_f32 v176, v158, v159
v_cvt_pk_bf16_f32 v177, v160, v161
v_cvt_pk_bf16_f32 v178, v162, v163
v_cvt_pk_bf16_f32 v179, v164, v165
v_cvt_pk_bf16_f32 v180, v166, 0
v_mfma_f32_16x16x32_bf16 v[166:169], v[190:193], v[174:177], 0
v_mfma_f32_16x16x32_bf16 v[154:157], v[114:117], v[174:177], 0
v_mfma_f32_16x16x32_bf16 v[158:161], v[122:125], v[174:177], 0
v_mfma_f32_16x16x32_bf16 v[162:165], v[130:133], v[174:177], 0
v_mfma_f32_16x16x32_bf16 v[166:169], v[190:193], v[178:181], v[166:169]
v_mfma_f32_16x16x32_bf16 v[154:157], v[118:121], v[178:181], v[154:157]
v_mfma_f32_16x16x32_bf16 v[158:161], v[126:129], v[178:181], v[158:161]
v_mfma_f32_16x16x32_bf16 v[162:165], v[134:137], v[178:181], v[162:165]
v_rcp_f32 v151, v150
s_nop 0
v_mul_f32 v151, s3, v151
v_mul_f32 v138, v138, v151
v_mul_f32 v139, v139, v151
v_cvt_pk_bf16_f32 v138, v138, v139
v_mul_f32 v140, v140, v151
v_mul_f32 v141, v141, v151
v_cvt_pk_bf16_f32 v139, v140, v141
v_mul_f32 v142, v142, v151
v_mul_f32 v143, v143, v151
v_cvt_pk_bf16_f32 v140, v142, v143
v_mul_f32 v144, v144, v151
v_mul_f32 v145, v145, v151
v_cvt_pk_bf16_f32 v141, v144, v145
ds_write_b128 v211, v[138:141] offset:36864
v_mul_f32 v146, v146, v151
v_mul_f32 v147, v147, v151
v_cvt_pk_bf16_f32 v142, v146, v147
v_mul_f32 v148, v148, v151
v_mul_f32 v149, v149, v151
v_cvt_pk_bf16_f32 v143, v148, v149
ds_write_b64 v212, v[142:143] offset:36864
v_mfma_f32_16x16x32_bf16 v[138:141], v[78:81], v[90:93], 0
v_mfma_f32_16x16x32_bf16 v[142:145], v[96:99], v[90:93], 0
v_mfma_f32_16x16x32_bf16 v[150:153], v[108:111], v[90:93], v[206:209]
v_mfma_f32_16x16x32_bf16 v[146:149], v[102:105], v[90:93], 0
v_mfma_f32_16x16x16_bf16 v[138:141], v[82:83], v[94:95], v[138:141]
v_mfma_f32_16x16x16_bf16 v[142:145], v[100:101], v[94:95], v[142:145]
v_mfma_f32_16x16x16_bf16 v[150:153], v[112:113], v[94:95], v[150:153]
v_mfma_f32_16x16x16_bf16 v[146:149], v[106:107], v[94:95], v[146:149]
v_rcp_f32 v167, v166
s_nop 0
v_mul_f32 v167, s3, v167
v_mul_f32 v154, v154, v167
v_mul_f32 v155, v155, v167
v_cvt_pk_bf16_f32 v154, v154, v155
v_mul_f32 v156, v156, v167
v_mul_f32 v157, v157, v167
v_cvt_pk_bf16_f32 v155, v156, v157
v_mul_f32 v158, v158, v167
v_mul_f32 v159, v159, v167
v_cvt_pk_bf16_f32 v156, v158, v159
v_mul_f32 v160, v160, v167
v_mul_f32 v161, v161, v167
v_cvt_pk_bf16_f32 v157, v160, v161
ds_write_b128 v211, v[154:157] offset:43008
v_mul_f32 v162, v162, v167
v_mul_f32 v163, v163, v167
v_cvt_pk_bf16_f32 v158, v162, v163
v_mul_f32 v164, v164, v167
v_mul_f32 v165, v165, v167
v_cvt_pk_bf16_f32 v159, v164, v165
ds_write_b64 v212, v[158:159] offset:43008
v_mfma_f32_16x16x32_bf16 v[154:157], v[72:75], v[78:81], 0
v_mfma_f32_16x16x32_bf16 v[158:161], v[72:75], v[96:99], 0
v_mfma_f32_16x16x32_bf16 v[162:165], v[72:75], v[102:105], 0
v_mfma_f32_16x16x32_bf16 v[166:169], v[72:75], v[108:111], v[206:209]
v_mfma_f32_16x16x16_bf16 v[154:157], v[76:77], v[82:83], v[154:157]
v_mfma_f32_16x16x16_bf16 v[158:161], v[76:77], v[100:101], v[158:161]
v_mfma_f32_16x16x16_bf16 v[162:165], v[76:77], v[106:107], v[162:165]
v_mfma_f32_16x16x16_bf16 v[166:169], v[76:77], v[112:113], v[166:169]
v_mov_b32_dpp v154, v158 quad_perm:[0,1,2,3] row_mask:0x2 bank_mask:0xf
s_nop 1
v_mov_b32_dpp v154, v162 quad_perm:[0,1,2,3] row_mask:0x4 bank_mask:0xf
s_nop 2
v_mov_b32_dpp v154, v167 quad_perm:[0,1,2,3] row_mask:0x8 bank_mask:0xf
v_mov_b32 v155, v154
s_nop 1
v_max_f32_dpp v155, v155, v155 row_ror:8 row_mask:0xf bank_mask:0xf
s_nop 1
v_max_f32_dpp v155, v155, v155 row_ror:4 row_mask:0xf bank_mask:0xf
s_nop 1
v_max_f32_dpp v155, v155, v155 row_ror:2 row_mask:0xf bank_mask:0xf
s_nop 1
v_max_f32_dpp v155, v155, v155 row_ror:1 row_mask:0xf bank_mask:0xf
v_mov_b32 v156, v155
s_nop 1
v_permlane16_swap_b32 v155, v156
v_max_f32 v155, v155, v156
v_mov_b32 v156, v155
s_nop 1
v_permlane32_swap_b32 v155, v156
v_max_f32 v155, v155, v156
v_sub_f32 v154, v154, v155
v_exp_f32 v154, v154
s_nop 0
v_cvt_pk_bf16_f32 v154, v154, 0
ds_write_b16 v214, v154
s_waitcnt lgkmcnt(1)
ds_read_b128 v[84:87], v215
ds_read_b128 v[88:91], v215 offset:16
v_add_u32 v215, 1408, v215
s_barrier
ds_read_b128 v[170:173], v210 offset:36864
s_waitcnt lgkmcnt(0)
v_mfma_f32_16x16x32_bf16 v[0:3], a[144:147], v[170:173], v[0:3]
v_mfma_f32_16x16x32_bf16 v[4:7], a[168:171], v[170:173], v[4:7]
v_mfma_f32_16x16x32_bf16 v[8:11], a[192:195], v[170:173], v[8:11]
ds_read_b128 v[182:185], v210 offset:37888
s_waitcnt lgkmcnt(0)
v_mfma_f32_16x16x32_bf16 v[0:3], a[148:151], v[182:185], v[0:3]
v_mfma_f32_16x16x32_bf16 v[4:7], a[172:175], v[182:185], v[4:7]
v_mfma_f32_16x16x32_bf16 v[8:11], a[196:199], v[182:185], v[8:11]
ds_read_b128 v[186:189], v210 offset:38912
s_waitcnt lgkmcnt(0)
v_mfma_f32_16x16x32_bf16 v[0:3], a[152:155], v[186:189], v[0:3]
v_mfma_f32_16x16x32_bf16 v[4:7], a[176:179], v[186:189], v[4:7]
v_mfma_f32_16x16x32_bf16 v[8:11], a[200:203], v[186:189], v[8:11]
ds_read_b128 v[170:173], v210 offset:39936
s_waitcnt lgkmcnt(0)
v_mfma_f32_16x16x32_bf16 v[0:3], a[156:159], v[170:173], v[0:3]
v_mfma_f32_16x16x32_bf16 v[4:7], a[180:183], v[170:173], v[4:7]
v_mfma_f32_16x16x32_bf16 v[8:11], a[204:207], v[170:173], v[8:11]
ds_read_b128 v[182:185], v210 offset:40960
s_waitcnt lgkmcnt(0)
v_mfma_f32_16x16x32_bf16 v[0:3], a[160:163], v[182:185], v[0:3]
v_mfma_f32_16x16x32_bf16 v[4:7], a[184:187], v[182:185], v[4:7]
v_mfma_f32_16x16x32_bf16 v[8:11], a[208:211], v[182:185], v[8:11]
ds_read_b128 v[186:189], v210 offset:41984
s_waitcnt lgkmcnt(0)
v_mfma_f32_16x16x32_bf16 v[0:3], a[164:167], v[186:189], v[0:3]
v_mfma_f32_16x16x32_bf16 v[4:7], a[188:191], v[186:189], v[4:7]
v_mfma_f32_16x16x32_bf16 v[8:11], a[212:215], v[186:189], v[8:11]
v_cvt_pk_bf16_f32 v72, v0, v1
v_cvt_pk_bf16_f32 v73, v2, v3
buffer_store_dwordx2 v[72:73], v203, s[8:11], s38 offen
v_cvt_pk_bf16_f32 v74, v4, v5
v_cvt_pk_bf16_f32 v75, v6, v7
buffer_store_dwordx2 v[74:75], v203, s[8:11], s38 offen offset:32
s_nop 0
v_cvt_pk_bf16_f32 v76, v8, v9
v_cvt_pk_bf16_f32 v77, v10, v11
buffer_store_dwordx2 v[76:77], v203, s[8:11], s38 offen offset:64
v_max3_f32 v151, v138, v139, v140
v_max3_f32 v151, v151, v141, v142
v_max3_f32 v151, v151, v143, v144
v_max3_f32 v151, v151, v145, v146
v_max3_f32 v151, v151, v147, v148
v_max3_f32 v151, v151, v149, v150
v_mov_b32 v152, v151
s_nop 1
v_permlane16_swap_b32 v151, v152
v_max_f32 v151, v151, v152
v_mov_b32 v152, v151
s_nop 1
v_permlane32_swap_b32 v151, v152
v_max_f32 v151, v151, v152
v_sub_f32 v138, v138, v151
v_sub_f32 v139, v139, v151
v_sub_f32 v140, v140, v151
v_sub_f32 v141, v141, v151
v_sub_f32 v142, v142, v151
v_sub_f32 v143, v143, v151
v_sub_f32 v144, v144, v151
v_sub_f32 v145, v145, v151
v_sub_f32 v150, v150, v151
v_sub_f32 v146, v146, v151
v_sub_f32 v147, v147, v151
v_sub_f32 v148, v148, v151
v_sub_f32 v149, v149, v151
v_exp_f32 v138, v138
v_exp_f32 v139, v139
v_exp_f32 v140, v140
v_exp_f32 v141, v141
v_exp_f32 v142, v142
v_exp_f32 v143, v143
v_exp_f32 v144, v144
v_exp_f32 v145, v145
v_exp_f32 v150, v150
v_exp_f32 v146, v146
v_exp_f32 v147, v147
v_exp_f32 v148, v148
v_exp_f32 v149, v149
v_cvt_pk_bf16_f32 v174, v138, v139
v_cvt_pk_bf16_f32 v175, v140, v141
v_cvt_pk_bf16_f32 v176, v142, v143
v_cvt_pk_bf16_f32 v177, v144, v145
v_cvt_pk_bf16_f32 v178, v146, v147
v_cvt_pk_bf16_f32 v179, v148, v149
v_cvt_pk_bf16_f32 v180, v150, 0
v_mfma_f32_16x16x32_bf16 v[150:153], v[190:193], v[174:177], 0
v_mfma_f32_16x16x32_bf16 v[138:141], v[114:117], v[174:177], 0
v_mfma_f32_16x16x32_bf16 v[142:145], v[122:125], v[174:177], 0
v_mfma_f32_16x16x32_bf16 v[146:149], v[130:133], v[174:177], 0
v_mfma_f32_16x16x32_bf16 v[150:153], v[190:193], v[178:181], v[150:153]
v_mfma_f32_16x16x32_bf16 v[138:141], v[118:121], v[178:181], v[138:141]
v_mfma_f32_16x16x32_bf16 v[142:145], v[126:129], v[178:181], v[142:145]
v_mfma_f32_16x16x32_bf16 v[146:149], v[134:137], v[178:181], v[146:149]
v_mfma_f32_16x16x32_bf16 v[166:169], v[84:87], v[190:193], 0
v_mfma_f32_16x16x32_bf16 v[154:157], v[84:87], v[114:117], 0
v_mfma_f32_16x16x32_bf16 v[158:161], v[84:87], v[122:125], 0
v_mfma_f32_16x16x32_bf16 v[162:165], v[84:87], v[130:133], 0
v_mfma_f32_16x16x32_bf16 v[166:169], v[88:91], v[190:193], v[166:169]
v_mfma_f32_16x16x32_bf16 v[154:157], v[88:91], v[118:121], v[154:157]
v_mfma_f32_16x16x32_bf16 v[158:161], v[88:91], v[126:129], v[158:161]
v_mfma_f32_16x16x32_bf16 v[162:165], v[88:91], v[134:137], v[162:165]
v_rcp_f32 v167, v166
s_nop 1
v_mov_b32_dpp v154, v158 quad_perm:[0,1,2,3] row_mask:0x2 bank_mask:0xf
s_nop 2
v_mov_b32_dpp v154, v162 quad_perm:[0,1,2,3] row_mask:0x4 bank_mask:0xf
v_mul_f32 v167, s3, v167
v_mul_f32 v154, v154, v167
v_cvt_pk_bf16_f32 v154, v154, 0
ds_write_b16 v214, v154
v_add_u32 v214, 1408, v214
ds_read_b128 v[170:173], v210 offset:43008
s_waitcnt lgkmcnt(0)
v_mfma_f32_16x16x32_bf16 v[12:15], a[144:147], v[170:173], v[12:15]
v_mfma_f32_16x16x32_bf16 v[16:19], a[168:171], v[170:173], v[16:19]
v_mfma_f32_16x16x32_bf16 v[20:23], a[192:195], v[170:173], v[20:23]
ds_read_b128 v[182:185], v210 offset:44032
s_waitcnt lgkmcnt(0)
v_mfma_f32_16x16x32_bf16 v[12:15], a[148:151], v[182:185], v[12:15]
v_mfma_f32_16x16x32_bf16 v[16:19], a[172:175], v[182:185], v[16:19]
v_mfma_f32_16x16x32_bf16 v[20:23], a[196:199], v[182:185], v[20:23]
ds_read_b128 v[186:189], v210 offset:45056
s_waitcnt lgkmcnt(0)
v_mfma_f32_16x16x32_bf16 v[12:15], a[152:155], v[186:189], v[12:15]
v_mfma_f32_16x16x32_bf16 v[16:19], a[176:179], v[186:189], v[16:19]
v_mfma_f32_16x16x32_bf16 v[20:23], a[200:203], v[186:189], v[20:23]
ds_read_b128 v[170:173], v210 offset:46080
s_waitcnt lgkmcnt(0)
v_mfma_f32_16x16x32_bf16 v[12:15], a[156:159], v[170:173], v[12:15]
v_mfma_f32_16x16x32_bf16 v[16:19], a[180:183], v[170:173], v[16:19]
v_mfma_f32_16x16x32_bf16 v[20:23], a[204:207], v[170:173], v[20:23]
ds_read_b128 v[182:185], v210 offset:47104
s_waitcnt lgkmcnt(0)
v_mfma_f32_16x16x32_bf16 v[12:15], a[160:163], v[182:185], v[12:15]
v_mfma_f32_16x16x32_bf16 v[16:19], a[184:187], v[182:185], v[16:19]
v_mfma_f32_16x16x32_bf16 v[20:23], a[208:211], v[182:185], v[20:23]
ds_read_b128 v[186:189], v210 offset:48128
s_waitcnt lgkmcnt(0)
v_mfma_f32_16x16x32_bf16 v[12:15], a[164:167], v[186:189], v[12:15]
v_mfma_f32_16x16x32_bf16 v[16:19], a[188:191], v[186:189], v[16:19]
v_mfma_f32_16x16x32_bf16 v[20:23], a[212:215], v[186:189], v[20:23]
v_cvt_pk_bf16_f32 v78, v12, v13
v_cvt_pk_bf16_f32 v79, v14, v15
buffer_store_dwordx2 v[78:79], v204, s[8:11], s38 offen
v_cvt_pk_bf16_f32 v80, v16, v17
v_cvt_pk_bf16_f32 v81, v18, v19
buffer_store_dwordx2 v[80:81], v204, s[8:11], s38 offen offset:32
s_nop 0
v_cvt_pk_bf16_f32 v82, v20, v21
v_cvt_pk_bf16_f32 v83, v22, v23
buffer_store_dwordx2 v[82:83], v204, s[8:11], s38 offen offset:64
v_rcp_f32 v151, v150
s_nop 0
v_mul_f32 v151, s3, v151
v_mul_f32 v138, v138, v151
v_mul_f32 v139, v139, v151
v_cvt_pk_bf16_f32 v138, v138, v139
v_mul_f32 v140, v140, v151
v_mul_f32 v141, v141, v151
v_cvt_pk_bf16_f32 v139, v140, v141
v_mul_f32 v142, v142, v151
v_mul_f32 v143, v143, v151
v_cvt_pk_bf16_f32 v140, v142, v143
v_mul_f32 v144, v144, v151
v_mul_f32 v145, v145, v151
v_cvt_pk_bf16_f32 v141, v144, v145
ds_write_b128 v211, v[138:141] offset:49152
v_mul_f32 v146, v146, v151
v_mul_f32 v147, v147, v151
v_cvt_pk_bf16_f32 v142, v146, v147
v_mul_f32 v148, v148, v151
v_mul_f32 v149, v149, v151
v_cvt_pk_bf16_f32 v143, v148, v149
ds_write_b64 v212, v[142:143] offset:49152
s_waitcnt lgkmcnt(0)
s_barrier
ds_read_b128 v[170:173], v210 offset:49152
s_waitcnt lgkmcnt(0)
v_mfma_f32_16x16x32_bf16 v[24:27], a[144:147], v[170:173], v[24:27]
v_mfma_f32_16x16x32_bf16 v[28:31], a[168:171], v[170:173], v[28:31]
v_mfma_f32_16x16x32_bf16 v[32:35], a[192:195], v[170:173], v[32:35]
ds_read_b128 v[182:185], v210 offset:50176
s_waitcnt lgkmcnt(0)
v_mfma_f32_16x16x32_bf16 v[24:27], a[148:151], v[182:185], v[24:27]
v_mfma_f32_16x16x32_bf16 v[28:31], a[172:175], v[182:185], v[28:31]
v_mfma_f32_16x16x32_bf16 v[32:35], a[196:199], v[182:185], v[32:35]
ds_read_b128 v[186:189], v210 offset:51200
s_waitcnt lgkmcnt(0)
v_mfma_f32_16x16x32_bf16 v[24:27], a[152:155], v[186:189], v[24:27]
v_mfma_f32_16x16x32_bf16 v[28:31], a[176:179], v[186:189], v[28:31]
v_mfma_f32_16x16x32_bf16 v[32:35], a[200:203], v[186:189], v[32:35]
ds_read_b128 v[170:173], v210 offset:52224
s_waitcnt lgkmcnt(0)
v_mfma_f32_16x16x32_bf16 v[24:27], a[156:159], v[170:173], v[24:27]
v_mfma_f32_16x16x32_bf16 v[28:31], a[180:183], v[170:173], v[28:31]
v_mfma_f32_16x16x32_bf16 v[32:35], a[204:207], v[170:173], v[32:35]
ds_read_b128 v[182:185], v210 offset:53248
s_waitcnt lgkmcnt(0)
v_mfma_f32_16x16x32_bf16 v[24:27], a[160:163], v[182:185], v[24:27]
v_mfma_f32_16x16x32_bf16 v[28:31], a[184:187], v[182:185], v[28:31]
v_mfma_f32_16x16x32_bf16 v[32:35], a[208:211], v[182:185], v[32:35]
ds_read_b128 v[186:189], v210 offset:54272
s_waitcnt lgkmcnt(0)
v_mfma_f32_16x16x32_bf16 v[24:27], a[164:167], v[186:189], v[24:27]
v_mfma_f32_16x16x32_bf16 v[28:31], a[188:191], v[186:189], v[28:31]
v_mfma_f32_16x16x32_bf16 v[32:35], a[212:215], v[186:189], v[32:35]
v_cvt_pk_bf16_f32 v116, v24, v25
v_cvt_pk_bf16_f32 v117, v26, v27
buffer_store_dwordx2 v[116:117], v205, s[8:11], s38 offen
v_cvt_pk_bf16_f32 v124, v28, v29
v_cvt_pk_bf16_f32 v125, v30, v31
buffer_store_dwordx2 v[124:125], v205, s[8:11], s38 offen offset:32
s_nop 0
v_cvt_pk_bf16_f32 v132, v32, v33
v_cvt_pk_bf16_f32 v133, v34, v35
buffer_store_dwordx2 v[132:133], v205, s[8:11], s38 offen offset:64
s_branch L_epi
.p2align 6
.type L_tab,@object
L_tab:
.long 0x0,0x3800,0x5500,0x190,0x320,0x2020,0x5820,0x4b0,0x640,0x2340,0x4040,0x7d0,0x960,0x2660,0x6060,0xaf0
.long 0x1010,0x4810,0x6510,0x11a0,0x1330,0x3030,0x6830,0x14c0,0x1650,0x3350,0x5050,0x17e0,0x1970,0x3670,0x5370,0x1b00
.long 0x190,0x3990,0x5690,0x320,0x4b0,0x21b0,0x59b0,0x640,0x7d0,0x24d0,0x41d0,0x960,0x27f0,0x44f0,0x61f0,0x2980
.long 0x2980,0x4680,0x6380,0x2b10,0x11a0,0x49a0,0x66a0,0x1330,0x14c0,0x31c0,0x69c0,0x1650,0x17e0,0x34e0,0x51e0,0x1970
.long 0x320,0x3b20,0x5820,0x1010,0x640,0x2340,0x5b40,0x1330,0x960,0x2660,0x4360,0x1650,0xc80,0x2980,0x6380,0x1970
.long 0x1330,0x4b30,0x6830,0x2020,0x1650,0x3350,0x6b50,0x2340,0x1970,0x3670,0x5370,0x2660,0x1c90,0x3990,0x5690,0x2980
.long 0x4b0,0x3cb0,0x59b0,0x11a0,0x7d0,0x24d0,0x5cd0,0x14c0,0xaf0,0x27f0,0x44f0,0x17e0,0x2b10,0x4810,0x6510,0x3800
.long 0x2ca0,0x49a0,0x66a0,0x3990,0x14c0,0x4cc0,0x69c0,0x21b0,0x17e0,0x34e0,0x6ce0,0x24d0,0x1b00,0x3800,0x5500,0x27f0
.long 0x2020,0x5820,0x7520,0x1330,0x2340,0x4040,0x7840,0x1650,0x2660,0x4360,0x6060,0x1970,0x2980,0x4680,0x8080,0x1c90
.long 0x3030,0x6830,0x8530,0x2340,0x3350,0x5050,0x8850,0x2660,0x3670,0x5370,0x7070,0x2980,0x3990,0x5690,0x7390,0x2ca0
.long 0x21b0,0x59b0,0x76b0,0x14c0,0x24d0,0x41d0,0x79d0,0x17e0,0x27f0,0x44f0,0x61f0,0x1b00,0x4810,0x6510,0x8210,0x3b20
.long 0x49a0,0x66a0,0x83a0,0x3cb0,0x31c0,0x69c0,0x86c0,0x24d0,0x34e0,0x51e0,0x89e0,0x27f0,0x3800,0x5500,0x7200,0x2b10
.long 0x2340,0x5b40,0x7840,0x21b0,0x2660,0x4360,0x7b60,0x24d0,0x2980,0x4680,0x6380,0x27f0,0x2ca0,0x49a0,0x83a0,0x2b10
.long 0x3350,0x6b50,0x8850,0x31c0,0x3670,0x5370,0x8b70,0x34e0,0x3990,0x5690,0x7390,0x3800,0x3cb0,0x59b0,0x76b0,0x3b20
.long 0x24d0,0x5cd0,0x79d0,0x2340,0x27f0,0x44f0,0x7cf0,0x2660,0x2b10,0x4810,0x6510,0x2980,0x4b30,0x6830,0x8530,0x49a0
.long 0x4cc0,0x69c0,0x86c0,0x4b30,0x34e0,0x6ce0,0x89e0,0x3350,0x3800,0x5500,0x8d00,0x3670,0x3b20,0x5820,0x7520,0x3990
.long 0x3990,0x5690,0x11a0,0x49a0,0x21b0,0x59b0,0x14c0,0x31c0,0x24d0,0x41d0,0x17e0,0x34e0,0x27f0,0x61f0,0x1b00,0x3800
.long 0x49a0,0x66a0,0x21b0,0x59b0,0x31c0,0x69c0,0x24d0,0x41d0,0x34e0,0x51e0,0x27f0,0x44f0,0x3800,0x5500,0x2b10,0x4810
.long 0x3b20,0x5820,0x1330,0x4b30,0x2340,0x5b40,0x1650,0x3350,0x2660,0x4360,0x1970,0x3670,0x4680,0x6380,0x3990,0x5690
.long 0x4810,0x6510,0x3b20,0x5820,0x4b30,0x6830,0x2340,0x5b40,0x3350,0x6b50,0x2660,0x4360,0x3670,0x5370,0x2980,0x4680
.long 0x4810,0x6510,0x11a0,0x49a0,0x3030,0x6830,0x14c0,0x31c0,0x3350,0x5050,0x17e0,0x34e0,0x3670,0x7070,0x1b00,0x3800
.long 0x5820,0x7520,0x21b0,0x59b0,0x4040,0x7840,0x24d0,0x41d0,0x4360,0x6060,0x27f0,0x44f0,0x4680,0x6380,0x2b10,0x4810
.long 0x49a0,0x66a0,0x1330,0x4b30,0x31c0,0x69c0,0x1650,0x3350,0x34e0,0x51e0,0x1970,0x3670,0x5500,0x7200,0x3990,0x5690
.long 0x5690,0x7390,0x3b20,0x5820,0x59b0,0x76b0,0x2340,0x5b40,0x41d0,0x79d0,0x2660,0x4360,0x44f0,0x61f0,0x2980,0x4680
.long 0x4b30,0x6830,0x11b0,0x49b0,0x3350,0x6b50,0x14d0,0x31d0,0x3670,0x5370,0x17f0,0x34f0,0x3990,0x7390,0x1b10,0x3810
.long 0x5b40,0x7840,0x21c0,0x59c0,0x4360,0x7b60,0x24e0,0x41e0,0x4680,0x6380,0x2800,0x4500,0x49a0,0x66a0,0x2b20,0x4820
.long 0x4cc0,0x69c0,0x1340,0x4b40,0x34e0,0x6ce0,0x1660,0x3360,0x3800,0x5500,0x1980,0x3680,0x5820,0x7520,0x39a0,0x56a0
.long 0x59b0,0x76b0,0x3b30,0x5830,0x5cd0,0x79d0,0x2350,0x5b50,0x44f0,0x7cf0,0x2670,0x4370,0x4810,0x6510,0x2990,0x4690
.long 0x59b0,0x76b0,0x11b0,0x49b0,0x41d0,0x79d0,0x14d0,0x31d0,0x44f0,0x61f0,0x17f0,0x34f0,0x4810,0x8210,0x1b10,0x3810
.long 0x69c0,0x86c0,0x21c0,0x59c0,0x51e0,0x89e0,0x24e0,0x41e0,0x5500,0x7200,0x2800,0x4500,0x5820,0x7520,0x2b20,0x4820
.long 0x5b40,0x7840,0x1340,0x4b40,0x4360,0x7b60,0x1660,0x3360,0x4680,0x6380,0x1980,0x3680,0x66a0,0x83a0,0x39a0,0x56a0
.long 0x6830,0x8530,0x3b30,0x5830,0x6b50,0x8850,0x2350,0x5b50,0x5370,0x8b70,0x2670,0x4370,0x5690,0x7390,0x2990,0x4690
.long 0x66a0,0x0,0x90300,0xefd00,0x69c0,0x300,0x5fd00,0xf0000,0x51e0,0x600,0x60000,0xbfa00,0x7200,0x900,0x60300,0x11f700
.long 0x76b0,0x2fe80,0xc0180,0x11fb80,0x79d0,0x30180,0x8fb80,0x11fe80,0x61f0,0x30480,0x8fe80,0xef880,0x6510,0x30780,0x90180,0xefb80
.long 0x6830,0x180,0x90480,0xefe80,0x6b50,0x480,0x5fe80,0xf0180,0x5370,0x780,0x60180,0xbfb80,0x7390,0x60480,0xbfe80,0x11f880
.long 0x7520,0x60600,0xc0000,0x11fa00,0x7840,0x30000,0xc0300,0x11fd00,0x7b60,0x30300,0x8fd00,0x120000,0x6380,0x30600,0x90000,0xefa00
.long 0x66a0,0x8,0x90308,0xefd08,0x69c0,0x308,0x5fd08,0xf0008,0x51e0,0x608,0x60008,0xbfa08,0x7200,0x908,0x60308,0x11f708
.long 0x76b0,0x2fe88,0xc0188,0x11fb88,0x79d0,0x30188,0x8fb88,0x11fe88,0x61f0,0x30488,0x8fe88,0xef888,0x6510,0x30788,0x90188,0xefb88
.long 0x6830,0x188,0x90488,0xefe88,0x6b50,0x488,0x5fe88,0xf0188,0x5370,0x788,0x60188,0xbfb88,0x7390,0x60488,0xbfe88,0x11f888
.long 0x7520,0x60608,0xc0008,0x11fa08,0x7840,0x30008,0xc0308,0x11fd08,0x7b60,0x30308,0x8fd08,0x120008,0x6380,0x30608,0x90008,0xefa08
.long 0x66b0,0x10,0x90310,0xefd10,0x69d0,0x310,0x5fd10,0xf0010,0x51f0,0x610,0x60010,0xbfa10,0x7210,0x910,0x60310,0x11f710
.long 0x76c0,0x2fe90,0xc0190,0x11fb90,0x79e0,0x30190,0x8fb90,0x11fe90,0x6200,0x30490,0x8fe90,0xef890,0x6520,0x30790,0x90190,0xefb90
.long 0x6840,0x190,0x90490,0xefe90,0x6b60,0x490,0x5fe90,0xf0190,0x5380,0x790,0x60190,0xbfb90,0x73a0,0x60490,0xbfe90,0x11f890
.long 0x7530,0x60610,0xc0010,0x11fa10,0x7850,0x30010,0xc0310,0x11fd10,0x7b70,0x30310,0x8fd10,0x120010,0x6390,0x30610,0x90010,0xefa10
.long 0x66b0,0x18,0x90318,0xefd18,0x69d0,0x318,0x5fd18,0xf0018,0x51f0,0x618,0x60018,0xbfa18,0x7210,0x918,0x60318,0x11f718
.long 0x76c0,0x2fe98,0xc0198,0x11fb98,0x79e0,0x30198,0x8fb98,0x11fe98,0x6200,0x30498,0x8fe98,0xef898,0x6520,0x30798,0x90198,0xefb98
.long 0x6840,0x198,0x90498,0xefe98,0x6b60,0x498,0x5fe98,0xf0198,0x5380,0x798,0x60198,0xbfb98,0x73a0,0x60498,0xbfe98,0x11f898
.long 0x7530,0x60618,0xc0018,0x11fa18,0x7850,0x30018,0xc0318,0x11fd18,0x7b70,0x30318,0x8fd18,0x120018,0x6390,0x30618,0x90018,0xefa18
.long 0x0,0x0,0x12100,0x16900,0x0,0xff800000,0x12110,0x16910,0x0,0xff800000,0x12120,0x16920,0x0,0xff800000,0x12130,0x16930
.long 0x0,0xff800000,0x12140,0x16940,0x0,0xff800000,0x12150,0x16950,0x0,0xff800000,0x12160,0x16960,0x0,0xff800000,0x12170,0x16970
.long 0x0,0xff800000,0x12180,0x16980,0x0,0xff800000,0x12190,0x16990,0x0,0xff800000,0x121a0,0x169a0,0x0,0xff800000,0x121b0,0x169b0
.long 0x0,0xff800000,0x121c0,0x169c0,0x0,0xff800000,0x121d0,0x169d0,0x0,0xff800000,0x121e0,0x169e0,0x0,0xff800000,0x121f0,0x169f0
.long 0xff800000,0x0,0x12100,0x16d00,0xff800000,0xff800000,0x12110,0x16d10,0xff800000,0xff800000,0x12120,0x16d20,0xff800000,0xff800000,0x12130,0x16d30
.long 0xff800000,0xff800000,0x12140,0x16d40,0xff800000,0xff800000,0x12150,0x16d50,0xff800000,0xff800000,0x12160,0x16d60,0xff800000,0xff800000,0x12170,0x16d70
.long 0xff800000,0xff800000,0x12180,0x16d80,0xff800000,0xff800000,0x12190,0x16d90,0xff800000,0xff800000,0x121a0,0x16da0,0xff800000,0xff800000,0x121b0,0x16db0
.long 0xff800000,0xff800000,0x121c0,0x16dc0,0xff800000,0xff800000,0x121d0,0x16dd0,0xff800000,0xff800000,0x121e0,0x16de0,0xff800000,0xff800000,0x121f0,0x16df0
.long 0xff800000,0x0,0x12100,0x16a00,0xff800000,0xff800000,0x12110,0x16a10,0xff800000,0xff800000,0x12120,0x16a20,0xff800000,0xff800000,0x12130,0x16a30
.long 0xff800000,0xff800000,0x12140,0x16a40,0xff800000,0xff800000,0x12150,0x16a50,0xff800000,0xff800000,0x12160,0x16a60,0xff800000,0xff800000,0x12170,0x16a70
.long 0xff800000,0xff800000,0x12180,0x16a80,0xff800000,0xff800000,0x12190,0x16a90,0xff800000,0xff800000,0x121a0,0x16aa0,0xff800000,0xff800000,0x121b0,0x16ab0
.long 0xff800000,0xff800000,0x121c0,0x16ac0,0xff800000,0xff800000,0x121d0,0x16ad0,0xff800000,0xff800000,0x121e0,0x16ae0,0xff800000,0xff800000,0x121f0,0x16af0
.long 0xff800000,0x0,0x12100,0x16e00,0xff800000,0xff800000,0x12110,0x16e10,0xff800000,0xff800000,0x12120,0x16e20,0xff800000,0xff800000,0x12130,0x16e30
.long 0xff800000,0xff800000,0x12140,0x16e40,0xff800000,0xff800000,0x12150,0x16e50,0xff800000,0xff800000,0x12160,0x16e60,0xff800000,0xff800000,0x12170,0x16e70
.long 0xff800000,0xff800000,0x12180,0x16e80,0xff800000,0xff800000,0x12190,0x16e90,0xff800000,0xff800000,0x121a0,0x16ea0,0xff800000,0xff800000,0x121b0,0x16eb0
.long 0xff800000,0xff800000,0x121c0,0x16ec0,0xff800000,0xff800000,0x121d0,0x16ed0,0xff800000,0xff800000,0x121e0,0x16ee0,0xff800000,0xff800000,0x121f0,0x16ef0
.long 0x9100,0x9100,0xa100,0x0,0x9110,0x9110,0xa110,0x55555555,0x9120,0x9120,0xa120,0xaaaaaaaa,0x9130,0x9130,0xa130,0xffffffff
.long 0x9140,0x9140,0xa140,0x0,0x9150,0x9150,0xa150,0x55555555,0x9160,0x9160,0xa160,0xaaaaaaaa,0x9170,0x9170,0xa170,0xffffffff
.long 0x9180,0x9180,0xa180,0x0,0x9190,0x9190,0xa190,0x55555555,0x91a0,0x91a0,0xa1a0,0xaaaaaaaa,0x91b0,0x91b0,0xa1b0,0xffffffff
.long 0x91c0,0x91c0,0xa1c0,0x0,0x91d0,0x91d0,0xa1d0,0x55555555,0x91e0,0x91e0,0xa1e0,0xaaaaaaaa,0x91f0,0x91f0,0xa1f0,0xffffffff
.long 0x9200,0x9200,0xa200,0x0,0x9210,0x9210,0xa210,0x55555555,0x9220,0x9220,0xa220,0xaaaaaaaa,0x9230,0x9230,0xa230,0xffffffff
.long 0x9240,0x9240,0xa240,0x0,0x9250,0x9250,0xa250,0x55555555,0x9260,0x9260,0xa260,0xaaaaaaaa,0x9270,0x9270,0xa270,0xffffffff
.long 0x9280,0x9280,0xa280,0x0,0x9290,0x9290,0xa290,0x55555555,0x92a0,0x92a0,0xa2a0,0xaaaaaaaa,0x92b0,0x92b0,0xa2b0,0xffffffff
.long 0x92c0,0x92c0,0xa2c0,0x0,0x92d0,0x92d0,0xa2d0,0x55555555,0x92e0,0x92e0,0xa2e0,0xaaaaaaaa,0x92f0,0x92f0,0xa2f0,0xffffffff
.long 0x9300,0x9300,0xa300,0x0,0x9310,0x9310,0xa310,0x55555555,0x9320,0x9320,0xa320,0xaaaaaaaa,0x9330,0x9330,0xa330,0xffffffff
.long 0x9340,0x9340,0xa340,0x0,0x9350,0x9350,0xa350,0x55555555,0x9360,0x9360,0xa360,0xaaaaaaaa,0x9370,0x9370,0xa370,0xffffffff
.long 0x9380,0x9380,0xa380,0x0,0x9390,0x9390,0xa390,0x55555555,0x93a0,0x93a0,0xa3a0,0xaaaaaaaa,0x93b0,0x93b0,0xa3b0,0xffffffff
.long 0x93c0,0x93c0,0xa3c0,0x0,0x93d0,0x93d0,0xa3d0,0x55555555,0x93e0,0x93e0,0xa3e0,0xaaaaaaaa,0x93f0,0x93f0,0xa3f0,0xffffffff
.long 0x9400,0x9400,0xa400,0x0,0x9410,0x9410,0xa410,0x55555555,0x9420,0x9420,0xa420,0xaaaaaaaa,0x9430,0x9430,0xa430,0xffffffff
.long 0x9440,0x9440,0xa440,0x0,0x9450,0x9450,0xa450,0x55555555,0x9460,0x9460,0xa460,0xaaaaaaaa,0x9470,0x9470,0xa470,0xffffffff
.long 0x9480,0x9480,0xa480,0x0,0x9490,0x9490,0xa490,0x55555555,0x94a0,0x94a0,0xa4a0,0xaaaaaaaa,0x94b0,0x94b0,0xa4b0,0xffffffff
.long 0x94c0,0x94c0,0xa4c0,0x0,0x94d0,0x94d0,0xa4d0,0x55555555,0x94e0,0x94e0,0xa4e0,0xaaaaaaaa,0x94f0,0x94f0,0xa4f0,0xffffffff
.long 0x17100,0x17100,0x17500,0x23100,0x17102,0x17100,0x17502,0x23110,0x17104,0x17100,0x17504,0x23120,0x17106,0x17100,0x17506,0x23130
.long 0x17120,0x17100,0x17508,0x23140,0x17122,0x17100,0x1750a,0x23150,0x17124,0x17100,0x1750c,0x23160,0x17126,0x17100,0x1750e,0x23170
.long 0x17140,0x17100,0x17510,0x23300,0x17142,0x17100,0x17512,0x23300,0x17144,0x17100,0x17514,0x23300,0x17146,0x17100,0x17516,0x23300
.long 0x17160,0x17100,0x17518,0x23300,0x17162,0x17100,0x1751a,0x23300,0x17164,0x17100,0x1751c,0x23300,0x17166,0x17100,0x1751e,0x23300
.long 0x17108,0x17120,0x17500,0x23200,0x1710a,0x17120,0x17502,0x23210,0x1710c,0x17120,0x17504,0x23220,0x1710e,0x17120,0x17506,0x23230
.long 0x17128,0x17120,0x17508,0x23240,0x1712a,0x17120,0x1750a,0x23250,0x1712c,0x17120,0x1750c,0x23260,0x1712e,0x17120,0x1750e,0x23270
.long 0x17148,0x17120,0x17510,0x23300,0x1714a,0x17120,0x17512,0x23300,0x1714c,0x17120,0x17514,0x23300,0x1714e,0x17120,0x17516,0x23300
.long 0x17168,0x17120,0x17518,0x23300,0x1716a,0x17120,0x1751a,0x23300,0x1716c,0x17120,0x1751c,0x23300,0x1716e,0x17120,0x1751e,0x23300
.long 0x17110,0x17140,0x17500,0x23300,0x17112,0x17140,0x17502,0x23300,0x17114,0x17140,0x17504,0x23300,0x17116,0x17140,0x17506,0x23300
.long 0x17130,0x17140,0x17508,0x23300,0x17132,0x17140,0x1750a,0x23300,0x17134,0x17140,0x1750c,0x23300,0x17136,0x17140,0x1750e,0x23300
.long 0x17150,0x17140,0x17510,0x23180,0x17152,0x17140,0x17512,0x23190,0x17154,0x17140,0x17514,0x231a0,0x17156,0x17140,0x17516,0x231b0
.long 0x17170,0x17140,0x17518,0x231c0,0x17172,0x17140,0x1751a,0x231d0,0x17174,0x17140,0x1751c,0x231e0,0x17176,0x17140,0x1751e,0x231f0
.long 0x17118,0x17160,0x17500,0x23300,0x1711a,0x17160,0x17502,0x23300,0x1711c,0x17160,0x17504,0x23300,0x1711e,0x17160,0x17506,0x23300
.long 0x17138,0x17160,0x17508,0x23300,0x1713a,0x17160,0x1750a,0x23300,0x1713c,0x17160,0x1750c,0x23300,0x1713e,0x17160,0x1750e,0x23300
.long 0x17158,0x17160,0x17510,0x23280,0x1715a,0x17160,0x17512,0x23290,0x1715c,0x17160,0x17514,0x232a0,0x1715e,0x17160,0x17516,0x232b0
.long 0x17178,0x17160,0x17518,0x232c0,0x1717a,0x17160,0x1751a,0x232d0,0x1717c,0x17160,0x1751c,0x232e0,0x1717e,0x17160,0x1751e,0x232f0
.long 0x13100,0x0,0x180,0x600,0x13108,0xd90,0xf10,0x1390,0x13110,0x1b20,0x1ca0,0x2120,0x13118,0x28b0,0x2a30,0x2eb0
.long 0x13160,0x3640,0x37c0,0x3c40,0x13168,0x43d0,0x4550,0x49d0,0x13170,0x5160,0x52e0,0x5760,0x13178,0x5ef0,0x6070,0x64f0
.long 0x131c0,0x6c80,0x6e00,0x7280,0x131c8,0x7a10,0x7b90,0x8010,0x131d0,0x87a0,0x8920,0x8da0,0x131d8,0x9530,0x96b0,0x9b30
.long 0x13220,0xa2c0,0xa440,0xa8c0,0x13228,0xb050,0xb1d0,0xb650,0x13230,0xbde0,0xbf60,0xc3e0,0x13238,0xcb70,0xccf0,0xd170
.long 0x13280,0x300,0x480,0x600,0x13288,0x1090,0x1210,0x1390,0x13290,0x1e20,0x1fa0,0x2120,0x13298,0x2bb0,0x2d30,0x2eb0
.long 0x132e0,0x3940,0x3ac0,0x3c40,0x132e8,0x46d0,0x4850,0x49d0,0x132f0,0x5460,0x55e0,0x5760,0x132f8,0x61f0,0x6370,0x64f0
.long 0x13340,0x6f80,0x7100,0x7280,0x13348,0x7d10,0x7e90,0x8010,0x13350,0x8aa0,0x8c20,0x8da0,0x13358,0x9830,0x99b0,0x9b30
.long 0x133a0,0xa5c0,0xa740,0xa8c0,0x133a8,0xb350,0xb4d0,0xb650,0x133b0,0xc0e0,0xc260,0xc3e0,0x133b8,0xce70,0xcff0,0xd170
.long 0x13400,0x900,0x780,0x610,0x13408,0x1690,0x1510,0x13a0,0x13410,0x2420,0x22a0,0x2130,0x13418,0x31b0,0x3030,0x2ec0
.long 0x13460,0x3f40,0x3dc0,0x3c50,0x13468,0x4cd0,0x4b50,0x49e0,0x13470,0x5a60,0x58e0,0x5770,0x13478,0x67f0,0x6670,0x6500
.long 0x134c0,0x7580,0x7400,0x7290,0x134c8,0x8310,0x8190,0x8020,0x134d0,0x90a0,0x8f20,0x8db0,0x134d8,0x9e30,0x9cb0,0x9b40
.long 0x13520,0xabc0,0xaa40,0xa8d0,0x13528,0xb950,0xb7d0,0xb660,0x13530,0xc6e0,0xc560,0xc3f0,0x13538,0xd470,0xd2f0,0xd180
.long 0x13580,0xc00,0xa80,0x610,0x13588,0x1990,0x1810,0x13a0,0x13590,0x2720,0x25a0,0x2130,0x13598,0x34b0,0x3330,0x2ec0
.long 0x135e0,0x4240,0x40c0,0x3c50,0x135e8,0x4fd0,0x4e50,0x49e0,0x135f0,0x5d60,0x5be0,0x5770,0x135f8,0x6af0,0x6970,0x6500
.long 0x13640,0x7880,0x7700,0x7290,0x13648,0x8610,0x8490,0x8020,0x13650,0x93a0,0x9220,0x8db0,0x13658,0xa130,0x9fb0,0x9b40
.long 0x136a0,0xaec0,0xad40,0xa8d0,0x136a8,0xbc50,0xbad0,0xb660,0x136b0,0xc9e0,0xc860,0xc3f0,0x136b8,0xd770,0xd5f0,0xd180
.long 0x17100,0x17500,0x0,0x0,0x17680,0x17a80,0x0,0x0,0x17c00,0x18000,0x0,0x0,0x18180,0x18580,0x0,0x0
.long 0x18700,0x18b00,0x0,0x0,0x18c80,0x19080,0x0,0x0,0x19200,0x19600,0x0,0x0,0x19780,0x19b80,0x0,0x0
.long 0x19d00,0x1a100,0x0,0x0,0x1a280,0x1a680,0x0,0x0,0x1a800,0x1ac00,0x0,0x0,0x1ad80,0x1b180,0x0,0x0
.long 0x1b300,0x1b700,0x0,0x0,0x1b880,0x1bc80,0x0,0x0,0x1be00,0x1c200,0x0,0x0,0x1c380,0x1c780,0x0,0x0
.long 0x17120,0x17508,0x0,0x0,0x176a0,0x17a88,0x0,0x0,0x17c20,0x18008,0x0,0x0,0x181a0,0x18588,0x0,0x0
.long 0x18720,0x18b08,0x0,0x0,0x18ca0,0x19088,0x0,0x0,0x19220,0x19608,0x0,0x0,0x197a0,0x19b88,0x0,0x0
.long 0x19d20,0x1a108,0x0,0x0,0x1a2a0,0x1a688,0x0,0x0,0x1a820,0x1ac08,0x0,0x0,0x1ada0,0x1b188,0x0,0x0
.long 0x1b320,0x1b708,0x0,0x0,0x1b8a0,0x1bc88,0x0,0x0,0x1be20,0x1c208,0x0,0x0,0x1c3a0,0x1c788,0x0,0x0
.long 0x17140,0x17510,0x0,0x0,0x176c0,0x17a90,0x0,0x0,0x17c40,0x18010,0x0,0x0,0x181c0,0x18590,0x0,0x0
.long 0x18740,0x18b10,0x0,0x0,0x18cc0,0x19090,0x0,0x0,0x19240,0x19610,0x0,0x0,0x197c0,0x19b90,0x0,0x0
.long 0x19d40,0x1a110,0x0,0x0,0x1a2c0,0x1a690,0x0,0x0,0x1a840,0x1ac10,0x0,0x0,0x1adc0,0x1b190,0x0,0x0
.long 0x1b340,0x1b710,0x0,0x0,0x1b8c0,0x1bc90,0x0,0x0,0x1be40,0x1c210,0x0,0x0,0x1c3c0,0x1c790,0x0,0x0
.long 0x17160,0x17518,0x0,0x0,0x176e0,0x17a98,0x0,0x0,0x17c60,0x18018,0x0,0x0,0x181e0,0x18598,0x0,0x0
.long 0x18760,0x18b18,0x0,0x0,0x18ce0,0x19098,0x0,0x0,0x19260,0x19618,0x0,0x0,0x197e0,0x19b98,0x0,0x0
.long 0x19d60,0x1a118,0x0,0x0,0x1a2e0,0x1a698,0x0,0x0,0x1a860,0x1ac18,0x0,0x0,0x1ade0,0x1b198,0x0,0x0
.long 0x1b360,0x1b718,0x0,0x0,0x1b8e0,0x1bc98,0x0,0x0,0x1be60,0x1c218,0x0,0x0,0x1c3e0,0x1c798,0x0,0x0
.long 0x26100,0x26160,0x26280,0x0,0x26102,0x26162,0x26282,0x0,0x26104,0x26164,0x26284,0x0,0x26106,0x26166,0x26286,0x0
.long 0x26108,0x26168,0x26288,0x0,0x2610a,0x2616a,0x2628a,0x0,0x2610c,0x2616c,0x2628c,0x0,0x2610e,0x2616e,0x2628e,0x0
.long 0x26110,0x26170,0x26290,0x0,0x26112,0x26172,0x26292,0x0,0x26114,0x26174,0x26294,0x0,0x26116,0x26176,0x26296,0x0
.long 0x26118,0x26178,0x26298,0x0,0x2611a,0x2617a,0x2629a,0x0,0x2611c,0x2617c,0x2629c,0x0,0x2611e,0x2617e,0x2629e,0x0
.long 0x26340,0x262e0,0x26280,0x0,0x26342,0x262e2,0x26282,0x0,0x26344,0x262e4,0x26284,0x0,0x26346,0x262e6,0x26286,0x0
.long 0x26348,0x262e8,0x26288,0x0,0x2634a,0x262ea,0x2628a,0x0,0x2634c,0x262ec,0x2628c,0x0,0x2634e,0x262ee,0x2628e,0x0
.long 0x26350,0x262f0,0x26290,0x0,0x26352,0x262f2,0x26292,0x0,0x26354,0x262f4,0x26294,0x0,0x26356,0x262f6,0x26296,0x0
.long 0x26358,0x262f8,0x26298,0x0,0x2635a,0x262fa,0x2629a,0x0,0x2635c,0x262fc,0x2629c,0x0,0x2635e,0x262fe,0x2629e,0x0
.long 0x26100,0x26160,0x26280,0x0,0x26102,0x26162,0x26282,0x0,0x26104,0x26164,0x26284,0x0,0x26106,0x26166,0x26286,0x0
.long 0x26108,0x26168,0x26288,0x0,0x2610a,0x2616a,0x2628a,0x0,0x2610c,0x2616c,0x2628c,0x0,0x2610e,0x2616e,0x2628e,0x0
.long 0x26110,0x26170,0x26290,0x0,0x26112,0x26172,0x26292,0x0,0x26114,0x26174,0x26294,0x0,0x26116,0x26176,0x26296,0x0
.long 0x26118,0x26178,0x26298,0x0,0x2611a,0x2617a,0x2629a,0x0,0x2611c,0x2617c,0x2629c,0x0,0x2611e,0x2617e,0x2629e,0x0
.long 0x26340,0x262e0,0x26280,0x0,0x26342,0x262e2,0x26282,0x0,0x26344,0x262e4,0x26284,0x0,0x26346,0x262e6,0x26286,0x0
.long 0x26348,0x262e8,0x26288,0x0,0x2634a,0x262ea,0x2628a,0x0,0x2634c,0x262ec,0x2628c,0x0,0x2634e,0x262ee,0x2628e,0x0
.long 0x26350,0x262f0,0x26290,0x0,0x26352,0x262f2,0x26292,0x0,0x26354,0x262f4,0x26294,0x0,0x26356,0x262f6,0x26296,0x0
.long 0x26358,0x262f8,0x26298,0x0,0x2635a,0x262fa,0x2629a,0x0,0x2635c,0x262fc,0x2629c,0x0,0x2635e,0x262fe,0x2629e,0x0
.long 0xffffffff,0x0,0xffff,0x0,0xffffffff,0x0,0xffff,0x0,0xffffffff,0x0,0xffff,0x0,0xffffffff,0x0,0xffff,0x0
.long 0x0,0xffffffff,0xffff,0x0,0x0,0xffffffff,0xffff,0x0,0x0,0xffffffff,0xffff,0x0,0x0,0xffffffff,0xffff,0x0
.long 0x0,0x0,0xffff,0x0,0x0,0x0,0xffff,0x0,0x0,0x0,0xffff,0x0,0x0,0x0,0xffff,0x0
.long 0x0,0x0,0xffff,0x0,0x0,0x0,0xffff,0x0,0x0,0x0,0xffff,0x0,0x0,0x0,0xffff,0x0
.long 0xffffffff,0x0,0x0,0x3f80,0xffffffff,0x0,0x0,0x3f80,0xffffffff,0x0,0x0,0x3f80,0xffffffff,0x0,0x0,0x3f80
.long 0x0,0xffffffff,0x0,0x3f80,0x0,0xffffffff,0x0,0x3f80,0x0,0xffffffff,0x0,0x3f80,0x0,0xffffffff,0x0,0x3f80
.long 0x0,0x0,0x0,0x3f80,0x0,0x0,0x0,0x3f80,0x0,0x0,0x0,0x3f80,0x0,0x0,0x0,0x3f80
.long 0x0,0x0,0x0,0x3f80,0x0,0x0,0x0,0x3f80,0x0,0x0,0x0,0x3f80,0x0,0x0,0x0,0x3f80
.long 0x0,0x0,0xffff,0x0,0x0,0x0,0xffff,0x0,0x0,0x0,0xffff,0x0,0x0,0x0,0xffff,0x0
.long 0x0,0x0,0xffff,0x0,0x0,0x0,0xffff,0x0,0x0,0x0,0xffff,0x0,0x0,0x0,0xffff,0x0
.long 0xffffffff,0x0,0xffff,0x0,0xffffffff,0x0,0xffff,0x0,0xffffffff,0x0,0xffff,0x0,0xffffffff,0x0,0xffff,0x0
.long 0x0,0xffffffff,0xffff,0x0,0x0,0xffffffff,0xffff,0x0,0x0,0xffffffff,0xffff,0x0,0x0,0xffffffff,0xffff,0x0
.long 0x0,0x0,0x0,0x3f80,0x0,0x0,0x0,0x3f80,0x0,0x0,0x0,0x3f80,0x0,0x0,0x0,0x3f80
.long 0x0,0x0,0x0,0x3f80,0x0,0x0,0x0,0x3f80,0x0,0x0,0x0,0x3f80,0x0,0x0,0x0,0x3f80
.long 0xffffffff,0x0,0x0,0x3f80,0xffffffff,0x0,0x0,0x3f80,0xffffffff,0x0,0x0,0x3f80,0xffffffff,0x0,0x0,0x3f80
.long 0x0,0xffffffff,0x0,0x3f80,0x0,0xffffffff,0x0,0x3f80,0x0,0xffffffff,0x0,0x3f80,0x0,0xffffffff,0x0,0x3f80
.long 0xffff,0x0,0x0,0x0,0xffff0000,0x0,0x0,0x0,0x0,0xffff,0x0,0x0,0x0,0xffff0000,0x0,0x0
.long 0x0,0x0,0xffff,0x0,0x0,0x0,0xffff0000,0x0,0x0,0x0,0x0,0xffff,0x0,0x0,0x0,0xffff0000
.long 0x0,0x0,0x0,0x0,0x0,0x0,0x0,0x0,0x0,0x0,0x0,0x0,0x0,0x0,0x0,0x0
.long 0x0,0x0,0x0,0x0,0x0,0x0,0x0,0x0,0x0,0x0,0x0,0x0,0x0,0x0,0x0,0x0
.long 0xffff,0x0,0x0,0x0,0xffff0000,0x0,0x0,0x0,0x0,0xffff,0x0,0x0,0x0,0xffff0000,0x0,0x0
.long 0x0,0x0,0xffff,0x0,0x0,0x0,0xffff0000,0x0,0x0,0x0,0x0,0xffff,0x0,0x0,0x0,0xffff0000
.long 0x0,0x0,0x0,0x0,0x0,0x0,0x0,0x0,0x0,0x0,0x0,0x0,0x0,0x0,0x0,0x0
.long 0x0,0x0,0x0,0x0,0x0,0x0,0x0,0x0,0x0,0x0,0x0,0x0,0x0,0x0,0x0,0x0
.long 0x0,0x0,0x0,0x0,0x0,0x0,0x0,0x0,0x0,0x0,0x0,0x0,0x0,0x0,0x0,0x0
.long 0x0,0x0,0x0,0x0,0x0,0x0,0x0,0x0,0x0,0x0,0x0,0x0,0x0,0x0,0x0,0x0
.long 0xffff,0x0,0x0,0x0,0xffff0000,0x0,0x0,0x0,0x0,0xffff,0x0,0x0,0x0,0xffff0000,0x0,0x0
.long 0x0,0x0,0xffff,0x0,0x0,0x0,0xffff0000,0x0,0x0,0x0,0x0,0xffff,0x0,0x0,0x0,0xffff0000
.long 0x0,0x0,0x0,0x0,0x0,0x0,0x0,0x0,0x0,0x0,0x0,0x0,0x0,0x0,0x0,0x0
.long 0x0,0x0,0x0,0x0,0x0,0x0,0x0,0x0,0x0,0x0,0x0,0x0,0x0,0x0,0x0,0x0
.long 0xffff,0x0,0x0,0x0,0xffff0000,0x0,0x0,0x0,0x0,0xffff,0x0,0x0,0x0,0xffff0000,0x0,0x0
.long 0x0,0x0,0xffff,0x0,0x0,0x0,0xffff0000,0x0,0x0,0x0,0x0,0xffff,0x0,0x0,0x0,0xffff0000
.long 0x0,0x0,0x0,0x0,0x0,0x0,0x0,0x0,0x0,0x0,0x0,0x0,0x0,0x0,0x0,0x0
.long 0x0,0x0,0x0,0x0,0x0,0x0,0x0,0x0,0x0,0x0,0x0,0x0,0x0,0x0,0x0,0x0
.long 0x0,0x0,0x0,0x0,0x0,0x0,0x0,0x0,0x0,0x0,0x0,0x0,0x0,0x0,0x0,0x0
.long 0x0,0x0,0x0,0x0,0x0,0x0,0x0,0x0,0x0,0x0,0x0,0x0,0x0,0x0,0x0,0x0
.long 0x0,0x0,0x0,0x0,0x0,0x0,0x0,0x0,0x0,0x0,0x0,0x0,0x0,0x0,0x0,0x0
.long 0x0,0x0,0x0,0x0,0x0,0x0,0x0,0x0,0x0,0x0,0x0,0x0,0x0,0x0,0x0,0x0
.long 0x0,0x0,0x0,0x0,0x0,0x0,0x0,0x0,0x0,0x0,0x0,0x0,0x0,0x0,0x0,0x0
.long 0x0,0x0,0x0,0x0,0x0,0x0,0x0,0x0,0x0,0x0,0x0,0x0,0x0,0x0,0x0,0x0
.long 0x0,0x0,0x0,0x0,0x0,0x0,0x0,0x0,0x0,0x0,0x0,0x0,0x0,0x0,0x0,0x0
.long 0x0,0x0,0x0,0x0,0x0,0x0,0x0,0x0,0x0,0x0,0x0,0x0,0x0,0x0,0x0,0x0
.long 0x0,0x0,0x0,0x0,0x0,0x0,0x0,0x0,0x0,0x0,0x0,0x0,0x0,0x0,0x0,0x0
.long 0x0,0x0,0x0,0x0,0x0,0x0,0x0,0x0,0x0,0x0,0x0,0x0,0x0,0x0,0x0,0x0
.long 0x0,0x0,0x0,0x0,0x0,0x0,0x0,0x0,0x0,0x0,0x0,0x0,0x0,0x0,0x0,0x0
.long 0x0,0x0,0x0,0x0,0x0,0x0,0x0,0x0,0x0,0x0,0x0,0x0,0x0,0x0,0x0,0x0
.long 0x0,0x0,0x0,0x0,0x0,0x0,0x0,0x0,0x0,0x0,0x0,0x0,0x0,0x0,0x0,0x0
.long 0x0,0x0,0x0,0x0,0x0,0x0,0x0,0x0,0x0,0x0,0x0,0x0,0x0,0x0,0x0,0x0
.size L_tab, 12288
.section .rodata,"a"
.p2align 6
.amdhsa_kernel standalone__window_attn_davit__vision_kernel
  .amdhsa_next_free_vgpr 512
  .amdhsa_next_free_sgpr 96
  .amdhsa_accum_offset 256
  .amdhsa_group_segment_fixed_size 0
  .amdhsa_kernarg_size 56
  .amdhsa_user_sgpr_count 2
  .amdhsa_user_sgpr_kernarg_segment_ptr 1
  .amdhsa_system_sgpr_workgroup_id_x 1
.end_amdhsa_kernel
```

```asm
; @launch grid=(256,1,1) block=(256,1,1) lds=163840
.amdgcn_target "amdgcn-amd-amdhsa--gfx950"
.text
.globl standalone__window_attn_davit__vision_kernel
.p2align 8
.type standalone__window_attn_davit__vision_kernel,@function
standalone__window_attn_davit__vision_kernel:
s_cmp_ge_u32 s2, 256
s_cbranch_scc1 L_end
v_lshrrev_b32 v1, 6, v0
s_mov_b32 s53, s2
s_mov_b32 s47, 0
v_readfirstlane_b32 s32, v1
s_nop 3
L_start:

s_load_dwordx8 s[56:63], s[0:1], 0
s_load_dwordx2 s[64:65], s[0:1], 32
s_load_dwordx2 s[66:67], s[0:1], 48
s_getpc_b64 s[68:69]
L_pc:
v_mbcnt_lo_u32_b32 v0, -1, 0
v_mbcnt_hi_u32_b32 v0, -1, v0
s_add_u32 s70, s68, L_tab-L_pc
s_addc_u32 s71, s69, 0
s_lshl_b32 s45, s32, 10
v_lshl_add_u32 v1, v0, 4, s45
s_add_u32 m0, s45, 143616
s_nop 0
global_load_lds_dwordx4 v1, s[70:71]
v_add_u32 v1, 4096, v1
s_add_u32 m0, s45, 147712
s_nop 0
global_load_lds_dwordx4 v1, s[70:71]
v_add_u32 v1, 4096, v1
s_add_u32 m0, s45, 151808
s_nop 0
global_load_lds_dwordx4 v1, s[70:71]
s_lshr_b32 s42, s53, 3
s_and_b32 s41, s42, 1
s_lshl_b32 s41, s41, 2
s_add_u32 s41, s41, s32
s_lshl_b32 s41, s41, 13
v_lshlrev_b32 v2, 7, v0
v_add_u32 v3, s41, v2
s_cmp_lt_u32 s42, 4
s_cbranch_scc0 L_nopf
global_load_dword v255, v3, s[68:69]
L_nopf:
s_and_b32 s41, s53, 7
s_mul_i32 s43, s41, 666
s_add_u32 s34, s43, 667
s_min_u32 s41, s41, 1
s_add_u32 s43, s43, s41
s_add_u32 s33, s43, s42
s_mov_b32 s35, s33
s_mov_b32 s72, 402653183
s_mul_i32 s54, s32, 96
s_mul_i32 s55, s32, 3072
s_mul_hi_u32 s41, s33, 58835169
s_mul_i32 s28, s41, 73
s_sub_u32 s28, s33, s28
s_mul_i32 s29, s41, 1373568
s_mul_i32 s41, s28, 2688
s_add_u32 s29, s29, s41
v_add_u32 v4, 0, v0
v_mul_u32_u24 v5, 171, v4
v_lshrrev_b32 v5, 10, v5
v_mul_u32_u24 v6, 6, v5
v_sub_u32 v6, v4, v6
v_lshlrev_b32 v6, 4, v6
v_mul_u32_u24 v7, 1152, v5
v_add_u32 v72, v7, v6
v_mul_u32_u24 v7, 384, v5
v_add_u32 v75, v7, v6
v_add_u32 v4, 64, v0
v_mul_u32_u24 v5, 171, v4
v_lshrrev_b32 v5, 10, v5
v_mul_u32_u24 v6, 6, v5
v_sub_u32 v6, v4, v6
v_lshlrev_b32 v6, 4, v6
v_mul_u32_u24 v7, 1152, v5
v_add_u32 v73, v7, v6
v_mul_u32_u24 v7, 384, v5
v_add_u32 v76, v7, v6
v_add_u32 v4, 128, v0
v_mul_u32_u24 v5, 171, v4
v_lshrrev_b32 v5, 10, v5
v_mul_u32_u24 v6, 6, v5
v_sub_u32 v6, v4, v6
v_lshlrev_b32 v6, 4, v6
v_mul_u32_u24 v7, 1152, v5
v_add_u32 v74, v7, v6
v_mul_u32_u24 v7, 384, v5
v_add_u32 v77, v7, v6
s_mul_i32 s41, s32, 54
v_add_u32 v4, s41, v0
v_mul_u32_u24 v5, 911, v4
v_lshrrev_b32 v5, 16, v5
v_mul_u32_u24 v6, 72, v5
v_sub_u32 v6, v4, v6
s_mov_b32 s43, 196224
v_mul_lo_u32 v5, v5, s43
v_lshl_add_u32 v8, v6, 4, v5
s_lshl_b32 s41, s32, 6
v_add_u32 v4, s41, v0
v_mul_u32_u24 v5, 2428, v4
v_lshrrev_b32 v5, 16, v5
v_mul_u32_u24 v6, 27, v5
v_sub_u32 v6, v4, v6
v_mul_lo_u32 v5, v5, s43
v_lshl_add_u32 v9, v6, 7, v5
v_mov_b32 v10, 268435456
v_cmp_gt_u32 vcc, 243, v4
s_nop 1
v_cndmask_b32 v9, v10, v9, vcc
s_waitcnt lgkmcnt(0)
s_mov_b32 s12, s60
s_mov_b32 s13, s61
s_mov_b32 s14, 221184
s_mov_b32 s15, 131072
s_mov_b32 s16, s62
s_mov_b32 s17, s63
s_mov_b32 s18, 73728
s_mov_b32 s19, 131072
s_lshl_b32 s41, s42, 13
s_cmp_eq_u32 s32, 0
s_cbranch_scc0 L_nopf2
buffer_load_dword v255, v2, s[12:15], s41 offen
L_nopf2:
s_and_b32 s41, s41, 131071
s_cmp_eq_u32 s32, 1
s_cbranch_scc0 L_nopf3
buffer_load_dword v255, v2, s[16:19], s41 offen
L_nopf3:
s_sub_u32 s4, s56, 196608
s_subb_u32 s5, s57, 0
s_mov_b32 s6, 100467072
s_mov_b32 s7, 131072
s_mov_b32 s20, s58
s_mov_b32 s21, s59
s_mov_b32 s22, 3456
s_mov_b32 s23, 131072
s_mov_b32 exec_hi, 4194303
s_mul_i32 s30, s32, 864
s_add_u32 m0, s30, 155904
s_nop 0
buffer_load_dwordx4 v75, s[20:23], s54 offen lds
s_add_u32 s40, s29, 785664
s_add_u32 m0, s30, 0
s_add_u32 s28, s28, 32
s_cmp_ge_u32 s28, 73
buffer_load_dwordx4 v8, s[4:7], s40 offen nt lds
s_cselect_b32 s41, 73, 0
s_cselect_b32 s43, 1177344, 0
s_sub_u32 s28, s28, s41
s_add_u32 s40, s40, s43
s_add_u32 s40, s40, 86016
s_add_u32 m0, s30, 3472
s_add_u32 s28, s28, 32
s_cmp_ge_u32 s28, 73
buffer_load_dwordx4 v8, s[4:7], s40 offen nt lds
s_cselect_b32 s41, 73, 0
s_cselect_b32 s43, 1177344, 0
s_sub_u32 s28, s28, s41
s_add_u32 s40, s40, s43
s_add_u32 s40, s40, 86016
s_add_u32 m0, s30, 6944
s_add_u32 s28, s28, 32
s_cmp_ge_u32 s28, 73
buffer_load_dwordx4 v8, s[4:7], s40 offen nt lds
s_cselect_b32 s41, 73, 0
s_cselect_b32 s43, 1177344, 0
s_sub_u32 s28, s28, s41
s_add_u32 s40, s40, s43
s_add_u32 s40, s40, 86016
s_add_u32 m0, s30, 10416
s_add_u32 s28, s28, 32
s_cmp_ge_u32 s28, 73
buffer_load_dwordx4 v8, s[4:7], s40 offen nt lds
s_cselect_b32 s41, 73, 0
s_cselect_b32 s43, 1177344, 0
s_sub_u32 s28, s28, s41
s_add_u32 s40, s40, s43
s_add_u32 s40, s40, 86016
s_add_u32 m0, s30, 13888
s_add_u32 s28, s28, 32
s_cmp_ge_u32 s28, 73
buffer_load_dwordx4 v8, s[4:7], s40 offen nt lds
s_cselect_b32 s41, 73, 0
s_cselect_b32 s43, 1177344, 0
s_sub_u32 s28, s28, s41
s_add_u32 s40, s40, s43
s_add_u32 s40, s40, 86016
s_add_u32 m0, s30, 17360
s_add_u32 s28, s28, 32
s_cmp_ge_u32 s28, 73
buffer_load_dwordx4 v8, s[4:7], s40 offen nt lds
s_cselect_b32 s41, 73, 0
s_cselect_b32 s43, 1177344, 0
s_sub_u32 s28, s28, s41
s_add_u32 s40, s40, s43
s_add_u32 s40, s40, 86016
s_add_u32 m0, s30, 20832
s_add_u32 s28, s28, 32
s_cmp_ge_u32 s28, 73
buffer_load_dwordx4 v8, s[4:7], s40 offen nt lds
s_cselect_b32 s41, 73, 0
s_cselect_b32 s43, 1177344, 0
s_sub_u32 s28, s28, s41
s_add_u32 s40, s40, s43
s_add_u32 s40, s40, 86016
s_add_u32 m0, s30, 24304
s_add_u32 s28, s28, 32
s_cmp_ge_u32 s28, 73
buffer_load_dwordx4 v8, s[4:7], s40 offen nt lds
s_cselect_b32 s41, 73, 0
s_cselect_b32 s43, 1177344, 0
s_sub_u32 s28, s28, s41
s_add_u32 s40, s40, s43
s_add_u32 s40, s40, 86016
s_add_u32 m0, s30, 27776
s_add_u32 s28, s28, 32
s_cmp_ge_u32 s28, 73
buffer_load_dwordx4 v8, s[4:7], s40 offen nt lds
s_cselect_b32 s41, 73, 0
s_cselect_b32 s43, 1177344, 0
s_sub_u32 s28, s28, s41
s_add_u32 s40, s40, s43
s_add_u32 s40, s40, 86016
s_add_u32 m0, s30, 31248
s_add_u32 s28, s28, 32
s_cmp_ge_u32 s28, 73
buffer_load_dwordx4 v8, s[4:7], s40 offen nt lds
s_cselect_b32 s41, 73, 0
s_cselect_b32 s43, 1177344, 0
s_sub_u32 s28, s28, s41
s_add_u32 s40, s40, s43
s_add_u32 s40, s40, 86016
s_add_u32 m0, s30, 34720
s_add_u32 s28, s28, 32
s_cmp_ge_u32 s28, 73
buffer_load_dwordx4 v8, s[4:7], s40 offen nt lds
s_cselect_b32 s41, 73, 0
s_cselect_b32 s43, 1177344, 0
s_sub_u32 s28, s28, s41
s_add_u32 s40, s40, s43
s_add_u32 s40, s40, 86016
s_add_u32 m0, s30, 38192
s_add_u32 s28, s28, 32
s_cmp_ge_u32 s28, 73
buffer_load_dwordx4 v8, s[4:7], s40 offen nt lds
s_cselect_b32 s41, 73, 0
s_cselect_b32 s43, 1177344, 0
s_sub_u32 s28, s28, s41
s_add_u32 s40, s40, s43
s_add_u32 s40, s40, 86016
s_add_u32 m0, s30, 41664
s_add_u32 s28, s28, 32
s_cmp_ge_u32 s28, 73
buffer_load_dwordx4 v8, s[4:7], s40 offen nt lds
s_cselect_b32 s41, 73, 0
s_cselect_b32 s43, 1177344, 0
s_sub_u32 s28, s28, s41
s_add_u32 s40, s40, s43
s_add_u32 s40, s40, 86016
s_add_u32 m0, s30, 45136
s_add_u32 s28, s28, 32
s_cmp_ge_u32 s28, 73
buffer_load_dwordx4 v8, s[4:7], s40 offen nt lds
s_cselect_b32 s41, 73, 0
s_cselect_b32 s43, 1177344, 0
s_sub_u32 s28, s28, s41
s_add_u32 s40, s40, s43
s_add_u32 s40, s40, 86016
s_add_u32 m0, s30, 48608
s_add_u32 s28, s28, 32
s_cmp_ge_u32 s28, 73
buffer_load_dwordx4 v8, s[4:7], s40 offen nt lds
s_cselect_b32 s41, 73, 0
s_cselect_b32 s43, 1177344, 0
s_sub_u32 s28, s28, s41
s_add_u32 s40, s40, s43
s_add_u32 s40, s40, 86016
s_add_u32 m0, s30, 52080
s_add_u32 s28, s28, 32
s_cmp_ge_u32 s28, 73
buffer_load_dwordx4 v8, s[4:7], s40 offen nt lds
s_cselect_b32 s41, 73, 0
s_cselect_b32 s43, 1177344, 0
s_sub_u32 s28, s28, s41
s_add_u32 s40, s40, s43
s_add_u32 s40, s40, 86016
s_add_u32 m0, s30, 55552
s_add_u32 s28, s28, 32
s_cmp_ge_u32 s28, 73
buffer_load_dwordx4 v8, s[4:7], s40 offen nt lds
s_cselect_b32 s41, 73, 0
s_cselect_b32 s43, 1177344, 0
s_sub_u32 s28, s28, s41
s_add_u32 s40, s40, s43
s_add_u32 s40, s40, 86016
s_add_u32 m0, s30, 59024
s_add_u32 s28, s28, 32
s_cmp_ge_u32 s28, 73
buffer_load_dwordx4 v8, s[4:7], s40 offen nt lds
s_cselect_b32 s41, 73, 0
s_cselect_b32 s43, 1177344, 0
s_sub_u32 s28, s28, s41
s_add_u32 s40, s40, s43
s_add_u32 s40, s40, 86016
s_add_u32 m0, s30, 62496
s_add_u32 s28, s28, 32
s_cmp_ge_u32 s28, 73
buffer_load_dwordx4 v8, s[4:7], s40 offen nt lds
s_cselect_b32 s41, 73, 0
s_cselect_b32 s43, 1177344, 0
s_sub_u32 s28, s28, s41
s_add_u32 s40, s40, s43
s_add_u32 s40, s40, 86016
s_add_u32 m0, s30, 65968
s_add_u32 s28, s28, 32
s_cmp_ge_u32 s28, 73
buffer_load_dwordx4 v8, s[4:7], s40 offen nt lds
s_cselect_b32 s41, 73, 0
s_cselect_b32 s43, 1177344, 0
s_sub_u32 s28, s28, s41
s_add_u32 s40, s40, s43
s_add_u32 s40, s40, 86016
s_add_u32 s41, s33, 640
s_cmp_lt_u32 s41, s34
s_cselect_b32 s40, s40, 1879048192
s_add_u32 m0, s30, 69440
s_nop 0
buffer_load_dwordx4 v8, s[4:7], s40 offen nt lds
s_mov_b64 exec, -1
s_max_u32 s41, s29, 196608
buffer_load_dword v255, v9, s[4:7], s41 offen nt
s_add_u32 m0, s55, 94464
s_add_u32 s29, s54, 384
buffer_load_dwordx4 v72, s[12:15], s29 offen lds
s_add_u32 m0, s55, 95488
s_add_u32 s29, s54, 384
buffer_load_dwordx4 v73, s[12:15], s29 offen lds
s_add_u32 m0, s55, 96512
s_add_u32 s29, s54, 384
buffer_load_dwordx4 v74, s[12:15], s29 offen lds
s_add_u32 m0, s55, 106752
s_add_u32 s29, s54, 37248
buffer_load_dwordx4 v72, s[12:15], s29 offen lds
s_add_u32 m0, s55, 107776
s_add_u32 s29, s54, 37248
buffer_load_dwordx4 v73, s[12:15], s29 offen lds
s_add_u32 m0, s55, 108800
s_add_u32 s29, s54, 37248
buffer_load_dwordx4 v74, s[12:15], s29 offen lds
s_add_u32 m0, s55, 119040
s_add_u32 s29, s54, 74112
buffer_load_dwordx4 v72, s[12:15], s29 offen lds
s_add_u32 m0, s55, 120064
s_add_u32 s29, s54, 74112
buffer_load_dwordx4 v73, s[12:15], s29 offen lds
s_add_u32 m0, s55, 121088
s_add_u32 s29, s54, 74112
buffer_load_dwordx4 v74, s[12:15], s29 offen lds
s_add_u32 m0, s55, 131328
s_add_u32 s29, s54, 110976
buffer_load_dwordx4 v72, s[12:15], s29 offen lds
s_add_u32 m0, s55, 132352
s_add_u32 s29, s54, 110976
buffer_load_dwordx4 v73, s[12:15], s29 offen lds
s_add_u32 m0, s55, 133376
s_add_u32 s29, s54, 110976
buffer_load_dwordx4 v74, s[12:15], s29 offen lds
s_add_u32 m0, s55, 78080
s_add_u32 s29, s54, 147840
buffer_load_dwordx4 v72, s[12:15], s29 offen lds
s_add_u32 m0, s55, 79104
s_add_u32 s29, s54, 147840
buffer_load_dwordx4 v73, s[12:15], s29 offen lds
s_add_u32 m0, s55, 80128
s_add_u32 s29, s54, 147840
buffer_load_dwordx4 v74, s[12:15], s29 offen lds
s_mov_b32 s8, s64
s_mov_b32 s9, s65
s_mov_b32 s10, 100270464
s_mov_b32 s11, 131072
s_mov_b32 s24, s66
s_mov_b32 s25, s67
s_mov_b32 s26, 6291456
s_mov_b32 s27, 131072
s_mov_b32 s48, 1001040555
s_mov_b32 s73, 1020061065
s_mov_b32 s49, 944335852
s_mov_b32 s3, 1074544643
v_mul_u32_u24 v5, 2622, v4
v_lshrrev_b32 v5, 16, v5
v_mul_u32_u24 v6, 25, v5
v_sub_u32 v6, v4, v6
v_mul_u32_u24 v7, 384, v5
v_lshl_add_u32 v7, v6, 4, v7
v_cmp_eq_u32 vcc, 0, v5
v_or_b32 v10, 134217728, v7
s_nop 0
v_cndmask_b32 v7, v7, v10, vcc
v_cmp_eq_u32 vcc, 8, v5
v_or_b32 v10, 536870912, v7
s_nop 0
v_cndmask_b32 v7, v7, v10, vcc
v_cmp_lt_u32 vcc, 8, v5
v_or_b32 v10, 268435456, v7
s_nop 0
v_cndmask_b32 v7, v7, v10, vcc
v_cmp_eq_u32 vcc, 24, v6
v_or_b32 v10, 268435456, v7
s_nop 0
v_cndmask_b32 v7, v7, v10, vcc
v_lshlrev_b32 v11, 4, v0
v_add_u32 v11, 143616, v11
s_waitcnt vmcnt(37)
s_barrier
ds_read_b128 v[194:197], v11
ds_read_b128 v[198:201], v11 offset:1024
ds_read_b128 v[202:205], v11 offset:2048
ds_read_b128 v[206:209], v11 offset:3072
ds_read_b128 v[210:213], v11 offset:4096
ds_read_b128 v[214:217], v11 offset:5120
ds_read_b128 v[78:81], v11 offset:6144
ds_read_b128 v[82:85], v11 offset:7168
ds_read_b128 v[138:141], v11 offset:8192
ds_read_b128 v[142:145], v11 offset:9216
ds_read_b128 v[146:149], v11 offset:10240
s_waitcnt lgkmcnt(7)
v_add_u32 v219, s45, v208
v_mov_b32 v208, v7
s_waitcnt lgkmcnt(5)
v_mov_b32 v216, v9
s_waitcnt lgkmcnt(2)
v_add_u32 v138, s30, v138
v_add_u32 v139, s30, v139
v_add_u32 v140, s30, v140
ds_read_u16 v150, v138
ds_read_u16 v151, v138 offset:192
ds_read_u16 v152, v139
ds_read_u16 v153, v139 offset:192
ds_read_u16 v154, v140
ds_read_u16 v155, v138 offset:32
ds_read_u16 v156, v138 offset:224
ds_read_u16 v157, v139 offset:32
ds_read_u16 v158, v139 offset:224
ds_read_u16 v159, v140 offset:32
ds_read_u16 v160, v138 offset:64
ds_read_u16 v161, v138 offset:256
ds_read_u16 v162, v139 offset:64
ds_read_u16 v163, v139 offset:256
ds_read_u16 v164, v140 offset:64
v_add_u32 v194, s54, v194
v_add_u32 v195, s54, v195
v_add_u32 v196, s54, v196
v_add_u32 v197, s54, v197
v_add_u32 v198, s54, v198
v_add_u32 v199, s54, v199
v_add_u32 v200, s54, v200
v_add_u32 v201, s54, v201
v_add_u32 v202, s54, v202
v_add_u32 v203, s54, v203
v_add_u32 v204, s54, v204
v_add_u32 v205, s54, v205
v_add_u32 v79, s54, v79
v_add_u32 v80, s54, v80
v_add_u32 v81, s54, v81
v_add_u32 v211, s45, v211
v_add_u32 v78, s55, v78
s_lshl_b32 s41, s54, 1
v_add_u32 v121, s41, v84
s_lshr_b32 s41, s32, 1
s_lshl_b32 s41, s41, 10
s_and_b32 s42, s32, 1
s_lshl_b32 s42, s42, 3
s_add_u32 s41, s41, s42
v_add_u32 v212, s41, v212
s_lshl_b32 s41, s32, 2
v_add_u32 v209, s41, v209
s_lshl_b32 s41, s32, 7
v_add_u32 v215, s41, v215
v_add_u32 v214, s41, v214
v_add_u32 v82, s41, v82
s_mul_i32 s41, s32, 4752
v_add_u32 v217, s41, v217
s_waitcnt lgkmcnt(0)
v_and_or_b32 v154, v154, v144, v145
v_lshl_or_b32 v154, v154, 16, v154
v_and_b32 v0, v154, v146
v_and_b32 v1, v154, v147
v_and_b32 v2, v154, v148
v_and_b32 v3, v154, v149
v_and_b32 v4, v150, v142
v_and_b32 v5, v150, v143
v_and_b32 v6, v151, v142
v_and_b32 v7, v151, v143
v_and_b32 v8, v152, v142
v_and_b32 v9, v152, v143
v_and_b32 v10, v153, v142
v_and_b32 v11, v153, v143
v_and_or_b32 v159, v159, v144, v145
v_lshl_or_b32 v159, v159, 16, v159
v_and_b32 v12, v159, v146
v_and_b32 v13, v159, v147
v_and_b32 v14, v159, v148
v_and_b32 v15, v159, v149
v_and_b32 v16, v155, v142
v_and_b32 v17, v155, v143
v_and_b32 v18, v156, v142
v_and_b32 v19, v156, v143
v_and_b32 v20, v157, v142
v_and_b32 v21, v157, v143
v_and_b32 v22, v158, v142
v_and_b32 v23, v158, v143
v_and_or_b32 v164, v164, v144, v145
v_lshl_or_b32 v164, v164, 16, v164
v_and_b32 v24, v164, v146
v_and_b32 v25, v164, v147
v_and_b32 v26, v164, v148
v_and_b32 v27, v164, v149
v_and_b32 v28, v160, v142
v_and_b32 v29, v160, v143
v_and_b32 v30, v161, v142
v_and_b32 v31, v161, v143
v_and_b32 v32, v162, v142
v_and_b32 v33, v162, v143
v_and_b32 v34, v163, v142
v_and_b32 v35, v163, v143
v_mov_b32 v190, 1065369472
v_mov_b32 v191, 1065369472
v_mov_b32 v192, 1065369472
v_mov_b32 v193, 1065369472
v_mov_b32 v218, 0
v_mov_b32 v220, 162624
s_mov_b32 s30, 16712191
s_mov_b32 s31, 4278255360
s_waitcnt vmcnt(16) lgkmcnt(0)
s_barrier
s_waitcnt vmcnt(10)
ds_read_b64_tr_b16 a[0:1], v78 offset:16384
ds_read_b64_tr_b16 a[24:25], v78 offset:16416
ds_read_b64_tr_b16 a[48:49], v78 offset:16448
ds_read_b64_tr_b16 a[2:3], v78 offset:17920
ds_read_b64_tr_b16 a[26:27], v78 offset:17952
ds_read_b64_tr_b16 a[50:51], v78 offset:17984
ds_read_b128 v[84:87], v81
ds_read_b128 v[92:95], v81 offset:55552
ds_read_b128 v[100:103], v79
s_mul_hi_u32 s41, s35, 58835169
s_mul_i32 s42, s41, 73
s_sub_u32 s42, s35, s42
s_mul_i32 s43, s41, 1373568
s_mul_i32 s51, s42, 2688
s_add_u32 s43, s43, s51
s_cmp_lt_u32 s35, s34
s_cselect_b32 s50, s43, 1879048192
s_add_u32 s35, s35, 32
s_cmp_eq_u32 s42, 0
s_cselect_b32 s44, 536870911, s72
s_cmp_eq_u32 s42, 72
s_cselect_b32 s44, 939524095, s44
s_cmp_eq_u32 s41, 0
s_cselect_b32 s52, 1879048192, s50
ds_read_b64_tr_b16 a[16:17], v78 offset:28672
ds_read_b64_tr_b16 a[40:41], v78 offset:28704
ds_read_b64_tr_b16 a[64:65], v78 offset:28736
ds_read_b128 v[104:107], v79 offset:16
v_and_b32 v180, s44, v208
s_mov_b32 s36, s50
s_waitcnt lgkmcnt(7)
s_add_u32 m0, s55, 94464
s_add_u32 s29, s54, 184704
buffer_load_dwordx4 v72, s[12:15], s29 offen lds
s_waitcnt lgkmcnt(6)
v_mfma_f32_16x16x32_bf16 v[36:39], v[0:3], v[84:87], 0
s_waitcnt vmcnt(10) lgkmcnt(5)
ds_read_b64_tr_b16 a[4:5], v78 offset:30208
ds_read_b64_tr_b16 a[28:29], v78 offset:30240
v_mfma_f32_16x16x32_bf16 v[48:51], v[0:3], v[92:95], 0
ds_read_b64_tr_b16 a[52:53], v78 offset:30272
s_add_u32 m0, s55, 95488
s_add_u32 s29, s54, 184704
buffer_load_dwordx4 v73, s[12:15], s29 offen lds
ds_read_b128 v[84:87], v79 offset:55552
ds_read_b128 v[88:91], v79 offset:55568
s_add_u32 m0, s55, 96512
s_add_u32 s29, s54, 184704
buffer_load_dwordx4 v74, s[12:15], s29 offen lds
ds_read_b128 v[92:95], v80
s_waitcnt lgkmcnt(6)
v_smfmac_f32_16x16x64_bf16 v[36:39], v[4:7], v[100:107], v213
ds_read_b128 v[96:99], v80 offset:16
ds_read_b128 v[100:103], v80 offset:55552
ds_read_b128 v[104:107], v80 offset:55568
ds_write_b32 v220, v218
s_waitcnt lgkmcnt(7)
s_mov_b64 exec, s[30:31]
ds_write_b128 v217, v[0:3]
s_mov_b64 exec, -1
s_add_u32 m0, s55, 106752
s_add_u32 s29, s54, 0
buffer_load_dwordx4 v72, s[12:15], s29 offen lds
s_waitcnt lgkmcnt(6)
v_smfmac_f32_16x16x64_bf16 v[48:51], v[4:7], v[84:91], v213
s_waitcnt vmcnt(11)
ds_read_b64_tr_b16 a[6:7], v78 offset:40960
ds_read_b64_tr_b16 a[30:31], v78 offset:40992
ds_read_b64_tr_b16 a[54:55], v78 offset:41024
s_waitcnt lgkmcnt(7)
v_smfmac_f32_16x16x64_bf16 v[36:39], v[8:11], v[92:99], v213
ds_read_b128 v[84:87], v81 offset:32
s_add_u32 m0, s55, 107776
s_add_u32 s29, s54, 0
buffer_load_dwordx4 v73, s[12:15], s29 offen lds
ds_read_b128 v[92:95], v81 offset:55584
ds_read_b128 v[88:91], v79 offset:55600
s_waitcnt lgkmcnt(8)
v_smfmac_f32_16x16x64_bf16 v[48:51], v[8:11], v[100:107], v213
s_waitcnt vmcnt(11)
ds_read_b64_tr_b16 a[18:19], v78 offset:42496
ds_read_b64_tr_b16 a[42:43], v78 offset:42528
ds_read_b64_tr_b16 a[66:67], v78 offset:42560
v_add_f32 v118, v36, v37
v_mul_f32 v119, v36, v36
s_add_u32 m0, s55, 108800
s_add_u32 s29, s54, 0
buffer_load_dwordx4 v74, s[12:15], s29 offen lds
ds_read_b128 v[100:103], v79 offset:32
ds_read_b128 v[104:107], v79 offset:48
ds_read_b128 v[96:99], v80 offset:48
v_add_f32 v118, v118, v38
v_fmac_f32 v119, v37, v37
v_add_f32 v118, v118, v39
v_fmac_f32 v119, v38, v38
v_fmac_f32 v119, v39, v39
v_add_f32 v126, v48, v49
v_mul_f32 v127, v48, v48
v_add_f32 v126, v126, v50
s_waitcnt lgkmcnt(8)
v_mfma_f32_16x16x32_bf16 v[40:43], v[12:15], v[84:87], 0
s_waitcnt lgkmcnt(7)
ds_read_b128 v[84:87], v79 offset:55584
s_mov_b64 exec, s[30:31]
ds_write_b128 v217, v[4:7] offset:528
s_mov_b64 exec, -1
v_mfma_f32_16x16x32_bf16 v[52:55], v[12:15], v[92:95], 0
s_waitcnt vmcnt(10) lgkmcnt(5)
s_add_u32 m0, s55, 119040
s_add_u32 s29, s54, 36864
buffer_load_dwordx4 v72, s[12:15], s29 offen lds
ds_read_b64_tr_b16 a[8:9], v78 offset:53248
ds_read_b64_tr_b16 a[32:33], v78 offset:53280
ds_read_b64_tr_b16 a[56:57], v78 offset:53312
ds_read_b128 v[92:95], v80 offset:32
s_add_u32 m0, s55, 120064
s_add_u32 s29, s54, 36864
buffer_load_dwordx4 v73, s[12:15], s29 offen lds
s_waitcnt lgkmcnt(7)
v_smfmac_f32_16x16x64_bf16 v[40:43], v[16:19], v[100:107], v213
s_waitcnt vmcnt(11) lgkmcnt(5)
ds_read_b64_tr_b16 a[10:11], v78 offset:54784
ds_read_b64_tr_b16 a[34:35], v78 offset:54816
v_smfmac_f32_16x16x64_bf16 v[52:55], v[16:19], v[84:91], v213
ds_read_b64_tr_b16 a[58:59], v78 offset:54848
ds_read_b128 v[100:103], v80 offset:55584
ds_read_b128 v[104:107], v80 offset:55600
ds_read_b128 v[84:87], v81 offset:64
v_fmac_f32 v127, v49, v49
s_add_u32 m0, s55, 121088
s_add_u32 s29, s54, 36864
buffer_load_dwordx4 v74, s[12:15], s29 offen lds
ds_read_b128 v[88:91], v79 offset:55632
s_mov_b64 exec, s[30:31]
ds_write_b128 v217, v[8:11] offset:1056
s_mov_b64 exec, -1
v_add_f32 v126, v126, v51
v_fmac_f32 v127, v50, v50
s_waitcnt lgkmcnt(8)
v_smfmac_f32_16x16x64_bf16 v[40:43], v[20:23], v[92:99], v213
s_waitcnt lgkmcnt(5)
s_add_u32 m0, s55, 131328
s_add_u32 s29, s54, 73728
buffer_load_dwordx4 v72, s[12:15], s29 offen lds
ds_read_b128 v[92:95], v81 offset:55616
ds_read_b128 v[96:99], v80 offset:80
s_waitcnt vmcnt(11)
ds_read_b64_tr_b16 a[20:21], v78
s_waitcnt lgkmcnt(6)
ds_read_b64_tr_b16 a[44:45], v78 offset:32
v_smfmac_f32_16x16x64_bf16 v[52:55], v[20:23], v[100:107], v213
s_waitcnt lgkmcnt(6)
ds_read_b64_tr_b16 a[68:69], v78 offset:64
ds_read_b128 v[100:103], v79 offset:64
v_mfma_f32_16x16x32_bf16 v[44:47], v[24:27], v[84:87], 0
ds_read_b128 v[104:107], v79 offset:80
s_add_u32 m0, s55, 132352
s_add_u32 s29, s54, 73728
buffer_load_dwordx4 v73, s[12:15], s29 offen lds
ds_read_b128 v[84:87], v79 offset:55616
v_fmac_f32 v127, v51, v51
s_waitcnt vmcnt(11)
ds_read_b64_tr_b16 a[12:13], v78 offset:1536
ds_read_b64_tr_b16 a[36:37], v78 offset:1568
ds_read_b64_tr_b16 a[60:61], v78 offset:1600
v_add_f32 v118, v118, v40
v_fmac_f32 v119, v40, v40
v_add_f32 v118, v118, v41
v_fmac_f32 v119, v41, v41
v_add_f32 v118, v118, v42
s_waitcnt lgkmcnt(10)
v_mfma_f32_16x16x32_bf16 v[56:59], v[24:27], v[92:95], 0
s_add_u32 m0, s55, 133376
s_add_u32 s29, s54, 73728
buffer_load_dwordx4 v74, s[12:15], s29 offen lds
ds_read_b128 v[92:95], v80 offset:64
s_mov_b64 exec, s[30:31]
ds_write_b128 v217, v[12:15] offset:1584
s_mov_b64 exec, -1
v_fmac_f32 v119, v42, v42
v_add_f32 v118, v118, v43
v_fmac_f32 v119, v43, v43
s_waitcnt lgkmcnt(6)
v_smfmac_f32_16x16x64_bf16 v[44:47], v[28:31], v[100:107], v213
s_waitcnt lgkmcnt(5)
ds_read_b128 v[100:103], v80 offset:55616
ds_read_b128 v[104:107], v80 offset:55632
v_smfmac_f32_16x16x64_bf16 v[56:59], v[28:31], v[84:91], v213
s_waitcnt vmcnt(10) lgkmcnt(4)
ds_read_b64_tr_b16 a[14:15], v78 offset:16384
ds_read_b64_tr_b16 a[38:39], v78 offset:16416
ds_read_b64_tr_b16 a[62:63], v78 offset:16448
s_add_u32 m0, s55, 78080
s_add_u32 s29, s54, 110592
buffer_load_dwordx4 v72, s[12:15], s29 offen lds
s_waitcnt lgkmcnt(6)
v_smfmac_f32_16x16x64_bf16 v[44:47], v[32:35], v[92:99], v213
s_mov_b64 exec, s[30:31]
ds_write_b128 v217, v[16:19] offset:2112
s_mov_b64 exec, -1
s_add_u32 m0, s55, 79104
s_add_u32 s29, s54, 110592
buffer_load_dwordx4 v73, s[12:15], s29 offen lds
s_waitcnt vmcnt(11)
ds_read_b64_tr_b16 a[22:23], v78 offset:17920
ds_read_b64_tr_b16 a[46:47], v78 offset:17952
ds_read_b64_tr_b16 a[70:71], v78 offset:17984
s_mov_b64 exec, s[30:31]
ds_write_b128 v217, v[20:23] offset:2640
s_mov_b64 exec, -1
s_waitcnt lgkmcnt(8)
v_smfmac_f32_16x16x64_bf16 v[56:59], v[32:35], v[100:107], v213
s_add_u32 m0, s55, 80128
s_add_u32 s29, s54, 110592
buffer_load_dwordx4 v74, s[12:15], s29 offen lds
s_mov_b64 exec, s[30:31]
ds_write_b128 v217, v[24:27] offset:3168
s_mov_b64 exec, -1
v_add_f32 v126, v126, v52
v_fmac_f32 v127, v52, v52
v_add_f32 v126, v126, v53
v_fmac_f32 v127, v53, v53
s_waitcnt vmcnt(10) lgkmcnt(2)
s_add_u32 m0, s55, 94464
s_add_u32 s29, s54, 147456
buffer_load_dwordx4 v72, s[12:15], s29 offen lds
ds_read_b64_tr_b16 a[216:217], v78 offset:28672
ds_read_b64_tr_b16 a[240:241], v78 offset:28704
ds_read_b64_tr_b16 v[232:233], v78 offset:28736
s_mov_b64 exec, s[30:31]
ds_write_b128 v217, v[28:31] offset:3696
s_mov_b64 exec, -1
s_add_u32 m0, s55, 95488
s_add_u32 s29, s54, 147456
buffer_load_dwordx4 v73, s[12:15], s29 offen lds
s_waitcnt vmcnt(11)
ds_read_b64_tr_b16 a[218:219], v78 offset:30208
ds_read_b64_tr_b16 a[242:243], v78 offset:30240
ds_read_b64_tr_b16 v[234:235], v78 offset:30272
s_mov_b64 exec, s[30:31]
ds_write_b128 v217, v[32:35] offset:4224
s_mov_b64 exec, -1
s_add_u32 m0, s55, 96512
s_add_u32 s29, s54, 147456
buffer_load_dwordx4 v74, s[12:15], s29 offen lds
v_add_f32 v126, v126, v54
v_fmac_f32 v127, v54, v54
v_add_f32 v126, v126, v55
v_add_f32 v118, v118, v44
v_fmac_f32 v127, v55, v55
v_fmac_f32 v119, v44, v44
v_add_f32 v118, v118, v45
v_fmac_f32 v119, v45, v45
v_add_f32 v118, v118, v46
v_fmac_f32 v119, v46, v46
v_add_f32 v118, v118, v47
v_fmac_f32 v119, v47, v47
v_add_f32 v126, v126, v56
v_fmac_f32 v127, v56, v56
s_waitcnt vmcnt(10) lgkmcnt(1)
s_add_u32 m0, s55, 106752
s_add_u32 s29, s54, 184320
buffer_load_dwordx4 v72, s[12:15], s29 offen lds
ds_read_b64_tr_b16 a[232:233], v78 offset:40960
ds_read_b64_tr_b16 v[224:225], v78 offset:40992
ds_read_b64_tr_b16 v[248:249], v78 offset:41024
v_add_f32 v126, v126, v57
v_fmac_f32 v127, v57, v57
v_add_f32 v126, v126, v58
v_fmac_f32 v127, v58, v58
v_add_f32 v126, v126, v59
s_add_u32 m0, s55, 107776
s_add_u32 s29, s54, 184320
buffer_load_dwordx4 v73, s[12:15], s29 offen lds
v_permlane16_swap_b32 v118, v119
s_waitcnt vmcnt(11)
ds_read_b64_tr_b16 a[220:221], v78 offset:42496
ds_read_b64_tr_b16 a[244:245], v78 offset:42528
ds_read_b64_tr_b16 v[236:237], v78 offset:42560
v_fmac_f32 v127, v59, v59
v_add_f32 v118, v118, v119
s_nop 0
v_permlane16_swap_b32 v126, v127
s_add_u32 m0, s55, 108800
s_add_u32 s29, s54, 184320
buffer_load_dwordx4 v74, s[12:15], s29 offen lds
v_add_f32 v126, v126, v127
s_nop 1
v_permlane32_swap_b32 v118, v126
v_add_f32 v118, v118, v126
ds_write_b32 v209, v118
s_waitcnt vmcnt(10) lgkmcnt(1)
s_add_u32 m0, s55, 119040
s_add_u32 s29, s54, 768
buffer_load_dwordx4 v72, s[12:15], s29 offen lds
ds_read_b64_tr_b16 a[222:223], v78 offset:53248
ds_read_b64_tr_b16 a[246:247], v78 offset:53280
ds_read_b64_tr_b16 v[238:239], v78 offset:53312
s_waitcnt vmcnt(10) lgkmcnt(3)
s_barrier
s_add_u32 m0, s55, 120064
s_add_u32 s29, s54, 768
buffer_load_dwordx4 v73, s[12:15], s29 offen lds
ds_read_b128 v[102:105], v210 offset:55296
ds_read_b128 v[106:109], v210 offset:56320
ds_read_b64_tr_b16 a[234:235], v78 offset:54784
ds_read_b64_tr_b16 v[226:227], v78 offset:54816
ds_read_b64_tr_b16 v[250:251], v78 offset:54848
s_add_u32 m0, s55, 121088
s_add_u32 s29, s54, 768
buffer_load_dwordx4 v74, s[12:15], s29 offen lds
s_waitcnt lgkmcnt(4)
v_add_f32 v102, v102, v103
v_add_f32 v104, v104, v105
v_add_f32 v102, v102, v104
v_mul_f32 v103, s48, v102
v_mul_f32 v104, s73, v102
s_waitcnt lgkmcnt(3)
v_add_f32 v106, v106, v107
v_add_f32 v108, v108, v109
v_add_f32 v106, v106, v108
v_mul_f32 v106, s73, v106
v_fma_f32 v106, -v103, v104, v106
s_waitcnt vmcnt(10) lgkmcnt(0)
s_add_u32 m0, s55, 131328
s_add_u32 s29, s54, 37632
buffer_load_dwordx4 v72, s[12:15], s29 offen lds
ds_read_b64_tr_b16 a[224:225], v78
ds_read_b64_tr_b16 a[248:249], v78 offset:32
ds_read_b64_tr_b16 v[240:241], v78 offset:64
v_max_f32 v106, 0, v106
v_add_f32 v106, s49, v106
v_rsq_f32 v102, v106
s_nop 0
v_mul_f32_e64 v103, -v103, v102
s_add_u32 m0, s55, 132352
s_add_u32 s29, s54, 37632
buffer_load_dwordx4 v73, s[12:15], s29 offen lds
ds_write_b64 v211, v[102:103] offset:36864
s_waitcnt vmcnt(11)
ds_read_b64_tr_b16 a[226:227], v78 offset:1536
ds_read_b64_tr_b16 a[250:251], v78 offset:1568
ds_read_b64_tr_b16 v[242:243], v78 offset:1600
ds_read_b64 v[118:119], v219
ds_read_b64 v[126:127], v219 offset:256
s_add_u32 m0, s55, 133376
s_add_u32 s29, s54, 37632
buffer_load_dwordx4 v74, s[12:15], s29 offen lds
s_waitcnt lgkmcnt(2)
s_add_u32 m0, s55, 78080
s_add_u32 s29, s54, 74496
buffer_load_dwordx4 v72, s[12:15], s29 offen lds
s_waitcnt lgkmcnt(1)
v_fma_f32 v220, v36, v118, v119
v_fma_f32 v221, v37, v118, v119
s_waitcnt vmcnt(11)
ds_read_b64_tr_b16 a[236:237], v78 offset:16384
ds_read_b64_tr_b16 v[228:229], v78 offset:16416
ds_read_b64_tr_b16 v[252:253], v78 offset:16448
v_cvt_pk_bf16_f32 v90, v220, v221
v_fma_f32 v222, v38, v118, v119
v_fma_f32 v223, v39, v118, v119
v_cvt_pk_bf16_f32 v91, v222, v223
v_fma_f32 v220, v40, v118, v119
s_add_u32 m0, s55, 79104
s_add_u32 s29, s54, 74496
buffer_load_dwordx4 v73, s[12:15], s29 offen lds
v_fma_f32 v221, v41, v118, v119
v_cvt_pk_bf16_f32 v92, v220, v221
s_waitcnt vmcnt(11)
ds_read_b64_tr_b16 a[228:229], v78 offset:17920
ds_read_b64_tr_b16 a[252:253], v78 offset:17952
ds_read_b64_tr_b16 v[244:245], v78 offset:17984
v_fma_f32 v222, v42, v118, v119
v_fma_f32 v223, v43, v118, v119
v_cvt_pk_bf16_f32 v93, v222, v223
v_fma_f32 v220, v44, v118, v119
v_fma_f32 v221, v45, v118, v119
s_waitcnt lgkmcnt(6)
s_add_u32 m0, s55, 80128
s_add_u32 s29, s54, 74496
buffer_load_dwordx4 v74, s[12:15], s29 offen lds
ds_write_b128 v211, v[90:93] offset:18432
v_cvt_pk_bf16_f32 v94, v220, v221
v_fma_f32 v222, v46, v118, v119
v_fma_f32 v223, v47, v118, v119
v_cvt_pk_bf16_f32 v95, v222, v223
v_fma_f32 v220, v48, v126, v127
v_fma_f32 v221, v49, v126, v127
s_waitcnt lgkmcnt(1)
s_add_u32 m0, s55, 94464
s_add_u32 s29, s54, 111360
buffer_load_dwordx4 v72, s[12:15], s29 offen lds
ds_write_b64 v212, v[94:95] offset:18432
v_cvt_pk_bf16_f32 v174, v220, v221
v_fma_f32 v222, v50, v126, v127
s_waitcnt vmcnt(11)
ds_read_b64_tr_b16 a[230:231], v78 offset:28672
ds_read_b64_tr_b16 a[254:255], v78 offset:28704
ds_read_b64_tr_b16 v[246:247], v78 offset:28736
v_fma_f32 v223, v51, v126, v127
v_cvt_pk_bf16_f32 v175, v222, v223
s_add_u32 m0, s55, 95488
s_add_u32 s29, s54, 111360
buffer_load_dwordx4 v73, s[12:15], s29 offen lds
v_fma_f32 v220, v52, v126, v127
v_fma_f32 v221, v53, v126, v127
s_waitcnt vmcnt(11)
ds_read_b64_tr_b16 a[238:239], v78 offset:30208
ds_read_b64_tr_b16 v[230:231], v78 offset:30240
ds_read_b64_tr_b16 v[254:255], v78 offset:30272
v_cvt_pk_bf16_f32 v176, v220, v221
v_fma_f32 v222, v54, v126, v127
v_fma_f32 v223, v55, v126, v127
v_cvt_pk_bf16_f32 v177, v222, v223
v_fma_f32 v220, v56, v126, v127
s_add_u32 m0, s55, 96512
s_add_u32 s29, s54, 111360
buffer_load_dwordx4 v74, s[12:15], s29 offen lds
ds_write_b128 v211, v[174:177] offset:24576
v_fma_f32 v221, v57, v126, v127
v_cvt_pk_bf16_f32 v178, v220, v221
v_fma_f32 v222, v58, v126, v127
v_fma_f32 v223, v59, v126, v127
v_cvt_pk_bf16_f32 v179, v222, v223
s_waitcnt vmcnt(9) lgkmcnt(1)
ds_write_b64 v212, v[178:179] offset:24576
s_add_u32 m0, s55, 106752
s_add_u32 s29, s54, 148224
buffer_load_dwordx4 v72, s[12:15], s29 offen lds
ds_read_b128 v[174:177], v217
ds_read_b64_tr_b16 a[72:73], v78 offset:40960
ds_read_b64_tr_b16 a[96:97], v78 offset:40992
ds_read_b64_tr_b16 a[120:121], v78 offset:41024
s_add_u32 m0, s55, 107776
s_add_u32 s29, s54, 148224
buffer_load_dwordx4 v73, s[12:15], s29 offen lds
ds_read_b64_tr_b16 a[74:75], v78 offset:42496
ds_read_b64_tr_b16 a[98:99], v78 offset:42528
ds_read_b64_tr_b16 a[122:123], v78 offset:42560
s_add_u32 m0, s55, 108800
s_add_u32 s29, s54, 148224
buffer_load_dwordx4 v74, s[12:15], s29 offen lds
s_waitcnt vmcnt(9) lgkmcnt(0)
s_add_u32 m0, s55, 119040
s_add_u32 s29, s54, 185088
buffer_load_dwordx4 v72, s[12:15], s29 offen lds
ds_read_b64_tr_b16 a[88:89], v78 offset:53248
ds_read_b64_tr_b16 a[112:113], v78 offset:53280
ds_read_b64_tr_b16 a[136:137], v78 offset:53312
s_add_u32 m0, s55, 120064
s_add_u32 s29, s54, 185088
buffer_load_dwordx4 v73, s[12:15], s29 offen lds
ds_read_b64_tr_b16 a[76:77], v78 offset:54784
ds_read_b64_tr_b16 a[100:101], v78 offset:54816
ds_read_b64_tr_b16 a[124:125], v78 offset:54848
s_add_u32 m0, s55, 121088
s_add_u32 s29, s54, 185088
buffer_load_dwordx4 v74, s[12:15], s29 offen lds
s_waitcnt vmcnt(10) lgkmcnt(0)
s_add_u32 m0, s55, 131328
s_add_u32 s29, s54, 0
buffer_load_dwordx4 v75, s[16:19], s29 offen lds
ds_read_b64_tr_b16 a[78:79], v78
ds_read_b64_tr_b16 a[102:103], v78 offset:32
ds_read_b64_tr_b16 a[126:127], v78 offset:64
s_add_u32 m0, s55, 132352
s_add_u32 s29, s54, 0
buffer_load_dwordx4 v76, s[16:19], s29 offen lds
s_waitcnt vmcnt(11)
ds_read_b64_tr_b16 a[90:91], v78 offset:1536
ds_read_b64_tr_b16 a[114:115], v78 offset:1568
ds_read_b64_tr_b16 a[138:139], v78 offset:1600
s_add_u32 m0, s55, 133376
s_add_u32 s29, s54, 0
buffer_load_dwordx4 v77, s[16:19], s29 offen lds
s_waitcnt lgkmcnt(0)
s_add_u32 m0, s55, 78080
s_add_u32 s29, s54, 12288
buffer_load_dwordx4 v75, s[16:19], s29 offen lds
s_waitcnt vmcnt(11)
ds_read_b64_tr_b16 a[80:81], v78 offset:16384
ds_read_b64_tr_b16 a[104:105], v78 offset:16416
ds_read_b64_tr_b16 a[128:129], v78 offset:16448
s_add_u32 m0, s55, 79104
s_add_u32 s29, s54, 12288
buffer_load_dwordx4 v76, s[16:19], s29 offen lds
s_waitcnt vmcnt(11)
ds_read_b64_tr_b16 a[82:83], v78 offset:17920
ds_read_b64_tr_b16 a[106:107], v78 offset:17952
ds_read_b64_tr_b16 a[130:131], v78 offset:17984
s_add_u32 m0, s55, 80128
s_add_u32 s29, s54, 12288
buffer_load_dwordx4 v77, s[16:19], s29 offen lds
s_waitcnt lgkmcnt(0)
s_add_u32 m0, s55, 94464
s_add_u32 s29, s54, 24576
buffer_load_dwordx4 v75, s[16:19], s29 offen lds
s_waitcnt vmcnt(11)
ds_read_b64_tr_b16 a[92:93], v78 offset:28672
ds_read_b64_tr_b16 a[116:117], v78 offset:28704
ds_read_b64_tr_b16 a[140:141], v78 offset:28736
s_add_u32 m0, s55, 95488
s_add_u32 s29, s54, 24576
buffer_load_dwordx4 v76, s[16:19], s29 offen lds
s_waitcnt vmcnt(11)
ds_read_b64_tr_b16 a[84:85], v78 offset:30208
ds_read_b64_tr_b16 a[108:109], v78 offset:30240
ds_read_b64_tr_b16 a[132:133], v78 offset:30272
s_add_u32 m0, s55, 96512
s_add_u32 s29, s54, 24576
buffer_load_dwordx4 v77, s[16:19], s29 offen lds
s_waitcnt lgkmcnt(0)
s_add_u32 m0, s55, 106752
s_add_u32 s29, s54, 36864
buffer_load_dwordx4 v75, s[16:19], s29 offen lds
s_waitcnt vmcnt(11)
ds_read_b64_tr_b16 a[86:87], v78 offset:40960
ds_read_b64_tr_b16 a[110:111], v78 offset:40992
ds_read_b64_tr_b16 a[134:135], v78 offset:41024
s_add_u32 m0, s55, 107776
s_add_u32 s29, s54, 36864
buffer_load_dwordx4 v76, s[16:19], s29 offen lds
s_waitcnt vmcnt(11)
ds_read_b64_tr_b16 a[94:95], v78 offset:42496
ds_read_b64_tr_b16 a[118:119], v78 offset:42528
ds_read_b64_tr_b16 a[142:143], v78 offset:42560
s_add_u32 m0, s55, 108800
s_add_u32 s29, s54, 36864
buffer_load_dwordx4 v77, s[16:19], s29 offen lds
s_waitcnt lgkmcnt(0)
s_add_u32 m0, s55, 119040
s_add_u32 s29, s54, 49152
buffer_load_dwordx4 v75, s[16:19], s29 offen lds
s_waitcnt vmcnt(11)
ds_read_b64_tr_b16 a[144:145], v78 offset:53248
ds_read_b64_tr_b16 a[168:169], v78 offset:53280
ds_read_b64_tr_b16 a[192:193], v78 offset:53312
s_add_u32 m0, s55, 120064
s_add_u32 s29, s54, 49152
buffer_load_dwordx4 v76, s[16:19], s29 offen lds
s_waitcnt vmcnt(11)
ds_read_b64_tr_b16 a[146:147], v78 offset:54784
ds_read_b64_tr_b16 a[170:171], v78 offset:54816
ds_read_b64_tr_b16 a[194:195], v78 offset:54848
s_add_u32 m0, s55, 121088
s_add_u32 s29, s54, 49152
buffer_load_dwordx4 v77, s[16:19], s29 offen lds
s_waitcnt lgkmcnt(0)
s_add_u32 m0, s55, 131328
s_add_u32 s29, s54, 61440
buffer_load_dwordx4 v75, s[16:19], s29 offen lds
s_waitcnt vmcnt(11)
ds_read_b64_tr_b16 a[160:161], v78
ds_read_b64_tr_b16 a[184:185], v78 offset:32
ds_read_b64_tr_b16 a[208:209], v78 offset:64
s_add_u32 m0, s55, 132352
s_add_u32 s29, s54, 61440
buffer_load_dwordx4 v76, s[16:19], s29 offen lds
s_waitcnt vmcnt(11)
ds_read_b64_tr_b16 a[148:149], v78 offset:1536
ds_read_b64_tr_b16 a[172:173], v78 offset:1568
ds_read_b64_tr_b16 a[196:197], v78 offset:1600
s_add_u32 m0, s55, 133376
s_add_u32 s29, s54, 61440
buffer_load_dwordx4 v77, s[16:19], s29 offen lds
s_add_u32 m0, s45, 0
s_nop 0
buffer_load_dwordx4 v180, s[4:7], s52 offen nt lds
s_mul_hi_u32 s41, s35, 58835169
s_mul_i32 s42, s41, 73
s_sub_u32 s42, s35, s42
s_mul_i32 s43, s41, 1373568
s_mul_i32 s51, s42, 2688
s_add_u32 s43, s43, s51
s_cmp_lt_u32 s35, s34
s_cselect_b32 s50, s43, 1879048192
s_add_u32 s35, s35, 32
s_cmp_eq_u32 s42, 0
s_cselect_b32 s44, 536870911, s72
s_cmp_eq_u32 s42, 72
s_cselect_b32 s44, 939524095, s44
s_cmp_eq_u32 s41, 0
s_cselect_b32 s52, 1879048192, s50
s_waitcnt vmcnt(11)
ds_read_b64_tr_b16 a[150:151], v78 offset:16384
ds_read_b64_tr_b16 a[174:175], v78 offset:16416
ds_read_b64_tr_b16 a[198:199], v78 offset:16448
s_add_u32 m0, s45, 4112
s_add_u32 s40, s36, 196224
buffer_load_dwordx4 v180, s[4:7], s40 offen nt lds
s_waitcnt vmcnt(11)
ds_read_b64_tr_b16 a[162:163], v78 offset:17920
ds_read_b64_tr_b16 a[186:187], v78 offset:17952
ds_read_b64_tr_b16 a[210:211], v78 offset:17984
s_mov_b32 s37, s50
s_add_u32 m0, s45, 8224
s_add_u32 s40, s36, 392448
buffer_load_dwordx4 v180, s[4:7], s40 offen nt lds
s_add_u32 m0, s45, 12336
s_add_u32 s40, s36, 588672
buffer_load_dwordx4 v180, s[4:7], s40 offen nt lds
s_waitcnt vmcnt(11)
ds_read_b64_tr_b16 a[152:153], v78 offset:28672
ds_read_b64_tr_b16 a[176:177], v78 offset:28704
ds_read_b64_tr_b16 a[200:201], v78 offset:28736
s_add_u32 m0, s45, 16448
s_add_u32 s40, s36, 784896
buffer_load_dwordx4 v180, s[4:7], s40 offen nt lds
s_waitcnt vmcnt(11)
ds_read_b64_tr_b16 a[154:155], v78 offset:30208
ds_read_b64_tr_b16 a[178:179], v78 offset:30240
ds_read_b64_tr_b16 a[202:203], v78 offset:30272
s_add_u32 m0, s45, 20560
s_add_u32 s40, s36, 981120
buffer_load_dwordx4 v180, s[4:7], s40 offen nt lds
s_add_u32 m0, s45, 24672
s_add_u32 s40, s36, 1177344
buffer_load_dwordx4 v180, s[4:7], s40 offen nt lds
s_add_u32 m0, s45, 28784
s_add_u32 s40, s36, 1373568
buffer_load_dwordx4 v180, s[4:7], s40 offen nt lds
s_waitcnt vmcnt(12)
ds_read_b64_tr_b16 a[164:165], v78 offset:40960
ds_read_b64_tr_b16 a[188:189], v78 offset:40992
ds_read_b64_tr_b16 a[212:213], v78 offset:41024
s_add_u32 m0, s45, 32896
s_add_u32 s40, s36, 1569792
buffer_load_dwordx4 v180, s[4:7], s40 offen nt lds
ds_read_b128 v[178:181], v217 offset:528
s_waitcnt vmcnt(12)
ds_read_b64_tr_b16 a[156:157], v78 offset:42496
ds_read_b64_tr_b16 a[180:181], v78 offset:42528
ds_read_b64_tr_b16 a[204:205], v78 offset:42560
s_waitcnt vmcnt(10)
ds_read_b64_tr_b16 a[158:159], v78 offset:53248
ds_read_b64_tr_b16 a[182:183], v78 offset:53280
ds_read_b64_tr_b16 a[206:207], v78 offset:53312
s_waitcnt vmcnt(9)
ds_read_b64_tr_b16 a[166:167], v78 offset:54784
ds_read_b64_tr_b16 a[190:191], v78 offset:54816
ds_read_b64_tr_b16 a[214:215], v78 offset:54848
s_waitcnt vmcnt(0)
s_barrier
ds_read_b128 v[84:87], v200
ds_read_b128 v[92:95], v201
ds_read_b128 v[100:103], v202
ds_read_b128 v[88:91], v194 offset:16
ds_read_b128 v[96:99], v195 offset:16
ds_read_b128 v[104:107], v196 offset:16
ds_read_b128 v[182:185], v210 offset:18432
ds_read_b128 v[186:189], v210 offset:24576
ds_read_b128 v[114:117], v210 offset:19456
s_waitcnt lgkmcnt(8)
v_mfma_f32_16x16x32_bf16 v[0:3], v[174:177], v[84:87], 0
ds_read_b128 v[84:87], v194
s_waitcnt lgkmcnt(8)
v_mfma_f32_16x16x32_bf16 v[12:15], v[174:177], v[92:95], 0
ds_read_b128 v[92:95], v195
s_waitcnt lgkmcnt(8)
v_mfma_f32_16x16x32_bf16 v[24:27], v[174:177], v[100:103], 0
ds_read_b128 v[100:103], v196
ds_read_b128 v[174:177], v217 offset:1056
ds_read_b128 v[122:125], v210 offset:25600
s_waitcnt lgkmcnt(7)
v_mfma_f32_16x16x32_bf16 v[138:141], a[0:3], v[182:185], 0
v_mfma_f32_16x16x32_bf16 v[142:145], a[24:27], v[182:185], 0
v_mfma_f32_16x16x32_bf16 v[146:149], a[48:51], v[182:185], 0
ds_read_b128 v[182:185], v210 offset:22528
s_waitcnt lgkmcnt(5)
v_smfmac_f32_16x16x64_bf16 v[0:3], v[178:181], v[84:91], v213
ds_read_b128 v[84:87], v197
ds_read_b128 v[88:91], v197 offset:16
v_mfma_f32_16x16x32_bf16 v[150:153], a[0:3], v[186:189], 0
s_waitcnt lgkmcnt(6)
v_smfmac_f32_16x16x64_bf16 v[12:15], v[178:181], v[92:99], v213
s_waitcnt lgkmcnt(5)
ds_read_b128 v[92:95], v198
ds_read_b128 v[96:99], v198 offset:16
v_smfmac_f32_16x16x64_bf16 v[24:27], v[178:181], v[100:107], v213
ds_read_b128 v[100:103], v199
ds_read_b128 v[104:107], v199 offset:16
v_mfma_f32_16x16x32_bf16 v[154:157], a[24:27], v[186:189], 0
ds_read_b128 v[178:181], v217 offset:1584
v_mfma_f32_16x16x32_bf16 v[158:161], a[48:51], v[186:189], 0
ds_read_b128 v[186:189], v210 offset:28672
v_mfma_f32_16x16x32_bf16 v[138:141], a[4:7], v[114:117], v[138:141]
s_waitcnt lgkmcnt(6)
v_smfmac_f32_16x16x64_bf16 v[0:3], v[174:177], v[84:91], v213
ds_read_b128 v[84:87], v200 offset:32
ds_read_b128 v[88:91], v194 offset:48
v_mfma_f32_16x16x32_bf16 v[142:145], a[28:31], v[114:117], v[142:145]
s_waitcnt lgkmcnt(6)
v_smfmac_f32_16x16x64_bf16 v[12:15], v[174:177], v[92:99], v213
ds_read_b128 v[92:95], v201 offset:32
ds_read_b128 v[96:99], v195 offset:48
v_mfma_f32_16x16x32_bf16 v[146:149], a[52:55], v[114:117], v[146:149]
ds_read_b128 v[114:117], v210 offset:20480
v_add_f32 v118, v0, v1
v_mfma_f32_16x16x32_bf16 v[150:153], a[4:7], v[122:125], v[150:153]
s_waitcnt lgkmcnt(7)
v_mul_f32 v119, v0, v0
v_add_f32 v118, v118, v2
v_smfmac_f32_16x16x64_bf16 v[24:27], v[174:177], v[100:107], v213
ds_read_b128 v[100:103], v202 offset:32
ds_read_b128 v[174:177], v217 offset:2112
v_mfma_f32_16x16x32_bf16 v[154:157], a[28:31], v[122:125], v[154:157]
ds_read_b128 v[104:107], v196 offset:48
v_fmac_f32 v119, v1, v1
v_mfma_f32_16x16x32_bf16 v[158:161], a[52:55], v[122:125], v[158:161]
s_waitcnt lgkmcnt(7)
ds_read_b128 v[122:125], v210 offset:26624
v_add_f32 v118, v118, v3
v_mfma_f32_16x16x32_bf16 v[4:7], v[178:181], v[84:87], 0
ds_read_b128 v[84:87], v194 offset:32
v_fmac_f32 v119, v2, v2
v_mfma_f32_16x16x32_bf16 v[138:141], a[16:19], v[182:185], v[138:141]
s_waitcnt lgkmcnt(7)
v_fmac_f32 v119, v3, v3
v_add_f32 v126, v12, v13
v_mfma_f32_16x16x32_bf16 v[16:19], v[178:181], v[92:95], 0
ds_read_b128 v[92:95], v195 offset:32
v_mul_f32 v127, v12, v12
v_mfma_f32_16x16x32_bf16 v[142:145], a[40:43], v[182:185], v[142:145]
v_add_f32 v126, v126, v14
v_fmac_f32 v127, v13, v13
v_mfma_f32_16x16x32_bf16 v[146:149], a[64:67], v[182:185], v[146:149]
s_waitcnt lgkmcnt(5)
ds_read_b128 v[182:185], v210 offset:21504
v_add_f32 v126, v126, v15
v_mfma_f32_16x16x32_bf16 v[28:31], v[178:181], v[100:103], 0
ds_read_b128 v[100:103], v196 offset:32
ds_read_b128 v[178:181], v217 offset:2640
v_mfma_f32_16x16x32_bf16 v[150:153], a[16:19], v[186:189], v[150:153]
v_fmac_f32 v127, v14, v14
v_fmac_f32 v127, v15, v15
v_mfma_f32_16x16x32_bf16 v[154:157], a[40:43], v[186:189], v[154:157]
v_add_f32 v134, v24, v25
v_mul_f32 v135, v24, v24
v_mfma_f32_16x16x32_bf16 v[158:161], a[64:67], v[186:189], v[158:161]
s_waitcnt lgkmcnt(4)
ds_read_b128 v[186:189], v210 offset:27648
v_add_f32 v134, v134, v26
v_smfmac_f32_16x16x64_bf16 v[4:7], v[174:177], v[84:91], v213
s_waitcnt lgkmcnt(4)
ds_read_b128 v[84:87], v197 offset:32
ds_read_b128 v[88:91], v197 offset:48
v_smfmac_f32_16x16x64_bf16 v[16:19], v[174:177], v[92:99], v213
ds_read_b128 v[92:95], v198 offset:32
ds_read_b128 v[96:99], v198 offset:48
v_mfma_f32_16x16x32_bf16 v[138:141], a[8:11], v[114:117], v[138:141]
s_waitcnt lgkmcnt(6)
v_fmac_f32 v135, v25, v25
v_add_f32 v134, v134, v27
v_smfmac_f32_16x16x64_bf16 v[28:31], v[174:177], v[100:107], v213
ds_read_b128 v[100:103], v199 offset:32
ds_read_b128 v[104:107], v199 offset:48
v_mfma_f32_16x16x32_bf16 v[142:145], a[32:35], v[114:117], v[142:145]
ds_read_b128 v[174:177], v217 offset:3168
v_fmac_f32 v135, v26, v26
v_mfma_f32_16x16x32_bf16 v[146:149], a[56:59], v[114:117], v[146:149]
ds_read_b128 v[114:117], v210 offset:23552
v_fmac_f32 v135, v27, v27
v_mfma_f32_16x16x32_bf16 v[150:153], a[8:11], v[122:125], v[150:153]
s_waitcnt lgkmcnt(6)
v_smfmac_f32_16x16x64_bf16 v[4:7], v[178:181], v[84:91], v213
ds_read_b128 v[84:87], v200 offset:64
ds_read_b128 v[88:91], v194 offset:80
v_mfma_f32_16x16x32_bf16 v[154:157], a[32:35], v[122:125], v[154:157]
s_waitcnt lgkmcnt(6)
v_smfmac_f32_16x16x64_bf16 v[16:19], v[178:181], v[92:99], v213
ds_read_b128 v[92:95], v201 offset:64
ds_read_b128 v[96:99], v195 offset:80
v_mfma_f32_16x16x32_bf16 v[158:161], a[56:59], v[122:125], v[158:161]
ds_read_b128 v[122:125], v210 offset:29696
v_add_f32 v118, v118, v4
v_mfma_f32_16x16x32_bf16 v[138:141], a[12:15], v[182:185], v[138:141]
s_waitcnt lgkmcnt(7)
v_fmac_f32 v119, v4, v4
v_add_f32 v118, v118, v5
v_smfmac_f32_16x16x64_bf16 v[28:31], v[178:181], v[100:107], v213
ds_read_b128 v[100:103], v202 offset:64
ds_read_b128 v[178:181], v217 offset:3696
v_mfma_f32_16x16x32_bf16 v[142:145], a[36:39], v[182:185], v[142:145]
ds_read_b128 v[104:107], v196 offset:80
v_fmac_f32 v119, v5, v5
v_mfma_f32_16x16x32_bf16 v[146:149], a[60:63], v[182:185], v[146:149]
s_waitcnt lgkmcnt(7)
ds_read_b128 v[182:185], v210 offset:18432
v_add_f32 v118, v118, v6
v_mfma_f32_16x16x32_bf16 v[8:11], v[174:177], v[84:87], 0
ds_read_b128 v[84:87], v194 offset:64
v_fmac_f32 v119, v6, v6
v_mfma_f32_16x16x32_bf16 v[150:153], a[12:15], v[186:189], v[150:153]
s_waitcnt lgkmcnt(7)
v_add_f32 v118, v118, v7
v_fmac_f32 v119, v7, v7
v_mfma_f32_16x16x32_bf16 v[20:23], v[174:177], v[92:95], 0
ds_read_b128 v[92:95], v195 offset:64
v_add_f32 v126, v126, v16
v_mfma_f32_16x16x32_bf16 v[154:157], a[36:39], v[186:189], v[154:157]
v_fmac_f32 v127, v16, v16
v_add_f32 v126, v126, v17
v_mfma_f32_16x16x32_bf16 v[158:161], a[60:63], v[186:189], v[158:161]
s_waitcnt lgkmcnt(5)
ds_read_b128 v[186:189], v210 offset:24576
v_fmac_f32 v127, v17, v17
v_mfma_f32_16x16x32_bf16 v[32:35], v[174:177], v[100:103], 0
ds_read_b128 v[100:103], v196 offset:64
ds_read_b128 v[174:177], v217 offset:4224
v_mfma_f32_16x16x32_bf16 v[138:141], a[20:23], v[114:117], v[138:141]
v_add_f32 v126, v126, v18
v_fmac_f32 v127, v18, v18
v_mfma_f32_16x16x32_bf16 v[142:145], a[44:47], v[114:117], v[142:145]
v_add_f32 v126, v126, v19
v_fmac_f32 v127, v19, v19
v_mfma_f32_16x16x32_bf16 v[146:149], a[68:71], v[114:117], v[146:149]
s_waitcnt lgkmcnt(4)
ds_read_b128 v[114:117], v210 offset:19456
v_add_f32 v134, v134, v28
v_smfmac_f32_16x16x64_bf16 v[8:11], v[178:181], v[84:91], v213
s_waitcnt lgkmcnt(4)
ds_read_b128 v[84:87], v197 offset:64
ds_read_b128 v[88:91], v197 offset:80
v_smfmac_f32_16x16x64_bf16 v[20:23], v[178:181], v[92:99], v213
ds_read_b128 v[92:95], v198 offset:64
ds_read_b128 v[96:99], v198 offset:80
v_mfma_f32_16x16x32_bf16 v[150:153], a[20:23], v[122:125], v[150:153]
s_waitcnt lgkmcnt(6)
v_fmac_f32 v135, v28, v28
v_add_f32 v134, v134, v29
v_smfmac_f32_16x16x64_bf16 v[32:35], v[178:181], v[100:107], v213
ds_read_b128 v[100:103], v199 offset:64
ds_read_b128 v[104:107], v199 offset:80
v_mfma_f32_16x16x32_bf16 v[154:157], a[44:47], v[122:125], v[154:157]
v_and_b32 v180, s44, v208
v_fmac_f32 v135, v29, v29
v_mfma_f32_16x16x32_bf16 v[158:161], a[68:71], v[122:125], v[158:161]
ds_read_b128 v[122:125], v210 offset:25600
v_add_f32 v134, v134, v30
v_fmac_f32 v135, v30, v30
v_add_f32 v134, v134, v31
v_fmac_f32 v135, v31, v31
v_cvt_pk_bf16_f32 v60, v138, v139
v_cvt_pk_bf16_f32 v61, v140, v141
v_cvt_pk_bf16_f32 v62, v142, v143
s_waitcnt lgkmcnt(5)
v_smfmac_f32_16x16x64_bf16 v[8:11], v[174:177], v[84:91], v213
v_cvt_pk_bf16_f32 v63, v144, v145
v_mfma_f32_16x16x32_bf16 v[138:141], a[216:219], v[182:185], 0
s_waitcnt lgkmcnt(3)
v_cvt_pk_bf16_f32 v64, v146, v147
v_cvt_pk_bf16_f32 v65, v148, v149
v_smfmac_f32_16x16x64_bf16 v[20:23], v[174:177], v[92:99], v213
v_add_f32 v118, v118, v8
v_mfma_f32_16x16x32_bf16 v[142:145], a[240:243], v[182:185], 0
s_waitcnt lgkmcnt(1)
v_fmac_f32 v119, v8, v8
v_add_f32 v118, v118, v9
v_smfmac_f32_16x16x64_bf16 v[32:35], v[174:177], v[100:107], v213
v_fmac_f32 v119, v9, v9
v_mfma_f32_16x16x32_bf16 v[146:149], v[232:235], v[182:185], 0
ds_read_b128 v[182:185], v210 offset:22528
v_add_f32 v118, v118, v10
v_mfma_f32_16x16x32_bf16 v[138:141], a[220:223], v[114:117], v[138:141]
v_fmac_f32 v119, v10, v10
v_add_f32 v118, v118, v11
v_mfma_f32_16x16x32_bf16 v[142:145], a[244:247], v[114:117], v[142:145]
v_fmac_f32 v119, v11, v11
v_add_f32 v126, v126, v20
v_mfma_f32_16x16x32_bf16 v[146:149], v[236:239], v[114:117], v[146:149]
ds_read_b128 v[114:117], v210 offset:20480
v_fmac_f32 v127, v20, v20
v_add_f32 v126, v126, v21
v_fmac_f32 v127, v21, v21
v_add_f32 v126, v126, v22
v_fmac_f32 v127, v22, v22
v_add_f32 v126, v126, v23
v_fmac_f32 v127, v23, v23
v_add_f32 v134, v134, v32
v_fmac_f32 v135, v32, v32
v_add_f32 v134, v134, v33
v_fmac_f32 v135, v33, v33
s_waitcnt lgkmcnt(1)
v_mfma_f32_16x16x32_bf16 v[138:141], a[232:235], v[182:185], v[138:141]
v_add_f32 v134, v134, v34
v_fmac_f32 v135, v34, v34
v_mfma_f32_16x16x32_bf16 v[142:145], v[224:227], v[182:185], v[142:145]
v_add_f32 v134, v134, v35
v_fmac_f32 v135, v35, v35
v_mfma_f32_16x16x32_bf16 v[146:149], v[248:251], v[182:185], v[146:149]
s_waitcnt lgkmcnt(0)
ds_read_b128 v[182:185], v210 offset:21504
v_cvt_pk_bf16_f32 v66, v150, v151
v_mfma_f32_16x16x32_bf16 v[138:141], a[224:227], v[114:117], v[138:141]
v_permlane16_swap_b32 v118, v119
v_mfma_f32_16x16x32_bf16 v[142:145], a[248:251], v[114:117], v[142:145]
v_add_f32 v118, v118, v119
v_cvt_pk_bf16_f32 v67, v152, v153
v_mfma_f32_16x16x32_bf16 v[150:153], a[216:219], v[186:189], 0
v_permlane16_swap_b32 v126, v127
v_mfma_f32_16x16x32_bf16 v[150:153], a[220:223], v[122:125], v[150:153]
v_add_f32 v126, v126, v127
v_cvt_pk_bf16_f32 v68, v154, v155
v_mfma_f32_16x16x32_bf16 v[146:149], v[240:243], v[114:117], v[146:149]
ds_read_b128 v[114:117], v210 offset:23552
v_permlane16_swap_b32 v134, v135
v_add_f32 v134, v134, v135
s_waitcnt lgkmcnt(1)
v_mfma_f32_16x16x32_bf16 v[138:141], a[228:231], v[182:185], v[138:141]
v_permlane32_swap_b32 v118, v126
v_mfma_f32_16x16x32_bf16 v[142:145], a[252:255], v[182:185], v[142:145]
v_add_f32 v118, v118, v126
v_mov_b32 v135, v134
v_mfma_f32_16x16x32_bf16 v[146:149], v[244:247], v[182:185], v[146:149]
ds_write_b32 v209, v118
v_permlane32_swap_b32 v134, v135
v_add_f32 v134, v134, v135
s_waitcnt lgkmcnt(1)
ds_write_b32 v209, v134 offset:512
v_mfma_f32_16x16x32_bf16 v[138:141], a[236:239], v[114:117], v[138:141]
ds_read_b128 v[182:185], v210 offset:18432
v_cvt_pk_bf16_f32 v69, v156, v157
v_mfma_f32_16x16x32_bf16 v[154:157], a[240:243], v[186:189], 0
v_cvt_pk_bf16_f32 v70, v158, v159
v_cvt_pk_bf16_f32 v71, v160, v161
v_mfma_f32_16x16x32_bf16 v[158:161], v[232:235], v[186:189], 0
ds_read_b128 v[186:189], v210 offset:28672
v_cvt_pk_bf16_f32 v162, v138, v139
v_mfma_f32_16x16x32_bf16 v[154:157], a[244:247], v[122:125], v[154:157]
v_cvt_pk_bf16_f32 v163, v140, v141
v_mfma_f32_16x16x32_bf16 v[158:161], v[236:239], v[122:125], v[158:161]
ds_read_b128 v[122:125], v210 offset:26624
s_waitcnt lgkmcnt(3)
s_barrier
v_mfma_f32_16x16x32_bf16 v[142:145], v[228:231], v[114:117], v[142:145]
s_add_u32 m0, s45, 0
s_nop 0
buffer_load_dwordx4 v180, s[4:7], s52 offen nt lds
v_mfma_f32_16x16x32_bf16 v[146:149], v[252:255], v[114:117], v[146:149]
s_mul_hi_u32 s41, s35, 58835169
s_mul_i32 s42, s41, 73
s_sub_u32 s42, s35, s42
s_mul_i32 s43, s41, 1373568
s_mul_i32 s51, s42, 2688
s_add_u32 s43, s43, s51
s_cmp_lt_u32 s35, s34
s_cselect_b32 s50, s43, 1879048192
s_add_u32 s35, s35, 32
s_cmp_eq_u32 s42, 0
s_cselect_b32 s44, 536870911, s72
s_cmp_eq_u32 s42, 72
s_cselect_b32 s44, 939524095, s44
s_cmp_eq_u32 s41, 0
s_cselect_b32 s52, 1879048192, s50
s_waitcnt lgkmcnt(1)
v_mfma_f32_16x16x32_bf16 v[150:153], a[232:235], v[186:189], v[150:153]
s_add_u32 m0, s45, 4112
s_add_u32 s40, s37, 196224
buffer_load_dwordx4 v180, s[4:7], s40 offen nt lds
v_mfma_f32_16x16x32_bf16 v[154:157], v[224:227], v[186:189], v[154:157]
s_add_u32 m0, s45, 8224
s_add_u32 s40, s37, 392448
buffer_load_dwordx4 v180, s[4:7], s40 offen nt lds
v_mfma_f32_16x16x32_bf16 v[158:161], v[248:251], v[186:189], v[158:161]
s_waitcnt lgkmcnt(0)
s_add_u32 m0, s45, 12336
s_add_u32 s40, s37, 588672
buffer_load_dwordx4 v180, s[4:7], s40 offen nt lds
v_mfma_f32_16x16x32_bf16 v[150:153], a[224:227], v[122:125], v[150:153]
s_add_u32 m0, s45, 16448
s_add_u32 s40, s37, 784896
buffer_load_dwordx4 v180, s[4:7], s40 offen nt lds
v_mfma_f32_16x16x32_bf16 v[154:157], a[248:251], v[122:125], v[154:157]
s_add_u32 m0, s45, 20560
s_add_u32 s40, s37, 981120
buffer_load_dwordx4 v180, s[4:7], s40 offen nt lds
v_mfma_f32_16x16x32_bf16 v[158:161], v[240:243], v[122:125], v[158:161]
s_add_u32 m0, s45, 24672
s_add_u32 s40, s37, 1177344
buffer_load_dwordx4 v180, s[4:7], s40 offen nt lds
v_mfma_f32_16x16x32_bf16 v[138:141], a[72:75], v[182:185], 0
s_add_u32 m0, s45, 28784
s_add_u32 s40, s37, 1373568
buffer_load_dwordx4 v180, s[4:7], s40 offen nt lds
ds_read_b128 v[102:105], v210 offset:55296
ds_read_b128 v[106:109], v210 offset:56320
ds_read_b128 v[186:189], v210 offset:27648
ds_read_b128 v[122:125], v210 offset:29696
ds_read_b128 v[114:117], v210 offset:19456
v_cvt_pk_bf16_f32 v164, v142, v143
s_add_u32 m0, s45, 32896
s_add_u32 s40, s37, 1569792
buffer_load_dwordx4 v180, s[4:7], s40 offen nt lds
v_cvt_pk_bf16_f32 v165, v144, v145
v_mfma_f32_16x16x32_bf16 v[142:145], a[96:99], v[182:185], 0
v_cvt_pk_bf16_f32 v166, v146, v147
v_cvt_pk_bf16_f32 v167, v148, v149
v_mfma_f32_16x16x32_bf16 v[146:149], a[120:123], v[182:185], 0
ds_read_b128 v[182:185], v210 offset:22528
s_waitcnt lgkmcnt(5)
v_add_f32 v102, v102, v103
v_add_f32 v104, v104, v105
v_add_f32 v102, v102, v104
v_mul_f32 v103, s48, v102
v_mul_f32 v104, s73, v102
s_waitcnt lgkmcnt(4)
v_add_f32 v106, v106, v107
v_add_f32 v108, v108, v109
v_add_f32 v106, v106, v108
v_mul_f32 v106, s73, v106
v_fma_f32 v106, -v103, v104, v106
s_waitcnt lgkmcnt(3)
v_mfma_f32_16x16x32_bf16 v[150:153], a[228:231], v[186:189], v[150:153]
v_max_f32 v106, 0, v106
v_add_f32 v106, s49, v106
v_mfma_f32_16x16x32_bf16 v[154:157], a[252:255], v[186:189], v[154:157]
v_rsq_f32 v102, v106
v_mfma_f32_16x16x32_bf16 v[158:161], v[244:247], v[186:189], v[158:161]
s_waitcnt lgkmcnt(2)
ds_read_b128 v[186:189], v210 offset:24576
v_mul_f32_e64 v103, -v103, v102
v_mfma_f32_16x16x32_bf16 v[150:153], a[236:239], v[122:125], v[150:153]
ds_write_b64 v211, v[102:103] offset:36864
v_mfma_f32_16x16x32_bf16 v[154:157], v[228:231], v[122:125], v[154:157]
v_mfma_f32_16x16x32_bf16 v[158:161], v[252:255], v[122:125], v[158:161]
s_waitcnt lgkmcnt(3)
ds_read_b64 v[118:119], v219
ds_read_b64 v[126:127], v219 offset:256
v_mfma_f32_16x16x32_bf16 v[138:141], a[76:79], v[114:117], v[138:141]
ds_read_b64 v[134:135], v219 offset:512
ds_read_b128 v[122:125], v210 offset:25600
v_mfma_f32_16x16x32_bf16 v[142:145], a[100:103], v[114:117], v[142:145]
s_waitcnt lgkmcnt(5)
v_cvt_pk_bf16_f32 v168, v150, v151
v_cvt_pk_bf16_f32 v169, v152, v153
v_mfma_f32_16x16x32_bf16 v[150:153], a[72:75], v[186:189], 0
v_cvt_pk_bf16_f32 v170, v154, v155
v_cvt_pk_bf16_f32 v171, v156, v157
v_mfma_f32_16x16x32_bf16 v[154:157], a[96:99], v[186:189], 0
v_cvt_pk_bf16_f32 v172, v158, v159
v_cvt_pk_bf16_f32 v173, v160, v161
v_mfma_f32_16x16x32_bf16 v[158:161], a[120:123], v[186:189], 0
s_waitcnt lgkmcnt(3)
ds_read_b128 v[186:189], v210 offset:28672
v_fma_f32 v220, v0, v118, v119
v_mfma_f32_16x16x32_bf16 v[146:149], a[124:127], v[114:117], v[146:149]
ds_read_b128 v[114:117], v210 offset:20480
v_fma_f32 v221, v1, v118, v119
v_mfma_f32_16x16x32_bf16 v[138:141], a[88:91], v[182:185], v[138:141]
s_waitcnt lgkmcnt(2)
v_cvt_pk_bf16_f32 v90, v220, v221
v_fma_f32 v222, v2, v118, v119
v_mfma_f32_16x16x32_bf16 v[150:153], a[76:79], v[122:125], v[150:153]
v_fma_f32 v223, v3, v118, v119
v_cvt_pk_bf16_f32 v91, v222, v223
v_mfma_f32_16x16x32_bf16 v[154:157], a[100:103], v[122:125], v[154:157]
v_fma_f32 v220, v4, v118, v119
v_fma_f32 v221, v5, v118, v119
v_mfma_f32_16x16x32_bf16 v[158:161], a[124:127], v[122:125], v[158:161]
ds_read_b128 v[122:125], v210 offset:26624
v_cvt_pk_bf16_f32 v92, v220, v221
v_mfma_f32_16x16x32_bf16 v[142:145], a[112:115], v[182:185], v[142:145]
v_fma_f32 v222, v6, v118, v119
v_fma_f32 v223, v7, v118, v119
v_mfma_f32_16x16x32_bf16 v[146:149], a[136:139], v[182:185], v[146:149]
s_waitcnt lgkmcnt(2)
ds_read_b128 v[182:185], v210 offset:21504
v_cvt_pk_bf16_f32 v93, v222, v223
v_mfma_f32_16x16x32_bf16 v[150:153], a[88:91], v[186:189], v[150:153]
ds_write_b128 v211, v[90:93]
v_mfma_f32_16x16x32_bf16 v[154:157], a[112:115], v[186:189], v[154:157]
v_fma_f32 v220, v8, v118, v119
v_fma_f32 v221, v9, v118, v119
v_mfma_f32_16x16x32_bf16 v[158:161], a[136:139], v[186:189], v[158:161]
s_waitcnt lgkmcnt(3)
v_cvt_pk_bf16_f32 v94, v220, v221
v_fma_f32 v222, v10, v118, v119
v_mfma_f32_16x16x32_bf16 v[138:141], a[80:83], v[114:117], v[138:141]
ds_read_b128 v[186:189], v210 offset:27648
v_fma_f32 v223, v11, v118, v119
v_mfma_f32_16x16x32_bf16 v[142:145], a[104:107], v[114:117], v[142:145]
v_cvt_pk_bf16_f32 v95, v222, v223
v_fma_f32 v220, v12, v126, v127
v_mfma_f32_16x16x32_bf16 v[146:149], a[128:131], v[114:117], v[146:149]
s_waitcnt lgkmcnt(3)
ds_write_b64 v212, v[94:95]
v_mfma_f32_16x16x32_bf16 v[150:153], a[80:83], v[122:125], v[150:153]
v_fma_f32 v221, v13, v126, v127
v_cvt_pk_bf16_f32 v174, v220, v221
v_mfma_f32_16x16x32_bf16 v[154:157], a[104:107], v[122:125], v[154:157]
ds_read_b128 v[114:117], v210 offset:23552
v_fma_f32 v222, v14, v126, v127
v_mfma_f32_16x16x32_bf16 v[158:161], a[128:131], v[122:125], v[158:161]
s_waitcnt lgkmcnt(4)
ds_read_b128 v[122:125], v210 offset:29696
v_fma_f32 v223, v15, v126, v127
v_mfma_f32_16x16x32_bf16 v[138:141], a[84:87], v[182:185], v[138:141]
v_cvt_pk_bf16_f32 v175, v222, v223
v_fma_f32 v220, v16, v126, v127
v_mfma_f32_16x16x32_bf16 v[142:145], a[108:111], v[182:185], v[142:145]
v_fma_f32 v221, v17, v126, v127
v_cvt_pk_bf16_f32 v176, v220, v221
v_mfma_f32_16x16x32_bf16 v[146:149], a[132:135], v[182:185], v[146:149]
s_waitcnt lgkmcnt(3)
v_fma_f32 v222, v18, v126, v127
v_fma_f32 v223, v19, v126, v127
v_mfma_f32_16x16x32_bf16 v[150:153], a[84:87], v[186:189], v[150:153]
v_cvt_pk_bf16_f32 v177, v222, v223
v_fma_f32 v220, v20, v126, v127
v_mfma_f32_16x16x32_bf16 v[154:157], a[108:111], v[186:189], v[154:157]
ds_write_b128 v211, v[174:177] offset:6144
v_mfma_f32_16x16x32_bf16 v[158:161], a[132:135], v[186:189], v[158:161]
s_waitcnt lgkmcnt(2)
v_fma_f32 v221, v21, v126, v127
v_cvt_pk_bf16_f32 v178, v220, v221
v_mfma_f32_16x16x32_bf16 v[138:141], a[92:95], v[114:117], v[138:141]
v_fma_f32 v222, v22, v126, v127
v_fma_f32 v223, v23, v126, v127
v_mfma_f32_16x16x32_bf16 v[142:145], a[116:119], v[114:117], v[142:145]
v_cvt_pk_bf16_f32 v179, v222, v223
v_fma_f32 v220, v24, v134, v135
v_mfma_f32_16x16x32_bf16 v[146:149], a[140:143], v[114:117], v[146:149]
s_waitcnt lgkmcnt(1)
ds_write_b64 v212, v[178:179] offset:6144
v_mfma_f32_16x16x32_bf16 v[150:153], a[92:95], v[122:125], v[150:153]
v_fma_f32 v221, v25, v134, v135
v_cvt_pk_bf16_f32 v90, v220, v221
v_mfma_f32_16x16x32_bf16 v[154:157], a[116:119], v[122:125], v[154:157]
v_fma_f32 v222, v26, v134, v135
v_fma_f32 v223, v27, v134, v135
v_mfma_f32_16x16x32_bf16 v[158:161], a[140:143], v[122:125], v[158:161]
v_cvt_pk_bf16_f32 v91, v222, v223
v_fma_f32 v220, v28, v134, v135
v_fma_f32 v221, v29, v134, v135
v_cvt_pk_bf16_f32 v92, v220, v221
v_fma_f32 v222, v30, v134, v135
v_fma_f32 v223, v31, v134, v135
v_cvt_pk_bf16_f32 v93, v222, v223
v_fma_f32 v220, v32, v134, v135
v_fma_f32 v221, v33, v134, v135
v_cvt_pk_bf16_f32 v94, v220, v221
v_fma_f32 v222, v34, v134, v135
v_fma_f32 v223, v35, v134, v135
v_cvt_pk_bf16_f32 v95, v222, v223
ds_write_b128 v211, v[90:93] offset:12288
v_cvt_pk_bf16_f32 v138, v138, v139
v_cvt_pk_bf16_f32 v139, v140, v141
v_cvt_pk_bf16_f32 v140, v142, v143
v_cvt_pk_bf16_f32 v141, v144, v145
v_cvt_pk_bf16_f32 v142, v146, v147
v_cvt_pk_bf16_f32 v143, v148, v149
ds_write_b64 v212, v[94:95] offset:12288
v_cvt_pk_bf16_f32 v144, v150, v151
v_cvt_pk_bf16_f32 v145, v152, v153
v_cvt_pk_bf16_f32 v146, v154, v155
v_cvt_pk_bf16_f32 v147, v156, v157
v_cvt_pk_bf16_f32 v148, v158, v159
v_cvt_pk_bf16_f32 v149, v160, v161
s_waitcnt lgkmcnt(0)
s_barrier
ds_write_b128 v121, v[36:39]
ds_write_b128 v121, v[40:43] offset:64
ds_write_b128 v121, v[44:47] offset:128
ds_write_b128 v82, v[162:165]
ds_write_b64 v82, v[166:167] offset:16
ds_write_b128 v82, v[60:63] offset:512
ds_write_b64 v82, v[64:65] offset:528
ds_write_b128 v82, v[138:141] offset:1024
ds_write_b64 v82, v[142:143] offset:1040
s_mov_b32 exec_lo, 2031647
s_mov_b32 exec_hi, 2031647
ds_write_b128 v121, v[48:51] offset:12544
ds_write_b128 v121, v[52:55] offset:12608
ds_write_b128 v121, v[56:59] offset:12672
ds_write_b128 v82, v[168:171] offset:24832
ds_write_b64 v82, v[172:173] offset:24848
ds_write_b128 v82, v[66:69] offset:25344
ds_write_b64 v82, v[70:71] offset:25360
ds_write_b128 v82, v[144:147] offset:25856
ds_write_b64 v82, v[148:149] offset:25872
s_mov_b64 exec, -1
s_waitcnt vmcnt(0) lgkmcnt(0)
s_nop 7
s_cmp_lg_u32 s47, 0
s_cbranch_scc1 L_safe
ds_read_b128 v[174:177], v217
ds_read_b128 v[178:181], v217 offset:528
s_add_u32 m0, s45, 0
s_mov_b32 s38, s36
s_mov_b32 s36, s50
s_barrier
ds_read_b128 v[84:87], v200
ds_read_b128 v[92:95], v201
ds_read_b128 v[100:103], v202
ds_read_b128 v[88:91], v194 offset:16
ds_read_b128 v[96:99], v195 offset:16
ds_read_b128 v[104:107], v196 offset:16
ds_read_b64 v[112:113], v215 offset:528
s_waitcnt lgkmcnt(6)
v_mfma_f32_16x16x32_bf16 v[36:39], v[174:177], v[84:87], 0
ds_read_b128 v[84:87], v194
s_waitcnt lgkmcnt(6)
v_mfma_f32_16x16x32_bf16 v[48:51], v[174:177], v[92:95], 0
ds_read_b128 v[92:95], v195
ds_read_b128 v[182:185], v210
s_waitcnt lgkmcnt(2)
v_smfmac_f32_16x16x64_bf16 v[36:39], v[178:181], v[84:91], v213
ds_read_b128 v[84:87], v197
ds_read_b128 v[88:91], v197 offset:16
v_mfma_f32_16x16x32_bf16 v[60:63], v[174:177], v[100:103], 0
s_waitcnt lgkmcnt(3)
ds_read_b128 v[100:103], v196
ds_read_b128 v[174:177], v217 offset:1056
ds_read_b128 v[186:189], v210 offset:1024
v_smfmac_f32_16x16x64_bf16 v[48:51], v[178:181], v[92:99], v213
ds_read_b128 v[92:95], v198
s_waitcnt lgkmcnt(6)
ds_read_b128 v[96:99], v198 offset:16
v_mfma_f32_16x16x32_bf16 v[138:141], a[0:3], v[182:185], 0
v_mfma_f32_16x16x32_bf16 v[142:145], a[24:27], v[182:185], 0
v_mfma_f32_16x16x32_bf16 v[146:149], a[48:51], v[182:185], 0
s_waitcnt lgkmcnt(4)
v_smfmac_f32_16x16x64_bf16 v[60:63], v[178:181], v[100:107], v213
ds_read_b128 v[100:103], v199
ds_read_b128 v[104:107], v199 offset:16
v_mfma_f32_16x16x32_bf16 v[150:153], a[216:219], v[182:185], 0
ds_read_b128 v[178:181], v217 offset:1584
s_waitcnt lgkmcnt(6)
v_smfmac_f32_16x16x64_bf16 v[36:39], v[174:177], v[84:91], v213
ds_read_b128 v[84:87], v200 offset:32
ds_read_b128 v[88:91], v194 offset:48
v_mfma_f32_16x16x32_bf16 v[154:157], a[240:243], v[182:185], 0
s_waitcnt lgkmcnt(5)
v_smfmac_f32_16x16x64_bf16 v[48:51], v[174:177], v[92:99], v213
ds_read_b128 v[92:95], v201 offset:32
ds_read_b128 v[96:99], v195 offset:48
v_mfma_f32_16x16x32_bf16 v[158:161], v[232:235], v[182:185], 0
v_mul_f32 v119, v36, v36
v_add_f32 v118, v36, v37
v_mfma_f32_16x16x32_bf16 v[162:165], v[182:185], a[72:75], 0
v_mul_f32 v127, v48, v48
v_add_f32 v126, v48, v49
s_waitcnt lgkmcnt(5)
v_smfmac_f32_16x16x64_bf16 v[60:63], v[174:177], v[100:107], v213
ds_read_b128 v[100:103], v202 offset:32
ds_read_b128 v[174:177], v217 offset:2112
v_mfma_f32_16x16x32_bf16 v[166:169], v[182:185], a[96:99], 0
s_waitcnt lgkmcnt(5)
ds_read_b128 v[104:107], v196 offset:48
v_fmac_f32 v119, v37, v37
v_mfma_f32_16x16x32_bf16 v[40:43], v[178:181], v[84:87], 0
ds_read_b128 v[84:87], v194 offset:32
v_mul_f32 v135, v60, v60
v_mfma_f32_16x16x32_bf16 v[170:173], v[182:185], a[120:123], 0
s_waitcnt lgkmcnt(5)
ds_read_b128 v[182:185], v210 offset:2048
v_add_f32 v134, v60, v61
v_mfma_f32_16x16x32_bf16 v[52:55], v[178:181], v[92:95], 0
ds_read_b128 v[92:95], v195 offset:32
v_fmac_f32 v135, v61, v61
v_mfma_f32_16x16x32_bf16 v[138:141], a[4:7], v[186:189], v[138:141]
v_fmac_f32 v127, v49, v49
v_add_f32 v134, v134, v62
v_mfma_f32_16x16x32_bf16 v[142:145], a[28:31], v[186:189], v[142:145]
s_waitcnt lgkmcnt(5)
v_fmac_f32 v135, v62, v62
v_add_f32 v118, v118, v38
v_mfma_f32_16x16x32_bf16 v[64:67], v[178:181], v[100:103], 0
ds_read_b128 v[100:103], v196 offset:32
ds_read_b128 v[178:181], v217 offset:2640
v_mfma_f32_16x16x32_bf16 v[146:149], a[52:55], v[186:189], v[146:149]
v_add_f32 v126, v126, v50
v_fmac_f32 v119, v38, v38
v_mfma_f32_16x16x32_bf16 v[150:153], a[220:223], v[186:189], v[150:153]
s_waitcnt lgkmcnt(4)
v_fmac_f32 v127, v50, v50
v_add_f32 v134, v134, v63
v_smfmac_f32_16x16x64_bf16 v[40:43], v[174:177], v[84:91], v213
ds_read_b128 v[84:87], v197 offset:32
ds_read_b128 v[88:91], v197 offset:48
v_mfma_f32_16x16x32_bf16 v[154:157], a[244:247], v[186:189], v[154:157]
v_fmac_f32 v135, v63, v63
s_waitcnt lgkmcnt(4)
v_smfmac_f32_16x16x64_bf16 v[52:55], v[174:177], v[92:99], v213
ds_read_b128 v[92:95], v198 offset:32
ds_read_b128 v[96:99], v198 offset:48
s_waitcnt lgkmcnt(5)
v_smfmac_f32_16x16x64_bf16 v[64:67], v[174:177], v[100:107], v213
ds_read_b128 v[100:103], v199 offset:32
ds_read_b128 v[104:107], v199 offset:48
v_mfma_f32_16x16x32_bf16 v[158:161], v[236:239], v[186:189], v[158:161]
ds_read_b128 v[174:177], v217 offset:3168
v_add_f32 v118, v118, v39
v_mfma_f32_16x16x32_bf16 v[162:165], v[186:189], a[76:79], v[162:165]
v_add_f32 v126, v126, v51
v_fmac_f32 v119, v39, v39
v_mfma_f32_16x16x32_bf16 v[166:169], v[186:189], a[100:103], v[166:169]
v_fmac_f32 v127, v51, v51
s_waitcnt lgkmcnt(5)
v_smfmac_f32_16x16x64_bf16 v[40:43], v[178:181], v[84:91], v213
ds_read_b128 v[84:87], v200 offset:64
ds_read_b128 v[88:91], v194 offset:80
v_mfma_f32_16x16x32_bf16 v[170:173], v[186:189], a[124:127], v[170:173]
ds_read_b128 v[186:189], v210 offset:3072
s_waitcnt lgkmcnt(6)
v_smfmac_f32_16x16x64_bf16 v[52:55], v[178:181], v[92:99], v213
ds_read_b128 v[92:95], v201 offset:64
ds_read_b128 v[96:99], v195 offset:80
v_mfma_f32_16x16x32_bf16 v[138:141], a[8:11], v[182:185], v[138:141]
v_add_f32 v118, v118, v40
v_fmac_f32 v119, v40, v40
v_mfma_f32_16x16x32_bf16 v[142:145], a[32:35], v[182:185], v[142:145]
s_waitcnt lgkmcnt(6)
v_add_f32 v126, v126, v52
v_fmac_f32 v127, v52, v52
v_smfmac_f32_16x16x64_bf16 v[64:67], v[178:181], v[100:107], v213
ds_read_b128 v[100:103], v202 offset:64
ds_read_b128 v[178:181], v217 offset:3696
v_mfma_f32_16x16x32_bf16 v[146:149], a[56:59], v[182:185], v[146:149]
s_waitcnt lgkmcnt(6)
ds_read_b128 v[104:107], v196 offset:80
v_add_f32 v118, v118, v41
v_mfma_f32_16x16x32_bf16 v[44:47], v[174:177], v[84:87], 0
ds_read_b128 v[84:87], v194 offset:64
v_add_f32 v134, v134, v64
v_mfma_f32_16x16x32_bf16 v[150:153], a[224:227], v[182:185], v[150:153]
v_fmac_f32 v135, v64, v64
v_mfma_f32_16x16x32_bf16 v[154:157], a[248:251], v[182:185], v[154:157]
s_waitcnt lgkmcnt(5)
v_add_f32 v134, v134, v65
v_fmac_f32 v135, v65, v65
v_mfma_f32_16x16x32_bf16 v[56:59], v[174:177], v[92:95], 0
ds_read_b128 v[92:95], v195 offset:64
v_fmac_f32 v119, v41, v41
s_waitcnt lgkmcnt(4)
v_mfma_f32_16x16x32_bf16 v[68:71], v[174:177], v[100:103], 0
ds_read_b128 v[100:103], v196 offset:64
ds_read_b128 v[174:177], v217 offset:4224
v_mfma_f32_16x16x32_bf16 v[158:161], v[240:243], v[182:185], v[158:161]
v_add_f32 v126, v126, v53
v_fmac_f32 v127, v53, v53
v_mfma_f32_16x16x32_bf16 v[162:165], v[182:185], a[80:83], v[162:165]
s_waitcnt lgkmcnt(3)
v_add_f32 v134, v134, v66
v_fmac_f32 v135, v66, v66
v_smfmac_f32_16x16x64_bf16 v[44:47], v[178:181], v[84:91], v213
ds_read_b128 v[84:87], v197 offset:64
ds_read_b128 v[88:91], v197 offset:80
v_mfma_f32_16x16x32_bf16 v[166:169], v[182:185], a[104:107], v[166:169]
v_add_f32 v118, v118, v42
v_fmac_f32 v119, v42, v42
v_mfma_f32_16x16x32_bf16 v[170:173], v[182:185], a[128:131], v[170:173]
s_waitcnt lgkmcnt(4)
ds_read_b128 v[182:185], v210 offset:4096
v_add_f32 v126, v126, v54
v_smfmac_f32_16x16x64_bf16 v[56:59], v[178:181], v[92:99], v213
ds_read_b128 v[92:95], v198 offset:64
ds_read_b128 v[96:99], v198 offset:80
v_mfma_f32_16x16x32_bf16 v[138:141], a[12:15], v[186:189], v[138:141]
s_waitcnt lgkmcnt(6)
v_fmac_f32 v127, v54, v54
v_add_f32 v134, v134, v67
v_smfmac_f32_16x16x64_bf16 v[68:71], v[178:181], v[100:107], v213
ds_read_b128 v[100:103], v199 offset:64
ds_read_b128 v[104:107], v199 offset:80
v_mfma_f32_16x16x32_bf16 v[142:145], a[36:39], v[186:189], v[142:145]
v_fmac_f32 v135, v67, v67
v_add_f32 v118, v118, v43
v_mfma_f32_16x16x32_bf16 v[146:149], a[60:63], v[186:189], v[146:149]
v_fmac_f32 v119, v43, v43
v_add_f32 v126, v126, v55
v_mfma_f32_16x16x32_bf16 v[150:153], a[228:231], v[186:189], v[150:153]
v_fmac_f32 v127, v55, v55
v_and_b32 v180, s44, v208
v_mfma_f32_16x16x32_bf16 v[154:157], a[252:255], v[186:189], v[154:157]
v_mov_b32 v181, 0
s_waitcnt lgkmcnt(5)
v_smfmac_f32_16x16x64_bf16 v[44:47], v[174:177], v[84:91], v213
v_mfma_f32_16x16x32_bf16 v[158:161], v[244:247], v[186:189], v[158:161]
v_mfma_f32_16x16x32_bf16 v[162:165], v[186:189], a[84:87], v[162:165]
s_waitcnt lgkmcnt(2)
v_add_f32 v118, v118, v44
v_fmac_f32 v119, v44, v44
v_smfmac_f32_16x16x64_bf16 v[56:59], v[174:177], v[92:99], v213
v_add_f32 v118, v118, v45
v_mfma_f32_16x16x32_bf16 v[166:169], v[186:189], a[108:111], v[166:169]
v_fmac_f32 v119, v45, v45
v_add_f32 v118, v118, v46
v_mfma_f32_16x16x32_bf16 v[170:173], v[186:189], a[132:135], v[170:173]
s_waitcnt lgkmcnt(0)
ds_read_b128 v[186:189], v210 offset:5120
v_add_f32 v126, v126, v56
v_smfmac_f32_16x16x64_bf16 v[68:71], v[174:177], v[100:107], v213
v_fmac_f32 v127, v56, v56
v_mfma_f32_16x16x32_bf16 v[138:141], a[16:19], v[182:185], v[138:141]
v_add_f32 v126, v126, v57
v_fmac_f32 v127, v57, v57
v_mfma_f32_16x16x32_bf16 v[142:145], a[40:43], v[182:185], v[142:145]
v_add_f32 v134, v134, v68
v_fmac_f32 v135, v68, v68
v_mfma_f32_16x16x32_bf16 v[146:149], a[64:67], v[182:185], v[146:149]
v_add_f32 v134, v134, v69
v_fmac_f32 v135, v69, v69
v_mfma_f32_16x16x32_bf16 v[150:153], a[232:235], v[182:185], v[150:153]
v_add_f32 v134, v134, v70
v_fmac_f32 v135, v70, v70
v_mfma_f32_16x16x32_bf16 v[154:157], v[224:227], v[182:185], v[154:157]
v_fmac_f32 v119, v46, v46
v_add_f32 v126, v126, v58
v_mfma_f32_16x16x32_bf16 v[158:161], v[248:251], v[182:185], v[158:161]
v_fmac_f32 v127, v58, v58
v_add_f32 v134, v134, v71
v_mfma_f32_16x16x32_bf16 v[162:165], v[182:185], a[88:91], v[162:165]
v_fmac_f32 v135, v71, v71
v_add_f32 v118, v118, v47
v_mfma_f32_16x16x32_bf16 v[166:169], v[182:185], a[112:115], v[166:169]
v_fmac_f32 v119, v47, v47
v_add_f32 v126, v126, v59
v_mfma_f32_16x16x32_bf16 v[170:173], v[182:185], a[136:139], v[170:173]
s_waitcnt lgkmcnt(0)
ds_read_b128 v[182:185], v210 offset:6144
v_fmac_f32 v127, v59, v59
v_mfma_f32_16x16x32_bf16 v[138:141], a[20:23], v[186:189], v[138:141]
v_permlane16_swap_b32 v134, v135
v_mfma_f32_16x16x32_bf16 v[142:145], a[44:47], v[186:189], v[142:145]
v_permlane16_swap_b32 v118, v119
v_mfma_f32_16x16x32_bf16 v[146:149], a[68:71], v[186:189], v[146:149]
v_cvt_pk_bf16_f32 v78, v138, v139
v_cvt_pk_bf16_f32 v79, v140, v141
v_mfma_f32_16x16x32_bf16 v[150:153], a[236:239], v[186:189], v[150:153]
v_cvt_pk_bf16_f32 v80, v142, v143
v_cvt_pk_bf16_f32 v81, v144, v145
v_mfma_f32_16x16x32_bf16 v[154:157], v[228:231], v[186:189], v[154:157]
v_cvt_pk_bf16_f32 v82, v146, v147
v_cvt_pk_bf16_f32 v83, v148, v149
v_mfma_f32_16x16x32_bf16 v[158:161], v[252:255], v[186:189], v[158:161]
v_cvt_pk_bf16_f32 v72, v150, v151
v_cvt_pk_bf16_f32 v73, v152, v153
v_mfma_f32_16x16x32_bf16 v[162:165], v[186:189], a[92:95], v[162:165]
v_cvt_pk_bf16_f32 v74, v154, v155
v_cvt_pk_bf16_f32 v75, v156, v157
v_mfma_f32_16x16x32_bf16 v[166:169], v[186:189], a[116:119], v[166:169]
v_cvt_pk_bf16_f32 v76, v158, v159
v_cvt_pk_bf16_f32 v77, v160, v161
v_mfma_f32_16x16x32_bf16 v[170:173], v[186:189], a[140:143], v[170:173]
s_waitcnt lgkmcnt(0)
ds_read_b128 v[186:189], v210 offset:7168
v_cvt_pk_bf16_f32 v114, v162, v163
v_mfma_f32_16x16x32_bf16 v[138:141], a[0:3], v[182:185], 0
v_cvt_pk_bf16_f32 v115, v164, v165
v_cvt_pk_bf16_f32 v122, v166, v167
v_mfma_f32_16x16x32_bf16 v[142:145], a[24:27], v[182:185], 0
v_cvt_pk_bf16_f32 v123, v168, v169
v_cvt_pk_bf16_f32 v130, v170, v171
v_mfma_f32_16x16x32_bf16 v[146:149], a[48:51], v[182:185], 0
v_cvt_pk_bf16_f32 v131, v172, v173
v_add_f32 v134, v134, v135
v_mfma_f32_16x16x32_bf16 v[150:153], a[216:219], v[182:185], 0
v_permlane16_swap_b32 v126, v127
v_mfma_f32_16x16x32_bf16 v[154:157], a[240:243], v[182:185], 0
v_add_f32 v118, v118, v119
v_mov_b32 v135, v134
v_mfma_f32_16x16x32_bf16 v[158:161], v[232:235], v[182:185], 0
v_add_f32 v126, v126, v127
v_permlane32_swap_b32 v134, v135
v_mfma_f32_16x16x32_bf16 v[162:165], v[182:185], a[72:75], 0
v_permlane32_swap_b32 v118, v126
v_mfma_f32_16x16x32_bf16 v[166:169], v[182:185], a[96:99], 0
v_add_f32 v134, v134, v135
v_add_f32 v118, v118, v126
v_mfma_f32_16x16x32_bf16 v[170:173], v[182:185], a[120:123], 0
s_waitcnt lgkmcnt(0)
ds_read_b128 v[182:185], v210 offset:8192
ds_write_b32 v209, v134 offset:512
v_mfma_f32_16x16x32_bf16 v[138:141], a[4:7], v[186:189], v[138:141]
ds_write_b32 v209, v118
v_mfma_f32_16x16x32_bf16 v[142:145], a[28:31], v[186:189], v[142:145]
v_mfma_f32_16x16x32_bf16 v[146:149], a[52:55], v[186:189], v[146:149]
v_mfma_f32_16x16x32_bf16 v[150:153], a[220:223], v[186:189], v[150:153]
v_mfma_f32_16x16x32_bf16 v[154:157], a[244:247], v[186:189], v[154:157]
v_mfma_f32_16x16x32_bf16 v[158:161], v[236:239], v[186:189], v[158:161]
v_mfma_f32_16x16x32_bf16 v[162:165], v[186:189], a[76:79], v[162:165]
s_waitcnt lgkmcnt(0)
s_barrier
v_mfma_f32_16x16x32_bf16 v[166:169], v[186:189], a[100:103], v[166:169]
ds_read_b128 v[102:105], v210 offset:55296
ds_read_b128 v[106:109], v210 offset:56320
v_mfma_f32_16x16x32_bf16 v[170:173], v[186:189], a[124:127], v[170:173]
s_mov_b32 s46, 9
.p2align 3
F_loop:
ds_read_b128 v[186:189], v210 offset:9216
v_mfma_f32_16x16x32_bf16 v[138:141], a[8:11], v[182:185], v[138:141]
v_mfma_f32_16x16x32_bf16 v[142:145], a[32:35], v[182:185], v[142:145]
v_mfma_f32_16x16x32_bf16 v[146:149], a[56:59], v[182:185], v[146:149]
v_mfma_f32_16x16x32_bf16 v[150:153], a[224:227], v[182:185], v[150:153]
buffer_load_dwordx4 v180, s[4:7], s52 offen nt lds
v_mfma_f32_16x16x32_bf16 v[154:157], a[248:251], v[182:185], v[154:157]
s_waitcnt lgkmcnt(2)
v_add_f32 v102, v102, v103
v_add_f32 v104, v104, v105
v_mfma_f32_16x16x32_bf16 v[158:161], v[240:243], v[182:185], v[158:161]
s_waitcnt lgkmcnt(1)
v_add_f32 v106, v106, v107
v_add_f32 v108, v108, v109
v_mfma_f32_16x16x32_bf16 v[162:165], v[182:185], a[80:83], v[162:165]
s_waitcnt lgkmcnt(0)
v_add_f32 v102, v102, v104
v_add_f32 v106, v106, v108
v_mfma_f32_16x16x32_bf16 v[166:169], v[182:185], a[104:107], v[166:169]
s_add_u32 m0, s45, 4112
ds_read_b128 v[108:111], v215 offset:512
v_mul_f32 v103, s48, v102
v_mfma_f32_16x16x32_bf16 v[170:173], v[182:185], a[128:131], v[170:173]
s_add_u32 s40, s36, 196224
ds_read_b128 v[182:185], v210 offset:10240
v_mul_f32 v104, s73, v102
v_mfma_f32_16x16x32_bf16 v[138:141], a[12:15], v[186:189], v[138:141]
v_mul_f32 v106, s73, v106
v_fma_f32 v106, -v103, v104, v106
v_mfma_f32_16x16x32_bf16 v[142:145], a[36:39], v[186:189], v[142:145]
v_max_f32 v106, 0, v106
v_add_f32 v106, s49, v106
v_mfma_f32_16x16x32_bf16 v[146:149], a[60:63], v[186:189], v[146:149]
v_rsq_f32 v102, v106
v_mfma_f32_16x16x32_bf16 v[150:153], a[228:231], v[186:189], v[150:153]
v_mul_f32_e64 v103, -v103, v102
v_mfma_f32_16x16x32_bf16 v[154:157], a[252:255], v[186:189], v[154:157]
buffer_load_dwordx4 v180, s[4:7], s40 offen nt lds
v_mfma_f32_16x16x32_bf16 v[158:161], v[244:247], v[186:189], v[158:161]
ds_write_b64 v211, v[102:103] offset:36864
v_mfma_f32_16x16x32_bf16 v[162:165], v[186:189], a[84:87], v[162:165]
s_add_u32 m0, s45, 8224
s_add_u32 s40, s36, 392448
v_mfma_f32_16x16x32_bf16 v[166:169], v[186:189], a[108:111], v[166:169]
ds_read_b64 v[118:119], v219
ds_read_b64 v[126:127], v219 offset:256
v_mfma_f32_16x16x32_bf16 v[170:173], v[186:189], a[132:135], v[170:173]
s_waitcnt lgkmcnt(3)
ds_read_b128 v[186:189], v210 offset:11264
ds_read_b64 v[134:135], v219 offset:512
v_mfma_f32_16x16x32_bf16 v[138:141], a[16:19], v[182:185], v[138:141]
v_mfma_f32_16x16x32_bf16 v[142:145], a[40:43], v[182:185], v[142:145]
v_mfma_f32_16x16x32_bf16 v[146:149], a[64:67], v[182:185], v[146:149]
v_mfma_f32_16x16x32_bf16 v[150:153], a[232:235], v[182:185], v[150:153]
s_waitcnt lgkmcnt(3)
v_fma_f32 v220, v36, v118, v119
v_fma_f32 v221, v37, v118, v119
v_mfma_f32_16x16x32_bf16 v[154:157], v[224:227], v[182:185], v[154:157]
v_fma_f32 v222, v38, v118, v119
v_fma_f32 v223, v39, v118, v119
v_mfma_f32_16x16x32_bf16 v[158:161], v[248:251], v[182:185], v[158:161]
buffer_load_dwordx4 v180, s[4:7], s40 offen nt lds
v_mfma_f32_16x16x32_bf16 v[162:165], v[182:185], a[88:91], v[162:165]
s_add_u32 m0, s45, 12336
v_cvt_pk_bf16_f32 v90, v220, v221
v_cvt_pk_bf16_f32 v91, v222, v223
v_mfma_f32_16x16x32_bf16 v[166:169], v[182:185], a[112:115], v[166:169]
s_add_u32 s40, s36, 588672
v_fma_f32 v220, v40, v118, v119
v_fma_f32 v221, v41, v118, v119
v_mfma_f32_16x16x32_bf16 v[170:173], v[182:185], a[136:139], v[170:173]
s_waitcnt lgkmcnt(1)
ds_read_b128 v[182:185], v210 offset:12288
v_fma_f32 v222, v42, v118, v119
v_mfma_f32_16x16x32_bf16 v[138:141], a[20:23], v[186:189], v[138:141]
v_fma_f32 v223, v43, v118, v119
v_cvt_pk_bf16_f32 v92, v220, v221
v_mfma_f32_16x16x32_bf16 v[142:145], a[44:47], v[186:189], v[142:145]
v_cvt_pk_bf16_f32 v93, v222, v223
v_fma_f32 v220, v44, v118, v119
v_mfma_f32_16x16x32_bf16 v[146:149], a[68:71], v[186:189], v[146:149]
ds_write_b128 v211, v[90:93] offset:18432
v_mfma_f32_16x16x32_bf16 v[150:153], a[236:239], v[186:189], v[150:153]
v_cvt_pk_bf16_f32 v96, v138, v139
v_cvt_pk_bf16_f32 v97, v140, v141
v_mfma_f32_16x16x32_bf16 v[154:157], v[228:231], v[186:189], v[154:157]
v_cvt_pk_bf16_f32 v98, v142, v143
v_cvt_pk_bf16_f32 v99, v144, v145
v_mfma_f32_16x16x32_bf16 v[158:161], v[252:255], v[186:189], v[158:161]
buffer_load_dwordx4 v180, s[4:7], s40 offen nt lds
v_mfma_f32_16x16x32_bf16 v[162:165], v[186:189], a[92:95], v[162:165]
s_add_u32 m0, s45, 16448
v_cvt_pk_bf16_f32 v100, v146, v147
v_cvt_pk_bf16_f32 v101, v148, v149
v_mfma_f32_16x16x32_bf16 v[166:169], v[186:189], a[116:119], v[166:169]
s_add_u32 s40, s36, 784896
v_cvt_pk_bf16_f32 v88, v158, v159
v_cvt_pk_bf16_f32 v89, v160, v161
v_mfma_f32_16x16x32_bf16 v[170:173], v[186:189], a[140:143], v[170:173]
s_waitcnt lgkmcnt(1)
ds_read_b128 v[186:189], v210 offset:13312
v_cvt_pk_bf16_f32 v86, v154, v155
v_mfma_f32_16x16x32_bf16 v[138:141], a[0:3], v[182:185], 0
v_cvt_pk_bf16_f32 v87, v156, v157
v_cvt_pk_bf16_f32 v124, v166, v167
v_mfma_f32_16x16x32_bf16 v[142:145], a[24:27], v[182:185], 0
v_cvt_pk_bf16_f32 v125, v168, v169
v_cvt_pk_bf16_f32 v84, v150, v151
v_mfma_f32_16x16x32_bf16 v[146:149], a[48:51], v[182:185], 0
ds_read_b128 v[182:185], v210 offset:14336
v_cvt_pk_bf16_f32 v85, v152, v153
v_cvt_pk_bf16_f32 v116, v162, v163
v_mfma_f32_16x16x16_bf16 v[154:157], v[82:83], v[88:89], 0
v_cvt_pk_bf16_f32 v117, v164, v165
v_fma_f32 v221, v45, v118, v119
v_fma_f32 v222, v46, v118, v119
v_mfma_f32_16x16x16_bf16 v[158:161], v[100:101], v[88:89], 0
v_fma_f32 v223, v47, v118, v119
v_cvt_pk_bf16_f32 v94, v220, v221
v_cvt_pk_bf16_f32 v95, v222, v223
v_fma_f32 v220, v48, v126, v127
s_waitcnt lgkmcnt(1)
v_mfma_f32_16x16x32_bf16 v[138:141], a[4:7], v[186:189], v[138:141]
buffer_load_dwordx4 v180, s[4:7], s40 offen nt lds
v_mfma_f32_16x16x32_bf16 v[142:145], a[28:31], v[186:189], v[142:145]
s_add_u32 m0, s45, 20560
ds_write_b64 v212, v[94:95] offset:18432
v_mfma_f32_16x16x32_bf16 v[146:149], a[52:55], v[186:189], v[146:149]
s_waitcnt lgkmcnt(1)
v_fma_f32 v221, v49, v126, v127
v_fma_f32 v222, v50, v126, v127
v_mfma_f32_16x16x32_bf16 v[138:141], a[8:11], v[182:185], v[138:141]
s_add_u32 s40, s36, 981120
ds_read_b128 v[186:189], v210 offset:15360
v_fma_f32 v223, v51, v126, v127
v_mfma_f32_16x16x32_bf16 v[142:145], a[32:35], v[182:185], v[142:145]
v_cvt_pk_bf16_f32 v174, v220, v221
v_cvt_pk_bf16_f32 v175, v222, v223
v_mfma_f32_16x16x32_bf16 v[146:149], a[56:59], v[182:185], v[146:149]
ds_read_b128 v[182:185], v210 offset:16384
v_fma_f32 v220, v52, v126, v127
v_fma_f32 v221, v53, v126, v127
v_mfma_f32_16x16x16_bf16 v[166:169], v[112:113], v[88:89], v[206:209]
v_fma_f32 v222, v54, v126, v127
v_fma_f32 v223, v55, v126, v127
v_cvt_pk_bf16_f32 v176, v220, v221
v_mfma_f32_16x16x16_bf16 v[150:153], v[112:113], v[76:77], v[206:209]
v_cvt_pk_bf16_f32 v177, v222, v223
v_fma_f32 v220, v56, v126, v127
v_fma_f32 v221, v57, v126, v127
v_fma_f32 v222, v58, v126, v127
v_mfma_f32_16x16x32_bf16 v[154:157], v[78:81], v[84:87], v[154:157]
s_waitcnt lgkmcnt(1)
ds_write_b128 v211, v[174:177] offset:24576
v_mfma_f32_16x16x32_bf16 v[138:141], a[12:15], v[186:189], v[138:141]
s_waitcnt lgkmcnt(1)
buffer_load_dwordx4 v180, s[4:7], s40 offen nt lds
v_mfma_f32_16x16x32_bf16 v[142:145], a[36:39], v[186:189], v[142:145]
s_add_u32 m0, s45, 24672
v_fma_f32 v223, v59, v126, v127
v_cvt_pk_bf16_f32 v178, v220, v221
v_mfma_f32_16x16x32_bf16 v[146:149], a[60:63], v[186:189], v[146:149]
s_add_u32 s40, s36, 1177344
ds_read_b128 v[186:189], v210 offset:17408
v_cvt_pk_bf16_f32 v179, v222, v223
v_mfma_f32_16x16x32_bf16 v[138:141], a[16:19], v[182:185], v[138:141]
ds_write_b64 v212, v[178:179] offset:24576
v_mfma_f32_16x16x32_bf16 v[142:145], a[40:43], v[182:185], v[142:145]
v_fma_f32 v220, v60, v134, v135
v_fma_f32 v221, v61, v134, v135
v_mfma_f32_16x16x32_bf16 v[150:153], v[108:111], v[72:75], v[150:153]
v_fma_f32 v222, v62, v134, v135
v_fma_f32 v223, v63, v134, v135
v_mfma_f32_16x16x32_bf16 v[146:149], a[64:67], v[182:185], v[146:149]
ds_read_b128 v[182:185], v210 offset:12288
v_cvt_pk_bf16_f32 v90, v220, v221
v_mfma_f32_16x16x32_bf16 v[158:161], v[96:99], v[84:87], v[158:161]
s_waitcnt lgkmcnt(2)
v_cvt_pk_bf16_f32 v91, v222, v223
v_fma_f32 v220, v64, v134, v135
v_mfma_f32_16x16x32_bf16 v[138:141], a[20:23], v[186:189], v[138:141]
v_fma_f32 v221, v65, v134, v135
v_fma_f32 v222, v66, v134, v135
v_mfma_f32_16x16x32_bf16 v[142:145], a[44:47], v[186:189], v[142:145]
buffer_load_dwordx4 v180, s[4:7], s40 offen nt lds
v_mfma_f32_16x16x32_bf16 v[146:149], a[68:71], v[186:189], v[146:149]
s_add_u32 m0, s45, 28784
ds_read_b128 v[186:189], v210 offset:13312
v_cvt_pk_bf16_f32 v102, v138, v139
v_mfma_f32_16x16x32_bf16 v[166:169], v[108:111], v[84:87], v[166:169]
s_add_u32 s40, s36, 1373568
v_cvt_pk_bf16_f32 v103, v140, v141
v_cvt_pk_bf16_f32 v104, v142, v143
v_cvt_pk_bf16_f32 v105, v144, v145
v_mfma_f32_16x16x16_bf16 v[138:141], v[82:83], v[76:77], 0
v_cvt_pk_bf16_f32 v106, v146, v147
v_cvt_pk_bf16_f32 v107, v148, v149
v_fma_f32 v223, v67, v134, v135
v_mfma_f32_16x16x16_bf16 v[142:145], v[100:101], v[76:77], 0
v_cvt_pk_bf16_f32 v92, v220, v221
v_cvt_pk_bf16_f32 v93, v222, v223
v_fma_f32 v220, v68, v134, v135
v_mfma_f32_16x16x16_bf16 v[162:165], v[106:107], v[88:89], 0
v_fma_f32 v221, v69, v134, v135
v_fma_f32 v222, v70, v134, v135
v_fma_f32 v223, v71, v134, v135
v_mfma_f32_16x16x16_bf16 v[146:149], v[106:107], v[76:77], 0
v_cvt_pk_bf16_f32 v132, v170, v171
v_cvt_pk_bf16_f32 v133, v172, v173
v_cvt_pk_bf16_f32 v94, v220, v221
v_cvt_pk_bf16_f32 v95, v222, v223
v_mfma_f32_16x16x32_bf16 v[138:141], v[78:81], v[72:75], v[138:141]
ds_write_b128 v211, v[90:93] offset:30720
v_mfma_f32_16x16x32_bf16 v[142:145], v[96:99], v[72:75], v[142:145]
s_waitcnt lgkmcnt(2)
s_nop 2
v_exp_f32 v138, v138
v_mfma_f32_16x16x32_bf16 v[118:121], v[182:185], a[72:75], 0
buffer_load_dwordx4 v180, s[4:7], s40 offen nt lds
v_mfma_f32_16x16x32_bf16 v[126:129], v[182:185], a[96:99], 0
s_add_u32 m0, s45, 32896
ds_write_b64 v212, v[94:95] offset:30720
v_mfma_f32_16x16x32_bf16 v[134:137], v[182:185], a[120:123], 0
s_add_u32 s40, s36, 1569792
v_exp_f32 v139, v139
v_mfma_f32_16x16x32_bf16 v[146:149], v[102:105], v[72:75], v[146:149]
ds_read_b64 v[76:77], v215 offset:16
v_cvt_pk_bf16_f32 v174, v138, v139
v_mfma_f32_16x16x32_bf16 v[90:93], a[216:219], v[182:185], 0
v_exp_f32 v140, v140
v_mfma_f32_16x16x32_bf16 v[170:173], a[240:243], v[182:185], 0
v_exp_f32 v141, v141
v_mfma_f32_16x16x32_bf16 v[220:223], v[232:235], v[182:185], 0
s_waitcnt lgkmcnt(3)
ds_read_b128 v[182:185], v210 offset:14336
v_cvt_pk_bf16_f32 v175, v140, v141
v_mfma_f32_16x16x32_bf16 v[118:121], v[186:189], a[76:79], v[118:121]
v_exp_f32 v142, v142
v_mfma_f32_16x16x32_bf16 v[126:129], v[186:189], a[100:103], v[126:129]
v_exp_f32 v143, v143
v_mfma_f32_16x16x32_bf16 v[134:137], v[186:189], a[124:127], v[134:137]
v_exp_f32 v144, v144
v_mfma_f32_16x16x32_bf16 v[90:93], a[220:223], v[186:189], v[90:93]
buffer_load_dwordx4 v180, s[4:7], s40 offen nt lds
v_mfma_f32_16x16x32_bf16 v[170:173], a[244:247], v[186:189], v[170:173]
v_exp_f32 v145, v145
v_mfma_f32_16x16x32_bf16 v[220:223], v[236:239], v[186:189], v[220:223]
s_waitcnt lgkmcnt(0)
ds_read_b128 v[186:189], v210 offset:15360
v_cvt_pk_bf16_f32 v176, v142, v143
v_mfma_f32_16x16x32_bf16 v[118:121], v[182:185], a[80:83], v[118:121]
v_exp_f32 v150, v150
v_mfma_f32_16x16x32_bf16 v[126:129], v[182:185], a[104:107], v[126:129]
v_cvt_pk_bf16_f32 v177, v144, v145
v_cvt_pk_bf16_f32 v180, v150, 0
v_mfma_f32_16x16x32_bf16 v[134:137], v[182:185], a[128:131], v[134:137]
v_exp_f32 v154, v154
v_mfma_f32_16x16x32_bf16 v[90:93], a[224:227], v[182:185], v[90:93]
v_exp_f32 v155, v155
v_mfma_f32_16x16x32_bf16 v[162:165], v[102:105], v[84:87], v[162:165]
v_exp_f32 v156, v156
v_mfma_f32_16x16x32_bf16 v[170:173], a[248:251], v[182:185], v[170:173]
v_exp_f32 v157, v157
v_mfma_f32_16x16x32_bf16 v[220:223], v[240:243], v[182:185], v[220:223]
s_waitcnt lgkmcnt(0)
ds_read_b128 v[182:185], v210 offset:16384
ds_read_b128 v[72:75], v215
v_mfma_f32_16x16x32_bf16 v[118:121], v[186:189], a[84:87], v[118:121]
v_exp_f32 v158, v158
v_mfma_f32_16x16x32_bf16 v[126:129], v[186:189], a[108:111], v[126:129]
v_exp_f32 v159, v159
v_mfma_f32_16x16x32_bf16 v[134:137], v[186:189], a[132:135], v[134:137]
v_exp_f32 v160, v160
v_mfma_f32_16x16x32_bf16 v[90:93], a[228:231], v[186:189], v[90:93]
v_exp_f32 v161, v161
v_mfma_f32_16x16x32_bf16 v[170:173], a[252:255], v[186:189], v[170:173]
v_exp_f32 v166, v166
v_mfma_f32_16x16x32_bf16 v[220:223], v[244:247], v[186:189], v[220:223]
s_waitcnt lgkmcnt(1)
ds_read_b128 v[186:189], v210 offset:17408
v_exp_f32 v146, v146
v_mfma_f32_16x16x32_bf16 v[118:121], v[182:185], a[88:91], v[118:121]
v_exp_f32 v147, v147
v_mfma_f32_16x16x32_bf16 v[126:129], v[182:185], a[112:115], v[126:129]
v_exp_f32 v148, v148
v_mfma_f32_16x16x32_bf16 v[134:137], v[182:185], a[136:139], v[134:137]
v_exp_f32 v149, v149
v_mfma_f32_16x16x32_bf16 v[90:93], a[232:235], v[182:185], v[90:93]
v_exp_f32 v162, v162
v_mfma_f32_16x16x32_bf16 v[170:173], v[224:227], v[182:185], v[170:173]
v_exp_f32 v163, v163
v_mfma_f32_16x16x32_bf16 v[220:223], v[248:251], v[182:185], v[220:223]
s_waitcnt lgkmcnt(0)
v_exp_f32 v164, v164
v_mfma_f32_16x16x32_bf16 v[118:121], v[186:189], a[92:95], v[118:121]
v_exp_f32 v165, v165
v_mfma_f32_16x16x32_bf16 v[126:129], v[186:189], a[116:119], v[126:129]
v_cvt_pk_bf16_f32 v178, v146, v147
v_cvt_pk_bf16_f32 v179, v148, v149
v_mfma_f32_16x16x32_bf16 v[134:137], v[186:189], a[140:143], v[134:137]
v_cvt_pk_bf16_f32 v118, v118, v119
v_cvt_pk_bf16_f32 v119, v120, v121
v_mfma_f32_16x16x32_bf16 v[90:93], a[236:239], v[186:189], v[90:93]
ds_read_u16 v120, v214 offset:1024
v_cvt_pk_bf16_f32 v126, v126, v127
v_mfma_f32_16x16x32_bf16 v[170:173], v[228:231], v[186:189], v[170:173]
v_cvt_pk_bf16_f32 v127, v128, v129
v_cvt_pk_bf16_f32 v134, v134, v135
v_mfma_f32_16x16x32_bf16 v[220:223], v[252:255], v[186:189], v[220:223]
ds_read_u16 v128, v214 offset:1032
v_cvt_pk_bf16_f32 v90, v90, v91
v_mfma_f32_16x16x32_bf16 v[150:153], v[190:193], v[174:177], 0
v_cvt_pk_bf16_f32 v91, v92, v93
v_cvt_pk_bf16_f32 v92, v170, v171
v_mfma_f32_16x16x32_bf16 v[138:141], v[114:117], v[174:177], 0
v_cvt_pk_bf16_f32 v93, v172, v173
v_cvt_pk_bf16_f32 v135, v136, v137
v_mfma_f32_16x16x32_bf16 v[142:145], v[122:125], v[174:177], 0
ds_read_u16 v136, v214 offset:1040
v_mov_b32 v121, 0
v_mfma_f32_16x16x32_bf16 v[146:149], v[130:133], v[174:177], 0
v_cvt_pk_bf16_f32 v174, v154, v155
v_cvt_pk_bf16_f32 v175, v156, v157
v_mfma_f32_16x16x32_bf16 v[150:153], v[190:193], v[178:181], v[150:153]
s_waitcnt lgkmcnt(2)
v_cvt_pk_bf16_f32 v176, v158, v159
v_cvt_pk_bf16_f32 v177, v160, v161
v_mfma_f32_16x16x32_bf16 v[138:141], v[118:121], v[178:181], v[138:141]
v_mov_b32 v129, 0
v_mov_b32 v137, 0
v_mfma_f32_16x16x32_bf16 v[154:157], v[114:117], v[174:177], 0
v_rcp_f32 v151, v150
v_mfma_f32_16x16x32_bf16 v[158:161], v[122:125], v[174:177], 0
s_waitcnt lgkmcnt(1)
v_max3_u32 v218, v218, v150, v151
v_mul_f32 v151, s3, v151
v_mfma_f32_16x16x32_bf16 v[142:145], v[126:129], v[178:181], v[142:145]
s_waitcnt lgkmcnt(0)
v_mul_f32 v138, v138, v151
v_mul_f32 v139, v139, v151
v_mfma_f32_16x16x32_bf16 v[146:149], v[134:137], v[178:181], v[146:149]
v_cvt_pk_bf16_f32 v180, v166, 0
v_mul_f32 v140, v140, v151
v_mfma_f32_16x16x32_bf16 v[166:169], v[190:193], v[174:177], 0
v_mul_f32 v141, v141, v151
v_cvt_pk_bf16_f32 v138, v138, v139
v_mul_f32 v142, v142, v151
v_mul_f32 v143, v143, v151
v_mul_f32 v144, v144, v151
v_mul_f32 v145, v145, v151
v_cvt_pk_bf16_f32 v139, v140, v141
v_cvt_pk_bf16_f32 v140, v142, v143
v_cvt_pk_bf16_f32 v141, v144, v145
v_cvt_pk_bf16_f32 v178, v162, v163
v_cvt_pk_bf16_f32 v179, v164, v165
v_mfma_f32_16x16x32_bf16 v[162:165], v[130:133], v[174:177], 0
ds_write_b128 v211, v[138:141] offset:36864
v_mfma_f32_16x16x32_bf16 v[138:141], v[78:81], v[90:93], 0
v_mul_f32 v146, v146, v151
v_mul_f32 v147, v147, v151
v_mfma_f32_16x16x32_bf16 v[166:169], v[190:193], v[178:181], v[166:169]
v_mul_f32 v148, v148, v151
v_mul_f32 v149, v149, v151
v_mfma_f32_16x16x32_bf16 v[154:157], v[118:121], v[178:181], v[154:157]
v_cvt_pk_bf16_f32 v142, v146, v147
v_cvt_pk_bf16_f32 v143, v148, v149
v_mfma_f32_16x16x32_bf16 v[158:161], v[126:129], v[178:181], v[158:161]
ds_write_b64 v212, v[142:143] offset:36864
v_mfma_f32_16x16x32_bf16 v[142:145], v[96:99], v[90:93], 0
v_rcp_f32 v167, v166
v_mfma_f32_16x16x32_bf16 v[162:165], v[134:137], v[178:181], v[162:165]
v_max3_u32 v218, v218, v166, v167
v_cvt_pk_bf16_f32 v94, v220, v221
v_mfma_f32_16x16x32_bf16 v[150:153], v[108:111], v[90:93], v[206:209]
v_cvt_pk_bf16_f32 v95, v222, v223
v_mul_f32 v167, s3, v167
v_mfma_f32_16x16x32_bf16 v[146:149], v[102:105], v[90:93], 0
v_mul_f32 v154, v154, v167
v_mul_f32 v155, v155, v167
v_mul_f32 v156, v156, v167
v_mfma_f32_16x16x16_bf16 v[138:141], v[82:83], v[94:95], v[138:141]
v_mul_f32 v157, v157, v167
v_cvt_pk_bf16_f32 v154, v154, v155
v_mul_f32 v158, v158, v167
v_mfma_f32_16x16x16_bf16 v[142:145], v[100:101], v[94:95], v[142:145]
v_mul_f32 v159, v159, v167
v_mul_f32 v160, v160, v167
v_mul_f32 v161, v161, v167
v_mfma_f32_16x16x16_bf16 v[150:153], v[112:113], v[94:95], v[150:153]
v_cvt_pk_bf16_f32 v155, v156, v157
v_cvt_pk_bf16_f32 v156, v158, v159
v_cvt_pk_bf16_f32 v157, v160, v161
v_mfma_f32_16x16x16_bf16 v[146:149], v[106:107], v[94:95], v[146:149]
v_mul_f32 v162, v162, v167
v_mul_f32 v163, v163, v167
v_mul_f32 v164, v164, v167
v_mul_f32 v165, v165, v167
v_mfma_f32_16x16x16_bf16 v[166:169], v[76:77], v[112:113], v[206:209]
v_cvt_pk_bf16_f32 v158, v162, v163
v_cvt_pk_bf16_f32 v159, v164, v165
v_exp_f32 v138, v138
v_mfma_f32_16x16x16_bf16 v[162:165], v[76:77], v[106:107], 0
v_exp_f32 v139, v139
v_exp_f32 v140, v140
v_mfma_f32_16x16x32_bf16 v[166:169], v[72:75], v[108:111], v[166:169]
ds_write_b128 v211, v[154:157] offset:43008
v_mfma_f32_16x16x16_bf16 v[154:157], v[76:77], v[82:83], 0
v_exp_f32 v141, v141
v_exp_f32 v142, v142
v_mfma_f32_16x16x32_bf16 v[162:165], v[72:75], v[102:105], v[162:165]
v_exp_f32 v143, v143
v_mfma_f32_16x16x32_bf16 v[154:157], v[72:75], v[78:81], v[154:157]
ds_write_b64 v212, v[158:159] offset:43008
v_mfma_f32_16x16x16_bf16 v[158:161], v[76:77], v[100:101], 0
v_exp_f32 v144, v144
v_exp_f32 v145, v145
v_exp_f32 v150, v150
v_mfma_f32_16x16x32_bf16 v[158:161], v[72:75], v[96:99], v[158:161]
v_cvt_pk_bf16_f32 v174, v138, v139
v_cvt_pk_bf16_f32 v175, v140, v141
v_cvt_pk_bf16_f32 v176, v142, v143
v_cvt_pk_bf16_f32 v177, v144, v145
v_cvt_pk_bf16_f32 v180, v150, 0
v_exp_f32 v146, v146
v_mfma_f32_16x16x32_bf16 v[150:153], v[190:193], v[174:177], 0
v_exp_f32 v147, v147
v_mfma_f32_16x16x32_bf16 v[138:141], v[114:117], v[174:177], 0
s_waitcnt lgkmcnt(0)
v_exp_f32 v148, v148
v_mfma_f32_16x16x32_bf16 v[142:145], v[122:125], v[174:177], 0
s_barrier
ds_read_b128 v[170:173], v210 offset:36864
ds_read_b128 v[182:185], v210 offset:37888
ds_read_b128 v[186:189], v210 offset:38912
v_exp_f32 v149, v149
v_cvt_pk_bf16_f32 v178, v146, v147
v_cvt_pk_bf16_f32 v179, v148, v149
v_mfma_f32_16x16x32_bf16 v[146:149], v[130:133], v[174:177], 0
v_mov_b32_dpp v154, v158 quad_perm:[0,1,2,3] row_mask:0x2 bank_mask:0xf
v_mfma_f32_16x16x32_bf16 v[150:153], v[190:193], v[178:181], v[150:153]
v_mov_b32_dpp v154, v162 quad_perm:[0,1,2,3] row_mask:0x4 bank_mask:0xf
v_mfma_f32_16x16x32_bf16 v[138:141], v[118:121], v[178:181], v[138:141]
v_mov_b32_dpp v154, v167 quad_perm:[0,1,2,3] row_mask:0x8 bank_mask:0xf
v_exp_f32 v154, v154
v_mfma_f32_16x16x32_bf16 v[142:145], v[126:129], v[178:181], v[142:145]
v_cvt_pk_bf16_f32 v154, v154, 0
v_rcp_f32 v151, v150
v_mfma_f32_16x16x32_bf16 v[146:149], v[134:137], v[178:181], v[146:149]
s_waitcnt lgkmcnt(2)
ds_write_b16 v214, v154
v_mfma_f32_16x16x32_bf16 v[0:3], a[144:147], v[170:173], v[0:3]
ds_read_b128 v[84:87], v215
ds_read_b128 v[88:91], v215 offset:16
v_mfma_f32_16x16x32_bf16 v[4:7], a[168:171], v[170:173], v[4:7]
ds_read_b128 v[174:177], v217
ds_read_b128 v[178:181], v217 offset:528
v_mfma_f32_16x16x32_bf16 v[8:11], a[192:195], v[170:173], v[8:11]
ds_read_b128 v[170:173], v210 offset:39936
s_waitcnt lgkmcnt(7)
v_mfma_f32_16x16x32_bf16 v[0:3], a[148:151], v[182:185], v[0:3]
v_mfma_f32_16x16x32_bf16 v[4:7], a[172:175], v[182:185], v[4:7]
v_mfma_f32_16x16x32_bf16 v[8:11], a[196:199], v[182:185], v[8:11]
ds_read_b128 v[182:185], v210 offset:40960
s_waitcnt lgkmcnt(5)
v_mfma_f32_16x16x32_bf16 v[166:169], v[84:87], v[190:193], 0
v_mfma_f32_16x16x32_bf16 v[154:157], v[84:87], v[114:117], 0
v_mfma_f32_16x16x32_bf16 v[158:161], v[84:87], v[122:125], 0
s_mul_hi_u32 s41, s35, 58835169
s_mul_i32 s42, s41, 73
s_waitcnt lgkmcnt(4)
v_mfma_f32_16x16x32_bf16 v[162:165], v[84:87], v[130:133], 0
s_sub_u32 s42, s35, s42
s_mul_i32 s43, s41, 1373568
s_mul_i32 s51, s42, 2688
v_mfma_f32_16x16x32_bf16 v[166:169], v[88:91], v[190:193], v[166:169]
s_add_u32 s43, s43, s51
v_mfma_f32_16x16x32_bf16 v[154:157], v[88:91], v[118:121], v[154:157]
s_cmp_lt_u32 s35, s34
s_cselect_b32 s50, s43, 1879048192
s_waitcnt lgkmcnt(0)
v_mfma_f32_16x16x32_bf16 v[158:161], v[88:91], v[126:129], v[158:161]
s_add_u32 s35, s35, 32
v_rcp_f32 v167, v166
v_mfma_f32_16x16x32_bf16 v[162:165], v[88:91], v[134:137], v[162:165]
s_cmp_eq_u32 s42, 0
v_max3_u32 v218, v218, v166, v167
v_max3_u32 v218, v218, v150, v151
v_mfma_f32_16x16x32_bf16 v[0:3], a[152:155], v[186:189], v[0:3]
s_cselect_b32 s44, 536870911, s72
v_mul_f32 v151, s3, v151
v_mul_f32 v138, v138, v151
v_mfma_f32_16x16x32_bf16 v[4:7], a[176:179], v[186:189], v[4:7]
s_cmp_eq_u32 s42, 72
v_mul_f32 v139, v139, v151
v_mul_f32 v140, v140, v151
v_mfma_f32_16x16x32_bf16 v[8:11], a[200:203], v[186:189], v[8:11]
s_cselect_b32 s44, 939524095, s44
ds_read_b128 v[186:189], v210 offset:41984
v_mul_f32 v141, v141, v151
v_mfma_f32_16x16x32_bf16 v[0:3], a[156:159], v[170:173], v[0:3]
s_cmp_eq_u32 s41, 0
v_cvt_pk_bf16_f32 v138, v138, v139
v_mul_f32 v142, v142, v151
v_mfma_f32_16x16x32_bf16 v[4:7], a[180:183], v[170:173], v[4:7]
s_cselect_b32 s52, 1879048192, s50
v_mul_f32 v143, v143, v151
v_mul_f32 v144, v144, v151
v_mfma_f32_16x16x32_bf16 v[8:11], a[204:207], v[170:173], v[8:11]
s_add_u32 m0, s45, 0
ds_read_b128 v[170:173], v210 offset:43008
v_mul_f32 v145, v145, v151
v_mfma_f32_16x16x32_bf16 v[0:3], a[160:163], v[182:185], v[0:3]
v_cvt_pk_bf16_f32 v139, v140, v141
v_cvt_pk_bf16_f32 v140, v142, v143
v_mfma_f32_16x16x32_bf16 v[4:7], a[184:187], v[182:185], v[4:7]
v_cvt_pk_bf16_f32 v141, v144, v145
v_mul_f32 v146, v146, v151
v_mfma_f32_16x16x32_bf16 v[8:11], a[208:211], v[182:185], v[8:11]
s_waitcnt lgkmcnt(1)
ds_read_b128 v[182:185], v210 offset:44032
ds_write_b128 v211, v[138:141] offset:49152
v_mfma_f32_16x16x32_bf16 v[0:3], a[164:167], v[186:189], v[0:3]
s_mov_b32 s39, s37
v_mul_f32 v147, v147, v151
v_mul_f32 v148, v148, v151
v_mfma_f32_16x16x32_bf16 v[4:7], a[188:191], v[186:189], v[4:7]
s_waitcnt lgkmcnt(2)
v_mul_f32 v149, v149, v151
v_cvt_pk_bf16_f32 v142, v146, v147
v_mfma_f32_16x16x32_bf16 v[8:11], a[212:215], v[186:189], v[8:11]
s_mov_b32 s37, s50
ds_read_b128 v[186:189], v210 offset:45056
v_cvt_pk_bf16_f32 v143, v148, v149
v_mfma_f32_16x16x32_bf16 v[12:15], a[144:147], v[170:173], v[12:15]
ds_write_b64 v212, v[142:143] offset:49152
v_mfma_f32_16x16x32_bf16 v[16:19], a[168:171], v[170:173], v[16:19]
v_cvt_pk_bf16_f32 v72, v0, v1
v_cvt_pk_bf16_f32 v73, v2, v3
v_mfma_f32_16x16x32_bf16 v[20:23], a[192:195], v[170:173], v[20:23]
s_waitcnt lgkmcnt(3)
ds_read_b128 v[170:173], v210 offset:46080
buffer_store_dwordx2 v[72:73], v203, s[8:11], s38 offen
v_cvt_pk_bf16_f32 v74, v4, v5
v_mfma_f32_16x16x32_bf16 v[12:15], a[148:151], v[182:185], v[12:15]
v_cvt_pk_bf16_f32 v75, v6, v7
v_mov_b32_dpp v154, v158 quad_perm:[0,1,2,3] row_mask:0x2 bank_mask:0xf
v_mfma_f32_16x16x32_bf16 v[16:19], a[172:175], v[182:185], v[16:19]
v_mul_f32 v167, s3, v167
v_mov_b32_dpp v154, v162 quad_perm:[0,1,2,3] row_mask:0x4 bank_mask:0xf
v_mfma_f32_16x16x32_bf16 v[20:23], a[196:199], v[182:185], v[20:23]
s_waitcnt lgkmcnt(2)
ds_read_b128 v[182:185], v210 offset:47104
v_mul_f32 v154, v154, v167
v_mfma_f32_16x16x32_bf16 v[12:15], a[152:155], v[186:189], v[12:15]
v_cvt_pk_bf16_f32 v154, v154, 0
v_cvt_pk_bf16_f32 v76, v8, v9
v_mfma_f32_16x16x32_bf16 v[16:19], a[176:179], v[186:189], v[16:19]
s_waitcnt vmcnt(1) lgkmcnt(1)
ds_write_b16 v214, v154
v_mfma_f32_16x16x32_bf16 v[20:23], a[200:203], v[186:189], v[20:23]
s_barrier
v_mfma_f32_16x16x32_bf16 v[12:15], a[156:159], v[170:173], v[12:15]
ds_read_b128 v[186:189], v210 offset:48128
ds_read_b128 v[84:87], v200
v_mfma_f32_16x16x32_bf16 v[16:19], a[180:183], v[170:173], v[16:19]
ds_read_b128 v[92:95], v201
ds_read_b128 v[100:103], v202
v_mfma_f32_16x16x32_bf16 v[20:23], a[204:207], v[170:173], v[20:23]
s_waitcnt lgkmcnt(5)
ds_read_b128 v[170:173], v210 offset:49152
ds_read_b128 v[88:91], v194 offset:16
v_mfma_f32_16x16x32_bf16 v[12:15], a[160:163], v[182:185], v[12:15]
ds_read_b128 v[96:99], v195 offset:16
v_cvt_pk_bf16_f32 v77, v10, v11
v_mfma_f32_16x16x32_bf16 v[16:19], a[184:187], v[182:185], v[16:19]
ds_read_b128 v[104:107], v196 offset:16
v_add_u32 v215, 1552, v215
v_mfma_f32_16x16x32_bf16 v[20:23], a[208:211], v[182:185], v[20:23]
ds_read_b128 v[182:185], v210 offset:50176
buffer_store_dwordx2 v[74:75], v203, s[8:11], s38 offen offset:32
s_waitcnt lgkmcnt(8)
v_mfma_f32_16x16x32_bf16 v[12:15], a[164:167], v[186:189], v[12:15]
ds_read_b64 v[112:113], v215 offset:528
v_mfma_f32_16x16x32_bf16 v[16:19], a[188:191], v[186:189], v[16:19]
v_mfma_f32_16x16x32_bf16 v[20:23], a[212:215], v[186:189], v[20:23]
s_waitcnt lgkmcnt(8)
ds_read_b128 v[186:189], v210 offset:51200
v_cvt_pk_bf16_f32 v78, v12, v13
v_mfma_f32_16x16x32_bf16 v[0:3], v[174:177], v[84:87], 0
s_waitcnt lgkmcnt(6)
ds_read_b128 v[84:87], v194
v_cvt_pk_bf16_f32 v79, v14, v15
v_mfma_f32_16x16x32_bf16 v[24:27], a[144:147], v[170:173], v[24:27]
v_cvt_pk_bf16_f32 v80, v16, v17
v_cvt_pk_bf16_f32 v81, v18, v19
v_mfma_f32_16x16x32_bf16 v[28:31], a[168:171], v[170:173], v[28:31]
v_cvt_pk_bf16_f32 v82, v20, v21
v_cvt_pk_bf16_f32 v83, v22, v23
v_mfma_f32_16x16x32_bf16 v[32:35], a[192:195], v[170:173], v[32:35]
ds_read_b128 v[170:173], v210 offset:52224
v_mfma_f32_16x16x32_bf16 v[12:15], v[174:177], v[92:95], 0
ds_read_b128 v[92:95], v195
s_waitcnt lgkmcnt(5)
v_mfma_f32_16x16x32_bf16 v[24:27], a[148:151], v[182:185], v[24:27]
v_mfma_f32_16x16x32_bf16 v[28:31], a[172:175], v[182:185], v[28:31]
v_mfma_f32_16x16x32_bf16 v[32:35], a[196:199], v[182:185], v[32:35]
ds_read_b128 v[182:185], v210 offset:53248
s_waitcnt lgkmcnt(4)
v_mfma_f32_16x16x32_bf16 v[24:27], a[152:155], v[186:189], v[24:27]
v_mfma_f32_16x16x32_bf16 v[28:31], a[176:179], v[186:189], v[28:31]
v_mfma_f32_16x16x32_bf16 v[32:35], a[200:203], v[186:189], v[32:35]
ds_read_b128 v[186:189], v210 offset:54272
s_waitcnt lgkmcnt(3)
v_mfma_f32_16x16x32_bf16 v[24:27], a[156:159], v[170:173], v[24:27]
buffer_store_dwordx2 v[76:77], v203, s[8:11], s38 offen offset:64
v_mfma_f32_16x16x32_bf16 v[28:31], a[180:183], v[170:173], v[28:31]
v_mfma_f32_16x16x32_bf16 v[32:35], a[204:207], v[170:173], v[32:35]
s_waitcnt lgkmcnt(1)
v_mfma_f32_16x16x32_bf16 v[24:27], a[160:163], v[182:185], v[24:27]
v_mfma_f32_16x16x32_bf16 v[28:31], a[184:187], v[182:185], v[28:31]
v_mfma_f32_16x16x32_bf16 v[32:35], a[208:211], v[182:185], v[32:35]
ds_read_b128 v[182:185], v210 offset:18432
s_waitcnt lgkmcnt(1)
v_mfma_f32_16x16x32_bf16 v[24:27], a[164:167], v[186:189], v[24:27]
v_smfmac_f32_16x16x64_bf16 v[0:3], v[178:181], v[84:91], v213
ds_read_b128 v[84:87], v197
ds_read_b128 v[88:91], v197 offset:16
v_mfma_f32_16x16x32_bf16 v[28:31], a[188:191], v[186:189], v[28:31]
v_cvt_pk_bf16_f32 v116, v24, v25
v_cvt_pk_bf16_f32 v117, v26, v27
v_mfma_f32_16x16x32_bf16 v[24:27], v[174:177], v[100:103], 0
ds_read_b128 v[100:103], v196
ds_read_b128 v[174:177], v217 offset:1056
v_mfma_f32_16x16x32_bf16 v[32:35], a[212:215], v[186:189], v[32:35]
ds_read_b128 v[186:189], v210 offset:19456
v_cvt_pk_bf16_f32 v124, v28, v29
v_smfmac_f32_16x16x64_bf16 v[12:15], v[178:181], v[92:99], v213
s_waitcnt lgkmcnt(5)
ds_read_b128 v[92:95], v198
ds_read_b128 v[96:99], v198 offset:16
v_mfma_f32_16x16x32_bf16 v[138:141], a[0:3], v[182:185], 0
v_cvt_pk_bf16_f32 v125, v30, v31
v_cvt_pk_bf16_f32 v132, v32, v33
v_mfma_f32_16x16x32_bf16 v[142:145], a[24:27], v[182:185], 0
v_cvt_pk_bf16_f32 v133, v34, v35
v_mfma_f32_16x16x32_bf16 v[146:149], a[48:51], v[182:185], 0
s_waitcnt lgkmcnt(4)
v_smfmac_f32_16x16x64_bf16 v[24:27], v[178:181], v[100:107], v213
ds_read_b128 v[100:103], v199
ds_read_b128 v[104:107], v199 offset:16
v_mfma_f32_16x16x32_bf16 v[150:153], a[216:219], v[182:185], 0
ds_read_b128 v[178:181], v217 offset:1584
buffer_store_dwordx2 v[78:79], v204, s[8:11], s38 offen
s_waitcnt lgkmcnt(6)
v_smfmac_f32_16x16x64_bf16 v[0:3], v[174:177], v[84:91], v213
ds_read_b128 v[84:87], v200 offset:32
ds_read_b128 v[88:91], v194 offset:48
v_mfma_f32_16x16x32_bf16 v[154:157], a[240:243], v[182:185], 0
s_waitcnt lgkmcnt(5)
v_smfmac_f32_16x16x64_bf16 v[12:15], v[174:177], v[92:99], v213
ds_read_b128 v[92:95], v201 offset:32
ds_read_b128 v[96:99], v195 offset:48
v_mfma_f32_16x16x32_bf16 v[158:161], v[232:235], v[182:185], 0
v_mul_f32 v119, v0, v0
v_add_f32 v118, v0, v1
v_mfma_f32_16x16x32_bf16 v[162:165], v[182:185], a[72:75], 0
s_waitcnt lgkmcnt(5)
v_mul_f32 v127, v12, v12
v_add_f32 v126, v12, v13
v_smfmac_f32_16x16x64_bf16 v[24:27], v[174:177], v[100:107], v213
ds_read_b128 v[100:103], v202 offset:32
ds_read_b128 v[174:177], v217 offset:2112
v_mfma_f32_16x16x32_bf16 v[166:169], v[182:185], a[96:99], 0
s_waitcnt lgkmcnt(5)
ds_read_b128 v[104:107], v196 offset:48
v_fmac_f32 v119, v1, v1
v_mfma_f32_16x16x32_bf16 v[4:7], v[178:181], v[84:87], 0
ds_read_b128 v[84:87], v194 offset:32
v_mul_f32 v135, v24, v24
v_mfma_f32_16x16x32_bf16 v[170:173], v[182:185], a[120:123], 0
s_waitcnt lgkmcnt(5)
ds_read_b128 v[182:185], v210 offset:20480
v_add_f32 v134, v24, v25
v_mfma_f32_16x16x32_bf16 v[16:19], v[178:181], v[92:95], 0
ds_read_b128 v[92:95], v195 offset:32
v_fmac_f32 v135, v25, v25
v_mfma_f32_16x16x32_bf16 v[138:141], a[4:7], v[186:189], v[138:141]
v_fmac_f32 v127, v13, v13
v_add_f32 v134, v134, v26
v_mfma_f32_16x16x32_bf16 v[142:145], a[28:31], v[186:189], v[142:145]
s_waitcnt lgkmcnt(5)
v_fmac_f32 v135, v26, v26
v_add_f32 v118, v118, v2
v_mfma_f32_16x16x32_bf16 v[28:31], v[178:181], v[100:103], 0
ds_read_b128 v[100:103], v196 offset:32
ds_read_b128 v[178:181], v217 offset:2640
v_mfma_f32_16x16x32_bf16 v[146:149], a[52:55], v[186:189], v[146:149]
v_add_f32 v126, v126, v14
v_fmac_f32 v119, v2, v2
v_mfma_f32_16x16x32_bf16 v[150:153], a[220:223], v[186:189], v[150:153]
s_waitcnt lgkmcnt(4)
v_fmac_f32 v127, v14, v14
v_add_f32 v134, v134, v27
v_smfmac_f32_16x16x64_bf16 v[4:7], v[174:177], v[84:91], v213
ds_read_b128 v[84:87], v197 offset:32
ds_read_b128 v[88:91], v197 offset:48
v_mfma_f32_16x16x32_bf16 v[154:157], a[244:247], v[186:189], v[154:157]
s_waitcnt lgkmcnt(4)
buffer_store_dwordx2 v[80:81], v204, s[8:11], s38 offen offset:32
v_fmac_f32 v135, v27, v27
v_smfmac_f32_16x16x64_bf16 v[16:19], v[174:177], v[92:99], v213
s_waitcnt lgkmcnt(3)
ds_read_b128 v[92:95], v198 offset:32
ds_read_b128 v[96:99], v198 offset:48
v_smfmac_f32_16x16x64_bf16 v[28:31], v[174:177], v[100:107], v213
ds_read_b128 v[100:103], v199 offset:32
ds_read_b128 v[104:107], v199 offset:48
v_mfma_f32_16x16x32_bf16 v[158:161], v[236:239], v[186:189], v[158:161]
ds_read_b128 v[174:177], v217 offset:3168
v_add_f32 v118, v118, v3
v_mfma_f32_16x16x32_bf16 v[162:165], v[186:189], a[76:79], v[162:165]
v_add_f32 v126, v126, v15
v_fmac_f32 v119, v3, v3
v_mfma_f32_16x16x32_bf16 v[166:169], v[186:189], a[100:103], v[166:169]
v_fmac_f32 v127, v15, v15
s_waitcnt lgkmcnt(5)
v_smfmac_f32_16x16x64_bf16 v[4:7], v[178:181], v[84:91], v213
ds_read_b128 v[84:87], v200 offset:64
ds_read_b128 v[88:91], v194 offset:80
v_mfma_f32_16x16x32_bf16 v[170:173], v[186:189], a[124:127], v[170:173]
ds_read_b128 v[186:189], v210 offset:21504
s_waitcnt lgkmcnt(6)
v_smfmac_f32_16x16x64_bf16 v[16:19], v[178:181], v[92:99], v213
ds_read_b128 v[92:95], v201 offset:64
ds_read_b128 v[96:99], v195 offset:80
v_mfma_f32_16x16x32_bf16 v[138:141], a[8:11], v[182:185], v[138:141]
v_add_f32 v118, v118, v4
v_fmac_f32 v119, v4, v4
v_mfma_f32_16x16x32_bf16 v[142:145], a[32:35], v[182:185], v[142:145]
s_waitcnt lgkmcnt(6)
v_add_f32 v126, v126, v16
v_fmac_f32 v127, v16, v16
v_smfmac_f32_16x16x64_bf16 v[28:31], v[178:181], v[100:107], v213
ds_read_b128 v[100:103], v202 offset:64
ds_read_b128 v[178:181], v217 offset:3696
v_mfma_f32_16x16x32_bf16 v[146:149], a[56:59], v[182:185], v[146:149]
s_waitcnt lgkmcnt(6)
ds_read_b128 v[104:107], v196 offset:80
v_add_f32 v118, v118, v5
v_mfma_f32_16x16x32_bf16 v[8:11], v[174:177], v[84:87], 0
ds_read_b128 v[84:87], v194 offset:64
v_add_f32 v134, v134, v28
v_mfma_f32_16x16x32_bf16 v[150:153], a[224:227], v[182:185], v[150:153]
buffer_store_dwordx2 v[82:83], v204, s[8:11], s38 offen offset:64
v_fmac_f32 v135, v28, v28
v_mfma_f32_16x16x32_bf16 v[154:157], a[248:251], v[182:185], v[154:157]
s_waitcnt lgkmcnt(5)
v_add_f32 v134, v134, v29
v_fmac_f32 v135, v29, v29
v_mfma_f32_16x16x32_bf16 v[20:23], v[174:177], v[92:95], 0
s_waitcnt lgkmcnt(3)
ds_read_b128 v[92:95], v195 offset:64
v_fmac_f32 v119, v5, v5
v_mfma_f32_16x16x32_bf16 v[32:35], v[174:177], v[100:103], 0
ds_read_b128 v[100:103], v196 offset:64
ds_read_b128 v[174:177], v217 offset:4224
v_mfma_f32_16x16x32_bf16 v[158:161], v[240:243], v[182:185], v[158:161]
v_add_f32 v126, v126, v17
v_fmac_f32 v127, v17, v17
v_mfma_f32_16x16x32_bf16 v[162:165], v[182:185], a[80:83], v[162:165]
s_waitcnt lgkmcnt(3)
v_add_f32 v134, v134, v30
v_fmac_f32 v135, v30, v30
v_smfmac_f32_16x16x64_bf16 v[8:11], v[178:181], v[84:91], v213
ds_read_b128 v[84:87], v197 offset:64
ds_read_b128 v[88:91], v197 offset:80
v_mfma_f32_16x16x32_bf16 v[166:169], v[182:185], a[104:107], v[166:169]
v_add_f32 v118, v118, v6
v_fmac_f32 v119, v6, v6
v_mfma_f32_16x16x32_bf16 v[170:173], v[182:185], a[128:131], v[170:173]
s_waitcnt lgkmcnt(4)
ds_read_b128 v[182:185], v210 offset:22528
v_add_f32 v126, v126, v18
v_smfmac_f32_16x16x64_bf16 v[20:23], v[178:181], v[92:99], v213
ds_read_b128 v[92:95], v198 offset:64
ds_read_b128 v[96:99], v198 offset:80
v_mfma_f32_16x16x32_bf16 v[138:141], a[12:15], v[186:189], v[138:141]
s_waitcnt lgkmcnt(6)
v_fmac_f32 v127, v18, v18
v_add_f32 v134, v134, v31
v_smfmac_f32_16x16x64_bf16 v[32:35], v[178:181], v[100:107], v213
ds_read_b128 v[100:103], v199 offset:64
ds_read_b128 v[104:107], v199 offset:80
v_mfma_f32_16x16x32_bf16 v[142:145], a[36:39], v[186:189], v[142:145]
v_fmac_f32 v135, v31, v31
v_add_f32 v118, v118, v7
v_mfma_f32_16x16x32_bf16 v[146:149], a[60:63], v[186:189], v[146:149]
v_fmac_f32 v119, v7, v7
v_add_f32 v126, v126, v19
v_mfma_f32_16x16x32_bf16 v[150:153], a[228:231], v[186:189], v[150:153]
v_fmac_f32 v127, v19, v19
v_and_b32 v180, s44, v208
v_mfma_f32_16x16x32_bf16 v[154:157], a[252:255], v[186:189], v[154:157]
s_waitcnt lgkmcnt(5)
v_add_u32 v214, 1552, v214
v_mov_b32 v181, 0
v_smfmac_f32_16x16x64_bf16 v[8:11], v[174:177], v[84:91], v213
buffer_store_dwordx2 v[116:117], v205, s[8:11], s38 offen
v_mfma_f32_16x16x32_bf16 v[158:161], v[244:247], v[186:189], v[158:161]
v_mfma_f32_16x16x32_bf16 v[162:165], v[186:189], a[84:87], v[162:165]
s_waitcnt lgkmcnt(2)
v_add_f32 v118, v118, v8
v_fmac_f32 v119, v8, v8
v_smfmac_f32_16x16x64_bf16 v[20:23], v[174:177], v[92:99], v213
v_add_f32 v118, v118, v9
v_mfma_f32_16x16x32_bf16 v[166:169], v[186:189], a[108:111], v[166:169]
v_fmac_f32 v119, v9, v9
v_add_f32 v118, v118, v10
v_mfma_f32_16x16x32_bf16 v[170:173], v[186:189], a[132:135], v[170:173]
s_waitcnt lgkmcnt(0)
ds_read_b128 v[186:189], v210 offset:23552
v_add_f32 v126, v126, v20
v_smfmac_f32_16x16x64_bf16 v[32:35], v[174:177], v[100:107], v213
v_fmac_f32 v127, v20, v20
v_mfma_f32_16x16x32_bf16 v[138:141], a[16:19], v[182:185], v[138:141]
v_add_f32 v126, v126, v21
v_fmac_f32 v127, v21, v21
v_mfma_f32_16x16x32_bf16 v[142:145], a[40:43], v[182:185], v[142:145]
v_add_f32 v134, v134, v32
v_fmac_f32 v135, v32, v32
v_mfma_f32_16x16x32_bf16 v[146:149], a[64:67], v[182:185], v[146:149]
v_add_f32 v134, v134, v33
v_fmac_f32 v135, v33, v33
v_mfma_f32_16x16x32_bf16 v[150:153], a[232:235], v[182:185], v[150:153]
v_add_f32 v134, v134, v34
v_fmac_f32 v135, v34, v34
v_mfma_f32_16x16x32_bf16 v[154:157], v[224:227], v[182:185], v[154:157]
v_fmac_f32 v119, v10, v10
v_add_f32 v126, v126, v22
v_mfma_f32_16x16x32_bf16 v[158:161], v[248:251], v[182:185], v[158:161]
v_fmac_f32 v127, v22, v22
v_add_f32 v134, v134, v35
v_mfma_f32_16x16x32_bf16 v[162:165], v[182:185], a[88:91], v[162:165]
v_fmac_f32 v135, v35, v35
v_add_f32 v118, v118, v11
v_mfma_f32_16x16x32_bf16 v[166:169], v[182:185], a[112:115], v[166:169]
v_fmac_f32 v119, v11, v11
v_add_f32 v126, v126, v23
v_mfma_f32_16x16x32_bf16 v[170:173], v[182:185], a[136:139], v[170:173]
s_waitcnt lgkmcnt(0)
ds_read_b128 v[182:185], v210 offset:24576
v_fmac_f32 v127, v23, v23
v_mfma_f32_16x16x32_bf16 v[138:141], a[20:23], v[186:189], v[138:141]
buffer_store_dwordx2 v[124:125], v205, s[8:11], s38 offen offset:32
v_permlane16_swap_b32 v134, v135
v_mfma_f32_16x16x32_bf16 v[142:145], a[44:47], v[186:189], v[142:145]
v_permlane16_swap_b32 v118, v119
v_mfma_f32_16x16x32_bf16 v[146:149], a[68:71], v[186:189], v[146:149]
v_cvt_pk_bf16_f32 v78, v138, v139
v_cvt_pk_bf16_f32 v79, v140, v141
v_mfma_f32_16x16x32_bf16 v[150:153], a[236:239], v[186:189], v[150:153]
v_cvt_pk_bf16_f32 v80, v142, v143
v_cvt_pk_bf16_f32 v81, v144, v145
v_mfma_f32_16x16x32_bf16 v[154:157], v[228:231], v[186:189], v[154:157]
v_cvt_pk_bf16_f32 v82, v146, v147
v_cvt_pk_bf16_f32 v83, v148, v149
v_mfma_f32_16x16x32_bf16 v[158:161], v[252:255], v[186:189], v[158:161]
v_cvt_pk_bf16_f32 v72, v150, v151
v_cvt_pk_bf16_f32 v73, v152, v153
v_mfma_f32_16x16x32_bf16 v[162:165], v[186:189], a[92:95], v[162:165]
v_cvt_pk_bf16_f32 v74, v154, v155
v_cvt_pk_bf16_f32 v75, v156, v157
v_mfma_f32_16x16x32_bf16 v[166:169], v[186:189], a[116:119], v[166:169]
v_cvt_pk_bf16_f32 v76, v158, v159
v_cvt_pk_bf16_f32 v77, v160, v161
v_mfma_f32_16x16x32_bf16 v[170:173], v[186:189], a[140:143], v[170:173]
s_waitcnt lgkmcnt(0)
ds_read_b128 v[186:189], v210 offset:25600
v_cvt_pk_bf16_f32 v114, v162, v163
v_mfma_f32_16x16x32_bf16 v[138:141], a[0:3], v[182:185], 0
v_cvt_pk_bf16_f32 v115, v164, v165
v_cvt_pk_bf16_f32 v122, v166, v167
v_mfma_f32_16x16x32_bf16 v[142:145], a[24:27], v[182:185], 0
v_cvt_pk_bf16_f32 v123, v168, v169
v_cvt_pk_bf16_f32 v130, v170, v171
v_mfma_f32_16x16x32_bf16 v[146:149], a[48:51], v[182:185], 0
v_cvt_pk_bf16_f32 v131, v172, v173
v_add_f32 v134, v134, v135
v_mfma_f32_16x16x32_bf16 v[150:153], a[216:219], v[182:185], 0
v_permlane16_swap_b32 v126, v127
v_mfma_f32_16x16x32_bf16 v[154:157], a[240:243], v[182:185], 0
v_add_f32 v118, v118, v119
v_mov_b32 v135, v134
v_mfma_f32_16x16x32_bf16 v[158:161], v[232:235], v[182:185], 0
v_add_f32 v126, v126, v127
v_permlane32_swap_b32 v134, v135
v_mfma_f32_16x16x32_bf16 v[162:165], v[182:185], a[72:75], 0
buffer_store_dwordx2 v[132:133], v205, s[8:11], s38 offen offset:64
v_permlane32_swap_b32 v118, v126
v_mfma_f32_16x16x32_bf16 v[166:169], v[182:185], a[96:99], 0
v_add_f32 v134, v134, v135
v_add_f32 v118, v118, v126
v_mfma_f32_16x16x32_bf16 v[170:173], v[182:185], a[120:123], 0
s_waitcnt lgkmcnt(0)
ds_read_b128 v[182:185], v210 offset:26624
ds_write_b32 v209, v134 offset:512
v_mfma_f32_16x16x32_bf16 v[138:141], a[4:7], v[186:189], v[138:141]
ds_write_b32 v209, v118
v_mfma_f32_16x16x32_bf16 v[142:145], a[28:31], v[186:189], v[142:145]
v_mfma_f32_16x16x32_bf16 v[146:149], a[52:55], v[186:189], v[146:149]
v_mfma_f32_16x16x32_bf16 v[150:153], a[220:223], v[186:189], v[150:153]
v_mfma_f32_16x16x32_bf16 v[154:157], a[244:247], v[186:189], v[154:157]
v_mfma_f32_16x16x32_bf16 v[158:161], v[236:239], v[186:189], v[158:161]
v_mfma_f32_16x16x32_bf16 v[162:165], v[186:189], a[76:79], v[162:165]
s_waitcnt lgkmcnt(0)
s_barrier
v_mfma_f32_16x16x32_bf16 v[166:169], v[186:189], a[100:103], v[166:169]
ds_read_b128 v[102:105], v210 offset:55296
ds_read_b128 v[106:109], v210 offset:56320
v_mfma_f32_16x16x32_bf16 v[170:173], v[186:189], a[124:127], v[170:173]
ds_read_b128 v[186:189], v210 offset:27648
v_mfma_f32_16x16x32_bf16 v[138:141], a[8:11], v[182:185], v[138:141]
v_mfma_f32_16x16x32_bf16 v[142:145], a[32:35], v[182:185], v[142:145]
v_mfma_f32_16x16x32_bf16 v[146:149], a[56:59], v[182:185], v[146:149]
v_mfma_f32_16x16x32_bf16 v[150:153], a[224:227], v[182:185], v[150:153]
buffer_load_dwordx4 v180, s[4:7], s52 offen nt lds
v_mfma_f32_16x16x32_bf16 v[154:157], a[248:251], v[182:185], v[154:157]
s_waitcnt lgkmcnt(2)
v_add_f32 v102, v102, v103
v_add_f32 v104, v104, v105
v_mfma_f32_16x16x32_bf16 v[158:161], v[240:243], v[182:185], v[158:161]
s_waitcnt lgkmcnt(1)
v_add_f32 v106, v106, v107
v_add_f32 v108, v108, v109
v_mfma_f32_16x16x32_bf16 v[162:165], v[182:185], a[80:83], v[162:165]
s_waitcnt lgkmcnt(0)
v_add_f32 v102, v102, v104
v_add_f32 v106, v106, v108
v_mfma_f32_16x16x32_bf16 v[166:169], v[182:185], a[104:107], v[166:169]
s_add_u32 m0, s45, 4112
ds_read_b128 v[108:111], v215 offset:512
v_mul_f32 v103, s48, v102
v_mfma_f32_16x16x32_bf16 v[170:173], v[182:185], a[128:131], v[170:173]
s_add_u32 s40, s37, 196224
ds_read_b128 v[182:185], v210 offset:28672
v_mul_f32 v104, s73, v102
v_mfma_f32_16x16x32_bf16 v[138:141], a[12:15], v[186:189], v[138:141]
v_mul_f32 v106, s73, v106
v_fma_f32 v106, -v103, v104, v106
v_mfma_f32_16x16x32_bf16 v[142:145], a[36:39], v[186:189], v[142:145]
v_max_f32 v106, 0, v106
v_add_f32 v106, s49, v106
v_mfma_f32_16x16x32_bf16 v[146:149], a[60:63], v[186:189], v[146:149]
v_rsq_f32 v102, v106
v_mfma_f32_16x16x32_bf16 v[150:153], a[228:231], v[186:189], v[150:153]
v_mul_f32_e64 v103, -v103, v102
v_mfma_f32_16x16x32_bf16 v[154:157], a[252:255], v[186:189], v[154:157]
buffer_load_dwordx4 v180, s[4:7], s40 offen nt lds
v_mfma_f32_16x16x32_bf16 v[158:161], v[244:247], v[186:189], v[158:161]
ds_write_b64 v211, v[102:103] offset:36864
v_mfma_f32_16x16x32_bf16 v[162:165], v[186:189], a[84:87], v[162:165]
s_add_u32 m0, s45, 8224
s_add_u32 s40, s37, 392448
v_mfma_f32_16x16x32_bf16 v[166:169], v[186:189], a[108:111], v[166:169]
ds_read_b64 v[118:119], v219
ds_read_b64 v[126:127], v219 offset:256
v_mfma_f32_16x16x32_bf16 v[170:173], v[186:189], a[132:135], v[170:173]
s_waitcnt lgkmcnt(3)
ds_read_b128 v[186:189], v210 offset:29696
ds_read_b64 v[134:135], v219 offset:512
v_mfma_f32_16x16x32_bf16 v[138:141], a[16:19], v[182:185], v[138:141]
v_mfma_f32_16x16x32_bf16 v[142:145], a[40:43], v[182:185], v[142:145]
v_mfma_f32_16x16x32_bf16 v[146:149], a[64:67], v[182:185], v[146:149]
v_mfma_f32_16x16x32_bf16 v[150:153], a[232:235], v[182:185], v[150:153]
s_waitcnt lgkmcnt(3)
v_fma_f32 v220, v0, v118, v119
v_fma_f32 v221, v1, v118, v119
v_mfma_f32_16x16x32_bf16 v[154:157], v[224:227], v[182:185], v[154:157]
v_fma_f32 v222, v2, v118, v119
v_fma_f32 v223, v3, v118, v119
v_mfma_f32_16x16x32_bf16 v[158:161], v[248:251], v[182:185], v[158:161]
buffer_load_dwordx4 v180, s[4:7], s40 offen nt lds
v_mfma_f32_16x16x32_bf16 v[162:165], v[182:185], a[88:91], v[162:165]
s_add_u32 m0, s45, 12336
v_cvt_pk_bf16_f32 v90, v220, v221
v_cvt_pk_bf16_f32 v91, v222, v223
v_mfma_f32_16x16x32_bf16 v[166:169], v[182:185], a[112:115], v[166:169]
s_add_u32 s40, s37, 588672
v_fma_f32 v220, v4, v118, v119
v_fma_f32 v221, v5, v118, v119
v_mfma_f32_16x16x32_bf16 v[170:173], v[182:185], a[136:139], v[170:173]
s_waitcnt lgkmcnt(1)
ds_read_b128 v[182:185], v210 offset:30720
v_fma_f32 v222, v6, v118, v119
v_mfma_f32_16x16x32_bf16 v[138:141], a[20:23], v[186:189], v[138:141]
v_fma_f32 v223, v7, v118, v119
v_cvt_pk_bf16_f32 v92, v220, v221
v_mfma_f32_16x16x32_bf16 v[142:145], a[44:47], v[186:189], v[142:145]
v_cvt_pk_bf16_f32 v93, v222, v223
v_fma_f32 v220, v8, v118, v119
v_mfma_f32_16x16x32_bf16 v[146:149], a[68:71], v[186:189], v[146:149]
ds_write_b128 v211, v[90:93]
v_mfma_f32_16x16x32_bf16 v[150:153], a[236:239], v[186:189], v[150:153]
v_cvt_pk_bf16_f32 v96, v138, v139
v_cvt_pk_bf16_f32 v97, v140, v141
v_mfma_f32_16x16x32_bf16 v[154:157], v[228:231], v[186:189], v[154:157]
v_cvt_pk_bf16_f32 v98, v142, v143
v_cvt_pk_bf16_f32 v99, v144, v145
v_mfma_f32_16x16x32_bf16 v[158:161], v[252:255], v[186:189], v[158:161]
buffer_load_dwordx4 v180, s[4:7], s40 offen nt lds
v_mfma_f32_16x16x32_bf16 v[162:165], v[186:189], a[92:95], v[162:165]
s_add_u32 m0, s45, 16448
v_cvt_pk_bf16_f32 v100, v146, v147
v_cvt_pk_bf16_f32 v101, v148, v149
v_mfma_f32_16x16x32_bf16 v[166:169], v[186:189], a[116:119], v[166:169]
s_add_u32 s40, s37, 784896
v_cvt_pk_bf16_f32 v88, v158, v159
v_cvt_pk_bf16_f32 v89, v160, v161
v_mfma_f32_16x16x32_bf16 v[170:173], v[186:189], a[140:143], v[170:173]
s_waitcnt lgkmcnt(1)
ds_read_b128 v[186:189], v210 offset:31744
v_cvt_pk_bf16_f32 v86, v154, v155
v_mfma_f32_16x16x32_bf16 v[138:141], a[0:3], v[182:185], 0
v_cvt_pk_bf16_f32 v87, v156, v157
v_cvt_pk_bf16_f32 v124, v166, v167
v_mfma_f32_16x16x32_bf16 v[142:145], a[24:27], v[182:185], 0
v_cvt_pk_bf16_f32 v125, v168, v169
v_cvt_pk_bf16_f32 v84, v150, v151
v_mfma_f32_16x16x32_bf16 v[146:149], a[48:51], v[182:185], 0
ds_read_b128 v[182:185], v210 offset:32768
v_cvt_pk_bf16_f32 v85, v152, v153
v_cvt_pk_bf16_f32 v116, v162, v163
v_mfma_f32_16x16x16_bf16 v[154:157], v[82:83], v[88:89], 0
v_cvt_pk_bf16_f32 v117, v164, v165
v_fma_f32 v221, v9, v118, v119
v_fma_f32 v222, v10, v118, v119
v_mfma_f32_16x16x16_bf16 v[158:161], v[100:101], v[88:89], 0
v_fma_f32 v223, v11, v118, v119
v_cvt_pk_bf16_f32 v94, v220, v221
v_cvt_pk_bf16_f32 v95, v222, v223
v_fma_f32 v220, v12, v126, v127
s_waitcnt lgkmcnt(1)
v_mfma_f32_16x16x32_bf16 v[138:141], a[4:7], v[186:189], v[138:141]
buffer_load_dwordx4 v180, s[4:7], s40 offen nt lds
v_mfma_f32_16x16x32_bf16 v[142:145], a[28:31], v[186:189], v[142:145]
s_add_u32 m0, s45, 20560
ds_write_b64 v212, v[94:95]
v_mfma_f32_16x16x32_bf16 v[146:149], a[52:55], v[186:189], v[146:149]
s_waitcnt lgkmcnt(1)
v_fma_f32 v221, v13, v126, v127
v_fma_f32 v222, v14, v126, v127
v_mfma_f32_16x16x32_bf16 v[138:141], a[8:11], v[182:185], v[138:141]
s_add_u32 s40, s37, 981120
ds_read_b128 v[186:189], v210 offset:33792
v_fma_f32 v223, v15, v126, v127
v_mfma_f32_16x16x32_bf16 v[142:145], a[32:35], v[182:185], v[142:145]
v_cvt_pk_bf16_f32 v174, v220, v221
v_cvt_pk_bf16_f32 v175, v222, v223
v_mfma_f32_16x16x32_bf16 v[146:149], a[56:59], v[182:185], v[146:149]
ds_read_b128 v[182:185], v210 offset:34816
v_fma_f32 v220, v16, v126, v127
v_fma_f32 v221, v17, v126, v127
v_mfma_f32_16x16x16_bf16 v[166:169], v[112:113], v[88:89], v[206:209]
v_fma_f32 v222, v18, v126, v127
v_fma_f32 v223, v19, v126, v127
v_cvt_pk_bf16_f32 v176, v220, v221
v_mfma_f32_16x16x16_bf16 v[150:153], v[112:113], v[76:77], v[206:209]
v_cvt_pk_bf16_f32 v177, v222, v223
v_fma_f32 v220, v20, v126, v127
v_fma_f32 v221, v21, v126, v127
v_fma_f32 v222, v22, v126, v127
v_mfma_f32_16x16x32_bf16 v[154:157], v[78:81], v[84:87], v[154:157]
s_waitcnt lgkmcnt(1)
ds_write_b128 v211, v[174:177] offset:6144
v_mfma_f32_16x16x32_bf16 v[138:141], a[12:15], v[186:189], v[138:141]
s_waitcnt lgkmcnt(1)
buffer_load_dwordx4 v180, s[4:7], s40 offen nt lds
v_mfma_f32_16x16x32_bf16 v[142:145], a[36:39], v[186:189], v[142:145]
s_add_u32 m0, s45, 24672
v_fma_f32 v223, v23, v126, v127
v_cvt_pk_bf16_f32 v178, v220, v221
v_mfma_f32_16x16x32_bf16 v[146:149], a[60:63], v[186:189], v[146:149]
s_add_u32 s40, s37, 1177344
ds_read_b128 v[186:189], v210 offset:35840
v_cvt_pk_bf16_f32 v179, v222, v223
v_mfma_f32_16x16x32_bf16 v[138:141], a[16:19], v[182:185], v[138:141]
ds_write_b64 v212, v[178:179] offset:6144
v_mfma_f32_16x16x32_bf16 v[142:145], a[40:43], v[182:185], v[142:145]
v_fma_f32 v220, v24, v134, v135
v_fma_f32 v221, v25, v134, v135
v_mfma_f32_16x16x32_bf16 v[150:153], v[108:111], v[72:75], v[150:153]
v_fma_f32 v222, v26, v134, v135
v_fma_f32 v223, v27, v134, v135
v_mfma_f32_16x16x32_bf16 v[146:149], a[64:67], v[182:185], v[146:149]
ds_read_b128 v[182:185], v210 offset:30720
v_cvt_pk_bf16_f32 v90, v220, v221
v_mfma_f32_16x16x32_bf16 v[158:161], v[96:99], v[84:87], v[158:161]
s_waitcnt lgkmcnt(2)
v_cvt_pk_bf16_f32 v91, v222, v223
v_fma_f32 v220, v28, v134, v135
v_mfma_f32_16x16x32_bf16 v[138:141], a[20:23], v[186:189], v[138:141]
v_fma_f32 v221, v29, v134, v135
v_fma_f32 v222, v30, v134, v135
v_mfma_f32_16x16x32_bf16 v[142:145], a[44:47], v[186:189], v[142:145]
buffer_load_dwordx4 v180, s[4:7], s40 offen nt lds
v_mfma_f32_16x16x32_bf16 v[146:149], a[68:71], v[186:189], v[146:149]
s_add_u32 m0, s45, 28784
ds_read_b128 v[186:189], v210 offset:31744
v_cvt_pk_bf16_f32 v102, v138, v139
v_mfma_f32_16x16x32_bf16 v[166:169], v[108:111], v[84:87], v[166:169]
s_add_u32 s40, s37, 1373568
v_cvt_pk_bf16_f32 v103, v140, v141
v_cvt_pk_bf16_f32 v104, v142, v143
v_cvt_pk_bf16_f32 v105, v144, v145
v_mfma_f32_16x16x16_bf16 v[138:141], v[82:83], v[76:77], 0
v_cvt_pk_bf16_f32 v106, v146, v147
v_cvt_pk_bf16_f32 v107, v148, v149
v_fma_f32 v223, v31, v134, v135
v_mfma_f32_16x16x16_bf16 v[142:145], v[100:101], v[76:77], 0
v_cvt_pk_bf16_f32 v92, v220, v221
v_cvt_pk_bf16_f32 v93, v222, v223
v_fma_f32 v220, v32, v134, v135
v_mfma_f32_16x16x16_bf16 v[162:165], v[106:107], v[88:89], 0
v_fma_f32 v221, v33, v134, v135
v_fma_f32 v222, v34, v134, v135
v_fma_f32 v223, v35, v134, v135
v_mfma_f32_16x16x16_bf16 v[146:149], v[106:107], v[76:77], 0
v_cvt_pk_bf16_f32 v132, v170, v171
v_cvt_pk_bf16_f32 v133, v172, v173
v_cvt_pk_bf16_f32 v94, v220, v221
v_cvt_pk_bf16_f32 v95, v222, v223
v_mfma_f32_16x16x32_bf16 v[138:141], v[78:81], v[72:75], v[138:141]
ds_write_b128 v211, v[90:93] offset:12288
v_mfma_f32_16x16x32_bf16 v[142:145], v[96:99], v[72:75], v[142:145]
s_waitcnt lgkmcnt(2)
s_nop 2
v_exp_f32 v138, v138
v_mfma_f32_16x16x32_bf16 v[118:121], v[182:185], a[72:75], 0
buffer_load_dwordx4 v180, s[4:7], s40 offen nt lds
v_mfma_f32_16x16x32_bf16 v[126:129], v[182:185], a[96:99], 0
s_add_u32 m0, s45, 32896
ds_write_b64 v212, v[94:95] offset:12288
v_mfma_f32_16x16x32_bf16 v[134:137], v[182:185], a[120:123], 0
s_add_u32 s40, s37, 1569792
v_exp_f32 v139, v139
v_mfma_f32_16x16x32_bf16 v[146:149], v[102:105], v[72:75], v[146:149]
ds_read_b64 v[76:77], v215 offset:16
v_cvt_pk_bf16_f32 v174, v138, v139
v_mfma_f32_16x16x32_bf16 v[90:93], a[216:219], v[182:185], 0
v_exp_f32 v140, v140
v_mfma_f32_16x16x32_bf16 v[170:173], a[240:243], v[182:185], 0
v_exp_f32 v141, v141
v_mfma_f32_16x16x32_bf16 v[220:223], v[232:235], v[182:185], 0
s_waitcnt lgkmcnt(3)
ds_read_b128 v[182:185], v210 offset:32768
v_cvt_pk_bf16_f32 v175, v140, v141
v_mfma_f32_16x16x32_bf16 v[118:121], v[186:189], a[76:79], v[118:121]
v_exp_f32 v142, v142
v_mfma_f32_16x16x32_bf16 v[126:129], v[186:189], a[100:103], v[126:129]
v_exp_f32 v143, v143
v_mfma_f32_16x16x32_bf16 v[134:137], v[186:189], a[124:127], v[134:137]
v_exp_f32 v144, v144
v_mfma_f32_16x16x32_bf16 v[90:93], a[220:223], v[186:189], v[90:93]
buffer_load_dwordx4 v180, s[4:7], s40 offen nt lds
v_mfma_f32_16x16x32_bf16 v[170:173], a[244:247], v[186:189], v[170:173]
v_exp_f32 v145, v145
v_mfma_f32_16x16x32_bf16 v[220:223], v[236:239], v[186:189], v[220:223]
s_waitcnt lgkmcnt(0)
ds_read_b128 v[186:189], v210 offset:33792
v_cvt_pk_bf16_f32 v176, v142, v143
v_mfma_f32_16x16x32_bf16 v[118:121], v[182:185], a[80:83], v[118:121]
v_exp_f32 v150, v150
v_mfma_f32_16x16x32_bf16 v[126:129], v[182:185], a[104:107], v[126:129]
v_cvt_pk_bf16_f32 v177, v144, v145
v_cvt_pk_bf16_f32 v180, v150, 0
v_mfma_f32_16x16x32_bf16 v[134:137], v[182:185], a[128:131], v[134:137]
v_exp_f32 v154, v154
v_mfma_f32_16x16x32_bf16 v[90:93], a[224:227], v[182:185], v[90:93]
v_exp_f32 v155, v155
v_mfma_f32_16x16x32_bf16 v[162:165], v[102:105], v[84:87], v[162:165]
v_exp_f32 v156, v156
v_mfma_f32_16x16x32_bf16 v[170:173], a[248:251], v[182:185], v[170:173]
v_exp_f32 v157, v157
v_mfma_f32_16x16x32_bf16 v[220:223], v[240:243], v[182:185], v[220:223]
s_waitcnt lgkmcnt(0)
ds_read_b128 v[182:185], v210 offset:34816
ds_read_b128 v[72:75], v215
v_mfma_f32_16x16x32_bf16 v[118:121], v[186:189], a[84:87], v[118:121]
v_exp_f32 v158, v158
v_mfma_f32_16x16x32_bf16 v[126:129], v[186:189], a[108:111], v[126:129]
v_exp_f32 v159, v159
v_mfma_f32_16x16x32_bf16 v[134:137], v[186:189], a[132:135], v[134:137]
v_exp_f32 v160, v160
v_mfma_f32_16x16x32_bf16 v[90:93], a[228:231], v[186:189], v[90:93]
v_exp_f32 v161, v161
v_mfma_f32_16x16x32_bf16 v[170:173], a[252:255], v[186:189], v[170:173]
v_exp_f32 v166, v166
v_mfma_f32_16x16x32_bf16 v[220:223], v[244:247], v[186:189], v[220:223]
s_waitcnt lgkmcnt(1)
ds_read_b128 v[186:189], v210 offset:35840
v_exp_f32 v146, v146
v_mfma_f32_16x16x32_bf16 v[118:121], v[182:185], a[88:91], v[118:121]
v_exp_f32 v147, v147
v_mfma_f32_16x16x32_bf16 v[126:129], v[182:185], a[112:115], v[126:129]
v_exp_f32 v148, v148
v_mfma_f32_16x16x32_bf16 v[134:137], v[182:185], a[136:139], v[134:137]
v_exp_f32 v149, v149
v_mfma_f32_16x16x32_bf16 v[90:93], a[232:235], v[182:185], v[90:93]
v_exp_f32 v162, v162
v_mfma_f32_16x16x32_bf16 v[170:173], v[224:227], v[182:185], v[170:173]
v_exp_f32 v163, v163
v_mfma_f32_16x16x32_bf16 v[220:223], v[248:251], v[182:185], v[220:223]
s_waitcnt lgkmcnt(0)
v_exp_f32 v164, v164
v_mfma_f32_16x16x32_bf16 v[118:121], v[186:189], a[92:95], v[118:121]
v_exp_f32 v165, v165
v_mfma_f32_16x16x32_bf16 v[126:129], v[186:189], a[116:119], v[126:129]
v_cvt_pk_bf16_f32 v178, v146, v147
v_cvt_pk_bf16_f32 v179, v148, v149
v_mfma_f32_16x16x32_bf16 v[134:137], v[186:189], a[140:143], v[134:137]
v_cvt_pk_bf16_f32 v118, v118, v119
v_cvt_pk_bf16_f32 v119, v120, v121
v_mfma_f32_16x16x32_bf16 v[90:93], a[236:239], v[186:189], v[90:93]
ds_read_u16 v120, v214 offset:1024
v_cvt_pk_bf16_f32 v126, v126, v127
v_mfma_f32_16x16x32_bf16 v[170:173], v[228:231], v[186:189], v[170:173]
v_cvt_pk_bf16_f32 v127, v128, v129
v_cvt_pk_bf16_f32 v134, v134, v135
v_mfma_f32_16x16x32_bf16 v[220:223], v[252:255], v[186:189], v[220:223]
ds_read_u16 v128, v214 offset:1032
v_cvt_pk_bf16_f32 v90, v90, v91
v_mfma_f32_16x16x32_bf16 v[150:153], v[190:193], v[174:177], 0
v_cvt_pk_bf16_f32 v91, v92, v93
v_cvt_pk_bf16_f32 v92, v170, v171
v_mfma_f32_16x16x32_bf16 v[138:141], v[114:117], v[174:177], 0
v_cvt_pk_bf16_f32 v93, v172, v173
v_cvt_pk_bf16_f32 v135, v136, v137
v_mfma_f32_16x16x32_bf16 v[142:145], v[122:125], v[174:177], 0
ds_read_u16 v136, v214 offset:1040
v_mov_b32 v121, 0
v_mfma_f32_16x16x32_bf16 v[146:149], v[130:133], v[174:177], 0
v_cvt_pk_bf16_f32 v174, v154, v155
v_cvt_pk_bf16_f32 v175, v156, v157
v_mfma_f32_16x16x32_bf16 v[150:153], v[190:193], v[178:181], v[150:153]
s_waitcnt lgkmcnt(2)
v_cvt_pk_bf16_f32 v176, v158, v159
v_cvt_pk_bf16_f32 v177, v160, v161
v_mfma_f32_16x16x32_bf16 v[138:141], v[118:121], v[178:181], v[138:141]
v_mov_b32 v129, 0
v_mov_b32 v137, 0
v_mfma_f32_16x16x32_bf16 v[154:157], v[114:117], v[174:177], 0
v_rcp_f32 v151, v150
v_mfma_f32_16x16x32_bf16 v[158:161], v[122:125], v[174:177], 0
s_waitcnt lgkmcnt(1)
v_max3_u32 v218, v218, v150, v151
v_mul_f32 v151, s3, v151
v_mfma_f32_16x16x32_bf16 v[142:145], v[126:129], v[178:181], v[142:145]
s_waitcnt lgkmcnt(0)
v_mul_f32 v138, v138, v151
v_mul_f32 v139, v139, v151
v_mfma_f32_16x16x32_bf16 v[146:149], v[134:137], v[178:181], v[146:149]
v_cvt_pk_bf16_f32 v180, v166, 0
v_mul_f32 v140, v140, v151
v_mfma_f32_16x16x32_bf16 v[166:169], v[190:193], v[174:177], 0
v_mul_f32 v141, v141, v151
v_cvt_pk_bf16_f32 v138, v138, v139
v_mul_f32 v142, v142, v151
v_mul_f32 v143, v143, v151
v_mul_f32 v144, v144, v151
v_mul_f32 v145, v145, v151
v_cvt_pk_bf16_f32 v139, v140, v141
v_cvt_pk_bf16_f32 v140, v142, v143
v_cvt_pk_bf16_f32 v141, v144, v145
v_cvt_pk_bf16_f32 v178, v162, v163
v_cvt_pk_bf16_f32 v179, v164, v165
v_mfma_f32_16x16x32_bf16 v[162:165], v[130:133], v[174:177], 0
ds_write_b128 v211, v[138:141] offset:36864
v_mfma_f32_16x16x32_bf16 v[138:141], v[78:81], v[90:93], 0
v_mul_f32 v146, v146, v151
v_mul_f32 v147, v147, v151
v_mfma_f32_16x16x32_bf16 v[166:169], v[190:193], v[178:181], v[166:169]
v_mul_f32 v148, v148, v151
v_mul_f32 v149, v149, v151
v_mfma_f32_16x16x32_bf16 v[154:157], v[118:121], v[178:181], v[154:157]
v_cvt_pk_bf16_f32 v142, v146, v147
v_cvt_pk_bf16_f32 v143, v148, v149
v_mfma_f32_16x16x32_bf16 v[158:161], v[126:129], v[178:181], v[158:161]
ds_write_b64 v212, v[142:143] offset:36864
v_mfma_f32_16x16x32_bf16 v[142:145], v[96:99], v[90:93], 0
v_rcp_f32 v167, v166
v_mfma_f32_16x16x32_bf16 v[162:165], v[134:137], v[178:181], v[162:165]
v_max3_u32 v218, v218, v166, v167
v_cvt_pk_bf16_f32 v94, v220, v221
v_mfma_f32_16x16x32_bf16 v[150:153], v[108:111], v[90:93], v[206:209]
v_cvt_pk_bf16_f32 v95, v222, v223
v_mul_f32 v167, s3, v167
v_mfma_f32_16x16x32_bf16 v[146:149], v[102:105], v[90:93], 0
v_mul_f32 v154, v154, v167
v_mul_f32 v155, v155, v167
v_mul_f32 v156, v156, v167
v_mfma_f32_16x16x16_bf16 v[138:141], v[82:83], v[94:95], v[138:141]
v_mul_f32 v157, v157, v167
v_cvt_pk_bf16_f32 v154, v154, v155
v_mul_f32 v158, v158, v167
v_mfma_f32_16x16x16_bf16 v[142:145], v[100:101], v[94:95], v[142:145]
v_mul_f32 v159, v159, v167
v_mul_f32 v160, v160, v167
v_mul_f32 v161, v161, v167
v_mfma_f32_16x16x16_bf16 v[150:153], v[112:113], v[94:95], v[150:153]
v_cvt_pk_bf16_f32 v155, v156, v157
v_cvt_pk_bf16_f32 v156, v158, v159
v_cvt_pk_bf16_f32 v157, v160, v161
v_mfma_f32_16x16x16_bf16 v[146:149], v[106:107], v[94:95], v[146:149]
v_mul_f32 v162, v162, v167
v_mul_f32 v163, v163, v167
v_mul_f32 v164, v164, v167
v_mul_f32 v165, v165, v167
v_mfma_f32_16x16x16_bf16 v[166:169], v[76:77], v[112:113], v[206:209]
v_cvt_pk_bf16_f32 v158, v162, v163
v_cvt_pk_bf16_f32 v159, v164, v165
v_exp_f32 v138, v138
v_mfma_f32_16x16x16_bf16 v[162:165], v[76:77], v[106:107], 0
v_exp_f32 v139, v139
v_exp_f32 v140, v140
v_mfma_f32_16x16x32_bf16 v[166:169], v[72:75], v[108:111], v[166:169]
ds_write_b128 v211, v[154:157] offset:43008
v_mfma_f32_16x16x16_bf16 v[154:157], v[76:77], v[82:83], 0
v_exp_f32 v141, v141
v_exp_f32 v142, v142
v_mfma_f32_16x16x32_bf16 v[162:165], v[72:75], v[102:105], v[162:165]
v_exp_f32 v143, v143
v_mfma_f32_16x16x32_bf16 v[154:157], v[72:75], v[78:81], v[154:157]
ds_write_b64 v212, v[158:159] offset:43008
v_mfma_f32_16x16x16_bf16 v[158:161], v[76:77], v[100:101], 0
v_exp_f32 v144, v144
v_exp_f32 v145, v145
v_exp_f32 v150, v150
v_mfma_f32_16x16x32_bf16 v[158:161], v[72:75], v[96:99], v[158:161]
v_cvt_pk_bf16_f32 v174, v138, v139
v_cvt_pk_bf16_f32 v175, v140, v141
v_cvt_pk_bf16_f32 v176, v142, v143
v_cvt_pk_bf16_f32 v177, v144, v145
v_cvt_pk_bf16_f32 v180, v150, 0
v_exp_f32 v146, v146
v_mfma_f32_16x16x32_bf16 v[150:153], v[190:193], v[174:177], 0
v_exp_f32 v147, v147
v_mfma_f32_16x16x32_bf16 v[138:141], v[114:117], v[174:177], 0
s_waitcnt lgkmcnt(0)
v_exp_f32 v148, v148
v_mfma_f32_16x16x32_bf16 v[142:145], v[122:125], v[174:177], 0
s_barrier
ds_read_b128 v[170:173], v210 offset:36864
ds_read_b128 v[182:185], v210 offset:37888
ds_read_b128 v[186:189], v210 offset:38912
v_exp_f32 v149, v149
v_cvt_pk_bf16_f32 v178, v146, v147
v_cvt_pk_bf16_f32 v179, v148, v149
v_mfma_f32_16x16x32_bf16 v[146:149], v[130:133], v[174:177], 0
v_mov_b32_dpp v154, v158 quad_perm:[0,1,2,3] row_mask:0x2 bank_mask:0xf
v_mfma_f32_16x16x32_bf16 v[150:153], v[190:193], v[178:181], v[150:153]
v_mov_b32_dpp v154, v162 quad_perm:[0,1,2,3] row_mask:0x4 bank_mask:0xf
v_mfma_f32_16x16x32_bf16 v[138:141], v[118:121], v[178:181], v[138:141]
v_mov_b32_dpp v154, v167 quad_perm:[0,1,2,3] row_mask:0x8 bank_mask:0xf
v_exp_f32 v154, v154
v_mfma_f32_16x16x32_bf16 v[142:145], v[126:129], v[178:181], v[142:145]
v_cvt_pk_bf16_f32 v154, v154, 0
v_rcp_f32 v151, v150
v_mfma_f32_16x16x32_bf16 v[146:149], v[134:137], v[178:181], v[146:149]
s_waitcnt lgkmcnt(2)
ds_write_b16 v214, v154
v_mfma_f32_16x16x32_bf16 v[36:39], a[144:147], v[170:173], v[36:39]
ds_read_b128 v[84:87], v215
ds_read_b128 v[88:91], v215 offset:16
v_mfma_f32_16x16x32_bf16 v[40:43], a[168:171], v[170:173], v[40:43]
ds_read_b128 v[174:177], v217
ds_read_b128 v[178:181], v217 offset:528
v_mfma_f32_16x16x32_bf16 v[44:47], a[192:195], v[170:173], v[44:47]
ds_read_b128 v[170:173], v210 offset:39936
s_waitcnt lgkmcnt(7)
v_mfma_f32_16x16x32_bf16 v[36:39], a[148:151], v[182:185], v[36:39]
v_mfma_f32_16x16x32_bf16 v[40:43], a[172:175], v[182:185], v[40:43]
v_mfma_f32_16x16x32_bf16 v[44:47], a[196:199], v[182:185], v[44:47]
ds_read_b128 v[182:185], v210 offset:40960
s_waitcnt lgkmcnt(5)
v_mfma_f32_16x16x32_bf16 v[166:169], v[84:87], v[190:193], 0
v_mfma_f32_16x16x32_bf16 v[154:157], v[84:87], v[114:117], 0
v_mfma_f32_16x16x32_bf16 v[158:161], v[84:87], v[122:125], 0
s_mul_hi_u32 s41, s35, 58835169
s_mul_i32 s42, s41, 73
s_waitcnt lgkmcnt(4)
v_mfma_f32_16x16x32_bf16 v[162:165], v[84:87], v[130:133], 0
s_sub_u32 s42, s35, s42
s_mul_i32 s43, s41, 1373568
s_mul_i32 s51, s42, 2688
v_mfma_f32_16x16x32_bf16 v[166:169], v[88:91], v[190:193], v[166:169]
s_add_u32 s43, s43, s51
v_mfma_f32_16x16x32_bf16 v[154:157], v[88:91], v[118:121], v[154:157]
s_cmp_lt_u32 s35, s34
s_cselect_b32 s50, s43, 1879048192
s_waitcnt lgkmcnt(0)
v_mfma_f32_16x16x32_bf16 v[158:161], v[88:91], v[126:129], v[158:161]
s_add_u32 s35, s35, 32
v_rcp_f32 v167, v166
v_mfma_f32_16x16x32_bf16 v[162:165], v[88:91], v[134:137], v[162:165]
s_cmp_eq_u32 s42, 0
v_max3_u32 v218, v218, v166, v167
v_max3_u32 v218, v218, v150, v151
v_mfma_f32_16x16x32_bf16 v[36:39], a[152:155], v[186:189], v[36:39]
s_cselect_b32 s44, 536870911, s72
v_mul_f32 v151, s3, v151
v_mul_f32 v138, v138, v151
v_mfma_f32_16x16x32_bf16 v[40:43], a[176:179], v[186:189], v[40:43]
s_cmp_eq_u32 s42, 72
v_mul_f32 v139, v139, v151
v_mul_f32 v140, v140, v151
v_mfma_f32_16x16x32_bf16 v[44:47], a[200:203], v[186:189], v[44:47]
s_cselect_b32 s44, 939524095, s44
ds_read_b128 v[186:189], v210 offset:41984
v_mul_f32 v141, v141, v151
v_mfma_f32_16x16x32_bf16 v[36:39], a[156:159], v[170:173], v[36:39]
s_cmp_eq_u32 s41, 0
v_cvt_pk_bf16_f32 v138, v138, v139
v_mul_f32 v142, v142, v151
v_mfma_f32_16x16x32_bf16 v[40:43], a[180:183], v[170:173], v[40:43]
s_cselect_b32 s52, 1879048192, s50
v_mul_f32 v143, v143, v151
v_mul_f32 v144, v144, v151
v_mfma_f32_16x16x32_bf16 v[44:47], a[204:207], v[170:173], v[44:47]
s_add_u32 m0, s45, 0
ds_read_b128 v[170:173], v210 offset:43008
v_mul_f32 v145, v145, v151
v_mfma_f32_16x16x32_bf16 v[36:39], a[160:163], v[182:185], v[36:39]
v_cvt_pk_bf16_f32 v139, v140, v141
v_cvt_pk_bf16_f32 v140, v142, v143
v_mfma_f32_16x16x32_bf16 v[40:43], a[184:187], v[182:185], v[40:43]
v_cvt_pk_bf16_f32 v141, v144, v145
v_mul_f32 v146, v146, v151
v_mfma_f32_16x16x32_bf16 v[44:47], a[208:211], v[182:185], v[44:47]
s_waitcnt lgkmcnt(1)
ds_read_b128 v[182:185], v210 offset:44032
ds_write_b128 v211, v[138:141] offset:49152
v_mfma_f32_16x16x32_bf16 v[36:39], a[164:167], v[186:189], v[36:39]
s_mov_b32 s38, s36
v_mul_f32 v147, v147, v151
v_mul_f32 v148, v148, v151
v_mfma_f32_16x16x32_bf16 v[40:43], a[188:191], v[186:189], v[40:43]
s_waitcnt lgkmcnt(2)
v_mul_f32 v149, v149, v151
v_cvt_pk_bf16_f32 v142, v146, v147
v_mfma_f32_16x16x32_bf16 v[44:47], a[212:215], v[186:189], v[44:47]
s_mov_b32 s36, s50
ds_read_b128 v[186:189], v210 offset:45056
v_cvt_pk_bf16_f32 v143, v148, v149
v_mfma_f32_16x16x32_bf16 v[48:51], a[144:147], v[170:173], v[48:51]
ds_write_b64 v212, v[142:143] offset:49152
v_mfma_f32_16x16x32_bf16 v[52:55], a[168:171], v[170:173], v[52:55]
v_cvt_pk_bf16_f32 v72, v36, v37
v_cvt_pk_bf16_f32 v73, v38, v39
v_mfma_f32_16x16x32_bf16 v[56:59], a[192:195], v[170:173], v[56:59]
s_waitcnt lgkmcnt(3)
ds_read_b128 v[170:173], v210 offset:46080
buffer_store_dwordx2 v[72:73], v203, s[8:11], s39 offen
v_cvt_pk_bf16_f32 v74, v40, v41
v_mfma_f32_16x16x32_bf16 v[48:51], a[148:151], v[182:185], v[48:51]
v_cvt_pk_bf16_f32 v75, v42, v43
v_mov_b32_dpp v154, v158 quad_perm:[0,1,2,3] row_mask:0x2 bank_mask:0xf
v_mfma_f32_16x16x32_bf16 v[52:55], a[172:175], v[182:185], v[52:55]
v_mul_f32 v167, s3, v167
v_mov_b32_dpp v154, v162 quad_perm:[0,1,2,3] row_mask:0x4 bank_mask:0xf
v_mfma_f32_16x16x32_bf16 v[56:59], a[196:199], v[182:185], v[56:59]
s_waitcnt lgkmcnt(2)
ds_read_b128 v[182:185], v210 offset:47104
v_mul_f32 v154, v154, v167
v_mfma_f32_16x16x32_bf16 v[48:51], a[152:155], v[186:189], v[48:51]
v_cvt_pk_bf16_f32 v154, v154, 0
v_cvt_pk_bf16_f32 v76, v44, v45
v_mfma_f32_16x16x32_bf16 v[52:55], a[176:179], v[186:189], v[52:55]
s_waitcnt vmcnt(1) lgkmcnt(1)
ds_write_b16 v214, v154
v_mfma_f32_16x16x32_bf16 v[56:59], a[200:203], v[186:189], v[56:59]
s_barrier
v_mfma_f32_16x16x32_bf16 v[48:51], a[156:159], v[170:173], v[48:51]
ds_read_b128 v[186:189], v210 offset:48128
ds_read_b128 v[84:87], v200
v_mfma_f32_16x16x32_bf16 v[52:55], a[180:183], v[170:173], v[52:55]
ds_read_b128 v[92:95], v201
ds_read_b128 v[100:103], v202
v_mfma_f32_16x16x32_bf16 v[56:59], a[204:207], v[170:173], v[56:59]
s_waitcnt lgkmcnt(5)
ds_read_b128 v[170:173], v210 offset:49152
ds_read_b128 v[88:91], v194 offset:16
v_mfma_f32_16x16x32_bf16 v[48:51], a[160:163], v[182:185], v[48:51]
ds_read_b128 v[96:99], v195 offset:16
v_cvt_pk_bf16_f32 v77, v46, v47
v_mfma_f32_16x16x32_bf16 v[52:55], a[184:187], v[182:185], v[52:55]
ds_read_b128 v[104:107], v196 offset:16
v_add_u32 v215, 1552, v215
v_mfma_f32_16x16x32_bf16 v[56:59], a[208:211], v[182:185], v[56:59]
ds_read_b128 v[182:185], v210 offset:50176
buffer_store_dwordx2 v[74:75], v203, s[8:11], s39 offen offset:32
s_waitcnt lgkmcnt(8)
v_mfma_f32_16x16x32_bf16 v[48:51], a[164:167], v[186:189], v[48:51]
ds_read_b64 v[112:113], v215 offset:528
v_mfma_f32_16x16x32_bf16 v[52:55], a[188:191], v[186:189], v[52:55]
v_mfma_f32_16x16x32_bf16 v[56:59], a[212:215], v[186:189], v[56:59]
s_waitcnt lgkmcnt(8)
ds_read_b128 v[186:189], v210 offset:51200
v_cvt_pk_bf16_f32 v78, v48, v49
v_mfma_f32_16x16x32_bf16 v[36:39], v[174:177], v[84:87], 0
s_waitcnt lgkmcnt(6)
ds_read_b128 v[84:87], v194
v_cvt_pk_bf16_f32 v79, v50, v51
v_mfma_f32_16x16x32_bf16 v[60:63], a[144:147], v[170:173], v[60:63]
v_cvt_pk_bf16_f32 v80, v52, v53
v_cvt_pk_bf16_f32 v81, v54, v55
v_mfma_f32_16x16x32_bf16 v[64:67], a[168:171], v[170:173], v[64:67]
v_cvt_pk_bf16_f32 v82, v56, v57
v_cvt_pk_bf16_f32 v83, v58, v59
v_mfma_f32_16x16x32_bf16 v[68:71], a[192:195], v[170:173], v[68:71]
ds_read_b128 v[170:173], v210 offset:52224
v_mfma_f32_16x16x32_bf16 v[48:51], v[174:177], v[92:95], 0
ds_read_b128 v[92:95], v195
s_waitcnt lgkmcnt(5)
v_mfma_f32_16x16x32_bf16 v[60:63], a[148:151], v[182:185], v[60:63]
v_mfma_f32_16x16x32_bf16 v[64:67], a[172:175], v[182:185], v[64:67]
v_mfma_f32_16x16x32_bf16 v[68:71], a[196:199], v[182:185], v[68:71]
ds_read_b128 v[182:185], v210 offset:53248
s_waitcnt lgkmcnt(4)
v_mfma_f32_16x16x32_bf16 v[60:63], a[152:155], v[186:189], v[60:63]
v_mfma_f32_16x16x32_bf16 v[64:67], a[176:179], v[186:189], v[64:67]
v_mfma_f32_16x16x32_bf16 v[68:71], a[200:203], v[186:189], v[68:71]
ds_read_b128 v[186:189], v210 offset:54272
s_waitcnt lgkmcnt(3)
v_mfma_f32_16x16x32_bf16 v[60:63], a[156:159], v[170:173], v[60:63]
buffer_store_dwordx2 v[76:77], v203, s[8:11], s39 offen offset:64
v_mfma_f32_16x16x32_bf16 v[64:67], a[180:183], v[170:173], v[64:67]
v_mfma_f32_16x16x32_bf16 v[68:71], a[204:207], v[170:173], v[68:71]
s_waitcnt lgkmcnt(1)
v_mfma_f32_16x16x32_bf16 v[60:63], a[160:163], v[182:185], v[60:63]
v_mfma_f32_16x16x32_bf16 v[64:67], a[184:187], v[182:185], v[64:67]
v_mfma_f32_16x16x32_bf16 v[68:71], a[208:211], v[182:185], v[68:71]
ds_read_b128 v[182:185], v210
s_waitcnt lgkmcnt(1)
v_mfma_f32_16x16x32_bf16 v[60:63], a[164:167], v[186:189], v[60:63]
v_smfmac_f32_16x16x64_bf16 v[36:39], v[178:181], v[84:91], v213
ds_read_b128 v[84:87], v197
ds_read_b128 v[88:91], v197 offset:16
v_mfma_f32_16x16x32_bf16 v[64:67], a[188:191], v[186:189], v[64:67]
v_cvt_pk_bf16_f32 v116, v60, v61
v_cvt_pk_bf16_f32 v117, v62, v63
v_mfma_f32_16x16x32_bf16 v[60:63], v[174:177], v[100:103], 0
ds_read_b128 v[100:103], v196
ds_read_b128 v[174:177], v217 offset:1056
v_mfma_f32_16x16x32_bf16 v[68:71], a[212:215], v[186:189], v[68:71]
ds_read_b128 v[186:189], v210 offset:1024
v_cvt_pk_bf16_f32 v124, v64, v65
v_smfmac_f32_16x16x64_bf16 v[48:51], v[178:181], v[92:99], v213
s_waitcnt lgkmcnt(5)
ds_read_b128 v[92:95], v198
ds_read_b128 v[96:99], v198 offset:16
v_mfma_f32_16x16x32_bf16 v[138:141], a[0:3], v[182:185], 0
v_cvt_pk_bf16_f32 v125, v66, v67
v_cvt_pk_bf16_f32 v132, v68, v69
v_mfma_f32_16x16x32_bf16 v[142:145], a[24:27], v[182:185], 0
v_cvt_pk_bf16_f32 v133, v70, v71
v_mfma_f32_16x16x32_bf16 v[146:149], a[48:51], v[182:185], 0
s_waitcnt lgkmcnt(4)
v_smfmac_f32_16x16x64_bf16 v[60:63], v[178:181], v[100:107], v213
ds_read_b128 v[100:103], v199
ds_read_b128 v[104:107], v199 offset:16
v_mfma_f32_16x16x32_bf16 v[150:153], a[216:219], v[182:185], 0
ds_read_b128 v[178:181], v217 offset:1584
buffer_store_dwordx2 v[78:79], v204, s[8:11], s39 offen
s_waitcnt lgkmcnt(6)
v_smfmac_f32_16x16x64_bf16 v[36:39], v[174:177], v[84:91], v213
ds_read_b128 v[84:87], v200 offset:32
ds_read_b128 v[88:91], v194 offset:48
v_mfma_f32_16x16x32_bf16 v[154:157], a[240:243], v[182:185], 0
s_waitcnt lgkmcnt(5)
v_smfmac_f32_16x16x64_bf16 v[48:51], v[174:177], v[92:99], v213
ds_read_b128 v[92:95], v201 offset:32
ds_read_b128 v[96:99], v195 offset:48
v_mfma_f32_16x16x32_bf16 v[158:161], v[232:235], v[182:185], 0
v_mul_f32 v119, v36, v36
v_add_f32 v118, v36, v37
v_mfma_f32_16x16x32_bf16 v[162:165], v[182:185], a[72:75], 0
s_waitcnt lgkmcnt(5)
v_mul_f32 v127, v48, v48
v_add_f32 v126, v48, v49
v_smfmac_f32_16x16x64_bf16 v[60:63], v[174:177], v[100:107], v213
ds_read_b128 v[100:103], v202 offset:32
ds_read_b128 v[174:177], v217 offset:2112
v_mfma_f32_16x16x32_bf16 v[166:169], v[182:185], a[96:99], 0
s_waitcnt lgkmcnt(5)
ds_read_b128 v[104:107], v196 offset:48
v_fmac_f32 v119, v37, v37
v_mfma_f32_16x16x32_bf16 v[40:43], v[178:181], v[84:87], 0
ds_read_b128 v[84:87], v194 offset:32
v_mul_f32 v135, v60, v60
v_mfma_f32_16x16x32_bf16 v[170:173], v[182:185], a[120:123], 0
s_waitcnt lgkmcnt(5)
ds_read_b128 v[182:185], v210 offset:2048
v_add_f32 v134, v60, v61
v_mfma_f32_16x16x32_bf16 v[52:55], v[178:181], v[92:95], 0
ds_read_b128 v[92:95], v195 offset:32
v_fmac_f32 v135, v61, v61
v_mfma_f32_16x16x32_bf16 v[138:141], a[4:7], v[186:189], v[138:141]
v_fmac_f32 v127, v49, v49
v_add_f32 v134, v134, v62
v_mfma_f32_16x16x32_bf16 v[142:145], a[28:31], v[186:189], v[142:145]
s_waitcnt lgkmcnt(5)
v_fmac_f32 v135, v62, v62
v_add_f32 v118, v118, v38
v_mfma_f32_16x16x32_bf16 v[64:67], v[178:181], v[100:103], 0
ds_read_b128 v[100:103], v196 offset:32
ds_read_b128 v[178:181], v217 offset:2640
v_mfma_f32_16x16x32_bf16 v[146:149], a[52:55], v[186:189], v[146:149]
v_add_f32 v126, v126, v50
v_fmac_f32 v119, v38, v38
v_mfma_f32_16x16x32_bf16 v[150:153], a[220:223], v[186:189], v[150:153]
s_waitcnt lgkmcnt(4)
v_fmac_f32 v127, v50, v50
v_add_f32 v134, v134, v63
v_smfmac_f32_16x16x64_bf16 v[40:43], v[174:177], v[84:91], v213
ds_read_b128 v[84:87], v197 offset:32
ds_read_b128 v[88:91], v197 offset:48
v_mfma_f32_16x16x32_bf16 v[154:157], a[244:247], v[186:189], v[154:157]
s_waitcnt lgkmcnt(4)
buffer_store_dwordx2 v[80:81], v204, s[8:11], s39 offen offset:32
v_fmac_f32 v135, v63, v63
v_smfmac_f32_16x16x64_bf16 v[52:55], v[174:177], v[92:99], v213
s_waitcnt lgkmcnt(3)
ds_read_b128 v[92:95], v198 offset:32
ds_read_b128 v[96:99], v198 offset:48
v_smfmac_f32_16x16x64_bf16 v[64:67], v[174:177], v[100:107], v213
ds_read_b128 v[100:103], v199 offset:32
ds_read_b128 v[104:107], v199 offset:48
v_mfma_f32_16x16x32_bf16 v[158:161], v[236:239], v[186:189], v[158:161]
ds_read_b128 v[174:177], v217 offset:3168
v_add_f32 v118, v118, v39
v_mfma_f32_16x16x32_bf16 v[162:165], v[186:189], a[76:79], v[162:165]
v_add_f32 v126, v126, v51
v_fmac_f32 v119, v39, v39
v_mfma_f32_16x16x32_bf16 v[166:169], v[186:189], a[100:103], v[166:169]
v_fmac_f32 v127, v51, v51
s_waitcnt lgkmcnt(5)
v_smfmac_f32_16x16x64_bf16 v[40:43], v[178:181], v[84:91], v213
ds_read_b128 v[84:87], v200 offset:64
ds_read_b128 v[88:91], v194 offset:80
v_mfma_f32_16x16x32_bf16 v[170:173], v[186:189], a[124:127], v[170:173]
ds_read_b128 v[186:189], v210 offset:3072
s_waitcnt lgkmcnt(6)
v_smfmac_f32_16x16x64_bf16 v[52:55], v[178:181], v[92:99], v213
ds_read_b128 v[92:95], v201 offset:64
ds_read_b128 v[96:99], v195 offset:80
v_mfma_f32_16x16x32_bf16 v[138:141], a[8:11], v[182:185], v[138:141]
v_add_f32 v118, v118, v40
v_fmac_f32 v119, v40, v40
v_mfma_f32_16x16x32_bf16 v[142:145], a[32:35], v[182:185], v[142:145]
s_waitcnt lgkmcnt(6)
v_add_f32 v126, v126, v52
v_fmac_f32 v127, v52, v52
v_smfmac_f32_16x16x64_bf16 v[64:67], v[178:181], v[100:107], v213
ds_read_b128 v[100:103], v202 offset:64
ds_read_b128 v[178:181], v217 offset:3696
v_mfma_f32_16x16x32_bf16 v[146:149], a[56:59], v[182:185], v[146:149]
s_waitcnt lgkmcnt(6)
ds_read_b128 v[104:107], v196 offset:80
v_add_f32 v118, v118, v41
v_mfma_f32_16x16x32_bf16 v[44:47], v[174:177], v[84:87], 0
ds_read_b128 v[84:87], v194 offset:64
v_add_f32 v134, v134, v64
v_mfma_f32_16x16x32_bf16 v[150:153], a[224:227], v[182:185], v[150:153]
buffer_store_dwordx2 v[82:83], v204, s[8:11], s39 offen offset:64
v_fmac_f32 v135, v64, v64
v_mfma_f32_16x16x32_bf16 v[154:157], a[248:251], v[182:185], v[154:157]
s_waitcnt lgkmcnt(5)
v_add_f32 v134, v134, v65
v_fmac_f32 v135, v65, v65
v_mfma_f32_16x16x32_bf16 v[56:59], v[174:177], v[92:95], 0
s_waitcnt lgkmcnt(3)
ds_read_b128 v[92:95], v195 offset:64
v_fmac_f32 v119, v41, v41
v_mfma_f32_16x16x32_bf16 v[68:71], v[174:177], v[100:103], 0
ds_read_b128 v[100:103], v196 offset:64
ds_read_b128 v[174:177], v217 offset:4224
v_mfma_f32_16x16x32_bf16 v[158:161], v[240:243], v[182:185], v[158:161]
v_add_f32 v126, v126, v53
v_fmac_f32 v127, v53, v53
v_mfma_f32_16x16x32_bf16 v[162:165], v[182:185], a[80:83], v[162:165]
s_waitcnt lgkmcnt(3)
v_add_f32 v134, v134, v66
v_fmac_f32 v135, v66, v66
v_smfmac_f32_16x16x64_bf16 v[44:47], v[178:181], v[84:91], v213
ds_read_b128 v[84:87], v197 offset:64
ds_read_b128 v[88:91], v197 offset:80
v_mfma_f32_16x16x32_bf16 v[166:169], v[182:185], a[104:107], v[166:169]
v_add_f32 v118, v118, v42
v_fmac_f32 v119, v42, v42
v_mfma_f32_16x16x32_bf16 v[170:173], v[182:185], a[128:131], v[170:173]
s_waitcnt lgkmcnt(4)
ds_read_b128 v[182:185], v210 offset:4096
v_add_f32 v126, v126, v54
v_smfmac_f32_16x16x64_bf16 v[56:59], v[178:181], v[92:99], v213
ds_read_b128 v[92:95], v198 offset:64
ds_read_b128 v[96:99], v198 offset:80
v_mfma_f32_16x16x32_bf16 v[138:141], a[12:15], v[186:189], v[138:141]
s_waitcnt lgkmcnt(6)
v_fmac_f32 v127, v54, v54
v_add_f32 v134, v134, v67
v_smfmac_f32_16x16x64_bf16 v[68:71], v[178:181], v[100:107], v213
ds_read_b128 v[100:103], v199 offset:64
ds_read_b128 v[104:107], v199 offset:80
v_mfma_f32_16x16x32_bf16 v[142:145], a[36:39], v[186:189], v[142:145]
v_fmac_f32 v135, v67, v67
v_add_f32 v118, v118, v43
v_mfma_f32_16x16x32_bf16 v[146:149], a[60:63], v[186:189], v[146:149]
v_fmac_f32 v119, v43, v43
v_add_f32 v126, v126, v55
v_mfma_f32_16x16x32_bf16 v[150:153], a[228:231], v[186:189], v[150:153]
v_fmac_f32 v127, v55, v55
v_and_b32 v180, s44, v208
v_mfma_f32_16x16x32_bf16 v[154:157], a[252:255], v[186:189], v[154:157]
s_waitcnt lgkmcnt(5)
v_add_u32 v214, 1552, v214
v_mov_b32 v181, 0
v_smfmac_f32_16x16x64_bf16 v[44:47], v[174:177], v[84:91], v213
buffer_store_dwordx2 v[116:117], v205, s[8:11], s39 offen
v_mfma_f32_16x16x32_bf16 v[158:161], v[244:247], v[186:189], v[158:161]
v_mfma_f32_16x16x32_bf16 v[162:165], v[186:189], a[84:87], v[162:165]
s_waitcnt lgkmcnt(2)
v_add_f32 v118, v118, v44
v_fmac_f32 v119, v44, v44
v_smfmac_f32_16x16x64_bf16 v[56:59], v[174:177], v[92:99], v213
v_add_f32 v118, v118, v45
v_mfma_f32_16x16x32_bf16 v[166:169], v[186:189], a[108:111], v[166:169]
v_fmac_f32 v119, v45, v45
v_add_f32 v118, v118, v46
v_mfma_f32_16x16x32_bf16 v[170:173], v[186:189], a[132:135], v[170:173]
s_waitcnt lgkmcnt(0)
ds_read_b128 v[186:189], v210 offset:5120
v_add_f32 v126, v126, v56
v_smfmac_f32_16x16x64_bf16 v[68:71], v[174:177], v[100:107], v213
v_fmac_f32 v127, v56, v56
v_mfma_f32_16x16x32_bf16 v[138:141], a[16:19], v[182:185], v[138:141]
v_add_f32 v126, v126, v57
v_fmac_f32 v127, v57, v57
v_mfma_f32_16x16x32_bf16 v[142:145], a[40:43], v[182:185], v[142:145]
v_add_f32 v134, v134, v68
v_fmac_f32 v135, v68, v68
v_mfma_f32_16x16x32_bf16 v[146:149], a[64:67], v[182:185], v[146:149]
v_add_f32 v134, v134, v69
v_fmac_f32 v135, v69, v69
v_mfma_f32_16x16x32_bf16 v[150:153], a[232:235], v[182:185], v[150:153]
v_add_f32 v134, v134, v70
v_fmac_f32 v135, v70, v70
v_mfma_f32_16x16x32_bf16 v[154:157], v[224:227], v[182:185], v[154:157]
v_fmac_f32 v119, v46, v46
v_add_f32 v126, v126, v58
v_mfma_f32_16x16x32_bf16 v[158:161], v[248:251], v[182:185], v[158:161]
v_fmac_f32 v127, v58, v58
v_add_f32 v134, v134, v71
v_mfma_f32_16x16x32_bf16 v[162:165], v[182:185], a[88:91], v[162:165]
v_fmac_f32 v135, v71, v71
v_add_f32 v118, v118, v47
v_mfma_f32_16x16x32_bf16 v[166:169], v[182:185], a[112:115], v[166:169]
v_fmac_f32 v119, v47, v47
v_add_f32 v126, v126, v59
v_mfma_f32_16x16x32_bf16 v[170:173], v[182:185], a[136:139], v[170:173]
s_waitcnt lgkmcnt(0)
ds_read_b128 v[182:185], v210 offset:6144
v_fmac_f32 v127, v59, v59
v_mfma_f32_16x16x32_bf16 v[138:141], a[20:23], v[186:189], v[138:141]
buffer_store_dwordx2 v[124:125], v205, s[8:11], s39 offen offset:32
v_permlane16_swap_b32 v134, v135
v_mfma_f32_16x16x32_bf16 v[142:145], a[44:47], v[186:189], v[142:145]
v_permlane16_swap_b32 v118, v119
v_mfma_f32_16x16x32_bf16 v[146:149], a[68:71], v[186:189], v[146:149]
v_cvt_pk_bf16_f32 v78, v138, v139
v_cvt_pk_bf16_f32 v79, v140, v141
v_mfma_f32_16x16x32_bf16 v[150:153], a[236:239], v[186:189], v[150:153]
v_cvt_pk_bf16_f32 v80, v142, v143
v_cvt_pk_bf16_f32 v81, v144, v145
v_mfma_f32_16x16x32_bf16 v[154:157], v[228:231], v[186:189], v[154:157]
v_cvt_pk_bf16_f32 v82, v146, v147
v_cvt_pk_bf16_f32 v83, v148, v149
v_mfma_f32_16x16x32_bf16 v[158:161], v[252:255], v[186:189], v[158:161]
v_cvt_pk_bf16_f32 v72, v150, v151
v_cvt_pk_bf16_f32 v73, v152, v153
v_mfma_f32_16x16x32_bf16 v[162:165], v[186:189], a[92:95], v[162:165]
v_cvt_pk_bf16_f32 v74, v154, v155
v_cvt_pk_bf16_f32 v75, v156, v157
v_mfma_f32_16x16x32_bf16 v[166:169], v[186:189], a[116:119], v[166:169]
v_cvt_pk_bf16_f32 v76, v158, v159
v_cvt_pk_bf16_f32 v77, v160, v161
v_mfma_f32_16x16x32_bf16 v[170:173], v[186:189], a[140:143], v[170:173]
s_waitcnt lgkmcnt(0)
ds_read_b128 v[186:189], v210 offset:7168
v_cvt_pk_bf16_f32 v114, v162, v163
v_mfma_f32_16x16x32_bf16 v[138:141], a[0:3], v[182:185], 0
v_cvt_pk_bf16_f32 v115, v164, v165
v_cvt_pk_bf16_f32 v122, v166, v167
v_mfma_f32_16x16x32_bf16 v[142:145], a[24:27], v[182:185], 0
v_cvt_pk_bf16_f32 v123, v168, v169
v_cvt_pk_bf16_f32 v130, v170, v171
v_mfma_f32_16x16x32_bf16 v[146:149], a[48:51], v[182:185], 0
v_cvt_pk_bf16_f32 v131, v172, v173
v_add_f32 v134, v134, v135
v_mfma_f32_16x16x32_bf16 v[150:153], a[216:219], v[182:185], 0
v_permlane16_swap_b32 v126, v127
v_mfma_f32_16x16x32_bf16 v[154:157], a[240:243], v[182:185], 0
v_add_f32 v118, v118, v119
v_mov_b32 v135, v134
v_mfma_f32_16x16x32_bf16 v[158:161], v[232:235], v[182:185], 0
v_add_f32 v126, v126, v127
v_permlane32_swap_b32 v134, v135
v_mfma_f32_16x16x32_bf16 v[162:165], v[182:185], a[72:75], 0
buffer_store_dwordx2 v[132:133], v205, s[8:11], s39 offen offset:64
v_permlane32_swap_b32 v118, v126
v_mfma_f32_16x16x32_bf16 v[166:169], v[182:185], a[96:99], 0
v_add_f32 v134, v134, v135
v_add_f32 v118, v118, v126
v_mfma_f32_16x16x32_bf16 v[170:173], v[182:185], a[120:123], 0
s_waitcnt lgkmcnt(0)
ds_read_b128 v[182:185], v210 offset:8192
ds_write_b32 v209, v134 offset:512
v_mfma_f32_16x16x32_bf16 v[138:141], a[4:7], v[186:189], v[138:141]
ds_write_b32 v209, v118
v_mfma_f32_16x16x32_bf16 v[142:145], a[28:31], v[186:189], v[142:145]
v_mfma_f32_16x16x32_bf16 v[146:149], a[52:55], v[186:189], v[146:149]
v_mfma_f32_16x16x32_bf16 v[150:153], a[220:223], v[186:189], v[150:153]
v_mfma_f32_16x16x32_bf16 v[154:157], a[244:247], v[186:189], v[154:157]
v_mfma_f32_16x16x32_bf16 v[158:161], v[236:239], v[186:189], v[158:161]
v_mfma_f32_16x16x32_bf16 v[162:165], v[186:189], a[76:79], v[162:165]
s_waitcnt lgkmcnt(0)
s_barrier
v_mfma_f32_16x16x32_bf16 v[166:169], v[186:189], a[100:103], v[166:169]
ds_read_b128 v[102:105], v210 offset:55296
ds_read_b128 v[106:109], v210 offset:56320
v_mfma_f32_16x16x32_bf16 v[170:173], v[186:189], a[124:127], v[170:173]
s_sub_u32 s46, s46, 1
s_cmp_lg_u32 s46, 0
s_cbranch_scc1 F_loop

ds_read_b128 v[186:189], v210 offset:9216
v_mfma_f32_16x16x32_bf16 v[138:141], a[8:11], v[182:185], v[138:141]
v_mfma_f32_16x16x32_bf16 v[142:145], a[32:35], v[182:185], v[142:145]
v_mfma_f32_16x16x32_bf16 v[146:149], a[56:59], v[182:185], v[146:149]
v_mfma_f32_16x16x32_bf16 v[150:153], a[224:227], v[182:185], v[150:153]
buffer_load_dwordx4 v180, s[4:7], s52 offen nt lds
v_mfma_f32_16x16x32_bf16 v[154:157], a[248:251], v[182:185], v[154:157]
s_waitcnt lgkmcnt(2)
v_add_f32 v102, v102, v103
v_add_f32 v104, v104, v105
v_mfma_f32_16x16x32_bf16 v[158:161], v[240:243], v[182:185], v[158:161]
s_waitcnt lgkmcnt(1)
v_add_f32 v106, v106, v107
v_add_f32 v108, v108, v109
v_mfma_f32_16x16x32_bf16 v[162:165], v[182:185], a[80:83], v[162:165]
s_waitcnt lgkmcnt(0)
v_add_f32 v102, v102, v104
v_add_f32 v106, v106, v108
v_mfma_f32_16x16x32_bf16 v[166:169], v[182:185], a[104:107], v[166:169]
s_add_u32 m0, s45, 4112
ds_read_b128 v[108:111], v215 offset:512
v_mul_f32 v103, s48, v102
v_mfma_f32_16x16x32_bf16 v[170:173], v[182:185], a[128:131], v[170:173]
s_add_u32 s40, s36, 196224
ds_read_b128 v[182:185], v210 offset:10240
v_mul_f32 v104, s73, v102
v_mfma_f32_16x16x32_bf16 v[138:141], a[12:15], v[186:189], v[138:141]
v_mul_f32 v106, s73, v106
v_fma_f32 v106, -v103, v104, v106
v_mfma_f32_16x16x32_bf16 v[142:145], a[36:39], v[186:189], v[142:145]
v_max_f32 v106, 0, v106
v_add_f32 v106, s49, v106
v_mfma_f32_16x16x32_bf16 v[146:149], a[60:63], v[186:189], v[146:149]
v_rsq_f32 v102, v106
v_mfma_f32_16x16x32_bf16 v[150:153], a[228:231], v[186:189], v[150:153]
v_mul_f32_e64 v103, -v103, v102
v_mfma_f32_16x16x32_bf16 v[154:157], a[252:255], v[186:189], v[154:157]
buffer_load_dwordx4 v180, s[4:7], s40 offen nt lds
v_mfma_f32_16x16x32_bf16 v[158:161], v[244:247], v[186:189], v[158:161]
ds_write_b64 v211, v[102:103] offset:36864
v_mfma_f32_16x16x32_bf16 v[162:165], v[186:189], a[84:87], v[162:165]
s_add_u32 m0, s45, 8224
s_add_u32 s40, s36, 392448
v_mfma_f32_16x16x32_bf16 v[166:169], v[186:189], a[108:111], v[166:169]
ds_read_b64 v[118:119], v219
ds_read_b64 v[126:127], v219 offset:256
v_mfma_f32_16x16x32_bf16 v[170:173], v[186:189], a[132:135], v[170:173]
s_waitcnt lgkmcnt(3)
ds_read_b128 v[186:189], v210 offset:11264
ds_read_b64 v[134:135], v219 offset:512
v_mfma_f32_16x16x32_bf16 v[138:141], a[16:19], v[182:185], v[138:141]
v_mfma_f32_16x16x32_bf16 v[142:145], a[40:43], v[182:185], v[142:145]
v_mfma_f32_16x16x32_bf16 v[146:149], a[64:67], v[182:185], v[146:149]
v_mfma_f32_16x16x32_bf16 v[150:153], a[232:235], v[182:185], v[150:153]
s_waitcnt lgkmcnt(3)
v_fma_f32 v220, v36, v118, v119
v_fma_f32 v221, v37, v118, v119
v_mfma_f32_16x16x32_bf16 v[154:157], v[224:227], v[182:185], v[154:157]
v_fma_f32 v222, v38, v118, v119
v_fma_f32 v223, v39, v118, v119
v_mfma_f32_16x16x32_bf16 v[158:161], v[248:251], v[182:185], v[158:161]
buffer_load_dwordx4 v180, s[4:7], s40 offen nt lds
v_mfma_f32_16x16x32_bf16 v[162:165], v[182:185], a[88:91], v[162:165]
s_add_u32 m0, s45, 12336
v_cvt_pk_bf16_f32 v90, v220, v221
v_cvt_pk_bf16_f32 v91, v222, v223
v_mfma_f32_16x16x32_bf16 v[166:169], v[182:185], a[112:115], v[166:169]
s_add_u32 s40, s36, 588672
v_fma_f32 v220, v40, v118, v119
v_fma_f32 v221, v41, v118, v119
v_mfma_f32_16x16x32_bf16 v[170:173], v[182:185], a[136:139], v[170:173]
s_waitcnt lgkmcnt(1)
ds_read_b128 v[182:185], v210 offset:12288
v_fma_f32 v222, v42, v118, v119
v_mfma_f32_16x16x32_bf16 v[138:141], a[20:23], v[186:189], v[138:141]
v_fma_f32 v223, v43, v118, v119
v_cvt_pk_bf16_f32 v92, v220, v221
v_mfma_f32_16x16x32_bf16 v[142:145], a[44:47], v[186:189], v[142:145]
v_cvt_pk_bf16_f32 v93, v222, v223
v_fma_f32 v220, v44, v118, v119
v_mfma_f32_16x16x32_bf16 v[146:149], a[68:71], v[186:189], v[146:149]
ds_write_b128 v211, v[90:93] offset:18432
v_mfma_f32_16x16x32_bf16 v[150:153], a[236:239], v[186:189], v[150:153]
v_cvt_pk_bf16_f32 v96, v138, v139
v_cvt_pk_bf16_f32 v97, v140, v141
v_mfma_f32_16x16x32_bf16 v[154:157], v[228:231], v[186:189], v[154:157]
v_cvt_pk_bf16_f32 v98, v142, v143
v_cvt_pk_bf16_f32 v99, v144, v145
v_mfma_f32_16x16x32_bf16 v[158:161], v[252:255], v[186:189], v[158:161]
buffer_load_dwordx4 v180, s[4:7], s40 offen nt lds
v_mfma_f32_16x16x32_bf16 v[162:165], v[186:189], a[92:95], v[162:165]
s_add_u32 m0, s45, 16448
v_cvt_pk_bf16_f32 v100, v146, v147
v_cvt_pk_bf16_f32 v101, v148, v149
v_mfma_f32_16x16x32_bf16 v[166:169], v[186:189], a[116:119], v[166:169]
s_add_u32 s40, s36, 784896
v_cvt_pk_bf16_f32 v88, v158, v159
v_cvt_pk_bf16_f32 v89, v160, v161
v_mfma_f32_16x16x32_bf16 v[170:173], v[186:189], a[140:143], v[170:173]
s_waitcnt lgkmcnt(1)
ds_read_b128 v[186:189], v210 offset:13312
v_cvt_pk_bf16_f32 v86, v154, v155
v_mfma_f32_16x16x32_bf16 v[138:141], a[0:3], v[182:185], 0
v_cvt_pk_bf16_f32 v87, v156, v157
v_cvt_pk_bf16_f32 v124, v166, v167
v_mfma_f32_16x16x32_bf16 v[142:145], a[24:27], v[182:185], 0
v_cvt_pk_bf16_f32 v125, v168, v169
v_cvt_pk_bf16_f32 v84, v150, v151
v_mfma_f32_16x16x32_bf16 v[146:149], a[48:51], v[182:185], 0
ds_read_b128 v[182:185], v210 offset:14336
v_cvt_pk_bf16_f32 v85, v152, v153
v_cvt_pk_bf16_f32 v116, v162, v163
v_mfma_f32_16x16x16_bf16 v[154:157], v[82:83], v[88:89], 0
v_cvt_pk_bf16_f32 v117, v164, v165
v_fma_f32 v221, v45, v118, v119
v_fma_f32 v222, v46, v118, v119
v_mfma_f32_16x16x16_bf16 v[158:161], v[100:101], v[88:89], 0
v_fma_f32 v223, v47, v118, v119
v_cvt_pk_bf16_f32 v94, v220, v221
v_cvt_pk_bf16_f32 v95, v222, v223
v_fma_f32 v220, v48, v126, v127
s_waitcnt lgkmcnt(1)
v_mfma_f32_16x16x32_bf16 v[138:141], a[4:7], v[186:189], v[138:141]
buffer_load_dwordx4 v180, s[4:7], s40 offen nt lds
v_mfma_f32_16x16x32_bf16 v[142:145], a[28:31], v[186:189], v[142:145]
s_add_u32 m0, s45, 20560
ds_write_b64 v212, v[94:95] offset:18432
v_mfma_f32_16x16x32_bf16 v[146:149], a[52:55], v[186:189], v[146:149]
s_waitcnt lgkmcnt(1)
v_fma_f32 v221, v49, v126, v127
v_fma_f32 v222, v50, v126, v127
v_mfma_f32_16x16x32_bf16 v[138:141], a[8:11], v[182:185], v[138:141]
s_add_u32 s40, s36, 981120
ds_read_b128 v[186:189], v210 offset:15360
v_fma_f32 v223, v51, v126, v127
v_mfma_f32_16x16x32_bf16 v[142:145], a[32:35], v[182:185], v[142:145]
v_cvt_pk_bf16_f32 v174, v220, v221
v_cvt_pk_bf16_f32 v175, v222, v223
v_mfma_f32_16x16x32_bf16 v[146:149], a[56:59], v[182:185], v[146:149]
ds_read_b128 v[182:185], v210 offset:16384
v_fma_f32 v220, v52, v126, v127
v_fma_f32 v221, v53, v126, v127
v_mfma_f32_16x16x16_bf16 v[166:169], v[112:113], v[88:89], v[206:209]
v_fma_f32 v222, v54, v126, v127
v_fma_f32 v223, v55, v126, v127
v_cvt_pk_bf16_f32 v176, v220, v221
v_mfma_f32_16x16x16_bf16 v[150:153], v[112:113], v[76:77], v[206:209]
v_cvt_pk_bf16_f32 v177, v222, v223
v_fma_f32 v220, v56, v126, v127
v_fma_f32 v221, v57, v126, v127
v_fma_f32 v222, v58, v126, v127
v_mfma_f32_16x16x32_bf16 v[154:157], v[78:81], v[84:87], v[154:157]
s_waitcnt lgkmcnt(1)
ds_write_b128 v211, v[174:177] offset:24576
v_mfma_f32_16x16x32_bf16 v[138:141], a[12:15], v[186:189], v[138:141]
s_waitcnt lgkmcnt(1)
buffer_load_dwordx4 v180, s[4:7], s40 offen nt lds
v_mfma_f32_16x16x32_bf16 v[142:145], a[36:39], v[186:189], v[142:145]
s_add_u32 m0, s45, 24672
v_fma_f32 v223, v59, v126, v127
v_cvt_pk_bf16_f32 v178, v220, v221
v_mfma_f32_16x16x32_bf16 v[146:149], a[60:63], v[186:189], v[146:149]
s_add_u32 s40, s36, 1177344
ds_read_b128 v[186:189], v210 offset:17408
v_cvt_pk_bf16_f32 v179, v222, v223
v_mfma_f32_16x16x32_bf16 v[138:141], a[16:19], v[182:185], v[138:141]
ds_write_b64 v212, v[178:179] offset:24576
v_mfma_f32_16x16x32_bf16 v[142:145], a[40:43], v[182:185], v[142:145]
v_fma_f32 v220, v60, v134, v135
v_fma_f32 v221, v61, v134, v135
v_mfma_f32_16x16x32_bf16 v[150:153], v[108:111], v[72:75], v[150:153]
v_fma_f32 v222, v62, v134, v135
v_fma_f32 v223, v63, v134, v135
v_mfma_f32_16x16x32_bf16 v[146:149], a[64:67], v[182:185], v[146:149]
ds_read_b128 v[182:185], v210 offset:12288
v_cvt_pk_bf16_f32 v90, v220, v221
v_mfma_f32_16x16x32_bf16 v[158:161], v[96:99], v[84:87], v[158:161]
s_waitcnt lgkmcnt(2)
v_cvt_pk_bf16_f32 v91, v222, v223
v_fma_f32 v220, v64, v134, v135
v_mfma_f32_16x16x32_bf16 v[138:141], a[20:23], v[186:189], v[138:141]
v_fma_f32 v221, v65, v134, v135
v_fma_f32 v222, v66, v134, v135
v_mfma_f32_16x16x32_bf16 v[142:145], a[44:47], v[186:189], v[142:145]
buffer_load_dwordx4 v180, s[4:7], s40 offen nt lds
v_mfma_f32_16x16x32_bf16 v[146:149], a[68:71], v[186:189], v[146:149]
s_add_u32 m0, s45, 28784
ds_read_b128 v[186:189], v210 offset:13312
v_cvt_pk_bf16_f32 v102, v138, v139
v_mfma_f32_16x16x32_bf16 v[166:169], v[108:111], v[84:87], v[166:169]
s_add_u32 s40, s36, 1373568
v_cvt_pk_bf16_f32 v103, v140, v141
v_cvt_pk_bf16_f32 v104, v142, v143
v_cvt_pk_bf16_f32 v105, v144, v145
v_mfma_f32_16x16x16_bf16 v[138:141], v[82:83], v[76:77], 0
v_cvt_pk_bf16_f32 v106, v146, v147
v_cvt_pk_bf16_f32 v107, v148, v149
v_fma_f32 v223, v67, v134, v135
v_mfma_f32_16x16x16_bf16 v[142:145], v[100:101], v[76:77], 0
v_cvt_pk_bf16_f32 v92, v220, v221
v_cvt_pk_bf16_f32 v93, v222, v223
v_fma_f32 v220, v68, v134, v135
v_mfma_f32_16x16x16_bf16 v[162:165], v[106:107], v[88:89], 0
v_fma_f32 v221, v69, v134, v135
v_fma_f32 v222, v70, v134, v135
v_fma_f32 v223, v71, v134, v135
v_mfma_f32_16x16x16_bf16 v[146:149], v[106:107], v[76:77], 0
v_cvt_pk_bf16_f32 v132, v170, v171
v_cvt_pk_bf16_f32 v133, v172, v173
v_cvt_pk_bf16_f32 v94, v220, v221
v_cvt_pk_bf16_f32 v95, v222, v223
v_mfma_f32_16x16x32_bf16 v[138:141], v[78:81], v[72:75], v[138:141]
ds_write_b128 v211, v[90:93] offset:30720
v_mfma_f32_16x16x32_bf16 v[142:145], v[96:99], v[72:75], v[142:145]
s_waitcnt lgkmcnt(2)
s_nop 2
v_exp_f32 v138, v138
v_mfma_f32_16x16x32_bf16 v[118:121], v[182:185], a[72:75], 0
buffer_load_dwordx4 v180, s[4:7], s40 offen nt lds
v_mfma_f32_16x16x32_bf16 v[126:129], v[182:185], a[96:99], 0
s_add_u32 m0, s45, 32896
ds_write_b64 v212, v[94:95] offset:30720
v_mfma_f32_16x16x32_bf16 v[134:137], v[182:185], a[120:123], 0
s_add_u32 s40, s36, 1569792
v_exp_f32 v139, v139
v_mfma_f32_16x16x32_bf16 v[146:149], v[102:105], v[72:75], v[146:149]
ds_read_b64 v[76:77], v215 offset:16
v_cvt_pk_bf16_f32 v174, v138, v139
v_mfma_f32_16x16x32_bf16 v[90:93], a[216:219], v[182:185], 0
v_exp_f32 v140, v140
v_mfma_f32_16x16x32_bf16 v[170:173], a[240:243], v[182:185], 0
v_exp_f32 v141, v141
v_mfma_f32_16x16x32_bf16 v[220:223], v[232:235], v[182:185], 0
s_waitcnt lgkmcnt(3)
ds_read_b128 v[182:185], v210 offset:14336
v_cvt_pk_bf16_f32 v175, v140, v141
v_mfma_f32_16x16x32_bf16 v[118:121], v[186:189], a[76:79], v[118:121]
v_exp_f32 v142, v142
v_mfma_f32_16x16x32_bf16 v[126:129], v[186:189], a[100:103], v[126:129]
v_exp_f32 v143, v143
v_mfma_f32_16x16x32_bf16 v[134:137], v[186:189], a[124:127], v[134:137]
v_exp_f32 v144, v144
v_mfma_f32_16x16x32_bf16 v[90:93], a[220:223], v[186:189], v[90:93]
buffer_load_dwordx4 v180, s[4:7], s40 offen nt lds
v_mfma_f32_16x16x32_bf16 v[170:173], a[244:247], v[186:189], v[170:173]
v_exp_f32 v145, v145
v_mfma_f32_16x16x32_bf16 v[220:223], v[236:239], v[186:189], v[220:223]
s_waitcnt lgkmcnt(0)
ds_read_b128 v[186:189], v210 offset:15360
v_cvt_pk_bf16_f32 v176, v142, v143
v_mfma_f32_16x16x32_bf16 v[118:121], v[182:185], a[80:83], v[118:121]
v_exp_f32 v150, v150
v_mfma_f32_16x16x32_bf16 v[126:129], v[182:185], a[104:107], v[126:129]
v_cvt_pk_bf16_f32 v177, v144, v145
v_cvt_pk_bf16_f32 v180, v150, 0
v_mfma_f32_16x16x32_bf16 v[134:137], v[182:185], a[128:131], v[134:137]
v_exp_f32 v154, v154
v_mfma_f32_16x16x32_bf16 v[90:93], a[224:227], v[182:185], v[90:93]
v_exp_f32 v155, v155
v_mfma_f32_16x16x32_bf16 v[162:165], v[102:105], v[84:87], v[162:165]
v_exp_f32 v156, v156
v_mfma_f32_16x16x32_bf16 v[170:173], a[248:251], v[182:185], v[170:173]
v_exp_f32 v157, v157
v_mfma_f32_16x16x32_bf16 v[220:223], v[240:243], v[182:185], v[220:223]
s_waitcnt lgkmcnt(0)
ds_read_b128 v[182:185], v210 offset:16384
ds_read_b128 v[72:75], v215
v_mfma_f32_16x16x32_bf16 v[118:121], v[186:189], a[84:87], v[118:121]
v_exp_f32 v158, v158
v_mfma_f32_16x16x32_bf16 v[126:129], v[186:189], a[108:111], v[126:129]
v_exp_f32 v159, v159
v_mfma_f32_16x16x32_bf16 v[134:137], v[186:189], a[132:135], v[134:137]
v_exp_f32 v160, v160
v_mfma_f32_16x16x32_bf16 v[90:93], a[228:231], v[186:189], v[90:93]
v_exp_f32 v161, v161
v_mfma_f32_16x16x32_bf16 v[170:173], a[252:255], v[186:189], v[170:173]
v_exp_f32 v166, v166
v_mfma_f32_16x16x32_bf16 v[220:223], v[244:247], v[186:189], v[220:223]
s_waitcnt lgkmcnt(1)
ds_read_b128 v[186:189], v210 offset:17408
v_exp_f32 v146, v146
v_mfma_f32_16x16x32_bf16 v[118:121], v[182:185], a[88:91], v[118:121]
v_exp_f32 v147, v147
v_mfma_f32_16x16x32_bf16 v[126:129], v[182:185], a[112:115], v[126:129]
v_exp_f32 v148, v148
v_mfma_f32_16x16x32_bf16 v[134:137], v[182:185], a[136:139], v[134:137]
v_exp_f32 v149, v149
v_mfma_f32_16x16x32_bf16 v[90:93], a[232:235], v[182:185], v[90:93]
v_exp_f32 v162, v162
v_mfma_f32_16x16x32_bf16 v[170:173], v[224:227], v[182:185], v[170:173]
v_exp_f32 v163, v163
v_mfma_f32_16x16x32_bf16 v[220:223], v[248:251], v[182:185], v[220:223]
s_waitcnt lgkmcnt(0)
v_exp_f32 v164, v164
v_mfma_f32_16x16x32_bf16 v[118:121], v[186:189], a[92:95], v[118:121]
v_exp_f32 v165, v165
v_mfma_f32_16x16x32_bf16 v[126:129], v[186:189], a[116:119], v[126:129]
v_cvt_pk_bf16_f32 v178, v146, v147
v_cvt_pk_bf16_f32 v179, v148, v149
v_mfma_f32_16x16x32_bf16 v[134:137], v[186:189], a[140:143], v[134:137]
v_cvt_pk_bf16_f32 v118, v118, v119
v_cvt_pk_bf16_f32 v119, v120, v121
v_mfma_f32_16x16x32_bf16 v[90:93], a[236:239], v[186:189], v[90:93]
ds_read_u16 v120, v214 offset:1024
v_cvt_pk_bf16_f32 v126, v126, v127
v_mfma_f32_16x16x32_bf16 v[170:173], v[228:231], v[186:189], v[170:173]
v_cvt_pk_bf16_f32 v127, v128, v129
v_cvt_pk_bf16_f32 v134, v134, v135
v_mfma_f32_16x16x32_bf16 v[220:223], v[252:255], v[186:189], v[220:223]
ds_read_u16 v128, v214 offset:1032
v_cvt_pk_bf16_f32 v90, v90, v91
v_mfma_f32_16x16x32_bf16 v[150:153], v[190:193], v[174:177], 0
v_cvt_pk_bf16_f32 v91, v92, v93
v_cvt_pk_bf16_f32 v92, v170, v171
v_mfma_f32_16x16x32_bf16 v[138:141], v[114:117], v[174:177], 0
v_cvt_pk_bf16_f32 v93, v172, v173
v_cvt_pk_bf16_f32 v135, v136, v137
v_mfma_f32_16x16x32_bf16 v[142:145], v[122:125], v[174:177], 0
ds_read_u16 v136, v214 offset:1040
v_mov_b32 v121, 0
v_mfma_f32_16x16x32_bf16 v[146:149], v[130:133], v[174:177], 0
v_cvt_pk_bf16_f32 v174, v154, v155
v_cvt_pk_bf16_f32 v175, v156, v157
v_mfma_f32_16x16x32_bf16 v[150:153], v[190:193], v[178:181], v[150:153]
s_waitcnt lgkmcnt(2)
v_cvt_pk_bf16_f32 v176, v158, v159
v_cvt_pk_bf16_f32 v177, v160, v161
v_mfma_f32_16x16x32_bf16 v[138:141], v[118:121], v[178:181], v[138:141]
v_mov_b32 v129, 0
v_mov_b32 v137, 0
v_mfma_f32_16x16x32_bf16 v[154:157], v[114:117], v[174:177], 0
v_rcp_f32 v151, v150
v_mfma_f32_16x16x32_bf16 v[158:161], v[122:125], v[174:177], 0
s_waitcnt lgkmcnt(1)
v_max3_u32 v218, v218, v150, v151
v_mul_f32 v151, s3, v151
v_mfma_f32_16x16x32_bf16 v[142:145], v[126:129], v[178:181], v[142:145]
s_waitcnt lgkmcnt(0)
v_mul_f32 v138, v138, v151
v_mul_f32 v139, v139, v151
v_mfma_f32_16x16x32_bf16 v[146:149], v[134:137], v[178:181], v[146:149]
v_cvt_pk_bf16_f32 v180, v166, 0
v_mul_f32 v140, v140, v151
v_mfma_f32_16x16x32_bf16 v[166:169], v[190:193], v[174:177], 0
v_mul_f32 v141, v141, v151
v_cvt_pk_bf16_f32 v138, v138, v139
v_mul_f32 v142, v142, v151
v_mul_f32 v143, v143, v151
v_mul_f32 v144, v144, v151
v_mul_f32 v145, v145, v151
v_cvt_pk_bf16_f32 v139, v140, v141
v_cvt_pk_bf16_f32 v140, v142, v143
v_cvt_pk_bf16_f32 v141, v144, v145
v_cvt_pk_bf16_f32 v178, v162, v163
v_cvt_pk_bf16_f32 v179, v164, v165
v_mfma_f32_16x16x32_bf16 v[162:165], v[130:133], v[174:177], 0
ds_write_b128 v211, v[138:141] offset:36864
v_mfma_f32_16x16x32_bf16 v[138:141], v[78:81], v[90:93], 0
v_mul_f32 v146, v146, v151
v_mul_f32 v147, v147, v151
v_mfma_f32_16x16x32_bf16 v[166:169], v[190:193], v[178:181], v[166:169]
v_mul_f32 v148, v148, v151
v_mul_f32 v149, v149, v151
v_mfma_f32_16x16x32_bf16 v[154:157], v[118:121], v[178:181], v[154:157]
v_cvt_pk_bf16_f32 v142, v146, v147
v_cvt_pk_bf16_f32 v143, v148, v149
v_mfma_f32_16x16x32_bf16 v[158:161], v[126:129], v[178:181], v[158:161]
ds_write_b64 v212, v[142:143] offset:36864
v_mfma_f32_16x16x32_bf16 v[142:145], v[96:99], v[90:93], 0
v_rcp_f32 v167, v166
v_mfma_f32_16x16x32_bf16 v[162:165], v[134:137], v[178:181], v[162:165]
v_max3_u32 v218, v218, v166, v167
v_cvt_pk_bf16_f32 v94, v220, v221
v_mfma_f32_16x16x32_bf16 v[150:153], v[108:111], v[90:93], v[206:209]
v_cvt_pk_bf16_f32 v95, v222, v223
v_mul_f32 v167, s3, v167
v_mfma_f32_16x16x32_bf16 v[146:149], v[102:105], v[90:93], 0
v_mul_f32 v154, v154, v167
v_mul_f32 v155, v155, v167
v_mul_f32 v156, v156, v167
v_mfma_f32_16x16x16_bf16 v[138:141], v[82:83], v[94:95], v[138:141]
v_mul_f32 v157, v157, v167
v_cvt_pk_bf16_f32 v154, v154, v155
v_mul_f32 v158, v158, v167
v_mfma_f32_16x16x16_bf16 v[142:145], v[100:101], v[94:95], v[142:145]
v_mul_f32 v159, v159, v167
v_mul_f32 v160, v160, v167
v_mul_f32 v161, v161, v167
v_mfma_f32_16x16x16_bf16 v[150:153], v[112:113], v[94:95], v[150:153]
v_cvt_pk_bf16_f32 v155, v156, v157
v_cvt_pk_bf16_f32 v156, v158, v159
v_cvt_pk_bf16_f32 v157, v160, v161
v_mfma_f32_16x16x16_bf16 v[146:149], v[106:107], v[94:95], v[146:149]
v_mul_f32 v162, v162, v167
v_mul_f32 v163, v163, v167
v_mul_f32 v164, v164, v167
v_mul_f32 v165, v165, v167
v_mfma_f32_16x16x16_bf16 v[166:169], v[76:77], v[112:113], v[206:209]
v_cvt_pk_bf16_f32 v158, v162, v163
v_cvt_pk_bf16_f32 v159, v164, v165
v_exp_f32 v138, v138
v_mfma_f32_16x16x16_bf16 v[162:165], v[76:77], v[106:107], 0
v_exp_f32 v139, v139
v_exp_f32 v140, v140
v_mfma_f32_16x16x32_bf16 v[166:169], v[72:75], v[108:111], v[166:169]
ds_write_b128 v211, v[154:157] offset:43008
v_mfma_f32_16x16x16_bf16 v[154:157], v[76:77], v[82:83], 0
v_exp_f32 v141, v141
v_exp_f32 v142, v142
v_mfma_f32_16x16x32_bf16 v[162:165], v[72:75], v[102:105], v[162:165]
v_exp_f32 v143, v143
v_mfma_f32_16x16x32_bf16 v[154:157], v[72:75], v[78:81], v[154:157]
ds_write_b64 v212, v[158:159] offset:43008
v_mfma_f32_16x16x16_bf16 v[158:161], v[76:77], v[100:101], 0
v_exp_f32 v144, v144
v_exp_f32 v145, v145
v_exp_f32 v150, v150
v_mfma_f32_16x16x32_bf16 v[158:161], v[72:75], v[96:99], v[158:161]
v_cvt_pk_bf16_f32 v174, v138, v139
v_cvt_pk_bf16_f32 v175, v140, v141
v_cvt_pk_bf16_f32 v176, v142, v143
v_cvt_pk_bf16_f32 v177, v144, v145
v_cvt_pk_bf16_f32 v180, v150, 0
v_exp_f32 v146, v146
v_mfma_f32_16x16x32_bf16 v[150:153], v[190:193], v[174:177], 0
v_exp_f32 v147, v147
v_mfma_f32_16x16x32_bf16 v[138:141], v[114:117], v[174:177], 0
s_waitcnt lgkmcnt(0)
v_exp_f32 v148, v148
v_mfma_f32_16x16x32_bf16 v[142:145], v[122:125], v[174:177], 0
s_barrier
ds_read_b128 v[170:173], v210 offset:36864
ds_read_b128 v[182:185], v210 offset:37888
ds_read_b128 v[186:189], v210 offset:38912
v_exp_f32 v149, v149
v_cvt_pk_bf16_f32 v178, v146, v147
v_cvt_pk_bf16_f32 v179, v148, v149
v_mfma_f32_16x16x32_bf16 v[146:149], v[130:133], v[174:177], 0
v_mov_b32_dpp v154, v158 quad_perm:[0,1,2,3] row_mask:0x2 bank_mask:0xf
v_mfma_f32_16x16x32_bf16 v[150:153], v[190:193], v[178:181], v[150:153]
v_mov_b32_dpp v154, v162 quad_perm:[0,1,2,3] row_mask:0x4 bank_mask:0xf
v_mfma_f32_16x16x32_bf16 v[138:141], v[118:121], v[178:181], v[138:141]
v_mov_b32_dpp v154, v167 quad_perm:[0,1,2,3] row_mask:0x8 bank_mask:0xf
v_exp_f32 v154, v154
v_mfma_f32_16x16x32_bf16 v[142:145], v[126:129], v[178:181], v[142:145]
v_cvt_pk_bf16_f32 v154, v154, 0
v_rcp_f32 v151, v150
v_mfma_f32_16x16x32_bf16 v[146:149], v[134:137], v[178:181], v[146:149]
s_waitcnt lgkmcnt(2)
ds_write_b16 v214, v154
v_mfma_f32_16x16x32_bf16 v[0:3], a[144:147], v[170:173], v[0:3]
ds_read_b128 v[84:87], v215
ds_read_b128 v[88:91], v215 offset:16
v_mfma_f32_16x16x32_bf16 v[4:7], a[168:171], v[170:173], v[4:7]
ds_read_b128 v[174:177], v217
ds_read_b128 v[178:181], v217 offset:528
v_mfma_f32_16x16x32_bf16 v[8:11], a[192:195], v[170:173], v[8:11]
ds_read_b128 v[170:173], v210 offset:39936
s_waitcnt lgkmcnt(7)
v_mfma_f32_16x16x32_bf16 v[0:3], a[148:151], v[182:185], v[0:3]
v_mfma_f32_16x16x32_bf16 v[4:7], a[172:175], v[182:185], v[4:7]
v_mfma_f32_16x16x32_bf16 v[8:11], a[196:199], v[182:185], v[8:11]
ds_read_b128 v[182:185], v210 offset:40960
s_waitcnt lgkmcnt(5)
v_mfma_f32_16x16x32_bf16 v[166:169], v[84:87], v[190:193], 0
v_mfma_f32_16x16x32_bf16 v[154:157], v[84:87], v[114:117], 0
v_mfma_f32_16x16x32_bf16 v[158:161], v[84:87], v[122:125], 0
v_mfma_f32_16x16x32_bf16 v[162:165], v[84:87], v[130:133], 0
s_waitcnt lgkmcnt(4)
v_mfma_f32_16x16x32_bf16 v[166:169], v[88:91], v[190:193], v[166:169]
v_mfma_f32_16x16x32_bf16 v[154:157], v[88:91], v[118:121], v[154:157]
v_mfma_f32_16x16x32_bf16 v[158:161], v[88:91], v[126:129], v[158:161]
v_rcp_f32 v167, v166
v_mfma_f32_16x16x32_bf16 v[162:165], v[88:91], v[134:137], v[162:165]
v_max3_u32 v218, v218, v166, v167
v_max3_u32 v218, v218, v150, v151
v_mfma_f32_16x16x32_bf16 v[0:3], a[152:155], v[186:189], v[0:3]
v_mul_f32 v151, s3, v151
v_mul_f32 v138, v138, v151
v_mfma_f32_16x16x32_bf16 v[4:7], a[176:179], v[186:189], v[4:7]
v_mul_f32 v139, v139, v151
v_mul_f32 v140, v140, v151
v_mfma_f32_16x16x32_bf16 v[8:11], a[200:203], v[186:189], v[8:11]
s_waitcnt lgkmcnt(1)
ds_read_b128 v[186:189], v210 offset:41984
v_mul_f32 v141, v141, v151
v_mfma_f32_16x16x32_bf16 v[0:3], a[156:159], v[170:173], v[0:3]
v_cvt_pk_bf16_f32 v138, v138, v139
v_mul_f32 v142, v142, v151
v_mfma_f32_16x16x32_bf16 v[4:7], a[180:183], v[170:173], v[4:7]
v_mul_f32 v143, v143, v151
v_mul_f32 v144, v144, v151
v_mfma_f32_16x16x32_bf16 v[8:11], a[204:207], v[170:173], v[8:11]
s_waitcnt lgkmcnt(1)
ds_read_b128 v[170:173], v210 offset:43008
v_mul_f32 v145, v145, v151
v_mfma_f32_16x16x32_bf16 v[0:3], a[160:163], v[182:185], v[0:3]
v_cvt_pk_bf16_f32 v139, v140, v141
v_cvt_pk_bf16_f32 v140, v142, v143
v_mfma_f32_16x16x32_bf16 v[4:7], a[184:187], v[182:185], v[4:7]
v_cvt_pk_bf16_f32 v141, v144, v145
v_mul_f32 v146, v146, v151
v_mfma_f32_16x16x32_bf16 v[8:11], a[208:211], v[182:185], v[8:11]
s_waitcnt lgkmcnt(1)
ds_read_b128 v[182:185], v210 offset:44032
ds_write_b128 v211, v[138:141] offset:49152
v_mfma_f32_16x16x32_bf16 v[0:3], a[164:167], v[186:189], v[0:3]
s_mov_b32 s39, s37
v_mul_f32 v147, v147, v151
v_mul_f32 v148, v148, v151
v_mfma_f32_16x16x32_bf16 v[4:7], a[188:191], v[186:189], v[4:7]
v_mul_f32 v149, v149, v151
v_cvt_pk_bf16_f32 v142, v146, v147
v_mfma_f32_16x16x32_bf16 v[8:11], a[212:215], v[186:189], v[8:11]
s_waitcnt lgkmcnt(2)
ds_read_b128 v[186:189], v210 offset:45056
v_cvt_pk_bf16_f32 v143, v148, v149
v_mfma_f32_16x16x32_bf16 v[12:15], a[144:147], v[170:173], v[12:15]
ds_write_b64 v212, v[142:143] offset:49152
v_mfma_f32_16x16x32_bf16 v[16:19], a[168:171], v[170:173], v[16:19]
v_cvt_pk_bf16_f32 v72, v0, v1
v_cvt_pk_bf16_f32 v73, v2, v3
v_mfma_f32_16x16x32_bf16 v[20:23], a[192:195], v[170:173], v[20:23]
s_waitcnt lgkmcnt(3)
ds_read_b128 v[170:173], v210 offset:46080
buffer_store_dwordx2 v[72:73], v203, s[8:11], s38 offen
v_cvt_pk_bf16_f32 v74, v4, v5
v_mfma_f32_16x16x32_bf16 v[12:15], a[148:151], v[182:185], v[12:15]
v_cvt_pk_bf16_f32 v75, v6, v7
v_mov_b32_dpp v154, v158 quad_perm:[0,1,2,3] row_mask:0x2 bank_mask:0xf
v_mfma_f32_16x16x32_bf16 v[16:19], a[172:175], v[182:185], v[16:19]
v_mul_f32 v167, s3, v167
v_mov_b32_dpp v154, v162 quad_perm:[0,1,2,3] row_mask:0x4 bank_mask:0xf
v_mfma_f32_16x16x32_bf16 v[20:23], a[196:199], v[182:185], v[20:23]
s_waitcnt lgkmcnt(2)
ds_read_b128 v[182:185], v210 offset:47104
v_mul_f32 v154, v154, v167
v_mfma_f32_16x16x32_bf16 v[12:15], a[152:155], v[186:189], v[12:15]
v_cvt_pk_bf16_f32 v154, v154, 0
v_cvt_pk_bf16_f32 v76, v8, v9
v_mfma_f32_16x16x32_bf16 v[16:19], a[176:179], v[186:189], v[16:19]
s_waitcnt vmcnt(1) lgkmcnt(1)
ds_write_b16 v214, v154
v_mfma_f32_16x16x32_bf16 v[20:23], a[200:203], v[186:189], v[20:23]
s_barrier
v_mfma_f32_16x16x32_bf16 v[12:15], a[156:159], v[170:173], v[12:15]
ds_read_b128 v[186:189], v210 offset:48128
ds_read_b128 v[84:87], v200
v_mfma_f32_16x16x32_bf16 v[16:19], a[180:183], v[170:173], v[16:19]
ds_read_b128 v[92:95], v201
ds_read_b128 v[100:103], v202
v_mfma_f32_16x16x32_bf16 v[20:23], a[204:207], v[170:173], v[20:23]
s_waitcnt lgkmcnt(5)
ds_read_b128 v[170:173], v210 offset:49152
ds_read_b128 v[88:91], v194 offset:16
v_mfma_f32_16x16x32_bf16 v[12:15], a[160:163], v[182:185], v[12:15]
ds_read_b128 v[96:99], v195 offset:16
v_cvt_pk_bf16_f32 v77, v10, v11
v_mfma_f32_16x16x32_bf16 v[16:19], a[184:187], v[182:185], v[16:19]
ds_read_b128 v[104:107], v196 offset:16
v_add_u32 v215, 1552, v215
v_mfma_f32_16x16x32_bf16 v[20:23], a[208:211], v[182:185], v[20:23]
ds_read_b128 v[182:185], v210 offset:50176
buffer_store_dwordx2 v[74:75], v203, s[8:11], s38 offen offset:32
s_waitcnt lgkmcnt(8)
v_mfma_f32_16x16x32_bf16 v[12:15], a[164:167], v[186:189], v[12:15]
ds_read_b64 v[112:113], v215 offset:528
v_mfma_f32_16x16x32_bf16 v[16:19], a[188:191], v[186:189], v[16:19]
v_mfma_f32_16x16x32_bf16 v[20:23], a[212:215], v[186:189], v[20:23]
s_waitcnt lgkmcnt(8)
ds_read_b128 v[186:189], v210 offset:51200
v_cvt_pk_bf16_f32 v78, v12, v13
v_mfma_f32_16x16x32_bf16 v[0:3], v[174:177], v[84:87], 0
s_waitcnt lgkmcnt(6)
ds_read_b128 v[84:87], v194
v_cvt_pk_bf16_f32 v79, v14, v15
v_mfma_f32_16x16x32_bf16 v[24:27], a[144:147], v[170:173], v[24:27]
v_cvt_pk_bf16_f32 v80, v16, v17
v_cvt_pk_bf16_f32 v81, v18, v19
v_mfma_f32_16x16x32_bf16 v[28:31], a[168:171], v[170:173], v[28:31]
v_cvt_pk_bf16_f32 v82, v20, v21
v_cvt_pk_bf16_f32 v83, v22, v23
v_mfma_f32_16x16x32_bf16 v[32:35], a[192:195], v[170:173], v[32:35]
ds_read_b128 v[170:173], v210 offset:52224
v_mfma_f32_16x16x32_bf16 v[12:15], v[174:177], v[92:95], 0
ds_read_b128 v[92:95], v195
s_waitcnt lgkmcnt(5)
v_mfma_f32_16x16x32_bf16 v[24:27], a[148:151], v[182:185], v[24:27]
v_mfma_f32_16x16x32_bf16 v[28:31], a[172:175], v[182:185], v[28:31]
v_mfma_f32_16x16x32_bf16 v[32:35], a[196:199], v[182:185], v[32:35]
ds_read_b128 v[182:185], v210 offset:53248
s_waitcnt lgkmcnt(4)
v_mfma_f32_16x16x32_bf16 v[24:27], a[152:155], v[186:189], v[24:27]
v_mfma_f32_16x16x32_bf16 v[28:31], a[176:179], v[186:189], v[28:31]
v_mfma_f32_16x16x32_bf16 v[32:35], a[200:203], v[186:189], v[32:35]
ds_read_b128 v[186:189], v210 offset:54272
s_waitcnt lgkmcnt(3)
v_mfma_f32_16x16x32_bf16 v[24:27], a[156:159], v[170:173], v[24:27]
buffer_store_dwordx2 v[76:77], v203, s[8:11], s38 offen offset:64
v_mfma_f32_16x16x32_bf16 v[28:31], a[180:183], v[170:173], v[28:31]
v_mfma_f32_16x16x32_bf16 v[32:35], a[204:207], v[170:173], v[32:35]
s_waitcnt lgkmcnt(1)
v_mfma_f32_16x16x32_bf16 v[24:27], a[160:163], v[182:185], v[24:27]
v_mfma_f32_16x16x32_bf16 v[28:31], a[184:187], v[182:185], v[28:31]
v_mfma_f32_16x16x32_bf16 v[32:35], a[208:211], v[182:185], v[32:35]
ds_read_b128 v[182:185], v210 offset:18432
s_waitcnt lgkmcnt(1)
v_mfma_f32_16x16x32_bf16 v[24:27], a[164:167], v[186:189], v[24:27]
v_smfmac_f32_16x16x64_bf16 v[0:3], v[178:181], v[84:91], v213
ds_read_b128 v[84:87], v197
ds_read_b128 v[88:91], v197 offset:16
v_mfma_f32_16x16x32_bf16 v[28:31], a[188:191], v[186:189], v[28:31]
v_cvt_pk_bf16_f32 v116, v24, v25
v_cvt_pk_bf16_f32 v117, v26, v27
v_mfma_f32_16x16x32_bf16 v[24:27], v[174:177], v[100:103], 0
ds_read_b128 v[100:103], v196
ds_read_b128 v[174:177], v217 offset:1056
v_mfma_f32_16x16x32_bf16 v[32:35], a[212:215], v[186:189], v[32:35]
ds_read_b128 v[186:189], v210 offset:19456
v_cvt_pk_bf16_f32 v124, v28, v29
v_smfmac_f32_16x16x64_bf16 v[12:15], v[178:181], v[92:99], v213
s_waitcnt lgkmcnt(5)
ds_read_b128 v[92:95], v198
ds_read_b128 v[96:99], v198 offset:16
v_mfma_f32_16x16x32_bf16 v[138:141], a[0:3], v[182:185], 0
v_cvt_pk_bf16_f32 v125, v30, v31
v_cvt_pk_bf16_f32 v132, v32, v33
v_mfma_f32_16x16x32_bf16 v[142:145], a[24:27], v[182:185], 0
v_cvt_pk_bf16_f32 v133, v34, v35
v_mfma_f32_16x16x32_bf16 v[146:149], a[48:51], v[182:185], 0
s_waitcnt lgkmcnt(4)
v_smfmac_f32_16x16x64_bf16 v[24:27], v[178:181], v[100:107], v213
ds_read_b128 v[100:103], v199
ds_read_b128 v[104:107], v199 offset:16
v_mfma_f32_16x16x32_bf16 v[150:153], a[216:219], v[182:185], 0
ds_read_b128 v[178:181], v217 offset:1584
buffer_store_dwordx2 v[78:79], v204, s[8:11], s38 offen
s_waitcnt lgkmcnt(6)
v_smfmac_f32_16x16x64_bf16 v[0:3], v[174:177], v[84:91], v213
ds_read_b128 v[84:87], v200 offset:32
ds_read_b128 v[88:91], v194 offset:48
v_mfma_f32_16x16x32_bf16 v[154:157], a[240:243], v[182:185], 0
s_waitcnt lgkmcnt(5)
v_smfmac_f32_16x16x64_bf16 v[12:15], v[174:177], v[92:99], v213
ds_read_b128 v[92:95], v201 offset:32
ds_read_b128 v[96:99], v195 offset:48
v_mfma_f32_16x16x32_bf16 v[158:161], v[232:235], v[182:185], 0
v_mul_f32 v119, v0, v0
v_add_f32 v118, v0, v1
v_mfma_f32_16x16x32_bf16 v[162:165], v[182:185], a[72:75], 0
s_waitcnt lgkmcnt(5)
v_mul_f32 v127, v12, v12
v_add_f32 v126, v12, v13
v_smfmac_f32_16x16x64_bf16 v[24:27], v[174:177], v[100:107], v213
ds_read_b128 v[100:103], v202 offset:32
ds_read_b128 v[174:177], v217 offset:2112
v_mfma_f32_16x16x32_bf16 v[166:169], v[182:185], a[96:99], 0
s_waitcnt lgkmcnt(5)
ds_read_b128 v[104:107], v196 offset:48
v_fmac_f32 v119, v1, v1
v_mfma_f32_16x16x32_bf16 v[4:7], v[178:181], v[84:87], 0
ds_read_b128 v[84:87], v194 offset:32
v_mul_f32 v135, v24, v24
v_mfma_f32_16x16x32_bf16 v[170:173], v[182:185], a[120:123], 0
s_waitcnt lgkmcnt(5)
ds_read_b128 v[182:185], v210 offset:20480
v_add_f32 v134, v24, v25
v_mfma_f32_16x16x32_bf16 v[16:19], v[178:181], v[92:95], 0
ds_read_b128 v[92:95], v195 offset:32
v_fmac_f32 v135, v25, v25
v_mfma_f32_16x16x32_bf16 v[138:141], a[4:7], v[186:189], v[138:141]
v_fmac_f32 v127, v13, v13
v_add_f32 v134, v134, v26
v_mfma_f32_16x16x32_bf16 v[142:145], a[28:31], v[186:189], v[142:145]
s_waitcnt lgkmcnt(5)
v_fmac_f32 v135, v26, v26
v_add_f32 v118, v118, v2
v_mfma_f32_16x16x32_bf16 v[28:31], v[178:181], v[100:103], 0
ds_read_b128 v[100:103], v196 offset:32
ds_read_b128 v[178:181], v217 offset:2640
v_mfma_f32_16x16x32_bf16 v[146:149], a[52:55], v[186:189], v[146:149]
v_add_f32 v126, v126, v14
v_fmac_f32 v119, v2, v2
v_mfma_f32_16x16x32_bf16 v[150:153], a[220:223], v[186:189], v[150:153]
s_waitcnt lgkmcnt(4)
v_fmac_f32 v127, v14, v14
v_add_f32 v134, v134, v27
v_smfmac_f32_16x16x64_bf16 v[4:7], v[174:177], v[84:91], v213
ds_read_b128 v[84:87], v197 offset:32
ds_read_b128 v[88:91], v197 offset:48
v_mfma_f32_16x16x32_bf16 v[154:157], a[244:247], v[186:189], v[154:157]
s_waitcnt lgkmcnt(4)
buffer_store_dwordx2 v[80:81], v204, s[8:11], s38 offen offset:32
v_fmac_f32 v135, v27, v27
v_smfmac_f32_16x16x64_bf16 v[16:19], v[174:177], v[92:99], v213
s_waitcnt lgkmcnt(3)
ds_read_b128 v[92:95], v198 offset:32
ds_read_b128 v[96:99], v198 offset:48
v_smfmac_f32_16x16x64_bf16 v[28:31], v[174:177], v[100:107], v213
ds_read_b128 v[100:103], v199 offset:32
ds_read_b128 v[104:107], v199 offset:48
v_mfma_f32_16x16x32_bf16 v[158:161], v[236:239], v[186:189], v[158:161]
ds_read_b128 v[174:177], v217 offset:3168
v_add_f32 v118, v118, v3
v_mfma_f32_16x16x32_bf16 v[162:165], v[186:189], a[76:79], v[162:165]
v_add_f32 v126, v126, v15
v_fmac_f32 v119, v3, v3
v_mfma_f32_16x16x32_bf16 v[166:169], v[186:189], a[100:103], v[166:169]
v_fmac_f32 v127, v15, v15
s_waitcnt lgkmcnt(5)
v_smfmac_f32_16x16x64_bf16 v[4:7], v[178:181], v[84:91], v213
ds_read_b128 v[84:87], v200 offset:64
ds_read_b128 v[88:91], v194 offset:80
v_mfma_f32_16x16x32_bf16 v[170:173], v[186:189], a[124:127], v[170:173]
ds_read_b128 v[186:189], v210 offset:21504
s_waitcnt lgkmcnt(6)
v_smfmac_f32_16x16x64_bf16 v[16:19], v[178:181], v[92:99], v213
ds_read_b128 v[92:95], v201 offset:64
ds_read_b128 v[96:99], v195 offset:80
v_mfma_f32_16x16x32_bf16 v[138:141], a[8:11], v[182:185], v[138:141]
v_add_f32 v118, v118, v4
v_fmac_f32 v119, v4, v4
v_mfma_f32_16x16x32_bf16 v[142:145], a[32:35], v[182:185], v[142:145]
s_waitcnt lgkmcnt(6)
v_add_f32 v126, v126, v16
v_fmac_f32 v127, v16, v16
v_smfmac_f32_16x16x64_bf16 v[28:31], v[178:181], v[100:107], v213
ds_read_b128 v[100:103], v202 offset:64
ds_read_b128 v[178:181], v217 offset:3696
v_mfma_f32_16x16x32_bf16 v[146:149], a[56:59], v[182:185], v[146:149]
s_waitcnt lgkmcnt(6)
ds_read_b128 v[104:107], v196 offset:80
v_add_f32 v118, v118, v5
v_mfma_f32_16x16x32_bf16 v[8:11], v[174:177], v[84:87], 0
ds_read_b128 v[84:87], v194 offset:64
v_add_f32 v134, v134, v28
v_mfma_f32_16x16x32_bf16 v[150:153], a[224:227], v[182:185], v[150:153]
buffer_store_dwordx2 v[82:83], v204, s[8:11], s38 offen offset:64
v_fmac_f32 v135, v28, v28
v_mfma_f32_16x16x32_bf16 v[154:157], a[248:251], v[182:185], v[154:157]
s_waitcnt lgkmcnt(5)
v_add_f32 v134, v134, v29
v_fmac_f32 v135, v29, v29
v_mfma_f32_16x16x32_bf16 v[20:23], v[174:177], v[92:95], 0
s_waitcnt lgkmcnt(3)
ds_read_b128 v[92:95], v195 offset:64
v_fmac_f32 v119, v5, v5
v_mfma_f32_16x16x32_bf16 v[32:35], v[174:177], v[100:103], 0
ds_read_b128 v[100:103], v196 offset:64
ds_read_b128 v[174:177], v217 offset:4224
v_mfma_f32_16x16x32_bf16 v[158:161], v[240:243], v[182:185], v[158:161]
v_add_f32 v126, v126, v17
v_fmac_f32 v127, v17, v17
v_mfma_f32_16x16x32_bf16 v[162:165], v[182:185], a[80:83], v[162:165]
s_waitcnt lgkmcnt(3)
v_add_f32 v134, v134, v30
v_fmac_f32 v135, v30, v30
v_smfmac_f32_16x16x64_bf16 v[8:11], v[178:181], v[84:91], v213
ds_read_b128 v[84:87], v197 offset:64
ds_read_b128 v[88:91], v197 offset:80
v_mfma_f32_16x16x32_bf16 v[166:169], v[182:185], a[104:107], v[166:169]
v_add_f32 v118, v118, v6
v_fmac_f32 v119, v6, v6
v_mfma_f32_16x16x32_bf16 v[170:173], v[182:185], a[128:131], v[170:173]
s_waitcnt lgkmcnt(4)
ds_read_b128 v[182:185], v210 offset:22528
v_add_f32 v126, v126, v18
v_smfmac_f32_16x16x64_bf16 v[20:23], v[178:181], v[92:99], v213
ds_read_b128 v[92:95], v198 offset:64
ds_read_b128 v[96:99], v198 offset:80
v_mfma_f32_16x16x32_bf16 v[138:141], a[12:15], v[186:189], v[138:141]
s_waitcnt lgkmcnt(6)
v_fmac_f32 v127, v18, v18
v_add_f32 v134, v134, v31
v_smfmac_f32_16x16x64_bf16 v[32:35], v[178:181], v[100:107], v213
ds_read_b128 v[100:103], v199 offset:64
ds_read_b128 v[104:107], v199 offset:80
v_mfma_f32_16x16x32_bf16 v[142:145], a[36:39], v[186:189], v[142:145]
v_fmac_f32 v135, v31, v31
v_add_f32 v118, v118, v7
v_mfma_f32_16x16x32_bf16 v[146:149], a[60:63], v[186:189], v[146:149]
v_fmac_f32 v119, v7, v7
v_add_f32 v126, v126, v19
v_mfma_f32_16x16x32_bf16 v[150:153], a[228:231], v[186:189], v[150:153]
v_fmac_f32 v127, v19, v19
v_mfma_f32_16x16x32_bf16 v[154:157], a[252:255], v[186:189], v[154:157]
s_waitcnt lgkmcnt(5)
v_add_u32 v214, 1552, v214
v_mov_b32 v181, 0
v_smfmac_f32_16x16x64_bf16 v[8:11], v[174:177], v[84:91], v213
buffer_store_dwordx2 v[116:117], v205, s[8:11], s38 offen
v_mfma_f32_16x16x32_bf16 v[158:161], v[244:247], v[186:189], v[158:161]
v_mfma_f32_16x16x32_bf16 v[162:165], v[186:189], a[84:87], v[162:165]
s_waitcnt lgkmcnt(2)
v_add_f32 v118, v118, v8
v_fmac_f32 v119, v8, v8
v_smfmac_f32_16x16x64_bf16 v[20:23], v[174:177], v[92:99], v213
v_add_f32 v118, v118, v9
v_mfma_f32_16x16x32_bf16 v[166:169], v[186:189], a[108:111], v[166:169]
v_fmac_f32 v119, v9, v9
v_add_f32 v118, v118, v10
v_mfma_f32_16x16x32_bf16 v[170:173], v[186:189], a[132:135], v[170:173]
s_waitcnt lgkmcnt(0)
ds_read_b128 v[186:189], v210 offset:23552
v_add_f32 v126, v126, v20
v_smfmac_f32_16x16x64_bf16 v[32:35], v[174:177], v[100:107], v213
v_fmac_f32 v127, v20, v20
v_mfma_f32_16x16x32_bf16 v[138:141], a[16:19], v[182:185], v[138:141]
v_add_f32 v126, v126, v21
v_fmac_f32 v127, v21, v21
v_mfma_f32_16x16x32_bf16 v[142:145], a[40:43], v[182:185], v[142:145]
v_add_f32 v134, v134, v32
v_fmac_f32 v135, v32, v32
v_mfma_f32_16x16x32_bf16 v[146:149], a[64:67], v[182:185], v[146:149]
v_add_f32 v134, v134, v33
v_fmac_f32 v135, v33, v33
v_mfma_f32_16x16x32_bf16 v[150:153], a[232:235], v[182:185], v[150:153]
v_add_f32 v134, v134, v34
v_fmac_f32 v135, v34, v34
v_mfma_f32_16x16x32_bf16 v[154:157], v[224:227], v[182:185], v[154:157]
v_fmac_f32 v119, v10, v10
v_add_f32 v126, v126, v22
v_mfma_f32_16x16x32_bf16 v[158:161], v[248:251], v[182:185], v[158:161]
v_fmac_f32 v127, v22, v22
v_add_f32 v134, v134, v35
v_mfma_f32_16x16x32_bf16 v[162:165], v[182:185], a[88:91], v[162:165]
v_fmac_f32 v135, v35, v35
v_add_f32 v118, v118, v11
v_mfma_f32_16x16x32_bf16 v[166:169], v[182:185], a[112:115], v[166:169]
v_fmac_f32 v119, v11, v11
v_add_f32 v126, v126, v23
v_mfma_f32_16x16x32_bf16 v[170:173], v[182:185], a[136:139], v[170:173]
s_waitcnt lgkmcnt(0)
ds_read_b128 v[182:185], v210 offset:24576
v_fmac_f32 v127, v23, v23
v_mfma_f32_16x16x32_bf16 v[138:141], a[20:23], v[186:189], v[138:141]
buffer_store_dwordx2 v[124:125], v205, s[8:11], s38 offen offset:32
v_permlane16_swap_b32 v134, v135
v_mfma_f32_16x16x32_bf16 v[142:145], a[44:47], v[186:189], v[142:145]
v_permlane16_swap_b32 v118, v119
v_mfma_f32_16x16x32_bf16 v[146:149], a[68:71], v[186:189], v[146:149]
v_cvt_pk_bf16_f32 v78, v138, v139
v_cvt_pk_bf16_f32 v79, v140, v141
v_mfma_f32_16x16x32_bf16 v[150:153], a[236:239], v[186:189], v[150:153]
v_cvt_pk_bf16_f32 v80, v142, v143
v_cvt_pk_bf16_f32 v81, v144, v145
v_mfma_f32_16x16x32_bf16 v[154:157], v[228:231], v[186:189], v[154:157]
v_cvt_pk_bf16_f32 v82, v146, v147
v_cvt_pk_bf16_f32 v83, v148, v149
v_mfma_f32_16x16x32_bf16 v[158:161], v[252:255], v[186:189], v[158:161]
v_cvt_pk_bf16_f32 v72, v150, v151
v_cvt_pk_bf16_f32 v73, v152, v153
v_mfma_f32_16x16x32_bf16 v[162:165], v[186:189], a[92:95], v[162:165]
v_cvt_pk_bf16_f32 v74, v154, v155
v_cvt_pk_bf16_f32 v75, v156, v157
v_mfma_f32_16x16x32_bf16 v[166:169], v[186:189], a[116:119], v[166:169]
v_cvt_pk_bf16_f32 v76, v158, v159
v_cvt_pk_bf16_f32 v77, v160, v161
v_mfma_f32_16x16x32_bf16 v[170:173], v[186:189], a[140:143], v[170:173]
s_waitcnt lgkmcnt(0)
ds_read_b128 v[186:189], v210 offset:25600
v_cvt_pk_bf16_f32 v114, v162, v163
v_mfma_f32_16x16x32_bf16 v[138:141], a[0:3], v[182:185], 0
v_cvt_pk_bf16_f32 v115, v164, v165
v_cvt_pk_bf16_f32 v122, v166, v167
v_mfma_f32_16x16x32_bf16 v[142:145], a[24:27], v[182:185], 0
v_cvt_pk_bf16_f32 v123, v168, v169
v_cvt_pk_bf16_f32 v130, v170, v171
v_mfma_f32_16x16x32_bf16 v[146:149], a[48:51], v[182:185], 0
v_cvt_pk_bf16_f32 v131, v172, v173
v_add_f32 v134, v134, v135
v_mfma_f32_16x16x32_bf16 v[150:153], a[216:219], v[182:185], 0
v_permlane16_swap_b32 v126, v127
v_mfma_f32_16x16x32_bf16 v[154:157], a[240:243], v[182:185], 0
v_add_f32 v118, v118, v119
v_mov_b32 v135, v134
v_mfma_f32_16x16x32_bf16 v[158:161], v[232:235], v[182:185], 0
v_add_f32 v126, v126, v127
v_permlane32_swap_b32 v134, v135
v_mfma_f32_16x16x32_bf16 v[162:165], v[182:185], a[72:75], 0
buffer_store_dwordx2 v[132:133], v205, s[8:11], s38 offen offset:64
v_permlane32_swap_b32 v118, v126
v_mfma_f32_16x16x32_bf16 v[166:169], v[182:185], a[96:99], 0
v_add_f32 v134, v134, v135
v_add_f32 v118, v118, v126
v_mfma_f32_16x16x32_bf16 v[170:173], v[182:185], a[120:123], 0
s_waitcnt lgkmcnt(0)
ds_read_b128 v[182:185], v210 offset:26624
ds_write_b32 v209, v134 offset:512
v_mfma_f32_16x16x32_bf16 v[138:141], a[4:7], v[186:189], v[138:141]
ds_write_b32 v209, v118
v_mfma_f32_16x16x32_bf16 v[142:145], a[28:31], v[186:189], v[142:145]
v_mfma_f32_16x16x32_bf16 v[146:149], a[52:55], v[186:189], v[146:149]
v_mfma_f32_16x16x32_bf16 v[150:153], a[220:223], v[186:189], v[150:153]
v_mfma_f32_16x16x32_bf16 v[154:157], a[244:247], v[186:189], v[154:157]
v_mfma_f32_16x16x32_bf16 v[158:161], v[236:239], v[186:189], v[158:161]
v_mfma_f32_16x16x32_bf16 v[162:165], v[186:189], a[76:79], v[162:165]
s_waitcnt lgkmcnt(0)
s_barrier
v_mfma_f32_16x16x32_bf16 v[166:169], v[186:189], a[100:103], v[166:169]
ds_read_b128 v[102:105], v210 offset:55296
ds_read_b128 v[106:109], v210 offset:56320
v_mfma_f32_16x16x32_bf16 v[170:173], v[186:189], a[124:127], v[170:173]
ds_read_b128 v[186:189], v210 offset:27648
v_mfma_f32_16x16x32_bf16 v[138:141], a[8:11], v[182:185], v[138:141]
v_mfma_f32_16x16x32_bf16 v[142:145], a[32:35], v[182:185], v[142:145]
v_mfma_f32_16x16x32_bf16 v[146:149], a[56:59], v[182:185], v[146:149]
v_mfma_f32_16x16x32_bf16 v[150:153], a[224:227], v[182:185], v[150:153]
v_mfma_f32_16x16x32_bf16 v[154:157], a[248:251], v[182:185], v[154:157]
s_waitcnt lgkmcnt(2)
v_add_f32 v102, v102, v103
v_add_f32 v104, v104, v105
v_mfma_f32_16x16x32_bf16 v[158:161], v[240:243], v[182:185], v[158:161]
s_waitcnt lgkmcnt(1)
v_add_f32 v106, v106, v107
v_add_f32 v108, v108, v109
v_mfma_f32_16x16x32_bf16 v[162:165], v[182:185], a[80:83], v[162:165]
v_add_f32 v102, v102, v104
v_add_f32 v106, v106, v108
v_mfma_f32_16x16x32_bf16 v[166:169], v[182:185], a[104:107], v[166:169]
ds_read_b128 v[108:111], v215 offset:512
v_mul_f32 v103, s48, v102
v_mfma_f32_16x16x32_bf16 v[170:173], v[182:185], a[128:131], v[170:173]
s_waitcnt lgkmcnt(1)
ds_read_b128 v[182:185], v210 offset:28672
v_mul_f32 v104, s73, v102
v_mfma_f32_16x16x32_bf16 v[138:141], a[12:15], v[186:189], v[138:141]
v_mul_f32 v106, s73, v106
v_fma_f32 v106, -v103, v104, v106
v_mfma_f32_16x16x32_bf16 v[142:145], a[36:39], v[186:189], v[142:145]
v_max_f32 v106, 0, v106
v_add_f32 v106, s49, v106
v_mfma_f32_16x16x32_bf16 v[146:149], a[60:63], v[186:189], v[146:149]
v_rsq_f32 v102, v106
v_mfma_f32_16x16x32_bf16 v[150:153], a[228:231], v[186:189], v[150:153]
v_mul_f32_e64 v103, -v103, v102
v_mfma_f32_16x16x32_bf16 v[154:157], a[252:255], v[186:189], v[154:157]
v_mfma_f32_16x16x32_bf16 v[158:161], v[244:247], v[186:189], v[158:161]
ds_write_b64 v211, v[102:103] offset:36864
v_mfma_f32_16x16x32_bf16 v[162:165], v[186:189], a[84:87], v[162:165]
v_mfma_f32_16x16x32_bf16 v[166:169], v[186:189], a[108:111], v[166:169]
ds_read_b64 v[118:119], v219
ds_read_b64 v[126:127], v219 offset:256
v_mfma_f32_16x16x32_bf16 v[170:173], v[186:189], a[132:135], v[170:173]
s_waitcnt lgkmcnt(3)
ds_read_b128 v[186:189], v210 offset:29696
ds_read_b64 v[134:135], v219 offset:512
v_mfma_f32_16x16x32_bf16 v[138:141], a[16:19], v[182:185], v[138:141]
v_mfma_f32_16x16x32_bf16 v[142:145], a[40:43], v[182:185], v[142:145]
v_mfma_f32_16x16x32_bf16 v[146:149], a[64:67], v[182:185], v[146:149]
v_mfma_f32_16x16x32_bf16 v[150:153], a[232:235], v[182:185], v[150:153]
s_waitcnt lgkmcnt(3)
v_fma_f32 v220, v0, v118, v119
v_fma_f32 v221, v1, v118, v119
v_mfma_f32_16x16x32_bf16 v[154:157], v[224:227], v[182:185], v[154:157]
v_fma_f32 v222, v2, v118, v119
v_fma_f32 v223, v3, v118, v119
v_mfma_f32_16x16x32_bf16 v[158:161], v[248:251], v[182:185], v[158:161]
v_mfma_f32_16x16x32_bf16 v[162:165], v[182:185], a[88:91], v[162:165]
v_cvt_pk_bf16_f32 v90, v220, v221
v_cvt_pk_bf16_f32 v91, v222, v223
v_mfma_f32_16x16x32_bf16 v[166:169], v[182:185], a[112:115], v[166:169]
v_fma_f32 v220, v4, v118, v119
v_fma_f32 v221, v5, v118, v119
v_mfma_f32_16x16x32_bf16 v[170:173], v[182:185], a[136:139], v[170:173]
s_waitcnt lgkmcnt(1)
ds_read_b128 v[182:185], v210 offset:30720
v_fma_f32 v222, v6, v118, v119
v_mfma_f32_16x16x32_bf16 v[138:141], a[20:23], v[186:189], v[138:141]
v_fma_f32 v223, v7, v118, v119
v_cvt_pk_bf16_f32 v92, v220, v221
v_mfma_f32_16x16x32_bf16 v[142:145], a[44:47], v[186:189], v[142:145]
v_cvt_pk_bf16_f32 v93, v222, v223
v_fma_f32 v220, v8, v118, v119
v_mfma_f32_16x16x32_bf16 v[146:149], a[68:71], v[186:189], v[146:149]
ds_write_b128 v211, v[90:93]
v_mfma_f32_16x16x32_bf16 v[150:153], a[236:239], v[186:189], v[150:153]
v_cvt_pk_bf16_f32 v96, v138, v139
v_cvt_pk_bf16_f32 v97, v140, v141
v_mfma_f32_16x16x32_bf16 v[154:157], v[228:231], v[186:189], v[154:157]
v_cvt_pk_bf16_f32 v98, v142, v143
v_cvt_pk_bf16_f32 v99, v144, v145
v_mfma_f32_16x16x32_bf16 v[158:161], v[252:255], v[186:189], v[158:161]
v_mfma_f32_16x16x32_bf16 v[162:165], v[186:189], a[92:95], v[162:165]
v_cvt_pk_bf16_f32 v100, v146, v147
v_cvt_pk_bf16_f32 v101, v148, v149
v_mfma_f32_16x16x32_bf16 v[166:169], v[186:189], a[116:119], v[166:169]
v_cvt_pk_bf16_f32 v88, v158, v159
v_cvt_pk_bf16_f32 v89, v160, v161
v_mfma_f32_16x16x32_bf16 v[170:173], v[186:189], a[140:143], v[170:173]
s_waitcnt lgkmcnt(1)
ds_read_b128 v[186:189], v210 offset:31744
v_cvt_pk_bf16_f32 v86, v154, v155
v_mfma_f32_16x16x32_bf16 v[138:141], a[0:3], v[182:185], 0
v_cvt_pk_bf16_f32 v87, v156, v157
v_cvt_pk_bf16_f32 v124, v166, v167
v_mfma_f32_16x16x32_bf16 v[142:145], a[24:27], v[182:185], 0
v_cvt_pk_bf16_f32 v125, v168, v169
v_cvt_pk_bf16_f32 v84, v150, v151
v_mfma_f32_16x16x32_bf16 v[146:149], a[48:51], v[182:185], 0
ds_read_b128 v[182:185], v210 offset:32768
v_cvt_pk_bf16_f32 v85, v152, v153
v_cvt_pk_bf16_f32 v116, v162, v163
v_mfma_f32_16x16x16_bf16 v[154:157], v[82:83], v[88:89], 0
v_cvt_pk_bf16_f32 v117, v164, v165
v_fma_f32 v221, v9, v118, v119
v_fma_f32 v222, v10, v118, v119
v_mfma_f32_16x16x16_bf16 v[158:161], v[100:101], v[88:89], 0
v_fma_f32 v223, v11, v118, v119
v_cvt_pk_bf16_f32 v94, v220, v221
v_cvt_pk_bf16_f32 v95, v222, v223
v_fma_f32 v220, v12, v126, v127
s_waitcnt lgkmcnt(1)
v_mfma_f32_16x16x32_bf16 v[138:141], a[4:7], v[186:189], v[138:141]
v_mfma_f32_16x16x32_bf16 v[142:145], a[28:31], v[186:189], v[142:145]
ds_write_b64 v212, v[94:95]
v_mfma_f32_16x16x32_bf16 v[146:149], a[52:55], v[186:189], v[146:149]
s_waitcnt lgkmcnt(1)
v_fma_f32 v221, v13, v126, v127
v_fma_f32 v222, v14, v126, v127
v_mfma_f32_16x16x32_bf16 v[138:141], a[8:11], v[182:185], v[138:141]
ds_read_b128 v[186:189], v210 offset:33792
v_fma_f32 v223, v15, v126, v127
v_mfma_f32_16x16x32_bf16 v[142:145], a[32:35], v[182:185], v[142:145]
v_cvt_pk_bf16_f32 v174, v220, v221
v_cvt_pk_bf16_f32 v175, v222, v223
v_mfma_f32_16x16x32_bf16 v[146:149], a[56:59], v[182:185], v[146:149]
ds_read_b128 v[182:185], v210 offset:34816
v_fma_f32 v220, v16, v126, v127
v_fma_f32 v221, v17, v126, v127
v_mfma_f32_16x16x16_bf16 v[166:169], v[112:113], v[88:89], v[206:209]
v_fma_f32 v222, v18, v126, v127
v_fma_f32 v223, v19, v126, v127
v_cvt_pk_bf16_f32 v176, v220, v221
v_mfma_f32_16x16x16_bf16 v[150:153], v[112:113], v[76:77], v[206:209]
v_cvt_pk_bf16_f32 v177, v222, v223
v_fma_f32 v220, v20, v126, v127
v_fma_f32 v221, v21, v126, v127
v_fma_f32 v222, v22, v126, v127
v_mfma_f32_16x16x32_bf16 v[154:157], v[78:81], v[84:87], v[154:157]
s_waitcnt lgkmcnt(1)
ds_write_b128 v211, v[174:177] offset:6144
v_mfma_f32_16x16x32_bf16 v[138:141], a[12:15], v[186:189], v[138:141]
v_mfma_f32_16x16x32_bf16 v[142:145], a[36:39], v[186:189], v[142:145]
v_fma_f32 v223, v23, v126, v127
v_cvt_pk_bf16_f32 v178, v220, v221
v_mfma_f32_16x16x32_bf16 v[146:149], a[60:63], v[186:189], v[146:149]
s_waitcnt lgkmcnt(1)
ds_read_b128 v[186:189], v210 offset:35840
v_cvt_pk_bf16_f32 v179, v222, v223
v_mfma_f32_16x16x32_bf16 v[138:141], a[16:19], v[182:185], v[138:141]
ds_write_b64 v212, v[178:179] offset:6144
v_mfma_f32_16x16x32_bf16 v[142:145], a[40:43], v[182:185], v[142:145]
v_fma_f32 v220, v24, v134, v135
v_fma_f32 v221, v25, v134, v135
v_mfma_f32_16x16x32_bf16 v[150:153], v[108:111], v[72:75], v[150:153]
v_fma_f32 v222, v26, v134, v135
v_fma_f32 v223, v27, v134, v135
v_mfma_f32_16x16x32_bf16 v[146:149], a[64:67], v[182:185], v[146:149]
ds_read_b128 v[182:185], v210 offset:30720
v_cvt_pk_bf16_f32 v90, v220, v221
v_mfma_f32_16x16x32_bf16 v[158:161], v[96:99], v[84:87], v[158:161]
s_waitcnt lgkmcnt(2)
v_cvt_pk_bf16_f32 v91, v222, v223
v_fma_f32 v220, v28, v134, v135
v_mfma_f32_16x16x32_bf16 v[138:141], a[20:23], v[186:189], v[138:141]
v_fma_f32 v221, v29, v134, v135
v_fma_f32 v222, v30, v134, v135
v_mfma_f32_16x16x32_bf16 v[142:145], a[44:47], v[186:189], v[142:145]
v_mfma_f32_16x16x32_bf16 v[146:149], a[68:71], v[186:189], v[146:149]
ds_read_b128 v[186:189], v210 offset:31744
v_cvt_pk_bf16_f32 v102, v138, v139
v_mfma_f32_16x16x32_bf16 v[166:169], v[108:111], v[84:87], v[166:169]
v_cvt_pk_bf16_f32 v103, v140, v141
v_cvt_pk_bf16_f32 v104, v142, v143
v_cvt_pk_bf16_f32 v105, v144, v145
v_mfma_f32_16x16x16_bf16 v[138:141], v[82:83], v[76:77], 0
v_cvt_pk_bf16_f32 v106, v146, v147
v_cvt_pk_bf16_f32 v107, v148, v149
v_fma_f32 v223, v31, v134, v135
v_mfma_f32_16x16x16_bf16 v[142:145], v[100:101], v[76:77], 0
v_cvt_pk_bf16_f32 v92, v220, v221
v_cvt_pk_bf16_f32 v93, v222, v223
v_fma_f32 v220, v32, v134, v135
v_mfma_f32_16x16x16_bf16 v[162:165], v[106:107], v[88:89], 0
v_fma_f32 v221, v33, v134, v135
v_fma_f32 v222, v34, v134, v135
v_fma_f32 v223, v35, v134, v135
v_mfma_f32_16x16x16_bf16 v[146:149], v[106:107], v[76:77], 0
v_cvt_pk_bf16_f32 v132, v170, v171
v_cvt_pk_bf16_f32 v133, v172, v173
v_cvt_pk_bf16_f32 v94, v220, v221
v_cvt_pk_bf16_f32 v95, v222, v223
v_mfma_f32_16x16x32_bf16 v[138:141], v[78:81], v[72:75], v[138:141]
ds_write_b128 v211, v[90:93] offset:12288
v_mfma_f32_16x16x32_bf16 v[142:145], v[96:99], v[72:75], v[142:145]
s_waitcnt lgkmcnt(2)
s_nop 2
v_exp_f32 v138, v138
v_mfma_f32_16x16x32_bf16 v[118:121], v[182:185], a[72:75], 0
v_mfma_f32_16x16x32_bf16 v[126:129], v[182:185], a[96:99], 0
ds_write_b64 v212, v[94:95] offset:12288
v_mfma_f32_16x16x32_bf16 v[134:137], v[182:185], a[120:123], 0
v_exp_f32 v139, v139
v_mfma_f32_16x16x32_bf16 v[146:149], v[102:105], v[72:75], v[146:149]
ds_read_b64 v[76:77], v215 offset:16
v_cvt_pk_bf16_f32 v174, v138, v139
v_mfma_f32_16x16x32_bf16 v[90:93], a[216:219], v[182:185], 0
v_exp_f32 v140, v140
v_mfma_f32_16x16x32_bf16 v[170:173], a[240:243], v[182:185], 0
v_exp_f32 v141, v141
v_mfma_f32_16x16x32_bf16 v[220:223], v[232:235], v[182:185], 0
s_waitcnt lgkmcnt(3)
ds_read_b128 v[182:185], v210 offset:32768
v_cvt_pk_bf16_f32 v175, v140, v141
v_mfma_f32_16x16x32_bf16 v[118:121], v[186:189], a[76:79], v[118:121]
v_exp_f32 v142, v142
v_mfma_f32_16x16x32_bf16 v[126:129], v[186:189], a[100:103], v[126:129]
v_exp_f32 v143, v143
v_mfma_f32_16x16x32_bf16 v[134:137], v[186:189], a[124:127], v[134:137]
v_exp_f32 v144, v144
v_mfma_f32_16x16x32_bf16 v[90:93], a[220:223], v[186:189], v[90:93]
v_mfma_f32_16x16x32_bf16 v[170:173], a[244:247], v[186:189], v[170:173]
v_exp_f32 v145, v145
v_mfma_f32_16x16x32_bf16 v[220:223], v[236:239], v[186:189], v[220:223]
s_waitcnt lgkmcnt(0)
ds_read_b128 v[186:189], v210 offset:33792
v_cvt_pk_bf16_f32 v176, v142, v143
v_mfma_f32_16x16x32_bf16 v[118:121], v[182:185], a[80:83], v[118:121]
v_exp_f32 v150, v150
v_mfma_f32_16x16x32_bf16 v[126:129], v[182:185], a[104:107], v[126:129]
v_cvt_pk_bf16_f32 v177, v144, v145
v_cvt_pk_bf16_f32 v180, v150, 0
v_mfma_f32_16x16x32_bf16 v[134:137], v[182:185], a[128:131], v[134:137]
v_exp_f32 v154, v154
v_mfma_f32_16x16x32_bf16 v[90:93], a[224:227], v[182:185], v[90:93]
v_exp_f32 v155, v155
v_mfma_f32_16x16x32_bf16 v[162:165], v[102:105], v[84:87], v[162:165]
v_exp_f32 v156, v156
v_mfma_f32_16x16x32_bf16 v[170:173], a[248:251], v[182:185], v[170:173]
v_exp_f32 v157, v157
v_mfma_f32_16x16x32_bf16 v[220:223], v[240:243], v[182:185], v[220:223]
s_waitcnt lgkmcnt(0)
ds_read_b128 v[182:185], v210 offset:34816
ds_read_b128 v[72:75], v215
v_mfma_f32_16x16x32_bf16 v[118:121], v[186:189], a[84:87], v[118:121]
v_exp_f32 v158, v158
v_mfma_f32_16x16x32_bf16 v[126:129], v[186:189], a[108:111], v[126:129]
v_exp_f32 v159, v159
v_mfma_f32_16x16x32_bf16 v[134:137], v[186:189], a[132:135], v[134:137]
v_exp_f32 v160, v160
v_mfma_f32_16x16x32_bf16 v[90:93], a[228:231], v[186:189], v[90:93]
v_exp_f32 v161, v161
v_mfma_f32_16x16x32_bf16 v[170:173], a[252:255], v[186:189], v[170:173]
v_exp_f32 v166, v166
v_mfma_f32_16x16x32_bf16 v[220:223], v[244:247], v[186:189], v[220:223]
s_waitcnt lgkmcnt(1)
ds_read_b128 v[186:189], v210 offset:35840
v_exp_f32 v146, v146
v_mfma_f32_16x16x32_bf16 v[118:121], v[182:185], a[88:91], v[118:121]
v_exp_f32 v147, v147
v_mfma_f32_16x16x32_bf16 v[126:129], v[182:185], a[112:115], v[126:129]
v_exp_f32 v148, v148
v_mfma_f32_16x16x32_bf16 v[134:137], v[182:185], a[136:139], v[134:137]
v_exp_f32 v149, v149
v_mfma_f32_16x16x32_bf16 v[90:93], a[232:235], v[182:185], v[90:93]
v_exp_f32 v162, v162
v_mfma_f32_16x16x32_bf16 v[170:173], v[224:227], v[182:185], v[170:173]
v_exp_f32 v163, v163
v_mfma_f32_16x16x32_bf16 v[220:223], v[248:251], v[182:185], v[220:223]
s_waitcnt lgkmcnt(0)
v_exp_f32 v164, v164
v_mfma_f32_16x16x32_bf16 v[118:121], v[186:189], a[92:95], v[118:121]
v_exp_f32 v165, v165
v_mfma_f32_16x16x32_bf16 v[126:129], v[186:189], a[116:119], v[126:129]
v_cvt_pk_bf16_f32 v178, v146, v147
v_cvt_pk_bf16_f32 v179, v148, v149
v_mfma_f32_16x16x32_bf16 v[134:137], v[186:189], a[140:143], v[134:137]
v_cvt_pk_bf16_f32 v118, v118, v119
v_cvt_pk_bf16_f32 v119, v120, v121
v_mfma_f32_16x16x32_bf16 v[90:93], a[236:239], v[186:189], v[90:93]
ds_read_u16 v120, v214 offset:1024
v_cvt_pk_bf16_f32 v126, v126, v127
v_mfma_f32_16x16x32_bf16 v[170:173], v[228:231], v[186:189], v[170:173]
v_cvt_pk_bf16_f32 v127, v128, v129
v_cvt_pk_bf16_f32 v134, v134, v135
v_mfma_f32_16x16x32_bf16 v[220:223], v[252:255], v[186:189], v[220:223]
ds_read_u16 v128, v214 offset:1032
v_cvt_pk_bf16_f32 v90, v90, v91
v_mfma_f32_16x16x32_bf16 v[150:153], v[190:193], v[174:177], 0
v_cvt_pk_bf16_f32 v91, v92, v93
v_cvt_pk_bf16_f32 v92, v170, v171
v_mfma_f32_16x16x32_bf16 v[138:141], v[114:117], v[174:177], 0
v_cvt_pk_bf16_f32 v93, v172, v173
v_cvt_pk_bf16_f32 v135, v136, v137
v_mfma_f32_16x16x32_bf16 v[142:145], v[122:125], v[174:177], 0
ds_read_u16 v136, v214 offset:1040
v_mov_b32 v121, 0
v_mfma_f32_16x16x32_bf16 v[146:149], v[130:133], v[174:177], 0
v_cvt_pk_bf16_f32 v174, v154, v155
v_cvt_pk_bf16_f32 v175, v156, v157
v_mfma_f32_16x16x32_bf16 v[150:153], v[190:193], v[178:181], v[150:153]
s_waitcnt lgkmcnt(2)
v_cvt_pk_bf16_f32 v176, v158, v159
v_cvt_pk_bf16_f32 v177, v160, v161
v_mfma_f32_16x16x32_bf16 v[138:141], v[118:121], v[178:181], v[138:141]
v_mov_b32 v129, 0
v_mov_b32 v137, 0
v_mfma_f32_16x16x32_bf16 v[154:157], v[114:117], v[174:177], 0
v_rcp_f32 v151, v150
v_mfma_f32_16x16x32_bf16 v[158:161], v[122:125], v[174:177], 0
s_waitcnt lgkmcnt(1)
v_max3_u32 v218, v218, v150, v151
v_mul_f32 v151, s3, v151
v_mfma_f32_16x16x32_bf16 v[142:145], v[126:129], v[178:181], v[142:145]
s_waitcnt lgkmcnt(0)
v_mul_f32 v138, v138, v151
v_mul_f32 v139, v139, v151
v_mfma_f32_16x16x32_bf16 v[146:149], v[134:137], v[178:181], v[146:149]
v_cvt_pk_bf16_f32 v180, v166, 0
v_mul_f32 v140, v140, v151
v_mfma_f32_16x16x32_bf16 v[166:169], v[190:193], v[174:177], 0
v_mul_f32 v141, v141, v151
v_cvt_pk_bf16_f32 v138, v138, v139
v_mul_f32 v142, v142, v151
v_mul_f32 v143, v143, v151
v_mul_f32 v144, v144, v151
v_mul_f32 v145, v145, v151
v_cvt_pk_bf16_f32 v139, v140, v141
v_cvt_pk_bf16_f32 v140, v142, v143
v_cvt_pk_bf16_f32 v141, v144, v145
v_cvt_pk_bf16_f32 v178, v162, v163
v_cvt_pk_bf16_f32 v179, v164, v165
v_mfma_f32_16x16x32_bf16 v[162:165], v[130:133], v[174:177], 0
ds_write_b128 v211, v[138:141] offset:36864
v_mfma_f32_16x16x32_bf16 v[138:141], v[78:81], v[90:93], 0
v_mul_f32 v146, v146, v151
v_mul_f32 v147, v147, v151
v_mfma_f32_16x16x32_bf16 v[166:169], v[190:193], v[178:181], v[166:169]
v_mul_f32 v148, v148, v151
v_mul_f32 v149, v149, v151
v_mfma_f32_16x16x32_bf16 v[154:157], v[118:121], v[178:181], v[154:157]
v_cvt_pk_bf16_f32 v142, v146, v147
v_cvt_pk_bf16_f32 v143, v148, v149
v_mfma_f32_16x16x32_bf16 v[158:161], v[126:129], v[178:181], v[158:161]
ds_write_b64 v212, v[142:143] offset:36864
v_mfma_f32_16x16x32_bf16 v[142:145], v[96:99], v[90:93], 0
v_rcp_f32 v167, v166
v_mfma_f32_16x16x32_bf16 v[162:165], v[134:137], v[178:181], v[162:165]
v_max3_u32 v218, v218, v166, v167
v_cvt_pk_bf16_f32 v94, v220, v221
v_mfma_f32_16x16x32_bf16 v[150:153], v[108:111], v[90:93], v[206:209]
v_cvt_pk_bf16_f32 v95, v222, v223
v_mul_f32 v167, s3, v167
v_mfma_f32_16x16x32_bf16 v[146:149], v[102:105], v[90:93], 0
v_mul_f32 v154, v154, v167
v_mul_f32 v155, v155, v167
v_mul_f32 v156, v156, v167
v_mfma_f32_16x16x16_bf16 v[138:141], v[82:83], v[94:95], v[138:141]
v_mul_f32 v157, v157, v167
v_cvt_pk_bf16_f32 v154, v154, v155
v_mul_f32 v158, v158, v167
v_mfma_f32_16x16x16_bf16 v[142:145], v[100:101], v[94:95], v[142:145]
v_mul_f32 v159, v159, v167
v_mul_f32 v160, v160, v167
v_mul_f32 v161, v161, v167
v_mfma_f32_16x16x16_bf16 v[150:153], v[112:113], v[94:95], v[150:153]
v_cvt_pk_bf16_f32 v155, v156, v157
v_cvt_pk_bf16_f32 v156, v158, v159
v_cvt_pk_bf16_f32 v157, v160, v161
v_mfma_f32_16x16x16_bf16 v[146:149], v[106:107], v[94:95], v[146:149]
v_mul_f32 v162, v162, v167
v_mul_f32 v163, v163, v167
v_mul_f32 v164, v164, v167
v_mul_f32 v165, v165, v167
v_mfma_f32_16x16x16_bf16 v[166:169], v[76:77], v[112:113], v[206:209]
v_cvt_pk_bf16_f32 v158, v162, v163
v_cvt_pk_bf16_f32 v159, v164, v165
v_exp_f32 v138, v138
v_mfma_f32_16x16x16_bf16 v[162:165], v[76:77], v[106:107], 0
v_exp_f32 v139, v139
v_exp_f32 v140, v140
v_mfma_f32_16x16x32_bf16 v[166:169], v[72:75], v[108:111], v[166:169]
ds_write_b128 v211, v[154:157] offset:43008
v_mfma_f32_16x16x16_bf16 v[154:157], v[76:77], v[82:83], 0
v_exp_f32 v141, v141
v_exp_f32 v142, v142
v_mfma_f32_16x16x32_bf16 v[162:165], v[72:75], v[102:105], v[162:165]
v_exp_f32 v143, v143
v_mfma_f32_16x16x32_bf16 v[154:157], v[72:75], v[78:81], v[154:157]
ds_write_b64 v212, v[158:159] offset:43008
v_mfma_f32_16x16x16_bf16 v[158:161], v[76:77], v[100:101], 0
v_exp_f32 v144, v144
v_exp_f32 v145, v145
v_exp_f32 v150, v150
v_mfma_f32_16x16x32_bf16 v[158:161], v[72:75], v[96:99], v[158:161]
v_cvt_pk_bf16_f32 v174, v138, v139
v_cvt_pk_bf16_f32 v175, v140, v141
v_cvt_pk_bf16_f32 v176, v142, v143
v_cvt_pk_bf16_f32 v177, v144, v145
v_cvt_pk_bf16_f32 v180, v150, 0
v_exp_f32 v146, v146
v_mfma_f32_16x16x32_bf16 v[150:153], v[190:193], v[174:177], 0
v_exp_f32 v147, v147
v_mfma_f32_16x16x32_bf16 v[138:141], v[114:117], v[174:177], 0
s_waitcnt lgkmcnt(0)
v_exp_f32 v148, v148
v_mfma_f32_16x16x32_bf16 v[142:145], v[122:125], v[174:177], 0
s_barrier
ds_read_b128 v[170:173], v210 offset:36864
ds_read_b128 v[182:185], v210 offset:37888
ds_read_b128 v[186:189], v210 offset:38912
v_exp_f32 v149, v149
v_cvt_pk_bf16_f32 v178, v146, v147
v_cvt_pk_bf16_f32 v179, v148, v149
v_mfma_f32_16x16x32_bf16 v[146:149], v[130:133], v[174:177], 0
v_mov_b32_dpp v154, v158 quad_perm:[0,1,2,3] row_mask:0x2 bank_mask:0xf
v_mfma_f32_16x16x32_bf16 v[150:153], v[190:193], v[178:181], v[150:153]
v_mov_b32_dpp v154, v162 quad_perm:[0,1,2,3] row_mask:0x4 bank_mask:0xf
v_mfma_f32_16x16x32_bf16 v[138:141], v[118:121], v[178:181], v[138:141]
v_mov_b32_dpp v154, v167 quad_perm:[0,1,2,3] row_mask:0x8 bank_mask:0xf
v_exp_f32 v154, v154
v_mfma_f32_16x16x32_bf16 v[142:145], v[126:129], v[178:181], v[142:145]
v_cvt_pk_bf16_f32 v154, v154, 0
v_rcp_f32 v151, v150
v_mfma_f32_16x16x32_bf16 v[146:149], v[134:137], v[178:181], v[146:149]
s_waitcnt lgkmcnt(2)
ds_write_b16 v214, v154
v_mfma_f32_16x16x32_bf16 v[36:39], a[144:147], v[170:173], v[36:39]
ds_read_b128 v[84:87], v215
ds_read_b128 v[88:91], v215 offset:16
v_mfma_f32_16x16x32_bf16 v[40:43], a[168:171], v[170:173], v[40:43]
v_mfma_f32_16x16x32_bf16 v[44:47], a[192:195], v[170:173], v[44:47]
ds_read_b128 v[170:173], v210 offset:39936
s_waitcnt lgkmcnt(5)
v_mfma_f32_16x16x32_bf16 v[36:39], a[148:151], v[182:185], v[36:39]
v_mfma_f32_16x16x32_bf16 v[40:43], a[172:175], v[182:185], v[40:43]
v_mfma_f32_16x16x32_bf16 v[44:47], a[196:199], v[182:185], v[44:47]
ds_read_b128 v[182:185], v210 offset:40960
s_waitcnt lgkmcnt(3)
v_mfma_f32_16x16x32_bf16 v[166:169], v[84:87], v[190:193], 0
v_mfma_f32_16x16x32_bf16 v[154:157], v[84:87], v[114:117], 0
v_mfma_f32_16x16x32_bf16 v[158:161], v[84:87], v[122:125], 0
v_mfma_f32_16x16x32_bf16 v[162:165], v[84:87], v[130:133], 0
s_waitcnt lgkmcnt(2)
v_mfma_f32_16x16x32_bf16 v[166:169], v[88:91], v[190:193], v[166:169]
v_mfma_f32_16x16x32_bf16 v[154:157], v[88:91], v[118:121], v[154:157]
v_mfma_f32_16x16x32_bf16 v[158:161], v[88:91], v[126:129], v[158:161]
v_rcp_f32 v167, v166
v_mfma_f32_16x16x32_bf16 v[162:165], v[88:91], v[134:137], v[162:165]
v_max3_u32 v218, v218, v166, v167
v_max3_u32 v218, v218, v150, v151
v_mfma_f32_16x16x32_bf16 v[36:39], a[152:155], v[186:189], v[36:39]
v_mul_f32 v151, s3, v151
v_mul_f32 v138, v138, v151
v_mfma_f32_16x16x32_bf16 v[40:43], a[176:179], v[186:189], v[40:43]
v_mul_f32 v139, v139, v151
v_mul_f32 v140, v140, v151
v_mfma_f32_16x16x32_bf16 v[44:47], a[200:203], v[186:189], v[44:47]
s_waitcnt lgkmcnt(1)
ds_read_b128 v[186:189], v210 offset:41984
v_mul_f32 v141, v141, v151
v_mfma_f32_16x16x32_bf16 v[36:39], a[156:159], v[170:173], v[36:39]
v_cvt_pk_bf16_f32 v138, v138, v139
v_mul_f32 v142, v142, v151
v_mfma_f32_16x16x32_bf16 v[40:43], a[180:183], v[170:173], v[40:43]
v_mul_f32 v143, v143, v151
v_mul_f32 v144, v144, v151
v_mfma_f32_16x16x32_bf16 v[44:47], a[204:207], v[170:173], v[44:47]
s_waitcnt lgkmcnt(1)
ds_read_b128 v[170:173], v210 offset:43008
v_mul_f32 v145, v145, v151
v_mfma_f32_16x16x32_bf16 v[36:39], a[160:163], v[182:185], v[36:39]
v_cvt_pk_bf16_f32 v139, v140, v141
v_cvt_pk_bf16_f32 v140, v142, v143
v_mfma_f32_16x16x32_bf16 v[40:43], a[184:187], v[182:185], v[40:43]
v_cvt_pk_bf16_f32 v141, v144, v145
v_mul_f32 v146, v146, v151
v_mfma_f32_16x16x32_bf16 v[44:47], a[208:211], v[182:185], v[44:47]
s_waitcnt lgkmcnt(1)
ds_read_b128 v[182:185], v210 offset:44032
ds_write_b128 v211, v[138:141] offset:49152
v_mfma_f32_16x16x32_bf16 v[36:39], a[164:167], v[186:189], v[36:39]
s_mov_b32 s38, s36
v_mul_f32 v147, v147, v151
v_mul_f32 v148, v148, v151
v_mfma_f32_16x16x32_bf16 v[40:43], a[188:191], v[186:189], v[40:43]
v_mul_f32 v149, v149, v151
v_cvt_pk_bf16_f32 v142, v146, v147
v_mfma_f32_16x16x32_bf16 v[44:47], a[212:215], v[186:189], v[44:47]
s_waitcnt lgkmcnt(2)
ds_read_b128 v[186:189], v210 offset:45056
v_cvt_pk_bf16_f32 v143, v148, v149
v_mfma_f32_16x16x32_bf16 v[48:51], a[144:147], v[170:173], v[48:51]
ds_write_b64 v212, v[142:143] offset:49152
v_mfma_f32_16x16x32_bf16 v[52:55], a[168:171], v[170:173], v[52:55]
v_cvt_pk_bf16_f32 v72, v36, v37
v_cvt_pk_bf16_f32 v73, v38, v39
v_mfma_f32_16x16x32_bf16 v[56:59], a[192:195], v[170:173], v[56:59]
s_waitcnt lgkmcnt(3)
ds_read_b128 v[170:173], v210 offset:46080
buffer_store_dwordx2 v[72:73], v203, s[8:11], s39 offen
v_cvt_pk_bf16_f32 v74, v40, v41
v_mfma_f32_16x16x32_bf16 v[48:51], a[148:151], v[182:185], v[48:51]
v_cvt_pk_bf16_f32 v75, v42, v43
v_mov_b32_dpp v154, v158 quad_perm:[0,1,2,3] row_mask:0x2 bank_mask:0xf
v_mfma_f32_16x16x32_bf16 v[52:55], a[172:175], v[182:185], v[52:55]
v_mul_f32 v167, s3, v167
v_mov_b32_dpp v154, v162 quad_perm:[0,1,2,3] row_mask:0x4 bank_mask:0xf
v_mfma_f32_16x16x32_bf16 v[56:59], a[196:199], v[182:185], v[56:59]
s_waitcnt lgkmcnt(2)
ds_read_b128 v[182:185], v210 offset:47104
v_mul_f32 v154, v154, v167
v_mfma_f32_16x16x32_bf16 v[48:51], a[152:155], v[186:189], v[48:51]
v_cvt_pk_bf16_f32 v154, v154, 0
v_cvt_pk_bf16_f32 v76, v44, v45
v_mfma_f32_16x16x32_bf16 v[52:55], a[176:179], v[186:189], v[52:55]
s_waitcnt lgkmcnt(1)
ds_write_b16 v214, v154
v_mfma_f32_16x16x32_bf16 v[56:59], a[200:203], v[186:189], v[56:59]
s_barrier
v_mfma_f32_16x16x32_bf16 v[48:51], a[156:159], v[170:173], v[48:51]
ds_read_b128 v[186:189], v210 offset:48128
v_mfma_f32_16x16x32_bf16 v[52:55], a[180:183], v[170:173], v[52:55]
v_mfma_f32_16x16x32_bf16 v[56:59], a[204:207], v[170:173], v[56:59]
ds_read_b128 v[170:173], v210 offset:49152
s_waitcnt lgkmcnt(3)
v_mfma_f32_16x16x32_bf16 v[48:51], a[160:163], v[182:185], v[48:51]
v_cvt_pk_bf16_f32 v77, v46, v47
v_mfma_f32_16x16x32_bf16 v[52:55], a[184:187], v[182:185], v[52:55]
v_add_u32 v215, 1552, v215
v_mfma_f32_16x16x32_bf16 v[56:59], a[208:211], v[182:185], v[56:59]
ds_read_b128 v[182:185], v210 offset:50176
buffer_store_dwordx2 v[74:75], v203, s[8:11], s39 offen offset:32
s_waitcnt lgkmcnt(2)
v_mfma_f32_16x16x32_bf16 v[48:51], a[164:167], v[186:189], v[48:51]
ds_read_b64 v[112:113], v215 offset:528
v_mfma_f32_16x16x32_bf16 v[52:55], a[188:191], v[186:189], v[52:55]
v_mfma_f32_16x16x32_bf16 v[56:59], a[212:215], v[186:189], v[56:59]
s_waitcnt lgkmcnt(2)
ds_read_b128 v[186:189], v210 offset:51200
v_cvt_pk_bf16_f32 v78, v48, v49
v_cvt_pk_bf16_f32 v79, v50, v51
v_mfma_f32_16x16x32_bf16 v[60:63], a[144:147], v[170:173], v[60:63]
v_cvt_pk_bf16_f32 v80, v52, v53
v_cvt_pk_bf16_f32 v81, v54, v55
v_mfma_f32_16x16x32_bf16 v[64:67], a[168:171], v[170:173], v[64:67]
v_cvt_pk_bf16_f32 v82, v56, v57
v_cvt_pk_bf16_f32 v83, v58, v59
v_mfma_f32_16x16x32_bf16 v[68:71], a[192:195], v[170:173], v[68:71]
ds_read_b128 v[170:173], v210 offset:52224
s_waitcnt lgkmcnt(3)
v_mfma_f32_16x16x32_bf16 v[60:63], a[148:151], v[182:185], v[60:63]
v_mfma_f32_16x16x32_bf16 v[64:67], a[172:175], v[182:185], v[64:67]
v_mfma_f32_16x16x32_bf16 v[68:71], a[196:199], v[182:185], v[68:71]
ds_read_b128 v[182:185], v210 offset:53248
s_waitcnt lgkmcnt(2)
v_mfma_f32_16x16x32_bf16 v[60:63], a[152:155], v[186:189], v[60:63]
v_mfma_f32_16x16x32_bf16 v[64:67], a[176:179], v[186:189], v[64:67]
v_mfma_f32_16x16x32_bf16 v[68:71], a[200:203], v[186:189], v[68:71]
ds_read_b128 v[186:189], v210 offset:54272
s_waitcnt lgkmcnt(2)
v_mfma_f32_16x16x32_bf16 v[60:63], a[156:159], v[170:173], v[60:63]
buffer_store_dwordx2 v[76:77], v203, s[8:11], s39 offen offset:64
v_mfma_f32_16x16x32_bf16 v[64:67], a[180:183], v[170:173], v[64:67]
v_mfma_f32_16x16x32_bf16 v[68:71], a[204:207], v[170:173], v[68:71]
s_waitcnt lgkmcnt(1)
v_mfma_f32_16x16x32_bf16 v[60:63], a[160:163], v[182:185], v[60:63]
v_mfma_f32_16x16x32_bf16 v[64:67], a[184:187], v[182:185], v[64:67]
v_mfma_f32_16x16x32_bf16 v[68:71], a[208:211], v[182:185], v[68:71]
ds_read_b128 v[182:185], v210
s_waitcnt lgkmcnt(1)
v_mfma_f32_16x16x32_bf16 v[60:63], a[164:167], v[186:189], v[60:63]
v_mfma_f32_16x16x32_bf16 v[64:67], a[188:191], v[186:189], v[64:67]
s_nop 3
v_cvt_pk_bf16_f32 v116, v60, v61
v_cvt_pk_bf16_f32 v117, v62, v63
v_mfma_f32_16x16x32_bf16 v[68:71], a[212:215], v[186:189], v[68:71]
ds_read_b128 v[186:189], v210 offset:1024
v_cvt_pk_bf16_f32 v124, v64, v65
s_waitcnt lgkmcnt(1)
v_mfma_f32_16x16x32_bf16 v[138:141], a[0:3], v[182:185], 0
v_cvt_pk_bf16_f32 v125, v66, v67
s_nop 0
v_cvt_pk_bf16_f32 v132, v68, v69
v_mfma_f32_16x16x32_bf16 v[142:145], a[24:27], v[182:185], 0
v_cvt_pk_bf16_f32 v133, v70, v71
v_mfma_f32_16x16x32_bf16 v[146:149], a[48:51], v[182:185], 0
v_mfma_f32_16x16x32_bf16 v[150:153], a[216:219], v[182:185], 0
buffer_store_dwordx2 v[78:79], v204, s[8:11], s39 offen
v_mfma_f32_16x16x32_bf16 v[154:157], a[240:243], v[182:185], 0
v_mfma_f32_16x16x32_bf16 v[158:161], v[232:235], v[182:185], 0
v_mfma_f32_16x16x32_bf16 v[162:165], v[182:185], a[72:75], 0
v_mfma_f32_16x16x32_bf16 v[166:169], v[182:185], a[96:99], 0
v_mfma_f32_16x16x32_bf16 v[170:173], v[182:185], a[120:123], 0
ds_read_b128 v[182:185], v210 offset:2048
s_waitcnt lgkmcnt(1)
v_mfma_f32_16x16x32_bf16 v[138:141], a[4:7], v[186:189], v[138:141]
v_mfma_f32_16x16x32_bf16 v[142:145], a[28:31], v[186:189], v[142:145]
v_mfma_f32_16x16x32_bf16 v[146:149], a[52:55], v[186:189], v[146:149]
v_mfma_f32_16x16x32_bf16 v[150:153], a[220:223], v[186:189], v[150:153]
v_mfma_f32_16x16x32_bf16 v[154:157], a[244:247], v[186:189], v[154:157]
buffer_store_dwordx2 v[80:81], v204, s[8:11], s39 offen offset:32
v_mfma_f32_16x16x32_bf16 v[158:161], v[236:239], v[186:189], v[158:161]
v_mfma_f32_16x16x32_bf16 v[162:165], v[186:189], a[76:79], v[162:165]
v_mfma_f32_16x16x32_bf16 v[166:169], v[186:189], a[100:103], v[166:169]
v_mfma_f32_16x16x32_bf16 v[170:173], v[186:189], a[124:127], v[170:173]
ds_read_b128 v[186:189], v210 offset:3072
s_waitcnt lgkmcnt(1)
v_mfma_f32_16x16x32_bf16 v[138:141], a[8:11], v[182:185], v[138:141]
v_mfma_f32_16x16x32_bf16 v[142:145], a[32:35], v[182:185], v[142:145]
v_mfma_f32_16x16x32_bf16 v[146:149], a[56:59], v[182:185], v[146:149]
v_mfma_f32_16x16x32_bf16 v[150:153], a[224:227], v[182:185], v[150:153]
buffer_store_dwordx2 v[82:83], v204, s[8:11], s39 offen offset:64
v_mfma_f32_16x16x32_bf16 v[154:157], a[248:251], v[182:185], v[154:157]
v_mfma_f32_16x16x32_bf16 v[158:161], v[240:243], v[182:185], v[158:161]
v_mfma_f32_16x16x32_bf16 v[162:165], v[182:185], a[80:83], v[162:165]
v_mfma_f32_16x16x32_bf16 v[166:169], v[182:185], a[104:107], v[166:169]
v_mfma_f32_16x16x32_bf16 v[170:173], v[182:185], a[128:131], v[170:173]
ds_read_b128 v[182:185], v210 offset:4096
s_waitcnt lgkmcnt(1)
v_mfma_f32_16x16x32_bf16 v[138:141], a[12:15], v[186:189], v[138:141]
v_mfma_f32_16x16x32_bf16 v[142:145], a[36:39], v[186:189], v[142:145]
v_mfma_f32_16x16x32_bf16 v[146:149], a[60:63], v[186:189], v[146:149]
v_mfma_f32_16x16x32_bf16 v[150:153], a[228:231], v[186:189], v[150:153]
v_mfma_f32_16x16x32_bf16 v[154:157], a[252:255], v[186:189], v[154:157]
v_add_u32 v214, 1552, v214
v_mov_b32 v181, 0
buffer_store_dwordx2 v[116:117], v205, s[8:11], s39 offen
v_mfma_f32_16x16x32_bf16 v[158:161], v[244:247], v[186:189], v[158:161]
v_mfma_f32_16x16x32_bf16 v[162:165], v[186:189], a[84:87], v[162:165]
v_mfma_f32_16x16x32_bf16 v[166:169], v[186:189], a[108:111], v[166:169]
v_mfma_f32_16x16x32_bf16 v[170:173], v[186:189], a[132:135], v[170:173]
ds_read_b128 v[186:189], v210 offset:5120
s_waitcnt lgkmcnt(1)
v_mfma_f32_16x16x32_bf16 v[138:141], a[16:19], v[182:185], v[138:141]
v_mfma_f32_16x16x32_bf16 v[142:145], a[40:43], v[182:185], v[142:145]
v_mfma_f32_16x16x32_bf16 v[146:149], a[64:67], v[182:185], v[146:149]
v_mfma_f32_16x16x32_bf16 v[150:153], a[232:235], v[182:185], v[150:153]
v_mfma_f32_16x16x32_bf16 v[154:157], v[224:227], v[182:185], v[154:157]
v_mfma_f32_16x16x32_bf16 v[158:161], v[248:251], v[182:185], v[158:161]
v_mfma_f32_16x16x32_bf16 v[162:165], v[182:185], a[88:91], v[162:165]
v_mfma_f32_16x16x32_bf16 v[166:169], v[182:185], a[112:115], v[166:169]
v_mfma_f32_16x16x32_bf16 v[170:173], v[182:185], a[136:139], v[170:173]
ds_read_b128 v[182:185], v210 offset:6144
s_waitcnt lgkmcnt(1)
v_mfma_f32_16x16x32_bf16 v[138:141], a[20:23], v[186:189], v[138:141]
buffer_store_dwordx2 v[124:125], v205, s[8:11], s39 offen offset:32
v_mfma_f32_16x16x32_bf16 v[142:145], a[44:47], v[186:189], v[142:145]
v_mfma_f32_16x16x32_bf16 v[146:149], a[68:71], v[186:189], v[146:149]
v_cvt_pk_bf16_f32 v78, v138, v139
v_cvt_pk_bf16_f32 v79, v140, v141
v_mfma_f32_16x16x32_bf16 v[150:153], a[236:239], v[186:189], v[150:153]
v_cvt_pk_bf16_f32 v80, v142, v143
v_cvt_pk_bf16_f32 v81, v144, v145
v_mfma_f32_16x16x32_bf16 v[154:157], v[228:231], v[186:189], v[154:157]
v_cvt_pk_bf16_f32 v82, v146, v147
v_cvt_pk_bf16_f32 v83, v148, v149
v_mfma_f32_16x16x32_bf16 v[158:161], v[252:255], v[186:189], v[158:161]
v_cvt_pk_bf16_f32 v72, v150, v151
v_cvt_pk_bf16_f32 v73, v152, v153
v_mfma_f32_16x16x32_bf16 v[162:165], v[186:189], a[92:95], v[162:165]
v_cvt_pk_bf16_f32 v74, v154, v155
v_cvt_pk_bf16_f32 v75, v156, v157
v_mfma_f32_16x16x32_bf16 v[166:169], v[186:189], a[116:119], v[166:169]
v_cvt_pk_bf16_f32 v76, v158, v159
v_cvt_pk_bf16_f32 v77, v160, v161
v_mfma_f32_16x16x32_bf16 v[170:173], v[186:189], a[140:143], v[170:173]
s_waitcnt lgkmcnt(0)
ds_read_b128 v[186:189], v210 offset:7168
v_cvt_pk_bf16_f32 v114, v162, v163
v_mfma_f32_16x16x32_bf16 v[138:141], a[0:3], v[182:185], 0
v_cvt_pk_bf16_f32 v115, v164, v165
v_cvt_pk_bf16_f32 v122, v166, v167
v_mfma_f32_16x16x32_bf16 v[142:145], a[24:27], v[182:185], 0
v_cvt_pk_bf16_f32 v123, v168, v169
v_cvt_pk_bf16_f32 v130, v170, v171
v_mfma_f32_16x16x32_bf16 v[146:149], a[48:51], v[182:185], 0
v_cvt_pk_bf16_f32 v131, v172, v173
v_mfma_f32_16x16x32_bf16 v[150:153], a[216:219], v[182:185], 0
v_mfma_f32_16x16x32_bf16 v[154:157], a[240:243], v[182:185], 0
v_mfma_f32_16x16x32_bf16 v[158:161], v[232:235], v[182:185], 0
v_mfma_f32_16x16x32_bf16 v[162:165], v[182:185], a[72:75], 0
buffer_store_dwordx2 v[132:133], v205, s[8:11], s39 offen offset:64
v_mfma_f32_16x16x32_bf16 v[166:169], v[182:185], a[96:99], 0
v_mfma_f32_16x16x32_bf16 v[170:173], v[182:185], a[120:123], 0
ds_read_b128 v[182:185], v210 offset:8192
s_waitcnt lgkmcnt(1)
v_mfma_f32_16x16x32_bf16 v[138:141], a[4:7], v[186:189], v[138:141]
v_mfma_f32_16x16x32_bf16 v[142:145], a[28:31], v[186:189], v[142:145]
v_mfma_f32_16x16x32_bf16 v[146:149], a[52:55], v[186:189], v[146:149]
v_mfma_f32_16x16x32_bf16 v[150:153], a[220:223], v[186:189], v[150:153]
v_mfma_f32_16x16x32_bf16 v[154:157], a[244:247], v[186:189], v[154:157]
v_mfma_f32_16x16x32_bf16 v[158:161], v[236:239], v[186:189], v[158:161]
v_mfma_f32_16x16x32_bf16 v[162:165], v[186:189], a[76:79], v[162:165]
s_barrier
v_mfma_f32_16x16x32_bf16 v[166:169], v[186:189], a[100:103], v[166:169]
v_mfma_f32_16x16x32_bf16 v[170:173], v[186:189], a[124:127], v[170:173]
ds_read_b128 v[186:189], v210 offset:9216
s_waitcnt lgkmcnt(1)
v_mfma_f32_16x16x32_bf16 v[138:141], a[8:11], v[182:185], v[138:141]
v_mfma_f32_16x16x32_bf16 v[142:145], a[32:35], v[182:185], v[142:145]
v_mfma_f32_16x16x32_bf16 v[146:149], a[56:59], v[182:185], v[146:149]
v_mfma_f32_16x16x32_bf16 v[150:153], a[224:227], v[182:185], v[150:153]
v_mfma_f32_16x16x32_bf16 v[154:157], a[248:251], v[182:185], v[154:157]
v_mfma_f32_16x16x32_bf16 v[158:161], v[240:243], v[182:185], v[158:161]
v_mfma_f32_16x16x32_bf16 v[162:165], v[182:185], a[80:83], v[162:165]
v_mfma_f32_16x16x32_bf16 v[166:169], v[182:185], a[104:107], v[166:169]
ds_read_b128 v[108:111], v215 offset:512
v_mfma_f32_16x16x32_bf16 v[170:173], v[182:185], a[128:131], v[170:173]
ds_read_b128 v[182:185], v210 offset:10240
s_waitcnt lgkmcnt(2)
v_mfma_f32_16x16x32_bf16 v[138:141], a[12:15], v[186:189], v[138:141]
v_mfma_f32_16x16x32_bf16 v[142:145], a[36:39], v[186:189], v[142:145]
v_mfma_f32_16x16x32_bf16 v[146:149], a[60:63], v[186:189], v[146:149]
v_mfma_f32_16x16x32_bf16 v[150:153], a[228:231], v[186:189], v[150:153]
v_mfma_f32_16x16x32_bf16 v[154:157], a[252:255], v[186:189], v[154:157]
v_mfma_f32_16x16x32_bf16 v[158:161], v[244:247], v[186:189], v[158:161]
v_mfma_f32_16x16x32_bf16 v[162:165], v[186:189], a[84:87], v[162:165]
v_mfma_f32_16x16x32_bf16 v[166:169], v[186:189], a[108:111], v[166:169]
v_mfma_f32_16x16x32_bf16 v[170:173], v[186:189], a[132:135], v[170:173]
ds_read_b128 v[186:189], v210 offset:11264
s_waitcnt lgkmcnt(1)
v_mfma_f32_16x16x32_bf16 v[138:141], a[16:19], v[182:185], v[138:141]
v_mfma_f32_16x16x32_bf16 v[142:145], a[40:43], v[182:185], v[142:145]
v_mfma_f32_16x16x32_bf16 v[146:149], a[64:67], v[182:185], v[146:149]
v_mfma_f32_16x16x32_bf16 v[150:153], a[232:235], v[182:185], v[150:153]
v_mfma_f32_16x16x32_bf16 v[154:157], v[224:227], v[182:185], v[154:157]
v_mfma_f32_16x16x32_bf16 v[158:161], v[248:251], v[182:185], v[158:161]
v_mfma_f32_16x16x32_bf16 v[162:165], v[182:185], a[88:91], v[162:165]
v_mfma_f32_16x16x32_bf16 v[166:169], v[182:185], a[112:115], v[166:169]
v_mfma_f32_16x16x32_bf16 v[170:173], v[182:185], a[136:139], v[170:173]
ds_read_b128 v[182:185], v210 offset:12288
s_waitcnt lgkmcnt(1)
v_mfma_f32_16x16x32_bf16 v[138:141], a[20:23], v[186:189], v[138:141]
v_mfma_f32_16x16x32_bf16 v[142:145], a[44:47], v[186:189], v[142:145]
v_mfma_f32_16x16x32_bf16 v[146:149], a[68:71], v[186:189], v[146:149]
v_mfma_f32_16x16x32_bf16 v[150:153], a[236:239], v[186:189], v[150:153]
v_cvt_pk_bf16_f32 v96, v138, v139
v_cvt_pk_bf16_f32 v97, v140, v141
v_mfma_f32_16x16x32_bf16 v[154:157], v[228:231], v[186:189], v[154:157]
v_cvt_pk_bf16_f32 v98, v142, v143
v_cvt_pk_bf16_f32 v99, v144, v145
v_mfma_f32_16x16x32_bf16 v[158:161], v[252:255], v[186:189], v[158:161]
v_mfma_f32_16x16x32_bf16 v[162:165], v[186:189], a[92:95], v[162:165]
v_cvt_pk_bf16_f32 v100, v146, v147
v_cvt_pk_bf16_f32 v101, v148, v149
v_mfma_f32_16x16x32_bf16 v[166:169], v[186:189], a[116:119], v[166:169]
v_cvt_pk_bf16_f32 v88, v158, v159
v_cvt_pk_bf16_f32 v89, v160, v161
v_mfma_f32_16x16x32_bf16 v[170:173], v[186:189], a[140:143], v[170:173]
s_waitcnt lgkmcnt(0)
ds_read_b128 v[186:189], v210 offset:13312
v_cvt_pk_bf16_f32 v86, v154, v155
v_mfma_f32_16x16x32_bf16 v[138:141], a[0:3], v[182:185], 0
v_cvt_pk_bf16_f32 v87, v156, v157
v_cvt_pk_bf16_f32 v124, v166, v167
v_mfma_f32_16x16x32_bf16 v[142:145], a[24:27], v[182:185], 0
v_cvt_pk_bf16_f32 v125, v168, v169
v_cvt_pk_bf16_f32 v84, v150, v151
v_mfma_f32_16x16x32_bf16 v[146:149], a[48:51], v[182:185], 0
ds_read_b128 v[182:185], v210 offset:14336
v_cvt_pk_bf16_f32 v85, v152, v153
v_cvt_pk_bf16_f32 v116, v162, v163
v_mfma_f32_16x16x16_bf16 v[154:157], v[82:83], v[88:89], 0
v_cvt_pk_bf16_f32 v117, v164, v165
v_mfma_f32_16x16x16_bf16 v[158:161], v[100:101], v[88:89], 0
s_waitcnt lgkmcnt(1)
v_mfma_f32_16x16x32_bf16 v[138:141], a[4:7], v[186:189], v[138:141]
v_mfma_f32_16x16x32_bf16 v[142:145], a[28:31], v[186:189], v[142:145]
v_mfma_f32_16x16x32_bf16 v[146:149], a[52:55], v[186:189], v[146:149]
s_waitcnt lgkmcnt(0)
v_mfma_f32_16x16x32_bf16 v[138:141], a[8:11], v[182:185], v[138:141]
ds_read_b128 v[186:189], v210 offset:15360
v_mfma_f32_16x16x32_bf16 v[142:145], a[32:35], v[182:185], v[142:145]
v_mfma_f32_16x16x32_bf16 v[146:149], a[56:59], v[182:185], v[146:149]
ds_read_b128 v[182:185], v210 offset:16384
v_mfma_f32_16x16x16_bf16 v[166:169], v[112:113], v[88:89], v[206:209]
v_mfma_f32_16x16x16_bf16 v[150:153], v[112:113], v[76:77], v[206:209]
v_mfma_f32_16x16x32_bf16 v[154:157], v[78:81], v[84:87], v[154:157]
s_waitcnt lgkmcnt(1)
v_mfma_f32_16x16x32_bf16 v[138:141], a[12:15], v[186:189], v[138:141]
v_mfma_f32_16x16x32_bf16 v[142:145], a[36:39], v[186:189], v[142:145]
v_mfma_f32_16x16x32_bf16 v[146:149], a[60:63], v[186:189], v[146:149]
ds_read_b128 v[186:189], v210 offset:17408
s_waitcnt lgkmcnt(1)
v_mfma_f32_16x16x32_bf16 v[138:141], a[16:19], v[182:185], v[138:141]
v_mfma_f32_16x16x32_bf16 v[142:145], a[40:43], v[182:185], v[142:145]
v_mfma_f32_16x16x32_bf16 v[150:153], v[108:111], v[72:75], v[150:153]
v_mfma_f32_16x16x32_bf16 v[146:149], a[64:67], v[182:185], v[146:149]
ds_read_b128 v[182:185], v210 offset:12288
v_mfma_f32_16x16x32_bf16 v[158:161], v[96:99], v[84:87], v[158:161]
s_waitcnt lgkmcnt(1)
v_mfma_f32_16x16x32_bf16 v[138:141], a[20:23], v[186:189], v[138:141]
v_mfma_f32_16x16x32_bf16 v[142:145], a[44:47], v[186:189], v[142:145]
v_mfma_f32_16x16x32_bf16 v[146:149], a[68:71], v[186:189], v[146:149]
ds_read_b128 v[186:189], v210 offset:13312
v_cvt_pk_bf16_f32 v102, v138, v139
v_mfma_f32_16x16x32_bf16 v[166:169], v[108:111], v[84:87], v[166:169]
v_cvt_pk_bf16_f32 v103, v140, v141
v_cvt_pk_bf16_f32 v104, v142, v143
v_cvt_pk_bf16_f32 v105, v144, v145
v_mfma_f32_16x16x16_bf16 v[138:141], v[82:83], v[76:77], 0
v_cvt_pk_bf16_f32 v106, v146, v147
v_cvt_pk_bf16_f32 v107, v148, v149
v_mfma_f32_16x16x16_bf16 v[142:145], v[100:101], v[76:77], 0
v_mfma_f32_16x16x16_bf16 v[162:165], v[106:107], v[88:89], 0
v_mfma_f32_16x16x16_bf16 v[146:149], v[106:107], v[76:77], 0
v_cvt_pk_bf16_f32 v132, v170, v171
v_cvt_pk_bf16_f32 v133, v172, v173
v_mfma_f32_16x16x32_bf16 v[138:141], v[78:81], v[72:75], v[138:141]
v_mfma_f32_16x16x32_bf16 v[142:145], v[96:99], v[72:75], v[142:145]
s_waitcnt lgkmcnt(1)
s_nop 2
v_exp_f32 v138, v138
v_mfma_f32_16x16x32_bf16 v[118:121], v[182:185], a[72:75], 0
v_mfma_f32_16x16x32_bf16 v[126:129], v[182:185], a[96:99], 0
v_mfma_f32_16x16x32_bf16 v[134:137], v[182:185], a[120:123], 0
v_exp_f32 v139, v139
v_mfma_f32_16x16x32_bf16 v[146:149], v[102:105], v[72:75], v[146:149]
ds_read_b64 v[76:77], v215 offset:16
v_cvt_pk_bf16_f32 v174, v138, v139
v_mfma_f32_16x16x32_bf16 v[90:93], a[216:219], v[182:185], 0
v_exp_f32 v140, v140
v_mfma_f32_16x16x32_bf16 v[170:173], a[240:243], v[182:185], 0
v_exp_f32 v141, v141
v_mfma_f32_16x16x32_bf16 v[220:223], v[232:235], v[182:185], 0
s_waitcnt lgkmcnt(1)
ds_read_b128 v[182:185], v210 offset:14336
v_cvt_pk_bf16_f32 v175, v140, v141
v_mfma_f32_16x16x32_bf16 v[118:121], v[186:189], a[76:79], v[118:121]
v_exp_f32 v142, v142
v_mfma_f32_16x16x32_bf16 v[126:129], v[186:189], a[100:103], v[126:129]
v_exp_f32 v143, v143
v_mfma_f32_16x16x32_bf16 v[134:137], v[186:189], a[124:127], v[134:137]
v_exp_f32 v144, v144
v_mfma_f32_16x16x32_bf16 v[90:93], a[220:223], v[186:189], v[90:93]
v_mfma_f32_16x16x32_bf16 v[170:173], a[244:247], v[186:189], v[170:173]
v_exp_f32 v145, v145
v_mfma_f32_16x16x32_bf16 v[220:223], v[236:239], v[186:189], v[220:223]
s_waitcnt lgkmcnt(0)
ds_read_b128 v[186:189], v210 offset:15360
v_cvt_pk_bf16_f32 v176, v142, v143
v_mfma_f32_16x16x32_bf16 v[118:121], v[182:185], a[80:83], v[118:121]
v_exp_f32 v150, v150
v_mfma_f32_16x16x32_bf16 v[126:129], v[182:185], a[104:107], v[126:129]
v_cvt_pk_bf16_f32 v177, v144, v145
v_cvt_pk_bf16_f32 v180, v150, 0
v_mfma_f32_16x16x32_bf16 v[134:137], v[182:185], a[128:131], v[134:137]
v_exp_f32 v154, v154
v_mfma_f32_16x16x32_bf16 v[90:93], a[224:227], v[182:185], v[90:93]
v_exp_f32 v155, v155
v_mfma_f32_16x16x32_bf16 v[162:165], v[102:105], v[84:87], v[162:165]
v_exp_f32 v156, v156
v_mfma_f32_16x16x32_bf16 v[170:173], a[248:251], v[182:185], v[170:173]
v_exp_f32 v157, v157
v_mfma_f32_16x16x32_bf16 v[220:223], v[240:243], v[182:185], v[220:223]
s_waitcnt lgkmcnt(0)
ds_read_b128 v[182:185], v210 offset:16384
ds_read_b128 v[72:75], v215
v_mfma_f32_16x16x32_bf16 v[118:121], v[186:189], a[84:87], v[118:121]
v_exp_f32 v158, v158
v_mfma_f32_16x16x32_bf16 v[126:129], v[186:189], a[108:111], v[126:129]
v_exp_f32 v159, v159
v_mfma_f32_16x16x32_bf16 v[134:137], v[186:189], a[132:135], v[134:137]
v_exp_f32 v160, v160
v_mfma_f32_16x16x32_bf16 v[90:93], a[228:231], v[186:189], v[90:93]
v_exp_f32 v161, v161
v_mfma_f32_16x16x32_bf16 v[170:173], a[252:255], v[186:189], v[170:173]
v_exp_f32 v166, v166
v_mfma_f32_16x16x32_bf16 v[220:223], v[244:247], v[186:189], v[220:223]
s_waitcnt lgkmcnt(1)
ds_read_b128 v[186:189], v210 offset:17408
v_exp_f32 v146, v146
v_mfma_f32_16x16x32_bf16 v[118:121], v[182:185], a[88:91], v[118:121]
v_exp_f32 v147, v147
v_mfma_f32_16x16x32_bf16 v[126:129], v[182:185], a[112:115], v[126:129]
v_exp_f32 v148, v148
v_mfma_f32_16x16x32_bf16 v[134:137], v[182:185], a[136:139], v[134:137]
v_exp_f32 v149, v149
v_mfma_f32_16x16x32_bf16 v[90:93], a[232:235], v[182:185], v[90:93]
v_exp_f32 v162, v162
v_mfma_f32_16x16x32_bf16 v[170:173], v[224:227], v[182:185], v[170:173]
v_exp_f32 v163, v163
v_mfma_f32_16x16x32_bf16 v[220:223], v[248:251], v[182:185], v[220:223]
s_waitcnt lgkmcnt(0)
v_exp_f32 v164, v164
v_mfma_f32_16x16x32_bf16 v[118:121], v[186:189], a[92:95], v[118:121]
v_exp_f32 v165, v165
v_mfma_f32_16x16x32_bf16 v[126:129], v[186:189], a[116:119], v[126:129]
v_cvt_pk_bf16_f32 v178, v146, v147
v_cvt_pk_bf16_f32 v179, v148, v149
v_mfma_f32_16x16x32_bf16 v[134:137], v[186:189], a[140:143], v[134:137]
v_cvt_pk_bf16_f32 v118, v118, v119
v_cvt_pk_bf16_f32 v119, v120, v121
v_mfma_f32_16x16x32_bf16 v[90:93], a[236:239], v[186:189], v[90:93]
ds_read_u16 v120, v214 offset:1024
v_cvt_pk_bf16_f32 v126, v126, v127
v_mfma_f32_16x16x32_bf16 v[170:173], v[228:231], v[186:189], v[170:173]
v_cvt_pk_bf16_f32 v127, v128, v129
v_cvt_pk_bf16_f32 v134, v134, v135
v_mfma_f32_16x16x32_bf16 v[220:223], v[252:255], v[186:189], v[220:223]
ds_read_u16 v128, v214 offset:1032
v_cvt_pk_bf16_f32 v90, v90, v91
v_mfma_f32_16x16x32_bf16 v[150:153], v[190:193], v[174:177], 0
v_cvt_pk_bf16_f32 v91, v92, v93
v_cvt_pk_bf16_f32 v92, v170, v171
v_mfma_f32_16x16x32_bf16 v[138:141], v[114:117], v[174:177], 0
v_cvt_pk_bf16_f32 v93, v172, v173
v_cvt_pk_bf16_f32 v135, v136, v137
v_mfma_f32_16x16x32_bf16 v[142:145], v[122:125], v[174:177], 0
ds_read_u16 v136, v214 offset:1040
v_mov_b32 v121, 0
v_mfma_f32_16x16x32_bf16 v[146:149], v[130:133], v[174:177], 0
v_cvt_pk_bf16_f32 v174, v154, v155
v_cvt_pk_bf16_f32 v175, v156, v157
v_mfma_f32_16x16x32_bf16 v[150:153], v[190:193], v[178:181], v[150:153]
s_waitcnt lgkmcnt(2)
v_cvt_pk_bf16_f32 v176, v158, v159
v_cvt_pk_bf16_f32 v177, v160, v161
v_mfma_f32_16x16x32_bf16 v[138:141], v[118:121], v[178:181], v[138:141]
v_mov_b32 v129, 0
v_mov_b32 v137, 0
v_mfma_f32_16x16x32_bf16 v[154:157], v[114:117], v[174:177], 0
v_rcp_f32 v151, v150
v_mfma_f32_16x16x32_bf16 v[158:161], v[122:125], v[174:177], 0
s_waitcnt lgkmcnt(1)
v_max3_u32 v218, v218, v150, v151
v_mul_f32 v151, s3, v151
v_mfma_f32_16x16x32_bf16 v[142:145], v[126:129], v[178:181], v[142:145]
s_waitcnt lgkmcnt(0)
v_mul_f32 v138, v138, v151
v_mul_f32 v139, v139, v151
v_mfma_f32_16x16x32_bf16 v[146:149], v[134:137], v[178:181], v[146:149]
v_cvt_pk_bf16_f32 v180, v166, 0
v_mul_f32 v140, v140, v151
v_mfma_f32_16x16x32_bf16 v[166:169], v[190:193], v[174:177], 0
v_mul_f32 v141, v141, v151
v_cvt_pk_bf16_f32 v138, v138, v139
v_mul_f32 v142, v142, v151
v_mul_f32 v143, v143, v151
v_mul_f32 v144, v144, v151
v_mul_f32 v145, v145, v151
v_cvt_pk_bf16_f32 v139, v140, v141
v_cvt_pk_bf16_f32 v140, v142, v143
v_cvt_pk_bf16_f32 v141, v144, v145
v_cvt_pk_bf16_f32 v178, v162, v163
v_cvt_pk_bf16_f32 v179, v164, v165
v_mfma_f32_16x16x32_bf16 v[162:165], v[130:133], v[174:177], 0
ds_write_b128 v211, v[138:141] offset:36864
v_mfma_f32_16x16x32_bf16 v[138:141], v[78:81], v[90:93], 0
v_mul_f32 v146, v146, v151
v_mul_f32 v147, v147, v151
v_mfma_f32_16x16x32_bf16 v[166:169], v[190:193], v[178:181], v[166:169]
v_mul_f32 v148, v148, v151
v_mul_f32 v149, v149, v151
v_mfma_f32_16x16x32_bf16 v[154:157], v[118:121], v[178:181], v[154:157]
v_cvt_pk_bf16_f32 v142, v146, v147
v_cvt_pk_bf16_f32 v143, v148, v149
v_mfma_f32_16x16x32_bf16 v[158:161], v[126:129], v[178:181], v[158:161]
ds_write_b64 v212, v[142:143] offset:36864
v_mfma_f32_16x16x32_bf16 v[142:145], v[96:99], v[90:93], 0
v_rcp_f32 v167, v166
v_mfma_f32_16x16x32_bf16 v[162:165], v[134:137], v[178:181], v[162:165]
v_max3_u32 v218, v218, v166, v167
v_cvt_pk_bf16_f32 v94, v220, v221
v_mfma_f32_16x16x32_bf16 v[150:153], v[108:111], v[90:93], v[206:209]
v_cvt_pk_bf16_f32 v95, v222, v223
v_mul_f32 v167, s3, v167
v_mfma_f32_16x16x32_bf16 v[146:149], v[102:105], v[90:93], 0
v_mul_f32 v154, v154, v167
v_mul_f32 v155, v155, v167
v_mul_f32 v156, v156, v167
v_mfma_f32_16x16x16_bf16 v[138:141], v[82:83], v[94:95], v[138:141]
v_mul_f32 v157, v157, v167
v_cvt_pk_bf16_f32 v154, v154, v155
v_mul_f32 v158, v158, v167
v_mfma_f32_16x16x16_bf16 v[142:145], v[100:101], v[94:95], v[142:145]
v_mul_f32 v159, v159, v167
v_mul_f32 v160, v160, v167
v_mul_f32 v161, v161, v167
v_mfma_f32_16x16x16_bf16 v[150:153], v[112:113], v[94:95], v[150:153]
v_cvt_pk_bf16_f32 v155, v156, v157
v_cvt_pk_bf16_f32 v156, v158, v159
v_cvt_pk_bf16_f32 v157, v160, v161
v_mfma_f32_16x16x16_bf16 v[146:149], v[106:107], v[94:95], v[146:149]
v_mul_f32 v162, v162, v167
v_mul_f32 v163, v163, v167
v_mul_f32 v164, v164, v167
v_mul_f32 v165, v165, v167
v_mfma_f32_16x16x16_bf16 v[166:169], v[76:77], v[112:113], v[206:209]
v_cvt_pk_bf16_f32 v158, v162, v163
v_cvt_pk_bf16_f32 v159, v164, v165
v_exp_f32 v138, v138
v_mfma_f32_16x16x16_bf16 v[162:165], v[76:77], v[106:107], 0
v_exp_f32 v139, v139
v_exp_f32 v140, v140
v_mfma_f32_16x16x32_bf16 v[166:169], v[72:75], v[108:111], v[166:169]
ds_write_b128 v211, v[154:157] offset:43008
v_mfma_f32_16x16x16_bf16 v[154:157], v[76:77], v[82:83], 0
v_exp_f32 v141, v141
v_exp_f32 v142, v142
v_mfma_f32_16x16x32_bf16 v[162:165], v[72:75], v[102:105], v[162:165]
v_exp_f32 v143, v143
v_mfma_f32_16x16x32_bf16 v[154:157], v[72:75], v[78:81], v[154:157]
ds_write_b64 v212, v[158:159] offset:43008
v_mfma_f32_16x16x16_bf16 v[158:161], v[76:77], v[100:101], 0
v_exp_f32 v144, v144
v_exp_f32 v145, v145
v_exp_f32 v150, v150
v_mfma_f32_16x16x32_bf16 v[158:161], v[72:75], v[96:99], v[158:161]
v_cvt_pk_bf16_f32 v174, v138, v139
v_cvt_pk_bf16_f32 v175, v140, v141
v_cvt_pk_bf16_f32 v176, v142, v143
v_cvt_pk_bf16_f32 v177, v144, v145
v_cvt_pk_bf16_f32 v180, v150, 0
v_exp_f32 v146, v146
v_mfma_f32_16x16x32_bf16 v[150:153], v[190:193], v[174:177], 0
v_exp_f32 v147, v147
v_mfma_f32_16x16x32_bf16 v[138:141], v[114:117], v[174:177], 0
s_waitcnt lgkmcnt(0)
v_exp_f32 v148, v148
v_mfma_f32_16x16x32_bf16 v[142:145], v[122:125], v[174:177], 0
s_barrier
ds_read_b128 v[170:173], v210 offset:36864
ds_read_b128 v[182:185], v210 offset:37888
ds_read_b128 v[186:189], v210 offset:38912
v_exp_f32 v149, v149
v_cvt_pk_bf16_f32 v178, v146, v147
v_cvt_pk_bf16_f32 v179, v148, v149
v_mfma_f32_16x16x32_bf16 v[146:149], v[130:133], v[174:177], 0
v_mov_b32_dpp v154, v158 quad_perm:[0,1,2,3] row_mask:0x2 bank_mask:0xf
v_mfma_f32_16x16x32_bf16 v[150:153], v[190:193], v[178:181], v[150:153]
v_mov_b32_dpp v154, v162 quad_perm:[0,1,2,3] row_mask:0x4 bank_mask:0xf
v_mfma_f32_16x16x32_bf16 v[138:141], v[118:121], v[178:181], v[138:141]
v_mov_b32_dpp v154, v167 quad_perm:[0,1,2,3] row_mask:0x8 bank_mask:0xf
v_exp_f32 v154, v154
v_mfma_f32_16x16x32_bf16 v[142:145], v[126:129], v[178:181], v[142:145]
v_cvt_pk_bf16_f32 v154, v154, 0
v_rcp_f32 v151, v150
v_mfma_f32_16x16x32_bf16 v[146:149], v[134:137], v[178:181], v[146:149]
s_waitcnt lgkmcnt(2)
ds_write_b16 v214, v154
v_mfma_f32_16x16x32_bf16 v[0:3], a[144:147], v[170:173], v[0:3]
ds_read_b128 v[84:87], v215
ds_read_b128 v[88:91], v215 offset:16
v_mfma_f32_16x16x32_bf16 v[4:7], a[168:171], v[170:173], v[4:7]
v_mfma_f32_16x16x32_bf16 v[8:11], a[192:195], v[170:173], v[8:11]
ds_read_b128 v[170:173], v210 offset:39936
s_waitcnt lgkmcnt(5)
v_mfma_f32_16x16x32_bf16 v[0:3], a[148:151], v[182:185], v[0:3]
v_mfma_f32_16x16x32_bf16 v[4:7], a[172:175], v[182:185], v[4:7]
v_mfma_f32_16x16x32_bf16 v[8:11], a[196:199], v[182:185], v[8:11]
ds_read_b128 v[182:185], v210 offset:40960
s_waitcnt lgkmcnt(3)
v_mfma_f32_16x16x32_bf16 v[166:169], v[84:87], v[190:193], 0
v_mfma_f32_16x16x32_bf16 v[154:157], v[84:87], v[114:117], 0
v_mfma_f32_16x16x32_bf16 v[158:161], v[84:87], v[122:125], 0
v_mfma_f32_16x16x32_bf16 v[162:165], v[84:87], v[130:133], 0
s_waitcnt lgkmcnt(2)
v_mfma_f32_16x16x32_bf16 v[166:169], v[88:91], v[190:193], v[166:169]
v_mfma_f32_16x16x32_bf16 v[154:157], v[88:91], v[118:121], v[154:157]
v_mfma_f32_16x16x32_bf16 v[158:161], v[88:91], v[126:129], v[158:161]
v_rcp_f32 v167, v166
v_mfma_f32_16x16x32_bf16 v[162:165], v[88:91], v[134:137], v[162:165]
v_max3_u32 v218, v218, v166, v167
v_max3_u32 v218, v218, v150, v151
v_mfma_f32_16x16x32_bf16 v[0:3], a[152:155], v[186:189], v[0:3]
v_mul_f32 v151, s3, v151
v_mul_f32 v138, v138, v151
v_mfma_f32_16x16x32_bf16 v[4:7], a[176:179], v[186:189], v[4:7]
v_mul_f32 v139, v139, v151
v_mul_f32 v140, v140, v151
v_mfma_f32_16x16x32_bf16 v[8:11], a[200:203], v[186:189], v[8:11]
s_waitcnt lgkmcnt(1)
ds_read_b128 v[186:189], v210 offset:41984
v_mul_f32 v141, v141, v151
v_mfma_f32_16x16x32_bf16 v[0:3], a[156:159], v[170:173], v[0:3]
v_cvt_pk_bf16_f32 v138, v138, v139
v_mul_f32 v142, v142, v151
v_mfma_f32_16x16x32_bf16 v[4:7], a[180:183], v[170:173], v[4:7]
v_mul_f32 v143, v143, v151
v_mul_f32 v144, v144, v151
v_mfma_f32_16x16x32_bf16 v[8:11], a[204:207], v[170:173], v[8:11]
s_waitcnt lgkmcnt(1)
ds_read_b128 v[170:173], v210 offset:43008
v_mul_f32 v145, v145, v151
v_mfma_f32_16x16x32_bf16 v[0:3], a[160:163], v[182:185], v[0:3]
v_cvt_pk_bf16_f32 v139, v140, v141
v_cvt_pk_bf16_f32 v140, v142, v143
v_mfma_f32_16x16x32_bf16 v[4:7], a[184:187], v[182:185], v[4:7]
v_cvt_pk_bf16_f32 v141, v144, v145
v_mul_f32 v146, v146, v151
v_mfma_f32_16x16x32_bf16 v[8:11], a[208:211], v[182:185], v[8:11]
s_waitcnt lgkmcnt(1)
ds_read_b128 v[182:185], v210 offset:44032
ds_write_b128 v211, v[138:141] offset:49152
v_mfma_f32_16x16x32_bf16 v[0:3], a[164:167], v[186:189], v[0:3]
v_mul_f32 v147, v147, v151
v_mul_f32 v148, v148, v151
v_mfma_f32_16x16x32_bf16 v[4:7], a[188:191], v[186:189], v[4:7]
v_mul_f32 v149, v149, v151
v_cvt_pk_bf16_f32 v142, v146, v147
v_mfma_f32_16x16x32_bf16 v[8:11], a[212:215], v[186:189], v[8:11]
s_waitcnt lgkmcnt(2)
ds_read_b128 v[186:189], v210 offset:45056
v_cvt_pk_bf16_f32 v143, v148, v149
v_mfma_f32_16x16x32_bf16 v[12:15], a[144:147], v[170:173], v[12:15]
ds_write_b64 v212, v[142:143] offset:49152
v_mfma_f32_16x16x32_bf16 v[16:19], a[168:171], v[170:173], v[16:19]
v_cvt_pk_bf16_f32 v72, v0, v1
v_cvt_pk_bf16_f32 v73, v2, v3
v_mfma_f32_16x16x32_bf16 v[20:23], a[192:195], v[170:173], v[20:23]
s_waitcnt lgkmcnt(3)
ds_read_b128 v[170:173], v210 offset:46080
buffer_store_dwordx2 v[72:73], v203, s[8:11], s38 offen
v_cvt_pk_bf16_f32 v74, v4, v5
v_mfma_f32_16x16x32_bf16 v[12:15], a[148:151], v[182:185], v[12:15]
v_cvt_pk_bf16_f32 v75, v6, v7
v_mov_b32_dpp v154, v158 quad_perm:[0,1,2,3] row_mask:0x2 bank_mask:0xf
v_mfma_f32_16x16x32_bf16 v[16:19], a[172:175], v[182:185], v[16:19]
v_mul_f32 v167, s3, v167
v_mov_b32_dpp v154, v162 quad_perm:[0,1,2,3] row_mask:0x4 bank_mask:0xf
v_mfma_f32_16x16x32_bf16 v[20:23], a[196:199], v[182:185], v[20:23]
s_waitcnt lgkmcnt(2)
ds_read_b128 v[182:185], v210 offset:47104
v_mul_f32 v154, v154, v167
v_mfma_f32_16x16x32_bf16 v[12:15], a[152:155], v[186:189], v[12:15]
v_cvt_pk_bf16_f32 v154, v154, 0
v_cvt_pk_bf16_f32 v76, v8, v9
v_mfma_f32_16x16x32_bf16 v[16:19], a[176:179], v[186:189], v[16:19]
s_waitcnt lgkmcnt(1)
ds_write_b16 v214, v154
v_mfma_f32_16x16x32_bf16 v[20:23], a[200:203], v[186:189], v[20:23]
s_barrier
v_mfma_f32_16x16x32_bf16 v[12:15], a[156:159], v[170:173], v[12:15]
ds_read_b128 v[186:189], v210 offset:48128
v_mfma_f32_16x16x32_bf16 v[16:19], a[180:183], v[170:173], v[16:19]
v_mfma_f32_16x16x32_bf16 v[20:23], a[204:207], v[170:173], v[20:23]
ds_read_b128 v[170:173], v210 offset:49152
s_waitcnt lgkmcnt(3)
v_mfma_f32_16x16x32_bf16 v[12:15], a[160:163], v[182:185], v[12:15]
v_cvt_pk_bf16_f32 v77, v10, v11
v_mfma_f32_16x16x32_bf16 v[16:19], a[184:187], v[182:185], v[16:19]
v_add_u32 v215, 1552, v215
v_mfma_f32_16x16x32_bf16 v[20:23], a[208:211], v[182:185], v[20:23]
ds_read_b128 v[182:185], v210 offset:50176
buffer_store_dwordx2 v[74:75], v203, s[8:11], s38 offen offset:32
s_waitcnt lgkmcnt(2)
v_mfma_f32_16x16x32_bf16 v[12:15], a[164:167], v[186:189], v[12:15]
v_mfma_f32_16x16x32_bf16 v[16:19], a[188:191], v[186:189], v[16:19]
v_mfma_f32_16x16x32_bf16 v[20:23], a[212:215], v[186:189], v[20:23]
s_waitcnt lgkmcnt(1)
ds_read_b128 v[186:189], v210 offset:51200
v_cvt_pk_bf16_f32 v78, v12, v13
v_cvt_pk_bf16_f32 v79, v14, v15
v_mfma_f32_16x16x32_bf16 v[24:27], a[144:147], v[170:173], v[24:27]
v_cvt_pk_bf16_f32 v80, v16, v17
v_cvt_pk_bf16_f32 v81, v18, v19
v_mfma_f32_16x16x32_bf16 v[28:31], a[168:171], v[170:173], v[28:31]
v_cvt_pk_bf16_f32 v82, v20, v21
v_cvt_pk_bf16_f32 v83, v22, v23
v_mfma_f32_16x16x32_bf16 v[32:35], a[192:195], v[170:173], v[32:35]
ds_read_b128 v[170:173], v210 offset:52224
s_waitcnt lgkmcnt(2)
v_mfma_f32_16x16x32_bf16 v[24:27], a[148:151], v[182:185], v[24:27]
v_mfma_f32_16x16x32_bf16 v[28:31], a[172:175], v[182:185], v[28:31]
v_mfma_f32_16x16x32_bf16 v[32:35], a[196:199], v[182:185], v[32:35]
ds_read_b128 v[182:185], v210 offset:53248
s_waitcnt lgkmcnt(2)
v_mfma_f32_16x16x32_bf16 v[24:27], a[152:155], v[186:189], v[24:27]
v_mfma_f32_16x16x32_bf16 v[28:31], a[176:179], v[186:189], v[28:31]
v_mfma_f32_16x16x32_bf16 v[32:35], a[200:203], v[186:189], v[32:35]
ds_read_b128 v[186:189], v210 offset:54272
s_waitcnt lgkmcnt(2)
v_mfma_f32_16x16x32_bf16 v[24:27], a[156:159], v[170:173], v[24:27]
buffer_store_dwordx2 v[76:77], v203, s[8:11], s38 offen offset:64
v_mfma_f32_16x16x32_bf16 v[28:31], a[180:183], v[170:173], v[28:31]
v_mfma_f32_16x16x32_bf16 v[32:35], a[204:207], v[170:173], v[32:35]
s_waitcnt lgkmcnt(1)
v_mfma_f32_16x16x32_bf16 v[24:27], a[160:163], v[182:185], v[24:27]
v_mfma_f32_16x16x32_bf16 v[28:31], a[184:187], v[182:185], v[28:31]
v_mfma_f32_16x16x32_bf16 v[32:35], a[208:211], v[182:185], v[32:35]
s_waitcnt lgkmcnt(0)
v_mfma_f32_16x16x32_bf16 v[24:27], a[164:167], v[186:189], v[24:27]
v_mfma_f32_16x16x32_bf16 v[28:31], a[188:191], v[186:189], v[28:31]
s_nop 3
v_cvt_pk_bf16_f32 v116, v24, v25
v_cvt_pk_bf16_f32 v117, v26, v27
v_mfma_f32_16x16x32_bf16 v[32:35], a[212:215], v[186:189], v[32:35]
v_cvt_pk_bf16_f32 v124, v28, v29
v_cvt_pk_bf16_f32 v125, v30, v31
s_nop 4
v_cvt_pk_bf16_f32 v132, v32, v33
v_cvt_pk_bf16_f32 v133, v34, v35
buffer_store_dwordx2 v[78:79], v204, s[8:11], s38 offen
buffer_store_dwordx2 v[80:81], v204, s[8:11], s38 offen offset:32
buffer_store_dwordx2 v[82:83], v204, s[8:11], s38 offen offset:64
v_add_u32 v214, 1552, v214
buffer_store_dwordx2 v[116:117], v205, s[8:11], s38 offen
buffer_store_dwordx2 v[124:125], v205, s[8:11], s38 offen offset:32
buffer_store_dwordx2 v[132:133], v205, s[8:11], s38 offen offset:64
L_epi:
s_nop 7
v_subrev_u32 v40, 37120, v210
v_cmp_lt_u32 vcc, 1602224128, v218
v_mov_b32 v41, 162624
v_mov_b32 v42, 1
s_cbranch_vccz L_noflag
ds_write_b32 v41, v42
L_noflag:
s_waitcnt lgkmcnt(0)
s_barrier
ds_read_b32 v42, v41
v_lshrrev_b32 v43, 4, v40
v_and_b32 v43, 15, v43
v_lshrrev_b32 v44, 8, v40
v_mul_u32_u24 v45, 1552, v43
v_lshl_add_u32 v45, v44, 5, v45
v_add_u32 v45, 94464, v45
v_mul_u32_u24 v50, 784, v43
v_lshl_add_u32 v50, v44, 4, v50
s_mul_i32 s41, s32, 192
s_add_u32 s41, s41, 127056
v_add_u32 v50, s41, v50
ds_read_b128 v[148:151], v50
ds_read_b128 v[152:155], v50 offset:64
ds_read_b128 v[156:159], v50 offset:128
ds_read_b128 v[160:163], v50 offset:12544
ds_read_b128 v[164:167], v50 offset:12608
s_waitcnt lgkmcnt(5)
ds_read_b128 v[168:171], v50 offset:12672
v_readfirstlane_b32 s43, v42
s_nop 0
s_cmp_lg_u32 s43, 0
s_cbranch_scc1 L_redo
ds_read_b128 v[100:103], v45
ds_read_b128 v[104:107], v45 offset:128
ds_read_b128 v[108:111], v45 offset:256
ds_read_b128 v[112:115], v45 offset:384
ds_read_b64 v[116:117], v45 offset:16
ds_read_b64 v[118:119], v45 offset:144
ds_read_b64 v[120:121], v45 offset:272
ds_read_b64 v[122:123], v45 offset:400
v_lshlrev_b32 v48, 5, v43
s_add_u32 s41, s33, 0
v_add_u32 v48, s41, v48
s_mov_b32 s42, 58835169
v_mul_hi_u32 v49, v48, s42
v_mul_u32_u24 v46, 73, v49
v_sub_u32 v46, v48, v46
v_mul_u32_u24 v46, 2688, v46
s_mov_b32 s42, 1373568
v_mul_lo_u32 v49, v49, s42
s_mul_i32 s42, s32, 96
v_add3_u32 v46, v46, v49, s42
v_cmp_gt_u32 vcc, s34, v48
v_mov_b32 v49, 1879048192
s_nop 0
v_cndmask_b32 v46, v49, v46, vcc
v_lshl_add_u32 v46, v44, 3, v46
v_add_u32 v46, 785664, v46
ds_read_b128 v[124:127], v45 offset:24832
ds_read_b128 v[128:131], v45 offset:24960
ds_read_b128 v[132:135], v45 offset:25088
ds_read_b128 v[136:139], v45 offset:25216
ds_read_b64 v[140:141], v45 offset:24848
ds_read_b64 v[142:143], v45 offset:24976
ds_read_b64 v[144:145], v45 offset:25104
s_waitcnt lgkmcnt(14)
ds_read_b64 v[146:147], v45 offset:25232
v_lshlrev_b32 v48, 5, v43
s_add_u32 s41, s33, 512
v_add_u32 v48, s41, v48
s_mov_b32 s42, 58835169
v_mul_hi_u32 v49, v48, s42
v_mul_u32_u24 v47, 73, v49
v_sub_u32 v47, v48, v47
v_mul_u32_u24 v47, 2688, v47
s_mov_b32 s42, 1373568
v_mul_lo_u32 v49, v49, s42
s_mul_i32 s42, s32, 96
v_add3_u32 v47, v47, v49, s42
v_cmp_gt_u32 vcc, s34, v48
v_mov_b32 v49, 1879048192
s_nop 0
v_cndmask_b32 v47, v49, v47, vcc
v_lshl_add_u32 v47, v44, 3, v47
v_add_u32 v47, 785664, v47
v_mfma_f32_16x16x32_bf16 v[148:151], a[144:147], v[100:103], v[148:151]
v_mfma_f32_16x16x32_bf16 v[152:155], a[168:171], v[100:103], v[152:155]
v_mfma_f32_16x16x32_bf16 v[156:159], a[192:195], v[100:103], v[156:159]
s_waitcnt lgkmcnt(14)
v_mfma_f32_16x16x32_bf16 v[148:151], a[148:151], v[104:107], v[148:151]
v_mfma_f32_16x16x32_bf16 v[152:155], a[172:175], v[104:107], v[152:155]
v_mfma_f32_16x16x32_bf16 v[156:159], a[196:199], v[104:107], v[156:159]
s_waitcnt lgkmcnt(13)
v_mfma_f32_16x16x32_bf16 v[148:151], a[152:155], v[108:111], v[148:151]
v_mfma_f32_16x16x32_bf16 v[152:155], a[176:179], v[108:111], v[152:155]
v_mfma_f32_16x16x32_bf16 v[156:159], a[200:203], v[108:111], v[156:159]
s_waitcnt lgkmcnt(12)
v_mfma_f32_16x16x32_bf16 v[148:151], a[156:159], v[112:115], v[148:151]
v_mfma_f32_16x16x32_bf16 v[152:155], a[180:183], v[112:115], v[152:155]
v_mfma_f32_16x16x32_bf16 v[156:159], a[204:207], v[112:115], v[156:159]
s_waitcnt lgkmcnt(10)
v_mfma_f32_16x16x32_bf16 v[148:151], a[160:163], v[116:119], v[148:151]
v_mfma_f32_16x16x32_bf16 v[152:155], a[184:187], v[116:119], v[152:155]
v_mfma_f32_16x16x32_bf16 v[156:159], a[208:211], v[116:119], v[156:159]
s_waitcnt lgkmcnt(8)
v_mfma_f32_16x16x32_bf16 v[148:151], a[164:167], v[120:123], v[148:151]
v_mfma_f32_16x16x32_bf16 v[152:155], a[188:191], v[120:123], v[152:155]
v_mfma_f32_16x16x32_bf16 v[156:159], a[212:215], v[120:123], v[156:159]
s_waitcnt lgkmcnt(7)
v_mfma_f32_16x16x32_bf16 v[160:163], a[144:147], v[124:127], v[160:163]
v_mfma_f32_16x16x32_bf16 v[164:167], a[168:171], v[124:127], v[164:167]
v_mfma_f32_16x16x32_bf16 v[168:171], a[192:195], v[124:127], v[168:171]
s_waitcnt lgkmcnt(6)
v_mfma_f32_16x16x32_bf16 v[160:163], a[148:151], v[128:131], v[160:163]
v_mfma_f32_16x16x32_bf16 v[164:167], a[172:175], v[128:131], v[164:167]
v_mfma_f32_16x16x32_bf16 v[168:171], a[196:199], v[128:131], v[168:171]
s_waitcnt lgkmcnt(5)
v_mfma_f32_16x16x32_bf16 v[160:163], a[152:155], v[132:135], v[160:163]
v_mfma_f32_16x16x32_bf16 v[164:167], a[176:179], v[132:135], v[164:167]
v_mfma_f32_16x16x32_bf16 v[168:171], a[200:203], v[132:135], v[168:171]
s_waitcnt lgkmcnt(4)
v_mfma_f32_16x16x32_bf16 v[160:163], a[156:159], v[136:139], v[160:163]
v_mfma_f32_16x16x32_bf16 v[164:167], a[180:183], v[136:139], v[164:167]
v_mfma_f32_16x16x32_bf16 v[168:171], a[204:207], v[136:139], v[168:171]
s_waitcnt lgkmcnt(2)
v_mfma_f32_16x16x32_bf16 v[160:163], a[160:163], v[140:143], v[160:163]
v_mfma_f32_16x16x32_bf16 v[164:167], a[184:187], v[140:143], v[164:167]
v_mfma_f32_16x16x32_bf16 v[168:171], a[208:211], v[140:143], v[168:171]
s_waitcnt lgkmcnt(0)
v_mfma_f32_16x16x32_bf16 v[160:163], a[164:167], v[144:147], v[160:163]
v_mfma_f32_16x16x32_bf16 v[164:167], a[188:191], v[144:147], v[164:167]
v_mfma_f32_16x16x32_bf16 v[168:171], a[212:215], v[144:147], v[168:171]
v_cvt_pk_bf16_f32 v148, v148, v149
v_cvt_pk_bf16_f32 v149, v150, v151
buffer_store_dwordx2 v[148:149], v46, s[8:11], 0 offen
v_cvt_pk_bf16_f32 v152, v152, v153
v_cvt_pk_bf16_f32 v153, v154, v155
buffer_store_dwordx2 v[152:153], v46, s[8:11], 0 offen offset:32
v_cvt_pk_bf16_f32 v156, v156, v157
v_cvt_pk_bf16_f32 v157, v158, v159
buffer_store_dwordx2 v[156:157], v46, s[8:11], 0 offen offset:64
v_cvt_pk_bf16_f32 v160, v160, v161
v_cvt_pk_bf16_f32 v161, v162, v163
buffer_store_dwordx2 v[160:161], v47, s[8:11], 0 offen
v_cvt_pk_bf16_f32 v164, v164, v165
v_cvt_pk_bf16_f32 v165, v166, v167
buffer_store_dwordx2 v[164:165], v47, s[8:11], 0 offen offset:32
v_cvt_pk_bf16_f32 v168, v168, v169
v_cvt_pk_bf16_f32 v169, v170, v171
buffer_store_dwordx2 v[168:169], v47, s[8:11], 0 offen offset:64
L_end:
s_endpgm
L_redo:
s_mov_b32 s47, 1
s_waitcnt vmcnt(0) lgkmcnt(0)
s_barrier
s_branch L_start
L_safe:
s_barrier
s_mov_b32 s38, s36
ds_read_b128 v[174:177], v217
ds_read_b128 v[84:87], v200
s_waitcnt lgkmcnt(0)
v_mfma_f32_16x16x32_bf16 v[36:39], v[174:177], v[84:87], 0
ds_read_b128 v[92:95], v201
s_waitcnt lgkmcnt(0)
v_mfma_f32_16x16x32_bf16 v[48:51], v[174:177], v[92:95], 0
ds_read_b128 v[100:103], v202
s_waitcnt lgkmcnt(0)
v_mfma_f32_16x16x32_bf16 v[60:63], v[174:177], v[100:103], 0
ds_read_b128 v[178:181], v217 offset:528
ds_read_b128 v[84:87], v194
ds_read_b128 v[88:91], v194 offset:16
s_waitcnt lgkmcnt(0)
v_smfmac_f32_16x16x64_bf16 v[36:39], v[178:181], v[84:91], v213
ds_read_b128 v[92:95], v195
ds_read_b128 v[96:99], v195 offset:16
s_waitcnt lgkmcnt(0)
v_smfmac_f32_16x16x64_bf16 v[48:51], v[178:181], v[92:99], v213
ds_read_b128 v[100:103], v196
ds_read_b128 v[104:107], v196 offset:16
s_waitcnt lgkmcnt(0)
v_smfmac_f32_16x16x64_bf16 v[60:63], v[178:181], v[100:107], v213
ds_read_b128 v[174:177], v217 offset:1056
ds_read_b128 v[84:87], v197
ds_read_b128 v[88:91], v197 offset:16
s_waitcnt lgkmcnt(0)
v_smfmac_f32_16x16x64_bf16 v[36:39], v[174:177], v[84:91], v213
ds_read_b128 v[92:95], v198
ds_read_b128 v[96:99], v198 offset:16
s_waitcnt lgkmcnt(0)
v_smfmac_f32_16x16x64_bf16 v[48:51], v[174:177], v[92:99], v213
ds_read_b128 v[100:103], v199
ds_read_b128 v[104:107], v199 offset:16
s_waitcnt lgkmcnt(0)
v_smfmac_f32_16x16x64_bf16 v[60:63], v[174:177], v[100:107], v213
ds_read_b128 v[178:181], v217 offset:1584
ds_read_b128 v[84:87], v200 offset:32
s_waitcnt lgkmcnt(0)
v_mfma_f32_16x16x32_bf16 v[40:43], v[178:181], v[84:87], 0
ds_read_b128 v[92:95], v201 offset:32
s_waitcnt lgkmcnt(0)
v_mfma_f32_16x16x32_bf16 v[52:55], v[178:181], v[92:95], 0
ds_read_b128 v[100:103], v202 offset:32
s_waitcnt lgkmcnt(0)
v_mfma_f32_16x16x32_bf16 v[64:67], v[178:181], v[100:103], 0
ds_read_b128 v[174:177], v217 offset:2112
ds_read_b128 v[84:87], v194 offset:32
ds_read_b128 v[88:91], v194 offset:48
s_waitcnt lgkmcnt(0)
v_smfmac_f32_16x16x64_bf16 v[40:43], v[174:177], v[84:91], v213
ds_read_b128 v[92:95], v195 offset:32
ds_read_b128 v[96:99], v195 offset:48
s_waitcnt lgkmcnt(0)
v_smfmac_f32_16x16x64_bf16 v[52:55], v[174:177], v[92:99], v213
ds_read_b128 v[100:103], v196 offset:32
ds_read_b128 v[104:107], v196 offset:48
s_waitcnt lgkmcnt(0)
v_smfmac_f32_16x16x64_bf16 v[64:67], v[174:177], v[100:107], v213
ds_read_b128 v[178:181], v217 offset:2640
ds_read_b128 v[84:87], v197 offset:32
ds_read_b128 v[88:91], v197 offset:48
s_waitcnt lgkmcnt(0)
v_smfmac_f32_16x16x64_bf16 v[40:43], v[178:181], v[84:91], v213
ds_read_b128 v[92:95], v198 offset:32
ds_read_b128 v[96:99], v198 offset:48
s_waitcnt lgkmcnt(0)
v_smfmac_f32_16x16x64_bf16 v[52:55], v[178:181], v[92:99], v213
ds_read_b128 v[100:103], v199 offset:32
ds_read_b128 v[104:107], v199 offset:48
s_waitcnt lgkmcnt(0)
v_smfmac_f32_16x16x64_bf16 v[64:67], v[178:181], v[100:107], v213
ds_read_b128 v[174:177], v217 offset:3168
ds_read_b128 v[84:87], v200 offset:64
s_waitcnt lgkmcnt(0)
v_mfma_f32_16x16x32_bf16 v[44:47], v[174:177], v[84:87], 0
ds_read_b128 v[92:95], v201 offset:64
s_waitcnt lgkmcnt(0)
v_mfma_f32_16x16x32_bf16 v[56:59], v[174:177], v[92:95], 0
ds_read_b128 v[100:103], v202 offset:64
s_waitcnt lgkmcnt(0)
v_mfma_f32_16x16x32_bf16 v[68:71], v[174:177], v[100:103], 0
ds_read_b128 v[178:181], v217 offset:3696
ds_read_b128 v[84:87], v194 offset:64
ds_read_b128 v[88:91], v194 offset:80
s_waitcnt lgkmcnt(0)
v_smfmac_f32_16x16x64_bf16 v[44:47], v[178:181], v[84:91], v213
ds_read_b128 v[92:95], v195 offset:64
ds_read_b128 v[96:99], v195 offset:80
s_waitcnt lgkmcnt(0)
v_smfmac_f32_16x16x64_bf16 v[56:59], v[178:181], v[92:99], v213
ds_read_b128 v[100:103], v196 offset:64
ds_read_b128 v[104:107], v196 offset:80
s_waitcnt lgkmcnt(0)
v_smfmac_f32_16x16x64_bf16 v[68:71], v[178:181], v[100:107], v213
ds_read_b128 v[174:177], v217 offset:4224
ds_read_b128 v[84:87], v197 offset:64
ds_read_b128 v[88:91], v197 offset:80
s_waitcnt lgkmcnt(0)
v_smfmac_f32_16x16x64_bf16 v[44:47], v[174:177], v[84:91], v213
ds_read_b128 v[92:95], v198 offset:64
ds_read_b128 v[96:99], v198 offset:80
s_waitcnt lgkmcnt(0)
v_smfmac_f32_16x16x64_bf16 v[56:59], v[174:177], v[92:99], v213
ds_read_b128 v[100:103], v199 offset:64
ds_read_b128 v[104:107], v199 offset:80
s_waitcnt lgkmcnt(0)
v_smfmac_f32_16x16x64_bf16 v[68:71], v[174:177], v[100:107], v213
v_add_f32 v118, v36, v37
v_mul_f32 v119, v36, v36
v_add_f32 v118, v118, v38
v_fmac_f32 v119, v37, v37
v_add_f32 v118, v118, v39
v_fmac_f32 v119, v38, v38
v_fmac_f32 v119, v39, v39
v_add_f32 v126, v48, v49
v_mul_f32 v127, v48, v48
v_add_f32 v126, v126, v50
v_fmac_f32 v127, v49, v49
v_add_f32 v126, v126, v51
v_fmac_f32 v127, v50, v50
v_fmac_f32 v127, v51, v51
v_add_f32 v134, v60, v61
v_mul_f32 v135, v60, v60
v_add_f32 v134, v134, v62
v_fmac_f32 v135, v61, v61
v_add_f32 v134, v134, v63
v_fmac_f32 v135, v62, v62
v_fmac_f32 v135, v63, v63
v_add_f32 v118, v118, v40
v_fmac_f32 v119, v40, v40
v_add_f32 v118, v118, v41
v_fmac_f32 v119, v41, v41
v_add_f32 v118, v118, v42
v_fmac_f32 v119, v42, v42
v_add_f32 v118, v118, v43
v_fmac_f32 v119, v43, v43
v_add_f32 v126, v126, v52
v_fmac_f32 v127, v52, v52
v_add_f32 v126, v126, v53
v_fmac_f32 v127, v53, v53
v_add_f32 v126, v126, v54
v_fmac_f32 v127, v54, v54
v_add_f32 v126, v126, v55
v_fmac_f32 v127, v55, v55
v_add_f32 v134, v134, v64
v_fmac_f32 v135, v64, v64
v_add_f32 v134, v134, v65
v_fmac_f32 v135, v65, v65
v_add_f32 v134, v134, v66
v_fmac_f32 v135, v66, v66
v_add_f32 v134, v134, v67
v_fmac_f32 v135, v67, v67
v_add_f32 v118, v118, v44
v_fmac_f32 v119, v44, v44
v_add_f32 v118, v118, v45
v_fmac_f32 v119, v45, v45
v_add_f32 v118, v118, v46
v_fmac_f32 v119, v46, v46
v_add_f32 v118, v118, v47
v_fmac_f32 v119, v47, v47
v_add_f32 v126, v126, v56
v_fmac_f32 v127, v56, v56
v_add_f32 v126, v126, v57
v_fmac_f32 v127, v57, v57
v_add_f32 v126, v126, v58
v_fmac_f32 v127, v58, v58
v_add_f32 v126, v126, v59
v_fmac_f32 v127, v59, v59
v_add_f32 v134, v134, v68
v_fmac_f32 v135, v68, v68
v_add_f32 v134, v134, v69
v_fmac_f32 v135, v69, v69
v_add_f32 v134, v134, v70
v_fmac_f32 v135, v70, v70
v_add_f32 v134, v134, v71
v_fmac_f32 v135, v71, v71
v_permlane16_swap_b32 v118, v119
v_add_f32 v118, v118, v119
v_permlane16_swap_b32 v126, v127
v_add_f32 v126, v126, v127
v_permlane16_swap_b32 v134, v135
v_add_f32 v134, v134, v135
v_permlane32_swap_b32 v118, v126
v_add_f32 v118, v118, v126
ds_write_b32 v209, v118
v_mov_b32 v135, v134
s_nop 1
v_permlane32_swap_b32 v134, v135
v_add_f32 v134, v134, v135
ds_write_b32 v209, v134 offset:512
s_waitcnt lgkmcnt(0)
s_barrier
s_mov_b32 s36, s50
v_and_b32 v180, s44, v208
s_add_u32 m0, s45, 0
s_nop 0
buffer_load_dwordx4 v180, s[4:7], s52 offen nt lds
s_add_u32 m0, s45, 4112
s_add_u32 s40, s36, 196224
buffer_load_dwordx4 v180, s[4:7], s40 offen nt lds
s_add_u32 m0, s45, 8224
s_add_u32 s40, s36, 392448
buffer_load_dwordx4 v180, s[4:7], s40 offen nt lds
s_add_u32 m0, s45, 12336
s_add_u32 s40, s36, 588672
buffer_load_dwordx4 v180, s[4:7], s40 offen nt lds
s_add_u32 m0, s45, 16448
s_add_u32 s40, s36, 784896
buffer_load_dwordx4 v180, s[4:7], s40 offen nt lds
s_add_u32 m0, s45, 20560
s_add_u32 s40, s36, 981120
buffer_load_dwordx4 v180, s[4:7], s40 offen nt lds
s_add_u32 m0, s45, 24672
s_add_u32 s40, s36, 1177344
buffer_load_dwordx4 v180, s[4:7], s40 offen nt lds
s_add_u32 m0, s45, 28784
s_add_u32 s40, s36, 1373568
buffer_load_dwordx4 v180, s[4:7], s40 offen nt lds
s_add_u32 m0, s45, 32896
s_add_u32 s40, s36, 1569792
buffer_load_dwordx4 v180, s[4:7], s40 offen nt lds
s_mul_hi_u32 s41, s35, 58835169
s_mul_i32 s42, s41, 73
s_sub_u32 s42, s35, s42
s_mul_i32 s43, s41, 1373568
s_mul_i32 s51, s42, 2688
s_add_u32 s43, s43, s51
s_cmp_lt_u32 s35, s34
s_cselect_b32 s50, s43, 1879048192
s_add_u32 s35, s35, 32
s_cmp_eq_u32 s42, 0
s_cselect_b32 s44, 536870911, s72
s_cmp_eq_u32 s42, 72
s_cselect_b32 s44, 939524095, s44
s_cmp_eq_u32 s41, 0
s_cselect_b32 s52, 1879048192, s50
ds_read_b128 v[102:105], v210 offset:55296
ds_read_b128 v[106:109], v210 offset:56320
s_waitcnt lgkmcnt(1)
v_add_f32 v102, v102, v103
s_waitcnt lgkmcnt(0)
v_add_f32 v106, v106, v107
v_add_f32 v104, v104, v105
v_add_f32 v108, v108, v109
v_add_f32 v102, v102, v104
v_add_f32 v106, v106, v108
v_mul_f32 v103, s48, v102
v_mul_f32 v104, s73, v102
v_mul_f32 v106, s73, v106
v_fma_f32 v106, -v103, v104, v106
v_max_f32 v106, 0, v106
v_add_f32 v106, s49, v106
v_rsq_f32 v102, v106
s_nop 0
v_mul_f32_e64 v103, -v103, v102
ds_write_b64 v211, v[102:103] offset:36864
ds_read_b64 v[118:119], v219
ds_read_b64 v[126:127], v219 offset:256
ds_read_b64 v[134:135], v219 offset:512
s_waitcnt lgkmcnt(2)
v_fma_f32 v220, v36, v118, v119
v_fma_f32 v221, v37, v118, v119
v_cvt_pk_bf16_f32 v90, v220, v221
v_fma_f32 v222, v38, v118, v119
v_fma_f32 v223, v39, v118, v119
v_cvt_pk_bf16_f32 v91, v222, v223
v_fma_f32 v220, v40, v118, v119
v_fma_f32 v221, v41, v118, v119
v_cvt_pk_bf16_f32 v92, v220, v221
v_fma_f32 v222, v42, v118, v119
v_fma_f32 v223, v43, v118, v119
v_cvt_pk_bf16_f32 v93, v222, v223
ds_write_b128 v211, v[90:93] offset:18432
v_fma_f32 v220, v44, v118, v119
v_fma_f32 v221, v45, v118, v119
v_cvt_pk_bf16_f32 v94, v220, v221
v_fma_f32 v222, v46, v118, v119
v_fma_f32 v223, v47, v118, v119
v_cvt_pk_bf16_f32 v95, v222, v223
s_waitcnt lgkmcnt(2)
ds_write_b64 v212, v[94:95] offset:18432
v_fma_f32 v220, v48, v126, v127
v_fma_f32 v221, v49, v126, v127
v_cvt_pk_bf16_f32 v174, v220, v221
v_fma_f32 v222, v50, v126, v127
v_fma_f32 v223, v51, v126, v127
v_cvt_pk_bf16_f32 v175, v222, v223
v_fma_f32 v220, v52, v126, v127
v_fma_f32 v221, v53, v126, v127
v_cvt_pk_bf16_f32 v176, v220, v221
v_fma_f32 v222, v54, v126, v127
v_fma_f32 v223, v55, v126, v127
v_cvt_pk_bf16_f32 v177, v222, v223
ds_write_b128 v211, v[174:177] offset:24576
v_fma_f32 v220, v56, v126, v127
v_fma_f32 v221, v57, v126, v127
v_cvt_pk_bf16_f32 v178, v220, v221
v_fma_f32 v222, v58, v126, v127
v_fma_f32 v223, v59, v126, v127
v_cvt_pk_bf16_f32 v179, v222, v223
s_waitcnt lgkmcnt(3)
ds_write_b64 v212, v[178:179] offset:24576
v_fma_f32 v220, v60, v134, v135
v_fma_f32 v221, v61, v134, v135
v_cvt_pk_bf16_f32 v90, v220, v221
v_fma_f32 v222, v62, v134, v135
v_fma_f32 v223, v63, v134, v135
v_cvt_pk_bf16_f32 v91, v222, v223
v_fma_f32 v220, v64, v134, v135
v_fma_f32 v221, v65, v134, v135
v_cvt_pk_bf16_f32 v92, v220, v221
v_fma_f32 v222, v66, v134, v135
v_fma_f32 v223, v67, v134, v135
v_cvt_pk_bf16_f32 v93, v222, v223
ds_write_b128 v211, v[90:93] offset:30720
v_fma_f32 v220, v68, v134, v135
v_fma_f32 v221, v69, v134, v135
v_cvt_pk_bf16_f32 v94, v220, v221
v_fma_f32 v222, v70, v134, v135
v_fma_f32 v223, v71, v134, v135
v_cvt_pk_bf16_f32 v95, v222, v223
ds_write_b64 v212, v[94:95] offset:30720
ds_read_b128 v[182:185], v210
s_waitcnt lgkmcnt(0)
v_mfma_f32_16x16x32_bf16 v[138:141], a[0:3], v[182:185], 0
v_mfma_f32_16x16x32_bf16 v[142:145], a[24:27], v[182:185], 0
v_mfma_f32_16x16x32_bf16 v[146:149], a[48:51], v[182:185], 0
v_mfma_f32_16x16x32_bf16 v[150:153], a[216:219], v[182:185], 0
v_mfma_f32_16x16x32_bf16 v[154:157], a[240:243], v[182:185], 0
v_mfma_f32_16x16x32_bf16 v[158:161], v[232:235], v[182:185], 0
v_mfma_f32_16x16x32_bf16 v[162:165], v[182:185], a[72:75], 0
v_mfma_f32_16x16x32_bf16 v[166:169], v[182:185], a[96:99], 0
v_mfma_f32_16x16x32_bf16 v[170:173], v[182:185], a[120:123], 0
ds_read_b128 v[186:189], v210 offset:1024
s_waitcnt lgkmcnt(0)
v_mfma_f32_16x16x32_bf16 v[138:141], a[4:7], v[186:189], v[138:141]
v_mfma_f32_16x16x32_bf16 v[142:145], a[28:31], v[186:189], v[142:145]
v_mfma_f32_16x16x32_bf16 v[146:149], a[52:55], v[186:189], v[146:149]
v_mfma_f32_16x16x32_bf16 v[150:153], a[220:223], v[186:189], v[150:153]
v_mfma_f32_16x16x32_bf16 v[154:157], a[244:247], v[186:189], v[154:157]
v_mfma_f32_16x16x32_bf16 v[158:161], v[236:239], v[186:189], v[158:161]
v_mfma_f32_16x16x32_bf16 v[162:165], v[186:189], a[76:79], v[162:165]
v_mfma_f32_16x16x32_bf16 v[166:169], v[186:189], a[100:103], v[166:169]
v_mfma_f32_16x16x32_bf16 v[170:173], v[186:189], a[124:127], v[170:173]
ds_read_b128 v[182:185], v210 offset:2048
s_waitcnt lgkmcnt(0)
v_mfma_f32_16x16x32_bf16 v[138:141], a[8:11], v[182:185], v[138:141]
v_mfma_f32_16x16x32_bf16 v[142:145], a[32:35], v[182:185], v[142:145]
v_mfma_f32_16x16x32_bf16 v[146:149], a[56:59], v[182:185], v[146:149]
v_mfma_f32_16x16x32_bf16 v[150:153], a[224:227], v[182:185], v[150:153]
v_mfma_f32_16x16x32_bf16 v[154:157], a[248:251], v[182:185], v[154:157]
v_mfma_f32_16x16x32_bf16 v[158:161], v[240:243], v[182:185], v[158:161]
v_mfma_f32_16x16x32_bf16 v[162:165], v[182:185], a[80:83], v[162:165]
v_mfma_f32_16x16x32_bf16 v[166:169], v[182:185], a[104:107], v[166:169]
v_mfma_f32_16x16x32_bf16 v[170:173], v[182:185], a[128:131], v[170:173]
ds_read_b128 v[186:189], v210 offset:3072
s_waitcnt lgkmcnt(0)
v_mfma_f32_16x16x32_bf16 v[138:141], a[12:15], v[186:189], v[138:141]
v_mfma_f32_16x16x32_bf16 v[142:145], a[36:39], v[186:189], v[142:145]
v_mfma_f32_16x16x32_bf16 v[146:149], a[60:63], v[186:189], v[146:149]
v_mfma_f32_16x16x32_bf16 v[150:153], a[228:231], v[186:189], v[150:153]
v_mfma_f32_16x16x32_bf16 v[154:157], a[252:255], v[186:189], v[154:157]
v_mfma_f32_16x16x32_bf16 v[158:161], v[244:247], v[186:189], v[158:161]
v_mfma_f32_16x16x32_bf16 v[162:165], v[186:189], a[84:87], v[162:165]
v_mfma_f32_16x16x32_bf16 v[166:169], v[186:189], a[108:111], v[166:169]
v_mfma_f32_16x16x32_bf16 v[170:173], v[186:189], a[132:135], v[170:173]
ds_read_b128 v[182:185], v210 offset:4096
s_waitcnt lgkmcnt(0)
v_mfma_f32_16x16x32_bf16 v[138:141], a[16:19], v[182:185], v[138:141]
v_mfma_f32_16x16x32_bf16 v[142:145], a[40:43], v[182:185], v[142:145]
v_mfma_f32_16x16x32_bf16 v[146:149], a[64:67], v[182:185], v[146:149]
v_mfma_f32_16x16x32_bf16 v[150:153], a[232:235], v[182:185], v[150:153]
v_mfma_f32_16x16x32_bf16 v[154:157], v[224:227], v[182:185], v[154:157]
v_mfma_f32_16x16x32_bf16 v[158:161], v[248:251], v[182:185], v[158:161]
v_mfma_f32_16x16x32_bf16 v[162:165], v[182:185], a[88:91], v[162:165]
v_mfma_f32_16x16x32_bf16 v[166:169], v[182:185], a[112:115], v[166:169]
v_mfma_f32_16x16x32_bf16 v[170:173], v[182:185], a[136:139], v[170:173]
ds_read_b128 v[186:189], v210 offset:5120
s_waitcnt lgkmcnt(0)
v_mfma_f32_16x16x32_bf16 v[138:141], a[20:23], v[186:189], v[138:141]
v_mfma_f32_16x16x32_bf16 v[142:145], a[44:47], v[186:189], v[142:145]
v_mfma_f32_16x16x32_bf16 v[146:149], a[68:71], v[186:189], v[146:149]
v_mfma_f32_16x16x32_bf16 v[150:153], a[236:239], v[186:189], v[150:153]
v_mfma_f32_16x16x32_bf16 v[154:157], v[228:231], v[186:189], v[154:157]
v_mfma_f32_16x16x32_bf16 v[158:161], v[252:255], v[186:189], v[158:161]
v_mfma_f32_16x16x32_bf16 v[162:165], v[186:189], a[92:95], v[162:165]
v_mfma_f32_16x16x32_bf16 v[166:169], v[186:189], a[116:119], v[166:169]
v_mfma_f32_16x16x32_bf16 v[170:173], v[186:189], a[140:143], v[170:173]
v_cvt_pk_bf16_f32 v78, v138, v139
v_cvt_pk_bf16_f32 v79, v140, v141
v_cvt_pk_bf16_f32 v80, v142, v143
v_cvt_pk_bf16_f32 v81, v144, v145
v_cvt_pk_bf16_f32 v82, v146, v147
v_cvt_pk_bf16_f32 v83, v148, v149
v_cvt_pk_bf16_f32 v72, v150, v151
v_cvt_pk_bf16_f32 v73, v152, v153
v_cvt_pk_bf16_f32 v74, v154, v155
v_cvt_pk_bf16_f32 v75, v156, v157
v_cvt_pk_bf16_f32 v76, v158, v159
v_cvt_pk_bf16_f32 v77, v160, v161
v_cvt_pk_bf16_f32 v114, v162, v163
v_cvt_pk_bf16_f32 v115, v164, v165
v_cvt_pk_bf16_f32 v122, v166, v167
v_cvt_pk_bf16_f32 v123, v168, v169
v_cvt_pk_bf16_f32 v130, v170, v171
v_cvt_pk_bf16_f32 v131, v172, v173
ds_read_b128 v[182:185], v210 offset:6144
s_waitcnt lgkmcnt(0)
v_mfma_f32_16x16x32_bf16 v[138:141], a[0:3], v[182:185], 0
v_mfma_f32_16x16x32_bf16 v[142:145], a[24:27], v[182:185], 0
v_mfma_f32_16x16x32_bf16 v[146:149], a[48:51], v[182:185], 0
v_mfma_f32_16x16x32_bf16 v[150:153], a[216:219], v[182:185], 0
v_mfma_f32_16x16x32_bf16 v[154:157], a[240:243], v[182:185], 0
v_mfma_f32_16x16x32_bf16 v[158:161], v[232:235], v[182:185], 0
v_mfma_f32_16x16x32_bf16 v[162:165], v[182:185], a[72:75], 0
v_mfma_f32_16x16x32_bf16 v[166:169], v[182:185], a[96:99], 0
v_mfma_f32_16x16x32_bf16 v[170:173], v[182:185], a[120:123], 0
ds_read_b128 v[186:189], v210 offset:7168
s_waitcnt lgkmcnt(0)
v_mfma_f32_16x16x32_bf16 v[138:141], a[4:7], v[186:189], v[138:141]
v_mfma_f32_16x16x32_bf16 v[142:145], a[28:31], v[186:189], v[142:145]
v_mfma_f32_16x16x32_bf16 v[146:149], a[52:55], v[186:189], v[146:149]
v_mfma_f32_16x16x32_bf16 v[150:153], a[220:223], v[186:189], v[150:153]
v_mfma_f32_16x16x32_bf16 v[154:157], a[244:247], v[186:189], v[154:157]
v_mfma_f32_16x16x32_bf16 v[158:161], v[236:239], v[186:189], v[158:161]
v_mfma_f32_16x16x32_bf16 v[162:165], v[186:189], a[76:79], v[162:165]
v_mfma_f32_16x16x32_bf16 v[166:169], v[186:189], a[100:103], v[166:169]
v_mfma_f32_16x16x32_bf16 v[170:173], v[186:189], a[124:127], v[170:173]
ds_read_b128 v[182:185], v210 offset:8192
s_waitcnt lgkmcnt(0)
v_mfma_f32_16x16x32_bf16 v[138:141], a[8:11], v[182:185], v[138:141]
v_mfma_f32_16x16x32_bf16 v[142:145], a[32:35], v[182:185], v[142:145]
v_mfma_f32_16x16x32_bf16 v[146:149], a[56:59], v[182:185], v[146:149]
v_mfma_f32_16x16x32_bf16 v[150:153], a[224:227], v[182:185], v[150:153]
v_mfma_f32_16x16x32_bf16 v[154:157], a[248:251], v[182:185], v[154:157]
v_mfma_f32_16x16x32_bf16 v[158:161], v[240:243], v[182:185], v[158:161]
v_mfma_f32_16x16x32_bf16 v[162:165], v[182:185], a[80:83], v[162:165]
v_mfma_f32_16x16x32_bf16 v[166:169], v[182:185], a[104:107], v[166:169]
v_mfma_f32_16x16x32_bf16 v[170:173], v[182:185], a[128:131], v[170:173]
ds_read_b128 v[186:189], v210 offset:9216
s_waitcnt lgkmcnt(0)
v_mfma_f32_16x16x32_bf16 v[138:141], a[12:15], v[186:189], v[138:141]
v_mfma_f32_16x16x32_bf16 v[142:145], a[36:39], v[186:189], v[142:145]
v_mfma_f32_16x16x32_bf16 v[146:149], a[60:63], v[186:189], v[146:149]
v_mfma_f32_16x16x32_bf16 v[150:153], a[228:231], v[186:189], v[150:153]
v_mfma_f32_16x16x32_bf16 v[154:157], a[252:255], v[186:189], v[154:157]
v_mfma_f32_16x16x32_bf16 v[158:161], v[244:247], v[186:189], v[158:161]
v_mfma_f32_16x16x32_bf16 v[162:165], v[186:189], a[84:87], v[162:165]
v_mfma_f32_16x16x32_bf16 v[166:169], v[186:189], a[108:111], v[166:169]
v_mfma_f32_16x16x32_bf16 v[170:173], v[186:189], a[132:135], v[170:173]
ds_read_b128 v[182:185], v210 offset:10240
s_waitcnt lgkmcnt(0)
v_mfma_f32_16x16x32_bf16 v[138:141], a[16:19], v[182:185], v[138:141]
v_mfma_f32_16x16x32_bf16 v[142:145], a[40:43], v[182:185], v[142:145]
v_mfma_f32_16x16x32_bf16 v[146:149], a[64:67], v[182:185], v[146:149]
v_mfma_f32_16x16x32_bf16 v[150:153], a[232:235], v[182:185], v[150:153]
v_mfma_f32_16x16x32_bf16 v[154:157], v[224:227], v[182:185], v[154:157]
v_mfma_f32_16x16x32_bf16 v[158:161], v[248:251], v[182:185], v[158:161]
v_mfma_f32_16x16x32_bf16 v[162:165], v[182:185], a[88:91], v[162:165]
v_mfma_f32_16x16x32_bf16 v[166:169], v[182:185], a[112:115], v[166:169]
v_mfma_f32_16x16x32_bf16 v[170:173], v[182:185], a[136:139], v[170:173]
ds_read_b128 v[186:189], v210 offset:11264
s_waitcnt lgkmcnt(0)
v_mfma_f32_16x16x32_bf16 v[138:141], a[20:23], v[186:189], v[138:141]
v_mfma_f32_16x16x32_bf16 v[142:145], a[44:47], v[186:189], v[142:145]
v_mfma_f32_16x16x32_bf16 v[146:149], a[68:71], v[186:189], v[146:149]
v_mfma_f32_16x16x32_bf16 v[150:153], a[236:239], v[186:189], v[150:153]
v_mfma_f32_16x16x32_bf16 v[154:157], v[228:231], v[186:189], v[154:157]
v_mfma_f32_16x16x32_bf16 v[158:161], v[252:255], v[186:189], v[158:161]
v_mfma_f32_16x16x32_bf16 v[162:165], v[186:189], a[92:95], v[162:165]
v_mfma_f32_16x16x32_bf16 v[166:169], v[186:189], a[116:119], v[166:169]
v_mfma_f32_16x16x32_bf16 v[170:173], v[186:189], a[140:143], v[170:173]
v_cvt_pk_bf16_f32 v96, v138, v139
v_cvt_pk_bf16_f32 v97, v140, v141
v_cvt_pk_bf16_f32 v98, v142, v143
v_cvt_pk_bf16_f32 v99, v144, v145
v_cvt_pk_bf16_f32 v100, v146, v147
v_cvt_pk_bf16_f32 v101, v148, v149
v_cvt_pk_bf16_f32 v84, v150, v151
v_cvt_pk_bf16_f32 v85, v152, v153
v_cvt_pk_bf16_f32 v86, v154, v155
v_cvt_pk_bf16_f32 v87, v156, v157
v_cvt_pk_bf16_f32 v88, v158, v159
v_cvt_pk_bf16_f32 v89, v160, v161
v_cvt_pk_bf16_f32 v116, v162, v163
v_cvt_pk_bf16_f32 v117, v164, v165
v_cvt_pk_bf16_f32 v124, v166, v167
v_cvt_pk_bf16_f32 v125, v168, v169
v_cvt_pk_bf16_f32 v132, v170, v171
v_cvt_pk_bf16_f32 v133, v172, v173
ds_read_b128 v[182:185], v210 offset:12288
s_waitcnt lgkmcnt(0)
v_mfma_f32_16x16x32_bf16 v[138:141], a[0:3], v[182:185], 0
v_mfma_f32_16x16x32_bf16 v[142:145], a[24:27], v[182:185], 0
v_mfma_f32_16x16x32_bf16 v[146:149], a[48:51], v[182:185], 0
ds_read_b128 v[186:189], v210 offset:13312
s_waitcnt lgkmcnt(0)
v_mfma_f32_16x16x32_bf16 v[138:141], a[4:7], v[186:189], v[138:141]
v_mfma_f32_16x16x32_bf16 v[142:145], a[28:31], v[186:189], v[142:145]
v_mfma_f32_16x16x32_bf16 v[146:149], a[52:55], v[186:189], v[146:149]
ds_read_b128 v[182:185], v210 offset:14336
s_waitcnt lgkmcnt(0)
v_mfma_f32_16x16x32_bf16 v[138:141], a[8:11], v[182:185], v[138:141]
v_mfma_f32_16x16x32_bf16 v[142:145], a[32:35], v[182:185], v[142:145]
v_mfma_f32_16x16x32_bf16 v[146:149], a[56:59], v[182:185], v[146:149]
ds_read_b128 v[186:189], v210 offset:15360
s_waitcnt lgkmcnt(0)
v_mfma_f32_16x16x32_bf16 v[138:141], a[12:15], v[186:189], v[138:141]
v_mfma_f32_16x16x32_bf16 v[142:145], a[36:39], v[186:189], v[142:145]
v_mfma_f32_16x16x32_bf16 v[146:149], a[60:63], v[186:189], v[146:149]
ds_read_b128 v[182:185], v210 offset:16384
s_waitcnt lgkmcnt(0)
v_mfma_f32_16x16x32_bf16 v[138:141], a[16:19], v[182:185], v[138:141]
v_mfma_f32_16x16x32_bf16 v[142:145], a[40:43], v[182:185], v[142:145]
v_mfma_f32_16x16x32_bf16 v[146:149], a[64:67], v[182:185], v[146:149]
ds_read_b128 v[186:189], v210 offset:17408
s_waitcnt lgkmcnt(0)
v_mfma_f32_16x16x32_bf16 v[138:141], a[20:23], v[186:189], v[138:141]
v_mfma_f32_16x16x32_bf16 v[142:145], a[44:47], v[186:189], v[142:145]
v_mfma_f32_16x16x32_bf16 v[146:149], a[68:71], v[186:189], v[146:149]
v_cvt_pk_bf16_f32 v102, v138, v139
v_cvt_pk_bf16_f32 v103, v140, v141
s_nop 0
v_cvt_pk_bf16_f32 v104, v142, v143
v_cvt_pk_bf16_f32 v105, v144, v145
s_nop 1
v_cvt_pk_bf16_f32 v106, v146, v147
v_cvt_pk_bf16_f32 v107, v148, v149
ds_read_b128 v[108:111], v215 offset:512
ds_read_b64 v[112:113], v215 offset:528
v_mov_b32 v181, 0
v_mfma_f32_16x16x16_bf16 v[138:141], v[82:83], v[76:77], 0
v_mfma_f32_16x16x16_bf16 v[142:145], v[100:101], v[76:77], 0
s_waitcnt lgkmcnt(0)
v_mfma_f32_16x16x16_bf16 v[150:153], v[112:113], v[76:77], v[206:209]
v_mfma_f32_16x16x16_bf16 v[146:149], v[106:107], v[76:77], 0
v_mfma_f32_16x16x32_bf16 v[138:141], v[78:81], v[72:75], v[138:141]
v_mfma_f32_16x16x32_bf16 v[142:145], v[96:99], v[72:75], v[142:145]
v_mfma_f32_16x16x32_bf16 v[150:153], v[108:111], v[72:75], v[150:153]
v_mfma_f32_16x16x32_bf16 v[146:149], v[102:105], v[72:75], v[146:149]
ds_read_b128 v[72:75], v215
ds_read_b64 v[76:77], v215 offset:16
v_mfma_f32_16x16x16_bf16 v[154:157], v[82:83], v[88:89], 0
v_mfma_f32_16x16x16_bf16 v[158:161], v[100:101], v[88:89], 0
v_mfma_f32_16x16x16_bf16 v[166:169], v[112:113], v[88:89], v[206:209]
v_mfma_f32_16x16x16_bf16 v[162:165], v[106:107], v[88:89], 0
v_mfma_f32_16x16x32_bf16 v[154:157], v[78:81], v[84:87], v[154:157]
v_mfma_f32_16x16x32_bf16 v[158:161], v[96:99], v[84:87], v[158:161]
v_mfma_f32_16x16x32_bf16 v[166:169], v[108:111], v[84:87], v[166:169]
v_mfma_f32_16x16x32_bf16 v[162:165], v[102:105], v[84:87], v[162:165]
ds_read_b128 v[182:185], v210 offset:12288
s_waitcnt lgkmcnt(0)
v_mfma_f32_16x16x32_bf16 v[118:121], v[182:185], a[72:75], 0
v_mfma_f32_16x16x32_bf16 v[126:129], v[182:185], a[96:99], 0
v_mfma_f32_16x16x32_bf16 v[134:137], v[182:185], a[120:123], 0
v_mfma_f32_16x16x32_bf16 v[90:93], a[216:219], v[182:185], 0
v_mfma_f32_16x16x32_bf16 v[170:173], a[240:243], v[182:185], 0
v_mfma_f32_16x16x32_bf16 v[220:223], v[232:235], v[182:185], 0
ds_read_b128 v[186:189], v210 offset:13312
s_waitcnt lgkmcnt(0)
v_mfma_f32_16x16x32_bf16 v[118:121], v[186:189], a[76:79], v[118:121]
v_mfma_f32_16x16x32_bf16 v[126:129], v[186:189], a[100:103], v[126:129]
v_mfma_f32_16x16x32_bf16 v[134:137], v[186:189], a[124:127], v[134:137]
v_mfma_f32_16x16x32_bf16 v[90:93], a[220:223], v[186:189], v[90:93]
v_mfma_f32_16x16x32_bf16 v[170:173], a[244:247], v[186:189], v[170:173]
v_mfma_f32_16x16x32_bf16 v[220:223], v[236:239], v[186:189], v[220:223]
ds_read_b128 v[182:185], v210 offset:14336
s_waitcnt lgkmcnt(0)
v_mfma_f32_16x16x32_bf16 v[118:121], v[182:185], a[80:83], v[118:121]
v_mfma_f32_16x16x32_bf16 v[126:129], v[182:185], a[104:107], v[126:129]
v_mfma_f32_16x16x32_bf16 v[134:137], v[182:185], a[128:131], v[134:137]
v_mfma_f32_16x16x32_bf16 v[90:93], a[224:227], v[182:185], v[90:93]
v_mfma_f32_16x16x32_bf16 v[170:173], a[248:251], v[182:185], v[170:173]
v_mfma_f32_16x16x32_bf16 v[220:223], v[240:243], v[182:185], v[220:223]
ds_read_b128 v[186:189], v210 offset:15360
s_waitcnt lgkmcnt(0)
v_mfma_f32_16x16x32_bf16 v[118:121], v[186:189], a[84:87], v[118:121]
v_mfma_f32_16x16x32_bf16 v[126:129], v[186:189], a[108:111], v[126:129]
v_mfma_f32_16x16x32_bf16 v[134:137], v[186:189], a[132:135], v[134:137]
v_mfma_f32_16x16x32_bf16 v[90:93], a[228:231], v[186:189], v[90:93]
v_mfma_f32_16x16x32_bf16 v[170:173], a[252:255], v[186:189], v[170:173]
v_mfma_f32_16x16x32_bf16 v[220:223], v[244:247], v[186:189], v[220:223]
ds_read_b128 v[182:185], v210 offset:16384
s_waitcnt lgkmcnt(0)
v_mfma_f32_16x16x32_bf16 v[118:121], v[182:185], a[88:91], v[118:121]
v_mfma_f32_16x16x32_bf16 v[126:129], v[182:185], a[112:115], v[126:129]
v_mfma_f32_16x16x32_bf16 v[134:137], v[182:185], a[136:139], v[134:137]
v_mfma_f32_16x16x32_bf16 v[90:93], a[232:235], v[182:185], v[90:93]
v_mfma_f32_16x16x32_bf16 v[170:173], v[224:227], v[182:185], v[170:173]
v_mfma_f32_16x16x32_bf16 v[220:223], v[248:251], v[182:185], v[220:223]
ds_read_b128 v[186:189], v210 offset:17408
s_waitcnt lgkmcnt(0)
v_mfma_f32_16x16x32_bf16 v[118:121], v[186:189], a[92:95], v[118:121]
v_mfma_f32_16x16x32_bf16 v[126:129], v[186:189], a[116:119], v[126:129]
v_mfma_f32_16x16x32_bf16 v[134:137], v[186:189], a[140:143], v[134:137]
v_mfma_f32_16x16x32_bf16 v[90:93], a[236:239], v[186:189], v[90:93]
v_mfma_f32_16x16x32_bf16 v[170:173], v[228:231], v[186:189], v[170:173]
v_mfma_f32_16x16x32_bf16 v[220:223], v[252:255], v[186:189], v[220:223]
v_cvt_pk_bf16_f32 v118, v118, v119
v_cvt_pk_bf16_f32 v119, v120, v121
ds_read_u16 v120, v214 offset:1024
v_mov_b32 v121, 0
v_cvt_pk_bf16_f32 v126, v126, v127
v_cvt_pk_bf16_f32 v127, v128, v129
ds_read_u16 v128, v214 offset:1032
v_mov_b32 v129, 0
v_cvt_pk_bf16_f32 v134, v134, v135
v_cvt_pk_bf16_f32 v135, v136, v137
ds_read_u16 v136, v214 offset:1040
v_mov_b32 v137, 0
v_cvt_pk_bf16_f32 v90, v90, v91
v_cvt_pk_bf16_f32 v91, v92, v93
v_cvt_pk_bf16_f32 v92, v170, v171
v_cvt_pk_bf16_f32 v93, v172, v173
v_cvt_pk_bf16_f32 v94, v220, v221
v_cvt_pk_bf16_f32 v95, v222, v223
v_max3_f32 v151, v138, v139, v140
v_max3_f32 v151, v151, v141, v142
v_max3_f32 v151, v151, v143, v144
v_max3_f32 v151, v151, v145, v146
v_max3_f32 v151, v151, v147, v148
v_max3_f32 v151, v151, v149, v150
v_mov_b32 v152, v151
s_nop 1
v_permlane16_swap_b32 v151, v152
v_max_f32 v151, v151, v152
v_mov_b32 v152, v151
s_nop 1
v_permlane32_swap_b32 v151, v152
v_max_f32 v151, v151, v152
v_sub_f32 v138, v138, v151
v_sub_f32 v139, v139, v151
v_sub_f32 v140, v140, v151
v_sub_f32 v141, v141, v151
v_sub_f32 v142, v142, v151
v_sub_f32 v143, v143, v151
v_sub_f32 v144, v144, v151
v_sub_f32 v145, v145, v151
v_sub_f32 v150, v150, v151
v_sub_f32 v146, v146, v151
v_sub_f32 v147, v147, v151
v_sub_f32 v148, v148, v151
v_sub_f32 v149, v149, v151
v_exp_f32 v138, v138
v_exp_f32 v139, v139
v_exp_f32 v140, v140
v_exp_f32 v141, v141
v_exp_f32 v142, v142
v_exp_f32 v143, v143
v_exp_f32 v144, v144
v_exp_f32 v145, v145
v_exp_f32 v150, v150
v_exp_f32 v146, v146
v_exp_f32 v147, v147
v_exp_f32 v148, v148
v_exp_f32 v149, v149
v_cvt_pk_bf16_f32 v174, v138, v139
v_cvt_pk_bf16_f32 v175, v140, v141
v_cvt_pk_bf16_f32 v176, v142, v143
v_cvt_pk_bf16_f32 v177, v144, v145
v_cvt_pk_bf16_f32 v178, v146, v147
v_cvt_pk_bf16_f32 v179, v148, v149
v_cvt_pk_bf16_f32 v180, v150, 0
v_mfma_f32_16x16x32_bf16 v[150:153], v[190:193], v[174:177], 0
v_mfma_f32_16x16x32_bf16 v[138:141], v[114:117], v[174:177], 0
v_mfma_f32_16x16x32_bf16 v[142:145], v[122:125], v[174:177], 0
v_mfma_f32_16x16x32_bf16 v[146:149], v[130:133], v[174:177], 0
v_mfma_f32_16x16x32_bf16 v[150:153], v[190:193], v[178:181], v[150:153]
s_waitcnt lgkmcnt(2)
v_mfma_f32_16x16x32_bf16 v[138:141], v[118:121], v[178:181], v[138:141]
s_waitcnt lgkmcnt(1)
v_mfma_f32_16x16x32_bf16 v[142:145], v[126:129], v[178:181], v[142:145]
s_waitcnt lgkmcnt(0)
v_mfma_f32_16x16x32_bf16 v[146:149], v[134:137], v[178:181], v[146:149]
v_max3_f32 v167, v154, v155, v156
v_max3_f32 v167, v167, v157, v158
v_max3_f32 v167, v167, v159, v160
v_max3_f32 v167, v167, v161, v162
v_max3_f32 v167, v167, v163, v164
v_max3_f32 v167, v167, v165, v166
v_mov_b32 v168, v167
s_nop 1
v_permlane16_swap_b32 v167, v168
v_max_f32 v167, v167, v168
v_mov_b32 v168, v167
s_nop 1
v_permlane32_swap_b32 v167, v168
v_max_f32 v167, v167, v168
v_sub_f32 v154, v154, v167
v_sub_f32 v155, v155, v167
v_sub_f32 v156, v156, v167
v_sub_f32 v157, v157, v167
v_sub_f32 v158, v158, v167
v_sub_f32 v159, v159, v167
v_sub_f32 v160, v160, v167
v_sub_f32 v161, v161, v167
v_sub_f32 v166, v166, v167
v_sub_f32 v162, v162, v167
v_sub_f32 v163, v163, v167
v_sub_f32 v164, v164, v167
v_sub_f32 v165, v165, v167
v_exp_f32 v154, v154
v_exp_f32 v155, v155
v_exp_f32 v156, v156
v_exp_f32 v157, v157
v_exp_f32 v158, v158
v_exp_f32 v159, v159
v_exp_f32 v160, v160
v_exp_f32 v161, v161
v_exp_f32 v166, v166
v_exp_f32 v162, v162
v_exp_f32 v163, v163
v_exp_f32 v164, v164
v_exp_f32 v165, v165
v_cvt_pk_bf16_f32 v174, v154, v155
v_cvt_pk_bf16_f32 v175, v156, v157
v_cvt_pk_bf16_f32 v176, v158, v159
v_cvt_pk_bf16_f32 v177, v160, v161
v_cvt_pk_bf16_f32 v178, v162, v163
v_cvt_pk_bf16_f32 v179, v164, v165
v_cvt_pk_bf16_f32 v180, v166, 0
v_mfma_f32_16x16x32_bf16 v[166:169], v[190:193], v[174:177], 0
v_mfma_f32_16x16x32_bf16 v[154:157], v[114:117], v[174:177], 0
v_mfma_f32_16x16x32_bf16 v[158:161], v[122:125], v[174:177], 0
v_mfma_f32_16x16x32_bf16 v[162:165], v[130:133], v[174:177], 0
v_mfma_f32_16x16x32_bf16 v[166:169], v[190:193], v[178:181], v[166:169]
v_mfma_f32_16x16x32_bf16 v[154:157], v[118:121], v[178:181], v[154:157]
v_mfma_f32_16x16x32_bf16 v[158:161], v[126:129], v[178:181], v[158:161]
v_mfma_f32_16x16x32_bf16 v[162:165], v[134:137], v[178:181], v[162:165]
v_rcp_f32 v151, v150
s_nop 0
v_mul_f32 v151, s3, v151
v_mul_f32 v138, v138, v151
v_mul_f32 v139, v139, v151
v_cvt_pk_bf16_f32 v138, v138, v139
v_mul_f32 v140, v140, v151
v_mul_f32 v141, v141, v151
v_cvt_pk_bf16_f32 v139, v140, v141
v_mul_f32 v142, v142, v151
v_mul_f32 v143, v143, v151
v_cvt_pk_bf16_f32 v140, v142, v143
v_mul_f32 v144, v144, v151
v_mul_f32 v145, v145, v151
v_cvt_pk_bf16_f32 v141, v144, v145
ds_write_b128 v211, v[138:141] offset:36864
v_mul_f32 v146, v146, v151
v_mul_f32 v147, v147, v151
v_cvt_pk_bf16_f32 v142, v146, v147
v_mul_f32 v148, v148, v151
v_mul_f32 v149, v149, v151
v_cvt_pk_bf16_f32 v143, v148, v149
ds_write_b64 v212, v[142:143] offset:36864
v_mfma_f32_16x16x32_bf16 v[138:141], v[78:81], v[90:93], 0
v_mfma_f32_16x16x32_bf16 v[142:145], v[96:99], v[90:93], 0
v_mfma_f32_16x16x32_bf16 v[150:153], v[108:111], v[90:93], v[206:209]
v_mfma_f32_16x16x32_bf16 v[146:149], v[102:105], v[90:93], 0
v_mfma_f32_16x16x16_bf16 v[138:141], v[82:83], v[94:95], v[138:141]
v_mfma_f32_16x16x16_bf16 v[142:145], v[100:101], v[94:95], v[142:145]
v_mfma_f32_16x16x16_bf16 v[150:153], v[112:113], v[94:95], v[150:153]
v_mfma_f32_16x16x16_bf16 v[146:149], v[106:107], v[94:95], v[146:149]
v_rcp_f32 v167, v166
s_nop 0
v_mul_f32 v167, s3, v167
v_mul_f32 v154, v154, v167
v_mul_f32 v155, v155, v167
v_cvt_pk_bf16_f32 v154, v154, v155
v_mul_f32 v156, v156, v167
v_mul_f32 v157, v157, v167
v_cvt_pk_bf16_f32 v155, v156, v157
v_mul_f32 v158, v158, v167
v_mul_f32 v159, v159, v167
v_cvt_pk_bf16_f32 v156, v158, v159
v_mul_f32 v160, v160, v167
v_mul_f32 v161, v161, v167
v_cvt_pk_bf16_f32 v157, v160, v161
ds_write_b128 v211, v[154:157] offset:43008
v_mul_f32 v162, v162, v167
v_mul_f32 v163, v163, v167
v_cvt_pk_bf16_f32 v158, v162, v163
v_mul_f32 v164, v164, v167
v_mul_f32 v165, v165, v167
v_cvt_pk_bf16_f32 v159, v164, v165
ds_write_b64 v212, v[158:159] offset:43008
v_mfma_f32_16x16x16_bf16 v[154:157], v[76:77], v[82:83], 0
v_mfma_f32_16x16x16_bf16 v[158:161], v[76:77], v[100:101], 0
v_mfma_f32_16x16x16_bf16 v[162:165], v[76:77], v[106:107], 0
v_mfma_f32_16x16x16_bf16 v[166:169], v[76:77], v[112:113], v[206:209]
v_mfma_f32_16x16x32_bf16 v[154:157], v[72:75], v[78:81], v[154:157]
v_mfma_f32_16x16x32_bf16 v[158:161], v[72:75], v[96:99], v[158:161]
v_mfma_f32_16x16x32_bf16 v[162:165], v[72:75], v[102:105], v[162:165]
v_mfma_f32_16x16x32_bf16 v[166:169], v[72:75], v[108:111], v[166:169]
v_mov_b32_dpp v154, v158 quad_perm:[0,1,2,3] row_mask:0x2 bank_mask:0xf
s_nop 1
v_mov_b32_dpp v154, v162 quad_perm:[0,1,2,3] row_mask:0x4 bank_mask:0xf
s_nop 2
v_mov_b32_dpp v154, v167 quad_perm:[0,1,2,3] row_mask:0x8 bank_mask:0xf
v_mov_b32 v155, v154
s_nop 1
v_max_f32_dpp v155, v155, v155 row_ror:8 row_mask:0xf bank_mask:0xf
s_nop 1
v_max_f32_dpp v155, v155, v155 row_ror:4 row_mask:0xf bank_mask:0xf
s_nop 1
v_max_f32_dpp v155, v155, v155 row_ror:2 row_mask:0xf bank_mask:0xf
s_nop 1
v_max_f32_dpp v155, v155, v155 row_ror:1 row_mask:0xf bank_mask:0xf
v_mov_b32 v156, v155
s_nop 1
v_permlane16_swap_b32 v155, v156
v_max_f32 v155, v155, v156
v_mov_b32 v156, v155
s_nop 1
v_permlane32_swap_b32 v155, v156
v_max_f32 v155, v155, v156
v_sub_f32 v154, v154, v155
v_exp_f32 v154, v154
s_nop 0
v_cvt_pk_bf16_f32 v154, v154, 0
ds_write_b16 v214, v154
s_waitcnt lgkmcnt(1)
ds_read_b128 v[84:87], v215
ds_read_b128 v[88:91], v215 offset:16
v_add_u32 v215, 1552, v215
s_barrier
ds_read_b128 v[170:173], v210 offset:36864
s_waitcnt lgkmcnt(0)
v_mfma_f32_16x16x32_bf16 v[0:3], a[144:147], v[170:173], v[0:3]
v_mfma_f32_16x16x32_bf16 v[4:7], a[168:171], v[170:173], v[4:7]
v_mfma_f32_16x16x32_bf16 v[8:11], a[192:195], v[170:173], v[8:11]
ds_read_b128 v[182:185], v210 offset:37888
s_waitcnt lgkmcnt(0)
v_mfma_f32_16x16x32_bf16 v[0:3], a[148:151], v[182:185], v[0:3]
v_mfma_f32_16x16x32_bf16 v[4:7], a[172:175], v[182:185], v[4:7]
v_mfma_f32_16x16x32_bf16 v[8:11], a[196:199], v[182:185], v[8:11]
ds_read_b128 v[186:189], v210 offset:38912
s_waitcnt lgkmcnt(0)
v_mfma_f32_16x16x32_bf16 v[0:3], a[152:155], v[186:189], v[0:3]
v_mfma_f32_16x16x32_bf16 v[4:7], a[176:179], v[186:189], v[4:7]
v_mfma_f32_16x16x32_bf16 v[8:11], a[200:203], v[186:189], v[8:11]
ds_read_b128 v[170:173], v210 offset:39936
s_waitcnt lgkmcnt(0)
v_mfma_f32_16x16x32_bf16 v[0:3], a[156:159], v[170:173], v[0:3]
v_mfma_f32_16x16x32_bf16 v[4:7], a[180:183], v[170:173], v[4:7]
v_mfma_f32_16x16x32_bf16 v[8:11], a[204:207], v[170:173], v[8:11]
ds_read_b128 v[182:185], v210 offset:40960
s_waitcnt lgkmcnt(0)
v_mfma_f32_16x16x32_bf16 v[0:3], a[160:163], v[182:185], v[0:3]
v_mfma_f32_16x16x32_bf16 v[4:7], a[184:187], v[182:185], v[4:7]
v_mfma_f32_16x16x32_bf16 v[8:11], a[208:211], v[182:185], v[8:11]
ds_read_b128 v[186:189], v210 offset:41984
s_waitcnt lgkmcnt(0)
v_mfma_f32_16x16x32_bf16 v[0:3], a[164:167], v[186:189], v[0:3]
v_mfma_f32_16x16x32_bf16 v[4:7], a[188:191], v[186:189], v[4:7]
v_mfma_f32_16x16x32_bf16 v[8:11], a[212:215], v[186:189], v[8:11]
v_cvt_pk_bf16_f32 v72, v0, v1
v_cvt_pk_bf16_f32 v73, v2, v3
buffer_store_dwordx2 v[72:73], v203, s[8:11], s38 offen
v_cvt_pk_bf16_f32 v74, v4, v5
v_cvt_pk_bf16_f32 v75, v6, v7
buffer_store_dwordx2 v[74:75], v203, s[8:11], s38 offen offset:32
s_nop 0
v_cvt_pk_bf16_f32 v76, v8, v9
v_cvt_pk_bf16_f32 v77, v10, v11
buffer_store_dwordx2 v[76:77], v203, s[8:11], s38 offen offset:64
v_max3_f32 v151, v138, v139, v140
v_max3_f32 v151, v151, v141, v142
v_max3_f32 v151, v151, v143, v144
v_max3_f32 v151, v151, v145, v146
v_max3_f32 v151, v151, v147, v148
v_max3_f32 v151, v151, v149, v150
v_mov_b32 v152, v151
s_nop 1
v_permlane16_swap_b32 v151, v152
v_max_f32 v151, v151, v152
v_mov_b32 v152, v151
s_nop 1
v_permlane32_swap_b32 v151, v152
v_max_f32 v151, v151, v152
v_sub_f32 v138, v138, v151
v_sub_f32 v139, v139, v151
v_sub_f32 v140, v140, v151
v_sub_f32 v141, v141, v151
v_sub_f32 v142, v142, v151
v_sub_f32 v143, v143, v151
v_sub_f32 v144, v144, v151
v_sub_f32 v145, v145, v151
v_sub_f32 v150, v150, v151
v_sub_f32 v146, v146, v151
v_sub_f32 v147, v147, v151
v_sub_f32 v148, v148, v151
v_sub_f32 v149, v149, v151
v_exp_f32 v138, v138
v_exp_f32 v139, v139
v_exp_f32 v140, v140
v_exp_f32 v141, v141
v_exp_f32 v142, v142
v_exp_f32 v143, v143
v_exp_f32 v144, v144
v_exp_f32 v145, v145
v_exp_f32 v150, v150
v_exp_f32 v146, v146
v_exp_f32 v147, v147
v_exp_f32 v148, v148
v_exp_f32 v149, v149
v_cvt_pk_bf16_f32 v174, v138, v139
v_cvt_pk_bf16_f32 v175, v140, v141
v_cvt_pk_bf16_f32 v176, v142, v143
v_cvt_pk_bf16_f32 v177, v144, v145
v_cvt_pk_bf16_f32 v178, v146, v147
v_cvt_pk_bf16_f32 v179, v148, v149
v_cvt_pk_bf16_f32 v180, v150, 0
v_mfma_f32_16x16x32_bf16 v[150:153], v[190:193], v[174:177], 0
v_mfma_f32_16x16x32_bf16 v[138:141], v[114:117], v[174:177], 0
v_mfma_f32_16x16x32_bf16 v[142:145], v[122:125], v[174:177], 0
v_mfma_f32_16x16x32_bf16 v[146:149], v[130:133], v[174:177], 0
v_mfma_f32_16x16x32_bf16 v[150:153], v[190:193], v[178:181], v[150:153]
v_mfma_f32_16x16x32_bf16 v[138:141], v[118:121], v[178:181], v[138:141]
v_mfma_f32_16x16x32_bf16 v[142:145], v[126:129], v[178:181], v[142:145]
v_mfma_f32_16x16x32_bf16 v[146:149], v[134:137], v[178:181], v[146:149]
v_mfma_f32_16x16x32_bf16 v[166:169], v[84:87], v[190:193], 0
v_mfma_f32_16x16x32_bf16 v[154:157], v[84:87], v[114:117], 0
v_mfma_f32_16x16x32_bf16 v[158:161], v[84:87], v[122:125], 0
v_mfma_f32_16x16x32_bf16 v[162:165], v[84:87], v[130:133], 0
v_mfma_f32_16x16x32_bf16 v[166:169], v[88:91], v[190:193], v[166:169]
v_mfma_f32_16x16x32_bf16 v[154:157], v[88:91], v[118:121], v[154:157]
v_mfma_f32_16x16x32_bf16 v[158:161], v[88:91], v[126:129], v[158:161]
v_mfma_f32_16x16x32_bf16 v[162:165], v[88:91], v[134:137], v[162:165]
v_rcp_f32 v167, v166
s_nop 1
v_mov_b32_dpp v154, v158 quad_perm:[0,1,2,3] row_mask:0x2 bank_mask:0xf
s_nop 2
v_mov_b32_dpp v154, v162 quad_perm:[0,1,2,3] row_mask:0x4 bank_mask:0xf
v_mul_f32 v167, s3, v167
v_mul_f32 v154, v154, v167
v_cvt_pk_bf16_f32 v154, v154, 0
ds_write_b16 v214, v154
v_add_u32 v214, 1552, v214
ds_read_b128 v[170:173], v210 offset:43008
s_waitcnt lgkmcnt(0)
v_mfma_f32_16x16x32_bf16 v[12:15], a[144:147], v[170:173], v[12:15]
v_mfma_f32_16x16x32_bf16 v[16:19], a[168:171], v[170:173], v[16:19]
v_mfma_f32_16x16x32_bf16 v[20:23], a[192:195], v[170:173], v[20:23]
ds_read_b128 v[182:185], v210 offset:44032
s_waitcnt lgkmcnt(0)
v_mfma_f32_16x16x32_bf16 v[12:15], a[148:151], v[182:185], v[12:15]
v_mfma_f32_16x16x32_bf16 v[16:19], a[172:175], v[182:185], v[16:19]
v_mfma_f32_16x16x32_bf16 v[20:23], a[196:199], v[182:185], v[20:23]
ds_read_b128 v[186:189], v210 offset:45056
s_waitcnt lgkmcnt(0)
v_mfma_f32_16x16x32_bf16 v[12:15], a[152:155], v[186:189], v[12:15]
v_mfma_f32_16x16x32_bf16 v[16:19], a[176:179], v[186:189], v[16:19]
v_mfma_f32_16x16x32_bf16 v[20:23], a[200:203], v[186:189], v[20:23]
ds_read_b128 v[170:173], v210 offset:46080
s_waitcnt lgkmcnt(0)
v_mfma_f32_16x16x32_bf16 v[12:15], a[156:159], v[170:173], v[12:15]
v_mfma_f32_16x16x32_bf16 v[16:19], a[180:183], v[170:173], v[16:19]
v_mfma_f32_16x16x32_bf16 v[20:23], a[204:207], v[170:173], v[20:23]
ds_read_b128 v[182:185], v210 offset:47104
s_waitcnt lgkmcnt(0)
v_mfma_f32_16x16x32_bf16 v[12:15], a[160:163], v[182:185], v[12:15]
v_mfma_f32_16x16x32_bf16 v[16:19], a[184:187], v[182:185], v[16:19]
v_mfma_f32_16x16x32_bf16 v[20:23], a[208:211], v[182:185], v[20:23]
ds_read_b128 v[186:189], v210 offset:48128
s_waitcnt lgkmcnt(0)
v_mfma_f32_16x16x32_bf16 v[12:15], a[164:167], v[186:189], v[12:15]
v_mfma_f32_16x16x32_bf16 v[16:19], a[188:191], v[186:189], v[16:19]
v_mfma_f32_16x16x32_bf16 v[20:23], a[212:215], v[186:189], v[20:23]
v_cvt_pk_bf16_f32 v78, v12, v13
v_cvt_pk_bf16_f32 v79, v14, v15
buffer_store_dwordx2 v[78:79], v204, s[8:11], s38 offen
v_cvt_pk_bf16_f32 v80, v16, v17
v_cvt_pk_bf16_f32 v81, v18, v19
buffer_store_dwordx2 v[80:81], v204, s[8:11], s38 offen offset:32
s_nop 0
v_cvt_pk_bf16_f32 v82, v20, v21
v_cvt_pk_bf16_f32 v83, v22, v23
buffer_store_dwordx2 v[82:83], v204, s[8:11], s38 offen offset:64
v_rcp_f32 v151, v150
s_nop 0
v_mul_f32 v151, s3, v151
v_mul_f32 v138, v138, v151
v_mul_f32 v139, v139, v151
v_cvt_pk_bf16_f32 v138, v138, v139
v_mul_f32 v140, v140, v151
v_mul_f32 v141, v141, v151
v_cvt_pk_bf16_f32 v139, v140, v141
v_mul_f32 v142, v142, v151
v_mul_f32 v143, v143, v151
v_cvt_pk_bf16_f32 v140, v142, v143
v_mul_f32 v144, v144, v151
v_mul_f32 v145, v145, v151
v_cvt_pk_bf16_f32 v141, v144, v145
ds_write_b128 v211, v[138:141] offset:49152
v_mul_f32 v146, v146, v151
v_mul_f32 v147, v147, v151
v_cvt_pk_bf16_f32 v142, v146, v147
v_mul_f32 v148, v148, v151
v_mul_f32 v149, v149, v151
v_cvt_pk_bf16_f32 v143, v148, v149
ds_write_b64 v212, v[142:143] offset:49152
s_mov_b32 s46, 8
.p2align 3
G_loop:
s_waitcnt vmcnt(6) lgkmcnt(0)
s_barrier
ds_read_b128 v[170:173], v210 offset:49152
s_waitcnt lgkmcnt(0)
v_mfma_f32_16x16x32_bf16 v[24:27], a[144:147], v[170:173], v[24:27]
v_mfma_f32_16x16x32_bf16 v[28:31], a[168:171], v[170:173], v[28:31]
v_mfma_f32_16x16x32_bf16 v[32:35], a[192:195], v[170:173], v[32:35]
ds_read_b128 v[182:185], v210 offset:50176
s_waitcnt lgkmcnt(0)
v_mfma_f32_16x16x32_bf16 v[24:27], a[148:151], v[182:185], v[24:27]
v_mfma_f32_16x16x32_bf16 v[28:31], a[172:175], v[182:185], v[28:31]
v_mfma_f32_16x16x32_bf16 v[32:35], a[196:199], v[182:185], v[32:35]
ds_read_b128 v[186:189], v210 offset:51200
s_waitcnt lgkmcnt(0)
v_mfma_f32_16x16x32_bf16 v[24:27], a[152:155], v[186:189], v[24:27]
v_mfma_f32_16x16x32_bf16 v[28:31], a[176:179], v[186:189], v[28:31]
v_mfma_f32_16x16x32_bf16 v[32:35], a[200:203], v[186:189], v[32:35]
ds_read_b128 v[170:173], v210 offset:52224
s_waitcnt lgkmcnt(0)
v_mfma_f32_16x16x32_bf16 v[24:27], a[156:159], v[170:173], v[24:27]
v_mfma_f32_16x16x32_bf16 v[28:31], a[180:183], v[170:173], v[28:31]
v_mfma_f32_16x16x32_bf16 v[32:35], a[204:207], v[170:173], v[32:35]
ds_read_b128 v[182:185], v210 offset:53248
s_waitcnt lgkmcnt(0)
v_mfma_f32_16x16x32_bf16 v[24:27], a[160:163], v[182:185], v[24:27]
v_mfma_f32_16x16x32_bf16 v[28:31], a[184:187], v[182:185], v[28:31]
v_mfma_f32_16x16x32_bf16 v[32:35], a[208:211], v[182:185], v[32:35]
ds_read_b128 v[186:189], v210 offset:54272
s_waitcnt lgkmcnt(0)
v_mfma_f32_16x16x32_bf16 v[24:27], a[164:167], v[186:189], v[24:27]
v_mfma_f32_16x16x32_bf16 v[28:31], a[188:191], v[186:189], v[28:31]
v_mfma_f32_16x16x32_bf16 v[32:35], a[212:215], v[186:189], v[32:35]
v_cvt_pk_bf16_f32 v116, v24, v25
v_cvt_pk_bf16_f32 v117, v26, v27
buffer_store_dwordx2 v[116:117], v205, s[8:11], s38 offen
v_cvt_pk_bf16_f32 v124, v28, v29
v_cvt_pk_bf16_f32 v125, v30, v31
buffer_store_dwordx2 v[124:125], v205, s[8:11], s38 offen offset:32
s_nop 0
v_cvt_pk_bf16_f32 v132, v32, v33
v_cvt_pk_bf16_f32 v133, v34, v35
buffer_store_dwordx2 v[132:133], v205, s[8:11], s38 offen offset:64
s_mov_b32 s39, s37
ds_read_b128 v[174:177], v217
ds_read_b128 v[84:87], v200
s_waitcnt lgkmcnt(0)
v_mfma_f32_16x16x32_bf16 v[0:3], v[174:177], v[84:87], 0
ds_read_b128 v[92:95], v201
s_waitcnt lgkmcnt(0)
v_mfma_f32_16x16x32_bf16 v[12:15], v[174:177], v[92:95], 0
ds_read_b128 v[100:103], v202
s_waitcnt lgkmcnt(0)
v_mfma_f32_16x16x32_bf16 v[24:27], v[174:177], v[100:103], 0
ds_read_b128 v[178:181], v217 offset:528
ds_read_b128 v[84:87], v194
ds_read_b128 v[88:91], v194 offset:16
s_waitcnt lgkmcnt(0)
v_smfmac_f32_16x16x64_bf16 v[0:3], v[178:181], v[84:91], v213
ds_read_b128 v[92:95], v195
ds_read_b128 v[96:99], v195 offset:16
s_waitcnt lgkmcnt(0)
v_smfmac_f32_16x16x64_bf16 v[12:15], v[178:181], v[92:99], v213
ds_read_b128 v[100:103], v196
ds_read_b128 v[104:107], v196 offset:16
s_waitcnt lgkmcnt(0)
v_smfmac_f32_16x16x64_bf16 v[24:27], v[178:181], v[100:107], v213
ds_read_b128 v[174:177], v217 offset:1056
ds_read_b128 v[84:87], v197
ds_read_b128 v[88:91], v197 offset:16
s_waitcnt lgkmcnt(0)
v_smfmac_f32_16x16x64_bf16 v[0:3], v[174:177], v[84:91], v213
ds_read_b128 v[92:95], v198
ds_read_b128 v[96:99], v198 offset:16
s_waitcnt lgkmcnt(0)
v_smfmac_f32_16x16x64_bf16 v[12:15], v[174:177], v[92:99], v213
ds_read_b128 v[100:103], v199
ds_read_b128 v[104:107], v199 offset:16
s_waitcnt lgkmcnt(0)
v_smfmac_f32_16x16x64_bf16 v[24:27], v[174:177], v[100:107], v213
ds_read_b128 v[178:181], v217 offset:1584
ds_read_b128 v[84:87], v200 offset:32
s_waitcnt lgkmcnt(0)
v_mfma_f32_16x16x32_bf16 v[4:7], v[178:181], v[84:87], 0
ds_read_b128 v[92:95], v201 offset:32
s_waitcnt lgkmcnt(0)
v_mfma_f32_16x16x32_bf16 v[16:19], v[178:181], v[92:95], 0
ds_read_b128 v[100:103], v202 offset:32
s_waitcnt lgkmcnt(0)
v_mfma_f32_16x16x32_bf16 v[28:31], v[178:181], v[100:103], 0
ds_read_b128 v[174:177], v217 offset:2112
ds_read_b128 v[84:87], v194 offset:32
ds_read_b128 v[88:91], v194 offset:48
s_waitcnt lgkmcnt(0)
v_smfmac_f32_16x16x64_bf16 v[4:7], v[174:177], v[84:91], v213
ds_read_b128 v[92:95], v195 offset:32
ds_read_b128 v[96:99], v195 offset:48
s_waitcnt lgkmcnt(0)
v_smfmac_f32_16x16x64_bf16 v[16:19], v[174:177], v[92:99], v213
ds_read_b128 v[100:103], v196 offset:32
ds_read_b128 v[104:107], v196 offset:48
s_waitcnt lgkmcnt(0)
v_smfmac_f32_16x16x64_bf16 v[28:31], v[174:177], v[100:107], v213
ds_read_b128 v[178:181], v217 offset:2640
ds_read_b128 v[84:87], v197 offset:32
ds_read_b128 v[88:91], v197 offset:48
s_waitcnt lgkmcnt(0)
v_smfmac_f32_16x16x64_bf16 v[4:7], v[178:181], v[84:91], v213
ds_read_b128 v[92:95], v198 offset:32
ds_read_b128 v[96:99], v198 offset:48
s_waitcnt lgkmcnt(0)
v_smfmac_f32_16x16x64_bf16 v[16:19], v[178:181], v[92:99], v213
ds_read_b128 v[100:103], v199 offset:32
ds_read_b128 v[104:107], v199 offset:48
s_waitcnt lgkmcnt(0)
v_smfmac_f32_16x16x64_bf16 v[28:31], v[178:181], v[100:107], v213
ds_read_b128 v[174:177], v217 offset:3168
ds_read_b128 v[84:87], v200 offset:64
s_waitcnt lgkmcnt(0)
v_mfma_f32_16x16x32_bf16 v[8:11], v[174:177], v[84:87], 0
ds_read_b128 v[92:95], v201 offset:64
s_waitcnt lgkmcnt(0)
v_mfma_f32_16x16x32_bf16 v[20:23], v[174:177], v[92:95], 0
ds_read_b128 v[100:103], v202 offset:64
s_waitcnt lgkmcnt(0)
v_mfma_f32_16x16x32_bf16 v[32:35], v[174:177], v[100:103], 0
ds_read_b128 v[178:181], v217 offset:3696
ds_read_b128 v[84:87], v194 offset:64
ds_read_b128 v[88:91], v194 offset:80
s_waitcnt lgkmcnt(0)
v_smfmac_f32_16x16x64_bf16 v[8:11], v[178:181], v[84:91], v213
ds_read_b128 v[92:95], v195 offset:64
ds_read_b128 v[96:99], v195 offset:80
s_waitcnt lgkmcnt(0)
v_smfmac_f32_16x16x64_bf16 v[20:23], v[178:181], v[92:99], v213
ds_read_b128 v[100:103], v196 offset:64
ds_read_b128 v[104:107], v196 offset:80
s_waitcnt lgkmcnt(0)
v_smfmac_f32_16x16x64_bf16 v[32:35], v[178:181], v[100:107], v213
ds_read_b128 v[174:177], v217 offset:4224
ds_read_b128 v[84:87], v197 offset:64
ds_read_b128 v[88:91], v197 offset:80
s_waitcnt lgkmcnt(0)
v_smfmac_f32_16x16x64_bf16 v[8:11], v[174:177], v[84:91], v213
ds_read_b128 v[92:95], v198 offset:64
ds_read_b128 v[96:99], v198 offset:80
s_waitcnt lgkmcnt(0)
v_smfmac_f32_16x16x64_bf16 v[20:23], v[174:177], v[92:99], v213
ds_read_b128 v[100:103], v199 offset:64
ds_read_b128 v[104:107], v199 offset:80
s_waitcnt lgkmcnt(0)
v_smfmac_f32_16x16x64_bf16 v[32:35], v[174:177], v[100:107], v213
v_add_f32 v118, v0, v1
v_mul_f32 v119, v0, v0
v_add_f32 v118, v118, v2
v_fmac_f32 v119, v1, v1
v_add_f32 v118, v118, v3
v_fmac_f32 v119, v2, v2
v_fmac_f32 v119, v3, v3
v_add_f32 v126, v12, v13
v_mul_f32 v127, v12, v12
v_add_f32 v126, v126, v14
v_fmac_f32 v127, v13, v13
v_add_f32 v126, v126, v15
v_fmac_f32 v127, v14, v14
v_fmac_f32 v127, v15, v15
v_add_f32 v134, v24, v25
v_mul_f32 v135, v24, v24
v_add_f32 v134, v134, v26
v_fmac_f32 v135, v25, v25
v_add_f32 v134, v134, v27
v_fmac_f32 v135, v26, v26
v_fmac_f32 v135, v27, v27
v_add_f32 v118, v118, v4
v_fmac_f32 v119, v4, v4
v_add_f32 v118, v118, v5
v_fmac_f32 v119, v5, v5
v_add_f32 v118, v118, v6
v_fmac_f32 v119, v6, v6
v_add_f32 v118, v118, v7
v_fmac_f32 v119, v7, v7
v_add_f32 v126, v126, v16
v_fmac_f32 v127, v16, v16
v_add_f32 v126, v126, v17
v_fmac_f32 v127, v17, v17
v_add_f32 v126, v126, v18
v_fmac_f32 v127, v18, v18
v_add_f32 v126, v126, v19
v_fmac_f32 v127, v19, v19
v_add_f32 v134, v134, v28
v_fmac_f32 v135, v28, v28
v_add_f32 v134, v134, v29
v_fmac_f32 v135, v29, v29
v_add_f32 v134, v134, v30
v_fmac_f32 v135, v30, v30
v_add_f32 v134, v134, v31
v_fmac_f32 v135, v31, v31
v_add_f32 v118, v118, v8
v_fmac_f32 v119, v8, v8
v_add_f32 v118, v118, v9
v_fmac_f32 v119, v9, v9
v_add_f32 v118, v118, v10
v_fmac_f32 v119, v10, v10
v_add_f32 v118, v118, v11
v_fmac_f32 v119, v11, v11
v_add_f32 v126, v126, v20
v_fmac_f32 v127, v20, v20
v_add_f32 v126, v126, v21
v_fmac_f32 v127, v21, v21
v_add_f32 v126, v126, v22
v_fmac_f32 v127, v22, v22
v_add_f32 v126, v126, v23
v_fmac_f32 v127, v23, v23
v_add_f32 v134, v134, v32
v_fmac_f32 v135, v32, v32
v_add_f32 v134, v134, v33
v_fmac_f32 v135, v33, v33
v_add_f32 v134, v134, v34
v_fmac_f32 v135, v34, v34
v_add_f32 v134, v134, v35
v_fmac_f32 v135, v35, v35
v_permlane16_swap_b32 v118, v119
v_add_f32 v118, v118, v119
v_permlane16_swap_b32 v126, v127
v_add_f32 v126, v126, v127
v_permlane16_swap_b32 v134, v135
v_add_f32 v134, v134, v135
v_permlane32_swap_b32 v118, v126
v_add_f32 v118, v118, v126
ds_write_b32 v209, v118
v_mov_b32 v135, v134
s_nop 1
v_permlane32_swap_b32 v134, v135
v_add_f32 v134, v134, v135
ds_write_b32 v209, v134 offset:512
s_waitcnt lgkmcnt(0)
s_barrier
s_mov_b32 s37, s50
v_and_b32 v180, s44, v208
s_add_u32 m0, s45, 0
s_nop 0
buffer_load_dwordx4 v180, s[4:7], s52 offen nt lds
s_add_u32 m0, s45, 4112
s_add_u32 s40, s37, 196224
buffer_load_dwordx4 v180, s[4:7], s40 offen nt lds
s_add_u32 m0, s45, 8224
s_add_u32 s40, s37, 392448
buffer_load_dwordx4 v180, s[4:7], s40 offen nt lds
s_add_u32 m0, s45, 12336
s_add_u32 s40, s37, 588672
buffer_load_dwordx4 v180, s[4:7], s40 offen nt lds
s_add_u32 m0, s45, 16448
s_add_u32 s40, s37, 784896
buffer_load_dwordx4 v180, s[4:7], s40 offen nt lds
s_add_u32 m0, s45, 20560
s_add_u32 s40, s37, 981120
buffer_load_dwordx4 v180, s[4:7], s40 offen nt lds
s_add_u32 m0, s45, 24672
s_add_u32 s40, s37, 1177344
buffer_load_dwordx4 v180, s[4:7], s40 offen nt lds
s_add_u32 m0, s45, 28784
s_add_u32 s40, s37, 1373568
buffer_load_dwordx4 v180, s[4:7], s40 offen nt lds
s_add_u32 m0, s45, 32896
s_add_u32 s40, s37, 1569792
buffer_load_dwordx4 v180, s[4:7], s40 offen nt lds
s_mul_hi_u32 s41, s35, 58835169
s_mul_i32 s42, s41, 73
s_sub_u32 s42, s35, s42
s_mul_i32 s43, s41, 1373568
s_mul_i32 s51, s42, 2688
s_add_u32 s43, s43, s51
s_cmp_lt_u32 s35, s34
s_cselect_b32 s50, s43, 1879048192
s_add_u32 s35, s35, 32
s_cmp_eq_u32 s42, 0
s_cselect_b32 s44, 536870911, s72
s_cmp_eq_u32 s42, 72
s_cselect_b32 s44, 939524095, s44
s_cmp_eq_u32 s41, 0
s_cselect_b32 s52, 1879048192, s50
ds_read_b128 v[102:105], v210 offset:55296
ds_read_b128 v[106:109], v210 offset:56320
s_waitcnt lgkmcnt(1)
v_add_f32 v102, v102, v103
s_waitcnt lgkmcnt(0)
v_add_f32 v106, v106, v107
v_add_f32 v104, v104, v105
v_add_f32 v108, v108, v109
v_add_f32 v102, v102, v104
v_add_f32 v106, v106, v108
v_mul_f32 v103, s48, v102
v_mul_f32 v104, s73, v102
v_mul_f32 v106, s73, v106
v_fma_f32 v106, -v103, v104, v106
v_max_f32 v106, 0, v106
v_add_f32 v106, s49, v106
v_rsq_f32 v102, v106
s_nop 0
v_mul_f32_e64 v103, -v103, v102
ds_write_b64 v211, v[102:103] offset:36864
ds_read_b64 v[118:119], v219
ds_read_b64 v[126:127], v219 offset:256
ds_read_b64 v[134:135], v219 offset:512
s_waitcnt lgkmcnt(2)
v_fma_f32 v220, v0, v118, v119
v_fma_f32 v221, v1, v118, v119
v_cvt_pk_bf16_f32 v90, v220, v221
v_fma_f32 v222, v2, v118, v119
v_fma_f32 v223, v3, v118, v119
v_cvt_pk_bf16_f32 v91, v222, v223
v_fma_f32 v220, v4, v118, v119
v_fma_f32 v221, v5, v118, v119
v_cvt_pk_bf16_f32 v92, v220, v221
v_fma_f32 v222, v6, v118, v119
v_fma_f32 v223, v7, v118, v119
v_cvt_pk_bf16_f32 v93, v222, v223
ds_write_b128 v211, v[90:93]
v_fma_f32 v220, v8, v118, v119
v_fma_f32 v221, v9, v118, v119
v_cvt_pk_bf16_f32 v94, v220, v221
v_fma_f32 v222, v10, v118, v119
v_fma_f32 v223, v11, v118, v119
v_cvt_pk_bf16_f32 v95, v222, v223
s_waitcnt lgkmcnt(2)
ds_write_b64 v212, v[94:95]
v_fma_f32 v220, v12, v126, v127
v_fma_f32 v221, v13, v126, v127
v_cvt_pk_bf16_f32 v174, v220, v221
v_fma_f32 v222, v14, v126, v127
v_fma_f32 v223, v15, v126, v127
v_cvt_pk_bf16_f32 v175, v222, v223
v_fma_f32 v220, v16, v126, v127
v_fma_f32 v221, v17, v126, v127
v_cvt_pk_bf16_f32 v176, v220, v221
v_fma_f32 v222, v18, v126, v127
v_fma_f32 v223, v19, v126, v127
v_cvt_pk_bf16_f32 v177, v222, v223
ds_write_b128 v211, v[174:177] offset:6144
v_fma_f32 v220, v20, v126, v127
v_fma_f32 v221, v21, v126, v127
v_cvt_pk_bf16_f32 v178, v220, v221
v_fma_f32 v222, v22, v126, v127
v_fma_f32 v223, v23, v126, v127
v_cvt_pk_bf16_f32 v179, v222, v223
s_waitcnt lgkmcnt(3)
ds_write_b64 v212, v[178:179] offset:6144
v_fma_f32 v220, v24, v134, v135
v_fma_f32 v221, v25, v134, v135
v_cvt_pk_bf16_f32 v90, v220, v221
v_fma_f32 v222, v26, v134, v135
v_fma_f32 v223, v27, v134, v135
v_cvt_pk_bf16_f32 v91, v222, v223
v_fma_f32 v220, v28, v134, v135
v_fma_f32 v221, v29, v134, v135
v_cvt_pk_bf16_f32 v92, v220, v221
v_fma_f32 v222, v30, v134, v135
v_fma_f32 v223, v31, v134, v135
v_cvt_pk_bf16_f32 v93, v222, v223
ds_write_b128 v211, v[90:93] offset:12288
v_fma_f32 v220, v32, v134, v135
v_fma_f32 v221, v33, v134, v135
v_cvt_pk_bf16_f32 v94, v220, v221
v_fma_f32 v222, v34, v134, v135
v_fma_f32 v223, v35, v134, v135
v_cvt_pk_bf16_f32 v95, v222, v223
ds_write_b64 v212, v[94:95] offset:12288
ds_read_b128 v[182:185], v210 offset:18432
s_waitcnt lgkmcnt(0)
v_mfma_f32_16x16x32_bf16 v[138:141], a[0:3], v[182:185], 0
v_mfma_f32_16x16x32_bf16 v[142:145], a[24:27], v[182:185], 0
v_mfma_f32_16x16x32_bf16 v[146:149], a[48:51], v[182:185], 0
v_mfma_f32_16x16x32_bf16 v[150:153], a[216:219], v[182:185], 0
v_mfma_f32_16x16x32_bf16 v[154:157], a[240:243], v[182:185], 0
v_mfma_f32_16x16x32_bf16 v[158:161], v[232:235], v[182:185], 0
v_mfma_f32_16x16x32_bf16 v[162:165], v[182:185], a[72:75], 0
v_mfma_f32_16x16x32_bf16 v[166:169], v[182:185], a[96:99], 0
v_mfma_f32_16x16x32_bf16 v[170:173], v[182:185], a[120:123], 0
ds_read_b128 v[186:189], v210 offset:19456
s_waitcnt lgkmcnt(0)
v_mfma_f32_16x16x32_bf16 v[138:141], a[4:7], v[186:189], v[138:141]
v_mfma_f32_16x16x32_bf16 v[142:145], a[28:31], v[186:189], v[142:145]
v_mfma_f32_16x16x32_bf16 v[146:149], a[52:55], v[186:189], v[146:149]
v_mfma_f32_16x16x32_bf16 v[150:153], a[220:223], v[186:189], v[150:153]
v_mfma_f32_16x16x32_bf16 v[154:157], a[244:247], v[186:189], v[154:157]
v_mfma_f32_16x16x32_bf16 v[158:161], v[236:239], v[186:189], v[158:161]
v_mfma_f32_16x16x32_bf16 v[162:165], v[186:189], a[76:79], v[162:165]
v_mfma_f32_16x16x32_bf16 v[166:169], v[186:189], a[100:103], v[166:169]
v_mfma_f32_16x16x32_bf16 v[170:173], v[186:189], a[124:127], v[170:173]
ds_read_b128 v[182:185], v210 offset:20480
s_waitcnt lgkmcnt(0)
v_mfma_f32_16x16x32_bf16 v[138:141], a[8:11], v[182:185], v[138:141]
v_mfma_f32_16x16x32_bf16 v[142:145], a[32:35], v[182:185], v[142:145]
v_mfma_f32_16x16x32_bf16 v[146:149], a[56:59], v[182:185], v[146:149]
v_mfma_f32_16x16x32_bf16 v[150:153], a[224:227], v[182:185], v[150:153]
v_mfma_f32_16x16x32_bf16 v[154:157], a[248:251], v[182:185], v[154:157]
v_mfma_f32_16x16x32_bf16 v[158:161], v[240:243], v[182:185], v[158:161]
v_mfma_f32_16x16x32_bf16 v[162:165], v[182:185], a[80:83], v[162:165]
v_mfma_f32_16x16x32_bf16 v[166:169], v[182:185], a[104:107], v[166:169]
v_mfma_f32_16x16x32_bf16 v[170:173], v[182:185], a[128:131], v[170:173]
ds_read_b128 v[186:189], v210 offset:21504
s_waitcnt lgkmcnt(0)
v_mfma_f32_16x16x32_bf16 v[138:141], a[12:15], v[186:189], v[138:141]
v_mfma_f32_16x16x32_bf16 v[142:145], a[36:39], v[186:189], v[142:145]
v_mfma_f32_16x16x32_bf16 v[146:149], a[60:63], v[186:189], v[146:149]
v_mfma_f32_16x16x32_bf16 v[150:153], a[228:231], v[186:189], v[150:153]
v_mfma_f32_16x16x32_bf16 v[154:157], a[252:255], v[186:189], v[154:157]
v_mfma_f32_16x16x32_bf16 v[158:161], v[244:247], v[186:189], v[158:161]
v_mfma_f32_16x16x32_bf16 v[162:165], v[186:189], a[84:87], v[162:165]
v_mfma_f32_16x16x32_bf16 v[166:169], v[186:189], a[108:111], v[166:169]
v_mfma_f32_16x16x32_bf16 v[170:173], v[186:189], a[132:135], v[170:173]
ds_read_b128 v[182:185], v210 offset:22528
s_waitcnt lgkmcnt(0)
v_mfma_f32_16x16x32_bf16 v[138:141], a[16:19], v[182:185], v[138:141]
v_mfma_f32_16x16x32_bf16 v[142:145], a[40:43], v[182:185], v[142:145]
v_mfma_f32_16x16x32_bf16 v[146:149], a[64:67], v[182:185], v[146:149]
v_mfma_f32_16x16x32_bf16 v[150:153], a[232:235], v[182:185], v[150:153]
v_mfma_f32_16x16x32_bf16 v[154:157], v[224:227], v[182:185], v[154:157]
v_mfma_f32_16x16x32_bf16 v[158:161], v[248:251], v[182:185], v[158:161]
v_mfma_f32_16x16x32_bf16 v[162:165], v[182:185], a[88:91], v[162:165]
v_mfma_f32_16x16x32_bf16 v[166:169], v[182:185], a[112:115], v[166:169]
v_mfma_f32_16x16x32_bf16 v[170:173], v[182:185], a[136:139], v[170:173]
ds_read_b128 v[186:189], v210 offset:23552
s_waitcnt lgkmcnt(0)
v_mfma_f32_16x16x32_bf16 v[138:141], a[20:23], v[186:189], v[138:141]
v_mfma_f32_16x16x32_bf16 v[142:145], a[44:47], v[186:189], v[142:145]
v_mfma_f32_16x16x32_bf16 v[146:149], a[68:71], v[186:189], v[146:149]
v_mfma_f32_16x16x32_bf16 v[150:153], a[236:239], v[186:189], v[150:153]
v_mfma_f32_16x16x32_bf16 v[154:157], v[228:231], v[186:189], v[154:157]
v_mfma_f32_16x16x32_bf16 v[158:161], v[252:255], v[186:189], v[158:161]
v_mfma_f32_16x16x32_bf16 v[162:165], v[186:189], a[92:95], v[162:165]
v_mfma_f32_16x16x32_bf16 v[166:169], v[186:189], a[116:119], v[166:169]
v_mfma_f32_16x16x32_bf16 v[170:173], v[186:189], a[140:143], v[170:173]
v_cvt_pk_bf16_f32 v78, v138, v139
v_cvt_pk_bf16_f32 v79, v140, v141
v_cvt_pk_bf16_f32 v80, v142, v143
v_cvt_pk_bf16_f32 v81, v144, v145
v_cvt_pk_bf16_f32 v82, v146, v147
v_cvt_pk_bf16_f32 v83, v148, v149
v_cvt_pk_bf16_f32 v72, v150, v151
v_cvt_pk_bf16_f32 v73, v152, v153
v_cvt_pk_bf16_f32 v74, v154, v155
v_cvt_pk_bf16_f32 v75, v156, v157
v_cvt_pk_bf16_f32 v76, v158, v159
v_cvt_pk_bf16_f32 v77, v160, v161
v_cvt_pk_bf16_f32 v114, v162, v163
v_cvt_pk_bf16_f32 v115, v164, v165
v_cvt_pk_bf16_f32 v122, v166, v167
v_cvt_pk_bf16_f32 v123, v168, v169
v_cvt_pk_bf16_f32 v130, v170, v171
v_cvt_pk_bf16_f32 v131, v172, v173
ds_read_b128 v[182:185], v210 offset:24576
s_waitcnt lgkmcnt(0)
v_mfma_f32_16x16x32_bf16 v[138:141], a[0:3], v[182:185], 0
v_mfma_f32_16x16x32_bf16 v[142:145], a[24:27], v[182:185], 0
v_mfma_f32_16x16x32_bf16 v[146:149], a[48:51], v[182:185], 0
v_mfma_f32_16x16x32_bf16 v[150:153], a[216:219], v[182:185], 0
v_mfma_f32_16x16x32_bf16 v[154:157], a[240:243], v[182:185], 0
v_mfma_f32_16x16x32_bf16 v[158:161], v[232:235], v[182:185], 0
v_mfma_f32_16x16x32_bf16 v[162:165], v[182:185], a[72:75], 0
v_mfma_f32_16x16x32_bf16 v[166:169], v[182:185], a[96:99], 0
v_mfma_f32_16x16x32_bf16 v[170:173], v[182:185], a[120:123], 0
ds_read_b128 v[186:189], v210 offset:25600
s_waitcnt lgkmcnt(0)
v_mfma_f32_16x16x32_bf16 v[138:141], a[4:7], v[186:189], v[138:141]
v_mfma_f32_16x16x32_bf16 v[142:145], a[28:31], v[186:189], v[142:145]
v_mfma_f32_16x16x32_bf16 v[146:149], a[52:55], v[186:189], v[146:149]
v_mfma_f32_16x16x32_bf16 v[150:153], a[220:223], v[186:189], v[150:153]
v_mfma_f32_16x16x32_bf16 v[154:157], a[244:247], v[186:189], v[154:157]
v_mfma_f32_16x16x32_bf16 v[158:161], v[236:239], v[186:189], v[158:161]
v_mfma_f32_16x16x32_bf16 v[162:165], v[186:189], a[76:79], v[162:165]
v_mfma_f32_16x16x32_bf16 v[166:169], v[186:189], a[100:103], v[166:169]
v_mfma_f32_16x16x32_bf16 v[170:173], v[186:189], a[124:127], v[170:173]
ds_read_b128 v[182:185], v210 offset:26624
s_waitcnt lgkmcnt(0)
v_mfma_f32_16x16x32_bf16 v[138:141], a[8:11], v[182:185], v[138:141]
v_mfma_f32_16x16x32_bf16 v[142:145], a[32:35], v[182:185], v[142:145]
v_mfma_f32_16x16x32_bf16 v[146:149], a[56:59], v[182:185], v[146:149]
v_mfma_f32_16x16x32_bf16 v[150:153], a[224:227], v[182:185], v[150:153]
v_mfma_f32_16x16x32_bf16 v[154:157], a[248:251], v[182:185], v[154:157]
v_mfma_f32_16x16x32_bf16 v[158:161], v[240:243], v[182:185], v[158:161]
v_mfma_f32_16x16x32_bf16 v[162:165], v[182:185], a[80:83], v[162:165]
v_mfma_f32_16x16x32_bf16 v[166:169], v[182:185], a[104:107], v[166:169]
v_mfma_f32_16x16x32_bf16 v[170:173], v[182:185], a[128:131], v[170:173]
ds_read_b128 v[186:189], v210 offset:27648
s_waitcnt lgkmcnt(0)
v_mfma_f32_16x16x32_bf16 v[138:141], a[12:15], v[186:189], v[138:141]
v_mfma_f32_16x16x32_bf16 v[142:145], a[36:39], v[186:189], v[142:145]
v_mfma_f32_16x16x32_bf16 v[146:149], a[60:63], v[186:189], v[146:149]
v_mfma_f32_16x16x32_bf16 v[150:153], a[228:231], v[186:189], v[150:153]
v_mfma_f32_16x16x32_bf16 v[154:157], a[252:255], v[186:189], v[154:157]
v_mfma_f32_16x16x32_bf16 v[158:161], v[244:247], v[186:189], v[158:161]
v_mfma_f32_16x16x32_bf16 v[162:165], v[186:189], a[84:87], v[162:165]
v_mfma_f32_16x16x32_bf16 v[166:169], v[186:189], a[108:111], v[166:169]
v_mfma_f32_16x16x32_bf16 v[170:173], v[186:189], a[132:135], v[170:173]
ds_read_b128 v[182:185], v210 offset:28672
s_waitcnt lgkmcnt(0)
v_mfma_f32_16x16x32_bf16 v[138:141], a[16:19], v[182:185], v[138:141]
v_mfma_f32_16x16x32_bf16 v[142:145], a[40:43], v[182:185], v[142:145]
v_mfma_f32_16x16x32_bf16 v[146:149], a[64:67], v[182:185], v[146:149]
v_mfma_f32_16x16x32_bf16 v[150:153], a[232:235], v[182:185], v[150:153]
v_mfma_f32_16x16x32_bf16 v[154:157], v[224:227], v[182:185], v[154:157]
v_mfma_f32_16x16x32_bf16 v[158:161], v[248:251], v[182:185], v[158:161]
v_mfma_f32_16x16x32_bf16 v[162:165], v[182:185], a[88:91], v[162:165]
v_mfma_f32_16x16x32_bf16 v[166:169], v[182:185], a[112:115], v[166:169]
v_mfma_f32_16x16x32_bf16 v[170:173], v[182:185], a[136:139], v[170:173]
ds_read_b128 v[186:189], v210 offset:29696
s_waitcnt lgkmcnt(0)
v_mfma_f32_16x16x32_bf16 v[138:141], a[20:23], v[186:189], v[138:141]
v_mfma_f32_16x16x32_bf16 v[142:145], a[44:47], v[186:189], v[142:145]
v_mfma_f32_16x16x32_bf16 v[146:149], a[68:71], v[186:189], v[146:149]
v_mfma_f32_16x16x32_bf16 v[150:153], a[236:239], v[186:189], v[150:153]
v_mfma_f32_16x16x32_bf16 v[154:157], v[228:231], v[186:189], v[154:157]
v_mfma_f32_16x16x32_bf16 v[158:161], v[252:255], v[186:189], v[158:161]
v_mfma_f32_16x16x32_bf16 v[162:165], v[186:189], a[92:95], v[162:165]
v_mfma_f32_16x16x32_bf16 v[166:169], v[186:189], a[116:119], v[166:169]
v_mfma_f32_16x16x32_bf16 v[170:173], v[186:189], a[140:143], v[170:173]
v_cvt_pk_bf16_f32 v96, v138, v139
v_cvt_pk_bf16_f32 v97, v140, v141
v_cvt_pk_bf16_f32 v98, v142, v143
v_cvt_pk_bf16_f32 v99, v144, v145
v_cvt_pk_bf16_f32 v100, v146, v147
v_cvt_pk_bf16_f32 v101, v148, v149
v_cvt_pk_bf16_f32 v84, v150, v151
v_cvt_pk_bf16_f32 v85, v152, v153
v_cvt_pk_bf16_f32 v86, v154, v155
v_cvt_pk_bf16_f32 v87, v156, v157
v_cvt_pk_bf16_f32 v88, v158, v159
v_cvt_pk_bf16_f32 v89, v160, v161
v_cvt_pk_bf16_f32 v116, v162, v163
v_cvt_pk_bf16_f32 v117, v164, v165
v_cvt_pk_bf16_f32 v124, v166, v167
v_cvt_pk_bf16_f32 v125, v168, v169
v_cvt_pk_bf16_f32 v132, v170, v171
v_cvt_pk_bf16_f32 v133, v172, v173
ds_read_b128 v[182:185], v210 offset:30720
s_waitcnt lgkmcnt(0)
v_mfma_f32_16x16x32_bf16 v[138:141], a[0:3], v[182:185], 0
v_mfma_f32_16x16x32_bf16 v[142:145], a[24:27], v[182:185], 0
v_mfma_f32_16x16x32_bf16 v[146:149], a[48:51], v[182:185], 0
ds_read_b128 v[186:189], v210 offset:31744
s_waitcnt lgkmcnt(0)
v_mfma_f32_16x16x32_bf16 v[138:141], a[4:7], v[186:189], v[138:141]
v_mfma_f32_16x16x32_bf16 v[142:145], a[28:31], v[186:189], v[142:145]
v_mfma_f32_16x16x32_bf16 v[146:149], a[52:55], v[186:189], v[146:149]
ds_read_b128 v[182:185], v210 offset:32768
s_waitcnt lgkmcnt(0)
v_mfma_f32_16x16x32_bf16 v[138:141], a[8:11], v[182:185], v[138:141]
v_mfma_f32_16x16x32_bf16 v[142:145], a[32:35], v[182:185], v[142:145]
v_mfma_f32_16x16x32_bf16 v[146:149], a[56:59], v[182:185], v[146:149]
ds_read_b128 v[186:189], v210 offset:33792
s_waitcnt lgkmcnt(0)
v_mfma_f32_16x16x32_bf16 v[138:141], a[12:15], v[186:189], v[138:141]
v_mfma_f32_16x16x32_bf16 v[142:145], a[36:39], v[186:189], v[142:145]
v_mfma_f32_16x16x32_bf16 v[146:149], a[60:63], v[186:189], v[146:149]
ds_read_b128 v[182:185], v210 offset:34816
s_waitcnt lgkmcnt(0)
v_mfma_f32_16x16x32_bf16 v[138:141], a[16:19], v[182:185], v[138:141]
v_mfma_f32_16x16x32_bf16 v[142:145], a[40:43], v[182:185], v[142:145]
v_mfma_f32_16x16x32_bf16 v[146:149], a[64:67], v[182:185], v[146:149]
ds_read_b128 v[186:189], v210 offset:35840
s_waitcnt lgkmcnt(0)
v_mfma_f32_16x16x32_bf16 v[138:141], a[20:23], v[186:189], v[138:141]
v_mfma_f32_16x16x32_bf16 v[142:145], a[44:47], v[186:189], v[142:145]
v_mfma_f32_16x16x32_bf16 v[146:149], a[68:71], v[186:189], v[146:149]
v_cvt_pk_bf16_f32 v102, v138, v139
v_cvt_pk_bf16_f32 v103, v140, v141
s_nop 0
v_cvt_pk_bf16_f32 v104, v142, v143
v_cvt_pk_bf16_f32 v105, v144, v145
s_nop 1
v_cvt_pk_bf16_f32 v106, v146, v147
v_cvt_pk_bf16_f32 v107, v148, v149
ds_read_b128 v[108:111], v215 offset:512
ds_read_b64 v[112:113], v215 offset:528
v_mov_b32 v181, 0
v_mfma_f32_16x16x16_bf16 v[138:141], v[82:83], v[76:77], 0
v_mfma_f32_16x16x16_bf16 v[142:145], v[100:101], v[76:77], 0
s_waitcnt lgkmcnt(0)
v_mfma_f32_16x16x16_bf16 v[150:153], v[112:113], v[76:77], v[206:209]
v_mfma_f32_16x16x16_bf16 v[146:149], v[106:107], v[76:77], 0
v_mfma_f32_16x16x32_bf16 v[138:141], v[78:81], v[72:75], v[138:141]
v_mfma_f32_16x16x32_bf16 v[142:145], v[96:99], v[72:75], v[142:145]
v_mfma_f32_16x16x32_bf16 v[150:153], v[108:111], v[72:75], v[150:153]
v_mfma_f32_16x16x32_bf16 v[146:149], v[102:105], v[72:75], v[146:149]
ds_read_b128 v[72:75], v215
ds_read_b64 v[76:77], v215 offset:16
v_mfma_f32_16x16x16_bf16 v[154:157], v[82:83], v[88:89], 0
v_mfma_f32_16x16x16_bf16 v[158:161], v[100:101], v[88:89], 0
v_mfma_f32_16x16x16_bf16 v[166:169], v[112:113], v[88:89], v[206:209]
v_mfma_f32_16x16x16_bf16 v[162:165], v[106:107], v[88:89], 0
v_mfma_f32_16x16x32_bf16 v[154:157], v[78:81], v[84:87], v[154:157]
v_mfma_f32_16x16x32_bf16 v[158:161], v[96:99], v[84:87], v[158:161]
v_mfma_f32_16x16x32_bf16 v[166:169], v[108:111], v[84:87], v[166:169]
v_mfma_f32_16x16x32_bf16 v[162:165], v[102:105], v[84:87], v[162:165]
ds_read_b128 v[182:185], v210 offset:30720
s_waitcnt lgkmcnt(0)
v_mfma_f32_16x16x32_bf16 v[118:121], v[182:185], a[72:75], 0
v_mfma_f32_16x16x32_bf16 v[126:129], v[182:185], a[96:99], 0
v_mfma_f32_16x16x32_bf16 v[134:137], v[182:185], a[120:123], 0
v_mfma_f32_16x16x32_bf16 v[90:93], a[216:219], v[182:185], 0
v_mfma_f32_16x16x32_bf16 v[170:173], a[240:243], v[182:185], 0
v_mfma_f32_16x16x32_bf16 v[220:223], v[232:235], v[182:185], 0
ds_read_b128 v[186:189], v210 offset:31744
s_waitcnt lgkmcnt(0)
v_mfma_f32_16x16x32_bf16 v[118:121], v[186:189], a[76:79], v[118:121]
v_mfma_f32_16x16x32_bf16 v[126:129], v[186:189], a[100:103], v[126:129]
v_mfma_f32_16x16x32_bf16 v[134:137], v[186:189], a[124:127], v[134:137]
v_mfma_f32_16x16x32_bf16 v[90:93], a[220:223], v[186:189], v[90:93]
v_mfma_f32_16x16x32_bf16 v[170:173], a[244:247], v[186:189], v[170:173]
v_mfma_f32_16x16x32_bf16 v[220:223], v[236:239], v[186:189], v[220:223]
ds_read_b128 v[182:185], v210 offset:32768
s_waitcnt lgkmcnt(0)
v_mfma_f32_16x16x32_bf16 v[118:121], v[182:185], a[80:83], v[118:121]
v_mfma_f32_16x16x32_bf16 v[126:129], v[182:185], a[104:107], v[126:129]
v_mfma_f32_16x16x32_bf16 v[134:137], v[182:185], a[128:131], v[134:137]
v_mfma_f32_16x16x32_bf16 v[90:93], a[224:227], v[182:185], v[90:93]
v_mfma_f32_16x16x32_bf16 v[170:173], a[248:251], v[182:185], v[170:173]
v_mfma_f32_16x16x32_bf16 v[220:223], v[240:243], v[182:185], v[220:223]
ds_read_b128 v[186:189], v210 offset:33792
s_waitcnt lgkmcnt(0)
v_mfma_f32_16x16x32_bf16 v[118:121], v[186:189], a[84:87], v[118:121]
v_mfma_f32_16x16x32_bf16 v[126:129], v[186:189], a[108:111], v[126:129]
v_mfma_f32_16x16x32_bf16 v[134:137], v[186:189], a[132:135], v[134:137]
v_mfma_f32_16x16x32_bf16 v[90:93], a[228:231], v[186:189], v[90:93]
v_mfma_f32_16x16x32_bf16 v[170:173], a[252:255], v[186:189], v[170:173]
v_mfma_f32_16x16x32_bf16 v[220:223], v[244:247], v[186:189], v[220:223]
ds_read_b128 v[182:185], v210 offset:34816
s_waitcnt lgkmcnt(0)
v_mfma_f32_16x16x32_bf16 v[118:121], v[182:185], a[88:91], v[118:121]
v_mfma_f32_16x16x32_bf16 v[126:129], v[182:185], a[112:115], v[126:129]
v_mfma_f32_16x16x32_bf16 v[134:137], v[182:185], a[136:139], v[134:137]
v_mfma_f32_16x16x32_bf16 v[90:93], a[232:235], v[182:185], v[90:93]
v_mfma_f32_16x16x32_bf16 v[170:173], v[224:227], v[182:185], v[170:173]
v_mfma_f32_16x16x32_bf16 v[220:223], v[248:251], v[182:185], v[220:223]
ds_read_b128 v[186:189], v210 offset:35840
s_waitcnt lgkmcnt(0)
v_mfma_f32_16x16x32_bf16 v[118:121], v[186:189], a[92:95], v[118:121]
v_mfma_f32_16x16x32_bf16 v[126:129], v[186:189], a[116:119], v[126:129]
v_mfma_f32_16x16x32_bf16 v[134:137], v[186:189], a[140:143], v[134:137]
v_mfma_f32_16x16x32_bf16 v[90:93], a[236:239], v[186:189], v[90:93]
v_mfma_f32_16x16x32_bf16 v[170:173], v[228:231], v[186:189], v[170:173]
v_mfma_f32_16x16x32_bf16 v[220:223], v[252:255], v[186:189], v[220:223]
v_cvt_pk_bf16_f32 v118, v118, v119
v_cvt_pk_bf16_f32 v119, v120, v121
ds_read_u16 v120, v214 offset:1024
v_mov_b32 v121, 0
v_cvt_pk_bf16_f32 v126, v126, v127
v_cvt_pk_bf16_f32 v127, v128, v129
ds_read_u16 v128, v214 offset:1032
v_mov_b32 v129, 0
v_cvt_pk_bf16_f32 v134, v134, v135
v_cvt_pk_bf16_f32 v135, v136, v137
ds_read_u16 v136, v214 offset:1040
v_mov_b32 v137, 0
v_cvt_pk_bf16_f32 v90, v90, v91
v_cvt_pk_bf16_f32 v91, v92, v93
v_cvt_pk_bf16_f32 v92, v170, v171
v_cvt_pk_bf16_f32 v93, v172, v173
v_cvt_pk_bf16_f32 v94, v220, v221
v_cvt_pk_bf16_f32 v95, v222, v223
v_max3_f32 v151, v138, v139, v140
v_max3_f32 v151, v151, v141, v142
v_max3_f32 v151, v151, v143, v144
v_max3_f32 v151, v151, v145, v146
v_max3_f32 v151, v151, v147, v148
v_max3_f32 v151, v151, v149, v150
v_mov_b32 v152, v151
s_nop 1
v_permlane16_swap_b32 v151, v152
v_max_f32 v151, v151, v152
v_mov_b32 v152, v151
s_nop 1
v_permlane32_swap_b32 v151, v152
v_max_f32 v151, v151, v152
v_sub_f32 v138, v138, v151
v_sub_f32 v139, v139, v151
v_sub_f32 v140, v140, v151
v_sub_f32 v141, v141, v151
v_sub_f32 v142, v142, v151
v_sub_f32 v143, v143, v151
v_sub_f32 v144, v144, v151
v_sub_f32 v145, v145, v151
v_sub_f32 v150, v150, v151
v_sub_f32 v146, v146, v151
v_sub_f32 v147, v147, v151
v_sub_f32 v148, v148, v151
v_sub_f32 v149, v149, v151
v_exp_f32 v138, v138
v_exp_f32 v139, v139
v_exp_f32 v140, v140
v_exp_f32 v141, v141
v_exp_f32 v142, v142
v_exp_f32 v143, v143
v_exp_f32 v144, v144
v_exp_f32 v145, v145
v_exp_f32 v150, v150
v_exp_f32 v146, v146
v_exp_f32 v147, v147
v_exp_f32 v148, v148
v_exp_f32 v149, v149
v_cvt_pk_bf16_f32 v174, v138, v139
v_cvt_pk_bf16_f32 v175, v140, v141
v_cvt_pk_bf16_f32 v176, v142, v143
v_cvt_pk_bf16_f32 v177, v144, v145
v_cvt_pk_bf16_f32 v178, v146, v147
v_cvt_pk_bf16_f32 v179, v148, v149
v_cvt_pk_bf16_f32 v180, v150, 0
v_mfma_f32_16x16x32_bf16 v[150:153], v[190:193], v[174:177], 0
v_mfma_f32_16x16x32_bf16 v[138:141], v[114:117], v[174:177], 0
v_mfma_f32_16x16x32_bf16 v[142:145], v[122:125], v[174:177], 0
v_mfma_f32_16x16x32_bf16 v[146:149], v[130:133], v[174:177], 0
v_mfma_f32_16x16x32_bf16 v[150:153], v[190:193], v[178:181], v[150:153]
s_waitcnt lgkmcnt(2)
v_mfma_f32_16x16x32_bf16 v[138:141], v[118:121], v[178:181], v[138:141]
s_waitcnt lgkmcnt(1)
v_mfma_f32_16x16x32_bf16 v[142:145], v[126:129], v[178:181], v[142:145]
s_waitcnt lgkmcnt(0)
v_mfma_f32_16x16x32_bf16 v[146:149], v[134:137], v[178:181], v[146:149]
v_max3_f32 v167, v154, v155, v156
v_max3_f32 v167, v167, v157, v158
v_max3_f32 v167, v167, v159, v160
v_max3_f32 v167, v167, v161, v162
v_max3_f32 v167, v167, v163, v164
v_max3_f32 v167, v167, v165, v166
v_mov_b32 v168, v167
s_nop 1
v_permlane16_swap_b32 v167, v168
v_max_f32 v167, v167, v168
v_mov_b32 v168, v167
s_nop 1
v_permlane32_swap_b32 v167, v168
v_max_f32 v167, v167, v168
v_sub_f32 v154, v154, v167
v_sub_f32 v155, v155, v167
v_sub_f32 v156, v156, v167
v_sub_f32 v157, v157, v167
v_sub_f32 v158, v158, v167
v_sub_f32 v159, v159, v167
v_sub_f32 v160, v160, v167
v_sub_f32 v161, v161, v167
v_sub_f32 v166, v166, v167
v_sub_f32 v162, v162, v167
v_sub_f32 v163, v163, v167
v_sub_f32 v164, v164, v167
v_sub_f32 v165, v165, v167
v_exp_f32 v154, v154
v_exp_f32 v155, v155
v_exp_f32 v156, v156
v_exp_f32 v157, v157
v_exp_f32 v158, v158
v_exp_f32 v159, v159
v_exp_f32 v160, v160
v_exp_f32 v161, v161
v_exp_f32 v166, v166
v_exp_f32 v162, v162
v_exp_f32 v163, v163
v_exp_f32 v164, v164
v_exp_f32 v165, v165
v_cvt_pk_bf16_f32 v174, v154, v155
v_cvt_pk_bf16_f32 v175, v156, v157
v_cvt_pk_bf16_f32 v176, v158, v159
v_cvt_pk_bf16_f32 v177, v160, v161
v_cvt_pk_bf16_f32 v178, v162, v163
v_cvt_pk_bf16_f32 v179, v164, v165
v_cvt_pk_bf16_f32 v180, v166, 0
v_mfma_f32_16x16x32_bf16 v[166:169], v[190:193], v[174:177], 0
v_mfma_f32_16x16x32_bf16 v[154:157], v[114:117], v[174:177], 0
v_mfma_f32_16x16x32_bf16 v[158:161], v[122:125], v[174:177], 0
v_mfma_f32_16x16x32_bf16 v[162:165], v[130:133], v[174:177], 0
v_mfma_f32_16x16x32_bf16 v[166:169], v[190:193], v[178:181], v[166:169]
v_mfma_f32_16x16x32_bf16 v[154:157], v[118:121], v[178:181], v[154:157]
v_mfma_f32_16x16x32_bf16 v[158:161], v[126:129], v[178:181], v[158:161]
v_mfma_f32_16x16x32_bf16 v[162:165], v[134:137], v[178:181], v[162:165]
v_rcp_f32 v151, v150
s_nop 0
v_mul_f32 v151, s3, v151
v_mul_f32 v138, v138, v151
v_mul_f32 v139, v139, v151
v_cvt_pk_bf16_f32 v138, v138, v139
v_mul_f32 v140, v140, v151
v_mul_f32 v141, v141, v151
v_cvt_pk_bf16_f32 v139, v140, v141
v_mul_f32 v142, v142, v151
v_mul_f32 v143, v143, v151
v_cvt_pk_bf16_f32 v140, v142, v143
v_mul_f32 v144, v144, v151
v_mul_f32 v145, v145, v151
v_cvt_pk_bf16_f32 v141, v144, v145
ds_write_b128 v211, v[138:141] offset:36864
v_mul_f32 v146, v146, v151
v_mul_f32 v147, v147, v151
v_cvt_pk_bf16_f32 v142, v146, v147
v_mul_f32 v148, v148, v151
v_mul_f32 v149, v149, v151
v_cvt_pk_bf16_f32 v143, v148, v149
ds_write_b64 v212, v[142:143] offset:36864
v_mfma_f32_16x16x32_bf16 v[138:141], v[78:81], v[90:93], 0
v_mfma_f32_16x16x32_bf16 v[142:145], v[96:99], v[90:93], 0
v_mfma_f32_16x16x32_bf16 v[150:153], v[108:111], v[90:93], v[206:209]
v_mfma_f32_16x16x32_bf16 v[146:149], v[102:105], v[90:93], 0
v_mfma_f32_16x16x16_bf16 v[138:141], v[82:83], v[94:95], v[138:141]
v_mfma_f32_16x16x16_bf16 v[142:145], v[100:101], v[94:95], v[142:145]
v_mfma_f32_16x16x16_bf16 v[150:153], v[112:113], v[94:95], v[150:153]
v_mfma_f32_16x16x16_bf16 v[146:149], v[106:107], v[94:95], v[146:149]
v_rcp_f32 v167, v166
s_nop 0
v_mul_f32 v167, s3, v167
v_mul_f32 v154, v154, v167
v_mul_f32 v155, v155, v167
v_cvt_pk_bf16_f32 v154, v154, v155
v_mul_f32 v156, v156, v167
v_mul_f32 v157, v157, v167
v_cvt_pk_bf16_f32 v155, v156, v157
v_mul_f32 v158, v158, v167
v_mul_f32 v159, v159, v167
v_cvt_pk_bf16_f32 v156, v158, v159
v_mul_f32 v160, v160, v167
v_mul_f32 v161, v161, v167
v_cvt_pk_bf16_f32 v157, v160, v161
ds_write_b128 v211, v[154:157] offset:43008
v_mul_f32 v162, v162, v167
v_mul_f32 v163, v163, v167
v_cvt_pk_bf16_f32 v158, v162, v163
v_mul_f32 v164, v164, v167
v_mul_f32 v165, v165, v167
v_cvt_pk_bf16_f32 v159, v164, v165
ds_write_b64 v212, v[158:159] offset:43008
v_mfma_f32_16x16x16_bf16 v[154:157], v[76:77], v[82:83], 0
v_mfma_f32_16x16x16_bf16 v[158:161], v[76:77], v[100:101], 0
v_mfma_f32_16x16x16_bf16 v[162:165], v[76:77], v[106:107], 0
v_mfma_f32_16x16x16_bf16 v[166:169], v[76:77], v[112:113], v[206:209]
v_mfma_f32_16x16x32_bf16 v[154:157], v[72:75], v[78:81], v[154:157]
v_mfma_f32_16x16x32_bf16 v[158:161], v[72:75], v[96:99], v[158:161]
v_mfma_f32_16x16x32_bf16 v[162:165], v[72:75], v[102:105], v[162:165]
v_mfma_f32_16x16x32_bf16 v[166:169], v[72:75], v[108:111], v[166:169]
v_mov_b32_dpp v154, v158 quad_perm:[0,1,2,3] row_mask:0x2 bank_mask:0xf
s_nop 1
v_mov_b32_dpp v154, v162 quad_perm:[0,1,2,3] row_mask:0x4 bank_mask:0xf
s_nop 2
v_mov_b32_dpp v154, v167 quad_perm:[0,1,2,3] row_mask:0x8 bank_mask:0xf
v_mov_b32 v155, v154
s_nop 1
v_max_f32_dpp v155, v155, v155 row_ror:8 row_mask:0xf bank_mask:0xf
s_nop 1
v_max_f32_dpp v155, v155, v155 row_ror:4 row_mask:0xf bank_mask:0xf
s_nop 1
v_max_f32_dpp v155, v155, v155 row_ror:2 row_mask:0xf bank_mask:0xf
s_nop 1
v_max_f32_dpp v155, v155, v155 row_ror:1 row_mask:0xf bank_mask:0xf
v_mov_b32 v156, v155
s_nop 1
v_permlane16_swap_b32 v155, v156
v_max_f32 v155, v155, v156
v_mov_b32 v156, v155
s_nop 1
v_permlane32_swap_b32 v155, v156
v_max_f32 v155, v155, v156
v_sub_f32 v154, v154, v155
v_exp_f32 v154, v154
s_nop 0
v_cvt_pk_bf16_f32 v154, v154, 0
ds_write_b16 v214, v154
s_waitcnt lgkmcnt(1)
ds_read_b128 v[84:87], v215
ds_read_b128 v[88:91], v215 offset:16
v_add_u32 v215, 1552, v215
s_barrier
ds_read_b128 v[170:173], v210 offset:36864
s_waitcnt lgkmcnt(0)
v_mfma_f32_16x16x32_bf16 v[36:39], a[144:147], v[170:173], v[36:39]
v_mfma_f32_16x16x32_bf16 v[40:43], a[168:171], v[170:173], v[40:43]
v_mfma_f32_16x16x32_bf16 v[44:47], a[192:195], v[170:173], v[44:47]
ds_read_b128 v[182:185], v210 offset:37888
s_waitcnt lgkmcnt(0)
v_mfma_f32_16x16x32_bf16 v[36:39], a[148:151], v[182:185], v[36:39]
v_mfma_f32_16x16x32_bf16 v[40:43], a[172:175], v[182:185], v[40:43]
v_mfma_f32_16x16x32_bf16 v[44:47], a[196:199], v[182:185], v[44:47]
ds_read_b128 v[186:189], v210 offset:38912
s_waitcnt lgkmcnt(0)
v_mfma_f32_16x16x32_bf16 v[36:39], a[152:155], v[186:189], v[36:39]
v_mfma_f32_16x16x32_bf16 v[40:43], a[176:179], v[186:189], v[40:43]
v_mfma_f32_16x16x32_bf16 v[44:47], a[200:203], v[186:189], v[44:47]
ds_read_b128 v[170:173], v210 offset:39936
s_waitcnt lgkmcnt(0)
v_mfma_f32_16x16x32_bf16 v[36:39], a[156:159], v[170:173], v[36:39]
v_mfma_f32_16x16x32_bf16 v[40:43], a[180:183], v[170:173], v[40:43]
v_mfma_f32_16x16x32_bf16 v[44:47], a[204:207], v[170:173], v[44:47]
ds_read_b128 v[182:185], v210 offset:40960
s_waitcnt lgkmcnt(0)
v_mfma_f32_16x16x32_bf16 v[36:39], a[160:163], v[182:185], v[36:39]
v_mfma_f32_16x16x32_bf16 v[40:43], a[184:187], v[182:185], v[40:43]
v_mfma_f32_16x16x32_bf16 v[44:47], a[208:211], v[182:185], v[44:47]
ds_read_b128 v[186:189], v210 offset:41984
s_waitcnt lgkmcnt(0)
v_mfma_f32_16x16x32_bf16 v[36:39], a[164:167], v[186:189], v[36:39]
v_mfma_f32_16x16x32_bf16 v[40:43], a[188:191], v[186:189], v[40:43]
v_mfma_f32_16x16x32_bf16 v[44:47], a[212:215], v[186:189], v[44:47]
v_cvt_pk_bf16_f32 v72, v36, v37
v_cvt_pk_bf16_f32 v73, v38, v39
buffer_store_dwordx2 v[72:73], v203, s[8:11], s39 offen
v_cvt_pk_bf16_f32 v74, v40, v41
v_cvt_pk_bf16_f32 v75, v42, v43
buffer_store_dwordx2 v[74:75], v203, s[8:11], s39 offen offset:32
s_nop 0
v_cvt_pk_bf16_f32 v76, v44, v45
v_cvt_pk_bf16_f32 v77, v46, v47
buffer_store_dwordx2 v[76:77], v203, s[8:11], s39 offen offset:64
v_max3_f32 v151, v138, v139, v140
v_max3_f32 v151, v151, v141, v142
v_max3_f32 v151, v151, v143, v144
v_max3_f32 v151, v151, v145, v146
v_max3_f32 v151, v151, v147, v148
v_max3_f32 v151, v151, v149, v150
v_mov_b32 v152, v151
s_nop 1
v_permlane16_swap_b32 v151, v152
v_max_f32 v151, v151, v152
v_mov_b32 v152, v151
s_nop 1
v_permlane32_swap_b32 v151, v152
v_max_f32 v151, v151, v152
v_sub_f32 v138, v138, v151
v_sub_f32 v139, v139, v151
v_sub_f32 v140, v140, v151
v_sub_f32 v141, v141, v151
v_sub_f32 v142, v142, v151
v_sub_f32 v143, v143, v151
v_sub_f32 v144, v144, v151
v_sub_f32 v145, v145, v151
v_sub_f32 v150, v150, v151
v_sub_f32 v146, v146, v151
v_sub_f32 v147, v147, v151
v_sub_f32 v148, v148, v151
v_sub_f32 v149, v149, v151
v_exp_f32 v138, v138
v_exp_f32 v139, v139
v_exp_f32 v140, v140
v_exp_f32 v141, v141
v_exp_f32 v142, v142
v_exp_f32 v143, v143
v_exp_f32 v144, v144
v_exp_f32 v145, v145
v_exp_f32 v150, v150
v_exp_f32 v146, v146
v_exp_f32 v147, v147
v_exp_f32 v148, v148
v_exp_f32 v149, v149
v_cvt_pk_bf16_f32 v174, v138, v139
v_cvt_pk_bf16_f32 v175, v140, v141
v_cvt_pk_bf16_f32 v176, v142, v143
v_cvt_pk_bf16_f32 v177, v144, v145
v_cvt_pk_bf16_f32 v178, v146, v147
v_cvt_pk_bf16_f32 v179, v148, v149
v_cvt_pk_bf16_f32 v180, v150, 0
v_mfma_f32_16x16x32_bf16 v[150:153], v[190:193], v[174:177], 0
v_mfma_f32_16x16x32_bf16 v[138:141], v[114:117], v[174:177], 0
v_mfma_f32_16x16x32_bf16 v[142:145], v[122:125], v[174:177], 0
v_mfma_f32_16x16x32_bf16 v[146:149], v[130:133], v[174:177], 0
v_mfma_f32_16x16x32_bf16 v[150:153], v[190:193], v[178:181], v[150:153]
v_mfma_f32_16x16x32_bf16 v[138:141], v[118:121], v[178:181], v[138:141]
v_mfma_f32_16x16x32_bf16 v[142:145], v[126:129], v[178:181], v[142:145]
v_mfma_f32_16x16x32_bf16 v[146:149], v[134:137], v[178:181], v[146:149]
v_mfma_f32_16x16x32_bf16 v[166:169], v[84:87], v[190:193], 0
v_mfma_f32_16x16x32_bf16 v[154:157], v[84:87], v[114:117], 0
v_mfma_f32_16x16x32_bf16 v[158:161], v[84:87], v[122:125], 0
v_mfma_f32_16x16x32_bf16 v[162:165], v[84:87], v[130:133], 0
v_mfma_f32_16x16x32_bf16 v[166:169], v[88:91], v[190:193], v[166:169]
v_mfma_f32_16x16x32_bf16 v[154:157], v[88:91], v[118:121], v[154:157]
v_mfma_f32_16x16x32_bf16 v[158:161], v[88:91], v[126:129], v[158:161]
v_mfma_f32_16x16x32_bf16 v[162:165], v[88:91], v[134:137], v[162:165]
v_rcp_f32 v167, v166
s_nop 1
v_mov_b32_dpp v154, v158 quad_perm:[0,1,2,3] row_mask:0x2 bank_mask:0xf
s_nop 2
v_mov_b32_dpp v154, v162 quad_perm:[0,1,2,3] row_mask:0x4 bank_mask:0xf
v_mul_f32 v167, s3, v167
v_mul_f32 v154, v154, v167
v_cvt_pk_bf16_f32 v154, v154, 0
ds_write_b16 v214, v154
v_add_u32 v214, 1552, v214
ds_read_b128 v[170:173], v210 offset:43008
s_waitcnt lgkmcnt(0)
v_mfma_f32_16x16x32_bf16 v[48:51], a[144:147], v[170:173], v[48:51]
v_mfma_f32_16x16x32_bf16 v[52:55], a[168:171], v[170:173], v[52:55]
v_mfma_f32_16x16x32_bf16 v[56:59], a[192:195], v[170:173], v[56:59]
ds_read_b128 v[182:185], v210 offset:44032
s_waitcnt lgkmcnt(0)
v_mfma_f32_16x16x32_bf16 v[48:51], a[148:151], v[182:185], v[48:51]
v_mfma_f32_16x16x32_bf16 v[52:55], a[172:175], v[182:185], v[52:55]
v_mfma_f32_16x16x32_bf16 v[56:59], a[196:199], v[182:185], v[56:59]
ds_read_b128 v[186:189], v210 offset:45056
s_waitcnt lgkmcnt(0)
v_mfma_f32_16x16x32_bf16 v[48:51], a[152:155], v[186:189], v[48:51]
v_mfma_f32_16x16x32_bf16 v[52:55], a[176:179], v[186:189], v[52:55]
v_mfma_f32_16x16x32_bf16 v[56:59], a[200:203], v[186:189], v[56:59]
ds_read_b128 v[170:173], v210 offset:46080
s_waitcnt lgkmcnt(0)
v_mfma_f32_16x16x32_bf16 v[48:51], a[156:159], v[170:173], v[48:51]
v_mfma_f32_16x16x32_bf16 v[52:55], a[180:183], v[170:173], v[52:55]
v_mfma_f32_16x16x32_bf16 v[56:59], a[204:207], v[170:173], v[56:59]
ds_read_b128 v[182:185], v210 offset:47104
s_waitcnt lgkmcnt(0)
v_mfma_f32_16x16x32_bf16 v[48:51], a[160:163], v[182:185], v[48:51]
v_mfma_f32_16x16x32_bf16 v[52:55], a[184:187], v[182:185], v[52:55]
v_mfma_f32_16x16x32_bf16 v[56:59], a[208:211], v[182:185], v[56:59]
ds_read_b128 v[186:189], v210 offset:48128
s_waitcnt lgkmcnt(0)
v_mfma_f32_16x16x32_bf16 v[48:51], a[164:167], v[186:189], v[48:51]
v_mfma_f32_16x16x32_bf16 v[52:55], a[188:191], v[186:189], v[52:55]
v_mfma_f32_16x16x32_bf16 v[56:59], a[212:215], v[186:189], v[56:59]
v_cvt_pk_bf16_f32 v78, v48, v49
v_cvt_pk_bf16_f32 v79, v50, v51
buffer_store_dwordx2 v[78:79], v204, s[8:11], s39 offen
v_cvt_pk_bf16_f32 v80, v52, v53
v_cvt_pk_bf16_f32 v81, v54, v55
buffer_store_dwordx2 v[80:81], v204, s[8:11], s39 offen offset:32
s_nop 0
v_cvt_pk_bf16_f32 v82, v56, v57
v_cvt_pk_bf16_f32 v83, v58, v59
buffer_store_dwordx2 v[82:83], v204, s[8:11], s39 offen offset:64
v_rcp_f32 v151, v150
s_nop 0
v_mul_f32 v151, s3, v151
v_mul_f32 v138, v138, v151
v_mul_f32 v139, v139, v151
v_cvt_pk_bf16_f32 v138, v138, v139
v_mul_f32 v140, v140, v151
v_mul_f32 v141, v141, v151
v_cvt_pk_bf16_f32 v139, v140, v141
v_mul_f32 v142, v142, v151
v_mul_f32 v143, v143, v151
v_cvt_pk_bf16_f32 v140, v142, v143
v_mul_f32 v144, v144, v151
v_mul_f32 v145, v145, v151
v_cvt_pk_bf16_f32 v141, v144, v145
ds_write_b128 v211, v[138:141] offset:49152
v_mul_f32 v146, v146, v151
v_mul_f32 v147, v147, v151
v_cvt_pk_bf16_f32 v142, v146, v147
v_mul_f32 v148, v148, v151
v_mul_f32 v149, v149, v151
v_cvt_pk_bf16_f32 v143, v148, v149
ds_write_b64 v212, v[142:143] offset:49152
s_waitcnt vmcnt(6) lgkmcnt(0)
s_barrier
ds_read_b128 v[170:173], v210 offset:49152
s_waitcnt lgkmcnt(0)
v_mfma_f32_16x16x32_bf16 v[60:63], a[144:147], v[170:173], v[60:63]
v_mfma_f32_16x16x32_bf16 v[64:67], a[168:171], v[170:173], v[64:67]
v_mfma_f32_16x16x32_bf16 v[68:71], a[192:195], v[170:173], v[68:71]
ds_read_b128 v[182:185], v210 offset:50176
s_waitcnt lgkmcnt(0)
v_mfma_f32_16x16x32_bf16 v[60:63], a[148:151], v[182:185], v[60:63]
v_mfma_f32_16x16x32_bf16 v[64:67], a[172:175], v[182:185], v[64:67]
v_mfma_f32_16x16x32_bf16 v[68:71], a[196:199], v[182:185], v[68:71]
ds_read_b128 v[186:189], v210 offset:51200
s_waitcnt lgkmcnt(0)
v_mfma_f32_16x16x32_bf16 v[60:63], a[152:155], v[186:189], v[60:63]
v_mfma_f32_16x16x32_bf16 v[64:67], a[176:179], v[186:189], v[64:67]
v_mfma_f32_16x16x32_bf16 v[68:71], a[200:203], v[186:189], v[68:71]
ds_read_b128 v[170:173], v210 offset:52224
s_waitcnt lgkmcnt(0)
v_mfma_f32_16x16x32_bf16 v[60:63], a[156:159], v[170:173], v[60:63]
v_mfma_f32_16x16x32_bf16 v[64:67], a[180:183], v[170:173], v[64:67]
v_mfma_f32_16x16x32_bf16 v[68:71], a[204:207], v[170:173], v[68:71]
ds_read_b128 v[182:185], v210 offset:53248
s_waitcnt lgkmcnt(0)
v_mfma_f32_16x16x32_bf16 v[60:63], a[160:163], v[182:185], v[60:63]
v_mfma_f32_16x16x32_bf16 v[64:67], a[184:187], v[182:185], v[64:67]
v_mfma_f32_16x16x32_bf16 v[68:71], a[208:211], v[182:185], v[68:71]
ds_read_b128 v[186:189], v210 offset:54272
s_waitcnt lgkmcnt(0)
v_mfma_f32_16x16x32_bf16 v[60:63], a[164:167], v[186:189], v[60:63]
v_mfma_f32_16x16x32_bf16 v[64:67], a[188:191], v[186:189], v[64:67]
v_mfma_f32_16x16x32_bf16 v[68:71], a[212:215], v[186:189], v[68:71]
v_cvt_pk_bf16_f32 v116, v60, v61
v_cvt_pk_bf16_f32 v117, v62, v63
buffer_store_dwordx2 v[116:117], v205, s[8:11], s39 offen
v_cvt_pk_bf16_f32 v124, v64, v65
v_cvt_pk_bf16_f32 v125, v66, v67
buffer_store_dwordx2 v[124:125], v205, s[8:11], s39 offen offset:32
s_nop 0
v_cvt_pk_bf16_f32 v132, v68, v69
v_cvt_pk_bf16_f32 v133, v70, v71
buffer_store_dwordx2 v[132:133], v205, s[8:11], s39 offen offset:64
s_mov_b32 s38, s36
ds_read_b128 v[174:177], v217
ds_read_b128 v[84:87], v200
s_waitcnt lgkmcnt(0)
v_mfma_f32_16x16x32_bf16 v[36:39], v[174:177], v[84:87], 0
ds_read_b128 v[92:95], v201
s_waitcnt lgkmcnt(0)
v_mfma_f32_16x16x32_bf16 v[48:51], v[174:177], v[92:95], 0
ds_read_b128 v[100:103], v202
s_waitcnt lgkmcnt(0)
v_mfma_f32_16x16x32_bf16 v[60:63], v[174:177], v[100:103], 0
ds_read_b128 v[178:181], v217 offset:528
ds_read_b128 v[84:87], v194
ds_read_b128 v[88:91], v194 offset:16
s_waitcnt lgkmcnt(0)
v_smfmac_f32_16x16x64_bf16 v[36:39], v[178:181], v[84:91], v213
ds_read_b128 v[92:95], v195
ds_read_b128 v[96:99], v195 offset:16
s_waitcnt lgkmcnt(0)
v_smfmac_f32_16x16x64_bf16 v[48:51], v[178:181], v[92:99], v213
ds_read_b128 v[100:103], v196
ds_read_b128 v[104:107], v196 offset:16
s_waitcnt lgkmcnt(0)
v_smfmac_f32_16x16x64_bf16 v[60:63], v[178:181], v[100:107], v213
ds_read_b128 v[174:177], v217 offset:1056
ds_read_b128 v[84:87], v197
ds_read_b128 v[88:91], v197 offset:16
s_waitcnt lgkmcnt(0)
v_smfmac_f32_16x16x64_bf16 v[36:39], v[174:177], v[84:91], v213
ds_read_b128 v[92:95], v198
ds_read_b128 v[96:99], v198 offset:16
s_waitcnt lgkmcnt(0)
v_smfmac_f32_16x16x64_bf16 v[48:51], v[174:177], v[92:99], v213
ds_read_b128 v[100:103], v199
ds_read_b128 v[104:107], v199 offset:16
s_waitcnt lgkmcnt(0)
v_smfmac_f32_16x16x64_bf16 v[60:63], v[174:177], v[100:107], v213
ds_read_b128 v[178:181], v217 offset:1584
ds_read_b128 v[84:87], v200 offset:32
s_waitcnt lgkmcnt(0)
v_mfma_f32_16x16x32_bf16 v[40:43], v[178:181], v[84:87], 0
ds_read_b128 v[92:95], v201 offset:32
s_waitcnt lgkmcnt(0)
v_mfma_f32_16x16x32_bf16 v[52:55], v[178:181], v[92:95], 0
ds_read_b128 v[100:103], v202 offset:32
s_waitcnt lgkmcnt(0)
v_mfma_f32_16x16x32_bf16 v[64:67], v[178:181], v[100:103], 0
ds_read_b128 v[174:177], v217 offset:2112
ds_read_b128 v[84:87], v194 offset:32
ds_read_b128 v[88:91], v194 offset:48
s_waitcnt lgkmcnt(0)
v_smfmac_f32_16x16x64_bf16 v[40:43], v[174:177], v[84:91], v213
ds_read_b128 v[92:95], v195 offset:32
ds_read_b128 v[96:99], v195 offset:48
s_waitcnt lgkmcnt(0)
v_smfmac_f32_16x16x64_bf16 v[52:55], v[174:177], v[92:99], v213
ds_read_b128 v[100:103], v196 offset:32
ds_read_b128 v[104:107], v196 offset:48
s_waitcnt lgkmcnt(0)
v_smfmac_f32_16x16x64_bf16 v[64:67], v[174:177], v[100:107], v213
ds_read_b128 v[178:181], v217 offset:2640
ds_read_b128 v[84:87], v197 offset:32
ds_read_b128 v[88:91], v197 offset:48
s_waitcnt lgkmcnt(0)
v_smfmac_f32_16x16x64_bf16 v[40:43], v[178:181], v[84:91], v213
ds_read_b128 v[92:95], v198 offset:32
ds_read_b128 v[96:99], v198 offset:48
s_waitcnt lgkmcnt(0)
v_smfmac_f32_16x16x64_bf16 v[52:55], v[178:181], v[92:99], v213
ds_read_b128 v[100:103], v199 offset:32
ds_read_b128 v[104:107], v199 offset:48
s_waitcnt lgkmcnt(0)
v_smfmac_f32_16x16x64_bf16 v[64:67], v[178:181], v[100:107], v213
ds_read_b128 v[174:177], v217 offset:3168
ds_read_b128 v[84:87], v200 offset:64
s_waitcnt lgkmcnt(0)
v_mfma_f32_16x16x32_bf16 v[44:47], v[174:177], v[84:87], 0
ds_read_b128 v[92:95], v201 offset:64
s_waitcnt lgkmcnt(0)
v_mfma_f32_16x16x32_bf16 v[56:59], v[174:177], v[92:95], 0
ds_read_b128 v[100:103], v202 offset:64
s_waitcnt lgkmcnt(0)
v_mfma_f32_16x16x32_bf16 v[68:71], v[174:177], v[100:103], 0
ds_read_b128 v[178:181], v217 offset:3696
ds_read_b128 v[84:87], v194 offset:64
ds_read_b128 v[88:91], v194 offset:80
s_waitcnt lgkmcnt(0)
v_smfmac_f32_16x16x64_bf16 v[44:47], v[178:181], v[84:91], v213
ds_read_b128 v[92:95], v195 offset:64
ds_read_b128 v[96:99], v195 offset:80
s_waitcnt lgkmcnt(0)
v_smfmac_f32_16x16x64_bf16 v[56:59], v[178:181], v[92:99], v213
ds_read_b128 v[100:103], v196 offset:64
ds_read_b128 v[104:107], v196 offset:80
s_waitcnt lgkmcnt(0)
v_smfmac_f32_16x16x64_bf16 v[68:71], v[178:181], v[100:107], v213
ds_read_b128 v[174:177], v217 offset:4224
ds_read_b128 v[84:87], v197 offset:64
ds_read_b128 v[88:91], v197 offset:80
s_waitcnt lgkmcnt(0)
v_smfmac_f32_16x16x64_bf16 v[44:47], v[174:177], v[84:91], v213
ds_read_b128 v[92:95], v198 offset:64
ds_read_b128 v[96:99], v198 offset:80
s_waitcnt lgkmcnt(0)
v_smfmac_f32_16x16x64_bf16 v[56:59], v[174:177], v[92:99], v213
ds_read_b128 v[100:103], v199 offset:64
ds_read_b128 v[104:107], v199 offset:80
s_waitcnt lgkmcnt(0)
v_smfmac_f32_16x16x64_bf16 v[68:71], v[174:177], v[100:107], v213
v_add_f32 v118, v36, v37
v_mul_f32 v119, v36, v36
v_add_f32 v118, v118, v38
v_fmac_f32 v119, v37, v37
v_add_f32 v118, v118, v39
v_fmac_f32 v119, v38, v38
v_fmac_f32 v119, v39, v39
v_add_f32 v126, v48, v49
v_mul_f32 v127, v48, v48
v_add_f32 v126, v126, v50
v_fmac_f32 v127, v49, v49
v_add_f32 v126, v126, v51
v_fmac_f32 v127, v50, v50
v_fmac_f32 v127, v51, v51
v_add_f32 v134, v60, v61
v_mul_f32 v135, v60, v60
v_add_f32 v134, v134, v62
v_fmac_f32 v135, v61, v61
v_add_f32 v134, v134, v63
v_fmac_f32 v135, v62, v62
v_fmac_f32 v135, v63, v63
v_add_f32 v118, v118, v40
v_fmac_f32 v119, v40, v40
v_add_f32 v118, v118, v41
v_fmac_f32 v119, v41, v41
v_add_f32 v118, v118, v42
v_fmac_f32 v119, v42, v42
v_add_f32 v118, v118, v43
v_fmac_f32 v119, v43, v43
v_add_f32 v126, v126, v52
v_fmac_f32 v127, v52, v52
v_add_f32 v126, v126, v53
v_fmac_f32 v127, v53, v53
v_add_f32 v126, v126, v54
v_fmac_f32 v127, v54, v54
v_add_f32 v126, v126, v55
v_fmac_f32 v127, v55, v55
v_add_f32 v134, v134, v64
v_fmac_f32 v135, v64, v64
v_add_f32 v134, v134, v65
v_fmac_f32 v135, v65, v65
v_add_f32 v134, v134, v66
v_fmac_f32 v135, v66, v66
v_add_f32 v134, v134, v67
v_fmac_f32 v135, v67, v67
v_add_f32 v118, v118, v44
v_fmac_f32 v119, v44, v44
v_add_f32 v118, v118, v45
v_fmac_f32 v119, v45, v45
v_add_f32 v118, v118, v46
v_fmac_f32 v119, v46, v46
v_add_f32 v118, v118, v47
v_fmac_f32 v119, v47, v47
v_add_f32 v126, v126, v56
v_fmac_f32 v127, v56, v56
v_add_f32 v126, v126, v57
v_fmac_f32 v127, v57, v57
v_add_f32 v126, v126, v58
v_fmac_f32 v127, v58, v58
v_add_f32 v126, v126, v59
v_fmac_f32 v127, v59, v59
v_add_f32 v134, v134, v68
v_fmac_f32 v135, v68, v68
v_add_f32 v134, v134, v69
v_fmac_f32 v135, v69, v69
v_add_f32 v134, v134, v70
v_fmac_f32 v135, v70, v70
v_add_f32 v134, v134, v71
v_fmac_f32 v135, v71, v71
v_permlane16_swap_b32 v118, v119
v_add_f32 v118, v118, v119
v_permlane16_swap_b32 v126, v127
v_add_f32 v126, v126, v127
v_permlane16_swap_b32 v134, v135
v_add_f32 v134, v134, v135
v_permlane32_swap_b32 v118, v126
v_add_f32 v118, v118, v126
ds_write_b32 v209, v118
v_mov_b32 v135, v134
s_nop 1
v_permlane32_swap_b32 v134, v135
v_add_f32 v134, v134, v135
ds_write_b32 v209, v134 offset:512
s_waitcnt lgkmcnt(0)
s_barrier
s_mov_b32 s36, s50
v_and_b32 v180, s44, v208
s_add_u32 m0, s45, 0
s_nop 0
buffer_load_dwordx4 v180, s[4:7], s52 offen nt lds
s_add_u32 m0, s45, 4112
s_add_u32 s40, s36, 196224
buffer_load_dwordx4 v180, s[4:7], s40 offen nt lds
s_add_u32 m0, s45, 8224
s_add_u32 s40, s36, 392448
buffer_load_dwordx4 v180, s[4:7], s40 offen nt lds
s_add_u32 m0, s45, 12336
s_add_u32 s40, s36, 588672
buffer_load_dwordx4 v180, s[4:7], s40 offen nt lds
s_add_u32 m0, s45, 16448
s_add_u32 s40, s36, 784896
buffer_load_dwordx4 v180, s[4:7], s40 offen nt lds
s_add_u32 m0, s45, 20560
s_add_u32 s40, s36, 981120
buffer_load_dwordx4 v180, s[4:7], s40 offen nt lds
s_add_u32 m0, s45, 24672
s_add_u32 s40, s36, 1177344
buffer_load_dwordx4 v180, s[4:7], s40 offen nt lds
s_add_u32 m0, s45, 28784
s_add_u32 s40, s36, 1373568
buffer_load_dwordx4 v180, s[4:7], s40 offen nt lds
s_add_u32 m0, s45, 32896
s_add_u32 s40, s36, 1569792
buffer_load_dwordx4 v180, s[4:7], s40 offen nt lds
s_mul_hi_u32 s41, s35, 58835169
s_mul_i32 s42, s41, 73
s_sub_u32 s42, s35, s42
s_mul_i32 s43, s41, 1373568
s_mul_i32 s51, s42, 2688
s_add_u32 s43, s43, s51
s_cmp_lt_u32 s35, s34
s_cselect_b32 s50, s43, 1879048192
s_add_u32 s35, s35, 32
s_cmp_eq_u32 s42, 0
s_cselect_b32 s44, 536870911, s72
s_cmp_eq_u32 s42, 72
s_cselect_b32 s44, 939524095, s44
s_cmp_eq_u32 s41, 0
s_cselect_b32 s52, 1879048192, s50
ds_read_b128 v[102:105], v210 offset:55296
ds_read_b128 v[106:109], v210 offset:56320
s_waitcnt lgkmcnt(1)
v_add_f32 v102, v102, v103
s_waitcnt lgkmcnt(0)
v_add_f32 v106, v106, v107
v_add_f32 v104, v104, v105
v_add_f32 v108, v108, v109
v_add_f32 v102, v102, v104
v_add_f32 v106, v106, v108
v_mul_f32 v103, s48, v102
v_mul_f32 v104, s73, v102
v_mul_f32 v106, s73, v106
v_fma_f32 v106, -v103, v104, v106
v_max_f32 v106, 0, v106
v_add_f32 v106, s49, v106
v_rsq_f32 v102, v106
s_nop 0
v_mul_f32_e64 v103, -v103, v102
ds_write_b64 v211, v[102:103] offset:36864
ds_read_b64 v[118:119], v219
ds_read_b64 v[126:127], v219 offset:256
ds_read_b64 v[134:135], v219 offset:512
s_waitcnt lgkmcnt(2)
v_fma_f32 v220, v36, v118, v119
v_fma_f32 v221, v37, v118, v119
v_cvt_pk_bf16_f32 v90, v220, v221
v_fma_f32 v222, v38, v118, v119
v_fma_f32 v223, v39, v118, v119
v_cvt_pk_bf16_f32 v91, v222, v223
v_fma_f32 v220, v40, v118, v119
v_fma_f32 v221, v41, v118, v119
v_cvt_pk_bf16_f32 v92, v220, v221
v_fma_f32 v222, v42, v118, v119
v_fma_f32 v223, v43, v118, v119
v_cvt_pk_bf16_f32 v93, v222, v223
ds_write_b128 v211, v[90:93] offset:18432
v_fma_f32 v220, v44, v118, v119
v_fma_f32 v221, v45, v118, v119
v_cvt_pk_bf16_f32 v94, v220, v221
v_fma_f32 v222, v46, v118, v119
v_fma_f32 v223, v47, v118, v119
v_cvt_pk_bf16_f32 v95, v222, v223
s_waitcnt lgkmcnt(2)
ds_write_b64 v212, v[94:95] offset:18432
v_fma_f32 v220, v48, v126, v127
v_fma_f32 v221, v49, v126, v127
v_cvt_pk_bf16_f32 v174, v220, v221
v_fma_f32 v222, v50, v126, v127
v_fma_f32 v223, v51, v126, v127
v_cvt_pk_bf16_f32 v175, v222, v223
v_fma_f32 v220, v52, v126, v127
v_fma_f32 v221, v53, v126, v127
v_cvt_pk_bf16_f32 v176, v220, v221
v_fma_f32 v222, v54, v126, v127
v_fma_f32 v223, v55, v126, v127
v_cvt_pk_bf16_f32 v177, v222, v223
ds_write_b128 v211, v[174:177] offset:24576
v_fma_f32 v220, v56, v126, v127
v_fma_f32 v221, v57, v126, v127
v_cvt_pk_bf16_f32 v178, v220, v221
v_fma_f32 v222, v58, v126, v127
v_fma_f32 v223, v59, v126, v127
v_cvt_pk_bf16_f32 v179, v222, v223
s_waitcnt lgkmcnt(3)
ds_write_b64 v212, v[178:179] offset:24576
v_fma_f32 v220, v60, v134, v135
v_fma_f32 v221, v61, v134, v135
v_cvt_pk_bf16_f32 v90, v220, v221
v_fma_f32 v222, v62, v134, v135
v_fma_f32 v223, v63, v134, v135
v_cvt_pk_bf16_f32 v91, v222, v223
v_fma_f32 v220, v64, v134, v135
v_fma_f32 v221, v65, v134, v135
v_cvt_pk_bf16_f32 v92, v220, v221
v_fma_f32 v222, v66, v134, v135
v_fma_f32 v223, v67, v134, v135
v_cvt_pk_bf16_f32 v93, v222, v223
ds_write_b128 v211, v[90:93] offset:30720
v_fma_f32 v220, v68, v134, v135
v_fma_f32 v221, v69, v134, v135
v_cvt_pk_bf16_f32 v94, v220, v221
v_fma_f32 v222, v70, v134, v135
v_fma_f32 v223, v71, v134, v135
v_cvt_pk_bf16_f32 v95, v222, v223
ds_write_b64 v212, v[94:95] offset:30720
ds_read_b128 v[182:185], v210
s_waitcnt lgkmcnt(0)
v_mfma_f32_16x16x32_bf16 v[138:141], a[0:3], v[182:185], 0
v_mfma_f32_16x16x32_bf16 v[142:145], a[24:27], v[182:185], 0
v_mfma_f32_16x16x32_bf16 v[146:149], a[48:51], v[182:185], 0
v_mfma_f32_16x16x32_bf16 v[150:153], a[216:219], v[182:185], 0
v_mfma_f32_16x16x32_bf16 v[154:157], a[240:243], v[182:185], 0
v_mfma_f32_16x16x32_bf16 v[158:161], v[232:235], v[182:185], 0
v_mfma_f32_16x16x32_bf16 v[162:165], v[182:185], a[72:75], 0
v_mfma_f32_16x16x32_bf16 v[166:169], v[182:185], a[96:99], 0
v_mfma_f32_16x16x32_bf16 v[170:173], v[182:185], a[120:123], 0
ds_read_b128 v[186:189], v210 offset:1024
s_waitcnt lgkmcnt(0)
v_mfma_f32_16x16x32_bf16 v[138:141], a[4:7], v[186:189], v[138:141]
v_mfma_f32_16x16x32_bf16 v[142:145], a[28:31], v[186:189], v[142:145]
v_mfma_f32_16x16x32_bf16 v[146:149], a[52:55], v[186:189], v[146:149]
v_mfma_f32_16x16x32_bf16 v[150:153], a[220:223], v[186:189], v[150:153]
v_mfma_f32_16x16x32_bf16 v[154:157], a[244:247], v[186:189], v[154:157]
v_mfma_f32_16x16x32_bf16 v[158:161], v[236:239], v[186:189], v[158:161]
v_mfma_f32_16x16x32_bf16 v[162:165], v[186:189], a[76:79], v[162:165]
v_mfma_f32_16x16x32_bf16 v[166:169], v[186:189], a[100:103], v[166:169]
v_mfma_f32_16x16x32_bf16 v[170:173], v[186:189], a[124:127], v[170:173]
ds_read_b128 v[182:185], v210 offset:2048
s_waitcnt lgkmcnt(0)
v_mfma_f32_16x16x32_bf16 v[138:141], a[8:11], v[182:185], v[138:141]
v_mfma_f32_16x16x32_bf16 v[142:145], a[32:35], v[182:185], v[142:145]
v_mfma_f32_16x16x32_bf16 v[146:149], a[56:59], v[182:185], v[146:149]
v_mfma_f32_16x16x32_bf16 v[150:153], a[224:227], v[182:185], v[150:153]
v_mfma_f32_16x16x32_bf16 v[154:157], a[248:251], v[182:185], v[154:157]
v_mfma_f32_16x16x32_bf16 v[158:161], v[240:243], v[182:185], v[158:161]
v_mfma_f32_16x16x32_bf16 v[162:165], v[182:185], a[80:83], v[162:165]
v_mfma_f32_16x16x32_bf16 v[166:169], v[182:185], a[104:107], v[166:169]
v_mfma_f32_16x16x32_bf16 v[170:173], v[182:185], a[128:131], v[170:173]
ds_read_b128 v[186:189], v210 offset:3072
s_waitcnt lgkmcnt(0)
v_mfma_f32_16x16x32_bf16 v[138:141], a[12:15], v[186:189], v[138:141]
v_mfma_f32_16x16x32_bf16 v[142:145], a[36:39], v[186:189], v[142:145]
v_mfma_f32_16x16x32_bf16 v[146:149], a[60:63], v[186:189], v[146:149]
v_mfma_f32_16x16x32_bf16 v[150:153], a[228:231], v[186:189], v[150:153]
v_mfma_f32_16x16x32_bf16 v[154:157], a[252:255], v[186:189], v[154:157]
v_mfma_f32_16x16x32_bf16 v[158:161], v[244:247], v[186:189], v[158:161]
v_mfma_f32_16x16x32_bf16 v[162:165], v[186:189], a[84:87], v[162:165]
v_mfma_f32_16x16x32_bf16 v[166:169], v[186:189], a[108:111], v[166:169]
v_mfma_f32_16x16x32_bf16 v[170:173], v[186:189], a[132:135], v[170:173]
ds_read_b128 v[182:185], v210 offset:4096
s_waitcnt lgkmcnt(0)
v_mfma_f32_16x16x32_bf16 v[138:141], a[16:19], v[182:185], v[138:141]
v_mfma_f32_16x16x32_bf16 v[142:145], a[40:43], v[182:185], v[142:145]
v_mfma_f32_16x16x32_bf16 v[146:149], a[64:67], v[182:185], v[146:149]
v_mfma_f32_16x16x32_bf16 v[150:153], a[232:235], v[182:185], v[150:153]
v_mfma_f32_16x16x32_bf16 v[154:157], v[224:227], v[182:185], v[154:157]
v_mfma_f32_16x16x32_bf16 v[158:161], v[248:251], v[182:185], v[158:161]
v_mfma_f32_16x16x32_bf16 v[162:165], v[182:185], a[88:91], v[162:165]
v_mfma_f32_16x16x32_bf16 v[166:169], v[182:185], a[112:115], v[166:169]
v_mfma_f32_16x16x32_bf16 v[170:173], v[182:185], a[136:139], v[170:173]
ds_read_b128 v[186:189], v210 offset:5120
s_waitcnt lgkmcnt(0)
v_mfma_f32_16x16x32_bf16 v[138:141], a[20:23], v[186:189], v[138:141]
v_mfma_f32_16x16x32_bf16 v[142:145], a[44:47], v[186:189], v[142:145]
v_mfma_f32_16x16x32_bf16 v[146:149], a[68:71], v[186:189], v[146:149]
v_mfma_f32_16x16x32_bf16 v[150:153], a[236:239], v[186:189], v[150:153]
v_mfma_f32_16x16x32_bf16 v[154:157], v[228:231], v[186:189], v[154:157]
v_mfma_f32_16x16x32_bf16 v[158:161], v[252:255], v[186:189], v[158:161]
v_mfma_f32_16x16x32_bf16 v[162:165], v[186:189], a[92:95], v[162:165]
v_mfma_f32_16x16x32_bf16 v[166:169], v[186:189], a[116:119], v[166:169]
v_mfma_f32_16x16x32_bf16 v[170:173], v[186:189], a[140:143], v[170:173]
v_cvt_pk_bf16_f32 v78, v138, v139
v_cvt_pk_bf16_f32 v79, v140, v141
v_cvt_pk_bf16_f32 v80, v142, v143
v_cvt_pk_bf16_f32 v81, v144, v145
v_cvt_pk_bf16_f32 v82, v146, v147
v_cvt_pk_bf16_f32 v83, v148, v149
v_cvt_pk_bf16_f32 v72, v150, v151
v_cvt_pk_bf16_f32 v73, v152, v153
v_cvt_pk_bf16_f32 v74, v154, v155
v_cvt_pk_bf16_f32 v75, v156, v157
v_cvt_pk_bf16_f32 v76, v158, v159
v_cvt_pk_bf16_f32 v77, v160, v161
v_cvt_pk_bf16_f32 v114, v162, v163
v_cvt_pk_bf16_f32 v115, v164, v165
v_cvt_pk_bf16_f32 v122, v166, v167
v_cvt_pk_bf16_f32 v123, v168, v169
v_cvt_pk_bf16_f32 v130, v170, v171
v_cvt_pk_bf16_f32 v131, v172, v173
ds_read_b128 v[182:185], v210 offset:6144
s_waitcnt lgkmcnt(0)
v_mfma_f32_16x16x32_bf16 v[138:141], a[0:3], v[182:185], 0
v_mfma_f32_16x16x32_bf16 v[142:145], a[24:27], v[182:185], 0
v_mfma_f32_16x16x32_bf16 v[146:149], a[48:51], v[182:185], 0
v_mfma_f32_16x16x32_bf16 v[150:153], a[216:219], v[182:185], 0
v_mfma_f32_16x16x32_bf16 v[154:157], a[240:243], v[182:185], 0
v_mfma_f32_16x16x32_bf16 v[158:161], v[232:235], v[182:185], 0
v_mfma_f32_16x16x32_bf16 v[162:165], v[182:185], a[72:75], 0
v_mfma_f32_16x16x32_bf16 v[166:169], v[182:185], a[96:99], 0
v_mfma_f32_16x16x32_bf16 v[170:173], v[182:185], a[120:123], 0
ds_read_b128 v[186:189], v210 offset:7168
s_waitcnt lgkmcnt(0)
v_mfma_f32_16x16x32_bf16 v[138:141], a[4:7], v[186:189], v[138:141]
v_mfma_f32_16x16x32_bf16 v[142:145], a[28:31], v[186:189], v[142:145]
v_mfma_f32_16x16x32_bf16 v[146:149], a[52:55], v[186:189], v[146:149]
v_mfma_f32_16x16x32_bf16 v[150:153], a[220:223], v[186:189], v[150:153]
v_mfma_f32_16x16x32_bf16 v[154:157], a[244:247], v[186:189], v[154:157]
v_mfma_f32_16x16x32_bf16 v[158:161], v[236:239], v[186:189], v[158:161]
v_mfma_f32_16x16x32_bf16 v[162:165], v[186:189], a[76:79], v[162:165]
v_mfma_f32_16x16x32_bf16 v[166:169], v[186:189], a[100:103], v[166:169]
v_mfma_f32_16x16x32_bf16 v[170:173], v[186:189], a[124:127], v[170:173]
ds_read_b128 v[182:185], v210 offset:8192
s_waitcnt lgkmcnt(0)
v_mfma_f32_16x16x32_bf16 v[138:141], a[8:11], v[182:185], v[138:141]
v_mfma_f32_16x16x32_bf16 v[142:145], a[32:35], v[182:185], v[142:145]
v_mfma_f32_16x16x32_bf16 v[146:149], a[56:59], v[182:185], v[146:149]
v_mfma_f32_16x16x32_bf16 v[150:153], a[224:227], v[182:185], v[150:153]
v_mfma_f32_16x16x32_bf16 v[154:157], a[248:251], v[182:185], v[154:157]
v_mfma_f32_16x16x32_bf16 v[158:161], v[240:243], v[182:185], v[158:161]
v_mfma_f32_16x16x32_bf16 v[162:165], v[182:185], a[80:83], v[162:165]
v_mfma_f32_16x16x32_bf16 v[166:169], v[182:185], a[104:107], v[166:169]
v_mfma_f32_16x16x32_bf16 v[170:173], v[182:185], a[128:131], v[170:173]
ds_read_b128 v[186:189], v210 offset:9216
s_waitcnt lgkmcnt(0)
v_mfma_f32_16x16x32_bf16 v[138:141], a[12:15], v[186:189], v[138:141]
v_mfma_f32_16x16x32_bf16 v[142:145], a[36:39], v[186:189], v[142:145]
v_mfma_f32_16x16x32_bf16 v[146:149], a[60:63], v[186:189], v[146:149]
v_mfma_f32_16x16x32_bf16 v[150:153], a[228:231], v[186:189], v[150:153]
v_mfma_f32_16x16x32_bf16 v[154:157], a[252:255], v[186:189], v[154:157]
v_mfma_f32_16x16x32_bf16 v[158:161], v[244:247], v[186:189], v[158:161]
v_mfma_f32_16x16x32_bf16 v[162:165], v[186:189], a[84:87], v[162:165]
v_mfma_f32_16x16x32_bf16 v[166:169], v[186:189], a[108:111], v[166:169]
v_mfma_f32_16x16x32_bf16 v[170:173], v[186:189], a[132:135], v[170:173]
ds_read_b128 v[182:185], v210 offset:10240
s_waitcnt lgkmcnt(0)
v_mfma_f32_16x16x32_bf16 v[138:141], a[16:19], v[182:185], v[138:141]
v_mfma_f32_16x16x32_bf16 v[142:145], a[40:43], v[182:185], v[142:145]
v_mfma_f32_16x16x32_bf16 v[146:149], a[64:67], v[182:185], v[146:149]
v_mfma_f32_16x16x32_bf16 v[150:153], a[232:235], v[182:185], v[150:153]
v_mfma_f32_16x16x32_bf16 v[154:157], v[224:227], v[182:185], v[154:157]
v_mfma_f32_16x16x32_bf16 v[158:161], v[248:251], v[182:185], v[158:161]
v_mfma_f32_16x16x32_bf16 v[162:165], v[182:185], a[88:91], v[162:165]
v_mfma_f32_16x16x32_bf16 v[166:169], v[182:185], a[112:115], v[166:169]
v_mfma_f32_16x16x32_bf16 v[170:173], v[182:185], a[136:139], v[170:173]
ds_read_b128 v[186:189], v210 offset:11264
s_waitcnt lgkmcnt(0)
v_mfma_f32_16x16x32_bf16 v[138:141], a[20:23], v[186:189], v[138:141]
v_mfma_f32_16x16x32_bf16 v[142:145], a[44:47], v[186:189], v[142:145]
v_mfma_f32_16x16x32_bf16 v[146:149], a[68:71], v[186:189], v[146:149]
v_mfma_f32_16x16x32_bf16 v[150:153], a[236:239], v[186:189], v[150:153]
v_mfma_f32_16x16x32_bf16 v[154:157], v[228:231], v[186:189], v[154:157]
v_mfma_f32_16x16x32_bf16 v[158:161], v[252:255], v[186:189], v[158:161]
v_mfma_f32_16x16x32_bf16 v[162:165], v[186:189], a[92:95], v[162:165]
v_mfma_f32_16x16x32_bf16 v[166:169], v[186:189], a[116:119], v[166:169]
v_mfma_f32_16x16x32_bf16 v[170:173], v[186:189], a[140:143], v[170:173]
v_cvt_pk_bf16_f32 v96, v138, v139
v_cvt_pk_bf16_f32 v97, v140, v141
v_cvt_pk_bf16_f32 v98, v142, v143
v_cvt_pk_bf16_f32 v99, v144, v145
v_cvt_pk_bf16_f32 v100, v146, v147
v_cvt_pk_bf16_f32 v101, v148, v149
v_cvt_pk_bf16_f32 v84, v150, v151
v_cvt_pk_bf16_f32 v85, v152, v153
v_cvt_pk_bf16_f32 v86, v154, v155
v_cvt_pk_bf16_f32 v87, v156, v157
v_cvt_pk_bf16_f32 v88, v158, v159
v_cvt_pk_bf16_f32 v89, v160, v161
v_cvt_pk_bf16_f32 v116, v162, v163
v_cvt_pk_bf16_f32 v117, v164, v165
v_cvt_pk_bf16_f32 v124, v166, v167
v_cvt_pk_bf16_f32 v125, v168, v169
v_cvt_pk_bf16_f32 v132, v170, v171
v_cvt_pk_bf16_f32 v133, v172, v173
ds_read_b128 v[182:185], v210 offset:12288
s_waitcnt lgkmcnt(0)
v_mfma_f32_16x16x32_bf16 v[138:141], a[0:3], v[182:185], 0
v_mfma_f32_16x16x32_bf16 v[142:145], a[24:27], v[182:185], 0
v_mfma_f32_16x16x32_bf16 v[146:149], a[48:51], v[182:185], 0
ds_read_b128 v[186:189], v210 offset:13312
s_waitcnt lgkmcnt(0)
v_mfma_f32_16x16x32_bf16 v[138:141], a[4:7], v[186:189], v[138:141]
v_mfma_f32_16x16x32_bf16 v[142:145], a[28:31], v[186:189], v[142:145]
v_mfma_f32_16x16x32_bf16 v[146:149], a[52:55], v[186:189], v[146:149]
ds_read_b128 v[182:185], v210 offset:14336
s_waitcnt lgkmcnt(0)
v_mfma_f32_16x16x32_bf16 v[138:141], a[8:11], v[182:185], v[138:141]
v_mfma_f32_16x16x32_bf16 v[142:145], a[32:35], v[182:185], v[142:145]
v_mfma_f32_16x16x32_bf16 v[146:149], a[56:59], v[182:185], v[146:149]
ds_read_b128 v[186:189], v210 offset:15360
s_waitcnt lgkmcnt(0)
v_mfma_f32_16x16x32_bf16 v[138:141], a[12:15], v[186:189], v[138:141]
v_mfma_f32_16x16x32_bf16 v[142:145], a[36:39], v[186:189], v[142:145]
v_mfma_f32_16x16x32_bf16 v[146:149], a[60:63], v[186:189], v[146:149]
ds_read_b128 v[182:185], v210 offset:16384
s_waitcnt lgkmcnt(0)
v_mfma_f32_16x16x32_bf16 v[138:141], a[16:19], v[182:185], v[138:141]
v_mfma_f32_16x16x32_bf16 v[142:145], a[40:43], v[182:185], v[142:145]
v_mfma_f32_16x16x32_bf16 v[146:149], a[64:67], v[182:185], v[146:149]
ds_read_b128 v[186:189], v210 offset:17408
s_waitcnt lgkmcnt(0)
v_mfma_f32_16x16x32_bf16 v[138:141], a[20:23], v[186:189], v[138:141]
v_mfma_f32_16x16x32_bf16 v[142:145], a[44:47], v[186:189], v[142:145]
v_mfma_f32_16x16x32_bf16 v[146:149], a[68:71], v[186:189], v[146:149]
v_cvt_pk_bf16_f32 v102, v138, v139
v_cvt_pk_bf16_f32 v103, v140, v141
s_nop 0
v_cvt_pk_bf16_f32 v104, v142, v143
v_cvt_pk_bf16_f32 v105, v144, v145
s_nop 1
v_cvt_pk_bf16_f32 v106, v146, v147
v_cvt_pk_bf16_f32 v107, v148, v149
ds_read_b128 v[108:111], v215 offset:512
ds_read_b64 v[112:113], v215 offset:528
v_mov_b32 v181, 0
v_mfma_f32_16x16x16_bf16 v[138:141], v[82:83], v[76:77], 0
v_mfma_f32_16x16x16_bf16 v[142:145], v[100:101], v[76:77], 0
s_waitcnt lgkmcnt(0)
v_mfma_f32_16x16x16_bf16 v[150:153], v[112:113], v[76:77], v[206:209]
v_mfma_f32_16x16x16_bf16 v[146:149], v[106:107], v[76:77], 0
v_mfma_f32_16x16x32_bf16 v[138:141], v[78:81], v[72:75], v[138:141]
v_mfma_f32_16x16x32_bf16 v[142:145], v[96:99], v[72:75], v[142:145]
v_mfma_f32_16x16x32_bf16 v[150:153], v[108:111], v[72:75], v[150:153]
v_mfma_f32_16x16x32_bf16 v[146:149], v[102:105], v[72:75], v[146:149]
ds_read_b128 v[72:75], v215
ds_read_b64 v[76:77], v215 offset:16
v_mfma_f32_16x16x16_bf16 v[154:157], v[82:83], v[88:89], 0
v_mfma_f32_16x16x16_bf16 v[158:161], v[100:101], v[88:89], 0
v_mfma_f32_16x16x16_bf16 v[166:169], v[112:113], v[88:89], v[206:209]
v_mfma_f32_16x16x16_bf16 v[162:165], v[106:107], v[88:89], 0
v_mfma_f32_16x16x32_bf16 v[154:157], v[78:81], v[84:87], v[154:157]
v_mfma_f32_16x16x32_bf16 v[158:161], v[96:99], v[84:87], v[158:161]
v_mfma_f32_16x16x32_bf16 v[166:169], v[108:111], v[84:87], v[166:169]
v_mfma_f32_16x16x32_bf16 v[162:165], v[102:105], v[84:87], v[162:165]
ds_read_b128 v[182:185], v210 offset:12288
s_waitcnt lgkmcnt(0)
v_mfma_f32_16x16x32_bf16 v[118:121], v[182:185], a[72:75], 0
v_mfma_f32_16x16x32_bf16 v[126:129], v[182:185], a[96:99], 0
v_mfma_f32_16x16x32_bf16 v[134:137], v[182:185], a[120:123], 0
v_mfma_f32_16x16x32_bf16 v[90:93], a[216:219], v[182:185], 0
v_mfma_f32_16x16x32_bf16 v[170:173], a[240:243], v[182:185], 0
v_mfma_f32_16x16x32_bf16 v[220:223], v[232:235], v[182:185], 0
ds_read_b128 v[186:189], v210 offset:13312
s_waitcnt lgkmcnt(0)
v_mfma_f32_16x16x32_bf16 v[118:121], v[186:189], a[76:79], v[118:121]
v_mfma_f32_16x16x32_bf16 v[126:129], v[186:189], a[100:103], v[126:129]
v_mfma_f32_16x16x32_bf16 v[134:137], v[186:189], a[124:127], v[134:137]
v_mfma_f32_16x16x32_bf16 v[90:93], a[220:223], v[186:189], v[90:93]
v_mfma_f32_16x16x32_bf16 v[170:173], a[244:247], v[186:189], v[170:173]
v_mfma_f32_16x16x32_bf16 v[220:223], v[236:239], v[186:189], v[220:223]
ds_read_b128 v[182:185], v210 offset:14336
s_waitcnt lgkmcnt(0)
v_mfma_f32_16x16x32_bf16 v[118:121], v[182:185], a[80:83], v[118:121]
v_mfma_f32_16x16x32_bf16 v[126:129], v[182:185], a[104:107], v[126:129]
v_mfma_f32_16x16x32_bf16 v[134:137], v[182:185], a[128:131], v[134:137]
v_mfma_f32_16x16x32_bf16 v[90:93], a[224:227], v[182:185], v[90:93]
v_mfma_f32_16x16x32_bf16 v[170:173], a[248:251], v[182:185], v[170:173]
v_mfma_f32_16x16x32_bf16 v[220:223], v[240:243], v[182:185], v[220:223]
ds_read_b128 v[186:189], v210 offset:15360
s_waitcnt lgkmcnt(0)
v_mfma_f32_16x16x32_bf16 v[118:121], v[186:189], a[84:87], v[118:121]
v_mfma_f32_16x16x32_bf16 v[126:129], v[186:189], a[108:111], v[126:129]
v_mfma_f32_16x16x32_bf16 v[134:137], v[186:189], a[132:135], v[134:137]
v_mfma_f32_16x16x32_bf16 v[90:93], a[228:231], v[186:189], v[90:93]
v_mfma_f32_16x16x32_bf16 v[170:173], a[252:255], v[186:189], v[170:173]
v_mfma_f32_16x16x32_bf16 v[220:223], v[244:247], v[186:189], v[220:223]
ds_read_b128 v[182:185], v210 offset:16384
s_waitcnt lgkmcnt(0)
v_mfma_f32_16x16x32_bf16 v[118:121], v[182:185], a[88:91], v[118:121]
v_mfma_f32_16x16x32_bf16 v[126:129], v[182:185], a[112:115], v[126:129]
v_mfma_f32_16x16x32_bf16 v[134:137], v[182:185], a[136:139], v[134:137]
v_mfma_f32_16x16x32_bf16 v[90:93], a[232:235], v[182:185], v[90:93]
v_mfma_f32_16x16x32_bf16 v[170:173], v[224:227], v[182:185], v[170:173]
v_mfma_f32_16x16x32_bf16 v[220:223], v[248:251], v[182:185], v[220:223]
ds_read_b128 v[186:189], v210 offset:17408
s_waitcnt lgkmcnt(0)
v_mfma_f32_16x16x32_bf16 v[118:121], v[186:189], a[92:95], v[118:121]
v_mfma_f32_16x16x32_bf16 v[126:129], v[186:189], a[116:119], v[126:129]
v_mfma_f32_16x16x32_bf16 v[134:137], v[186:189], a[140:143], v[134:137]
v_mfma_f32_16x16x32_bf16 v[90:93], a[236:239], v[186:189], v[90:93]
v_mfma_f32_16x16x32_bf16 v[170:173], v[228:231], v[186:189], v[170:173]
v_mfma_f32_16x16x32_bf16 v[220:223], v[252:255], v[186:189], v[220:223]
v_cvt_pk_bf16_f32 v118, v118, v119
v_cvt_pk_bf16_f32 v119, v120, v121
ds_read_u16 v120, v214 offset:1024
v_mov_b32 v121, 0
v_cvt_pk_bf16_f32 v126, v126, v127
v_cvt_pk_bf16_f32 v127, v128, v129
ds_read_u16 v128, v214 offset:1032
v_mov_b32 v129, 0
v_cvt_pk_bf16_f32 v134, v134, v135
v_cvt_pk_bf16_f32 v135, v136, v137
ds_read_u16 v136, v214 offset:1040
v_mov_b32 v137, 0
v_cvt_pk_bf16_f32 v90, v90, v91
v_cvt_pk_bf16_f32 v91, v92, v93
v_cvt_pk_bf16_f32 v92, v170, v171
v_cvt_pk_bf16_f32 v93, v172, v173
v_cvt_pk_bf16_f32 v94, v220, v221
v_cvt_pk_bf16_f32 v95, v222, v223
v_max3_f32 v151, v138, v139, v140
v_max3_f32 v151, v151, v141, v142
v_max3_f32 v151, v151, v143, v144
v_max3_f32 v151, v151, v145, v146
v_max3_f32 v151, v151, v147, v148
v_max3_f32 v151, v151, v149, v150
v_mov_b32 v152, v151
s_nop 1
v_permlane16_swap_b32 v151, v152
v_max_f32 v151, v151, v152
v_mov_b32 v152, v151
s_nop 1
v_permlane32_swap_b32 v151, v152
v_max_f32 v151, v151, v152
v_sub_f32 v138, v138, v151
v_sub_f32 v139, v139, v151
v_sub_f32 v140, v140, v151
v_sub_f32 v141, v141, v151
v_sub_f32 v142, v142, v151
v_sub_f32 v143, v143, v151
v_sub_f32 v144, v144, v151
v_sub_f32 v145, v145, v151
v_sub_f32 v150, v150, v151
v_sub_f32 v146, v146, v151
v_sub_f32 v147, v147, v151
v_sub_f32 v148, v148, v151
v_sub_f32 v149, v149, v151
v_exp_f32 v138, v138
v_exp_f32 v139, v139
v_exp_f32 v140, v140
v_exp_f32 v141, v141
v_exp_f32 v142, v142
v_exp_f32 v143, v143
v_exp_f32 v144, v144
v_exp_f32 v145, v145
v_exp_f32 v150, v150
v_exp_f32 v146, v146
v_exp_f32 v147, v147
v_exp_f32 v148, v148
v_exp_f32 v149, v149
v_cvt_pk_bf16_f32 v174, v138, v139
v_cvt_pk_bf16_f32 v175, v140, v141
v_cvt_pk_bf16_f32 v176, v142, v143
v_cvt_pk_bf16_f32 v177, v144, v145
v_cvt_pk_bf16_f32 v178, v146, v147
v_cvt_pk_bf16_f32 v179, v148, v149
v_cvt_pk_bf16_f32 v180, v150, 0
v_mfma_f32_16x16x32_bf16 v[150:153], v[190:193], v[174:177], 0
v_mfma_f32_16x16x32_bf16 v[138:141], v[114:117], v[174:177], 0
v_mfma_f32_16x16x32_bf16 v[142:145], v[122:125], v[174:177], 0
v_mfma_f32_16x16x32_bf16 v[146:149], v[130:133], v[174:177], 0
v_mfma_f32_16x16x32_bf16 v[150:153], v[190:193], v[178:181], v[150:153]
s_waitcnt lgkmcnt(2)
v_mfma_f32_16x16x32_bf16 v[138:141], v[118:121], v[178:181], v[138:141]
s_waitcnt lgkmcnt(1)
v_mfma_f32_16x16x32_bf16 v[142:145], v[126:129], v[178:181], v[142:145]
s_waitcnt lgkmcnt(0)
v_mfma_f32_16x16x32_bf16 v[146:149], v[134:137], v[178:181], v[146:149]
v_max3_f32 v167, v154, v155, v156
v_max3_f32 v167, v167, v157, v158
v_max3_f32 v167, v167, v159, v160
v_max3_f32 v167, v167, v161, v162
v_max3_f32 v167, v167, v163, v164
v_max3_f32 v167, v167, v165, v166
v_mov_b32 v168, v167
s_nop 1
v_permlane16_swap_b32 v167, v168
v_max_f32 v167, v167, v168
v_mov_b32 v168, v167
s_nop 1
v_permlane32_swap_b32 v167, v168
v_max_f32 v167, v167, v168
v_sub_f32 v154, v154, v167
v_sub_f32 v155, v155, v167
v_sub_f32 v156, v156, v167
v_sub_f32 v157, v157, v167
v_sub_f32 v158, v158, v167
v_sub_f32 v159, v159, v167
v_sub_f32 v160, v160, v167
v_sub_f32 v161, v161, v167
v_sub_f32 v166, v166, v167
v_sub_f32 v162, v162, v167
v_sub_f32 v163, v163, v167
v_sub_f32 v164, v164, v167
v_sub_f32 v165, v165, v167
v_exp_f32 v154, v154
v_exp_f32 v155, v155
v_exp_f32 v156, v156
v_exp_f32 v157, v157
v_exp_f32 v158, v158
v_exp_f32 v159, v159
v_exp_f32 v160, v160
v_exp_f32 v161, v161
v_exp_f32 v166, v166
v_exp_f32 v162, v162
v_exp_f32 v163, v163
v_exp_f32 v164, v164
v_exp_f32 v165, v165
v_cvt_pk_bf16_f32 v174, v154, v155
v_cvt_pk_bf16_f32 v175, v156, v157
v_cvt_pk_bf16_f32 v176, v158, v159
v_cvt_pk_bf16_f32 v177, v160, v161
v_cvt_pk_bf16_f32 v178, v162, v163
v_cvt_pk_bf16_f32 v179, v164, v165
v_cvt_pk_bf16_f32 v180, v166, 0
v_mfma_f32_16x16x32_bf16 v[166:169], v[190:193], v[174:177], 0
v_mfma_f32_16x16x32_bf16 v[154:157], v[114:117], v[174:177], 0
v_mfma_f32_16x16x32_bf16 v[158:161], v[122:125], v[174:177], 0
v_mfma_f32_16x16x32_bf16 v[162:165], v[130:133], v[174:177], 0
v_mfma_f32_16x16x32_bf16 v[166:169], v[190:193], v[178:181], v[166:169]
v_mfma_f32_16x16x32_bf16 v[154:157], v[118:121], v[178:181], v[154:157]
v_mfma_f32_16x16x32_bf16 v[158:161], v[126:129], v[178:181], v[158:161]
v_mfma_f32_16x16x32_bf16 v[162:165], v[134:137], v[178:181], v[162:165]
v_rcp_f32 v151, v150
s_nop 0
v_mul_f32 v151, s3, v151
v_mul_f32 v138, v138, v151
v_mul_f32 v139, v139, v151
v_cvt_pk_bf16_f32 v138, v138, v139
v_mul_f32 v140, v140, v151
v_mul_f32 v141, v141, v151
v_cvt_pk_bf16_f32 v139, v140, v141
v_mul_f32 v142, v142, v151
v_mul_f32 v143, v143, v151
v_cvt_pk_bf16_f32 v140, v142, v143
v_mul_f32 v144, v144, v151
v_mul_f32 v145, v145, v151
v_cvt_pk_bf16_f32 v141, v144, v145
ds_write_b128 v211, v[138:141] offset:36864
v_mul_f32 v146, v146, v151
v_mul_f32 v147, v147, v151
v_cvt_pk_bf16_f32 v142, v146, v147
v_mul_f32 v148, v148, v151
v_mul_f32 v149, v149, v151
v_cvt_pk_bf16_f32 v143, v148, v149
ds_write_b64 v212, v[142:143] offset:36864
v_mfma_f32_16x16x32_bf16 v[138:141], v[78:81], v[90:93], 0
v_mfma_f32_16x16x32_bf16 v[142:145], v[96:99], v[90:93], 0
v_mfma_f32_16x16x32_bf16 v[150:153], v[108:111], v[90:93], v[206:209]
v_mfma_f32_16x16x32_bf16 v[146:149], v[102:105], v[90:93], 0
v_mfma_f32_16x16x16_bf16 v[138:141], v[82:83], v[94:95], v[138:141]
v_mfma_f32_16x16x16_bf16 v[142:145], v[100:101], v[94:95], v[142:145]
v_mfma_f32_16x16x16_bf16 v[150:153], v[112:113], v[94:95], v[150:153]
v_mfma_f32_16x16x16_bf16 v[146:149], v[106:107], v[94:95], v[146:149]
v_rcp_f32 v167, v166
s_nop 0
v_mul_f32 v167, s3, v167
v_mul_f32 v154, v154, v167
v_mul_f32 v155, v155, v167
v_cvt_pk_bf16_f32 v154, v154, v155
v_mul_f32 v156, v156, v167
v_mul_f32 v157, v157, v167
v_cvt_pk_bf16_f32 v155, v156, v157
v_mul_f32 v158, v158, v167
v_mul_f32 v159, v159, v167
v_cvt_pk_bf16_f32 v156, v158, v159
v_mul_f32 v160, v160, v167
v_mul_f32 v161, v161, v167
v_cvt_pk_bf16_f32 v157, v160, v161
ds_write_b128 v211, v[154:157] offset:43008
v_mul_f32 v162, v162, v167
v_mul_f32 v163, v163, v167
v_cvt_pk_bf16_f32 v158, v162, v163
v_mul_f32 v164, v164, v167
v_mul_f32 v165, v165, v167
v_cvt_pk_bf16_f32 v159, v164, v165
ds_write_b64 v212, v[158:159] offset:43008
v_mfma_f32_16x16x16_bf16 v[154:157], v[76:77], v[82:83], 0
v_mfma_f32_16x16x16_bf16 v[158:161], v[76:77], v[100:101], 0
v_mfma_f32_16x16x16_bf16 v[162:165], v[76:77], v[106:107], 0
v_mfma_f32_16x16x16_bf16 v[166:169], v[76:77], v[112:113], v[206:209]
v_mfma_f32_16x16x32_bf16 v[154:157], v[72:75], v[78:81], v[154:157]
v_mfma_f32_16x16x32_bf16 v[158:161], v[72:75], v[96:99], v[158:161]
v_mfma_f32_16x16x32_bf16 v[162:165], v[72:75], v[102:105], v[162:165]
v_mfma_f32_16x16x32_bf16 v[166:169], v[72:75], v[108:111], v[166:169]
v_mov_b32_dpp v154, v158 quad_perm:[0,1,2,3] row_mask:0x2 bank_mask:0xf
s_nop 1
v_mov_b32_dpp v154, v162 quad_perm:[0,1,2,3] row_mask:0x4 bank_mask:0xf
s_nop 2
v_mov_b32_dpp v154, v167 quad_perm:[0,1,2,3] row_mask:0x8 bank_mask:0xf
v_mov_b32 v155, v154
s_nop 1
v_max_f32_dpp v155, v155, v155 row_ror:8 row_mask:0xf bank_mask:0xf
s_nop 1
v_max_f32_dpp v155, v155, v155 row_ror:4 row_mask:0xf bank_mask:0xf
s_nop 1
v_max_f32_dpp v155, v155, v155 row_ror:2 row_mask:0xf bank_mask:0xf
s_nop 1
v_max_f32_dpp v155, v155, v155 row_ror:1 row_mask:0xf bank_mask:0xf
v_mov_b32 v156, v155
s_nop 1
v_permlane16_swap_b32 v155, v156
v_max_f32 v155, v155, v156
v_mov_b32 v156, v155
s_nop 1
v_permlane32_swap_b32 v155, v156
v_max_f32 v155, v155, v156
v_sub_f32 v154, v154, v155
v_exp_f32 v154, v154
s_nop 0
v_cvt_pk_bf16_f32 v154, v154, 0
ds_write_b16 v214, v154
s_waitcnt lgkmcnt(1)
ds_read_b128 v[84:87], v215
ds_read_b128 v[88:91], v215 offset:16
v_add_u32 v215, 1552, v215
s_barrier
ds_read_b128 v[170:173], v210 offset:36864
s_waitcnt lgkmcnt(0)
v_mfma_f32_16x16x32_bf16 v[0:3], a[144:147], v[170:173], v[0:3]
v_mfma_f32_16x16x32_bf16 v[4:7], a[168:171], v[170:173], v[4:7]
v_mfma_f32_16x16x32_bf16 v[8:11], a[192:195], v[170:173], v[8:11]
ds_read_b128 v[182:185], v210 offset:37888
s_waitcnt lgkmcnt(0)
v_mfma_f32_16x16x32_bf16 v[0:3], a[148:151], v[182:185], v[0:3]
v_mfma_f32_16x16x32_bf16 v[4:7], a[172:175], v[182:185], v[4:7]
v_mfma_f32_16x16x32_bf16 v[8:11], a[196:199], v[182:185], v[8:11]
ds_read_b128 v[186:189], v210 offset:38912
s_waitcnt lgkmcnt(0)
v_mfma_f32_16x16x32_bf16 v[0:3], a[152:155], v[186:189], v[0:3]
v_mfma_f32_16x16x32_bf16 v[4:7], a[176:179], v[186:189], v[4:7]
v_mfma_f32_16x16x32_bf16 v[8:11], a[200:203], v[186:189], v[8:11]
ds_read_b128 v[170:173], v210 offset:39936
s_waitcnt lgkmcnt(0)
v_mfma_f32_16x16x32_bf16 v[0:3], a[156:159], v[170:173], v[0:3]
v_mfma_f32_16x16x32_bf16 v[4:7], a[180:183], v[170:173], v[4:7]
v_mfma_f32_16x16x32_bf16 v[8:11], a[204:207], v[170:173], v[8:11]
ds_read_b128 v[182:185], v210 offset:40960
s_waitcnt lgkmcnt(0)
v_mfma_f32_16x16x32_bf16 v[0:3], a[160:163], v[182:185], v[0:3]
v_mfma_f32_16x16x32_bf16 v[4:7], a[184:187], v[182:185], v[4:7]
v_mfma_f32_16x16x32_bf16 v[8:11], a[208:211], v[182:185], v[8:11]
ds_read_b128 v[186:189], v210 offset:41984
s_waitcnt lgkmcnt(0)
v_mfma_f32_16x16x32_bf16 v[0:3], a[164:167], v[186:189], v[0:3]
v_mfma_f32_16x16x32_bf16 v[4:7], a[188:191], v[186:189], v[4:7]
v_mfma_f32_16x16x32_bf16 v[8:11], a[212:215], v[186:189], v[8:11]
v_cvt_pk_bf16_f32 v72, v0, v1
v_cvt_pk_bf16_f32 v73, v2, v3
buffer_store_dwordx2 v[72:73], v203, s[8:11], s38 offen
v_cvt_pk_bf16_f32 v74, v4, v5
v_cvt_pk_bf16_f32 v75, v6, v7
buffer_store_dwordx2 v[74:75], v203, s[8:11], s38 offen offset:32
s_nop 0
v_cvt_pk_bf16_f32 v76, v8, v9
v_cvt_pk_bf16_f32 v77, v10, v11
buffer_store_dwordx2 v[76:77], v203, s[8:11], s38 offen offset:64
v_max3_f32 v151, v138, v139, v140
v_max3_f32 v151, v151, v141, v142
v_max3_f32 v151, v151, v143, v144
v_max3_f32 v151, v151, v145, v146
v_max3_f32 v151, v151, v147, v148
v_max3_f32 v151, v151, v149, v150
v_mov_b32 v152, v151
s_nop 1
v_permlane16_swap_b32 v151, v152
v_max_f32 v151, v151, v152
v_mov_b32 v152, v151
s_nop 1
v_permlane32_swap_b32 v151, v152
v_max_f32 v151, v151, v152
v_sub_f32 v138, v138, v151
v_sub_f32 v139, v139, v151
v_sub_f32 v140, v140, v151
v_sub_f32 v141, v141, v151
v_sub_f32 v142, v142, v151
v_sub_f32 v143, v143, v151
v_sub_f32 v144, v144, v151
v_sub_f32 v145, v145, v151
v_sub_f32 v150, v150, v151
v_sub_f32 v146, v146, v151
v_sub_f32 v147, v147, v151
v_sub_f32 v148, v148, v151
v_sub_f32 v149, v149, v151
v_exp_f32 v138, v138
v_exp_f32 v139, v139
v_exp_f32 v140, v140
v_exp_f32 v141, v141
v_exp_f32 v142, v142
v_exp_f32 v143, v143
v_exp_f32 v144, v144
v_exp_f32 v145, v145
v_exp_f32 v150, v150
v_exp_f32 v146, v146
v_exp_f32 v147, v147
v_exp_f32 v148, v148
v_exp_f32 v149, v149
v_cvt_pk_bf16_f32 v174, v138, v139
v_cvt_pk_bf16_f32 v175, v140, v141
v_cvt_pk_bf16_f32 v176, v142, v143
v_cvt_pk_bf16_f32 v177, v144, v145
v_cvt_pk_bf16_f32 v178, v146, v147
v_cvt_pk_bf16_f32 v179, v148, v149
v_cvt_pk_bf16_f32 v180, v150, 0
v_mfma_f32_16x16x32_bf16 v[150:153], v[190:193], v[174:177], 0
v_mfma_f32_16x16x32_bf16 v[138:141], v[114:117], v[174:177], 0
v_mfma_f32_16x16x32_bf16 v[142:145], v[122:125], v[174:177], 0
v_mfma_f32_16x16x32_bf16 v[146:149], v[130:133], v[174:177], 0
v_mfma_f32_16x16x32_bf16 v[150:153], v[190:193], v[178:181], v[150:153]
v_mfma_f32_16x16x32_bf16 v[138:141], v[118:121], v[178:181], v[138:141]
v_mfma_f32_16x16x32_bf16 v[142:145], v[126:129], v[178:181], v[142:145]
v_mfma_f32_16x16x32_bf16 v[146:149], v[134:137], v[178:181], v[146:149]
v_mfma_f32_16x16x32_bf16 v[166:169], v[84:87], v[190:193], 0
v_mfma_f32_16x16x32_bf16 v[154:157], v[84:87], v[114:117], 0
v_mfma_f32_16x16x32_bf16 v[158:161], v[84:87], v[122:125], 0
v_mfma_f32_16x16x32_bf16 v[162:165], v[84:87], v[130:133], 0
v_mfma_f32_16x16x32_bf16 v[166:169], v[88:91], v[190:193], v[166:169]
v_mfma_f32_16x16x32_bf16 v[154:157], v[88:91], v[118:121], v[154:157]
v_mfma_f32_16x16x32_bf16 v[158:161], v[88:91], v[126:129], v[158:161]
v_mfma_f32_16x16x32_bf16 v[162:165], v[88:91], v[134:137], v[162:165]
v_rcp_f32 v167, v166
s_nop 1
v_mov_b32_dpp v154, v158 quad_perm:[0,1,2,3] row_mask:0x2 bank_mask:0xf
s_nop 2
v_mov_b32_dpp v154, v162 quad_perm:[0,1,2,3] row_mask:0x4 bank_mask:0xf
v_mul_f32 v167, s3, v167
v_mul_f32 v154, v154, v167
v_cvt_pk_bf16_f32 v154, v154, 0
ds_write_b16 v214, v154
v_add_u32 v214, 1552, v214
ds_read_b128 v[170:173], v210 offset:43008
s_waitcnt lgkmcnt(0)
v_mfma_f32_16x16x32_bf16 v[12:15], a[144:147], v[170:173], v[12:15]
v_mfma_f32_16x16x32_bf16 v[16:19], a[168:171], v[170:173], v[16:19]
v_mfma_f32_16x16x32_bf16 v[20:23], a[192:195], v[170:173], v[20:23]
ds_read_b128 v[182:185], v210 offset:44032
s_waitcnt lgkmcnt(0)
v_mfma_f32_16x16x32_bf16 v[12:15], a[148:151], v[182:185], v[12:15]
v_mfma_f32_16x16x32_bf16 v[16:19], a[172:175], v[182:185], v[16:19]
v_mfma_f32_16x16x32_bf16 v[20:23], a[196:199], v[182:185], v[20:23]
ds_read_b128 v[186:189], v210 offset:45056
s_waitcnt lgkmcnt(0)
v_mfma_f32_16x16x32_bf16 v[12:15], a[152:155], v[186:189], v[12:15]
v_mfma_f32_16x16x32_bf16 v[16:19], a[176:179], v[186:189], v[16:19]
v_mfma_f32_16x16x32_bf16 v[20:23], a[200:203], v[186:189], v[20:23]
ds_read_b128 v[170:173], v210 offset:46080
s_waitcnt lgkmcnt(0)
v_mfma_f32_16x16x32_bf16 v[12:15], a[156:159], v[170:173], v[12:15]
v_mfma_f32_16x16x32_bf16 v[16:19], a[180:183], v[170:173], v[16:19]
v_mfma_f32_16x16x32_bf16 v[20:23], a[204:207], v[170:173], v[20:23]
ds_read_b128 v[182:185], v210 offset:47104
s_waitcnt lgkmcnt(0)
v_mfma_f32_16x16x32_bf16 v[12:15], a[160:163], v[182:185], v[12:15]
v_mfma_f32_16x16x32_bf16 v[16:19], a[184:187], v[182:185], v[16:19]
v_mfma_f32_16x16x32_bf16 v[20:23], a[208:211], v[182:185], v[20:23]
ds_read_b128 v[186:189], v210 offset:48128
s_waitcnt lgkmcnt(0)
v_mfma_f32_16x16x32_bf16 v[12:15], a[164:167], v[186:189], v[12:15]
v_mfma_f32_16x16x32_bf16 v[16:19], a[188:191], v[186:189], v[16:19]
v_mfma_f32_16x16x32_bf16 v[20:23], a[212:215], v[186:189], v[20:23]
v_cvt_pk_bf16_f32 v78, v12, v13
v_cvt_pk_bf16_f32 v79, v14, v15
buffer_store_dwordx2 v[78:79], v204, s[8:11], s38 offen
v_cvt_pk_bf16_f32 v80, v16, v17
v_cvt_pk_bf16_f32 v81, v18, v19
buffer_store_dwordx2 v[80:81], v204, s[8:11], s38 offen offset:32
s_nop 0
v_cvt_pk_bf16_f32 v82, v20, v21
v_cvt_pk_bf16_f32 v83, v22, v23
buffer_store_dwordx2 v[82:83], v204, s[8:11], s38 offen offset:64
v_rcp_f32 v151, v150
s_nop 0
v_mul_f32 v151, s3, v151
v_mul_f32 v138, v138, v151
v_mul_f32 v139, v139, v151
v_cvt_pk_bf16_f32 v138, v138, v139
v_mul_f32 v140, v140, v151
v_mul_f32 v141, v141, v151
v_cvt_pk_bf16_f32 v139, v140, v141
v_mul_f32 v142, v142, v151
v_mul_f32 v143, v143, v151
v_cvt_pk_bf16_f32 v140, v142, v143
v_mul_f32 v144, v144, v151
v_mul_f32 v145, v145, v151
v_cvt_pk_bf16_f32 v141, v144, v145
ds_write_b128 v211, v[138:141] offset:49152
v_mul_f32 v146, v146, v151
v_mul_f32 v147, v147, v151
v_cvt_pk_bf16_f32 v142, v146, v147
v_mul_f32 v148, v148, v151
v_mul_f32 v149, v149, v151
v_cvt_pk_bf16_f32 v143, v148, v149
ds_write_b64 v212, v[142:143] offset:49152
s_sub_u32 s46, s46, 1
s_cmp_lg_u32 s46, 0
s_cbranch_scc1 G_loop

s_waitcnt vmcnt(6) lgkmcnt(0)
s_barrier
ds_read_b128 v[170:173], v210 offset:49152
s_waitcnt lgkmcnt(0)
v_mfma_f32_16x16x32_bf16 v[24:27], a[144:147], v[170:173], v[24:27]
v_mfma_f32_16x16x32_bf16 v[28:31], a[168:171], v[170:173], v[28:31]
v_mfma_f32_16x16x32_bf16 v[32:35], a[192:195], v[170:173], v[32:35]
ds_read_b128 v[182:185], v210 offset:50176
s_waitcnt lgkmcnt(0)
v_mfma_f32_16x16x32_bf16 v[24:27], a[148:151], v[182:185], v[24:27]
v_mfma_f32_16x16x32_bf16 v[28:31], a[172:175], v[182:185], v[28:31]
v_mfma_f32_16x16x32_bf16 v[32:35], a[196:199], v[182:185], v[32:35]
ds_read_b128 v[186:189], v210 offset:51200
s_waitcnt lgkmcnt(0)
v_mfma_f32_16x16x32_bf16 v[24:27], a[152:155], v[186:189], v[24:27]
v_mfma_f32_16x16x32_bf16 v[28:31], a[176:179], v[186:189], v[28:31]
v_mfma_f32_16x16x32_bf16 v[32:35], a[200:203], v[186:189], v[32:35]
ds_read_b128 v[170:173], v210 offset:52224
s_waitcnt lgkmcnt(0)
v_mfma_f32_16x16x32_bf16 v[24:27], a[156:159], v[170:173], v[24:27]
v_mfma_f32_16x16x32_bf16 v[28:31], a[180:183], v[170:173], v[28:31]
v_mfma_f32_16x16x32_bf16 v[32:35], a[204:207], v[170:173], v[32:35]
ds_read_b128 v[182:185], v210 offset:53248
s_waitcnt lgkmcnt(0)
v_mfma_f32_16x16x32_bf16 v[24:27], a[160:163], v[182:185], v[24:27]
v_mfma_f32_16x16x32_bf16 v[28:31], a[184:187], v[182:185], v[28:31]
v_mfma_f32_16x16x32_bf16 v[32:35], a[208:211], v[182:185], v[32:35]
ds_read_b128 v[186:189], v210 offset:54272
s_waitcnt lgkmcnt(0)
v_mfma_f32_16x16x32_bf16 v[24:27], a[164:167], v[186:189], v[24:27]
v_mfma_f32_16x16x32_bf16 v[28:31], a[188:191], v[186:189], v[28:31]
v_mfma_f32_16x16x32_bf16 v[32:35], a[212:215], v[186:189], v[32:35]
v_cvt_pk_bf16_f32 v116, v24, v25
v_cvt_pk_bf16_f32 v117, v26, v27
buffer_store_dwordx2 v[116:117], v205, s[8:11], s38 offen
v_cvt_pk_bf16_f32 v124, v28, v29
v_cvt_pk_bf16_f32 v125, v30, v31
buffer_store_dwordx2 v[124:125], v205, s[8:11], s38 offen offset:32
s_nop 0
v_cvt_pk_bf16_f32 v132, v32, v33
v_cvt_pk_bf16_f32 v133, v34, v35
buffer_store_dwordx2 v[132:133], v205, s[8:11], s38 offen offset:64
s_mov_b32 s39, s37
ds_read_b128 v[174:177], v217
ds_read_b128 v[84:87], v200
s_waitcnt lgkmcnt(0)
v_mfma_f32_16x16x32_bf16 v[0:3], v[174:177], v[84:87], 0
ds_read_b128 v[92:95], v201
s_waitcnt lgkmcnt(0)
v_mfma_f32_16x16x32_bf16 v[12:15], v[174:177], v[92:95], 0
ds_read_b128 v[100:103], v202
s_waitcnt lgkmcnt(0)
v_mfma_f32_16x16x32_bf16 v[24:27], v[174:177], v[100:103], 0
ds_read_b128 v[178:181], v217 offset:528
ds_read_b128 v[84:87], v194
ds_read_b128 v[88:91], v194 offset:16
s_waitcnt lgkmcnt(0)
v_smfmac_f32_16x16x64_bf16 v[0:3], v[178:181], v[84:91], v213
ds_read_b128 v[92:95], v195
ds_read_b128 v[96:99], v195 offset:16
s_waitcnt lgkmcnt(0)
v_smfmac_f32_16x16x64_bf16 v[12:15], v[178:181], v[92:99], v213
ds_read_b128 v[100:103], v196
ds_read_b128 v[104:107], v196 offset:16
s_waitcnt lgkmcnt(0)
v_smfmac_f32_16x16x64_bf16 v[24:27], v[178:181], v[100:107], v213
ds_read_b128 v[174:177], v217 offset:1056
ds_read_b128 v[84:87], v197
ds_read_b128 v[88:91], v197 offset:16
s_waitcnt lgkmcnt(0)
v_smfmac_f32_16x16x64_bf16 v[0:3], v[174:177], v[84:91], v213
ds_read_b128 v[92:95], v198
ds_read_b128 v[96:99], v198 offset:16
s_waitcnt lgkmcnt(0)
v_smfmac_f32_16x16x64_bf16 v[12:15], v[174:177], v[92:99], v213
ds_read_b128 v[100:103], v199
ds_read_b128 v[104:107], v199 offset:16
s_waitcnt lgkmcnt(0)
v_smfmac_f32_16x16x64_bf16 v[24:27], v[174:177], v[100:107], v213
ds_read_b128 v[178:181], v217 offset:1584
ds_read_b128 v[84:87], v200 offset:32
s_waitcnt lgkmcnt(0)
v_mfma_f32_16x16x32_bf16 v[4:7], v[178:181], v[84:87], 0
ds_read_b128 v[92:95], v201 offset:32
s_waitcnt lgkmcnt(0)
v_mfma_f32_16x16x32_bf16 v[16:19], v[178:181], v[92:95], 0
ds_read_b128 v[100:103], v202 offset:32
s_waitcnt lgkmcnt(0)
v_mfma_f32_16x16x32_bf16 v[28:31], v[178:181], v[100:103], 0
ds_read_b128 v[174:177], v217 offset:2112
ds_read_b128 v[84:87], v194 offset:32
ds_read_b128 v[88:91], v194 offset:48
s_waitcnt lgkmcnt(0)
v_smfmac_f32_16x16x64_bf16 v[4:7], v[174:177], v[84:91], v213
ds_read_b128 v[92:95], v195 offset:32
ds_read_b128 v[96:99], v195 offset:48
s_waitcnt lgkmcnt(0)
v_smfmac_f32_16x16x64_bf16 v[16:19], v[174:177], v[92:99], v213
ds_read_b128 v[100:103], v196 offset:32
ds_read_b128 v[104:107], v196 offset:48
s_waitcnt lgkmcnt(0)
v_smfmac_f32_16x16x64_bf16 v[28:31], v[174:177], v[100:107], v213
ds_read_b128 v[178:181], v217 offset:2640
ds_read_b128 v[84:87], v197 offset:32
ds_read_b128 v[88:91], v197 offset:48
s_waitcnt lgkmcnt(0)
v_smfmac_f32_16x16x64_bf16 v[4:7], v[178:181], v[84:91], v213
ds_read_b128 v[92:95], v198 offset:32
ds_read_b128 v[96:99], v198 offset:48
s_waitcnt lgkmcnt(0)
v_smfmac_f32_16x16x64_bf16 v[16:19], v[178:181], v[92:99], v213
ds_read_b128 v[100:103], v199 offset:32
ds_read_b128 v[104:107], v199 offset:48
s_waitcnt lgkmcnt(0)
v_smfmac_f32_16x16x64_bf16 v[28:31], v[178:181], v[100:107], v213
ds_read_b128 v[174:177], v217 offset:3168
ds_read_b128 v[84:87], v200 offset:64
s_waitcnt lgkmcnt(0)
v_mfma_f32_16x16x32_bf16 v[8:11], v[174:177], v[84:87], 0
ds_read_b128 v[92:95], v201 offset:64
s_waitcnt lgkmcnt(0)
v_mfma_f32_16x16x32_bf16 v[20:23], v[174:177], v[92:95], 0
ds_read_b128 v[100:103], v202 offset:64
s_waitcnt lgkmcnt(0)
v_mfma_f32_16x16x32_bf16 v[32:35], v[174:177], v[100:103], 0
ds_read_b128 v[178:181], v217 offset:3696
ds_read_b128 v[84:87], v194 offset:64
ds_read_b128 v[88:91], v194 offset:80
s_waitcnt lgkmcnt(0)
v_smfmac_f32_16x16x64_bf16 v[8:11], v[178:181], v[84:91], v213
ds_read_b128 v[92:95], v195 offset:64
ds_read_b128 v[96:99], v195 offset:80
s_waitcnt lgkmcnt(0)
v_smfmac_f32_16x16x64_bf16 v[20:23], v[178:181], v[92:99], v213
ds_read_b128 v[100:103], v196 offset:64
ds_read_b128 v[104:107], v196 offset:80
s_waitcnt lgkmcnt(0)
v_smfmac_f32_16x16x64_bf16 v[32:35], v[178:181], v[100:107], v213
ds_read_b128 v[174:177], v217 offset:4224
ds_read_b128 v[84:87], v197 offset:64
ds_read_b128 v[88:91], v197 offset:80
s_waitcnt lgkmcnt(0)
v_smfmac_f32_16x16x64_bf16 v[8:11], v[174:177], v[84:91], v213
ds_read_b128 v[92:95], v198 offset:64
ds_read_b128 v[96:99], v198 offset:80
s_waitcnt lgkmcnt(0)
v_smfmac_f32_16x16x64_bf16 v[20:23], v[174:177], v[92:99], v213
ds_read_b128 v[100:103], v199 offset:64
ds_read_b128 v[104:107], v199 offset:80
s_waitcnt lgkmcnt(0)
v_smfmac_f32_16x16x64_bf16 v[32:35], v[174:177], v[100:107], v213
v_add_f32 v118, v0, v1
v_mul_f32 v119, v0, v0
v_add_f32 v118, v118, v2
v_fmac_f32 v119, v1, v1
v_add_f32 v118, v118, v3
v_fmac_f32 v119, v2, v2
v_fmac_f32 v119, v3, v3
v_add_f32 v126, v12, v13
v_mul_f32 v127, v12, v12
v_add_f32 v126, v126, v14
v_fmac_f32 v127, v13, v13
v_add_f32 v126, v126, v15
v_fmac_f32 v127, v14, v14
v_fmac_f32 v127, v15, v15
v_add_f32 v134, v24, v25
v_mul_f32 v135, v24, v24
v_add_f32 v134, v134, v26
v_fmac_f32 v135, v25, v25
v_add_f32 v134, v134, v27
v_fmac_f32 v135, v26, v26
v_fmac_f32 v135, v27, v27
v_add_f32 v118, v118, v4
v_fmac_f32 v119, v4, v4
v_add_f32 v118, v118, v5
v_fmac_f32 v119, v5, v5
v_add_f32 v118, v118, v6
v_fmac_f32 v119, v6, v6
v_add_f32 v118, v118, v7
v_fmac_f32 v119, v7, v7
v_add_f32 v126, v126, v16
v_fmac_f32 v127, v16, v16
v_add_f32 v126, v126, v17
v_fmac_f32 v127, v17, v17
v_add_f32 v126, v126, v18
v_fmac_f32 v127, v18, v18
v_add_f32 v126, v126, v19
v_fmac_f32 v127, v19, v19
v_add_f32 v134, v134, v28
v_fmac_f32 v135, v28, v28
v_add_f32 v134, v134, v29
v_fmac_f32 v135, v29, v29
v_add_f32 v134, v134, v30
v_fmac_f32 v135, v30, v30
v_add_f32 v134, v134, v31
v_fmac_f32 v135, v31, v31
v_add_f32 v118, v118, v8
v_fmac_f32 v119, v8, v8
v_add_f32 v118, v118, v9
v_fmac_f32 v119, v9, v9
v_add_f32 v118, v118, v10
v_fmac_f32 v119, v10, v10
v_add_f32 v118, v118, v11
v_fmac_f32 v119, v11, v11
v_add_f32 v126, v126, v20
v_fmac_f32 v127, v20, v20
v_add_f32 v126, v126, v21
v_fmac_f32 v127, v21, v21
v_add_f32 v126, v126, v22
v_fmac_f32 v127, v22, v22
v_add_f32 v126, v126, v23
v_fmac_f32 v127, v23, v23
v_add_f32 v134, v134, v32
v_fmac_f32 v135, v32, v32
v_add_f32 v134, v134, v33
v_fmac_f32 v135, v33, v33
v_add_f32 v134, v134, v34
v_fmac_f32 v135, v34, v34
v_add_f32 v134, v134, v35
v_fmac_f32 v135, v35, v35
v_permlane16_swap_b32 v118, v119
v_add_f32 v118, v118, v119
v_permlane16_swap_b32 v126, v127
v_add_f32 v126, v126, v127
v_permlane16_swap_b32 v134, v135
v_add_f32 v134, v134, v135
v_permlane32_swap_b32 v118, v126
v_add_f32 v118, v118, v126
ds_write_b32 v209, v118
v_mov_b32 v135, v134
s_nop 1
v_permlane32_swap_b32 v134, v135
v_add_f32 v134, v134, v135
ds_write_b32 v209, v134 offset:512
s_waitcnt lgkmcnt(0)
s_barrier
s_mov_b32 s37, s50
v_and_b32 v180, s44, v208
s_add_u32 m0, s45, 0
s_nop 0
buffer_load_dwordx4 v180, s[4:7], s52 offen nt lds
s_add_u32 m0, s45, 4112
s_add_u32 s40, s37, 196224
buffer_load_dwordx4 v180, s[4:7], s40 offen nt lds
s_add_u32 m0, s45, 8224
s_add_u32 s40, s37, 392448
buffer_load_dwordx4 v180, s[4:7], s40 offen nt lds
s_add_u32 m0, s45, 12336
s_add_u32 s40, s37, 588672
buffer_load_dwordx4 v180, s[4:7], s40 offen nt lds
s_add_u32 m0, s45, 16448
s_add_u32 s40, s37, 784896
buffer_load_dwordx4 v180, s[4:7], s40 offen nt lds
s_add_u32 m0, s45, 20560
s_add_u32 s40, s37, 981120
buffer_load_dwordx4 v180, s[4:7], s40 offen nt lds
s_add_u32 m0, s45, 24672
s_add_u32 s40, s37, 1177344
buffer_load_dwordx4 v180, s[4:7], s40 offen nt lds
s_add_u32 m0, s45, 28784
s_add_u32 s40, s37, 1373568
buffer_load_dwordx4 v180, s[4:7], s40 offen nt lds
s_add_u32 m0, s45, 32896
s_add_u32 s40, s37, 1569792
buffer_load_dwordx4 v180, s[4:7], s40 offen nt lds
s_mul_hi_u32 s41, s35, 58835169
s_mul_i32 s42, s41, 73
s_sub_u32 s42, s35, s42
s_mul_i32 s43, s41, 1373568
s_mul_i32 s51, s42, 2688
s_add_u32 s43, s43, s51
s_cmp_lt_u32 s35, s34
s_cselect_b32 s50, s43, 1879048192
s_add_u32 s35, s35, 32
s_cmp_eq_u32 s42, 0
s_cselect_b32 s44, 536870911, s72
s_cmp_eq_u32 s42, 72
s_cselect_b32 s44, 939524095, s44
s_cmp_eq_u32 s41, 0
s_cselect_b32 s52, 1879048192, s50
ds_read_b128 v[102:105], v210 offset:55296
ds_read_b128 v[106:109], v210 offset:56320
s_waitcnt lgkmcnt(1)
v_add_f32 v102, v102, v103
s_waitcnt lgkmcnt(0)
v_add_f32 v106, v106, v107
v_add_f32 v104, v104, v105
v_add_f32 v108, v108, v109
v_add_f32 v102, v102, v104
v_add_f32 v106, v106, v108
v_mul_f32 v103, s48, v102
v_mul_f32 v104, s73, v102
v_mul_f32 v106, s73, v106
v_fma_f32 v106, -v103, v104, v106
v_max_f32 v106, 0, v106
v_add_f32 v106, s49, v106
v_rsq_f32 v102, v106
s_nop 0
v_mul_f32_e64 v103, -v103, v102
ds_write_b64 v211, v[102:103] offset:36864
ds_read_b64 v[118:119], v219
ds_read_b64 v[126:127], v219 offset:256
ds_read_b64 v[134:135], v219 offset:512
s_waitcnt lgkmcnt(2)
v_fma_f32 v220, v0, v118, v119
v_fma_f32 v221, v1, v118, v119
v_cvt_pk_bf16_f32 v90, v220, v221
v_fma_f32 v222, v2, v118, v119
v_fma_f32 v223, v3, v118, v119
v_cvt_pk_bf16_f32 v91, v222, v223
v_fma_f32 v220, v4, v118, v119
v_fma_f32 v221, v5, v118, v119
v_cvt_pk_bf16_f32 v92, v220, v221
v_fma_f32 v222, v6, v118, v119
v_fma_f32 v223, v7, v118, v119
v_cvt_pk_bf16_f32 v93, v222, v223
ds_write_b128 v211, v[90:93]
v_fma_f32 v220, v8, v118, v119
v_fma_f32 v221, v9, v118, v119
v_cvt_pk_bf16_f32 v94, v220, v221
v_fma_f32 v222, v10, v118, v119
v_fma_f32 v223, v11, v118, v119
v_cvt_pk_bf16_f32 v95, v222, v223
s_waitcnt lgkmcnt(2)
ds_write_b64 v212, v[94:95]
v_fma_f32 v220, v12, v126, v127
v_fma_f32 v221, v13, v126, v127
v_cvt_pk_bf16_f32 v174, v220, v221
v_fma_f32 v222, v14, v126, v127
v_fma_f32 v223, v15, v126, v127
v_cvt_pk_bf16_f32 v175, v222, v223
v_fma_f32 v220, v16, v126, v127
v_fma_f32 v221, v17, v126, v127
v_cvt_pk_bf16_f32 v176, v220, v221
v_fma_f32 v222, v18, v126, v127
v_fma_f32 v223, v19, v126, v127
v_cvt_pk_bf16_f32 v177, v222, v223
ds_write_b128 v211, v[174:177] offset:6144
v_fma_f32 v220, v20, v126, v127
v_fma_f32 v221, v21, v126, v127
v_cvt_pk_bf16_f32 v178, v220, v221
v_fma_f32 v222, v22, v126, v127
v_fma_f32 v223, v23, v126, v127
v_cvt_pk_bf16_f32 v179, v222, v223
s_waitcnt lgkmcnt(3)
ds_write_b64 v212, v[178:179] offset:6144
v_fma_f32 v220, v24, v134, v135
v_fma_f32 v221, v25, v134, v135
v_cvt_pk_bf16_f32 v90, v220, v221
v_fma_f32 v222, v26, v134, v135
v_fma_f32 v223, v27, v134, v135
v_cvt_pk_bf16_f32 v91, v222, v223
v_fma_f32 v220, v28, v134, v135
v_fma_f32 v221, v29, v134, v135
v_cvt_pk_bf16_f32 v92, v220, v221
v_fma_f32 v222, v30, v134, v135
v_fma_f32 v223, v31, v134, v135
v_cvt_pk_bf16_f32 v93, v222, v223
ds_write_b128 v211, v[90:93] offset:12288
v_fma_f32 v220, v32, v134, v135
v_fma_f32 v221, v33, v134, v135
v_cvt_pk_bf16_f32 v94, v220, v221
v_fma_f32 v222, v34, v134, v135
v_fma_f32 v223, v35, v134, v135
v_cvt_pk_bf16_f32 v95, v222, v223
ds_write_b64 v212, v[94:95] offset:12288
ds_read_b128 v[182:185], v210 offset:18432
s_waitcnt lgkmcnt(0)
v_mfma_f32_16x16x32_bf16 v[138:141], a[0:3], v[182:185], 0
v_mfma_f32_16x16x32_bf16 v[142:145], a[24:27], v[182:185], 0
v_mfma_f32_16x16x32_bf16 v[146:149], a[48:51], v[182:185], 0
v_mfma_f32_16x16x32_bf16 v[150:153], a[216:219], v[182:185], 0
v_mfma_f32_16x16x32_bf16 v[154:157], a[240:243], v[182:185], 0
v_mfma_f32_16x16x32_bf16 v[158:161], v[232:235], v[182:185], 0
v_mfma_f32_16x16x32_bf16 v[162:165], v[182:185], a[72:75], 0
v_mfma_f32_16x16x32_bf16 v[166:169], v[182:185], a[96:99], 0
v_mfma_f32_16x16x32_bf16 v[170:173], v[182:185], a[120:123], 0
ds_read_b128 v[186:189], v210 offset:19456
s_waitcnt lgkmcnt(0)
v_mfma_f32_16x16x32_bf16 v[138:141], a[4:7], v[186:189], v[138:141]
v_mfma_f32_16x16x32_bf16 v[142:145], a[28:31], v[186:189], v[142:145]
v_mfma_f32_16x16x32_bf16 v[146:149], a[52:55], v[186:189], v[146:149]
v_mfma_f32_16x16x32_bf16 v[150:153], a[220:223], v[186:189], v[150:153]
v_mfma_f32_16x16x32_bf16 v[154:157], a[244:247], v[186:189], v[154:157]
v_mfma_f32_16x16x32_bf16 v[158:161], v[236:239], v[186:189], v[158:161]
v_mfma_f32_16x16x32_bf16 v[162:165], v[186:189], a[76:79], v[162:165]
v_mfma_f32_16x16x32_bf16 v[166:169], v[186:189], a[100:103], v[166:169]
v_mfma_f32_16x16x32_bf16 v[170:173], v[186:189], a[124:127], v[170:173]
ds_read_b128 v[182:185], v210 offset:20480
s_waitcnt lgkmcnt(0)
v_mfma_f32_16x16x32_bf16 v[138:141], a[8:11], v[182:185], v[138:141]
v_mfma_f32_16x16x32_bf16 v[142:145], a[32:35], v[182:185], v[142:145]
v_mfma_f32_16x16x32_bf16 v[146:149], a[56:59], v[182:185], v[146:149]
v_mfma_f32_16x16x32_bf16 v[150:153], a[224:227], v[182:185], v[150:153]
v_mfma_f32_16x16x32_bf16 v[154:157], a[248:251], v[182:185], v[154:157]
v_mfma_f32_16x16x32_bf16 v[158:161], v[240:243], v[182:185], v[158:161]
v_mfma_f32_16x16x32_bf16 v[162:165], v[182:185], a[80:83], v[162:165]
v_mfma_f32_16x16x32_bf16 v[166:169], v[182:185], a[104:107], v[166:169]
v_mfma_f32_16x16x32_bf16 v[170:173], v[182:185], a[128:131], v[170:173]
ds_read_b128 v[186:189], v210 offset:21504
s_waitcnt lgkmcnt(0)
v_mfma_f32_16x16x32_bf16 v[138:141], a[12:15], v[186:189], v[138:141]
v_mfma_f32_16x16x32_bf16 v[142:145], a[36:39], v[186:189], v[142:145]
v_mfma_f32_16x16x32_bf16 v[146:149], a[60:63], v[186:189], v[146:149]
v_mfma_f32_16x16x32_bf16 v[150:153], a[228:231], v[186:189], v[150:153]
v_mfma_f32_16x16x32_bf16 v[154:157], a[252:255], v[186:189], v[154:157]
v_mfma_f32_16x16x32_bf16 v[158:161], v[244:247], v[186:189], v[158:161]
v_mfma_f32_16x16x32_bf16 v[162:165], v[186:189], a[84:87], v[162:165]
v_mfma_f32_16x16x32_bf16 v[166:169], v[186:189], a[108:111], v[166:169]
v_mfma_f32_16x16x32_bf16 v[170:173], v[186:189], a[132:135], v[170:173]
ds_read_b128 v[182:185], v210 offset:22528
s_waitcnt lgkmcnt(0)
v_mfma_f32_16x16x32_bf16 v[138:141], a[16:19], v[182:185], v[138:141]
v_mfma_f32_16x16x32_bf16 v[142:145], a[40:43], v[182:185], v[142:145]
v_mfma_f32_16x16x32_bf16 v[146:149], a[64:67], v[182:185], v[146:149]
v_mfma_f32_16x16x32_bf16 v[150:153], a[232:235], v[182:185], v[150:153]
v_mfma_f32_16x16x32_bf16 v[154:157], v[224:227], v[182:185], v[154:157]
v_mfma_f32_16x16x32_bf16 v[158:161], v[248:251], v[182:185], v[158:161]
v_mfma_f32_16x16x32_bf16 v[162:165], v[182:185], a[88:91], v[162:165]
v_mfma_f32_16x16x32_bf16 v[166:169], v[182:185], a[112:115], v[166:169]
v_mfma_f32_16x16x32_bf16 v[170:173], v[182:185], a[136:139], v[170:173]
ds_read_b128 v[186:189], v210 offset:23552
s_waitcnt lgkmcnt(0)
v_mfma_f32_16x16x32_bf16 v[138:141], a[20:23], v[186:189], v[138:141]
v_mfma_f32_16x16x32_bf16 v[142:145], a[44:47], v[186:189], v[142:145]
v_mfma_f32_16x16x32_bf16 v[146:149], a[68:71], v[186:189], v[146:149]
v_mfma_f32_16x16x32_bf16 v[150:153], a[236:239], v[186:189], v[150:153]
v_mfma_f32_16x16x32_bf16 v[154:157], v[228:231], v[186:189], v[154:157]
v_mfma_f32_16x16x32_bf16 v[158:161], v[252:255], v[186:189], v[158:161]
v_mfma_f32_16x16x32_bf16 v[162:165], v[186:189], a[92:95], v[162:165]
v_mfma_f32_16x16x32_bf16 v[166:169], v[186:189], a[116:119], v[166:169]
v_mfma_f32_16x16x32_bf16 v[170:173], v[186:189], a[140:143], v[170:173]
v_cvt_pk_bf16_f32 v78, v138, v139
v_cvt_pk_bf16_f32 v79, v140, v141
v_cvt_pk_bf16_f32 v80, v142, v143
v_cvt_pk_bf16_f32 v81, v144, v145
v_cvt_pk_bf16_f32 v82, v146, v147
v_cvt_pk_bf16_f32 v83, v148, v149
v_cvt_pk_bf16_f32 v72, v150, v151
v_cvt_pk_bf16_f32 v73, v152, v153
v_cvt_pk_bf16_f32 v74, v154, v155
v_cvt_pk_bf16_f32 v75, v156, v157
v_cvt_pk_bf16_f32 v76, v158, v159
v_cvt_pk_bf16_f32 v77, v160, v161
v_cvt_pk_bf16_f32 v114, v162, v163
v_cvt_pk_bf16_f32 v115, v164, v165
v_cvt_pk_bf16_f32 v122, v166, v167
v_cvt_pk_bf16_f32 v123, v168, v169
v_cvt_pk_bf16_f32 v130, v170, v171
v_cvt_pk_bf16_f32 v131, v172, v173
ds_read_b128 v[182:185], v210 offset:24576
s_waitcnt lgkmcnt(0)
v_mfma_f32_16x16x32_bf16 v[138:141], a[0:3], v[182:185], 0
v_mfma_f32_16x16x32_bf16 v[142:145], a[24:27], v[182:185], 0
v_mfma_f32_16x16x32_bf16 v[146:149], a[48:51], v[182:185], 0
v_mfma_f32_16x16x32_bf16 v[150:153], a[216:219], v[182:185], 0
v_mfma_f32_16x16x32_bf16 v[154:157], a[240:243], v[182:185], 0
v_mfma_f32_16x16x32_bf16 v[158:161], v[232:235], v[182:185], 0
v_mfma_f32_16x16x32_bf16 v[162:165], v[182:185], a[72:75], 0
v_mfma_f32_16x16x32_bf16 v[166:169], v[182:185], a[96:99], 0
v_mfma_f32_16x16x32_bf16 v[170:173], v[182:185], a[120:123], 0
ds_read_b128 v[186:189], v210 offset:25600
s_waitcnt lgkmcnt(0)
v_mfma_f32_16x16x32_bf16 v[138:141], a[4:7], v[186:189], v[138:141]
v_mfma_f32_16x16x32_bf16 v[142:145], a[28:31], v[186:189], v[142:145]
v_mfma_f32_16x16x32_bf16 v[146:149], a[52:55], v[186:189], v[146:149]
v_mfma_f32_16x16x32_bf16 v[150:153], a[220:223], v[186:189], v[150:153]
v_mfma_f32_16x16x32_bf16 v[154:157], a[244:247], v[186:189], v[154:157]
v_mfma_f32_16x16x32_bf16 v[158:161], v[236:239], v[186:189], v[158:161]
v_mfma_f32_16x16x32_bf16 v[162:165], v[186:189], a[76:79], v[162:165]
v_mfma_f32_16x16x32_bf16 v[166:169], v[186:189], a[100:103], v[166:169]
v_mfma_f32_16x16x32_bf16 v[170:173], v[186:189], a[124:127], v[170:173]
ds_read_b128 v[182:185], v210 offset:26624
s_waitcnt lgkmcnt(0)
v_mfma_f32_16x16x32_bf16 v[138:141], a[8:11], v[182:185], v[138:141]
v_mfma_f32_16x16x32_bf16 v[142:145], a[32:35], v[182:185], v[142:145]
v_mfma_f32_16x16x32_bf16 v[146:149], a[56:59], v[182:185], v[146:149]
v_mfma_f32_16x16x32_bf16 v[150:153], a[224:227], v[182:185], v[150:153]
v_mfma_f32_16x16x32_bf16 v[154:157], a[248:251], v[182:185], v[154:157]
v_mfma_f32_16x16x32_bf16 v[158:161], v[240:243], v[182:185], v[158:161]
v_mfma_f32_16x16x32_bf16 v[162:165], v[182:185], a[80:83], v[162:165]
v_mfma_f32_16x16x32_bf16 v[166:169], v[182:185], a[104:107], v[166:169]
v_mfma_f32_16x16x32_bf16 v[170:173], v[182:185], a[128:131], v[170:173]
ds_read_b128 v[186:189], v210 offset:27648
s_waitcnt lgkmcnt(0)
v_mfma_f32_16x16x32_bf16 v[138:141], a[12:15], v[186:189], v[138:141]
v_mfma_f32_16x16x32_bf16 v[142:145], a[36:39], v[186:189], v[142:145]
v_mfma_f32_16x16x32_bf16 v[146:149], a[60:63], v[186:189], v[146:149]
v_mfma_f32_16x16x32_bf16 v[150:153], a[228:231], v[186:189], v[150:153]
v_mfma_f32_16x16x32_bf16 v[154:157], a[252:255], v[186:189], v[154:157]
v_mfma_f32_16x16x32_bf16 v[158:161], v[244:247], v[186:189], v[158:161]
v_mfma_f32_16x16x32_bf16 v[162:165], v[186:189], a[84:87], v[162:165]
v_mfma_f32_16x16x32_bf16 v[166:169], v[186:189], a[108:111], v[166:169]
v_mfma_f32_16x16x32_bf16 v[170:173], v[186:189], a[132:135], v[170:173]
ds_read_b128 v[182:185], v210 offset:28672
s_waitcnt lgkmcnt(0)
v_mfma_f32_16x16x32_bf16 v[138:141], a[16:19], v[182:185], v[138:141]
v_mfma_f32_16x16x32_bf16 v[142:145], a[40:43], v[182:185], v[142:145]
v_mfma_f32_16x16x32_bf16 v[146:149], a[64:67], v[182:185], v[146:149]
v_mfma_f32_16x16x32_bf16 v[150:153], a[232:235], v[182:185], v[150:153]
v_mfma_f32_16x16x32_bf16 v[154:157], v[224:227], v[182:185], v[154:157]
v_mfma_f32_16x16x32_bf16 v[158:161], v[248:251], v[182:185], v[158:161]
v_mfma_f32_16x16x32_bf16 v[162:165], v[182:185], a[88:91], v[162:165]
v_mfma_f32_16x16x32_bf16 v[166:169], v[182:185], a[112:115], v[166:169]
v_mfma_f32_16x16x32_bf16 v[170:173], v[182:185], a[136:139], v[170:173]
ds_read_b128 v[186:189], v210 offset:29696
s_waitcnt lgkmcnt(0)
v_mfma_f32_16x16x32_bf16 v[138:141], a[20:23], v[186:189], v[138:141]
v_mfma_f32_16x16x32_bf16 v[142:145], a[44:47], v[186:189], v[142:145]
v_mfma_f32_16x16x32_bf16 v[146:149], a[68:71], v[186:189], v[146:149]
v_mfma_f32_16x16x32_bf16 v[150:153], a[236:239], v[186:189], v[150:153]
v_mfma_f32_16x16x32_bf16 v[154:157], v[228:231], v[186:189], v[154:157]
v_mfma_f32_16x16x32_bf16 v[158:161], v[252:255], v[186:189], v[158:161]
v_mfma_f32_16x16x32_bf16 v[162:165], v[186:189], a[92:95], v[162:165]
v_mfma_f32_16x16x32_bf16 v[166:169], v[186:189], a[116:119], v[166:169]
v_mfma_f32_16x16x32_bf16 v[170:173], v[186:189], a[140:143], v[170:173]
v_cvt_pk_bf16_f32 v96, v138, v139
v_cvt_pk_bf16_f32 v97, v140, v141
v_cvt_pk_bf16_f32 v98, v142, v143
v_cvt_pk_bf16_f32 v99, v144, v145
v_cvt_pk_bf16_f32 v100, v146, v147
v_cvt_pk_bf16_f32 v101, v148, v149
v_cvt_pk_bf16_f32 v84, v150, v151
v_cvt_pk_bf16_f32 v85, v152, v153
v_cvt_pk_bf16_f32 v86, v154, v155
v_cvt_pk_bf16_f32 v87, v156, v157
v_cvt_pk_bf16_f32 v88, v158, v159
v_cvt_pk_bf16_f32 v89, v160, v161
v_cvt_pk_bf16_f32 v116, v162, v163
v_cvt_pk_bf16_f32 v117, v164, v165
v_cvt_pk_bf16_f32 v124, v166, v167
v_cvt_pk_bf16_f32 v125, v168, v169
v_cvt_pk_bf16_f32 v132, v170, v171
v_cvt_pk_bf16_f32 v133, v172, v173
ds_read_b128 v[182:185], v210 offset:30720
s_waitcnt lgkmcnt(0)
v_mfma_f32_16x16x32_bf16 v[138:141], a[0:3], v[182:185], 0
v_mfma_f32_16x16x32_bf16 v[142:145], a[24:27], v[182:185], 0
v_mfma_f32_16x16x32_bf16 v[146:149], a[48:51], v[182:185], 0
ds_read_b128 v[186:189], v210 offset:31744
s_waitcnt lgkmcnt(0)
v_mfma_f32_16x16x32_bf16 v[138:141], a[4:7], v[186:189], v[138:141]
v_mfma_f32_16x16x32_bf16 v[142:145], a[28:31], v[186:189], v[142:145]
v_mfma_f32_16x16x32_bf16 v[146:149], a[52:55], v[186:189], v[146:149]
ds_read_b128 v[182:185], v210 offset:32768
s_waitcnt lgkmcnt(0)
v_mfma_f32_16x16x32_bf16 v[138:141], a[8:11], v[182:185], v[138:141]
v_mfma_f32_16x16x32_bf16 v[142:145], a[32:35], v[182:185], v[142:145]
v_mfma_f32_16x16x32_bf16 v[146:149], a[56:59], v[182:185], v[146:149]
ds_read_b128 v[186:189], v210 offset:33792
s_waitcnt lgkmcnt(0)
v_mfma_f32_16x16x32_bf16 v[138:141], a[12:15], v[186:189], v[138:141]
v_mfma_f32_16x16x32_bf16 v[142:145], a[36:39], v[186:189], v[142:145]
v_mfma_f32_16x16x32_bf16 v[146:149], a[60:63], v[186:189], v[146:149]
ds_read_b128 v[182:185], v210 offset:34816
s_waitcnt lgkmcnt(0)
v_mfma_f32_16x16x32_bf16 v[138:141], a[16:19], v[182:185], v[138:141]
v_mfma_f32_16x16x32_bf16 v[142:145], a[40:43], v[182:185], v[142:145]
v_mfma_f32_16x16x32_bf16 v[146:149], a[64:67], v[182:185], v[146:149]
ds_read_b128 v[186:189], v210 offset:35840
s_waitcnt lgkmcnt(0)
v_mfma_f32_16x16x32_bf16 v[138:141], a[20:23], v[186:189], v[138:141]
v_mfma_f32_16x16x32_bf16 v[142:145], a[44:47], v[186:189], v[142:145]
v_mfma_f32_16x16x32_bf16 v[146:149], a[68:71], v[186:189], v[146:149]
v_cvt_pk_bf16_f32 v102, v138, v139
v_cvt_pk_bf16_f32 v103, v140, v141
s_nop 0
v_cvt_pk_bf16_f32 v104, v142, v143
v_cvt_pk_bf16_f32 v105, v144, v145
s_nop 1
v_cvt_pk_bf16_f32 v106, v146, v147
v_cvt_pk_bf16_f32 v107, v148, v149
ds_read_b128 v[108:111], v215 offset:512
ds_read_b64 v[112:113], v215 offset:528
v_mov_b32 v181, 0
v_mfma_f32_16x16x16_bf16 v[138:141], v[82:83], v[76:77], 0
v_mfma_f32_16x16x16_bf16 v[142:145], v[100:101], v[76:77], 0
s_waitcnt lgkmcnt(0)
v_mfma_f32_16x16x16_bf16 v[150:153], v[112:113], v[76:77], v[206:209]
v_mfma_f32_16x16x16_bf16 v[146:149], v[106:107], v[76:77], 0
v_mfma_f32_16x16x32_bf16 v[138:141], v[78:81], v[72:75], v[138:141]
v_mfma_f32_16x16x32_bf16 v[142:145], v[96:99], v[72:75], v[142:145]
v_mfma_f32_16x16x32_bf16 v[150:153], v[108:111], v[72:75], v[150:153]
v_mfma_f32_16x16x32_bf16 v[146:149], v[102:105], v[72:75], v[146:149]
ds_read_b128 v[72:75], v215
ds_read_b64 v[76:77], v215 offset:16
v_mfma_f32_16x16x16_bf16 v[154:157], v[82:83], v[88:89], 0
v_mfma_f32_16x16x16_bf16 v[158:161], v[100:101], v[88:89], 0
v_mfma_f32_16x16x16_bf16 v[166:169], v[112:113], v[88:89], v[206:209]
v_mfma_f32_16x16x16_bf16 v[162:165], v[106:107], v[88:89], 0
v_mfma_f32_16x16x32_bf16 v[154:157], v[78:81], v[84:87], v[154:157]
v_mfma_f32_16x16x32_bf16 v[158:161], v[96:99], v[84:87], v[158:161]
v_mfma_f32_16x16x32_bf16 v[166:169], v[108:111], v[84:87], v[166:169]
v_mfma_f32_16x16x32_bf16 v[162:165], v[102:105], v[84:87], v[162:165]
ds_read_b128 v[182:185], v210 offset:30720
s_waitcnt lgkmcnt(0)
v_mfma_f32_16x16x32_bf16 v[118:121], v[182:185], a[72:75], 0
v_mfma_f32_16x16x32_bf16 v[126:129], v[182:185], a[96:99], 0
v_mfma_f32_16x16x32_bf16 v[134:137], v[182:185], a[120:123], 0
v_mfma_f32_16x16x32_bf16 v[90:93], a[216:219], v[182:185], 0
v_mfma_f32_16x16x32_bf16 v[170:173], a[240:243], v[182:185], 0
v_mfma_f32_16x16x32_bf16 v[220:223], v[232:235], v[182:185], 0
ds_read_b128 v[186:189], v210 offset:31744
s_waitcnt lgkmcnt(0)
v_mfma_f32_16x16x32_bf16 v[118:121], v[186:189], a[76:79], v[118:121]
v_mfma_f32_16x16x32_bf16 v[126:129], v[186:189], a[100:103], v[126:129]
v_mfma_f32_16x16x32_bf16 v[134:137], v[186:189], a[124:127], v[134:137]
v_mfma_f32_16x16x32_bf16 v[90:93], a[220:223], v[186:189], v[90:93]
v_mfma_f32_16x16x32_bf16 v[170:173], a[244:247], v[186:189], v[170:173]
v_mfma_f32_16x16x32_bf16 v[220:223], v[236:239], v[186:189], v[220:223]
ds_read_b128 v[182:185], v210 offset:32768
s_waitcnt lgkmcnt(0)
v_mfma_f32_16x16x32_bf16 v[118:121], v[182:185], a[80:83], v[118:121]
v_mfma_f32_16x16x32_bf16 v[126:129], v[182:185], a[104:107], v[126:129]
v_mfma_f32_16x16x32_bf16 v[134:137], v[182:185], a[128:131], v[134:137]
v_mfma_f32_16x16x32_bf16 v[90:93], a[224:227], v[182:185], v[90:93]
v_mfma_f32_16x16x32_bf16 v[170:173], a[248:251], v[182:185], v[170:173]
v_mfma_f32_16x16x32_bf16 v[220:223], v[240:243], v[182:185], v[220:223]
ds_read_b128 v[186:189], v210 offset:33792
s_waitcnt lgkmcnt(0)
v_mfma_f32_16x16x32_bf16 v[118:121], v[186:189], a[84:87], v[118:121]
v_mfma_f32_16x16x32_bf16 v[126:129], v[186:189], a[108:111], v[126:129]
v_mfma_f32_16x16x32_bf16 v[134:137], v[186:189], a[132:135], v[134:137]
v_mfma_f32_16x16x32_bf16 v[90:93], a[228:231], v[186:189], v[90:93]
v_mfma_f32_16x16x32_bf16 v[170:173], a[252:255], v[186:189], v[170:173]
v_mfma_f32_16x16x32_bf16 v[220:223], v[244:247], v[186:189], v[220:223]
ds_read_b128 v[182:185], v210 offset:34816
s_waitcnt lgkmcnt(0)
v_mfma_f32_16x16x32_bf16 v[118:121], v[182:185], a[88:91], v[118:121]
v_mfma_f32_16x16x32_bf16 v[126:129], v[182:185], a[112:115], v[126:129]
v_mfma_f32_16x16x32_bf16 v[134:137], v[182:185], a[136:139], v[134:137]
v_mfma_f32_16x16x32_bf16 v[90:93], a[232:235], v[182:185], v[90:93]
v_mfma_f32_16x16x32_bf16 v[170:173], v[224:227], v[182:185], v[170:173]
v_mfma_f32_16x16x32_bf16 v[220:223], v[248:251], v[182:185], v[220:223]
ds_read_b128 v[186:189], v210 offset:35840
s_waitcnt lgkmcnt(0)
v_mfma_f32_16x16x32_bf16 v[118:121], v[186:189], a[92:95], v[118:121]
v_mfma_f32_16x16x32_bf16 v[126:129], v[186:189], a[116:119], v[126:129]
v_mfma_f32_16x16x32_bf16 v[134:137], v[186:189], a[140:143], v[134:137]
v_mfma_f32_16x16x32_bf16 v[90:93], a[236:239], v[186:189], v[90:93]
v_mfma_f32_16x16x32_bf16 v[170:173], v[228:231], v[186:189], v[170:173]
v_mfma_f32_16x16x32_bf16 v[220:223], v[252:255], v[186:189], v[220:223]
v_cvt_pk_bf16_f32 v118, v118, v119
v_cvt_pk_bf16_f32 v119, v120, v121
ds_read_u16 v120, v214 offset:1024
v_mov_b32 v121, 0
v_cvt_pk_bf16_f32 v126, v126, v127
v_cvt_pk_bf16_f32 v127, v128, v129
ds_read_u16 v128, v214 offset:1032
v_mov_b32 v129, 0
v_cvt_pk_bf16_f32 v134, v134, v135
v_cvt_pk_bf16_f32 v135, v136, v137
ds_read_u16 v136, v214 offset:1040
v_mov_b32 v137, 0
v_cvt_pk_bf16_f32 v90, v90, v91
v_cvt_pk_bf16_f32 v91, v92, v93
v_cvt_pk_bf16_f32 v92, v170, v171
v_cvt_pk_bf16_f32 v93, v172, v173
v_cvt_pk_bf16_f32 v94, v220, v221
v_cvt_pk_bf16_f32 v95, v222, v223
v_max3_f32 v151, v138, v139, v140
v_max3_f32 v151, v151, v141, v142
v_max3_f32 v151, v151, v143, v144
v_max3_f32 v151, v151, v145, v146
v_max3_f32 v151, v151, v147, v148
v_max3_f32 v151, v151, v149, v150
v_mov_b32 v152, v151
s_nop 1
v_permlane16_swap_b32 v151, v152
v_max_f32 v151, v151, v152
v_mov_b32 v152, v151
s_nop 1
v_permlane32_swap_b32 v151, v152
v_max_f32 v151, v151, v152
v_sub_f32 v138, v138, v151
v_sub_f32 v139, v139, v151
v_sub_f32 v140, v140, v151
v_sub_f32 v141, v141, v151
v_sub_f32 v142, v142, v151
v_sub_f32 v143, v143, v151
v_sub_f32 v144, v144, v151
v_sub_f32 v145, v145, v151
v_sub_f32 v150, v150, v151
v_sub_f32 v146, v146, v151
v_sub_f32 v147, v147, v151
v_sub_f32 v148, v148, v151
v_sub_f32 v149, v149, v151
v_exp_f32 v138, v138
v_exp_f32 v139, v139
v_exp_f32 v140, v140
v_exp_f32 v141, v141
v_exp_f32 v142, v142
v_exp_f32 v143, v143
v_exp_f32 v144, v144
v_exp_f32 v145, v145
v_exp_f32 v150, v150
v_exp_f32 v146, v146
v_exp_f32 v147, v147
v_exp_f32 v148, v148
v_exp_f32 v149, v149
v_cvt_pk_bf16_f32 v174, v138, v139
v_cvt_pk_bf16_f32 v175, v140, v141
v_cvt_pk_bf16_f32 v176, v142, v143
v_cvt_pk_bf16_f32 v177, v144, v145
v_cvt_pk_bf16_f32 v178, v146, v147
v_cvt_pk_bf16_f32 v179, v148, v149
v_cvt_pk_bf16_f32 v180, v150, 0
v_mfma_f32_16x16x32_bf16 v[150:153], v[190:193], v[174:177], 0
v_mfma_f32_16x16x32_bf16 v[138:141], v[114:117], v[174:177], 0
v_mfma_f32_16x16x32_bf16 v[142:145], v[122:125], v[174:177], 0
v_mfma_f32_16x16x32_bf16 v[146:149], v[130:133], v[174:177], 0
v_mfma_f32_16x16x32_bf16 v[150:153], v[190:193], v[178:181], v[150:153]
s_waitcnt lgkmcnt(2)
v_mfma_f32_16x16x32_bf16 v[138:141], v[118:121], v[178:181], v[138:141]
s_waitcnt lgkmcnt(1)
v_mfma_f32_16x16x32_bf16 v[142:145], v[126:129], v[178:181], v[142:145]
s_waitcnt lgkmcnt(0)
v_mfma_f32_16x16x32_bf16 v[146:149], v[134:137], v[178:181], v[146:149]
v_max3_f32 v167, v154, v155, v156
v_max3_f32 v167, v167, v157, v158
v_max3_f32 v167, v167, v159, v160
v_max3_f32 v167, v167, v161, v162
v_max3_f32 v167, v167, v163, v164
v_max3_f32 v167, v167, v165, v166
v_mov_b32 v168, v167
s_nop 1
v_permlane16_swap_b32 v167, v168
v_max_f32 v167, v167, v168
v_mov_b32 v168, v167
s_nop 1
v_permlane32_swap_b32 v167, v168
v_max_f32 v167, v167, v168
v_sub_f32 v154, v154, v167
v_sub_f32 v155, v155, v167
v_sub_f32 v156, v156, v167
v_sub_f32 v157, v157, v167
v_sub_f32 v158, v158, v167
v_sub_f32 v159, v159, v167
v_sub_f32 v160, v160, v167
v_sub_f32 v161, v161, v167
v_sub_f32 v166, v166, v167
v_sub_f32 v162, v162, v167
v_sub_f32 v163, v163, v167
v_sub_f32 v164, v164, v167
v_sub_f32 v165, v165, v167
v_exp_f32 v154, v154
v_exp_f32 v155, v155
v_exp_f32 v156, v156
v_exp_f32 v157, v157
v_exp_f32 v158, v158
v_exp_f32 v159, v159
v_exp_f32 v160, v160
v_exp_f32 v161, v161
v_exp_f32 v166, v166
v_exp_f32 v162, v162
v_exp_f32 v163, v163
v_exp_f32 v164, v164
v_exp_f32 v165, v165
v_cvt_pk_bf16_f32 v174, v154, v155
v_cvt_pk_bf16_f32 v175, v156, v157
v_cvt_pk_bf16_f32 v176, v158, v159
v_cvt_pk_bf16_f32 v177, v160, v161
v_cvt_pk_bf16_f32 v178, v162, v163
v_cvt_pk_bf16_f32 v179, v164, v165
v_cvt_pk_bf16_f32 v180, v166, 0
v_mfma_f32_16x16x32_bf16 v[166:169], v[190:193], v[174:177], 0
v_mfma_f32_16x16x32_bf16 v[154:157], v[114:117], v[174:177], 0
v_mfma_f32_16x16x32_bf16 v[158:161], v[122:125], v[174:177], 0
v_mfma_f32_16x16x32_bf16 v[162:165], v[130:133], v[174:177], 0
v_mfma_f32_16x16x32_bf16 v[166:169], v[190:193], v[178:181], v[166:169]
v_mfma_f32_16x16x32_bf16 v[154:157], v[118:121], v[178:181], v[154:157]
v_mfma_f32_16x16x32_bf16 v[158:161], v[126:129], v[178:181], v[158:161]
v_mfma_f32_16x16x32_bf16 v[162:165], v[134:137], v[178:181], v[162:165]
v_rcp_f32 v151, v150
s_nop 0
v_mul_f32 v151, s3, v151
v_mul_f32 v138, v138, v151
v_mul_f32 v139, v139, v151
v_cvt_pk_bf16_f32 v138, v138, v139
v_mul_f32 v140, v140, v151
v_mul_f32 v141, v141, v151
v_cvt_pk_bf16_f32 v139, v140, v141
v_mul_f32 v142, v142, v151
v_mul_f32 v143, v143, v151
v_cvt_pk_bf16_f32 v140, v142, v143
v_mul_f32 v144, v144, v151
v_mul_f32 v145, v145, v151
v_cvt_pk_bf16_f32 v141, v144, v145
ds_write_b128 v211, v[138:141] offset:36864
v_mul_f32 v146, v146, v151
v_mul_f32 v147, v147, v151
v_cvt_pk_bf16_f32 v142, v146, v147
v_mul_f32 v148, v148, v151
v_mul_f32 v149, v149, v151
v_cvt_pk_bf16_f32 v143, v148, v149
ds_write_b64 v212, v[142:143] offset:36864
v_mfma_f32_16x16x32_bf16 v[138:141], v[78:81], v[90:93], 0
v_mfma_f32_16x16x32_bf16 v[142:145], v[96:99], v[90:93], 0
v_mfma_f32_16x16x32_bf16 v[150:153], v[108:111], v[90:93], v[206:209]
v_mfma_f32_16x16x32_bf16 v[146:149], v[102:105], v[90:93], 0
v_mfma_f32_16x16x16_bf16 v[138:141], v[82:83], v[94:95], v[138:141]
v_mfma_f32_16x16x16_bf16 v[142:145], v[100:101], v[94:95], v[142:145]
v_mfma_f32_16x16x16_bf16 v[150:153], v[112:113], v[94:95], v[150:153]
v_mfma_f32_16x16x16_bf16 v[146:149], v[106:107], v[94:95], v[146:149]
v_rcp_f32 v167, v166
s_nop 0
v_mul_f32 v167, s3, v167
v_mul_f32 v154, v154, v167
v_mul_f32 v155, v155, v167
v_cvt_pk_bf16_f32 v154, v154, v155
v_mul_f32 v156, v156, v167
v_mul_f32 v157, v157, v167
v_cvt_pk_bf16_f32 v155, v156, v157
v_mul_f32 v158, v158, v167
v_mul_f32 v159, v159, v167
v_cvt_pk_bf16_f32 v156, v158, v159
v_mul_f32 v160, v160, v167
v_mul_f32 v161, v161, v167
v_cvt_pk_bf16_f32 v157, v160, v161
ds_write_b128 v211, v[154:157] offset:43008
v_mul_f32 v162, v162, v167
v_mul_f32 v163, v163, v167
v_cvt_pk_bf16_f32 v158, v162, v163
v_mul_f32 v164, v164, v167
v_mul_f32 v165, v165, v167
v_cvt_pk_bf16_f32 v159, v164, v165
ds_write_b64 v212, v[158:159] offset:43008
v_mfma_f32_16x16x16_bf16 v[154:157], v[76:77], v[82:83], 0
v_mfma_f32_16x16x16_bf16 v[158:161], v[76:77], v[100:101], 0
v_mfma_f32_16x16x16_bf16 v[162:165], v[76:77], v[106:107], 0
v_mfma_f32_16x16x16_bf16 v[166:169], v[76:77], v[112:113], v[206:209]
v_mfma_f32_16x16x32_bf16 v[154:157], v[72:75], v[78:81], v[154:157]
v_mfma_f32_16x16x32_bf16 v[158:161], v[72:75], v[96:99], v[158:161]
v_mfma_f32_16x16x32_bf16 v[162:165], v[72:75], v[102:105], v[162:165]
v_mfma_f32_16x16x32_bf16 v[166:169], v[72:75], v[108:111], v[166:169]
v_mov_b32_dpp v154, v158 quad_perm:[0,1,2,3] row_mask:0x2 bank_mask:0xf
s_nop 1
v_mov_b32_dpp v154, v162 quad_perm:[0,1,2,3] row_mask:0x4 bank_mask:0xf
s_nop 2
v_mov_b32_dpp v154, v167 quad_perm:[0,1,2,3] row_mask:0x8 bank_mask:0xf
v_mov_b32 v155, v154
s_nop 1
v_max_f32_dpp v155, v155, v155 row_ror:8 row_mask:0xf bank_mask:0xf
s_nop 1
v_max_f32_dpp v155, v155, v155 row_ror:4 row_mask:0xf bank_mask:0xf
s_nop 1
v_max_f32_dpp v155, v155, v155 row_ror:2 row_mask:0xf bank_mask:0xf
s_nop 1
v_max_f32_dpp v155, v155, v155 row_ror:1 row_mask:0xf bank_mask:0xf
v_mov_b32 v156, v155
s_nop 1
v_permlane16_swap_b32 v155, v156
v_max_f32 v155, v155, v156
v_mov_b32 v156, v155
s_nop 1
v_permlane32_swap_b32 v155, v156
v_max_f32 v155, v155, v156
v_sub_f32 v154, v154, v155
v_exp_f32 v154, v154
s_nop 0
v_cvt_pk_bf16_f32 v154, v154, 0
ds_write_b16 v214, v154
s_waitcnt lgkmcnt(1)
ds_read_b128 v[84:87], v215
ds_read_b128 v[88:91], v215 offset:16
v_add_u32 v215, 1552, v215
s_barrier
ds_read_b128 v[170:173], v210 offset:36864
s_waitcnt lgkmcnt(0)
v_mfma_f32_16x16x32_bf16 v[36:39], a[144:147], v[170:173], v[36:39]
v_mfma_f32_16x16x32_bf16 v[40:43], a[168:171], v[170:173], v[40:43]
v_mfma_f32_16x16x32_bf16 v[44:47], a[192:195], v[170:173], v[44:47]
ds_read_b128 v[182:185], v210 offset:37888
s_waitcnt lgkmcnt(0)
v_mfma_f32_16x16x32_bf16 v[36:39], a[148:151], v[182:185], v[36:39]
v_mfma_f32_16x16x32_bf16 v[40:43], a[172:175], v[182:185], v[40:43]
v_mfma_f32_16x16x32_bf16 v[44:47], a[196:199], v[182:185], v[44:47]
ds_read_b128 v[186:189], v210 offset:38912
s_waitcnt lgkmcnt(0)
v_mfma_f32_16x16x32_bf16 v[36:39], a[152:155], v[186:189], v[36:39]
v_mfma_f32_16x16x32_bf16 v[40:43], a[176:179], v[186:189], v[40:43]
v_mfma_f32_16x16x32_bf16 v[44:47], a[200:203], v[186:189], v[44:47]
ds_read_b128 v[170:173], v210 offset:39936
s_waitcnt lgkmcnt(0)
v_mfma_f32_16x16x32_bf16 v[36:39], a[156:159], v[170:173], v[36:39]
v_mfma_f32_16x16x32_bf16 v[40:43], a[180:183], v[170:173], v[40:43]
v_mfma_f32_16x16x32_bf16 v[44:47], a[204:207], v[170:173], v[44:47]
ds_read_b128 v[182:185], v210 offset:40960
s_waitcnt lgkmcnt(0)
v_mfma_f32_16x16x32_bf16 v[36:39], a[160:163], v[182:185], v[36:39]
v_mfma_f32_16x16x32_bf16 v[40:43], a[184:187], v[182:185], v[40:43]
v_mfma_f32_16x16x32_bf16 v[44:47], a[208:211], v[182:185], v[44:47]
ds_read_b128 v[186:189], v210 offset:41984
s_waitcnt lgkmcnt(0)
v_mfma_f32_16x16x32_bf16 v[36:39], a[164:167], v[186:189], v[36:39]
v_mfma_f32_16x16x32_bf16 v[40:43], a[188:191], v[186:189], v[40:43]
v_mfma_f32_16x16x32_bf16 v[44:47], a[212:215], v[186:189], v[44:47]
v_cvt_pk_bf16_f32 v72, v36, v37
v_cvt_pk_bf16_f32 v73, v38, v39
buffer_store_dwordx2 v[72:73], v203, s[8:11], s39 offen
v_cvt_pk_bf16_f32 v74, v40, v41
v_cvt_pk_bf16_f32 v75, v42, v43
buffer_store_dwordx2 v[74:75], v203, s[8:11], s39 offen offset:32
s_nop 0
v_cvt_pk_bf16_f32 v76, v44, v45
v_cvt_pk_bf16_f32 v77, v46, v47
buffer_store_dwordx2 v[76:77], v203, s[8:11], s39 offen offset:64
v_max3_f32 v151, v138, v139, v140
v_max3_f32 v151, v151, v141, v142
v_max3_f32 v151, v151, v143, v144
v_max3_f32 v151, v151, v145, v146
v_max3_f32 v151, v151, v147, v148
v_max3_f32 v151, v151, v149, v150
v_mov_b32 v152, v151
s_nop 1
v_permlane16_swap_b32 v151, v152
v_max_f32 v151, v151, v152
v_mov_b32 v152, v151
s_nop 1
v_permlane32_swap_b32 v151, v152
v_max_f32 v151, v151, v152
v_sub_f32 v138, v138, v151
v_sub_f32 v139, v139, v151
v_sub_f32 v140, v140, v151
v_sub_f32 v141, v141, v151
v_sub_f32 v142, v142, v151
v_sub_f32 v143, v143, v151
v_sub_f32 v144, v144, v151
v_sub_f32 v145, v145, v151
v_sub_f32 v150, v150, v151
v_sub_f32 v146, v146, v151
v_sub_f32 v147, v147, v151
v_sub_f32 v148, v148, v151
v_sub_f32 v149, v149, v151
v_exp_f32 v138, v138
v_exp_f32 v139, v139
v_exp_f32 v140, v140
v_exp_f32 v141, v141
v_exp_f32 v142, v142
v_exp_f32 v143, v143
v_exp_f32 v144, v144
v_exp_f32 v145, v145
v_exp_f32 v150, v150
v_exp_f32 v146, v146
v_exp_f32 v147, v147
v_exp_f32 v148, v148
v_exp_f32 v149, v149
v_cvt_pk_bf16_f32 v174, v138, v139
v_cvt_pk_bf16_f32 v175, v140, v141
v_cvt_pk_bf16_f32 v176, v142, v143
v_cvt_pk_bf16_f32 v177, v144, v145
v_cvt_pk_bf16_f32 v178, v146, v147
v_cvt_pk_bf16_f32 v179, v148, v149
v_cvt_pk_bf16_f32 v180, v150, 0
v_mfma_f32_16x16x32_bf16 v[150:153], v[190:193], v[174:177], 0
v_mfma_f32_16x16x32_bf16 v[138:141], v[114:117], v[174:177], 0
v_mfma_f32_16x16x32_bf16 v[142:145], v[122:125], v[174:177], 0
v_mfma_f32_16x16x32_bf16 v[146:149], v[130:133], v[174:177], 0
v_mfma_f32_16x16x32_bf16 v[150:153], v[190:193], v[178:181], v[150:153]
v_mfma_f32_16x16x32_bf16 v[138:141], v[118:121], v[178:181], v[138:141]
v_mfma_f32_16x16x32_bf16 v[142:145], v[126:129], v[178:181], v[142:145]
v_mfma_f32_16x16x32_bf16 v[146:149], v[134:137], v[178:181], v[146:149]
v_mfma_f32_16x16x32_bf16 v[166:169], v[84:87], v[190:193], 0
v_mfma_f32_16x16x32_bf16 v[154:157], v[84:87], v[114:117], 0
v_mfma_f32_16x16x32_bf16 v[158:161], v[84:87], v[122:125], 0
v_mfma_f32_16x16x32_bf16 v[162:165], v[84:87], v[130:133], 0
v_mfma_f32_16x16x32_bf16 v[166:169], v[88:91], v[190:193], v[166:169]
v_mfma_f32_16x16x32_bf16 v[154:157], v[88:91], v[118:121], v[154:157]
v_mfma_f32_16x16x32_bf16 v[158:161], v[88:91], v[126:129], v[158:161]
v_mfma_f32_16x16x32_bf16 v[162:165], v[88:91], v[134:137], v[162:165]
v_rcp_f32 v167, v166
s_nop 1
v_mov_b32_dpp v154, v158 quad_perm:[0,1,2,3] row_mask:0x2 bank_mask:0xf
s_nop 2
v_mov_b32_dpp v154, v162 quad_perm:[0,1,2,3] row_mask:0x4 bank_mask:0xf
v_mul_f32 v167, s3, v167
v_mul_f32 v154, v154, v167
v_cvt_pk_bf16_f32 v154, v154, 0
ds_write_b16 v214, v154
v_add_u32 v214, 1552, v214
ds_read_b128 v[170:173], v210 offset:43008
s_waitcnt lgkmcnt(0)
v_mfma_f32_16x16x32_bf16 v[48:51], a[144:147], v[170:173], v[48:51]
v_mfma_f32_16x16x32_bf16 v[52:55], a[168:171], v[170:173], v[52:55]
v_mfma_f32_16x16x32_bf16 v[56:59], a[192:195], v[170:173], v[56:59]
ds_read_b128 v[182:185], v210 offset:44032
s_waitcnt lgkmcnt(0)
v_mfma_f32_16x16x32_bf16 v[48:51], a[148:151], v[182:185], v[48:51]
v_mfma_f32_16x16x32_bf16 v[52:55], a[172:175], v[182:185], v[52:55]
v_mfma_f32_16x16x32_bf16 v[56:59], a[196:199], v[182:185], v[56:59]
ds_read_b128 v[186:189], v210 offset:45056
s_waitcnt lgkmcnt(0)
v_mfma_f32_16x16x32_bf16 v[48:51], a[152:155], v[186:189], v[48:51]
v_mfma_f32_16x16x32_bf16 v[52:55], a[176:179], v[186:189], v[52:55]
v_mfma_f32_16x16x32_bf16 v[56:59], a[200:203], v[186:189], v[56:59]
ds_read_b128 v[170:173], v210 offset:46080
s_waitcnt lgkmcnt(0)
v_mfma_f32_16x16x32_bf16 v[48:51], a[156:159], v[170:173], v[48:51]
v_mfma_f32_16x16x32_bf16 v[52:55], a[180:183], v[170:173], v[52:55]
v_mfma_f32_16x16x32_bf16 v[56:59], a[204:207], v[170:173], v[56:59]
ds_read_b128 v[182:185], v210 offset:47104
s_waitcnt lgkmcnt(0)
v_mfma_f32_16x16x32_bf16 v[48:51], a[160:163], v[182:185], v[48:51]
v_mfma_f32_16x16x32_bf16 v[52:55], a[184:187], v[182:185], v[52:55]
v_mfma_f32_16x16x32_bf16 v[56:59], a[208:211], v[182:185], v[56:59]
ds_read_b128 v[186:189], v210 offset:48128
s_waitcnt lgkmcnt(0)
v_mfma_f32_16x16x32_bf16 v[48:51], a[164:167], v[186:189], v[48:51]
v_mfma_f32_16x16x32_bf16 v[52:55], a[188:191], v[186:189], v[52:55]
v_mfma_f32_16x16x32_bf16 v[56:59], a[212:215], v[186:189], v[56:59]
v_cvt_pk_bf16_f32 v78, v48, v49
v_cvt_pk_bf16_f32 v79, v50, v51
buffer_store_dwordx2 v[78:79], v204, s[8:11], s39 offen
v_cvt_pk_bf16_f32 v80, v52, v53
v_cvt_pk_bf16_f32 v81, v54, v55
buffer_store_dwordx2 v[80:81], v204, s[8:11], s39 offen offset:32
s_nop 0
v_cvt_pk_bf16_f32 v82, v56, v57
v_cvt_pk_bf16_f32 v83, v58, v59
buffer_store_dwordx2 v[82:83], v204, s[8:11], s39 offen offset:64
v_rcp_f32 v151, v150
s_nop 0
v_mul_f32 v151, s3, v151
v_mul_f32 v138, v138, v151
v_mul_f32 v139, v139, v151
v_cvt_pk_bf16_f32 v138, v138, v139
v_mul_f32 v140, v140, v151
v_mul_f32 v141, v141, v151
v_cvt_pk_bf16_f32 v139, v140, v141
v_mul_f32 v142, v142, v151
v_mul_f32 v143, v143, v151
v_cvt_pk_bf16_f32 v140, v142, v143
v_mul_f32 v144, v144, v151
v_mul_f32 v145, v145, v151
v_cvt_pk_bf16_f32 v141, v144, v145
ds_write_b128 v211, v[138:141] offset:49152
v_mul_f32 v146, v146, v151
v_mul_f32 v147, v147, v151
v_cvt_pk_bf16_f32 v142, v146, v147
v_mul_f32 v148, v148, v151
v_mul_f32 v149, v149, v151
v_cvt_pk_bf16_f32 v143, v148, v149
ds_write_b64 v212, v[142:143] offset:49152
s_waitcnt vmcnt(6) lgkmcnt(0)
s_barrier
ds_read_b128 v[170:173], v210 offset:49152
s_waitcnt lgkmcnt(0)
v_mfma_f32_16x16x32_bf16 v[60:63], a[144:147], v[170:173], v[60:63]
v_mfma_f32_16x16x32_bf16 v[64:67], a[168:171], v[170:173], v[64:67]
v_mfma_f32_16x16x32_bf16 v[68:71], a[192:195], v[170:173], v[68:71]
ds_read_b128 v[182:185], v210 offset:50176
s_waitcnt lgkmcnt(0)
v_mfma_f32_16x16x32_bf16 v[60:63], a[148:151], v[182:185], v[60:63]
v_mfma_f32_16x16x32_bf16 v[64:67], a[172:175], v[182:185], v[64:67]
v_mfma_f32_16x16x32_bf16 v[68:71], a[196:199], v[182:185], v[68:71]
ds_read_b128 v[186:189], v210 offset:51200
s_waitcnt lgkmcnt(0)
v_mfma_f32_16x16x32_bf16 v[60:63], a[152:155], v[186:189], v[60:63]
v_mfma_f32_16x16x32_bf16 v[64:67], a[176:179], v[186:189], v[64:67]
v_mfma_f32_16x16x32_bf16 v[68:71], a[200:203], v[186:189], v[68:71]
ds_read_b128 v[170:173], v210 offset:52224
s_waitcnt lgkmcnt(0)
v_mfma_f32_16x16x32_bf16 v[60:63], a[156:159], v[170:173], v[60:63]
v_mfma_f32_16x16x32_bf16 v[64:67], a[180:183], v[170:173], v[64:67]
v_mfma_f32_16x16x32_bf16 v[68:71], a[204:207], v[170:173], v[68:71]
ds_read_b128 v[182:185], v210 offset:53248
s_waitcnt lgkmcnt(0)
v_mfma_f32_16x16x32_bf16 v[60:63], a[160:163], v[182:185], v[60:63]
v_mfma_f32_16x16x32_bf16 v[64:67], a[184:187], v[182:185], v[64:67]
v_mfma_f32_16x16x32_bf16 v[68:71], a[208:211], v[182:185], v[68:71]
ds_read_b128 v[186:189], v210 offset:54272
s_waitcnt lgkmcnt(0)
v_mfma_f32_16x16x32_bf16 v[60:63], a[164:167], v[186:189], v[60:63]
v_mfma_f32_16x16x32_bf16 v[64:67], a[188:191], v[186:189], v[64:67]
v_mfma_f32_16x16x32_bf16 v[68:71], a[212:215], v[186:189], v[68:71]
v_cvt_pk_bf16_f32 v116, v60, v61
v_cvt_pk_bf16_f32 v117, v62, v63
buffer_store_dwordx2 v[116:117], v205, s[8:11], s39 offen
v_cvt_pk_bf16_f32 v124, v64, v65
v_cvt_pk_bf16_f32 v125, v66, v67
buffer_store_dwordx2 v[124:125], v205, s[8:11], s39 offen offset:32
s_nop 0
v_cvt_pk_bf16_f32 v132, v68, v69
v_cvt_pk_bf16_f32 v133, v70, v71
buffer_store_dwordx2 v[132:133], v205, s[8:11], s39 offen offset:64
s_mov_b32 s38, s36
ds_read_b128 v[174:177], v217
ds_read_b128 v[84:87], v200
s_waitcnt lgkmcnt(0)
v_mfma_f32_16x16x32_bf16 v[36:39], v[174:177], v[84:87], 0
ds_read_b128 v[92:95], v201
s_waitcnt lgkmcnt(0)
v_mfma_f32_16x16x32_bf16 v[48:51], v[174:177], v[92:95], 0
ds_read_b128 v[100:103], v202
s_waitcnt lgkmcnt(0)
v_mfma_f32_16x16x32_bf16 v[60:63], v[174:177], v[100:103], 0
ds_read_b128 v[178:181], v217 offset:528
ds_read_b128 v[84:87], v194
ds_read_b128 v[88:91], v194 offset:16
s_waitcnt lgkmcnt(0)
v_smfmac_f32_16x16x64_bf16 v[36:39], v[178:181], v[84:91], v213
ds_read_b128 v[92:95], v195
ds_read_b128 v[96:99], v195 offset:16
s_waitcnt lgkmcnt(0)
v_smfmac_f32_16x16x64_bf16 v[48:51], v[178:181], v[92:99], v213
ds_read_b128 v[100:103], v196
ds_read_b128 v[104:107], v196 offset:16
s_waitcnt lgkmcnt(0)
v_smfmac_f32_16x16x64_bf16 v[60:63], v[178:181], v[100:107], v213
ds_read_b128 v[174:177], v217 offset:1056
ds_read_b128 v[84:87], v197
ds_read_b128 v[88:91], v197 offset:16
s_waitcnt lgkmcnt(0)
v_smfmac_f32_16x16x64_bf16 v[36:39], v[174:177], v[84:91], v213
ds_read_b128 v[92:95], v198
ds_read_b128 v[96:99], v198 offset:16
s_waitcnt lgkmcnt(0)
v_smfmac_f32_16x16x64_bf16 v[48:51], v[174:177], v[92:99], v213
ds_read_b128 v[100:103], v199
ds_read_b128 v[104:107], v199 offset:16
s_waitcnt lgkmcnt(0)
v_smfmac_f32_16x16x64_bf16 v[60:63], v[174:177], v[100:107], v213
ds_read_b128 v[178:181], v217 offset:1584
ds_read_b128 v[84:87], v200 offset:32
s_waitcnt lgkmcnt(0)
v_mfma_f32_16x16x32_bf16 v[40:43], v[178:181], v[84:87], 0
ds_read_b128 v[92:95], v201 offset:32
s_waitcnt lgkmcnt(0)
v_mfma_f32_16x16x32_bf16 v[52:55], v[178:181], v[92:95], 0
ds_read_b128 v[100:103], v202 offset:32
s_waitcnt lgkmcnt(0)
v_mfma_f32_16x16x32_bf16 v[64:67], v[178:181], v[100:103], 0
ds_read_b128 v[174:177], v217 offset:2112
ds_read_b128 v[84:87], v194 offset:32
ds_read_b128 v[88:91], v194 offset:48
s_waitcnt lgkmcnt(0)
v_smfmac_f32_16x16x64_bf16 v[40:43], v[174:177], v[84:91], v213
ds_read_b128 v[92:95], v195 offset:32
ds_read_b128 v[96:99], v195 offset:48
s_waitcnt lgkmcnt(0)
v_smfmac_f32_16x16x64_bf16 v[52:55], v[174:177], v[92:99], v213
ds_read_b128 v[100:103], v196 offset:32
ds_read_b128 v[104:107], v196 offset:48
s_waitcnt lgkmcnt(0)
v_smfmac_f32_16x16x64_bf16 v[64:67], v[174:177], v[100:107], v213
ds_read_b128 v[178:181], v217 offset:2640
ds_read_b128 v[84:87], v197 offset:32
ds_read_b128 v[88:91], v197 offset:48
s_waitcnt lgkmcnt(0)
v_smfmac_f32_16x16x64_bf16 v[40:43], v[178:181], v[84:91], v213
ds_read_b128 v[92:95], v198 offset:32
ds_read_b128 v[96:99], v198 offset:48
s_waitcnt lgkmcnt(0)
v_smfmac_f32_16x16x64_bf16 v[52:55], v[178:181], v[92:99], v213
ds_read_b128 v[100:103], v199 offset:32
ds_read_b128 v[104:107], v199 offset:48
s_waitcnt lgkmcnt(0)
v_smfmac_f32_16x16x64_bf16 v[64:67], v[178:181], v[100:107], v213
ds_read_b128 v[174:177], v217 offset:3168
ds_read_b128 v[84:87], v200 offset:64
s_waitcnt lgkmcnt(0)
v_mfma_f32_16x16x32_bf16 v[44:47], v[174:177], v[84:87], 0
ds_read_b128 v[92:95], v201 offset:64
s_waitcnt lgkmcnt(0)
v_mfma_f32_16x16x32_bf16 v[56:59], v[174:177], v[92:95], 0
ds_read_b128 v[100:103], v202 offset:64
s_waitcnt lgkmcnt(0)
v_mfma_f32_16x16x32_bf16 v[68:71], v[174:177], v[100:103], 0
ds_read_b128 v[178:181], v217 offset:3696
ds_read_b128 v[84:87], v194 offset:64
ds_read_b128 v[88:91], v194 offset:80
s_waitcnt lgkmcnt(0)
v_smfmac_f32_16x16x64_bf16 v[44:47], v[178:181], v[84:91], v213
ds_read_b128 v[92:95], v195 offset:64
ds_read_b128 v[96:99], v195 offset:80
s_waitcnt lgkmcnt(0)
v_smfmac_f32_16x16x64_bf16 v[56:59], v[178:181], v[92:99], v213
ds_read_b128 v[100:103], v196 offset:64
ds_read_b128 v[104:107], v196 offset:80
s_waitcnt lgkmcnt(0)
v_smfmac_f32_16x16x64_bf16 v[68:71], v[178:181], v[100:107], v213
ds_read_b128 v[174:177], v217 offset:4224
ds_read_b128 v[84:87], v197 offset:64
ds_read_b128 v[88:91], v197 offset:80
s_waitcnt lgkmcnt(0)
v_smfmac_f32_16x16x64_bf16 v[44:47], v[174:177], v[84:91], v213
ds_read_b128 v[92:95], v198 offset:64
ds_read_b128 v[96:99], v198 offset:80
s_waitcnt lgkmcnt(0)
v_smfmac_f32_16x16x64_bf16 v[56:59], v[174:177], v[92:99], v213
ds_read_b128 v[100:103], v199 offset:64
ds_read_b128 v[104:107], v199 offset:80
s_waitcnt lgkmcnt(0)
v_smfmac_f32_16x16x64_bf16 v[68:71], v[174:177], v[100:107], v213
v_add_f32 v118, v36, v37
v_mul_f32 v119, v36, v36
v_add_f32 v118, v118, v38
v_fmac_f32 v119, v37, v37
v_add_f32 v118, v118, v39
v_fmac_f32 v119, v38, v38
v_fmac_f32 v119, v39, v39
v_add_f32 v126, v48, v49
v_mul_f32 v127, v48, v48
v_add_f32 v126, v126, v50
v_fmac_f32 v127, v49, v49
v_add_f32 v126, v126, v51
v_fmac_f32 v127, v50, v50
v_fmac_f32 v127, v51, v51
v_add_f32 v134, v60, v61
v_mul_f32 v135, v60, v60
v_add_f32 v134, v134, v62
v_fmac_f32 v135, v61, v61
v_add_f32 v134, v134, v63
v_fmac_f32 v135, v62, v62
v_fmac_f32 v135, v63, v63
v_add_f32 v118, v118, v40
v_fmac_f32 v119, v40, v40
v_add_f32 v118, v118, v41
v_fmac_f32 v119, v41, v41
v_add_f32 v118, v118, v42
v_fmac_f32 v119, v42, v42
v_add_f32 v118, v118, v43
v_fmac_f32 v119, v43, v43
v_add_f32 v126, v126, v52
v_fmac_f32 v127, v52, v52
v_add_f32 v126, v126, v53
v_fmac_f32 v127, v53, v53
v_add_f32 v126, v126, v54
v_fmac_f32 v127, v54, v54
v_add_f32 v126, v126, v55
v_fmac_f32 v127, v55, v55
v_add_f32 v134, v134, v64
v_fmac_f32 v135, v64, v64
v_add_f32 v134, v134, v65
v_fmac_f32 v135, v65, v65
v_add_f32 v134, v134, v66
v_fmac_f32 v135, v66, v66
v_add_f32 v134, v134, v67
v_fmac_f32 v135, v67, v67
v_add_f32 v118, v118, v44
v_fmac_f32 v119, v44, v44
v_add_f32 v118, v118, v45
v_fmac_f32 v119, v45, v45
v_add_f32 v118, v118, v46
v_fmac_f32 v119, v46, v46
v_add_f32 v118, v118, v47
v_fmac_f32 v119, v47, v47
v_add_f32 v126, v126, v56
v_fmac_f32 v127, v56, v56
v_add_f32 v126, v126, v57
v_fmac_f32 v127, v57, v57
v_add_f32 v126, v126, v58
v_fmac_f32 v127, v58, v58
v_add_f32 v126, v126, v59
v_fmac_f32 v127, v59, v59
v_add_f32 v134, v134, v68
v_fmac_f32 v135, v68, v68
v_add_f32 v134, v134, v69
v_fmac_f32 v135, v69, v69
v_add_f32 v134, v134, v70
v_fmac_f32 v135, v70, v70
v_add_f32 v134, v134, v71
v_fmac_f32 v135, v71, v71
v_permlane16_swap_b32 v118, v119
v_add_f32 v118, v118, v119
v_permlane16_swap_b32 v126, v127
v_add_f32 v126, v126, v127
v_permlane16_swap_b32 v134, v135
v_add_f32 v134, v134, v135
v_permlane32_swap_b32 v118, v126
v_add_f32 v118, v118, v126
ds_write_b32 v209, v118
v_mov_b32 v135, v134
s_nop 1
v_permlane32_swap_b32 v134, v135
v_add_f32 v134, v134, v135
ds_write_b32 v209, v134 offset:512
s_waitcnt lgkmcnt(0)
s_barrier
s_mov_b32 s36, s50
v_and_b32 v180, s44, v208
s_add_u32 m0, s45, 0
s_nop 0
buffer_load_dwordx4 v180, s[4:7], s52 offen nt lds
s_add_u32 m0, s45, 4112
s_add_u32 s40, s36, 196224
buffer_load_dwordx4 v180, s[4:7], s40 offen nt lds
s_add_u32 m0, s45, 8224
s_add_u32 s40, s36, 392448
buffer_load_dwordx4 v180, s[4:7], s40 offen nt lds
s_add_u32 m0, s45, 12336
s_add_u32 s40, s36, 588672
buffer_load_dwordx4 v180, s[4:7], s40 offen nt lds
s_add_u32 m0, s45, 16448
s_add_u32 s40, s36, 784896
buffer_load_dwordx4 v180, s[4:7], s40 offen nt lds
s_add_u32 m0, s45, 20560
s_add_u32 s40, s36, 981120
buffer_load_dwordx4 v180, s[4:7], s40 offen nt lds
s_add_u32 m0, s45, 24672
s_add_u32 s40, s36, 1177344
buffer_load_dwordx4 v180, s[4:7], s40 offen nt lds
s_add_u32 m0, s45, 28784
s_add_u32 s40, s36, 1373568
buffer_load_dwordx4 v180, s[4:7], s40 offen nt lds
s_add_u32 m0, s45, 32896
s_add_u32 s40, s36, 1569792
buffer_load_dwordx4 v180, s[4:7], s40 offen nt lds
ds_read_b128 v[102:105], v210 offset:55296
ds_read_b128 v[106:109], v210 offset:56320
s_waitcnt lgkmcnt(1)
v_add_f32 v102, v102, v103
s_waitcnt lgkmcnt(0)
v_add_f32 v106, v106, v107
v_add_f32 v104, v104, v105
v_add_f32 v108, v108, v109
v_add_f32 v102, v102, v104
v_add_f32 v106, v106, v108
v_mul_f32 v103, s48, v102
v_mul_f32 v104, s73, v102
v_mul_f32 v106, s73, v106
v_fma_f32 v106, -v103, v104, v106
v_max_f32 v106, 0, v106
v_add_f32 v106, s49, v106
v_rsq_f32 v102, v106
s_nop 0
v_mul_f32_e64 v103, -v103, v102
ds_write_b64 v211, v[102:103] offset:36864
ds_read_b64 v[118:119], v219
ds_read_b64 v[126:127], v219 offset:256
ds_read_b64 v[134:135], v219 offset:512
s_waitcnt lgkmcnt(2)
v_fma_f32 v220, v36, v118, v119
v_fma_f32 v221, v37, v118, v119
v_cvt_pk_bf16_f32 v90, v220, v221
v_fma_f32 v222, v38, v118, v119
v_fma_f32 v223, v39, v118, v119
v_cvt_pk_bf16_f32 v91, v222, v223
v_fma_f32 v220, v40, v118, v119
v_fma_f32 v221, v41, v118, v119
v_cvt_pk_bf16_f32 v92, v220, v221
v_fma_f32 v222, v42, v118, v119
v_fma_f32 v223, v43, v118, v119
v_cvt_pk_bf16_f32 v93, v222, v223
ds_write_b128 v211, v[90:93] offset:18432
v_fma_f32 v220, v44, v118, v119
v_fma_f32 v221, v45, v118, v119
v_cvt_pk_bf16_f32 v94, v220, v221
v_fma_f32 v222, v46, v118, v119
v_fma_f32 v223, v47, v118, v119
v_cvt_pk_bf16_f32 v95, v222, v223
s_waitcnt lgkmcnt(2)
ds_write_b64 v212, v[94:95] offset:18432
v_fma_f32 v220, v48, v126, v127
v_fma_f32 v221, v49, v126, v127
v_cvt_pk_bf16_f32 v174, v220, v221
v_fma_f32 v222, v50, v126, v127
v_fma_f32 v223, v51, v126, v127
v_cvt_pk_bf16_f32 v175, v222, v223
v_fma_f32 v220, v52, v126, v127
v_fma_f32 v221, v53, v126, v127
v_cvt_pk_bf16_f32 v176, v220, v221
v_fma_f32 v222, v54, v126, v127
v_fma_f32 v223, v55, v126, v127
v_cvt_pk_bf16_f32 v177, v222, v223
ds_write_b128 v211, v[174:177] offset:24576
v_fma_f32 v220, v56, v126, v127
v_fma_f32 v221, v57, v126, v127
v_cvt_pk_bf16_f32 v178, v220, v221
v_fma_f32 v222, v58, v126, v127
v_fma_f32 v223, v59, v126, v127
v_cvt_pk_bf16_f32 v179, v222, v223
s_waitcnt lgkmcnt(3)
ds_write_b64 v212, v[178:179] offset:24576
v_fma_f32 v220, v60, v134, v135
v_fma_f32 v221, v61, v134, v135
v_cvt_pk_bf16_f32 v90, v220, v221
v_fma_f32 v222, v62, v134, v135
v_fma_f32 v223, v63, v134, v135
v_cvt_pk_bf16_f32 v91, v222, v223
v_fma_f32 v220, v64, v134, v135
v_fma_f32 v221, v65, v134, v135
v_cvt_pk_bf16_f32 v92, v220, v221
v_fma_f32 v222, v66, v134, v135
v_fma_f32 v223, v67, v134, v135
v_cvt_pk_bf16_f32 v93, v222, v223
ds_write_b128 v211, v[90:93] offset:30720
v_fma_f32 v220, v68, v134, v135
v_fma_f32 v221, v69, v134, v135
v_cvt_pk_bf16_f32 v94, v220, v221
v_fma_f32 v222, v70, v134, v135
v_fma_f32 v223, v71, v134, v135
v_cvt_pk_bf16_f32 v95, v222, v223
ds_write_b64 v212, v[94:95] offset:30720
ds_read_b128 v[182:185], v210
s_waitcnt lgkmcnt(0)
v_mfma_f32_16x16x32_bf16 v[138:141], a[0:3], v[182:185], 0
v_mfma_f32_16x16x32_bf16 v[142:145], a[24:27], v[182:185], 0
v_mfma_f32_16x16x32_bf16 v[146:149], a[48:51], v[182:185], 0
v_mfma_f32_16x16x32_bf16 v[150:153], a[216:219], v[182:185], 0
v_mfma_f32_16x16x32_bf16 v[154:157], a[240:243], v[182:185], 0
v_mfma_f32_16x16x32_bf16 v[158:161], v[232:235], v[182:185], 0
v_mfma_f32_16x16x32_bf16 v[162:165], v[182:185], a[72:75], 0
v_mfma_f32_16x16x32_bf16 v[166:169], v[182:185], a[96:99], 0
v_mfma_f32_16x16x32_bf16 v[170:173], v[182:185], a[120:123], 0
ds_read_b128 v[186:189], v210 offset:1024
s_waitcnt lgkmcnt(0)
v_mfma_f32_16x16x32_bf16 v[138:141], a[4:7], v[186:189], v[138:141]
v_mfma_f32_16x16x32_bf16 v[142:145], a[28:31], v[186:189], v[142:145]
v_mfma_f32_16x16x32_bf16 v[146:149], a[52:55], v[186:189], v[146:149]
v_mfma_f32_16x16x32_bf16 v[150:153], a[220:223], v[186:189], v[150:153]
v_mfma_f32_16x16x32_bf16 v[154:157], a[244:247], v[186:189], v[154:157]
v_mfma_f32_16x16x32_bf16 v[158:161], v[236:239], v[186:189], v[158:161]
v_mfma_f32_16x16x32_bf16 v[162:165], v[186:189], a[76:79], v[162:165]
v_mfma_f32_16x16x32_bf16 v[166:169], v[186:189], a[100:103], v[166:169]
v_mfma_f32_16x16x32_bf16 v[170:173], v[186:189], a[124:127], v[170:173]
ds_read_b128 v[182:185], v210 offset:2048
s_waitcnt lgkmcnt(0)
v_mfma_f32_16x16x32_bf16 v[138:141], a[8:11], v[182:185], v[138:141]
v_mfma_f32_16x16x32_bf16 v[142:145], a[32:35], v[182:185], v[142:145]
v_mfma_f32_16x16x32_bf16 v[146:149], a[56:59], v[182:185], v[146:149]
v_mfma_f32_16x16x32_bf16 v[150:153], a[224:227], v[182:185], v[150:153]
v_mfma_f32_16x16x32_bf16 v[154:157], a[248:251], v[182:185], v[154:157]
v_mfma_f32_16x16x32_bf16 v[158:161], v[240:243], v[182:185], v[158:161]
v_mfma_f32_16x16x32_bf16 v[162:165], v[182:185], a[80:83], v[162:165]
v_mfma_f32_16x16x32_bf16 v[166:169], v[182:185], a[104:107], v[166:169]
v_mfma_f32_16x16x32_bf16 v[170:173], v[182:185], a[128:131], v[170:173]
ds_read_b128 v[186:189], v210 offset:3072
s_waitcnt lgkmcnt(0)
v_mfma_f32_16x16x32_bf16 v[138:141], a[12:15], v[186:189], v[138:141]
v_mfma_f32_16x16x32_bf16 v[142:145], a[36:39], v[186:189], v[142:145]
v_mfma_f32_16x16x32_bf16 v[146:149], a[60:63], v[186:189], v[146:149]
v_mfma_f32_16x16x32_bf16 v[150:153], a[228:231], v[186:189], v[150:153]
v_mfma_f32_16x16x32_bf16 v[154:157], a[252:255], v[186:189], v[154:157]
v_mfma_f32_16x16x32_bf16 v[158:161], v[244:247], v[186:189], v[158:161]
v_mfma_f32_16x16x32_bf16 v[162:165], v[186:189], a[84:87], v[162:165]
v_mfma_f32_16x16x32_bf16 v[166:169], v[186:189], a[108:111], v[166:169]
v_mfma_f32_16x16x32_bf16 v[170:173], v[186:189], a[132:135], v[170:173]
ds_read_b128 v[182:185], v210 offset:4096
s_waitcnt lgkmcnt(0)
v_mfma_f32_16x16x32_bf16 v[138:141], a[16:19], v[182:185], v[138:141]
v_mfma_f32_16x16x32_bf16 v[142:145], a[40:43], v[182:185], v[142:145]
v_mfma_f32_16x16x32_bf16 v[146:149], a[64:67], v[182:185], v[146:149]
v_mfma_f32_16x16x32_bf16 v[150:153], a[232:235], v[182:185], v[150:153]
v_mfma_f32_16x16x32_bf16 v[154:157], v[224:227], v[182:185], v[154:157]
v_mfma_f32_16x16x32_bf16 v[158:161], v[248:251], v[182:185], v[158:161]
v_mfma_f32_16x16x32_bf16 v[162:165], v[182:185], a[88:91], v[162:165]
v_mfma_f32_16x16x32_bf16 v[166:169], v[182:185], a[112:115], v[166:169]
v_mfma_f32_16x16x32_bf16 v[170:173], v[182:185], a[136:139], v[170:173]
ds_read_b128 v[186:189], v210 offset:5120
s_waitcnt lgkmcnt(0)
v_mfma_f32_16x16x32_bf16 v[138:141], a[20:23], v[186:189], v[138:141]
v_mfma_f32_16x16x32_bf16 v[142:145], a[44:47], v[186:189], v[142:145]
v_mfma_f32_16x16x32_bf16 v[146:149], a[68:71], v[186:189], v[146:149]
v_mfma_f32_16x16x32_bf16 v[150:153], a[236:239], v[186:189], v[150:153]
v_mfma_f32_16x16x32_bf16 v[154:157], v[228:231], v[186:189], v[154:157]
v_mfma_f32_16x16x32_bf16 v[158:161], v[252:255], v[186:189], v[158:161]
v_mfma_f32_16x16x32_bf16 v[162:165], v[186:189], a[92:95], v[162:165]
v_mfma_f32_16x16x32_bf16 v[166:169], v[186:189], a[116:119], v[166:169]
v_mfma_f32_16x16x32_bf16 v[170:173], v[186:189], a[140:143], v[170:173]
v_cvt_pk_bf16_f32 v78, v138, v139
v_cvt_pk_bf16_f32 v79, v140, v141
v_cvt_pk_bf16_f32 v80, v142, v143
v_cvt_pk_bf16_f32 v81, v144, v145
v_cvt_pk_bf16_f32 v82, v146, v147
v_cvt_pk_bf16_f32 v83, v148, v149
v_cvt_pk_bf16_f32 v72, v150, v151
v_cvt_pk_bf16_f32 v73, v152, v153
v_cvt_pk_bf16_f32 v74, v154, v155
v_cvt_pk_bf16_f32 v75, v156, v157
v_cvt_pk_bf16_f32 v76, v158, v159
v_cvt_pk_bf16_f32 v77, v160, v161
v_cvt_pk_bf16_f32 v114, v162, v163
v_cvt_pk_bf16_f32 v115, v164, v165
v_cvt_pk_bf16_f32 v122, v166, v167
v_cvt_pk_bf16_f32 v123, v168, v169
v_cvt_pk_bf16_f32 v130, v170, v171
v_cvt_pk_bf16_f32 v131, v172, v173
ds_read_b128 v[182:185], v210 offset:6144
s_waitcnt lgkmcnt(0)
v_mfma_f32_16x16x32_bf16 v[138:141], a[0:3], v[182:185], 0
v_mfma_f32_16x16x32_bf16 v[142:145], a[24:27], v[182:185], 0
v_mfma_f32_16x16x32_bf16 v[146:149], a[48:51], v[182:185], 0
v_mfma_f32_16x16x32_bf16 v[150:153], a[216:219], v[182:185], 0
v_mfma_f32_16x16x32_bf16 v[154:157], a[240:243], v[182:185], 0
v_mfma_f32_16x16x32_bf16 v[158:161], v[232:235], v[182:185], 0
v_mfma_f32_16x16x32_bf16 v[162:165], v[182:185], a[72:75], 0
v_mfma_f32_16x16x32_bf16 v[166:169], v[182:185], a[96:99], 0
v_mfma_f32_16x16x32_bf16 v[170:173], v[182:185], a[120:123], 0
ds_read_b128 v[186:189], v210 offset:7168
s_waitcnt lgkmcnt(0)
v_mfma_f32_16x16x32_bf16 v[138:141], a[4:7], v[186:189], v[138:141]
v_mfma_f32_16x16x32_bf16 v[142:145], a[28:31], v[186:189], v[142:145]
v_mfma_f32_16x16x32_bf16 v[146:149], a[52:55], v[186:189], v[146:149]
v_mfma_f32_16x16x32_bf16 v[150:153], a[220:223], v[186:189], v[150:153]
v_mfma_f32_16x16x32_bf16 v[154:157], a[244:247], v[186:189], v[154:157]
v_mfma_f32_16x16x32_bf16 v[158:161], v[236:239], v[186:189], v[158:161]
v_mfma_f32_16x16x32_bf16 v[162:165], v[186:189], a[76:79], v[162:165]
v_mfma_f32_16x16x32_bf16 v[166:169], v[186:189], a[100:103], v[166:169]
v_mfma_f32_16x16x32_bf16 v[170:173], v[186:189], a[124:127], v[170:173]
ds_read_b128 v[182:185], v210 offset:8192
s_waitcnt lgkmcnt(0)
v_mfma_f32_16x16x32_bf16 v[138:141], a[8:11], v[182:185], v[138:141]
v_mfma_f32_16x16x32_bf16 v[142:145], a[32:35], v[182:185], v[142:145]
v_mfma_f32_16x16x32_bf16 v[146:149], a[56:59], v[182:185], v[146:149]
v_mfma_f32_16x16x32_bf16 v[150:153], a[224:227], v[182:185], v[150:153]
v_mfma_f32_16x16x32_bf16 v[154:157], a[248:251], v[182:185], v[154:157]
v_mfma_f32_16x16x32_bf16 v[158:161], v[240:243], v[182:185], v[158:161]
v_mfma_f32_16x16x32_bf16 v[162:165], v[182:185], a[80:83], v[162:165]
v_mfma_f32_16x16x32_bf16 v[166:169], v[182:185], a[104:107], v[166:169]
v_mfma_f32_16x16x32_bf16 v[170:173], v[182:185], a[128:131], v[170:173]
ds_read_b128 v[186:189], v210 offset:9216
s_waitcnt lgkmcnt(0)
v_mfma_f32_16x16x32_bf16 v[138:141], a[12:15], v[186:189], v[138:141]
v_mfma_f32_16x16x32_bf16 v[142:145], a[36:39], v[186:189], v[142:145]
v_mfma_f32_16x16x32_bf16 v[146:149], a[60:63], v[186:189], v[146:149]
v_mfma_f32_16x16x32_bf16 v[150:153], a[228:231], v[186:189], v[150:153]
v_mfma_f32_16x16x32_bf16 v[154:157], a[252:255], v[186:189], v[154:157]
v_mfma_f32_16x16x32_bf16 v[158:161], v[244:247], v[186:189], v[158:161]
v_mfma_f32_16x16x32_bf16 v[162:165], v[186:189], a[84:87], v[162:165]
v_mfma_f32_16x16x32_bf16 v[166:169], v[186:189], a[108:111], v[166:169]
v_mfma_f32_16x16x32_bf16 v[170:173], v[186:189], a[132:135], v[170:173]
ds_read_b128 v[182:185], v210 offset:10240
s_waitcnt lgkmcnt(0)
v_mfma_f32_16x16x32_bf16 v[138:141], a[16:19], v[182:185], v[138:141]
v_mfma_f32_16x16x32_bf16 v[142:145], a[40:43], v[182:185], v[142:145]
v_mfma_f32_16x16x32_bf16 v[146:149], a[64:67], v[182:185], v[146:149]
v_mfma_f32_16x16x32_bf16 v[150:153], a[232:235], v[182:185], v[150:153]
v_mfma_f32_16x16x32_bf16 v[154:157], v[224:227], v[182:185], v[154:157]
v_mfma_f32_16x16x32_bf16 v[158:161], v[248:251], v[182:185], v[158:161]
v_mfma_f32_16x16x32_bf16 v[162:165], v[182:185], a[88:91], v[162:165]
v_mfma_f32_16x16x32_bf16 v[166:169], v[182:185], a[112:115], v[166:169]
v_mfma_f32_16x16x32_bf16 v[170:173], v[182:185], a[136:139], v[170:173]
ds_read_b128 v[186:189], v210 offset:11264
s_waitcnt lgkmcnt(0)
v_mfma_f32_16x16x32_bf16 v[138:141], a[20:23], v[186:189], v[138:141]
v_mfma_f32_16x16x32_bf16 v[142:145], a[44:47], v[186:189], v[142:145]
v_mfma_f32_16x16x32_bf16 v[146:149], a[68:71], v[186:189], v[146:149]
v_mfma_f32_16x16x32_bf16 v[150:153], a[236:239], v[186:189], v[150:153]
v_mfma_f32_16x16x32_bf16 v[154:157], v[228:231], v[186:189], v[154:157]
v_mfma_f32_16x16x32_bf16 v[158:161], v[252:255], v[186:189], v[158:161]
v_mfma_f32_16x16x32_bf16 v[162:165], v[186:189], a[92:95], v[162:165]
v_mfma_f32_16x16x32_bf16 v[166:169], v[186:189], a[116:119], v[166:169]
v_mfma_f32_16x16x32_bf16 v[170:173], v[186:189], a[140:143], v[170:173]
v_cvt_pk_bf16_f32 v96, v138, v139
v_cvt_pk_bf16_f32 v97, v140, v141
v_cvt_pk_bf16_f32 v98, v142, v143
v_cvt_pk_bf16_f32 v99, v144, v145
v_cvt_pk_bf16_f32 v100, v146, v147
v_cvt_pk_bf16_f32 v101, v148, v149
v_cvt_pk_bf16_f32 v84, v150, v151
v_cvt_pk_bf16_f32 v85, v152, v153
v_cvt_pk_bf16_f32 v86, v154, v155
v_cvt_pk_bf16_f32 v87, v156, v157
v_cvt_pk_bf16_f32 v88, v158, v159
v_cvt_pk_bf16_f32 v89, v160, v161
v_cvt_pk_bf16_f32 v116, v162, v163
v_cvt_pk_bf16_f32 v117, v164, v165
v_cvt_pk_bf16_f32 v124, v166, v167
v_cvt_pk_bf16_f32 v125, v168, v169
v_cvt_pk_bf16_f32 v132, v170, v171
v_cvt_pk_bf16_f32 v133, v172, v173
ds_read_b128 v[182:185], v210 offset:12288
s_waitcnt lgkmcnt(0)
v_mfma_f32_16x16x32_bf16 v[138:141], a[0:3], v[182:185], 0
v_mfma_f32_16x16x32_bf16 v[142:145], a[24:27], v[182:185], 0
v_mfma_f32_16x16x32_bf16 v[146:149], a[48:51], v[182:185], 0
ds_read_b128 v[186:189], v210 offset:13312
s_waitcnt lgkmcnt(0)
v_mfma_f32_16x16x32_bf16 v[138:141], a[4:7], v[186:189], v[138:141]
v_mfma_f32_16x16x32_bf16 v[142:145], a[28:31], v[186:189], v[142:145]
v_mfma_f32_16x16x32_bf16 v[146:149], a[52:55], v[186:189], v[146:149]
ds_read_b128 v[182:185], v210 offset:14336
s_waitcnt lgkmcnt(0)
v_mfma_f32_16x16x32_bf16 v[138:141], a[8:11], v[182:185], v[138:141]
v_mfma_f32_16x16x32_bf16 v[142:145], a[32:35], v[182:185], v[142:145]
v_mfma_f32_16x16x32_bf16 v[146:149], a[56:59], v[182:185], v[146:149]
ds_read_b128 v[186:189], v210 offset:15360
s_waitcnt lgkmcnt(0)
v_mfma_f32_16x16x32_bf16 v[138:141], a[12:15], v[186:189], v[138:141]
v_mfma_f32_16x16x32_bf16 v[142:145], a[36:39], v[186:189], v[142:145]
v_mfma_f32_16x16x32_bf16 v[146:149], a[60:63], v[186:189], v[146:149]
ds_read_b128 v[182:185], v210 offset:16384
s_waitcnt lgkmcnt(0)
v_mfma_f32_16x16x32_bf16 v[138:141], a[16:19], v[182:185], v[138:141]
v_mfma_f32_16x16x32_bf16 v[142:145], a[40:43], v[182:185], v[142:145]
v_mfma_f32_16x16x32_bf16 v[146:149], a[64:67], v[182:185], v[146:149]
ds_read_b128 v[186:189], v210 offset:17408
s_waitcnt lgkmcnt(0)
v_mfma_f32_16x16x32_bf16 v[138:141], a[20:23], v[186:189], v[138:141]
v_mfma_f32_16x16x32_bf16 v[142:145], a[44:47], v[186:189], v[142:145]
v_mfma_f32_16x16x32_bf16 v[146:149], a[68:71], v[186:189], v[146:149]
v_cvt_pk_bf16_f32 v102, v138, v139
v_cvt_pk_bf16_f32 v103, v140, v141
s_nop 0
v_cvt_pk_bf16_f32 v104, v142, v143
v_cvt_pk_bf16_f32 v105, v144, v145
s_nop 1
v_cvt_pk_bf16_f32 v106, v146, v147
v_cvt_pk_bf16_f32 v107, v148, v149
ds_read_b128 v[108:111], v215 offset:512
ds_read_b64 v[112:113], v215 offset:528
v_mov_b32 v181, 0
v_mfma_f32_16x16x16_bf16 v[138:141], v[82:83], v[76:77], 0
v_mfma_f32_16x16x16_bf16 v[142:145], v[100:101], v[76:77], 0
s_waitcnt lgkmcnt(0)
v_mfma_f32_16x16x16_bf16 v[150:153], v[112:113], v[76:77], v[206:209]
v_mfma_f32_16x16x16_bf16 v[146:149], v[106:107], v[76:77], 0
v_mfma_f32_16x16x32_bf16 v[138:141], v[78:81], v[72:75], v[138:141]
v_mfma_f32_16x16x32_bf16 v[142:145], v[96:99], v[72:75], v[142:145]
v_mfma_f32_16x16x32_bf16 v[150:153], v[108:111], v[72:75], v[150:153]
v_mfma_f32_16x16x32_bf16 v[146:149], v[102:105], v[72:75], v[146:149]
ds_read_b128 v[72:75], v215
ds_read_b64 v[76:77], v215 offset:16
v_mfma_f32_16x16x16_bf16 v[154:157], v[82:83], v[88:89], 0
v_mfma_f32_16x16x16_bf16 v[158:161], v[100:101], v[88:89], 0
v_mfma_f32_16x16x16_bf16 v[166:169], v[112:113], v[88:89], v[206:209]
v_mfma_f32_16x16x16_bf16 v[162:165], v[106:107], v[88:89], 0
v_mfma_f32_16x16x32_bf16 v[154:157], v[78:81], v[84:87], v[154:157]
v_mfma_f32_16x16x32_bf16 v[158:161], v[96:99], v[84:87], v[158:161]
v_mfma_f32_16x16x32_bf16 v[166:169], v[108:111], v[84:87], v[166:169]
v_mfma_f32_16x16x32_bf16 v[162:165], v[102:105], v[84:87], v[162:165]
ds_read_b128 v[182:185], v210 offset:12288
s_waitcnt lgkmcnt(0)
v_mfma_f32_16x16x32_bf16 v[118:121], v[182:185], a[72:75], 0
v_mfma_f32_16x16x32_bf16 v[126:129], v[182:185], a[96:99], 0
v_mfma_f32_16x16x32_bf16 v[134:137], v[182:185], a[120:123], 0
v_mfma_f32_16x16x32_bf16 v[90:93], a[216:219], v[182:185], 0
v_mfma_f32_16x16x32_bf16 v[170:173], a[240:243], v[182:185], 0
v_mfma_f32_16x16x32_bf16 v[220:223], v[232:235], v[182:185], 0
ds_read_b128 v[186:189], v210 offset:13312
s_waitcnt lgkmcnt(0)
v_mfma_f32_16x16x32_bf16 v[118:121], v[186:189], a[76:79], v[118:121]
v_mfma_f32_16x16x32_bf16 v[126:129], v[186:189], a[100:103], v[126:129]
v_mfma_f32_16x16x32_bf16 v[134:137], v[186:189], a[124:127], v[134:137]
v_mfma_f32_16x16x32_bf16 v[90:93], a[220:223], v[186:189], v[90:93]
v_mfma_f32_16x16x32_bf16 v[170:173], a[244:247], v[186:189], v[170:173]
v_mfma_f32_16x16x32_bf16 v[220:223], v[236:239], v[186:189], v[220:223]
ds_read_b128 v[182:185], v210 offset:14336
s_waitcnt lgkmcnt(0)
v_mfma_f32_16x16x32_bf16 v[118:121], v[182:185], a[80:83], v[118:121]
v_mfma_f32_16x16x32_bf16 v[126:129], v[182:185], a[104:107], v[126:129]
v_mfma_f32_16x16x32_bf16 v[134:137], v[182:185], a[128:131], v[134:137]
v_mfma_f32_16x16x32_bf16 v[90:93], a[224:227], v[182:185], v[90:93]
v_mfma_f32_16x16x32_bf16 v[170:173], a[248:251], v[182:185], v[170:173]
v_mfma_f32_16x16x32_bf16 v[220:223], v[240:243], v[182:185], v[220:223]
ds_read_b128 v[186:189], v210 offset:15360
s_waitcnt lgkmcnt(0)
v_mfma_f32_16x16x32_bf16 v[118:121], v[186:189], a[84:87], v[118:121]
v_mfma_f32_16x16x32_bf16 v[126:129], v[186:189], a[108:111], v[126:129]
v_mfma_f32_16x16x32_bf16 v[134:137], v[186:189], a[132:135], v[134:137]
v_mfma_f32_16x16x32_bf16 v[90:93], a[228:231], v[186:189], v[90:93]
v_mfma_f32_16x16x32_bf16 v[170:173], a[252:255], v[186:189], v[170:173]
v_mfma_f32_16x16x32_bf16 v[220:223], v[244:247], v[186:189], v[220:223]
ds_read_b128 v[182:185], v210 offset:16384
s_waitcnt lgkmcnt(0)
v_mfma_f32_16x16x32_bf16 v[118:121], v[182:185], a[88:91], v[118:121]
v_mfma_f32_16x16x32_bf16 v[126:129], v[182:185], a[112:115], v[126:129]
v_mfma_f32_16x16x32_bf16 v[134:137], v[182:185], a[136:139], v[134:137]
v_mfma_f32_16x16x32_bf16 v[90:93], a[232:235], v[182:185], v[90:93]
v_mfma_f32_16x16x32_bf16 v[170:173], v[224:227], v[182:185], v[170:173]
v_mfma_f32_16x16x32_bf16 v[220:223], v[248:251], v[182:185], v[220:223]
ds_read_b128 v[186:189], v210 offset:17408
s_waitcnt lgkmcnt(0)
v_mfma_f32_16x16x32_bf16 v[118:121], v[186:189], a[92:95], v[118:121]
v_mfma_f32_16x16x32_bf16 v[126:129], v[186:189], a[116:119], v[126:129]
v_mfma_f32_16x16x32_bf16 v[134:137], v[186:189], a[140:143], v[134:137]
v_mfma_f32_16x16x32_bf16 v[90:93], a[236:239], v[186:189], v[90:93]
v_mfma_f32_16x16x32_bf16 v[170:173], v[228:231], v[186:189], v[170:173]
v_mfma_f32_16x16x32_bf16 v[220:223], v[252:255], v[186:189], v[220:223]
v_cvt_pk_bf16_f32 v118, v118, v119
v_cvt_pk_bf16_f32 v119, v120, v121
ds_read_u16 v120, v214 offset:1024
v_mov_b32 v121, 0
v_cvt_pk_bf16_f32 v126, v126, v127
v_cvt_pk_bf16_f32 v127, v128, v129
ds_read_u16 v128, v214 offset:1032
v_mov_b32 v129, 0
v_cvt_pk_bf16_f32 v134, v134, v135
v_cvt_pk_bf16_f32 v135, v136, v137
ds_read_u16 v136, v214 offset:1040
v_mov_b32 v137, 0
v_cvt_pk_bf16_f32 v90, v90, v91
v_cvt_pk_bf16_f32 v91, v92, v93
v_cvt_pk_bf16_f32 v92, v170, v171
v_cvt_pk_bf16_f32 v93, v172, v173
v_cvt_pk_bf16_f32 v94, v220, v221
v_cvt_pk_bf16_f32 v95, v222, v223
v_max3_f32 v151, v138, v139, v140
v_max3_f32 v151, v151, v141, v142
v_max3_f32 v151, v151, v143, v144
v_max3_f32 v151, v151, v145, v146
v_max3_f32 v151, v151, v147, v148
v_max3_f32 v151, v151, v149, v150
v_mov_b32 v152, v151
s_nop 1
v_permlane16_swap_b32 v151, v152
v_max_f32 v151, v151, v152
v_mov_b32 v152, v151
s_nop 1
v_permlane32_swap_b32 v151, v152
v_max_f32 v151, v151, v152
v_sub_f32 v138, v138, v151
v_sub_f32 v139, v139, v151
v_sub_f32 v140, v140, v151
v_sub_f32 v141, v141, v151
v_sub_f32 v142, v142, v151
v_sub_f32 v143, v143, v151
v_sub_f32 v144, v144, v151
v_sub_f32 v145, v145, v151
v_sub_f32 v150, v150, v151
v_sub_f32 v146, v146, v151
v_sub_f32 v147, v147, v151
v_sub_f32 v148, v148, v151
v_sub_f32 v149, v149, v151
v_exp_f32 v138, v138
v_exp_f32 v139, v139
v_exp_f32 v140, v140
v_exp_f32 v141, v141
v_exp_f32 v142, v142
v_exp_f32 v143, v143
v_exp_f32 v144, v144
v_exp_f32 v145, v145
v_exp_f32 v150, v150
v_exp_f32 v146, v146
v_exp_f32 v147, v147
v_exp_f32 v148, v148
v_exp_f32 v149, v149
v_cvt_pk_bf16_f32 v174, v138, v139
v_cvt_pk_bf16_f32 v175, v140, v141
v_cvt_pk_bf16_f32 v176, v142, v143
v_cvt_pk_bf16_f32 v177, v144, v145
v_cvt_pk_bf16_f32 v178, v146, v147
v_cvt_pk_bf16_f32 v179, v148, v149
v_cvt_pk_bf16_f32 v180, v150, 0
v_mfma_f32_16x16x32_bf16 v[150:153], v[190:193], v[174:177], 0
v_mfma_f32_16x16x32_bf16 v[138:141], v[114:117], v[174:177], 0
v_mfma_f32_16x16x32_bf16 v[142:145], v[122:125], v[174:177], 0
v_mfma_f32_16x16x32_bf16 v[146:149], v[130:133], v[174:177], 0
v_mfma_f32_16x16x32_bf16 v[150:153], v[190:193], v[178:181], v[150:153]
s_waitcnt lgkmcnt(2)
v_mfma_f32_16x16x32_bf16 v[138:141], v[118:121], v[178:181], v[138:141]
s_waitcnt lgkmcnt(1)
v_mfma_f32_16x16x32_bf16 v[142:145], v[126:129], v[178:181], v[142:145]
s_waitcnt lgkmcnt(0)
v_mfma_f32_16x16x32_bf16 v[146:149], v[134:137], v[178:181], v[146:149]
v_max3_f32 v167, v154, v155, v156
v_max3_f32 v167, v167, v157, v158
v_max3_f32 v167, v167, v159, v160
v_max3_f32 v167, v167, v161, v162
v_max3_f32 v167, v167, v163, v164
v_max3_f32 v167, v167, v165, v166
v_mov_b32 v168, v167
s_nop 1
v_permlane16_swap_b32 v167, v168
v_max_f32 v167, v167, v168
v_mov_b32 v168, v167
s_nop 1
v_permlane32_swap_b32 v167, v168
v_max_f32 v167, v167, v168
v_sub_f32 v154, v154, v167
v_sub_f32 v155, v155, v167
v_sub_f32 v156, v156, v167
v_sub_f32 v157, v157, v167
v_sub_f32 v158, v158, v167
v_sub_f32 v159, v159, v167
v_sub_f32 v160, v160, v167
v_sub_f32 v161, v161, v167
v_sub_f32 v166, v166, v167
v_sub_f32 v162, v162, v167
v_sub_f32 v163, v163, v167
v_sub_f32 v164, v164, v167
v_sub_f32 v165, v165, v167
v_exp_f32 v154, v154
v_exp_f32 v155, v155
v_exp_f32 v156, v156
v_exp_f32 v157, v157
v_exp_f32 v158, v158
v_exp_f32 v159, v159
v_exp_f32 v160, v160
v_exp_f32 v161, v161
v_exp_f32 v166, v166
v_exp_f32 v162, v162
v_exp_f32 v163, v163
v_exp_f32 v164, v164
v_exp_f32 v165, v165
v_cvt_pk_bf16_f32 v174, v154, v155
v_cvt_pk_bf16_f32 v175, v156, v157
v_cvt_pk_bf16_f32 v176, v158, v159
v_cvt_pk_bf16_f32 v177, v160, v161
v_cvt_pk_bf16_f32 v178, v162, v163
v_cvt_pk_bf16_f32 v179, v164, v165
v_cvt_pk_bf16_f32 v180, v166, 0
v_mfma_f32_16x16x32_bf16 v[166:169], v[190:193], v[174:177], 0
v_mfma_f32_16x16x32_bf16 v[154:157], v[114:117], v[174:177], 0
v_mfma_f32_16x16x32_bf16 v[158:161], v[122:125], v[174:177], 0
v_mfma_f32_16x16x32_bf16 v[162:165], v[130:133], v[174:177], 0
v_mfma_f32_16x16x32_bf16 v[166:169], v[190:193], v[178:181], v[166:169]
v_mfma_f32_16x16x32_bf16 v[154:157], v[118:121], v[178:181], v[154:157]
v_mfma_f32_16x16x32_bf16 v[158:161], v[126:129], v[178:181], v[158:161]
v_mfma_f32_16x16x32_bf16 v[162:165], v[134:137], v[178:181], v[162:165]
v_rcp_f32 v151, v150
s_nop 0
v_mul_f32 v151, s3, v151
v_mul_f32 v138, v138, v151
v_mul_f32 v139, v139, v151
v_cvt_pk_bf16_f32 v138, v138, v139
v_mul_f32 v140, v140, v151
v_mul_f32 v141, v141, v151
v_cvt_pk_bf16_f32 v139, v140, v141
v_mul_f32 v142, v142, v151
v_mul_f32 v143, v143, v151
v_cvt_pk_bf16_f32 v140, v142, v143
v_mul_f32 v144, v144, v151
v_mul_f32 v145, v145, v151
v_cvt_pk_bf16_f32 v141, v144, v145
ds_write_b128 v211, v[138:141] offset:36864
v_mul_f32 v146, v146, v151
v_mul_f32 v147, v147, v151
v_cvt_pk_bf16_f32 v142, v146, v147
v_mul_f32 v148, v148, v151
v_mul_f32 v149, v149, v151
v_cvt_pk_bf16_f32 v143, v148, v149
ds_write_b64 v212, v[142:143] offset:36864
v_mfma_f32_16x16x32_bf16 v[138:141], v[78:81], v[90:93], 0
v_mfma_f32_16x16x32_bf16 v[142:145], v[96:99], v[90:93], 0
v_mfma_f32_16x16x32_bf16 v[150:153], v[108:111], v[90:93], v[206:209]
v_mfma_f32_16x16x32_bf16 v[146:149], v[102:105], v[90:93], 0
v_mfma_f32_16x16x16_bf16 v[138:141], v[82:83], v[94:95], v[138:141]
v_mfma_f32_16x16x16_bf16 v[142:145], v[100:101], v[94:95], v[142:145]
v_mfma_f32_16x16x16_bf16 v[150:153], v[112:113], v[94:95], v[150:153]
v_mfma_f32_16x16x16_bf16 v[146:149], v[106:107], v[94:95], v[146:149]
v_rcp_f32 v167, v166
s_nop 0
v_mul_f32 v167, s3, v167
v_mul_f32 v154, v154, v167
v_mul_f32 v155, v155, v167
v_cvt_pk_bf16_f32 v154, v154, v155
v_mul_f32 v156, v156, v167
v_mul_f32 v157, v157, v167
v_cvt_pk_bf16_f32 v155, v156, v157
v_mul_f32 v158, v158, v167
v_mul_f32 v159, v159, v167
v_cvt_pk_bf16_f32 v156, v158, v159
v_mul_f32 v160, v160, v167
v_mul_f32 v161, v161, v167
v_cvt_pk_bf16_f32 v157, v160, v161
ds_write_b128 v211, v[154:157] offset:43008
v_mul_f32 v162, v162, v167
v_mul_f32 v163, v163, v167
v_cvt_pk_bf16_f32 v158, v162, v163
v_mul_f32 v164, v164, v167
v_mul_f32 v165, v165, v167
v_cvt_pk_bf16_f32 v159, v164, v165
ds_write_b64 v212, v[158:159] offset:43008
v_mfma_f32_16x16x16_bf16 v[154:157], v[76:77], v[82:83], 0
v_mfma_f32_16x16x16_bf16 v[158:161], v[76:77], v[100:101], 0
v_mfma_f32_16x16x16_bf16 v[162:165], v[76:77], v[106:107], 0
v_mfma_f32_16x16x16_bf16 v[166:169], v[76:77], v[112:113], v[206:209]
v_mfma_f32_16x16x32_bf16 v[154:157], v[72:75], v[78:81], v[154:157]
v_mfma_f32_16x16x32_bf16 v[158:161], v[72:75], v[96:99], v[158:161]
v_mfma_f32_16x16x32_bf16 v[162:165], v[72:75], v[102:105], v[162:165]
v_mfma_f32_16x16x32_bf16 v[166:169], v[72:75], v[108:111], v[166:169]
v_mov_b32_dpp v154, v158 quad_perm:[0,1,2,3] row_mask:0x2 bank_mask:0xf
s_nop 1
v_mov_b32_dpp v154, v162 quad_perm:[0,1,2,3] row_mask:0x4 bank_mask:0xf
s_nop 2
v_mov_b32_dpp v154, v167 quad_perm:[0,1,2,3] row_mask:0x8 bank_mask:0xf
v_mov_b32 v155, v154
s_nop 1
v_max_f32_dpp v155, v155, v155 row_ror:8 row_mask:0xf bank_mask:0xf
s_nop 1
v_max_f32_dpp v155, v155, v155 row_ror:4 row_mask:0xf bank_mask:0xf
s_nop 1
v_max_f32_dpp v155, v155, v155 row_ror:2 row_mask:0xf bank_mask:0xf
s_nop 1
v_max_f32_dpp v155, v155, v155 row_ror:1 row_mask:0xf bank_mask:0xf
v_mov_b32 v156, v155
s_nop 1
v_permlane16_swap_b32 v155, v156
v_max_f32 v155, v155, v156
v_mov_b32 v156, v155
s_nop 1
v_permlane32_swap_b32 v155, v156
v_max_f32 v155, v155, v156
v_sub_f32 v154, v154, v155
v_exp_f32 v154, v154
s_nop 0
v_cvt_pk_bf16_f32 v154, v154, 0
ds_write_b16 v214, v154
s_waitcnt lgkmcnt(1)
ds_read_b128 v[84:87], v215
ds_read_b128 v[88:91], v215 offset:16
v_add_u32 v215, 1552, v215
s_barrier
ds_read_b128 v[170:173], v210 offset:36864
s_waitcnt lgkmcnt(0)
v_mfma_f32_16x16x32_bf16 v[0:3], a[144:147], v[170:173], v[0:3]
v_mfma_f32_16x16x32_bf16 v[4:7], a[168:171], v[170:173], v[4:7]
v_mfma_f32_16x16x32_bf16 v[8:11], a[192:195], v[170:173], v[8:11]
ds_read_b128 v[182:185], v210 offset:37888
s_waitcnt lgkmcnt(0)
v_mfma_f32_16x16x32_bf16 v[0:3], a[148:151], v[182:185], v[0:3]
v_mfma_f32_16x16x32_bf16 v[4:7], a[172:175], v[182:185], v[4:7]
v_mfma_f32_16x16x32_bf16 v[8:11], a[196:199], v[182:185], v[8:11]
ds_read_b128 v[186:189], v210 offset:38912
s_waitcnt lgkmcnt(0)
v_mfma_f32_16x16x32_bf16 v[0:3], a[152:155], v[186:189], v[0:3]
v_mfma_f32_16x16x32_bf16 v[4:7], a[176:179], v[186:189], v[4:7]
v_mfma_f32_16x16x32_bf16 v[8:11], a[200:203], v[186:189], v[8:11]
ds_read_b128 v[170:173], v210 offset:39936
s_waitcnt lgkmcnt(0)
v_mfma_f32_16x16x32_bf16 v[0:3], a[156:159], v[170:173], v[0:3]
v_mfma_f32_16x16x32_bf16 v[4:7], a[180:183], v[170:173], v[4:7]
v_mfma_f32_16x16x32_bf16 v[8:11], a[204:207], v[170:173], v[8:11]
ds_read_b128 v[182:185], v210 offset:40960
s_waitcnt lgkmcnt(0)
v_mfma_f32_16x16x32_bf16 v[0:3], a[160:163], v[182:185], v[0:3]
v_mfma_f32_16x16x32_bf16 v[4:7], a[184:187], v[182:185], v[4:7]
v_mfma_f32_16x16x32_bf16 v[8:11], a[208:211], v[182:185], v[8:11]
ds_read_b128 v[186:189], v210 offset:41984
s_waitcnt lgkmcnt(0)
v_mfma_f32_16x16x32_bf16 v[0:3], a[164:167], v[186:189], v[0:3]
v_mfma_f32_16x16x32_bf16 v[4:7], a[188:191], v[186:189], v[4:7]
v_mfma_f32_16x16x32_bf16 v[8:11], a[212:215], v[186:189], v[8:11]
v_cvt_pk_bf16_f32 v72, v0, v1
v_cvt_pk_bf16_f32 v73, v2, v3
buffer_store_dwordx2 v[72:73], v203, s[8:11], s38 offen
v_cvt_pk_bf16_f32 v74, v4, v5
v_cvt_pk_bf16_f32 v75, v6, v7
buffer_store_dwordx2 v[74:75], v203, s[8:11], s38 offen offset:32
s_nop 0
v_cvt_pk_bf16_f32 v76, v8, v9
v_cvt_pk_bf16_f32 v77, v10, v11
buffer_store_dwordx2 v[76:77], v203, s[8:11], s38 offen offset:64
v_max3_f32 v151, v138, v139, v140
v_max3_f32 v151, v151, v141, v142
v_max3_f32 v151, v151, v143, v144
v_max3_f32 v151, v151, v145, v146
v_max3_f32 v151, v151, v147, v148
v_max3_f32 v151, v151, v149, v150
v_mov_b32 v152, v151
s_nop 1
v_permlane16_swap_b32 v151, v152
v_max_f32 v151, v151, v152
v_mov_b32 v152, v151
s_nop 1
v_permlane32_swap_b32 v151, v152
v_max_f32 v151, v151, v152
v_sub_f32 v138, v138, v151
v_sub_f32 v139, v139, v151
v_sub_f32 v140, v140, v151
v_sub_f32 v141, v141, v151
v_sub_f32 v142, v142, v151
v_sub_f32 v143, v143, v151
v_sub_f32 v144, v144, v151
v_sub_f32 v145, v145, v151
v_sub_f32 v150, v150, v151
v_sub_f32 v146, v146, v151
v_sub_f32 v147, v147, v151
v_sub_f32 v148, v148, v151
v_sub_f32 v149, v149, v151
v_exp_f32 v138, v138
v_exp_f32 v139, v139
v_exp_f32 v140, v140
v_exp_f32 v141, v141
v_exp_f32 v142, v142
v_exp_f32 v143, v143
v_exp_f32 v144, v144
v_exp_f32 v145, v145
v_exp_f32 v150, v150
v_exp_f32 v146, v146
v_exp_f32 v147, v147
v_exp_f32 v148, v148
v_exp_f32 v149, v149
v_cvt_pk_bf16_f32 v174, v138, v139
v_cvt_pk_bf16_f32 v175, v140, v141
v_cvt_pk_bf16_f32 v176, v142, v143
v_cvt_pk_bf16_f32 v177, v144, v145
v_cvt_pk_bf16_f32 v178, v146, v147
v_cvt_pk_bf16_f32 v179, v148, v149
v_cvt_pk_bf16_f32 v180, v150, 0
v_mfma_f32_16x16x32_bf16 v[150:153], v[190:193], v[174:177], 0
v_mfma_f32_16x16x32_bf16 v[138:141], v[114:117], v[174:177], 0
v_mfma_f32_16x16x32_bf16 v[142:145], v[122:125], v[174:177], 0
v_mfma_f32_16x16x32_bf16 v[146:149], v[130:133], v[174:177], 0
v_mfma_f32_16x16x32_bf16 v[150:153], v[190:193], v[178:181], v[150:153]
v_mfma_f32_16x16x32_bf16 v[138:141], v[118:121], v[178:181], v[138:141]
v_mfma_f32_16x16x32_bf16 v[142:145], v[126:129], v[178:181], v[142:145]
v_mfma_f32_16x16x32_bf16 v[146:149], v[134:137], v[178:181], v[146:149]
v_mfma_f32_16x16x32_bf16 v[166:169], v[84:87], v[190:193], 0
v_mfma_f32_16x16x32_bf16 v[154:157], v[84:87], v[114:117], 0
v_mfma_f32_16x16x32_bf16 v[158:161], v[84:87], v[122:125], 0
v_mfma_f32_16x16x32_bf16 v[162:165], v[84:87], v[130:133], 0
v_mfma_f32_16x16x32_bf16 v[166:169], v[88:91], v[190:193], v[166:169]
v_mfma_f32_16x16x32_bf16 v[154:157], v[88:91], v[118:121], v[154:157]
v_mfma_f32_16x16x32_bf16 v[158:161], v[88:91], v[126:129], v[158:161]
v_mfma_f32_16x16x32_bf16 v[162:165], v[88:91], v[134:137], v[162:165]
v_rcp_f32 v167, v166
s_nop 1
v_mov_b32_dpp v154, v158 quad_perm:[0,1,2,3] row_mask:0x2 bank_mask:0xf
s_nop 2
v_mov_b32_dpp v154, v162 quad_perm:[0,1,2,3] row_mask:0x4 bank_mask:0xf
v_mul_f32 v167, s3, v167
v_mul_f32 v154, v154, v167
v_cvt_pk_bf16_f32 v154, v154, 0
ds_write_b16 v214, v154
v_add_u32 v214, 1552, v214
ds_read_b128 v[170:173], v210 offset:43008
s_waitcnt lgkmcnt(0)
v_mfma_f32_16x16x32_bf16 v[12:15], a[144:147], v[170:173], v[12:15]
v_mfma_f32_16x16x32_bf16 v[16:19], a[168:171], v[170:173], v[16:19]
v_mfma_f32_16x16x32_bf16 v[20:23], a[192:195], v[170:173], v[20:23]
ds_read_b128 v[182:185], v210 offset:44032
s_waitcnt lgkmcnt(0)
v_mfma_f32_16x16x32_bf16 v[12:15], a[148:151], v[182:185], v[12:15]
v_mfma_f32_16x16x32_bf16 v[16:19], a[172:175], v[182:185], v[16:19]
v_mfma_f32_16x16x32_bf16 v[20:23], a[196:199], v[182:185], v[20:23]
ds_read_b128 v[186:189], v210 offset:45056
s_waitcnt lgkmcnt(0)
v_mfma_f32_16x16x32_bf16 v[12:15], a[152:155], v[186:189], v[12:15]
v_mfma_f32_16x16x32_bf16 v[16:19], a[176:179], v[186:189], v[16:19]
v_mfma_f32_16x16x32_bf16 v[20:23], a[200:203], v[186:189], v[20:23]
ds_read_b128 v[170:173], v210 offset:46080
s_waitcnt lgkmcnt(0)
v_mfma_f32_16x16x32_bf16 v[12:15], a[156:159], v[170:173], v[12:15]
v_mfma_f32_16x16x32_bf16 v[16:19], a[180:183], v[170:173], v[16:19]
v_mfma_f32_16x16x32_bf16 v[20:23], a[204:207], v[170:173], v[20:23]
ds_read_b128 v[182:185], v210 offset:47104
s_waitcnt lgkmcnt(0)
v_mfma_f32_16x16x32_bf16 v[12:15], a[160:163], v[182:185], v[12:15]
v_mfma_f32_16x16x32_bf16 v[16:19], a[184:187], v[182:185], v[16:19]
v_mfma_f32_16x16x32_bf16 v[20:23], a[208:211], v[182:185], v[20:23]
ds_read_b128 v[186:189], v210 offset:48128
s_waitcnt lgkmcnt(0)
v_mfma_f32_16x16x32_bf16 v[12:15], a[164:167], v[186:189], v[12:15]
v_mfma_f32_16x16x32_bf16 v[16:19], a[188:191], v[186:189], v[16:19]
v_mfma_f32_16x16x32_bf16 v[20:23], a[212:215], v[186:189], v[20:23]
v_cvt_pk_bf16_f32 v78, v12, v13
v_cvt_pk_bf16_f32 v79, v14, v15
buffer_store_dwordx2 v[78:79], v204, s[8:11], s38 offen
v_cvt_pk_bf16_f32 v80, v16, v17
v_cvt_pk_bf16_f32 v81, v18, v19
buffer_store_dwordx2 v[80:81], v204, s[8:11], s38 offen offset:32
s_nop 0
v_cvt_pk_bf16_f32 v82, v20, v21
v_cvt_pk_bf16_f32 v83, v22, v23
buffer_store_dwordx2 v[82:83], v204, s[8:11], s38 offen offset:64
v_rcp_f32 v151, v150
s_nop 0
v_mul_f32 v151, s3, v151
v_mul_f32 v138, v138, v151
v_mul_f32 v139, v139, v151
v_cvt_pk_bf16_f32 v138, v138, v139
v_mul_f32 v140, v140, v151
v_mul_f32 v141, v141, v151
v_cvt_pk_bf16_f32 v139, v140, v141
v_mul_f32 v142, v142, v151
v_mul_f32 v143, v143, v151
v_cvt_pk_bf16_f32 v140, v142, v143
v_mul_f32 v144, v144, v151
v_mul_f32 v145, v145, v151
v_cvt_pk_bf16_f32 v141, v144, v145
ds_write_b128 v211, v[138:141] offset:49152
v_mul_f32 v146, v146, v151
v_mul_f32 v147, v147, v151
v_cvt_pk_bf16_f32 v142, v146, v147
v_mul_f32 v148, v148, v151
v_mul_f32 v149, v149, v151
v_cvt_pk_bf16_f32 v143, v148, v149
ds_write_b64 v212, v[142:143] offset:49152
s_waitcnt vmcnt(6) lgkmcnt(0)
s_barrier
ds_read_b128 v[170:173], v210 offset:49152
s_waitcnt lgkmcnt(0)
v_mfma_f32_16x16x32_bf16 v[24:27], a[144:147], v[170:173], v[24:27]
v_mfma_f32_16x16x32_bf16 v[28:31], a[168:171], v[170:173], v[28:31]
v_mfma_f32_16x16x32_bf16 v[32:35], a[192:195], v[170:173], v[32:35]
ds_read_b128 v[182:185], v210 offset:50176
s_waitcnt lgkmcnt(0)
v_mfma_f32_16x16x32_bf16 v[24:27], a[148:151], v[182:185], v[24:27]
v_mfma_f32_16x16x32_bf16 v[28:31], a[172:175], v[182:185], v[28:31]
v_mfma_f32_16x16x32_bf16 v[32:35], a[196:199], v[182:185], v[32:35]
ds_read_b128 v[186:189], v210 offset:51200
s_waitcnt lgkmcnt(0)
v_mfma_f32_16x16x32_bf16 v[24:27], a[152:155], v[186:189], v[24:27]
v_mfma_f32_16x16x32_bf16 v[28:31], a[176:179], v[186:189], v[28:31]
v_mfma_f32_16x16x32_bf16 v[32:35], a[200:203], v[186:189], v[32:35]
ds_read_b128 v[170:173], v210 offset:52224
s_waitcnt lgkmcnt(0)
v_mfma_f32_16x16x32_bf16 v[24:27], a[156:159], v[170:173], v[24:27]
v_mfma_f32_16x16x32_bf16 v[28:31], a[180:183], v[170:173], v[28:31]
v_mfma_f32_16x16x32_bf16 v[32:35], a[204:207], v[170:173], v[32:35]
ds_read_b128 v[182:185], v210 offset:53248
s_waitcnt lgkmcnt(0)
v_mfma_f32_16x16x32_bf16 v[24:27], a[160:163], v[182:185], v[24:27]
v_mfma_f32_16x16x32_bf16 v[28:31], a[184:187], v[182:185], v[28:31]
v_mfma_f32_16x16x32_bf16 v[32:35], a[208:211], v[182:185], v[32:35]
ds_read_b128 v[186:189], v210 offset:54272
s_waitcnt lgkmcnt(0)
v_mfma_f32_16x16x32_bf16 v[24:27], a[164:167], v[186:189], v[24:27]
v_mfma_f32_16x16x32_bf16 v[28:31], a[188:191], v[186:189], v[28:31]
v_mfma_f32_16x16x32_bf16 v[32:35], a[212:215], v[186:189], v[32:35]
v_cvt_pk_bf16_f32 v116, v24, v25
v_cvt_pk_bf16_f32 v117, v26, v27
buffer_store_dwordx2 v[116:117], v205, s[8:11], s38 offen
v_cvt_pk_bf16_f32 v124, v28, v29
v_cvt_pk_bf16_f32 v125, v30, v31
buffer_store_dwordx2 v[124:125], v205, s[8:11], s38 offen offset:32
s_nop 0
v_cvt_pk_bf16_f32 v132, v32, v33
v_cvt_pk_bf16_f32 v133, v34, v35
buffer_store_dwordx2 v[132:133], v205, s[8:11], s38 offen offset:64
s_mov_b32 s39, s37
ds_read_b128 v[174:177], v217
ds_read_b128 v[84:87], v200
s_waitcnt lgkmcnt(0)
v_mfma_f32_16x16x32_bf16 v[0:3], v[174:177], v[84:87], 0
ds_read_b128 v[92:95], v201
s_waitcnt lgkmcnt(0)
v_mfma_f32_16x16x32_bf16 v[12:15], v[174:177], v[92:95], 0
ds_read_b128 v[100:103], v202
s_waitcnt lgkmcnt(0)
v_mfma_f32_16x16x32_bf16 v[24:27], v[174:177], v[100:103], 0
ds_read_b128 v[178:181], v217 offset:528
ds_read_b128 v[84:87], v194
ds_read_b128 v[88:91], v194 offset:16
s_waitcnt lgkmcnt(0)
v_smfmac_f32_16x16x64_bf16 v[0:3], v[178:181], v[84:91], v213
ds_read_b128 v[92:95], v195
ds_read_b128 v[96:99], v195 offset:16
s_waitcnt lgkmcnt(0)
v_smfmac_f32_16x16x64_bf16 v[12:15], v[178:181], v[92:99], v213
ds_read_b128 v[100:103], v196
ds_read_b128 v[104:107], v196 offset:16
s_waitcnt lgkmcnt(0)
v_smfmac_f32_16x16x64_bf16 v[24:27], v[178:181], v[100:107], v213
ds_read_b128 v[174:177], v217 offset:1056
ds_read_b128 v[84:87], v197
ds_read_b128 v[88:91], v197 offset:16
s_waitcnt lgkmcnt(0)
v_smfmac_f32_16x16x64_bf16 v[0:3], v[174:177], v[84:91], v213
ds_read_b128 v[92:95], v198
ds_read_b128 v[96:99], v198 offset:16
s_waitcnt lgkmcnt(0)
v_smfmac_f32_16x16x64_bf16 v[12:15], v[174:177], v[92:99], v213
ds_read_b128 v[100:103], v199
ds_read_b128 v[104:107], v199 offset:16
s_waitcnt lgkmcnt(0)
v_smfmac_f32_16x16x64_bf16 v[24:27], v[174:177], v[100:107], v213
ds_read_b128 v[178:181], v217 offset:1584
ds_read_b128 v[84:87], v200 offset:32
s_waitcnt lgkmcnt(0)
v_mfma_f32_16x16x32_bf16 v[4:7], v[178:181], v[84:87], 0
ds_read_b128 v[92:95], v201 offset:32
s_waitcnt lgkmcnt(0)
v_mfma_f32_16x16x32_bf16 v[16:19], v[178:181], v[92:95], 0
ds_read_b128 v[100:103], v202 offset:32
s_waitcnt lgkmcnt(0)
v_mfma_f32_16x16x32_bf16 v[28:31], v[178:181], v[100:103], 0
ds_read_b128 v[174:177], v217 offset:2112
ds_read_b128 v[84:87], v194 offset:32
ds_read_b128 v[88:91], v194 offset:48
s_waitcnt lgkmcnt(0)
v_smfmac_f32_16x16x64_bf16 v[4:7], v[174:177], v[84:91], v213
ds_read_b128 v[92:95], v195 offset:32
ds_read_b128 v[96:99], v195 offset:48
s_waitcnt lgkmcnt(0)
v_smfmac_f32_16x16x64_bf16 v[16:19], v[174:177], v[92:99], v213
ds_read_b128 v[100:103], v196 offset:32
ds_read_b128 v[104:107], v196 offset:48
s_waitcnt lgkmcnt(0)
v_smfmac_f32_16x16x64_bf16 v[28:31], v[174:177], v[100:107], v213
ds_read_b128 v[178:181], v217 offset:2640
ds_read_b128 v[84:87], v197 offset:32
ds_read_b128 v[88:91], v197 offset:48
s_waitcnt lgkmcnt(0)
v_smfmac_f32_16x16x64_bf16 v[4:7], v[178:181], v[84:91], v213
ds_read_b128 v[92:95], v198 offset:32
ds_read_b128 v[96:99], v198 offset:48
s_waitcnt lgkmcnt(0)
v_smfmac_f32_16x16x64_bf16 v[16:19], v[178:181], v[92:99], v213
ds_read_b128 v[100:103], v199 offset:32
ds_read_b128 v[104:107], v199 offset:48
s_waitcnt lgkmcnt(0)
v_smfmac_f32_16x16x64_bf16 v[28:31], v[178:181], v[100:107], v213
ds_read_b128 v[174:177], v217 offset:3168
ds_read_b128 v[84:87], v200 offset:64
s_waitcnt lgkmcnt(0)
v_mfma_f32_16x16x32_bf16 v[8:11], v[174:177], v[84:87], 0
ds_read_b128 v[92:95], v201 offset:64
s_waitcnt lgkmcnt(0)
v_mfma_f32_16x16x32_bf16 v[20:23], v[174:177], v[92:95], 0
ds_read_b128 v[100:103], v202 offset:64
s_waitcnt lgkmcnt(0)
v_mfma_f32_16x16x32_bf16 v[32:35], v[174:177], v[100:103], 0
ds_read_b128 v[178:181], v217 offset:3696
ds_read_b128 v[84:87], v194 offset:64
ds_read_b128 v[88:91], v194 offset:80
s_waitcnt lgkmcnt(0)
v_smfmac_f32_16x16x64_bf16 v[8:11], v[178:181], v[84:91], v213
ds_read_b128 v[92:95], v195 offset:64
ds_read_b128 v[96:99], v195 offset:80
s_waitcnt lgkmcnt(0)
v_smfmac_f32_16x16x64_bf16 v[20:23], v[178:181], v[92:99], v213
ds_read_b128 v[100:103], v196 offset:64
ds_read_b128 v[104:107], v196 offset:80
s_waitcnt lgkmcnt(0)
v_smfmac_f32_16x16x64_bf16 v[32:35], v[178:181], v[100:107], v213
ds_read_b128 v[174:177], v217 offset:4224
ds_read_b128 v[84:87], v197 offset:64
ds_read_b128 v[88:91], v197 offset:80
s_waitcnt lgkmcnt(0)
v_smfmac_f32_16x16x64_bf16 v[8:11], v[174:177], v[84:91], v213
ds_read_b128 v[92:95], v198 offset:64
ds_read_b128 v[96:99], v198 offset:80
s_waitcnt lgkmcnt(0)
v_smfmac_f32_16x16x64_bf16 v[20:23], v[174:177], v[92:99], v213
ds_read_b128 v[100:103], v199 offset:64
ds_read_b128 v[104:107], v199 offset:80
s_waitcnt lgkmcnt(0)
v_smfmac_f32_16x16x64_bf16 v[32:35], v[174:177], v[100:107], v213
v_add_f32 v118, v0, v1
v_mul_f32 v119, v0, v0
v_add_f32 v118, v118, v2
v_fmac_f32 v119, v1, v1
v_add_f32 v118, v118, v3
v_fmac_f32 v119, v2, v2
v_fmac_f32 v119, v3, v3
v_add_f32 v126, v12, v13
v_mul_f32 v127, v12, v12
v_add_f32 v126, v126, v14
v_fmac_f32 v127, v13, v13
v_add_f32 v126, v126, v15
v_fmac_f32 v127, v14, v14
v_fmac_f32 v127, v15, v15
v_add_f32 v134, v24, v25
v_mul_f32 v135, v24, v24
v_add_f32 v134, v134, v26
v_fmac_f32 v135, v25, v25
v_add_f32 v134, v134, v27
v_fmac_f32 v135, v26, v26
v_fmac_f32 v135, v27, v27
v_add_f32 v118, v118, v4
v_fmac_f32 v119, v4, v4
v_add_f32 v118, v118, v5
v_fmac_f32 v119, v5, v5
v_add_f32 v118, v118, v6
v_fmac_f32 v119, v6, v6
v_add_f32 v118, v118, v7
v_fmac_f32 v119, v7, v7
v_add_f32 v126, v126, v16
v_fmac_f32 v127, v16, v16
v_add_f32 v126, v126, v17
v_fmac_f32 v127, v17, v17
v_add_f32 v126, v126, v18
v_fmac_f32 v127, v18, v18
v_add_f32 v126, v126, v19
v_fmac_f32 v127, v19, v19
v_add_f32 v134, v134, v28
v_fmac_f32 v135, v28, v28
v_add_f32 v134, v134, v29
v_fmac_f32 v135, v29, v29
v_add_f32 v134, v134, v30
v_fmac_f32 v135, v30, v30
v_add_f32 v134, v134, v31
v_fmac_f32 v135, v31, v31
v_add_f32 v118, v118, v8
v_fmac_f32 v119, v8, v8
v_add_f32 v118, v118, v9
v_fmac_f32 v119, v9, v9
v_add_f32 v118, v118, v10
v_fmac_f32 v119, v10, v10
v_add_f32 v118, v118, v11
v_fmac_f32 v119, v11, v11
v_add_f32 v126, v126, v20
v_fmac_f32 v127, v20, v20
v_add_f32 v126, v126, v21
v_fmac_f32 v127, v21, v21
v_add_f32 v126, v126, v22
v_fmac_f32 v127, v22, v22
v_add_f32 v126, v126, v23
v_fmac_f32 v127, v23, v23
v_add_f32 v134, v134, v32
v_fmac_f32 v135, v32, v32
v_add_f32 v134, v134, v33
v_fmac_f32 v135, v33, v33
v_add_f32 v134, v134, v34
v_fmac_f32 v135, v34, v34
v_add_f32 v134, v134, v35
v_fmac_f32 v135, v35, v35
v_permlane16_swap_b32 v118, v119
v_add_f32 v118, v118, v119
v_permlane16_swap_b32 v126, v127
v_add_f32 v126, v126, v127
v_permlane16_swap_b32 v134, v135
v_add_f32 v134, v134, v135
v_permlane32_swap_b32 v118, v126
v_add_f32 v118, v118, v126
ds_write_b32 v209, v118
v_mov_b32 v135, v134
s_nop 1
v_permlane32_swap_b32 v134, v135
v_add_f32 v134, v134, v135
ds_write_b32 v209, v134 offset:512
s_waitcnt lgkmcnt(0)
s_barrier
ds_read_b128 v[102:105], v210 offset:55296
ds_read_b128 v[106:109], v210 offset:56320
s_waitcnt lgkmcnt(1)
v_add_f32 v102, v102, v103
s_waitcnt lgkmcnt(0)
v_add_f32 v106, v106, v107
v_add_f32 v104, v104, v105
v_add_f32 v108, v108, v109
v_add_f32 v102, v102, v104
v_add_f32 v106, v106, v108
v_mul_f32 v103, s48, v102
v_mul_f32 v104, s73, v102
v_mul_f32 v106, s73, v106
v_fma_f32 v106, -v103, v104, v106
v_max_f32 v106, 0, v106
v_add_f32 v106, s49, v106
v_rsq_f32 v102, v106
s_nop 0
v_mul_f32_e64 v103, -v103, v102
ds_write_b64 v211, v[102:103] offset:36864
ds_read_b64 v[118:119], v219
ds_read_b64 v[126:127], v219 offset:256
ds_read_b64 v[134:135], v219 offset:512
s_waitcnt lgkmcnt(2)
v_fma_f32 v220, v0, v118, v119
v_fma_f32 v221, v1, v118, v119
v_cvt_pk_bf16_f32 v90, v220, v221
v_fma_f32 v222, v2, v118, v119
v_fma_f32 v223, v3, v118, v119
v_cvt_pk_bf16_f32 v91, v222, v223
v_fma_f32 v220, v4, v118, v119
v_fma_f32 v221, v5, v118, v119
v_cvt_pk_bf16_f32 v92, v220, v221
v_fma_f32 v222, v6, v118, v119
v_fma_f32 v223, v7, v118, v119
v_cvt_pk_bf16_f32 v93, v222, v223
ds_write_b128 v211, v[90:93]
v_fma_f32 v220, v8, v118, v119
v_fma_f32 v221, v9, v118, v119
v_cvt_pk_bf16_f32 v94, v220, v221
v_fma_f32 v222, v10, v118, v119
v_fma_f32 v223, v11, v118, v119
v_cvt_pk_bf16_f32 v95, v222, v223
s_waitcnt lgkmcnt(2)
ds_write_b64 v212, v[94:95]
v_fma_f32 v220, v12, v126, v127
v_fma_f32 v221, v13, v126, v127
v_cvt_pk_bf16_f32 v174, v220, v221
v_fma_f32 v222, v14, v126, v127
v_fma_f32 v223, v15, v126, v127
v_cvt_pk_bf16_f32 v175, v222, v223
v_fma_f32 v220, v16, v126, v127
v_fma_f32 v221, v17, v126, v127
v_cvt_pk_bf16_f32 v176, v220, v221
v_fma_f32 v222, v18, v126, v127
v_fma_f32 v223, v19, v126, v127
v_cvt_pk_bf16_f32 v177, v222, v223
ds_write_b128 v211, v[174:177] offset:6144
v_fma_f32 v220, v20, v126, v127
v_fma_f32 v221, v21, v126, v127
v_cvt_pk_bf16_f32 v178, v220, v221
v_fma_f32 v222, v22, v126, v127
v_fma_f32 v223, v23, v126, v127
v_cvt_pk_bf16_f32 v179, v222, v223
s_waitcnt lgkmcnt(3)
ds_write_b64 v212, v[178:179] offset:6144
v_fma_f32 v220, v24, v134, v135
v_fma_f32 v221, v25, v134, v135
v_cvt_pk_bf16_f32 v90, v220, v221
v_fma_f32 v222, v26, v134, v135
v_fma_f32 v223, v27, v134, v135
v_cvt_pk_bf16_f32 v91, v222, v223
v_fma_f32 v220, v28, v134, v135
v_fma_f32 v221, v29, v134, v135
v_cvt_pk_bf16_f32 v92, v220, v221
v_fma_f32 v222, v30, v134, v135
v_fma_f32 v223, v31, v134, v135
v_cvt_pk_bf16_f32 v93, v222, v223
ds_write_b128 v211, v[90:93] offset:12288
v_fma_f32 v220, v32, v134, v135
v_fma_f32 v221, v33, v134, v135
v_cvt_pk_bf16_f32 v94, v220, v221
v_fma_f32 v222, v34, v134, v135
v_fma_f32 v223, v35, v134, v135
v_cvt_pk_bf16_f32 v95, v222, v223
ds_write_b64 v212, v[94:95] offset:12288
ds_read_b128 v[182:185], v210 offset:18432
s_waitcnt lgkmcnt(0)
v_mfma_f32_16x16x32_bf16 v[138:141], a[0:3], v[182:185], 0
v_mfma_f32_16x16x32_bf16 v[142:145], a[24:27], v[182:185], 0
v_mfma_f32_16x16x32_bf16 v[146:149], a[48:51], v[182:185], 0
v_mfma_f32_16x16x32_bf16 v[150:153], a[216:219], v[182:185], 0
v_mfma_f32_16x16x32_bf16 v[154:157], a[240:243], v[182:185], 0
v_mfma_f32_16x16x32_bf16 v[158:161], v[232:235], v[182:185], 0
v_mfma_f32_16x16x32_bf16 v[162:165], v[182:185], a[72:75], 0
v_mfma_f32_16x16x32_bf16 v[166:169], v[182:185], a[96:99], 0
v_mfma_f32_16x16x32_bf16 v[170:173], v[182:185], a[120:123], 0
ds_read_b128 v[186:189], v210 offset:19456
s_waitcnt lgkmcnt(0)
v_mfma_f32_16x16x32_bf16 v[138:141], a[4:7], v[186:189], v[138:141]
v_mfma_f32_16x16x32_bf16 v[142:145], a[28:31], v[186:189], v[142:145]
v_mfma_f32_16x16x32_bf16 v[146:149], a[52:55], v[186:189], v[146:149]
v_mfma_f32_16x16x32_bf16 v[150:153], a[220:223], v[186:189], v[150:153]
v_mfma_f32_16x16x32_bf16 v[154:157], a[244:247], v[186:189], v[154:157]
v_mfma_f32_16x16x32_bf16 v[158:161], v[236:239], v[186:189], v[158:161]
v_mfma_f32_16x16x32_bf16 v[162:165], v[186:189], a[76:79], v[162:165]
v_mfma_f32_16x16x32_bf16 v[166:169], v[186:189], a[100:103], v[166:169]
v_mfma_f32_16x16x32_bf16 v[170:173], v[186:189], a[124:127], v[170:173]
ds_read_b128 v[182:185], v210 offset:20480
s_waitcnt lgkmcnt(0)
v_mfma_f32_16x16x32_bf16 v[138:141], a[8:11], v[182:185], v[138:141]
v_mfma_f32_16x16x32_bf16 v[142:145], a[32:35], v[182:185], v[142:145]
v_mfma_f32_16x16x32_bf16 v[146:149], a[56:59], v[182:185], v[146:149]
v_mfma_f32_16x16x32_bf16 v[150:153], a[224:227], v[182:185], v[150:153]
v_mfma_f32_16x16x32_bf16 v[154:157], a[248:251], v[182:185], v[154:157]
v_mfma_f32_16x16x32_bf16 v[158:161], v[240:243], v[182:185], v[158:161]
v_mfma_f32_16x16x32_bf16 v[162:165], v[182:185], a[80:83], v[162:165]
v_mfma_f32_16x16x32_bf16 v[166:169], v[182:185], a[104:107], v[166:169]
v_mfma_f32_16x16x32_bf16 v[170:173], v[182:185], a[128:131], v[170:173]
ds_read_b128 v[186:189], v210 offset:21504
s_waitcnt lgkmcnt(0)
v_mfma_f32_16x16x32_bf16 v[138:141], a[12:15], v[186:189], v[138:141]
v_mfma_f32_16x16x32_bf16 v[142:145], a[36:39], v[186:189], v[142:145]
v_mfma_f32_16x16x32_bf16 v[146:149], a[60:63], v[186:189], v[146:149]
v_mfma_f32_16x16x32_bf16 v[150:153], a[228:231], v[186:189], v[150:153]
v_mfma_f32_16x16x32_bf16 v[154:157], a[252:255], v[186:189], v[154:157]
v_mfma_f32_16x16x32_bf16 v[158:161], v[244:247], v[186:189], v[158:161]
v_mfma_f32_16x16x32_bf16 v[162:165], v[186:189], a[84:87], v[162:165]
v_mfma_f32_16x16x32_bf16 v[166:169], v[186:189], a[108:111], v[166:169]
v_mfma_f32_16x16x32_bf16 v[170:173], v[186:189], a[132:135], v[170:173]
ds_read_b128 v[182:185], v210 offset:22528
s_waitcnt lgkmcnt(0)
v_mfma_f32_16x16x32_bf16 v[138:141], a[16:19], v[182:185], v[138:141]
v_mfma_f32_16x16x32_bf16 v[142:145], a[40:43], v[182:185], v[142:145]
v_mfma_f32_16x16x32_bf16 v[146:149], a[64:67], v[182:185], v[146:149]
v_mfma_f32_16x16x32_bf16 v[150:153], a[232:235], v[182:185], v[150:153]
v_mfma_f32_16x16x32_bf16 v[154:157], v[224:227], v[182:185], v[154:157]
v_mfma_f32_16x16x32_bf16 v[158:161], v[248:251], v[182:185], v[158:161]
v_mfma_f32_16x16x32_bf16 v[162:165], v[182:185], a[88:91], v[162:165]
v_mfma_f32_16x16x32_bf16 v[166:169], v[182:185], a[112:115], v[166:169]
v_mfma_f32_16x16x32_bf16 v[170:173], v[182:185], a[136:139], v[170:173]
ds_read_b128 v[186:189], v210 offset:23552
s_waitcnt lgkmcnt(0)
v_mfma_f32_16x16x32_bf16 v[138:141], a[20:23], v[186:189], v[138:141]
v_mfma_f32_16x16x32_bf16 v[142:145], a[44:47], v[186:189], v[142:145]
v_mfma_f32_16x16x32_bf16 v[146:149], a[68:71], v[186:189], v[146:149]
v_mfma_f32_16x16x32_bf16 v[150:153], a[236:239], v[186:189], v[150:153]
v_mfma_f32_16x16x32_bf16 v[154:157], v[228:231], v[186:189], v[154:157]
v_mfma_f32_16x16x32_bf16 v[158:161], v[252:255], v[186:189], v[158:161]
v_mfma_f32_16x16x32_bf16 v[162:165], v[186:189], a[92:95], v[162:165]
v_mfma_f32_16x16x32_bf16 v[166:169], v[186:189], a[116:119], v[166:169]
v_mfma_f32_16x16x32_bf16 v[170:173], v[186:189], a[140:143], v[170:173]
v_cvt_pk_bf16_f32 v78, v138, v139
v_cvt_pk_bf16_f32 v79, v140, v141
v_cvt_pk_bf16_f32 v80, v142, v143
v_cvt_pk_bf16_f32 v81, v144, v145
v_cvt_pk_bf16_f32 v82, v146, v147
v_cvt_pk_bf16_f32 v83, v148, v149
v_cvt_pk_bf16_f32 v72, v150, v151
v_cvt_pk_bf16_f32 v73, v152, v153
v_cvt_pk_bf16_f32 v74, v154, v155
v_cvt_pk_bf16_f32 v75, v156, v157
v_cvt_pk_bf16_f32 v76, v158, v159
v_cvt_pk_bf16_f32 v77, v160, v161
v_cvt_pk_bf16_f32 v114, v162, v163
v_cvt_pk_bf16_f32 v115, v164, v165
v_cvt_pk_bf16_f32 v122, v166, v167
v_cvt_pk_bf16_f32 v123, v168, v169
v_cvt_pk_bf16_f32 v130, v170, v171
v_cvt_pk_bf16_f32 v131, v172, v173
ds_read_b128 v[182:185], v210 offset:24576
s_waitcnt lgkmcnt(0)
v_mfma_f32_16x16x32_bf16 v[138:141], a[0:3], v[182:185], 0
v_mfma_f32_16x16x32_bf16 v[142:145], a[24:27], v[182:185], 0
v_mfma_f32_16x16x32_bf16 v[146:149], a[48:51], v[182:185], 0
v_mfma_f32_16x16x32_bf16 v[150:153], a[216:219], v[182:185], 0
v_mfma_f32_16x16x32_bf16 v[154:157], a[240:243], v[182:185], 0
v_mfma_f32_16x16x32_bf16 v[158:161], v[232:235], v[182:185], 0
v_mfma_f32_16x16x32_bf16 v[162:165], v[182:185], a[72:75], 0
v_mfma_f32_16x16x32_bf16 v[166:169], v[182:185], a[96:99], 0
v_mfma_f32_16x16x32_bf16 v[170:173], v[182:185], a[120:123], 0
ds_read_b128 v[186:189], v210 offset:25600
s_waitcnt lgkmcnt(0)
v_mfma_f32_16x16x32_bf16 v[138:141], a[4:7], v[186:189], v[138:141]
v_mfma_f32_16x16x32_bf16 v[142:145], a[28:31], v[186:189], v[142:145]
v_mfma_f32_16x16x32_bf16 v[146:149], a[52:55], v[186:189], v[146:149]
v_mfma_f32_16x16x32_bf16 v[150:153], a[220:223], v[186:189], v[150:153]
v_mfma_f32_16x16x32_bf16 v[154:157], a[244:247], v[186:189], v[154:157]
v_mfma_f32_16x16x32_bf16 v[158:161], v[236:239], v[186:189], v[158:161]
v_mfma_f32_16x16x32_bf16 v[162:165], v[186:189], a[76:79], v[162:165]
v_mfma_f32_16x16x32_bf16 v[166:169], v[186:189], a[100:103], v[166:169]
v_mfma_f32_16x16x32_bf16 v[170:173], v[186:189], a[124:127], v[170:173]
ds_read_b128 v[182:185], v210 offset:26624
s_waitcnt lgkmcnt(0)
v_mfma_f32_16x16x32_bf16 v[138:141], a[8:11], v[182:185], v[138:141]
v_mfma_f32_16x16x32_bf16 v[142:145], a[32:35], v[182:185], v[142:145]
v_mfma_f32_16x16x32_bf16 v[146:149], a[56:59], v[182:185], v[146:149]
v_mfma_f32_16x16x32_bf16 v[150:153], a[224:227], v[182:185], v[150:153]
v_mfma_f32_16x16x32_bf16 v[154:157], a[248:251], v[182:185], v[154:157]
v_mfma_f32_16x16x32_bf16 v[158:161], v[240:243], v[182:185], v[158:161]
v_mfma_f32_16x16x32_bf16 v[162:165], v[182:185], a[80:83], v[162:165]
v_mfma_f32_16x16x32_bf16 v[166:169], v[182:185], a[104:107], v[166:169]
v_mfma_f32_16x16x32_bf16 v[170:173], v[182:185], a[128:131], v[170:173]
ds_read_b128 v[186:189], v210 offset:27648
s_waitcnt lgkmcnt(0)
v_mfma_f32_16x16x32_bf16 v[138:141], a[12:15], v[186:189], v[138:141]
v_mfma_f32_16x16x32_bf16 v[142:145], a[36:39], v[186:189], v[142:145]
v_mfma_f32_16x16x32_bf16 v[146:149], a[60:63], v[186:189], v[146:149]
v_mfma_f32_16x16x32_bf16 v[150:153], a[228:231], v[186:189], v[150:153]
v_mfma_f32_16x16x32_bf16 v[154:157], a[252:255], v[186:189], v[154:157]
v_mfma_f32_16x16x32_bf16 v[158:161], v[244:247], v[186:189], v[158:161]
v_mfma_f32_16x16x32_bf16 v[162:165], v[186:189], a[84:87], v[162:165]
v_mfma_f32_16x16x32_bf16 v[166:169], v[186:189], a[108:111], v[166:169]
v_mfma_f32_16x16x32_bf16 v[170:173], v[186:189], a[132:135], v[170:173]
ds_read_b128 v[182:185], v210 offset:28672
s_waitcnt lgkmcnt(0)
v_mfma_f32_16x16x32_bf16 v[138:141], a[16:19], v[182:185], v[138:141]
v_mfma_f32_16x16x32_bf16 v[142:145], a[40:43], v[182:185], v[142:145]
v_mfma_f32_16x16x32_bf16 v[146:149], a[64:67], v[182:185], v[146:149]
v_mfma_f32_16x16x32_bf16 v[150:153], a[232:235], v[182:185], v[150:153]
v_mfma_f32_16x16x32_bf16 v[154:157], v[224:227], v[182:185], v[154:157]
v_mfma_f32_16x16x32_bf16 v[158:161], v[248:251], v[182:185], v[158:161]
v_mfma_f32_16x16x32_bf16 v[162:165], v[182:185], a[88:91], v[162:165]
v_mfma_f32_16x16x32_bf16 v[166:169], v[182:185], a[112:115], v[166:169]
v_mfma_f32_16x16x32_bf16 v[170:173], v[182:185], a[136:139], v[170:173]
ds_read_b128 v[186:189], v210 offset:29696
s_waitcnt lgkmcnt(0)
v_mfma_f32_16x16x32_bf16 v[138:141], a[20:23], v[186:189], v[138:141]
v_mfma_f32_16x16x32_bf16 v[142:145], a[44:47], v[186:189], v[142:145]
v_mfma_f32_16x16x32_bf16 v[146:149], a[68:71], v[186:189], v[146:149]
v_mfma_f32_16x16x32_bf16 v[150:153], a[236:239], v[186:189], v[150:153]
v_mfma_f32_16x16x32_bf16 v[154:157], v[228:231], v[186:189], v[154:157]
v_mfma_f32_16x16x32_bf16 v[158:161], v[252:255], v[186:189], v[158:161]
v_mfma_f32_16x16x32_bf16 v[162:165], v[186:189], a[92:95], v[162:165]
v_mfma_f32_16x16x32_bf16 v[166:169], v[186:189], a[116:119], v[166:169]
v_mfma_f32_16x16x32_bf16 v[170:173], v[186:189], a[140:143], v[170:173]
v_cvt_pk_bf16_f32 v96, v138, v139
v_cvt_pk_bf16_f32 v97, v140, v141
v_cvt_pk_bf16_f32 v98, v142, v143
v_cvt_pk_bf16_f32 v99, v144, v145
v_cvt_pk_bf16_f32 v100, v146, v147
v_cvt_pk_bf16_f32 v101, v148, v149
v_cvt_pk_bf16_f32 v84, v150, v151
v_cvt_pk_bf16_f32 v85, v152, v153
v_cvt_pk_bf16_f32 v86, v154, v155
v_cvt_pk_bf16_f32 v87, v156, v157
v_cvt_pk_bf16_f32 v88, v158, v159
v_cvt_pk_bf16_f32 v89, v160, v161
v_cvt_pk_bf16_f32 v116, v162, v163
v_cvt_pk_bf16_f32 v117, v164, v165
v_cvt_pk_bf16_f32 v124, v166, v167
v_cvt_pk_bf16_f32 v125, v168, v169
v_cvt_pk_bf16_f32 v132, v170, v171
v_cvt_pk_bf16_f32 v133, v172, v173
ds_read_b128 v[182:185], v210 offset:30720
s_waitcnt lgkmcnt(0)
v_mfma_f32_16x16x32_bf16 v[138:141], a[0:3], v[182:185], 0
v_mfma_f32_16x16x32_bf16 v[142:145], a[24:27], v[182:185], 0
v_mfma_f32_16x16x32_bf16 v[146:149], a[48:51], v[182:185], 0
ds_read_b128 v[186:189], v210 offset:31744
s_waitcnt lgkmcnt(0)
v_mfma_f32_16x16x32_bf16 v[138:141], a[4:7], v[186:189], v[138:141]
v_mfma_f32_16x16x32_bf16 v[142:145], a[28:31], v[186:189], v[142:145]
v_mfma_f32_16x16x32_bf16 v[146:149], a[52:55], v[186:189], v[146:149]
ds_read_b128 v[182:185], v210 offset:32768
s_waitcnt lgkmcnt(0)
v_mfma_f32_16x16x32_bf16 v[138:141], a[8:11], v[182:185], v[138:141]
v_mfma_f32_16x16x32_bf16 v[142:145], a[32:35], v[182:185], v[142:145]
v_mfma_f32_16x16x32_bf16 v[146:149], a[56:59], v[182:185], v[146:149]
ds_read_b128 v[186:189], v210 offset:33792
s_waitcnt lgkmcnt(0)
v_mfma_f32_16x16x32_bf16 v[138:141], a[12:15], v[186:189], v[138:141]
v_mfma_f32_16x16x32_bf16 v[142:145], a[36:39], v[186:189], v[142:145]
v_mfma_f32_16x16x32_bf16 v[146:149], a[60:63], v[186:189], v[146:149]
ds_read_b128 v[182:185], v210 offset:34816
s_waitcnt lgkmcnt(0)
v_mfma_f32_16x16x32_bf16 v[138:141], a[16:19], v[182:185], v[138:141]
v_mfma_f32_16x16x32_bf16 v[142:145], a[40:43], v[182:185], v[142:145]
v_mfma_f32_16x16x32_bf16 v[146:149], a[64:67], v[182:185], v[146:149]
ds_read_b128 v[186:189], v210 offset:35840
s_waitcnt lgkmcnt(0)
v_mfma_f32_16x16x32_bf16 v[138:141], a[20:23], v[186:189], v[138:141]
v_mfma_f32_16x16x32_bf16 v[142:145], a[44:47], v[186:189], v[142:145]
v_mfma_f32_16x16x32_bf16 v[146:149], a[68:71], v[186:189], v[146:149]
v_cvt_pk_bf16_f32 v102, v138, v139
v_cvt_pk_bf16_f32 v103, v140, v141
s_nop 0
v_cvt_pk_bf16_f32 v104, v142, v143
v_cvt_pk_bf16_f32 v105, v144, v145
s_nop 1
v_cvt_pk_bf16_f32 v106, v146, v147
v_cvt_pk_bf16_f32 v107, v148, v149
ds_read_b128 v[108:111], v215 offset:512
ds_read_b64 v[112:113], v215 offset:528
v_mov_b32 v181, 0
v_mfma_f32_16x16x16_bf16 v[138:141], v[82:83], v[76:77], 0
v_mfma_f32_16x16x16_bf16 v[142:145], v[100:101], v[76:77], 0
s_waitcnt lgkmcnt(0)
v_mfma_f32_16x16x16_bf16 v[150:153], v[112:113], v[76:77], v[206:209]
v_mfma_f32_16x16x16_bf16 v[146:149], v[106:107], v[76:77], 0
v_mfma_f32_16x16x32_bf16 v[138:141], v[78:81], v[72:75], v[138:141]
v_mfma_f32_16x16x32_bf16 v[142:145], v[96:99], v[72:75], v[142:145]
v_mfma_f32_16x16x32_bf16 v[150:153], v[108:111], v[72:75], v[150:153]
v_mfma_f32_16x16x32_bf16 v[146:149], v[102:105], v[72:75], v[146:149]
ds_read_b128 v[72:75], v215
ds_read_b64 v[76:77], v215 offset:16
v_mfma_f32_16x16x16_bf16 v[154:157], v[82:83], v[88:89], 0
v_mfma_f32_16x16x16_bf16 v[158:161], v[100:101], v[88:89], 0
v_mfma_f32_16x16x16_bf16 v[166:169], v[112:113], v[88:89], v[206:209]
v_mfma_f32_16x16x16_bf16 v[162:165], v[106:107], v[88:89], 0
v_mfma_f32_16x16x32_bf16 v[154:157], v[78:81], v[84:87], v[154:157]
v_mfma_f32_16x16x32_bf16 v[158:161], v[96:99], v[84:87], v[158:161]
v_mfma_f32_16x16x32_bf16 v[166:169], v[108:111], v[84:87], v[166:169]
v_mfma_f32_16x16x32_bf16 v[162:165], v[102:105], v[84:87], v[162:165]
ds_read_b128 v[182:185], v210 offset:30720
s_waitcnt lgkmcnt(0)
v_mfma_f32_16x16x32_bf16 v[118:121], v[182:185], a[72:75], 0
v_mfma_f32_16x16x32_bf16 v[126:129], v[182:185], a[96:99], 0
v_mfma_f32_16x16x32_bf16 v[134:137], v[182:185], a[120:123], 0
v_mfma_f32_16x16x32_bf16 v[90:93], a[216:219], v[182:185], 0
v_mfma_f32_16x16x32_bf16 v[170:173], a[240:243], v[182:185], 0
v_mfma_f32_16x16x32_bf16 v[220:223], v[232:235], v[182:185], 0
ds_read_b128 v[186:189], v210 offset:31744
s_waitcnt lgkmcnt(0)
v_mfma_f32_16x16x32_bf16 v[118:121], v[186:189], a[76:79], v[118:121]
v_mfma_f32_16x16x32_bf16 v[126:129], v[186:189], a[100:103], v[126:129]
v_mfma_f32_16x16x32_bf16 v[134:137], v[186:189], a[124:127], v[134:137]
v_mfma_f32_16x16x32_bf16 v[90:93], a[220:223], v[186:189], v[90:93]
v_mfma_f32_16x16x32_bf16 v[170:173], a[244:247], v[186:189], v[170:173]
v_mfma_f32_16x16x32_bf16 v[220:223], v[236:239], v[186:189], v[220:223]
ds_read_b128 v[182:185], v210 offset:32768
s_waitcnt lgkmcnt(0)
v_mfma_f32_16x16x32_bf16 v[118:121], v[182:185], a[80:83], v[118:121]
v_mfma_f32_16x16x32_bf16 v[126:129], v[182:185], a[104:107], v[126:129]
v_mfma_f32_16x16x32_bf16 v[134:137], v[182:185], a[128:131], v[134:137]
v_mfma_f32_16x16x32_bf16 v[90:93], a[224:227], v[182:185], v[90:93]
v_mfma_f32_16x16x32_bf16 v[170:173], a[248:251], v[182:185], v[170:173]
v_mfma_f32_16x16x32_bf16 v[220:223], v[240:243], v[182:185], v[220:223]
ds_read_b128 v[186:189], v210 offset:33792
s_waitcnt lgkmcnt(0)
v_mfma_f32_16x16x32_bf16 v[118:121], v[186:189], a[84:87], v[118:121]
v_mfma_f32_16x16x32_bf16 v[126:129], v[186:189], a[108:111], v[126:129]
v_mfma_f32_16x16x32_bf16 v[134:137], v[186:189], a[132:135], v[134:137]
v_mfma_f32_16x16x32_bf16 v[90:93], a[228:231], v[186:189], v[90:93]
v_mfma_f32_16x16x32_bf16 v[170:173], a[252:255], v[186:189], v[170:173]
v_mfma_f32_16x16x32_bf16 v[220:223], v[244:247], v[186:189], v[220:223]
ds_read_b128 v[182:185], v210 offset:34816
s_waitcnt lgkmcnt(0)
v_mfma_f32_16x16x32_bf16 v[118:121], v[182:185], a[88:91], v[118:121]
v_mfma_f32_16x16x32_bf16 v[126:129], v[182:185], a[112:115], v[126:129]
v_mfma_f32_16x16x32_bf16 v[134:137], v[182:185], a[136:139], v[134:137]
v_mfma_f32_16x16x32_bf16 v[90:93], a[232:235], v[182:185], v[90:93]
v_mfma_f32_16x16x32_bf16 v[170:173], v[224:227], v[182:185], v[170:173]
v_mfma_f32_16x16x32_bf16 v[220:223], v[248:251], v[182:185], v[220:223]
ds_read_b128 v[186:189], v210 offset:35840
s_waitcnt lgkmcnt(0)
v_mfma_f32_16x16x32_bf16 v[118:121], v[186:189], a[92:95], v[118:121]
v_mfma_f32_16x16x32_bf16 v[126:129], v[186:189], a[116:119], v[126:129]
v_mfma_f32_16x16x32_bf16 v[134:137], v[186:189], a[140:143], v[134:137]
v_mfma_f32_16x16x32_bf16 v[90:93], a[236:239], v[186:189], v[90:93]
v_mfma_f32_16x16x32_bf16 v[170:173], v[228:231], v[186:189], v[170:173]
v_mfma_f32_16x16x32_bf16 v[220:223], v[252:255], v[186:189], v[220:223]
v_cvt_pk_bf16_f32 v118, v118, v119
v_cvt_pk_bf16_f32 v119, v120, v121
ds_read_u16 v120, v214 offset:1024
v_mov_b32 v121, 0
v_cvt_pk_bf16_f32 v126, v126, v127
v_cvt_pk_bf16_f32 v127, v128, v129
ds_read_u16 v128, v214 offset:1032
v_mov_b32 v129, 0
v_cvt_pk_bf16_f32 v134, v134, v135
v_cvt_pk_bf16_f32 v135, v136, v137
ds_read_u16 v136, v214 offset:1040
v_mov_b32 v137, 0
v_cvt_pk_bf16_f32 v90, v90, v91
v_cvt_pk_bf16_f32 v91, v92, v93
v_cvt_pk_bf16_f32 v92, v170, v171
v_cvt_pk_bf16_f32 v93, v172, v173
v_cvt_pk_bf16_f32 v94, v220, v221
v_cvt_pk_bf16_f32 v95, v222, v223
v_max3_f32 v151, v138, v139, v140
v_max3_f32 v151, v151, v141, v142
v_max3_f32 v151, v151, v143, v144
v_max3_f32 v151, v151, v145, v146
v_max3_f32 v151, v151, v147, v148
v_max3_f32 v151, v151, v149, v150
v_mov_b32 v152, v151
s_nop 1
v_permlane16_swap_b32 v151, v152
v_max_f32 v151, v151, v152
v_mov_b32 v152, v151
s_nop 1
v_permlane32_swap_b32 v151, v152
v_max_f32 v151, v151, v152
v_sub_f32 v138, v138, v151
v_sub_f32 v139, v139, v151
v_sub_f32 v140, v140, v151
v_sub_f32 v141, v141, v151
v_sub_f32 v142, v142, v151
v_sub_f32 v143, v143, v151
v_sub_f32 v144, v144, v151
v_sub_f32 v145, v145, v151
v_sub_f32 v150, v150, v151
v_sub_f32 v146, v146, v151
v_sub_f32 v147, v147, v151
v_sub_f32 v148, v148, v151
v_sub_f32 v149, v149, v151
v_exp_f32 v138, v138
v_exp_f32 v139, v139
v_exp_f32 v140, v140
v_exp_f32 v141, v141
v_exp_f32 v142, v142
v_exp_f32 v143, v143
v_exp_f32 v144, v144
v_exp_f32 v145, v145
v_exp_f32 v150, v150
v_exp_f32 v146, v146
v_exp_f32 v147, v147
v_exp_f32 v148, v148
v_exp_f32 v149, v149
v_cvt_pk_bf16_f32 v174, v138, v139
v_cvt_pk_bf16_f32 v175, v140, v141
v_cvt_pk_bf16_f32 v176, v142, v143
v_cvt_pk_bf16_f32 v177, v144, v145
v_cvt_pk_bf16_f32 v178, v146, v147
v_cvt_pk_bf16_f32 v179, v148, v149
v_cvt_pk_bf16_f32 v180, v150, 0
v_mfma_f32_16x16x32_bf16 v[150:153], v[190:193], v[174:177], 0
v_mfma_f32_16x16x32_bf16 v[138:141], v[114:117], v[174:177], 0
v_mfma_f32_16x16x32_bf16 v[142:145], v[122:125], v[174:177], 0
v_mfma_f32_16x16x32_bf16 v[146:149], v[130:133], v[174:177], 0
v_mfma_f32_16x16x32_bf16 v[150:153], v[190:193], v[178:181], v[150:153]
s_waitcnt lgkmcnt(2)
v_mfma_f32_16x16x32_bf16 v[138:141], v[118:121], v[178:181], v[138:141]
s_waitcnt lgkmcnt(1)
v_mfma_f32_16x16x32_bf16 v[142:145], v[126:129], v[178:181], v[142:145]
s_waitcnt lgkmcnt(0)
v_mfma_f32_16x16x32_bf16 v[146:149], v[134:137], v[178:181], v[146:149]
v_max3_f32 v167, v154, v155, v156
v_max3_f32 v167, v167, v157, v158
v_max3_f32 v167, v167, v159, v160
v_max3_f32 v167, v167, v161, v162
v_max3_f32 v167, v167, v163, v164
v_max3_f32 v167, v167, v165, v166
v_mov_b32 v168, v167
s_nop 1
v_permlane16_swap_b32 v167, v168
v_max_f32 v167, v167, v168
v_mov_b32 v168, v167
s_nop 1
v_permlane32_swap_b32 v167, v168
v_max_f32 v167, v167, v168
v_sub_f32 v154, v154, v167
v_sub_f32 v155, v155, v167
v_sub_f32 v156, v156, v167
v_sub_f32 v157, v157, v167
v_sub_f32 v158, v158, v167
v_sub_f32 v159, v159, v167
v_sub_f32 v160, v160, v167
v_sub_f32 v161, v161, v167
v_sub_f32 v166, v166, v167
v_sub_f32 v162, v162, v167
v_sub_f32 v163, v163, v167
v_sub_f32 v164, v164, v167
v_sub_f32 v165, v165, v167
v_exp_f32 v154, v154
v_exp_f32 v155, v155
v_exp_f32 v156, v156
v_exp_f32 v157, v157
v_exp_f32 v158, v158
v_exp_f32 v159, v159
v_exp_f32 v160, v160
v_exp_f32 v161, v161
v_exp_f32 v166, v166
v_exp_f32 v162, v162
v_exp_f32 v163, v163
v_exp_f32 v164, v164
v_exp_f32 v165, v165
v_cvt_pk_bf16_f32 v174, v154, v155
v_cvt_pk_bf16_f32 v175, v156, v157
v_cvt_pk_bf16_f32 v176, v158, v159
v_cvt_pk_bf16_f32 v177, v160, v161
v_cvt_pk_bf16_f32 v178, v162, v163
v_cvt_pk_bf16_f32 v179, v164, v165
v_cvt_pk_bf16_f32 v180, v166, 0
v_mfma_f32_16x16x32_bf16 v[166:169], v[190:193], v[174:177], 0
v_mfma_f32_16x16x32_bf16 v[154:157], v[114:117], v[174:177], 0
v_mfma_f32_16x16x32_bf16 v[158:161], v[122:125], v[174:177], 0
v_mfma_f32_16x16x32_bf16 v[162:165], v[130:133], v[174:177], 0
v_mfma_f32_16x16x32_bf16 v[166:169], v[190:193], v[178:181], v[166:169]
v_mfma_f32_16x16x32_bf16 v[154:157], v[118:121], v[178:181], v[154:157]
v_mfma_f32_16x16x32_bf16 v[158:161], v[126:129], v[178:181], v[158:161]
v_mfma_f32_16x16x32_bf16 v[162:165], v[134:137], v[178:181], v[162:165]
v_rcp_f32 v151, v150
s_nop 0
v_mul_f32 v151, s3, v151
v_mul_f32 v138, v138, v151
v_mul_f32 v139, v139, v151
v_cvt_pk_bf16_f32 v138, v138, v139
v_mul_f32 v140, v140, v151
v_mul_f32 v141, v141, v151
v_cvt_pk_bf16_f32 v139, v140, v141
v_mul_f32 v142, v142, v151
v_mul_f32 v143, v143, v151
v_cvt_pk_bf16_f32 v140, v142, v143
v_mul_f32 v144, v144, v151
v_mul_f32 v145, v145, v151
v_cvt_pk_bf16_f32 v141, v144, v145
ds_write_b128 v211, v[138:141] offset:36864
v_mul_f32 v146, v146, v151
v_mul_f32 v147, v147, v151
v_cvt_pk_bf16_f32 v142, v146, v147
v_mul_f32 v148, v148, v151
v_mul_f32 v149, v149, v151
v_cvt_pk_bf16_f32 v143, v148, v149
ds_write_b64 v212, v[142:143] offset:36864
v_mfma_f32_16x16x32_bf16 v[138:141], v[78:81], v[90:93], 0
v_mfma_f32_16x16x32_bf16 v[142:145], v[96:99], v[90:93], 0
v_mfma_f32_16x16x32_bf16 v[150:153], v[108:111], v[90:93], v[206:209]
v_mfma_f32_16x16x32_bf16 v[146:149], v[102:105], v[90:93], 0
v_mfma_f32_16x16x16_bf16 v[138:141], v[82:83], v[94:95], v[138:141]
v_mfma_f32_16x16x16_bf16 v[142:145], v[100:101], v[94:95], v[142:145]
v_mfma_f32_16x16x16_bf16 v[150:153], v[112:113], v[94:95], v[150:153]
v_mfma_f32_16x16x16_bf16 v[146:149], v[106:107], v[94:95], v[146:149]
v_rcp_f32 v167, v166
s_nop 0
v_mul_f32 v167, s3, v167
v_mul_f32 v154, v154, v167
v_mul_f32 v155, v155, v167
v_cvt_pk_bf16_f32 v154, v154, v155
v_mul_f32 v156, v156, v167
v_mul_f32 v157, v157, v167
v_cvt_pk_bf16_f32 v155, v156, v157
v_mul_f32 v158, v158, v167
v_mul_f32 v159, v159, v167
v_cvt_pk_bf16_f32 v156, v158, v159
v_mul_f32 v160, v160, v167
v_mul_f32 v161, v161, v167
v_cvt_pk_bf16_f32 v157, v160, v161
ds_write_b128 v211, v[154:157] offset:43008
v_mul_f32 v162, v162, v167
v_mul_f32 v163, v163, v167
v_cvt_pk_bf16_f32 v158, v162, v163
v_mul_f32 v164, v164, v167
v_mul_f32 v165, v165, v167
v_cvt_pk_bf16_f32 v159, v164, v165
ds_write_b64 v212, v[158:159] offset:43008
v_mfma_f32_16x16x16_bf16 v[154:157], v[76:77], v[82:83], 0
v_mfma_f32_16x16x16_bf16 v[158:161], v[76:77], v[100:101], 0
v_mfma_f32_16x16x16_bf16 v[162:165], v[76:77], v[106:107], 0
v_mfma_f32_16x16x16_bf16 v[166:169], v[76:77], v[112:113], v[206:209]
v_mfma_f32_16x16x32_bf16 v[154:157], v[72:75], v[78:81], v[154:157]
v_mfma_f32_16x16x32_bf16 v[158:161], v[72:75], v[96:99], v[158:161]
v_mfma_f32_16x16x32_bf16 v[162:165], v[72:75], v[102:105], v[162:165]
v_mfma_f32_16x16x32_bf16 v[166:169], v[72:75], v[108:111], v[166:169]
v_mov_b32_dpp v154, v158 quad_perm:[0,1,2,3] row_mask:0x2 bank_mask:0xf
s_nop 1
v_mov_b32_dpp v154, v162 quad_perm:[0,1,2,3] row_mask:0x4 bank_mask:0xf
s_nop 2
v_mov_b32_dpp v154, v167 quad_perm:[0,1,2,3] row_mask:0x8 bank_mask:0xf
v_mov_b32 v155, v154
s_nop 1
v_max_f32_dpp v155, v155, v155 row_ror:8 row_mask:0xf bank_mask:0xf
s_nop 1
v_max_f32_dpp v155, v155, v155 row_ror:4 row_mask:0xf bank_mask:0xf
s_nop 1
v_max_f32_dpp v155, v155, v155 row_ror:2 row_mask:0xf bank_mask:0xf
s_nop 1
v_max_f32_dpp v155, v155, v155 row_ror:1 row_mask:0xf bank_mask:0xf
v_mov_b32 v156, v155
s_nop 1
v_permlane16_swap_b32 v155, v156
v_max_f32 v155, v155, v156
v_mov_b32 v156, v155
s_nop 1
v_permlane32_swap_b32 v155, v156
v_max_f32 v155, v155, v156
v_sub_f32 v154, v154, v155
v_exp_f32 v154, v154
s_nop 0
v_cvt_pk_bf16_f32 v154, v154, 0
ds_write_b16 v214, v154
s_waitcnt lgkmcnt(1)
ds_read_b128 v[84:87], v215
ds_read_b128 v[88:91], v215 offset:16
v_add_u32 v215, 1552, v215
s_barrier
ds_read_b128 v[170:173], v210 offset:36864
s_waitcnt lgkmcnt(0)
v_mfma_f32_16x16x32_bf16 v[36:39], a[144:147], v[170:173], v[36:39]
v_mfma_f32_16x16x32_bf16 v[40:43], a[168:171], v[170:173], v[40:43]
v_mfma_f32_16x16x32_bf16 v[44:47], a[192:195], v[170:173], v[44:47]
ds_read_b128 v[182:185], v210 offset:37888
s_waitcnt lgkmcnt(0)
v_mfma_f32_16x16x32_bf16 v[36:39], a[148:151], v[182:185], v[36:39]
v_mfma_f32_16x16x32_bf16 v[40:43], a[172:175], v[182:185], v[40:43]
v_mfma_f32_16x16x32_bf16 v[44:47], a[196:199], v[182:185], v[44:47]
ds_read_b128 v[186:189], v210 offset:38912
s_waitcnt lgkmcnt(0)
v_mfma_f32_16x16x32_bf16 v[36:39], a[152:155], v[186:189], v[36:39]
v_mfma_f32_16x16x32_bf16 v[40:43], a[176:179], v[186:189], v[40:43]
v_mfma_f32_16x16x32_bf16 v[44:47], a[200:203], v[186:189], v[44:47]
ds_read_b128 v[170:173], v210 offset:39936
s_waitcnt lgkmcnt(0)
v_mfma_f32_16x16x32_bf16 v[36:39], a[156:159], v[170:173], v[36:39]
v_mfma_f32_16x16x32_bf16 v[40:43], a[180:183], v[170:173], v[40:43]
v_mfma_f32_16x16x32_bf16 v[44:47], a[204:207], v[170:173], v[44:47]
ds_read_b128 v[182:185], v210 offset:40960
s_waitcnt lgkmcnt(0)
v_mfma_f32_16x16x32_bf16 v[36:39], a[160:163], v[182:185], v[36:39]
v_mfma_f32_16x16x32_bf16 v[40:43], a[184:187], v[182:185], v[40:43]
v_mfma_f32_16x16x32_bf16 v[44:47], a[208:211], v[182:185], v[44:47]
ds_read_b128 v[186:189], v210 offset:41984
s_waitcnt lgkmcnt(0)
v_mfma_f32_16x16x32_bf16 v[36:39], a[164:167], v[186:189], v[36:39]
v_mfma_f32_16x16x32_bf16 v[40:43], a[188:191], v[186:189], v[40:43]
v_mfma_f32_16x16x32_bf16 v[44:47], a[212:215], v[186:189], v[44:47]
v_cvt_pk_bf16_f32 v72, v36, v37
v_cvt_pk_bf16_f32 v73, v38, v39
buffer_store_dwordx2 v[72:73], v203, s[8:11], s39 offen
v_cvt_pk_bf16_f32 v74, v40, v41
v_cvt_pk_bf16_f32 v75, v42, v43
buffer_store_dwordx2 v[74:75], v203, s[8:11], s39 offen offset:32
s_nop 0
v_cvt_pk_bf16_f32 v76, v44, v45
v_cvt_pk_bf16_f32 v77, v46, v47
buffer_store_dwordx2 v[76:77], v203, s[8:11], s39 offen offset:64
v_max3_f32 v151, v138, v139, v140
v_max3_f32 v151, v151, v141, v142
v_max3_f32 v151, v151, v143, v144
v_max3_f32 v151, v151, v145, v146
v_max3_f32 v151, v151, v147, v148
v_max3_f32 v151, v151, v149, v150
v_mov_b32 v152, v151
s_nop 1
v_permlane16_swap_b32 v151, v152
v_max_f32 v151, v151, v152
v_mov_b32 v152, v151
s_nop 1
v_permlane32_swap_b32 v151, v152
v_max_f32 v151, v151, v152
v_sub_f32 v138, v138, v151
v_sub_f32 v139, v139, v151
v_sub_f32 v140, v140, v151
v_sub_f32 v141, v141, v151
v_sub_f32 v142, v142, v151
v_sub_f32 v143, v143, v151
v_sub_f32 v144, v144, v151
v_sub_f32 v145, v145, v151
v_sub_f32 v150, v150, v151
v_sub_f32 v146, v146, v151
v_sub_f32 v147, v147, v151
v_sub_f32 v148, v148, v151
v_sub_f32 v149, v149, v151
v_exp_f32 v138, v138
v_exp_f32 v139, v139
v_exp_f32 v140, v140
v_exp_f32 v141, v141
v_exp_f32 v142, v142
v_exp_f32 v143, v143
v_exp_f32 v144, v144
v_exp_f32 v145, v145
v_exp_f32 v150, v150
v_exp_f32 v146, v146
v_exp_f32 v147, v147
v_exp_f32 v148, v148
v_exp_f32 v149, v149
v_cvt_pk_bf16_f32 v174, v138, v139
v_cvt_pk_bf16_f32 v175, v140, v141
v_cvt_pk_bf16_f32 v176, v142, v143
v_cvt_pk_bf16_f32 v177, v144, v145
v_cvt_pk_bf16_f32 v178, v146, v147
v_cvt_pk_bf16_f32 v179, v148, v149
v_cvt_pk_bf16_f32 v180, v150, 0
v_mfma_f32_16x16x32_bf16 v[150:153], v[190:193], v[174:177], 0
v_mfma_f32_16x16x32_bf16 v[138:141], v[114:117], v[174:177], 0
v_mfma_f32_16x16x32_bf16 v[142:145], v[122:125], v[174:177], 0
v_mfma_f32_16x16x32_bf16 v[146:149], v[130:133], v[174:177], 0
v_mfma_f32_16x16x32_bf16 v[150:153], v[190:193], v[178:181], v[150:153]
v_mfma_f32_16x16x32_bf16 v[138:141], v[118:121], v[178:181], v[138:141]
v_mfma_f32_16x16x32_bf16 v[142:145], v[126:129], v[178:181], v[142:145]
v_mfma_f32_16x16x32_bf16 v[146:149], v[134:137], v[178:181], v[146:149]
v_mfma_f32_16x16x32_bf16 v[166:169], v[84:87], v[190:193], 0
v_mfma_f32_16x16x32_bf16 v[154:157], v[84:87], v[114:117], 0
v_mfma_f32_16x16x32_bf16 v[158:161], v[84:87], v[122:125], 0
v_mfma_f32_16x16x32_bf16 v[162:165], v[84:87], v[130:133], 0
v_mfma_f32_16x16x32_bf16 v[166:169], v[88:91], v[190:193], v[166:169]
v_mfma_f32_16x16x32_bf16 v[154:157], v[88:91], v[118:121], v[154:157]
v_mfma_f32_16x16x32_bf16 v[158:161], v[88:91], v[126:129], v[158:161]
v_mfma_f32_16x16x32_bf16 v[162:165], v[88:91], v[134:137], v[162:165]
v_rcp_f32 v167, v166
s_nop 1
v_mov_b32_dpp v154, v158 quad_perm:[0,1,2,3] row_mask:0x2 bank_mask:0xf
s_nop 2
v_mov_b32_dpp v154, v162 quad_perm:[0,1,2,3] row_mask:0x4 bank_mask:0xf
v_mul_f32 v167, s3, v167
v_mul_f32 v154, v154, v167
v_cvt_pk_bf16_f32 v154, v154, 0
ds_write_b16 v214, v154
v_add_u32 v214, 1552, v214
ds_read_b128 v[170:173], v210 offset:43008
s_waitcnt lgkmcnt(0)
v_mfma_f32_16x16x32_bf16 v[48:51], a[144:147], v[170:173], v[48:51]
v_mfma_f32_16x16x32_bf16 v[52:55], a[168:171], v[170:173], v[52:55]
v_mfma_f32_16x16x32_bf16 v[56:59], a[192:195], v[170:173], v[56:59]
ds_read_b128 v[182:185], v210 offset:44032
s_waitcnt lgkmcnt(0)
v_mfma_f32_16x16x32_bf16 v[48:51], a[148:151], v[182:185], v[48:51]
v_mfma_f32_16x16x32_bf16 v[52:55], a[172:175], v[182:185], v[52:55]
v_mfma_f32_16x16x32_bf16 v[56:59], a[196:199], v[182:185], v[56:59]
ds_read_b128 v[186:189], v210 offset:45056
s_waitcnt lgkmcnt(0)
v_mfma_f32_16x16x32_bf16 v[48:51], a[152:155], v[186:189], v[48:51]
v_mfma_f32_16x16x32_bf16 v[52:55], a[176:179], v[186:189], v[52:55]
v_mfma_f32_16x16x32_bf16 v[56:59], a[200:203], v[186:189], v[56:59]
ds_read_b128 v[170:173], v210 offset:46080
s_waitcnt lgkmcnt(0)
v_mfma_f32_16x16x32_bf16 v[48:51], a[156:159], v[170:173], v[48:51]
v_mfma_f32_16x16x32_bf16 v[52:55], a[180:183], v[170:173], v[52:55]
v_mfma_f32_16x16x32_bf16 v[56:59], a[204:207], v[170:173], v[56:59]
ds_read_b128 v[182:185], v210 offset:47104
s_waitcnt lgkmcnt(0)
v_mfma_f32_16x16x32_bf16 v[48:51], a[160:163], v[182:185], v[48:51]
v_mfma_f32_16x16x32_bf16 v[52:55], a[184:187], v[182:185], v[52:55]
v_mfma_f32_16x16x32_bf16 v[56:59], a[208:211], v[182:185], v[56:59]
ds_read_b128 v[186:189], v210 offset:48128
s_waitcnt lgkmcnt(0)
v_mfma_f32_16x16x32_bf16 v[48:51], a[164:167], v[186:189], v[48:51]
v_mfma_f32_16x16x32_bf16 v[52:55], a[188:191], v[186:189], v[52:55]
v_mfma_f32_16x16x32_bf16 v[56:59], a[212:215], v[186:189], v[56:59]
v_cvt_pk_bf16_f32 v78, v48, v49
v_cvt_pk_bf16_f32 v79, v50, v51
buffer_store_dwordx2 v[78:79], v204, s[8:11], s39 offen
v_cvt_pk_bf16_f32 v80, v52, v53
v_cvt_pk_bf16_f32 v81, v54, v55
buffer_store_dwordx2 v[80:81], v204, s[8:11], s39 offen offset:32
s_nop 0
v_cvt_pk_bf16_f32 v82, v56, v57
v_cvt_pk_bf16_f32 v83, v58, v59
buffer_store_dwordx2 v[82:83], v204, s[8:11], s39 offen offset:64
v_rcp_f32 v151, v150
s_nop 0
v_mul_f32 v151, s3, v151
v_mul_f32 v138, v138, v151
v_mul_f32 v139, v139, v151
v_cvt_pk_bf16_f32 v138, v138, v139
v_mul_f32 v140, v140, v151
v_mul_f32 v141, v141, v151
v_cvt_pk_bf16_f32 v139, v140, v141
v_mul_f32 v142, v142, v151
v_mul_f32 v143, v143, v151
v_cvt_pk_bf16_f32 v140, v142, v143
v_mul_f32 v144, v144, v151
v_mul_f32 v145, v145, v151
v_cvt_pk_bf16_f32 v141, v144, v145
ds_write_b128 v211, v[138:141] offset:49152
v_mul_f32 v146, v146, v151
v_mul_f32 v147, v147, v151
v_cvt_pk_bf16_f32 v142, v146, v147
v_mul_f32 v148, v148, v151
v_mul_f32 v149, v149, v151
v_cvt_pk_bf16_f32 v143, v148, v149
ds_write_b64 v212, v[142:143] offset:49152
s_waitcnt lgkmcnt(0)
s_barrier
ds_read_b128 v[170:173], v210 offset:49152
s_waitcnt lgkmcnt(0)
v_mfma_f32_16x16x32_bf16 v[60:63], a[144:147], v[170:173], v[60:63]
v_mfma_f32_16x16x32_bf16 v[64:67], a[168:171], v[170:173], v[64:67]
v_mfma_f32_16x16x32_bf16 v[68:71], a[192:195], v[170:173], v[68:71]
ds_read_b128 v[182:185], v210 offset:50176
s_waitcnt lgkmcnt(0)
v_mfma_f32_16x16x32_bf16 v[60:63], a[148:151], v[182:185], v[60:63]
v_mfma_f32_16x16x32_bf16 v[64:67], a[172:175], v[182:185], v[64:67]
v_mfma_f32_16x16x32_bf16 v[68:71], a[196:199], v[182:185], v[68:71]
ds_read_b128 v[186:189], v210 offset:51200
s_waitcnt lgkmcnt(0)
v_mfma_f32_16x16x32_bf16 v[60:63], a[152:155], v[186:189], v[60:63]
v_mfma_f32_16x16x32_bf16 v[64:67], a[176:179], v[186:189], v[64:67]
v_mfma_f32_16x16x32_bf16 v[68:71], a[200:203], v[186:189], v[68:71]
ds_read_b128 v[170:173], v210 offset:52224
s_waitcnt lgkmcnt(0)
v_mfma_f32_16x16x32_bf16 v[60:63], a[156:159], v[170:173], v[60:63]
v_mfma_f32_16x16x32_bf16 v[64:67], a[180:183], v[170:173], v[64:67]
v_mfma_f32_16x16x32_bf16 v[68:71], a[204:207], v[170:173], v[68:71]
ds_read_b128 v[182:185], v210 offset:53248
s_waitcnt lgkmcnt(0)
v_mfma_f32_16x16x32_bf16 v[60:63], a[160:163], v[182:185], v[60:63]
v_mfma_f32_16x16x32_bf16 v[64:67], a[184:187], v[182:185], v[64:67]
v_mfma_f32_16x16x32_bf16 v[68:71], a[208:211], v[182:185], v[68:71]
ds_read_b128 v[186:189], v210 offset:54272
s_waitcnt lgkmcnt(0)
v_mfma_f32_16x16x32_bf16 v[60:63], a[164:167], v[186:189], v[60:63]
v_mfma_f32_16x16x32_bf16 v[64:67], a[188:191], v[186:189], v[64:67]
v_mfma_f32_16x16x32_bf16 v[68:71], a[212:215], v[186:189], v[68:71]
v_cvt_pk_bf16_f32 v116, v60, v61
v_cvt_pk_bf16_f32 v117, v62, v63
buffer_store_dwordx2 v[116:117], v205, s[8:11], s39 offen
v_cvt_pk_bf16_f32 v124, v64, v65
v_cvt_pk_bf16_f32 v125, v66, v67
buffer_store_dwordx2 v[124:125], v205, s[8:11], s39 offen offset:32
s_nop 0
v_cvt_pk_bf16_f32 v132, v68, v69
v_cvt_pk_bf16_f32 v133, v70, v71
buffer_store_dwordx2 v[132:133], v205, s[8:11], s39 offen offset:64
s_mov_b32 s38, s36
s_barrier
ds_read_b128 v[182:185], v210
s_waitcnt lgkmcnt(0)
v_mfma_f32_16x16x32_bf16 v[138:141], a[0:3], v[182:185], 0
v_mfma_f32_16x16x32_bf16 v[142:145], a[24:27], v[182:185], 0
v_mfma_f32_16x16x32_bf16 v[146:149], a[48:51], v[182:185], 0
v_mfma_f32_16x16x32_bf16 v[150:153], a[216:219], v[182:185], 0
v_mfma_f32_16x16x32_bf16 v[154:157], a[240:243], v[182:185], 0
v_mfma_f32_16x16x32_bf16 v[158:161], v[232:235], v[182:185], 0
v_mfma_f32_16x16x32_bf16 v[162:165], v[182:185], a[72:75], 0
v_mfma_f32_16x16x32_bf16 v[166:169], v[182:185], a[96:99], 0
v_mfma_f32_16x16x32_bf16 v[170:173], v[182:185], a[120:123], 0
ds_read_b128 v[186:189], v210 offset:1024
s_waitcnt lgkmcnt(0)
v_mfma_f32_16x16x32_bf16 v[138:141], a[4:7], v[186:189], v[138:141]
v_mfma_f32_16x16x32_bf16 v[142:145], a[28:31], v[186:189], v[142:145]
v_mfma_f32_16x16x32_bf16 v[146:149], a[52:55], v[186:189], v[146:149]
v_mfma_f32_16x16x32_bf16 v[150:153], a[220:223], v[186:189], v[150:153]
v_mfma_f32_16x16x32_bf16 v[154:157], a[244:247], v[186:189], v[154:157]
v_mfma_f32_16x16x32_bf16 v[158:161], v[236:239], v[186:189], v[158:161]
v_mfma_f32_16x16x32_bf16 v[162:165], v[186:189], a[76:79], v[162:165]
v_mfma_f32_16x16x32_bf16 v[166:169], v[186:189], a[100:103], v[166:169]
v_mfma_f32_16x16x32_bf16 v[170:173], v[186:189], a[124:127], v[170:173]
ds_read_b128 v[182:185], v210 offset:2048
s_waitcnt lgkmcnt(0)
v_mfma_f32_16x16x32_bf16 v[138:141], a[8:11], v[182:185], v[138:141]
v_mfma_f32_16x16x32_bf16 v[142:145], a[32:35], v[182:185], v[142:145]
v_mfma_f32_16x16x32_bf16 v[146:149], a[56:59], v[182:185], v[146:149]
v_mfma_f32_16x16x32_bf16 v[150:153], a[224:227], v[182:185], v[150:153]
v_mfma_f32_16x16x32_bf16 v[154:157], a[248:251], v[182:185], v[154:157]
v_mfma_f32_16x16x32_bf16 v[158:161], v[240:243], v[182:185], v[158:161]
v_mfma_f32_16x16x32_bf16 v[162:165], v[182:185], a[80:83], v[162:165]
v_mfma_f32_16x16x32_bf16 v[166:169], v[182:185], a[104:107], v[166:169]
v_mfma_f32_16x16x32_bf16 v[170:173], v[182:185], a[128:131], v[170:173]
ds_read_b128 v[186:189], v210 offset:3072
s_waitcnt lgkmcnt(0)
v_mfma_f32_16x16x32_bf16 v[138:141], a[12:15], v[186:189], v[138:141]
v_mfma_f32_16x16x32_bf16 v[142:145], a[36:39], v[186:189], v[142:145]
v_mfma_f32_16x16x32_bf16 v[146:149], a[60:63], v[186:189], v[146:149]
v_mfma_f32_16x16x32_bf16 v[150:153], a[228:231], v[186:189], v[150:153]
v_mfma_f32_16x16x32_bf16 v[154:157], a[252:255], v[186:189], v[154:157]
v_mfma_f32_16x16x32_bf16 v[158:161], v[244:247], v[186:189], v[158:161]
v_mfma_f32_16x16x32_bf16 v[162:165], v[186:189], a[84:87], v[162:165]
v_mfma_f32_16x16x32_bf16 v[166:169], v[186:189], a[108:111], v[166:169]
v_mfma_f32_16x16x32_bf16 v[170:173], v[186:189], a[132:135], v[170:173]
ds_read_b128 v[182:185], v210 offset:4096
s_waitcnt lgkmcnt(0)
v_mfma_f32_16x16x32_bf16 v[138:141], a[16:19], v[182:185], v[138:141]
v_mfma_f32_16x16x32_bf16 v[142:145], a[40:43], v[182:185], v[142:145]
v_mfma_f32_16x16x32_bf16 v[146:149], a[64:67], v[182:185], v[146:149]
v_mfma_f32_16x16x32_bf16 v[150:153], a[232:235], v[182:185], v[150:153]
v_mfma_f32_16x16x32_bf16 v[154:157], v[224:227], v[182:185], v[154:157]
v_mfma_f32_16x16x32_bf16 v[158:161], v[248:251], v[182:185], v[158:161]
v_mfma_f32_16x16x32_bf16 v[162:165], v[182:185], a[88:91], v[162:165]
v_mfma_f32_16x16x32_bf16 v[166:169], v[182:185], a[112:115], v[166:169]
v_mfma_f32_16x16x32_bf16 v[170:173], v[182:185], a[136:139], v[170:173]
ds_read_b128 v[186:189], v210 offset:5120
s_waitcnt lgkmcnt(0)
v_mfma_f32_16x16x32_bf16 v[138:141], a[20:23], v[186:189], v[138:141]
v_mfma_f32_16x16x32_bf16 v[142:145], a[44:47], v[186:189], v[142:145]
v_mfma_f32_16x16x32_bf16 v[146:149], a[68:71], v[186:189], v[146:149]
v_mfma_f32_16x16x32_bf16 v[150:153], a[236:239], v[186:189], v[150:153]
v_mfma_f32_16x16x32_bf16 v[154:157], v[228:231], v[186:189], v[154:157]
v_mfma_f32_16x16x32_bf16 v[158:161], v[252:255], v[186:189], v[158:161]
v_mfma_f32_16x16x32_bf16 v[162:165], v[186:189], a[92:95], v[162:165]
v_mfma_f32_16x16x32_bf16 v[166:169], v[186:189], a[116:119], v[166:169]
v_mfma_f32_16x16x32_bf16 v[170:173], v[186:189], a[140:143], v[170:173]
v_cvt_pk_bf16_f32 v78, v138, v139
v_cvt_pk_bf16_f32 v79, v140, v141
v_cvt_pk_bf16_f32 v80, v142, v143
v_cvt_pk_bf16_f32 v81, v144, v145
v_cvt_pk_bf16_f32 v82, v146, v147
v_cvt_pk_bf16_f32 v83, v148, v149
v_cvt_pk_bf16_f32 v72, v150, v151
v_cvt_pk_bf16_f32 v73, v152, v153
v_cvt_pk_bf16_f32 v74, v154, v155
v_cvt_pk_bf16_f32 v75, v156, v157
v_cvt_pk_bf16_f32 v76, v158, v159
v_cvt_pk_bf16_f32 v77, v160, v161
v_cvt_pk_bf16_f32 v114, v162, v163
v_cvt_pk_bf16_f32 v115, v164, v165
v_cvt_pk_bf16_f32 v122, v166, v167
v_cvt_pk_bf16_f32 v123, v168, v169
v_cvt_pk_bf16_f32 v130, v170, v171
v_cvt_pk_bf16_f32 v131, v172, v173
ds_read_b128 v[182:185], v210 offset:6144
s_waitcnt lgkmcnt(0)
v_mfma_f32_16x16x32_bf16 v[138:141], a[0:3], v[182:185], 0
v_mfma_f32_16x16x32_bf16 v[142:145], a[24:27], v[182:185], 0
v_mfma_f32_16x16x32_bf16 v[146:149], a[48:51], v[182:185], 0
v_mfma_f32_16x16x32_bf16 v[150:153], a[216:219], v[182:185], 0
v_mfma_f32_16x16x32_bf16 v[154:157], a[240:243], v[182:185], 0
v_mfma_f32_16x16x32_bf16 v[158:161], v[232:235], v[182:185], 0
v_mfma_f32_16x16x32_bf16 v[162:165], v[182:185], a[72:75], 0
v_mfma_f32_16x16x32_bf16 v[166:169], v[182:185], a[96:99], 0
v_mfma_f32_16x16x32_bf16 v[170:173], v[182:185], a[120:123], 0
ds_read_b128 v[186:189], v210 offset:7168
s_waitcnt lgkmcnt(0)
v_mfma_f32_16x16x32_bf16 v[138:141], a[4:7], v[186:189], v[138:141]
v_mfma_f32_16x16x32_bf16 v[142:145], a[28:31], v[186:189], v[142:145]
v_mfma_f32_16x16x32_bf16 v[146:149], a[52:55], v[186:189], v[146:149]
v_mfma_f32_16x16x32_bf16 v[150:153], a[220:223], v[186:189], v[150:153]
v_mfma_f32_16x16x32_bf16 v[154:157], a[244:247], v[186:189], v[154:157]
v_mfma_f32_16x16x32_bf16 v[158:161], v[236:239], v[186:189], v[158:161]
v_mfma_f32_16x16x32_bf16 v[162:165], v[186:189], a[76:79], v[162:165]
v_mfma_f32_16x16x32_bf16 v[166:169], v[186:189], a[100:103], v[166:169]
v_mfma_f32_16x16x32_bf16 v[170:173], v[186:189], a[124:127], v[170:173]
ds_read_b128 v[182:185], v210 offset:8192
s_waitcnt lgkmcnt(0)
v_mfma_f32_16x16x32_bf16 v[138:141], a[8:11], v[182:185], v[138:141]
v_mfma_f32_16x16x32_bf16 v[142:145], a[32:35], v[182:185], v[142:145]
v_mfma_f32_16x16x32_bf16 v[146:149], a[56:59], v[182:185], v[146:149]
v_mfma_f32_16x16x32_bf16 v[150:153], a[224:227], v[182:185], v[150:153]
v_mfma_f32_16x16x32_bf16 v[154:157], a[248:251], v[182:185], v[154:157]
v_mfma_f32_16x16x32_bf16 v[158:161], v[240:243], v[182:185], v[158:161]
v_mfma_f32_16x16x32_bf16 v[162:165], v[182:185], a[80:83], v[162:165]
v_mfma_f32_16x16x32_bf16 v[166:169], v[182:185], a[104:107], v[166:169]
v_mfma_f32_16x16x32_bf16 v[170:173], v[182:185], a[128:131], v[170:173]
ds_read_b128 v[186:189], v210 offset:9216
s_waitcnt lgkmcnt(0)
v_mfma_f32_16x16x32_bf16 v[138:141], a[12:15], v[186:189], v[138:141]
v_mfma_f32_16x16x32_bf16 v[142:145], a[36:39], v[186:189], v[142:145]
v_mfma_f32_16x16x32_bf16 v[146:149], a[60:63], v[186:189], v[146:149]
v_mfma_f32_16x16x32_bf16 v[150:153], a[228:231], v[186:189], v[150:153]
v_mfma_f32_16x16x32_bf16 v[154:157], a[252:255], v[186:189], v[154:157]
v_mfma_f32_16x16x32_bf16 v[158:161], v[244:247], v[186:189], v[158:161]
v_mfma_f32_16x16x32_bf16 v[162:165], v[186:189], a[84:87], v[162:165]
v_mfma_f32_16x16x32_bf16 v[166:169], v[186:189], a[108:111], v[166:169]
v_mfma_f32_16x16x32_bf16 v[170:173], v[186:189], a[132:135], v[170:173]
ds_read_b128 v[182:185], v210 offset:10240
s_waitcnt lgkmcnt(0)
v_mfma_f32_16x16x32_bf16 v[138:141], a[16:19], v[182:185], v[138:141]
v_mfma_f32_16x16x32_bf16 v[142:145], a[40:43], v[182:185], v[142:145]
v_mfma_f32_16x16x32_bf16 v[146:149], a[64:67], v[182:185], v[146:149]
v_mfma_f32_16x16x32_bf16 v[150:153], a[232:235], v[182:185], v[150:153]
v_mfma_f32_16x16x32_bf16 v[154:157], v[224:227], v[182:185], v[154:157]
v_mfma_f32_16x16x32_bf16 v[158:161], v[248:251], v[182:185], v[158:161]
v_mfma_f32_16x16x32_bf16 v[162:165], v[182:185], a[88:91], v[162:165]
v_mfma_f32_16x16x32_bf16 v[166:169], v[182:185], a[112:115], v[166:169]
v_mfma_f32_16x16x32_bf16 v[170:173], v[182:185], a[136:139], v[170:173]
ds_read_b128 v[186:189], v210 offset:11264
s_waitcnt lgkmcnt(0)
v_mfma_f32_16x16x32_bf16 v[138:141], a[20:23], v[186:189], v[138:141]
v_mfma_f32_16x16x32_bf16 v[142:145], a[44:47], v[186:189], v[142:145]
v_mfma_f32_16x16x32_bf16 v[146:149], a[68:71], v[186:189], v[146:149]
v_mfma_f32_16x16x32_bf16 v[150:153], a[236:239], v[186:189], v[150:153]
v_mfma_f32_16x16x32_bf16 v[154:157], v[228:231], v[186:189], v[154:157]
v_mfma_f32_16x16x32_bf16 v[158:161], v[252:255], v[186:189], v[158:161]
v_mfma_f32_16x16x32_bf16 v[162:165], v[186:189], a[92:95], v[162:165]
v_mfma_f32_16x16x32_bf16 v[166:169], v[186:189], a[116:119], v[166:169]
v_mfma_f32_16x16x32_bf16 v[170:173], v[186:189], a[140:143], v[170:173]
v_cvt_pk_bf16_f32 v96, v138, v139
v_cvt_pk_bf16_f32 v97, v140, v141
v_cvt_pk_bf16_f32 v98, v142, v143
v_cvt_pk_bf16_f32 v99, v144, v145
v_cvt_pk_bf16_f32 v100, v146, v147
v_cvt_pk_bf16_f32 v101, v148, v149
v_cvt_pk_bf16_f32 v84, v150, v151
v_cvt_pk_bf16_f32 v85, v152, v153
v_cvt_pk_bf16_f32 v86, v154, v155
v_cvt_pk_bf16_f32 v87, v156, v157
v_cvt_pk_bf16_f32 v88, v158, v159
v_cvt_pk_bf16_f32 v89, v160, v161
v_cvt_pk_bf16_f32 v116, v162, v163
v_cvt_pk_bf16_f32 v117, v164, v165
v_cvt_pk_bf16_f32 v124, v166, v167
v_cvt_pk_bf16_f32 v125, v168, v169
v_cvt_pk_bf16_f32 v132, v170, v171
v_cvt_pk_bf16_f32 v133, v172, v173
ds_read_b128 v[182:185], v210 offset:12288
s_waitcnt lgkmcnt(0)
v_mfma_f32_16x16x32_bf16 v[138:141], a[0:3], v[182:185], 0
v_mfma_f32_16x16x32_bf16 v[142:145], a[24:27], v[182:185], 0
v_mfma_f32_16x16x32_bf16 v[146:149], a[48:51], v[182:185], 0
ds_read_b128 v[186:189], v210 offset:13312
s_waitcnt lgkmcnt(0)
v_mfma_f32_16x16x32_bf16 v[138:141], a[4:7], v[186:189], v[138:141]
v_mfma_f32_16x16x32_bf16 v[142:145], a[28:31], v[186:189], v[142:145]
v_mfma_f32_16x16x32_bf16 v[146:149], a[52:55], v[186:189], v[146:149]
ds_read_b128 v[182:185], v210 offset:14336
s_waitcnt lgkmcnt(0)
v_mfma_f32_16x16x32_bf16 v[138:141], a[8:11], v[182:185], v[138:141]
v_mfma_f32_16x16x32_bf16 v[142:145], a[32:35], v[182:185], v[142:145]
v_mfma_f32_16x16x32_bf16 v[146:149], a[56:59], v[182:185], v[146:149]
ds_read_b128 v[186:189], v210 offset:15360
s_waitcnt lgkmcnt(0)
v_mfma_f32_16x16x32_bf16 v[138:141], a[12:15], v[186:189], v[138:141]
v_mfma_f32_16x16x32_bf16 v[142:145], a[36:39], v[186:189], v[142:145]
v_mfma_f32_16x16x32_bf16 v[146:149], a[60:63], v[186:189], v[146:149]
ds_read_b128 v[182:185], v210 offset:16384
s_waitcnt lgkmcnt(0)
v_mfma_f32_16x16x32_bf16 v[138:141], a[16:19], v[182:185], v[138:141]
v_mfma_f32_16x16x32_bf16 v[142:145], a[40:43], v[182:185], v[142:145]
v_mfma_f32_16x16x32_bf16 v[146:149], a[64:67], v[182:185], v[146:149]
ds_read_b128 v[186:189], v210 offset:17408
s_waitcnt lgkmcnt(0)
v_mfma_f32_16x16x32_bf16 v[138:141], a[20:23], v[186:189], v[138:141]
v_mfma_f32_16x16x32_bf16 v[142:145], a[44:47], v[186:189], v[142:145]
v_mfma_f32_16x16x32_bf16 v[146:149], a[68:71], v[186:189], v[146:149]
v_cvt_pk_bf16_f32 v102, v138, v139
v_cvt_pk_bf16_f32 v103, v140, v141
s_nop 0
v_cvt_pk_bf16_f32 v104, v142, v143
v_cvt_pk_bf16_f32 v105, v144, v145
s_nop 1
v_cvt_pk_bf16_f32 v106, v146, v147
v_cvt_pk_bf16_f32 v107, v148, v149
ds_read_b128 v[108:111], v215 offset:512
ds_read_b64 v[112:113], v215 offset:528
v_mov_b32 v181, 0
v_mfma_f32_16x16x16_bf16 v[138:141], v[82:83], v[76:77], 0
v_mfma_f32_16x16x16_bf16 v[142:145], v[100:101], v[76:77], 0
s_waitcnt lgkmcnt(0)
v_mfma_f32_16x16x16_bf16 v[150:153], v[112:113], v[76:77], v[206:209]
v_mfma_f32_16x16x16_bf16 v[146:149], v[106:107], v[76:77], 0
v_mfma_f32_16x16x32_bf16 v[138:141], v[78:81], v[72:75], v[138:141]
v_mfma_f32_16x16x32_bf16 v[142:145], v[96:99], v[72:75], v[142:145]
v_mfma_f32_16x16x32_bf16 v[150:153], v[108:111], v[72:75], v[150:153]
v_mfma_f32_16x16x32_bf16 v[146:149], v[102:105], v[72:75], v[146:149]
ds_read_b128 v[72:75], v215
ds_read_b64 v[76:77], v215 offset:16
v_mfma_f32_16x16x16_bf16 v[154:157], v[82:83], v[88:89], 0
v_mfma_f32_16x16x16_bf16 v[158:161], v[100:101], v[88:89], 0
v_mfma_f32_16x16x16_bf16 v[166:169], v[112:113], v[88:89], v[206:209]
v_mfma_f32_16x16x16_bf16 v[162:165], v[106:107], v[88:89], 0
v_mfma_f32_16x16x32_bf16 v[154:157], v[78:81], v[84:87], v[154:157]
v_mfma_f32_16x16x32_bf16 v[158:161], v[96:99], v[84:87], v[158:161]
v_mfma_f32_16x16x32_bf16 v[166:169], v[108:111], v[84:87], v[166:169]
v_mfma_f32_16x16x32_bf16 v[162:165], v[102:105], v[84:87], v[162:165]
ds_read_b128 v[182:185], v210 offset:12288
s_waitcnt lgkmcnt(0)
v_mfma_f32_16x16x32_bf16 v[118:121], v[182:185], a[72:75], 0
v_mfma_f32_16x16x32_bf16 v[126:129], v[182:185], a[96:99], 0
v_mfma_f32_16x16x32_bf16 v[134:137], v[182:185], a[120:123], 0
v_mfma_f32_16x16x32_bf16 v[90:93], a[216:219], v[182:185], 0
v_mfma_f32_16x16x32_bf16 v[170:173], a[240:243], v[182:185], 0
v_mfma_f32_16x16x32_bf16 v[220:223], v[232:235], v[182:185], 0
ds_read_b128 v[186:189], v210 offset:13312
s_waitcnt lgkmcnt(0)
v_mfma_f32_16x16x32_bf16 v[118:121], v[186:189], a[76:79], v[118:121]
v_mfma_f32_16x16x32_bf16 v[126:129], v[186:189], a[100:103], v[126:129]
v_mfma_f32_16x16x32_bf16 v[134:137], v[186:189], a[124:127], v[134:137]
v_mfma_f32_16x16x32_bf16 v[90:93], a[220:223], v[186:189], v[90:93]
v_mfma_f32_16x16x32_bf16 v[170:173], a[244:247], v[186:189], v[170:173]
v_mfma_f32_16x16x32_bf16 v[220:223], v[236:239], v[186:189], v[220:223]
ds_read_b128 v[182:185], v210 offset:14336
s_waitcnt lgkmcnt(0)
v_mfma_f32_16x16x32_bf16 v[118:121], v[182:185], a[80:83], v[118:121]
v_mfma_f32_16x16x32_bf16 v[126:129], v[182:185], a[104:107], v[126:129]
v_mfma_f32_16x16x32_bf16 v[134:137], v[182:185], a[128:131], v[134:137]
v_mfma_f32_16x16x32_bf16 v[90:93], a[224:227], v[182:185], v[90:93]
v_mfma_f32_16x16x32_bf16 v[170:173], a[248:251], v[182:185], v[170:173]
v_mfma_f32_16x16x32_bf16 v[220:223], v[240:243], v[182:185], v[220:223]
ds_read_b128 v[186:189], v210 offset:15360
s_waitcnt lgkmcnt(0)
v_mfma_f32_16x16x32_bf16 v[118:121], v[186:189], a[84:87], v[118:121]
v_mfma_f32_16x16x32_bf16 v[126:129], v[186:189], a[108:111], v[126:129]
v_mfma_f32_16x16x32_bf16 v[134:137], v[186:189], a[132:135], v[134:137]
v_mfma_f32_16x16x32_bf16 v[90:93], a[228:231], v[186:189], v[90:93]
v_mfma_f32_16x16x32_bf16 v[170:173], a[252:255], v[186:189], v[170:173]
v_mfma_f32_16x16x32_bf16 v[220:223], v[244:247], v[186:189], v[220:223]
ds_read_b128 v[182:185], v210 offset:16384
s_waitcnt lgkmcnt(0)
v_mfma_f32_16x16x32_bf16 v[118:121], v[182:185], a[88:91], v[118:121]
v_mfma_f32_16x16x32_bf16 v[126:129], v[182:185], a[112:115], v[126:129]
v_mfma_f32_16x16x32_bf16 v[134:137], v[182:185], a[136:139], v[134:137]
v_mfma_f32_16x16x32_bf16 v[90:93], a[232:235], v[182:185], v[90:93]
v_mfma_f32_16x16x32_bf16 v[170:173], v[224:227], v[182:185], v[170:173]
v_mfma_f32_16x16x32_bf16 v[220:223], v[248:251], v[182:185], v[220:223]
ds_read_b128 v[186:189], v210 offset:17408
s_waitcnt lgkmcnt(0)
v_mfma_f32_16x16x32_bf16 v[118:121], v[186:189], a[92:95], v[118:121]
v_mfma_f32_16x16x32_bf16 v[126:129], v[186:189], a[116:119], v[126:129]
v_mfma_f32_16x16x32_bf16 v[134:137], v[186:189], a[140:143], v[134:137]
v_mfma_f32_16x16x32_bf16 v[90:93], a[236:239], v[186:189], v[90:93]
v_mfma_f32_16x16x32_bf16 v[170:173], v[228:231], v[186:189], v[170:173]
v_mfma_f32_16x16x32_bf16 v[220:223], v[252:255], v[186:189], v[220:223]
v_cvt_pk_bf16_f32 v118, v118, v119
v_cvt_pk_bf16_f32 v119, v120, v121
ds_read_u16 v120, v214 offset:1024
v_mov_b32 v121, 0
v_cvt_pk_bf16_f32 v126, v126, v127
v_cvt_pk_bf16_f32 v127, v128, v129
ds_read_u16 v128, v214 offset:1032
v_mov_b32 v129, 0
v_cvt_pk_bf16_f32 v134, v134, v135
v_cvt_pk_bf16_f32 v135, v136, v137
ds_read_u16 v136, v214 offset:1040
v_mov_b32 v137, 0
v_cvt_pk_bf16_f32 v90, v90, v91
v_cvt_pk_bf16_f32 v91, v92, v93
v_cvt_pk_bf16_f32 v92, v170, v171
v_cvt_pk_bf16_f32 v93, v172, v173
v_cvt_pk_bf16_f32 v94, v220, v221
v_cvt_pk_bf16_f32 v95, v222, v223
v_max3_f32 v151, v138, v139, v140
v_max3_f32 v151, v151, v141, v142
v_max3_f32 v151, v151, v143, v144
v_max3_f32 v151, v151, v145, v146
v_max3_f32 v151, v151, v147, v148
v_max3_f32 v151, v151, v149, v150
v_mov_b32 v152, v151
s_nop 1
v_permlane16_swap_b32 v151, v152
v_max_f32 v151, v151, v152
v_mov_b32 v152, v151
s_nop 1
v_permlane32_swap_b32 v151, v152
v_max_f32 v151, v151, v152
v_sub_f32 v138, v138, v151
v_sub_f32 v139, v139, v151
v_sub_f32 v140, v140, v151
v_sub_f32 v141, v141, v151
v_sub_f32 v142, v142, v151
v_sub_f32 v143, v143, v151
v_sub_f32 v144, v144, v151
v_sub_f32 v145, v145, v151
v_sub_f32 v150, v150, v151
v_sub_f32 v146, v146, v151
v_sub_f32 v147, v147, v151
v_sub_f32 v148, v148, v151
v_sub_f32 v149, v149, v151
v_exp_f32 v138, v138
v_exp_f32 v139, v139
v_exp_f32 v140, v140
v_exp_f32 v141, v141
v_exp_f32 v142, v142
v_exp_f32 v143, v143
v_exp_f32 v144, v144
v_exp_f32 v145, v145
v_exp_f32 v150, v150
v_exp_f32 v146, v146
v_exp_f32 v147, v147
v_exp_f32 v148, v148
v_exp_f32 v149, v149
v_cvt_pk_bf16_f32 v174, v138, v139
v_cvt_pk_bf16_f32 v175, v140, v141
v_cvt_pk_bf16_f32 v176, v142, v143
v_cvt_pk_bf16_f32 v177, v144, v145
v_cvt_pk_bf16_f32 v178, v146, v147
v_cvt_pk_bf16_f32 v179, v148, v149
v_cvt_pk_bf16_f32 v180, v150, 0
v_mfma_f32_16x16x32_bf16 v[150:153], v[190:193], v[174:177], 0
v_mfma_f32_16x16x32_bf16 v[138:141], v[114:117], v[174:177], 0
v_mfma_f32_16x16x32_bf16 v[142:145], v[122:125], v[174:177], 0
v_mfma_f32_16x16x32_bf16 v[146:149], v[130:133], v[174:177], 0
v_mfma_f32_16x16x32_bf16 v[150:153], v[190:193], v[178:181], v[150:153]
s_waitcnt lgkmcnt(2)
v_mfma_f32_16x16x32_bf16 v[138:141], v[118:121], v[178:181], v[138:141]
s_waitcnt lgkmcnt(1)
v_mfma_f32_16x16x32_bf16 v[142:145], v[126:129], v[178:181], v[142:145]
s_waitcnt lgkmcnt(0)
v_mfma_f32_16x16x32_bf16 v[146:149], v[134:137], v[178:181], v[146:149]
v_max3_f32 v167, v154, v155, v156
v_max3_f32 v167, v167, v157, v158
v_max3_f32 v167, v167, v159, v160
v_max3_f32 v167, v167, v161, v162
v_max3_f32 v167, v167, v163, v164
v_max3_f32 v167, v167, v165, v166
v_mov_b32 v168, v167
s_nop 1
v_permlane16_swap_b32 v167, v168
v_max_f32 v167, v167, v168
v_mov_b32 v168, v167
s_nop 1
v_permlane32_swap_b32 v167, v168
v_max_f32 v167, v167, v168
v_sub_f32 v154, v154, v167
v_sub_f32 v155, v155, v167
v_sub_f32 v156, v156, v167
v_sub_f32 v157, v157, v167
v_sub_f32 v158, v158, v167
v_sub_f32 v159, v159, v167
v_sub_f32 v160, v160, v167
v_sub_f32 v161, v161, v167
v_sub_f32 v166, v166, v167
v_sub_f32 v162, v162, v167
v_sub_f32 v163, v163, v167
v_sub_f32 v164, v164, v167
v_sub_f32 v165, v165, v167
v_exp_f32 v154, v154
v_exp_f32 v155, v155
v_exp_f32 v156, v156
v_exp_f32 v157, v157
v_exp_f32 v158, v158
v_exp_f32 v159, v159
v_exp_f32 v160, v160
v_exp_f32 v161, v161
v_exp_f32 v166, v166
v_exp_f32 v162, v162
v_exp_f32 v163, v163
v_exp_f32 v164, v164
v_exp_f32 v165, v165
v_cvt_pk_bf16_f32 v174, v154, v155
v_cvt_pk_bf16_f32 v175, v156, v157
v_cvt_pk_bf16_f32 v176, v158, v159
v_cvt_pk_bf16_f32 v177, v160, v161
v_cvt_pk_bf16_f32 v178, v162, v163
v_cvt_pk_bf16_f32 v179, v164, v165
v_cvt_pk_bf16_f32 v180, v166, 0
v_mfma_f32_16x16x32_bf16 v[166:169], v[190:193], v[174:177], 0
v_mfma_f32_16x16x32_bf16 v[154:157], v[114:117], v[174:177], 0
v_mfma_f32_16x16x32_bf16 v[158:161], v[122:125], v[174:177], 0
v_mfma_f32_16x16x32_bf16 v[162:165], v[130:133], v[174:177], 0
v_mfma_f32_16x16x32_bf16 v[166:169], v[190:193], v[178:181], v[166:169]
v_mfma_f32_16x16x32_bf16 v[154:157], v[118:121], v[178:181], v[154:157]
v_mfma_f32_16x16x32_bf16 v[158:161], v[126:129], v[178:181], v[158:161]
v_mfma_f32_16x16x32_bf16 v[162:165], v[134:137], v[178:181], v[162:165]
v_rcp_f32 v151, v150
s_nop 0
v_mul_f32 v151, s3, v151
v_mul_f32 v138, v138, v151
v_mul_f32 v139, v139, v151
v_cvt_pk_bf16_f32 v138, v138, v139
v_mul_f32 v140, v140, v151
v_mul_f32 v141, v141, v151
v_cvt_pk_bf16_f32 v139, v140, v141
v_mul_f32 v142, v142, v151
v_mul_f32 v143, v143, v151
v_cvt_pk_bf16_f32 v140, v142, v143
v_mul_f32 v144, v144, v151
v_mul_f32 v145, v145, v151
v_cvt_pk_bf16_f32 v141, v144, v145
ds_write_b128 v211, v[138:141] offset:36864
v_mul_f32 v146, v146, v151
v_mul_f32 v147, v147, v151
v_cvt_pk_bf16_f32 v142, v146, v147
v_mul_f32 v148, v148, v151
v_mul_f32 v149, v149, v151
v_cvt_pk_bf16_f32 v143, v148, v149
ds_write_b64 v212, v[142:143] offset:36864
v_mfma_f32_16x16x32_bf16 v[138:141], v[78:81], v[90:93], 0
v_mfma_f32_16x16x32_bf16 v[142:145], v[96:99], v[90:93], 0
v_mfma_f32_16x16x32_bf16 v[150:153], v[108:111], v[90:93], v[206:209]
v_mfma_f32_16x16x32_bf16 v[146:149], v[102:105], v[90:93], 0
v_mfma_f32_16x16x16_bf16 v[138:141], v[82:83], v[94:95], v[138:141]
v_mfma_f32_16x16x16_bf16 v[142:145], v[100:101], v[94:95], v[142:145]
v_mfma_f32_16x16x16_bf16 v[150:153], v[112:113], v[94:95], v[150:153]
v_mfma_f32_16x16x16_bf16 v[146:149], v[106:107], v[94:95], v[146:149]
v_rcp_f32 v167, v166
s_nop 0
v_mul_f32 v167, s3, v167
v_mul_f32 v154, v154, v167
v_mul_f32 v155, v155, v167
v_cvt_pk_bf16_f32 v154, v154, v155
v_mul_f32 v156, v156, v167
v_mul_f32 v157, v157, v167
v_cvt_pk_bf16_f32 v155, v156, v157
v_mul_f32 v158, v158, v167
v_mul_f32 v159, v159, v167
v_cvt_pk_bf16_f32 v156, v158, v159
v_mul_f32 v160, v160, v167
v_mul_f32 v161, v161, v167
v_cvt_pk_bf16_f32 v157, v160, v161
ds_write_b128 v211, v[154:157] offset:43008
v_mul_f32 v162, v162, v167
v_mul_f32 v163, v163, v167
v_cvt_pk_bf16_f32 v158, v162, v163
v_mul_f32 v164, v164, v167
v_mul_f32 v165, v165, v167
v_cvt_pk_bf16_f32 v159, v164, v165
ds_write_b64 v212, v[158:159] offset:43008
v_mfma_f32_16x16x16_bf16 v[154:157], v[76:77], v[82:83], 0
v_mfma_f32_16x16x16_bf16 v[158:161], v[76:77], v[100:101], 0
v_mfma_f32_16x16x16_bf16 v[162:165], v[76:77], v[106:107], 0
v_mfma_f32_16x16x16_bf16 v[166:169], v[76:77], v[112:113], v[206:209]
v_mfma_f32_16x16x32_bf16 v[154:157], v[72:75], v[78:81], v[154:157]
v_mfma_f32_16x16x32_bf16 v[158:161], v[72:75], v[96:99], v[158:161]
v_mfma_f32_16x16x32_bf16 v[162:165], v[72:75], v[102:105], v[162:165]
v_mfma_f32_16x16x32_bf16 v[166:169], v[72:75], v[108:111], v[166:169]
v_mov_b32_dpp v154, v158 quad_perm:[0,1,2,3] row_mask:0x2 bank_mask:0xf
s_nop 1
v_mov_b32_dpp v154, v162 quad_perm:[0,1,2,3] row_mask:0x4 bank_mask:0xf
s_nop 2
v_mov_b32_dpp v154, v167 quad_perm:[0,1,2,3] row_mask:0x8 bank_mask:0xf
v_mov_b32 v155, v154
s_nop 1
v_max_f32_dpp v155, v155, v155 row_ror:8 row_mask:0xf bank_mask:0xf
s_nop 1
v_max_f32_dpp v155, v155, v155 row_ror:4 row_mask:0xf bank_mask:0xf
s_nop 1
v_max_f32_dpp v155, v155, v155 row_ror:2 row_mask:0xf bank_mask:0xf
s_nop 1
v_max_f32_dpp v155, v155, v155 row_ror:1 row_mask:0xf bank_mask:0xf
v_mov_b32 v156, v155
s_nop 1
v_permlane16_swap_b32 v155, v156
v_max_f32 v155, v155, v156
v_mov_b32 v156, v155
s_nop 1
v_permlane32_swap_b32 v155, v156
v_max_f32 v155, v155, v156
v_sub_f32 v154, v154, v155
v_exp_f32 v154, v154
s_nop 0
v_cvt_pk_bf16_f32 v154, v154, 0
ds_write_b16 v214, v154
s_waitcnt lgkmcnt(1)
ds_read_b128 v[84:87], v215
ds_read_b128 v[88:91], v215 offset:16
v_add_u32 v215, 1552, v215
s_barrier
ds_read_b128 v[170:173], v210 offset:36864
s_waitcnt lgkmcnt(0)
v_mfma_f32_16x16x32_bf16 v[0:3], a[144:147], v[170:173], v[0:3]
v_mfma_f32_16x16x32_bf16 v[4:7], a[168:171], v[170:173], v[4:7]
v_mfma_f32_16x16x32_bf16 v[8:11], a[192:195], v[170:173], v[8:11]
ds_read_b128 v[182:185], v210 offset:37888
s_waitcnt lgkmcnt(0)
v_mfma_f32_16x16x32_bf16 v[0:3], a[148:151], v[182:185], v[0:3]
v_mfma_f32_16x16x32_bf16 v[4:7], a[172:175], v[182:185], v[4:7]
v_mfma_f32_16x16x32_bf16 v[8:11], a[196:199], v[182:185], v[8:11]
ds_read_b128 v[186:189], v210 offset:38912
s_waitcnt lgkmcnt(0)
v_mfma_f32_16x16x32_bf16 v[0:3], a[152:155], v[186:189], v[0:3]
v_mfma_f32_16x16x32_bf16 v[4:7], a[176:179], v[186:189], v[4:7]
v_mfma_f32_16x16x32_bf16 v[8:11], a[200:203], v[186:189], v[8:11]
ds_read_b128 v[170:173], v210 offset:39936
s_waitcnt lgkmcnt(0)
v_mfma_f32_16x16x32_bf16 v[0:3], a[156:159], v[170:173], v[0:3]
v_mfma_f32_16x16x32_bf16 v[4:7], a[180:183], v[170:173], v[4:7]
v_mfma_f32_16x16x32_bf16 v[8:11], a[204:207], v[170:173], v[8:11]
ds_read_b128 v[182:185], v210 offset:40960
s_waitcnt lgkmcnt(0)
v_mfma_f32_16x16x32_bf16 v[0:3], a[160:163], v[182:185], v[0:3]
v_mfma_f32_16x16x32_bf16 v[4:7], a[184:187], v[182:185], v[4:7]
v_mfma_f32_16x16x32_bf16 v[8:11], a[208:211], v[182:185], v[8:11]
ds_read_b128 v[186:189], v210 offset:41984
s_waitcnt lgkmcnt(0)
v_mfma_f32_16x16x32_bf16 v[0:3], a[164:167], v[186:189], v[0:3]
v_mfma_f32_16x16x32_bf16 v[4:7], a[188:191], v[186:189], v[4:7]
v_mfma_f32_16x16x32_bf16 v[8:11], a[212:215], v[186:189], v[8:11]
v_cvt_pk_bf16_f32 v72, v0, v1
v_cvt_pk_bf16_f32 v73, v2, v3
buffer_store_dwordx2 v[72:73], v203, s[8:11], s38 offen
v_cvt_pk_bf16_f32 v74, v4, v5
v_cvt_pk_bf16_f32 v75, v6, v7
buffer_store_dwordx2 v[74:75], v203, s[8:11], s38 offen offset:32
s_nop 0
v_cvt_pk_bf16_f32 v76, v8, v9
v_cvt_pk_bf16_f32 v77, v10, v11
buffer_store_dwordx2 v[76:77], v203, s[8:11], s38 offen offset:64
v_max3_f32 v151, v138, v139, v140
v_max3_f32 v151, v151, v141, v142
v_max3_f32 v151, v151, v143, v144
v_max3_f32 v151, v151, v145, v146
v_max3_f32 v151, v151, v147, v148
v_max3_f32 v151, v151, v149, v150
v_mov_b32 v152, v151
s_nop 1
v_permlane16_swap_b32 v151, v152
v_max_f32 v151, v151, v152
v_mov_b32 v152, v151
s_nop 1
v_permlane32_swap_b32 v151, v152
v_max_f32 v151, v151, v152
v_sub_f32 v138, v138, v151
v_sub_f32 v139, v139, v151
v_sub_f32 v140, v140, v151
v_sub_f32 v141, v141, v151
v_sub_f32 v142, v142, v151
v_sub_f32 v143, v143, v151
v_sub_f32 v144, v144, v151
v_sub_f32 v145, v145, v151
v_sub_f32 v150, v150, v151
v_sub_f32 v146, v146, v151
v_sub_f32 v147, v147, v151
v_sub_f32 v148, v148, v151
v_sub_f32 v149, v149, v151
v_exp_f32 v138, v138
v_exp_f32 v139, v139
v_exp_f32 v140, v140
v_exp_f32 v141, v141
v_exp_f32 v142, v142
v_exp_f32 v143, v143
v_exp_f32 v144, v144
v_exp_f32 v145, v145
v_exp_f32 v150, v150
v_exp_f32 v146, v146
v_exp_f32 v147, v147
v_exp_f32 v148, v148
v_exp_f32 v149, v149
v_cvt_pk_bf16_f32 v174, v138, v139
v_cvt_pk_bf16_f32 v175, v140, v141
v_cvt_pk_bf16_f32 v176, v142, v143
v_cvt_pk_bf16_f32 v177, v144, v145
v_cvt_pk_bf16_f32 v178, v146, v147
v_cvt_pk_bf16_f32 v179, v148, v149
v_cvt_pk_bf16_f32 v180, v150, 0
v_mfma_f32_16x16x32_bf16 v[150:153], v[190:193], v[174:177], 0
v_mfma_f32_16x16x32_bf16 v[138:141], v[114:117], v[174:177], 0
v_mfma_f32_16x16x32_bf16 v[142:145], v[122:125], v[174:177], 0
v_mfma_f32_16x16x32_bf16 v[146:149], v[130:133], v[174:177], 0
v_mfma_f32_16x16x32_bf16 v[150:153], v[190:193], v[178:181], v[150:153]
v_mfma_f32_16x16x32_bf16 v[138:141], v[118:121], v[178:181], v[138:141]
v_mfma_f32_16x16x32_bf16 v[142:145], v[126:129], v[178:181], v[142:145]
v_mfma_f32_16x16x32_bf16 v[146:149], v[134:137], v[178:181], v[146:149]
v_mfma_f32_16x16x32_bf16 v[166:169], v[84:87], v[190:193], 0
v_mfma_f32_16x16x32_bf16 v[154:157], v[84:87], v[114:117], 0
v_mfma_f32_16x16x32_bf16 v[158:161], v[84:87], v[122:125], 0
v_mfma_f32_16x16x32_bf16 v[162:165], v[84:87], v[130:133], 0
v_mfma_f32_16x16x32_bf16 v[166:169], v[88:91], v[190:193], v[166:169]
v_mfma_f32_16x16x32_bf16 v[154:157], v[88:91], v[118:121], v[154:157]
v_mfma_f32_16x16x32_bf16 v[158:161], v[88:91], v[126:129], v[158:161]
v_mfma_f32_16x16x32_bf16 v[162:165], v[88:91], v[134:137], v[162:165]
v_rcp_f32 v167, v166
s_nop 1
v_mov_b32_dpp v154, v158 quad_perm:[0,1,2,3] row_mask:0x2 bank_mask:0xf
s_nop 2
v_mov_b32_dpp v154, v162 quad_perm:[0,1,2,3] row_mask:0x4 bank_mask:0xf
v_mul_f32 v167, s3, v167
v_mul_f32 v154, v154, v167
v_cvt_pk_bf16_f32 v154, v154, 0
ds_write_b16 v214, v154
v_add_u32 v214, 1552, v214
ds_read_b128 v[170:173], v210 offset:43008
s_waitcnt lgkmcnt(0)
v_mfma_f32_16x16x32_bf16 v[12:15], a[144:147], v[170:173], v[12:15]
v_mfma_f32_16x16x32_bf16 v[16:19], a[168:171], v[170:173], v[16:19]
v_mfma_f32_16x16x32_bf16 v[20:23], a[192:195], v[170:173], v[20:23]
ds_read_b128 v[182:185], v210 offset:44032
s_waitcnt lgkmcnt(0)
v_mfma_f32_16x16x32_bf16 v[12:15], a[148:151], v[182:185], v[12:15]
v_mfma_f32_16x16x32_bf16 v[16:19], a[172:175], v[182:185], v[16:19]
v_mfma_f32_16x16x32_bf16 v[20:23], a[196:199], v[182:185], v[20:23]
ds_read_b128 v[186:189], v210 offset:45056
s_waitcnt lgkmcnt(0)
v_mfma_f32_16x16x32_bf16 v[12:15], a[152:155], v[186:189], v[12:15]
v_mfma_f32_16x16x32_bf16 v[16:19], a[176:179], v[186:189], v[16:19]
v_mfma_f32_16x16x32_bf16 v[20:23], a[200:203], v[186:189], v[20:23]
ds_read_b128 v[170:173], v210 offset:46080
s_waitcnt lgkmcnt(0)
v_mfma_f32_16x16x32_bf16 v[12:15], a[156:159], v[170:173], v[12:15]
v_mfma_f32_16x16x32_bf16 v[16:19], a[180:183], v[170:173], v[16:19]
v_mfma_f32_16x16x32_bf16 v[20:23], a[204:207], v[170:173], v[20:23]
ds_read_b128 v[182:185], v210 offset:47104
s_waitcnt lgkmcnt(0)
v_mfma_f32_16x16x32_bf16 v[12:15], a[160:163], v[182:185], v[12:15]
v_mfma_f32_16x16x32_bf16 v[16:19], a[184:187], v[182:185], v[16:19]
v_mfma_f32_16x16x32_bf16 v[20:23], a[208:211], v[182:185], v[20:23]
ds_read_b128 v[186:189], v210 offset:48128
s_waitcnt lgkmcnt(0)
v_mfma_f32_16x16x32_bf16 v[12:15], a[164:167], v[186:189], v[12:15]
v_mfma_f32_16x16x32_bf16 v[16:19], a[188:191], v[186:189], v[16:19]
v_mfma_f32_16x16x32_bf16 v[20:23], a[212:215], v[186:189], v[20:23]
v_cvt_pk_bf16_f32 v78, v12, v13
v_cvt_pk_bf16_f32 v79, v14, v15
buffer_store_dwordx2 v[78:79], v204, s[8:11], s38 offen
v_cvt_pk_bf16_f32 v80, v16, v17
v_cvt_pk_bf16_f32 v81, v18, v19
buffer_store_dwordx2 v[80:81], v204, s[8:11], s38 offen offset:32
s_nop 0
v_cvt_pk_bf16_f32 v82, v20, v21
v_cvt_pk_bf16_f32 v83, v22, v23
buffer_store_dwordx2 v[82:83], v204, s[8:11], s38 offen offset:64
v_rcp_f32 v151, v150
s_nop 0
v_mul_f32 v151, s3, v151
v_mul_f32 v138, v138, v151
v_mul_f32 v139, v139, v151
v_cvt_pk_bf16_f32 v138, v138, v139
v_mul_f32 v140, v140, v151
v_mul_f32 v141, v141, v151
v_cvt_pk_bf16_f32 v139, v140, v141
v_mul_f32 v142, v142, v151
v_mul_f32 v143, v143, v151
v_cvt_pk_bf16_f32 v140, v142, v143
v_mul_f32 v144, v144, v151
v_mul_f32 v145, v145, v151
v_cvt_pk_bf16_f32 v141, v144, v145
ds_write_b128 v211, v[138:141] offset:49152
v_mul_f32 v146, v146, v151
v_mul_f32 v147, v147, v151
v_cvt_pk_bf16_f32 v142, v146, v147
v_mul_f32 v148, v148, v151
v_mul_f32 v149, v149, v151
v_cvt_pk_bf16_f32 v143, v148, v149
ds_write_b64 v212, v[142:143] offset:49152
s_waitcnt lgkmcnt(0)
s_barrier
ds_read_b128 v[170:173], v210 offset:49152
s_waitcnt lgkmcnt(0)
v_mfma_f32_16x16x32_bf16 v[24:27], a[144:147], v[170:173], v[24:27]
v_mfma_f32_16x16x32_bf16 v[28:31], a[168:171], v[170:173], v[28:31]
v_mfma_f32_16x16x32_bf16 v[32:35], a[192:195], v[170:173], v[32:35]
ds_read_b128 v[182:185], v210 offset:50176
s_waitcnt lgkmcnt(0)
v_mfma_f32_16x16x32_bf16 v[24:27], a[148:151], v[182:185], v[24:27]
v_mfma_f32_16x16x32_bf16 v[28:31], a[172:175], v[182:185], v[28:31]
v_mfma_f32_16x16x32_bf16 v[32:35], a[196:199], v[182:185], v[32:35]
ds_read_b128 v[186:189], v210 offset:51200
s_waitcnt lgkmcnt(0)
v_mfma_f32_16x16x32_bf16 v[24:27], a[152:155], v[186:189], v[24:27]
v_mfma_f32_16x16x32_bf16 v[28:31], a[176:179], v[186:189], v[28:31]
v_mfma_f32_16x16x32_bf16 v[32:35], a[200:203], v[186:189], v[32:35]
ds_read_b128 v[170:173], v210 offset:52224
s_waitcnt lgkmcnt(0)
v_mfma_f32_16x16x32_bf16 v[24:27], a[156:159], v[170:173], v[24:27]
v_mfma_f32_16x16x32_bf16 v[28:31], a[180:183], v[170:173], v[28:31]
v_mfma_f32_16x16x32_bf16 v[32:35], a[204:207], v[170:173], v[32:35]
ds_read_b128 v[182:185], v210 offset:53248
s_waitcnt lgkmcnt(0)
v_mfma_f32_16x16x32_bf16 v[24:27], a[160:163], v[182:185], v[24:27]
v_mfma_f32_16x16x32_bf16 v[28:31], a[184:187], v[182:185], v[28:31]
v_mfma_f32_16x16x32_bf16 v[32:35], a[208:211], v[182:185], v[32:35]
ds_read_b128 v[186:189], v210 offset:54272
s_waitcnt lgkmcnt(0)
v_mfma_f32_16x16x32_bf16 v[24:27], a[164:167], v[186:189], v[24:27]
v_mfma_f32_16x16x32_bf16 v[28:31], a[188:191], v[186:189], v[28:31]
v_mfma_f32_16x16x32_bf16 v[32:35], a[212:215], v[186:189], v[32:35]
v_cvt_pk_bf16_f32 v116, v24, v25
v_cvt_pk_bf16_f32 v117, v26, v27
buffer_store_dwordx2 v[116:117], v205, s[8:11], s38 offen
v_cvt_pk_bf16_f32 v124, v28, v29
v_cvt_pk_bf16_f32 v125, v30, v31
buffer_store_dwordx2 v[124:125], v205, s[8:11], s38 offen offset:32
s_nop 0
v_cvt_pk_bf16_f32 v132, v32, v33
v_cvt_pk_bf16_f32 v133, v34, v35
buffer_store_dwordx2 v[132:133], v205, s[8:11], s38 offen offset:64
s_branch L_epi
.p2align 6
.type L_tab,@object
L_tab:
.long 0x0,0x3800,0x5500,0x190,0x320,0x2020,0x5820,0x4b0,0x640,0x2340,0x4040,0x7d0,0x960,0x2660,0x6060,0xaf0
.long 0x1010,0x4810,0x6510,0x11a0,0x1330,0x3030,0x6830,0x14c0,0x1650,0x3350,0x5050,0x17e0,0x1970,0x3670,0x5370,0x1b00
.long 0x190,0x3990,0x5690,0x320,0x4b0,0x21b0,0x59b0,0x640,0x7d0,0x24d0,0x41d0,0x960,0x27f0,0x44f0,0x61f0,0x2980
.long 0x2980,0x4680,0x6380,0x2b10,0x11a0,0x49a0,0x66a0,0x1330,0x14c0,0x31c0,0x69c0,0x1650,0x17e0,0x34e0,0x51e0,0x1970
.long 0x320,0x3b20,0x5820,0x1010,0x640,0x2340,0x5b40,0x1330,0x960,0x2660,0x4360,0x1650,0xc80,0x2980,0x6380,0x1970
.long 0x1330,0x4b30,0x6830,0x2020,0x1650,0x3350,0x6b50,0x2340,0x1970,0x3670,0x5370,0x2660,0x1c90,0x3990,0x5690,0x2980
.long 0x4b0,0x3cb0,0x59b0,0x11a0,0x7d0,0x24d0,0x5cd0,0x14c0,0xaf0,0x27f0,0x44f0,0x17e0,0x2b10,0x4810,0x6510,0x3800
.long 0x2ca0,0x49a0,0x66a0,0x3990,0x14c0,0x4cc0,0x69c0,0x21b0,0x17e0,0x34e0,0x6ce0,0x24d0,0x1b00,0x3800,0x5500,0x27f0
.long 0x2020,0x5820,0x7520,0x1330,0x2340,0x4040,0x7840,0x1650,0x2660,0x4360,0x6060,0x1970,0x2980,0x4680,0x8080,0x1c90
.long 0x3030,0x6830,0x8530,0x2340,0x3350,0x5050,0x8850,0x2660,0x3670,0x5370,0x7070,0x2980,0x3990,0x5690,0x7390,0x2ca0
.long 0x21b0,0x59b0,0x76b0,0x14c0,0x24d0,0x41d0,0x79d0,0x17e0,0x27f0,0x44f0,0x61f0,0x1b00,0x4810,0x6510,0x8210,0x3b20
.long 0x49a0,0x66a0,0x83a0,0x3cb0,0x31c0,0x69c0,0x86c0,0x24d0,0x34e0,0x51e0,0x89e0,0x27f0,0x3800,0x5500,0x7200,0x2b10
.long 0x2340,0x5b40,0x7840,0x21b0,0x2660,0x4360,0x7b60,0x24d0,0x2980,0x4680,0x6380,0x27f0,0x2ca0,0x49a0,0x83a0,0x2b10
.long 0x3350,0x6b50,0x8850,0x31c0,0x3670,0x5370,0x8b70,0x34e0,0x3990,0x5690,0x7390,0x3800,0x3cb0,0x59b0,0x76b0,0x3b20
.long 0x24d0,0x5cd0,0x79d0,0x2340,0x27f0,0x44f0,0x7cf0,0x2660,0x2b10,0x4810,0x6510,0x2980,0x4b30,0x6830,0x8530,0x49a0
.long 0x4cc0,0x69c0,0x86c0,0x4b30,0x34e0,0x6ce0,0x89e0,0x3350,0x3800,0x5500,0x8d00,0x3670,0x3b20,0x5820,0x7520,0x3990
.long 0x3990,0x5690,0x11a0,0x49a0,0x21b0,0x59b0,0x14c0,0x31c0,0x24d0,0x41d0,0x17e0,0x34e0,0x27f0,0x61f0,0x1b00,0x3800
.long 0x49a0,0x66a0,0x21b0,0x59b0,0x31c0,0x69c0,0x24d0,0x41d0,0x34e0,0x51e0,0x27f0,0x44f0,0x3800,0x5500,0x2b10,0x4810
.long 0x3b20,0x5820,0x1330,0x4b30,0x2340,0x5b40,0x1650,0x3350,0x2660,0x4360,0x1970,0x3670,0x4680,0x6380,0x3990,0x5690
.long 0x4810,0x6510,0x3b20,0x5820,0x4b30,0x6830,0x2340,0x5b40,0x3350,0x6b50,0x2660,0x4360,0x3670,0x5370,0x2980,0x4680
.long 0x4810,0x6510,0x11a0,0x49a0,0x3030,0x6830,0x14c0,0x31c0,0x3350,0x5050,0x17e0,0x34e0,0x3670,0x7070,0x1b00,0x3800
.long 0x5820,0x7520,0x21b0,0x59b0,0x4040,0x7840,0x24d0,0x41d0,0x4360,0x6060,0x27f0,0x44f0,0x4680,0x6380,0x2b10,0x4810
.long 0x49a0,0x66a0,0x1330,0x4b30,0x31c0,0x69c0,0x1650,0x3350,0x34e0,0x51e0,0x1970,0x3670,0x5500,0x7200,0x3990,0x5690
.long 0x5690,0x7390,0x3b20,0x5820,0x59b0,0x76b0,0x2340,0x5b40,0x41d0,0x79d0,0x2660,0x4360,0x44f0,0x61f0,0x2980,0x4680
.long 0x4b30,0x6830,0x11b0,0x49b0,0x3350,0x6b50,0x14d0,0x31d0,0x3670,0x5370,0x17f0,0x34f0,0x3990,0x7390,0x1b10,0x3810
.long 0x5b40,0x7840,0x21c0,0x59c0,0x4360,0x7b60,0x24e0,0x41e0,0x4680,0x6380,0x2800,0x4500,0x49a0,0x66a0,0x2b20,0x4820
.long 0x4cc0,0x69c0,0x1340,0x4b40,0x34e0,0x6ce0,0x1660,0x3360,0x3800,0x5500,0x1980,0x3680,0x5820,0x7520,0x39a0,0x56a0
.long 0x59b0,0x76b0,0x3b30,0x5830,0x5cd0,0x79d0,0x2350,0x5b50,0x44f0,0x7cf0,0x2670,0x4370,0x4810,0x6510,0x2990,0x4690
.long 0x59b0,0x76b0,0x11b0,0x49b0,0x41d0,0x79d0,0x14d0,0x31d0,0x44f0,0x61f0,0x17f0,0x34f0,0x4810,0x8210,0x1b10,0x3810
.long 0x69c0,0x86c0,0x21c0,0x59c0,0x51e0,0x89e0,0x24e0,0x41e0,0x5500,0x7200,0x2800,0x4500,0x5820,0x7520,0x2b20,0x4820
.long 0x5b40,0x7840,0x1340,0x4b40,0x4360,0x7b60,0x1660,0x3360,0x4680,0x6380,0x1980,0x3680,0x66a0,0x83a0,0x39a0,0x56a0
.long 0x6830,0x8530,0x3b30,0x5830,0x6b50,0x8850,0x2350,0x5b50,0x5370,0x8b70,0x2670,0x4370,0x5690,0x7390,0x2990,0x4690
.long 0x66a0,0x0,0x90300,0xefd00,0x69c0,0x300,0x5fd00,0xf0000,0x51e0,0x600,0x60000,0xbfa00,0x7200,0x900,0x60300,0x11f700
.long 0x76b0,0x2fe80,0xc0180,0x11fb80,0x79d0,0x30180,0x8fb80,0x11fe80,0x61f0,0x30480,0x8fe80,0xef880,0x6510,0x30780,0x90180,0xefb80
.long 0x6830,0x180,0x90480,0xefe80,0x6b50,0x480,0x5fe80,0xf0180,0x5370,0x780,0x60180,0xbfb80,0x7390,0x60480,0xbfe80,0x11f880
.long 0x7520,0x60600,0xc0000,0x11fa00,0x7840,0x30000,0xc0300,0x11fd00,0x7b60,0x30300,0x8fd00,0x120000,0x6380,0x30600,0x90000,0xefa00
.long 0x66a0,0x8,0x90308,0xefd08,0x69c0,0x308,0x5fd08,0xf0008,0x51e0,0x608,0x60008,0xbfa08,0x7200,0x908,0x60308,0x11f708
.long 0x76b0,0x2fe88,0xc0188,0x11fb88,0x79d0,0x30188,0x8fb88,0x11fe88,0x61f0,0x30488,0x8fe88,0xef888,0x6510,0x30788,0x90188,0xefb88
.long 0x6830,0x188,0x90488,0xefe88,0x6b50,0x488,0x5fe88,0xf0188,0x5370,0x788,0x60188,0xbfb88,0x7390,0x60488,0xbfe88,0x11f888
.long 0x7520,0x60608,0xc0008,0x11fa08,0x7840,0x30008,0xc0308,0x11fd08,0x7b60,0x30308,0x8fd08,0x120008,0x6380,0x30608,0x90008,0xefa08
.long 0x66b0,0x10,0x90310,0xefd10,0x69d0,0x310,0x5fd10,0xf0010,0x51f0,0x610,0x60010,0xbfa10,0x7210,0x910,0x60310,0x11f710
.long 0x76c0,0x2fe90,0xc0190,0x11fb90,0x79e0,0x30190,0x8fb90,0x11fe90,0x6200,0x30490,0x8fe90,0xef890,0x6520,0x30790,0x90190,0xefb90
.long 0x6840,0x190,0x90490,0xefe90,0x6b60,0x490,0x5fe90,0xf0190,0x5380,0x790,0x60190,0xbfb90,0x73a0,0x60490,0xbfe90,0x11f890
.long 0x7530,0x60610,0xc0010,0x11fa10,0x7850,0x30010,0xc0310,0x11fd10,0x7b70,0x30310,0x8fd10,0x120010,0x6390,0x30610,0x90010,0xefa10
.long 0x66b0,0x18,0x90318,0xefd18,0x69d0,0x318,0x5fd18,0xf0018,0x51f0,0x618,0x60018,0xbfa18,0x7210,0x918,0x60318,0x11f718
.long 0x76c0,0x2fe98,0xc0198,0x11fb98,0x79e0,0x30198,0x8fb98,0x11fe98,0x6200,0x30498,0x8fe98,0xef898,0x6520,0x30798,0x90198,0xefb98
.long 0x6840,0x198,0x90498,0xefe98,0x6b60,0x498,0x5fe98,0xf0198,0x5380,0x798,0x60198,0xbfb98,0x73a0,0x60498,0xbfe98,0x11f898
.long 0x7530,0x60618,0xc0018,0x11fa18,0x7850,0x30018,0xc0318,0x11fd18,0x7b70,0x30318,0x8fd18,0x120018,0x6390,0x30618,0x90018,0xefa18
.long 0x0,0x0,0x12100,0x16900,0x0,0xff800000,0x12110,0x16910,0x0,0xff800000,0x12120,0x16920,0x0,0xff800000,0x12130,0x16930
.long 0x0,0xff800000,0x12140,0x16940,0x0,0xff800000,0x12150,0x16950,0x0,0xff800000,0x12160,0x16960,0x0,0xff800000,0x12170,0x16970
.long 0x0,0xff800000,0x12180,0x16980,0x0,0xff800000,0x12190,0x16990,0x0,0xff800000,0x121a0,0x169a0,0x0,0xff800000,0x121b0,0x169b0
.long 0x0,0xff800000,0x121c0,0x169c0,0x0,0xff800000,0x121d0,0x169d0,0x0,0xff800000,0x121e0,0x169e0,0x0,0xff800000,0x121f0,0x169f0
.long 0xff800000,0x0,0x12100,0x16d00,0xff800000,0xff800000,0x12110,0x16d10,0xff800000,0xff800000,0x12120,0x16d20,0xff800000,0xff800000,0x12130,0x16d30
.long 0xff800000,0xff800000,0x12140,0x16d40,0xff800000,0xff800000,0x12150,0x16d50,0xff800000,0xff800000,0x12160,0x16d60,0xff800000,0xff800000,0x12170,0x16d70
.long 0xff800000,0xff800000,0x12180,0x16d80,0xff800000,0xff800000,0x12190,0x16d90,0xff800000,0xff800000,0x121a0,0x16da0,0xff800000,0xff800000,0x121b0,0x16db0
.long 0xff800000,0xff800000,0x121c0,0x16dc0,0xff800000,0xff800000,0x121d0,0x16dd0,0xff800000,0xff800000,0x121e0,0x16de0,0xff800000,0xff800000,0x121f0,0x16df0
.long 0xff800000,0x0,0x12100,0x16a00,0xff800000,0xff800000,0x12110,0x16a10,0xff800000,0xff800000,0x12120,0x16a20,0xff800000,0xff800000,0x12130,0x16a30
.long 0xff800000,0xff800000,0x12140,0x16a40,0xff800000,0xff800000,0x12150,0x16a50,0xff800000,0xff800000,0x12160,0x16a60,0xff800000,0xff800000,0x12170,0x16a70
.long 0xff800000,0xff800000,0x12180,0x16a80,0xff800000,0xff800000,0x12190,0x16a90,0xff800000,0xff800000,0x121a0,0x16aa0,0xff800000,0xff800000,0x121b0,0x16ab0
.long 0xff800000,0xff800000,0x121c0,0x16ac0,0xff800000,0xff800000,0x121d0,0x16ad0,0xff800000,0xff800000,0x121e0,0x16ae0,0xff800000,0xff800000,0x121f0,0x16af0
.long 0xff800000,0x0,0x12100,0x16e00,0xff800000,0xff800000,0x12110,0x16e10,0xff800000,0xff800000,0x12120,0x16e20,0xff800000,0xff800000,0x12130,0x16e30
.long 0xff800000,0xff800000,0x12140,0x16e40,0xff800000,0xff800000,0x12150,0x16e50,0xff800000,0xff800000,0x12160,0x16e60,0xff800000,0xff800000,0x12170,0x16e70
.long 0xff800000,0xff800000,0x12180,0x16e80,0xff800000,0xff800000,0x12190,0x16e90,0xff800000,0xff800000,0x121a0,0x16ea0,0xff800000,0xff800000,0x121b0,0x16eb0
.long 0xff800000,0xff800000,0x121c0,0x16ec0,0xff800000,0xff800000,0x121d0,0x16ed0,0xff800000,0xff800000,0x121e0,0x16ee0,0xff800000,0xff800000,0x121f0,0x16ef0
.long 0x9100,0x9100,0xa100,0x0,0x9110,0x9110,0xa110,0x55555555,0x9120,0x9120,0xa120,0xaaaaaaaa,0x9130,0x9130,0xa130,0xffffffff
.long 0x9140,0x9140,0xa140,0x0,0x9150,0x9150,0xa150,0x55555555,0x9160,0x9160,0xa160,0xaaaaaaaa,0x9170,0x9170,0xa170,0xffffffff
.long 0x9180,0x9180,0xa180,0x0,0x9190,0x9190,0xa190,0x55555555,0x91a0,0x91a0,0xa1a0,0xaaaaaaaa,0x91b0,0x91b0,0xa1b0,0xffffffff
.long 0x91c0,0x91c0,0xa1c0,0x0,0x91d0,0x91d0,0xa1d0,0x55555555,0x91e0,0x91e0,0xa1e0,0xaaaaaaaa,0x91f0,0x91f0,0xa1f0,0xffffffff
.long 0x9200,0x9200,0xa200,0x0,0x9210,0x9210,0xa210,0x55555555,0x9220,0x9220,0xa220,0xaaaaaaaa,0x9230,0x9230,0xa230,0xffffffff
.long 0x9240,0x9240,0xa240,0x0,0x9250,0x9250,0xa250,0x55555555,0x9260,0x9260,0xa260,0xaaaaaaaa,0x9270,0x9270,0xa270,0xffffffff
.long 0x9280,0x9280,0xa280,0x0,0x9290,0x9290,0xa290,0x55555555,0x92a0,0x92a0,0xa2a0,0xaaaaaaaa,0x92b0,0x92b0,0xa2b0,0xffffffff
.long 0x92c0,0x92c0,0xa2c0,0x0,0x92d0,0x92d0,0xa2d0,0x55555555,0x92e0,0x92e0,0xa2e0,0xaaaaaaaa,0x92f0,0x92f0,0xa2f0,0xffffffff
.long 0x9300,0x9300,0xa300,0x0,0x9310,0x9310,0xa310,0x55555555,0x9320,0x9320,0xa320,0xaaaaaaaa,0x9330,0x9330,0xa330,0xffffffff
.long 0x9340,0x9340,0xa340,0x0,0x9350,0x9350,0xa350,0x55555555,0x9360,0x9360,0xa360,0xaaaaaaaa,0x9370,0x9370,0xa370,0xffffffff
.long 0x9380,0x9380,0xa380,0x0,0x9390,0x9390,0xa390,0x55555555,0x93a0,0x93a0,0xa3a0,0xaaaaaaaa,0x93b0,0x93b0,0xa3b0,0xffffffff
.long 0x93c0,0x93c0,0xa3c0,0x0,0x93d0,0x93d0,0xa3d0,0x55555555,0x93e0,0x93e0,0xa3e0,0xaaaaaaaa,0x93f0,0x93f0,0xa3f0,0xffffffff
.long 0x9400,0x9400,0xa400,0x0,0x9410,0x9410,0xa410,0x55555555,0x9420,0x9420,0xa420,0xaaaaaaaa,0x9430,0x9430,0xa430,0xffffffff
.long 0x9440,0x9440,0xa440,0x0,0x9450,0x9450,0xa450,0x55555555,0x9460,0x9460,0xa460,0xaaaaaaaa,0x9470,0x9470,0xa470,0xffffffff
.long 0x9480,0x9480,0xa480,0x0,0x9490,0x9490,0xa490,0x55555555,0x94a0,0x94a0,0xa4a0,0xaaaaaaaa,0x94b0,0x94b0,0xa4b0,0xffffffff
.long 0x94c0,0x94c0,0xa4c0,0x0,0x94d0,0x94d0,0xa4d0,0x55555555,0x94e0,0x94e0,0xa4e0,0xaaaaaaaa,0x94f0,0x94f0,0xa4f0,0xffffffff
.long 0x17100,0x17100,0x0,0x23100,0x17102,0x17100,0x0,0x23110,0x17104,0x17100,0x0,0x23120,0x17106,0x17100,0x0,0x23130
.long 0x17120,0x17100,0x0,0x23140,0x17122,0x17100,0x0,0x23150,0x17124,0x17100,0x0,0x23160,0x17126,0x17100,0x0,0x23170
.long 0x17140,0x17100,0x0,0x23300,0x17142,0x17100,0x0,0x23300,0x17144,0x17100,0x0,0x23300,0x17146,0x17100,0x0,0x23300
.long 0x17160,0x17100,0x0,0x23300,0x17162,0x17100,0x0,0x23300,0x17164,0x17100,0x0,0x23300,0x17166,0x17100,0x0,0x23300
.long 0x17108,0x17120,0x0,0x23200,0x1710a,0x17120,0x0,0x23210,0x1710c,0x17120,0x0,0x23220,0x1710e,0x17120,0x0,0x23230
.long 0x17128,0x17120,0x0,0x23240,0x1712a,0x17120,0x0,0x23250,0x1712c,0x17120,0x0,0x23260,0x1712e,0x17120,0x0,0x23270
.long 0x17148,0x17120,0x0,0x23300,0x1714a,0x17120,0x0,0x23300,0x1714c,0x17120,0x0,0x23300,0x1714e,0x17120,0x0,0x23300
.long 0x17168,0x17120,0x0,0x23300,0x1716a,0x17120,0x0,0x23300,0x1716c,0x17120,0x0,0x23300,0x1716e,0x17120,0x0,0x23300
.long 0x17110,0x17140,0x0,0x23300,0x17112,0x17140,0x0,0x23300,0x17114,0x17140,0x0,0x23300,0x17116,0x17140,0x0,0x23300
.long 0x17130,0x17140,0x0,0x23300,0x17132,0x17140,0x0,0x23300,0x17134,0x17140,0x0,0x23300,0x17136,0x17140,0x0,0x23300
.long 0x17150,0x17140,0x0,0x23180,0x17152,0x17140,0x0,0x23190,0x17154,0x17140,0x0,0x231a0,0x17156,0x17140,0x0,0x231b0
.long 0x17170,0x17140,0x0,0x231c0,0x17172,0x17140,0x0,0x231d0,0x17174,0x17140,0x0,0x231e0,0x17176,0x17140,0x0,0x231f0
.long 0x17118,0x17160,0x0,0x23300,0x1711a,0x17160,0x0,0x23300,0x1711c,0x17160,0x0,0x23300,0x1711e,0x17160,0x0,0x23300
.long 0x17138,0x17160,0x0,0x23300,0x1713a,0x17160,0x0,0x23300,0x1713c,0x17160,0x0,0x23300,0x1713e,0x17160,0x0,0x23300
.long 0x17158,0x17160,0x0,0x23280,0x1715a,0x17160,0x0,0x23290,0x1715c,0x17160,0x0,0x232a0,0x1715e,0x17160,0x0,0x232b0
.long 0x17178,0x17160,0x0,0x232c0,0x1717a,0x17160,0x0,0x232d0,0x1717c,0x17160,0x0,0x232e0,0x1717e,0x17160,0x0,0x232f0
.long 0x13100,0x0,0x180,0x600,0x13108,0xd90,0xf10,0x1390,0x13110,0x1b20,0x1ca0,0x2120,0x13118,0x28b0,0x2a30,0x2eb0
.long 0x13160,0x3640,0x37c0,0x3c40,0x13168,0x43d0,0x4550,0x49d0,0x13170,0x5160,0x52e0,0x5760,0x13178,0x5ef0,0x6070,0x64f0
.long 0x131c0,0x6c80,0x6e00,0x7280,0x131c8,0x7a10,0x7b90,0x8010,0x131d0,0x87a0,0x8920,0x8da0,0x131d8,0x9530,0x96b0,0x9b30
.long 0x13220,0xa2c0,0xa440,0xa8c0,0x13228,0xb050,0xb1d0,0xb650,0x13230,0xbde0,0xbf60,0xc3e0,0x13238,0xcb70,0xccf0,0xd170
.long 0x13280,0x300,0x480,0x600,0x13288,0x1090,0x1210,0x1390,0x13290,0x1e20,0x1fa0,0x2120,0x13298,0x2bb0,0x2d30,0x2eb0
.long 0x132e0,0x3940,0x3ac0,0x3c40,0x132e8,0x46d0,0x4850,0x49d0,0x132f0,0x5460,0x55e0,0x5760,0x132f8,0x61f0,0x6370,0x64f0
.long 0x13340,0x6f80,0x7100,0x7280,0x13348,0x7d10,0x7e90,0x8010,0x13350,0x8aa0,0x8c20,0x8da0,0x13358,0x9830,0x99b0,0x9b30
.long 0x133a0,0xa5c0,0xa740,0xa8c0,0x133a8,0xb350,0xb4d0,0xb650,0x133b0,0xc0e0,0xc260,0xc3e0,0x133b8,0xce70,0xcff0,0xd170
.long 0x13400,0x900,0x780,0x610,0x13408,0x1690,0x1510,0x13a0,0x13410,0x2420,0x22a0,0x2130,0x13418,0x31b0,0x3030,0x2ec0
.long 0x13460,0x3f40,0x3dc0,0x3c50,0x13468,0x4cd0,0x4b50,0x49e0,0x13470,0x5a60,0x58e0,0x5770,0x13478,0x67f0,0x6670,0x6500
.long 0x134c0,0x7580,0x7400,0x7290,0x134c8,0x8310,0x8190,0x8020,0x134d0,0x90a0,0x8f20,0x8db0,0x134d8,0x9e30,0x9cb0,0x9b40
.long 0x13520,0xabc0,0xaa40,0xa8d0,0x13528,0xb950,0xb7d0,0xb660,0x13530,0xc6e0,0xc560,0xc3f0,0x13538,0xd470,0xd2f0,0xd180
.long 0x13580,0xc00,0xa80,0x610,0x13588,0x1990,0x1810,0x13a0,0x13590,0x2720,0x25a0,0x2130,0x13598,0x34b0,0x3330,0x2ec0
.long 0x135e0,0x4240,0x40c0,0x3c50,0x135e8,0x4fd0,0x4e50,0x49e0,0x135f0,0x5d60,0x5be0,0x5770,0x135f8,0x6af0,0x6970,0x6500
.long 0x13640,0x7880,0x7700,0x7290,0x13648,0x8610,0x8490,0x8020,0x13650,0x93a0,0x9220,0x8db0,0x13658,0xa130,0x9fb0,0x9b40
.long 0x136a0,0xaec0,0xad40,0xa8d0,0x136a8,0xbc50,0xbad0,0xb660,0x136b0,0xc9e0,0xc860,0xc3f0,0x136b8,0xd770,0xd5f0,0xd180
.long 0x17100,0x17500,0x1f050,0x0,0x17710,0x17b10,0x1f360,0x0,0x17d20,0x18120,0x1f670,0x0,0x18330,0x18730,0x1f980,0x0
.long 0x18940,0x18d40,0x1fc90,0x0,0x18f50,0x19350,0x1ffa0,0x0,0x19560,0x19960,0x202b0,0x0,0x19b70,0x19f70,0x205c0,0x0
.long 0x1a180,0x1a580,0x208d0,0x0,0x1a790,0x1ab90,0x20be0,0x0,0x1ada0,0x1b1a0,0x20ef0,0x0,0x1b3b0,0x1b7b0,0x21200,0x0
.long 0x1b9c0,0x1bdc0,0x21510,0x0,0x1bfd0,0x1c3d0,0x21820,0x0,0x1c5e0,0x1c9e0,0x21b30,0x0,0x1cbf0,0x1cff0,0x21e40,0x0
.long 0x17120,0x17508,0x1f060,0x0,0x17730,0x17b18,0x1f370,0x0,0x17d40,0x18128,0x1f680,0x0,0x18350,0x18738,0x1f990,0x0
.long 0x18960,0x18d48,0x1fca0,0x0,0x18f70,0x19358,0x1ffb0,0x0,0x19580,0x19968,0x202c0,0x0,0x19b90,0x19f78,0x205d0,0x0
.long 0x1a1a0,0x1a588,0x208e0,0x0,0x1a7b0,0x1ab98,0x20bf0,0x0,0x1adc0,0x1b1a8,0x20f00,0x0,0x1b3d0,0x1b7b8,0x21210,0x0
.long 0x1b9e0,0x1bdc8,0x21520,0x0,0x1bff0,0x1c3d8,0x21830,0x0,0x1c600,0x1c9e8,0x21b40,0x0,0x1cc10,0x1cff8,0x21e50,0x0
.long 0x17140,0x17510,0x1f070,0x0,0x17750,0x17b20,0x1f380,0x0,0x17d60,0x18130,0x1f690,0x0,0x18370,0x18740,0x1f9a0,0x0
.long 0x18980,0x18d50,0x1fcb0,0x0,0x18f90,0x19360,0x1ffc0,0x0,0x195a0,0x19970,0x202d0,0x0,0x19bb0,0x19f80,0x205e0,0x0
.long 0x1a1c0,0x1a590,0x208f0,0x0,0x1a7d0,0x1aba0,0x20c00,0x0,0x1ade0,0x1b1b0,0x20f10,0x0,0x1b3f0,0x1b7c0,0x21220,0x0
.long 0x1ba00,0x1bdd0,0x21530,0x0,0x1c010,0x1c3e0,0x21840,0x0,0x1c620,0x1c9f0,0x21b50,0x0,0x1cc30,0x1d000,0x21e60,0x0
.long 0x17160,0x17518,0x1f080,0x0,0x17770,0x17b28,0x1f390,0x0,0x17d80,0x18138,0x1f6a0,0x0,0x18390,0x18748,0x1f9b0,0x0
.long 0x189a0,0x18d58,0x1fcc0,0x0,0x18fb0,0x19368,0x1ffd0,0x0,0x195c0,0x19978,0x202e0,0x0,0x19bd0,0x19f88,0x205f0,0x0
.long 0x1a1e0,0x1a598,0x20900,0x0,0x1a7f0,0x1aba8,0x20c10,0x0,0x1ae00,0x1b1b8,0x20f20,0x0,0x1b410,0x1b7c8,0x21230,0x0
.long 0x1ba20,0x1bdd8,0x21540,0x0,0x1c030,0x1c3e8,0x21850,0x0,0x1c640,0x1c9f8,0x21b60,0x0,0x1cc50,0x1d008,0x21e70,0x0
.long 0x26100,0x26160,0x26280,0x0,0x26102,0x26162,0x26282,0x0,0x26104,0x26164,0x26284,0x0,0x26106,0x26166,0x26286,0x0
.long 0x26108,0x26168,0x26288,0x0,0x2610a,0x2616a,0x2628a,0x0,0x2610c,0x2616c,0x2628c,0x0,0x2610e,0x2616e,0x2628e,0x0
.long 0x26110,0x26170,0x26290,0x0,0x26112,0x26172,0x26292,0x0,0x26114,0x26174,0x26294,0x0,0x26116,0x26176,0x26296,0x0
.long 0x26118,0x26178,0x26298,0x0,0x2611a,0x2617a,0x2629a,0x0,0x2611c,0x2617c,0x2629c,0x0,0x2611e,0x2617e,0x2629e,0x0
.long 0x26340,0x262e0,0x26280,0x0,0x26342,0x262e2,0x26282,0x0,0x26344,0x262e4,0x26284,0x0,0x26346,0x262e6,0x26286,0x0
.long 0x26348,0x262e8,0x26288,0x0,0x2634a,0x262ea,0x2628a,0x0,0x2634c,0x262ec,0x2628c,0x0,0x2634e,0x262ee,0x2628e,0x0
.long 0x26350,0x262f0,0x26290,0x0,0x26352,0x262f2,0x26292,0x0,0x26354,0x262f4,0x26294,0x0,0x26356,0x262f6,0x26296,0x0
.long 0x26358,0x262f8,0x26298,0x0,0x2635a,0x262fa,0x2629a,0x0,0x2635c,0x262fc,0x2629c,0x0,0x2635e,0x262fe,0x2629e,0x0
.long 0x26100,0x26160,0x26280,0x0,0x26102,0x26162,0x26282,0x0,0x26104,0x26164,0x26284,0x0,0x26106,0x26166,0x26286,0x0
.long 0x26108,0x26168,0x26288,0x0,0x2610a,0x2616a,0x2628a,0x0,0x2610c,0x2616c,0x2628c,0x0,0x2610e,0x2616e,0x2628e,0x0
.long 0x26110,0x26170,0x26290,0x0,0x26112,0x26172,0x26292,0x0,0x26114,0x26174,0x26294,0x0,0x26116,0x26176,0x26296,0x0
.long 0x26118,0x26178,0x26298,0x0,0x2611a,0x2617a,0x2629a,0x0,0x2611c,0x2617c,0x2629c,0x0,0x2611e,0x2617e,0x2629e,0x0
.long 0x26340,0x262e0,0x26280,0x0,0x26342,0x262e2,0x26282,0x0,0x26344,0x262e4,0x26284,0x0,0x26346,0x262e6,0x26286,0x0
.long 0x26348,0x262e8,0x26288,0x0,0x2634a,0x262ea,0x2628a,0x0,0x2634c,0x262ec,0x2628c,0x0,0x2634e,0x262ee,0x2628e,0x0
.long 0x26350,0x262f0,0x26290,0x0,0x26352,0x262f2,0x26292,0x0,0x26354,0x262f4,0x26294,0x0,0x26356,0x262f6,0x26296,0x0
.long 0x26358,0x262f8,0x26298,0x0,0x2635a,0x262fa,0x2629a,0x0,0x2635c,0x262fc,0x2629c,0x0,0x2635e,0x262fe,0x2629e,0x0
.long 0xffffffff,0x0,0xffff,0x0,0xffffffff,0x0,0xffff,0x0,0xffffffff,0x0,0xffff,0x0,0xffffffff,0x0,0xffff,0x0
.long 0x0,0xffffffff,0xffff,0x0,0x0,0xffffffff,0xffff,0x0,0x0,0xffffffff,0xffff,0x0,0x0,0xffffffff,0xffff,0x0
.long 0x0,0x0,0xffff,0x0,0x0,0x0,0xffff,0x0,0x0,0x0,0xffff,0x0,0x0,0x0,0xffff,0x0
.long 0x0,0x0,0xffff,0x0,0x0,0x0,0xffff,0x0,0x0,0x0,0xffff,0x0,0x0,0x0,0xffff,0x0
.long 0xffffffff,0x0,0x0,0x3f80,0xffffffff,0x0,0x0,0x3f80,0xffffffff,0x0,0x0,0x3f80,0xffffffff,0x0,0x0,0x3f80
.long 0x0,0xffffffff,0x0,0x3f80,0x0,0xffffffff,0x0,0x3f80,0x0,0xffffffff,0x0,0x3f80,0x0,0xffffffff,0x0,0x3f80
.long 0x0,0x0,0x0,0x3f80,0x0,0x0,0x0,0x3f80,0x0,0x0,0x0,0x3f80,0x0,0x0,0x0,0x3f80
.long 0x0,0x0,0x0,0x3f80,0x0,0x0,0x0,0x3f80,0x0,0x0,0x0,0x3f80,0x0,0x0,0x0,0x3f80
.long 0x0,0x0,0xffff,0x0,0x0,0x0,0xffff,0x0,0x0,0x0,0xffff,0x0,0x0,0x0,0xffff,0x0
.long 0x0,0x0,0xffff,0x0,0x0,0x0,0xffff,0x0,0x0,0x0,0xffff,0x0,0x0,0x0,0xffff,0x0
.long 0xffffffff,0x0,0xffff,0x0,0xffffffff,0x0,0xffff,0x0,0xffffffff,0x0,0xffff,0x0,0xffffffff,0x0,0xffff,0x0
.long 0x0,0xffffffff,0xffff,0x0,0x0,0xffffffff,0xffff,0x0,0x0,0xffffffff,0xffff,0x0,0x0,0xffffffff,0xffff,0x0
.long 0x0,0x0,0x0,0x3f80,0x0,0x0,0x0,0x3f80,0x0,0x0,0x0,0x3f80,0x0,0x0,0x0,0x3f80
.long 0x0,0x0,0x0,0x3f80,0x0,0x0,0x0,0x3f80,0x0,0x0,0x0,0x3f80,0x0,0x0,0x0,0x3f80
.long 0xffffffff,0x0,0x0,0x3f80,0xffffffff,0x0,0x0,0x3f80,0xffffffff,0x0,0x0,0x3f80,0xffffffff,0x0,0x0,0x3f80
.long 0x0,0xffffffff,0x0,0x3f80,0x0,0xffffffff,0x0,0x3f80,0x0,0xffffffff,0x0,0x3f80,0x0,0xffffffff,0x0,0x3f80
.long 0xffff,0x0,0x0,0x0,0xffff0000,0x0,0x0,0x0,0x0,0xffff,0x0,0x0,0x0,0xffff0000,0x0,0x0
.long 0x0,0x0,0xffff,0x0,0x0,0x0,0xffff0000,0x0,0x0,0x0,0x0,0xffff,0x0,0x0,0x0,0xffff0000
.long 0x0,0x0,0x0,0x0,0x0,0x0,0x0,0x0,0x0,0x0,0x0,0x0,0x0,0x0,0x0,0x0
.long 0x0,0x0,0x0,0x0,0x0,0x0,0x0,0x0,0x0,0x0,0x0,0x0,0x0,0x0,0x0,0x0
.long 0xffff,0x0,0x0,0x0,0xffff0000,0x0,0x0,0x0,0x0,0xffff,0x0,0x0,0x0,0xffff0000,0x0,0x0
.long 0x0,0x0,0xffff,0x0,0x0,0x0,0xffff0000,0x0,0x0,0x0,0x0,0xffff,0x0,0x0,0x0,0xffff0000
.long 0x0,0x0,0x0,0x0,0x0,0x0,0x0,0x0,0x0,0x0,0x0,0x0,0x0,0x0,0x0,0x0
.long 0x0,0x0,0x0,0x0,0x0,0x0,0x0,0x0,0x0,0x0,0x0,0x0,0x0,0x0,0x0,0x0
.long 0x0,0x0,0x0,0x0,0x0,0x0,0x0,0x0,0x0,0x0,0x0,0x0,0x0,0x0,0x0,0x0
.long 0x0,0x0,0x0,0x0,0x0,0x0,0x0,0x0,0x0,0x0,0x0,0x0,0x0,0x0,0x0,0x0
.long 0xffff,0x0,0x0,0x0,0xffff0000,0x0,0x0,0x0,0x0,0xffff,0x0,0x0,0x0,0xffff0000,0x0,0x0
.long 0x0,0x0,0xffff,0x0,0x0,0x0,0xffff0000,0x0,0x0,0x0,0x0,0xffff,0x0,0x0,0x0,0xffff0000
.long 0x0,0x0,0x0,0x0,0x0,0x0,0x0,0x0,0x0,0x0,0x0,0x0,0x0,0x0,0x0,0x0
.long 0x0,0x0,0x0,0x0,0x0,0x0,0x0,0x0,0x0,0x0,0x0,0x0,0x0,0x0,0x0,0x0
.long 0xffff,0x0,0x0,0x0,0xffff0000,0x0,0x0,0x0,0x0,0xffff,0x0,0x0,0x0,0xffff0000,0x0,0x0
.long 0x0,0x0,0xffff,0x0,0x0,0x0,0xffff0000,0x0,0x0,0x0,0x0,0xffff,0x0,0x0,0x0,0xffff0000
.long 0x0,0x0,0x0,0x0,0x0,0x0,0x0,0x0,0x0,0x0,0x0,0x0,0x0,0x0,0x0,0x0
.long 0x0,0x0,0x0,0x0,0x0,0x0,0x0,0x0,0x0,0x0,0x0,0x0,0x0,0x0,0x0,0x0
.long 0x0,0x0,0x0,0x0,0x0,0x0,0x0,0x0,0x0,0x0,0x0,0x0,0x0,0x0,0x0,0x0
.long 0x0,0x0,0x0,0x0,0x0,0x0,0x0,0x0,0x0,0x0,0x0,0x0,0x0,0x0,0x0,0x0
.long 0x0,0x0,0x0,0x0,0x0,0x0,0x0,0x0,0x0,0x0,0x0,0x0,0x0,0x0,0x0,0x0
.long 0x0,0x0,0x0,0x0,0x0,0x0,0x0,0x0,0x0,0x0,0x0,0x0,0x0,0x0,0x0,0x0
.long 0x0,0x0,0x0,0x0,0x0,0x0,0x0,0x0,0x0,0x0,0x0,0x0,0x0,0x0,0x0,0x0
.long 0x0,0x0,0x0,0x0,0x0,0x0,0x0,0x0,0x0,0x0,0x0,0x0,0x0,0x0,0x0,0x0
.long 0x0,0x0,0x0,0x0,0x0,0x0,0x0,0x0,0x0,0x0,0x0,0x0,0x0,0x0,0x0,0x0
.long 0x0,0x0,0x0,0x0,0x0,0x0,0x0,0x0,0x0,0x0,0x0,0x0,0x0,0x0,0x0,0x0
.long 0x0,0x0,0x0,0x0,0x0,0x0,0x0,0x0,0x0,0x0,0x0,0x0,0x0,0x0,0x0,0x0
.long 0x0,0x0,0x0,0x0,0x0,0x0,0x0,0x0,0x0,0x0,0x0,0x0,0x0,0x0,0x0,0x0
.long 0x0,0x0,0x0,0x0,0x0,0x0,0x0,0x0,0x0,0x0,0x0,0x0,0x0,0x0,0x0,0x0
.long 0x0,0x0,0x0,0x0,0x0,0x0,0x0,0x0,0x0,0x0,0x0,0x0,0x0,0x0,0x0,0x0
.long 0x0,0x0,0x0,0x0,0x0,0x0,0x0,0x0,0x0,0x0,0x0,0x0,0x0,0x0,0x0,0x0
.long 0x0,0x0,0x0,0x0,0x0,0x0,0x0,0x0,0x0,0x0,0x0,0x0,0x0,0x0,0x0,0x0
.size L_tab, 12288
.section .rodata,"a"
.p2align 6
.amdhsa_kernel standalone__window_attn_davit__vision_kernel
  .amdhsa_next_free_vgpr 512
  .amdhsa_next_free_sgpr 96
  .amdhsa_accum_offset 256
  .amdhsa_group_segment_fixed_size 0
  .amdhsa_kernarg_size 56
  .amdhsa_user_sgpr_count 2
  .amdhsa_user_sgpr_kernarg_segment_ptr 1
  .amdhsa_system_sgpr_workgroup_id_x 1
.end_amdhsa_kernel
```

```asm
; @launch grid=(256,1,1) block=(256,1,1) lds=163840
.amdgcn_target "amdgcn-amd-amdhsa--gfx950"
.text
.globl standalone__window_attn_davit__vision_kernel
.p2align 8
.type standalone__window_attn_davit__vision_kernel,@function
standalone__window_attn_davit__vision_kernel:
s_cmp_ge_u32 s2, 256
s_cbranch_scc1 L_end
v_lshrrev_b32 v1, 6, v0
s_mov_b32 s53, s2
s_mov_b32 s47, 0
v_readfirstlane_b32 s32, v1
s_nop 3
L_start:

s_load_dwordx8 s[56:63], s[0:1], 0
s_load_dwordx2 s[64:65], s[0:1], 32
s_load_dwordx2 s[66:67], s[0:1], 48
s_getpc_b64 s[68:69]
L_pc:
v_mbcnt_lo_u32_b32 v0, -1, 0
v_mbcnt_hi_u32_b32 v0, -1, v0
s_add_u32 s70, s68, L_tab-L_pc
s_addc_u32 s71, s69, 0
s_lshl_b32 s45, s32, 10
v_lshl_add_u32 v1, v0, 4, s45
s_add_u32 m0, s45, 143616
s_nop 0
global_load_lds_dwordx4 v1, s[70:71]
v_add_u32 v1, 4096, v1
s_add_u32 m0, s45, 147712
s_nop 0
global_load_lds_dwordx4 v1, s[70:71]
v_add_u32 v1, 4096, v1
s_add_u32 m0, s45, 151808
s_nop 0
global_load_lds_dwordx4 v1, s[70:71]
s_lshr_b32 s42, s53, 3
s_and_b32 s41, s42, 1
s_lshl_b32 s41, s41, 2
s_add_u32 s41, s41, s32
s_lshl_b32 s41, s41, 13
v_lshlrev_b32 v2, 7, v0
v_add_u32 v3, s41, v2
s_cmp_lt_u32 s42, 4
s_cbranch_scc0 L_nopf
global_load_dword v255, v3, s[68:69]
L_nopf:
s_and_b32 s41, s53, 7
s_mul_i32 s43, s41, 666
s_add_u32 s34, s43, 667
s_min_u32 s41, s41, 1
s_add_u32 s43, s43, s41
s_add_u32 s33, s43, s42
s_mov_b32 s35, s33
s_mov_b32 s72, 402653183
s_mul_i32 s54, s32, 96
s_mul_i32 s55, s32, 3072
s_mul_hi_u32 s41, s33, 58835169
s_mul_i32 s28, s41, 73
s_sub_u32 s28, s33, s28
s_mul_i32 s29, s41, 1373568
s_mul_i32 s41, s28, 2688
s_add_u32 s29, s29, s41
s_lshl_b32 s41, s32, 6
v_add_u32 v4, s41, v0
v_mul_u32_u24 v5, 2622, v4
v_lshrrev_b32 v5, 16, v5
v_mul_u32_u24 v6, 25, v5
v_sub_u32 v6, v4, v6
v_mul_u32_u24 v7, 384, v5
v_lshl_add_u32 v7, v6, 4, v7
v_cmp_eq_u32 vcc, 0, v5
v_or_b32 v10, 134217728, v7
s_nop 0
v_cndmask_b32 v7, v7, v10, vcc
v_cmp_eq_u32 vcc, 8, v5
v_or_b32 v10, 536870912, v7
s_nop 0
v_cndmask_b32 v7, v7, v10, vcc
v_cmp_lt_u32 vcc, 8, v5
v_or_b32 v10, 268435456, v7
s_nop 0
v_cndmask_b32 v7, v7, v10, vcc
v_cmp_eq_u32 vcc, 24, v6
v_or_b32 v10, 268435456, v7
s_nop 0
v_cndmask_b32 v7, v7, v10, vcc
v_mov_b32 v208, v7
v_add_u32 v4, 0, v0
v_mul_u32_u24 v5, 171, v4
v_lshrrev_b32 v5, 10, v5
v_mul_u32_u24 v6, 6, v5
v_sub_u32 v6, v4, v6
v_lshlrev_b32 v6, 4, v6
v_mul_u32_u24 v8, 1152, v5
v_add_u32 v72, v8, v6
v_mul_u32_u24 v8, 384, v5
v_add_u32 v136, v8, v6
s_lshl_b32 s96, s42, 13
s_mul_hi_u32 s41, s35, 58835169
s_mul_i32 s42, s41, 73
s_sub_u32 s42, s35, s42
s_mul_i32 s43, s41, 1373568
s_mul_i32 s51, s42, 2688
s_add_u32 s43, s43, s51
s_cmp_lt_u32 s35, s34
s_cselect_b32 s50, s43, 1879048192
s_add_u32 s35, s35, 32
s_cmp_eq_u32 s42, 0
s_cselect_b32 s44, 536870911, s72
s_cmp_eq_u32 s42, 72
s_cselect_b32 s44, 939524095, s44
s_cmp_eq_u32 s41, 0
s_cselect_b32 s52, 1879048192, s50
s_waitcnt lgkmcnt(0)
s_mov_b32 s12, s60
s_mov_b32 s13, s61
s_mov_b32 s14, 221184
s_mov_b32 s15, 131072
s_mov_b32 s16, s62
s_mov_b32 s17, s63
s_mov_b32 s18, 73728
s_mov_b32 s19, 131072
s_cmp_eq_u32 s32, 0
s_cbranch_scc0 L_nopf2
buffer_load_dword v255, v2, s[12:15], s96 offen
L_nopf2:
s_and_b32 s96, s96, 131071
s_cmp_eq_u32 s32, 1
s_cbranch_scc0 L_nopf3
buffer_load_dword v255, v2, s[16:19], s96 offen
L_nopf3:
s_sub_u32 s4, s56, 196608
s_subb_u32 s5, s57, 0
s_mov_b32 s6, 100467072
s_mov_b32 s7, 131072
s_mov_b32 s20, s58
s_mov_b32 s21, s59
s_mov_b32 s22, 3456
s_mov_b32 s23, 131072
s_mul_i32 s96, s32, 864
s_mov_b32 exec_hi, 4194303
s_add_u32 m0, s96, 155904
s_nop 0
buffer_load_dwordx4 v136, s[20:23], s54 offen lds
s_mov_b64 exec, -1
s_mov_b32 s36, s50
v_and_b32 v180, s44, v208
s_add_u32 m0, s45, 0
s_nop 0
buffer_load_dwordx4 v180, s[4:7], s52 offen nt lds
s_add_u32 m0, s45, 4112
s_add_u32 s40, s36, 196224
buffer_load_dwordx4 v180, s[4:7], s40 offen nt lds
s_add_u32 m0, s45, 8224
s_add_u32 s40, s36, 392448
buffer_load_dwordx4 v180, s[4:7], s40 offen nt lds
s_add_u32 m0, s45, 12336
s_add_u32 s40, s36, 588672
buffer_load_dwordx4 v180, s[4:7], s40 offen nt lds
s_add_u32 m0, s45, 16448
s_add_u32 s40, s36, 784896
buffer_load_dwordx4 v180, s[4:7], s40 offen nt lds
s_add_u32 m0, s45, 20560
s_add_u32 s40, s36, 981120
buffer_load_dwordx4 v180, s[4:7], s40 offen nt lds
s_add_u32 m0, s45, 24672
s_add_u32 s40, s36, 1177344
buffer_load_dwordx4 v180, s[4:7], s40 offen nt lds
s_add_u32 m0, s45, 28784
s_add_u32 s40, s36, 1373568
buffer_load_dwordx4 v180, s[4:7], s40 offen nt lds
s_add_u32 m0, s45, 32896
s_add_u32 s40, s36, 1569792
buffer_load_dwordx4 v180, s[4:7], s40 offen nt lds
s_mul_i32 s41, s32, 54
v_add_u32 v4, s41, v0
v_mul_u32_u24 v5, 911, v4
v_lshrrev_b32 v5, 16, v5
v_mul_u32_u24 v6, 72, v5
v_sub_u32 v6, v4, v6
s_mov_b32 s43, 196224
v_mul_lo_u32 v5, v5, s43
v_lshl_add_u32 v82, v6, 4, v5
s_add_u32 s20, s29, 785664
s_add_u32 m0, s96, 57600
s_mov_b32 exec_hi, 4194303
buffer_load_dwordx4 v82, s[4:7], s20 offen nt lds
s_mov_b32 exec_hi, -1
s_add_u32 s28, s28, 32
s_cmp_ge_u32 s28, 73
s_cselect_b32 s21, 73, 0
s_cselect_b32 s22, 1177344, 0
s_sub_u32 s28, s28, s21
s_add_u32 s20, s20, s22
s_add_u32 s20, s20, 86016
s_add_u32 m0, s96, 61072
s_mov_b32 exec_hi, 4194303
buffer_load_dwordx4 v82, s[4:7], s20 offen nt lds
s_mov_b32 exec_hi, -1
s_add_u32 s28, s28, 32
s_cmp_ge_u32 s28, 73
s_cselect_b32 s21, 73, 0
s_cselect_b32 s22, 1177344, 0
s_sub_u32 s28, s28, s21
s_add_u32 s20, s20, s22
s_add_u32 s20, s20, 86016
s_add_u32 m0, s96, 64544
s_mov_b32 exec_hi, 4194303
buffer_load_dwordx4 v82, s[4:7], s20 offen nt lds
s_mov_b32 exec_hi, -1
s_add_u32 s28, s28, 32
s_cmp_ge_u32 s28, 73
s_cselect_b32 s21, 73, 0
s_cselect_b32 s22, 1177344, 0
s_sub_u32 s28, s28, s21
s_add_u32 s20, s20, s22
s_add_u32 s20, s20, 86016
s_add_u32 m0, s96, 68016
s_mov_b32 exec_hi, 4194303
buffer_load_dwordx4 v82, s[4:7], s20 offen nt lds
s_mov_b32 exec_hi, -1
v_add_u32 v4, 64, v0
v_mul_u32_u24 v5, 171, v4
v_lshrrev_b32 v5, 10, v5
v_mul_u32_u24 v6, 6, v5
v_sub_u32 v6, v4, v6
v_lshlrev_b32 v6, 4, v6
v_mul_u32_u24 v8, 1152, v5
v_add_u32 v73, v8, v6
v_mul_u32_u24 v8, 384, v5
v_add_u32 v137, v8, v6
s_mov_b32 s8, s64
s_mov_b32 s9, s65
s_mov_b32 s10, 100270464
s_mov_b32 s11, 131072
s_mov_b32 s24, s66
s_mov_b32 s25, s67
s_mov_b32 s26, 6291456
s_mov_b32 s27, 131072
s_mov_b32 s48, 1001040555
s_mov_b32 s73, 1020061065
s_mov_b32 s49, 944335852
s_mov_b32 s3, 1074544643
v_lshlrev_b32 v11, 4, v0
v_add_u32 v11, 143616, v11
s_waitcnt vmcnt(13)
s_barrier
ds_read_b128 v[194:197], v11
ds_read_b128 v[198:201], v11 offset:1024
ds_read_b128 v[202:205], v11 offset:2048
ds_read_b128 v[206:209], v11 offset:3072
ds_read_b128 v[210:213], v11 offset:4096
ds_read_b128 v[214:217], v11 offset:5120
ds_read_b128 v[110:113], v11 offset:6144
ds_read_b128 v[78:81], v11 offset:7168
ds_read_b128 v[36:39], v11 offset:8192
ds_read_b128 v[40:43], v11 offset:9216
ds_read_b128 v[44:47], v11 offset:10240
s_waitcnt lgkmcnt(7)
v_add_u32 v219, s45, v208
v_mov_b32 v208, v7
v_add_u32 v4, 128, v0
v_mul_u32_u24 v5, 171, v4
v_lshrrev_b32 v5, 10, v5
v_mul_u32_u24 v6, 6, v5
v_sub_u32 v6, v4, v6
v_lshlrev_b32 v6, 4, v6
v_mul_u32_u24 v8, 1152, v5
v_add_u32 v74, v8, v6
v_mul_u32_u24 v8, 384, v5
s_waitcnt lgkmcnt(5)
v_add_u32 v216, v8, v6
s_waitcnt lgkmcnt(2)
v_add_u32 v36, s96, v36
v_add_u32 v37, s96, v37
v_add_u32 v38, s96, v38
ds_read_u16 v48, v36
ds_read_u16 v49, v36 offset:192
ds_read_u16 v50, v37
ds_read_u16 v51, v37 offset:192
ds_read_u16 v52, v38
ds_read_u16 v53, v36 offset:32
ds_read_u16 v54, v36 offset:224
ds_read_u16 v55, v37 offset:32
ds_read_u16 v56, v37 offset:224
ds_read_u16 v57, v38 offset:32
ds_read_u16 v58, v36 offset:64
ds_read_u16 v59, v36 offset:256
ds_read_u16 v60, v37 offset:64
ds_read_u16 v61, v37 offset:256
ds_read_u16 v62, v38 offset:64
v_add_u32 v194, s54, v194
v_add_u32 v195, s54, v195
v_add_u32 v196, s54, v196
v_add_u32 v197, s54, v197
v_add_u32 v198, s54, v198
v_add_u32 v199, s54, v199
v_add_u32 v200, s54, v200
v_add_u32 v201, s54, v201
v_add_u32 v202, s54, v202
v_add_u32 v203, s54, v203
v_add_u32 v204, s54, v204
v_add_u32 v205, s54, v205
v_add_u32 v111, s54, v111
v_add_u32 v112, s54, v112
v_add_u32 v113, s54, v113
v_add_u32 v211, s45, v211
v_add_u32 v110, s55, v110
v_subrev_u32 v128, 94464, v110
v_subrev_u32 v129, 24576, v110
s_lshl_b32 s41, s54, 1
v_add_u32 v121, s41, v80
s_lshr_b32 s41, s32, 1
s_lshl_b32 s41, s41, 10
s_and_b32 s42, s32, 1
s_lshl_b32 s42, s42, 3
s_add_u32 s41, s41, s42
v_add_u32 v212, s41, v212
s_lshl_b32 s41, s32, 2
v_add_u32 v209, s41, v209
s_lshl_b32 s41, s32, 7
v_add_u32 v215, s41, v215
v_add_u32 v214, s41, v214
v_add_u32 v120, s41, v78
s_mul_i32 s41, s32, 4752
v_add_u32 v217, s41, v217
s_waitcnt lgkmcnt(0)
v_and_or_b32 v52, v52, v42, v43
v_lshl_or_b32 v52, v52, 16, v52
v_and_b32 v138, v52, v44
v_and_b32 v139, v52, v45
v_and_b32 v140, v52, v46
v_and_b32 v141, v52, v47
v_and_b32 v142, v48, v40
v_and_b32 v143, v48, v41
v_and_b32 v144, v49, v40
v_and_b32 v145, v49, v41
v_and_b32 v146, v50, v40
v_and_b32 v147, v50, v41
v_and_b32 v148, v51, v40
v_and_b32 v149, v51, v41
v_and_or_b32 v57, v57, v42, v43
v_lshl_or_b32 v57, v57, 16, v57
v_and_b32 v150, v57, v44
v_and_b32 v151, v57, v45
v_and_b32 v152, v57, v46
v_and_b32 v153, v57, v47
v_and_b32 v154, v53, v40
v_and_b32 v155, v53, v41
v_and_b32 v156, v54, v40
v_and_b32 v157, v54, v41
v_and_b32 v158, v55, v40
v_and_b32 v159, v55, v41
v_and_b32 v160, v56, v40
v_and_b32 v161, v56, v41
v_and_or_b32 v62, v62, v42, v43
v_lshl_or_b32 v62, v62, 16, v62
v_and_b32 v162, v62, v44
v_and_b32 v163, v62, v45
v_and_b32 v164, v62, v46
v_and_b32 v165, v62, v47
v_and_b32 v166, v58, v40
v_and_b32 v167, v58, v41
v_and_b32 v168, v59, v40
v_and_b32 v169, v59, v41
v_and_b32 v170, v60, v40
v_and_b32 v171, v60, v41
v_and_b32 v172, v61, v40
v_and_b32 v173, v61, v41
v_mov_b32 v190, 1065369472
v_mov_b32 v191, 1065369472
v_mov_b32 v192, 1065369472
v_mov_b32 v193, 1065369472
v_mov_b32 v218, 0
s_mov_b32 s30, 16712191
s_mov_b32 s31, 4278255360
s_mov_b32 s56, 2031647
s_mov_b32 s57, 2031647
s_waitcnt vmcnt(4) lgkmcnt(0)
s_barrier

s_cmp_lg_u32 s47, 0
s_cbranch_scc1 L_safe
.p2align 3
s_add_u32 s28, s28, 32
s_cmp_ge_u32 s28, 73
s_cselect_b32 s21, 73, 0
s_cselect_b32 s22, 1177344, 0
s_sub_u32 s28, s28, s21
s_add_u32 s20, s20, s22
s_add_u32 s20, s20, 86016
s_add_u32 m0, s96, 71488
s_mov_b32 exec_hi, 4194303
buffer_load_dwordx4 v82, s[4:7], s20 offen nt lds
s_mov_b32 exec_hi, -1
s_add_u32 s28, s28, 32
s_cmp_ge_u32 s28, 73
s_cselect_b32 s21, 73, 0
s_cselect_b32 s22, 1177344, 0
s_sub_u32 s28, s28, s21
s_add_u32 s20, s20, s22
s_add_u32 s20, s20, 86016
s_add_u32 m0, s96, 74960
s_mov_b32 exec_hi, 4194303
buffer_load_dwordx4 v82, s[4:7], s20 offen nt lds
s_mov_b32 exec_hi, -1
s_add_u32 s28, s28, 32
s_cmp_ge_u32 s28, 73
s_cselect_b32 s21, 73, 0
s_cselect_b32 s22, 1177344, 0
s_sub_u32 s28, s28, s21
s_add_u32 s20, s20, s22
s_add_u32 s20, s20, 86016
s_add_u32 m0, s96, 78432
s_mov_b32 exec_hi, 4194303
buffer_load_dwordx4 v82, s[4:7], s20 offen nt lds
s_mov_b32 exec_hi, -1
s_add_u32 s28, s28, 32
s_cmp_ge_u32 s28, 73
s_cselect_b32 s21, 73, 0
s_cselect_b32 s22, 1177344, 0
s_sub_u32 s28, s28, s21
s_add_u32 s20, s20, s22
s_add_u32 s20, s20, 86016
s_add_u32 m0, s96, 81904
s_mov_b32 exec_hi, 4194303
buffer_load_dwordx4 v82, s[4:7], s20 offen nt lds
s_mov_b32 exec_hi, -1
s_add_u32 s28, s28, 32
s_cmp_ge_u32 s28, 73
s_cselect_b32 s21, 73, 0
s_cselect_b32 s22, 1177344, 0
s_sub_u32 s28, s28, s21
s_add_u32 s20, s20, s22
s_add_u32 s20, s20, 86016
s_add_u32 m0, s96, 85376
s_mov_b32 exec_hi, 4194303
buffer_load_dwordx4 v82, s[4:7], s20 offen nt lds
s_mov_b32 exec_hi, -1
s_add_u32 s28, s28, 32
s_cmp_ge_u32 s28, 73
s_cselect_b32 s21, 73, 0
s_cselect_b32 s22, 1177344, 0
s_sub_u32 s28, s28, s21
s_add_u32 s20, s20, s22
s_add_u32 s20, s20, 86016
s_add_u32 m0, s96, 88848
s_mov_b32 exec_hi, 4194303
buffer_load_dwordx4 v82, s[4:7], s20 offen nt lds
s_mov_b32 exec_hi, -1
s_add_u32 s28, s28, 32
s_cmp_ge_u32 s28, 73
s_cselect_b32 s21, 73, 0
s_cselect_b32 s22, 1177344, 0
s_sub_u32 s28, s28, s21
s_add_u32 s20, s20, s22
s_add_u32 s20, s20, 86016
s_add_u32 m0, s96, 92320
s_mov_b32 exec_hi, 4194303
buffer_load_dwordx4 v82, s[4:7], s20 offen nt lds
s_mov_b32 exec_hi, -1
s_add_u32 s28, s28, 32
s_cmp_ge_u32 s28, 73
s_cselect_b32 s21, 73, 0
s_cselect_b32 s22, 1177344, 0
s_sub_u32 s28, s28, s21
s_add_u32 s20, s20, s22
s_add_u32 s20, s20, 86016
s_add_u32 m0, s96, 95792
s_mov_b32 exec_hi, 4194303
buffer_load_dwordx4 v82, s[4:7], s20 offen nt lds
s_mov_b32 exec_hi, -1
ds_read_b128 v[84:87], v200
ds_read_b128 v[92:95], v201
ds_read_b128 v[100:103], v202
ds_read_b128 v[88:91], v194 offset:16
ds_read_b128 v[96:99], v195 offset:16
s_mul_hi_u32 s41, s35, 58835169
s_mul_i32 s42, s41, 73
s_sub_u32 s42, s35, s42
s_mul_i32 s43, s41, 1373568
s_mul_i32 s51, s42, 2688
s_add_u32 s43, s43, s51
s_cmp_lt_u32 s35, s34
s_cselect_b32 s50, s43, 1879048192
s_add_u32 s35, s35, 32
s_cmp_eq_u32 s42, 0
s_cselect_b32 s44, 536870911, s72
s_cmp_eq_u32 s42, 72
s_cselect_b32 s44, 939524095, s44
s_cmp_eq_u32 s41, 0
s_cselect_b32 s52, 1879048192, s50
v_and_b32 v180, s44, v208
s_mov_b32 s37, s50
s_mul_hi_u32 s41, s35, 58835169
ds_read_b128 v[104:107], v196 offset:16
s_waitcnt lgkmcnt(5)
v_mfma_f32_16x16x32_bf16 v[0:3], v[138:141], v[84:87], 0
s_waitcnt lgkmcnt(4)
ds_read_b128 v[84:87], v194
s_mov_b64 exec, s[30:31]
ds_write_b128 v217, v[138:141]
s_mov_b64 exec, -1
v_mfma_f32_16x16x32_bf16 v[12:15], v[138:141], v[92:95], 0
s_mul_i32 s42, s41, 73
s_mul_i32 s43, s41, 1373568
s_waitcnt lgkmcnt(5)
v_mfma_f32_16x16x32_bf16 v[24:27], v[138:141], v[100:103], 0
s_mov_b32 s38, s36
ds_read_b128 v[92:95], v195
ds_read_b128 v[100:103], v196
s_mov_b64 exec, s[30:31]
ds_write_b128 v217, v[142:145] offset:528
s_mov_b64 exec, -1
s_add_u32 s28, s28, 32
s_cmp_ge_u32 s28, 73
s_cselect_b32 s21, 73, 0
s_cselect_b32 s22, 1177344, 0
s_sub_u32 s28, s28, s21
s_add_u32 s20, s20, s22
s_add_u32 s20, s20, 86016
s_add_u32 m0, s96, 99264
s_mov_b32 exec_hi, 4194303
buffer_load_dwordx4 v82, s[4:7], s20 offen nt lds
s_mov_b32 exec_hi, -1
s_waitcnt lgkmcnt(4)
v_smfmac_f32_16x16x64_bf16 v[0:3], v[142:145], v[84:91], v213
s_mov_b32 s39, s37
ds_read_b128 v[84:87], v197
ds_read_b128 v[88:91], v197 offset:16
s_mov_b64 exec, s[30:31]
ds_write_b128 v217, v[146:149] offset:1056
s_mov_b64 exec, -1
s_waitcnt lgkmcnt(5)
v_smfmac_f32_16x16x64_bf16 v[12:15], v[142:145], v[92:99], v213
s_waitcnt lgkmcnt(4)
v_smfmac_f32_16x16x64_bf16 v[24:27], v[142:145], v[100:107], v213
ds_read_b128 v[92:95], v198
ds_read_b128 v[96:99], v198 offset:16
ds_read_b128 v[100:103], v199
ds_read_b128 v[104:107], v199 offset:16
s_waitcnt lgkmcnt(5)
v_smfmac_f32_16x16x64_bf16 v[0:3], v[146:149], v[84:91], v213
ds_read_b128 v[84:87], v200 offset:32
ds_read_b128 v[88:91], v194 offset:48
s_mov_b64 exec, s[30:31]
ds_write_b128 v217, v[150:153] offset:1584
s_mov_b64 exec, -1
v_add_f32 v118, v0, v1
v_mul_f32 v119, v0, v0
v_add_f32 v118, v118, v2
v_fmac_f32 v119, v1, v1
v_add_f32 v118, v118, v3
v_fmac_f32_e64 v119, v2, v2
v_fmac_f32 v119, v3, v3
s_waitcnt lgkmcnt(5)
v_smfmac_f32_16x16x64_bf16 v[12:15], v[146:149], v[92:99], v213
s_add_u32 s28, s28, 32
s_cmp_ge_u32 s28, 73
s_cselect_b32 s21, 73, 0
s_cselect_b32 s22, 1177344, 0
s_sub_u32 s28, s28, s21
s_add_u32 s20, s20, s22
s_add_u32 s20, s20, 86016
s_add_u32 m0, s96, 102736
s_mov_b32 exec_hi, 4194303
buffer_load_dwordx4 v82, s[4:7], s20 offen nt lds
s_mov_b32 exec_hi, -1
s_waitcnt lgkmcnt(3)
v_smfmac_f32_16x16x64_bf16 v[24:27], v[146:149], v[100:107], v213
s_waitcnt lgkmcnt(2)
ds_read_b128 v[92:95], v201 offset:32
ds_read_b128 v[100:103], v202 offset:32
v_mfma_f32_16x16x32_bf16 v[4:7], v[150:153], v[84:87], 0
ds_read_b128 v[84:87], v194 offset:32
ds_read_b128 v[96:99], v195 offset:48
ds_read_b128 v[104:107], v196 offset:48
v_add_f32 v126, v12, v13
v_mul_f32 v127, v12, v12
v_add_f32 v126, v126, v14
v_fmac_f32 v127, v13, v13
v_add_f32 v126, v126, v15
v_fmac_f32 v127, v14, v14
v_fmac_f32 v127, v15, v15
v_add_f32 v134, v24, v25
v_mul_f32 v135, v24, v24
v_add_f32 v134, v134, v26
v_fmac_f32 v135, v25, v25
v_add_f32 v134, v134, v27
v_fmac_f32_e64 v135, v26, v26
v_fmac_f32 v135, v27, v27
s_waitcnt lgkmcnt(4)
v_mfma_f32_16x16x32_bf16 v[16:19], v[150:153], v[92:95], 0
ds_read_b128 v[92:95], v195 offset:32
s_mov_b64 exec, s[30:31]
ds_write_b128 v217, v[154:157] offset:2112
s_mov_b64 exec, -1
s_waitcnt lgkmcnt(5)
v_mfma_f32_16x16x32_bf16 v[28:31], v[150:153], v[100:103], 0
s_waitcnt lgkmcnt(4)
v_smfmac_f32_16x16x64_bf16 v[4:7], v[154:157], v[84:91], v213
ds_read_b128 v[100:103], v196 offset:32
ds_read_b128 v[84:87], v197 offset:32
ds_read_b128 v[88:91], v197 offset:48
s_mov_b64 exec, s[30:31]
ds_write_b128 v217, v[158:161] offset:2640
s_mov_b64 exec, -1
s_waitcnt lgkmcnt(5)
v_smfmac_f32_16x16x64_bf16 v[16:19], v[154:157], v[92:99], v213
s_add_u32 s28, s28, 32
s_cmp_ge_u32 s28, 73
s_cselect_b32 s21, 73, 0
s_cselect_b32 s22, 1177344, 0
s_sub_u32 s28, s28, s21
s_add_u32 s20, s20, s22
s_add_u32 s20, s20, 86016
s_add_u32 m0, s96, 106208
s_mov_b32 exec_hi, 4194303
buffer_load_dwordx4 v82, s[4:7], s20 offen nt lds
s_mov_b32 exec_hi, -1
s_waitcnt lgkmcnt(3)
v_smfmac_f32_16x16x64_bf16 v[28:31], v[154:157], v[100:107], v213
ds_read_b128 v[92:95], v198 offset:32
ds_read_b128 v[96:99], v198 offset:48
ds_read_b128 v[100:103], v199 offset:32
ds_read_b128 v[104:107], v199 offset:48
s_waitcnt lgkmcnt(5)
v_smfmac_f32_16x16x64_bf16 v[4:7], v[158:161], v[84:91], v213
ds_read_b128 v[84:87], v200 offset:64
ds_read_b128 v[88:91], v194 offset:80
s_mov_b64 exec, s[30:31]
ds_write_b128 v217, v[162:165] offset:3168
s_mov_b64 exec, -1
v_add_f32 v118, v118, v4
v_fmac_f32 v119, v4, v4
v_add_f32 v118, v118, v5
v_fmac_f32 v119, v5, v5
v_add_f32 v118, v118, v6
v_fmac_f32 v119, v6, v6
v_add_f32 v118, v118, v7
v_fmac_f32 v119, v7, v7
s_waitcnt lgkmcnt(5)
v_smfmac_f32_16x16x64_bf16 v[16:19], v[158:161], v[92:99], v213
s_nop 0
ds_read_b128 v[92:95], v201 offset:64
ds_read_b128 v[96:99], v195 offset:80
s_waitcnt lgkmcnt(5)
v_smfmac_f32_16x16x64_bf16 v[28:31], v[158:161], v[100:107], v213
ds_read_b128 v[100:103], v202 offset:64
s_waitcnt lgkmcnt(5)
v_mfma_f32_16x16x32_bf16 v[8:11], v[162:165], v[84:87], 0
ds_read_b128 v[84:87], v194 offset:64
v_add_f32 v126, v126, v16
v_fmac_f32 v127, v16, v16
v_add_f32 v126, v126, v17
v_fmac_f32 v127, v17, v17
v_add_f32 v126, v126, v18
v_fmac_f32 v127, v18, v18
v_add_f32 v126, v126, v19
v_fmac_f32 v127, v19, v19
v_add_f32 v134, v134, v28
v_fmac_f32 v135, v28, v28
v_add_f32 v134, v134, v29
v_fmac_f32 v135, v29, v29
v_add_f32 v134, v134, v30
s_add_u32 s28, s28, 32
s_cmp_ge_u32 s28, 73
s_cselect_b32 s21, 73, 0
s_cselect_b32 s22, 1177344, 0
s_sub_u32 s28, s28, s21
s_add_u32 s20, s20, s22
s_add_u32 s20, s20, 86016
s_add_u32 m0, s96, 109680
s_mov_b32 exec_hi, 4194303
buffer_load_dwordx4 v82, s[4:7], s20 offen nt lds
s_mov_b32 exec_hi, -1
s_waitcnt lgkmcnt(3)
v_mfma_f32_16x16x32_bf16 v[20:23], v[162:165], v[92:95], 0
s_waitcnt lgkmcnt(1)
ds_read_b128 v[92:95], v195 offset:64
ds_read_b128 v[104:107], v196 offset:80
v_mfma_f32_16x16x32_bf16 v[32:35], v[162:165], v[100:103], 0
s_waitcnt lgkmcnt(2)
ds_read_b128 v[100:103], v196 offset:64
v_fmac_f32 v135, v30, v30
v_smfmac_f32_16x16x64_bf16 v[8:11], v[166:169], v[84:91], v213
ds_read_b128 v[84:87], v197 offset:64
ds_read_b128 v[88:91], v197 offset:80
v_add_f32_e64 v134, v134, v31
v_fmac_f32 v135, v31, v31
s_mov_b64 exec, s[30:31]
ds_write_b128 v217, v[166:169] offset:3696
s_mov_b64 exec, -1
s_waitcnt lgkmcnt(5)
v_smfmac_f32_16x16x64_bf16 v[20:23], v[166:169], v[92:99], v213
ds_read_b128 v[92:95], v198 offset:64
ds_read_b128 v[96:99], v198 offset:80
s_mov_b64 exec, s[30:31]
ds_write_b128 v217, v[170:173] offset:4224
s_mov_b64 exec, -1
s_waitcnt lgkmcnt(6)
v_smfmac_f32_16x16x64_bf16 v[32:35], v[166:169], v[100:107], v213
s_waitcnt lgkmcnt(4)
v_smfmac_f32_16x16x64_bf16 v[8:11], v[170:173], v[84:91], v213
ds_read_b128 v[100:103], v199 offset:64
ds_read_b128 v[104:107], v199 offset:80
s_nop 4
v_add_f32 v118, v118, v8
v_fmac_f32_e64 v119, v8, v8
v_add_f32 v118, v118, v9
s_add_u32 s28, s28, 32
s_cmp_ge_u32 s28, 73
s_cselect_b32 s21, 73, 0
s_cselect_b32 s22, 1177344, 0
s_sub_u32 s28, s28, s21
s_add_u32 s20, s20, s22
s_add_u32 s20, s20, 86016
s_add_u32 m0, s96, 113152
s_mov_b32 exec_hi, 4194303
buffer_load_dwordx4 v82, s[4:7], s20 offen nt lds
s_mov_b32 exec_hi, -1
s_waitcnt lgkmcnt(3)
v_smfmac_f32_16x16x64_bf16 v[20:23], v[170:173], v[92:99], v213
v_fmac_f32 v119, v9, v9
v_add_f32 v118, v118, v10
v_fmac_f32 v119, v10, v10
v_add_f32 v118, v118, v11
v_fmac_f32 v119, v11, v11
s_nop 1
v_add_f32 v126, v126, v20
v_fmac_f32 v127, v20, v20
v_add_f32 v126, v126, v21
v_fmac_f32 v127, v21, v21
v_add_f32 v126, v126, v22
s_waitcnt lgkmcnt(0)
v_smfmac_f32_16x16x64_bf16 v[32:35], v[170:173], v[100:107], v213
v_fmac_f32 v127, v22, v22
v_add_f32 v126, v126, v23
v_fmac_f32 v127, v23, v23
v_permlane16_swap_b32 v118, v119
v_add_f32 v118, v118, v119
s_nop 0
v_add_f32 v134, v134, v32
v_fmac_f32 v135, v32, v32
v_add_f32 v134, v134, v33
v_fmac_f32 v135, v33, v33
v_add_f32 v134, v134, v34
v_fmac_f32 v135, v34, v34
v_add_f32 v134, v134, v35
v_fmac_f32 v135, v35, v35
v_permlane16_swap_b32 v126, v127
v_add_f32 v126, v126, v127
v_permlane16_swap_b32 v134, v135
v_add_f32 v134, v134, v135
v_permlane32_swap_b32 v118, v126
v_add_f32 v118, v118, v126
v_mov_b32 v135, v134
ds_write_b32 v209, v118
v_permlane32_swap_b32 v134, v135
v_add_f32 v134, v134, v135
ds_write_b32 v209, v134 offset:512
s_add_u32 s28, s28, 32
s_cmp_ge_u32 s28, 73
s_cselect_b32 s21, 73, 0
s_cselect_b32 s22, 1177344, 0
s_sub_u32 s28, s28, s21
s_add_u32 s20, s20, s22
s_add_u32 s20, s20, 86016
s_add_u32 m0, s96, 116624
s_mov_b32 exec_hi, 4194303
buffer_load_dwordx4 v82, s[4:7], s20 offen nt lds
s_mov_b32 exec_hi, -1
s_waitcnt lgkmcnt(0)
s_barrier
ds_read_b128 v[102:105], v210 offset:18432
ds_read_b128 v[106:109], v210 offset:19456
s_waitcnt lgkmcnt(1)
v_add_f32 v102, v102, v103
v_add_f32 v104, v104, v105
v_add_f32 v102, v102, v104
v_mul_f32 v103, s48, v102
v_mul_f32 v104, s73, v102
s_waitcnt lgkmcnt(0)
v_add_f32 v106, v106, v107
v_add_f32 v108, v108, v109
v_add_f32 v106, v106, v108
v_mul_f32 v106, s73, v106
v_fma_f32 v106, -v103, v104, v106
v_max_f32 v106, 0, v106
v_add_f32 v106, s49, v106
v_rsq_f32 v102, v106
s_nop 0
v_mul_f32_e64 v103, -v103, v102
ds_write_b64 v211, v[102:103]
ds_read_b64 v[118:119], v219
ds_read_b64 v[126:127], v219 offset:256
ds_read_b64 v[134:135], v219 offset:512
s_add_u32 s28, s28, 32
s_cmp_ge_u32 s28, 73
s_cselect_b32 s21, 73, 0
s_cselect_b32 s22, 1177344, 0
s_sub_u32 s28, s28, s21
s_add_u32 s20, s20, s22
s_add_u32 s20, s20, 86016
s_add_u32 m0, s96, 120096
s_mov_b32 exec_hi, 4194303
buffer_load_dwordx4 v82, s[4:7], s20 offen nt lds
s_mov_b32 exec_hi, -1
s_waitcnt lgkmcnt(2)
v_fma_f32 v220, v0, v118, v119
v_fma_f32 v221, v1, v118, v119
v_cvt_pk_bf16_f32 v90, v220, v221
v_fma_f32 v222, v2, v118, v119
v_fma_f32 v223, v3, v118, v119
v_cvt_pk_bf16_f32 v91, v222, v223
v_fma_f32 v220, v4, v118, v119
v_fma_f32 v221, v5, v118, v119
v_cvt_pk_bf16_f32 v92, v220, v221
v_fma_f32 v222, v6, v118, v119
v_fma_f32 v223, v7, v118, v119
v_cvt_pk_bf16_f32 v93, v222, v223
v_fma_f32 v220, v8, v118, v119
v_fma_f32 v221, v9, v118, v119
v_cvt_pk_bf16_f32 v94, v220, v221
v_fma_f32 v222, v10, v118, v119
v_fma_f32 v223, v11, v118, v119
v_cvt_pk_bf16_f32 v95, v222, v223
s_waitcnt lgkmcnt(0)
v_fma_f32 v220, v12, v126, v127
v_fma_f32 v221, v13, v126, v127
v_cvt_pk_bf16_f32 v174, v220, v221
v_fma_f32 v222, v14, v126, v127
v_fma_f32 v223, v15, v126, v127
v_cvt_pk_bf16_f32 v175, v222, v223
v_fma_f32 v220, v16, v126, v127
v_fma_f32 v221, v17, v126, v127
v_cvt_pk_bf16_f32 v176, v220, v221
v_fma_f32 v222, v18, v126, v127
v_fma_f32 v223, v19, v126, v127
v_cvt_pk_bf16_f32 v177, v222, v223
v_fma_f32 v220, v20, v126, v127
v_fma_f32 v221, v21, v126, v127
v_cvt_pk_bf16_f32 v178, v220, v221
v_fma_f32 v222, v22, v126, v127
v_fma_f32 v223, v23, v126, v127
v_cvt_pk_bf16_f32 v179, v222, v223
v_fma_f32 v220, v24, v134, v135
v_fma_f32 v221, v25, v134, v135
v_fma_f32 v222, v26, v134, v135
v_fma_f32 v223, v27, v134, v135
ds_write_b128 v211, v[90:93]
v_cvt_pk_bf16_f32 v90, v220, v221
v_cvt_pk_bf16_f32 v91, v222, v223
v_fma_f32 v220, v28, v134, v135
v_fma_f32 v221, v29, v134, v135
v_cvt_pk_bf16_f32 v92, v220, v221
s_add_u32 s28, s28, 32
s_cmp_ge_u32 s28, 73
s_cselect_b32 s21, 73, 0
s_cselect_b32 s22, 1177344, 0
s_sub_u32 s28, s28, s21
s_add_u32 s20, s20, s22
s_add_u32 s20, s20, 86016
s_add_u32 m0, s96, 123568
s_mov_b32 exec_hi, 4194303
buffer_load_dwordx4 v82, s[4:7], s20 offen nt lds
s_mov_b32 exec_hi, -1
ds_write_b64 v212, v[94:95]
v_fma_f32 v222, v30, v134, v135
v_fma_f32 v223, v31, v134, v135
v_cvt_pk_bf16_f32 v93, v222, v223
v_fma_f32 v220, v32, v134, v135
v_fma_f32 v221, v33, v134, v135
v_cvt_pk_bf16_f32 v94, v220, v221
v_fma_f32 v222, v34, v134, v135
v_fma_f32 v223, v35, v134, v135
v_cvt_pk_bf16_f32 v95, v222, v223
ds_write_b128 v211, v[174:177] offset:6144
ds_write_b64 v212, v[178:179] offset:6144
ds_write_b128 v211, v[90:93] offset:12288
ds_write_b64 v212, v[94:95] offset:12288
s_add_u32 s28, s28, 32
s_cmp_ge_u32 s28, 73
s_cselect_b32 s21, 73, 0
s_cselect_b32 s22, 1177344, 0
s_sub_u32 s28, s28, s21
s_add_u32 s20, s20, s22
s_add_u32 s20, s20, 86016
s_add_u32 s21, s33, 640
s_cmp_lt_u32 s21, s34
s_cselect_b32 s20, s20, 1879048192
s_add_u32 m0, s96, 127040
s_mov_b32 exec_hi, 4194303
buffer_load_dwordx4 v82, s[4:7], s20 offen nt lds
s_mov_b32 exec_hi, -1
s_add_u32 m0, s55, 131328
s_add_u32 s29, s54, 384
buffer_load_dwordx4 v72, s[12:15], s29 offen lds
s_add_u32 m0, s55, 132352
s_add_u32 s29, s54, 384
buffer_load_dwordx4 v73, s[12:15], s29 offen lds
s_add_u32 m0, s55, 133376
s_add_u32 s29, s54, 384
buffer_load_dwordx4 v74, s[12:15], s29 offen lds
s_add_u32 m0, s55, 0
s_add_u32 s29, s54, 37248
buffer_load_dwordx4 v72, s[12:15], s29 offen lds
s_add_u32 m0, s55, 1024
s_add_u32 s29, s54, 37248
buffer_load_dwordx4 v73, s[12:15], s29 offen lds
s_add_u32 m0, s55, 2048
s_add_u32 s29, s54, 37248
buffer_load_dwordx4 v74, s[12:15], s29 offen lds
s_add_u32 m0, s55, 12288
s_add_u32 s29, s54, 74112
buffer_load_dwordx4 v72, s[12:15], s29 offen lds
s_add_u32 m0, s55, 13312
s_add_u32 s29, s54, 74112
buffer_load_dwordx4 v73, s[12:15], s29 offen lds
s_add_u32 m0, s55, 14336
s_add_u32 s29, s54, 74112
buffer_load_dwordx4 v74, s[12:15], s29 offen lds
s_add_u32 m0, s55, 24576
s_add_u32 s29, s54, 110976
buffer_load_dwordx4 v72, s[12:15], s29 offen lds
s_add_u32 m0, s55, 25600
s_add_u32 s29, s54, 110976
buffer_load_dwordx4 v73, s[12:15], s29 offen lds
s_add_u32 m0, s55, 26624
s_add_u32 s29, s54, 110976
buffer_load_dwordx4 v74, s[12:15], s29 offen lds
s_waitcnt vmcnt(3) lgkmcnt(0)
ds_read_b64_tr_b16 a[0:1], v110 offset:36864
ds_read_b64_tr_b16 a[24:25], v110 offset:36896
ds_read_b64_tr_b16 a[48:49], v110 offset:36928
ds_read_b64_tr_b16 a[2:3], v110 offset:38400
ds_read_b64_tr_b16 a[26:27], v110 offset:38432
ds_read_b64_tr_b16 a[50:51], v110 offset:38464
ds_read_b64_tr_b16 a[4:5], v128 offset:1536
ds_read_b64_tr_b16 a[28:29], v128 offset:1568
ds_read_b64_tr_b16 a[52:53], v128 offset:1600
ds_read_b64_tr_b16 a[16:17], v128
ds_read_b64_tr_b16 a[40:41], v128 offset:32
ds_read_b64_tr_b16 a[64:65], v128 offset:64
ds_read_b64_tr_b16 a[6:7], v128 offset:12288
s_barrier
ds_read_b64_tr_b16 a[30:31], v128 offset:12320
ds_read_b64_tr_b16 a[54:55], v128 offset:12352
ds_read_b64_tr_b16 a[18:19], v128 offset:13824
ds_read_b64_tr_b16 a[42:43], v128 offset:13856
ds_read_b64_tr_b16 a[66:67], v128 offset:13888
s_waitcnt vmcnt(1)
ds_read_b64_tr_b16 a[8:9], v128 offset:24576
ds_read_b64_tr_b16 a[32:33], v128 offset:24608
ds_read_b64_tr_b16 a[56:57], v128 offset:24640
s_waitcnt vmcnt(0)
ds_read_b64_tr_b16 a[10:11], v128 offset:26112
ds_read_b64_tr_b16 a[34:35], v128 offset:26144
ds_read_b64_tr_b16 a[58:59], v128 offset:26176
ds_read_b128 v[84:87], v113
ds_read_b128 v[92:95], v113 offset:55552
ds_read_b128 v[100:103], v111
ds_read_b128 v[104:107], v111 offset:16
ds_read_b128 v[88:91], v111 offset:55568
ds_read_b128 v[96:99], v112 offset:16
s_waitcnt lgkmcnt(5)
v_mfma_f32_16x16x32_bf16 v[36:39], v[138:141], v[84:87], 0
ds_read_b128 v[84:87], v111 offset:55552
s_waitcnt lgkmcnt(5)
v_mfma_f32_16x16x32_bf16 v[48:51], v[138:141], v[92:95], 0
s_nop 0
ds_read_b128 v[92:95], v112
s_waitcnt lgkmcnt(4)
v_smfmac_f32_16x16x64_bf16 v[36:39], v[142:145], v[100:107], v213
ds_read_b128 v[100:103], v112 offset:55552
ds_read_b128 v[104:107], v112 offset:55568
s_waitcnt lgkmcnt(3)
v_smfmac_f32_16x16x64_bf16 v[48:51], v[142:145], v[84:91], v213
ds_read_b128 v[84:87], v113 offset:32
ds_read_b128 v[88:91], v111 offset:55600
s_waitcnt lgkmcnt(4)
v_smfmac_f32_16x16x64_bf16 v[36:39], v[146:149], v[92:99], v213
ds_read_b128 v[92:95], v113 offset:55584
ds_read_b128 v[96:99], v112 offset:48
s_nop 4
v_add_f32 v118, v36, v37
v_mul_f32 v119, v36, v36
v_add_f32 v118, v118, v38
v_fmac_f32 v119, v37, v37
s_waitcnt lgkmcnt(4)
v_smfmac_f32_16x16x64_bf16 v[48:51], v[146:149], v[100:107], v213
ds_read_b128 v[100:103], v111 offset:32
ds_read_b128 v[104:107], v111 offset:48
v_add_f32 v118, v118, v39
v_fmac_f32 v119, v38, v38
v_fmac_f32 v119, v39, v39
s_waitcnt lgkmcnt(5)
v_mfma_f32_16x16x32_bf16 v[40:43], v[150:153], v[84:87], 0
ds_read_b128 v[84:87], v111 offset:55584
v_add_f32 v126, v48, v49
v_mul_f32 v127, v48, v48
v_add_f32_e64 v126, v126, v50
v_fmac_f32 v127, v49, v49
s_waitcnt lgkmcnt(4)
v_mfma_f32_16x16x32_bf16 v[52:55], v[150:153], v[92:95], 0
ds_read_b128 v[92:95], v112 offset:32
v_add_f32 v126, v126, v51
v_fmac_f32 v127, v50, v50
v_fmac_f32 v127, v51, v51
s_waitcnt lgkmcnt(2)
v_smfmac_f32_16x16x64_bf16 v[40:43], v[154:157], v[100:107], v213
s_nop 0
ds_read_b128 v[100:103], v112 offset:55584
ds_read_b128 v[104:107], v112 offset:55600
s_waitcnt lgkmcnt(3)
v_smfmac_f32_16x16x64_bf16 v[52:55], v[154:157], v[84:91], v213
ds_read_b128 v[84:87], v113 offset:64
ds_read_b128 v[88:91], v111 offset:55632
s_waitcnt lgkmcnt(4)
v_smfmac_f32_16x16x64_bf16 v[40:43], v[158:161], v[92:99], v213
ds_read_b128 v[92:95], v113 offset:55616
ds_read_b128 v[96:99], v112 offset:80
s_nop 4
v_add_f32 v118, v118, v40
v_fmac_f32 v119, v40, v40
v_add_f32 v118, v118, v41
v_fmac_f32 v119, v41, v41
v_add_f32 v118, v118, v42
v_fmac_f32 v119, v42, v42
v_add_f32 v118, v118, v43
v_fmac_f32 v119, v43, v43
s_waitcnt lgkmcnt(4)
v_smfmac_f32_16x16x64_bf16 v[52:55], v[158:161], v[100:107], v213
s_waitcnt lgkmcnt(3)
ds_read_b128 v[100:103], v111 offset:64
ds_read_b128 v[104:107], v111 offset:80
v_mfma_f32_16x16x32_bf16 v[44:47], v[162:165], v[84:87], 0
ds_read_b128 v[84:87], v111 offset:55616
s_waitcnt lgkmcnt(4)
v_mfma_f32_16x16x32_bf16 v[56:59], v[162:165], v[92:95], 0
ds_read_b128 v[92:95], v112 offset:64
v_add_f32 v126, v126, v52
v_fmac_f32 v127, v52, v52
v_add_f32 v126, v126, v53
v_fmac_f32 v127, v53, v53
v_add_f32 v126, v126, v54
v_fmac_f32 v127, v54, v54
v_add_f32 v126, v126, v55
v_fmac_f32 v127, v55, v55
s_waitcnt lgkmcnt(2)
v_smfmac_f32_16x16x64_bf16 v[44:47], v[166:169], v[100:107], v213
ds_read_b128 v[100:103], v112 offset:55616
ds_read_b128 v[104:107], v112 offset:55632
s_waitcnt lgkmcnt(3)
v_smfmac_f32_16x16x64_bf16 v[56:59], v[166:169], v[84:91], v213
s_waitcnt lgkmcnt(2)
v_smfmac_f32_16x16x64_bf16 v[44:47], v[170:173], v[92:99], v213
s_nop 7
v_add_f32 v118, v118, v44
v_fmac_f32 v119, v44, v44
v_add_f32 v118, v118, v45
v_fmac_f32 v119, v45, v45
v_add_f32 v118, v118, v46
v_fmac_f32 v119, v46, v46
v_add_f32 v118, v118, v47
v_fmac_f32 v119, v47, v47
s_waitcnt lgkmcnt(0)
v_smfmac_f32_16x16x64_bf16 v[56:59], v[170:173], v[100:107], v213
s_barrier
s_add_u32 m0, s55, 94464
s_add_u32 s29, s54, 147840
buffer_load_dwordx4 v72, s[12:15], s29 offen lds
s_add_u32 m0, s55, 95488
s_add_u32 s29, s54, 147840
buffer_load_dwordx4 v73, s[12:15], s29 offen lds
s_add_u32 m0, s55, 96512
s_add_u32 s29, s54, 147840
buffer_load_dwordx4 v74, s[12:15], s29 offen lds
s_add_u32 m0, s55, 106752
s_add_u32 s29, s54, 184704
buffer_load_dwordx4 v72, s[12:15], s29 offen lds
s_add_u32 m0, s55, 107776
s_add_u32 s29, s54, 184704
buffer_load_dwordx4 v73, s[12:15], s29 offen lds
s_nop 1
v_add_f32 v126, v126, v56
v_fmac_f32 v127, v56, v56
v_add_f32 v126, v126, v57
v_fmac_f32 v127, v57, v57
s_add_u32 m0, s55, 108800
s_add_u32 s29, s54, 184704
buffer_load_dwordx4 v74, s[12:15], s29 offen lds
v_add_f32 v126, v126, v58
v_fmac_f32 v127, v58, v58
v_add_f32 v126, v126, v59
v_fmac_f32 v127, v59, v59
v_permlane16_swap_b32 v118, v119
v_add_f32 v118, v118, v119
v_permlane16_swap_b32 v126, v127
v_add_f32 v126, v126, v127
s_add_u32 m0, s55, 119040
s_add_u32 s29, s54, 0
buffer_load_dwordx4 v72, s[12:15], s29 offen lds
s_nop 0
v_permlane32_swap_b32 v118, v126
v_add_f32 v118, v118, v126
ds_write_b32 v209, v118
s_add_u32 m0, s55, 120064
s_add_u32 s29, s54, 0
buffer_load_dwordx4 v73, s[12:15], s29 offen lds
s_waitcnt lgkmcnt(0)
s_barrier
ds_read_b128 v[102:105], v210 offset:18432
ds_read_b128 v[106:109], v210 offset:19456
s_add_u32 m0, s55, 121088
s_add_u32 s29, s54, 0
buffer_load_dwordx4 v74, s[12:15], s29 offen lds
s_add_u32 m0, s55, 69888
s_add_u32 s29, s54, 36864
buffer_load_dwordx4 v72, s[12:15], s29 offen lds
s_waitcnt lgkmcnt(0)
v_add_f32 v102, v102, v103
v_add_f32 v104, v104, v105
v_add_f32 v102, v102, v104
v_mul_f32 v103, s48, v102
v_mul_f32 v104, s73, v102
v_add_f32 v106, v106, v107
v_add_f32 v108, v108, v109
v_add_f32 v106, v106, v108
v_mul_f32 v106, s73, v106
v_fma_f32 v106, -v103, v104, v106
s_add_u32 m0, s55, 70912
s_add_u32 s29, s54, 36864
buffer_load_dwordx4 v73, s[12:15], s29 offen lds
v_max_f32 v106, 0, v106
v_add_f32 v106, s49, v106
v_rsq_f32_e64 v102, v106
s_nop 0
v_mul_f32_e64 v103, -v103, v102
ds_write_b64 v211, v[102:103] offset:20480
s_add_u32 m0, s55, 71936
s_add_u32 s29, s54, 36864
buffer_load_dwordx4 v74, s[12:15], s29 offen lds
ds_read_b64 v[118:119], v219 offset:20480
ds_read_b64 v[126:127], v219 offset:20736
s_add_u32 m0, s55, 82176
s_add_u32 s29, s54, 73728
buffer_load_dwordx4 v72, s[12:15], s29 offen lds
s_waitcnt vmcnt(11) lgkmcnt(1)
ds_read_b64_tr_b16 a[20:21], v110
ds_read_b64_tr_b16 a[44:45], v110 offset:32
ds_read_b64_tr_b16 a[68:69], v110 offset:64
v_fma_f32 v220, v36, v118, v119
v_fma_f32 v221, v37, v118, v119
v_cvt_pk_bf16_f32 v90, v220, v221
v_fma_f32 v222, v38, v118, v119
v_fma_f32 v223, v39, v118, v119
v_cvt_pk_bf16_f32 v91, v222, v223
v_fma_f32 v220, v40, v118, v119
v_fma_f32 v221, v41, v118, v119
s_add_u32 m0, s55, 83200
s_add_u32 s29, s54, 73728
buffer_load_dwordx4 v73, s[12:15], s29 offen lds
v_cvt_pk_bf16_f32 v92, v220, v221
v_fma_f32 v222, v42, v118, v119
s_waitcnt vmcnt(11)
ds_read_b64_tr_b16 a[12:13], v110 offset:1536
ds_read_b64_tr_b16 a[36:37], v110 offset:1568
ds_read_b64_tr_b16 a[60:61], v110 offset:1600
v_fma_f32 v223, v43, v118, v119
v_cvt_pk_bf16_f32 v93, v222, v223
v_fma_f32 v220, v44, v118, v119
v_fma_f32 v221, v45, v118, v119
v_cvt_pk_bf16_f32 v94, v220, v221
s_waitcnt lgkmcnt(6)
s_add_u32 m0, s55, 84224
s_add_u32 s29, s54, 73728
buffer_load_dwordx4 v74, s[12:15], s29 offen lds
ds_write_b128 v211, v[90:93] offset:20480
v_fma_f32 v222, v46, v118, v119
v_fma_f32 v223, v47, v118, v119
v_cvt_pk_bf16_f32 v95, v222, v223
v_fma_f32 v220, v48, v126, v127
v_fma_f32 v221, v49, v126, v127
v_cvt_pk_bf16_f32 v174, v220, v221
s_add_u32 m0, s55, 131328
s_add_u32 s29, s54, 110592
buffer_load_dwordx4 v72, s[12:15], s29 offen lds
ds_write_b64 v212, v[94:95] offset:20480
v_fma_f32 v222, v50, v126, v127
v_fma_f32 v223, v51, v126, v127
s_waitcnt vmcnt(11)
ds_read_b64_tr_b16 a[14:15], v110 offset:12288
ds_read_b64_tr_b16 a[38:39], v110 offset:12320
ds_read_b64_tr_b16 a[62:63], v110 offset:12352
v_cvt_pk_bf16_f32 v175, v222, v223
v_fma_f32 v220, v52, v126, v127
s_add_u32 m0, s55, 132352
s_add_u32 s29, s54, 110592
buffer_load_dwordx4 v73, s[12:15], s29 offen lds
v_fma_f32 v221, v53, v126, v127
v_cvt_pk_bf16_f32 v176, v220, v221
s_waitcnt vmcnt(11)
ds_read_b64_tr_b16 a[22:23], v110 offset:13824
ds_read_b64_tr_b16 a[46:47], v110 offset:13856
v_fma_f32 v222, v54, v126, v127
v_fma_f32 v223, v55, v126, v127
v_cvt_pk_bf16_f32 v177, v222, v223
v_fma_f32 v220, v56, v126, v127
v_fma_f32 v221, v57, v126, v127
v_cvt_pk_bf16_f32 v178, v220, v221
s_add_u32 m0, s55, 133376
s_add_u32 s29, s54, 110592
buffer_load_dwordx4 v74, s[12:15], s29 offen lds
v_fma_f32 v222, v58, v126, v127
v_fma_f32 v223, v59, v126, v127
v_cvt_pk_bf16_f32 v179, v222, v223
ds_read_b64_tr_b16 a[70:71], v110 offset:13888
ds_write_b128 v211, v[174:177] offset:26624
s_waitcnt lgkmcnt(9)
s_add_u32 m0, s55, 94464
s_add_u32 s29, s54, 147456
buffer_load_dwordx4 v72, s[12:15], s29 offen lds
s_waitcnt vmcnt(11)
ds_read_b64_tr_b16 a[216:217], v110 offset:24576
ds_read_b64_tr_b16 a[240:241], v110 offset:24608
ds_read_b64_tr_b16 v[232:233], v110 offset:24640
ds_write_b64 v212, v[178:179] offset:26624
ds_read_b128 v[174:177], v217
s_add_u32 m0, s55, 95488
s_add_u32 s29, s54, 147456
buffer_load_dwordx4 v73, s[12:15], s29 offen lds
s_waitcnt vmcnt(11)
ds_read_b64_tr_b16 a[218:219], v110 offset:26112
ds_read_b64_tr_b16 a[242:243], v110 offset:26144
ds_read_b64_tr_b16 v[234:235], v110 offset:26176
s_waitcnt lgkmcnt(4)
s_add_u32 m0, s55, 96512
s_add_u32 s29, s54, 147456
buffer_load_dwordx4 v74, s[12:15], s29 offen lds
s_barrier
ds_read_b128 v[182:185], v210 offset:20480
ds_read_b128 v[186:189], v210 offset:26624
ds_read_b128 v[114:117], v210 offset:21504
ds_read_b128 v[122:125], v210 offset:27648
s_add_u32 m0, s55, 106752
s_add_u32 s29, s54, 184320
buffer_load_dwordx4 v72, s[12:15], s29 offen lds
s_waitcnt vmcnt(11)
ds_read_b64_tr_b16 a[232:233], v129
ds_read_b64_tr_b16 v[224:225], v129 offset:32
ds_read_b64_tr_b16 v[248:249], v129 offset:64
s_waitcnt lgkmcnt(6)
v_mfma_f32_16x16x32_bf16 v[138:141], a[0:3], v[182:185], 0
v_mfma_f32_16x16x32_bf16 v[142:145], a[24:27], v[182:185], 0
s_add_u32 m0, s55, 107776
s_add_u32 s29, s54, 184320
buffer_load_dwordx4 v73, s[12:15], s29 offen lds
v_mfma_f32_16x16x32_bf16 v[146:149], a[48:51], v[182:185], 0
s_waitcnt vmcnt(11) lgkmcnt(5)
ds_read_b64_tr_b16 a[220:221], v129 offset:1536
ds_read_b64_tr_b16 a[244:245], v129 offset:1568
v_mfma_f32_16x16x32_bf16 v[150:153], a[0:3], v[186:189], 0
ds_read_b64_tr_b16 v[236:237], v129 offset:1600
ds_read_b128 v[182:185], v210 offset:24576
v_mfma_f32_16x16x32_bf16 v[154:157], a[24:27], v[186:189], 0
v_mfma_f32_16x16x32_bf16 v[158:161], a[48:51], v[186:189], 0
s_waitcnt lgkmcnt(8)
s_add_u32 m0, s55, 108800
s_add_u32 s29, s54, 184320
buffer_load_dwordx4 v74, s[12:15], s29 offen lds
v_mfma_f32_16x16x32_bf16 v[138:141], a[4:7], v[114:117], v[138:141]
ds_read_b128 v[186:189], v210 offset:30720
v_mfma_f32_16x16x32_bf16 v[142:145], a[28:31], v[114:117], v[142:145]
v_mfma_f32_16x16x32_bf16 v[146:149], a[52:55], v[114:117], v[146:149]
ds_read_b128 v[114:117], v210 offset:22528
s_waitcnt lgkmcnt(9)
v_mfma_f32_16x16x32_bf16 v[150:153], a[4:7], v[122:125], v[150:153]
s_add_u32 m0, s55, 119040
s_add_u32 s29, s54, 768
buffer_load_dwordx4 v72, s[12:15], s29 offen lds
v_mfma_f32_16x16x32_bf16 v[154:157], a[28:31], v[122:125], v[154:157]
s_waitcnt vmcnt(11)
ds_read_b64_tr_b16 a[222:223], v129 offset:12288
ds_read_b64_tr_b16 a[246:247], v129 offset:12320
v_mfma_f32_16x16x32_bf16 v[158:161], a[52:55], v[122:125], v[158:161]
s_waitcnt lgkmcnt(4)
ds_read_b64_tr_b16 v[238:239], v129 offset:12352
ds_read_b128 v[122:125], v210 offset:28672
v_mfma_f32_16x16x32_bf16 v[138:141], a[16:19], v[182:185], v[138:141]
v_mfma_f32_16x16x32_bf16 v[142:145], a[40:43], v[182:185], v[142:145]
s_nop 0
s_add_u32 m0, s55, 120064
s_add_u32 s29, s54, 768
buffer_load_dwordx4 v73, s[12:15], s29 offen lds
v_mfma_f32_16x16x32_bf16 v[146:149], a[64:67], v[182:185], v[146:149]
s_waitcnt vmcnt(11) lgkmcnt(5)
ds_read_b64_tr_b16 a[234:235], v129 offset:13824
ds_read_b64_tr_b16 v[226:227], v129 offset:13856
v_mfma_f32_16x16x32_bf16 v[150:153], a[16:19], v[186:189], v[150:153]
ds_read_b64_tr_b16 v[250:251], v129 offset:13888
ds_read_b128 v[182:185], v210 offset:23552
v_mfma_f32_16x16x32_bf16 v[154:157], a[40:43], v[186:189], v[154:157]
v_mfma_f32_16x16x32_bf16 v[158:161], a[64:67], v[186:189], v[158:161]
s_waitcnt lgkmcnt(8)
s_add_u32 m0, s55, 121088
s_add_u32 s29, s54, 768
buffer_load_dwordx4 v74, s[12:15], s29 offen lds
v_mfma_f32_16x16x32_bf16 v[138:141], a[8:11], v[114:117], v[138:141]
ds_read_b128 v[186:189], v210 offset:29696
v_mfma_f32_16x16x32_bf16 v[142:145], a[32:35], v[114:117], v[142:145]
v_mfma_f32_16x16x32_bf16 v[146:149], a[56:59], v[114:117], v[146:149]
ds_read_b128 v[114:117], v210 offset:25600
s_waitcnt lgkmcnt(6)
v_mfma_f32_16x16x32_bf16 v[150:153], a[8:11], v[122:125], v[150:153]
s_add_u32 m0, s55, 69888
s_add_u32 s29, s54, 37632
buffer_load_dwordx4 v72, s[12:15], s29 offen lds
v_mfma_f32_16x16x32_bf16 v[154:157], a[32:35], v[122:125], v[154:157]
s_waitcnt vmcnt(11)
ds_read_b64_tr_b16 a[224:225], v110 offset:36864
ds_read_b64_tr_b16 a[248:249], v110 offset:36896
v_mfma_f32_16x16x32_bf16 v[158:161], a[56:59], v[122:125], v[158:161]
s_waitcnt lgkmcnt(4)
ds_read_b64_tr_b16 v[240:241], v110 offset:36928
ds_read_b128 v[122:125], v210 offset:31744
v_mfma_f32_16x16x32_bf16 v[138:141], a[12:15], v[182:185], v[138:141]
v_mfma_f32_16x16x32_bf16 v[142:145], a[36:39], v[182:185], v[142:145]
s_nop 0
s_add_u32 m0, s55, 70912
s_add_u32 s29, s54, 37632
buffer_load_dwordx4 v73, s[12:15], s29 offen lds
v_mfma_f32_16x16x32_bf16 v[146:149], a[60:63], v[182:185], v[146:149]
s_waitcnt vmcnt(11) lgkmcnt(5)
ds_read_b64_tr_b16 a[226:227], v110 offset:38400
ds_read_b64_tr_b16 a[250:251], v110 offset:38432
v_mfma_f32_16x16x32_bf16 v[150:153], a[12:15], v[186:189], v[150:153]
ds_read_b64_tr_b16 v[242:243], v110 offset:38464
ds_read_b128 v[182:185], v210 offset:20480
v_mfma_f32_16x16x32_bf16 v[154:157], a[36:39], v[186:189], v[154:157]
v_mfma_f32_16x16x32_bf16 v[158:161], a[60:63], v[186:189], v[158:161]
s_waitcnt lgkmcnt(8)
s_add_u32 m0, s55, 71936
s_add_u32 s29, s54, 37632
buffer_load_dwordx4 v74, s[12:15], s29 offen lds
v_mfma_f32_16x16x32_bf16 v[138:141], a[20:23], v[114:117], v[138:141]
ds_read_b128 v[186:189], v210 offset:26624
v_mfma_f32_16x16x32_bf16 v[142:145], a[44:47], v[114:117], v[142:145]
v_mfma_f32_16x16x32_bf16 v[146:149], a[68:71], v[114:117], v[146:149]
s_waitcnt lgkmcnt(5)
ds_read_b128 v[114:117], v210 offset:21504
v_cvt_pk_bf16_f32 v60, v138, v139
v_mfma_f32_16x16x32_bf16 v[150:153], a[20:23], v[122:125], v[150:153]
s_add_u32 m0, s55, 82176
s_add_u32 s29, s54, 74496
buffer_load_dwordx4 v72, s[12:15], s29 offen lds
v_mfma_f32_16x16x32_bf16 v[154:157], a[44:47], v[122:125], v[154:157]
s_waitcnt vmcnt(11)
ds_read_b64_tr_b16 a[236:237], v110
ds_read_b64_tr_b16 v[228:229], v110 offset:32
v_mfma_f32_16x16x32_bf16 v[158:161], a[68:71], v[122:125], v[158:161]
s_waitcnt lgkmcnt(4)
ds_read_b64_tr_b16 v[252:253], v110 offset:64
ds_read_b128 v[122:125], v210 offset:27648
v_mfma_f32_16x16x32_bf16 v[162:165], a[216:219], v[182:185], 0
v_cvt_pk_bf16_f32 v61, v140, v141
v_cvt_pk_bf16_f32 v62, v142, v143
v_mfma_f32_16x16x32_bf16 v[166:169], a[240:243], v[182:185], 0
s_add_u32 m0, s55, 83200
s_add_u32 s29, s54, 74496
buffer_load_dwordx4 v73, s[12:15], s29 offen lds
v_mfma_f32_16x16x32_bf16 v[170:173], v[232:235], v[182:185], 0
s_waitcnt vmcnt(11) lgkmcnt(5)
ds_read_b64_tr_b16 a[228:229], v110 offset:1536
ds_read_b64_tr_b16 a[252:253], v110 offset:1568
v_mfma_f32_16x16x32_bf16 v[138:141], a[216:219], v[186:189], 0
s_waitcnt lgkmcnt(6)
ds_read_b64_tr_b16 v[244:245], v110 offset:1600
ds_read_b128 v[182:185], v210 offset:24576
v_mfma_f32_16x16x32_bf16 v[162:165], a[220:223], v[114:117], v[162:165]
v_cvt_pk_bf16_f32 v63, v144, v145
v_cvt_pk_bf16_f32 v64, v146, v147
v_mfma_f32_16x16x32_bf16 v[142:145], a[240:243], v[186:189], 0
s_add_u32 m0, s55, 84224
s_add_u32 s29, s54, 74496
buffer_load_dwordx4 v74, s[12:15], s29 offen lds
v_mfma_f32_16x16x32_bf16 v[166:169], a[244:247], v[114:117], v[166:169]
v_cvt_pk_bf16_f32 v65, v148, v149
v_cvt_pk_bf16_f32 v66, v150, v151
v_mfma_f32_16x16x32_bf16 v[146:149], v[232:235], v[186:189], 0
s_nop 0
ds_read_b128 v[186:189], v210 offset:30720
v_cvt_pk_bf16_f32 v67, v152, v153
v_mfma_f32_16x16x32_bf16 v[170:173], v[236:239], v[114:117], v[170:173]
s_waitcnt lgkmcnt(5)
ds_read_b128 v[114:117], v210 offset:22528
v_cvt_pk_bf16_f32 v68, v154, v155
v_mfma_f32_16x16x32_bf16 v[138:141], a[220:223], v[122:125], v[138:141]
s_add_u32 m0, s55, 131328
s_add_u32 s29, s54, 111360
buffer_load_dwordx4 v72, s[12:15], s29 offen lds
v_mfma_f32_16x16x32_bf16 v[142:145], a[244:247], v[122:125], v[142:145]
s_waitcnt vmcnt(11)
ds_read_b64_tr_b16 a[230:231], v110 offset:12288
ds_read_b64_tr_b16 a[254:255], v110 offset:12320
v_mfma_f32_16x16x32_bf16 v[146:149], v[236:239], v[122:125], v[146:149]
s_waitcnt lgkmcnt(4)
ds_read_b64_tr_b16 v[246:247], v110 offset:12352
ds_read_b128 v[122:125], v210 offset:28672
v_mfma_f32_16x16x32_bf16 v[162:165], a[232:235], v[182:185], v[162:165]
v_cvt_pk_bf16_f32 v69, v156, v157
v_cvt_pk_bf16_f32 v70, v158, v159
v_mfma_f32_16x16x32_bf16 v[166:169], v[224:227], v[182:185], v[166:169]
s_nop 0
s_add_u32 m0, s55, 132352
s_add_u32 s29, s54, 111360
buffer_load_dwordx4 v73, s[12:15], s29 offen lds
v_mfma_f32_16x16x32_bf16 v[170:173], v[248:251], v[182:185], v[170:173]
s_waitcnt vmcnt(11) lgkmcnt(5)
ds_read_b64_tr_b16 a[238:239], v110 offset:13824
ds_read_b64_tr_b16 v[230:231], v110 offset:13856
v_mfma_f32_16x16x32_bf16 v[138:141], a[232:235], v[186:189], v[138:141]
ds_read_b64_tr_b16 v[254:255], v110 offset:13888
ds_read_b128 v[182:185], v210 offset:23552
v_mfma_f32_16x16x32_bf16 v[142:145], v[224:227], v[186:189], v[142:145]
v_cvt_pk_bf16_f32 v71, v160, v161
v_mfma_f32_16x16x32_bf16 v[146:149], v[248:251], v[186:189], v[146:149]
s_waitcnt lgkmcnt(8)
s_add_u32 m0, s55, 133376
s_add_u32 s29, s54, 111360
buffer_load_dwordx4 v74, s[12:15], s29 offen lds
v_mfma_f32_16x16x32_bf16 v[162:165], a[224:227], v[114:117], v[162:165]
ds_read_b128 v[186:189], v210 offset:29696
v_mfma_f32_16x16x32_bf16 v[166:169], a[248:251], v[114:117], v[166:169]
v_mfma_f32_16x16x32_bf16 v[170:173], v[240:243], v[114:117], v[170:173]
ds_read_b128 v[114:117], v210 offset:25600
s_waitcnt lgkmcnt(6)
v_mfma_f32_16x16x32_bf16 v[138:141], a[224:227], v[122:125], v[138:141]
s_add_u32 m0, s55, 94464
s_add_u32 s29, s54, 148224
buffer_load_dwordx4 v72, s[12:15], s29 offen lds
v_mfma_f32_16x16x32_bf16 v[142:145], a[248:251], v[122:125], v[142:145]
s_waitcnt vmcnt(11)
ds_read_b64_tr_b16 a[72:73], v110 offset:24576
ds_read_b64_tr_b16 a[96:97], v110 offset:24608
v_mfma_f32_16x16x32_bf16 v[146:149], v[240:243], v[122:125], v[146:149]
s_waitcnt lgkmcnt(4)
ds_read_b64_tr_b16 a[120:121], v110 offset:24640
ds_read_b128 v[122:125], v210 offset:31744
v_mfma_f32_16x16x32_bf16 v[162:165], a[228:231], v[182:185], v[162:165]
v_mfma_f32_16x16x32_bf16 v[166:169], a[252:255], v[182:185], v[166:169]
s_nop 0
s_add_u32 m0, s55, 95488
s_add_u32 s29, s54, 148224
buffer_load_dwordx4 v73, s[12:15], s29 offen lds
v_mfma_f32_16x16x32_bf16 v[170:173], v[244:247], v[182:185], v[170:173]
s_waitcnt vmcnt(11) lgkmcnt(5)
ds_read_b64_tr_b16 a[74:75], v110 offset:26112
ds_read_b64_tr_b16 a[98:99], v110 offset:26144
v_mfma_f32_16x16x32_bf16 v[138:141], a[228:231], v[186:189], v[138:141]
ds_read_b64_tr_b16 a[122:123], v110 offset:26176
ds_read_b128 v[182:185], v210 offset:20480
v_mfma_f32_16x16x32_bf16 v[142:145], a[252:255], v[186:189], v[142:145]
v_mfma_f32_16x16x32_bf16 v[146:149], v[244:247], v[186:189], v[146:149]
s_waitcnt lgkmcnt(8)
s_add_u32 m0, s55, 96512
s_add_u32 s29, s54, 148224
buffer_load_dwordx4 v74, s[12:15], s29 offen lds
v_mfma_f32_16x16x32_bf16 v[162:165], a[236:239], v[114:117], v[162:165]
ds_read_b128 v[186:189], v210 offset:26624
v_mfma_f32_16x16x32_bf16 v[166:169], v[228:231], v[114:117], v[166:169]
v_mfma_f32_16x16x32_bf16 v[170:173], v[252:255], v[114:117], v[170:173]
s_waitcnt lgkmcnt(5)
ds_read_b128 v[114:117], v210 offset:21504
v_cvt_pk_bf16_f32 v84, v162, v163
v_mfma_f32_16x16x32_bf16 v[138:141], a[236:239], v[122:125], v[138:141]
s_add_u32 m0, s55, 106752
s_add_u32 s29, s54, 185088
buffer_load_dwordx4 v72, s[12:15], s29 offen lds
v_mfma_f32_16x16x32_bf16 v[142:145], v[228:231], v[122:125], v[142:145]
s_waitcnt vmcnt(11)
ds_read_b64_tr_b16 a[88:89], v129
ds_read_b64_tr_b16 a[112:113], v129 offset:32
v_mfma_f32_16x16x32_bf16 v[146:149], v[252:255], v[122:125], v[146:149]
s_waitcnt lgkmcnt(4)
ds_read_b64_tr_b16 a[136:137], v129 offset:64
ds_read_b128 v[122:125], v210 offset:27648
v_mfma_f32_16x16x32_bf16 v[150:153], a[72:75], v[182:185], 0
v_cvt_pk_bf16_f32 v85, v164, v165
v_cvt_pk_bf16_f32 v86, v166, v167
v_mfma_f32_16x16x32_bf16 v[154:157], a[96:99], v[182:185], 0
s_nop 0
s_add_u32 m0, s55, 107776
s_add_u32 s29, s54, 185088
buffer_load_dwordx4 v73, s[12:15], s29 offen lds
v_mfma_f32_16x16x32_bf16 v[158:161], a[120:123], v[182:185], 0
s_waitcnt vmcnt(11) lgkmcnt(5)
ds_read_b64_tr_b16 a[76:77], v129 offset:1536
ds_read_b64_tr_b16 a[100:101], v129 offset:1568
v_mfma_f32_16x16x32_bf16 v[162:165], a[72:75], v[186:189], 0
ds_read_b64_tr_b16 a[124:125], v129 offset:1600
ds_read_b128 v[182:185], v210 offset:24576
v_cvt_pk_bf16_f32 v87, v168, v169
v_mfma_f32_16x16x32_bf16 v[166:169], a[96:99], v[186:189], 0
v_cvt_pk_bf16_f32 v88, v170, v171
s_add_u32 m0, s55, 108800
s_add_u32 s29, s54, 185088
buffer_load_dwordx4 v74, s[12:15], s29 offen lds
v_cvt_pk_bf16_f32 v89, v172, v173
v_mfma_f32_16x16x32_bf16 v[170:173], a[120:123], v[186:189], 0
ds_read_b128 v[186:189], v210 offset:30720
v_cvt_pk_bf16_f32 v96, v138, v139
v_cvt_pk_bf16_f32 v97, v140, v141
v_cvt_pk_bf16_f32 v98, v142, v143
v_cvt_pk_bf16_f32 v99, v144, v145
v_cvt_pk_bf16_f32 v100, v146, v147
v_cvt_pk_bf16_f32 v101, v148, v149
s_add_u32 m0, s45, 0
s_nop 0
buffer_load_dwordx4 v180, s[4:7], s52 offen nt lds
s_waitcnt vmcnt(11)
ds_read_b64_tr_b16 a[78:79], v129 offset:12288
ds_read_b64_tr_b16 a[102:103], v129 offset:12320
ds_read_b64_tr_b16 a[126:127], v129 offset:12352
s_add_u32 m0, s45, 4112
s_add_u32 s40, s37, 196224
buffer_load_dwordx4 v180, s[4:7], s40 offen nt lds
s_waitcnt vmcnt(11)
ds_read_b64_tr_b16 a[90:91], v129 offset:13824
ds_read_b64_tr_b16 a[114:115], v129 offset:13856
ds_read_b64_tr_b16 a[138:139], v129 offset:13888
s_waitcnt lgkmcnt(5)
v_mfma_f32_16x16x32_bf16 v[150:153], a[76:79], v[114:117], v[150:153]
s_waitcnt lgkmcnt(4)
v_mfma_f32_16x16x32_bf16 v[154:157], a[100:103], v[114:117], v[154:157]
s_waitcnt lgkmcnt(3)
s_add_u32 m0, s45, 8224
s_add_u32 s40, s37, 392448
buffer_load_dwordx4 v180, s[4:7], s40 offen nt lds
v_mfma_f32_16x16x32_bf16 v[158:161], a[124:127], v[114:117], v[158:161]
ds_read_b128 v[114:117], v210 offset:22528
v_mfma_f32_16x16x32_bf16 v[162:165], a[76:79], v[122:125], v[162:165]
v_mfma_f32_16x16x32_bf16 v[166:169], a[100:103], v[122:125], v[166:169]
s_add_u32 m0, s45, 12336
s_add_u32 s40, s37, 588672
buffer_load_dwordx4 v180, s[4:7], s40 offen nt lds
v_mfma_f32_16x16x32_bf16 v[170:173], a[124:127], v[122:125], v[170:173]
ds_read_b128 v[122:125], v210 offset:28672
s_waitcnt lgkmcnt(4)
v_mfma_f32_16x16x32_bf16 v[150:153], a[88:91], v[182:185], v[150:153]
s_waitcnt vmcnt(11) lgkmcnt(3)
ds_read_b64_tr_b16 a[80:81], v110 offset:36864
v_mfma_f32_16x16x32_bf16 v[154:157], a[112:115], v[182:185], v[154:157]
s_waitcnt lgkmcnt(3)
ds_read_b64_tr_b16 a[104:105], v110 offset:36896
ds_read_b64_tr_b16 a[128:129], v110 offset:36928
v_mfma_f32_16x16x32_bf16 v[158:161], a[136:139], v[182:185], v[158:161]
s_add_u32 m0, s45, 16448
s_add_u32 s40, s37, 784896
buffer_load_dwordx4 v180, s[4:7], s40 offen nt lds
v_mfma_f32_16x16x32_bf16 v[162:165], a[88:91], v[186:189], v[162:165]
s_nop 0
ds_read_b128 v[182:185], v210 offset:23552
v_mfma_f32_16x16x32_bf16 v[166:169], a[112:115], v[186:189], v[166:169]
s_waitcnt vmcnt(11)
ds_read_b64_tr_b16 a[82:83], v110 offset:38400
v_mfma_f32_16x16x32_bf16 v[170:173], a[136:139], v[186:189], v[170:173]
s_add_u32 m0, s45, 20560
s_add_u32 s40, s37, 981120
buffer_load_dwordx4 v180, s[4:7], s40 offen nt lds
ds_read_b64_tr_b16 a[106:107], v110 offset:38432
ds_read_b64_tr_b16 a[130:131], v110 offset:38464
ds_read_b128 v[186:189], v210 offset:29696
s_waitcnt lgkmcnt(3)
v_mfma_f32_16x16x32_bf16 v[150:153], a[80:83], v[114:117], v[150:153]
s_add_u32 m0, s45, 24672
s_add_u32 s40, s37, 1177344
buffer_load_dwordx4 v180, s[4:7], s40 offen nt lds
v_mfma_f32_16x16x32_bf16 v[162:165], a[80:83], v[122:125], v[162:165]
s_waitcnt lgkmcnt(2)
v_mfma_f32_16x16x32_bf16 v[154:157], a[104:107], v[114:117], v[154:157]
s_waitcnt lgkmcnt(1)
v_mfma_f32_16x16x32_bf16 v[158:161], a[128:131], v[114:117], v[158:161]
s_add_u32 m0, s45, 28784
s_add_u32 s40, s37, 1373568
buffer_load_dwordx4 v180, s[4:7], s40 offen nt lds
v_mfma_f32_16x16x32_bf16 v[166:169], a[104:107], v[122:125], v[166:169]
s_waitcnt vmcnt(12)
ds_read_b64_tr_b16 a[92:93], v110
ds_read_b64_tr_b16 a[116:117], v110 offset:32
v_mfma_f32_16x16x32_bf16 v[170:173], a[128:131], v[122:125], v[170:173]
ds_read_b64_tr_b16 a[140:141], v110 offset:64
ds_read_b128 v[114:117], v210 offset:25600
ds_read_b128 v[122:125], v210 offset:31744
s_add_u32 m0, s45, 32896
s_add_u32 s40, s37, 1569792
buffer_load_dwordx4 v180, s[4:7], s40 offen nt lds
ds_read_b128 v[178:181], v217 offset:528
s_waitcnt vmcnt(12)
ds_read_b64_tr_b16 a[84:85], v110 offset:1536
ds_read_b64_tr_b16 a[108:109], v110 offset:1568
ds_read_b64_tr_b16 a[132:133], v110 offset:1600
s_add_u32 m0, s55, 69888
s_add_u32 s29, s54, 0
buffer_load_dwordx4 v136, s[16:19], s29 offen lds
s_add_u32 m0, s55, 70912
s_add_u32 s29, s54, 0
buffer_load_dwordx4 v137, s[16:19], s29 offen lds
s_waitcnt vmcnt(12)
ds_read_b64_tr_b16 a[86:87], v110 offset:12288
ds_read_b64_tr_b16 a[110:111], v110 offset:12320
ds_read_b64_tr_b16 a[134:135], v110 offset:12352
s_add_u32 m0, s55, 71936
s_add_u32 s29, s54, 0
buffer_load_dwordx4 v216, s[16:19], s29 offen lds
s_waitcnt vmcnt(12)
ds_read_b64_tr_b16 a[94:95], v110 offset:13824
ds_read_b64_tr_b16 a[118:119], v110 offset:13856
ds_read_b64_tr_b16 a[142:143], v110 offset:13888
s_waitcnt lgkmcnt(5)
v_mfma_f32_16x16x32_bf16 v[150:153], a[84:87], v[182:185], v[150:153]
s_waitcnt lgkmcnt(4)
v_mfma_f32_16x16x32_bf16 v[154:157], a[108:111], v[182:185], v[154:157]
s_waitcnt lgkmcnt(3)
v_mfma_f32_16x16x32_bf16 v[158:161], a[132:135], v[182:185], v[158:161]
s_nop 0
s_add_u32 m0, s55, 82176
s_add_u32 s29, s54, 12288
buffer_load_dwordx4 v136, s[16:19], s29 offen lds
v_mfma_f32_16x16x32_bf16 v[162:165], a[84:87], v[186:189], v[162:165]
ds_read_b128 v[182:185], v210
v_mfma_f32_16x16x32_bf16 v[166:169], a[108:111], v[186:189], v[166:169]
s_waitcnt lgkmcnt(1)
s_barrier
v_mfma_f32_16x16x32_bf16 v[170:173], a[132:135], v[186:189], v[170:173]
ds_read_b128 v[186:189], v210 offset:1024
s_add_u32 m0, s55, 83200
s_add_u32 s29, s54, 12288
buffer_load_dwordx4 v137, s[16:19], s29 offen lds
v_mfma_f32_16x16x32_bf16 v[150:153], a[92:95], v[114:117], v[150:153]
ds_write_b128 v121, v[36:39]
v_mfma_f32_16x16x32_bf16 v[154:157], a[116:119], v[114:117], v[154:157]
v_cvt_pk_bf16_f32 v90, v150, v151
v_cvt_pk_bf16_f32 v91, v152, v153
v_mfma_f32_16x16x32_bf16 v[158:161], a[140:143], v[114:117], v[158:161]
s_add_u32 m0, s55, 84224
s_add_u32 s29, s54, 12288
buffer_load_dwordx4 v216, s[16:19], s29 offen lds
v_mfma_f32_16x16x32_bf16 v[162:165], a[92:95], v[122:125], v[162:165]
v_cvt_pk_bf16_f32 v92, v154, v155
v_cvt_pk_bf16_f32 v93, v156, v157
v_mfma_f32_16x16x32_bf16 v[166:169], a[116:119], v[122:125], v[166:169]
s_nop 0
v_cvt_pk_bf16_f32 v94, v158, v159
v_cvt_pk_bf16_f32 v95, v160, v161
v_mfma_f32_16x16x32_bf16 v[170:173], a[140:143], v[122:125], v[170:173]
s_waitcnt lgkmcnt(2)
v_cvt_pk_bf16_f32 v102, v162, v163
v_cvt_pk_bf16_f32 v103, v164, v165
v_mfma_f32_16x16x32_bf16 v[138:141], a[0:3], v[182:185], 0
v_cvt_pk_bf16_f32 v104, v166, v167
v_cvt_pk_bf16_f32 v105, v168, v169
v_mfma_f32_16x16x32_bf16 v[142:145], a[24:27], v[182:185], 0
v_cvt_pk_bf16_f32 v106, v170, v171
v_cvt_pk_bf16_f32 v107, v172, v173
v_mfma_f32_16x16x32_bf16 v[146:149], a[48:51], v[182:185], 0
ds_write_b128 v121, v[40:43] offset:64
v_mfma_f32_16x16x32_bf16 v[150:153], a[216:219], v[182:185], 0
v_mfma_f32_16x16x32_bf16 v[154:157], a[240:243], v[182:185], 0
v_mfma_f32_16x16x32_bf16 v[158:161], v[232:235], v[182:185], 0
ds_write_b128 v121, v[44:47] offset:128
v_mfma_f32_16x16x32_bf16 v[162:165], v[182:185], a[72:75], 0
v_mfma_f32_16x16x32_bf16 v[166:169], v[182:185], a[96:99], 0
s_nop 0
v_mfma_f32_16x16x32_bf16 v[170:173], v[182:185], a[120:123], 0
s_waitcnt lgkmcnt(3)
ds_read_b128 v[182:185], v210 offset:2048
ds_write_b128 v120, v[84:87]
v_mfma_f32_16x16x32_bf16 v[138:141], a[4:7], v[186:189], v[138:141]
v_mfma_f32_16x16x32_bf16 v[142:145], a[28:31], v[186:189], v[142:145]
v_mfma_f32_16x16x32_bf16 v[146:149], a[52:55], v[186:189], v[146:149]
ds_write_b64 v120, v[88:89] offset:16
v_mfma_f32_16x16x32_bf16 v[150:153], a[220:223], v[186:189], v[150:153]
v_mfma_f32_16x16x32_bf16 v[154:157], a[244:247], v[186:189], v[154:157]
ds_write_b128 v120, v[60:63] offset:512
v_mfma_f32_16x16x32_bf16 v[158:161], v[236:239], v[186:189], v[158:161]
v_mfma_f32_16x16x32_bf16 v[162:165], v[186:189], a[76:79], v[162:165]
v_mfma_f32_16x16x32_bf16 v[166:169], v[186:189], a[100:103], v[166:169]
ds_write_b64 v120, v[64:65] offset:528
v_mfma_f32_16x16x32_bf16 v[170:173], v[186:189], a[124:127], v[170:173]
s_waitcnt lgkmcnt(4)
v_mfma_f32_16x16x32_bf16 v[138:141], a[8:11], v[182:185], v[138:141]
ds_read_b128 v[186:189], v210 offset:3072
ds_write_b128 v120, v[90:93] offset:1024
v_mfma_f32_16x16x32_bf16 v[142:145], a[32:35], v[182:185], v[142:145]
v_mfma_f32_16x16x32_bf16 v[146:149], a[56:59], v[182:185], v[146:149]
v_mfma_f32_16x16x32_bf16 v[150:153], a[224:227], v[182:185], v[150:153]
ds_write_b64 v120, v[94:95] offset:1040
v_mfma_f32_16x16x32_bf16 v[154:157], a[248:251], v[182:185], v[154:157]
v_mfma_f32_16x16x32_bf16 v[158:161], v[240:243], v[182:185], v[158:161]
s_mov_b64 exec, s[56:57]
ds_write_b128 v121, v[48:51] offset:12544
s_mov_b64 exec, -1
v_mfma_f32_16x16x32_bf16 v[162:165], v[182:185], a[80:83], v[162:165]
v_mfma_f32_16x16x32_bf16 v[166:169], v[182:185], a[104:107], v[166:169]
s_mov_b64 exec, s[56:57]
ds_write_b128 v121, v[52:55] offset:12608
s_mov_b64 exec, -1
v_mfma_f32_16x16x32_bf16 v[170:173], v[182:185], a[128:131], v[170:173]
s_waitcnt lgkmcnt(4)
v_mfma_f32_16x16x32_bf16 v[138:141], a[12:15], v[186:189], v[138:141]
ds_read_b128 v[182:185], v210 offset:4096
s_mov_b64 exec, s[56:57]
ds_write_b128 v121, v[56:59] offset:12672
s_mov_b64 exec, -1
v_mfma_f32_16x16x32_bf16 v[142:145], a[36:39], v[186:189], v[142:145]
v_mfma_f32_16x16x32_bf16 v[146:149], a[60:63], v[186:189], v[146:149]
s_mov_b64 exec, s[56:57]
ds_write_b128 v120, v[96:99] offset:24832
s_mov_b64 exec, -1
v_mfma_f32_16x16x32_bf16 v[150:153], a[228:231], v[186:189], v[150:153]
v_mfma_f32_16x16x32_bf16 v[154:157], a[252:255], v[186:189], v[154:157]
s_mov_b64 exec, s[56:57]
ds_write_b64 v120, v[100:101] offset:24848
s_mov_b64 exec, -1
v_mfma_f32_16x16x32_bf16 v[158:161], v[244:247], v[186:189], v[158:161]
s_mov_b64 exec, s[56:57]
ds_write_b128 v120, v[66:69] offset:25344
s_mov_b64 exec, -1
v_mfma_f32_16x16x32_bf16 v[162:165], v[186:189], a[84:87], v[162:165]
v_mfma_f32_16x16x32_bf16 v[166:169], v[186:189], a[108:111], v[166:169]
s_nop 0
s_mov_b64 exec, s[56:57]
ds_write_b64 v120, v[70:71] offset:25360
s_mov_b64 exec, -1
v_mfma_f32_16x16x32_bf16 v[170:173], v[186:189], a[132:135], v[170:173]
s_waitcnt lgkmcnt(5)
ds_read_b128 v[186:189], v210 offset:5120
s_mov_b64 exec, s[56:57]
ds_write_b128 v120, v[102:105] offset:25856
s_mov_b64 exec, -1
v_mfma_f32_16x16x32_bf16 v[138:141], a[16:19], v[182:185], v[138:141]
v_mfma_f32_16x16x32_bf16 v[142:145], a[40:43], v[182:185], v[142:145]
s_nop 0
s_mov_b64 exec, s[56:57]
ds_write_b64 v120, v[106:107] offset:25872
s_mov_b64 exec, -1
v_mfma_f32_16x16x32_bf16 v[146:149], a[64:67], v[182:185], v[146:149]
s_waitcnt vmcnt(4)
ds_read_b64_tr_b16 a[144:145], v129
ds_read_b64_tr_b16 a[168:169], v129 offset:32
v_mfma_f32_16x16x32_bf16 v[150:153], a[232:235], v[182:185], v[150:153]
s_barrier
v_mfma_f32_16x16x32_bf16 v[154:157], v[224:227], v[182:185], v[154:157]
s_waitcnt vmcnt(3)
ds_read_b64_tr_b16 a[192:193], v129 offset:64
ds_read_b64_tr_b16 a[146:147], v129 offset:1536
v_mfma_f32_16x16x32_bf16 v[158:161], v[248:251], v[182:185], v[158:161]
s_nop 0
ds_read_b64_tr_b16 a[170:171], v129 offset:1568
ds_read_b64_tr_b16 a[194:195], v129 offset:1600
v_mfma_f32_16x16x32_bf16 v[162:165], v[182:185], a[88:91], v[162:165]
s_waitcnt vmcnt(0)
ds_read_b64_tr_b16 a[148:149], v129 offset:13824
ds_read_b64_tr_b16 a[172:173], v129 offset:13856
v_mfma_f32_16x16x32_bf16 v[166:169], v[182:185], a[112:115], v[166:169]
s_nop 0
ds_read_b64_tr_b16 a[196:197], v129 offset:13888
ds_read_b64_tr_b16 a[160:161], v129 offset:12288
v_mfma_f32_16x16x32_bf16 v[170:173], v[182:185], a[136:139], v[170:173]
s_waitcnt lgkmcnt(12)
ds_read_b64_tr_b16 a[184:185], v129 offset:12320
ds_read_b64_tr_b16 a[208:209], v129 offset:12352
v_mfma_f32_16x16x32_bf16 v[138:141], a[20:23], v[186:189], v[138:141]
ds_read_b128 v[84:87], v200
ds_read_b128 v[92:95], v201
v_mfma_f32_16x16x32_bf16 v[142:145], a[44:47], v[186:189], v[142:145]
ds_read_b128 v[100:103], v202
ds_read_b128 v[88:91], v194 offset:16
v_mfma_f32_16x16x32_bf16 v[146:149], a[68:71], v[186:189], v[146:149]
s_waitcnt lgkmcnt(10)
s_add_u32 m0, s55, 69888
s_add_u32 s29, s54, 24576
buffer_load_dwordx4 v136, s[16:19], s29 offen lds
v_mfma_f32_16x16x32_bf16 v[150:153], a[236:239], v[186:189], v[150:153]
s_add_u32 m0, s55, 70912
s_add_u32 s29, s54, 24576
buffer_load_dwordx4 v137, s[16:19], s29 offen lds
v_mfma_f32_16x16x32_bf16 v[154:157], v[228:231], v[186:189], v[154:157]
s_add_u32 m0, s55, 71936
s_add_u32 s29, s54, 24576
buffer_load_dwordx4 v216, s[16:19], s29 offen lds
ds_read_b128 v[96:99], v195 offset:16
s_waitcnt lgkmcnt(4)
v_mfma_f32_16x16x32_bf16 v[36:39], v[174:177], v[84:87], 0
s_waitcnt lgkmcnt(3)
s_add_u32 m0, s55, 82176
s_add_u32 s29, s54, 36864
buffer_load_dwordx4 v136, s[16:19], s29 offen lds
v_mfma_f32_16x16x32_bf16 v[48:51], v[174:177], v[92:95], 0
s_waitcnt lgkmcnt(2)
s_add_u32 m0, s55, 83200
s_add_u32 s29, s54, 36864
buffer_load_dwordx4 v137, s[16:19], s29 offen lds
v_mfma_f32_16x16x32_bf16 v[60:63], v[174:177], v[100:103], 0
s_add_u32 m0, s55, 84224
s_add_u32 s29, s54, 36864
buffer_load_dwordx4 v216, s[16:19], s29 offen lds
v_mfma_f32_16x16x32_bf16 v[158:161], v[252:255], v[186:189], v[158:161]
ds_read_b128 v[84:87], v194
ds_read_b128 v[92:95], v195
v_mfma_f32_16x16x32_bf16 v[162:165], v[186:189], a[92:95], v[162:165]
ds_read_b128 v[100:103], v196
ds_read_b128 v[104:107], v196 offset:16
v_mfma_f32_16x16x32_bf16 v[166:169], v[186:189], a[116:119], v[166:169]
ds_read_b128 v[174:177], v217 offset:1056
ds_read_b128 v[182:185], v210 offset:6144
v_mfma_f32_16x16x32_bf16 v[170:173], v[186:189], a[140:143], v[170:173]
ds_read_b128 v[186:189], v210 offset:7168
v_cvt_pk_bf16_f32 v78, v138, v139
v_cvt_pk_bf16_f32 v79, v140, v141
v_cvt_pk_bf16_f32 v80, v142, v143
v_cvt_pk_bf16_f32 v81, v144, v145
v_cvt_pk_bf16_f32 v82, v146, v147
v_cvt_pk_bf16_f32 v83, v148, v149
v_cvt_pk_bf16_f32 v72, v150, v151
v_cvt_pk_bf16_f32 v73, v152, v153
v_cvt_pk_bf16_f32 v74, v154, v155
v_cvt_pk_bf16_f32 v75, v156, v157
v_cvt_pk_bf16_f32 v76, v158, v159
s_waitcnt lgkmcnt(6)
v_smfmac_f32_16x16x64_bf16 v[36:39], v[178:181], v[84:91], v213
s_waitcnt lgkmcnt(5)
ds_read_b128 v[84:87], v197
ds_read_b128 v[88:91], v197 offset:16
v_smfmac_f32_16x16x64_bf16 v[48:51], v[178:181], v[92:99], v213
ds_read_b128 v[92:95], v198
ds_read_b128 v[96:99], v198 offset:16
v_cvt_pk_bf16_f32 v77, v160, v161
v_cvt_pk_bf16_f32 v114, v162, v163
v_cvt_pk_bf16_f32 v115, v164, v165
s_waitcnt lgkmcnt(7)
v_smfmac_f32_16x16x64_bf16 v[60:63], v[178:181], v[100:107], v213
s_nop 0
ds_read_b128 v[100:103], v199
ds_read_b128 v[104:107], v199 offset:16
ds_read_b128 v[178:181], v217 offset:1584
v_cvt_pk_bf16_f32 v122, v166, v167
v_cvt_pk_bf16_f32 v123, v168, v169
s_waitcnt lgkmcnt(8)
v_mfma_f32_16x16x32_bf16 v[138:141], a[0:3], v[182:185], 0
s_nop 0
v_cvt_pk_bf16_f32 v130, v170, v171
v_cvt_pk_bf16_f32 v131, v172, v173
v_mfma_f32_16x16x32_bf16 v[142:145], a[24:27], v[182:185], 0
s_nop 0
ds_read_b64 v[112:113], v215 offset:528
s_waitcnt lgkmcnt(6)
v_smfmac_f32_16x16x64_bf16 v[36:39], v[174:177], v[84:91], v213
ds_read_b128 v[84:87], v200 offset:32
ds_read_b128 v[88:91], v194 offset:48
v_mfma_f32_16x16x32_bf16 v[146:149], a[48:51], v[182:185], 0
s_waitcnt lgkmcnt(6)
v_smfmac_f32_16x16x64_bf16 v[48:51], v[174:177], v[92:99], v213
s_nop 0
ds_read_b128 v[92:95], v201 offset:32
ds_read_b128 v[96:99], v195 offset:48
v_mfma_f32_16x16x32_bf16 v[150:153], a[216:219], v[182:185], 0
v_mul_f32 v119, v36, v36
v_add_f32 v118, v36, v37
v_mfma_f32_16x16x32_bf16 v[154:157], a[240:243], v[182:185], 0
s_waitcnt lgkmcnt(6)
v_mul_f32 v127, v48, v48
v_add_f32_e64 v126, v48, v49
v_smfmac_f32_16x16x64_bf16 v[60:63], v[174:177], v[100:107], v213
ds_read_b128 v[100:103], v202 offset:32
ds_read_b128 v[174:177], v217 offset:2112
v_mfma_f32_16x16x32_bf16 v[158:161], v[232:235], v[182:185], 0
s_waitcnt lgkmcnt(5)
ds_read_b128 v[104:107], v196 offset:48
v_fmac_f32 v119, v37, v37
v_mfma_f32_16x16x32_bf16 v[40:43], v[178:181], v[84:87], 0
ds_read_b128 v[84:87], v194 offset:32
v_mul_f32_e64 v135, v60, v60
v_mfma_f32_16x16x32_bf16 v[162:165], v[182:185], a[72:75], 0
s_waitcnt lgkmcnt(5)
v_add_f32 v134, v60, v61
v_fmac_f32_e64 v135, v61, v61
v_mfma_f32_16x16x32_bf16 v[52:55], v[178:181], v[92:95], 0
ds_read_b128 v[92:95], v195 offset:32
v_fmac_f32_e64 v127, v49, v49
v_mfma_f32_16x16x32_bf16 v[166:169], v[182:185], a[96:99], 0
v_add_f32_e64 v134, v134, v62
v_fmac_f32 v135, v62, v62
v_mfma_f32_16x16x32_bf16 v[170:173], v[182:185], a[120:123], 0
s_waitcnt lgkmcnt(4)
ds_read_b128 v[182:185], v210 offset:8192
v_add_f32_e64 v118, v118, v38
v_mfma_f32_16x16x32_bf16 v[64:67], v[178:181], v[100:103], 0
ds_read_b128 v[100:103], v196 offset:32
ds_read_b128 v[178:181], v217 offset:2640
v_mfma_f32_16x16x32_bf16 v[138:141], a[4:7], v[186:189], v[138:141]
v_add_f32 v126, v126, v50
v_fmac_f32 v119, v38, v38
v_mfma_f32_16x16x32_bf16 v[142:145], a[28:31], v[186:189], v[142:145]
s_waitcnt lgkmcnt(4)
v_fmac_f32 v127, v50, v50
v_add_f32_e64 v134, v134, v63
v_smfmac_f32_16x16x64_bf16 v[40:43], v[174:177], v[84:91], v213
s_waitcnt lgkmcnt(3)
ds_read_b128 v[84:87], v197 offset:32
ds_read_b128 v[88:91], v197 offset:48
v_smfmac_f32_16x16x64_bf16 v[52:55], v[174:177], v[92:99], v213
s_waitcnt vmcnt(4)
ds_read_b64_tr_b16 a[150:151], v129
ds_read_b64_tr_b16 a[174:175], v129 offset:32
v_mfma_f32_16x16x32_bf16 v[146:149], a[52:55], v[186:189], v[146:149]
ds_read_b64_tr_b16 a[198:199], v129 offset:64
ds_read_b128 v[92:95], v198 offset:32
v_mfma_f32_16x16x32_bf16 v[150:153], a[220:223], v[186:189], v[150:153]
s_waitcnt lgkmcnt(7)
ds_read_b128 v[96:99], v198 offset:48
v_fmac_f32 v135, v63, v63
v_smfmac_f32_16x16x64_bf16 v[64:67], v[174:177], v[100:107], v213
ds_read_b128 v[100:103], v199 offset:32
ds_read_b128 v[104:107], v199 offset:48
v_mfma_f32_16x16x32_bf16 v[154:157], a[244:247], v[186:189], v[154:157]
ds_read_b128 v[174:177], v217 offset:3168
v_add_f32 v118, v118, v39
v_mfma_f32_16x16x32_bf16 v[158:161], v[236:239], v[186:189], v[158:161]
s_waitcnt vmcnt(3)
ds_read_b64_tr_b16 a[162:163], v129 offset:1536
ds_read_b64_tr_b16 a[186:187], v129 offset:1568
v_mfma_f32_16x16x32_bf16 v[162:165], v[186:189], a[76:79], v[162:165]
s_waitcnt lgkmcnt(10)
ds_read_b64_tr_b16 a[210:211], v129 offset:1600
v_add_f32 v126, v126, v51
v_smfmac_f32_16x16x64_bf16 v[40:43], v[178:181], v[84:91], v213
ds_read_b128 v[84:87], v200 offset:64
ds_read_b128 v[88:91], v194 offset:80
v_mfma_f32_16x16x32_bf16 v[166:169], v[186:189], a[100:103], v[166:169]
v_fmac_f32_e64 v119, v39, v39
v_fmac_f32 v127, v51, v51
v_mfma_f32_16x16x32_bf16 v[170:173], v[186:189], a[124:127], v[170:173]
s_waitcnt lgkmcnt(8)
ds_read_b128 v[186:189], v210 offset:9216
v_add_f32_e64 v118, v118, v40
v_smfmac_f32_16x16x64_bf16 v[52:55], v[178:181], v[92:99], v213
ds_read_b128 v[92:95], v201 offset:64
ds_read_b128 v[96:99], v195 offset:80
v_mfma_f32_16x16x32_bf16 v[138:141], a[8:11], v[182:185], v[138:141]
s_waitcnt lgkmcnt(9)
v_fmac_f32 v119, v40, v40
v_add_f32_e64 v118, v118, v41
v_smfmac_f32_16x16x64_bf16 v[64:67], v[178:181], v[100:107], v213
ds_read_b128 v[100:103], v202 offset:64
ds_read_b128 v[178:181], v217 offset:3696
v_mfma_f32_16x16x32_bf16 v[142:145], a[32:35], v[182:185], v[142:145]
ds_read_b128 v[104:107], v196 offset:80
v_add_f32 v126, v126, v52
v_mfma_f32_16x16x32_bf16 v[146:149], a[56:59], v[182:185], v[146:149]
s_waitcnt lgkmcnt(8)
s_add_u32 m0, s55, 69888
s_add_u32 s29, s54, 49152
buffer_load_dwordx4 v136, s[16:19], s29 offen lds
s_waitcnt lgkmcnt(7)
v_mfma_f32_16x16x32_bf16 v[44:47], v[174:177], v[84:87], 0
s_add_u32 m0, s55, 70912
s_add_u32 s29, s54, 49152
buffer_load_dwordx4 v137, s[16:19], s29 offen lds
v_mfma_f32_16x16x32_bf16 v[150:153], a[224:227], v[182:185], v[150:153]
s_waitcnt lgkmcnt(4)
s_add_u32 m0, s55, 71936
s_add_u32 s29, s54, 49152
buffer_load_dwordx4 v216, s[16:19], s29 offen lds
v_mfma_f32_16x16x32_bf16 v[56:59], v[174:177], v[92:95], 0
s_waitcnt vmcnt(4)
ds_read_b64_tr_b16 a[152:153], v129 offset:12288
ds_read_b64_tr_b16 a[176:177], v129 offset:12320
v_mfma_f32_16x16x32_bf16 v[154:157], a[248:251], v[182:185], v[154:157]
s_waitcnt vmcnt(3) lgkmcnt(4)
ds_read_b64_tr_b16 a[200:201], v129 offset:12352
ds_read_b64_tr_b16 a[154:155], v129 offset:13824
v_mfma_f32_16x16x32_bf16 v[68:71], v[174:177], v[100:103], 0
ds_read_b64_tr_b16 a[178:179], v129 offset:13856
ds_read_b64_tr_b16 a[202:203], v129 offset:13888
v_mfma_f32_16x16x32_bf16 v[158:161], v[240:243], v[182:185], v[158:161]
ds_read_b128 v[84:87], v194 offset:64
ds_read_b128 v[92:95], v195 offset:64
v_mfma_f32_16x16x32_bf16 v[162:165], v[182:185], a[80:83], v[162:165]
ds_read_b128 v[100:103], v196 offset:64
ds_read_b128 v[174:177], v217 offset:4224
v_mfma_f32_16x16x32_bf16 v[166:169], v[182:185], a[104:107], v[166:169]
v_add_f32 v134, v134, v64
v_fmac_f32 v135, v64, v64
v_mfma_f32_16x16x32_bf16 v[170:173], v[182:185], a[128:131], v[170:173]
ds_read_b128 v[182:185], v210 offset:10240
v_fmac_f32_e64 v127, v52, v52
v_mfma_f32_16x16x32_bf16 v[138:141], a[12:15], v[186:189], v[138:141]
v_add_f32_e64 v134, v134, v65
v_fmac_f32 v135, v65, v65
v_mfma_f32_16x16x32_bf16 v[142:145], a[36:39], v[186:189], v[142:145]
s_waitcnt lgkmcnt(5)
s_add_u32 m0, s55, 82176
s_add_u32 s29, s54, 61440
buffer_load_dwordx4 v136, s[16:19], s29 offen lds
s_waitcnt lgkmcnt(4)
v_smfmac_f32_16x16x64_bf16 v[44:47], v[178:181], v[84:91], v213
s_waitcnt lgkmcnt(3)
s_add_u32 m0, s55, 83200
s_add_u32 s29, s54, 61440
buffer_load_dwordx4 v137, s[16:19], s29 offen lds
v_smfmac_f32_16x16x64_bf16 v[56:59], v[178:181], v[92:99], v213
s_waitcnt lgkmcnt(2)
s_add_u32 m0, s55, 84224
s_add_u32 s29, s54, 61440
buffer_load_dwordx4 v216, s[16:19], s29 offen lds
v_smfmac_f32_16x16x64_bf16 v[68:71], v[178:181], v[100:107], v213
ds_read_b128 v[84:87], v197 offset:64
ds_read_b128 v[88:91], v197 offset:80
v_mfma_f32_16x16x32_bf16 v[146:149], a[60:63], v[186:189], v[146:149]
s_sub_u32 s42, s35, s42
ds_read_b128 v[92:95], v198 offset:64
ds_read_b128 v[96:99], v198 offset:80
v_mfma_f32_16x16x32_bf16 v[150:153], a[228:231], v[186:189], v[150:153]
s_mul_i32 s51, s42, 2688
ds_read_b128 v[100:103], v199 offset:64
ds_read_b128 v[104:107], v199 offset:80
v_mfma_f32_16x16x32_bf16 v[154:157], a[252:255], v[186:189], v[154:157]
s_add_u32 s43, s43, s51
v_fmac_f32 v119, v41, v41
v_add_f32_e64 v126, v126, v53
v_mfma_f32_16x16x32_bf16 v[158:161], v[244:247], v[186:189], v[158:161]
s_cmp_lt_u32 s35, s34
v_fmac_f32 v127, v53, v53
v_add_f32_e64 v134, v134, v66
v_mfma_f32_16x16x32_bf16 v[162:165], v[186:189], a[84:87], v[162:165]
s_cselect_b32 s50, s43, 1879048192
v_fmac_f32 v135, v66, v66
v_add_f32 v118, v118, v42
v_mfma_f32_16x16x32_bf16 v[166:169], v[186:189], a[108:111], v[166:169]
s_add_u32 s35, s35, 32
v_fmac_f32 v119, v42, v42
v_add_f32 v126, v126, v54
v_mfma_f32_16x16x32_bf16 v[170:173], v[186:189], a[132:135], v[170:173]
s_waitcnt lgkmcnt(4)
ds_read_b128 v[186:189], v210 offset:11264
v_fmac_f32 v127, v54, v54
v_smfmac_f32_16x16x64_bf16 v[44:47], v[174:177], v[84:91], v213
s_cmp_eq_u32 s42, 0
s_cselect_b32 s44, 536870911, s72
v_add_f32_e64 v134, v134, v67
v_mfma_f32_16x16x32_bf16 v[138:141], a[16:19], v[182:185], v[138:141]
s_waitcnt lgkmcnt(3)
v_fmac_f32 v135, v67, v67
v_add_f32_e64 v118, v118, v43
v_smfmac_f32_16x16x64_bf16 v[56:59], v[174:177], v[92:99], v213
s_cmp_eq_u32 s42, 72
s_cselect_b32 s44, 939524095, s44
v_fmac_f32_e64 v119, v43, v43
v_mfma_f32_16x16x32_bf16 v[142:145], a[40:43], v[182:185], v[142:145]
s_waitcnt lgkmcnt(1)
v_add_f32 v126, v126, v55
v_fmac_f32 v127, v55, v55
v_smfmac_f32_16x16x64_bf16 v[68:71], v[174:177], v[100:107], v213
s_cmp_eq_u32 s41, 0
s_cselect_b32 s52, 1879048192, s50
v_add_f32_e64 v118, v118, v44
v_mfma_f32_16x16x32_bf16 v[146:149], a[64:67], v[182:185], v[146:149]
v_fmac_f32 v119, v44, v44
v_add_f32 v126, v126, v56
v_mfma_f32_16x16x32_bf16 v[150:153], a[232:235], v[182:185], v[150:153]
s_add_u32 m0, s45, 0
v_add_f32 v134, v134, v68
v_fmac_f32_e64 v135, v68, v68
v_mfma_f32_16x16x32_bf16 v[154:157], v[224:227], v[182:185], v[154:157]
s_mov_b32 s36, s50
v_fmac_f32 v127, v56, v56
v_add_f32_e64 v134, v134, v69
v_mfma_f32_16x16x32_bf16 v[158:161], v[248:251], v[182:185], v[158:161]
s_mul_hi_u32 s41, s35, 58835169
v_fmac_f32 v135, v69, v69
v_add_f32 v118, v118, v45
v_mfma_f32_16x16x32_bf16 v[162:165], v[182:185], a[88:91], v[162:165]
s_mul_i32 s42, s41, 73
v_fmac_f32 v119, v45, v45
v_add_f32 v126, v126, v57
v_mfma_f32_16x16x32_bf16 v[166:169], v[182:185], a[112:115], v[166:169]
s_mul_i32 s43, s41, 1373568
v_fmac_f32 v127, v57, v57
v_add_f32 v134, v134, v70
v_mfma_f32_16x16x32_bf16 v[170:173], v[182:185], a[136:139], v[170:173]
s_waitcnt lgkmcnt(0)
ds_read_b128 v[182:185], v210 offset:12288
v_fmac_f32 v135, v70, v70
v_mfma_f32_16x16x32_bf16 v[138:141], a[20:23], v[186:189], v[138:141]
v_add_f32 v118, v118, v46
v_fmac_f32 v119, v46, v46
v_mfma_f32_16x16x32_bf16 v[142:145], a[44:47], v[186:189], v[142:145]
v_add_f32_e64 v126, v126, v58
v_fmac_f32 v127, v58, v58
v_mfma_f32_16x16x32_bf16 v[146:149], a[68:71], v[186:189], v[146:149]
s_waitcnt vmcnt(4)
ds_read_b64_tr_b16 a[164:165], v129
ds_read_b64_tr_b16 a[188:189], v129 offset:32
v_mfma_f32_16x16x32_bf16 v[150:153], a[236:239], v[186:189], v[150:153]
ds_read_b64_tr_b16 a[212:213], v129 offset:64
v_add_f32_e64 v134, v134, v71
v_mfma_f32_16x16x32_bf16 v[154:157], v[228:231], v[186:189], v[154:157]
v_fmac_f32 v135, v71, v71
v_add_f32 v118, v118, v47
v_mfma_f32_16x16x32_bf16 v[158:161], v[252:255], v[186:189], v[158:161]
v_fmac_f32 v119, v47, v47
v_add_f32 v126, v126, v59
v_mfma_f32_16x16x32_bf16 v[162:165], v[186:189], a[92:95], v[162:165]
v_fmac_f32_e64 v127, v59, v59
v_and_b32 v180, s44, v208
v_mfma_f32_16x16x32_bf16 v[166:169], v[186:189], a[116:119], v[166:169]
s_waitcnt vmcnt(3)
ds_read_b64_tr_b16 a[156:157], v129 offset:1536
ds_read_b64_tr_b16 a[180:181], v129 offset:1568
v_mfma_f32_16x16x32_bf16 v[170:173], v[186:189], a[140:143], v[170:173]
s_waitcnt lgkmcnt(5)
ds_read_b64_tr_b16 a[204:205], v129 offset:1600
ds_read_b128 v[186:189], v210 offset:13312
v_permlane16_swap_b32 v134, v135
v_permlane16_swap_b32 v118, v119
v_permlane16_swap_b32 v126, v127
v_add_f32 v134, v134, v135
v_add_f32 v118, v118, v119
v_add_f32 v126, v126, v127
v_mov_b32 v135, v134
v_cvt_pk_bf16_f32 v96, v138, v139
v_permlane32_swap_b32 v118, v126
v_permlane32_swap_b32 v134, v135
v_add_f32 v118, v118, v126
v_add_f32 v134, v134, v135
v_cvt_pk_bf16_f32 v97, v140, v141
v_mfma_f32_16x16x32_bf16 v[138:141], a[0:3], v[182:185], 0
ds_write_b32 v209, v118
v_cvt_pk_bf16_f32 v98, v142, v143
v_cvt_pk_bf16_f32 v99, v144, v145
v_mfma_f32_16x16x32_bf16 v[142:145], a[24:27], v[182:185], 0
s_waitcnt lgkmcnt(1)
ds_write_b32 v209, v134 offset:512
v_mfma_f32_16x16x32_bf16 v[138:141], a[4:7], v[186:189], v[138:141]
s_waitcnt vmcnt(1)
ds_read_b64_tr_b16 a[158:159], v129 offset:12288
ds_read_b64_tr_b16 a[182:183], v129 offset:12320
v_mfma_f32_16x16x32_bf16 v[142:145], a[28:31], v[186:189], v[142:145]
ds_read_b64_tr_b16 a[206:207], v129 offset:12352
v_cvt_pk_bf16_f32 v100, v146, v147
v_cvt_pk_bf16_f32 v101, v148, v149
v_mfma_f32_16x16x32_bf16 v[146:149], a[48:51], v[182:185], 0
ds_read_b128 v[182:185], v210 offset:14336
v_cvt_pk_bf16_f32 v88, v158, v159
v_mfma_f32_16x16x32_bf16 v[146:149], a[52:55], v[186:189], v[146:149]
ds_read_b128 v[186:189], v210 offset:15360
v_cvt_pk_bf16_f32 v89, v160, v161
v_cvt_pk_bf16_f32 v86, v154, v155
v_cvt_pk_bf16_f32 v87, v156, v157
v_mfma_f32_16x16x16_bf16 v[154:157], v[82:83], v[88:89], 0
v_cvt_pk_bf16_f32 v124, v166, v167
v_cvt_pk_bf16_f32 v125, v168, v169
v_cvt_pk_bf16_f32 v84, v150, v151
v_mfma_f32_16x16x16_bf16 v[158:161], v[100:101], v[88:89], 0
v_cvt_pk_bf16_f32 v85, v152, v153
v_cvt_pk_bf16_f32 v116, v162, v163
v_cvt_pk_bf16_f32 v117, v164, v165
v_mfma_f32_16x16x16_bf16 v[166:169], v[112:113], v[88:89], v[206:209]
v_cvt_pk_bf16_f32 v132, v170, v171
v_cvt_pk_bf16_f32 v133, v172, v173
v_mov_b32 v181, 0
v_mfma_f32_16x16x16_bf16 v[150:153], v[112:113], v[76:77], v[206:209]
s_waitcnt vmcnt(0) lgkmcnt(1)
ds_read_b64_tr_b16 a[166:167], v129 offset:13824
ds_read_b64_tr_b16 a[190:191], v129 offset:13856
ds_read_b64_tr_b16 a[214:215], v129 offset:13888
v_mfma_f32_16x16x32_bf16 v[138:141], a[8:11], v[182:185], v[138:141]
v_mfma_f32_16x16x32_bf16 v[142:145], a[32:35], v[182:185], v[142:145]
v_mfma_f32_16x16x32_bf16 v[146:149], a[56:59], v[182:185], v[146:149]
s_nop 0
ds_read_b128 v[182:185], v210 offset:16384
s_waitcnt lgkmcnt(4)
v_mfma_f32_16x16x32_bf16 v[138:141], a[12:15], v[186:189], v[138:141]
v_mfma_f32_16x16x32_bf16 v[142:145], a[36:39], v[186:189], v[142:145]
s_waitcnt lgkmcnt(1)
v_mfma_f32_16x16x32_bf16 v[146:149], a[60:63], v[186:189], v[146:149]
s_barrier
v_mfma_f32_16x16x32_bf16 v[154:157], v[78:81], v[84:87], v[154:157]
buffer_load_dwordx4 v180, s[4:7], s52 offen nt lds
v_mfma_f32_16x16x32_bf16 v[158:161], v[96:99], v[84:87], v[158:161]
s_add_u32 m0, s45, 4112
ds_read_b128 v[102:105], v210 offset:18432
ds_read_b128 v[106:109], v210 offset:19456
ds_read_b128 v[186:189], v210 offset:17408
s_waitcnt lgkmcnt(3)
v_mfma_f32_16x16x32_bf16 v[138:141], a[16:19], v[182:185], v[138:141]
s_add_u32 s40, s36, 196224
v_exp_f32 v154, v154
v_mfma_f32_16x16x32_bf16 v[142:145], a[40:43], v[182:185], v[142:145]
v_exp_f32 v155, v155
v_mfma_f32_16x16x32_bf16 v[146:149], a[64:67], v[182:185], v[146:149]
ds_read_b128 v[182:185], v210 offset:12288
v_exp_f32 v156, v156
v_exp_f32 v157, v157
s_waitcnt lgkmcnt(3)
buffer_load_dwordx4 v180, s[4:7], s40 offen nt lds
s_add_u32 m0, s45, 8224
v_add_f32 v102, v102, v103
v_add_f32 v104, v104, v105
v_add_f32 v102, v102, v104
v_mul_f32 v103, s48, v102
v_mul_f32 v104, s73, v102
s_waitcnt lgkmcnt(1)
v_add_f32_e64 v106, v106, v107
v_mfma_f32_16x16x32_bf16 v[138:141], a[20:23], v[186:189], v[138:141]
s_add_u32 s40, s36, 392448
v_add_f32 v108, v108, v109
v_add_f32 v106, v106, v108
v_mul_f32 v106, s73, v106
v_mfma_f32_16x16x32_bf16 v[142:145], a[44:47], v[186:189], v[142:145]
s_waitcnt lgkmcnt(0)
ds_read_b128 v[108:111], v215 offset:512
v_fma_f32 v106, -v103, v104, v106
v_mfma_f32_16x16x32_bf16 v[170:173], a[240:243], v[182:185], 0
v_max_f32 v106, 0, v106
v_add_f32 v106, s49, v106
v_mfma_f32_16x16x32_bf16 v[146:149], a[68:71], v[186:189], v[146:149]
ds_read_b128 v[186:189], v210 offset:13312
v_rsq_f32 v102, v106
s_nop 0
v_mul_f32_e64 v103, -v103, v102
v_cvt_pk_bf16_f32 v105, v144, v145
v_cvt_pk_bf16_f32 v104, v142, v143
v_mfma_f32_16x16x16_bf16 v[142:145], v[100:101], v[76:77], 0
v_cvt_pk_bf16_f32 v107, v148, v149
v_cvt_pk_bf16_f32 v106, v146, v147
v_exp_f32 v158, v158
v_mfma_f32_16x16x16_bf16 v[162:165], v[106:107], v[88:89], 0
v_exp_f32 v159, v159
v_exp_f32 v160, v160
v_mfma_f32_16x16x16_bf16 v[146:149], v[106:107], v[76:77], 0
buffer_load_dwordx4 v180, s[4:7], s40 offen nt lds
ds_write_b64 v211, v[102:103] offset:20480
v_mfma_f32_16x16x32_bf16 v[142:145], v[96:99], v[72:75], v[142:145]
s_waitcnt lgkmcnt(2)
v_cvt_pk_bf16_f32 v102, v138, v139
v_cvt_pk_bf16_f32 v103, v140, v141
s_add_u32 m0, s45, 12336
v_mfma_f32_16x16x16_bf16 v[138:141], v[82:83], v[76:77], 0
ds_read_b64 v[118:119], v219 offset:20480
ds_read_b64 v[126:127], v219 offset:20736
ds_read_b64 v[134:135], v219 offset:20992
ds_read_b64 v[76:77], v215 offset:16
v_mfma_f32_16x16x32_bf16 v[150:153], v[108:111], v[72:75], v[150:153]
s_add_u32 s40, s36, 588672
v_exp_f32 v142, v142
v_mfma_f32_16x16x32_bf16 v[138:141], v[78:81], v[72:75], v[138:141]
v_exp_f32 v143, v143
v_mfma_f32_16x16x32_bf16 v[146:149], v[102:105], v[72:75], v[146:149]
s_waitcnt lgkmcnt(5)
v_exp_f32 v144, v144
v_mfma_f32_16x16x32_bf16 v[170:173], a[244:247], v[186:189], v[170:173]
v_exp_f32_e64 v145, v145
v_mfma_f32_16x16x32_bf16 v[166:169], v[108:111], v[84:87], v[166:169]
s_waitcnt lgkmcnt(3)
v_fma_f32 v220, v36, v118, v119
v_fma_f32 v221, v37, v118, v119
v_mfma_f32_16x16x32_bf16 v[162:165], v[102:105], v[84:87], v[162:165]
s_waitcnt lgkmcnt(2)
buffer_load_dwordx4 v180, s[4:7], s40 offen nt lds
v_fma_f32 v222, v38, v118, v119
v_fma_f32 v223, v39, v118, v119
v_cvt_pk_bf16_f32 v90, v220, v221
v_cvt_pk_bf16_f32 v91, v222, v223
v_fma_f32 v220, v40, v118, v119
v_fma_f32 v221, v41, v118, v119
v_fma_f32 v222, v42, v118, v119
v_fma_f32 v223, v43, v118, v119
v_cvt_pk_bf16_f32 v92, v220, v221
v_cvt_pk_bf16_f32 v93, v222, v223
v_fma_f32 v220, v44, v118, v119
v_fma_f32 v221, v45, v118, v119
v_fma_f32 v222, v46, v118, v119
v_fma_f32 v223, v47, v118, v119
v_mfma_f32_16x16x32_bf16 v[118:121], v[182:185], a[72:75], 0
s_add_u32 m0, s45, 16448
ds_write_b128 v211, v[90:93] offset:20480
v_mfma_f32_16x16x32_bf16 v[118:121], v[186:189], a[76:79], v[118:121]
s_add_u32 s40, s36, 784896
v_cvt_pk_bf16_f32 v94, v220, v221
v_cvt_pk_bf16_f32 v95, v222, v223
v_fma_f32 v220, v48, v126, v127
v_fma_f32 v221, v49, v126, v127
v_fma_f32 v222, v50, v126, v127
v_fma_f32 v223, v51, v126, v127
v_cvt_pk_bf16_f32 v174, v220, v221
v_cvt_pk_bf16_f32 v175, v222, v223
v_fma_f32 v220, v52, v126, v127
v_fma_f32 v221, v53, v126, v127
v_fma_f32 v222, v54, v126, v127
v_fma_f32 v223, v55, v126, v127
v_cvt_pk_bf16_f32 v176, v220, v221
v_cvt_pk_bf16_f32 v177, v222, v223
v_fma_f32 v220, v56, v126, v127
v_fma_f32 v221, v57, v126, v127
v_fma_f32 v222, v58, v126, v127
v_fma_f32 v223, v59, v126, v127
v_mfma_f32_16x16x32_bf16 v[126:129], v[182:185], a[96:99], 0
s_waitcnt lgkmcnt(2)
buffer_load_dwordx4 v180, s[4:7], s40 offen nt lds
v_mfma_f32_16x16x32_bf16 v[126:129], v[186:189], a[100:103], v[126:129]
s_add_u32 m0, s45, 20560
ds_write_b64 v212, v[94:95] offset:20480
v_cvt_pk_bf16_f32 v178, v220, v221
v_cvt_pk_bf16_f32 v179, v222, v223
v_fma_f32 v220, v60, v134, v135
v_fma_f32 v221, v61, v134, v135
v_fma_f32 v222, v62, v134, v135
v_fma_f32 v223, v63, v134, v135
v_cvt_pk_bf16_f32 v90, v220, v221
v_cvt_pk_bf16_f32 v91, v222, v223
v_fma_f32 v220, v64, v134, v135
v_fma_f32 v221, v65, v134, v135
v_fma_f32 v222, v66, v134, v135
v_fma_f32 v223, v67, v134, v135
v_cvt_pk_bf16_f32 v92, v220, v221
v_cvt_pk_bf16_f32 v93, v222, v223
v_fma_f32 v220, v68, v134, v135
v_fma_f32 v221, v69, v134, v135
v_fma_f32 v222, v70, v134, v135
v_fma_f32 v223, v71, v134, v135
v_mfma_f32_16x16x32_bf16 v[134:137], v[182:185], a[120:123], 0
s_add_u32 s40, s36, 981120
ds_write_b128 v211, v[90:93] offset:32768
v_mfma_f32_16x16x32_bf16 v[90:93], a[216:219], v[182:185], 0
s_nop 0
buffer_load_dwordx4 v180, s[4:7], s40 offen nt lds
v_mfma_f32_16x16x32_bf16 v[134:137], v[186:189], a[124:127], v[134:137]
s_add_u32 m0, s45, 24672
v_cvt_pk_bf16_f32 v94, v220, v221
v_cvt_pk_bf16_f32 v95, v222, v223
v_mfma_f32_16x16x32_bf16 v[220:223], v[232:235], v[182:185], 0
s_add_u32 s40, s36, 1177344
ds_read_b128 v[182:185], v210 offset:14336
ds_write_b128 v211, v[174:177] offset:26624
v_mfma_f32_16x16x32_bf16 v[90:93], a[220:223], v[186:189], v[90:93]
v_exp_f32_e64 v138, v138
v_mfma_f32_16x16x32_bf16 v[220:223], v[236:239], v[186:189], v[220:223]
ds_read_b128 v[186:189], v210 offset:15360
ds_write_b64 v212, v[178:179] offset:26624
v_exp_f32 v139, v139
v_exp_f32 v140, v140
v_exp_f32 v141, v141
s_waitcnt lgkmcnt(3)
v_mfma_f32_16x16x32_bf16 v[118:121], v[182:185], a[80:83], v[118:121]
ds_write_b64 v212, v[94:95] offset:32768
v_mfma_f32_16x16x32_bf16 v[126:129], v[182:185], a[104:107], v[126:129]
buffer_load_dwordx4 v180, s[4:7], s40 offen nt lds
v_mfma_f32_16x16x32_bf16 v[134:137], v[182:185], a[128:131], v[134:137]
s_add_u32 m0, s45, 28784
v_exp_f32_e64 v150, v150
v_mfma_f32_16x16x32_bf16 v[90:93], a[224:227], v[182:185], v[90:93]
v_cvt_pk_bf16_f32 v176, v142, v143
v_cvt_pk_bf16_f32 v177, v144, v145
v_mfma_f32_16x16x32_bf16 v[170:173], a[248:251], v[182:185], v[170:173]
s_add_u32 s40, s36, 1373568
v_cvt_pk_bf16_f32 v174, v138, v139
v_cvt_pk_bf16_f32 v175, v140, v141
v_mfma_f32_16x16x32_bf16 v[220:223], v[240:243], v[182:185], v[220:223]
s_waitcnt lgkmcnt(2)
ds_read_b128 v[182:185], v210 offset:16384
ds_read_b128 v[72:75], v215
v_mfma_f32_16x16x32_bf16 v[118:121], v[186:189], a[84:87], v[118:121]
v_exp_f32 v161, v161
v_mfma_f32_16x16x32_bf16 v[126:129], v[186:189], a[108:111], v[126:129]
v_exp_f32 v166, v166
v_mfma_f32_16x16x32_bf16 v[134:137], v[186:189], a[132:135], v[134:137]
v_exp_f32 v146, v146
v_mfma_f32_16x16x32_bf16 v[90:93], a[228:231], v[186:189], v[90:93]
v_exp_f32_e64 v147, v147
v_mfma_f32_16x16x32_bf16 v[170:173], a[252:255], v[186:189], v[170:173]
v_exp_f32 v148, v148
v_mfma_f32_16x16x32_bf16 v[220:223], v[244:247], v[186:189], v[220:223]
s_waitcnt lgkmcnt(1)
ds_read_b128 v[186:189], v210 offset:17408
buffer_load_dwordx4 v180, s[4:7], s40 offen nt lds
v_mfma_f32_16x16x32_bf16 v[118:121], v[182:185], a[88:91], v[118:121]
s_add_u32 m0, s45, 32896
v_exp_f32 v149, v149
v_mfma_f32_16x16x32_bf16 v[126:129], v[182:185], a[112:115], v[126:129]
s_add_u32 s40, s36, 1569792
v_exp_f32 v162, v162
v_mfma_f32_16x16x32_bf16 v[134:137], v[182:185], a[136:139], v[134:137]
s_sub_u32 s42, s35, s42
v_exp_f32 v163, v163
v_mfma_f32_16x16x32_bf16 v[90:93], a[232:235], v[182:185], v[90:93]
s_mul_i32 s51, s42, 2688
v_exp_f32 v164, v164
v_mfma_f32_16x16x32_bf16 v[170:173], v[224:227], v[182:185], v[170:173]
s_add_u32 s43, s43, s51
v_exp_f32_e64 v165, v165
v_mfma_f32_16x16x32_bf16 v[220:223], v[248:251], v[182:185], v[220:223]
s_waitcnt lgkmcnt(0)
v_cvt_pk_bf16_f32 v178, v146, v147
v_cvt_pk_bf16_f32 v179, v148, v149
v_mfma_f32_16x16x32_bf16 v[118:121], v[186:189], a[92:95], v[118:121]
s_cmp_lt_u32 s35, s34
s_cselect_b32 s50, s43, 1879048192
s_add_u32 s35, s35, 32
v_mfma_f32_16x16x32_bf16 v[126:129], v[186:189], a[116:119], v[126:129]
s_cmp_eq_u32 s42, 0
s_cselect_b32 s44, 536870911, s72
s_cmp_eq_u32 s42, 72
v_mfma_f32_16x16x32_bf16 v[134:137], v[186:189], a[140:143], v[134:137]
s_cselect_b32 s44, 939524095, s44
v_cvt_pk_bf16_f32 v118, v118, v119
v_cvt_pk_bf16_f32 v119, v120, v121
v_mfma_f32_16x16x32_bf16 v[90:93], a[236:239], v[186:189], v[90:93]
s_cmp_eq_u32 s41, 0
buffer_load_dwordx4 v180, s[4:7], s40 offen nt lds
v_mfma_f32_16x16x32_bf16 v[170:173], v[228:231], v[186:189], v[170:173]
s_cselect_b32 s52, 1879048192, s50
ds_read_u16 v120, v214 offset:1024
v_cvt_pk_bf16_f32 v180, v150, 0
v_mfma_f32_16x16x32_bf16 v[220:223], v[252:255], v[186:189], v[220:223]
s_mov_b32 s37, s50
v_cvt_pk_bf16_f32 v90, v90, v91
v_cvt_pk_bf16_f32 v91, v92, v93
v_mfma_f32_16x16x32_bf16 v[150:153], v[190:193], v[174:177], 0
s_add_u32 m0, s45, 0
v_cvt_pk_bf16_f32 v92, v170, v171
v_cvt_pk_bf16_f32 v93, v172, v173
v_mfma_f32_16x16x32_bf16 v[138:141], v[114:117], v[174:177], 0
s_nop 0
v_cvt_pk_bf16_f32 v126, v126, v127
v_cvt_pk_bf16_f32 v127, v128, v129
v_mfma_f32_16x16x32_bf16 v[142:145], v[122:125], v[174:177], 0
ds_read_u16 v128, v214 offset:1032
v_cvt_pk_bf16_f32 v134, v134, v135
v_mfma_f32_16x16x32_bf16 v[146:149], v[130:133], v[174:177], 0
v_cvt_pk_bf16_f32 v174, v154, v155
v_cvt_pk_bf16_f32 v175, v156, v157
v_mfma_f32_16x16x32_bf16 v[150:153], v[190:193], v[178:181], v[150:153]
v_cvt_pk_bf16_f32 v176, v158, v159
v_cvt_pk_bf16_f32 v177, v160, v161
v_cvt_pk_bf16_f32 v135, v136, v137
v_mov_b32_e64 v121, 0
v_mfma_f32_16x16x32_bf16 v[154:157], v[114:117], v[174:177], 0
ds_read_u16 v136, v214 offset:1040
v_mov_b32 v129, 0
v_mfma_f32_16x16x32_bf16 v[158:161], v[122:125], v[174:177], 0
s_waitcnt lgkmcnt(2)
v_rcp_f32 v151, v150
v_mfma_f32_16x16x32_bf16 v[138:141], v[118:121], v[178:181], v[138:141]
s_waitcnt lgkmcnt(1)
v_max3_u32 v218, v218, v150, v151
v_mul_f32_e64 v151, s3, v151
v_mfma_f32_16x16x32_bf16 v[142:145], v[126:129], v[178:181], v[142:145]
v_mov_b32_e64 v137, 0
v_cvt_pk_bf16_f32 v94, v220, v221
v_cvt_pk_bf16_f32 v95, v222, v223
v_mul_f32 v138, v138, v151
v_mul_f32 v139, v139, v151
v_mul_f32 v140, v140, v151
v_mul_f32 v141, v141, v151
v_cvt_pk_bf16_f32 v138, v138, v139
v_mul_f32_e64 v142, v142, v151
v_mul_f32 v143, v143, v151
s_waitcnt lgkmcnt(0)
v_mfma_f32_16x16x32_bf16 v[146:149], v[134:137], v[178:181], v[146:149]
v_cvt_pk_bf16_f32 v180, v166, 0
v_mul_f32_e64 v144, v144, v151
v_mfma_f32_16x16x32_bf16 v[166:169], v[190:193], v[174:177], 0
v_mul_f32_e64 v145, v145, v151
v_cvt_pk_bf16_f32 v139, v140, v141
v_cvt_pk_bf16_f32 v140, v142, v143
v_cvt_pk_bf16_f32 v141, v144, v145
v_cvt_pk_bf16_f32 v178, v162, v163
v_cvt_pk_bf16_f32 v179, v164, v165
v_mfma_f32_16x16x32_bf16 v[162:165], v[130:133], v[174:177], 0
ds_write_b128 v211, v[138:141] offset:38912
v_mfma_f32_16x16x32_bf16 v[138:141], v[78:81], v[90:93], 0
v_mul_f32 v146, v146, v151
v_mul_f32 v147, v147, v151
v_mfma_f32_16x16x32_bf16 v[166:169], v[190:193], v[178:181], v[166:169]
v_mul_f32 v148, v148, v151
v_mul_f32 v149, v149, v151
v_mfma_f32_16x16x32_bf16 v[154:157], v[118:121], v[178:181], v[154:157]
v_cvt_pk_bf16_f32 v142, v146, v147
v_cvt_pk_bf16_f32 v143, v148, v149
v_mfma_f32_16x16x32_bf16 v[158:161], v[126:129], v[178:181], v[158:161]
ds_write_b64 v212, v[142:143] offset:38912
v_mfma_f32_16x16x32_bf16 v[142:145], v[96:99], v[90:93], 0
v_rcp_f32 v167, v166
v_mfma_f32_16x16x32_bf16 v[162:165], v[134:137], v[178:181], v[162:165]
v_max3_u32 v218, v218, v166, v167
v_mul_f32 v167, s3, v167
v_mfma_f32_16x16x32_bf16 v[150:153], v[108:111], v[90:93], v[206:209]
v_mul_f32 v154, v154, v167
v_mul_f32 v155, v155, v167
v_mfma_f32_16x16x32_bf16 v[146:149], v[102:105], v[90:93], 0
v_mul_f32 v156, v156, v167
v_mul_f32 v157, v157, v167
v_cvt_pk_bf16_f32 v154, v154, v155
v_mfma_f32_16x16x16_bf16 v[138:141], v[82:83], v[94:95], v[138:141]
v_mul_f32 v158, v158, v167
v_mul_f32 v159, v159, v167
v_mul_f32_e64 v160, v160, v167
v_mfma_f32_16x16x16_bf16 v[142:145], v[100:101], v[94:95], v[142:145]
v_mul_f32_e64 v161, v161, v167
v_cvt_pk_bf16_f32 v155, v156, v157
v_cvt_pk_bf16_f32 v156, v158, v159
v_mfma_f32_16x16x16_bf16 v[150:153], v[112:113], v[94:95], v[150:153]
v_cvt_pk_bf16_f32 v157, v160, v161
v_mul_f32 v162, v162, v167
v_mul_f32 v163, v163, v167
v_mfma_f32_16x16x16_bf16 v[146:149], v[106:107], v[94:95], v[146:149]
v_mul_f32 v164, v164, v167
v_mul_f32 v165, v165, v167
v_cvt_pk_bf16_f32 v158, v162, v163
v_mfma_f32_16x16x16_bf16 v[166:169], v[76:77], v[112:113], v[206:209]
v_cvt_pk_bf16_f32 v159, v164, v165
v_exp_f32 v138, v138
v_mfma_f32_16x16x16_bf16 v[162:165], v[76:77], v[106:107], 0
v_exp_f32 v139, v139
v_exp_f32 v140, v140
v_mfma_f32_16x16x32_bf16 v[166:169], v[72:75], v[108:111], v[166:169]
ds_write_b128 v211, v[154:157] offset:45056
v_mfma_f32_16x16x16_bf16 v[154:157], v[76:77], v[82:83], 0
v_exp_f32 v141, v141
v_exp_f32 v142, v142
v_mfma_f32_16x16x32_bf16 v[162:165], v[72:75], v[102:105], v[162:165]
v_exp_f32 v143, v143
v_mfma_f32_16x16x32_bf16 v[154:157], v[72:75], v[78:81], v[154:157]
ds_write_b64 v212, v[158:159] offset:45056
v_mfma_f32_16x16x16_bf16 v[158:161], v[76:77], v[100:101], 0
v_exp_f32 v144, v144
v_exp_f32 v145, v145
v_exp_f32_e64 v150, v150
v_mfma_f32_16x16x32_bf16 v[158:161], v[72:75], v[96:99], v[158:161]
v_cvt_pk_bf16_f32 v174, v138, v139
v_cvt_pk_bf16_f32 v175, v140, v141
v_cvt_pk_bf16_f32 v176, v142, v143
v_cvt_pk_bf16_f32 v177, v144, v145
v_cvt_pk_bf16_f32 v180, v150, 0
v_exp_f32_e64 v146, v146
v_mfma_f32_16x16x32_bf16 v[150:153], v[190:193], v[174:177], 0
v_exp_f32 v147, v147
v_mfma_f32_16x16x32_bf16 v[138:141], v[114:117], v[174:177], 0
s_waitcnt lgkmcnt(0)
v_exp_f32 v148, v148
v_mfma_f32_16x16x32_bf16 v[142:145], v[122:125], v[174:177], 0
s_barrier
ds_read_b128 v[170:173], v210 offset:38912
ds_read_b128 v[182:185], v210 offset:39936
ds_read_b128 v[186:189], v210 offset:40960
v_exp_f32_e64 v149, v149
v_cvt_pk_bf16_f32 v178, v146, v147
v_cvt_pk_bf16_f32 v179, v148, v149
v_mfma_f32_16x16x32_bf16 v[146:149], v[130:133], v[174:177], 0
v_mov_b32_dpp v154, v158 quad_perm:[0,1,2,3] row_mask:0x2 bank_mask:0xf
v_mfma_f32_16x16x32_bf16 v[150:153], v[190:193], v[178:181], v[150:153]
v_mov_b32_dpp v154, v162 quad_perm:[0,1,2,3] row_mask:0x4 bank_mask:0xf
v_mfma_f32_16x16x32_bf16 v[138:141], v[118:121], v[178:181], v[138:141]
v_mov_b32_dpp v154, v167 quad_perm:[0,1,2,3] row_mask:0x8 bank_mask:0xf
v_exp_f32_e64 v154, v154
v_mfma_f32_16x16x32_bf16 v[142:145], v[126:129], v[178:181], v[142:145]
v_cvt_pk_bf16_f32 v154, v154, 0
v_rcp_f32 v151, v150
v_mfma_f32_16x16x32_bf16 v[146:149], v[134:137], v[178:181], v[146:149]
s_waitcnt lgkmcnt(2)
ds_write_b16 v214, v154
v_mfma_f32_16x16x32_bf16 v[0:3], a[144:147], v[170:173], v[0:3]
ds_read_b128 v[84:87], v215
ds_read_b128 v[88:91], v215 offset:16
v_mfma_f32_16x16x32_bf16 v[4:7], a[168:171], v[170:173], v[4:7]
s_nop 0
ds_read_b128 v[174:177], v217
ds_read_b128 v[178:181], v217 offset:528
v_mfma_f32_16x16x32_bf16 v[8:11], a[192:195], v[170:173], v[8:11]
s_waitcnt lgkmcnt(6)
ds_read_b128 v[170:173], v210 offset:41984
v_add_u32 v215, 1552, v215
v_mfma_f32_16x16x32_bf16 v[0:3], a[148:151], v[182:185], v[0:3]
ds_read_b64 v[112:113], v215 offset:528
v_mfma_f32_16x16x32_bf16 v[4:7], a[172:175], v[182:185], v[4:7]
v_mfma_f32_16x16x32_bf16 v[8:11], a[196:199], v[182:185], v[8:11]
s_nop 0
ds_read_b128 v[182:185], v210 offset:43008
s_waitcnt lgkmcnt(6)
v_mfma_f32_16x16x32_bf16 v[166:169], v[84:87], v[190:193], 0
v_mfma_f32_16x16x32_bf16 v[154:157], v[84:87], v[114:117], 0
v_mfma_f32_16x16x32_bf16 v[158:161], v[84:87], v[122:125], 0
v_mfma_f32_16x16x32_bf16 v[162:165], v[84:87], v[130:133], 0
s_waitcnt lgkmcnt(5)
v_mfma_f32_16x16x32_bf16 v[166:169], v[88:91], v[190:193], v[166:169]
v_mfma_f32_16x16x32_bf16 v[154:157], v[88:91], v[118:121], v[154:157]
v_mfma_f32_16x16x32_bf16 v[158:161], v[88:91], v[126:129], v[158:161]
v_rcp_f32 v167, v166
v_mfma_f32_16x16x32_bf16 v[162:165], v[88:91], v[134:137], v[162:165]
v_max3_u32 v218, v218, v166, v167
v_max3_u32 v218, v218, v150, v151
v_mfma_f32_16x16x32_bf16 v[0:3], a[152:155], v[186:189], v[0:3]
v_mul_f32 v151, s3, v151
v_mul_f32 v138, v138, v151
v_mfma_f32_16x16x32_bf16 v[4:7], a[176:179], v[186:189], v[4:7]
v_mul_f32_e64 v139, v139, v151
v_mul_f32 v140, v140, v151
v_mfma_f32_16x16x32_bf16 v[8:11], a[200:203], v[186:189], v[8:11]
s_waitcnt lgkmcnt(2)
ds_read_b128 v[186:189], v210 offset:44032
v_mul_f32_e64 v141, v141, v151
v_mfma_f32_16x16x32_bf16 v[0:3], a[156:159], v[170:173], v[0:3]
v_cvt_pk_bf16_f32 v138, v138, v139
v_mul_f32_e64 v142, v142, v151
v_mfma_f32_16x16x32_bf16 v[4:7], a[180:183], v[170:173], v[4:7]
v_mul_f32_e64 v143, v143, v151
v_mul_f32 v144, v144, v151
v_mfma_f32_16x16x32_bf16 v[8:11], a[204:207], v[170:173], v[8:11]
s_waitcnt lgkmcnt(1)
ds_read_b128 v[170:173], v210 offset:45056
v_mul_f32_e64 v145, v145, v151
v_mfma_f32_16x16x32_bf16 v[0:3], a[160:163], v[182:185], v[0:3]
v_cvt_pk_bf16_f32 v139, v140, v141
v_cvt_pk_bf16_f32 v140, v142, v143
v_mfma_f32_16x16x32_bf16 v[4:7], a[184:187], v[182:185], v[4:7]
v_cvt_pk_bf16_f32 v141, v144, v145
v_mul_f32 v146, v146, v151
v_mfma_f32_16x16x32_bf16 v[8:11], a[208:211], v[182:185], v[8:11]
s_waitcnt lgkmcnt(1)
ds_read_b128 v[182:185], v210 offset:46080
ds_write_b128 v211, v[138:141] offset:51200
v_mfma_f32_16x16x32_bf16 v[0:3], a[164:167], v[186:189], v[0:3]
v_mul_f32 v147, v147, v151
v_mul_f32 v148, v148, v151
v_mfma_f32_16x16x32_bf16 v[4:7], a[188:191], v[186:189], v[4:7]
v_mul_f32 v149, v149, v151
v_cvt_pk_bf16_f32 v142, v146, v147
v_mfma_f32_16x16x32_bf16 v[8:11], a[212:215], v[186:189], v[8:11]
s_waitcnt lgkmcnt(2)
ds_read_b128 v[186:189], v210 offset:47104
v_cvt_pk_bf16_f32 v143, v148, v149
v_mfma_f32_16x16x32_bf16 v[12:15], a[144:147], v[170:173], v[12:15]
ds_write_b64 v212, v[142:143] offset:51200
v_mfma_f32_16x16x32_bf16 v[16:19], a[168:171], v[170:173], v[16:19]
s_nop 0
v_cvt_pk_bf16_f32 v72, v0, v1
v_cvt_pk_bf16_f32 v73, v2, v3
v_mfma_f32_16x16x32_bf16 v[20:23], a[192:195], v[170:173], v[20:23]
s_waitcnt lgkmcnt(3)
ds_read_b128 v[170:173], v210 offset:48128
buffer_store_dwordx2 v[72:73], v203, s[8:11], s38 offen
v_cvt_pk_bf16_f32 v74, v4, v5
v_mfma_f32_16x16x32_bf16 v[12:15], a[148:151], v[182:185], v[12:15]
v_cvt_pk_bf16_f32 v75, v6, v7
v_mov_b32_dpp v154, v158 quad_perm:[0,1,2,3] row_mask:0x2 bank_mask:0xf
v_mfma_f32_16x16x32_bf16 v[16:19], a[172:175], v[182:185], v[16:19]
v_mul_f32 v167, s3, v167
v_mov_b32_dpp v154, v162 quad_perm:[0,1,2,3] row_mask:0x4 bank_mask:0xf
v_mfma_f32_16x16x32_bf16 v[20:23], a[196:199], v[182:185], v[20:23]
s_waitcnt lgkmcnt(2)
ds_read_b128 v[182:185], v210 offset:49152
v_mul_f32_e64 v154, v154, v167
v_mfma_f32_16x16x32_bf16 v[12:15], a[152:155], v[186:189], v[12:15]
s_nop 0
v_cvt_pk_bf16_f32 v76, v8, v9
v_cvt_pk_bf16_f32 v77, v10, v11
v_mfma_f32_16x16x32_bf16 v[16:19], a[176:179], v[186:189], v[16:19]
s_waitcnt vmcnt(1) lgkmcnt(2)
v_cvt_pk_bf16_f32 v154, v154, 0
s_barrier
v_mfma_f32_16x16x32_bf16 v[20:23], a[200:203], v[186:189], v[20:23]
s_waitcnt lgkmcnt(1)
ds_read_b128 v[186:189], v210 offset:50176
ds_read_b128 v[84:87], v200
v_mfma_f32_16x16x32_bf16 v[12:15], a[156:159], v[170:173], v[12:15]
ds_read_b128 v[92:95], v201
ds_read_b128 v[100:103], v202
v_mfma_f32_16x16x32_bf16 v[16:19], a[180:183], v[170:173], v[16:19]
ds_read_b128 v[88:91], v194 offset:16
ds_read_b128 v[96:99], v195 offset:16
v_mfma_f32_16x16x32_bf16 v[20:23], a[204:207], v[170:173], v[20:23]
ds_read_b128 v[170:173], v210 offset:51200
s_waitcnt lgkmcnt(7)
v_mfma_f32_16x16x32_bf16 v[12:15], a[160:163], v[182:185], v[12:15]
ds_read_b128 v[104:107], v196 offset:16
v_mfma_f32_16x16x32_bf16 v[16:19], a[184:187], v[182:185], v[16:19]
buffer_store_dwordx2 v[74:75], v203, s[8:11], s38 offen offset:32
ds_write_b16 v214, v154
v_mfma_f32_16x16x32_bf16 v[20:23], a[208:211], v[182:185], v[20:23]
s_waitcnt lgkmcnt(8)
ds_read_b128 v[182:185], v210 offset:52224
v_add_u32 v214, 1552, v214
v_mfma_f32_16x16x32_bf16 v[12:15], a[164:167], v[186:189], v[12:15]
v_mfma_f32_16x16x32_bf16 v[16:19], a[188:191], v[186:189], v[16:19]
s_nop 0
v_mfma_f32_16x16x32_bf16 v[20:23], a[212:215], v[186:189], v[20:23]
s_waitcnt lgkmcnt(8)
ds_read_b128 v[186:189], v210 offset:53248
v_cvt_pk_bf16_f32 v78, v12, v13
v_mfma_f32_16x16x32_bf16 v[0:3], v[174:177], v[84:87], 0
s_waitcnt lgkmcnt(8)
ds_read_b128 v[84:87], v194
v_cvt_pk_bf16_f32 v79, v14, v15
v_mfma_f32_16x16x32_bf16 v[12:15], v[174:177], v[92:95], 0
s_waitcnt lgkmcnt(5)
ds_read_b128 v[92:95], v195
v_cvt_pk_bf16_f32 v80, v16, v17
v_mfma_f32_16x16x32_bf16 v[24:27], a[144:147], v[170:173], v[24:27]
v_cvt_pk_bf16_f32 v81, v18, v19
v_cvt_pk_bf16_f32 v82, v20, v21
v_mfma_f32_16x16x32_bf16 v[28:31], a[168:171], v[170:173], v[28:31]
v_cvt_pk_bf16_f32 v83, v22, v23
v_mfma_f32_16x16x32_bf16 v[32:35], a[192:195], v[170:173], v[32:35]
ds_read_b128 v[170:173], v210 offset:54272
s_waitcnt lgkmcnt(4)
v_mfma_f32_16x16x32_bf16 v[24:27], a[148:151], v[182:185], v[24:27]
v_mfma_f32_16x16x32_bf16 v[28:31], a[172:175], v[182:185], v[28:31]
v_mfma_f32_16x16x32_bf16 v[32:35], a[196:199], v[182:185], v[32:35]
ds_read_b128 v[182:185], v210 offset:55296
s_waitcnt lgkmcnt(4)
v_mfma_f32_16x16x32_bf16 v[24:27], a[152:155], v[186:189], v[24:27]
v_mfma_f32_16x16x32_bf16 v[28:31], a[176:179], v[186:189], v[28:31]
v_mfma_f32_16x16x32_bf16 v[32:35], a[200:203], v[186:189], v[32:35]
s_nop 0
ds_read_b128 v[186:189], v210 offset:56320
s_waitcnt lgkmcnt(2)
v_mfma_f32_16x16x32_bf16 v[24:27], a[156:159], v[170:173], v[24:27]
buffer_store_dwordx2 v[76:77], v203, s[8:11], s38 offen offset:64
v_mfma_f32_16x16x32_bf16 v[28:31], a[180:183], v[170:173], v[28:31]
v_mfma_f32_16x16x32_bf16 v[32:35], a[204:207], v[170:173], v[32:35]
s_waitcnt lgkmcnt(1)
v_mfma_f32_16x16x32_bf16 v[24:27], a[160:163], v[182:185], v[24:27]
v_mfma_f32_16x16x32_bf16 v[28:31], a[184:187], v[182:185], v[28:31]
v_mfma_f32_16x16x32_bf16 v[32:35], a[208:211], v[182:185], v[32:35]
ds_read_b128 v[182:185], v210 offset:20480
s_waitcnt lgkmcnt(1)
v_mfma_f32_16x16x32_bf16 v[24:27], a[164:167], v[186:189], v[24:27]
v_smfmac_f32_16x16x64_bf16 v[0:3], v[178:181], v[84:91], v213
ds_read_b128 v[84:87], v197
ds_read_b128 v[88:91], v197 offset:16
v_mfma_f32_16x16x32_bf16 v[28:31], a[188:191], v[186:189], v[28:31]
v_cvt_pk_bf16_f32 v116, v24, v25
v_cvt_pk_bf16_f32 v117, v26, v27
v_mfma_f32_16x16x32_bf16 v[24:27], v[174:177], v[100:103], 0
ds_read_b128 v[100:103], v196
ds_read_b128 v[174:177], v217 offset:1056
v_mfma_f32_16x16x32_bf16 v[32:35], a[212:215], v[186:189], v[32:35]
s_nop 0
ds_read_b128 v[186:189], v210 offset:21504
v_cvt_pk_bf16_f32 v124, v28, v29
v_smfmac_f32_16x16x64_bf16 v[12:15], v[178:181], v[92:99], v213
s_waitcnt lgkmcnt(5)
ds_read_b128 v[92:95], v198
ds_read_b128 v[96:99], v198 offset:16
v_mfma_f32_16x16x32_bf16 v[138:141], a[0:3], v[182:185], 0
v_cvt_pk_bf16_f32 v125, v30, v31
v_cvt_pk_bf16_f32 v132, v32, v33
v_mfma_f32_16x16x32_bf16 v[142:145], a[24:27], v[182:185], 0
s_nop 0
v_cvt_pk_bf16_f32 v133, v34, v35
v_mfma_f32_16x16x32_bf16 v[146:149], a[48:51], v[182:185], 0
s_waitcnt lgkmcnt(4)
v_smfmac_f32_16x16x64_bf16 v[24:27], v[178:181], v[100:107], v213
ds_read_b128 v[100:103], v199
ds_read_b128 v[104:107], v199 offset:16
v_mfma_f32_16x16x32_bf16 v[150:153], a[216:219], v[182:185], 0
ds_read_b128 v[178:181], v217 offset:1584
buffer_store_dwordx2 v[78:79], v204, s[8:11], s38 offen
s_waitcnt lgkmcnt(6)
v_smfmac_f32_16x16x64_bf16 v[0:3], v[174:177], v[84:91], v213
ds_read_b128 v[84:87], v200 offset:32
ds_read_b128 v[88:91], v194 offset:48
v_mfma_f32_16x16x32_bf16 v[154:157], a[240:243], v[182:185], 0
s_waitcnt lgkmcnt(5)
v_smfmac_f32_16x16x64_bf16 v[12:15], v[174:177], v[92:99], v213
ds_read_b128 v[92:95], v201 offset:32
ds_read_b128 v[96:99], v195 offset:48
v_mfma_f32_16x16x32_bf16 v[158:161], v[232:235], v[182:185], 0
v_mul_f32 v119, v0, v0
v_add_f32 v118, v0, v1
v_mfma_f32_16x16x32_bf16 v[162:165], v[182:185], a[72:75], 0
s_waitcnt lgkmcnt(5)
v_mul_f32 v127, v12, v12
v_add_f32_e64 v126, v12, v13
v_smfmac_f32_16x16x64_bf16 v[24:27], v[174:177], v[100:107], v213
ds_read_b128 v[100:103], v202 offset:32
ds_read_b128 v[174:177], v217 offset:2112
v_mfma_f32_16x16x32_bf16 v[166:169], v[182:185], a[96:99], 0
s_waitcnt lgkmcnt(5)
ds_read_b128 v[104:107], v196 offset:48
v_fmac_f32 v119, v1, v1
v_mfma_f32_16x16x32_bf16 v[4:7], v[178:181], v[84:87], 0
ds_read_b128 v[84:87], v194 offset:32
v_mul_f32 v135, v24, v24
v_mfma_f32_16x16x32_bf16 v[170:173], v[182:185], a[120:123], 0
s_waitcnt lgkmcnt(5)
ds_read_b128 v[182:185], v210 offset:22528
v_add_f32_e64 v134, v24, v25
v_mfma_f32_16x16x32_bf16 v[16:19], v[178:181], v[92:95], 0
ds_read_b128 v[92:95], v195 offset:32
v_fmac_f32_e64 v135, v25, v25
v_mfma_f32_16x16x32_bf16 v[138:141], a[4:7], v[186:189], v[138:141]
v_fmac_f32 v127, v13, v13
v_add_f32 v134, v134, v26
v_mfma_f32_16x16x32_bf16 v[142:145], a[28:31], v[186:189], v[142:145]
s_waitcnt lgkmcnt(5)
v_fmac_f32 v135, v26, v26
v_add_f32_e64 v118, v118, v2
v_mfma_f32_16x16x32_bf16 v[28:31], v[178:181], v[100:103], 0
ds_read_b128 v[100:103], v196 offset:32
ds_read_b128 v[178:181], v217 offset:2640
v_mfma_f32_16x16x32_bf16 v[146:149], a[52:55], v[186:189], v[146:149]
v_add_f32_e64 v126, v126, v14
v_fmac_f32 v119, v2, v2
v_mfma_f32_16x16x32_bf16 v[150:153], a[220:223], v[186:189], v[150:153]
s_waitcnt lgkmcnt(4)
buffer_store_dwordx2 v[80:81], v204, s[8:11], s38 offen offset:32
v_fmac_f32 v127, v14, v14
v_smfmac_f32_16x16x64_bf16 v[4:7], v[174:177], v[84:91], v213
s_waitcnt lgkmcnt(2)
ds_read_b128 v[84:87], v197 offset:32
ds_read_b128 v[88:91], v197 offset:48
v_smfmac_f32_16x16x64_bf16 v[16:19], v[174:177], v[92:99], v213
ds_read_b128 v[92:95], v198 offset:32
ds_read_b128 v[96:99], v198 offset:48
v_mfma_f32_16x16x32_bf16 v[154:157], a[244:247], v[186:189], v[154:157]
s_waitcnt lgkmcnt(5)
v_add_f32 v134, v134, v27
v_fmac_f32_e64 v135, v27, v27
v_smfmac_f32_16x16x64_bf16 v[28:31], v[174:177], v[100:107], v213
ds_read_b128 v[100:103], v199 offset:32
ds_read_b128 v[104:107], v199 offset:48
v_mfma_f32_16x16x32_bf16 v[158:161], v[236:239], v[186:189], v[158:161]
ds_read_b128 v[174:177], v217 offset:3168
v_add_f32_e64 v118, v118, v3
v_mfma_f32_16x16x32_bf16 v[162:165], v[186:189], a[76:79], v[162:165]
v_add_f32 v126, v126, v15
v_fmac_f32 v119, v3, v3
v_mfma_f32_16x16x32_bf16 v[166:169], v[186:189], a[100:103], v[166:169]
v_fmac_f32 v127, v15, v15
s_waitcnt lgkmcnt(5)
v_smfmac_f32_16x16x64_bf16 v[4:7], v[178:181], v[84:91], v213
ds_read_b128 v[84:87], v200 offset:64
ds_read_b128 v[88:91], v194 offset:80
v_mfma_f32_16x16x32_bf16 v[170:173], v[186:189], a[124:127], v[170:173]
s_nop 0
ds_read_b128 v[186:189], v210 offset:23552
s_waitcnt lgkmcnt(6)
v_smfmac_f32_16x16x64_bf16 v[16:19], v[178:181], v[92:99], v213
ds_read_b128 v[92:95], v201 offset:64
ds_read_b128 v[96:99], v195 offset:80
v_mfma_f32_16x16x32_bf16 v[138:141], a[8:11], v[182:185], v[138:141]
v_add_f32 v118, v118, v4
v_fmac_f32 v119, v4, v4
v_mfma_f32_16x16x32_bf16 v[142:145], a[32:35], v[182:185], v[142:145]
s_waitcnt lgkmcnt(6)
v_add_f32 v126, v126, v16
v_fmac_f32_e64 v127, v16, v16
v_smfmac_f32_16x16x64_bf16 v[28:31], v[178:181], v[100:107], v213
ds_read_b128 v[100:103], v202 offset:64
ds_read_b128 v[178:181], v217 offset:3696
v_mfma_f32_16x16x32_bf16 v[146:149], a[56:59], v[182:185], v[146:149]
s_waitcnt lgkmcnt(6)
ds_read_b128 v[104:107], v196 offset:80
v_add_f32 v118, v118, v5
v_mfma_f32_16x16x32_bf16 v[8:11], v[174:177], v[84:87], 0
ds_read_b128 v[84:87], v194 offset:64
v_add_f32_e64 v134, v134, v28
v_mfma_f32_16x16x32_bf16 v[150:153], a[224:227], v[182:185], v[150:153]
buffer_store_dwordx2 v[82:83], v204, s[8:11], s38 offen offset:64
v_fmac_f32 v135, v28, v28
v_mfma_f32_16x16x32_bf16 v[154:157], a[248:251], v[182:185], v[154:157]
s_waitcnt lgkmcnt(5)
v_add_f32 v134, v134, v29
v_fmac_f32 v135, v29, v29
v_mfma_f32_16x16x32_bf16 v[20:23], v[174:177], v[92:95], 0
s_waitcnt lgkmcnt(3)
ds_read_b128 v[92:95], v195 offset:64
v_fmac_f32 v119, v5, v5
v_mfma_f32_16x16x32_bf16 v[32:35], v[174:177], v[100:103], 0
ds_read_b128 v[100:103], v196 offset:64
ds_read_b128 v[174:177], v217 offset:4224
v_mfma_f32_16x16x32_bf16 v[158:161], v[240:243], v[182:185], v[158:161]
v_add_f32 v126, v126, v17
v_fmac_f32 v127, v17, v17
v_mfma_f32_16x16x32_bf16 v[162:165], v[182:185], a[80:83], v[162:165]
s_waitcnt lgkmcnt(3)
v_add_f32 v134, v134, v30
v_fmac_f32_e64 v135, v30, v30
v_smfmac_f32_16x16x64_bf16 v[8:11], v[178:181], v[84:91], v213
ds_read_b128 v[84:87], v197 offset:64
ds_read_b128 v[88:91], v197 offset:80
v_mfma_f32_16x16x32_bf16 v[166:169], v[182:185], a[104:107], v[166:169]
v_add_f32_e64 v118, v118, v6
v_fmac_f32 v119, v6, v6
v_mfma_f32_16x16x32_bf16 v[170:173], v[182:185], a[128:131], v[170:173]
s_waitcnt lgkmcnt(4)
ds_read_b128 v[182:185], v210 offset:24576
v_add_f32_e64 v126, v126, v18
v_smfmac_f32_16x16x64_bf16 v[20:23], v[178:181], v[92:99], v213
ds_read_b128 v[92:95], v198 offset:64
ds_read_b128 v[96:99], v198 offset:80
v_mfma_f32_16x16x32_bf16 v[138:141], a[12:15], v[186:189], v[138:141]
s_waitcnt lgkmcnt(6)
v_fmac_f32 v127, v18, v18
v_add_f32_e64 v134, v134, v31
v_smfmac_f32_16x16x64_bf16 v[32:35], v[178:181], v[100:107], v213
ds_read_b128 v[100:103], v199 offset:64
ds_read_b128 v[104:107], v199 offset:80
v_mfma_f32_16x16x32_bf16 v[142:145], a[36:39], v[186:189], v[142:145]
v_fmac_f32 v135, v31, v31
v_add_f32 v118, v118, v7
v_mfma_f32_16x16x32_bf16 v[146:149], a[60:63], v[186:189], v[146:149]
v_fmac_f32 v119, v7, v7
v_add_f32 v126, v126, v19
v_mfma_f32_16x16x32_bf16 v[150:153], a[228:231], v[186:189], v[150:153]
v_fmac_f32 v127, v19, v19
v_and_b32 v180, s44, v208
v_mfma_f32_16x16x32_bf16 v[154:157], a[252:255], v[186:189], v[154:157]
v_mov_b32 v181, 0
s_waitcnt lgkmcnt(5)
v_smfmac_f32_16x16x64_bf16 v[8:11], v[174:177], v[84:91], v213
buffer_store_dwordx2 v[116:117], v205, s[8:11], s38 offen
v_mfma_f32_16x16x32_bf16 v[158:161], v[244:247], v[186:189], v[158:161]
v_mfma_f32_16x16x32_bf16 v[162:165], v[186:189], a[84:87], v[162:165]
s_waitcnt lgkmcnt(2)
v_add_f32 v118, v118, v8
v_fmac_f32_e64 v119, v8, v8
v_smfmac_f32_16x16x64_bf16 v[20:23], v[174:177], v[92:99], v213
v_add_f32 v118, v118, v9
v_mfma_f32_16x16x32_bf16 v[166:169], v[186:189], a[108:111], v[166:169]
v_fmac_f32 v119, v9, v9
v_add_f32 v118, v118, v10
v_mfma_f32_16x16x32_bf16 v[170:173], v[186:189], a[132:135], v[170:173]
s_waitcnt lgkmcnt(0)
ds_read_b128 v[186:189], v210 offset:25600
v_add_f32_e64 v126, v126, v20
v_smfmac_f32_16x16x64_bf16 v[32:35], v[174:177], v[100:107], v213
v_fmac_f32_e64 v127, v20, v20
v_mfma_f32_16x16x32_bf16 v[138:141], a[16:19], v[182:185], v[138:141]
v_add_f32 v126, v126, v21
v_fmac_f32 v127, v21, v21
v_mfma_f32_16x16x32_bf16 v[142:145], a[40:43], v[182:185], v[142:145]
v_add_f32 v134, v134, v32
v_fmac_f32 v135, v32, v32
v_mfma_f32_16x16x32_bf16 v[146:149], a[64:67], v[182:185], v[146:149]
v_add_f32 v134, v134, v33
v_fmac_f32 v135, v33, v33
v_mfma_f32_16x16x32_bf16 v[150:153], a[232:235], v[182:185], v[150:153]
v_add_f32 v134, v134, v34
v_fmac_f32 v135, v34, v34
v_mfma_f32_16x16x32_bf16 v[154:157], v[224:227], v[182:185], v[154:157]
v_fmac_f32 v119, v10, v10
v_add_f32 v126, v126, v22
v_mfma_f32_16x16x32_bf16 v[158:161], v[248:251], v[182:185], v[158:161]
v_fmac_f32 v127, v22, v22
v_add_f32 v134, v134, v35
v_mfma_f32_16x16x32_bf16 v[162:165], v[182:185], a[88:91], v[162:165]
v_fmac_f32 v135, v35, v35
v_add_f32 v118, v118, v11
v_mfma_f32_16x16x32_bf16 v[166:169], v[182:185], a[112:115], v[166:169]
v_fmac_f32_e64 v119, v11, v11
v_add_f32 v126, v126, v23
v_mfma_f32_16x16x32_bf16 v[170:173], v[182:185], a[136:139], v[170:173]
s_waitcnt lgkmcnt(0)
ds_read_b128 v[182:185], v210 offset:26624
buffer_store_dwordx2 v[124:125], v205, s[8:11], s38 offen offset:32
v_fmac_f32_e64 v127, v23, v23
v_mfma_f32_16x16x32_bf16 v[138:141], a[20:23], v[186:189], v[138:141]
v_permlane16_swap_b32 v134, v135
v_mfma_f32_16x16x32_bf16 v[142:145], a[44:47], v[186:189], v[142:145]
v_permlane16_swap_b32 v118, v119
v_mfma_f32_16x16x32_bf16 v[146:149], a[68:71], v[186:189], v[146:149]
v_cvt_pk_bf16_f32 v78, v138, v139
v_cvt_pk_bf16_f32 v79, v140, v141
v_mfma_f32_16x16x32_bf16 v[150:153], a[236:239], v[186:189], v[150:153]
v_cvt_pk_bf16_f32 v80, v142, v143
v_cvt_pk_bf16_f32 v81, v144, v145
v_mfma_f32_16x16x32_bf16 v[154:157], v[228:231], v[186:189], v[154:157]
v_cvt_pk_bf16_f32 v82, v146, v147
v_cvt_pk_bf16_f32 v83, v148, v149
v_mfma_f32_16x16x32_bf16 v[158:161], v[252:255], v[186:189], v[158:161]
v_cvt_pk_bf16_f32 v72, v150, v151
v_cvt_pk_bf16_f32 v73, v152, v153
v_mfma_f32_16x16x32_bf16 v[162:165], v[186:189], a[92:95], v[162:165]
v_cvt_pk_bf16_f32 v74, v154, v155
v_cvt_pk_bf16_f32 v75, v156, v157
v_mfma_f32_16x16x32_bf16 v[166:169], v[186:189], a[116:119], v[166:169]
s_nop 0
v_cvt_pk_bf16_f32 v76, v158, v159
v_cvt_pk_bf16_f32 v77, v160, v161
v_mfma_f32_16x16x32_bf16 v[170:173], v[186:189], a[140:143], v[170:173]
s_waitcnt lgkmcnt(0)
ds_read_b128 v[186:189], v210 offset:27648
v_cvt_pk_bf16_f32 v114, v162, v163
v_mfma_f32_16x16x32_bf16 v[138:141], a[0:3], v[182:185], 0
v_cvt_pk_bf16_f32 v115, v164, v165
v_cvt_pk_bf16_f32 v122, v166, v167
v_mfma_f32_16x16x32_bf16 v[142:145], a[24:27], v[182:185], 0
v_cvt_pk_bf16_f32 v123, v168, v169
v_cvt_pk_bf16_f32 v130, v170, v171
v_mfma_f32_16x16x32_bf16 v[146:149], a[48:51], v[182:185], 0
v_cvt_pk_bf16_f32 v131, v172, v173
v_add_f32_e64 v134, v134, v135
v_mfma_f32_16x16x32_bf16 v[150:153], a[216:219], v[182:185], 0
v_permlane16_swap_b32 v126, v127
v_mfma_f32_16x16x32_bf16 v[154:157], a[240:243], v[182:185], 0
v_add_f32 v118, v118, v119
v_mov_b32_e64 v135, v134
v_mfma_f32_16x16x32_bf16 v[158:161], v[232:235], v[182:185], 0
v_add_f32 v126, v126, v127
v_permlane32_swap_b32 v134, v135
v_mfma_f32_16x16x32_bf16 v[162:165], v[182:185], a[72:75], 0
buffer_store_dwordx2 v[132:133], v205, s[8:11], s38 offen offset:64
v_permlane32_swap_b32 v118, v126
v_mfma_f32_16x16x32_bf16 v[166:169], v[182:185], a[96:99], 0
v_add_f32 v134, v134, v135
v_add_f32 v118, v118, v126
v_mfma_f32_16x16x32_bf16 v[170:173], v[182:185], a[120:123], 0
s_waitcnt lgkmcnt(0)
ds_write_b32 v209, v134 offset:512
v_mfma_f32_16x16x32_bf16 v[138:141], a[4:7], v[186:189], v[138:141]
ds_write_b32 v209, v118
v_mfma_f32_16x16x32_bf16 v[142:145], a[28:31], v[186:189], v[142:145]
ds_read_b128 v[182:185], v210 offset:28672
v_mfma_f32_16x16x32_bf16 v[146:149], a[52:55], v[186:189], v[146:149]
v_mfma_f32_16x16x32_bf16 v[150:153], a[220:223], v[186:189], v[150:153]
v_mfma_f32_16x16x32_bf16 v[154:157], a[244:247], v[186:189], v[154:157]
v_mfma_f32_16x16x32_bf16 v[158:161], v[236:239], v[186:189], v[158:161]
s_waitcnt lgkmcnt(1)
s_barrier
v_mfma_f32_16x16x32_bf16 v[162:165], v[186:189], a[76:79], v[162:165]
ds_read_b128 v[102:105], v210 offset:18432
ds_read_b128 v[106:109], v210 offset:19456
v_mfma_f32_16x16x32_bf16 v[166:169], v[186:189], a[100:103], v[166:169]
v_mfma_f32_16x16x32_bf16 v[170:173], v[186:189], a[124:127], v[170:173]
s_waitcnt lgkmcnt(0)
s_nop 6
s_mov_b32 s46, 7
.p2align 6
F_loop:
ds_read_b128 v[186:189], v210 offset:29696
v_mfma_f32_16x16x32_bf16 v[138:141], a[8:11], v[182:185], v[138:141]
v_mfma_f32_16x16x32_bf16 v[142:145], a[32:35], v[182:185], v[142:145]
v_mfma_f32_16x16x32_bf16 v[146:149], a[56:59], v[182:185], v[146:149]
v_mfma_f32_16x16x32_bf16 v[150:153], a[224:227], v[182:185], v[150:153]
buffer_load_dwordx4 v180, s[4:7], s52 offen nt lds
v_mfma_f32_16x16x32_bf16 v[154:157], a[248:251], v[182:185], v[154:157]
s_waitcnt lgkmcnt(2)
v_add_f32 v102, v102, v103
v_add_f32_e64 v104, v104, v105
v_mfma_f32_16x16x32_bf16 v[158:161], v[240:243], v[182:185], v[158:161]
s_waitcnt lgkmcnt(1)
v_add_f32 v106, v106, v107
v_add_f32_e64 v108, v108, v109
v_mfma_f32_16x16x32_bf16 v[162:165], v[182:185], a[80:83], v[162:165]
s_waitcnt lgkmcnt(0)
v_add_f32 v102, v102, v104
v_add_f32_e64 v106, v106, v108
v_mfma_f32_16x16x32_bf16 v[166:169], v[182:185], a[104:107], v[166:169]
s_add_u32 m0, s45, 4112
ds_read_b128 v[108:111], v215 offset:512
v_mul_f32_e64 v103, s48, v102
v_mfma_f32_16x16x32_bf16 v[170:173], v[182:185], a[128:131], v[170:173]
s_add_u32 s40, s37, 196224
ds_read_b128 v[182:185], v210 offset:30720
v_mul_f32_e64 v104, s73, v102
v_mfma_f32_16x16x32_bf16 v[138:141], a[12:15], v[186:189], v[138:141]
v_mul_f32_e64 v106, s73, v106
v_fma_f32 v106, -v103, v104, v106
v_mfma_f32_16x16x32_bf16 v[142:145], a[36:39], v[186:189], v[142:145]
v_max_f32 v106, 0, v106
v_add_f32 v106, s49, v106
v_mfma_f32_16x16x32_bf16 v[146:149], a[60:63], v[186:189], v[146:149]
v_rsq_f32_e64 v102, v106
v_mfma_f32_16x16x32_bf16 v[150:153], a[228:231], v[186:189], v[150:153]
v_mul_f32_e64 v103, -v103, v102
v_mfma_f32_16x16x32_bf16 v[154:157], a[252:255], v[186:189], v[154:157]
buffer_load_dwordx4 v180, s[4:7], s40 offen nt lds
v_mfma_f32_16x16x32_bf16 v[158:161], v[244:247], v[186:189], v[158:161]
ds_write_b64 v211, v[102:103]
v_mfma_f32_16x16x32_bf16 v[162:165], v[186:189], a[84:87], v[162:165]
s_add_u32 m0, s45, 8224
s_add_u32 s40, s37, 392448
v_mfma_f32_16x16x32_bf16 v[166:169], v[186:189], a[108:111], v[166:169]
s_nop 0
ds_read_b64 v[118:119], v219
ds_read_b64 v[126:127], v219 offset:256
v_mfma_f32_16x16x32_bf16 v[170:173], v[186:189], a[132:135], v[170:173]
s_waitcnt lgkmcnt(3)
ds_read_b128 v[186:189], v210 offset:31744
ds_read_b64 v[134:135], v219 offset:512
v_mfma_f32_16x16x32_bf16 v[138:141], a[16:19], v[182:185], v[138:141]
v_mfma_f32_16x16x32_bf16 v[142:145], a[40:43], v[182:185], v[142:145]
v_mfma_f32_16x16x32_bf16 v[146:149], a[64:67], v[182:185], v[146:149]
s_nop 0
v_mfma_f32_16x16x32_bf16 v[150:153], a[232:235], v[182:185], v[150:153]
s_waitcnt lgkmcnt(3)
v_fma_f32 v220, v0, v118, v119
v_fma_f32 v221, v1, v118, v119
v_mfma_f32_16x16x32_bf16 v[154:157], v[224:227], v[182:185], v[154:157]
v_fma_f32 v222, v2, v118, v119
v_fma_f32 v223, v3, v118, v119
v_mfma_f32_16x16x32_bf16 v[158:161], v[248:251], v[182:185], v[158:161]
buffer_load_dwordx4 v180, s[4:7], s40 offen nt lds
v_mfma_f32_16x16x32_bf16 v[162:165], v[182:185], a[88:91], v[162:165]
s_add_u32 m0, s45, 12336
v_cvt_pk_bf16_f32 v90, v220, v221
v_cvt_pk_bf16_f32 v91, v222, v223
v_mfma_f32_16x16x32_bf16 v[166:169], v[182:185], a[112:115], v[166:169]
s_add_u32 s40, s37, 588672
v_fma_f32 v220, v4, v118, v119
v_fma_f32 v221, v5, v118, v119
v_mfma_f32_16x16x32_bf16 v[170:173], v[182:185], a[136:139], v[170:173]
s_waitcnt lgkmcnt(1)
ds_read_b128 v[182:185], v210 offset:32768
v_fma_f32 v222, v6, v118, v119
v_mfma_f32_16x16x32_bf16 v[138:141], a[20:23], v[186:189], v[138:141]
s_nop 0
v_fma_f32 v223, v7, v118, v119
v_cvt_pk_bf16_f32 v92, v220, v221
v_mfma_f32_16x16x32_bf16 v[142:145], a[44:47], v[186:189], v[142:145]
v_cvt_pk_bf16_f32 v93, v222, v223
v_fma_f32 v220, v8, v118, v119
v_mfma_f32_16x16x32_bf16 v[146:149], a[68:71], v[186:189], v[146:149]
ds_write_b128 v211, v[90:93]
v_mfma_f32_16x16x32_bf16 v[150:153], a[236:239], v[186:189], v[150:153]
v_cvt_pk_bf16_f32 v96, v138, v139
v_cvt_pk_bf16_f32 v97, v140, v141
v_mfma_f32_16x16x32_bf16 v[154:157], v[228:231], v[186:189], v[154:157]
v_cvt_pk_bf16_f32 v98, v142, v143
v_cvt_pk_bf16_f32 v99, v144, v145
v_mfma_f32_16x16x32_bf16 v[158:161], v[252:255], v[186:189], v[158:161]
buffer_load_dwordx4 v180, s[4:7], s40 offen nt lds
v_mfma_f32_16x16x32_bf16 v[162:165], v[186:189], a[92:95], v[162:165]
s_add_u32 m0, s45, 16448
v_cvt_pk_bf16_f32 v100, v146, v147
v_cvt_pk_bf16_f32 v101, v148, v149
v_mfma_f32_16x16x32_bf16 v[166:169], v[186:189], a[116:119], v[166:169]
s_add_u32 s40, s37, 784896
v_cvt_pk_bf16_f32 v88, v158, v159
v_cvt_pk_bf16_f32 v89, v160, v161
v_mfma_f32_16x16x32_bf16 v[170:173], v[186:189], a[140:143], v[170:173]
s_waitcnt lgkmcnt(1)
ds_read_b128 v[186:189], v210 offset:33792
v_cvt_pk_bf16_f32 v86, v154, v155
v_mfma_f32_16x16x32_bf16 v[138:141], a[0:3], v[182:185], 0
s_nop 0
v_cvt_pk_bf16_f32 v87, v156, v157
v_cvt_pk_bf16_f32 v124, v166, v167
v_mfma_f32_16x16x32_bf16 v[142:145], a[24:27], v[182:185], 0
v_cvt_pk_bf16_f32 v125, v168, v169
v_cvt_pk_bf16_f32 v84, v150, v151
v_mfma_f32_16x16x32_bf16 v[146:149], a[48:51], v[182:185], 0
ds_read_b128 v[182:185], v210 offset:34816
v_cvt_pk_bf16_f32 v85, v152, v153
v_cvt_pk_bf16_f32 v116, v162, v163
v_mfma_f32_16x16x16_bf16 v[154:157], v[82:83], v[88:89], 0
v_cvt_pk_bf16_f32 v117, v164, v165
v_fma_f32 v221, v9, v118, v119
v_fma_f32 v222, v10, v118, v119
v_mfma_f32_16x16x16_bf16 v[158:161], v[100:101], v[88:89], 0
v_fma_f32 v223, v11, v118, v119
v_cvt_pk_bf16_f32 v94, v220, v221
v_cvt_pk_bf16_f32 v95, v222, v223
v_fma_f32 v220, v12, v126, v127
s_waitcnt lgkmcnt(1)
v_mfma_f32_16x16x32_bf16 v[138:141], a[4:7], v[186:189], v[138:141]
buffer_load_dwordx4 v180, s[4:7], s40 offen nt lds
v_mfma_f32_16x16x32_bf16 v[142:145], a[28:31], v[186:189], v[142:145]
s_add_u32 m0, s45, 20560
ds_write_b64 v212, v[94:95]
v_mfma_f32_16x16x32_bf16 v[146:149], a[52:55], v[186:189], v[146:149]
s_waitcnt lgkmcnt(1)
v_fma_f32 v221, v13, v126, v127
v_fma_f32 v222, v14, v126, v127
v_mfma_f32_16x16x32_bf16 v[138:141], a[8:11], v[182:185], v[138:141]
s_add_u32 s40, s37, 981120
ds_read_b128 v[186:189], v210 offset:35840
v_fma_f32 v223, v15, v126, v127
v_mfma_f32_16x16x32_bf16 v[142:145], a[32:35], v[182:185], v[142:145]
v_cvt_pk_bf16_f32 v174, v220, v221
v_cvt_pk_bf16_f32 v175, v222, v223
v_mfma_f32_16x16x32_bf16 v[146:149], a[56:59], v[182:185], v[146:149]
ds_read_b128 v[182:185], v210 offset:36864
v_fma_f32 v220, v16, v126, v127
v_fma_f32 v221, v17, v126, v127
v_mfma_f32_16x16x16_bf16 v[166:169], v[112:113], v[88:89], v[206:209]
v_fma_f32 v222, v18, v126, v127
v_fma_f32 v223, v19, v126, v127
v_cvt_pk_bf16_f32 v176, v220, v221
v_mfma_f32_16x16x16_bf16 v[150:153], v[112:113], v[76:77], v[206:209]
v_cvt_pk_bf16_f32 v177, v222, v223
v_fma_f32 v220, v20, v126, v127
v_fma_f32 v221, v21, v126, v127
v_fma_f32 v222, v22, v126, v127
v_mfma_f32_16x16x32_bf16 v[154:157], v[78:81], v[84:87], v[154:157]
s_waitcnt lgkmcnt(1)
ds_write_b128 v211, v[174:177] offset:6144
v_mfma_f32_16x16x32_bf16 v[138:141], a[12:15], v[186:189], v[138:141]
s_waitcnt lgkmcnt(1)
buffer_load_dwordx4 v180, s[4:7], s40 offen nt lds
v_mfma_f32_16x16x32_bf16 v[142:145], a[36:39], v[186:189], v[142:145]
s_add_u32 m0, s45, 24672
v_fma_f32 v223, v23, v126, v127
v_cvt_pk_bf16_f32 v178, v220, v221
v_mfma_f32_16x16x32_bf16 v[146:149], a[60:63], v[186:189], v[146:149]
s_add_u32 s40, s37, 1177344
ds_read_b128 v[186:189], v210 offset:37888
v_cvt_pk_bf16_f32 v179, v222, v223
v_mfma_f32_16x16x32_bf16 v[138:141], a[16:19], v[182:185], v[138:141]
ds_write_b64 v212, v[178:179] offset:6144
v_mfma_f32_16x16x32_bf16 v[142:145], a[40:43], v[182:185], v[142:145]
v_fma_f32 v220, v24, v134, v135
v_fma_f32 v221, v25, v134, v135
v_mfma_f32_16x16x32_bf16 v[150:153], v[108:111], v[72:75], v[150:153]
v_fma_f32 v222, v26, v134, v135
v_fma_f32 v223, v27, v134, v135
v_mfma_f32_16x16x32_bf16 v[146:149], a[64:67], v[182:185], v[146:149]
s_nop 0
ds_read_b128 v[182:185], v210 offset:32768
v_cvt_pk_bf16_f32 v90, v220, v221
v_mfma_f32_16x16x32_bf16 v[158:161], v[96:99], v[84:87], v[158:161]
s_waitcnt lgkmcnt(2)
v_cvt_pk_bf16_f32 v91, v222, v223
v_fma_f32 v220, v28, v134, v135
v_mfma_f32_16x16x32_bf16 v[138:141], a[20:23], v[186:189], v[138:141]
v_fma_f32 v221, v29, v134, v135
v_fma_f32 v222, v30, v134, v135
v_mfma_f32_16x16x32_bf16 v[142:145], a[44:47], v[186:189], v[142:145]
buffer_load_dwordx4 v180, s[4:7], s40 offen nt lds
v_mfma_f32_16x16x32_bf16 v[146:149], a[68:71], v[186:189], v[146:149]
s_add_u32 m0, s45, 28784
ds_read_b128 v[186:189], v210 offset:33792
v_cvt_pk_bf16_f32 v102, v138, v139
v_mfma_f32_16x16x32_bf16 v[166:169], v[108:111], v[84:87], v[166:169]
s_add_u32 s40, s37, 1373568
v_cvt_pk_bf16_f32 v103, v140, v141
v_cvt_pk_bf16_f32 v104, v142, v143
v_cvt_pk_bf16_f32 v105, v144, v145
v_mfma_f32_16x16x16_bf16 v[138:141], v[82:83], v[76:77], 0
v_cvt_pk_bf16_f32 v106, v146, v147
v_cvt_pk_bf16_f32 v107, v148, v149
v_fma_f32 v223, v31, v134, v135
v_mfma_f32_16x16x16_bf16 v[142:145], v[100:101], v[76:77], 0
v_cvt_pk_bf16_f32 v92, v220, v221
v_cvt_pk_bf16_f32 v93, v222, v223
v_fma_f32 v220, v32, v134, v135
v_mfma_f32_16x16x16_bf16 v[162:165], v[106:107], v[88:89], 0
v_fma_f32 v221, v33, v134, v135
v_fma_f32 v222, v34, v134, v135
v_fma_f32 v223, v35, v134, v135
v_mfma_f32_16x16x16_bf16 v[146:149], v[106:107], v[76:77], 0
v_cvt_pk_bf16_f32 v132, v170, v171
v_cvt_pk_bf16_f32 v133, v172, v173
v_cvt_pk_bf16_f32 v94, v220, v221
v_cvt_pk_bf16_f32 v95, v222, v223
v_mfma_f32_16x16x32_bf16 v[138:141], v[78:81], v[72:75], v[138:141]
ds_write_b128 v211, v[90:93] offset:12288
v_mfma_f32_16x16x32_bf16 v[142:145], v[96:99], v[72:75], v[142:145]
s_waitcnt lgkmcnt(2)
v_exp_f32 v138, v138
v_mfma_f32_16x16x32_bf16 v[118:121], v[182:185], a[72:75], 0
buffer_load_dwordx4 v180, s[4:7], s40 offen nt lds
v_mfma_f32_16x16x32_bf16 v[126:129], v[182:185], a[96:99], 0
s_add_u32 m0, s45, 32896
ds_write_b64 v212, v[94:95] offset:12288
v_mfma_f32_16x16x32_bf16 v[134:137], v[182:185], a[120:123], 0
s_add_u32 s40, s37, 1569792
v_exp_f32_e64 v139, v139
v_mfma_f32_16x16x32_bf16 v[146:149], v[102:105], v[72:75], v[146:149]
ds_read_b64 v[76:77], v215 offset:16
v_cvt_pk_bf16_f32 v174, v138, v139
v_mfma_f32_16x16x32_bf16 v[90:93], a[216:219], v[182:185], 0
v_exp_f32_e64 v140, v140
v_mfma_f32_16x16x32_bf16 v[170:173], a[240:243], v[182:185], 0
v_exp_f32 v141, v141
v_mfma_f32_16x16x32_bf16 v[220:223], v[232:235], v[182:185], 0
s_waitcnt lgkmcnt(3)
ds_read_b128 v[182:185], v210 offset:34816
v_cvt_pk_bf16_f32 v175, v140, v141
v_mfma_f32_16x16x32_bf16 v[118:121], v[186:189], a[76:79], v[118:121]
v_exp_f32 v142, v142
v_mfma_f32_16x16x32_bf16 v[126:129], v[186:189], a[100:103], v[126:129]
v_exp_f32 v143, v143
v_mfma_f32_16x16x32_bf16 v[134:137], v[186:189], a[124:127], v[134:137]
v_exp_f32_e64 v144, v144
v_mfma_f32_16x16x32_bf16 v[90:93], a[220:223], v[186:189], v[90:93]
buffer_load_dwordx4 v180, s[4:7], s40 offen nt lds
v_mfma_f32_16x16x32_bf16 v[170:173], a[244:247], v[186:189], v[170:173]
v_exp_f32 v145, v145
v_mfma_f32_16x16x32_bf16 v[220:223], v[236:239], v[186:189], v[220:223]
s_waitcnt lgkmcnt(0)
ds_read_b128 v[186:189], v210 offset:35840
v_cvt_pk_bf16_f32 v176, v142, v143
v_mfma_f32_16x16x32_bf16 v[118:121], v[182:185], a[80:83], v[118:121]
v_exp_f32_e64 v150, v150
v_mfma_f32_16x16x32_bf16 v[126:129], v[182:185], a[104:107], v[126:129]
v_cvt_pk_bf16_f32 v177, v144, v145
v_cvt_pk_bf16_f32 v180, v150, 0
v_mfma_f32_16x16x32_bf16 v[134:137], v[182:185], a[128:131], v[134:137]
v_exp_f32 v154, v154
v_mfma_f32_16x16x32_bf16 v[90:93], a[224:227], v[182:185], v[90:93]
v_exp_f32 v155, v155
v_mfma_f32_16x16x32_bf16 v[162:165], v[102:105], v[84:87], v[162:165]
v_exp_f32_e64 v156, v156
v_mfma_f32_16x16x32_bf16 v[170:173], a[248:251], v[182:185], v[170:173]
v_exp_f32 v157, v157
v_mfma_f32_16x16x32_bf16 v[220:223], v[240:243], v[182:185], v[220:223]
s_waitcnt lgkmcnt(0)
ds_read_b128 v[182:185], v210 offset:36864
ds_read_b128 v[72:75], v215
v_mfma_f32_16x16x32_bf16 v[118:121], v[186:189], a[84:87], v[118:121]
v_exp_f32 v158, v158
v_mfma_f32_16x16x32_bf16 v[126:129], v[186:189], a[108:111], v[126:129]
v_exp_f32 v159, v159
v_mfma_f32_16x16x32_bf16 v[134:137], v[186:189], a[132:135], v[134:137]
v_exp_f32 v160, v160
v_mfma_f32_16x16x32_bf16 v[90:93], a[228:231], v[186:189], v[90:93]
v_exp_f32 v161, v161
v_mfma_f32_16x16x32_bf16 v[170:173], a[252:255], v[186:189], v[170:173]
v_exp_f32 v166, v166
v_mfma_f32_16x16x32_bf16 v[220:223], v[244:247], v[186:189], v[220:223]
s_waitcnt lgkmcnt(1)
ds_read_b128 v[186:189], v210 offset:37888
v_exp_f32 v146, v146
v_mfma_f32_16x16x32_bf16 v[118:121], v[182:185], a[88:91], v[118:121]
v_exp_f32 v147, v147
v_mfma_f32_16x16x32_bf16 v[126:129], v[182:185], a[112:115], v[126:129]
v_exp_f32 v148, v148
v_mfma_f32_16x16x32_bf16 v[134:137], v[182:185], a[136:139], v[134:137]
v_exp_f32 v149, v149
v_mfma_f32_16x16x32_bf16 v[90:93], a[232:235], v[182:185], v[90:93]
v_exp_f32 v162, v162
v_mfma_f32_16x16x32_bf16 v[170:173], v[224:227], v[182:185], v[170:173]
v_exp_f32 v163, v163
v_mfma_f32_16x16x32_bf16 v[220:223], v[248:251], v[182:185], v[220:223]
s_waitcnt lgkmcnt(0)
v_exp_f32 v164, v164
v_mfma_f32_16x16x32_bf16 v[118:121], v[186:189], a[92:95], v[118:121]
v_exp_f32_e64 v165, v165
v_mfma_f32_16x16x32_bf16 v[126:129], v[186:189], a[116:119], v[126:129]
v_cvt_pk_bf16_f32 v178, v146, v147
v_cvt_pk_bf16_f32 v179, v148, v149
v_mfma_f32_16x16x32_bf16 v[134:137], v[186:189], a[140:143], v[134:137]
v_cvt_pk_bf16_f32 v118, v118, v119
v_cvt_pk_bf16_f32 v119, v120, v121
v_mfma_f32_16x16x32_bf16 v[90:93], a[236:239], v[186:189], v[90:93]
ds_read_u16 v120, v214 offset:1024
v_cvt_pk_bf16_f32 v126, v126, v127
v_mfma_f32_16x16x32_bf16 v[170:173], v[228:231], v[186:189], v[170:173]
v_cvt_pk_bf16_f32 v127, v128, v129
v_cvt_pk_bf16_f32 v134, v134, v135
v_mfma_f32_16x16x32_bf16 v[220:223], v[252:255], v[186:189], v[220:223]
ds_read_u16 v128, v214 offset:1032
v_cvt_pk_bf16_f32 v90, v90, v91
v_mfma_f32_16x16x32_bf16 v[150:153], v[190:193], v[174:177], 0
v_cvt_pk_bf16_f32 v91, v92, v93
v_cvt_pk_bf16_f32 v92, v170, v171
v_mfma_f32_16x16x32_bf16 v[138:141], v[114:117], v[174:177], 0
v_cvt_pk_bf16_f32 v93, v172, v173
v_cvt_pk_bf16_f32 v135, v136, v137
v_mfma_f32_16x16x32_bf16 v[142:145], v[122:125], v[174:177], 0
ds_read_u16 v136, v214 offset:1040
v_mov_b32 v121, 0
v_mfma_f32_16x16x32_bf16 v[146:149], v[130:133], v[174:177], 0
v_cvt_pk_bf16_f32 v174, v154, v155
v_cvt_pk_bf16_f32 v175, v156, v157
v_mfma_f32_16x16x32_bf16 v[150:153], v[190:193], v[178:181], v[150:153]
s_waitcnt lgkmcnt(2)
v_cvt_pk_bf16_f32 v176, v158, v159
v_cvt_pk_bf16_f32 v177, v160, v161
v_mfma_f32_16x16x32_bf16 v[138:141], v[118:121], v[178:181], v[138:141]
v_mov_b32 v129, 0
v_mov_b32 v137, 0
v_mfma_f32_16x16x32_bf16 v[154:157], v[114:117], v[174:177], 0
v_rcp_f32 v151, v150
v_mfma_f32_16x16x32_bf16 v[158:161], v[122:125], v[174:177], 0
s_waitcnt lgkmcnt(1)
v_max3_u32 v218, v218, v150, v151
v_mul_f32_e64 v151, s3, v151
v_mfma_f32_16x16x32_bf16 v[142:145], v[126:129], v[178:181], v[142:145]
s_waitcnt lgkmcnt(0)
v_mul_f32 v138, v138, v151
v_mul_f32_e64 v139, v139, v151
v_mfma_f32_16x16x32_bf16 v[146:149], v[134:137], v[178:181], v[146:149]
v_cvt_pk_bf16_f32 v180, v166, 0
v_mul_f32_e64 v140, v140, v151
v_mfma_f32_16x16x32_bf16 v[166:169], v[190:193], v[174:177], 0
v_mul_f32_e64 v141, v141, v151
v_cvt_pk_bf16_f32 v138, v138, v139
v_mul_f32 v142, v142, v151
v_mul_f32 v143, v143, v151
v_mul_f32 v144, v144, v151
v_mul_f32 v145, v145, v151
v_cvt_pk_bf16_f32 v139, v140, v141
v_cvt_pk_bf16_f32 v140, v142, v143
v_cvt_pk_bf16_f32 v141, v144, v145
v_cvt_pk_bf16_f32 v178, v162, v163
v_cvt_pk_bf16_f32 v179, v164, v165
v_mfma_f32_16x16x32_bf16 v[162:165], v[130:133], v[174:177], 0
ds_write_b128 v211, v[138:141] offset:38912
v_mfma_f32_16x16x32_bf16 v[138:141], v[78:81], v[90:93], 0
v_mul_f32 v146, v146, v151
v_mul_f32 v147, v147, v151
v_mfma_f32_16x16x32_bf16 v[166:169], v[190:193], v[178:181], v[166:169]
v_mul_f32 v148, v148, v151
v_mul_f32 v149, v149, v151
v_mfma_f32_16x16x32_bf16 v[154:157], v[118:121], v[178:181], v[154:157]
v_cvt_pk_bf16_f32 v142, v146, v147
v_cvt_pk_bf16_f32 v143, v148, v149
v_mfma_f32_16x16x32_bf16 v[158:161], v[126:129], v[178:181], v[158:161]
ds_write_b64 v212, v[142:143] offset:38912
v_mfma_f32_16x16x32_bf16 v[142:145], v[96:99], v[90:93], 0
v_rcp_f32_e64 v167, v166
v_mfma_f32_16x16x32_bf16 v[162:165], v[134:137], v[178:181], v[162:165]
v_max3_u32 v218, v218, v166, v167
v_cvt_pk_bf16_f32 v94, v220, v221
v_mfma_f32_16x16x32_bf16 v[150:153], v[108:111], v[90:93], v[206:209]
v_cvt_pk_bf16_f32 v95, v222, v223
v_mul_f32_e64 v167, s3, v167
v_mfma_f32_16x16x32_bf16 v[146:149], v[102:105], v[90:93], 0
v_mul_f32 v154, v154, v167
v_mul_f32 v155, v155, v167
v_mul_f32_e64 v156, v156, v167
v_mfma_f32_16x16x16_bf16 v[138:141], v[82:83], v[94:95], v[138:141]
v_mul_f32_e64 v157, v157, v167
v_cvt_pk_bf16_f32 v154, v154, v155
v_mul_f32_e64 v158, v158, v167
v_mfma_f32_16x16x16_bf16 v[142:145], v[100:101], v[94:95], v[142:145]
v_mul_f32 v159, v159, v167
v_mul_f32 v160, v160, v167
v_mul_f32_e64 v161, v161, v167
v_mfma_f32_16x16x16_bf16 v[150:153], v[112:113], v[94:95], v[150:153]
v_cvt_pk_bf16_f32 v155, v156, v157
v_cvt_pk_bf16_f32 v156, v158, v159
v_cvt_pk_bf16_f32 v157, v160, v161
v_mfma_f32_16x16x16_bf16 v[146:149], v[106:107], v[94:95], v[146:149]
v_mul_f32 v162, v162, v167
v_mul_f32 v163, v163, v167
v_mul_f32 v164, v164, v167
v_mul_f32 v165, v165, v167
v_mfma_f32_16x16x16_bf16 v[166:169], v[76:77], v[112:113], v[206:209]
v_cvt_pk_bf16_f32 v158, v162, v163
v_cvt_pk_bf16_f32 v159, v164, v165
v_exp_f32 v138, v138
v_mfma_f32_16x16x16_bf16 v[162:165], v[76:77], v[106:107], 0
v_exp_f32 v139, v139
v_exp_f32 v140, v140
v_mfma_f32_16x16x32_bf16 v[166:169], v[72:75], v[108:111], v[166:169]
ds_write_b128 v211, v[154:157] offset:45056
v_mfma_f32_16x16x16_bf16 v[154:157], v[76:77], v[82:83], 0
v_exp_f32 v141, v141
v_exp_f32 v142, v142
v_mfma_f32_16x16x32_bf16 v[162:165], v[72:75], v[102:105], v[162:165]
v_exp_f32 v143, v143
v_mfma_f32_16x16x32_bf16 v[154:157], v[72:75], v[78:81], v[154:157]
ds_write_b64 v212, v[158:159] offset:45056
v_mfma_f32_16x16x16_bf16 v[158:161], v[76:77], v[100:101], 0
v_exp_f32 v144, v144
v_exp_f32 v145, v145
v_exp_f32_e64 v150, v150
v_mfma_f32_16x16x32_bf16 v[158:161], v[72:75], v[96:99], v[158:161]
v_cvt_pk_bf16_f32 v174, v138, v139
v_cvt_pk_bf16_f32 v175, v140, v141
v_cvt_pk_bf16_f32 v176, v142, v143
v_cvt_pk_bf16_f32 v177, v144, v145
v_cvt_pk_bf16_f32 v180, v150, 0
v_exp_f32_e64 v146, v146
v_mfma_f32_16x16x32_bf16 v[150:153], v[190:193], v[174:177], 0
v_exp_f32 v147, v147
v_mfma_f32_16x16x32_bf16 v[138:141], v[114:117], v[174:177], 0
s_waitcnt lgkmcnt(0)
v_exp_f32 v148, v148
v_mfma_f32_16x16x32_bf16 v[142:145], v[122:125], v[174:177], 0
s_barrier
ds_read_b128 v[170:173], v210 offset:38912
ds_read_b128 v[182:185], v210 offset:39936
ds_read_b128 v[186:189], v210 offset:40960
v_exp_f32_e64 v149, v149
v_cvt_pk_bf16_f32 v178, v146, v147
v_cvt_pk_bf16_f32 v179, v148, v149
v_mfma_f32_16x16x32_bf16 v[146:149], v[130:133], v[174:177], 0
v_mov_b32_dpp v154, v158 quad_perm:[0,1,2,3] row_mask:0x2 bank_mask:0xf
v_mfma_f32_16x16x32_bf16 v[150:153], v[190:193], v[178:181], v[150:153]
v_mov_b32_dpp v154, v162 quad_perm:[0,1,2,3] row_mask:0x4 bank_mask:0xf
v_mfma_f32_16x16x32_bf16 v[138:141], v[118:121], v[178:181], v[138:141]
v_mov_b32_dpp v154, v167 quad_perm:[0,1,2,3] row_mask:0x8 bank_mask:0xf
v_exp_f32_e64 v154, v154
v_mfma_f32_16x16x32_bf16 v[142:145], v[126:129], v[178:181], v[142:145]
v_cvt_pk_bf16_f32 v154, v154, 0
v_rcp_f32 v151, v150
v_mfma_f32_16x16x32_bf16 v[146:149], v[134:137], v[178:181], v[146:149]
s_waitcnt lgkmcnt(2)
ds_write_b16 v214, v154
v_mfma_f32_16x16x32_bf16 v[36:39], a[144:147], v[170:173], v[36:39]
ds_read_b128 v[84:87], v215
ds_read_b128 v[88:91], v215 offset:16
v_mfma_f32_16x16x32_bf16 v[40:43], a[168:171], v[170:173], v[40:43]
ds_read_b128 v[174:177], v217
ds_read_b128 v[178:181], v217 offset:528
v_mfma_f32_16x16x32_bf16 v[44:47], a[192:195], v[170:173], v[44:47]
ds_read_b128 v[170:173], v210 offset:41984
s_waitcnt lgkmcnt(7)
v_mfma_f32_16x16x32_bf16 v[36:39], a[148:151], v[182:185], v[36:39]
v_mfma_f32_16x16x32_bf16 v[40:43], a[172:175], v[182:185], v[40:43]
v_mfma_f32_16x16x32_bf16 v[44:47], a[196:199], v[182:185], v[44:47]
ds_read_b128 v[182:185], v210 offset:43008
s_waitcnt lgkmcnt(5)
v_mfma_f32_16x16x32_bf16 v[166:169], v[84:87], v[190:193], 0
v_mfma_f32_16x16x32_bf16 v[154:157], v[84:87], v[114:117], 0
v_mfma_f32_16x16x32_bf16 v[158:161], v[84:87], v[122:125], 0
s_mul_hi_u32 s41, s35, 58835169
s_mul_i32 s42, s41, 73
s_waitcnt lgkmcnt(4)
v_mfma_f32_16x16x32_bf16 v[162:165], v[84:87], v[130:133], 0
s_sub_u32 s42, s35, s42
s_mul_i32 s43, s41, 1373568
s_mul_i32 s51, s42, 2688
v_mfma_f32_16x16x32_bf16 v[166:169], v[88:91], v[190:193], v[166:169]
s_add_u32 s43, s43, s51
v_mfma_f32_16x16x32_bf16 v[154:157], v[88:91], v[118:121], v[154:157]
s_cmp_lt_u32 s35, s34
s_cselect_b32 s50, s43, 1879048192
s_waitcnt lgkmcnt(0)
v_mfma_f32_16x16x32_bf16 v[158:161], v[88:91], v[126:129], v[158:161]
s_add_u32 s35, s35, 32
v_rcp_f32 v167, v166
v_mfma_f32_16x16x32_bf16 v[162:165], v[88:91], v[134:137], v[162:165]
s_cmp_eq_u32 s42, 0
v_max3_u32 v218, v218, v166, v167
v_max3_u32 v218, v218, v150, v151
v_mfma_f32_16x16x32_bf16 v[36:39], a[152:155], v[186:189], v[36:39]
s_cselect_b32 s44, 536870911, s72
v_mul_f32 v151, s3, v151
v_mul_f32 v138, v138, v151
v_mfma_f32_16x16x32_bf16 v[40:43], a[176:179], v[186:189], v[40:43]
s_cmp_eq_u32 s42, 72
v_mul_f32 v139, v139, v151
v_mul_f32 v140, v140, v151
v_mfma_f32_16x16x32_bf16 v[44:47], a[200:203], v[186:189], v[44:47]
s_cselect_b32 s44, 939524095, s44
ds_read_b128 v[186:189], v210 offset:44032
v_mul_f32 v141, v141, v151
v_mfma_f32_16x16x32_bf16 v[36:39], a[156:159], v[170:173], v[36:39]
s_cmp_eq_u32 s41, 0
v_cvt_pk_bf16_f32 v138, v138, v139
v_mul_f32_e64 v142, v142, v151
v_mfma_f32_16x16x32_bf16 v[40:43], a[180:183], v[170:173], v[40:43]
s_cselect_b32 s52, 1879048192, s50
v_mul_f32 v143, v143, v151
v_mul_f32 v144, v144, v151
v_mfma_f32_16x16x32_bf16 v[44:47], a[204:207], v[170:173], v[44:47]
s_add_u32 m0, s45, 0
ds_read_b128 v[170:173], v210 offset:45056
v_mul_f32 v145, v145, v151
v_mfma_f32_16x16x32_bf16 v[36:39], a[160:163], v[182:185], v[36:39]
v_cvt_pk_bf16_f32 v139, v140, v141
v_cvt_pk_bf16_f32 v140, v142, v143
v_mfma_f32_16x16x32_bf16 v[40:43], a[184:187], v[182:185], v[40:43]
v_cvt_pk_bf16_f32 v141, v144, v145
v_mul_f32 v146, v146, v151
v_mfma_f32_16x16x32_bf16 v[44:47], a[208:211], v[182:185], v[44:47]
s_waitcnt lgkmcnt(1)
ds_read_b128 v[182:185], v210 offset:46080
ds_write_b128 v211, v[138:141] offset:51200
v_mfma_f32_16x16x32_bf16 v[36:39], a[164:167], v[186:189], v[36:39]
s_mov_b32 s38, s36
v_mul_f32 v147, v147, v151
v_mul_f32_e64 v148, v148, v151
v_mfma_f32_16x16x32_bf16 v[40:43], a[188:191], v[186:189], v[40:43]
s_waitcnt lgkmcnt(2)
v_mul_f32 v149, v149, v151
v_cvt_pk_bf16_f32 v142, v146, v147
v_mfma_f32_16x16x32_bf16 v[44:47], a[212:215], v[186:189], v[44:47]
s_mov_b32 s36, s50
ds_read_b128 v[186:189], v210 offset:47104
v_cvt_pk_bf16_f32 v143, v148, v149
v_mfma_f32_16x16x32_bf16 v[48:51], a[144:147], v[170:173], v[48:51]
ds_write_b64 v212, v[142:143] offset:51200
v_mfma_f32_16x16x32_bf16 v[52:55], a[168:171], v[170:173], v[52:55]
v_cvt_pk_bf16_f32 v72, v36, v37
v_cvt_pk_bf16_f32 v73, v38, v39
v_mfma_f32_16x16x32_bf16 v[56:59], a[192:195], v[170:173], v[56:59]
s_waitcnt lgkmcnt(3)
ds_read_b128 v[170:173], v210 offset:48128
buffer_store_dwordx2 v[72:73], v203, s[8:11], s39 offen
v_cvt_pk_bf16_f32 v74, v40, v41
v_mfma_f32_16x16x32_bf16 v[48:51], a[148:151], v[182:185], v[48:51]
v_cvt_pk_bf16_f32 v75, v42, v43
v_mov_b32_dpp v154, v158 quad_perm:[0,1,2,3] row_mask:0x2 bank_mask:0xf
v_mfma_f32_16x16x32_bf16 v[52:55], a[172:175], v[182:185], v[52:55]
v_mul_f32 v167, s3, v167
v_mov_b32_dpp v154, v162 quad_perm:[0,1,2,3] row_mask:0x4 bank_mask:0xf
v_mfma_f32_16x16x32_bf16 v[56:59], a[196:199], v[182:185], v[56:59]
s_waitcnt lgkmcnt(2)
ds_read_b128 v[182:185], v210 offset:49152
v_mul_f32_e64 v154, v154, v167
v_mfma_f32_16x16x32_bf16 v[48:51], a[152:155], v[186:189], v[48:51]
v_cvt_pk_bf16_f32 v154, v154, 0
v_cvt_pk_bf16_f32 v76, v44, v45
v_mfma_f32_16x16x32_bf16 v[52:55], a[176:179], v[186:189], v[52:55]
s_waitcnt vmcnt(1) lgkmcnt(1)
ds_write_b16 v214, v154
v_mfma_f32_16x16x32_bf16 v[56:59], a[200:203], v[186:189], v[56:59]
s_barrier
v_mfma_f32_16x16x32_bf16 v[48:51], a[156:159], v[170:173], v[48:51]
ds_read_b128 v[186:189], v210 offset:50176
ds_read_b128 v[84:87], v200
v_mfma_f32_16x16x32_bf16 v[52:55], a[180:183], v[170:173], v[52:55]
s_nop 0
ds_read_b128 v[92:95], v201
ds_read_b128 v[100:103], v202
v_mfma_f32_16x16x32_bf16 v[56:59], a[204:207], v[170:173], v[56:59]
s_waitcnt lgkmcnt(5)
ds_read_b128 v[170:173], v210 offset:51200
ds_read_b128 v[88:91], v194 offset:16
v_mfma_f32_16x16x32_bf16 v[48:51], a[160:163], v[182:185], v[48:51]
ds_read_b128 v[96:99], v195 offset:16
v_cvt_pk_bf16_f32 v77, v46, v47
v_mfma_f32_16x16x32_bf16 v[52:55], a[184:187], v[182:185], v[52:55]
ds_read_b128 v[104:107], v196 offset:16
v_add_u32 v215, 1552, v215
v_mfma_f32_16x16x32_bf16 v[56:59], a[208:211], v[182:185], v[56:59]
s_nop 0
ds_read_b128 v[182:185], v210 offset:52224
buffer_store_dwordx2 v[74:75], v203, s[8:11], s39 offen offset:32
s_waitcnt lgkmcnt(8)
v_mfma_f32_16x16x32_bf16 v[48:51], a[164:167], v[186:189], v[48:51]
ds_read_b64 v[112:113], v215 offset:528
v_mfma_f32_16x16x32_bf16 v[52:55], a[188:191], v[186:189], v[52:55]
v_mfma_f32_16x16x32_bf16 v[56:59], a[212:215], v[186:189], v[56:59]
s_waitcnt lgkmcnt(8)
ds_read_b128 v[186:189], v210 offset:53248
v_cvt_pk_bf16_f32 v78, v48, v49
v_mfma_f32_16x16x32_bf16 v[36:39], v[174:177], v[84:87], 0
s_waitcnt lgkmcnt(6)
ds_read_b128 v[84:87], v194
v_cvt_pk_bf16_f32 v79, v50, v51
v_mfma_f32_16x16x32_bf16 v[60:63], a[144:147], v[170:173], v[60:63]
v_cvt_pk_bf16_f32 v80, v52, v53
v_cvt_pk_bf16_f32 v81, v54, v55
v_mfma_f32_16x16x32_bf16 v[64:67], a[168:171], v[170:173], v[64:67]
v_cvt_pk_bf16_f32 v82, v56, v57
v_cvt_pk_bf16_f32 v83, v58, v59
v_mfma_f32_16x16x32_bf16 v[68:71], a[192:195], v[170:173], v[68:71]
ds_read_b128 v[170:173], v210 offset:54272
v_mfma_f32_16x16x32_bf16 v[48:51], v[174:177], v[92:95], 0
ds_read_b128 v[92:95], v195
s_waitcnt lgkmcnt(5)
v_mfma_f32_16x16x32_bf16 v[60:63], a[148:151], v[182:185], v[60:63]
v_mfma_f32_16x16x32_bf16 v[64:67], a[172:175], v[182:185], v[64:67]
v_mfma_f32_16x16x32_bf16 v[68:71], a[196:199], v[182:185], v[68:71]
ds_read_b128 v[182:185], v210 offset:55296
s_waitcnt lgkmcnt(4)
v_mfma_f32_16x16x32_bf16 v[60:63], a[152:155], v[186:189], v[60:63]
v_mfma_f32_16x16x32_bf16 v[64:67], a[176:179], v[186:189], v[64:67]
v_mfma_f32_16x16x32_bf16 v[68:71], a[200:203], v[186:189], v[68:71]
s_nop 0
ds_read_b128 v[186:189], v210 offset:56320
s_waitcnt lgkmcnt(3)
v_mfma_f32_16x16x32_bf16 v[60:63], a[156:159], v[170:173], v[60:63]
buffer_store_dwordx2 v[76:77], v203, s[8:11], s39 offen offset:64
v_mfma_f32_16x16x32_bf16 v[64:67], a[180:183], v[170:173], v[64:67]
v_mfma_f32_16x16x32_bf16 v[68:71], a[204:207], v[170:173], v[68:71]
s_waitcnt lgkmcnt(1)
v_mfma_f32_16x16x32_bf16 v[60:63], a[160:163], v[182:185], v[60:63]
v_mfma_f32_16x16x32_bf16 v[64:67], a[184:187], v[182:185], v[64:67]
v_mfma_f32_16x16x32_bf16 v[68:71], a[208:211], v[182:185], v[68:71]
ds_read_b128 v[182:185], v210
s_waitcnt lgkmcnt(1)
v_mfma_f32_16x16x32_bf16 v[60:63], a[164:167], v[186:189], v[60:63]
v_smfmac_f32_16x16x64_bf16 v[36:39], v[178:181], v[84:91], v213
ds_read_b128 v[84:87], v197
ds_read_b128 v[88:91], v197 offset:16
v_mfma_f32_16x16x32_bf16 v[64:67], a[188:191], v[186:189], v[64:67]
v_cvt_pk_bf16_f32 v116, v60, v61
v_cvt_pk_bf16_f32 v117, v62, v63
v_mfma_f32_16x16x32_bf16 v[60:63], v[174:177], v[100:103], 0
ds_read_b128 v[100:103], v196
ds_read_b128 v[174:177], v217 offset:1056
v_mfma_f32_16x16x32_bf16 v[68:71], a[212:215], v[186:189], v[68:71]
s_nop 0
ds_read_b128 v[186:189], v210 offset:1024
v_cvt_pk_bf16_f32 v124, v64, v65
v_smfmac_f32_16x16x64_bf16 v[48:51], v[178:181], v[92:99], v213
s_waitcnt lgkmcnt(5)
ds_read_b128 v[92:95], v198
ds_read_b128 v[96:99], v198 offset:16
v_mfma_f32_16x16x32_bf16 v[138:141], a[0:3], v[182:185], 0
v_cvt_pk_bf16_f32 v125, v66, v67
v_cvt_pk_bf16_f32 v132, v68, v69
v_mfma_f32_16x16x32_bf16 v[142:145], a[24:27], v[182:185], 0
s_nop 0
v_cvt_pk_bf16_f32 v133, v70, v71
v_mfma_f32_16x16x32_bf16 v[146:149], a[48:51], v[182:185], 0
s_waitcnt lgkmcnt(4)
v_smfmac_f32_16x16x64_bf16 v[60:63], v[178:181], v[100:107], v213
ds_read_b128 v[100:103], v199
ds_read_b128 v[104:107], v199 offset:16
v_mfma_f32_16x16x32_bf16 v[150:153], a[216:219], v[182:185], 0
ds_read_b128 v[178:181], v217 offset:1584
buffer_store_dwordx2 v[78:79], v204, s[8:11], s39 offen
s_waitcnt lgkmcnt(6)
v_smfmac_f32_16x16x64_bf16 v[36:39], v[174:177], v[84:91], v213
ds_read_b128 v[84:87], v200 offset:32
ds_read_b128 v[88:91], v194 offset:48
v_mfma_f32_16x16x32_bf16 v[154:157], a[240:243], v[182:185], 0
s_waitcnt lgkmcnt(5)
v_smfmac_f32_16x16x64_bf16 v[48:51], v[174:177], v[92:99], v213
ds_read_b128 v[92:95], v201 offset:32
ds_read_b128 v[96:99], v195 offset:48
v_mfma_f32_16x16x32_bf16 v[158:161], v[232:235], v[182:185], 0
v_mul_f32 v119, v36, v36
v_add_f32 v118, v36, v37
v_mfma_f32_16x16x32_bf16 v[162:165], v[182:185], a[72:75], 0
s_waitcnt lgkmcnt(5)
v_mul_f32 v127, v48, v48
v_add_f32_e64 v126, v48, v49
v_smfmac_f32_16x16x64_bf16 v[60:63], v[174:177], v[100:107], v213
ds_read_b128 v[100:103], v202 offset:32
ds_read_b128 v[174:177], v217 offset:2112
v_mfma_f32_16x16x32_bf16 v[166:169], v[182:185], a[96:99], 0
s_waitcnt lgkmcnt(5)
ds_read_b128 v[104:107], v196 offset:48
v_fmac_f32 v119, v37, v37
v_mfma_f32_16x16x32_bf16 v[40:43], v[178:181], v[84:87], 0
ds_read_b128 v[84:87], v194 offset:32
v_mul_f32 v135, v60, v60
v_mfma_f32_16x16x32_bf16 v[170:173], v[182:185], a[120:123], 0
s_waitcnt lgkmcnt(5)
ds_read_b128 v[182:185], v210 offset:2048
v_add_f32_e64 v134, v60, v61
v_mfma_f32_16x16x32_bf16 v[52:55], v[178:181], v[92:95], 0
ds_read_b128 v[92:95], v195 offset:32
v_fmac_f32_e64 v135, v61, v61
v_mfma_f32_16x16x32_bf16 v[138:141], a[4:7], v[186:189], v[138:141]
v_fmac_f32 v127, v49, v49
v_add_f32 v134, v134, v62
v_mfma_f32_16x16x32_bf16 v[142:145], a[28:31], v[186:189], v[142:145]
s_waitcnt lgkmcnt(5)
v_fmac_f32 v135, v62, v62
v_add_f32_e64 v118, v118, v38
v_mfma_f32_16x16x32_bf16 v[64:67], v[178:181], v[100:103], 0
ds_read_b128 v[100:103], v196 offset:32
ds_read_b128 v[178:181], v217 offset:2640
v_mfma_f32_16x16x32_bf16 v[146:149], a[52:55], v[186:189], v[146:149]
v_add_f32 v126, v126, v50
v_fmac_f32 v119, v38, v38
v_mfma_f32_16x16x32_bf16 v[150:153], a[220:223], v[186:189], v[150:153]
s_waitcnt lgkmcnt(4)
v_fmac_f32 v127, v50, v50
v_add_f32_e64 v134, v134, v63
v_smfmac_f32_16x16x64_bf16 v[40:43], v[174:177], v[84:91], v213
s_nop 0
ds_read_b128 v[84:87], v197 offset:32
ds_read_b128 v[88:91], v197 offset:48
v_mfma_f32_16x16x32_bf16 v[154:157], a[244:247], v[186:189], v[154:157]
s_waitcnt lgkmcnt(4)
buffer_store_dwordx2 v[80:81], v204, s[8:11], s39 offen offset:32
v_fmac_f32 v135, v63, v63
v_smfmac_f32_16x16x64_bf16 v[52:55], v[174:177], v[92:99], v213
s_waitcnt lgkmcnt(3)
ds_read_b128 v[92:95], v198 offset:32
ds_read_b128 v[96:99], v198 offset:48
v_smfmac_f32_16x16x64_bf16 v[64:67], v[174:177], v[100:107], v213
ds_read_b128 v[100:103], v199 offset:32
ds_read_b128 v[104:107], v199 offset:48
v_mfma_f32_16x16x32_bf16 v[158:161], v[236:239], v[186:189], v[158:161]
ds_read_b128 v[174:177], v217 offset:3168
v_add_f32_e64 v118, v118, v39
v_mfma_f32_16x16x32_bf16 v[162:165], v[186:189], a[76:79], v[162:165]
v_add_f32 v126, v126, v51
v_fmac_f32 v119, v39, v39
v_mfma_f32_16x16x32_bf16 v[166:169], v[186:189], a[100:103], v[166:169]
v_fmac_f32 v127, v51, v51
s_waitcnt lgkmcnt(5)
v_smfmac_f32_16x16x64_bf16 v[40:43], v[178:181], v[84:91], v213
ds_read_b128 v[84:87], v200 offset:64
ds_read_b128 v[88:91], v194 offset:80
v_mfma_f32_16x16x32_bf16 v[170:173], v[186:189], a[124:127], v[170:173]
s_nop 0
ds_read_b128 v[186:189], v210 offset:3072
s_waitcnt lgkmcnt(6)
v_smfmac_f32_16x16x64_bf16 v[52:55], v[178:181], v[92:99], v213
ds_read_b128 v[92:95], v201 offset:64
ds_read_b128 v[96:99], v195 offset:80
v_mfma_f32_16x16x32_bf16 v[138:141], a[8:11], v[182:185], v[138:141]
v_add_f32 v118, v118, v40
v_fmac_f32 v119, v40, v40
v_mfma_f32_16x16x32_bf16 v[142:145], a[32:35], v[182:185], v[142:145]
s_waitcnt lgkmcnt(6)
v_add_f32 v126, v126, v52
v_fmac_f32_e64 v127, v52, v52
v_smfmac_f32_16x16x64_bf16 v[64:67], v[178:181], v[100:107], v213
ds_read_b128 v[100:103], v202 offset:64
ds_read_b128 v[178:181], v217 offset:3696
v_mfma_f32_16x16x32_bf16 v[146:149], a[56:59], v[182:185], v[146:149]
s_waitcnt lgkmcnt(6)
ds_read_b128 v[104:107], v196 offset:80
v_add_f32 v118, v118, v41
v_mfma_f32_16x16x32_bf16 v[44:47], v[174:177], v[84:87], 0
ds_read_b128 v[84:87], v194 offset:64
v_add_f32_e64 v134, v134, v64
v_mfma_f32_16x16x32_bf16 v[150:153], a[224:227], v[182:185], v[150:153]
buffer_store_dwordx2 v[82:83], v204, s[8:11], s39 offen offset:64
v_fmac_f32 v135, v64, v64
v_mfma_f32_16x16x32_bf16 v[154:157], a[248:251], v[182:185], v[154:157]
s_waitcnt lgkmcnt(5)
v_add_f32 v134, v134, v65
v_fmac_f32 v135, v65, v65
v_mfma_f32_16x16x32_bf16 v[56:59], v[174:177], v[92:95], 0
s_waitcnt lgkmcnt(3)
ds_read_b128 v[92:95], v195 offset:64
v_fmac_f32 v119, v41, v41
v_mfma_f32_16x16x32_bf16 v[68:71], v[174:177], v[100:103], 0
ds_read_b128 v[100:103], v196 offset:64
ds_read_b128 v[174:177], v217 offset:4224
v_mfma_f32_16x16x32_bf16 v[158:161], v[240:243], v[182:185], v[158:161]
v_add_f32 v126, v126, v53
v_fmac_f32 v127, v53, v53
v_mfma_f32_16x16x32_bf16 v[162:165], v[182:185], a[80:83], v[162:165]
s_waitcnt lgkmcnt(3)
v_add_f32 v134, v134, v66
v_fmac_f32_e64 v135, v66, v66
v_smfmac_f32_16x16x64_bf16 v[44:47], v[178:181], v[84:91], v213
ds_read_b128 v[84:87], v197 offset:64
ds_read_b128 v[88:91], v197 offset:80
v_mfma_f32_16x16x32_bf16 v[166:169], v[182:185], a[104:107], v[166:169]
v_add_f32_e64 v118, v118, v42
v_fmac_f32 v119, v42, v42
v_mfma_f32_16x16x32_bf16 v[170:173], v[182:185], a[128:131], v[170:173]
s_waitcnt lgkmcnt(4)
ds_read_b128 v[182:185], v210 offset:4096
v_add_f32_e64 v126, v126, v54
v_smfmac_f32_16x16x64_bf16 v[56:59], v[178:181], v[92:99], v213
ds_read_b128 v[92:95], v198 offset:64
ds_read_b128 v[96:99], v198 offset:80
v_mfma_f32_16x16x32_bf16 v[138:141], a[12:15], v[186:189], v[138:141]
s_waitcnt lgkmcnt(6)
v_fmac_f32 v127, v54, v54
v_add_f32_e64 v134, v134, v67
v_smfmac_f32_16x16x64_bf16 v[68:71], v[178:181], v[100:107], v213
ds_read_b128 v[100:103], v199 offset:64
ds_read_b128 v[104:107], v199 offset:80
v_mfma_f32_16x16x32_bf16 v[142:145], a[36:39], v[186:189], v[142:145]
v_fmac_f32 v135, v67, v67
v_add_f32 v118, v118, v43
v_mfma_f32_16x16x32_bf16 v[146:149], a[60:63], v[186:189], v[146:149]
v_fmac_f32 v119, v43, v43
v_add_f32 v126, v126, v55
v_mfma_f32_16x16x32_bf16 v[150:153], a[228:231], v[186:189], v[150:153]
v_fmac_f32_e64 v127, v55, v55
v_and_b32 v180, s44, v208
v_mfma_f32_16x16x32_bf16 v[154:157], a[252:255], v[186:189], v[154:157]
s_waitcnt lgkmcnt(5)
v_add_u32 v214, 1552, v214
v_mov_b32_e64 v181, 0
v_smfmac_f32_16x16x64_bf16 v[44:47], v[174:177], v[84:91], v213
buffer_store_dwordx2 v[116:117], v205, s[8:11], s39 offen
v_mfma_f32_16x16x32_bf16 v[158:161], v[244:247], v[186:189], v[158:161]
v_mfma_f32_16x16x32_bf16 v[162:165], v[186:189], a[84:87], v[162:165]
s_waitcnt lgkmcnt(2)
v_add_f32 v118, v118, v44
v_fmac_f32_e64 v119, v44, v44
v_smfmac_f32_16x16x64_bf16 v[56:59], v[174:177], v[92:99], v213
v_add_f32 v118, v118, v45
v_mfma_f32_16x16x32_bf16 v[166:169], v[186:189], a[108:111], v[166:169]
v_fmac_f32 v119, v45, v45
v_add_f32 v118, v118, v46
v_mfma_f32_16x16x32_bf16 v[170:173], v[186:189], a[132:135], v[170:173]
s_waitcnt lgkmcnt(0)
ds_read_b128 v[186:189], v210 offset:5120
v_add_f32_e64 v126, v126, v56
v_smfmac_f32_16x16x64_bf16 v[68:71], v[174:177], v[100:107], v213
v_fmac_f32_e64 v127, v56, v56
v_mfma_f32_16x16x32_bf16 v[138:141], a[16:19], v[182:185], v[138:141]
v_add_f32 v126, v126, v57
v_fmac_f32 v127, v57, v57
v_mfma_f32_16x16x32_bf16 v[142:145], a[40:43], v[182:185], v[142:145]
v_add_f32 v134, v134, v68
v_fmac_f32 v135, v68, v68
v_mfma_f32_16x16x32_bf16 v[146:149], a[64:67], v[182:185], v[146:149]
v_add_f32 v134, v134, v69
v_fmac_f32 v135, v69, v69
v_mfma_f32_16x16x32_bf16 v[150:153], a[232:235], v[182:185], v[150:153]
v_add_f32 v134, v134, v70
v_fmac_f32 v135, v70, v70
v_mfma_f32_16x16x32_bf16 v[154:157], v[224:227], v[182:185], v[154:157]
v_fmac_f32 v119, v46, v46
v_add_f32 v126, v126, v58
v_mfma_f32_16x16x32_bf16 v[158:161], v[248:251], v[182:185], v[158:161]
v_fmac_f32 v127, v58, v58
v_add_f32 v134, v134, v71
v_mfma_f32_16x16x32_bf16 v[162:165], v[182:185], a[88:91], v[162:165]
v_fmac_f32 v135, v71, v71
v_add_f32 v118, v118, v47
v_mfma_f32_16x16x32_bf16 v[166:169], v[182:185], a[112:115], v[166:169]
v_fmac_f32_e64 v119, v47, v47
v_add_f32 v126, v126, v59
v_mfma_f32_16x16x32_bf16 v[170:173], v[182:185], a[136:139], v[170:173]
s_waitcnt lgkmcnt(0)
ds_read_b128 v[182:185], v210 offset:6144
v_fmac_f32_e64 v127, v59, v59
v_mfma_f32_16x16x32_bf16 v[138:141], a[20:23], v[186:189], v[138:141]
buffer_store_dwordx2 v[124:125], v205, s[8:11], s39 offen offset:32
v_permlane16_swap_b32 v134, v135
v_mfma_f32_16x16x32_bf16 v[142:145], a[44:47], v[186:189], v[142:145]
v_permlane16_swap_b32 v118, v119
v_mfma_f32_16x16x32_bf16 v[146:149], a[68:71], v[186:189], v[146:149]
v_cvt_pk_bf16_f32 v78, v138, v139
v_cvt_pk_bf16_f32 v79, v140, v141
v_mfma_f32_16x16x32_bf16 v[150:153], a[236:239], v[186:189], v[150:153]
v_cvt_pk_bf16_f32 v80, v142, v143
v_cvt_pk_bf16_f32 v81, v144, v145
v_mfma_f32_16x16x32_bf16 v[154:157], v[228:231], v[186:189], v[154:157]
v_cvt_pk_bf16_f32 v82, v146, v147
v_cvt_pk_bf16_f32 v83, v148, v149
v_mfma_f32_16x16x32_bf16 v[158:161], v[252:255], v[186:189], v[158:161]
v_cvt_pk_bf16_f32 v72, v150, v151
v_cvt_pk_bf16_f32 v73, v152, v153
v_mfma_f32_16x16x32_bf16 v[162:165], v[186:189], a[92:95], v[162:165]
v_cvt_pk_bf16_f32 v74, v154, v155
v_cvt_pk_bf16_f32 v75, v156, v157
v_mfma_f32_16x16x32_bf16 v[166:169], v[186:189], a[116:119], v[166:169]
s_nop 0
v_cvt_pk_bf16_f32 v76, v158, v159
v_cvt_pk_bf16_f32 v77, v160, v161
v_mfma_f32_16x16x32_bf16 v[170:173], v[186:189], a[140:143], v[170:173]
s_waitcnt lgkmcnt(0)
ds_read_b128 v[186:189], v210 offset:7168
v_cvt_pk_bf16_f32 v114, v162, v163
v_mfma_f32_16x16x32_bf16 v[138:141], a[0:3], v[182:185], 0
v_cvt_pk_bf16_f32 v115, v164, v165
v_cvt_pk_bf16_f32 v122, v166, v167
v_mfma_f32_16x16x32_bf16 v[142:145], a[24:27], v[182:185], 0
v_cvt_pk_bf16_f32 v123, v168, v169
v_cvt_pk_bf16_f32 v130, v170, v171
v_mfma_f32_16x16x32_bf16 v[146:149], a[48:51], v[182:185], 0
v_cvt_pk_bf16_f32 v131, v172, v173
v_add_f32_e64 v134, v134, v135
v_mfma_f32_16x16x32_bf16 v[150:153], a[216:219], v[182:185], 0
v_permlane16_swap_b32 v126, v127
v_mfma_f32_16x16x32_bf16 v[154:157], a[240:243], v[182:185], 0
v_add_f32 v118, v118, v119
v_mov_b32_e64 v135, v134
v_mfma_f32_16x16x32_bf16 v[158:161], v[232:235], v[182:185], 0
v_add_f32 v126, v126, v127
v_permlane32_swap_b32 v134, v135
v_mfma_f32_16x16x32_bf16 v[162:165], v[182:185], a[72:75], 0
buffer_store_dwordx2 v[132:133], v205, s[8:11], s39 offen offset:64
v_permlane32_swap_b32 v118, v126
v_mfma_f32_16x16x32_bf16 v[166:169], v[182:185], a[96:99], 0
v_add_f32 v134, v134, v135
v_add_f32 v118, v118, v126
v_mfma_f32_16x16x32_bf16 v[170:173], v[182:185], a[120:123], 0
s_waitcnt lgkmcnt(0)
ds_read_b128 v[182:185], v210 offset:8192
ds_write_b32 v209, v134 offset:512
v_mfma_f32_16x16x32_bf16 v[138:141], a[4:7], v[186:189], v[138:141]
ds_write_b32 v209, v118
v_mfma_f32_16x16x32_bf16 v[142:145], a[28:31], v[186:189], v[142:145]
v_mfma_f32_16x16x32_bf16 v[146:149], a[52:55], v[186:189], v[146:149]
v_mfma_f32_16x16x32_bf16 v[150:153], a[220:223], v[186:189], v[150:153]
v_mfma_f32_16x16x32_bf16 v[154:157], a[244:247], v[186:189], v[154:157]
v_mfma_f32_16x16x32_bf16 v[158:161], v[236:239], v[186:189], v[158:161]
v_mfma_f32_16x16x32_bf16 v[162:165], v[186:189], a[76:79], v[162:165]
s_waitcnt lgkmcnt(0)
s_barrier
v_mfma_f32_16x16x32_bf16 v[166:169], v[186:189], a[100:103], v[166:169]
ds_read_b128 v[102:105], v210 offset:18432
ds_read_b128 v[106:109], v210 offset:19456
v_mfma_f32_16x16x32_bf16 v[170:173], v[186:189], a[124:127], v[170:173]
ds_read_b128 v[186:189], v210 offset:9216
v_mfma_f32_16x16x32_bf16 v[138:141], a[8:11], v[182:185], v[138:141]
v_mfma_f32_16x16x32_bf16 v[142:145], a[32:35], v[182:185], v[142:145]
v_mfma_f32_16x16x32_bf16 v[146:149], a[56:59], v[182:185], v[146:149]
v_mfma_f32_16x16x32_bf16 v[150:153], a[224:227], v[182:185], v[150:153]
buffer_load_dwordx4 v180, s[4:7], s52 offen nt lds
v_mfma_f32_16x16x32_bf16 v[154:157], a[248:251], v[182:185], v[154:157]
s_waitcnt lgkmcnt(2)
v_add_f32 v102, v102, v103
v_add_f32_e64 v104, v104, v105
v_mfma_f32_16x16x32_bf16 v[158:161], v[240:243], v[182:185], v[158:161]
s_waitcnt lgkmcnt(1)
v_add_f32 v106, v106, v107
v_add_f32_e64 v108, v108, v109
v_mfma_f32_16x16x32_bf16 v[162:165], v[182:185], a[80:83], v[162:165]
s_waitcnt lgkmcnt(0)
v_add_f32 v102, v102, v104
v_add_f32_e64 v106, v106, v108
v_mfma_f32_16x16x32_bf16 v[166:169], v[182:185], a[104:107], v[166:169]
s_add_u32 m0, s45, 4112
ds_read_b128 v[108:111], v215 offset:512
v_mul_f32_e64 v103, s48, v102
v_mfma_f32_16x16x32_bf16 v[170:173], v[182:185], a[128:131], v[170:173]
s_add_u32 s40, s36, 196224
ds_read_b128 v[182:185], v210 offset:10240
v_mul_f32_e64 v104, s73, v102
v_mfma_f32_16x16x32_bf16 v[138:141], a[12:15], v[186:189], v[138:141]
v_mul_f32_e64 v106, s73, v106
v_fma_f32 v106, -v103, v104, v106
v_mfma_f32_16x16x32_bf16 v[142:145], a[36:39], v[186:189], v[142:145]
v_max_f32 v106, 0, v106
v_add_f32 v106, s49, v106
v_mfma_f32_16x16x32_bf16 v[146:149], a[60:63], v[186:189], v[146:149]
v_rsq_f32_e64 v102, v106
v_mfma_f32_16x16x32_bf16 v[150:153], a[228:231], v[186:189], v[150:153]
v_mul_f32_e64 v103, -v103, v102
v_mfma_f32_16x16x32_bf16 v[154:157], a[252:255], v[186:189], v[154:157]
buffer_load_dwordx4 v180, s[4:7], s40 offen nt lds
v_mfma_f32_16x16x32_bf16 v[158:161], v[244:247], v[186:189], v[158:161]
ds_write_b64 v211, v[102:103] offset:20480
v_mfma_f32_16x16x32_bf16 v[162:165], v[186:189], a[84:87], v[162:165]
s_add_u32 m0, s45, 8224
s_add_u32 s40, s36, 392448
v_mfma_f32_16x16x32_bf16 v[166:169], v[186:189], a[108:111], v[166:169]
s_nop 0
ds_read_b64 v[118:119], v219 offset:20480
ds_read_b64 v[126:127], v219 offset:20736
v_mfma_f32_16x16x32_bf16 v[170:173], v[186:189], a[132:135], v[170:173]
s_waitcnt lgkmcnt(3)
ds_read_b128 v[186:189], v210 offset:11264
ds_read_b64 v[134:135], v219 offset:20992
v_mfma_f32_16x16x32_bf16 v[138:141], a[16:19], v[182:185], v[138:141]
v_mfma_f32_16x16x32_bf16 v[142:145], a[40:43], v[182:185], v[142:145]
v_mfma_f32_16x16x32_bf16 v[146:149], a[64:67], v[182:185], v[146:149]
s_nop 0
v_mfma_f32_16x16x32_bf16 v[150:153], a[232:235], v[182:185], v[150:153]
s_waitcnt lgkmcnt(3)
v_fma_f32 v220, v36, v118, v119
v_fma_f32 v221, v37, v118, v119
v_mfma_f32_16x16x32_bf16 v[154:157], v[224:227], v[182:185], v[154:157]
v_fma_f32 v222, v38, v118, v119
v_fma_f32 v223, v39, v118, v119
v_mfma_f32_16x16x32_bf16 v[158:161], v[248:251], v[182:185], v[158:161]
buffer_load_dwordx4 v180, s[4:7], s40 offen nt lds
v_mfma_f32_16x16x32_bf16 v[162:165], v[182:185], a[88:91], v[162:165]
s_add_u32 m0, s45, 12336
v_cvt_pk_bf16_f32 v90, v220, v221
v_cvt_pk_bf16_f32 v91, v222, v223
v_mfma_f32_16x16x32_bf16 v[166:169], v[182:185], a[112:115], v[166:169]
s_add_u32 s40, s36, 588672
v_fma_f32 v220, v40, v118, v119
v_fma_f32 v221, v41, v118, v119
v_mfma_f32_16x16x32_bf16 v[170:173], v[182:185], a[136:139], v[170:173]
s_waitcnt lgkmcnt(1)
ds_read_b128 v[182:185], v210 offset:12288
v_fma_f32 v222, v42, v118, v119
v_mfma_f32_16x16x32_bf16 v[138:141], a[20:23], v[186:189], v[138:141]
s_nop 0
v_fma_f32 v223, v43, v118, v119
v_cvt_pk_bf16_f32 v92, v220, v221
v_mfma_f32_16x16x32_bf16 v[142:145], a[44:47], v[186:189], v[142:145]
v_cvt_pk_bf16_f32 v93, v222, v223
v_fma_f32 v220, v44, v118, v119
v_mfma_f32_16x16x32_bf16 v[146:149], a[68:71], v[186:189], v[146:149]
ds_write_b128 v211, v[90:93] offset:20480
v_mfma_f32_16x16x32_bf16 v[150:153], a[236:239], v[186:189], v[150:153]
v_cvt_pk_bf16_f32 v96, v138, v139
v_cvt_pk_bf16_f32 v97, v140, v141
v_mfma_f32_16x16x32_bf16 v[154:157], v[228:231], v[186:189], v[154:157]
v_cvt_pk_bf16_f32 v98, v142, v143
v_cvt_pk_bf16_f32 v99, v144, v145
v_mfma_f32_16x16x32_bf16 v[158:161], v[252:255], v[186:189], v[158:161]
buffer_load_dwordx4 v180, s[4:7], s40 offen nt lds
v_mfma_f32_16x16x32_bf16 v[162:165], v[186:189], a[92:95], v[162:165]
s_add_u32 m0, s45, 16448
v_cvt_pk_bf16_f32 v100, v146, v147
v_cvt_pk_bf16_f32 v101, v148, v149
v_mfma_f32_16x16x32_bf16 v[166:169], v[186:189], a[116:119], v[166:169]
s_add_u32 s40, s36, 784896
v_cvt_pk_bf16_f32 v88, v158, v159
v_cvt_pk_bf16_f32 v89, v160, v161
v_mfma_f32_16x16x32_bf16 v[170:173], v[186:189], a[140:143], v[170:173]
s_waitcnt lgkmcnt(1)
ds_read_b128 v[186:189], v210 offset:13312
v_cvt_pk_bf16_f32 v86, v154, v155
v_mfma_f32_16x16x32_bf16 v[138:141], a[0:3], v[182:185], 0
s_nop 0
v_cvt_pk_bf16_f32 v87, v156, v157
v_cvt_pk_bf16_f32 v124, v166, v167
v_mfma_f32_16x16x32_bf16 v[142:145], a[24:27], v[182:185], 0
v_cvt_pk_bf16_f32 v125, v168, v169
v_cvt_pk_bf16_f32 v84, v150, v151
v_mfma_f32_16x16x32_bf16 v[146:149], a[48:51], v[182:185], 0
ds_read_b128 v[182:185], v210 offset:14336
v_cvt_pk_bf16_f32 v85, v152, v153
v_cvt_pk_bf16_f32 v116, v162, v163
v_mfma_f32_16x16x16_bf16 v[154:157], v[82:83], v[88:89], 0
v_cvt_pk_bf16_f32 v117, v164, v165
v_fma_f32 v221, v45, v118, v119
v_fma_f32 v222, v46, v118, v119
v_mfma_f32_16x16x16_bf16 v[158:161], v[100:101], v[88:89], 0
v_fma_f32 v223, v47, v118, v119
v_cvt_pk_bf16_f32 v94, v220, v221
v_cvt_pk_bf16_f32 v95, v222, v223
v_fma_f32 v220, v48, v126, v127
s_waitcnt lgkmcnt(1)
v_mfma_f32_16x16x32_bf16 v[138:141], a[4:7], v[186:189], v[138:141]
buffer_load_dwordx4 v180, s[4:7], s40 offen nt lds
v_mfma_f32_16x16x32_bf16 v[142:145], a[28:31], v[186:189], v[142:145]
s_add_u32 m0, s45, 20560
ds_write_b64 v212, v[94:95] offset:20480
v_mfma_f32_16x16x32_bf16 v[146:149], a[52:55], v[186:189], v[146:149]
s_waitcnt lgkmcnt(1)
v_fma_f32 v221, v49, v126, v127
v_fma_f32 v222, v50, v126, v127
v_mfma_f32_16x16x32_bf16 v[138:141], a[8:11], v[182:185], v[138:141]
s_add_u32 s40, s36, 981120
ds_read_b128 v[186:189], v210 offset:15360
v_fma_f32 v223, v51, v126, v127
v_mfma_f32_16x16x32_bf16 v[142:145], a[32:35], v[182:185], v[142:145]
v_cvt_pk_bf16_f32 v174, v220, v221
v_cvt_pk_bf16_f32 v175, v222, v223
v_mfma_f32_16x16x32_bf16 v[146:149], a[56:59], v[182:185], v[146:149]
ds_read_b128 v[182:185], v210 offset:16384
v_fma_f32 v220, v52, v126, v127
v_fma_f32 v221, v53, v126, v127
v_mfma_f32_16x16x16_bf16 v[166:169], v[112:113], v[88:89], v[206:209]
v_fma_f32 v222, v54, v126, v127
v_fma_f32 v223, v55, v126, v127
v_cvt_pk_bf16_f32 v176, v220, v221
v_mfma_f32_16x16x16_bf16 v[150:153], v[112:113], v[76:77], v[206:209]
v_cvt_pk_bf16_f32 v177, v222, v223
v_fma_f32 v220, v56, v126, v127
v_fma_f32 v221, v57, v126, v127
v_fma_f32 v222, v58, v126, v127
v_mfma_f32_16x16x32_bf16 v[154:157], v[78:81], v[84:87], v[154:157]
s_waitcnt lgkmcnt(1)
ds_write_b128 v211, v[174:177] offset:26624
v_mfma_f32_16x16x32_bf16 v[138:141], a[12:15], v[186:189], v[138:141]
s_waitcnt lgkmcnt(1)
buffer_load_dwordx4 v180, s[4:7], s40 offen nt lds
v_mfma_f32_16x16x32_bf16 v[142:145], a[36:39], v[186:189], v[142:145]
s_add_u32 m0, s45, 24672
v_fma_f32 v223, v59, v126, v127
v_cvt_pk_bf16_f32 v178, v220, v221
v_mfma_f32_16x16x32_bf16 v[146:149], a[60:63], v[186:189], v[146:149]
s_add_u32 s40, s36, 1177344
ds_read_b128 v[186:189], v210 offset:17408
v_cvt_pk_bf16_f32 v179, v222, v223
v_mfma_f32_16x16x32_bf16 v[138:141], a[16:19], v[182:185], v[138:141]
ds_write_b64 v212, v[178:179] offset:26624
v_mfma_f32_16x16x32_bf16 v[142:145], a[40:43], v[182:185], v[142:145]
v_fma_f32 v220, v60, v134, v135
v_fma_f32 v221, v61, v134, v135
v_mfma_f32_16x16x32_bf16 v[150:153], v[108:111], v[72:75], v[150:153]
v_fma_f32 v222, v62, v134, v135
v_fma_f32 v223, v63, v134, v135
v_mfma_f32_16x16x32_bf16 v[146:149], a[64:67], v[182:185], v[146:149]
s_nop 0
ds_read_b128 v[182:185], v210 offset:12288
v_cvt_pk_bf16_f32 v90, v220, v221
v_mfma_f32_16x16x32_bf16 v[158:161], v[96:99], v[84:87], v[158:161]
s_waitcnt lgkmcnt(2)
v_cvt_pk_bf16_f32 v91, v222, v223
v_fma_f32 v220, v64, v134, v135
v_mfma_f32_16x16x32_bf16 v[138:141], a[20:23], v[186:189], v[138:141]
v_fma_f32 v221, v65, v134, v135
v_fma_f32 v222, v66, v134, v135
v_mfma_f32_16x16x32_bf16 v[142:145], a[44:47], v[186:189], v[142:145]
buffer_load_dwordx4 v180, s[4:7], s40 offen nt lds
v_mfma_f32_16x16x32_bf16 v[146:149], a[68:71], v[186:189], v[146:149]
s_add_u32 m0, s45, 28784
ds_read_b128 v[186:189], v210 offset:13312
v_cvt_pk_bf16_f32 v102, v138, v139
v_mfma_f32_16x16x32_bf16 v[166:169], v[108:111], v[84:87], v[166:169]
s_add_u32 s40, s36, 1373568
v_cvt_pk_bf16_f32 v103, v140, v141
v_cvt_pk_bf16_f32 v104, v142, v143
v_cvt_pk_bf16_f32 v105, v144, v145
v_mfma_f32_16x16x16_bf16 v[138:141], v[82:83], v[76:77], 0
v_cvt_pk_bf16_f32 v106, v146, v147
v_cvt_pk_bf16_f32 v107, v148, v149
v_fma_f32 v223, v67, v134, v135
v_mfma_f32_16x16x16_bf16 v[142:145], v[100:101], v[76:77], 0
v_cvt_pk_bf16_f32 v92, v220, v221
v_cvt_pk_bf16_f32 v93, v222, v223
v_fma_f32 v220, v68, v134, v135
v_mfma_f32_16x16x16_bf16 v[162:165], v[106:107], v[88:89], 0
v_fma_f32 v221, v69, v134, v135
v_fma_f32 v222, v70, v134, v135
v_fma_f32 v223, v71, v134, v135
v_mfma_f32_16x16x16_bf16 v[146:149], v[106:107], v[76:77], 0
v_cvt_pk_bf16_f32 v132, v170, v171
v_cvt_pk_bf16_f32 v133, v172, v173
v_cvt_pk_bf16_f32 v94, v220, v221
v_cvt_pk_bf16_f32 v95, v222, v223
v_mfma_f32_16x16x32_bf16 v[138:141], v[78:81], v[72:75], v[138:141]
ds_write_b128 v211, v[90:93] offset:32768
v_mfma_f32_16x16x32_bf16 v[142:145], v[96:99], v[72:75], v[142:145]
s_waitcnt lgkmcnt(2)
v_exp_f32 v138, v138
v_mfma_f32_16x16x32_bf16 v[118:121], v[182:185], a[72:75], 0
buffer_load_dwordx4 v180, s[4:7], s40 offen nt lds
v_mfma_f32_16x16x32_bf16 v[126:129], v[182:185], a[96:99], 0
s_add_u32 m0, s45, 32896
ds_write_b64 v212, v[94:95] offset:32768
v_mfma_f32_16x16x32_bf16 v[134:137], v[182:185], a[120:123], 0
s_add_u32 s40, s36, 1569792
v_exp_f32_e64 v139, v139
v_mfma_f32_16x16x32_bf16 v[146:149], v[102:105], v[72:75], v[146:149]
ds_read_b64 v[76:77], v215 offset:16
v_cvt_pk_bf16_f32 v174, v138, v139
v_mfma_f32_16x16x32_bf16 v[90:93], a[216:219], v[182:185], 0
v_exp_f32_e64 v140, v140
v_mfma_f32_16x16x32_bf16 v[170:173], a[240:243], v[182:185], 0
v_exp_f32 v141, v141
v_mfma_f32_16x16x32_bf16 v[220:223], v[232:235], v[182:185], 0
s_waitcnt lgkmcnt(3)
ds_read_b128 v[182:185], v210 offset:14336
v_cvt_pk_bf16_f32 v175, v140, v141
v_mfma_f32_16x16x32_bf16 v[118:121], v[186:189], a[76:79], v[118:121]
v_exp_f32 v142, v142
v_mfma_f32_16x16x32_bf16 v[126:129], v[186:189], a[100:103], v[126:129]
v_exp_f32 v143, v143
v_mfma_f32_16x16x32_bf16 v[134:137], v[186:189], a[124:127], v[134:137]
v_exp_f32_e64 v144, v144
v_mfma_f32_16x16x32_bf16 v[90:93], a[220:223], v[186:189], v[90:93]
buffer_load_dwordx4 v180, s[4:7], s40 offen nt lds
v_mfma_f32_16x16x32_bf16 v[170:173], a[244:247], v[186:189], v[170:173]
v_exp_f32 v145, v145
v_mfma_f32_16x16x32_bf16 v[220:223], v[236:239], v[186:189], v[220:223]
s_waitcnt lgkmcnt(0)
ds_read_b128 v[186:189], v210 offset:15360
v_cvt_pk_bf16_f32 v176, v142, v143
v_mfma_f32_16x16x32_bf16 v[118:121], v[182:185], a[80:83], v[118:121]
v_exp_f32_e64 v150, v150
v_mfma_f32_16x16x32_bf16 v[126:129], v[182:185], a[104:107], v[126:129]
v_cvt_pk_bf16_f32 v177, v144, v145
v_cvt_pk_bf16_f32 v180, v150, 0
v_mfma_f32_16x16x32_bf16 v[134:137], v[182:185], a[128:131], v[134:137]
v_exp_f32 v154, v154
v_mfma_f32_16x16x32_bf16 v[90:93], a[224:227], v[182:185], v[90:93]
v_exp_f32 v155, v155
v_mfma_f32_16x16x32_bf16 v[162:165], v[102:105], v[84:87], v[162:165]
v_exp_f32_e64 v156, v156
v_mfma_f32_16x16x32_bf16 v[170:173], a[248:251], v[182:185], v[170:173]
v_exp_f32 v157, v157
v_mfma_f32_16x16x32_bf16 v[220:223], v[240:243], v[182:185], v[220:223]
s_waitcnt lgkmcnt(0)
ds_read_b128 v[182:185], v210 offset:16384
ds_read_b128 v[72:75], v215
v_mfma_f32_16x16x32_bf16 v[118:121], v[186:189], a[84:87], v[118:121]
v_exp_f32 v158, v158
v_mfma_f32_16x16x32_bf16 v[126:129], v[186:189], a[108:111], v[126:129]
v_exp_f32 v159, v159
v_mfma_f32_16x16x32_bf16 v[134:137], v[186:189], a[132:135], v[134:137]
v_exp_f32 v160, v160
v_mfma_f32_16x16x32_bf16 v[90:93], a[228:231], v[186:189], v[90:93]
v_exp_f32 v161, v161
v_mfma_f32_16x16x32_bf16 v[170:173], a[252:255], v[186:189], v[170:173]
v_exp_f32 v166, v166
v_mfma_f32_16x16x32_bf16 v[220:223], v[244:247], v[186:189], v[220:223]
s_waitcnt lgkmcnt(1)
ds_read_b128 v[186:189], v210 offset:17408
v_exp_f32 v146, v146
v_mfma_f32_16x16x32_bf16 v[118:121], v[182:185], a[88:91], v[118:121]
v_exp_f32 v147, v147
v_mfma_f32_16x16x32_bf16 v[126:129], v[182:185], a[112:115], v[126:129]
v_exp_f32 v148, v148
v_mfma_f32_16x16x32_bf16 v[134:137], v[182:185], a[136:139], v[134:137]
v_exp_f32 v149, v149
v_mfma_f32_16x16x32_bf16 v[90:93], a[232:235], v[182:185], v[90:93]
v_exp_f32 v162, v162
v_mfma_f32_16x16x32_bf16 v[170:173], v[224:227], v[182:185], v[170:173]
v_exp_f32 v163, v163
v_mfma_f32_16x16x32_bf16 v[220:223], v[248:251], v[182:185], v[220:223]
s_waitcnt lgkmcnt(0)
v_exp_f32 v164, v164
v_mfma_f32_16x16x32_bf16 v[118:121], v[186:189], a[92:95], v[118:121]
v_exp_f32_e64 v165, v165
v_mfma_f32_16x16x32_bf16 v[126:129], v[186:189], a[116:119], v[126:129]
v_cvt_pk_bf16_f32 v178, v146, v147
v_cvt_pk_bf16_f32 v179, v148, v149
v_mfma_f32_16x16x32_bf16 v[134:137], v[186:189], a[140:143], v[134:137]
v_cvt_pk_bf16_f32 v118, v118, v119
v_cvt_pk_bf16_f32 v119, v120, v121
v_mfma_f32_16x16x32_bf16 v[90:93], a[236:239], v[186:189], v[90:93]
ds_read_u16 v120, v214 offset:1024
v_cvt_pk_bf16_f32 v126, v126, v127
v_mfma_f32_16x16x32_bf16 v[170:173], v[228:231], v[186:189], v[170:173]
v_cvt_pk_bf16_f32 v127, v128, v129
v_cvt_pk_bf16_f32 v134, v134, v135
v_mfma_f32_16x16x32_bf16 v[220:223], v[252:255], v[186:189], v[220:223]
ds_read_u16 v128, v214 offset:1032
v_cvt_pk_bf16_f32 v90, v90, v91
v_mfma_f32_16x16x32_bf16 v[150:153], v[190:193], v[174:177], 0
v_cvt_pk_bf16_f32 v91, v92, v93
v_cvt_pk_bf16_f32 v92, v170, v171
v_mfma_f32_16x16x32_bf16 v[138:141], v[114:117], v[174:177], 0
v_cvt_pk_bf16_f32 v93, v172, v173
v_cvt_pk_bf16_f32 v135, v136, v137
v_mfma_f32_16x16x32_bf16 v[142:145], v[122:125], v[174:177], 0
ds_read_u16 v136, v214 offset:1040
v_mov_b32 v121, 0
v_mfma_f32_16x16x32_bf16 v[146:149], v[130:133], v[174:177], 0
v_cvt_pk_bf16_f32 v174, v154, v155
v_cvt_pk_bf16_f32 v175, v156, v157
v_mfma_f32_16x16x32_bf16 v[150:153], v[190:193], v[178:181], v[150:153]
s_waitcnt lgkmcnt(2)
v_cvt_pk_bf16_f32 v176, v158, v159
v_cvt_pk_bf16_f32 v177, v160, v161
v_mfma_f32_16x16x32_bf16 v[138:141], v[118:121], v[178:181], v[138:141]
v_mov_b32 v129, 0
v_mov_b32 v137, 0
v_mfma_f32_16x16x32_bf16 v[154:157], v[114:117], v[174:177], 0
v_rcp_f32 v151, v150
v_mfma_f32_16x16x32_bf16 v[158:161], v[122:125], v[174:177], 0
s_waitcnt lgkmcnt(1)
v_max3_u32 v218, v218, v150, v151
v_mul_f32_e64 v151, s3, v151
v_mfma_f32_16x16x32_bf16 v[142:145], v[126:129], v[178:181], v[142:145]
s_waitcnt lgkmcnt(0)
v_mul_f32 v138, v138, v151
v_mul_f32_e64 v139, v139, v151
v_mfma_f32_16x16x32_bf16 v[146:149], v[134:137], v[178:181], v[146:149]
v_cvt_pk_bf16_f32 v180, v166, 0
v_mul_f32_e64 v140, v140, v151
v_mfma_f32_16x16x32_bf16 v[166:169], v[190:193], v[174:177], 0
v_mul_f32_e64 v141, v141, v151
v_cvt_pk_bf16_f32 v138, v138, v139
v_mul_f32 v142, v142, v151
v_mul_f32 v143, v143, v151
v_mul_f32 v144, v144, v151
v_mul_f32 v145, v145, v151
v_cvt_pk_bf16_f32 v139, v140, v141
v_cvt_pk_bf16_f32 v140, v142, v143
v_cvt_pk_bf16_f32 v141, v144, v145
v_cvt_pk_bf16_f32 v178, v162, v163
v_cvt_pk_bf16_f32 v179, v164, v165
v_mfma_f32_16x16x32_bf16 v[162:165], v[130:133], v[174:177], 0
ds_write_b128 v211, v[138:141] offset:38912
v_mfma_f32_16x16x32_bf16 v[138:141], v[78:81], v[90:93], 0
v_mul_f32 v146, v146, v151
v_mul_f32 v147, v147, v151
v_mfma_f32_16x16x32_bf16 v[166:169], v[190:193], v[178:181], v[166:169]
v_mul_f32 v148, v148, v151
v_mul_f32 v149, v149, v151
v_mfma_f32_16x16x32_bf16 v[154:157], v[118:121], v[178:181], v[154:157]
v_cvt_pk_bf16_f32 v142, v146, v147
v_cvt_pk_bf16_f32 v143, v148, v149
v_mfma_f32_16x16x32_bf16 v[158:161], v[126:129], v[178:181], v[158:161]
ds_write_b64 v212, v[142:143] offset:38912
v_mfma_f32_16x16x32_bf16 v[142:145], v[96:99], v[90:93], 0
v_rcp_f32_e64 v167, v166
v_mfma_f32_16x16x32_bf16 v[162:165], v[134:137], v[178:181], v[162:165]
v_max3_u32 v218, v218, v166, v167
v_cvt_pk_bf16_f32 v94, v220, v221
v_mfma_f32_16x16x32_bf16 v[150:153], v[108:111], v[90:93], v[206:209]
v_cvt_pk_bf16_f32 v95, v222, v223
v_mul_f32_e64 v167, s3, v167
v_mfma_f32_16x16x32_bf16 v[146:149], v[102:105], v[90:93], 0
v_mul_f32 v154, v154, v167
v_mul_f32 v155, v155, v167
v_mul_f32_e64 v156, v156, v167
v_mfma_f32_16x16x16_bf16 v[138:141], v[82:83], v[94:95], v[138:141]
v_mul_f32_e64 v157, v157, v167
v_cvt_pk_bf16_f32 v154, v154, v155
v_mul_f32_e64 v158, v158, v167
v_mfma_f32_16x16x16_bf16 v[142:145], v[100:101], v[94:95], v[142:145]
v_mul_f32 v159, v159, v167
v_mul_f32 v160, v160, v167
v_mul_f32_e64 v161, v161, v167
v_mfma_f32_16x16x16_bf16 v[150:153], v[112:113], v[94:95], v[150:153]
v_cvt_pk_bf16_f32 v155, v156, v157
v_cvt_pk_bf16_f32 v156, v158, v159
v_cvt_pk_bf16_f32 v157, v160, v161
v_mfma_f32_16x16x16_bf16 v[146:149], v[106:107], v[94:95], v[146:149]
v_mul_f32 v162, v162, v167
v_mul_f32 v163, v163, v167
v_mul_f32 v164, v164, v167
v_mul_f32 v165, v165, v167
v_mfma_f32_16x16x16_bf16 v[166:169], v[76:77], v[112:113], v[206:209]
v_cvt_pk_bf16_f32 v158, v162, v163
v_cvt_pk_bf16_f32 v159, v164, v165
v_exp_f32 v138, v138
v_mfma_f32_16x16x16_bf16 v[162:165], v[76:77], v[106:107], 0
v_exp_f32 v139, v139
v_exp_f32 v140, v140
v_mfma_f32_16x16x32_bf16 v[166:169], v[72:75], v[108:111], v[166:169]
ds_write_b128 v211, v[154:157] offset:45056
v_mfma_f32_16x16x16_bf16 v[154:157], v[76:77], v[82:83], 0
v_exp_f32 v141, v141
v_exp_f32 v142, v142
v_mfma_f32_16x16x32_bf16 v[162:165], v[72:75], v[102:105], v[162:165]
v_exp_f32 v143, v143
v_mfma_f32_16x16x32_bf16 v[154:157], v[72:75], v[78:81], v[154:157]
ds_write_b64 v212, v[158:159] offset:45056
v_mfma_f32_16x16x16_bf16 v[158:161], v[76:77], v[100:101], 0
v_exp_f32 v144, v144
v_exp_f32 v145, v145
v_exp_f32_e64 v150, v150
v_mfma_f32_16x16x32_bf16 v[158:161], v[72:75], v[96:99], v[158:161]
v_cvt_pk_bf16_f32 v174, v138, v139
v_cvt_pk_bf16_f32 v175, v140, v141
v_cvt_pk_bf16_f32 v176, v142, v143
v_cvt_pk_bf16_f32 v177, v144, v145
v_cvt_pk_bf16_f32 v180, v150, 0
v_exp_f32_e64 v146, v146
v_mfma_f32_16x16x32_bf16 v[150:153], v[190:193], v[174:177], 0
v_exp_f32 v147, v147
v_mfma_f32_16x16x32_bf16 v[138:141], v[114:117], v[174:177], 0
s_waitcnt lgkmcnt(0)
v_exp_f32 v148, v148
v_mfma_f32_16x16x32_bf16 v[142:145], v[122:125], v[174:177], 0
s_barrier
ds_read_b128 v[170:173], v210 offset:38912
ds_read_b128 v[182:185], v210 offset:39936
ds_read_b128 v[186:189], v210 offset:40960
v_exp_f32_e64 v149, v149
v_cvt_pk_bf16_f32 v178, v146, v147
v_cvt_pk_bf16_f32 v179, v148, v149
v_mfma_f32_16x16x32_bf16 v[146:149], v[130:133], v[174:177], 0
v_mov_b32_dpp v154, v158 quad_perm:[0,1,2,3] row_mask:0x2 bank_mask:0xf
v_mfma_f32_16x16x32_bf16 v[150:153], v[190:193], v[178:181], v[150:153]
v_mov_b32_dpp v154, v162 quad_perm:[0,1,2,3] row_mask:0x4 bank_mask:0xf
v_mfma_f32_16x16x32_bf16 v[138:141], v[118:121], v[178:181], v[138:141]
v_mov_b32_dpp v154, v167 quad_perm:[0,1,2,3] row_mask:0x8 bank_mask:0xf
v_exp_f32_e64 v154, v154
v_mfma_f32_16x16x32_bf16 v[142:145], v[126:129], v[178:181], v[142:145]
v_cvt_pk_bf16_f32 v154, v154, 0
v_rcp_f32 v151, v150
v_mfma_f32_16x16x32_bf16 v[146:149], v[134:137], v[178:181], v[146:149]
s_waitcnt lgkmcnt(2)
ds_write_b16 v214, v154
v_mfma_f32_16x16x32_bf16 v[0:3], a[144:147], v[170:173], v[0:3]
ds_read_b128 v[84:87], v215
ds_read_b128 v[88:91], v215 offset:16
v_mfma_f32_16x16x32_bf16 v[4:7], a[168:171], v[170:173], v[4:7]
ds_read_b128 v[174:177], v217
ds_read_b128 v[178:181], v217 offset:528
v_mfma_f32_16x16x32_bf16 v[8:11], a[192:195], v[170:173], v[8:11]
ds_read_b128 v[170:173], v210 offset:41984
s_waitcnt lgkmcnt(7)
v_mfma_f32_16x16x32_bf16 v[0:3], a[148:151], v[182:185], v[0:3]
v_mfma_f32_16x16x32_bf16 v[4:7], a[172:175], v[182:185], v[4:7]
v_mfma_f32_16x16x32_bf16 v[8:11], a[196:199], v[182:185], v[8:11]
ds_read_b128 v[182:185], v210 offset:43008
s_waitcnt lgkmcnt(5)
v_mfma_f32_16x16x32_bf16 v[166:169], v[84:87], v[190:193], 0
v_mfma_f32_16x16x32_bf16 v[154:157], v[84:87], v[114:117], 0
v_mfma_f32_16x16x32_bf16 v[158:161], v[84:87], v[122:125], 0
s_mul_hi_u32 s41, s35, 58835169
s_mul_i32 s42, s41, 73
s_waitcnt lgkmcnt(4)
v_mfma_f32_16x16x32_bf16 v[162:165], v[84:87], v[130:133], 0
s_sub_u32 s42, s35, s42
s_mul_i32 s43, s41, 1373568
s_mul_i32 s51, s42, 2688
v_mfma_f32_16x16x32_bf16 v[166:169], v[88:91], v[190:193], v[166:169]
s_add_u32 s43, s43, s51
v_mfma_f32_16x16x32_bf16 v[154:157], v[88:91], v[118:121], v[154:157]
s_cmp_lt_u32 s35, s34
s_cselect_b32 s50, s43, 1879048192
s_waitcnt lgkmcnt(0)
v_mfma_f32_16x16x32_bf16 v[158:161], v[88:91], v[126:129], v[158:161]
s_add_u32 s35, s35, 32
v_rcp_f32 v167, v166
v_mfma_f32_16x16x32_bf16 v[162:165], v[88:91], v[134:137], v[162:165]
s_cmp_eq_u32 s42, 0
v_max3_u32 v218, v218, v166, v167
v_max3_u32 v218, v218, v150, v151
v_mfma_f32_16x16x32_bf16 v[0:3], a[152:155], v[186:189], v[0:3]
s_cselect_b32 s44, 536870911, s72
v_mul_f32 v151, s3, v151
v_mul_f32 v138, v138, v151
v_mfma_f32_16x16x32_bf16 v[4:7], a[176:179], v[186:189], v[4:7]
s_cmp_eq_u32 s42, 72
v_mul_f32 v139, v139, v151
v_mul_f32 v140, v140, v151
v_mfma_f32_16x16x32_bf16 v[8:11], a[200:203], v[186:189], v[8:11]
s_cselect_b32 s44, 939524095, s44
ds_read_b128 v[186:189], v210 offset:44032
v_mul_f32 v141, v141, v151
v_mfma_f32_16x16x32_bf16 v[0:3], a[156:159], v[170:173], v[0:3]
s_cmp_eq_u32 s41, 0
v_cvt_pk_bf16_f32 v138, v138, v139
v_mul_f32_e64 v142, v142, v151
v_mfma_f32_16x16x32_bf16 v[4:7], a[180:183], v[170:173], v[4:7]
s_cselect_b32 s52, 1879048192, s50
v_mul_f32 v143, v143, v151
v_mul_f32 v144, v144, v151
v_mfma_f32_16x16x32_bf16 v[8:11], a[204:207], v[170:173], v[8:11]
s_add_u32 m0, s45, 0
ds_read_b128 v[170:173], v210 offset:45056
v_mul_f32 v145, v145, v151
v_mfma_f32_16x16x32_bf16 v[0:3], a[160:163], v[182:185], v[0:3]
v_cvt_pk_bf16_f32 v139, v140, v141
v_cvt_pk_bf16_f32 v140, v142, v143
v_mfma_f32_16x16x32_bf16 v[4:7], a[184:187], v[182:185], v[4:7]
v_cvt_pk_bf16_f32 v141, v144, v145
v_mul_f32 v146, v146, v151
v_mfma_f32_16x16x32_bf16 v[8:11], a[208:211], v[182:185], v[8:11]
s_waitcnt lgkmcnt(1)
ds_read_b128 v[182:185], v210 offset:46080
ds_write_b128 v211, v[138:141] offset:51200
v_mfma_f32_16x16x32_bf16 v[0:3], a[164:167], v[186:189], v[0:3]
s_mov_b32 s39, s37
v_mul_f32 v147, v147, v151
v_mul_f32_e64 v148, v148, v151
v_mfma_f32_16x16x32_bf16 v[4:7], a[188:191], v[186:189], v[4:7]
s_waitcnt lgkmcnt(2)
v_mul_f32 v149, v149, v151
v_cvt_pk_bf16_f32 v142, v146, v147
v_mfma_f32_16x16x32_bf16 v[8:11], a[212:215], v[186:189], v[8:11]
s_mov_b32 s37, s50
ds_read_b128 v[186:189], v210 offset:47104
v_cvt_pk_bf16_f32 v143, v148, v149
v_mfma_f32_16x16x32_bf16 v[12:15], a[144:147], v[170:173], v[12:15]
ds_write_b64 v212, v[142:143] offset:51200
v_mfma_f32_16x16x32_bf16 v[16:19], a[168:171], v[170:173], v[16:19]
v_cvt_pk_bf16_f32 v72, v0, v1
v_cvt_pk_bf16_f32 v73, v2, v3
v_mfma_f32_16x16x32_bf16 v[20:23], a[192:195], v[170:173], v[20:23]
s_waitcnt lgkmcnt(3)
ds_read_b128 v[170:173], v210 offset:48128
buffer_store_dwordx2 v[72:73], v203, s[8:11], s38 offen
v_cvt_pk_bf16_f32 v74, v4, v5
v_mfma_f32_16x16x32_bf16 v[12:15], a[148:151], v[182:185], v[12:15]
v_cvt_pk_bf16_f32 v75, v6, v7
v_mov_b32_dpp v154, v158 quad_perm:[0,1,2,3] row_mask:0x2 bank_mask:0xf
v_mfma_f32_16x16x32_bf16 v[16:19], a[172:175], v[182:185], v[16:19]
v_mul_f32 v167, s3, v167
v_mov_b32_dpp v154, v162 quad_perm:[0,1,2,3] row_mask:0x4 bank_mask:0xf
v_mfma_f32_16x16x32_bf16 v[20:23], a[196:199], v[182:185], v[20:23]
s_waitcnt lgkmcnt(2)
ds_read_b128 v[182:185], v210 offset:49152
v_mul_f32_e64 v154, v154, v167
v_mfma_f32_16x16x32_bf16 v[12:15], a[152:155], v[186:189], v[12:15]
v_cvt_pk_bf16_f32 v154, v154, 0
v_cvt_pk_bf16_f32 v76, v8, v9
v_mfma_f32_16x16x32_bf16 v[16:19], a[176:179], v[186:189], v[16:19]
s_waitcnt vmcnt(1) lgkmcnt(1)
ds_write_b16 v214, v154
v_mfma_f32_16x16x32_bf16 v[20:23], a[200:203], v[186:189], v[20:23]
s_barrier
v_mfma_f32_16x16x32_bf16 v[12:15], a[156:159], v[170:173], v[12:15]
ds_read_b128 v[186:189], v210 offset:50176
ds_read_b128 v[84:87], v200
v_mfma_f32_16x16x32_bf16 v[16:19], a[180:183], v[170:173], v[16:19]
s_nop 0
ds_read_b128 v[92:95], v201
ds_read_b128 v[100:103], v202
v_mfma_f32_16x16x32_bf16 v[20:23], a[204:207], v[170:173], v[20:23]
s_waitcnt lgkmcnt(5)
ds_read_b128 v[170:173], v210 offset:51200
ds_read_b128 v[88:91], v194 offset:16
v_mfma_f32_16x16x32_bf16 v[12:15], a[160:163], v[182:185], v[12:15]
ds_read_b128 v[96:99], v195 offset:16
v_cvt_pk_bf16_f32 v77, v10, v11
v_mfma_f32_16x16x32_bf16 v[16:19], a[184:187], v[182:185], v[16:19]
ds_read_b128 v[104:107], v196 offset:16
v_add_u32 v215, 1552, v215
v_mfma_f32_16x16x32_bf16 v[20:23], a[208:211], v[182:185], v[20:23]
s_nop 0
ds_read_b128 v[182:185], v210 offset:52224
buffer_store_dwordx2 v[74:75], v203, s[8:11], s38 offen offset:32
s_waitcnt lgkmcnt(8)
v_mfma_f32_16x16x32_bf16 v[12:15], a[164:167], v[186:189], v[12:15]
ds_read_b64 v[112:113], v215 offset:528
v_mfma_f32_16x16x32_bf16 v[16:19], a[188:191], v[186:189], v[16:19]
v_mfma_f32_16x16x32_bf16 v[20:23], a[212:215], v[186:189], v[20:23]
s_waitcnt lgkmcnt(8)
ds_read_b128 v[186:189], v210 offset:53248
v_cvt_pk_bf16_f32 v78, v12, v13
v_mfma_f32_16x16x32_bf16 v[0:3], v[174:177], v[84:87], 0
s_waitcnt lgkmcnt(6)
ds_read_b128 v[84:87], v194
v_cvt_pk_bf16_f32 v79, v14, v15
v_mfma_f32_16x16x32_bf16 v[24:27], a[144:147], v[170:173], v[24:27]
v_cvt_pk_bf16_f32 v80, v16, v17
v_cvt_pk_bf16_f32 v81, v18, v19
v_mfma_f32_16x16x32_bf16 v[28:31], a[168:171], v[170:173], v[28:31]
v_cvt_pk_bf16_f32 v82, v20, v21
v_cvt_pk_bf16_f32 v83, v22, v23
v_mfma_f32_16x16x32_bf16 v[32:35], a[192:195], v[170:173], v[32:35]
ds_read_b128 v[170:173], v210 offset:54272
v_mfma_f32_16x16x32_bf16 v[12:15], v[174:177], v[92:95], 0
ds_read_b128 v[92:95], v195
s_waitcnt lgkmcnt(5)
v_mfma_f32_16x16x32_bf16 v[24:27], a[148:151], v[182:185], v[24:27]
v_mfma_f32_16x16x32_bf16 v[28:31], a[172:175], v[182:185], v[28:31]
v_mfma_f32_16x16x32_bf16 v[32:35], a[196:199], v[182:185], v[32:35]
ds_read_b128 v[182:185], v210 offset:55296
s_waitcnt lgkmcnt(4)
v_mfma_f32_16x16x32_bf16 v[24:27], a[152:155], v[186:189], v[24:27]
v_mfma_f32_16x16x32_bf16 v[28:31], a[176:179], v[186:189], v[28:31]
v_mfma_f32_16x16x32_bf16 v[32:35], a[200:203], v[186:189], v[32:35]
s_nop 0
ds_read_b128 v[186:189], v210 offset:56320
s_waitcnt lgkmcnt(3)
v_mfma_f32_16x16x32_bf16 v[24:27], a[156:159], v[170:173], v[24:27]
buffer_store_dwordx2 v[76:77], v203, s[8:11], s38 offen offset:64
v_mfma_f32_16x16x32_bf16 v[28:31], a[180:183], v[170:173], v[28:31]
v_mfma_f32_16x16x32_bf16 v[32:35], a[204:207], v[170:173], v[32:35]
s_waitcnt lgkmcnt(1)
v_mfma_f32_16x16x32_bf16 v[24:27], a[160:163], v[182:185], v[24:27]
v_mfma_f32_16x16x32_bf16 v[28:31], a[184:187], v[182:185], v[28:31]
v_mfma_f32_16x16x32_bf16 v[32:35], a[208:211], v[182:185], v[32:35]
ds_read_b128 v[182:185], v210 offset:20480
s_waitcnt lgkmcnt(1)
v_mfma_f32_16x16x32_bf16 v[24:27], a[164:167], v[186:189], v[24:27]
v_smfmac_f32_16x16x64_bf16 v[0:3], v[178:181], v[84:91], v213
ds_read_b128 v[84:87], v197
ds_read_b128 v[88:91], v197 offset:16
v_mfma_f32_16x16x32_bf16 v[28:31], a[188:191], v[186:189], v[28:31]
v_cvt_pk_bf16_f32 v116, v24, v25
v_cvt_pk_bf16_f32 v117, v26, v27
v_mfma_f32_16x16x32_bf16 v[24:27], v[174:177], v[100:103], 0
ds_read_b128 v[100:103], v196
ds_read_b128 v[174:177], v217 offset:1056
v_mfma_f32_16x16x32_bf16 v[32:35], a[212:215], v[186:189], v[32:35]
s_nop 0
ds_read_b128 v[186:189], v210 offset:21504
v_cvt_pk_bf16_f32 v124, v28, v29
v_smfmac_f32_16x16x64_bf16 v[12:15], v[178:181], v[92:99], v213
s_waitcnt lgkmcnt(5)
ds_read_b128 v[92:95], v198
ds_read_b128 v[96:99], v198 offset:16
v_mfma_f32_16x16x32_bf16 v[138:141], a[0:3], v[182:185], 0
v_cvt_pk_bf16_f32 v125, v30, v31
v_cvt_pk_bf16_f32 v132, v32, v33
v_mfma_f32_16x16x32_bf16 v[142:145], a[24:27], v[182:185], 0
s_nop 0
v_cvt_pk_bf16_f32 v133, v34, v35
v_mfma_f32_16x16x32_bf16 v[146:149], a[48:51], v[182:185], 0
s_waitcnt lgkmcnt(4)
v_smfmac_f32_16x16x64_bf16 v[24:27], v[178:181], v[100:107], v213
ds_read_b128 v[100:103], v199
ds_read_b128 v[104:107], v199 offset:16
v_mfma_f32_16x16x32_bf16 v[150:153], a[216:219], v[182:185], 0
ds_read_b128 v[178:181], v217 offset:1584
buffer_store_dwordx2 v[78:79], v204, s[8:11], s38 offen
s_waitcnt lgkmcnt(6)
v_smfmac_f32_16x16x64_bf16 v[0:3], v[174:177], v[84:91], v213
ds_read_b128 v[84:87], v200 offset:32
ds_read_b128 v[88:91], v194 offset:48
v_mfma_f32_16x16x32_bf16 v[154:157], a[240:243], v[182:185], 0
s_waitcnt lgkmcnt(5)
v_smfmac_f32_16x16x64_bf16 v[12:15], v[174:177], v[92:99], v213
ds_read_b128 v[92:95], v201 offset:32
ds_read_b128 v[96:99], v195 offset:48
v_mfma_f32_16x16x32_bf16 v[158:161], v[232:235], v[182:185], 0
v_mul_f32 v119, v0, v0
v_add_f32 v118, v0, v1
v_mfma_f32_16x16x32_bf16 v[162:165], v[182:185], a[72:75], 0
s_waitcnt lgkmcnt(5)
v_mul_f32 v127, v12, v12
v_add_f32_e64 v126, v12, v13
v_smfmac_f32_16x16x64_bf16 v[24:27], v[174:177], v[100:107], v213
ds_read_b128 v[100:103], v202 offset:32
ds_read_b128 v[174:177], v217 offset:2112
v_mfma_f32_16x16x32_bf16 v[166:169], v[182:185], a[96:99], 0
s_waitcnt lgkmcnt(5)
ds_read_b128 v[104:107], v196 offset:48
v_fmac_f32 v119, v1, v1
v_mfma_f32_16x16x32_bf16 v[4:7], v[178:181], v[84:87], 0
ds_read_b128 v[84:87], v194 offset:32
v_mul_f32 v135, v24, v24
v_mfma_f32_16x16x32_bf16 v[170:173], v[182:185], a[120:123], 0
s_waitcnt lgkmcnt(5)
ds_read_b128 v[182:185], v210 offset:22528
v_add_f32_e64 v134, v24, v25
v_mfma_f32_16x16x32_bf16 v[16:19], v[178:181], v[92:95], 0
ds_read_b128 v[92:95], v195 offset:32
v_fmac_f32_e64 v135, v25, v25
v_mfma_f32_16x16x32_bf16 v[138:141], a[4:7], v[186:189], v[138:141]
v_fmac_f32 v127, v13, v13
v_add_f32 v134, v134, v26
v_mfma_f32_16x16x32_bf16 v[142:145], a[28:31], v[186:189], v[142:145]
s_waitcnt lgkmcnt(5)
v_fmac_f32 v135, v26, v26
v_add_f32_e64 v118, v118, v2
v_mfma_f32_16x16x32_bf16 v[28:31], v[178:181], v[100:103], 0
ds_read_b128 v[100:103], v196 offset:32
ds_read_b128 v[178:181], v217 offset:2640
v_mfma_f32_16x16x32_bf16 v[146:149], a[52:55], v[186:189], v[146:149]
v_add_f32 v126, v126, v14
v_fmac_f32 v119, v2, v2
v_mfma_f32_16x16x32_bf16 v[150:153], a[220:223], v[186:189], v[150:153]
s_waitcnt lgkmcnt(4)
v_fmac_f32 v127, v14, v14
v_add_f32_e64 v134, v134, v27
v_smfmac_f32_16x16x64_bf16 v[4:7], v[174:177], v[84:91], v213
s_nop 0
ds_read_b128 v[84:87], v197 offset:32
ds_read_b128 v[88:91], v197 offset:48
v_mfma_f32_16x16x32_bf16 v[154:157], a[244:247], v[186:189], v[154:157]
s_waitcnt lgkmcnt(4)
buffer_store_dwordx2 v[80:81], v204, s[8:11], s38 offen offset:32
v_fmac_f32 v135, v27, v27
v_smfmac_f32_16x16x64_bf16 v[16:19], v[174:177], v[92:99], v213
s_waitcnt lgkmcnt(3)
ds_read_b128 v[92:95], v198 offset:32
ds_read_b128 v[96:99], v198 offset:48
v_smfmac_f32_16x16x64_bf16 v[28:31], v[174:177], v[100:107], v213
ds_read_b128 v[100:103], v199 offset:32
ds_read_b128 v[104:107], v199 offset:48
v_mfma_f32_16x16x32_bf16 v[158:161], v[236:239], v[186:189], v[158:161]
ds_read_b128 v[174:177], v217 offset:3168
v_add_f32_e64 v118, v118, v3
v_mfma_f32_16x16x32_bf16 v[162:165], v[186:189], a[76:79], v[162:165]
v_add_f32 v126, v126, v15
v_fmac_f32 v119, v3, v3
v_mfma_f32_16x16x32_bf16 v[166:169], v[186:189], a[100:103], v[166:169]
v_fmac_f32 v127, v15, v15
s_waitcnt lgkmcnt(5)
v_smfmac_f32_16x16x64_bf16 v[4:7], v[178:181], v[84:91], v213
ds_read_b128 v[84:87], v200 offset:64
ds_read_b128 v[88:91], v194 offset:80
v_mfma_f32_16x16x32_bf16 v[170:173], v[186:189], a[124:127], v[170:173]
s_nop 0
ds_read_b128 v[186:189], v210 offset:23552
s_waitcnt lgkmcnt(6)
v_smfmac_f32_16x16x64_bf16 v[16:19], v[178:181], v[92:99], v213
ds_read_b128 v[92:95], v201 offset:64
ds_read_b128 v[96:99], v195 offset:80
v_mfma_f32_16x16x32_bf16 v[138:141], a[8:11], v[182:185], v[138:141]
v_add_f32 v118, v118, v4
v_fmac_f32 v119, v4, v4
v_mfma_f32_16x16x32_bf16 v[142:145], a[32:35], v[182:185], v[142:145]
s_waitcnt lgkmcnt(6)
v_add_f32 v126, v126, v16
v_fmac_f32_e64 v127, v16, v16
v_smfmac_f32_16x16x64_bf16 v[28:31], v[178:181], v[100:107], v213
ds_read_b128 v[100:103], v202 offset:64
ds_read_b128 v[178:181], v217 offset:3696
v_mfma_f32_16x16x32_bf16 v[146:149], a[56:59], v[182:185], v[146:149]
s_waitcnt lgkmcnt(6)
ds_read_b128 v[104:107], v196 offset:80
v_add_f32 v118, v118, v5
v_mfma_f32_16x16x32_bf16 v[8:11], v[174:177], v[84:87], 0
ds_read_b128 v[84:87], v194 offset:64
v_add_f32_e64 v134, v134, v28
v_mfma_f32_16x16x32_bf16 v[150:153], a[224:227], v[182:185], v[150:153]
buffer_store_dwordx2 v[82:83], v204, s[8:11], s38 offen offset:64
v_fmac_f32 v135, v28, v28
v_mfma_f32_16x16x32_bf16 v[154:157], a[248:251], v[182:185], v[154:157]
s_waitcnt lgkmcnt(5)
v_add_f32 v134, v134, v29
v_fmac_f32 v135, v29, v29
v_mfma_f32_16x16x32_bf16 v[20:23], v[174:177], v[92:95], 0
s_waitcnt lgkmcnt(3)
ds_read_b128 v[92:95], v195 offset:64
v_fmac_f32 v119, v5, v5
v_mfma_f32_16x16x32_bf16 v[32:35], v[174:177], v[100:103], 0
ds_read_b128 v[100:103], v196 offset:64
ds_read_b128 v[174:177], v217 offset:4224
v_mfma_f32_16x16x32_bf16 v[158:161], v[240:243], v[182:185], v[158:161]
v_add_f32 v126, v126, v17
v_fmac_f32 v127, v17, v17
v_mfma_f32_16x16x32_bf16 v[162:165], v[182:185], a[80:83], v[162:165]
s_waitcnt lgkmcnt(3)
v_add_f32 v134, v134, v30
v_fmac_f32_e64 v135, v30, v30
v_smfmac_f32_16x16x64_bf16 v[8:11], v[178:181], v[84:91], v213
ds_read_b128 v[84:87], v197 offset:64
ds_read_b128 v[88:91], v197 offset:80
v_mfma_f32_16x16x32_bf16 v[166:169], v[182:185], a[104:107], v[166:169]
v_add_f32_e64 v118, v118, v6
v_fmac_f32 v119, v6, v6
v_mfma_f32_16x16x32_bf16 v[170:173], v[182:185], a[128:131], v[170:173]
s_waitcnt lgkmcnt(4)
ds_read_b128 v[182:185], v210 offset:24576
v_add_f32_e64 v126, v126, v18
v_smfmac_f32_16x16x64_bf16 v[20:23], v[178:181], v[92:99], v213
ds_read_b128 v[92:95], v198 offset:64
ds_read_b128 v[96:99], v198 offset:80
v_mfma_f32_16x16x32_bf16 v[138:141], a[12:15], v[186:189], v[138:141]
s_waitcnt lgkmcnt(6)
v_fmac_f32 v127, v18, v18
v_add_f32_e64 v134, v134, v31
v_smfmac_f32_16x16x64_bf16 v[32:35], v[178:181], v[100:107], v213
ds_read_b128 v[100:103], v199 offset:64
ds_read_b128 v[104:107], v199 offset:80
v_mfma_f32_16x16x32_bf16 v[142:145], a[36:39], v[186:189], v[142:145]
v_fmac_f32 v135, v31, v31
v_add_f32 v118, v118, v7
v_mfma_f32_16x16x32_bf16 v[146:149], a[60:63], v[186:189], v[146:149]
v_fmac_f32 v119, v7, v7
v_add_f32 v126, v126, v19
v_mfma_f32_16x16x32_bf16 v[150:153], a[228:231], v[186:189], v[150:153]
v_fmac_f32_e64 v127, v19, v19
v_and_b32 v180, s44, v208
v_mfma_f32_16x16x32_bf16 v[154:157], a[252:255], v[186:189], v[154:157]
s_waitcnt lgkmcnt(5)
v_add_u32 v214, 1552, v214
v_mov_b32_e64 v181, 0
v_smfmac_f32_16x16x64_bf16 v[8:11], v[174:177], v[84:91], v213
buffer_store_dwordx2 v[116:117], v205, s[8:11], s38 offen
v_mfma_f32_16x16x32_bf16 v[158:161], v[244:247], v[186:189], v[158:161]
v_mfma_f32_16x16x32_bf16 v[162:165], v[186:189], a[84:87], v[162:165]
s_waitcnt lgkmcnt(2)
v_add_f32 v118, v118, v8
v_fmac_f32_e64 v119, v8, v8
v_smfmac_f32_16x16x64_bf16 v[20:23], v[174:177], v[92:99], v213
v_add_f32 v118, v118, v9
v_mfma_f32_16x16x32_bf16 v[166:169], v[186:189], a[108:111], v[166:169]
v_fmac_f32 v119, v9, v9
v_add_f32 v118, v118, v10
v_mfma_f32_16x16x32_bf16 v[170:173], v[186:189], a[132:135], v[170:173]
s_waitcnt lgkmcnt(0)
ds_read_b128 v[186:189], v210 offset:25600
v_add_f32_e64 v126, v126, v20
v_smfmac_f32_16x16x64_bf16 v[32:35], v[174:177], v[100:107], v213
v_fmac_f32_e64 v127, v20, v20
v_mfma_f32_16x16x32_bf16 v[138:141], a[16:19], v[182:185], v[138:141]
v_add_f32 v126, v126, v21
v_fmac_f32 v127, v21, v21
v_mfma_f32_16x16x32_bf16 v[142:145], a[40:43], v[182:185], v[142:145]
v_add_f32 v134, v134, v32
v_fmac_f32 v135, v32, v32
v_mfma_f32_16x16x32_bf16 v[146:149], a[64:67], v[182:185], v[146:149]
v_add_f32 v134, v134, v33
v_fmac_f32 v135, v33, v33
v_mfma_f32_16x16x32_bf16 v[150:153], a[232:235], v[182:185], v[150:153]
v_add_f32 v134, v134, v34
v_fmac_f32 v135, v34, v34
v_mfma_f32_16x16x32_bf16 v[154:157], v[224:227], v[182:185], v[154:157]
v_fmac_f32 v119, v10, v10
v_add_f32 v126, v126, v22
v_mfma_f32_16x16x32_bf16 v[158:161], v[248:251], v[182:185], v[158:161]
v_fmac_f32 v127, v22, v22
v_add_f32 v134, v134, v35
v_mfma_f32_16x16x32_bf16 v[162:165], v[182:185], a[88:91], v[162:165]
v_fmac_f32 v135, v35, v35
v_add_f32 v118, v118, v11
v_mfma_f32_16x16x32_bf16 v[166:169], v[182:185], a[112:115], v[166:169]
v_fmac_f32_e64 v119, v11, v11
v_add_f32 v126, v126, v23
v_mfma_f32_16x16x32_bf16 v[170:173], v[182:185], a[136:139], v[170:173]
s_waitcnt lgkmcnt(0)
ds_read_b128 v[182:185], v210 offset:26624
v_fmac_f32_e64 v127, v23, v23
v_mfma_f32_16x16x32_bf16 v[138:141], a[20:23], v[186:189], v[138:141]
buffer_store_dwordx2 v[124:125], v205, s[8:11], s38 offen offset:32
v_permlane16_swap_b32 v134, v135
v_mfma_f32_16x16x32_bf16 v[142:145], a[44:47], v[186:189], v[142:145]
v_permlane16_swap_b32 v118, v119
v_mfma_f32_16x16x32_bf16 v[146:149], a[68:71], v[186:189], v[146:149]
v_cvt_pk_bf16_f32 v78, v138, v139
v_cvt_pk_bf16_f32 v79, v140, v141
v_mfma_f32_16x16x32_bf16 v[150:153], a[236:239], v[186:189], v[150:153]
v_cvt_pk_bf16_f32 v80, v142, v143
v_cvt_pk_bf16_f32 v81, v144, v145
v_mfma_f32_16x16x32_bf16 v[154:157], v[228:231], v[186:189], v[154:157]
v_cvt_pk_bf16_f32 v82, v146, v147
v_cvt_pk_bf16_f32 v83, v148, v149
v_mfma_f32_16x16x32_bf16 v[158:161], v[252:255], v[186:189], v[158:161]
v_cvt_pk_bf16_f32 v72, v150, v151
v_cvt_pk_bf16_f32 v73, v152, v153
v_mfma_f32_16x16x32_bf16 v[162:165], v[186:189], a[92:95], v[162:165]
v_cvt_pk_bf16_f32 v74, v154, v155
v_cvt_pk_bf16_f32 v75, v156, v157
v_mfma_f32_16x16x32_bf16 v[166:169], v[186:189], a[116:119], v[166:169]
s_nop 0
v_cvt_pk_bf16_f32 v76, v158, v159
v_cvt_pk_bf16_f32 v77, v160, v161
v_mfma_f32_16x16x32_bf16 v[170:173], v[186:189], a[140:143], v[170:173]
s_waitcnt lgkmcnt(0)
ds_read_b128 v[186:189], v210 offset:27648
v_cvt_pk_bf16_f32 v114, v162, v163
v_mfma_f32_16x16x32_bf16 v[138:141], a[0:3], v[182:185], 0
v_cvt_pk_bf16_f32 v115, v164, v165
v_cvt_pk_bf16_f32 v122, v166, v167
v_mfma_f32_16x16x32_bf16 v[142:145], a[24:27], v[182:185], 0
v_cvt_pk_bf16_f32 v123, v168, v169
v_cvt_pk_bf16_f32 v130, v170, v171
v_mfma_f32_16x16x32_bf16 v[146:149], a[48:51], v[182:185], 0
v_cvt_pk_bf16_f32 v131, v172, v173
v_add_f32_e64 v134, v134, v135
v_mfma_f32_16x16x32_bf16 v[150:153], a[216:219], v[182:185], 0
v_permlane16_swap_b32 v126, v127
v_mfma_f32_16x16x32_bf16 v[154:157], a[240:243], v[182:185], 0
v_add_f32 v118, v118, v119
v_mov_b32_e64 v135, v134
v_mfma_f32_16x16x32_bf16 v[158:161], v[232:235], v[182:185], 0
v_add_f32 v126, v126, v127
v_permlane32_swap_b32 v134, v135
v_mfma_f32_16x16x32_bf16 v[162:165], v[182:185], a[72:75], 0
buffer_store_dwordx2 v[132:133], v205, s[8:11], s38 offen offset:64
v_permlane32_swap_b32 v118, v126
v_mfma_f32_16x16x32_bf16 v[166:169], v[182:185], a[96:99], 0
v_add_f32 v134, v134, v135
v_add_f32 v118, v118, v126
v_mfma_f32_16x16x32_bf16 v[170:173], v[182:185], a[120:123], 0
s_waitcnt lgkmcnt(0)
ds_read_b128 v[182:185], v210 offset:28672
ds_write_b32 v209, v134 offset:512
v_mfma_f32_16x16x32_bf16 v[138:141], a[4:7], v[186:189], v[138:141]
ds_write_b32 v209, v118
v_mfma_f32_16x16x32_bf16 v[142:145], a[28:31], v[186:189], v[142:145]
v_mfma_f32_16x16x32_bf16 v[146:149], a[52:55], v[186:189], v[146:149]
v_mfma_f32_16x16x32_bf16 v[150:153], a[220:223], v[186:189], v[150:153]
v_mfma_f32_16x16x32_bf16 v[154:157], a[244:247], v[186:189], v[154:157]
v_mfma_f32_16x16x32_bf16 v[158:161], v[236:239], v[186:189], v[158:161]
v_mfma_f32_16x16x32_bf16 v[162:165], v[186:189], a[76:79], v[162:165]
s_waitcnt lgkmcnt(0)
s_barrier
v_mfma_f32_16x16x32_bf16 v[166:169], v[186:189], a[100:103], v[166:169]
s_sub_u32 s46, s46, 1
ds_read_b128 v[102:105], v210 offset:18432
ds_read_b128 v[106:109], v210 offset:19456
v_mfma_f32_16x16x32_bf16 v[170:173], v[186:189], a[124:127], v[170:173]
s_cbranch_scc0 F_loop
v_mfma_f32_16x16x32_bf16 v[138:141], a[8:11], v[182:185], v[138:141]
s_mul_hi_u32 s41, s35, 58835169
ds_read_b128 v[186:189], v210 offset:29696
buffer_load_dwordx4 v180, s[4:7], s52 offen nt lds
v_mfma_f32_16x16x32_bf16 v[142:145], a[32:35], v[182:185], v[142:145]
s_add_u32 m0, s45, 4112
s_waitcnt lgkmcnt(2)
v_add_f32 v102, v102, v103
s_waitcnt lgkmcnt(1)
v_add_f32 v106, v106, v107
v_mfma_f32_16x16x32_bf16 v[146:149], a[56:59], v[182:185], v[146:149]
s_add_u32 s40, s37, 196224
v_add_f32 v104, v104, v105
v_add_f32 v108, v108, v109
v_mfma_f32_16x16x32_bf16 v[150:153], a[224:227], v[182:185], v[150:153]
s_mul_i32 s42, s41, 73
v_add_f32 v102, v102, v104
v_add_f32 v106, v106, v108
v_mfma_f32_16x16x32_bf16 v[154:157], a[248:251], v[182:185], v[154:157]
s_mul_i32 s43, s41, 1373568
ds_read_b128 v[108:111], v215 offset:512
v_mul_f32_e64 v103, s48, v102
v_mfma_f32_16x16x32_bf16 v[158:161], v[240:243], v[182:185], v[158:161]
s_mov_b32 s38, s36
v_mul_f32 v104, s73, v102
v_mul_f32 v106, s73, v106
v_mfma_f32_16x16x32_bf16 v[162:165], v[182:185], a[80:83], v[162:165]
s_waitcnt lgkmcnt(1)
buffer_load_dwordx4 v180, s[4:7], s40 offen nt lds
v_mfma_f32_16x16x32_bf16 v[166:169], v[182:185], a[104:107], v[166:169]
s_add_u32 m0, s45, 8224
v_fma_f32 v106, -v103, v104, v106
v_max_f32_e64 v106, 0, v106
v_mfma_f32_16x16x32_bf16 v[170:173], v[182:185], a[128:131], v[170:173]
s_add_u32 s40, s37, 392448
ds_read_b128 v[182:185], v210 offset:30720
v_add_f32_e64 v106, s49, v106
v_mfma_f32_16x16x32_bf16 v[138:141], a[12:15], v[186:189], v[138:141]
v_rsq_f32_e64 v102, v106
v_mfma_f32_16x16x32_bf16 v[142:145], a[36:39], v[186:189], v[142:145]
v_mul_f32_e64 v103, -v103, v102
v_mfma_f32_16x16x32_bf16 v[146:149], a[60:63], v[186:189], v[146:149]
ds_write_b64 v211, v[102:103]
v_mfma_f32_16x16x32_bf16 v[150:153], a[228:231], v[186:189], v[150:153]
v_mfma_f32_16x16x32_bf16 v[154:157], a[252:255], v[186:189], v[154:157]
ds_read_b64 v[118:119], v219
ds_read_b64 v[126:127], v219 offset:256
v_mfma_f32_16x16x32_bf16 v[158:161], v[244:247], v[186:189], v[158:161]
ds_read_b64 v[134:135], v219 offset:512
v_mfma_f32_16x16x32_bf16 v[162:165], v[186:189], a[84:87], v[162:165]
v_mfma_f32_16x16x32_bf16 v[166:169], v[186:189], a[108:111], v[166:169]
s_waitcnt lgkmcnt(4)
buffer_load_dwordx4 v180, s[4:7], s40 offen nt lds
v_mfma_f32_16x16x32_bf16 v[170:173], v[186:189], a[132:135], v[170:173]
s_add_u32 m0, s45, 12336
ds_read_b128 v[186:189], v210 offset:31744
s_add_u32 s40, s37, 588672
v_mfma_f32_16x16x32_bf16 v[138:141], a[16:19], v[182:185], v[138:141]
s_waitcnt lgkmcnt(3)
v_fma_f32 v220, v0, v118, v119
v_fma_f32 v221, v1, v118, v119
v_mfma_f32_16x16x32_bf16 v[142:145], a[40:43], v[182:185], v[142:145]
v_fma_f32 v222, v2, v118, v119
v_fma_f32 v223, v3, v118, v119
v_mfma_f32_16x16x32_bf16 v[146:149], a[64:67], v[182:185], v[146:149]
v_cvt_pk_bf16_f32 v90, v220, v221
v_cvt_pk_bf16_f32 v91, v222, v223
v_mfma_f32_16x16x32_bf16 v[150:153], a[232:235], v[182:185], v[150:153]
v_fma_f32 v220, v4, v118, v119
v_fma_f32 v221, v5, v118, v119
v_mfma_f32_16x16x32_bf16 v[154:157], v[224:227], v[182:185], v[154:157]
v_fma_f32 v222, v6, v118, v119
v_fma_f32 v223, v7, v118, v119
v_mfma_f32_16x16x32_bf16 v[158:161], v[248:251], v[182:185], v[158:161]
v_cvt_pk_bf16_f32 v92, v220, v221
v_cvt_pk_bf16_f32 v93, v222, v223
v_mfma_f32_16x16x32_bf16 v[162:165], v[182:185], a[88:91], v[162:165]
s_nop 0
ds_write_b128 v211, v[90:93]
v_mfma_f32_16x16x32_bf16 v[166:169], v[182:185], a[112:115], v[166:169]
s_waitcnt lgkmcnt(1)
buffer_load_dwordx4 v180, s[4:7], s40 offen nt lds
v_mfma_f32_16x16x32_bf16 v[170:173], v[182:185], a[136:139], v[170:173]
s_add_u32 m0, s45, 16448
v_fma_f32 v220, v8, v118, v119
v_fma_f32 v221, v9, v118, v119
v_mfma_f32_16x16x32_bf16 v[138:141], a[20:23], v[186:189], v[138:141]
s_add_u32 s40, s37, 784896
ds_read_b128 v[182:185], v210 offset:32768
v_fma_f32 v222, v10, v118, v119
v_mfma_f32_16x16x32_bf16 v[142:145], a[44:47], v[186:189], v[142:145]
v_fma_f32 v223, v11, v118, v119
v_cvt_pk_bf16_f32 v94, v220, v221
v_mfma_f32_16x16x32_bf16 v[146:149], a[68:71], v[186:189], v[146:149]
v_cvt_pk_bf16_f32 v96, v138, v139
v_cvt_pk_bf16_f32 v97, v140, v141
v_mfma_f32_16x16x32_bf16 v[150:153], a[236:239], v[186:189], v[150:153]
v_cvt_pk_bf16_f32 v98, v142, v143
v_cvt_pk_bf16_f32 v99, v144, v145
v_mfma_f32_16x16x32_bf16 v[154:157], v[228:231], v[186:189], v[154:157]
v_cvt_pk_bf16_f32 v100, v146, v147
v_cvt_pk_bf16_f32 v101, v148, v149
v_mfma_f32_16x16x32_bf16 v[158:161], v[252:255], v[186:189], v[158:161]
v_cvt_pk_bf16_f32 v84, v150, v151
v_cvt_pk_bf16_f32 v85, v152, v153
v_mfma_f32_16x16x32_bf16 v[162:165], v[186:189], a[92:95], v[162:165]
v_cvt_pk_bf16_f32 v86, v154, v155
v_cvt_pk_bf16_f32 v87, v156, v157
v_mfma_f32_16x16x32_bf16 v[166:169], v[186:189], a[116:119], v[166:169]
s_nop 0
v_cvt_pk_bf16_f32 v88, v158, v159
v_cvt_pk_bf16_f32 v89, v160, v161
v_mfma_f32_16x16x32_bf16 v[170:173], v[186:189], a[140:143], v[170:173]
s_waitcnt lgkmcnt(0)
ds_read_b128 v[186:189], v210 offset:33792
buffer_load_dwordx4 v180, s[4:7], s40 offen nt lds
v_mfma_f32_16x16x32_bf16 v[138:141], a[0:3], v[182:185], 0
s_add_u32 m0, s45, 20560
v_cvt_pk_bf16_f32 v124, v166, v167
v_cvt_pk_bf16_f32 v125, v168, v169
v_mfma_f32_16x16x32_bf16 v[142:145], a[24:27], v[182:185], 0
s_add_u32 s40, s37, 981120
v_cvt_pk_bf16_f32 v116, v162, v163
v_cvt_pk_bf16_f32 v117, v164, v165
v_mfma_f32_16x16x32_bf16 v[146:149], a[48:51], v[182:185], 0
ds_read_b128 v[182:185], v210 offset:34816
v_cvt_pk_bf16_f32 v95, v222, v223
v_fma_f32 v220, v12, v126, v127
v_mfma_f32_16x16x16_bf16 v[154:157], v[82:83], v[88:89], 0
v_fma_f32 v221, v13, v126, v127
v_fma_f32 v222, v14, v126, v127
v_fma_f32 v223, v15, v126, v127
v_mfma_f32_16x16x16_bf16 v[158:161], v[100:101], v[88:89], 0
v_cvt_pk_bf16_f32 v174, v220, v221
v_cvt_pk_bf16_f32 v175, v222, v223
v_fma_f32 v220, v16, v126, v127
v_fma_f32 v221, v17, v126, v127
s_waitcnt lgkmcnt(1)
v_mfma_f32_16x16x32_bf16 v[138:141], a[4:7], v[186:189], v[138:141]
ds_write_b64 v212, v[94:95]
v_mfma_f32_16x16x32_bf16 v[142:145], a[28:31], v[186:189], v[142:145]
v_fma_f32 v222, v18, v126, v127
v_fma_f32 v223, v19, v126, v127
v_mfma_f32_16x16x32_bf16 v[146:149], a[52:55], v[186:189], v[146:149]
s_waitcnt lgkmcnt(1)
ds_read_b128 v[186:189], v210 offset:35840
v_cvt_pk_bf16_f32 v176, v220, v221
v_mfma_f32_16x16x32_bf16 v[138:141], a[8:11], v[182:185], v[138:141]
buffer_load_dwordx4 v180, s[4:7], s40 offen nt lds
v_mfma_f32_16x16x32_bf16 v[142:145], a[32:35], v[182:185], v[142:145]
s_add_u32 m0, s45, 24672
v_cvt_pk_bf16_f32 v177, v222, v223
v_fma_f32 v220, v20, v126, v127
v_mfma_f32_16x16x32_bf16 v[146:149], a[56:59], v[182:185], v[146:149]
s_add_u32 s40, s37, 1177344
ds_read_b128 v[182:185], v210 offset:36864
ds_write_b128 v211, v[174:177] offset:6144
v_mfma_f32_16x16x16_bf16 v[166:169], v[112:113], v[88:89], v[206:209]
v_fma_f32 v221, v21, v126, v127
v_fma_f32 v222, v22, v126, v127
v_fma_f32 v223, v23, v126, v127
v_mfma_f32_16x16x16_bf16 v[150:153], v[112:113], v[76:77], v[206:209]
v_cvt_pk_bf16_f32 v178, v220, v221
v_cvt_pk_bf16_f32 v179, v222, v223
v_fma_f32 v220, v24, v134, v135
v_fma_f32 v221, v25, v134, v135
s_waitcnt lgkmcnt(2)
v_mfma_f32_16x16x32_bf16 v[138:141], a[12:15], v[186:189], v[138:141]
ds_write_b64 v212, v[178:179] offset:6144
v_mfma_f32_16x16x32_bf16 v[142:145], a[36:39], v[186:189], v[142:145]
v_fma_f32 v222, v26, v134, v135
v_fma_f32 v223, v27, v134, v135
v_mfma_f32_16x16x32_bf16 v[146:149], a[60:63], v[186:189], v[146:149]
s_waitcnt lgkmcnt(2)
ds_read_b128 v[186:189], v210 offset:37888
v_cvt_pk_bf16_f32 v90, v220, v221
v_mfma_f32_16x16x32_bf16 v[138:141], a[16:19], v[182:185], v[138:141]
buffer_load_dwordx4 v180, s[4:7], s40 offen nt lds
v_mfma_f32_16x16x32_bf16 v[142:145], a[40:43], v[182:185], v[142:145]
s_add_u32 m0, s45, 28784
v_cvt_pk_bf16_f32 v91, v222, v223
v_fma_f32 v220, v28, v134, v135
v_mfma_f32_16x16x32_bf16 v[154:157], v[78:81], v[84:87], v[154:157]
s_add_u32 s40, s37, 1373568
v_fma_f32 v221, v29, v134, v135
v_fma_f32 v222, v30, v134, v135
v_mfma_f32_16x16x32_bf16 v[150:153], v[108:111], v[72:75], v[150:153]
v_fma_f32 v223, v31, v134, v135
v_cvt_pk_bf16_f32 v92, v220, v221
v_mfma_f32_16x16x32_bf16 v[146:149], a[64:67], v[182:185], v[146:149]
s_nop 0
ds_read_b128 v[182:185], v210 offset:32768
v_cvt_pk_bf16_f32 v93, v222, v223
v_mfma_f32_16x16x32_bf16 v[158:161], v[96:99], v[84:87], v[158:161]
s_waitcnt lgkmcnt(1)
ds_write_b128 v211, v[90:93] offset:12288
v_mfma_f32_16x16x32_bf16 v[138:141], a[20:23], v[186:189], v[138:141]
v_fma_f32 v220, v32, v134, v135
v_fma_f32 v221, v33, v134, v135
v_mfma_f32_16x16x32_bf16 v[142:145], a[44:47], v[186:189], v[142:145]
v_fma_f32 v222, v34, v134, v135
v_fma_f32 v223, v35, v134, v135
v_mfma_f32_16x16x32_bf16 v[146:149], a[68:71], v[186:189], v[146:149]
ds_read_b128 v[186:189], v210 offset:33792
v_cvt_pk_bf16_f32 v102, v138, v139
v_mfma_f32_16x16x32_bf16 v[166:169], v[108:111], v[84:87], v[166:169]
v_cvt_pk_bf16_f32 v103, v140, v141
v_cvt_pk_bf16_f32 v104, v142, v143
v_cvt_pk_bf16_f32 v105, v144, v145
v_mfma_f32_16x16x16_bf16 v[138:141], v[82:83], v[76:77], 0
v_cvt_pk_bf16_f32 v106, v146, v147
v_cvt_pk_bf16_f32 v107, v148, v149
v_cvt_pk_bf16_f32 v132, v170, v171
v_mfma_f32_16x16x16_bf16 v[142:145], v[100:101], v[76:77], 0
v_cvt_pk_bf16_f32 v133, v172, v173
v_cvt_pk_bf16_f32 v94, v220, v221
v_cvt_pk_bf16_f32 v95, v222, v223
v_mfma_f32_16x16x16_bf16 v[162:165], v[106:107], v[88:89], 0
v_exp_f32 v150, v150
v_exp_f32 v154, v154
v_mfma_f32_16x16x16_bf16 v[146:149], v[106:107], v[76:77], 0
v_exp_f32_e64 v155, v155
v_exp_f32 v156, v156
v_mfma_f32_16x16x32_bf16 v[138:141], v[78:81], v[72:75], v[138:141]
s_waitcnt lgkmcnt(0)
buffer_load_dwordx4 v180, s[4:7], s40 offen nt lds
v_mfma_f32_16x16x32_bf16 v[142:145], v[96:99], v[72:75], v[142:145]
s_add_u32 m0, s45, 32896
ds_write_b64 v212, v[94:95] offset:12288
v_mfma_f32_16x16x32_bf16 v[118:121], v[182:185], a[72:75], 0
s_add_u32 s40, s37, 1569792
v_exp_f32 v138, v138
v_mfma_f32_16x16x32_bf16 v[126:129], v[182:185], a[96:99], 0
s_sub_u32 s42, s35, s42
ds_read_b64 v[76:77], v215 offset:16
v_exp_f32_e64 v139, v139
v_mfma_f32_16x16x32_bf16 v[134:137], v[182:185], a[120:123], 0
s_mul_i32 s51, s42, 2688
v_exp_f32 v140, v140
v_mfma_f32_16x16x32_bf16 v[146:149], v[102:105], v[72:75], v[146:149]
s_add_u32 s43, s43, s51
v_exp_f32 v141, v141
v_mfma_f32_16x16x32_bf16 v[90:93], a[216:219], v[182:185], 0
s_cmp_lt_u32 s35, s34
buffer_load_dwordx4 v180, s[4:7], s40 offen nt lds
v_mfma_f32_16x16x32_bf16 v[170:173], a[240:243], v[182:185], 0
s_cselect_b32 s50, s43, 1879048192
v_exp_f32 v142, v142
v_mfma_f32_16x16x32_bf16 v[220:223], v[232:235], v[182:185], 0
s_add_u32 s35, s35, 32
ds_read_b128 v[182:185], v210 offset:34816
v_cvt_pk_bf16_f32 v174, v138, v139
v_mfma_f32_16x16x32_bf16 v[118:121], v[186:189], a[76:79], v[118:121]
s_cmp_eq_u32 s42, 0
v_exp_f32 v143, v143
v_mfma_f32_16x16x32_bf16 v[126:129], v[186:189], a[100:103], v[126:129]
s_cselect_b32 s44, 536870911, s72
v_exp_f32 v144, v144
v_mfma_f32_16x16x32_bf16 v[134:137], v[186:189], a[124:127], v[134:137]
s_cmp_eq_u32 s42, 72
v_exp_f32 v145, v145
v_mfma_f32_16x16x32_bf16 v[90:93], a[220:223], v[186:189], v[90:93]
s_cselect_b32 s44, 939524095, s44
v_cvt_pk_bf16_f32 v175, v140, v141
v_cvt_pk_bf16_f32 v176, v142, v143
v_mfma_f32_16x16x32_bf16 v[170:173], a[244:247], v[186:189], v[170:173]
s_cmp_eq_u32 s41, 0
v_cvt_pk_bf16_f32 v177, v144, v145
v_cvt_pk_bf16_f32 v180, v150, 0
v_mfma_f32_16x16x32_bf16 v[220:223], v[236:239], v[186:189], v[220:223]
s_waitcnt lgkmcnt(0)
ds_read_b128 v[186:189], v210 offset:35840
ds_read_b128 v[72:75], v215
v_mfma_f32_16x16x32_bf16 v[118:121], v[182:185], a[80:83], v[118:121]
s_cselect_b32 s52, 1879048192, s50
v_exp_f32 v157, v157
v_mfma_f32_16x16x32_bf16 v[126:129], v[182:185], a[104:107], v[126:129]
s_add_u32 m0, s45, 0
v_exp_f32 v158, v158
v_mfma_f32_16x16x32_bf16 v[134:137], v[182:185], a[128:131], v[134:137]
s_mov_b32 s36, s50
v_exp_f32 v159, v159
v_mfma_f32_16x16x32_bf16 v[90:93], a[224:227], v[182:185], v[90:93]
s_mul_i32 s41, s32, 192
v_exp_f32 v160, v160
v_mfma_f32_16x16x32_bf16 v[162:165], v[102:105], v[84:87], v[162:165]
s_mov_b32 s42, 58835169
v_exp_f32_e64 v161, v161
v_mfma_f32_16x16x32_bf16 v[170:173], a[248:251], v[182:185], v[170:173]
v_exp_f32 v166, v166
v_mfma_f32_16x16x32_bf16 v[220:223], v[240:243], v[182:185], v[220:223]
s_waitcnt lgkmcnt(1)
ds_read_b128 v[182:185], v210 offset:36864
v_exp_f32 v146, v146
v_mfma_f32_16x16x32_bf16 v[118:121], v[186:189], a[84:87], v[118:121]
v_exp_f32 v147, v147
v_mfma_f32_16x16x32_bf16 v[126:129], v[186:189], a[108:111], v[126:129]
v_exp_f32 v148, v148
v_mfma_f32_16x16x32_bf16 v[134:137], v[186:189], a[132:135], v[134:137]
v_exp_f32 v149, v149
v_mfma_f32_16x16x32_bf16 v[90:93], a[228:231], v[186:189], v[90:93]
v_exp_f32_e64 v162, v162
v_mfma_f32_16x16x32_bf16 v[170:173], a[252:255], v[186:189], v[170:173]
v_exp_f32 v163, v163
v_mfma_f32_16x16x32_bf16 v[220:223], v[244:247], v[186:189], v[220:223]
s_waitcnt lgkmcnt(0)
ds_read_b128 v[186:189], v210 offset:37888
v_cvt_pk_bf16_f32 v178, v146, v147
v_mfma_f32_16x16x32_bf16 v[118:121], v[182:185], a[88:91], v[118:121]
v_exp_f32_e64 v164, v164
v_mfma_f32_16x16x32_bf16 v[126:129], v[182:185], a[112:115], v[126:129]
v_exp_f32 v165, v165
v_mfma_f32_16x16x32_bf16 v[134:137], v[182:185], a[136:139], v[134:137]
v_cvt_pk_bf16_f32 v179, v148, v149
v_mfma_f32_16x16x32_bf16 v[90:93], a[232:235], v[182:185], v[90:93]
v_mfma_f32_16x16x32_bf16 v[170:173], v[224:227], v[182:185], v[170:173]
v_mfma_f32_16x16x32_bf16 v[220:223], v[248:251], v[182:185], v[220:223]
s_waitcnt lgkmcnt(0)
v_mfma_f32_16x16x32_bf16 v[118:121], v[186:189], a[92:95], v[118:121]
v_mfma_f32_16x16x32_bf16 v[126:129], v[186:189], a[116:119], v[126:129]
v_mfma_f32_16x16x32_bf16 v[134:137], v[186:189], a[140:143], v[134:137]
v_cvt_pk_bf16_f32 v118, v118, v119
v_cvt_pk_bf16_f32 v119, v120, v121
v_mfma_f32_16x16x32_bf16 v[90:93], a[236:239], v[186:189], v[90:93]
ds_read_u16 v120, v214 offset:1024
v_cvt_pk_bf16_f32 v126, v126, v127
v_mfma_f32_16x16x32_bf16 v[170:173], v[228:231], v[186:189], v[170:173]
v_cvt_pk_bf16_f32 v127, v128, v129
v_cvt_pk_bf16_f32 v134, v134, v135
v_mfma_f32_16x16x32_bf16 v[220:223], v[252:255], v[186:189], v[220:223]
ds_read_u16 v128, v214 offset:1032
v_cvt_pk_bf16_f32 v90, v90, v91
v_mfma_f32_16x16x32_bf16 v[150:153], v[190:193], v[174:177], 0
v_cvt_pk_bf16_f32 v91, v92, v93
v_cvt_pk_bf16_f32 v92, v170, v171
v_mfma_f32_16x16x32_bf16 v[138:141], v[114:117], v[174:177], 0
v_cvt_pk_bf16_f32 v93, v172, v173
v_cvt_pk_bf16_f32 v135, v136, v137
v_mfma_f32_16x16x32_bf16 v[142:145], v[122:125], v[174:177], 0
ds_read_u16 v136, v214 offset:1040
v_mov_b32 v121, 0
v_mfma_f32_16x16x32_bf16 v[146:149], v[130:133], v[174:177], 0
v_cvt_pk_bf16_f32 v174, v154, v155
v_cvt_pk_bf16_f32 v175, v156, v157
v_mfma_f32_16x16x32_bf16 v[150:153], v[190:193], v[178:181], v[150:153]
s_waitcnt lgkmcnt(2)
v_cvt_pk_bf16_f32 v176, v158, v159
v_cvt_pk_bf16_f32 v177, v160, v161
v_mfma_f32_16x16x32_bf16 v[138:141], v[118:121], v[178:181], v[138:141]
v_mov_b32 v129, 0
v_mov_b32 v137, 0
v_mfma_f32_16x16x32_bf16 v[154:157], v[114:117], v[174:177], 0
v_rcp_f32 v151, v150
v_mfma_f32_16x16x32_bf16 v[158:161], v[122:125], v[174:177], 0
s_waitcnt lgkmcnt(1)
v_max3_u32 v218, v218, v150, v151
v_mul_f32_e64 v151, s3, v151
v_mfma_f32_16x16x32_bf16 v[142:145], v[126:129], v[178:181], v[142:145]
s_waitcnt lgkmcnt(0)
v_mul_f32 v138, v138, v151
v_mul_f32_e64 v139, v139, v151
v_mfma_f32_16x16x32_bf16 v[146:149], v[134:137], v[178:181], v[146:149]
v_cvt_pk_bf16_f32 v180, v166, 0
v_mul_f32_e64 v140, v140, v151
v_mfma_f32_16x16x32_bf16 v[166:169], v[190:193], v[174:177], 0
v_mul_f32_e64 v141, v141, v151
v_cvt_pk_bf16_f32 v138, v138, v139
v_mul_f32 v142, v142, v151
v_mul_f32 v143, v143, v151
v_mul_f32 v144, v144, v151
v_mul_f32 v145, v145, v151
v_cvt_pk_bf16_f32 v139, v140, v141
v_cvt_pk_bf16_f32 v140, v142, v143
v_cvt_pk_bf16_f32 v141, v144, v145
v_cvt_pk_bf16_f32 v178, v162, v163
v_cvt_pk_bf16_f32 v179, v164, v165
v_mfma_f32_16x16x32_bf16 v[162:165], v[130:133], v[174:177], 0
ds_write_b128 v211, v[138:141] offset:38912
v_mfma_f32_16x16x32_bf16 v[138:141], v[78:81], v[90:93], 0
v_mul_f32 v146, v146, v151
v_mul_f32 v147, v147, v151
v_mfma_f32_16x16x32_bf16 v[166:169], v[190:193], v[178:181], v[166:169]
v_mul_f32 v148, v148, v151
v_mul_f32 v149, v149, v151
v_mfma_f32_16x16x32_bf16 v[154:157], v[118:121], v[178:181], v[154:157]
v_cvt_pk_bf16_f32 v142, v146, v147
v_cvt_pk_bf16_f32 v143, v148, v149
v_mfma_f32_16x16x32_bf16 v[158:161], v[126:129], v[178:181], v[158:161]
ds_write_b64 v212, v[142:143] offset:38912
v_mfma_f32_16x16x32_bf16 v[142:145], v[96:99], v[90:93], 0
v_rcp_f32_e64 v167, v166
v_mfma_f32_16x16x32_bf16 v[162:165], v[134:137], v[178:181], v[162:165]
v_max3_u32 v218, v218, v166, v167
v_cvt_pk_bf16_f32 v94, v220, v221
v_mfma_f32_16x16x32_bf16 v[150:153], v[108:111], v[90:93], v[206:209]
v_cvt_pk_bf16_f32 v95, v222, v223
v_mul_f32_e64 v167, s3, v167
v_mfma_f32_16x16x32_bf16 v[146:149], v[102:105], v[90:93], 0
v_mul_f32 v154, v154, v167
v_mul_f32 v155, v155, v167
v_mul_f32_e64 v156, v156, v167
v_mfma_f32_16x16x16_bf16 v[138:141], v[82:83], v[94:95], v[138:141]
v_mul_f32_e64 v157, v157, v167
v_cvt_pk_bf16_f32 v154, v154, v155
v_mul_f32_e64 v158, v158, v167
v_mfma_f32_16x16x16_bf16 v[142:145], v[100:101], v[94:95], v[142:145]
v_mul_f32 v159, v159, v167
v_mul_f32 v160, v160, v167
v_mul_f32_e64 v161, v161, v167
v_mfma_f32_16x16x16_bf16 v[150:153], v[112:113], v[94:95], v[150:153]
v_cvt_pk_bf16_f32 v155, v156, v157
v_cvt_pk_bf16_f32 v156, v158, v159
v_cvt_pk_bf16_f32 v157, v160, v161
v_mfma_f32_16x16x16_bf16 v[146:149], v[106:107], v[94:95], v[146:149]
v_mul_f32 v162, v162, v167
v_mul_f32 v163, v163, v167
v_mul_f32 v164, v164, v167
v_mul_f32 v165, v165, v167
v_mfma_f32_16x16x16_bf16 v[166:169], v[76:77], v[112:113], v[206:209]
v_cvt_pk_bf16_f32 v158, v162, v163
v_cvt_pk_bf16_f32 v159, v164, v165
v_exp_f32 v138, v138
v_mfma_f32_16x16x16_bf16 v[162:165], v[76:77], v[106:107], 0
v_exp_f32 v139, v139
v_exp_f32 v140, v140
v_mfma_f32_16x16x32_bf16 v[166:169], v[72:75], v[108:111], v[166:169]
ds_write_b128 v211, v[154:157] offset:45056
v_mfma_f32_16x16x16_bf16 v[154:157], v[76:77], v[82:83], 0
v_exp_f32 v141, v141
v_exp_f32 v142, v142
v_mfma_f32_16x16x32_bf16 v[162:165], v[72:75], v[102:105], v[162:165]
v_exp_f32 v143, v143
v_mfma_f32_16x16x32_bf16 v[154:157], v[72:75], v[78:81], v[154:157]
ds_write_b64 v212, v[158:159] offset:45056
v_mfma_f32_16x16x16_bf16 v[158:161], v[76:77], v[100:101], 0
v_exp_f32 v144, v144
v_exp_f32 v145, v145
v_exp_f32_e64 v150, v150
v_mfma_f32_16x16x32_bf16 v[158:161], v[72:75], v[96:99], v[158:161]
v_cvt_pk_bf16_f32 v174, v138, v139
v_cvt_pk_bf16_f32 v175, v140, v141
v_cvt_pk_bf16_f32 v176, v142, v143
v_cvt_pk_bf16_f32 v177, v144, v145
v_cvt_pk_bf16_f32 v180, v150, 0
v_exp_f32_e64 v146, v146
v_mfma_f32_16x16x32_bf16 v[150:153], v[190:193], v[174:177], 0
v_exp_f32 v147, v147
v_mfma_f32_16x16x32_bf16 v[138:141], v[114:117], v[174:177], 0
s_waitcnt lgkmcnt(0)
v_exp_f32 v148, v148
v_mfma_f32_16x16x32_bf16 v[142:145], v[122:125], v[174:177], 0
s_barrier
ds_read_b128 v[170:173], v210 offset:38912
ds_read_b128 v[182:185], v210 offset:39936
ds_read_b128 v[186:189], v210 offset:40960
v_exp_f32_e64 v149, v149
v_cvt_pk_bf16_f32 v178, v146, v147
v_cvt_pk_bf16_f32 v179, v148, v149
v_mfma_f32_16x16x32_bf16 v[146:149], v[130:133], v[174:177], 0
v_mov_b32_dpp v154, v158 quad_perm:[0,1,2,3] row_mask:0x2 bank_mask:0xf
v_mfma_f32_16x16x32_bf16 v[150:153], v[190:193], v[178:181], v[150:153]
v_mov_b32_dpp v154, v162 quad_perm:[0,1,2,3] row_mask:0x4 bank_mask:0xf
v_mfma_f32_16x16x32_bf16 v[138:141], v[118:121], v[178:181], v[138:141]
v_mov_b32_dpp v154, v167 quad_perm:[0,1,2,3] row_mask:0x8 bank_mask:0xf
v_exp_f32_e64 v154, v154
v_mfma_f32_16x16x32_bf16 v[142:145], v[126:129], v[178:181], v[142:145]
v_cvt_pk_bf16_f32 v154, v154, 0
v_rcp_f32 v151, v150
v_mfma_f32_16x16x32_bf16 v[146:149], v[134:137], v[178:181], v[146:149]
s_waitcnt lgkmcnt(2)
ds_write_b16 v214, v154
v_mfma_f32_16x16x32_bf16 v[36:39], a[144:147], v[170:173], v[36:39]
ds_read_b128 v[84:87], v215
ds_read_b128 v[88:91], v215 offset:16
v_mfma_f32_16x16x32_bf16 v[40:43], a[168:171], v[170:173], v[40:43]
s_nop 0
ds_read_b128 v[174:177], v217
ds_read_b128 v[178:181], v217 offset:528
v_mfma_f32_16x16x32_bf16 v[44:47], a[192:195], v[170:173], v[44:47]
s_waitcnt lgkmcnt(6)
ds_read_b128 v[170:173], v210 offset:41984
v_add_u32 v215, 1552, v215
v_mfma_f32_16x16x32_bf16 v[36:39], a[148:151], v[182:185], v[36:39]
ds_read_b64 v[112:113], v215 offset:528
v_mfma_f32_16x16x32_bf16 v[40:43], a[172:175], v[182:185], v[40:43]
v_mfma_f32_16x16x32_bf16 v[44:47], a[196:199], v[182:185], v[44:47]
s_nop 0
ds_read_b128 v[182:185], v210 offset:43008
s_waitcnt lgkmcnt(6)
v_mfma_f32_16x16x32_bf16 v[166:169], v[84:87], v[190:193], 0
v_mfma_f32_16x16x32_bf16 v[154:157], v[84:87], v[114:117], 0
v_mfma_f32_16x16x32_bf16 v[158:161], v[84:87], v[122:125], 0
v_mfma_f32_16x16x32_bf16 v[162:165], v[84:87], v[130:133], 0
s_waitcnt lgkmcnt(5)
v_mfma_f32_16x16x32_bf16 v[166:169], v[88:91], v[190:193], v[166:169]
v_mfma_f32_16x16x32_bf16 v[154:157], v[88:91], v[118:121], v[154:157]
v_mfma_f32_16x16x32_bf16 v[158:161], v[88:91], v[126:129], v[158:161]
v_rcp_f32 v167, v166
v_mfma_f32_16x16x32_bf16 v[162:165], v[88:91], v[134:137], v[162:165]
v_max3_u32 v218, v218, v166, v167
v_max3_u32 v218, v218, v150, v151
v_mfma_f32_16x16x32_bf16 v[36:39], a[152:155], v[186:189], v[36:39]
v_mul_f32 v151, s3, v151
v_mul_f32 v138, v138, v151
v_mfma_f32_16x16x32_bf16 v[40:43], a[176:179], v[186:189], v[40:43]
v_mul_f32_e64 v139, v139, v151
v_mul_f32 v140, v140, v151
v_mfma_f32_16x16x32_bf16 v[44:47], a[200:203], v[186:189], v[44:47]
s_waitcnt lgkmcnt(2)
ds_read_b128 v[186:189], v210 offset:44032
v_mul_f32_e64 v141, v141, v151
v_mfma_f32_16x16x32_bf16 v[36:39], a[156:159], v[170:173], v[36:39]
v_cvt_pk_bf16_f32 v138, v138, v139
v_mul_f32_e64 v142, v142, v151
v_mfma_f32_16x16x32_bf16 v[40:43], a[180:183], v[170:173], v[40:43]
v_mul_f32_e64 v143, v143, v151
v_mul_f32 v144, v144, v151
v_mfma_f32_16x16x32_bf16 v[44:47], a[204:207], v[170:173], v[44:47]
s_waitcnt lgkmcnt(1)
ds_read_b128 v[170:173], v210 offset:45056
v_mul_f32_e64 v145, v145, v151
v_mfma_f32_16x16x32_bf16 v[36:39], a[160:163], v[182:185], v[36:39]
v_cvt_pk_bf16_f32 v139, v140, v141
v_cvt_pk_bf16_f32 v140, v142, v143
v_mfma_f32_16x16x32_bf16 v[40:43], a[184:187], v[182:185], v[40:43]
v_cvt_pk_bf16_f32 v141, v144, v145
v_mul_f32 v146, v146, v151
v_mfma_f32_16x16x32_bf16 v[44:47], a[208:211], v[182:185], v[44:47]
s_waitcnt lgkmcnt(1)
ds_read_b128 v[182:185], v210 offset:46080
ds_write_b128 v211, v[138:141] offset:51200
v_mfma_f32_16x16x32_bf16 v[36:39], a[164:167], v[186:189], v[36:39]
v_mul_f32 v147, v147, v151
v_mul_f32 v148, v148, v151
v_mfma_f32_16x16x32_bf16 v[40:43], a[188:191], v[186:189], v[40:43]
v_mul_f32 v149, v149, v151
v_cvt_pk_bf16_f32 v142, v146, v147
v_mfma_f32_16x16x32_bf16 v[44:47], a[212:215], v[186:189], v[44:47]
s_waitcnt lgkmcnt(2)
ds_read_b128 v[186:189], v210 offset:47104
v_cvt_pk_bf16_f32 v143, v148, v149
v_mfma_f32_16x16x32_bf16 v[48:51], a[144:147], v[170:173], v[48:51]
ds_write_b64 v212, v[142:143] offset:51200
v_mfma_f32_16x16x32_bf16 v[52:55], a[168:171], v[170:173], v[52:55]
s_nop 0
v_cvt_pk_bf16_f32 v72, v36, v37
v_cvt_pk_bf16_f32 v73, v38, v39
v_mfma_f32_16x16x32_bf16 v[56:59], a[192:195], v[170:173], v[56:59]
s_waitcnt lgkmcnt(3)
ds_read_b128 v[170:173], v210 offset:48128
buffer_store_dwordx2 v[72:73], v203, s[8:11], s39 offen
v_cvt_pk_bf16_f32 v74, v40, v41
v_mfma_f32_16x16x32_bf16 v[48:51], a[148:151], v[182:185], v[48:51]
v_cvt_pk_bf16_f32 v75, v42, v43
v_mov_b32_dpp v154, v158 quad_perm:[0,1,2,3] row_mask:0x2 bank_mask:0xf
v_mfma_f32_16x16x32_bf16 v[52:55], a[172:175], v[182:185], v[52:55]
v_mul_f32 v167, s3, v167
v_mov_b32_dpp v154, v162 quad_perm:[0,1,2,3] row_mask:0x4 bank_mask:0xf
v_mfma_f32_16x16x32_bf16 v[56:59], a[196:199], v[182:185], v[56:59]
s_waitcnt lgkmcnt(2)
ds_read_b128 v[182:185], v210 offset:49152
v_mul_f32_e64 v154, v154, v167
v_mfma_f32_16x16x32_bf16 v[48:51], a[152:155], v[186:189], v[48:51]
v_cvt_pk_bf16_f32 v154, v154, 0
v_cvt_pk_bf16_f32 v76, v44, v45
v_mfma_f32_16x16x32_bf16 v[52:55], a[176:179], v[186:189], v[52:55]
s_waitcnt vmcnt(1) lgkmcnt(1)
ds_write_b16 v214, v154
v_mfma_f32_16x16x32_bf16 v[56:59], a[200:203], v[186:189], v[56:59]
s_barrier
v_mfma_f32_16x16x32_bf16 v[48:51], a[156:159], v[170:173], v[48:51]
ds_read_b128 v[186:189], v210 offset:50176
ds_read_b128 v[84:87], v200
v_mfma_f32_16x16x32_bf16 v[52:55], a[180:183], v[170:173], v[52:55]
s_nop 0
ds_read_b128 v[92:95], v201
ds_read_b128 v[100:103], v202
v_mfma_f32_16x16x32_bf16 v[56:59], a[204:207], v[170:173], v[56:59]
s_waitcnt lgkmcnt(5)
ds_read_b128 v[170:173], v210 offset:51200
ds_read_b128 v[88:91], v194 offset:16
v_mfma_f32_16x16x32_bf16 v[48:51], a[160:163], v[182:185], v[48:51]
ds_read_b128 v[96:99], v195 offset:16
v_cvt_pk_bf16_f32 v77, v46, v47
v_mfma_f32_16x16x32_bf16 v[52:55], a[184:187], v[182:185], v[52:55]
ds_read_b128 v[104:107], v196 offset:16
v_add_u32 v214, 1552, v214
v_mfma_f32_16x16x32_bf16 v[56:59], a[208:211], v[182:185], v[56:59]
s_nop 0
ds_read_b128 v[182:185], v210 offset:52224
buffer_store_dwordx2 v[74:75], v203, s[8:11], s39 offen offset:32
s_waitcnt lgkmcnt(8)
v_mfma_f32_16x16x32_bf16 v[48:51], a[164:167], v[186:189], v[48:51]
v_mfma_f32_16x16x32_bf16 v[52:55], a[188:191], v[186:189], v[52:55]
v_mfma_f32_16x16x32_bf16 v[56:59], a[212:215], v[186:189], v[56:59]
s_waitcnt lgkmcnt(7)
ds_read_b128 v[186:189], v210 offset:53248
v_cvt_pk_bf16_f32 v78, v48, v49
v_mfma_f32_16x16x32_bf16 v[36:39], v[174:177], v[84:87], 0
s_waitcnt lgkmcnt(5)
ds_read_b128 v[84:87], v194
v_cvt_pk_bf16_f32 v79, v50, v51
v_mfma_f32_16x16x32_bf16 v[60:63], a[144:147], v[170:173], v[60:63]
v_cvt_pk_bf16_f32 v80, v52, v53
v_cvt_pk_bf16_f32 v81, v54, v55
v_mfma_f32_16x16x32_bf16 v[64:67], a[168:171], v[170:173], v[64:67]
v_cvt_pk_bf16_f32 v82, v56, v57
v_cvt_pk_bf16_f32 v83, v58, v59
v_mfma_f32_16x16x32_bf16 v[68:71], a[192:195], v[170:173], v[68:71]
ds_read_b128 v[170:173], v210 offset:54272
v_mfma_f32_16x16x32_bf16 v[48:51], v[174:177], v[92:95], 0
ds_read_b128 v[92:95], v195
s_waitcnt lgkmcnt(4)
v_mfma_f32_16x16x32_bf16 v[60:63], a[148:151], v[182:185], v[60:63]
v_mfma_f32_16x16x32_bf16 v[64:67], a[172:175], v[182:185], v[64:67]
v_mfma_f32_16x16x32_bf16 v[68:71], a[196:199], v[182:185], v[68:71]
ds_read_b128 v[182:185], v210 offset:55296
s_waitcnt lgkmcnt(4)
v_mfma_f32_16x16x32_bf16 v[60:63], a[152:155], v[186:189], v[60:63]
v_mfma_f32_16x16x32_bf16 v[64:67], a[176:179], v[186:189], v[64:67]
v_mfma_f32_16x16x32_bf16 v[68:71], a[200:203], v[186:189], v[68:71]
s_nop 0
ds_read_b128 v[186:189], v210 offset:56320
s_waitcnt lgkmcnt(3)
v_mfma_f32_16x16x32_bf16 v[60:63], a[156:159], v[170:173], v[60:63]
buffer_store_dwordx2 v[76:77], v203, s[8:11], s39 offen offset:64
v_mfma_f32_16x16x32_bf16 v[64:67], a[180:183], v[170:173], v[64:67]
v_mfma_f32_16x16x32_bf16 v[68:71], a[204:207], v[170:173], v[68:71]
s_waitcnt lgkmcnt(1)
v_mfma_f32_16x16x32_bf16 v[60:63], a[160:163], v[182:185], v[60:63]
v_mfma_f32_16x16x32_bf16 v[64:67], a[184:187], v[182:185], v[64:67]
v_mfma_f32_16x16x32_bf16 v[68:71], a[208:211], v[182:185], v[68:71]
ds_read_b128 v[182:185], v210
s_waitcnt lgkmcnt(1)
v_mfma_f32_16x16x32_bf16 v[60:63], a[164:167], v[186:189], v[60:63]
v_smfmac_f32_16x16x64_bf16 v[36:39], v[178:181], v[84:91], v213
ds_read_b128 v[84:87], v197
ds_read_b128 v[88:91], v197 offset:16
v_mfma_f32_16x16x32_bf16 v[64:67], a[188:191], v[186:189], v[64:67]
v_cvt_pk_bf16_f32 v116, v60, v61
v_cvt_pk_bf16_f32 v117, v62, v63
v_mfma_f32_16x16x32_bf16 v[60:63], v[174:177], v[100:103], 0
ds_read_b128 v[100:103], v196
ds_read_b128 v[174:177], v217 offset:1056
v_mfma_f32_16x16x32_bf16 v[68:71], a[212:215], v[186:189], v[68:71]
s_nop 0
ds_read_b128 v[186:189], v210 offset:1024
v_cvt_pk_bf16_f32 v124, v64, v65
v_smfmac_f32_16x16x64_bf16 v[48:51], v[178:181], v[92:99], v213
s_waitcnt lgkmcnt(5)
ds_read_b128 v[92:95], v198
ds_read_b128 v[96:99], v198 offset:16
v_mfma_f32_16x16x32_bf16 v[138:141], a[0:3], v[182:185], 0
v_cvt_pk_bf16_f32 v125, v66, v67
v_cvt_pk_bf16_f32 v132, v68, v69
v_mfma_f32_16x16x32_bf16 v[142:145], a[24:27], v[182:185], 0
s_nop 0
v_cvt_pk_bf16_f32 v133, v70, v71
v_mfma_f32_16x16x32_bf16 v[146:149], a[48:51], v[182:185], 0
s_waitcnt lgkmcnt(4)
v_smfmac_f32_16x16x64_bf16 v[60:63], v[178:181], v[100:107], v213
ds_read_b128 v[100:103], v199
ds_read_b128 v[104:107], v199 offset:16
v_mfma_f32_16x16x32_bf16 v[150:153], a[216:219], v[182:185], 0
ds_read_b128 v[178:181], v217 offset:1584
buffer_store_dwordx2 v[78:79], v204, s[8:11], s39 offen
s_waitcnt lgkmcnt(6)
v_smfmac_f32_16x16x64_bf16 v[36:39], v[174:177], v[84:91], v213
ds_read_b128 v[84:87], v200 offset:32
ds_read_b128 v[88:91], v194 offset:48
v_mfma_f32_16x16x32_bf16 v[154:157], a[240:243], v[182:185], 0
s_waitcnt lgkmcnt(5)
v_smfmac_f32_16x16x64_bf16 v[48:51], v[174:177], v[92:99], v213
ds_read_b128 v[92:95], v201 offset:32
ds_read_b128 v[96:99], v195 offset:48
v_mfma_f32_16x16x32_bf16 v[158:161], v[232:235], v[182:185], 0
v_mul_f32 v119, v36, v36
v_add_f32 v118, v36, v37
v_mfma_f32_16x16x32_bf16 v[162:165], v[182:185], a[72:75], 0
s_waitcnt lgkmcnt(5)
v_mul_f32 v127, v48, v48
v_add_f32_e64 v126, v48, v49
v_smfmac_f32_16x16x64_bf16 v[60:63], v[174:177], v[100:107], v213
ds_read_b128 v[100:103], v202 offset:32
ds_read_b128 v[174:177], v217 offset:2112
v_mfma_f32_16x16x32_bf16 v[166:169], v[182:185], a[96:99], 0
s_waitcnt lgkmcnt(5)
ds_read_b128 v[104:107], v196 offset:48
v_fmac_f32 v119, v37, v37
v_mfma_f32_16x16x32_bf16 v[40:43], v[178:181], v[84:87], 0
ds_read_b128 v[84:87], v194 offset:32
v_mul_f32 v135, v60, v60
v_mfma_f32_16x16x32_bf16 v[170:173], v[182:185], a[120:123], 0
s_waitcnt lgkmcnt(5)
ds_read_b128 v[182:185], v210 offset:2048
v_add_f32_e64 v134, v60, v61
v_mfma_f32_16x16x32_bf16 v[52:55], v[178:181], v[92:95], 0
ds_read_b128 v[92:95], v195 offset:32
v_fmac_f32_e64 v135, v61, v61
v_mfma_f32_16x16x32_bf16 v[138:141], a[4:7], v[186:189], v[138:141]
v_fmac_f32 v127, v49, v49
v_add_f32 v134, v134, v62
v_mfma_f32_16x16x32_bf16 v[142:145], a[28:31], v[186:189], v[142:145]
s_waitcnt lgkmcnt(5)
v_fmac_f32 v135, v62, v62
v_add_f32_e64 v118, v118, v38
v_mfma_f32_16x16x32_bf16 v[64:67], v[178:181], v[100:103], 0
ds_read_b128 v[100:103], v196 offset:32
ds_read_b128 v[178:181], v217 offset:2640
v_mfma_f32_16x16x32_bf16 v[146:149], a[52:55], v[186:189], v[146:149]
v_add_f32 v126, v126, v50
v_fmac_f32 v119, v38, v38
v_mfma_f32_16x16x32_bf16 v[150:153], a[220:223], v[186:189], v[150:153]
s_waitcnt lgkmcnt(4)
v_fmac_f32 v127, v50, v50
v_add_f32_e64 v134, v134, v63
v_smfmac_f32_16x16x64_bf16 v[40:43], v[174:177], v[84:91], v213
s_nop 0
ds_read_b128 v[84:87], v197 offset:32
ds_read_b128 v[88:91], v197 offset:48
v_mfma_f32_16x16x32_bf16 v[154:157], a[244:247], v[186:189], v[154:157]
s_waitcnt lgkmcnt(4)
buffer_store_dwordx2 v[80:81], v204, s[8:11], s39 offen offset:32
v_fmac_f32 v135, v63, v63
v_smfmac_f32_16x16x64_bf16 v[52:55], v[174:177], v[92:99], v213
s_waitcnt lgkmcnt(3)
ds_read_b128 v[92:95], v198 offset:32
ds_read_b128 v[96:99], v198 offset:48
v_smfmac_f32_16x16x64_bf16 v[64:67], v[174:177], v[100:107], v213
ds_read_b128 v[100:103], v199 offset:32
ds_read_b128 v[104:107], v199 offset:48
v_mfma_f32_16x16x32_bf16 v[158:161], v[236:239], v[186:189], v[158:161]
ds_read_b128 v[174:177], v217 offset:3168
v_add_f32_e64 v118, v118, v39
v_mfma_f32_16x16x32_bf16 v[162:165], v[186:189], a[76:79], v[162:165]
v_add_f32 v126, v126, v51
v_fmac_f32 v119, v39, v39
v_mfma_f32_16x16x32_bf16 v[166:169], v[186:189], a[100:103], v[166:169]
v_fmac_f32 v127, v51, v51
s_waitcnt lgkmcnt(5)
v_smfmac_f32_16x16x64_bf16 v[40:43], v[178:181], v[84:91], v213
ds_read_b128 v[84:87], v200 offset:64
ds_read_b128 v[88:91], v194 offset:80
v_mfma_f32_16x16x32_bf16 v[170:173], v[186:189], a[124:127], v[170:173]
s_nop 0
ds_read_b128 v[186:189], v210 offset:3072
s_waitcnt lgkmcnt(6)
v_smfmac_f32_16x16x64_bf16 v[52:55], v[178:181], v[92:99], v213
ds_read_b128 v[92:95], v201 offset:64
ds_read_b128 v[96:99], v195 offset:80
v_mfma_f32_16x16x32_bf16 v[138:141], a[8:11], v[182:185], v[138:141]
v_add_f32 v118, v118, v40
v_fmac_f32 v119, v40, v40
v_mfma_f32_16x16x32_bf16 v[142:145], a[32:35], v[182:185], v[142:145]
s_waitcnt lgkmcnt(6)
v_add_f32 v126, v126, v52
v_fmac_f32_e64 v127, v52, v52
v_smfmac_f32_16x16x64_bf16 v[64:67], v[178:181], v[100:107], v213
ds_read_b128 v[100:103], v202 offset:64
ds_read_b128 v[178:181], v217 offset:3696
v_mfma_f32_16x16x32_bf16 v[146:149], a[56:59], v[182:185], v[146:149]
s_waitcnt lgkmcnt(6)
ds_read_b128 v[104:107], v196 offset:80
v_add_f32 v118, v118, v41
v_mfma_f32_16x16x32_bf16 v[44:47], v[174:177], v[84:87], 0
ds_read_b128 v[84:87], v194 offset:64
v_add_f32_e64 v134, v134, v64
v_mfma_f32_16x16x32_bf16 v[150:153], a[224:227], v[182:185], v[150:153]
buffer_store_dwordx2 v[82:83], v204, s[8:11], s39 offen offset:64
v_fmac_f32 v135, v64, v64
v_mfma_f32_16x16x32_bf16 v[154:157], a[248:251], v[182:185], v[154:157]
s_waitcnt lgkmcnt(5)
v_add_f32 v134, v134, v65
v_fmac_f32 v135, v65, v65
v_mfma_f32_16x16x32_bf16 v[56:59], v[174:177], v[92:95], 0
s_waitcnt lgkmcnt(3)
ds_read_b128 v[92:95], v195 offset:64
v_fmac_f32 v119, v41, v41
v_mfma_f32_16x16x32_bf16 v[68:71], v[174:177], v[100:103], 0
ds_read_b128 v[100:103], v196 offset:64
ds_read_b128 v[174:177], v217 offset:4224
v_mfma_f32_16x16x32_bf16 v[158:161], v[240:243], v[182:185], v[158:161]
v_add_f32 v126, v126, v53
v_fmac_f32 v127, v53, v53
v_mfma_f32_16x16x32_bf16 v[162:165], v[182:185], a[80:83], v[162:165]
s_waitcnt lgkmcnt(3)
v_add_f32 v134, v134, v66
v_fmac_f32_e64 v135, v66, v66
v_smfmac_f32_16x16x64_bf16 v[44:47], v[178:181], v[84:91], v213
ds_read_b128 v[84:87], v197 offset:64
ds_read_b128 v[88:91], v197 offset:80
v_mfma_f32_16x16x32_bf16 v[166:169], v[182:185], a[104:107], v[166:169]
v_add_f32_e64 v118, v118, v42
v_fmac_f32 v119, v42, v42
v_mfma_f32_16x16x32_bf16 v[170:173], v[182:185], a[128:131], v[170:173]
s_waitcnt lgkmcnt(4)
ds_read_b128 v[182:185], v210 offset:4096
v_add_f32_e64 v126, v126, v54
v_smfmac_f32_16x16x64_bf16 v[56:59], v[178:181], v[92:99], v213
ds_read_b128 v[92:95], v198 offset:64
ds_read_b128 v[96:99], v198 offset:80
v_mfma_f32_16x16x32_bf16 v[138:141], a[12:15], v[186:189], v[138:141]
s_waitcnt lgkmcnt(6)
v_fmac_f32 v127, v54, v54
v_add_f32_e64 v134, v134, v67
v_smfmac_f32_16x16x64_bf16 v[68:71], v[178:181], v[100:107], v213
ds_read_b128 v[100:103], v199 offset:64
ds_read_b128 v[104:107], v199 offset:80
v_mfma_f32_16x16x32_bf16 v[142:145], a[36:39], v[186:189], v[142:145]
v_fmac_f32 v135, v67, v67
v_add_f32 v118, v118, v43
v_mfma_f32_16x16x32_bf16 v[146:149], a[60:63], v[186:189], v[146:149]
v_fmac_f32 v119, v43, v43
v_add_f32 v126, v126, v55
v_mfma_f32_16x16x32_bf16 v[150:153], a[228:231], v[186:189], v[150:153]
v_fmac_f32 v127, v55, v55
v_and_b32 v180, s44, v208
v_mfma_f32_16x16x32_bf16 v[154:157], a[252:255], v[186:189], v[154:157]
v_mov_b32 v181, 0
s_waitcnt lgkmcnt(5)
v_smfmac_f32_16x16x64_bf16 v[44:47], v[174:177], v[84:91], v213
buffer_store_dwordx2 v[116:117], v205, s[8:11], s39 offen
v_mfma_f32_16x16x32_bf16 v[158:161], v[244:247], v[186:189], v[158:161]
v_mfma_f32_16x16x32_bf16 v[162:165], v[186:189], a[84:87], v[162:165]
s_waitcnt lgkmcnt(2)
v_add_f32 v118, v118, v44
v_fmac_f32_e64 v119, v44, v44
v_smfmac_f32_16x16x64_bf16 v[56:59], v[174:177], v[92:99], v213
v_add_f32 v118, v118, v45
v_mfma_f32_16x16x32_bf16 v[166:169], v[186:189], a[108:111], v[166:169]
v_fmac_f32 v119, v45, v45
v_add_f32 v118, v118, v46
v_mfma_f32_16x16x32_bf16 v[170:173], v[186:189], a[132:135], v[170:173]
s_waitcnt lgkmcnt(0)
ds_read_b128 v[186:189], v210 offset:5120
v_add_f32_e64 v126, v126, v56
v_smfmac_f32_16x16x64_bf16 v[68:71], v[174:177], v[100:107], v213
v_fmac_f32_e64 v127, v56, v56
v_mfma_f32_16x16x32_bf16 v[138:141], a[16:19], v[182:185], v[138:141]
v_add_f32 v126, v126, v57
v_fmac_f32 v127, v57, v57
v_mfma_f32_16x16x32_bf16 v[142:145], a[40:43], v[182:185], v[142:145]
v_add_f32 v134, v134, v68
v_fmac_f32 v135, v68, v68
v_mfma_f32_16x16x32_bf16 v[146:149], a[64:67], v[182:185], v[146:149]
v_add_f32 v134, v134, v69
v_fmac_f32 v135, v69, v69
v_mfma_f32_16x16x32_bf16 v[150:153], a[232:235], v[182:185], v[150:153]
v_add_f32 v134, v134, v70
v_fmac_f32 v135, v70, v70
v_mfma_f32_16x16x32_bf16 v[154:157], v[224:227], v[182:185], v[154:157]
v_fmac_f32 v119, v46, v46
v_add_f32 v126, v126, v58
v_mfma_f32_16x16x32_bf16 v[158:161], v[248:251], v[182:185], v[158:161]
v_fmac_f32 v127, v58, v58
v_add_f32 v134, v134, v71
v_mfma_f32_16x16x32_bf16 v[162:165], v[182:185], a[88:91], v[162:165]
v_fmac_f32 v135, v71, v71
v_add_f32 v118, v118, v47
v_mfma_f32_16x16x32_bf16 v[166:169], v[182:185], a[112:115], v[166:169]
v_fmac_f32_e64 v119, v47, v47
v_add_f32 v126, v126, v59
v_mfma_f32_16x16x32_bf16 v[170:173], v[182:185], a[136:139], v[170:173]
s_waitcnt lgkmcnt(0)
ds_read_b128 v[182:185], v210 offset:6144
v_fmac_f32_e64 v127, v59, v59
v_mfma_f32_16x16x32_bf16 v[138:141], a[20:23], v[186:189], v[138:141]
buffer_store_dwordx2 v[124:125], v205, s[8:11], s39 offen offset:32
v_permlane16_swap_b32 v134, v135
v_mfma_f32_16x16x32_bf16 v[142:145], a[44:47], v[186:189], v[142:145]
v_permlane16_swap_b32 v118, v119
v_mfma_f32_16x16x32_bf16 v[146:149], a[68:71], v[186:189], v[146:149]
v_cvt_pk_bf16_f32 v78, v138, v139
v_cvt_pk_bf16_f32 v79, v140, v141
v_mfma_f32_16x16x32_bf16 v[150:153], a[236:239], v[186:189], v[150:153]
v_cvt_pk_bf16_f32 v80, v142, v143
v_cvt_pk_bf16_f32 v81, v144, v145
v_mfma_f32_16x16x32_bf16 v[154:157], v[228:231], v[186:189], v[154:157]
v_cvt_pk_bf16_f32 v82, v146, v147
v_cvt_pk_bf16_f32 v83, v148, v149
v_mfma_f32_16x16x32_bf16 v[158:161], v[252:255], v[186:189], v[158:161]
v_cvt_pk_bf16_f32 v72, v150, v151
v_cvt_pk_bf16_f32 v73, v152, v153
v_mfma_f32_16x16x32_bf16 v[162:165], v[186:189], a[92:95], v[162:165]
v_cvt_pk_bf16_f32 v74, v154, v155
v_cvt_pk_bf16_f32 v75, v156, v157
v_mfma_f32_16x16x32_bf16 v[166:169], v[186:189], a[116:119], v[166:169]
s_nop 0
v_cvt_pk_bf16_f32 v76, v158, v159
v_cvt_pk_bf16_f32 v77, v160, v161
v_mfma_f32_16x16x32_bf16 v[170:173], v[186:189], a[140:143], v[170:173]
s_waitcnt lgkmcnt(0)
ds_read_b128 v[186:189], v210 offset:7168
v_cvt_pk_bf16_f32 v114, v162, v163
v_mfma_f32_16x16x32_bf16 v[138:141], a[0:3], v[182:185], 0
v_cvt_pk_bf16_f32 v115, v164, v165
v_cvt_pk_bf16_f32 v122, v166, v167
v_mfma_f32_16x16x32_bf16 v[142:145], a[24:27], v[182:185], 0
v_cvt_pk_bf16_f32 v123, v168, v169
v_cvt_pk_bf16_f32 v130, v170, v171
v_mfma_f32_16x16x32_bf16 v[146:149], a[48:51], v[182:185], 0
v_cvt_pk_bf16_f32 v131, v172, v173
v_add_f32_e64 v134, v134, v135
v_mfma_f32_16x16x32_bf16 v[150:153], a[216:219], v[182:185], 0
v_permlane16_swap_b32 v126, v127
v_mfma_f32_16x16x32_bf16 v[154:157], a[240:243], v[182:185], 0
v_add_f32 v118, v118, v119
v_mov_b32_e64 v135, v134
v_mfma_f32_16x16x32_bf16 v[158:161], v[232:235], v[182:185], 0
v_add_f32 v126, v126, v127
v_permlane32_swap_b32 v134, v135
v_mfma_f32_16x16x32_bf16 v[162:165], v[182:185], a[72:75], 0
buffer_store_dwordx2 v[132:133], v205, s[8:11], s39 offen offset:64
v_permlane32_swap_b32 v118, v126
v_mfma_f32_16x16x32_bf16 v[166:169], v[182:185], a[96:99], 0
s_mov_b32 s39, s37
v_add_f32_e64 v134, v134, v135
v_add_f32 v118, v118, v126
v_mfma_f32_16x16x32_bf16 v[170:173], v[182:185], a[120:123], 0
s_waitcnt lgkmcnt(0)
ds_read_b128 v[182:185], v210 offset:8192
ds_write_b32 v209, v134 offset:512
v_mfma_f32_16x16x32_bf16 v[138:141], a[4:7], v[186:189], v[138:141]
ds_write_b32 v209, v118
v_mfma_f32_16x16x32_bf16 v[142:145], a[28:31], v[186:189], v[142:145]
v_mfma_f32_16x16x32_bf16 v[146:149], a[52:55], v[186:189], v[146:149]
v_mfma_f32_16x16x32_bf16 v[150:153], a[220:223], v[186:189], v[150:153]
v_mfma_f32_16x16x32_bf16 v[154:157], a[244:247], v[186:189], v[154:157]
v_mfma_f32_16x16x32_bf16 v[158:161], v[236:239], v[186:189], v[158:161]
v_mfma_f32_16x16x32_bf16 v[162:165], v[186:189], a[76:79], v[162:165]
s_waitcnt lgkmcnt(0)
s_barrier
v_mfma_f32_16x16x32_bf16 v[166:169], v[186:189], a[100:103], v[166:169]
ds_read_b128 v[102:105], v210 offset:18432
ds_read_b128 v[106:109], v210 offset:19456
v_mfma_f32_16x16x32_bf16 v[170:173], v[186:189], a[124:127], v[170:173]
ds_read_b128 v[186:189], v210 offset:9216
v_mfma_f32_16x16x32_bf16 v[138:141], a[8:11], v[182:185], v[138:141]
v_mfma_f32_16x16x32_bf16 v[142:145], a[32:35], v[182:185], v[142:145]
v_mfma_f32_16x16x32_bf16 v[146:149], a[56:59], v[182:185], v[146:149]
v_mfma_f32_16x16x32_bf16 v[150:153], a[224:227], v[182:185], v[150:153]
buffer_load_dwordx4 v180, s[4:7], s52 offen nt lds
v_mfma_f32_16x16x32_bf16 v[154:157], a[248:251], v[182:185], v[154:157]
s_waitcnt lgkmcnt(2)
v_add_f32 v102, v102, v103
v_add_f32_e64 v104, v104, v105
v_mfma_f32_16x16x32_bf16 v[158:161], v[240:243], v[182:185], v[158:161]
s_waitcnt lgkmcnt(1)
v_add_f32 v106, v106, v107
v_add_f32_e64 v108, v108, v109
v_mfma_f32_16x16x32_bf16 v[162:165], v[182:185], a[80:83], v[162:165]
s_waitcnt lgkmcnt(0)
v_add_f32 v102, v102, v104
v_add_f32_e64 v106, v106, v108
v_mfma_f32_16x16x32_bf16 v[166:169], v[182:185], a[104:107], v[166:169]
s_add_u32 m0, s45, 4112
ds_read_b128 v[108:111], v215 offset:512
v_mul_f32_e64 v103, s48, v102
v_mfma_f32_16x16x32_bf16 v[170:173], v[182:185], a[128:131], v[170:173]
s_add_u32 s40, s36, 196224
ds_read_b128 v[182:185], v210 offset:10240
v_mul_f32_e64 v104, s73, v102
v_mfma_f32_16x16x32_bf16 v[138:141], a[12:15], v[186:189], v[138:141]
v_mul_f32_e64 v106, s73, v106
v_fma_f32 v106, -v103, v104, v106
v_mfma_f32_16x16x32_bf16 v[142:145], a[36:39], v[186:189], v[142:145]
v_max_f32 v106, 0, v106
v_add_f32 v106, s49, v106
v_mfma_f32_16x16x32_bf16 v[146:149], a[60:63], v[186:189], v[146:149]
v_rsq_f32_e64 v102, v106
v_mfma_f32_16x16x32_bf16 v[150:153], a[228:231], v[186:189], v[150:153]
v_mul_f32_e64 v103, -v103, v102
v_mfma_f32_16x16x32_bf16 v[154:157], a[252:255], v[186:189], v[154:157]
buffer_load_dwordx4 v180, s[4:7], s40 offen nt lds
v_mfma_f32_16x16x32_bf16 v[158:161], v[244:247], v[186:189], v[158:161]
ds_write_b64 v211, v[102:103] offset:20480
v_mfma_f32_16x16x32_bf16 v[162:165], v[186:189], a[84:87], v[162:165]
s_add_u32 m0, s45, 8224
s_add_u32 s40, s36, 392448
v_mfma_f32_16x16x32_bf16 v[166:169], v[186:189], a[108:111], v[166:169]
s_nop 0
ds_read_b64 v[118:119], v219 offset:20480
ds_read_b64 v[126:127], v219 offset:20736
v_mfma_f32_16x16x32_bf16 v[170:173], v[186:189], a[132:135], v[170:173]
s_waitcnt lgkmcnt(3)
ds_read_b128 v[186:189], v210 offset:11264
ds_read_b64 v[134:135], v219 offset:20992
v_mfma_f32_16x16x32_bf16 v[138:141], a[16:19], v[182:185], v[138:141]
v_mfma_f32_16x16x32_bf16 v[142:145], a[40:43], v[182:185], v[142:145]
v_mfma_f32_16x16x32_bf16 v[146:149], a[64:67], v[182:185], v[146:149]
s_nop 0
v_mfma_f32_16x16x32_bf16 v[150:153], a[232:235], v[182:185], v[150:153]
s_waitcnt lgkmcnt(3)
v_fma_f32 v220, v36, v118, v119
v_fma_f32 v221, v37, v118, v119
v_mfma_f32_16x16x32_bf16 v[154:157], v[224:227], v[182:185], v[154:157]
v_fma_f32 v222, v38, v118, v119
v_fma_f32 v223, v39, v118, v119
v_mfma_f32_16x16x32_bf16 v[158:161], v[248:251], v[182:185], v[158:161]
buffer_load_dwordx4 v180, s[4:7], s40 offen nt lds
v_mfma_f32_16x16x32_bf16 v[162:165], v[182:185], a[88:91], v[162:165]
s_add_u32 m0, s45, 12336
v_cvt_pk_bf16_f32 v90, v220, v221
v_cvt_pk_bf16_f32 v91, v222, v223
v_mfma_f32_16x16x32_bf16 v[166:169], v[182:185], a[112:115], v[166:169]
s_add_u32 s40, s36, 588672
v_fma_f32 v220, v40, v118, v119
v_fma_f32 v221, v41, v118, v119
v_mfma_f32_16x16x32_bf16 v[170:173], v[182:185], a[136:139], v[170:173]
s_waitcnt lgkmcnt(1)
ds_read_b128 v[182:185], v210 offset:12288
v_fma_f32 v222, v42, v118, v119
v_mfma_f32_16x16x32_bf16 v[138:141], a[20:23], v[186:189], v[138:141]
s_nop 0
v_fma_f32 v223, v43, v118, v119
v_cvt_pk_bf16_f32 v92, v220, v221
v_mfma_f32_16x16x32_bf16 v[142:145], a[44:47], v[186:189], v[142:145]
v_cvt_pk_bf16_f32 v93, v222, v223
v_fma_f32 v220, v44, v118, v119
v_mfma_f32_16x16x32_bf16 v[146:149], a[68:71], v[186:189], v[146:149]
ds_write_b128 v211, v[90:93] offset:20480
v_mfma_f32_16x16x32_bf16 v[150:153], a[236:239], v[186:189], v[150:153]
v_cvt_pk_bf16_f32 v96, v138, v139
v_cvt_pk_bf16_f32 v97, v140, v141
v_mfma_f32_16x16x32_bf16 v[154:157], v[228:231], v[186:189], v[154:157]
v_cvt_pk_bf16_f32 v98, v142, v143
v_cvt_pk_bf16_f32 v99, v144, v145
v_mfma_f32_16x16x32_bf16 v[158:161], v[252:255], v[186:189], v[158:161]
buffer_load_dwordx4 v180, s[4:7], s40 offen nt lds
v_mfma_f32_16x16x32_bf16 v[162:165], v[186:189], a[92:95], v[162:165]
s_add_u32 m0, s45, 16448
v_cvt_pk_bf16_f32 v100, v146, v147
v_cvt_pk_bf16_f32 v101, v148, v149
v_mfma_f32_16x16x32_bf16 v[166:169], v[186:189], a[116:119], v[166:169]
s_add_u32 s40, s36, 784896
v_cvt_pk_bf16_f32 v88, v158, v159
v_cvt_pk_bf16_f32 v89, v160, v161
v_mfma_f32_16x16x32_bf16 v[170:173], v[186:189], a[140:143], v[170:173]
s_waitcnt lgkmcnt(1)
ds_read_b128 v[186:189], v210 offset:13312
v_cvt_pk_bf16_f32 v86, v154, v155
v_mfma_f32_16x16x32_bf16 v[138:141], a[0:3], v[182:185], 0
s_nop 0
v_cvt_pk_bf16_f32 v87, v156, v157
v_cvt_pk_bf16_f32 v124, v166, v167
v_mfma_f32_16x16x32_bf16 v[142:145], a[24:27], v[182:185], 0
v_cvt_pk_bf16_f32 v125, v168, v169
v_cvt_pk_bf16_f32 v84, v150, v151
v_mfma_f32_16x16x32_bf16 v[146:149], a[48:51], v[182:185], 0
ds_read_b128 v[182:185], v210 offset:14336
v_cvt_pk_bf16_f32 v85, v152, v153
v_cvt_pk_bf16_f32 v116, v162, v163
v_mfma_f32_16x16x16_bf16 v[154:157], v[82:83], v[88:89], 0
v_cvt_pk_bf16_f32 v117, v164, v165
v_fma_f32 v221, v45, v118, v119
v_fma_f32 v222, v46, v118, v119
v_mfma_f32_16x16x16_bf16 v[158:161], v[100:101], v[88:89], 0
v_fma_f32 v223, v47, v118, v119
v_cvt_pk_bf16_f32 v94, v220, v221
v_cvt_pk_bf16_f32 v95, v222, v223
v_fma_f32 v220, v48, v126, v127
s_waitcnt lgkmcnt(1)
v_mfma_f32_16x16x32_bf16 v[138:141], a[4:7], v[186:189], v[138:141]
buffer_load_dwordx4 v180, s[4:7], s40 offen nt lds
v_mfma_f32_16x16x32_bf16 v[142:145], a[28:31], v[186:189], v[142:145]
s_add_u32 m0, s45, 20560
ds_write_b64 v212, v[94:95] offset:20480
v_mfma_f32_16x16x32_bf16 v[146:149], a[52:55], v[186:189], v[146:149]
s_waitcnt lgkmcnt(1)
v_fma_f32 v221, v49, v126, v127
v_fma_f32 v222, v50, v126, v127
v_mfma_f32_16x16x32_bf16 v[138:141], a[8:11], v[182:185], v[138:141]
s_add_u32 s40, s36, 981120
ds_read_b128 v[186:189], v210 offset:15360
v_fma_f32 v223, v51, v126, v127
v_mfma_f32_16x16x32_bf16 v[142:145], a[32:35], v[182:185], v[142:145]
v_cvt_pk_bf16_f32 v174, v220, v221
v_cvt_pk_bf16_f32 v175, v222, v223
v_mfma_f32_16x16x32_bf16 v[146:149], a[56:59], v[182:185], v[146:149]
ds_read_b128 v[182:185], v210 offset:16384
v_fma_f32 v220, v52, v126, v127
v_fma_f32 v221, v53, v126, v127
v_mfma_f32_16x16x16_bf16 v[166:169], v[112:113], v[88:89], v[206:209]
v_fma_f32 v222, v54, v126, v127
v_fma_f32 v223, v55, v126, v127
v_cvt_pk_bf16_f32 v176, v220, v221
v_mfma_f32_16x16x16_bf16 v[150:153], v[112:113], v[76:77], v[206:209]
v_cvt_pk_bf16_f32 v177, v222, v223
v_fma_f32 v220, v56, v126, v127
v_fma_f32 v221, v57, v126, v127
v_fma_f32 v222, v58, v126, v127
v_mfma_f32_16x16x32_bf16 v[154:157], v[78:81], v[84:87], v[154:157]
s_waitcnt lgkmcnt(1)
ds_write_b128 v211, v[174:177] offset:26624
v_mfma_f32_16x16x32_bf16 v[138:141], a[12:15], v[186:189], v[138:141]
s_waitcnt lgkmcnt(1)
buffer_load_dwordx4 v180, s[4:7], s40 offen nt lds
v_mfma_f32_16x16x32_bf16 v[142:145], a[36:39], v[186:189], v[142:145]
s_add_u32 m0, s45, 24672
v_fma_f32 v223, v59, v126, v127
v_cvt_pk_bf16_f32 v178, v220, v221
v_mfma_f32_16x16x32_bf16 v[146:149], a[60:63], v[186:189], v[146:149]
s_add_u32 s40, s36, 1177344
ds_read_b128 v[186:189], v210 offset:17408
v_cvt_pk_bf16_f32 v179, v222, v223
v_mfma_f32_16x16x32_bf16 v[138:141], a[16:19], v[182:185], v[138:141]
ds_write_b64 v212, v[178:179] offset:26624
v_mfma_f32_16x16x32_bf16 v[142:145], a[40:43], v[182:185], v[142:145]
v_fma_f32 v220, v60, v134, v135
v_fma_f32 v221, v61, v134, v135
v_mfma_f32_16x16x32_bf16 v[150:153], v[108:111], v[72:75], v[150:153]
v_fma_f32 v222, v62, v134, v135
v_fma_f32 v223, v63, v134, v135
v_mfma_f32_16x16x32_bf16 v[146:149], a[64:67], v[182:185], v[146:149]
s_nop 0
ds_read_b128 v[182:185], v210 offset:12288
v_cvt_pk_bf16_f32 v90, v220, v221
v_mfma_f32_16x16x32_bf16 v[158:161], v[96:99], v[84:87], v[158:161]
s_waitcnt lgkmcnt(2)
v_cvt_pk_bf16_f32 v91, v222, v223
v_fma_f32 v220, v64, v134, v135
v_mfma_f32_16x16x32_bf16 v[138:141], a[20:23], v[186:189], v[138:141]
v_fma_f32 v221, v65, v134, v135
v_fma_f32 v222, v66, v134, v135
v_mfma_f32_16x16x32_bf16 v[142:145], a[44:47], v[186:189], v[142:145]
buffer_load_dwordx4 v180, s[4:7], s40 offen nt lds
v_mfma_f32_16x16x32_bf16 v[146:149], a[68:71], v[186:189], v[146:149]
s_add_u32 m0, s45, 28784
ds_read_b128 v[186:189], v210 offset:13312
v_cvt_pk_bf16_f32 v102, v138, v139
v_mfma_f32_16x16x32_bf16 v[166:169], v[108:111], v[84:87], v[166:169]
s_add_u32 s40, s36, 1373568
v_cvt_pk_bf16_f32 v103, v140, v141
v_cvt_pk_bf16_f32 v104, v142, v143
v_cvt_pk_bf16_f32 v105, v144, v145
v_mfma_f32_16x16x16_bf16 v[138:141], v[82:83], v[76:77], 0
v_cvt_pk_bf16_f32 v106, v146, v147
v_cvt_pk_bf16_f32 v107, v148, v149
v_fma_f32 v223, v67, v134, v135
v_mfma_f32_16x16x16_bf16 v[142:145], v[100:101], v[76:77], 0
v_cvt_pk_bf16_f32 v92, v220, v221
v_cvt_pk_bf16_f32 v93, v222, v223
v_fma_f32 v220, v68, v134, v135
v_mfma_f32_16x16x16_bf16 v[162:165], v[106:107], v[88:89], 0
v_fma_f32 v221, v69, v134, v135
v_fma_f32 v222, v70, v134, v135
v_fma_f32 v223, v71, v134, v135
v_mfma_f32_16x16x16_bf16 v[146:149], v[106:107], v[76:77], 0
v_cvt_pk_bf16_f32 v132, v170, v171
v_cvt_pk_bf16_f32 v133, v172, v173
v_cvt_pk_bf16_f32 v94, v220, v221
v_cvt_pk_bf16_f32 v95, v222, v223
v_mfma_f32_16x16x32_bf16 v[138:141], v[78:81], v[72:75], v[138:141]
ds_write_b128 v211, v[90:93] offset:32768
v_mfma_f32_16x16x32_bf16 v[142:145], v[96:99], v[72:75], v[142:145]
s_waitcnt lgkmcnt(2)
v_exp_f32 v138, v138
v_mfma_f32_16x16x32_bf16 v[118:121], v[182:185], a[72:75], 0
buffer_load_dwordx4 v180, s[4:7], s40 offen nt lds
v_mfma_f32_16x16x32_bf16 v[126:129], v[182:185], a[96:99], 0
s_add_u32 m0, s45, 32896
ds_write_b64 v212, v[94:95] offset:32768
v_mfma_f32_16x16x32_bf16 v[134:137], v[182:185], a[120:123], 0
s_add_u32 s40, s36, 1569792
v_exp_f32_e64 v139, v139
v_mfma_f32_16x16x32_bf16 v[146:149], v[102:105], v[72:75], v[146:149]
s_add_u32 s41, s41, 127056
ds_read_b64 v[76:77], v215 offset:16
v_cvt_pk_bf16_f32 v174, v138, v139
v_mfma_f32_16x16x32_bf16 v[90:93], a[216:219], v[182:185], 0
v_exp_f32_e64 v140, v140
v_mfma_f32_16x16x32_bf16 v[170:173], a[240:243], v[182:185], 0
v_exp_f32 v141, v141
v_mfma_f32_16x16x32_bf16 v[220:223], v[232:235], v[182:185], 0
s_waitcnt lgkmcnt(3)
ds_read_b128 v[182:185], v210 offset:14336
v_cvt_pk_bf16_f32 v175, v140, v141
v_mfma_f32_16x16x32_bf16 v[118:121], v[186:189], a[76:79], v[118:121]
v_exp_f32 v142, v142
v_mfma_f32_16x16x32_bf16 v[126:129], v[186:189], a[100:103], v[126:129]
v_exp_f32 v143, v143
v_mfma_f32_16x16x32_bf16 v[134:137], v[186:189], a[124:127], v[134:137]
v_exp_f32_e64 v144, v144
v_mfma_f32_16x16x32_bf16 v[90:93], a[220:223], v[186:189], v[90:93]
buffer_load_dwordx4 v180, s[4:7], s40 offen nt lds
v_mfma_f32_16x16x32_bf16 v[170:173], a[244:247], v[186:189], v[170:173]
v_exp_f32 v145, v145
v_mfma_f32_16x16x32_bf16 v[220:223], v[236:239], v[186:189], v[220:223]
s_waitcnt lgkmcnt(0)
ds_read_b128 v[186:189], v210 offset:15360
v_cvt_pk_bf16_f32 v176, v142, v143
v_mfma_f32_16x16x32_bf16 v[118:121], v[182:185], a[80:83], v[118:121]
v_exp_f32_e64 v150, v150
v_mfma_f32_16x16x32_bf16 v[126:129], v[182:185], a[104:107], v[126:129]
v_cvt_pk_bf16_f32 v177, v144, v145
v_cvt_pk_bf16_f32 v180, v150, 0
v_mfma_f32_16x16x32_bf16 v[134:137], v[182:185], a[128:131], v[134:137]
v_exp_f32 v154, v154
v_mfma_f32_16x16x32_bf16 v[90:93], a[224:227], v[182:185], v[90:93]
v_exp_f32 v155, v155
v_mfma_f32_16x16x32_bf16 v[162:165], v[102:105], v[84:87], v[162:165]
v_exp_f32_e64 v156, v156
v_mfma_f32_16x16x32_bf16 v[170:173], a[248:251], v[182:185], v[170:173]
v_exp_f32 v157, v157
v_mfma_f32_16x16x32_bf16 v[220:223], v[240:243], v[182:185], v[220:223]
s_waitcnt lgkmcnt(0)
ds_read_b128 v[182:185], v210 offset:16384
ds_read_b128 v[72:75], v215
v_mfma_f32_16x16x32_bf16 v[118:121], v[186:189], a[84:87], v[118:121]
v_exp_f32 v158, v158
v_mfma_f32_16x16x32_bf16 v[126:129], v[186:189], a[108:111], v[126:129]
v_exp_f32 v159, v159
v_mfma_f32_16x16x32_bf16 v[134:137], v[186:189], a[132:135], v[134:137]
v_exp_f32 v160, v160
v_mfma_f32_16x16x32_bf16 v[90:93], a[228:231], v[186:189], v[90:93]
v_exp_f32 v161, v161
v_mfma_f32_16x16x32_bf16 v[170:173], a[252:255], v[186:189], v[170:173]
v_exp_f32 v166, v166
v_mfma_f32_16x16x32_bf16 v[220:223], v[244:247], v[186:189], v[220:223]
s_waitcnt lgkmcnt(1)
ds_read_b128 v[186:189], v210 offset:17408
v_exp_f32 v146, v146
v_mfma_f32_16x16x32_bf16 v[118:121], v[182:185], a[88:91], v[118:121]
v_exp_f32 v147, v147
v_mfma_f32_16x16x32_bf16 v[126:129], v[182:185], a[112:115], v[126:129]
v_exp_f32 v148, v148
v_mfma_f32_16x16x32_bf16 v[134:137], v[182:185], a[136:139], v[134:137]
v_exp_f32 v149, v149
v_mfma_f32_16x16x32_bf16 v[90:93], a[232:235], v[182:185], v[90:93]
v_exp_f32 v162, v162
v_mfma_f32_16x16x32_bf16 v[170:173], v[224:227], v[182:185], v[170:173]
v_exp_f32 v163, v163
v_mfma_f32_16x16x32_bf16 v[220:223], v[248:251], v[182:185], v[220:223]
s_waitcnt lgkmcnt(0)
v_exp_f32 v164, v164
v_mfma_f32_16x16x32_bf16 v[118:121], v[186:189], a[92:95], v[118:121]
v_exp_f32_e64 v165, v165
v_mfma_f32_16x16x32_bf16 v[126:129], v[186:189], a[116:119], v[126:129]
v_cvt_pk_bf16_f32 v178, v146, v147
v_cvt_pk_bf16_f32 v179, v148, v149
v_mfma_f32_16x16x32_bf16 v[134:137], v[186:189], a[140:143], v[134:137]
v_cvt_pk_bf16_f32 v118, v118, v119
v_cvt_pk_bf16_f32 v119, v120, v121
v_mfma_f32_16x16x32_bf16 v[90:93], a[236:239], v[186:189], v[90:93]
ds_read_u16 v120, v214 offset:1024
v_cvt_pk_bf16_f32 v126, v126, v127
v_mfma_f32_16x16x32_bf16 v[170:173], v[228:231], v[186:189], v[170:173]
v_cvt_pk_bf16_f32 v127, v128, v129
v_cvt_pk_bf16_f32 v134, v134, v135
v_mfma_f32_16x16x32_bf16 v[220:223], v[252:255], v[186:189], v[220:223]
ds_read_u16 v128, v214 offset:1032
v_cvt_pk_bf16_f32 v90, v90, v91
v_mfma_f32_16x16x32_bf16 v[150:153], v[190:193], v[174:177], 0
v_cvt_pk_bf16_f32 v91, v92, v93
v_cvt_pk_bf16_f32 v92, v170, v171
v_mfma_f32_16x16x32_bf16 v[138:141], v[114:117], v[174:177], 0
v_cvt_pk_bf16_f32 v93, v172, v173
v_cvt_pk_bf16_f32 v135, v136, v137
v_mfma_f32_16x16x32_bf16 v[142:145], v[122:125], v[174:177], 0
ds_read_u16 v136, v214 offset:1040
v_mov_b32 v121, 0
v_mfma_f32_16x16x32_bf16 v[146:149], v[130:133], v[174:177], 0
v_cvt_pk_bf16_f32 v174, v154, v155
v_cvt_pk_bf16_f32 v175, v156, v157
v_mfma_f32_16x16x32_bf16 v[150:153], v[190:193], v[178:181], v[150:153]
s_waitcnt lgkmcnt(2)
v_cvt_pk_bf16_f32 v176, v158, v159
v_cvt_pk_bf16_f32 v177, v160, v161
v_mfma_f32_16x16x32_bf16 v[138:141], v[118:121], v[178:181], v[138:141]
v_mov_b32 v129, 0
v_mov_b32 v137, 0
v_mfma_f32_16x16x32_bf16 v[154:157], v[114:117], v[174:177], 0
v_rcp_f32 v151, v150
v_mfma_f32_16x16x32_bf16 v[158:161], v[122:125], v[174:177], 0
s_waitcnt lgkmcnt(1)
v_max3_u32 v218, v218, v150, v151
v_mul_f32_e64 v151, s3, v151
v_mfma_f32_16x16x32_bf16 v[142:145], v[126:129], v[178:181], v[142:145]
s_waitcnt lgkmcnt(0)
v_mul_f32 v138, v138, v151
v_mul_f32_e64 v139, v139, v151
v_mfma_f32_16x16x32_bf16 v[146:149], v[134:137], v[178:181], v[146:149]
v_cvt_pk_bf16_f32 v180, v166, 0
v_mul_f32_e64 v140, v140, v151
v_mfma_f32_16x16x32_bf16 v[166:169], v[190:193], v[174:177], 0
v_mul_f32_e64 v141, v141, v151
v_cvt_pk_bf16_f32 v138, v138, v139
v_mul_f32 v142, v142, v151
v_mul_f32 v143, v143, v151
v_mul_f32 v144, v144, v151
v_mul_f32 v145, v145, v151
v_cvt_pk_bf16_f32 v139, v140, v141
v_cvt_pk_bf16_f32 v140, v142, v143
v_cvt_pk_bf16_f32 v141, v144, v145
v_cvt_pk_bf16_f32 v178, v162, v163
v_cvt_pk_bf16_f32 v179, v164, v165
v_mfma_f32_16x16x32_bf16 v[162:165], v[130:133], v[174:177], 0
ds_write_b128 v211, v[138:141] offset:38912
v_mfma_f32_16x16x32_bf16 v[138:141], v[78:81], v[90:93], 0
v_mul_f32 v146, v146, v151
v_mul_f32 v147, v147, v151
v_mfma_f32_16x16x32_bf16 v[166:169], v[190:193], v[178:181], v[166:169]
v_mul_f32 v148, v148, v151
v_mul_f32 v149, v149, v151
v_mfma_f32_16x16x32_bf16 v[154:157], v[118:121], v[178:181], v[154:157]
v_cvt_pk_bf16_f32 v142, v146, v147
v_cvt_pk_bf16_f32 v143, v148, v149
v_mfma_f32_16x16x32_bf16 v[158:161], v[126:129], v[178:181], v[158:161]
ds_write_b64 v212, v[142:143] offset:38912
v_mfma_f32_16x16x32_bf16 v[142:145], v[96:99], v[90:93], 0
v_rcp_f32_e64 v167, v166
v_mfma_f32_16x16x32_bf16 v[162:165], v[134:137], v[178:181], v[162:165]
v_max3_u32 v218, v218, v166, v167
v_cvt_pk_bf16_f32 v94, v220, v221
v_mfma_f32_16x16x32_bf16 v[150:153], v[108:111], v[90:93], v[206:209]
v_cvt_pk_bf16_f32 v95, v222, v223
v_mul_f32_e64 v167, s3, v167
v_mfma_f32_16x16x32_bf16 v[146:149], v[102:105], v[90:93], 0
v_mul_f32 v154, v154, v167
v_mul_f32 v155, v155, v167
v_mul_f32_e64 v156, v156, v167
v_mfma_f32_16x16x16_bf16 v[138:141], v[82:83], v[94:95], v[138:141]
v_mul_f32_e64 v157, v157, v167
v_cvt_pk_bf16_f32 v154, v154, v155
v_mul_f32_e64 v158, v158, v167
v_mfma_f32_16x16x16_bf16 v[142:145], v[100:101], v[94:95], v[142:145]
v_mul_f32 v159, v159, v167
v_mul_f32 v160, v160, v167
v_mul_f32_e64 v161, v161, v167
v_mfma_f32_16x16x16_bf16 v[150:153], v[112:113], v[94:95], v[150:153]
v_cvt_pk_bf16_f32 v155, v156, v157
v_cvt_pk_bf16_f32 v156, v158, v159
v_cvt_pk_bf16_f32 v157, v160, v161
v_mfma_f32_16x16x16_bf16 v[146:149], v[106:107], v[94:95], v[146:149]
v_mul_f32 v162, v162, v167
v_mul_f32 v163, v163, v167
v_mul_f32 v164, v164, v167
v_mul_f32 v165, v165, v167
v_mfma_f32_16x16x16_bf16 v[166:169], v[76:77], v[112:113], v[206:209]
v_cvt_pk_bf16_f32 v158, v162, v163
v_cvt_pk_bf16_f32 v159, v164, v165
v_exp_f32 v138, v138
v_mfma_f32_16x16x16_bf16 v[162:165], v[76:77], v[106:107], 0
v_exp_f32 v139, v139
v_exp_f32 v140, v140
v_mfma_f32_16x16x32_bf16 v[166:169], v[72:75], v[108:111], v[166:169]
ds_write_b128 v211, v[154:157] offset:45056
v_mfma_f32_16x16x16_bf16 v[154:157], v[76:77], v[82:83], 0
v_exp_f32 v141, v141
v_exp_f32 v142, v142
v_mfma_f32_16x16x32_bf16 v[162:165], v[72:75], v[102:105], v[162:165]
v_exp_f32 v143, v143
v_mfma_f32_16x16x32_bf16 v[154:157], v[72:75], v[78:81], v[154:157]
ds_write_b64 v212, v[158:159] offset:45056
v_mfma_f32_16x16x16_bf16 v[158:161], v[76:77], v[100:101], 0
v_exp_f32 v144, v144
v_exp_f32 v145, v145
v_exp_f32_e64 v150, v150
v_mfma_f32_16x16x32_bf16 v[158:161], v[72:75], v[96:99], v[158:161]
v_cvt_pk_bf16_f32 v174, v138, v139
v_cvt_pk_bf16_f32 v175, v140, v141
v_cvt_pk_bf16_f32 v176, v142, v143
v_cvt_pk_bf16_f32 v177, v144, v145
v_cvt_pk_bf16_f32 v180, v150, 0
v_exp_f32_e64 v146, v146
v_mfma_f32_16x16x32_bf16 v[150:153], v[190:193], v[174:177], 0
v_exp_f32 v147, v147
v_mfma_f32_16x16x32_bf16 v[138:141], v[114:117], v[174:177], 0
s_waitcnt lgkmcnt(0)
v_exp_f32 v148, v148
v_mfma_f32_16x16x32_bf16 v[142:145], v[122:125], v[174:177], 0
s_barrier
ds_read_b128 v[170:173], v210 offset:38912
ds_read_b128 v[182:185], v210 offset:39936
ds_read_b128 v[186:189], v210 offset:40960
v_exp_f32_e64 v149, v149
v_cvt_pk_bf16_f32 v178, v146, v147
v_cvt_pk_bf16_f32 v179, v148, v149
v_mfma_f32_16x16x32_bf16 v[146:149], v[130:133], v[174:177], 0
v_mov_b32_dpp v154, v158 quad_perm:[0,1,2,3] row_mask:0x2 bank_mask:0xf
v_mfma_f32_16x16x32_bf16 v[150:153], v[190:193], v[178:181], v[150:153]
v_mov_b32_dpp v154, v162 quad_perm:[0,1,2,3] row_mask:0x4 bank_mask:0xf
v_mfma_f32_16x16x32_bf16 v[138:141], v[118:121], v[178:181], v[138:141]
v_mov_b32_dpp v154, v167 quad_perm:[0,1,2,3] row_mask:0x8 bank_mask:0xf
v_exp_f32_e64 v154, v154
v_mfma_f32_16x16x32_bf16 v[142:145], v[126:129], v[178:181], v[142:145]
v_cvt_pk_bf16_f32 v154, v154, 0
v_rcp_f32 v151, v150
v_mfma_f32_16x16x32_bf16 v[146:149], v[134:137], v[178:181], v[146:149]
s_waitcnt lgkmcnt(2)
ds_write_b16 v214, v154
v_mfma_f32_16x16x32_bf16 v[0:3], a[144:147], v[170:173], v[0:3]
ds_read_b128 v[84:87], v215
ds_read_b128 v[88:91], v215 offset:16
v_mfma_f32_16x16x32_bf16 v[4:7], a[168:171], v[170:173], v[4:7]
s_nop 0
ds_read_b128 v[174:177], v217
ds_read_b128 v[178:181], v217 offset:528
v_mfma_f32_16x16x32_bf16 v[8:11], a[192:195], v[170:173], v[8:11]
s_waitcnt lgkmcnt(6)
ds_read_b128 v[170:173], v210 offset:41984
v_add_u32 v215, 1552, v215
v_mfma_f32_16x16x32_bf16 v[0:3], a[148:151], v[182:185], v[0:3]
ds_read_b64 v[112:113], v215 offset:528
v_mfma_f32_16x16x32_bf16 v[4:7], a[172:175], v[182:185], v[4:7]
v_mfma_f32_16x16x32_bf16 v[8:11], a[196:199], v[182:185], v[8:11]
s_nop 0
ds_read_b128 v[182:185], v210 offset:43008
s_waitcnt lgkmcnt(6)
v_mfma_f32_16x16x32_bf16 v[166:169], v[84:87], v[190:193], 0
v_mfma_f32_16x16x32_bf16 v[154:157], v[84:87], v[114:117], 0
v_mfma_f32_16x16x32_bf16 v[158:161], v[84:87], v[122:125], 0
v_mfma_f32_16x16x32_bf16 v[162:165], v[84:87], v[130:133], 0
s_waitcnt lgkmcnt(5)
v_mfma_f32_16x16x32_bf16 v[166:169], v[88:91], v[190:193], v[166:169]
v_mfma_f32_16x16x32_bf16 v[154:157], v[88:91], v[118:121], v[154:157]
v_mfma_f32_16x16x32_bf16 v[158:161], v[88:91], v[126:129], v[158:161]
v_rcp_f32 v167, v166
v_mfma_f32_16x16x32_bf16 v[162:165], v[88:91], v[134:137], v[162:165]
v_max3_u32 v218, v218, v166, v167
v_max3_u32 v218, v218, v150, v151
v_mfma_f32_16x16x32_bf16 v[0:3], a[152:155], v[186:189], v[0:3]
v_mul_f32 v151, s3, v151
v_mul_f32 v138, v138, v151
v_mfma_f32_16x16x32_bf16 v[4:7], a[176:179], v[186:189], v[4:7]
v_mul_f32_e64 v139, v139, v151
v_mul_f32 v140, v140, v151
v_mfma_f32_16x16x32_bf16 v[8:11], a[200:203], v[186:189], v[8:11]
s_waitcnt lgkmcnt(2)
ds_read_b128 v[186:189], v210 offset:44032
v_mul_f32_e64 v141, v141, v151
v_mfma_f32_16x16x32_bf16 v[0:3], a[156:159], v[170:173], v[0:3]
v_cvt_pk_bf16_f32 v138, v138, v139
v_mul_f32_e64 v142, v142, v151
v_mfma_f32_16x16x32_bf16 v[4:7], a[180:183], v[170:173], v[4:7]
v_mul_f32_e64 v143, v143, v151
v_mul_f32 v144, v144, v151
v_mfma_f32_16x16x32_bf16 v[8:11], a[204:207], v[170:173], v[8:11]
s_waitcnt lgkmcnt(1)
ds_read_b128 v[170:173], v210 offset:45056
v_mul_f32_e64 v145, v145, v151
v_mfma_f32_16x16x32_bf16 v[0:3], a[160:163], v[182:185], v[0:3]
v_cvt_pk_bf16_f32 v139, v140, v141
v_cvt_pk_bf16_f32 v140, v142, v143
v_mfma_f32_16x16x32_bf16 v[4:7], a[184:187], v[182:185], v[4:7]
v_cvt_pk_bf16_f32 v141, v144, v145
v_mul_f32 v146, v146, v151
v_mfma_f32_16x16x32_bf16 v[8:11], a[208:211], v[182:185], v[8:11]
s_waitcnt lgkmcnt(1)
ds_read_b128 v[182:185], v210 offset:46080
ds_write_b128 v211, v[138:141] offset:51200
v_mfma_f32_16x16x32_bf16 v[0:3], a[164:167], v[186:189], v[0:3]
v_mul_f32 v147, v147, v151
v_mul_f32 v148, v148, v151
v_mfma_f32_16x16x32_bf16 v[4:7], a[188:191], v[186:189], v[4:7]
v_mul_f32 v149, v149, v151
v_cvt_pk_bf16_f32 v142, v146, v147
v_mfma_f32_16x16x32_bf16 v[8:11], a[212:215], v[186:189], v[8:11]
s_waitcnt lgkmcnt(2)
ds_read_b128 v[186:189], v210 offset:47104
v_cvt_pk_bf16_f32 v143, v148, v149
v_mfma_f32_16x16x32_bf16 v[12:15], a[144:147], v[170:173], v[12:15]
ds_write_b64 v212, v[142:143] offset:51200
v_mfma_f32_16x16x32_bf16 v[16:19], a[168:171], v[170:173], v[16:19]
s_nop 0
v_cvt_pk_bf16_f32 v72, v0, v1
v_cvt_pk_bf16_f32 v73, v2, v3
v_mfma_f32_16x16x32_bf16 v[20:23], a[192:195], v[170:173], v[20:23]
s_waitcnt lgkmcnt(3)
ds_read_b128 v[170:173], v210 offset:48128
buffer_store_dwordx2 v[72:73], v203, s[8:11], s38 offen
v_cvt_pk_bf16_f32 v74, v4, v5
v_mfma_f32_16x16x32_bf16 v[12:15], a[148:151], v[182:185], v[12:15]
v_cvt_pk_bf16_f32 v75, v6, v7
v_mov_b32_dpp v154, v158 quad_perm:[0,1,2,3] row_mask:0x2 bank_mask:0xf
v_mfma_f32_16x16x32_bf16 v[16:19], a[172:175], v[182:185], v[16:19]
v_mul_f32 v167, s3, v167
v_mov_b32_dpp v154, v162 quad_perm:[0,1,2,3] row_mask:0x4 bank_mask:0xf
v_mfma_f32_16x16x32_bf16 v[20:23], a[196:199], v[182:185], v[20:23]
s_waitcnt lgkmcnt(2)
ds_read_b128 v[182:185], v210 offset:49152
v_mul_f32_e64 v154, v154, v167
v_mfma_f32_16x16x32_bf16 v[12:15], a[152:155], v[186:189], v[12:15]
v_cvt_pk_bf16_f32 v154, v154, 0
v_cvt_pk_bf16_f32 v76, v8, v9
v_mfma_f32_16x16x32_bf16 v[16:19], a[176:179], v[186:189], v[16:19]
s_waitcnt vmcnt(1) lgkmcnt(1)
ds_write_b16 v214, v154
v_mfma_f32_16x16x32_bf16 v[20:23], a[200:203], v[186:189], v[20:23]
s_barrier
v_mfma_f32_16x16x32_bf16 v[12:15], a[156:159], v[170:173], v[12:15]
ds_read_b128 v[186:189], v210 offset:50176
ds_read_b128 v[84:87], v200
v_mfma_f32_16x16x32_bf16 v[16:19], a[180:183], v[170:173], v[16:19]
s_nop 0
ds_read_b128 v[92:95], v201
ds_read_b128 v[100:103], v202
v_mfma_f32_16x16x32_bf16 v[20:23], a[204:207], v[170:173], v[20:23]
s_waitcnt lgkmcnt(5)
ds_read_b128 v[170:173], v210 offset:51200
ds_read_b128 v[88:91], v194 offset:16
v_mfma_f32_16x16x32_bf16 v[12:15], a[160:163], v[182:185], v[12:15]
ds_read_b128 v[96:99], v195 offset:16
v_cvt_pk_bf16_f32 v77, v10, v11
v_mfma_f32_16x16x32_bf16 v[16:19], a[184:187], v[182:185], v[16:19]
ds_read_b128 v[104:107], v196 offset:16
v_add_u32 v214, 1552, v214
v_mfma_f32_16x16x32_bf16 v[20:23], a[208:211], v[182:185], v[20:23]
s_nop 0
ds_read_b128 v[182:185], v210 offset:52224
buffer_store_dwordx2 v[74:75], v203, s[8:11], s38 offen offset:32
s_waitcnt lgkmcnt(8)
v_mfma_f32_16x16x32_bf16 v[12:15], a[164:167], v[186:189], v[12:15]
v_mfma_f32_16x16x32_bf16 v[16:19], a[188:191], v[186:189], v[16:19]
v_mfma_f32_16x16x32_bf16 v[20:23], a[212:215], v[186:189], v[20:23]
s_waitcnt lgkmcnt(7)
ds_read_b128 v[186:189], v210 offset:53248
v_cvt_pk_bf16_f32 v78, v12, v13
v_mfma_f32_16x16x32_bf16 v[0:3], v[174:177], v[84:87], 0
s_waitcnt lgkmcnt(5)
ds_read_b128 v[84:87], v194
v_cvt_pk_bf16_f32 v79, v14, v15
v_mfma_f32_16x16x32_bf16 v[24:27], a[144:147], v[170:173], v[24:27]
v_cvt_pk_bf16_f32 v80, v16, v17
v_cvt_pk_bf16_f32 v81, v18, v19
v_mfma_f32_16x16x32_bf16 v[28:31], a[168:171], v[170:173], v[28:31]
v_cvt_pk_bf16_f32 v82, v20, v21
v_cvt_pk_bf16_f32 v83, v22, v23
v_mfma_f32_16x16x32_bf16 v[32:35], a[192:195], v[170:173], v[32:35]
ds_read_b128 v[170:173], v210 offset:54272
v_mfma_f32_16x16x32_bf16 v[12:15], v[174:177], v[92:95], 0
ds_read_b128 v[92:95], v195
s_waitcnt lgkmcnt(4)
v_mfma_f32_16x16x32_bf16 v[24:27], a[148:151], v[182:185], v[24:27]
v_mfma_f32_16x16x32_bf16 v[28:31], a[172:175], v[182:185], v[28:31]
v_mfma_f32_16x16x32_bf16 v[32:35], a[196:199], v[182:185], v[32:35]
ds_read_b128 v[182:185], v210 offset:55296
s_waitcnt lgkmcnt(4)
v_mfma_f32_16x16x32_bf16 v[24:27], a[152:155], v[186:189], v[24:27]
v_mfma_f32_16x16x32_bf16 v[28:31], a[176:179], v[186:189], v[28:31]
v_mfma_f32_16x16x32_bf16 v[32:35], a[200:203], v[186:189], v[32:35]
s_nop 0
ds_read_b128 v[186:189], v210 offset:56320
s_waitcnt lgkmcnt(3)
v_mfma_f32_16x16x32_bf16 v[24:27], a[156:159], v[170:173], v[24:27]
buffer_store_dwordx2 v[76:77], v203, s[8:11], s38 offen offset:64
v_mfma_f32_16x16x32_bf16 v[28:31], a[180:183], v[170:173], v[28:31]
v_mfma_f32_16x16x32_bf16 v[32:35], a[204:207], v[170:173], v[32:35]
s_waitcnt lgkmcnt(1)
v_mfma_f32_16x16x32_bf16 v[24:27], a[160:163], v[182:185], v[24:27]
v_mfma_f32_16x16x32_bf16 v[28:31], a[184:187], v[182:185], v[28:31]
v_mfma_f32_16x16x32_bf16 v[32:35], a[208:211], v[182:185], v[32:35]
ds_read_b128 v[182:185], v210 offset:20480
s_waitcnt lgkmcnt(1)
v_mfma_f32_16x16x32_bf16 v[24:27], a[164:167], v[186:189], v[24:27]
v_smfmac_f32_16x16x64_bf16 v[0:3], v[178:181], v[84:91], v213
ds_read_b128 v[84:87], v197
ds_read_b128 v[88:91], v197 offset:16
v_mfma_f32_16x16x32_bf16 v[28:31], a[188:191], v[186:189], v[28:31]
v_cvt_pk_bf16_f32 v116, v24, v25
v_cvt_pk_bf16_f32 v117, v26, v27
v_mfma_f32_16x16x32_bf16 v[24:27], v[174:177], v[100:103], 0
ds_read_b128 v[100:103], v196
ds_read_b128 v[174:177], v217 offset:1056
v_mfma_f32_16x16x32_bf16 v[32:35], a[212:215], v[186:189], v[32:35]
s_nop 0
ds_read_b128 v[186:189], v210 offset:21504
v_cvt_pk_bf16_f32 v124, v28, v29
v_smfmac_f32_16x16x64_bf16 v[12:15], v[178:181], v[92:99], v213
s_waitcnt lgkmcnt(5)
ds_read_b128 v[92:95], v198
ds_read_b128 v[96:99], v198 offset:16
v_mfma_f32_16x16x32_bf16 v[138:141], a[0:3], v[182:185], 0
v_cvt_pk_bf16_f32 v125, v30, v31
v_cvt_pk_bf16_f32 v132, v32, v33
v_mfma_f32_16x16x32_bf16 v[142:145], a[24:27], v[182:185], 0
s_nop 0
v_cvt_pk_bf16_f32 v133, v34, v35
v_mfma_f32_16x16x32_bf16 v[146:149], a[48:51], v[182:185], 0
s_waitcnt lgkmcnt(4)
v_smfmac_f32_16x16x64_bf16 v[24:27], v[178:181], v[100:107], v213
ds_read_b128 v[100:103], v199
ds_read_b128 v[104:107], v199 offset:16
v_mfma_f32_16x16x32_bf16 v[150:153], a[216:219], v[182:185], 0
ds_read_b128 v[178:181], v217 offset:1584
buffer_store_dwordx2 v[78:79], v204, s[8:11], s38 offen
s_waitcnt lgkmcnt(6)
v_smfmac_f32_16x16x64_bf16 v[0:3], v[174:177], v[84:91], v213
ds_read_b128 v[84:87], v200 offset:32
ds_read_b128 v[88:91], v194 offset:48
v_mfma_f32_16x16x32_bf16 v[154:157], a[240:243], v[182:185], 0
s_waitcnt lgkmcnt(5)
v_smfmac_f32_16x16x64_bf16 v[12:15], v[174:177], v[92:99], v213
ds_read_b128 v[92:95], v201 offset:32
ds_read_b128 v[96:99], v195 offset:48
v_mfma_f32_16x16x32_bf16 v[158:161], v[232:235], v[182:185], 0
v_mul_f32 v119, v0, v0
v_add_f32 v118, v0, v1
v_mfma_f32_16x16x32_bf16 v[162:165], v[182:185], a[72:75], 0
s_waitcnt lgkmcnt(5)
v_mul_f32 v127, v12, v12
v_add_f32_e64 v126, v12, v13
v_smfmac_f32_16x16x64_bf16 v[24:27], v[174:177], v[100:107], v213
ds_read_b128 v[100:103], v202 offset:32
ds_read_b128 v[174:177], v217 offset:2112
v_mfma_f32_16x16x32_bf16 v[166:169], v[182:185], a[96:99], 0
s_waitcnt lgkmcnt(5)
ds_read_b128 v[104:107], v196 offset:48
v_fmac_f32 v119, v1, v1
v_mfma_f32_16x16x32_bf16 v[4:7], v[178:181], v[84:87], 0
ds_read_b128 v[84:87], v194 offset:32
v_mul_f32 v135, v24, v24
v_mfma_f32_16x16x32_bf16 v[170:173], v[182:185], a[120:123], 0
s_waitcnt lgkmcnt(5)
ds_read_b128 v[182:185], v210 offset:22528
v_add_f32_e64 v134, v24, v25
v_mfma_f32_16x16x32_bf16 v[16:19], v[178:181], v[92:95], 0
ds_read_b128 v[92:95], v195 offset:32
v_fmac_f32_e64 v135, v25, v25
v_mfma_f32_16x16x32_bf16 v[138:141], a[4:7], v[186:189], v[138:141]
v_fmac_f32 v127, v13, v13
v_add_f32 v134, v134, v26
v_mfma_f32_16x16x32_bf16 v[142:145], a[28:31], v[186:189], v[142:145]
s_waitcnt lgkmcnt(5)
v_fmac_f32 v135, v26, v26
v_add_f32_e64 v118, v118, v2
v_mfma_f32_16x16x32_bf16 v[28:31], v[178:181], v[100:103], 0
ds_read_b128 v[100:103], v196 offset:32
ds_read_b128 v[178:181], v217 offset:2640
v_mfma_f32_16x16x32_bf16 v[146:149], a[52:55], v[186:189], v[146:149]
v_add_f32 v126, v126, v14
v_fmac_f32 v119, v2, v2
v_mfma_f32_16x16x32_bf16 v[150:153], a[220:223], v[186:189], v[150:153]
s_waitcnt lgkmcnt(4)
v_fmac_f32 v127, v14, v14
v_add_f32_e64 v134, v134, v27
v_smfmac_f32_16x16x64_bf16 v[4:7], v[174:177], v[84:91], v213
s_nop 0
ds_read_b128 v[84:87], v197 offset:32
ds_read_b128 v[88:91], v197 offset:48
v_mfma_f32_16x16x32_bf16 v[154:157], a[244:247], v[186:189], v[154:157]
s_waitcnt lgkmcnt(4)
buffer_store_dwordx2 v[80:81], v204, s[8:11], s38 offen offset:32
v_fmac_f32 v135, v27, v27
v_smfmac_f32_16x16x64_bf16 v[16:19], v[174:177], v[92:99], v213
s_waitcnt lgkmcnt(3)
ds_read_b128 v[92:95], v198 offset:32
ds_read_b128 v[96:99], v198 offset:48
v_smfmac_f32_16x16x64_bf16 v[28:31], v[174:177], v[100:107], v213
ds_read_b128 v[100:103], v199 offset:32
ds_read_b128 v[104:107], v199 offset:48
v_mfma_f32_16x16x32_bf16 v[158:161], v[236:239], v[186:189], v[158:161]
ds_read_b128 v[174:177], v217 offset:3168
v_add_f32_e64 v118, v118, v3
v_mfma_f32_16x16x32_bf16 v[162:165], v[186:189], a[76:79], v[162:165]
v_add_f32 v126, v126, v15
v_fmac_f32 v119, v3, v3
v_mfma_f32_16x16x32_bf16 v[166:169], v[186:189], a[100:103], v[166:169]
v_fmac_f32 v127, v15, v15
s_waitcnt lgkmcnt(5)
v_smfmac_f32_16x16x64_bf16 v[4:7], v[178:181], v[84:91], v213
ds_read_b128 v[84:87], v200 offset:64
ds_read_b128 v[88:91], v194 offset:80
v_mfma_f32_16x16x32_bf16 v[170:173], v[186:189], a[124:127], v[170:173]
s_nop 0
ds_read_b128 v[186:189], v210 offset:23552
s_waitcnt lgkmcnt(6)
v_smfmac_f32_16x16x64_bf16 v[16:19], v[178:181], v[92:99], v213
ds_read_b128 v[92:95], v201 offset:64
ds_read_b128 v[96:99], v195 offset:80
v_mfma_f32_16x16x32_bf16 v[138:141], a[8:11], v[182:185], v[138:141]
v_add_f32 v118, v118, v4
v_fmac_f32 v119, v4, v4
v_mfma_f32_16x16x32_bf16 v[142:145], a[32:35], v[182:185], v[142:145]
s_waitcnt lgkmcnt(6)
v_add_f32 v126, v126, v16
v_fmac_f32_e64 v127, v16, v16
v_smfmac_f32_16x16x64_bf16 v[28:31], v[178:181], v[100:107], v213
ds_read_b128 v[100:103], v202 offset:64
ds_read_b128 v[178:181], v217 offset:3696
v_mfma_f32_16x16x32_bf16 v[146:149], a[56:59], v[182:185], v[146:149]
s_waitcnt lgkmcnt(6)
ds_read_b128 v[104:107], v196 offset:80
v_add_f32 v118, v118, v5
v_mfma_f32_16x16x32_bf16 v[8:11], v[174:177], v[84:87], 0
ds_read_b128 v[84:87], v194 offset:64
v_add_f32_e64 v134, v134, v28
v_mfma_f32_16x16x32_bf16 v[150:153], a[224:227], v[182:185], v[150:153]
buffer_store_dwordx2 v[82:83], v204, s[8:11], s38 offen offset:64
v_fmac_f32 v135, v28, v28
v_mfma_f32_16x16x32_bf16 v[154:157], a[248:251], v[182:185], v[154:157]
s_waitcnt lgkmcnt(5)
v_add_f32 v134, v134, v29
v_fmac_f32 v135, v29, v29
v_mfma_f32_16x16x32_bf16 v[20:23], v[174:177], v[92:95], 0
s_waitcnt lgkmcnt(3)
ds_read_b128 v[92:95], v195 offset:64
v_fmac_f32 v119, v5, v5
v_mfma_f32_16x16x32_bf16 v[32:35], v[174:177], v[100:103], 0
ds_read_b128 v[100:103], v196 offset:64
ds_read_b128 v[174:177], v217 offset:4224
v_mfma_f32_16x16x32_bf16 v[158:161], v[240:243], v[182:185], v[158:161]
v_add_f32 v126, v126, v17
v_fmac_f32 v127, v17, v17
v_mfma_f32_16x16x32_bf16 v[162:165], v[182:185], a[80:83], v[162:165]
s_waitcnt lgkmcnt(3)
v_add_f32 v134, v134, v30
v_fmac_f32_e64 v135, v30, v30
v_smfmac_f32_16x16x64_bf16 v[8:11], v[178:181], v[84:91], v213
ds_read_b128 v[84:87], v197 offset:64
ds_read_b128 v[88:91], v197 offset:80
v_mfma_f32_16x16x32_bf16 v[166:169], v[182:185], a[104:107], v[166:169]
v_add_f32_e64 v118, v118, v6
v_fmac_f32 v119, v6, v6
v_mfma_f32_16x16x32_bf16 v[170:173], v[182:185], a[128:131], v[170:173]
s_waitcnt lgkmcnt(4)
ds_read_b128 v[182:185], v210 offset:24576
v_add_f32_e64 v126, v126, v18
v_smfmac_f32_16x16x64_bf16 v[20:23], v[178:181], v[92:99], v213
ds_read_b128 v[92:95], v198 offset:64
ds_read_b128 v[96:99], v198 offset:80
v_mfma_f32_16x16x32_bf16 v[138:141], a[12:15], v[186:189], v[138:141]
s_waitcnt lgkmcnt(6)
v_fmac_f32 v127, v18, v18
v_add_f32_e64 v134, v134, v31
v_smfmac_f32_16x16x64_bf16 v[32:35], v[178:181], v[100:107], v213
ds_read_b128 v[100:103], v199 offset:64
ds_read_b128 v[104:107], v199 offset:80
v_mfma_f32_16x16x32_bf16 v[142:145], a[36:39], v[186:189], v[142:145]
v_fmac_f32 v135, v31, v31
v_add_f32 v118, v118, v7
v_mfma_f32_16x16x32_bf16 v[146:149], a[60:63], v[186:189], v[146:149]
v_fmac_f32 v119, v7, v7
v_add_f32 v126, v126, v19
v_mfma_f32_16x16x32_bf16 v[150:153], a[228:231], v[186:189], v[150:153]
v_fmac_f32 v127, v19, v19
v_mov_b32 v181, 0
v_mfma_f32_16x16x32_bf16 v[154:157], a[252:255], v[186:189], v[154:157]
s_waitcnt lgkmcnt(5)
v_smfmac_f32_16x16x64_bf16 v[8:11], v[174:177], v[84:91], v213
buffer_store_dwordx2 v[116:117], v205, s[8:11], s38 offen
v_mfma_f32_16x16x32_bf16 v[158:161], v[244:247], v[186:189], v[158:161]
v_mfma_f32_16x16x32_bf16 v[162:165], v[186:189], a[84:87], v[162:165]
s_waitcnt lgkmcnt(2)
v_add_f32 v118, v118, v8
v_fmac_f32 v119, v8, v8
v_smfmac_f32_16x16x64_bf16 v[20:23], v[174:177], v[92:99], v213
v_add_f32 v118, v118, v9
v_mfma_f32_16x16x32_bf16 v[166:169], v[186:189], a[108:111], v[166:169]
v_fmac_f32 v119, v9, v9
v_add_f32 v118, v118, v10
v_mfma_f32_16x16x32_bf16 v[170:173], v[186:189], a[132:135], v[170:173]
s_waitcnt lgkmcnt(0)
ds_read_b128 v[186:189], v210 offset:25600
v_add_f32_e64 v126, v126, v20
v_smfmac_f32_16x16x64_bf16 v[32:35], v[174:177], v[100:107], v213
v_fmac_f32_e64 v127, v20, v20
v_mfma_f32_16x16x32_bf16 v[138:141], a[16:19], v[182:185], v[138:141]
v_add_f32 v126, v126, v21
v_fmac_f32 v127, v21, v21
v_mfma_f32_16x16x32_bf16 v[142:145], a[40:43], v[182:185], v[142:145]
v_add_f32 v134, v134, v32
v_fmac_f32 v135, v32, v32
v_mfma_f32_16x16x32_bf16 v[146:149], a[64:67], v[182:185], v[146:149]
v_add_f32 v134, v134, v33
v_fmac_f32 v135, v33, v33
v_mfma_f32_16x16x32_bf16 v[150:153], a[232:235], v[182:185], v[150:153]
v_add_f32 v134, v134, v34
v_fmac_f32 v135, v34, v34
v_mfma_f32_16x16x32_bf16 v[154:157], v[224:227], v[182:185], v[154:157]
v_fmac_f32 v119, v10, v10
v_add_f32 v126, v126, v22
v_mfma_f32_16x16x32_bf16 v[158:161], v[248:251], v[182:185], v[158:161]
v_fmac_f32 v127, v22, v22
v_add_f32 v134, v134, v35
v_mfma_f32_16x16x32_bf16 v[162:165], v[182:185], a[88:91], v[162:165]
v_fmac_f32 v135, v35, v35
v_add_f32 v118, v118, v11
v_mfma_f32_16x16x32_bf16 v[166:169], v[182:185], a[112:115], v[166:169]
v_fmac_f32_e64 v119, v11, v11
v_add_f32 v126, v126, v23
v_mfma_f32_16x16x32_bf16 v[170:173], v[182:185], a[136:139], v[170:173]
s_waitcnt lgkmcnt(0)
ds_read_b128 v[182:185], v210 offset:26624
v_fmac_f32_e64 v127, v23, v23
v_mfma_f32_16x16x32_bf16 v[138:141], a[20:23], v[186:189], v[138:141]
buffer_store_dwordx2 v[124:125], v205, s[8:11], s38 offen offset:32
v_permlane16_swap_b32 v134, v135
v_mfma_f32_16x16x32_bf16 v[142:145], a[44:47], v[186:189], v[142:145]
v_permlane16_swap_b32 v118, v119
v_mfma_f32_16x16x32_bf16 v[146:149], a[68:71], v[186:189], v[146:149]
v_cvt_pk_bf16_f32 v78, v138, v139
v_cvt_pk_bf16_f32 v79, v140, v141
v_mfma_f32_16x16x32_bf16 v[150:153], a[236:239], v[186:189], v[150:153]
v_cvt_pk_bf16_f32 v80, v142, v143
v_cvt_pk_bf16_f32 v81, v144, v145
v_mfma_f32_16x16x32_bf16 v[154:157], v[228:231], v[186:189], v[154:157]
v_cvt_pk_bf16_f32 v82, v146, v147
v_cvt_pk_bf16_f32 v83, v148, v149
v_mfma_f32_16x16x32_bf16 v[158:161], v[252:255], v[186:189], v[158:161]
v_cvt_pk_bf16_f32 v72, v150, v151
v_cvt_pk_bf16_f32 v73, v152, v153
v_mfma_f32_16x16x32_bf16 v[162:165], v[186:189], a[92:95], v[162:165]
v_cvt_pk_bf16_f32 v74, v154, v155
v_cvt_pk_bf16_f32 v75, v156, v157
v_mfma_f32_16x16x32_bf16 v[166:169], v[186:189], a[116:119], v[166:169]
s_nop 0
v_cvt_pk_bf16_f32 v76, v158, v159
v_cvt_pk_bf16_f32 v77, v160, v161
v_mfma_f32_16x16x32_bf16 v[170:173], v[186:189], a[140:143], v[170:173]
s_waitcnt lgkmcnt(0)
ds_read_b128 v[186:189], v210 offset:27648
v_cvt_pk_bf16_f32 v114, v162, v163
v_mfma_f32_16x16x32_bf16 v[138:141], a[0:3], v[182:185], 0
v_cvt_pk_bf16_f32 v115, v164, v165
v_cvt_pk_bf16_f32 v122, v166, v167
v_mfma_f32_16x16x32_bf16 v[142:145], a[24:27], v[182:185], 0
v_cvt_pk_bf16_f32 v123, v168, v169
v_cvt_pk_bf16_f32 v130, v170, v171
v_mfma_f32_16x16x32_bf16 v[146:149], a[48:51], v[182:185], 0
v_cvt_pk_bf16_f32 v131, v172, v173
v_add_f32_e64 v134, v134, v135
v_mfma_f32_16x16x32_bf16 v[150:153], a[216:219], v[182:185], 0
v_permlane16_swap_b32 v126, v127
v_mfma_f32_16x16x32_bf16 v[154:157], a[240:243], v[182:185], 0
v_add_f32 v118, v118, v119
v_mov_b32_e64 v135, v134
v_mfma_f32_16x16x32_bf16 v[158:161], v[232:235], v[182:185], 0
v_add_f32 v126, v126, v127
v_permlane32_swap_b32 v134, v135
v_mfma_f32_16x16x32_bf16 v[162:165], v[182:185], a[72:75], 0
buffer_store_dwordx2 v[132:133], v205, s[8:11], s38 offen offset:64
v_permlane32_swap_b32 v118, v126
v_mfma_f32_16x16x32_bf16 v[166:169], v[182:185], a[96:99], 0
s_mov_b32 s38, s36
v_add_f32_e64 v134, v134, v135
v_add_f32 v118, v118, v126
v_mfma_f32_16x16x32_bf16 v[170:173], v[182:185], a[120:123], 0
s_waitcnt lgkmcnt(0)
ds_read_b128 v[182:185], v210 offset:28672
ds_write_b32 v209, v134 offset:512
v_mfma_f32_16x16x32_bf16 v[138:141], a[4:7], v[186:189], v[138:141]
ds_write_b32 v209, v118
v_mfma_f32_16x16x32_bf16 v[142:145], a[28:31], v[186:189], v[142:145]
v_mfma_f32_16x16x32_bf16 v[146:149], a[52:55], v[186:189], v[146:149]
v_mfma_f32_16x16x32_bf16 v[150:153], a[220:223], v[186:189], v[150:153]
v_mfma_f32_16x16x32_bf16 v[154:157], a[244:247], v[186:189], v[154:157]
v_mfma_f32_16x16x32_bf16 v[158:161], v[236:239], v[186:189], v[158:161]
v_mfma_f32_16x16x32_bf16 v[162:165], v[186:189], a[76:79], v[162:165]
s_waitcnt lgkmcnt(0)
s_barrier
v_mfma_f32_16x16x32_bf16 v[166:169], v[186:189], a[100:103], v[166:169]
ds_read_b128 v[102:105], v210 offset:18432
ds_read_b128 v[106:109], v210 offset:19456
v_mfma_f32_16x16x32_bf16 v[170:173], v[186:189], a[124:127], v[170:173]
ds_read_b128 v[186:189], v210 offset:29696
v_mfma_f32_16x16x32_bf16 v[138:141], a[8:11], v[182:185], v[138:141]
v_mfma_f32_16x16x32_bf16 v[142:145], a[32:35], v[182:185], v[142:145]
v_mfma_f32_16x16x32_bf16 v[146:149], a[56:59], v[182:185], v[146:149]
v_mfma_f32_16x16x32_bf16 v[150:153], a[224:227], v[182:185], v[150:153]
s_waitcnt lgkmcnt(2)
v_add_f32 v102, v102, v103
v_mfma_f32_16x16x32_bf16 v[154:157], a[248:251], v[182:185], v[154:157]
v_add_f32 v104, v104, v105
v_add_f32 v102, v102, v104
v_mfma_f32_16x16x32_bf16 v[158:161], v[240:243], v[182:185], v[158:161]
s_waitcnt lgkmcnt(1)
v_add_f32 v106, v106, v107
v_add_f32_e64 v108, v108, v109
v_mfma_f32_16x16x32_bf16 v[162:165], v[182:185], a[80:83], v[162:165]
v_add_f32 v106, v106, v108
v_mul_f32 v103, s48, v102
v_mfma_f32_16x16x32_bf16 v[166:169], v[182:185], a[104:107], v[166:169]
ds_read_b128 v[108:111], v215 offset:512
v_mul_f32 v104, s73, v102
v_mfma_f32_16x16x32_bf16 v[170:173], v[182:185], a[128:131], v[170:173]
s_waitcnt lgkmcnt(1)
ds_read_b128 v[182:185], v210 offset:30720
v_mul_f32_e64 v106, s73, v106
v_mfma_f32_16x16x32_bf16 v[138:141], a[12:15], v[186:189], v[138:141]
v_fma_f32 v106, -v103, v104, v106
v_max_f32_e64 v106, 0, v106
v_mfma_f32_16x16x32_bf16 v[142:145], a[36:39], v[186:189], v[142:145]
v_add_f32 v106, s49, v106
v_rsq_f32 v102, v106
v_mfma_f32_16x16x32_bf16 v[146:149], a[60:63], v[186:189], v[146:149]
v_mul_f32_e64 v103, -v103, v102
v_mfma_f32_16x16x32_bf16 v[150:153], a[228:231], v[186:189], v[150:153]
ds_write_b64 v211, v[102:103]
v_mfma_f32_16x16x32_bf16 v[154:157], a[252:255], v[186:189], v[154:157]
v_mfma_f32_16x16x32_bf16 v[158:161], v[244:247], v[186:189], v[158:161]
ds_read_b64 v[118:119], v219
ds_read_b64 v[126:127], v219 offset:256
v_mfma_f32_16x16x32_bf16 v[162:165], v[186:189], a[84:87], v[162:165]
ds_read_b64 v[134:135], v219 offset:512
v_mfma_f32_16x16x32_bf16 v[166:169], v[186:189], a[108:111], v[166:169]
v_mfma_f32_16x16x32_bf16 v[170:173], v[186:189], a[132:135], v[170:173]
ds_read_b128 v[186:189], v210 offset:31744
s_waitcnt lgkmcnt(5)
v_mfma_f32_16x16x32_bf16 v[138:141], a[16:19], v[182:185], v[138:141]
v_mfma_f32_16x16x32_bf16 v[142:145], a[40:43], v[182:185], v[142:145]
s_waitcnt lgkmcnt(3)
v_fma_f32 v220, v0, v118, v119
v_fma_f32 v221, v1, v118, v119
v_mfma_f32_16x16x32_bf16 v[146:149], a[64:67], v[182:185], v[146:149]
v_fma_f32 v222, v2, v118, v119
v_fma_f32 v223, v3, v118, v119
v_mfma_f32_16x16x32_bf16 v[150:153], a[232:235], v[182:185], v[150:153]
v_cvt_pk_bf16_f32 v90, v220, v221
v_cvt_pk_bf16_f32 v91, v222, v223
v_mfma_f32_16x16x32_bf16 v[154:157], v[224:227], v[182:185], v[154:157]
v_fma_f32 v220, v4, v118, v119
v_fma_f32 v221, v5, v118, v119
v_mfma_f32_16x16x32_bf16 v[158:161], v[248:251], v[182:185], v[158:161]
v_fma_f32 v222, v6, v118, v119
v_fma_f32 v223, v7, v118, v119
v_mfma_f32_16x16x32_bf16 v[162:165], v[182:185], a[88:91], v[162:165]
v_cvt_pk_bf16_f32 v92, v220, v221
v_cvt_pk_bf16_f32 v93, v222, v223
v_mfma_f32_16x16x32_bf16 v[166:169], v[182:185], a[112:115], v[166:169]
s_nop 0
ds_write_b128 v211, v[90:93]
v_mfma_f32_16x16x32_bf16 v[170:173], v[182:185], a[136:139], v[170:173]
s_waitcnt lgkmcnt(1)
v_fma_f32 v220, v8, v118, v119
v_fma_f32 v221, v9, v118, v119
v_mfma_f32_16x16x32_bf16 v[138:141], a[20:23], v[186:189], v[138:141]
v_fma_f32 v222, v10, v118, v119
v_fma_f32 v223, v11, v118, v119
v_mfma_f32_16x16x32_bf16 v[142:145], a[44:47], v[186:189], v[142:145]
ds_read_b128 v[182:185], v210 offset:32768
v_cvt_pk_bf16_f32 v94, v220, v221
v_mfma_f32_16x16x32_bf16 v[146:149], a[68:71], v[186:189], v[146:149]
v_cvt_pk_bf16_f32 v96, v138, v139
v_cvt_pk_bf16_f32 v97, v140, v141
v_mfma_f32_16x16x32_bf16 v[150:153], a[236:239], v[186:189], v[150:153]
v_cvt_pk_bf16_f32 v98, v142, v143
v_cvt_pk_bf16_f32 v99, v144, v145
v_mfma_f32_16x16x32_bf16 v[154:157], v[228:231], v[186:189], v[154:157]
v_cvt_pk_bf16_f32 v100, v146, v147
v_cvt_pk_bf16_f32 v101, v148, v149
v_mfma_f32_16x16x32_bf16 v[158:161], v[252:255], v[186:189], v[158:161]
v_cvt_pk_bf16_f32 v84, v150, v151
v_cvt_pk_bf16_f32 v85, v152, v153
v_mfma_f32_16x16x32_bf16 v[162:165], v[186:189], a[92:95], v[162:165]
v_cvt_pk_bf16_f32 v86, v154, v155
v_cvt_pk_bf16_f32 v87, v156, v157
v_mfma_f32_16x16x32_bf16 v[166:169], v[186:189], a[116:119], v[166:169]
s_nop 0
v_cvt_pk_bf16_f32 v88, v158, v159
v_cvt_pk_bf16_f32 v89, v160, v161
v_mfma_f32_16x16x32_bf16 v[170:173], v[186:189], a[140:143], v[170:173]
s_waitcnt lgkmcnt(0)
ds_read_b128 v[186:189], v210 offset:33792
v_cvt_pk_bf16_f32 v116, v162, v163
v_mfma_f32_16x16x32_bf16 v[138:141], a[0:3], v[182:185], 0
v_cvt_pk_bf16_f32 v124, v166, v167
v_cvt_pk_bf16_f32 v125, v168, v169
v_mfma_f32_16x16x32_bf16 v[142:145], a[24:27], v[182:185], 0
v_cvt_pk_bf16_f32 v117, v164, v165
v_cvt_pk_bf16_f32 v95, v222, v223
v_mfma_f32_16x16x32_bf16 v[146:149], a[48:51], v[182:185], 0
ds_read_b128 v[182:185], v210 offset:34816
ds_write_b64 v212, v[94:95]
v_mfma_f32_16x16x16_bf16 v[154:157], v[82:83], v[88:89], 0
v_fma_f32 v220, v12, v126, v127
v_fma_f32 v221, v13, v126, v127
v_fma_f32 v222, v14, v126, v127
v_mfma_f32_16x16x16_bf16 v[158:161], v[100:101], v[88:89], 0
v_fma_f32 v223, v15, v126, v127
v_cvt_pk_bf16_f32 v174, v220, v221
v_cvt_pk_bf16_f32 v175, v222, v223
v_fma_f32 v220, v16, v126, v127
s_waitcnt lgkmcnt(2)
v_mfma_f32_16x16x32_bf16 v[138:141], a[4:7], v[186:189], v[138:141]
s_nop 0
v_fma_f32 v221, v17, v126, v127
v_fma_f32 v222, v18, v126, v127
v_mfma_f32_16x16x32_bf16 v[142:145], a[28:31], v[186:189], v[142:145]
s_nop 0
v_fma_f32 v223, v19, v126, v127
v_cvt_pk_bf16_f32 v176, v220, v221
v_mfma_f32_16x16x32_bf16 v[146:149], a[52:55], v[186:189], v[146:149]
s_waitcnt lgkmcnt(1)
ds_read_b128 v[186:189], v210 offset:35840
v_cvt_pk_bf16_f32 v177, v222, v223
v_mfma_f32_16x16x32_bf16 v[138:141], a[8:11], v[182:185], v[138:141]
ds_write_b128 v211, v[174:177] offset:6144
v_mfma_f32_16x16x32_bf16 v[142:145], a[32:35], v[182:185], v[142:145]
v_fma_f32 v220, v20, v126, v127
v_fma_f32 v221, v21, v126, v127
v_mfma_f32_16x16x32_bf16 v[146:149], a[56:59], v[182:185], v[146:149]
v_fma_f32 v222, v22, v126, v127
v_fma_f32 v223, v23, v126, v127
v_cvt_pk_bf16_f32 v178, v220, v221
v_mfma_f32_16x16x16_bf16 v[166:169], v[112:113], v[88:89], v[206:209]
v_cvt_pk_bf16_f32 v179, v222, v223
v_fma_f32 v220, v24, v134, v135
v_fma_f32 v221, v25, v134, v135
v_mfma_f32_16x16x16_bf16 v[150:153], v[112:113], v[76:77], v[206:209]
v_fma_f32 v222, v26, v134, v135
v_fma_f32 v223, v27, v134, v135
v_cvt_pk_bf16_f32 v90, v220, v221
v_cvt_pk_bf16_f32 v91, v222, v223
s_waitcnt lgkmcnt(1)
v_mfma_f32_16x16x32_bf16 v[138:141], a[12:15], v[186:189], v[138:141]
s_nop 0
ds_read_b128 v[182:185], v210 offset:36864
ds_write_b64 v212, v[178:179] offset:6144
v_mfma_f32_16x16x32_bf16 v[142:145], a[36:39], v[186:189], v[142:145]
v_fma_f32 v220, v28, v134, v135
v_fma_f32 v221, v29, v134, v135
v_mfma_f32_16x16x32_bf16 v[146:149], a[60:63], v[186:189], v[146:149]
ds_read_b128 v[186:189], v210 offset:37888
v_fma_f32 v222, v30, v134, v135
v_mfma_f32_16x16x32_bf16 v[154:157], v[78:81], v[84:87], v[154:157]
v_fma_f32 v223, v31, v134, v135
v_cvt_pk_bf16_f32 v92, v220, v221
v_mfma_f32_16x16x32_bf16 v[150:153], v[108:111], v[72:75], v[150:153]
s_nop 0
v_cvt_pk_bf16_f32 v93, v222, v223
v_fma_f32 v220, v32, v134, v135
v_mfma_f32_16x16x32_bf16 v[158:161], v[96:99], v[84:87], v[158:161]
s_waitcnt lgkmcnt(2)
ds_write_b128 v211, v[90:93] offset:12288
v_mfma_f32_16x16x32_bf16 v[138:141], a[16:19], v[182:185], v[138:141]
v_fma_f32 v221, v33, v134, v135
v_fma_f32 v222, v34, v134, v135
v_mfma_f32_16x16x32_bf16 v[142:145], a[40:43], v[182:185], v[142:145]
s_nop 0
v_fma_f32 v223, v35, v134, v135
v_cvt_pk_bf16_f32 v132, v170, v171
v_mfma_f32_16x16x32_bf16 v[146:149], a[64:67], v[182:185], v[146:149]
s_waitcnt lgkmcnt(1)
ds_read_b128 v[182:185], v210 offset:32768
v_cvt_pk_bf16_f32 v133, v172, v173
v_mfma_f32_16x16x32_bf16 v[138:141], a[20:23], v[186:189], v[138:141]
v_cvt_pk_bf16_f32 v94, v220, v221
v_cvt_pk_bf16_f32 v95, v222, v223
v_mfma_f32_16x16x32_bf16 v[142:145], a[44:47], v[186:189], v[142:145]
ds_write_b64 v212, v[94:95] offset:12288
v_mfma_f32_16x16x32_bf16 v[146:149], a[68:71], v[186:189], v[146:149]
v_cvt_pk_bf16_f32 v102, v138, v139
v_cvt_pk_bf16_f32 v103, v140, v141
v_cvt_pk_bf16_f32 v104, v142, v143
v_mfma_f32_16x16x16_bf16 v[138:141], v[82:83], v[76:77], 0
v_cvt_pk_bf16_f32 v105, v144, v145
v_exp_f32_e64 v150, v150
v_mfma_f32_16x16x16_bf16 v[142:145], v[100:101], v[76:77], 0
v_cvt_pk_bf16_f32 v106, v146, v147
v_cvt_pk_bf16_f32 v107, v148, v149
v_cvt_pk_bf16_f32 v180, v150, 0
v_exp_f32 v154, v154
v_mfma_f32_16x16x16_bf16 v[162:165], v[106:107], v[88:89], 0
v_exp_f32 v155, v155
v_exp_f32 v156, v156
v_mfma_f32_16x16x16_bf16 v[146:149], v[106:107], v[76:77], 0
ds_read_b128 v[186:189], v210 offset:33792
ds_read_b64 v[76:77], v215 offset:16
v_exp_f32 v157, v157
v_mfma_f32_16x16x32_bf16 v[138:141], v[78:81], v[72:75], v[138:141]
v_exp_f32 v158, v158
v_mfma_f32_16x16x32_bf16 v[142:145], v[96:99], v[72:75], v[142:145]
s_waitcnt lgkmcnt(3)
v_exp_f32 v159, v159
v_mfma_f32_16x16x32_bf16 v[118:121], v[182:185], a[72:75], 0
v_exp_f32 v138, v138
v_mfma_f32_16x16x32_bf16 v[126:129], v[182:185], a[96:99], 0
v_exp_f32 v139, v139
v_mfma_f32_16x16x32_bf16 v[134:137], v[182:185], a[120:123], 0
v_exp_f32 v140, v140
v_mfma_f32_16x16x32_bf16 v[146:149], v[102:105], v[72:75], v[146:149]
v_exp_f32 v141, v141
v_mfma_f32_16x16x32_bf16 v[90:93], a[216:219], v[182:185], 0
v_exp_f32 v142, v142
v_mfma_f32_16x16x32_bf16 v[170:173], a[240:243], v[182:185], 0
v_exp_f32 v143, v143
v_mfma_f32_16x16x32_bf16 v[220:223], v[232:235], v[182:185], 0
s_waitcnt lgkmcnt(1)
ds_read_b128 v[182:185], v210 offset:34816
v_cvt_pk_bf16_f32 v174, v138, v139
v_mfma_f32_16x16x32_bf16 v[118:121], v[186:189], a[76:79], v[118:121]
v_exp_f32 v144, v144
v_mfma_f32_16x16x32_bf16 v[126:129], v[186:189], a[100:103], v[126:129]
v_exp_f32 v145, v145
v_mfma_f32_16x16x32_bf16 v[134:137], v[186:189], a[124:127], v[134:137]
v_cvt_pk_bf16_f32 v175, v140, v141
v_cvt_pk_bf16_f32 v176, v142, v143
v_mfma_f32_16x16x32_bf16 v[90:93], a[220:223], v[186:189], v[90:93]
v_cvt_pk_bf16_f32 v177, v144, v145
v_exp_f32 v160, v160
v_mfma_f32_16x16x32_bf16 v[170:173], a[244:247], v[186:189], v[170:173]
v_exp_f32 v161, v161
v_mfma_f32_16x16x32_bf16 v[166:169], v[108:111], v[84:87], v[166:169]
v_exp_f32 v146, v146
v_mfma_f32_16x16x32_bf16 v[220:223], v[236:239], v[186:189], v[220:223]
s_waitcnt lgkmcnt(0)
ds_read_b128 v[186:189], v210 offset:35840
ds_read_b128 v[72:75], v215
v_mfma_f32_16x16x32_bf16 v[118:121], v[182:185], a[80:83], v[118:121]
v_exp_f32 v166, v166
v_mfma_f32_16x16x32_bf16 v[126:129], v[182:185], a[104:107], v[126:129]
v_exp_f32 v147, v147
v_mfma_f32_16x16x32_bf16 v[134:137], v[182:185], a[128:131], v[134:137]
v_exp_f32 v148, v148
v_mfma_f32_16x16x32_bf16 v[90:93], a[224:227], v[182:185], v[90:93]
v_exp_f32 v149, v149
v_mfma_f32_16x16x32_bf16 v[162:165], v[102:105], v[84:87], v[162:165]
v_cvt_pk_bf16_f32 v178, v146, v147
v_cvt_pk_bf16_f32 v179, v148, v149
v_mfma_f32_16x16x32_bf16 v[170:173], a[248:251], v[182:185], v[170:173]
v_mfma_f32_16x16x32_bf16 v[220:223], v[240:243], v[182:185], v[220:223]
s_waitcnt lgkmcnt(1)
ds_read_b128 v[182:185], v210 offset:36864
v_exp_f32 v162, v162
v_mfma_f32_16x16x32_bf16 v[118:121], v[186:189], a[84:87], v[118:121]
v_exp_f32 v163, v163
v_mfma_f32_16x16x32_bf16 v[126:129], v[186:189], a[108:111], v[126:129]
v_exp_f32 v164, v164
v_mfma_f32_16x16x32_bf16 v[134:137], v[186:189], a[132:135], v[134:137]
v_exp_f32 v165, v165
v_mfma_f32_16x16x32_bf16 v[90:93], a[228:231], v[186:189], v[90:93]
v_mfma_f32_16x16x32_bf16 v[170:173], a[252:255], v[186:189], v[170:173]
v_mfma_f32_16x16x32_bf16 v[220:223], v[244:247], v[186:189], v[220:223]
ds_read_b128 v[186:189], v210 offset:37888
s_waitcnt lgkmcnt(1)
v_mfma_f32_16x16x32_bf16 v[118:121], v[182:185], a[88:91], v[118:121]
v_mfma_f32_16x16x32_bf16 v[126:129], v[182:185], a[112:115], v[126:129]
v_mfma_f32_16x16x32_bf16 v[134:137], v[182:185], a[136:139], v[134:137]
v_mfma_f32_16x16x32_bf16 v[90:93], a[232:235], v[182:185], v[90:93]
v_mfma_f32_16x16x32_bf16 v[170:173], v[224:227], v[182:185], v[170:173]
s_nop 0
v_mfma_f32_16x16x32_bf16 v[220:223], v[248:251], v[182:185], v[220:223]
s_waitcnt lgkmcnt(0)
v_mfma_f32_16x16x32_bf16 v[118:121], v[186:189], a[92:95], v[118:121]
v_mfma_f32_16x16x32_bf16 v[126:129], v[186:189], a[116:119], v[126:129]
v_mfma_f32_16x16x32_bf16 v[134:137], v[186:189], a[140:143], v[134:137]
v_cvt_pk_bf16_f32 v118, v118, v119
v_cvt_pk_bf16_f32 v119, v120, v121
v_mfma_f32_16x16x32_bf16 v[90:93], a[236:239], v[186:189], v[90:93]
ds_read_u16 v120, v214 offset:1024
v_cvt_pk_bf16_f32 v126, v126, v127
v_mfma_f32_16x16x32_bf16 v[170:173], v[228:231], v[186:189], v[170:173]
v_cvt_pk_bf16_f32 v127, v128, v129
v_cvt_pk_bf16_f32 v134, v134, v135
v_mfma_f32_16x16x32_bf16 v[220:223], v[252:255], v[186:189], v[220:223]
ds_read_u16 v128, v214 offset:1032
v_cvt_pk_bf16_f32 v90, v90, v91
v_mfma_f32_16x16x32_bf16 v[150:153], v[190:193], v[174:177], 0
v_cvt_pk_bf16_f32 v91, v92, v93
v_cvt_pk_bf16_f32 v92, v170, v171
v_mfma_f32_16x16x32_bf16 v[138:141], v[114:117], v[174:177], 0
v_cvt_pk_bf16_f32 v93, v172, v173
v_cvt_pk_bf16_f32 v135, v136, v137
v_mfma_f32_16x16x32_bf16 v[142:145], v[122:125], v[174:177], 0
ds_read_u16 v136, v214 offset:1040
v_mov_b32 v121, 0
v_mfma_f32_16x16x32_bf16 v[146:149], v[130:133], v[174:177], 0
v_cvt_pk_bf16_f32 v174, v154, v155
v_cvt_pk_bf16_f32 v175, v156, v157
v_mfma_f32_16x16x32_bf16 v[150:153], v[190:193], v[178:181], v[150:153]
s_waitcnt lgkmcnt(2)
v_cvt_pk_bf16_f32 v176, v158, v159
v_cvt_pk_bf16_f32 v177, v160, v161
v_mfma_f32_16x16x32_bf16 v[138:141], v[118:121], v[178:181], v[138:141]
v_mov_b32 v129, 0
v_mov_b32 v137, 0
v_mfma_f32_16x16x32_bf16 v[154:157], v[114:117], v[174:177], 0
v_rcp_f32 v151, v150
v_mfma_f32_16x16x32_bf16 v[158:161], v[122:125], v[174:177], 0
s_waitcnt lgkmcnt(1)
v_max3_u32 v218, v218, v150, v151
v_mul_f32_e64 v151, s3, v151
v_mfma_f32_16x16x32_bf16 v[142:145], v[126:129], v[178:181], v[142:145]
s_waitcnt lgkmcnt(0)
v_mul_f32 v138, v138, v151
v_mul_f32_e64 v139, v139, v151
v_mfma_f32_16x16x32_bf16 v[146:149], v[134:137], v[178:181], v[146:149]
v_cvt_pk_bf16_f32 v180, v166, 0
v_mul_f32_e64 v140, v140, v151
v_mfma_f32_16x16x32_bf16 v[166:169], v[190:193], v[174:177], 0
v_mul_f32_e64 v141, v141, v151
v_cvt_pk_bf16_f32 v138, v138, v139
v_mul_f32 v142, v142, v151
v_mul_f32 v143, v143, v151
v_mul_f32 v144, v144, v151
v_mul_f32 v145, v145, v151
v_cvt_pk_bf16_f32 v139, v140, v141
v_cvt_pk_bf16_f32 v140, v142, v143
v_cvt_pk_bf16_f32 v141, v144, v145
v_cvt_pk_bf16_f32 v178, v162, v163
v_cvt_pk_bf16_f32 v179, v164, v165
v_mfma_f32_16x16x32_bf16 v[162:165], v[130:133], v[174:177], 0
ds_write_b128 v211, v[138:141] offset:38912
v_mfma_f32_16x16x32_bf16 v[138:141], v[78:81], v[90:93], 0
v_mul_f32 v146, v146, v151
v_mul_f32 v147, v147, v151
v_mfma_f32_16x16x32_bf16 v[166:169], v[190:193], v[178:181], v[166:169]
v_mul_f32 v148, v148, v151
v_mul_f32 v149, v149, v151
v_mfma_f32_16x16x32_bf16 v[154:157], v[118:121], v[178:181], v[154:157]
v_cvt_pk_bf16_f32 v142, v146, v147
v_cvt_pk_bf16_f32 v143, v148, v149
v_mfma_f32_16x16x32_bf16 v[158:161], v[126:129], v[178:181], v[158:161]
ds_write_b64 v212, v[142:143] offset:38912
v_mfma_f32_16x16x32_bf16 v[142:145], v[96:99], v[90:93], 0
v_rcp_f32_e64 v167, v166
v_mfma_f32_16x16x32_bf16 v[162:165], v[134:137], v[178:181], v[162:165]
v_max3_u32 v218, v218, v166, v167
v_cvt_pk_bf16_f32 v94, v220, v221
v_mfma_f32_16x16x32_bf16 v[150:153], v[108:111], v[90:93], v[206:209]
v_cvt_pk_bf16_f32 v95, v222, v223
v_mul_f32_e64 v167, s3, v167
v_mfma_f32_16x16x32_bf16 v[146:149], v[102:105], v[90:93], 0
v_mul_f32 v154, v154, v167
v_mul_f32 v155, v155, v167
v_mul_f32_e64 v156, v156, v167
v_mfma_f32_16x16x16_bf16 v[138:141], v[82:83], v[94:95], v[138:141]
v_mul_f32_e64 v157, v157, v167
v_cvt_pk_bf16_f32 v154, v154, v155
v_mul_f32_e64 v158, v158, v167
v_mfma_f32_16x16x16_bf16 v[142:145], v[100:101], v[94:95], v[142:145]
v_mul_f32 v159, v159, v167
v_mul_f32 v160, v160, v167
v_mul_f32_e64 v161, v161, v167
v_mfma_f32_16x16x16_bf16 v[150:153], v[112:113], v[94:95], v[150:153]
v_cvt_pk_bf16_f32 v155, v156, v157
v_cvt_pk_bf16_f32 v156, v158, v159
v_cvt_pk_bf16_f32 v157, v160, v161
v_mfma_f32_16x16x16_bf16 v[146:149], v[106:107], v[94:95], v[146:149]
v_mul_f32 v162, v162, v167
v_mul_f32 v163, v163, v167
v_mul_f32 v164, v164, v167
v_mul_f32 v165, v165, v167
v_mfma_f32_16x16x16_bf16 v[166:169], v[76:77], v[112:113], v[206:209]
v_cvt_pk_bf16_f32 v158, v162, v163
v_cvt_pk_bf16_f32 v159, v164, v165
v_exp_f32 v138, v138
v_mfma_f32_16x16x16_bf16 v[162:165], v[76:77], v[106:107], 0
v_exp_f32 v139, v139
v_exp_f32 v140, v140
v_mfma_f32_16x16x32_bf16 v[166:169], v[72:75], v[108:111], v[166:169]
ds_write_b128 v211, v[154:157] offset:45056
v_mfma_f32_16x16x16_bf16 v[154:157], v[76:77], v[82:83], 0
v_exp_f32 v141, v141
v_exp_f32 v142, v142
v_mfma_f32_16x16x32_bf16 v[162:165], v[72:75], v[102:105], v[162:165]
v_exp_f32 v143, v143
v_mfma_f32_16x16x32_bf16 v[154:157], v[72:75], v[78:81], v[154:157]
ds_write_b64 v212, v[158:159] offset:45056
v_mfma_f32_16x16x16_bf16 v[158:161], v[76:77], v[100:101], 0
v_exp_f32 v144, v144
v_exp_f32 v145, v145
v_exp_f32_e64 v150, v150
v_mfma_f32_16x16x32_bf16 v[158:161], v[72:75], v[96:99], v[158:161]
v_cvt_pk_bf16_f32 v174, v138, v139
v_cvt_pk_bf16_f32 v175, v140, v141
v_cvt_pk_bf16_f32 v176, v142, v143
v_cvt_pk_bf16_f32 v177, v144, v145
v_cvt_pk_bf16_f32 v180, v150, 0
v_exp_f32_e64 v146, v146
v_mfma_f32_16x16x32_bf16 v[150:153], v[190:193], v[174:177], 0
v_exp_f32 v147, v147
v_mfma_f32_16x16x32_bf16 v[138:141], v[114:117], v[174:177], 0
s_waitcnt lgkmcnt(0)
v_exp_f32 v148, v148
v_mfma_f32_16x16x32_bf16 v[142:145], v[122:125], v[174:177], 0
s_barrier
ds_read_b128 v[170:173], v210 offset:38912
ds_read_b128 v[182:185], v210 offset:39936
ds_read_b128 v[186:189], v210 offset:40960
v_exp_f32_e64 v149, v149
v_cvt_pk_bf16_f32 v178, v146, v147
v_cvt_pk_bf16_f32 v179, v148, v149
v_mfma_f32_16x16x32_bf16 v[146:149], v[130:133], v[174:177], 0
v_mov_b32_dpp v154, v158 quad_perm:[0,1,2,3] row_mask:0x2 bank_mask:0xf
v_mfma_f32_16x16x32_bf16 v[150:153], v[190:193], v[178:181], v[150:153]
v_mov_b32_dpp v154, v162 quad_perm:[0,1,2,3] row_mask:0x4 bank_mask:0xf
v_mfma_f32_16x16x32_bf16 v[138:141], v[118:121], v[178:181], v[138:141]
v_mov_b32_dpp v154, v167 quad_perm:[0,1,2,3] row_mask:0x8 bank_mask:0xf
v_exp_f32_e64 v154, v154
v_mfma_f32_16x16x32_bf16 v[142:145], v[126:129], v[178:181], v[142:145]
v_cvt_pk_bf16_f32 v154, v154, 0
v_rcp_f32 v151, v150
v_mfma_f32_16x16x32_bf16 v[146:149], v[134:137], v[178:181], v[146:149]
s_waitcnt lgkmcnt(2)
ds_write_b16 v214, v154
v_mfma_f32_16x16x32_bf16 v[36:39], a[144:147], v[170:173], v[36:39]
ds_read_b128 v[84:87], v215
ds_read_b128 v[88:91], v215 offset:16
v_mfma_f32_16x16x32_bf16 v[40:43], a[168:171], v[170:173], v[40:43]
v_add_u32 v215, 1552, v215
v_mov_b32 v181, 0
v_mfma_f32_16x16x32_bf16 v[44:47], a[192:195], v[170:173], v[44:47]
s_waitcnt lgkmcnt(4)
ds_read_b128 v[170:173], v210 offset:41984
ds_read_b64 v[112:113], v215 offset:528
v_mfma_f32_16x16x32_bf16 v[36:39], a[148:151], v[182:185], v[36:39]
ds_read_b128 v[108:111], v215 offset:512
v_mfma_f32_16x16x32_bf16 v[40:43], a[172:175], v[182:185], v[40:43]
v_mfma_f32_16x16x32_bf16 v[44:47], a[196:199], v[182:185], v[44:47]
s_nop 0
ds_read_b128 v[182:185], v210 offset:43008
s_waitcnt lgkmcnt(5)
v_mfma_f32_16x16x32_bf16 v[166:169], v[84:87], v[190:193], 0
v_mfma_f32_16x16x32_bf16 v[154:157], v[84:87], v[114:117], 0
v_mfma_f32_16x16x32_bf16 v[158:161], v[84:87], v[122:125], 0
v_mfma_f32_16x16x32_bf16 v[162:165], v[84:87], v[130:133], 0
s_waitcnt lgkmcnt(4)
v_mfma_f32_16x16x32_bf16 v[166:169], v[88:91], v[190:193], v[166:169]
v_mfma_f32_16x16x32_bf16 v[154:157], v[88:91], v[118:121], v[154:157]
v_mfma_f32_16x16x32_bf16 v[158:161], v[88:91], v[126:129], v[158:161]
v_rcp_f32 v167, v166
v_mfma_f32_16x16x32_bf16 v[162:165], v[88:91], v[134:137], v[162:165]
v_max3_u32 v218, v218, v166, v167
v_max3_u32 v218, v218, v150, v151
v_mfma_f32_16x16x32_bf16 v[36:39], a[152:155], v[186:189], v[36:39]
v_mul_f32 v151, s3, v151
v_mul_f32 v138, v138, v151
v_mfma_f32_16x16x32_bf16 v[40:43], a[176:179], v[186:189], v[40:43]
v_mul_f32_e64 v139, v139, v151
v_mul_f32 v140, v140, v151
v_mfma_f32_16x16x32_bf16 v[44:47], a[200:203], v[186:189], v[44:47]
s_waitcnt lgkmcnt(3)
ds_read_b128 v[186:189], v210 offset:44032
v_mul_f32_e64 v141, v141, v151
v_mfma_f32_16x16x32_bf16 v[36:39], a[156:159], v[170:173], v[36:39]
v_cvt_pk_bf16_f32 v138, v138, v139
v_mul_f32_e64 v142, v142, v151
v_mfma_f32_16x16x32_bf16 v[40:43], a[180:183], v[170:173], v[40:43]
v_mul_f32_e64 v143, v143, v151
v_mul_f32 v144, v144, v151
v_mfma_f32_16x16x32_bf16 v[44:47], a[204:207], v[170:173], v[44:47]
s_waitcnt lgkmcnt(1)
ds_read_b128 v[170:173], v210 offset:45056
v_mul_f32_e64 v145, v145, v151
v_mfma_f32_16x16x32_bf16 v[36:39], a[160:163], v[182:185], v[36:39]
v_cvt_pk_bf16_f32 v139, v140, v141
v_cvt_pk_bf16_f32 v140, v142, v143
v_mfma_f32_16x16x32_bf16 v[40:43], a[184:187], v[182:185], v[40:43]
v_cvt_pk_bf16_f32 v141, v144, v145
v_mul_f32 v146, v146, v151
v_mfma_f32_16x16x32_bf16 v[44:47], a[208:211], v[182:185], v[44:47]
s_waitcnt lgkmcnt(1)
ds_read_b128 v[182:185], v210 offset:46080
ds_write_b128 v211, v[138:141] offset:51200
v_mfma_f32_16x16x32_bf16 v[36:39], a[164:167], v[186:189], v[36:39]
v_mul_f32 v147, v147, v151
v_mul_f32 v148, v148, v151
v_mfma_f32_16x16x32_bf16 v[40:43], a[188:191], v[186:189], v[40:43]
v_mul_f32 v149, v149, v151
v_cvt_pk_bf16_f32 v142, v146, v147
v_mfma_f32_16x16x32_bf16 v[44:47], a[212:215], v[186:189], v[44:47]
s_waitcnt lgkmcnt(2)
ds_read_b128 v[186:189], v210 offset:47104
v_cvt_pk_bf16_f32 v143, v148, v149
v_mfma_f32_16x16x32_bf16 v[48:51], a[144:147], v[170:173], v[48:51]
ds_write_b64 v212, v[142:143] offset:51200
v_mfma_f32_16x16x32_bf16 v[52:55], a[168:171], v[170:173], v[52:55]
s_nop 0
v_cvt_pk_bf16_f32 v72, v36, v37
v_cvt_pk_bf16_f32 v73, v38, v39
v_mfma_f32_16x16x32_bf16 v[56:59], a[192:195], v[170:173], v[56:59]
s_waitcnt lgkmcnt(3)
ds_read_b128 v[170:173], v210 offset:48128
buffer_store_dwordx2 v[72:73], v203, s[8:11], s39 offen
v_cvt_pk_bf16_f32 v74, v40, v41
v_mfma_f32_16x16x32_bf16 v[48:51], a[148:151], v[182:185], v[48:51]
v_cvt_pk_bf16_f32 v75, v42, v43
v_cvt_pk_bf16_f32 v76, v44, v45
v_mfma_f32_16x16x32_bf16 v[52:55], a[172:175], v[182:185], v[52:55]
v_cvt_pk_bf16_f32 v77, v46, v47
v_mov_b32_dpp v154, v158 quad_perm:[0,1,2,3] row_mask:0x2 bank_mask:0xf
v_mfma_f32_16x16x32_bf16 v[56:59], a[196:199], v[182:185], v[56:59]
s_waitcnt lgkmcnt(2)
ds_read_b128 v[182:185], v210 offset:49152
v_mul_f32 v167, s3, v167
v_mfma_f32_16x16x32_bf16 v[48:51], a[152:155], v[186:189], v[48:51]
v_mov_b32_dpp v154, v162 quad_perm:[0,1,2,3] row_mask:0x4 bank_mask:0xf
v_mul_f32 v154, v154, v167
v_mfma_f32_16x16x32_bf16 v[52:55], a[176:179], v[186:189], v[52:55]
s_waitcnt lgkmcnt(2)
v_cvt_pk_bf16_f32 v154, v154, 0
s_barrier
v_mfma_f32_16x16x32_bf16 v[56:59], a[200:203], v[186:189], v[56:59]
s_waitcnt lgkmcnt(1)
ds_read_b128 v[186:189], v210 offset:50176
ds_write_b16 v214, v154
v_mfma_f32_16x16x32_bf16 v[48:51], a[156:159], v[170:173], v[48:51]
v_add_u32 v214, 1552, v214
v_mfma_f32_16x16x32_bf16 v[52:55], a[180:183], v[170:173], v[52:55]
v_mfma_f32_16x16x32_bf16 v[56:59], a[204:207], v[170:173], v[56:59]
ds_read_b128 v[170:173], v210 offset:51200
s_waitcnt lgkmcnt(3)
v_mfma_f32_16x16x32_bf16 v[48:51], a[160:163], v[182:185], v[48:51]
v_mfma_f32_16x16x32_bf16 v[52:55], a[184:187], v[182:185], v[52:55]
buffer_store_dwordx2 v[74:75], v203, s[8:11], s39 offen offset:32
v_mfma_f32_16x16x32_bf16 v[56:59], a[208:211], v[182:185], v[56:59]
ds_read_b128 v[182:185], v210 offset:52224
s_waitcnt lgkmcnt(3)
v_mfma_f32_16x16x32_bf16 v[48:51], a[164:167], v[186:189], v[48:51]
v_mfma_f32_16x16x32_bf16 v[52:55], a[188:191], v[186:189], v[52:55]
s_nop 0
v_mfma_f32_16x16x32_bf16 v[56:59], a[212:215], v[186:189], v[56:59]
s_waitcnt lgkmcnt(1)
ds_read_b128 v[186:189], v210 offset:53248
v_cvt_pk_bf16_f32 v78, v48, v49
v_mfma_f32_16x16x32_bf16 v[60:63], a[144:147], v[170:173], v[60:63]
v_cvt_pk_bf16_f32 v79, v50, v51
v_cvt_pk_bf16_f32 v80, v52, v53
v_mfma_f32_16x16x32_bf16 v[64:67], a[168:171], v[170:173], v[64:67]
s_nop 0
v_cvt_pk_bf16_f32 v81, v54, v55
v_cvt_pk_bf16_f32 v82, v56, v57
v_mfma_f32_16x16x32_bf16 v[68:71], a[192:195], v[170:173], v[68:71]
s_waitcnt lgkmcnt(1)
ds_read_b128 v[170:173], v210 offset:54272
v_cvt_pk_bf16_f32 v83, v58, v59
v_mfma_f32_16x16x32_bf16 v[60:63], a[148:151], v[182:185], v[60:63]
v_mfma_f32_16x16x32_bf16 v[64:67], a[172:175], v[182:185], v[64:67]
v_mfma_f32_16x16x32_bf16 v[68:71], a[196:199], v[182:185], v[68:71]
ds_read_b128 v[182:185], v210 offset:55296
s_waitcnt lgkmcnt(2)
v_mfma_f32_16x16x32_bf16 v[60:63], a[152:155], v[186:189], v[60:63]
v_mfma_f32_16x16x32_bf16 v[64:67], a[176:179], v[186:189], v[64:67]
v_mfma_f32_16x16x32_bf16 v[68:71], a[200:203], v[186:189], v[68:71]
ds_read_b128 v[186:189], v210 offset:56320
s_waitcnt lgkmcnt(2)
v_mfma_f32_16x16x32_bf16 v[60:63], a[156:159], v[170:173], v[60:63]
v_mfma_f32_16x16x32_bf16 v[64:67], a[180:183], v[170:173], v[64:67]
v_mfma_f32_16x16x32_bf16 v[68:71], a[204:207], v[170:173], v[68:71]
buffer_store_dwordx2 v[76:77], v203, s[8:11], s39 offen offset:64
s_waitcnt lgkmcnt(1)
v_mfma_f32_16x16x32_bf16 v[60:63], a[160:163], v[182:185], v[60:63]
v_mfma_f32_16x16x32_bf16 v[64:67], a[184:187], v[182:185], v[64:67]
s_waitcnt lgkmcnt(0)
s_barrier
v_mfma_f32_16x16x32_bf16 v[68:71], a[208:211], v[182:185], v[68:71]
ds_read_b128 v[182:185], v210
v_mfma_f32_16x16x32_bf16 v[60:63], a[164:167], v[186:189], v[60:63]
v_mfma_f32_16x16x32_bf16 v[64:67], a[188:191], v[186:189], v[64:67]
v_mfma_f32_16x16x32_bf16 v[68:71], a[212:215], v[186:189], v[68:71]
ds_read_b128 v[186:189], v210 offset:1024
v_cvt_pk_bf16_f32 v116, v60, v61
v_subrev_u32 v60, 37120, v210
v_lshrrev_b32 v61, 4, v60
v_cvt_pk_bf16_f32 v117, v62, v63
v_cvt_pk_bf16_f32 v124, v64, v65
v_and_b32 v61, 15, v61
v_lshrrev_b32 v62, 8, v60
v_mul_u32_u24 v63, 1552, v61
v_mul_u32_u24 v64, 784, v61
v_lshl_add_u32 v63, v62, 5, v63
v_lshl_add_u32 v64, v62, 4, v64
s_waitcnt lgkmcnt(1)
v_mfma_f32_16x16x32_bf16 v[138:141], a[0:3], v[182:185], 0
s_nop 0
v_add_u32 v63, 94464, v63
v_add_u32 v64, s41, v64
v_mfma_f32_16x16x32_bf16 v[142:145], a[24:27], v[182:185], 0
s_add_u32 s41, s33, 0
ds_read_b128 v[84:87], v63
ds_read_b128 v[36:39], v64
v_mfma_f32_16x16x32_bf16 v[146:149], a[48:51], v[182:185], 0
ds_read_b128 v[88:91], v63 offset:128
ds_read_b128 v[92:95], v63 offset:256
v_mfma_f32_16x16x32_bf16 v[150:153], a[216:219], v[182:185], 0
ds_read_b128 v[96:99], v63 offset:384
ds_read_b64 v[100:101], v63 offset:16
v_mfma_f32_16x16x32_bf16 v[154:157], a[240:243], v[182:185], 0
ds_read_b64 v[102:103], v63 offset:144
ds_read_b64 v[104:105], v63 offset:272
v_mfma_f32_16x16x32_bf16 v[158:161], v[232:235], v[182:185], 0
ds_read_b64 v[106:107], v63 offset:400
ds_read_b128 v[40:43], v64 offset:64
v_mfma_f32_16x16x32_bf16 v[162:165], v[182:185], a[72:75], 0
ds_read_b128 v[44:47], v64 offset:128
buffer_store_dwordx2 v[78:79], v204, s[8:11], s39 offen
v_cvt_pk_bf16_f32 v125, v66, v67
v_mfma_f32_16x16x32_bf16 v[166:169], v[182:185], a[96:99], 0
s_waitcnt lgkmcnt(9)
v_cvt_pk_bf16_f32 v132, v68, v69
v_cvt_pk_bf16_f32 v133, v70, v71
v_mfma_f32_16x16x32_bf16 v[36:39], a[144:147], v[84:87], v[36:39]
s_waitcnt lgkmcnt(8)
ds_read_b128 v[48:51], v64 offset:12544
ds_read_b128 v[52:55], v64 offset:12608
v_mfma_f32_16x16x32_bf16 v[36:39], a[148:151], v[88:91], v[36:39]
s_waitcnt lgkmcnt(9)
ds_read_b128 v[56:59], v64 offset:12672
v_lshlrev_b32 v67, 5, v61
v_mfma_f32_16x16x32_bf16 v[36:39], a[152:155], v[92:95], v[36:39]
s_waitcnt lgkmcnt(9)
v_add_u32 v67, s41, v67
v_mul_hi_u32 v68, v67, s42
v_mfma_f32_16x16x32_bf16 v[36:39], a[156:159], v[96:99], v[36:39]
s_waitcnt lgkmcnt(7)
v_mul_u32_u24 v65, 73, v68
v_sub_u32 v65, v67, v65
v_mfma_f32_16x16x32_bf16 v[36:39], a[160:163], v[100:103], v[36:39]
s_waitcnt lgkmcnt(5)
v_mul_u32_u24 v65, 2688, v65
v_cmp_gt_u32 vcc, s34, v67
v_mfma_f32_16x16x32_bf16 v[36:39], a[164:167], v[104:107], v[36:39]
s_waitcnt lgkmcnt(4)
v_lshlrev_b32 v67, 5, v61
s_mov_b32 s42, 1373568
v_mfma_f32_16x16x32_bf16 v[40:43], a[168:171], v[84:87], v[40:43]
v_mul_lo_u32 v68, v68, s42
s_mul_i32 s42, s32, 96
v_mfma_f32_16x16x32_bf16 v[40:43], a[172:175], v[88:91], v[40:43]
s_add_u32 s41, s33, 512
v_add3_u32 v65, v65, v68, s42
v_mov_b32 v68, 1879048192
v_mfma_f32_16x16x32_bf16 v[40:43], a[176:179], v[92:95], v[40:43]
s_mov_b32 s42, 58835169
v_add_u32 v67, s41, v67
v_cndmask_b32 v65, v68, v65, vcc
v_mfma_f32_16x16x32_bf16 v[40:43], a[180:183], v[96:99], v[40:43]
s_waitcnt lgkmcnt(3)
v_mul_hi_u32 v68, v67, s42
v_mul_u32_u24 v66, 73, v68
v_mfma_f32_16x16x32_bf16 v[40:43], a[184:187], v[100:103], v[40:43]
s_mov_b32 s42, 1373568
v_mul_lo_u32 v68, v68, s42
v_sub_u32 v66, v67, v66
v_mfma_f32_16x16x32_bf16 v[40:43], a[188:191], v[104:107], v[40:43]
s_mul_i32 s42, s32, 96
v_cmp_gt_u32 vcc, s34, v67
v_mul_u32_u24 v66, 2688, v66
v_mfma_f32_16x16x32_bf16 v[44:47], a[192:195], v[84:87], v[44:47]
s_nop 0
v_add3_u32 v66, v66, v68, s42
v_mov_b32 v68, 1879048192
v_mfma_f32_16x16x32_bf16 v[44:47], a[196:199], v[88:91], v[44:47]
s_nop 0
buffer_store_dwordx2 v[80:81], v204, s[8:11], s39 offen offset:32
v_cndmask_b32 v66, v68, v66, vcc
v_mfma_f32_16x16x32_bf16 v[170:173], v[182:185], a[120:123], 0
ds_read_b128 v[182:185], v210 offset:2048
v_cvt_pk_bf16_f32 v36, v36, v37
v_mfma_f32_16x16x32_bf16 v[44:47], a[200:203], v[92:95], v[44:47]
v_lshl_add_u32 v65, v62, 3, v65
v_cvt_pk_bf16_f32 v40, v40, v41
v_mfma_f32_16x16x32_bf16 v[44:47], a[204:207], v[96:99], v[44:47]
v_lshl_add_u32 v66, v62, 3, v66
v_cvt_pk_bf16_f32 v37, v38, v39
v_mfma_f32_16x16x32_bf16 v[138:141], a[4:7], v[186:189], v[138:141]
v_add_u32 v65, 785664, v65
v_cvt_pk_bf16_f32 v41, v42, v43
v_mfma_f32_16x16x32_bf16 v[44:47], a[208:211], v[100:103], v[44:47]
v_add_u32 v66, 785664, v66
v_mfma_f32_16x16x32_bf16 v[44:47], a[212:215], v[104:107], v[44:47]
v_mfma_f32_16x16x32_bf16 v[142:145], a[28:31], v[186:189], v[142:145]
v_mfma_f32_16x16x32_bf16 v[146:149], a[52:55], v[186:189], v[146:149]
v_cvt_pk_bf16_f32 v44, v44, v45
v_cvt_pk_bf16_f32 v45, v46, v47
v_mfma_f32_16x16x32_bf16 v[150:153], a[220:223], v[186:189], v[150:153]
v_mfma_f32_16x16x32_bf16 v[154:157], a[244:247], v[186:189], v[154:157]
v_mfma_f32_16x16x32_bf16 v[158:161], v[236:239], v[186:189], v[158:161]
v_mfma_f32_16x16x32_bf16 v[162:165], v[186:189], a[76:79], v[162:165]
v_mfma_f32_16x16x32_bf16 v[166:169], v[186:189], a[100:103], v[166:169]
v_mfma_f32_16x16x32_bf16 v[170:173], v[186:189], a[124:127], v[170:173]
ds_read_b128 v[186:189], v210 offset:3072
s_waitcnt lgkmcnt(1)
v_mfma_f32_16x16x32_bf16 v[138:141], a[8:11], v[182:185], v[138:141]
buffer_store_dwordx2 v[82:83], v204, s[8:11], s39 offen offset:64
v_mfma_f32_16x16x32_bf16 v[142:145], a[32:35], v[182:185], v[142:145]
v_mfma_f32_16x16x32_bf16 v[146:149], a[56:59], v[182:185], v[146:149]
v_mfma_f32_16x16x32_bf16 v[150:153], a[224:227], v[182:185], v[150:153]
v_mfma_f32_16x16x32_bf16 v[154:157], a[248:251], v[182:185], v[154:157]
v_mfma_f32_16x16x32_bf16 v[158:161], v[240:243], v[182:185], v[158:161]
v_mfma_f32_16x16x32_bf16 v[162:165], v[182:185], a[80:83], v[162:165]
v_mfma_f32_16x16x32_bf16 v[166:169], v[182:185], a[104:107], v[166:169]
v_mfma_f32_16x16x32_bf16 v[170:173], v[182:185], a[128:131], v[170:173]
ds_read_b128 v[182:185], v210 offset:4096
s_waitcnt lgkmcnt(1)
v_mfma_f32_16x16x32_bf16 v[138:141], a[12:15], v[186:189], v[138:141]
v_mfma_f32_16x16x32_bf16 v[142:145], a[36:39], v[186:189], v[142:145]
v_mfma_f32_16x16x32_bf16 v[146:149], a[60:63], v[186:189], v[146:149]
v_mfma_f32_16x16x32_bf16 v[150:153], a[228:231], v[186:189], v[150:153]
v_mfma_f32_16x16x32_bf16 v[154:157], a[252:255], v[186:189], v[154:157]
v_mfma_f32_16x16x32_bf16 v[158:161], v[244:247], v[186:189], v[158:161]
v_mfma_f32_16x16x32_bf16 v[162:165], v[186:189], a[84:87], v[162:165]
v_mfma_f32_16x16x32_bf16 v[166:169], v[186:189], a[108:111], v[166:169]
buffer_store_dwordx2 v[116:117], v205, s[8:11], s39 offen
v_mfma_f32_16x16x32_bf16 v[170:173], v[186:189], a[132:135], v[170:173]
ds_read_b128 v[186:189], v210 offset:5120
s_waitcnt lgkmcnt(1)
v_mfma_f32_16x16x32_bf16 v[138:141], a[16:19], v[182:185], v[138:141]
v_mfma_f32_16x16x32_bf16 v[142:145], a[40:43], v[182:185], v[142:145]
v_mfma_f32_16x16x32_bf16 v[146:149], a[64:67], v[182:185], v[146:149]
v_mfma_f32_16x16x32_bf16 v[150:153], a[232:235], v[182:185], v[150:153]
v_mfma_f32_16x16x32_bf16 v[154:157], v[224:227], v[182:185], v[154:157]
v_mfma_f32_16x16x32_bf16 v[158:161], v[248:251], v[182:185], v[158:161]
v_mfma_f32_16x16x32_bf16 v[162:165], v[182:185], a[88:91], v[162:165]
v_mfma_f32_16x16x32_bf16 v[166:169], v[182:185], a[112:115], v[166:169]
v_mfma_f32_16x16x32_bf16 v[170:173], v[182:185], a[136:139], v[170:173]
ds_read_b128 v[182:185], v210 offset:6144
s_waitcnt lgkmcnt(1)
v_mfma_f32_16x16x32_bf16 v[138:141], a[20:23], v[186:189], v[138:141]
v_mfma_f32_16x16x32_bf16 v[142:145], a[44:47], v[186:189], v[142:145]
v_mfma_f32_16x16x32_bf16 v[146:149], a[68:71], v[186:189], v[146:149]
v_cvt_pk_bf16_f32 v78, v138, v139
v_cvt_pk_bf16_f32 v79, v140, v141
v_mfma_f32_16x16x32_bf16 v[150:153], a[236:239], v[186:189], v[150:153]
v_cvt_pk_bf16_f32 v80, v142, v143
v_cvt_pk_bf16_f32 v81, v144, v145
v_mfma_f32_16x16x32_bf16 v[154:157], v[228:231], v[186:189], v[154:157]
v_cvt_pk_bf16_f32 v82, v146, v147
v_cvt_pk_bf16_f32 v83, v148, v149
v_mfma_f32_16x16x32_bf16 v[158:161], v[252:255], v[186:189], v[158:161]
v_cvt_pk_bf16_f32 v72, v150, v151
v_cvt_pk_bf16_f32 v73, v152, v153
v_mfma_f32_16x16x32_bf16 v[162:165], v[186:189], a[92:95], v[162:165]
v_cvt_pk_bf16_f32 v74, v154, v155
v_cvt_pk_bf16_f32 v75, v156, v157
v_mfma_f32_16x16x32_bf16 v[166:169], v[186:189], a[116:119], v[166:169]
s_nop 0
v_cvt_pk_bf16_f32 v76, v158, v159
v_cvt_pk_bf16_f32 v77, v160, v161
v_mfma_f32_16x16x32_bf16 v[170:173], v[186:189], a[140:143], v[170:173]
s_waitcnt lgkmcnt(0)
ds_read_b128 v[186:189], v210 offset:7168
v_cvt_pk_bf16_f32 v114, v162, v163
v_mfma_f32_16x16x32_bf16 v[138:141], a[0:3], v[182:185], 0
v_cvt_pk_bf16_f32 v115, v164, v165
v_cvt_pk_bf16_f32 v122, v166, v167
v_mfma_f32_16x16x32_bf16 v[142:145], a[24:27], v[182:185], 0
v_cvt_pk_bf16_f32 v123, v168, v169
v_cvt_pk_bf16_f32 v130, v170, v171
v_mfma_f32_16x16x32_bf16 v[146:149], a[48:51], v[182:185], 0
v_cvt_pk_bf16_f32 v131, v172, v173
v_mfma_f32_16x16x32_bf16 v[150:153], a[216:219], v[182:185], 0
buffer_store_dwordx2 v[124:125], v205, s[8:11], s39 offen offset:32
v_mfma_f32_16x16x32_bf16 v[154:157], a[240:243], v[182:185], 0
v_mfma_f32_16x16x32_bf16 v[158:161], v[232:235], v[182:185], 0
v_mfma_f32_16x16x32_bf16 v[162:165], v[182:185], a[72:75], 0
v_mfma_f32_16x16x32_bf16 v[166:169], v[182:185], a[96:99], 0
v_mfma_f32_16x16x32_bf16 v[170:173], v[182:185], a[120:123], 0
ds_read_b128 v[182:185], v210 offset:8192
s_waitcnt lgkmcnt(1)
v_mfma_f32_16x16x32_bf16 v[138:141], a[4:7], v[186:189], v[138:141]
v_mfma_f32_16x16x32_bf16 v[142:145], a[28:31], v[186:189], v[142:145]
v_mfma_f32_16x16x32_bf16 v[146:149], a[52:55], v[186:189], v[146:149]
v_mfma_f32_16x16x32_bf16 v[150:153], a[220:223], v[186:189], v[150:153]
v_mfma_f32_16x16x32_bf16 v[154:157], a[244:247], v[186:189], v[154:157]
v_mfma_f32_16x16x32_bf16 v[158:161], v[236:239], v[186:189], v[158:161]
v_mfma_f32_16x16x32_bf16 v[162:165], v[186:189], a[76:79], v[162:165]
buffer_store_dwordx2 v[132:133], v205, s[8:11], s39 offen offset:64
v_mfma_f32_16x16x32_bf16 v[166:169], v[186:189], a[100:103], v[166:169]
v_mfma_f32_16x16x32_bf16 v[170:173], v[186:189], a[124:127], v[170:173]
ds_read_b128 v[186:189], v210 offset:9216
s_waitcnt lgkmcnt(1)
v_mfma_f32_16x16x32_bf16 v[138:141], a[8:11], v[182:185], v[138:141]
v_mfma_f32_16x16x32_bf16 v[142:145], a[32:35], v[182:185], v[142:145]
v_mfma_f32_16x16x32_bf16 v[146:149], a[56:59], v[182:185], v[146:149]
v_mfma_f32_16x16x32_bf16 v[150:153], a[224:227], v[182:185], v[150:153]
v_mfma_f32_16x16x32_bf16 v[154:157], a[248:251], v[182:185], v[154:157]
v_mfma_f32_16x16x32_bf16 v[158:161], v[240:243], v[182:185], v[158:161]
v_mfma_f32_16x16x32_bf16 v[162:165], v[182:185], a[80:83], v[162:165]
v_mfma_f32_16x16x32_bf16 v[166:169], v[182:185], a[104:107], v[166:169]
v_mfma_f32_16x16x32_bf16 v[170:173], v[182:185], a[128:131], v[170:173]
ds_read_b128 v[182:185], v210 offset:10240
s_waitcnt lgkmcnt(1)
v_mfma_f32_16x16x32_bf16 v[138:141], a[12:15], v[186:189], v[138:141]
v_mfma_f32_16x16x32_bf16 v[142:145], a[36:39], v[186:189], v[142:145]
v_mfma_f32_16x16x32_bf16 v[146:149], a[60:63], v[186:189], v[146:149]
v_mfma_f32_16x16x32_bf16 v[150:153], a[228:231], v[186:189], v[150:153]
v_mfma_f32_16x16x32_bf16 v[154:157], a[252:255], v[186:189], v[154:157]
buffer_store_dwordx2 v[36:37], v65, s[8:11], 0 offen
v_mfma_f32_16x16x32_bf16 v[158:161], v[244:247], v[186:189], v[158:161]
v_mfma_f32_16x16x32_bf16 v[162:165], v[186:189], a[84:87], v[162:165]
v_mfma_f32_16x16x32_bf16 v[166:169], v[186:189], a[108:111], v[166:169]
v_mfma_f32_16x16x32_bf16 v[170:173], v[186:189], a[132:135], v[170:173]
ds_read_b128 v[186:189], v210 offset:11264
s_waitcnt lgkmcnt(1)
v_mfma_f32_16x16x32_bf16 v[138:141], a[16:19], v[182:185], v[138:141]
v_mfma_f32_16x16x32_bf16 v[142:145], a[40:43], v[182:185], v[142:145]
v_mfma_f32_16x16x32_bf16 v[146:149], a[64:67], v[182:185], v[146:149]
v_mfma_f32_16x16x32_bf16 v[150:153], a[232:235], v[182:185], v[150:153]
v_mfma_f32_16x16x32_bf16 v[154:157], v[224:227], v[182:185], v[154:157]
v_mfma_f32_16x16x32_bf16 v[158:161], v[248:251], v[182:185], v[158:161]
v_mfma_f32_16x16x32_bf16 v[162:165], v[182:185], a[88:91], v[162:165]
v_mfma_f32_16x16x32_bf16 v[166:169], v[182:185], a[112:115], v[166:169]
v_mfma_f32_16x16x32_bf16 v[170:173], v[182:185], a[136:139], v[170:173]
ds_read_b128 v[182:185], v210 offset:12288
s_waitcnt lgkmcnt(1)
v_mfma_f32_16x16x32_bf16 v[138:141], a[20:23], v[186:189], v[138:141]
v_mfma_f32_16x16x32_bf16 v[142:145], a[44:47], v[186:189], v[142:145]
buffer_store_dwordx2 v[40:41], v65, s[8:11], 0 offen offset:32
s_nop 1
v_cvt_pk_bf16_f32 v96, v138, v139
v_mfma_f32_16x16x32_bf16 v[146:149], a[68:71], v[186:189], v[146:149]
v_cvt_pk_bf16_f32 v97, v140, v141
v_cvt_pk_bf16_f32 v98, v142, v143
v_mfma_f32_16x16x32_bf16 v[150:153], a[236:239], v[186:189], v[150:153]
v_cvt_pk_bf16_f32 v99, v144, v145
v_mfma_f32_16x16x32_bf16 v[154:157], v[228:231], v[186:189], v[154:157]
v_cvt_pk_bf16_f32 v100, v146, v147
v_cvt_pk_bf16_f32 v101, v148, v149
v_mfma_f32_16x16x32_bf16 v[158:161], v[252:255], v[186:189], v[158:161]
v_cvt_pk_bf16_f32 v84, v150, v151
v_cvt_pk_bf16_f32 v85, v152, v153
v_mfma_f32_16x16x32_bf16 v[162:165], v[186:189], a[92:95], v[162:165]
v_cvt_pk_bf16_f32 v86, v154, v155
v_cvt_pk_bf16_f32 v87, v156, v157
v_mfma_f32_16x16x32_bf16 v[166:169], v[186:189], a[116:119], v[166:169]
s_nop 0
v_cvt_pk_bf16_f32 v88, v158, v159
v_cvt_pk_bf16_f32 v89, v160, v161
v_mfma_f32_16x16x32_bf16 v[170:173], v[186:189], a[140:143], v[170:173]
s_waitcnt lgkmcnt(0)
ds_read_b128 v[186:189], v210 offset:13312
v_cvt_pk_bf16_f32 v116, v162, v163
v_mfma_f32_16x16x32_bf16 v[138:141], a[0:3], v[182:185], 0
v_cvt_pk_bf16_f32 v124, v166, v167
v_cvt_pk_bf16_f32 v125, v168, v169
v_mfma_f32_16x16x32_bf16 v[142:145], a[24:27], v[182:185], 0
v_cvt_pk_bf16_f32 v117, v164, v165
v_cvt_pk_bf16_f32 v132, v170, v171
v_mfma_f32_16x16x32_bf16 v[146:149], a[48:51], v[182:185], 0
ds_read_b128 v[182:185], v210 offset:14336
v_cvt_pk_bf16_f32 v133, v172, v173
v_mfma_f32_16x16x16_bf16 v[154:157], v[82:83], v[88:89], 0
v_mfma_f32_16x16x16_bf16 v[158:161], v[100:101], v[88:89], 0
s_waitcnt lgkmcnt(1)
v_mfma_f32_16x16x32_bf16 v[138:141], a[4:7], v[186:189], v[138:141]
v_mfma_f32_16x16x32_bf16 v[142:145], a[28:31], v[186:189], v[142:145]
v_mfma_f32_16x16x32_bf16 v[146:149], a[52:55], v[186:189], v[146:149]
ds_read_b128 v[186:189], v210 offset:15360
buffer_store_dwordx2 v[44:45], v65, s[8:11], 0 offen offset:64
s_waitcnt lgkmcnt(1)
v_mfma_f32_16x16x32_bf16 v[138:141], a[8:11], v[182:185], v[138:141]
v_mfma_f32_16x16x32_bf16 v[142:145], a[32:35], v[182:185], v[142:145]
v_mfma_f32_16x16x32_bf16 v[146:149], a[56:59], v[182:185], v[146:149]
ds_read_b128 v[182:185], v210 offset:16384
v_mfma_f32_16x16x16_bf16 v[166:169], v[112:113], v[88:89], v[206:209]
v_mfma_f32_16x16x16_bf16 v[150:153], v[112:113], v[76:77], v[206:209]
s_waitcnt lgkmcnt(1)
v_mfma_f32_16x16x32_bf16 v[138:141], a[12:15], v[186:189], v[138:141]
v_mfma_f32_16x16x32_bf16 v[142:145], a[36:39], v[186:189], v[142:145]
v_mfma_f32_16x16x32_bf16 v[146:149], a[60:63], v[186:189], v[146:149]
ds_read_b128 v[186:189], v210 offset:17408
s_waitcnt lgkmcnt(1)
v_mfma_f32_16x16x32_bf16 v[138:141], a[16:19], v[182:185], v[138:141]
v_mfma_f32_16x16x32_bf16 v[142:145], a[40:43], v[182:185], v[142:145]
v_mfma_f32_16x16x32_bf16 v[154:157], v[78:81], v[84:87], v[154:157]
v_mfma_f32_16x16x32_bf16 v[150:153], v[108:111], v[72:75], v[150:153]
v_mfma_f32_16x16x32_bf16 v[146:149], a[64:67], v[182:185], v[146:149]
ds_read_b128 v[182:185], v210 offset:12288
v_exp_f32 v154, v154
v_mfma_f32_16x16x32_bf16 v[158:161], v[96:99], v[84:87], v[158:161]
s_waitcnt lgkmcnt(1)
v_exp_f32 v150, v150
v_mfma_f32_16x16x32_bf16 v[138:141], a[20:23], v[186:189], v[138:141]
v_cvt_pk_bf16_f32 v180, v150, 0
v_exp_f32 v155, v155
v_mfma_f32_16x16x32_bf16 v[142:145], a[44:47], v[186:189], v[142:145]
v_exp_f32_e64 v156, v156
v_mfma_f32_16x16x32_bf16 v[146:149], a[68:71], v[186:189], v[146:149]
ds_read_b128 v[186:189], v210 offset:13312
v_cvt_pk_bf16_f32 v102, v138, v139
v_mfma_f32_16x16x32_bf16 v[166:169], v[108:111], v[84:87], v[166:169]
v_cvt_pk_bf16_f32 v103, v140, v141
v_cvt_pk_bf16_f32 v104, v142, v143
v_cvt_pk_bf16_f32 v105, v144, v145
v_mfma_f32_16x16x16_bf16 v[138:141], v[82:83], v[76:77], 0
v_cvt_pk_bf16_f32 v106, v146, v147
v_cvt_pk_bf16_f32 v107, v148, v149
v_exp_f32 v157, v157
v_mfma_f32_16x16x16_bf16 v[142:145], v[100:101], v[76:77], 0
v_exp_f32 v158, v158
v_exp_f32 v159, v159
v_mfma_f32_16x16x16_bf16 v[162:165], v[106:107], v[88:89], 0
v_exp_f32 v160, v160
v_exp_f32 v161, v161
v_mfma_f32_16x16x16_bf16 v[146:149], v[106:107], v[76:77], 0
v_exp_f32 v166, v166
v_mfma_f32_16x16x32_bf16 v[138:141], v[78:81], v[72:75], v[138:141]
ds_read_b64 v[76:77], v215 offset:16
v_mfma_f32_16x16x32_bf16 v[142:145], v[96:99], v[72:75], v[142:145]
s_waitcnt lgkmcnt(2)
v_mfma_f32_16x16x32_bf16 v[118:121], v[182:185], a[72:75], 0
v_exp_f32 v138, v138
v_mfma_f32_16x16x32_bf16 v[126:129], v[182:185], a[96:99], 0
v_exp_f32 v139, v139
v_mfma_f32_16x16x32_bf16 v[134:137], v[182:185], a[120:123], 0
v_exp_f32 v140, v140
v_mfma_f32_16x16x32_bf16 v[146:149], v[102:105], v[72:75], v[146:149]
ds_read_b128 v[72:75], v215
v_cvt_pk_bf16_f32 v174, v138, v139
v_mfma_f32_16x16x32_bf16 v[90:93], a[216:219], v[182:185], 0
v_exp_f32_e64 v141, v141
v_mfma_f32_16x16x32_bf16 v[170:173], a[240:243], v[182:185], 0
v_exp_f32 v142, v142
v_mfma_f32_16x16x32_bf16 v[220:223], v[232:235], v[182:185], 0
s_waitcnt lgkmcnt(2)
ds_read_b128 v[182:185], v210 offset:14336
v_cvt_pk_bf16_f32 v175, v140, v141
v_mfma_f32_16x16x32_bf16 v[118:121], v[186:189], a[76:79], v[118:121]
v_exp_f32 v143, v143
v_mfma_f32_16x16x32_bf16 v[126:129], v[186:189], a[100:103], v[126:129]
v_exp_f32 v144, v144
v_mfma_f32_16x16x32_bf16 v[134:137], v[186:189], a[124:127], v[134:137]
v_exp_f32_e64 v145, v145
v_mfma_f32_16x16x32_bf16 v[90:93], a[220:223], v[186:189], v[90:93]
v_cvt_pk_bf16_f32 v176, v142, v143
v_cvt_pk_bf16_f32 v177, v144, v145
v_mfma_f32_16x16x32_bf16 v[170:173], a[244:247], v[186:189], v[170:173]
v_exp_f32 v146, v146
v_mfma_f32_16x16x32_bf16 v[220:223], v[236:239], v[186:189], v[220:223]
s_waitcnt lgkmcnt(0)
ds_read_b128 v[186:189], v210 offset:15360
v_exp_f32 v147, v147
v_mfma_f32_16x16x32_bf16 v[118:121], v[182:185], a[80:83], v[118:121]
v_exp_f32 v148, v148
v_mfma_f32_16x16x32_bf16 v[126:129], v[182:185], a[104:107], v[126:129]
v_exp_f32_e64 v149, v149
v_mfma_f32_16x16x32_bf16 v[134:137], v[182:185], a[128:131], v[134:137]
v_cvt_pk_bf16_f32 v178, v146, v147
v_cvt_pk_bf16_f32 v179, v148, v149
v_mfma_f32_16x16x32_bf16 v[90:93], a[224:227], v[182:185], v[90:93]
v_mfma_f32_16x16x32_bf16 v[162:165], v[102:105], v[84:87], v[162:165]
v_mfma_f32_16x16x32_bf16 v[170:173], a[248:251], v[182:185], v[170:173]
v_mfma_f32_16x16x32_bf16 v[220:223], v[240:243], v[182:185], v[220:223]
s_waitcnt lgkmcnt(0)
ds_read_b128 v[182:185], v210 offset:16384
v_exp_f32 v162, v162
v_mfma_f32_16x16x32_bf16 v[118:121], v[186:189], a[84:87], v[118:121]
v_exp_f32 v163, v163
v_mfma_f32_16x16x32_bf16 v[126:129], v[186:189], a[108:111], v[126:129]
v_exp_f32 v164, v164
v_mfma_f32_16x16x32_bf16 v[134:137], v[186:189], a[132:135], v[134:137]
v_exp_f32 v165, v165
v_mfma_f32_16x16x32_bf16 v[90:93], a[228:231], v[186:189], v[90:93]
v_mfma_f32_16x16x32_bf16 v[170:173], a[252:255], v[186:189], v[170:173]
v_mfma_f32_16x16x32_bf16 v[220:223], v[244:247], v[186:189], v[220:223]
ds_read_b128 v[186:189], v210 offset:17408
s_waitcnt lgkmcnt(1)
v_mfma_f32_16x16x32_bf16 v[118:121], v[182:185], a[88:91], v[118:121]
v_mfma_f32_16x16x32_bf16 v[126:129], v[182:185], a[112:115], v[126:129]
v_mfma_f32_16x16x32_bf16 v[134:137], v[182:185], a[136:139], v[134:137]
v_mfma_f32_16x16x32_bf16 v[90:93], a[232:235], v[182:185], v[90:93]
v_mfma_f32_16x16x32_bf16 v[170:173], v[224:227], v[182:185], v[170:173]
s_nop 0
v_mfma_f32_16x16x32_bf16 v[220:223], v[248:251], v[182:185], v[220:223]
s_waitcnt lgkmcnt(0)
v_mfma_f32_16x16x32_bf16 v[118:121], v[186:189], a[92:95], v[118:121]
v_mfma_f32_16x16x32_bf16 v[126:129], v[186:189], a[116:119], v[126:129]
v_mfma_f32_16x16x32_bf16 v[134:137], v[186:189], a[140:143], v[134:137]
v_cvt_pk_bf16_f32 v118, v118, v119
v_cvt_pk_bf16_f32 v119, v120, v121
v_mfma_f32_16x16x32_bf16 v[90:93], a[236:239], v[186:189], v[90:93]
ds_read_u16 v120, v214 offset:1024
v_cvt_pk_bf16_f32 v126, v126, v127
v_mfma_f32_16x16x32_bf16 v[170:173], v[228:231], v[186:189], v[170:173]
v_cvt_pk_bf16_f32 v127, v128, v129
v_cvt_pk_bf16_f32 v134, v134, v135
v_mfma_f32_16x16x32_bf16 v[220:223], v[252:255], v[186:189], v[220:223]
ds_read_u16 v128, v214 offset:1032
v_cvt_pk_bf16_f32 v90, v90, v91
v_mfma_f32_16x16x32_bf16 v[150:153], v[190:193], v[174:177], 0
v_cvt_pk_bf16_f32 v91, v92, v93
v_cvt_pk_bf16_f32 v92, v170, v171
v_mfma_f32_16x16x32_bf16 v[138:141], v[114:117], v[174:177], 0
v_cvt_pk_bf16_f32 v93, v172, v173
v_cvt_pk_bf16_f32 v135, v136, v137
v_mfma_f32_16x16x32_bf16 v[142:145], v[122:125], v[174:177], 0
ds_read_u16 v136, v214 offset:1040
v_mov_b32 v121, 0
v_mfma_f32_16x16x32_bf16 v[146:149], v[130:133], v[174:177], 0
v_cvt_pk_bf16_f32 v174, v154, v155
v_cvt_pk_bf16_f32 v175, v156, v157
v_mfma_f32_16x16x32_bf16 v[150:153], v[190:193], v[178:181], v[150:153]
s_waitcnt lgkmcnt(2)
v_cvt_pk_bf16_f32 v176, v158, v159
v_cvt_pk_bf16_f32 v177, v160, v161
v_mfma_f32_16x16x32_bf16 v[138:141], v[118:121], v[178:181], v[138:141]
v_mov_b32 v129, 0
v_mov_b32 v137, 0
v_mfma_f32_16x16x32_bf16 v[154:157], v[114:117], v[174:177], 0
v_rcp_f32 v151, v150
v_mfma_f32_16x16x32_bf16 v[158:161], v[122:125], v[174:177], 0
s_waitcnt lgkmcnt(1)
v_max3_u32 v218, v218, v150, v151
v_mul_f32_e64 v151, s3, v151
v_mfma_f32_16x16x32_bf16 v[142:145], v[126:129], v[178:181], v[142:145]
s_waitcnt lgkmcnt(0)
v_mul_f32 v138, v138, v151
v_mul_f32_e64 v139, v139, v151
v_mfma_f32_16x16x32_bf16 v[146:149], v[134:137], v[178:181], v[146:149]
v_cvt_pk_bf16_f32 v180, v166, 0
v_mul_f32_e64 v140, v140, v151
v_mfma_f32_16x16x32_bf16 v[166:169], v[190:193], v[174:177], 0
v_mul_f32_e64 v141, v141, v151
v_cvt_pk_bf16_f32 v138, v138, v139
v_mul_f32 v142, v142, v151
v_mul_f32 v143, v143, v151
v_mul_f32 v144, v144, v151
v_mul_f32 v145, v145, v151
v_cvt_pk_bf16_f32 v139, v140, v141
v_cvt_pk_bf16_f32 v140, v142, v143
v_cvt_pk_bf16_f32 v141, v144, v145
v_cvt_pk_bf16_f32 v178, v162, v163
v_cvt_pk_bf16_f32 v179, v164, v165
v_mfma_f32_16x16x32_bf16 v[162:165], v[130:133], v[174:177], 0
ds_write_b128 v211, v[138:141] offset:38912
v_mfma_f32_16x16x32_bf16 v[138:141], v[78:81], v[90:93], 0
v_mul_f32 v146, v146, v151
v_mul_f32 v147, v147, v151
v_mfma_f32_16x16x32_bf16 v[166:169], v[190:193], v[178:181], v[166:169]
v_mul_f32 v148, v148, v151
v_mul_f32 v149, v149, v151
v_mfma_f32_16x16x32_bf16 v[154:157], v[118:121], v[178:181], v[154:157]
v_cvt_pk_bf16_f32 v142, v146, v147
v_cvt_pk_bf16_f32 v143, v148, v149
v_mfma_f32_16x16x32_bf16 v[158:161], v[126:129], v[178:181], v[158:161]
ds_write_b64 v212, v[142:143] offset:38912
v_mfma_f32_16x16x32_bf16 v[142:145], v[96:99], v[90:93], 0
v_rcp_f32_e64 v167, v166
v_mfma_f32_16x16x32_bf16 v[162:165], v[134:137], v[178:181], v[162:165]
v_max3_u32 v218, v218, v166, v167
v_cvt_pk_bf16_f32 v94, v220, v221
v_mfma_f32_16x16x32_bf16 v[150:153], v[108:111], v[90:93], v[206:209]
v_cvt_pk_bf16_f32 v95, v222, v223
v_mul_f32_e64 v167, s3, v167
v_mfma_f32_16x16x32_bf16 v[146:149], v[102:105], v[90:93], 0
v_mul_f32 v154, v154, v167
v_mul_f32 v155, v155, v167
v_mul_f32_e64 v156, v156, v167
v_mfma_f32_16x16x16_bf16 v[138:141], v[82:83], v[94:95], v[138:141]
v_mul_f32_e64 v157, v157, v167
v_cvt_pk_bf16_f32 v154, v154, v155
v_mul_f32_e64 v158, v158, v167
v_mfma_f32_16x16x16_bf16 v[142:145], v[100:101], v[94:95], v[142:145]
v_mul_f32 v159, v159, v167
v_mul_f32 v160, v160, v167
v_mul_f32_e64 v161, v161, v167
v_mfma_f32_16x16x16_bf16 v[150:153], v[112:113], v[94:95], v[150:153]
v_cvt_pk_bf16_f32 v155, v156, v157
v_cvt_pk_bf16_f32 v156, v158, v159
v_cvt_pk_bf16_f32 v157, v160, v161
v_mfma_f32_16x16x16_bf16 v[146:149], v[106:107], v[94:95], v[146:149]
v_mul_f32 v162, v162, v167
v_mul_f32 v163, v163, v167
v_mul_f32 v164, v164, v167
v_mul_f32 v165, v165, v167
v_mfma_f32_16x16x16_bf16 v[166:169], v[76:77], v[112:113], v[206:209]
v_cvt_pk_bf16_f32 v158, v162, v163
v_cvt_pk_bf16_f32 v159, v164, v165
v_exp_f32 v138, v138
v_mfma_f32_16x16x16_bf16 v[162:165], v[76:77], v[106:107], 0
v_exp_f32 v139, v139
v_exp_f32 v140, v140
v_mfma_f32_16x16x32_bf16 v[166:169], v[72:75], v[108:111], v[166:169]
ds_write_b128 v211, v[154:157] offset:45056
v_mfma_f32_16x16x16_bf16 v[154:157], v[76:77], v[82:83], 0
v_exp_f32 v141, v141
v_exp_f32 v142, v142
v_mfma_f32_16x16x32_bf16 v[162:165], v[72:75], v[102:105], v[162:165]
v_exp_f32 v143, v143
v_mfma_f32_16x16x32_bf16 v[154:157], v[72:75], v[78:81], v[154:157]
ds_write_b64 v212, v[158:159] offset:45056
v_mfma_f32_16x16x16_bf16 v[158:161], v[76:77], v[100:101], 0
v_exp_f32 v144, v144
v_exp_f32 v145, v145
v_exp_f32_e64 v150, v150
v_mfma_f32_16x16x32_bf16 v[158:161], v[72:75], v[96:99], v[158:161]
v_cvt_pk_bf16_f32 v174, v138, v139
v_cvt_pk_bf16_f32 v175, v140, v141
v_cvt_pk_bf16_f32 v176, v142, v143
v_cvt_pk_bf16_f32 v177, v144, v145
v_cvt_pk_bf16_f32 v180, v150, 0
v_exp_f32_e64 v146, v146
v_mfma_f32_16x16x32_bf16 v[150:153], v[190:193], v[174:177], 0
v_exp_f32 v147, v147
v_mfma_f32_16x16x32_bf16 v[138:141], v[114:117], v[174:177], 0
s_waitcnt lgkmcnt(0)
v_exp_f32 v148, v148
v_mfma_f32_16x16x32_bf16 v[142:145], v[122:125], v[174:177], 0
s_barrier
ds_read_b128 v[170:173], v210 offset:38912
ds_read_b128 v[182:185], v210 offset:39936
ds_read_b128 v[186:189], v210 offset:40960
v_exp_f32_e64 v149, v149
v_cvt_pk_bf16_f32 v178, v146, v147
v_cvt_pk_bf16_f32 v179, v148, v149
v_mfma_f32_16x16x32_bf16 v[146:149], v[130:133], v[174:177], 0
v_mov_b32_dpp v154, v158 quad_perm:[0,1,2,3] row_mask:0x2 bank_mask:0xf
v_mfma_f32_16x16x32_bf16 v[150:153], v[190:193], v[178:181], v[150:153]
v_mov_b32_dpp v154, v162 quad_perm:[0,1,2,3] row_mask:0x4 bank_mask:0xf
v_mfma_f32_16x16x32_bf16 v[138:141], v[118:121], v[178:181], v[138:141]
v_mov_b32_dpp v154, v167 quad_perm:[0,1,2,3] row_mask:0x8 bank_mask:0xf
v_exp_f32_e64 v154, v154
v_mfma_f32_16x16x32_bf16 v[142:145], v[126:129], v[178:181], v[142:145]
v_cvt_pk_bf16_f32 v154, v154, 0
v_rcp_f32 v151, v150
v_mfma_f32_16x16x32_bf16 v[146:149], v[134:137], v[178:181], v[146:149]
s_waitcnt lgkmcnt(2)
ds_write_b16 v214, v154
v_mfma_f32_16x16x32_bf16 v[0:3], a[144:147], v[170:173], v[0:3]
ds_read_b128 v[84:87], v215
ds_read_b128 v[88:91], v215 offset:16
v_mfma_f32_16x16x32_bf16 v[4:7], a[168:171], v[170:173], v[4:7]
v_add_u32 v215, 1552, v215
v_mfma_f32_16x16x32_bf16 v[8:11], a[192:195], v[170:173], v[8:11]
ds_read_b128 v[170:173], v210 offset:41984
s_waitcnt lgkmcnt(5)
v_mfma_f32_16x16x32_bf16 v[0:3], a[148:151], v[182:185], v[0:3]
v_mfma_f32_16x16x32_bf16 v[4:7], a[172:175], v[182:185], v[4:7]
v_mfma_f32_16x16x32_bf16 v[8:11], a[196:199], v[182:185], v[8:11]
ds_read_b128 v[182:185], v210 offset:43008
s_waitcnt lgkmcnt(3)
v_mfma_f32_16x16x32_bf16 v[166:169], v[84:87], v[190:193], 0
v_mfma_f32_16x16x32_bf16 v[154:157], v[84:87], v[114:117], 0
v_mfma_f32_16x16x32_bf16 v[158:161], v[84:87], v[122:125], 0
v_mfma_f32_16x16x32_bf16 v[162:165], v[84:87], v[130:133], 0
s_waitcnt lgkmcnt(2)
v_mfma_f32_16x16x32_bf16 v[166:169], v[88:91], v[190:193], v[166:169]
v_mfma_f32_16x16x32_bf16 v[154:157], v[88:91], v[118:121], v[154:157]
v_mfma_f32_16x16x32_bf16 v[158:161], v[88:91], v[126:129], v[158:161]
v_rcp_f32 v167, v166
v_mfma_f32_16x16x32_bf16 v[162:165], v[88:91], v[134:137], v[162:165]
v_max3_u32 v218, v218, v166, v167
v_max3_u32 v218, v218, v150, v151
v_mfma_f32_16x16x32_bf16 v[0:3], a[152:155], v[186:189], v[0:3]
v_mul_f32 v151, s3, v151
v_mul_f32 v138, v138, v151
v_mfma_f32_16x16x32_bf16 v[4:7], a[176:179], v[186:189], v[4:7]
v_mul_f32_e64 v139, v139, v151
v_mul_f32 v140, v140, v151
v_mfma_f32_16x16x32_bf16 v[8:11], a[200:203], v[186:189], v[8:11]
s_waitcnt lgkmcnt(1)
ds_read_b128 v[186:189], v210 offset:44032
v_mul_f32_e64 v141, v141, v151
v_mfma_f32_16x16x32_bf16 v[0:3], a[156:159], v[170:173], v[0:3]
v_cvt_pk_bf16_f32 v138, v138, v139
v_mul_f32_e64 v142, v142, v151
v_mfma_f32_16x16x32_bf16 v[4:7], a[180:183], v[170:173], v[4:7]
v_mul_f32_e64 v143, v143, v151
v_mul_f32 v144, v144, v151
v_mfma_f32_16x16x32_bf16 v[8:11], a[204:207], v[170:173], v[8:11]
s_waitcnt lgkmcnt(1)
ds_read_b128 v[170:173], v210 offset:45056
v_mul_f32_e64 v145, v145, v151
v_mfma_f32_16x16x32_bf16 v[0:3], a[160:163], v[182:185], v[0:3]
v_cvt_pk_bf16_f32 v139, v140, v141
v_cvt_pk_bf16_f32 v140, v142, v143
v_mfma_f32_16x16x32_bf16 v[4:7], a[184:187], v[182:185], v[4:7]
s_nop 0
v_cvt_pk_bf16_f32 v141, v144, v145
v_cmp_lt_u32 vcc, 1602224128, v218
v_mfma_f32_16x16x32_bf16 v[8:11], a[208:211], v[182:185], v[8:11]
s_waitcnt lgkmcnt(1)
ds_read_b128 v[182:185], v210 offset:46080
ds_write_b128 v211, v[138:141] offset:51200
v_mfma_f32_16x16x32_bf16 v[0:3], a[164:167], v[186:189], v[0:3]
s_or_b32 s41, vcc_lo, vcc_hi
v_mov_b32_dpp v154, v158 quad_perm:[0,1,2,3] row_mask:0x2 bank_mask:0xf
v_mul_f32 v146, v146, v151
v_mfma_f32_16x16x32_bf16 v[4:7], a[188:191], v[186:189], v[4:7]
v_mul_f32_e64 v147, v147, v151
v_mul_f32 v148, v148, v151
v_mfma_f32_16x16x32_bf16 v[8:11], a[212:215], v[186:189], v[8:11]
s_waitcnt lgkmcnt(2)
v_cvt_pk_bf16_f32 v72, v0, v1
v_cvt_pk_bf16_f32 v73, v2, v3
v_mfma_f32_16x16x32_bf16 v[12:15], a[144:147], v[170:173], v[12:15]
buffer_store_dwordx2 v[72:73], v203, s[8:11], s38 offen
ds_read_b128 v[186:189], v210 offset:47104
v_mfma_f32_16x16x32_bf16 v[16:19], a[168:171], v[170:173], v[16:19]
s_nop 0
v_cvt_pk_bf16_f32 v74, v4, v5
v_cvt_pk_bf16_f32 v75, v6, v7
v_mfma_f32_16x16x32_bf16 v[20:23], a[192:195], v[170:173], v[20:23]
s_waitcnt lgkmcnt(2)
ds_read_b128 v[170:173], v210 offset:48128
v_cvt_pk_bf16_f32 v76, v8, v9
v_mfma_f32_16x16x32_bf16 v[12:15], a[148:151], v[182:185], v[12:15]
v_cvt_pk_bf16_f32 v77, v10, v11
v_mul_f32_e64 v149, v149, v151
v_mfma_f32_16x16x32_bf16 v[16:19], a[172:175], v[182:185], v[16:19]
v_cvt_pk_bf16_f32 v142, v146, v147
v_cvt_pk_bf16_f32 v143, v148, v149
v_mfma_f32_16x16x32_bf16 v[20:23], a[196:199], v[182:185], v[20:23]
ds_write_b64 v212, v[142:143] offset:51200
v_mul_f32 v167, s3, v167
v_mov_b32_dpp v154, v162 quad_perm:[0,1,2,3] row_mask:0x4 bank_mask:0xf
s_waitcnt lgkmcnt(2)
v_mfma_f32_16x16x32_bf16 v[12:15], a[152:155], v[186:189], v[12:15]
ds_read_b128 v[182:185], v210 offset:49152
v_mul_f32_e64 v154, v154, v167
v_mfma_f32_16x16x32_bf16 v[16:19], a[176:179], v[186:189], v[16:19]
v_mov_b32 v69, s41
v_cvt_pk_bf16_f32 v154, v154, 0
v_mfma_f32_16x16x32_bf16 v[20:23], a[200:203], v[186:189], v[20:23]
s_waitcnt lgkmcnt(2)
ds_write_b32 v209, v69
v_mfma_f32_16x16x32_bf16 v[12:15], a[156:159], v[170:173], v[12:15]
ds_write_b16 v214, v154
v_mfma_f32_16x16x32_bf16 v[16:19], a[180:183], v[170:173], v[16:19]
ds_read_b128 v[186:189], v210 offset:50176
v_add_u32 v214, 1552, v214
v_mfma_f32_16x16x32_bf16 v[20:23], a[204:207], v[170:173], v[20:23]
buffer_store_dwordx2 v[74:75], v203, s[8:11], s38 offen offset:32
s_waitcnt lgkmcnt(3)
v_mfma_f32_16x16x32_bf16 v[12:15], a[160:163], v[182:185], v[12:15]
v_mfma_f32_16x16x32_bf16 v[16:19], a[184:187], v[182:185], v[16:19]
v_mfma_f32_16x16x32_bf16 v[20:23], a[208:211], v[182:185], v[20:23]
s_waitcnt lgkmcnt(1)
s_barrier
ds_read_b128 v[170:173], v210 offset:51200
ds_read_b128 v[182:185], v210 offset:52224
ds_read_b128 v[84:87], v63 offset:24832
s_waitcnt lgkmcnt(3)
v_mfma_f32_16x16x32_bf16 v[12:15], a[164:167], v[186:189], v[12:15]
ds_read_b128 v[88:91], v63 offset:24960
ds_read_b128 v[92:95], v63 offset:25088
v_mfma_f32_16x16x32_bf16 v[16:19], a[188:191], v[186:189], v[16:19]
ds_read_b128 v[96:99], v63 offset:25216
v_mfma_f32_16x16x32_bf16 v[20:23], a[212:215], v[186:189], v[20:23]
ds_read_b64 v[100:101], v63 offset:24848
ds_read_b64 v[102:103], v63 offset:24976
ds_read_b64 v[104:105], v63 offset:25104
v_cvt_pk_bf16_f32 v78, v12, v13
v_cvt_pk_bf16_f32 v79, v14, v15
v_cvt_pk_bf16_f32 v80, v16, v17
v_cvt_pk_bf16_f32 v81, v18, v19
v_cvt_pk_bf16_f32 v82, v20, v21
v_cvt_pk_bf16_f32 v83, v22, v23
s_waitcnt lgkmcnt(8)
v_mfma_f32_16x16x32_bf16 v[24:27], a[144:147], v[170:173], v[24:27]
s_nop 0
ds_read_b64 v[106:107], v63 offset:25232
ds_read_b128 v[186:189], v210 offset:53248
v_mfma_f32_16x16x32_bf16 v[28:31], a[168:171], v[170:173], v[28:31]
ds_read_b128 v[174:177], v210 offset:18432
v_mfma_f32_16x16x32_bf16 v[32:35], a[192:195], v[170:173], v[32:35]
s_nop 0
ds_read_b128 v[170:173], v210 offset:54272
s_waitcnt lgkmcnt(11)
v_mfma_f32_16x16x32_bf16 v[24:27], a[148:151], v[182:185], v[24:27]
s_waitcnt lgkmcnt(10)
v_mfma_f32_16x16x32_bf16 v[48:51], a[144:147], v[84:87], v[48:51]
v_mfma_f32_16x16x32_bf16 v[28:31], a[172:175], v[182:185], v[28:31]
buffer_store_dwordx2 v[76:77], v203, s[8:11], s38 offen offset:64
s_waitcnt lgkmcnt(9)
v_mfma_f32_16x16x32_bf16 v[48:51], a[148:151], v[88:91], v[48:51]
s_waitcnt lgkmcnt(8)
v_mfma_f32_16x16x32_bf16 v[48:51], a[152:155], v[92:95], v[48:51]
v_mfma_f32_16x16x32_bf16 v[32:35], a[196:199], v[182:185], v[32:35]
s_waitcnt lgkmcnt(1)
ds_read_b128 v[182:185], v210 offset:55296
v_or3_b32 v174, v174, v175, v176
v_mfma_f32_16x16x32_bf16 v[48:51], a[156:159], v[96:99], v[48:51]
v_or_b32 v174, v174, v177
v_mfma_f32_16x16x32_bf16 v[48:51], a[160:163], v[100:103], v[48:51]
v_readfirstlane_b32 s43, v174
v_mfma_f32_16x16x32_bf16 v[48:51], a[164:167], v[104:107], v[48:51]
v_mfma_f32_16x16x32_bf16 v[24:27], a[152:155], v[186:189], v[24:27]
v_mfma_f32_16x16x32_bf16 v[28:31], a[176:179], v[186:189], v[28:31]
v_cvt_pk_bf16_f32 v48, v48, v49
v_cvt_pk_bf16_f32 v49, v50, v51
v_mfma_f32_16x16x32_bf16 v[32:35], a[200:203], v[186:189], v[32:35]
ds_read_b128 v[186:189], v210 offset:56320
v_mfma_f32_16x16x32_bf16 v[52:55], a[168:171], v[84:87], v[52:55]
v_mfma_f32_16x16x32_bf16 v[52:55], a[172:175], v[88:91], v[52:55]
v_mfma_f32_16x16x32_bf16 v[52:55], a[176:179], v[92:95], v[52:55]
s_waitcnt lgkmcnt(2)
v_mfma_f32_16x16x32_bf16 v[24:27], a[156:159], v[170:173], v[24:27]
v_mfma_f32_16x16x32_bf16 v[52:55], a[180:183], v[96:99], v[52:55]
v_mfma_f32_16x16x32_bf16 v[28:31], a[180:183], v[170:173], v[28:31]
v_mfma_f32_16x16x32_bf16 v[52:55], a[184:187], v[100:103], v[52:55]
buffer_store_dwordx2 v[78:79], v204, s[8:11], s38 offen
v_mfma_f32_16x16x32_bf16 v[52:55], a[188:191], v[104:107], v[52:55]
v_mfma_f32_16x16x32_bf16 v[32:35], a[204:207], v[170:173], v[32:35]
s_waitcnt lgkmcnt(1)
v_mfma_f32_16x16x32_bf16 v[24:27], a[160:163], v[182:185], v[24:27]
v_cvt_pk_bf16_f32 v52, v52, v53
v_cvt_pk_bf16_f32 v53, v54, v55
v_mfma_f32_16x16x32_bf16 v[56:59], a[192:195], v[84:87], v[56:59]
v_mfma_f32_16x16x32_bf16 v[28:31], a[184:187], v[182:185], v[28:31]
v_mfma_f32_16x16x32_bf16 v[56:59], a[196:199], v[88:91], v[56:59]
v_mfma_f32_16x16x32_bf16 v[56:59], a[200:203], v[92:95], v[56:59]
v_mfma_f32_16x16x32_bf16 v[32:35], a[208:211], v[182:185], v[32:35]
v_mfma_f32_16x16x32_bf16 v[56:59], a[204:207], v[96:99], v[56:59]
v_mfma_f32_16x16x32_bf16 v[56:59], a[208:211], v[100:103], v[56:59]
s_nop 0
v_mfma_f32_16x16x32_bf16 v[56:59], a[212:215], v[104:107], v[56:59]
s_waitcnt lgkmcnt(0)
v_mfma_f32_16x16x32_bf16 v[24:27], a[164:167], v[186:189], v[24:27]
v_mfma_f32_16x16x32_bf16 v[28:31], a[188:191], v[186:189], v[28:31]
v_cvt_pk_bf16_f32 v56, v56, v57
v_cvt_pk_bf16_f32 v57, v58, v59
v_mfma_f32_16x16x32_bf16 v[32:35], a[212:215], v[186:189], v[32:35]
v_cvt_pk_bf16_f32 v116, v24, v25
v_cvt_pk_bf16_f32 v117, v26, v27
s_nop 0
v_cvt_pk_bf16_f32 v124, v28, v29
buffer_store_dwordx2 v[80:81], v204, s[8:11], s38 offen offset:32
v_cvt_pk_bf16_f32 v125, v30, v31
s_nop 0
v_cvt_pk_bf16_f32 v132, v32, v33
v_cvt_pk_bf16_f32 v133, v34, v35
buffer_store_dwordx2 v[82:83], v204, s[8:11], s38 offen offset:64
buffer_store_dwordx2 v[116:117], v205, s[8:11], s38 offen
buffer_store_dwordx2 v[124:125], v205, s[8:11], s38 offen offset:32
buffer_store_dwordx2 v[48:49], v66, s[8:11], 0 offen
buffer_store_dwordx2 v[52:53], v66, s[8:11], 0 offen offset:32
buffer_store_dwordx2 v[56:57], v66, s[8:11], 0 offen offset:64
buffer_store_dwordx2 v[132:133], v205, s[8:11], s38 offen offset:64
s_nop 1
s_cmp_lg_u32 s43, 0
s_cbranch_scc1 L_redo
L_end:
s_endpgm
L_redo:
s_mov_b32 s47, 1
s_waitcnt vmcnt(0) lgkmcnt(0)
s_barrier
s_branch L_start
L_safe:
.p2align 3
s_add_u32 s28, s28, 32
s_cmp_ge_u32 s28, 73
s_cselect_b32 s21, 73, 0
s_cselect_b32 s22, 1177344, 0
s_sub_u32 s28, s28, s21
s_add_u32 s20, s20, s22
s_add_u32 s20, s20, 86016
s_add_u32 m0, s96, 71488
s_mov_b32 exec_hi, 4194303
buffer_load_dwordx4 v82, s[4:7], s20 offen nt lds
s_mov_b32 exec_hi, -1
s_add_u32 s28, s28, 32
s_cmp_ge_u32 s28, 73
s_cselect_b32 s21, 73, 0
s_cselect_b32 s22, 1177344, 0
s_sub_u32 s28, s28, s21
s_add_u32 s20, s20, s22
s_add_u32 s20, s20, 86016
s_add_u32 m0, s96, 74960
s_mov_b32 exec_hi, 4194303
buffer_load_dwordx4 v82, s[4:7], s20 offen nt lds
s_mov_b32 exec_hi, -1
s_add_u32 s28, s28, 32
s_cmp_ge_u32 s28, 73
s_cselect_b32 s21, 73, 0
s_cselect_b32 s22, 1177344, 0
s_sub_u32 s28, s28, s21
s_add_u32 s20, s20, s22
s_add_u32 s20, s20, 86016
s_add_u32 m0, s96, 78432
s_mov_b32 exec_hi, 4194303
buffer_load_dwordx4 v82, s[4:7], s20 offen nt lds
s_mov_b32 exec_hi, -1
s_add_u32 s28, s28, 32
s_cmp_ge_u32 s28, 73
s_cselect_b32 s21, 73, 0
s_cselect_b32 s22, 1177344, 0
s_sub_u32 s28, s28, s21
s_add_u32 s20, s20, s22
s_add_u32 s20, s20, 86016
s_add_u32 m0, s96, 81904
s_mov_b32 exec_hi, 4194303
buffer_load_dwordx4 v82, s[4:7], s20 offen nt lds
s_mov_b32 exec_hi, -1
s_add_u32 s28, s28, 32
s_cmp_ge_u32 s28, 73
s_cselect_b32 s21, 73, 0
s_cselect_b32 s22, 1177344, 0
s_sub_u32 s28, s28, s21
s_add_u32 s20, s20, s22
s_add_u32 s20, s20, 86016
s_add_u32 m0, s96, 85376
s_mov_b32 exec_hi, 4194303
buffer_load_dwordx4 v82, s[4:7], s20 offen nt lds
s_mov_b32 exec_hi, -1
s_add_u32 s28, s28, 32
s_cmp_ge_u32 s28, 73
s_cselect_b32 s21, 73, 0
s_cselect_b32 s22, 1177344, 0
s_sub_u32 s28, s28, s21
s_add_u32 s20, s20, s22
s_add_u32 s20, s20, 86016
s_add_u32 m0, s96, 88848
s_mov_b32 exec_hi, 4194303
buffer_load_dwordx4 v82, s[4:7], s20 offen nt lds
s_mov_b32 exec_hi, -1
s_add_u32 s28, s28, 32
s_cmp_ge_u32 s28, 73
s_cselect_b32 s21, 73, 0
s_cselect_b32 s22, 1177344, 0
s_sub_u32 s28, s28, s21
s_add_u32 s20, s20, s22
s_add_u32 s20, s20, 86016
s_add_u32 m0, s96, 92320
s_mov_b32 exec_hi, 4194303
buffer_load_dwordx4 v82, s[4:7], s20 offen nt lds
s_mov_b32 exec_hi, -1
s_add_u32 s28, s28, 32
s_cmp_ge_u32 s28, 73
s_cselect_b32 s21, 73, 0
s_cselect_b32 s22, 1177344, 0
s_sub_u32 s28, s28, s21
s_add_u32 s20, s20, s22
s_add_u32 s20, s20, 86016
s_add_u32 m0, s96, 95792
s_mov_b32 exec_hi, 4194303
buffer_load_dwordx4 v82, s[4:7], s20 offen nt lds
s_mov_b32 exec_hi, -1
s_add_u32 s28, s28, 32
s_cmp_ge_u32 s28, 73
s_cselect_b32 s21, 73, 0
s_cselect_b32 s22, 1177344, 0
s_sub_u32 s28, s28, s21
s_add_u32 s20, s20, s22
s_add_u32 s20, s20, 86016
s_add_u32 m0, s96, 99264
s_mov_b32 exec_hi, 4194303
buffer_load_dwordx4 v82, s[4:7], s20 offen nt lds
s_mov_b32 exec_hi, -1
s_add_u32 s28, s28, 32
s_cmp_ge_u32 s28, 73
s_cselect_b32 s21, 73, 0
s_cselect_b32 s22, 1177344, 0
s_sub_u32 s28, s28, s21
s_add_u32 s20, s20, s22
s_add_u32 s20, s20, 86016
s_add_u32 m0, s96, 102736
s_mov_b32 exec_hi, 4194303
buffer_load_dwordx4 v82, s[4:7], s20 offen nt lds
s_mov_b32 exec_hi, -1
s_add_u32 s28, s28, 32
s_cmp_ge_u32 s28, 73
s_cselect_b32 s21, 73, 0
s_cselect_b32 s22, 1177344, 0
s_sub_u32 s28, s28, s21
s_add_u32 s20, s20, s22
s_add_u32 s20, s20, 86016
s_add_u32 m0, s96, 106208
s_mov_b32 exec_hi, 4194303
buffer_load_dwordx4 v82, s[4:7], s20 offen nt lds
s_mov_b32 exec_hi, -1
s_add_u32 s28, s28, 32
s_cmp_ge_u32 s28, 73
s_cselect_b32 s21, 73, 0
s_cselect_b32 s22, 1177344, 0
s_sub_u32 s28, s28, s21
s_add_u32 s20, s20, s22
s_add_u32 s20, s20, 86016
s_add_u32 m0, s96, 109680
s_mov_b32 exec_hi, 4194303
buffer_load_dwordx4 v82, s[4:7], s20 offen nt lds
s_mov_b32 exec_hi, -1
s_add_u32 s28, s28, 32
s_cmp_ge_u32 s28, 73
s_cselect_b32 s21, 73, 0
s_cselect_b32 s22, 1177344, 0
s_sub_u32 s28, s28, s21
s_add_u32 s20, s20, s22
s_add_u32 s20, s20, 86016
s_add_u32 m0, s96, 113152
s_mov_b32 exec_hi, 4194303
buffer_load_dwordx4 v82, s[4:7], s20 offen nt lds
s_mov_b32 exec_hi, -1
s_add_u32 s28, s28, 32
s_cmp_ge_u32 s28, 73
s_cselect_b32 s21, 73, 0
s_cselect_b32 s22, 1177344, 0
s_sub_u32 s28, s28, s21
s_add_u32 s20, s20, s22
s_add_u32 s20, s20, 86016
s_add_u32 m0, s96, 116624
s_mov_b32 exec_hi, 4194303
buffer_load_dwordx4 v82, s[4:7], s20 offen nt lds
s_mov_b32 exec_hi, -1
s_add_u32 s28, s28, 32
s_cmp_ge_u32 s28, 73
s_cselect_b32 s21, 73, 0
s_cselect_b32 s22, 1177344, 0
s_sub_u32 s28, s28, s21
s_add_u32 s20, s20, s22
s_add_u32 s20, s20, 86016
s_add_u32 m0, s96, 120096
s_mov_b32 exec_hi, 4194303
buffer_load_dwordx4 v82, s[4:7], s20 offen nt lds
s_mov_b32 exec_hi, -1
s_add_u32 s28, s28, 32
s_cmp_ge_u32 s28, 73
s_cselect_b32 s21, 73, 0
s_cselect_b32 s22, 1177344, 0
s_sub_u32 s28, s28, s21
s_add_u32 s20, s20, s22
s_add_u32 s20, s20, 86016
s_add_u32 m0, s96, 123568
s_mov_b32 exec_hi, 4194303
buffer_load_dwordx4 v82, s[4:7], s20 offen nt lds
s_mov_b32 exec_hi, -1
s_add_u32 s28, s28, 32
s_cmp_ge_u32 s28, 73
s_cselect_b32 s21, 73, 0
s_cselect_b32 s22, 1177344, 0
s_sub_u32 s28, s28, s21
s_add_u32 s20, s20, s22
s_add_u32 s20, s20, 86016
s_add_u32 s21, s33, 640
s_cmp_lt_u32 s21, s34
s_cselect_b32 s20, s20, 1879048192
s_add_u32 m0, s96, 127040
s_mov_b32 exec_hi, 4194303
buffer_load_dwordx4 v82, s[4:7], s20 offen nt lds
s_mov_b32 exec_hi, -1
s_add_u32 m0, s55, 131328
s_add_u32 s29, s54, 384
buffer_load_dwordx4 v72, s[12:15], s29 offen lds
s_add_u32 m0, s55, 132352
s_add_u32 s29, s54, 384
buffer_load_dwordx4 v73, s[12:15], s29 offen lds
s_add_u32 m0, s55, 133376
s_add_u32 s29, s54, 384
buffer_load_dwordx4 v74, s[12:15], s29 offen lds
ds_read_b128 v[84:87], v200
s_waitcnt lgkmcnt(0)
v_mfma_f32_16x16x32_bf16 v[0:3], v[138:141], v[84:87], 0
ds_read_b128 v[92:95], v201
s_waitcnt lgkmcnt(0)
v_mfma_f32_16x16x32_bf16 v[12:15], v[138:141], v[92:95], 0
ds_read_b128 v[100:103], v202
s_waitcnt lgkmcnt(0)
v_mfma_f32_16x16x32_bf16 v[24:27], v[138:141], v[100:103], 0
ds_read_b128 v[84:87], v194
ds_read_b128 v[88:91], v194 offset:16
s_waitcnt lgkmcnt(0)
v_smfmac_f32_16x16x64_bf16 v[0:3], v[142:145], v[84:91], v213
ds_read_b128 v[92:95], v195
ds_read_b128 v[96:99], v195 offset:16
s_waitcnt lgkmcnt(0)
v_smfmac_f32_16x16x64_bf16 v[12:15], v[142:145], v[92:99], v213
ds_read_b128 v[100:103], v196
ds_read_b128 v[104:107], v196 offset:16
s_waitcnt lgkmcnt(0)
v_smfmac_f32_16x16x64_bf16 v[24:27], v[142:145], v[100:107], v213
ds_read_b128 v[84:87], v197
ds_read_b128 v[88:91], v197 offset:16
s_waitcnt lgkmcnt(0)
v_smfmac_f32_16x16x64_bf16 v[0:3], v[146:149], v[84:91], v213
ds_read_b128 v[92:95], v198
ds_read_b128 v[96:99], v198 offset:16
s_waitcnt lgkmcnt(0)
v_smfmac_f32_16x16x64_bf16 v[12:15], v[146:149], v[92:99], v213
ds_read_b128 v[100:103], v199
ds_read_b128 v[104:107], v199 offset:16
s_waitcnt lgkmcnt(0)
v_smfmac_f32_16x16x64_bf16 v[24:27], v[146:149], v[100:107], v213
ds_read_b128 v[84:87], v200 offset:32
s_waitcnt lgkmcnt(0)
v_mfma_f32_16x16x32_bf16 v[4:7], v[150:153], v[84:87], 0
ds_read_b128 v[92:95], v201 offset:32
s_waitcnt lgkmcnt(0)
v_mfma_f32_16x16x32_bf16 v[16:19], v[150:153], v[92:95], 0
ds_read_b128 v[100:103], v202 offset:32
s_waitcnt lgkmcnt(0)
v_mfma_f32_16x16x32_bf16 v[28:31], v[150:153], v[100:103], 0
ds_read_b128 v[84:87], v194 offset:32
ds_read_b128 v[88:91], v194 offset:48
s_waitcnt lgkmcnt(0)
v_smfmac_f32_16x16x64_bf16 v[4:7], v[154:157], v[84:91], v213
ds_read_b128 v[92:95], v195 offset:32
ds_read_b128 v[96:99], v195 offset:48
s_waitcnt lgkmcnt(0)
v_smfmac_f32_16x16x64_bf16 v[16:19], v[154:157], v[92:99], v213
ds_read_b128 v[100:103], v196 offset:32
ds_read_b128 v[104:107], v196 offset:48
s_waitcnt lgkmcnt(0)
v_smfmac_f32_16x16x64_bf16 v[28:31], v[154:157], v[100:107], v213
ds_read_b128 v[84:87], v197 offset:32
ds_read_b128 v[88:91], v197 offset:48
s_waitcnt lgkmcnt(0)
v_smfmac_f32_16x16x64_bf16 v[4:7], v[158:161], v[84:91], v213
ds_read_b128 v[92:95], v198 offset:32
ds_read_b128 v[96:99], v198 offset:48
s_waitcnt lgkmcnt(0)
v_smfmac_f32_16x16x64_bf16 v[16:19], v[158:161], v[92:99], v213
ds_read_b128 v[100:103], v199 offset:32
ds_read_b128 v[104:107], v199 offset:48
s_waitcnt lgkmcnt(0)
v_smfmac_f32_16x16x64_bf16 v[28:31], v[158:161], v[100:107], v213
ds_read_b128 v[84:87], v200 offset:64
s_waitcnt lgkmcnt(0)
v_mfma_f32_16x16x32_bf16 v[8:11], v[162:165], v[84:87], 0
ds_read_b128 v[92:95], v201 offset:64
s_waitcnt lgkmcnt(0)
v_mfma_f32_16x16x32_bf16 v[20:23], v[162:165], v[92:95], 0
ds_read_b128 v[100:103], v202 offset:64
s_waitcnt lgkmcnt(0)
v_mfma_f32_16x16x32_bf16 v[32:35], v[162:165], v[100:103], 0
ds_read_b128 v[84:87], v194 offset:64
ds_read_b128 v[88:91], v194 offset:80
s_waitcnt lgkmcnt(0)
v_smfmac_f32_16x16x64_bf16 v[8:11], v[166:169], v[84:91], v213
ds_read_b128 v[92:95], v195 offset:64
ds_read_b128 v[96:99], v195 offset:80
s_waitcnt lgkmcnt(0)
v_smfmac_f32_16x16x64_bf16 v[20:23], v[166:169], v[92:99], v213
ds_read_b128 v[100:103], v196 offset:64
ds_read_b128 v[104:107], v196 offset:80
s_waitcnt lgkmcnt(0)
v_smfmac_f32_16x16x64_bf16 v[32:35], v[166:169], v[100:107], v213
ds_read_b128 v[84:87], v197 offset:64
ds_read_b128 v[88:91], v197 offset:80
s_waitcnt lgkmcnt(0)
v_smfmac_f32_16x16x64_bf16 v[8:11], v[170:173], v[84:91], v213
ds_read_b128 v[92:95], v198 offset:64
ds_read_b128 v[96:99], v198 offset:80
s_waitcnt lgkmcnt(0)
v_smfmac_f32_16x16x64_bf16 v[20:23], v[170:173], v[92:99], v213
ds_read_b128 v[100:103], v199 offset:64
ds_read_b128 v[104:107], v199 offset:80
s_waitcnt lgkmcnt(0)
v_smfmac_f32_16x16x64_bf16 v[32:35], v[170:173], v[100:107], v213
v_add_f32 v118, v0, v1
v_mul_f32 v119, v0, v0
v_add_f32 v118, v118, v2
v_fmac_f32 v119, v1, v1
v_add_f32 v118, v118, v3
v_fmac_f32 v119, v2, v2
v_fmac_f32 v119, v3, v3
v_add_f32 v126, v12, v13
v_mul_f32 v127, v12, v12
v_add_f32 v126, v126, v14
v_fmac_f32 v127, v13, v13
v_add_f32 v126, v126, v15
v_fmac_f32 v127, v14, v14
v_fmac_f32 v127, v15, v15
v_add_f32 v134, v24, v25
v_mul_f32 v135, v24, v24
v_add_f32 v134, v134, v26
v_fmac_f32 v135, v25, v25
v_add_f32 v134, v134, v27
v_fmac_f32 v135, v26, v26
v_fmac_f32 v135, v27, v27
v_add_f32 v118, v118, v4
v_fmac_f32 v119, v4, v4
v_add_f32 v118, v118, v5
v_fmac_f32 v119, v5, v5
v_add_f32 v118, v118, v6
v_fmac_f32 v119, v6, v6
v_add_f32 v118, v118, v7
v_fmac_f32 v119, v7, v7
v_add_f32 v126, v126, v16
v_fmac_f32 v127, v16, v16
v_add_f32 v126, v126, v17
v_fmac_f32 v127, v17, v17
v_add_f32 v126, v126, v18
v_fmac_f32 v127, v18, v18
v_add_f32 v126, v126, v19
v_fmac_f32 v127, v19, v19
v_add_f32 v134, v134, v28
v_fmac_f32 v135, v28, v28
v_add_f32 v134, v134, v29
v_fmac_f32 v135, v29, v29
v_add_f32 v134, v134, v30
v_fmac_f32 v135, v30, v30
v_add_f32 v134, v134, v31
v_fmac_f32 v135, v31, v31
v_add_f32 v118, v118, v8
v_fmac_f32 v119, v8, v8
v_add_f32 v118, v118, v9
v_fmac_f32 v119, v9, v9
v_add_f32 v118, v118, v10
v_fmac_f32 v119, v10, v10
v_add_f32 v118, v118, v11
v_fmac_f32 v119, v11, v11
v_add_f32 v126, v126, v20
v_fmac_f32 v127, v20, v20
v_add_f32 v126, v126, v21
v_fmac_f32 v127, v21, v21
v_add_f32 v126, v126, v22
v_fmac_f32 v127, v22, v22
v_add_f32 v126, v126, v23
v_fmac_f32 v127, v23, v23
v_add_f32 v134, v134, v32
v_fmac_f32 v135, v32, v32
v_add_f32 v134, v134, v33
v_fmac_f32 v135, v33, v33
v_add_f32 v134, v134, v34
v_fmac_f32 v135, v34, v34
v_add_f32 v134, v134, v35
v_fmac_f32 v135, v35, v35
v_permlane16_swap_b32 v118, v119
v_add_f32 v118, v118, v119
v_permlane16_swap_b32 v126, v127
v_add_f32 v126, v126, v127
v_permlane16_swap_b32 v134, v135
v_add_f32 v134, v134, v135
v_permlane32_swap_b32 v118, v126
v_add_f32 v118, v118, v126
ds_write_b32 v209, v118
v_mov_b32 v135, v134
s_nop 1
v_permlane32_swap_b32 v134, v135
v_add_f32 v134, v134, v135
ds_write_b32 v209, v134 offset:512
s_waitcnt lgkmcnt(0)
s_barrier
ds_read_b128 v[102:105], v210 offset:18432
ds_read_b128 v[106:109], v210 offset:19456
s_waitcnt lgkmcnt(1)
v_add_f32 v102, v102, v103
s_waitcnt lgkmcnt(0)
v_add_f32 v106, v106, v107
v_add_f32 v104, v104, v105
v_add_f32 v108, v108, v109
v_add_f32 v102, v102, v104
v_add_f32 v106, v106, v108
v_mul_f32 v103, s48, v102
v_mul_f32 v104, s73, v102
v_mul_f32 v106, s73, v106
v_fma_f32 v106, -v103, v104, v106
v_max_f32 v106, 0, v106
v_add_f32 v106, s49, v106
v_rsq_f32 v102, v106
s_nop 0
v_mul_f32_e64 v103, -v103, v102
ds_write_b64 v211, v[102:103]
ds_read_b64 v[118:119], v219
ds_read_b64 v[126:127], v219 offset:256
ds_read_b64 v[134:135], v219 offset:512
s_waitcnt lgkmcnt(2)
v_fma_f32 v220, v0, v118, v119
v_fma_f32 v221, v1, v118, v119
v_cvt_pk_bf16_f32 v90, v220, v221
v_fma_f32 v222, v2, v118, v119
v_fma_f32 v223, v3, v118, v119
v_cvt_pk_bf16_f32 v91, v222, v223
v_fma_f32 v220, v4, v118, v119
v_fma_f32 v221, v5, v118, v119
v_cvt_pk_bf16_f32 v92, v220, v221
v_fma_f32 v222, v6, v118, v119
v_fma_f32 v223, v7, v118, v119
v_cvt_pk_bf16_f32 v93, v222, v223
ds_write_b128 v211, v[90:93]
v_fma_f32 v220, v8, v118, v119
v_fma_f32 v221, v9, v118, v119
v_cvt_pk_bf16_f32 v94, v220, v221
v_fma_f32 v222, v10, v118, v119
v_fma_f32 v223, v11, v118, v119
v_cvt_pk_bf16_f32 v95, v222, v223
s_waitcnt lgkmcnt(2)
ds_write_b64 v212, v[94:95]
v_fma_f32 v220, v12, v126, v127
v_fma_f32 v221, v13, v126, v127
v_cvt_pk_bf16_f32 v174, v220, v221
v_fma_f32 v222, v14, v126, v127
v_fma_f32 v223, v15, v126, v127
v_cvt_pk_bf16_f32 v175, v222, v223
v_fma_f32 v220, v16, v126, v127
v_fma_f32 v221, v17, v126, v127
v_cvt_pk_bf16_f32 v176, v220, v221
v_fma_f32 v222, v18, v126, v127
v_fma_f32 v223, v19, v126, v127
v_cvt_pk_bf16_f32 v177, v222, v223
ds_write_b128 v211, v[174:177] offset:6144
v_fma_f32 v220, v20, v126, v127
v_fma_f32 v221, v21, v126, v127
v_cvt_pk_bf16_f32 v178, v220, v221
v_fma_f32 v222, v22, v126, v127
v_fma_f32 v223, v23, v126, v127
v_cvt_pk_bf16_f32 v179, v222, v223
s_waitcnt lgkmcnt(3)
ds_write_b64 v212, v[178:179] offset:6144
v_fma_f32 v220, v24, v134, v135
v_fma_f32 v221, v25, v134, v135
v_cvt_pk_bf16_f32 v90, v220, v221
v_fma_f32 v222, v26, v134, v135
v_fma_f32 v223, v27, v134, v135
v_cvt_pk_bf16_f32 v91, v222, v223
v_fma_f32 v220, v28, v134, v135
v_fma_f32 v221, v29, v134, v135
v_cvt_pk_bf16_f32 v92, v220, v221
v_fma_f32 v222, v30, v134, v135
v_fma_f32 v223, v31, v134, v135
v_cvt_pk_bf16_f32 v93, v222, v223
ds_write_b128 v211, v[90:93] offset:12288
v_fma_f32 v220, v32, v134, v135
v_fma_f32 v221, v33, v134, v135
v_cvt_pk_bf16_f32 v94, v220, v221
v_fma_f32 v222, v34, v134, v135
v_fma_f32 v223, v35, v134, v135
v_cvt_pk_bf16_f32 v95, v222, v223
ds_write_b64 v212, v[94:95] offset:12288
s_mov_b64 exec, s[30:31]
ds_write_b128 v217, v[138:141]
s_mov_b64 exec, -1
s_mov_b64 exec, s[30:31]
ds_write_b128 v217, v[142:145] offset:528
s_mov_b64 exec, -1
s_mov_b64 exec, s[30:31]
ds_write_b128 v217, v[146:149] offset:1056
s_mov_b64 exec, -1
s_mov_b64 exec, s[30:31]
ds_write_b128 v217, v[150:153] offset:1584
s_mov_b64 exec, -1
s_mov_b64 exec, s[30:31]
ds_write_b128 v217, v[154:157] offset:2112
s_mov_b64 exec, -1
s_mov_b64 exec, s[30:31]
ds_write_b128 v217, v[158:161] offset:2640
s_mov_b64 exec, -1
s_mov_b64 exec, s[30:31]
ds_write_b128 v217, v[162:165] offset:3168
s_mov_b64 exec, -1
s_mov_b64 exec, s[30:31]
ds_write_b128 v217, v[166:169] offset:3696
s_mov_b64 exec, -1
s_mov_b64 exec, s[30:31]
ds_write_b128 v217, v[170:173] offset:4224
s_mov_b64 exec, -1
s_add_u32 m0, s55, 0
s_add_u32 s29, s54, 37248
buffer_load_dwordx4 v72, s[12:15], s29 offen lds
s_add_u32 m0, s55, 1024
s_add_u32 s29, s54, 37248
buffer_load_dwordx4 v73, s[12:15], s29 offen lds
s_add_u32 m0, s55, 2048
s_add_u32 s29, s54, 37248
buffer_load_dwordx4 v74, s[12:15], s29 offen lds
s_add_u32 m0, s55, 12288
s_add_u32 s29, s54, 74112
buffer_load_dwordx4 v72, s[12:15], s29 offen lds
s_add_u32 m0, s55, 13312
s_add_u32 s29, s54, 74112
buffer_load_dwordx4 v73, s[12:15], s29 offen lds
s_add_u32 m0, s55, 14336
s_add_u32 s29, s54, 74112
buffer_load_dwordx4 v74, s[12:15], s29 offen lds
s_add_u32 m0, s55, 24576
s_add_u32 s29, s54, 110976
buffer_load_dwordx4 v72, s[12:15], s29 offen lds
s_add_u32 m0, s55, 25600
s_add_u32 s29, s54, 110976
buffer_load_dwordx4 v73, s[12:15], s29 offen lds
s_waitcnt vmcnt(11) lgkmcnt(9)
s_add_u32 m0, s55, 26624
s_add_u32 s29, s54, 110976
buffer_load_dwordx4 v74, s[12:15], s29 offen lds
s_barrier
ds_read_b128 v[84:87], v113
s_waitcnt lgkmcnt(0)
v_mfma_f32_16x16x32_bf16 v[36:39], v[138:141], v[84:87], 0
ds_read_b128 v[92:95], v113 offset:55552
s_waitcnt lgkmcnt(0)
v_mfma_f32_16x16x32_bf16 v[48:51], v[138:141], v[92:95], 0
ds_read_b128 v[100:103], v111
ds_read_b128 v[104:107], v111 offset:16
s_waitcnt lgkmcnt(0)
v_smfmac_f32_16x16x64_bf16 v[36:39], v[142:145], v[100:107], v213
ds_read_b128 v[84:87], v111 offset:55552
ds_read_b128 v[88:91], v111 offset:55568
s_waitcnt lgkmcnt(0)
v_smfmac_f32_16x16x64_bf16 v[48:51], v[142:145], v[84:91], v213
ds_read_b128 v[92:95], v112
ds_read_b128 v[96:99], v112 offset:16
s_waitcnt lgkmcnt(0)
v_smfmac_f32_16x16x64_bf16 v[36:39], v[146:149], v[92:99], v213
ds_read_b128 v[100:103], v112 offset:55552
ds_read_b128 v[104:107], v112 offset:55568
s_waitcnt lgkmcnt(0)
v_smfmac_f32_16x16x64_bf16 v[48:51], v[146:149], v[100:107], v213
ds_read_b128 v[84:87], v113 offset:32
s_waitcnt lgkmcnt(0)
v_mfma_f32_16x16x32_bf16 v[40:43], v[150:153], v[84:87], 0
ds_read_b128 v[92:95], v113 offset:55584
s_waitcnt lgkmcnt(0)
v_mfma_f32_16x16x32_bf16 v[52:55], v[150:153], v[92:95], 0
ds_read_b128 v[100:103], v111 offset:32
ds_read_b128 v[104:107], v111 offset:48
s_waitcnt lgkmcnt(0)
v_smfmac_f32_16x16x64_bf16 v[40:43], v[154:157], v[100:107], v213
ds_read_b128 v[84:87], v111 offset:55584
ds_read_b128 v[88:91], v111 offset:55600
s_waitcnt lgkmcnt(0)
v_smfmac_f32_16x16x64_bf16 v[52:55], v[154:157], v[84:91], v213
ds_read_b128 v[92:95], v112 offset:32
ds_read_b128 v[96:99], v112 offset:48
s_waitcnt lgkmcnt(0)
v_smfmac_f32_16x16x64_bf16 v[40:43], v[158:161], v[92:99], v213
ds_read_b128 v[100:103], v112 offset:55584
ds_read_b128 v[104:107], v112 offset:55600
s_waitcnt lgkmcnt(0)
v_smfmac_f32_16x16x64_bf16 v[52:55], v[158:161], v[100:107], v213
ds_read_b128 v[84:87], v113 offset:64
s_waitcnt lgkmcnt(0)
v_mfma_f32_16x16x32_bf16 v[44:47], v[162:165], v[84:87], 0
ds_read_b128 v[92:95], v113 offset:55616
s_waitcnt lgkmcnt(0)
v_mfma_f32_16x16x32_bf16 v[56:59], v[162:165], v[92:95], 0
ds_read_b128 v[100:103], v111 offset:64
ds_read_b128 v[104:107], v111 offset:80
s_waitcnt lgkmcnt(0)
v_smfmac_f32_16x16x64_bf16 v[44:47], v[166:169], v[100:107], v213
ds_read_b128 v[84:87], v111 offset:55616
ds_read_b128 v[88:91], v111 offset:55632
s_waitcnt lgkmcnt(0)
v_smfmac_f32_16x16x64_bf16 v[56:59], v[166:169], v[84:91], v213
ds_read_b128 v[92:95], v112 offset:64
ds_read_b128 v[96:99], v112 offset:80
s_waitcnt lgkmcnt(0)
v_smfmac_f32_16x16x64_bf16 v[44:47], v[170:173], v[92:99], v213
ds_read_b128 v[100:103], v112 offset:55616
ds_read_b128 v[104:107], v112 offset:55632
s_waitcnt lgkmcnt(0)
v_smfmac_f32_16x16x64_bf16 v[56:59], v[170:173], v[100:107], v213
s_barrier
v_add_f32 v118, v36, v37
v_mul_f32 v119, v36, v36
v_add_f32 v118, v118, v38
v_fmac_f32 v119, v37, v37
v_add_f32 v118, v118, v39
v_fmac_f32 v119, v38, v38
v_fmac_f32 v119, v39, v39
v_add_f32 v126, v48, v49
v_mul_f32 v127, v48, v48
v_add_f32 v126, v126, v50
v_fmac_f32 v127, v49, v49
v_add_f32 v126, v126, v51
v_fmac_f32 v127, v50, v50
v_fmac_f32 v127, v51, v51
v_add_f32 v118, v118, v40
v_fmac_f32 v119, v40, v40
v_add_f32 v118, v118, v41
v_fmac_f32 v119, v41, v41
v_add_f32 v118, v118, v42
v_fmac_f32 v119, v42, v42
v_add_f32 v118, v118, v43
v_fmac_f32 v119, v43, v43
v_add_f32 v126, v126, v52
v_fmac_f32 v127, v52, v52
v_add_f32 v126, v126, v53
v_fmac_f32 v127, v53, v53
v_add_f32 v126, v126, v54
v_fmac_f32 v127, v54, v54
v_add_f32 v126, v126, v55
v_fmac_f32 v127, v55, v55
v_add_f32 v118, v118, v44
v_fmac_f32 v119, v44, v44
v_add_f32 v118, v118, v45
v_fmac_f32 v119, v45, v45
v_add_f32 v118, v118, v46
v_fmac_f32 v119, v46, v46
v_add_f32 v118, v118, v47
v_fmac_f32 v119, v47, v47
v_add_f32 v126, v126, v56
v_fmac_f32 v127, v56, v56
v_add_f32 v126, v126, v57
v_fmac_f32 v127, v57, v57
v_add_f32 v126, v126, v58
v_fmac_f32 v127, v58, v58
v_add_f32 v126, v126, v59
v_fmac_f32 v127, v59, v59
v_permlane16_swap_b32 v118, v119
v_add_f32 v118, v118, v119
v_permlane16_swap_b32 v126, v127
v_add_f32 v126, v126, v127
s_nop 1
v_permlane32_swap_b32 v118, v126
v_add_f32 v118, v118, v126
ds_write_b32 v209, v118
s_add_u32 m0, s55, 94464
s_add_u32 s29, s54, 147840
buffer_load_dwordx4 v72, s[12:15], s29 offen lds
s_add_u32 m0, s55, 95488
s_add_u32 s29, s54, 147840
buffer_load_dwordx4 v73, s[12:15], s29 offen lds
s_add_u32 m0, s55, 96512
s_add_u32 s29, s54, 147840
buffer_load_dwordx4 v74, s[12:15], s29 offen lds
s_add_u32 m0, s55, 106752
s_add_u32 s29, s54, 184704
buffer_load_dwordx4 v72, s[12:15], s29 offen lds
s_add_u32 m0, s55, 107776
s_add_u32 s29, s54, 184704
buffer_load_dwordx4 v73, s[12:15], s29 offen lds
s_add_u32 m0, s55, 108800
s_add_u32 s29, s54, 184704
buffer_load_dwordx4 v74, s[12:15], s29 offen lds
s_add_u32 m0, s55, 119040
s_add_u32 s29, s54, 0
buffer_load_dwordx4 v72, s[12:15], s29 offen lds
s_add_u32 m0, s55, 120064
s_add_u32 s29, s54, 0
buffer_load_dwordx4 v73, s[12:15], s29 offen lds
s_add_u32 m0, s55, 121088
s_add_u32 s29, s54, 0
buffer_load_dwordx4 v74, s[12:15], s29 offen lds
s_add_u32 m0, s55, 69888
s_add_u32 s29, s54, 36864
buffer_load_dwordx4 v72, s[12:15], s29 offen lds
s_add_u32 m0, s55, 70912
s_add_u32 s29, s54, 36864
buffer_load_dwordx4 v73, s[12:15], s29 offen lds
s_add_u32 m0, s55, 71936
s_add_u32 s29, s54, 36864
buffer_load_dwordx4 v74, s[12:15], s29 offen lds
s_add_u32 m0, s55, 82176
s_add_u32 s29, s54, 73728
buffer_load_dwordx4 v72, s[12:15], s29 offen lds
s_add_u32 m0, s55, 83200
s_add_u32 s29, s54, 73728
buffer_load_dwordx4 v73, s[12:15], s29 offen lds
s_waitcnt vmcnt(18)
s_add_u32 m0, s55, 84224
s_add_u32 s29, s54, 73728
buffer_load_dwordx4 v74, s[12:15], s29 offen lds
ds_read_b64_tr_b16 a[0:1], v110 offset:36864
ds_read_b64_tr_b16 a[24:25], v110 offset:36896
ds_read_b64_tr_b16 a[48:49], v110 offset:36928
ds_read_b64_tr_b16 a[2:3], v110 offset:38400
ds_read_b64_tr_b16 a[26:27], v110 offset:38432
ds_read_b64_tr_b16 a[50:51], v110 offset:38464
ds_read_b64_tr_b16 a[4:5], v128 offset:1536
ds_read_b64_tr_b16 a[28:29], v128 offset:1568
ds_read_b64_tr_b16 a[52:53], v128 offset:1600
ds_read_b64_tr_b16 a[16:17], v128
ds_read_b64_tr_b16 a[40:41], v128 offset:32
ds_read_b64_tr_b16 a[64:65], v128 offset:64
ds_read_b64_tr_b16 a[6:7], v128 offset:12288
ds_read_b64_tr_b16 a[30:31], v128 offset:12320
ds_read_b64_tr_b16 a[54:55], v128 offset:12352
s_waitcnt vmcnt(18)
ds_read_b64_tr_b16 a[18:19], v128 offset:13824
ds_read_b64_tr_b16 a[42:43], v128 offset:13856
ds_read_b64_tr_b16 a[66:67], v128 offset:13888
s_waitcnt vmcnt(16)
ds_read_b64_tr_b16 a[8:9], v128 offset:24576
ds_read_b64_tr_b16 a[32:33], v128 offset:24608
ds_read_b64_tr_b16 a[56:57], v128 offset:24640
s_waitcnt vmcnt(15)
ds_read_b64_tr_b16 a[10:11], v128 offset:26112
ds_read_b64_tr_b16 a[34:35], v128 offset:26144
s_waitcnt lgkmcnt(14)
ds_read_b64_tr_b16 a[58:59], v128 offset:26176
s_add_u32 m0, s55, 131328
s_add_u32 s29, s54, 110592
buffer_load_dwordx4 v72, s[12:15], s29 offen lds
s_add_u32 m0, s55, 132352
s_add_u32 s29, s54, 110592
buffer_load_dwordx4 v73, s[12:15], s29 offen lds
s_add_u32 m0, s55, 133376
s_add_u32 s29, s54, 110592
buffer_load_dwordx4 v74, s[12:15], s29 offen lds
s_barrier
ds_read_b128 v[102:105], v210 offset:18432
ds_read_b128 v[106:109], v210 offset:19456
s_waitcnt lgkmcnt(1)
v_add_f32 v102, v102, v103
s_waitcnt lgkmcnt(0)
v_add_f32 v106, v106, v107
v_add_f32 v104, v104, v105
v_add_f32 v108, v108, v109
v_add_f32 v102, v102, v104
v_add_f32 v106, v106, v108
v_mul_f32 v103, s48, v102
v_mul_f32 v104, s73, v102
v_mul_f32 v106, s73, v106
v_fma_f32 v106, -v103, v104, v106
v_max_f32 v106, 0, v106
v_add_f32 v106, s49, v106
v_rsq_f32 v102, v106
s_nop 0
v_mul_f32_e64 v103, -v103, v102
ds_write_b64 v211, v[102:103] offset:20480
ds_read_b64 v[118:119], v219 offset:20480
ds_read_b64 v[126:127], v219 offset:20736
s_waitcnt lgkmcnt(1)
v_fma_f32 v220, v36, v118, v119
v_fma_f32 v221, v37, v118, v119
v_cvt_pk_bf16_f32 v90, v220, v221
v_fma_f32 v222, v38, v118, v119
v_fma_f32 v223, v39, v118, v119
v_cvt_pk_bf16_f32 v91, v222, v223
v_fma_f32 v220, v40, v118, v119
v_fma_f32 v221, v41, v118, v119
v_cvt_pk_bf16_f32 v92, v220, v221
v_fma_f32 v222, v42, v118, v119
v_fma_f32 v223, v43, v118, v119
v_cvt_pk_bf16_f32 v93, v222, v223
ds_write_b128 v211, v[90:93] offset:20480
v_fma_f32 v220, v44, v118, v119
v_fma_f32 v221, v45, v118, v119
v_cvt_pk_bf16_f32 v94, v220, v221
v_fma_f32 v222, v46, v118, v119
v_fma_f32 v223, v47, v118, v119
v_cvt_pk_bf16_f32 v95, v222, v223
s_waitcnt lgkmcnt(1)
ds_write_b64 v212, v[94:95] offset:20480
v_fma_f32 v220, v48, v126, v127
v_fma_f32 v221, v49, v126, v127
v_cvt_pk_bf16_f32 v174, v220, v221
v_fma_f32 v222, v50, v126, v127
v_fma_f32 v223, v51, v126, v127
v_cvt_pk_bf16_f32 v175, v222, v223
v_fma_f32 v220, v52, v126, v127
v_fma_f32 v221, v53, v126, v127
v_cvt_pk_bf16_f32 v176, v220, v221
v_fma_f32 v222, v54, v126, v127
v_fma_f32 v223, v55, v126, v127
v_cvt_pk_bf16_f32 v177, v222, v223
ds_write_b128 v211, v[174:177] offset:26624
v_fma_f32 v220, v56, v126, v127
v_fma_f32 v221, v57, v126, v127
v_cvt_pk_bf16_f32 v178, v220, v221
v_fma_f32 v222, v58, v126, v127
v_fma_f32 v223, v59, v126, v127
v_cvt_pk_bf16_f32 v179, v222, v223
ds_write_b64 v212, v[178:179] offset:26624
s_waitcnt vmcnt(15) lgkmcnt(0)
s_barrier
ds_read_b64_tr_b16 a[12:13], v110 offset:1536
ds_read_b64_tr_b16 a[36:37], v110 offset:1568
ds_read_b64_tr_b16 a[60:61], v110 offset:1600
ds_read_b64_tr_b16 a[20:21], v110
ds_read_b64_tr_b16 a[44:45], v110 offset:32
ds_read_b64_tr_b16 a[68:69], v110 offset:64
s_waitcnt vmcnt(12) lgkmcnt(0)
s_add_u32 m0, s55, 94464
s_add_u32 s29, s54, 147456
buffer_load_dwordx4 v72, s[12:15], s29 offen lds
s_add_u32 m0, s55, 95488
s_add_u32 s29, s54, 147456
buffer_load_dwordx4 v73, s[12:15], s29 offen lds
s_add_u32 m0, s55, 96512
s_add_u32 s29, s54, 147456
buffer_load_dwordx4 v74, s[12:15], s29 offen lds
ds_read_b64_tr_b16 a[14:15], v110 offset:12288
ds_read_b64_tr_b16 a[38:39], v110 offset:12320
ds_read_b64_tr_b16 a[62:63], v110 offset:12352
ds_read_b64_tr_b16 a[22:23], v110 offset:13824
ds_read_b64_tr_b16 a[46:47], v110 offset:13856
ds_read_b64_tr_b16 a[70:71], v110 offset:13888
s_waitcnt vmcnt(12) lgkmcnt(0)
s_add_u32 m0, s55, 106752
s_add_u32 s29, s54, 184320
buffer_load_dwordx4 v72, s[12:15], s29 offen lds
s_add_u32 m0, s55, 107776
s_add_u32 s29, s54, 184320
buffer_load_dwordx4 v73, s[12:15], s29 offen lds
s_add_u32 m0, s55, 108800
s_add_u32 s29, s54, 184320
buffer_load_dwordx4 v74, s[12:15], s29 offen lds
ds_read_b64_tr_b16 a[216:217], v110 offset:24576
ds_read_b64_tr_b16 a[240:241], v110 offset:24608
ds_read_b64_tr_b16 v[232:233], v110 offset:24640
ds_read_b64_tr_b16 a[218:219], v110 offset:26112
ds_read_b64_tr_b16 a[242:243], v110 offset:26144
ds_read_b64_tr_b16 v[234:235], v110 offset:26176
s_waitcnt vmcnt(12) lgkmcnt(0)
s_add_u32 m0, s55, 119040
s_add_u32 s29, s54, 768
buffer_load_dwordx4 v72, s[12:15], s29 offen lds
s_add_u32 m0, s55, 120064
s_add_u32 s29, s54, 768
buffer_load_dwordx4 v73, s[12:15], s29 offen lds
s_add_u32 m0, s55, 121088
s_add_u32 s29, s54, 768
buffer_load_dwordx4 v74, s[12:15], s29 offen lds
ds_read_b64_tr_b16 a[220:221], v129 offset:1536
ds_read_b64_tr_b16 a[244:245], v129 offset:1568
ds_read_b64_tr_b16 v[236:237], v129 offset:1600
ds_read_b64_tr_b16 a[232:233], v129
ds_read_b64_tr_b16 v[224:225], v129 offset:32
ds_read_b64_tr_b16 v[248:249], v129 offset:64
s_waitcnt lgkmcnt(0)
s_add_u32 m0, s55, 69888
s_add_u32 s29, s54, 37632
buffer_load_dwordx4 v72, s[12:15], s29 offen lds
s_add_u32 m0, s55, 70912
s_add_u32 s29, s54, 37632
buffer_load_dwordx4 v73, s[12:15], s29 offen lds
s_waitcnt vmcnt(14)
s_add_u32 m0, s55, 71936
s_add_u32 s29, s54, 37632
buffer_load_dwordx4 v74, s[12:15], s29 offen lds
ds_read_b64_tr_b16 a[222:223], v129 offset:12288
ds_read_b64_tr_b16 a[246:247], v129 offset:12320
ds_read_b64_tr_b16 v[238:239], v129 offset:12352
ds_read_b64_tr_b16 a[234:235], v129 offset:13824
ds_read_b64_tr_b16 v[226:227], v129 offset:13856
ds_read_b64_tr_b16 v[250:251], v129 offset:13888
s_waitcnt lgkmcnt(0)
s_add_u32 m0, s55, 82176
s_add_u32 s29, s54, 74496
buffer_load_dwordx4 v72, s[12:15], s29 offen lds
s_add_u32 m0, s55, 83200
s_add_u32 s29, s54, 74496
buffer_load_dwordx4 v73, s[12:15], s29 offen lds
s_waitcnt vmcnt(14)
s_add_u32 m0, s55, 84224
s_add_u32 s29, s54, 74496
buffer_load_dwordx4 v74, s[12:15], s29 offen lds
ds_read_b64_tr_b16 a[224:225], v110 offset:36864
ds_read_b64_tr_b16 a[248:249], v110 offset:36896
ds_read_b64_tr_b16 v[240:241], v110 offset:36928
ds_read_b64_tr_b16 a[226:227], v110 offset:38400
ds_read_b64_tr_b16 a[250:251], v110 offset:38432
ds_read_b64_tr_b16 v[242:243], v110 offset:38464
s_waitcnt lgkmcnt(0)
s_add_u32 m0, s55, 131328
s_add_u32 s29, s54, 111360
buffer_load_dwordx4 v72, s[12:15], s29 offen lds
s_add_u32 m0, s55, 132352
s_add_u32 s29, s54, 111360
buffer_load_dwordx4 v73, s[12:15], s29 offen lds
s_waitcnt vmcnt(14)
s_add_u32 m0, s55, 133376
s_add_u32 s29, s54, 111360
buffer_load_dwordx4 v74, s[12:15], s29 offen lds
ds_read_b64_tr_b16 a[228:229], v110 offset:1536
ds_read_b64_tr_b16 a[252:253], v110 offset:1568
ds_read_b64_tr_b16 v[244:245], v110 offset:1600
ds_read_b64_tr_b16 a[236:237], v110
ds_read_b64_tr_b16 v[228:229], v110 offset:32
ds_read_b64_tr_b16 v[252:253], v110 offset:64
s_waitcnt lgkmcnt(0)
s_add_u32 m0, s55, 94464
s_add_u32 s29, s54, 148224
buffer_load_dwordx4 v72, s[12:15], s29 offen lds
s_add_u32 m0, s55, 95488
s_add_u32 s29, s54, 148224
buffer_load_dwordx4 v73, s[12:15], s29 offen lds
s_waitcnt vmcnt(14)
s_add_u32 m0, s55, 96512
s_add_u32 s29, s54, 148224
buffer_load_dwordx4 v74, s[12:15], s29 offen lds
ds_read_b64_tr_b16 a[230:231], v110 offset:12288
ds_read_b64_tr_b16 a[254:255], v110 offset:12320
ds_read_b64_tr_b16 v[246:247], v110 offset:12352
ds_read_b64_tr_b16 a[238:239], v110 offset:13824
ds_read_b64_tr_b16 v[230:231], v110 offset:13856
ds_read_b64_tr_b16 v[254:255], v110 offset:13888
s_waitcnt lgkmcnt(0)
s_add_u32 m0, s55, 106752
s_add_u32 s29, s54, 185088
buffer_load_dwordx4 v72, s[12:15], s29 offen lds
s_add_u32 m0, s55, 107776
s_add_u32 s29, s54, 185088
buffer_load_dwordx4 v73, s[12:15], s29 offen lds
s_add_u32 m0, s55, 108800
s_add_u32 s29, s54, 185088
buffer_load_dwordx4 v74, s[12:15], s29 offen lds
s_mul_hi_u32 s41, s35, 58835169
s_mul_i32 s42, s41, 73
s_sub_u32 s42, s35, s42
s_mul_i32 s43, s41, 1373568
s_mul_i32 s51, s42, 2688
s_add_u32 s43, s43, s51
s_cmp_lt_u32 s35, s34
s_cselect_b32 s50, s43, 1879048192
s_add_u32 s35, s35, 32
s_cmp_eq_u32 s42, 0
s_cselect_b32 s44, 536870911, s72
s_cmp_eq_u32 s42, 72
s_cselect_b32 s44, 939524095, s44
s_cmp_eq_u32 s41, 0
s_cselect_b32 s52, 1879048192, s50
s_mov_b32 s37, s50
v_and_b32 v180, s44, v208
s_add_u32 m0, s45, 0
s_nop 0
buffer_load_dwordx4 v180, s[4:7], s52 offen nt lds
s_add_u32 m0, s45, 4112
s_add_u32 s40, s37, 196224
buffer_load_dwordx4 v180, s[4:7], s40 offen nt lds
s_add_u32 m0, s45, 8224
s_add_u32 s40, s37, 392448
buffer_load_dwordx4 v180, s[4:7], s40 offen nt lds
s_add_u32 m0, s45, 12336
s_add_u32 s40, s37, 588672
buffer_load_dwordx4 v180, s[4:7], s40 offen nt lds
s_add_u32 m0, s45, 16448
s_add_u32 s40, s37, 784896
buffer_load_dwordx4 v180, s[4:7], s40 offen nt lds
s_add_u32 m0, s45, 20560
s_add_u32 s40, s37, 981120
buffer_load_dwordx4 v180, s[4:7], s40 offen nt lds
s_add_u32 m0, s45, 24672
s_add_u32 s40, s37, 1177344
buffer_load_dwordx4 v180, s[4:7], s40 offen nt lds
s_add_u32 m0, s45, 28784
s_add_u32 s40, s37, 1373568
buffer_load_dwordx4 v180, s[4:7], s40 offen nt lds
s_waitcnt vmcnt(20)
s_add_u32 m0, s45, 32896
s_add_u32 s40, s37, 1569792
buffer_load_dwordx4 v180, s[4:7], s40 offen nt lds
ds_read_b64_tr_b16 a[72:73], v110 offset:24576
ds_read_b64_tr_b16 a[96:97], v110 offset:24608
ds_read_b64_tr_b16 a[120:121], v110 offset:24640
ds_read_b64_tr_b16 a[74:75], v110 offset:26112
ds_read_b64_tr_b16 a[98:99], v110 offset:26144
ds_read_b64_tr_b16 a[122:123], v110 offset:26176
ds_read_b64_tr_b16 a[76:77], v129 offset:1536
ds_read_b64_tr_b16 a[100:101], v129 offset:1568
ds_read_b64_tr_b16 a[124:125], v129 offset:1600
ds_read_b64_tr_b16 a[88:89], v129
ds_read_b64_tr_b16 a[112:113], v129 offset:32
ds_read_b64_tr_b16 a[136:137], v129 offset:64
s_waitcnt vmcnt(18) lgkmcnt(0)
s_add_u32 m0, s55, 69888
s_add_u32 s29, s54, 0
buffer_load_dwordx4 v136, s[16:19], s29 offen lds
s_add_u32 m0, s55, 70912
s_add_u32 s29, s54, 0
buffer_load_dwordx4 v137, s[16:19], s29 offen lds
s_add_u32 m0, s55, 71936
s_add_u32 s29, s54, 0
buffer_load_dwordx4 v216, s[16:19], s29 offen lds
ds_read_b64_tr_b16 a[78:79], v129 offset:12288
ds_read_b64_tr_b16 a[102:103], v129 offset:12320
ds_read_b64_tr_b16 a[126:127], v129 offset:12352
ds_read_b64_tr_b16 a[90:91], v129 offset:13824
ds_read_b64_tr_b16 a[114:115], v129 offset:13856
ds_read_b64_tr_b16 a[138:139], v129 offset:13888
s_waitcnt lgkmcnt(0)
s_add_u32 m0, s55, 82176
s_add_u32 s29, s54, 12288
buffer_load_dwordx4 v136, s[16:19], s29 offen lds
s_add_u32 m0, s55, 83200
s_add_u32 s29, s54, 12288
buffer_load_dwordx4 v137, s[16:19], s29 offen lds
s_waitcnt vmcnt(15)
s_add_u32 m0, s55, 84224
s_add_u32 s29, s54, 12288
buffer_load_dwordx4 v216, s[16:19], s29 offen lds
ds_read_b64_tr_b16 a[80:81], v110 offset:36864
ds_read_b64_tr_b16 a[104:105], v110 offset:36896
ds_read_b64_tr_b16 a[128:129], v110 offset:36928
ds_read_b64_tr_b16 a[82:83], v110 offset:38400
ds_read_b64_tr_b16 a[106:107], v110 offset:38432
ds_read_b64_tr_b16 a[130:131], v110 offset:38464
ds_read_b64_tr_b16 a[84:85], v110 offset:1536
ds_read_b64_tr_b16 a[108:109], v110 offset:1568
ds_read_b64_tr_b16 a[132:133], v110 offset:1600
ds_read_b64_tr_b16 a[92:93], v110
ds_read_b64_tr_b16 a[116:117], v110 offset:32
ds_read_b64_tr_b16 a[140:141], v110 offset:64
ds_read_b64_tr_b16 a[86:87], v110 offset:12288
ds_read_b64_tr_b16 a[110:111], v110 offset:12320
ds_read_b64_tr_b16 a[134:135], v110 offset:12352
s_waitcnt vmcnt(15)
ds_read_b64_tr_b16 a[94:95], v110 offset:13824
ds_read_b64_tr_b16 a[118:119], v110 offset:13856
ds_read_b64_tr_b16 a[142:143], v110 offset:13888
s_waitcnt vmcnt(3)
ds_read_b64_tr_b16 a[144:145], v129
ds_read_b64_tr_b16 a[168:169], v129 offset:32
ds_read_b64_tr_b16 a[192:193], v129 offset:64
ds_read_b64_tr_b16 a[146:147], v129 offset:1536
ds_read_b64_tr_b16 a[170:171], v129 offset:1568
ds_read_b64_tr_b16 a[194:195], v129 offset:1600
s_waitcnt vmcnt(0) lgkmcnt(0)
s_add_u32 m0, s55, 69888
s_add_u32 s29, s54, 24576
buffer_load_dwordx4 v136, s[16:19], s29 offen lds
s_add_u32 m0, s55, 70912
s_add_u32 s29, s54, 24576
buffer_load_dwordx4 v137, s[16:19], s29 offen lds
s_add_u32 m0, s55, 71936
s_add_u32 s29, s54, 24576
buffer_load_dwordx4 v216, s[16:19], s29 offen lds
ds_read_b64_tr_b16 a[148:149], v129 offset:13824
ds_read_b64_tr_b16 a[172:173], v129 offset:13856
ds_read_b64_tr_b16 a[196:197], v129 offset:13888
ds_read_b64_tr_b16 a[160:161], v129 offset:12288
ds_read_b64_tr_b16 a[184:185], v129 offset:12320
ds_read_b64_tr_b16 a[208:209], v129 offset:12352
s_waitcnt lgkmcnt(0)
s_add_u32 m0, s55, 82176
s_add_u32 s29, s54, 36864
buffer_load_dwordx4 v136, s[16:19], s29 offen lds
s_add_u32 m0, s55, 83200
s_add_u32 s29, s54, 36864
buffer_load_dwordx4 v137, s[16:19], s29 offen lds
s_add_u32 m0, s55, 84224
s_add_u32 s29, s54, 36864
buffer_load_dwordx4 v216, s[16:19], s29 offen lds
s_waitcnt vmcnt(4)
ds_read_b64_tr_b16 a[150:151], v129
ds_read_b64_tr_b16 a[174:175], v129 offset:32
ds_read_b64_tr_b16 a[198:199], v129 offset:64
s_waitcnt vmcnt(3)
ds_read_b64_tr_b16 a[162:163], v129 offset:1536
ds_read_b64_tr_b16 a[186:187], v129 offset:1568
ds_read_b64_tr_b16 a[210:211], v129 offset:1600
s_waitcnt lgkmcnt(0)
s_add_u32 m0, s55, 69888
s_add_u32 s29, s54, 49152
buffer_load_dwordx4 v136, s[16:19], s29 offen lds
s_add_u32 m0, s55, 70912
s_add_u32 s29, s54, 49152
buffer_load_dwordx4 v137, s[16:19], s29 offen lds
s_add_u32 m0, s55, 71936
s_add_u32 s29, s54, 49152
buffer_load_dwordx4 v216, s[16:19], s29 offen lds
s_waitcnt vmcnt(4)
ds_read_b64_tr_b16 a[152:153], v129 offset:12288
ds_read_b64_tr_b16 a[176:177], v129 offset:12320
ds_read_b64_tr_b16 a[200:201], v129 offset:12352
s_waitcnt vmcnt(3)
ds_read_b64_tr_b16 a[154:155], v129 offset:13824
ds_read_b64_tr_b16 a[178:179], v129 offset:13856
ds_read_b64_tr_b16 a[202:203], v129 offset:13888
s_waitcnt lgkmcnt(0)
s_add_u32 m0, s55, 82176
s_add_u32 s29, s54, 61440
buffer_load_dwordx4 v136, s[16:19], s29 offen lds
s_add_u32 m0, s55, 83200
s_add_u32 s29, s54, 61440
buffer_load_dwordx4 v137, s[16:19], s29 offen lds
s_add_u32 m0, s55, 84224
s_add_u32 s29, s54, 61440
buffer_load_dwordx4 v216, s[16:19], s29 offen lds
s_waitcnt vmcnt(3)
ds_read_b64_tr_b16 a[156:157], v129 offset:1536
ds_read_b64_tr_b16 a[180:181], v129 offset:1568
ds_read_b64_tr_b16 a[204:205], v129 offset:1600
ds_read_b64_tr_b16 a[164:165], v129
ds_read_b64_tr_b16 a[188:189], v129 offset:32
ds_read_b64_tr_b16 a[212:213], v129 offset:64
s_waitcnt vmcnt(1)
ds_read_b64_tr_b16 a[158:159], v129 offset:12288
ds_read_b64_tr_b16 a[182:183], v129 offset:12320
ds_read_b64_tr_b16 a[206:207], v129 offset:12352
s_waitcnt vmcnt(0)
ds_read_b64_tr_b16 a[166:167], v129 offset:13824
ds_read_b64_tr_b16 a[190:191], v129 offset:13856
ds_read_b64_tr_b16 a[214:215], v129 offset:13888
ds_read_b128 v[182:185], v210 offset:20480
s_waitcnt lgkmcnt(0)
v_mfma_f32_16x16x32_bf16 v[138:141], a[0:3], v[182:185], 0
v_mfma_f32_16x16x32_bf16 v[142:145], a[24:27], v[182:185], 0
v_mfma_f32_16x16x32_bf16 v[146:149], a[48:51], v[182:185], 0
ds_read_b128 v[186:189], v210 offset:26624
s_waitcnt lgkmcnt(0)
v_mfma_f32_16x16x32_bf16 v[150:153], a[0:3], v[186:189], 0
v_mfma_f32_16x16x32_bf16 v[154:157], a[24:27], v[186:189], 0
v_mfma_f32_16x16x32_bf16 v[158:161], a[48:51], v[186:189], 0
ds_read_b128 v[114:117], v210 offset:21504
s_waitcnt lgkmcnt(0)
v_mfma_f32_16x16x32_bf16 v[138:141], a[4:7], v[114:117], v[138:141]
v_mfma_f32_16x16x32_bf16 v[142:145], a[28:31], v[114:117], v[142:145]
v_mfma_f32_16x16x32_bf16 v[146:149], a[52:55], v[114:117], v[146:149]
ds_read_b128 v[122:125], v210 offset:27648
s_waitcnt lgkmcnt(0)
v_mfma_f32_16x16x32_bf16 v[150:153], a[4:7], v[122:125], v[150:153]
v_mfma_f32_16x16x32_bf16 v[154:157], a[28:31], v[122:125], v[154:157]
v_mfma_f32_16x16x32_bf16 v[158:161], a[52:55], v[122:125], v[158:161]
ds_read_b128 v[182:185], v210 offset:24576
s_waitcnt lgkmcnt(0)
v_mfma_f32_16x16x32_bf16 v[138:141], a[16:19], v[182:185], v[138:141]
v_mfma_f32_16x16x32_bf16 v[142:145], a[40:43], v[182:185], v[142:145]
v_mfma_f32_16x16x32_bf16 v[146:149], a[64:67], v[182:185], v[146:149]
ds_read_b128 v[186:189], v210 offset:30720
s_waitcnt lgkmcnt(0)
v_mfma_f32_16x16x32_bf16 v[150:153], a[16:19], v[186:189], v[150:153]
v_mfma_f32_16x16x32_bf16 v[154:157], a[40:43], v[186:189], v[154:157]
v_mfma_f32_16x16x32_bf16 v[158:161], a[64:67], v[186:189], v[158:161]
ds_read_b128 v[114:117], v210 offset:22528
s_waitcnt lgkmcnt(0)
v_mfma_f32_16x16x32_bf16 v[138:141], a[8:11], v[114:117], v[138:141]
v_mfma_f32_16x16x32_bf16 v[142:145], a[32:35], v[114:117], v[142:145]
v_mfma_f32_16x16x32_bf16 v[146:149], a[56:59], v[114:117], v[146:149]
ds_read_b128 v[122:125], v210 offset:28672
s_waitcnt lgkmcnt(0)
v_mfma_f32_16x16x32_bf16 v[150:153], a[8:11], v[122:125], v[150:153]
v_mfma_f32_16x16x32_bf16 v[154:157], a[32:35], v[122:125], v[154:157]
v_mfma_f32_16x16x32_bf16 v[158:161], a[56:59], v[122:125], v[158:161]
ds_read_b128 v[182:185], v210 offset:23552
s_waitcnt lgkmcnt(0)
v_mfma_f32_16x16x32_bf16 v[138:141], a[12:15], v[182:185], v[138:141]
v_mfma_f32_16x16x32_bf16 v[142:145], a[36:39], v[182:185], v[142:145]
v_mfma_f32_16x16x32_bf16 v[146:149], a[60:63], v[182:185], v[146:149]
ds_read_b128 v[186:189], v210 offset:29696
s_waitcnt lgkmcnt(0)
v_mfma_f32_16x16x32_bf16 v[150:153], a[12:15], v[186:189], v[150:153]
v_mfma_f32_16x16x32_bf16 v[154:157], a[36:39], v[186:189], v[154:157]
v_mfma_f32_16x16x32_bf16 v[158:161], a[60:63], v[186:189], v[158:161]
ds_read_b128 v[114:117], v210 offset:25600
s_waitcnt lgkmcnt(0)
v_mfma_f32_16x16x32_bf16 v[138:141], a[20:23], v[114:117], v[138:141]
v_mfma_f32_16x16x32_bf16 v[142:145], a[44:47], v[114:117], v[142:145]
v_mfma_f32_16x16x32_bf16 v[146:149], a[68:71], v[114:117], v[146:149]
ds_read_b128 v[122:125], v210 offset:31744
s_waitcnt lgkmcnt(0)
v_mfma_f32_16x16x32_bf16 v[150:153], a[20:23], v[122:125], v[150:153]
v_mfma_f32_16x16x32_bf16 v[154:157], a[44:47], v[122:125], v[154:157]
v_mfma_f32_16x16x32_bf16 v[158:161], a[68:71], v[122:125], v[158:161]
v_cvt_pk_bf16_f32 v60, v138, v139
v_cvt_pk_bf16_f32 v61, v140, v141
v_cvt_pk_bf16_f32 v62, v142, v143
v_cvt_pk_bf16_f32 v63, v144, v145
v_cvt_pk_bf16_f32 v64, v146, v147
v_cvt_pk_bf16_f32 v65, v148, v149
v_cvt_pk_bf16_f32 v66, v150, v151
v_cvt_pk_bf16_f32 v67, v152, v153
v_cvt_pk_bf16_f32 v68, v154, v155
v_cvt_pk_bf16_f32 v69, v156, v157
v_cvt_pk_bf16_f32 v70, v158, v159
v_cvt_pk_bf16_f32 v71, v160, v161
ds_read_b128 v[182:185], v210 offset:20480
s_waitcnt lgkmcnt(0)
v_mfma_f32_16x16x32_bf16 v[162:165], a[216:219], v[182:185], 0
v_mfma_f32_16x16x32_bf16 v[166:169], a[240:243], v[182:185], 0
v_mfma_f32_16x16x32_bf16 v[170:173], v[232:235], v[182:185], 0
ds_read_b128 v[186:189], v210 offset:26624
s_waitcnt lgkmcnt(0)
v_mfma_f32_16x16x32_bf16 v[138:141], a[216:219], v[186:189], 0
v_mfma_f32_16x16x32_bf16 v[142:145], a[240:243], v[186:189], 0
v_mfma_f32_16x16x32_bf16 v[146:149], v[232:235], v[186:189], 0
ds_read_b128 v[114:117], v210 offset:21504
s_waitcnt lgkmcnt(0)
v_mfma_f32_16x16x32_bf16 v[162:165], a[220:223], v[114:117], v[162:165]
v_mfma_f32_16x16x32_bf16 v[166:169], a[244:247], v[114:117], v[166:169]
v_mfma_f32_16x16x32_bf16 v[170:173], v[236:239], v[114:117], v[170:173]
ds_read_b128 v[122:125], v210 offset:27648
s_waitcnt lgkmcnt(0)
v_mfma_f32_16x16x32_bf16 v[138:141], a[220:223], v[122:125], v[138:141]
v_mfma_f32_16x16x32_bf16 v[142:145], a[244:247], v[122:125], v[142:145]
v_mfma_f32_16x16x32_bf16 v[146:149], v[236:239], v[122:125], v[146:149]
ds_read_b128 v[182:185], v210 offset:24576
s_waitcnt lgkmcnt(0)
v_mfma_f32_16x16x32_bf16 v[162:165], a[232:235], v[182:185], v[162:165]
v_mfma_f32_16x16x32_bf16 v[166:169], v[224:227], v[182:185], v[166:169]
v_mfma_f32_16x16x32_bf16 v[170:173], v[248:251], v[182:185], v[170:173]
ds_read_b128 v[186:189], v210 offset:30720
s_waitcnt lgkmcnt(0)
v_mfma_f32_16x16x32_bf16 v[138:141], a[232:235], v[186:189], v[138:141]
v_mfma_f32_16x16x32_bf16 v[142:145], v[224:227], v[186:189], v[142:145]
v_mfma_f32_16x16x32_bf16 v[146:149], v[248:251], v[186:189], v[146:149]
ds_read_b128 v[114:117], v210 offset:22528
s_waitcnt lgkmcnt(0)
v_mfma_f32_16x16x32_bf16 v[162:165], a[224:227], v[114:117], v[162:165]
v_mfma_f32_16x16x32_bf16 v[166:169], a[248:251], v[114:117], v[166:169]
v_mfma_f32_16x16x32_bf16 v[170:173], v[240:243], v[114:117], v[170:173]
ds_read_b128 v[122:125], v210 offset:28672
s_waitcnt lgkmcnt(0)
v_mfma_f32_16x16x32_bf16 v[138:141], a[224:227], v[122:125], v[138:141]
v_mfma_f32_16x16x32_bf16 v[142:145], a[248:251], v[122:125], v[142:145]
v_mfma_f32_16x16x32_bf16 v[146:149], v[240:243], v[122:125], v[146:149]
ds_read_b128 v[182:185], v210 offset:23552
s_waitcnt lgkmcnt(0)
v_mfma_f32_16x16x32_bf16 v[162:165], a[228:231], v[182:185], v[162:165]
v_mfma_f32_16x16x32_bf16 v[166:169], a[252:255], v[182:185], v[166:169]
v_mfma_f32_16x16x32_bf16 v[170:173], v[244:247], v[182:185], v[170:173]
ds_read_b128 v[186:189], v210 offset:29696
s_waitcnt lgkmcnt(0)
v_mfma_f32_16x16x32_bf16 v[138:141], a[228:231], v[186:189], v[138:141]
v_mfma_f32_16x16x32_bf16 v[142:145], a[252:255], v[186:189], v[142:145]
v_mfma_f32_16x16x32_bf16 v[146:149], v[244:247], v[186:189], v[146:149]
ds_read_b128 v[114:117], v210 offset:25600
s_waitcnt lgkmcnt(0)
v_mfma_f32_16x16x32_bf16 v[162:165], a[236:239], v[114:117], v[162:165]
v_mfma_f32_16x16x32_bf16 v[166:169], v[228:231], v[114:117], v[166:169]
v_mfma_f32_16x16x32_bf16 v[170:173], v[252:255], v[114:117], v[170:173]
ds_read_b128 v[122:125], v210 offset:31744
s_waitcnt lgkmcnt(0)
v_mfma_f32_16x16x32_bf16 v[138:141], a[236:239], v[122:125], v[138:141]
v_mfma_f32_16x16x32_bf16 v[142:145], v[228:231], v[122:125], v[142:145]
v_mfma_f32_16x16x32_bf16 v[146:149], v[252:255], v[122:125], v[146:149]
v_cvt_pk_bf16_f32 v84, v162, v163
v_cvt_pk_bf16_f32 v85, v164, v165
v_cvt_pk_bf16_f32 v86, v166, v167
v_cvt_pk_bf16_f32 v87, v168, v169
v_cvt_pk_bf16_f32 v88, v170, v171
v_cvt_pk_bf16_f32 v89, v172, v173
v_cvt_pk_bf16_f32 v96, v138, v139
v_cvt_pk_bf16_f32 v97, v140, v141
v_cvt_pk_bf16_f32 v98, v142, v143
v_cvt_pk_bf16_f32 v99, v144, v145
v_cvt_pk_bf16_f32 v100, v146, v147
v_cvt_pk_bf16_f32 v101, v148, v149
ds_read_b128 v[182:185], v210 offset:20480
s_waitcnt lgkmcnt(0)
v_mfma_f32_16x16x32_bf16 v[150:153], a[72:75], v[182:185], 0
v_mfma_f32_16x16x32_bf16 v[154:157], a[96:99], v[182:185], 0
v_mfma_f32_16x16x32_bf16 v[158:161], a[120:123], v[182:185], 0
ds_read_b128 v[186:189], v210 offset:26624
s_waitcnt lgkmcnt(0)
v_mfma_f32_16x16x32_bf16 v[162:165], a[72:75], v[186:189], 0
v_mfma_f32_16x16x32_bf16 v[166:169], a[96:99], v[186:189], 0
v_mfma_f32_16x16x32_bf16 v[170:173], a[120:123], v[186:189], 0
ds_read_b128 v[114:117], v210 offset:21504
s_waitcnt lgkmcnt(0)
v_mfma_f32_16x16x32_bf16 v[150:153], a[76:79], v[114:117], v[150:153]
v_mfma_f32_16x16x32_bf16 v[154:157], a[100:103], v[114:117], v[154:157]
v_mfma_f32_16x16x32_bf16 v[158:161], a[124:127], v[114:117], v[158:161]
ds_read_b128 v[122:125], v210 offset:27648
s_waitcnt lgkmcnt(0)
v_mfma_f32_16x16x32_bf16 v[162:165], a[76:79], v[122:125], v[162:165]
v_mfma_f32_16x16x32_bf16 v[166:169], a[100:103], v[122:125], v[166:169]
v_mfma_f32_16x16x32_bf16 v[170:173], a[124:127], v[122:125], v[170:173]
ds_read_b128 v[182:185], v210 offset:24576
s_waitcnt lgkmcnt(0)
v_mfma_f32_16x16x32_bf16 v[150:153], a[88:91], v[182:185], v[150:153]
v_mfma_f32_16x16x32_bf16 v[154:157], a[112:115], v[182:185], v[154:157]
v_mfma_f32_16x16x32_bf16 v[158:161], a[136:139], v[182:185], v[158:161]
ds_read_b128 v[186:189], v210 offset:30720
s_waitcnt lgkmcnt(0)
v_mfma_f32_16x16x32_bf16 v[162:165], a[88:91], v[186:189], v[162:165]
v_mfma_f32_16x16x32_bf16 v[166:169], a[112:115], v[186:189], v[166:169]
v_mfma_f32_16x16x32_bf16 v[170:173], a[136:139], v[186:189], v[170:173]
ds_read_b128 v[114:117], v210 offset:22528
s_waitcnt lgkmcnt(0)
v_mfma_f32_16x16x32_bf16 v[150:153], a[80:83], v[114:117], v[150:153]
v_mfma_f32_16x16x32_bf16 v[154:157], a[104:107], v[114:117], v[154:157]
v_mfma_f32_16x16x32_bf16 v[158:161], a[128:131], v[114:117], v[158:161]
ds_read_b128 v[122:125], v210 offset:28672
s_waitcnt lgkmcnt(0)
v_mfma_f32_16x16x32_bf16 v[162:165], a[80:83], v[122:125], v[162:165]
v_mfma_f32_16x16x32_bf16 v[166:169], a[104:107], v[122:125], v[166:169]
v_mfma_f32_16x16x32_bf16 v[170:173], a[128:131], v[122:125], v[170:173]
ds_read_b128 v[182:185], v210 offset:23552
s_waitcnt lgkmcnt(0)
v_mfma_f32_16x16x32_bf16 v[150:153], a[84:87], v[182:185], v[150:153]
v_mfma_f32_16x16x32_bf16 v[154:157], a[108:111], v[182:185], v[154:157]
v_mfma_f32_16x16x32_bf16 v[158:161], a[132:135], v[182:185], v[158:161]
ds_read_b128 v[186:189], v210 offset:29696
s_waitcnt lgkmcnt(0)
v_mfma_f32_16x16x32_bf16 v[162:165], a[84:87], v[186:189], v[162:165]
v_mfma_f32_16x16x32_bf16 v[166:169], a[108:111], v[186:189], v[166:169]
v_mfma_f32_16x16x32_bf16 v[170:173], a[132:135], v[186:189], v[170:173]
ds_read_b128 v[114:117], v210 offset:25600
s_waitcnt lgkmcnt(0)
v_mfma_f32_16x16x32_bf16 v[150:153], a[92:95], v[114:117], v[150:153]
v_mfma_f32_16x16x32_bf16 v[154:157], a[116:119], v[114:117], v[154:157]
v_mfma_f32_16x16x32_bf16 v[158:161], a[140:143], v[114:117], v[158:161]
ds_read_b128 v[122:125], v210 offset:31744
s_waitcnt lgkmcnt(0)
v_mfma_f32_16x16x32_bf16 v[162:165], a[92:95], v[122:125], v[162:165]
v_mfma_f32_16x16x32_bf16 v[166:169], a[116:119], v[122:125], v[166:169]
v_mfma_f32_16x16x32_bf16 v[170:173], a[140:143], v[122:125], v[170:173]
v_cvt_pk_bf16_f32 v90, v150, v151
v_cvt_pk_bf16_f32 v91, v152, v153
v_cvt_pk_bf16_f32 v92, v154, v155
v_cvt_pk_bf16_f32 v93, v156, v157
v_cvt_pk_bf16_f32 v94, v158, v159
v_cvt_pk_bf16_f32 v95, v160, v161
v_cvt_pk_bf16_f32 v102, v162, v163
v_cvt_pk_bf16_f32 v103, v164, v165
v_cvt_pk_bf16_f32 v104, v166, v167
v_cvt_pk_bf16_f32 v105, v168, v169
v_cvt_pk_bf16_f32 v106, v170, v171
v_cvt_pk_bf16_f32 v107, v172, v173
s_barrier
ds_write_b128 v121, v[36:39]
ds_write_b128 v121, v[40:43] offset:64
ds_write_b128 v121, v[44:47] offset:128
ds_write_b128 v120, v[84:87]
ds_write_b64 v120, v[88:89] offset:16
ds_write_b128 v120, v[60:63] offset:512
ds_write_b64 v120, v[64:65] offset:528
ds_write_b128 v120, v[90:93] offset:1024
ds_write_b64 v120, v[94:95] offset:1040
s_mov_b64 exec, s[56:57]
ds_write_b128 v121, v[48:51] offset:12544
s_mov_b64 exec, -1
s_mov_b64 exec, s[56:57]
ds_write_b128 v121, v[52:55] offset:12608
s_mov_b64 exec, -1
s_mov_b64 exec, s[56:57]
ds_write_b128 v121, v[56:59] offset:12672
s_mov_b64 exec, -1
s_mov_b64 exec, s[56:57]
ds_write_b128 v120, v[96:99] offset:24832
s_mov_b64 exec, -1
s_mov_b64 exec, s[56:57]
ds_write_b64 v120, v[100:101] offset:24848
s_mov_b64 exec, -1
s_mov_b64 exec, s[56:57]
ds_write_b128 v120, v[66:69] offset:25344
s_mov_b64 exec, -1
s_mov_b64 exec, s[56:57]
ds_write_b64 v120, v[70:71] offset:25360
s_mov_b64 exec, -1
s_mov_b64 exec, s[56:57]
ds_write_b128 v120, v[102:105] offset:25856
s_mov_b64 exec, -1
s_mov_b64 exec, s[56:57]
ds_write_b64 v120, v[106:107] offset:25872
s_mov_b64 exec, -1
s_nop 0
s_barrier
s_mov_b32 s38, s36
ds_read_b128 v[174:177], v217
ds_read_b128 v[84:87], v200
s_waitcnt lgkmcnt(0)
v_mfma_f32_16x16x32_bf16 v[36:39], v[174:177], v[84:87], 0
ds_read_b128 v[92:95], v201
s_waitcnt lgkmcnt(0)
v_mfma_f32_16x16x32_bf16 v[48:51], v[174:177], v[92:95], 0
ds_read_b128 v[100:103], v202
s_waitcnt lgkmcnt(0)
v_mfma_f32_16x16x32_bf16 v[60:63], v[174:177], v[100:103], 0
ds_read_b128 v[178:181], v217 offset:528
ds_read_b128 v[84:87], v194
ds_read_b128 v[88:91], v194 offset:16
s_waitcnt lgkmcnt(0)
v_smfmac_f32_16x16x64_bf16 v[36:39], v[178:181], v[84:91], v213
ds_read_b128 v[92:95], v195
ds_read_b128 v[96:99], v195 offset:16
s_waitcnt lgkmcnt(0)
v_smfmac_f32_16x16x64_bf16 v[48:51], v[178:181], v[92:99], v213
ds_read_b128 v[100:103], v196
ds_read_b128 v[104:107], v196 offset:16
s_waitcnt lgkmcnt(0)
v_smfmac_f32_16x16x64_bf16 v[60:63], v[178:181], v[100:107], v213
ds_read_b128 v[174:177], v217 offset:1056
ds_read_b128 v[84:87], v197
ds_read_b128 v[88:91], v197 offset:16
s_waitcnt lgkmcnt(0)
v_smfmac_f32_16x16x64_bf16 v[36:39], v[174:177], v[84:91], v213
ds_read_b128 v[92:95], v198
ds_read_b128 v[96:99], v198 offset:16
s_waitcnt lgkmcnt(0)
v_smfmac_f32_16x16x64_bf16 v[48:51], v[174:177], v[92:99], v213
ds_read_b128 v[100:103], v199
ds_read_b128 v[104:107], v199 offset:16
s_waitcnt lgkmcnt(0)
v_smfmac_f32_16x16x64_bf16 v[60:63], v[174:177], v[100:107], v213
ds_read_b128 v[178:181], v217 offset:1584
ds_read_b128 v[84:87], v200 offset:32
s_waitcnt lgkmcnt(0)
v_mfma_f32_16x16x32_bf16 v[40:43], v[178:181], v[84:87], 0
ds_read_b128 v[92:95], v201 offset:32
s_waitcnt lgkmcnt(0)
v_mfma_f32_16x16x32_bf16 v[52:55], v[178:181], v[92:95], 0
ds_read_b128 v[100:103], v202 offset:32
s_waitcnt lgkmcnt(0)
v_mfma_f32_16x16x32_bf16 v[64:67], v[178:181], v[100:103], 0
ds_read_b128 v[174:177], v217 offset:2112
ds_read_b128 v[84:87], v194 offset:32
ds_read_b128 v[88:91], v194 offset:48
s_waitcnt lgkmcnt(0)
v_smfmac_f32_16x16x64_bf16 v[40:43], v[174:177], v[84:91], v213
ds_read_b128 v[92:95], v195 offset:32
ds_read_b128 v[96:99], v195 offset:48
s_waitcnt lgkmcnt(0)
v_smfmac_f32_16x16x64_bf16 v[52:55], v[174:177], v[92:99], v213
ds_read_b128 v[100:103], v196 offset:32
ds_read_b128 v[104:107], v196 offset:48
s_waitcnt lgkmcnt(0)
v_smfmac_f32_16x16x64_bf16 v[64:67], v[174:177], v[100:107], v213
ds_read_b128 v[178:181], v217 offset:2640
ds_read_b128 v[84:87], v197 offset:32
ds_read_b128 v[88:91], v197 offset:48
s_waitcnt lgkmcnt(0)
v_smfmac_f32_16x16x64_bf16 v[40:43], v[178:181], v[84:91], v213
ds_read_b128 v[92:95], v198 offset:32
ds_read_b128 v[96:99], v198 offset:48
s_waitcnt lgkmcnt(0)
v_smfmac_f32_16x16x64_bf16 v[52:55], v[178:181], v[92:99], v213
ds_read_b128 v[100:103], v199 offset:32
ds_read_b128 v[104:107], v199 offset:48
s_waitcnt lgkmcnt(0)
v_smfmac_f32_16x16x64_bf16 v[64:67], v[178:181], v[100:107], v213
ds_read_b128 v[174:177], v217 offset:3168
ds_read_b128 v[84:87], v200 offset:64
s_waitcnt lgkmcnt(0)
v_mfma_f32_16x16x32_bf16 v[44:47], v[174:177], v[84:87], 0
ds_read_b128 v[92:95], v201 offset:64
s_waitcnt lgkmcnt(0)
v_mfma_f32_16x16x32_bf16 v[56:59], v[174:177], v[92:95], 0
ds_read_b128 v[100:103], v202 offset:64
s_waitcnt lgkmcnt(0)
v_mfma_f32_16x16x32_bf16 v[68:71], v[174:177], v[100:103], 0
ds_read_b128 v[178:181], v217 offset:3696
ds_read_b128 v[84:87], v194 offset:64
ds_read_b128 v[88:91], v194 offset:80
s_waitcnt lgkmcnt(0)
v_smfmac_f32_16x16x64_bf16 v[44:47], v[178:181], v[84:91], v213
ds_read_b128 v[92:95], v195 offset:64
ds_read_b128 v[96:99], v195 offset:80
s_waitcnt lgkmcnt(0)
v_smfmac_f32_16x16x64_bf16 v[56:59], v[178:181], v[92:99], v213
ds_read_b128 v[100:103], v196 offset:64
ds_read_b128 v[104:107], v196 offset:80
s_waitcnt lgkmcnt(0)
v_smfmac_f32_16x16x64_bf16 v[68:71], v[178:181], v[100:107], v213
ds_read_b128 v[174:177], v217 offset:4224
ds_read_b128 v[84:87], v197 offset:64
ds_read_b128 v[88:91], v197 offset:80
s_waitcnt lgkmcnt(0)
v_smfmac_f32_16x16x64_bf16 v[44:47], v[174:177], v[84:91], v213
ds_read_b128 v[92:95], v198 offset:64
ds_read_b128 v[96:99], v198 offset:80
s_waitcnt lgkmcnt(0)
v_smfmac_f32_16x16x64_bf16 v[56:59], v[174:177], v[92:99], v213
ds_read_b128 v[100:103], v199 offset:64
ds_read_b128 v[104:107], v199 offset:80
s_waitcnt lgkmcnt(0)
v_smfmac_f32_16x16x64_bf16 v[68:71], v[174:177], v[100:107], v213
v_add_f32 v118, v36, v37
v_mul_f32 v119, v36, v36
v_add_f32 v118, v118, v38
v_fmac_f32 v119, v37, v37
v_add_f32 v118, v118, v39
v_fmac_f32 v119, v38, v38
v_fmac_f32 v119, v39, v39
v_add_f32 v126, v48, v49
v_mul_f32 v127, v48, v48
v_add_f32 v126, v126, v50
v_fmac_f32 v127, v49, v49
v_add_f32 v126, v126, v51
v_fmac_f32 v127, v50, v50
v_fmac_f32 v127, v51, v51
v_add_f32 v134, v60, v61
v_mul_f32 v135, v60, v60
v_add_f32 v134, v134, v62
v_fmac_f32 v135, v61, v61
v_add_f32 v134, v134, v63
v_fmac_f32 v135, v62, v62
v_fmac_f32 v135, v63, v63
v_add_f32 v118, v118, v40
v_fmac_f32 v119, v40, v40
v_add_f32 v118, v118, v41
v_fmac_f32 v119, v41, v41
v_add_f32 v118, v118, v42
v_fmac_f32 v119, v42, v42
v_add_f32 v118, v118, v43
v_fmac_f32 v119, v43, v43
v_add_f32 v126, v126, v52
v_fmac_f32 v127, v52, v52
v_add_f32 v126, v126, v53
v_fmac_f32 v127, v53, v53
v_add_f32 v126, v126, v54
v_fmac_f32 v127, v54, v54
v_add_f32 v126, v126, v55
v_fmac_f32 v127, v55, v55
v_add_f32 v134, v134, v64
v_fmac_f32 v135, v64, v64
v_add_f32 v134, v134, v65
v_fmac_f32 v135, v65, v65
v_add_f32 v134, v134, v66
v_fmac_f32 v135, v66, v66
v_add_f32 v134, v134, v67
v_fmac_f32 v135, v67, v67
v_add_f32 v118, v118, v44
v_fmac_f32 v119, v44, v44
v_add_f32 v118, v118, v45
v_fmac_f32 v119, v45, v45
v_add_f32 v118, v118, v46
v_fmac_f32 v119, v46, v46
v_add_f32 v118, v118, v47
v_fmac_f32 v119, v47, v47
v_add_f32 v126, v126, v56
v_fmac_f32 v127, v56, v56
v_add_f32 v126, v126, v57
v_fmac_f32 v127, v57, v57
v_add_f32 v126, v126, v58
v_fmac_f32 v127, v58, v58
v_add_f32 v126, v126, v59
v_fmac_f32 v127, v59, v59
v_add_f32 v134, v134, v68
v_fmac_f32 v135, v68, v68
v_add_f32 v134, v134, v69
v_fmac_f32 v135, v69, v69
v_add_f32 v134, v134, v70
v_fmac_f32 v135, v70, v70
v_add_f32 v134, v134, v71
v_fmac_f32 v135, v71, v71
v_permlane16_swap_b32 v118, v119
v_add_f32 v118, v118, v119
v_permlane16_swap_b32 v126, v127
v_add_f32 v126, v126, v127
v_permlane16_swap_b32 v134, v135
v_add_f32 v134, v134, v135
v_permlane32_swap_b32 v118, v126
v_add_f32 v118, v118, v126
ds_write_b32 v209, v118
v_mov_b32 v135, v134
s_nop 1
v_permlane32_swap_b32 v134, v135
v_add_f32 v134, v134, v135
ds_write_b32 v209, v134 offset:512
s_waitcnt lgkmcnt(0)
s_barrier
s_mul_hi_u32 s41, s35, 58835169
s_mul_i32 s42, s41, 73
s_sub_u32 s42, s35, s42
s_mul_i32 s43, s41, 1373568
s_mul_i32 s51, s42, 2688
s_add_u32 s43, s43, s51
s_cmp_lt_u32 s35, s34
s_cselect_b32 s50, s43, 1879048192
s_add_u32 s35, s35, 32
s_cmp_eq_u32 s42, 0
s_cselect_b32 s44, 536870911, s72
s_cmp_eq_u32 s42, 72
s_cselect_b32 s44, 939524095, s44
s_cmp_eq_u32 s41, 0
s_cselect_b32 s52, 1879048192, s50
s_mov_b32 s36, s50
v_and_b32 v180, s44, v208
s_add_u32 m0, s45, 0
s_nop 0
buffer_load_dwordx4 v180, s[4:7], s52 offen nt lds
s_add_u32 m0, s45, 4112
s_add_u32 s40, s36, 196224
buffer_load_dwordx4 v180, s[4:7], s40 offen nt lds
s_add_u32 m0, s45, 8224
s_add_u32 s40, s36, 392448
buffer_load_dwordx4 v180, s[4:7], s40 offen nt lds
s_add_u32 m0, s45, 12336
s_add_u32 s40, s36, 588672
buffer_load_dwordx4 v180, s[4:7], s40 offen nt lds
s_add_u32 m0, s45, 16448
s_add_u32 s40, s36, 784896
buffer_load_dwordx4 v180, s[4:7], s40 offen nt lds
s_add_u32 m0, s45, 20560
s_add_u32 s40, s36, 981120
buffer_load_dwordx4 v180, s[4:7], s40 offen nt lds
s_add_u32 m0, s45, 24672
s_add_u32 s40, s36, 1177344
buffer_load_dwordx4 v180, s[4:7], s40 offen nt lds
s_add_u32 m0, s45, 28784
s_add_u32 s40, s36, 1373568
buffer_load_dwordx4 v180, s[4:7], s40 offen nt lds
s_add_u32 m0, s45, 32896
s_add_u32 s40, s36, 1569792
buffer_load_dwordx4 v180, s[4:7], s40 offen nt lds
ds_read_b128 v[102:105], v210 offset:18432
ds_read_b128 v[106:109], v210 offset:19456
s_waitcnt lgkmcnt(1)
v_add_f32 v102, v102, v103
s_waitcnt lgkmcnt(0)
v_add_f32 v106, v106, v107
v_add_f32 v104, v104, v105
v_add_f32 v108, v108, v109
v_add_f32 v102, v102, v104
v_add_f32 v106, v106, v108
v_mul_f32 v103, s48, v102
v_mul_f32 v104, s73, v102
v_mul_f32 v106, s73, v106
v_fma_f32 v106, -v103, v104, v106
v_max_f32 v106, 0, v106
v_add_f32 v106, s49, v106
v_rsq_f32 v102, v106
s_nop 0
v_mul_f32_e64 v103, -v103, v102
ds_write_b64 v211, v[102:103] offset:20480
ds_read_b64 v[118:119], v219 offset:20480
ds_read_b64 v[126:127], v219 offset:20736
ds_read_b64 v[134:135], v219 offset:20992
s_waitcnt lgkmcnt(2)
v_fma_f32 v220, v36, v118, v119
v_fma_f32 v221, v37, v118, v119
v_cvt_pk_bf16_f32 v90, v220, v221
v_fma_f32 v222, v38, v118, v119
v_fma_f32 v223, v39, v118, v119
v_cvt_pk_bf16_f32 v91, v222, v223
v_fma_f32 v220, v40, v118, v119
v_fma_f32 v221, v41, v118, v119
v_cvt_pk_bf16_f32 v92, v220, v221
v_fma_f32 v222, v42, v118, v119
v_fma_f32 v223, v43, v118, v119
v_cvt_pk_bf16_f32 v93, v222, v223
ds_write_b128 v211, v[90:93] offset:20480
v_fma_f32 v220, v44, v118, v119
v_fma_f32 v221, v45, v118, v119
v_cvt_pk_bf16_f32 v94, v220, v221
v_fma_f32 v222, v46, v118, v119
v_fma_f32 v223, v47, v118, v119
v_cvt_pk_bf16_f32 v95, v222, v223
s_waitcnt lgkmcnt(2)
ds_write_b64 v212, v[94:95] offset:20480
v_fma_f32 v220, v48, v126, v127
v_fma_f32 v221, v49, v126, v127
v_cvt_pk_bf16_f32 v174, v220, v221
v_fma_f32 v222, v50, v126, v127
v_fma_f32 v223, v51, v126, v127
v_cvt_pk_bf16_f32 v175, v222, v223
v_fma_f32 v220, v52, v126, v127
v_fma_f32 v221, v53, v126, v127
v_cvt_pk_bf16_f32 v176, v220, v221
v_fma_f32 v222, v54, v126, v127
v_fma_f32 v223, v55, v126, v127
v_cvt_pk_bf16_f32 v177, v222, v223
ds_write_b128 v211, v[174:177] offset:26624
v_fma_f32 v220, v56, v126, v127
v_fma_f32 v221, v57, v126, v127
v_cvt_pk_bf16_f32 v178, v220, v221
v_fma_f32 v222, v58, v126, v127
v_fma_f32 v223, v59, v126, v127
v_cvt_pk_bf16_f32 v179, v222, v223
s_waitcnt lgkmcnt(3)
ds_write_b64 v212, v[178:179] offset:26624
v_fma_f32 v220, v60, v134, v135
v_fma_f32 v221, v61, v134, v135
v_cvt_pk_bf16_f32 v90, v220, v221
v_fma_f32 v222, v62, v134, v135
v_fma_f32 v223, v63, v134, v135
v_cvt_pk_bf16_f32 v91, v222, v223
v_fma_f32 v220, v64, v134, v135
v_fma_f32 v221, v65, v134, v135
v_cvt_pk_bf16_f32 v92, v220, v221
v_fma_f32 v222, v66, v134, v135
v_fma_f32 v223, v67, v134, v135
v_cvt_pk_bf16_f32 v93, v222, v223
ds_write_b128 v211, v[90:93] offset:32768
v_fma_f32 v220, v68, v134, v135
v_fma_f32 v221, v69, v134, v135
v_cvt_pk_bf16_f32 v94, v220, v221
v_fma_f32 v222, v70, v134, v135
v_fma_f32 v223, v71, v134, v135
v_cvt_pk_bf16_f32 v95, v222, v223
ds_write_b64 v212, v[94:95] offset:32768
ds_read_b128 v[182:185], v210
s_waitcnt lgkmcnt(0)
v_mfma_f32_16x16x32_bf16 v[138:141], a[0:3], v[182:185], 0
v_mfma_f32_16x16x32_bf16 v[142:145], a[24:27], v[182:185], 0
v_mfma_f32_16x16x32_bf16 v[146:149], a[48:51], v[182:185], 0
v_mfma_f32_16x16x32_bf16 v[150:153], a[216:219], v[182:185], 0
v_mfma_f32_16x16x32_bf16 v[154:157], a[240:243], v[182:185], 0
v_mfma_f32_16x16x32_bf16 v[158:161], v[232:235], v[182:185], 0
v_mfma_f32_16x16x32_bf16 v[162:165], v[182:185], a[72:75], 0
v_mfma_f32_16x16x32_bf16 v[166:169], v[182:185], a[96:99], 0
v_mfma_f32_16x16x32_bf16 v[170:173], v[182:185], a[120:123], 0
ds_read_b128 v[186:189], v210 offset:1024
s_waitcnt lgkmcnt(0)
v_mfma_f32_16x16x32_bf16 v[138:141], a[4:7], v[186:189], v[138:141]
v_mfma_f32_16x16x32_bf16 v[142:145], a[28:31], v[186:189], v[142:145]
v_mfma_f32_16x16x32_bf16 v[146:149], a[52:55], v[186:189], v[146:149]
v_mfma_f32_16x16x32_bf16 v[150:153], a[220:223], v[186:189], v[150:153]
v_mfma_f32_16x16x32_bf16 v[154:157], a[244:247], v[186:189], v[154:157]
v_mfma_f32_16x16x32_bf16 v[158:161], v[236:239], v[186:189], v[158:161]
v_mfma_f32_16x16x32_bf16 v[162:165], v[186:189], a[76:79], v[162:165]
v_mfma_f32_16x16x32_bf16 v[166:169], v[186:189], a[100:103], v[166:169]
v_mfma_f32_16x16x32_bf16 v[170:173], v[186:189], a[124:127], v[170:173]
ds_read_b128 v[182:185], v210 offset:2048
s_waitcnt lgkmcnt(0)
v_mfma_f32_16x16x32_bf16 v[138:141], a[8:11], v[182:185], v[138:141]
v_mfma_f32_16x16x32_bf16 v[142:145], a[32:35], v[182:185], v[142:145]
v_mfma_f32_16x16x32_bf16 v[146:149], a[56:59], v[182:185], v[146:149]
v_mfma_f32_16x16x32_bf16 v[150:153], a[224:227], v[182:185], v[150:153]
v_mfma_f32_16x16x32_bf16 v[154:157], a[248:251], v[182:185], v[154:157]
v_mfma_f32_16x16x32_bf16 v[158:161], v[240:243], v[182:185], v[158:161]
v_mfma_f32_16x16x32_bf16 v[162:165], v[182:185], a[80:83], v[162:165]
v_mfma_f32_16x16x32_bf16 v[166:169], v[182:185], a[104:107], v[166:169]
v_mfma_f32_16x16x32_bf16 v[170:173], v[182:185], a[128:131], v[170:173]
ds_read_b128 v[186:189], v210 offset:3072
s_waitcnt lgkmcnt(0)
v_mfma_f32_16x16x32_bf16 v[138:141], a[12:15], v[186:189], v[138:141]
v_mfma_f32_16x16x32_bf16 v[142:145], a[36:39], v[186:189], v[142:145]
v_mfma_f32_16x16x32_bf16 v[146:149], a[60:63], v[186:189], v[146:149]
v_mfma_f32_16x16x32_bf16 v[150:153], a[228:231], v[186:189], v[150:153]
v_mfma_f32_16x16x32_bf16 v[154:157], a[252:255], v[186:189], v[154:157]
v_mfma_f32_16x16x32_bf16 v[158:161], v[244:247], v[186:189], v[158:161]
v_mfma_f32_16x16x32_bf16 v[162:165], v[186:189], a[84:87], v[162:165]
v_mfma_f32_16x16x32_bf16 v[166:169], v[186:189], a[108:111], v[166:169]
v_mfma_f32_16x16x32_bf16 v[170:173], v[186:189], a[132:135], v[170:173]
ds_read_b128 v[182:185], v210 offset:4096
s_waitcnt lgkmcnt(0)
v_mfma_f32_16x16x32_bf16 v[138:141], a[16:19], v[182:185], v[138:141]
v_mfma_f32_16x16x32_bf16 v[142:145], a[40:43], v[182:185], v[142:145]
v_mfma_f32_16x16x32_bf16 v[146:149], a[64:67], v[182:185], v[146:149]
v_mfma_f32_16x16x32_bf16 v[150:153], a[232:235], v[182:185], v[150:153]
v_mfma_f32_16x16x32_bf16 v[154:157], v[224:227], v[182:185], v[154:157]
v_mfma_f32_16x16x32_bf16 v[158:161], v[248:251], v[182:185], v[158:161]
v_mfma_f32_16x16x32_bf16 v[162:165], v[182:185], a[88:91], v[162:165]
v_mfma_f32_16x16x32_bf16 v[166:169], v[182:185], a[112:115], v[166:169]
v_mfma_f32_16x16x32_bf16 v[170:173], v[182:185], a[136:139], v[170:173]
ds_read_b128 v[186:189], v210 offset:5120
s_waitcnt lgkmcnt(0)
v_mfma_f32_16x16x32_bf16 v[138:141], a[20:23], v[186:189], v[138:141]
v_mfma_f32_16x16x32_bf16 v[142:145], a[44:47], v[186:189], v[142:145]
v_mfma_f32_16x16x32_bf16 v[146:149], a[68:71], v[186:189], v[146:149]
v_mfma_f32_16x16x32_bf16 v[150:153], a[236:239], v[186:189], v[150:153]
v_mfma_f32_16x16x32_bf16 v[154:157], v[228:231], v[186:189], v[154:157]
v_mfma_f32_16x16x32_bf16 v[158:161], v[252:255], v[186:189], v[158:161]
v_mfma_f32_16x16x32_bf16 v[162:165], v[186:189], a[92:95], v[162:165]
v_mfma_f32_16x16x32_bf16 v[166:169], v[186:189], a[116:119], v[166:169]
v_mfma_f32_16x16x32_bf16 v[170:173], v[186:189], a[140:143], v[170:173]
v_cvt_pk_bf16_f32 v78, v138, v139
v_cvt_pk_bf16_f32 v79, v140, v141
v_cvt_pk_bf16_f32 v80, v142, v143
v_cvt_pk_bf16_f32 v81, v144, v145
v_cvt_pk_bf16_f32 v82, v146, v147
v_cvt_pk_bf16_f32 v83, v148, v149
v_cvt_pk_bf16_f32 v72, v150, v151
v_cvt_pk_bf16_f32 v73, v152, v153
v_cvt_pk_bf16_f32 v74, v154, v155
v_cvt_pk_bf16_f32 v75, v156, v157
v_cvt_pk_bf16_f32 v76, v158, v159
v_cvt_pk_bf16_f32 v77, v160, v161
v_cvt_pk_bf16_f32 v114, v162, v163
v_cvt_pk_bf16_f32 v115, v164, v165
v_cvt_pk_bf16_f32 v122, v166, v167
v_cvt_pk_bf16_f32 v123, v168, v169
v_cvt_pk_bf16_f32 v130, v170, v171
v_cvt_pk_bf16_f32 v131, v172, v173
ds_read_b128 v[182:185], v210 offset:6144
s_waitcnt lgkmcnt(0)
v_mfma_f32_16x16x32_bf16 v[138:141], a[0:3], v[182:185], 0
v_mfma_f32_16x16x32_bf16 v[142:145], a[24:27], v[182:185], 0
v_mfma_f32_16x16x32_bf16 v[146:149], a[48:51], v[182:185], 0
v_mfma_f32_16x16x32_bf16 v[150:153], a[216:219], v[182:185], 0
v_mfma_f32_16x16x32_bf16 v[154:157], a[240:243], v[182:185], 0
v_mfma_f32_16x16x32_bf16 v[158:161], v[232:235], v[182:185], 0
v_mfma_f32_16x16x32_bf16 v[162:165], v[182:185], a[72:75], 0
v_mfma_f32_16x16x32_bf16 v[166:169], v[182:185], a[96:99], 0
v_mfma_f32_16x16x32_bf16 v[170:173], v[182:185], a[120:123], 0
ds_read_b128 v[186:189], v210 offset:7168
s_waitcnt lgkmcnt(0)
v_mfma_f32_16x16x32_bf16 v[138:141], a[4:7], v[186:189], v[138:141]
v_mfma_f32_16x16x32_bf16 v[142:145], a[28:31], v[186:189], v[142:145]
v_mfma_f32_16x16x32_bf16 v[146:149], a[52:55], v[186:189], v[146:149]
v_mfma_f32_16x16x32_bf16 v[150:153], a[220:223], v[186:189], v[150:153]
v_mfma_f32_16x16x32_bf16 v[154:157], a[244:247], v[186:189], v[154:157]
v_mfma_f32_16x16x32_bf16 v[158:161], v[236:239], v[186:189], v[158:161]
v_mfma_f32_16x16x32_bf16 v[162:165], v[186:189], a[76:79], v[162:165]
v_mfma_f32_16x16x32_bf16 v[166:169], v[186:189], a[100:103], v[166:169]
v_mfma_f32_16x16x32_bf16 v[170:173], v[186:189], a[124:127], v[170:173]
ds_read_b128 v[182:185], v210 offset:8192
s_waitcnt lgkmcnt(0)
v_mfma_f32_16x16x32_bf16 v[138:141], a[8:11], v[182:185], v[138:141]
v_mfma_f32_16x16x32_bf16 v[142:145], a[32:35], v[182:185], v[142:145]
v_mfma_f32_16x16x32_bf16 v[146:149], a[56:59], v[182:185], v[146:149]
v_mfma_f32_16x16x32_bf16 v[150:153], a[224:227], v[182:185], v[150:153]
v_mfma_f32_16x16x32_bf16 v[154:157], a[248:251], v[182:185], v[154:157]
v_mfma_f32_16x16x32_bf16 v[158:161], v[240:243], v[182:185], v[158:161]
v_mfma_f32_16x16x32_bf16 v[162:165], v[182:185], a[80:83], v[162:165]
v_mfma_f32_16x16x32_bf16 v[166:169], v[182:185], a[104:107], v[166:169]
v_mfma_f32_16x16x32_bf16 v[170:173], v[182:185], a[128:131], v[170:173]
ds_read_b128 v[186:189], v210 offset:9216
s_waitcnt lgkmcnt(0)
v_mfma_f32_16x16x32_bf16 v[138:141], a[12:15], v[186:189], v[138:141]
v_mfma_f32_16x16x32_bf16 v[142:145], a[36:39], v[186:189], v[142:145]
v_mfma_f32_16x16x32_bf16 v[146:149], a[60:63], v[186:189], v[146:149]
v_mfma_f32_16x16x32_bf16 v[150:153], a[228:231], v[186:189], v[150:153]
v_mfma_f32_16x16x32_bf16 v[154:157], a[252:255], v[186:189], v[154:157]
v_mfma_f32_16x16x32_bf16 v[158:161], v[244:247], v[186:189], v[158:161]
v_mfma_f32_16x16x32_bf16 v[162:165], v[186:189], a[84:87], v[162:165]
v_mfma_f32_16x16x32_bf16 v[166:169], v[186:189], a[108:111], v[166:169]
v_mfma_f32_16x16x32_bf16 v[170:173], v[186:189], a[132:135], v[170:173]
ds_read_b128 v[182:185], v210 offset:10240
s_waitcnt lgkmcnt(0)
v_mfma_f32_16x16x32_bf16 v[138:141], a[16:19], v[182:185], v[138:141]
v_mfma_f32_16x16x32_bf16 v[142:145], a[40:43], v[182:185], v[142:145]
v_mfma_f32_16x16x32_bf16 v[146:149], a[64:67], v[182:185], v[146:149]
v_mfma_f32_16x16x32_bf16 v[150:153], a[232:235], v[182:185], v[150:153]
v_mfma_f32_16x16x32_bf16 v[154:157], v[224:227], v[182:185], v[154:157]
v_mfma_f32_16x16x32_bf16 v[158:161], v[248:251], v[182:185], v[158:161]
v_mfma_f32_16x16x32_bf16 v[162:165], v[182:185], a[88:91], v[162:165]
v_mfma_f32_16x16x32_bf16 v[166:169], v[182:185], a[112:115], v[166:169]
v_mfma_f32_16x16x32_bf16 v[170:173], v[182:185], a[136:139], v[170:173]
ds_read_b128 v[186:189], v210 offset:11264
s_waitcnt lgkmcnt(0)
v_mfma_f32_16x16x32_bf16 v[138:141], a[20:23], v[186:189], v[138:141]
v_mfma_f32_16x16x32_bf16 v[142:145], a[44:47], v[186:189], v[142:145]
v_mfma_f32_16x16x32_bf16 v[146:149], a[68:71], v[186:189], v[146:149]
v_mfma_f32_16x16x32_bf16 v[150:153], a[236:239], v[186:189], v[150:153]
v_mfma_f32_16x16x32_bf16 v[154:157], v[228:231], v[186:189], v[154:157]
v_mfma_f32_16x16x32_bf16 v[158:161], v[252:255], v[186:189], v[158:161]
v_mfma_f32_16x16x32_bf16 v[162:165], v[186:189], a[92:95], v[162:165]
v_mfma_f32_16x16x32_bf16 v[166:169], v[186:189], a[116:119], v[166:169]
v_mfma_f32_16x16x32_bf16 v[170:173], v[186:189], a[140:143], v[170:173]
v_cvt_pk_bf16_f32 v96, v138, v139
v_cvt_pk_bf16_f32 v97, v140, v141
v_cvt_pk_bf16_f32 v98, v142, v143
v_cvt_pk_bf16_f32 v99, v144, v145
v_cvt_pk_bf16_f32 v100, v146, v147
v_cvt_pk_bf16_f32 v101, v148, v149
v_cvt_pk_bf16_f32 v84, v150, v151
v_cvt_pk_bf16_f32 v85, v152, v153
v_cvt_pk_bf16_f32 v86, v154, v155
v_cvt_pk_bf16_f32 v87, v156, v157
v_cvt_pk_bf16_f32 v88, v158, v159
v_cvt_pk_bf16_f32 v89, v160, v161
v_cvt_pk_bf16_f32 v116, v162, v163
v_cvt_pk_bf16_f32 v117, v164, v165
v_cvt_pk_bf16_f32 v124, v166, v167
v_cvt_pk_bf16_f32 v125, v168, v169
v_cvt_pk_bf16_f32 v132, v170, v171
v_cvt_pk_bf16_f32 v133, v172, v173
ds_read_b128 v[182:185], v210 offset:12288
s_waitcnt lgkmcnt(0)
v_mfma_f32_16x16x32_bf16 v[138:141], a[0:3], v[182:185], 0
v_mfma_f32_16x16x32_bf16 v[142:145], a[24:27], v[182:185], 0
v_mfma_f32_16x16x32_bf16 v[146:149], a[48:51], v[182:185], 0
ds_read_b128 v[186:189], v210 offset:13312
s_waitcnt lgkmcnt(0)
v_mfma_f32_16x16x32_bf16 v[138:141], a[4:7], v[186:189], v[138:141]
v_mfma_f32_16x16x32_bf16 v[142:145], a[28:31], v[186:189], v[142:145]
v_mfma_f32_16x16x32_bf16 v[146:149], a[52:55], v[186:189], v[146:149]
ds_read_b128 v[182:185], v210 offset:14336
s_waitcnt lgkmcnt(0)
v_mfma_f32_16x16x32_bf16 v[138:141], a[8:11], v[182:185], v[138:141]
v_mfma_f32_16x16x32_bf16 v[142:145], a[32:35], v[182:185], v[142:145]
v_mfma_f32_16x16x32_bf16 v[146:149], a[56:59], v[182:185], v[146:149]
ds_read_b128 v[186:189], v210 offset:15360
s_waitcnt lgkmcnt(0)
v_mfma_f32_16x16x32_bf16 v[138:141], a[12:15], v[186:189], v[138:141]
v_mfma_f32_16x16x32_bf16 v[142:145], a[36:39], v[186:189], v[142:145]
v_mfma_f32_16x16x32_bf16 v[146:149], a[60:63], v[186:189], v[146:149]
ds_read_b128 v[182:185], v210 offset:16384
s_waitcnt lgkmcnt(0)
v_mfma_f32_16x16x32_bf16 v[138:141], a[16:19], v[182:185], v[138:141]
v_mfma_f32_16x16x32_bf16 v[142:145], a[40:43], v[182:185], v[142:145]
v_mfma_f32_16x16x32_bf16 v[146:149], a[64:67], v[182:185], v[146:149]
ds_read_b128 v[186:189], v210 offset:17408
s_waitcnt lgkmcnt(0)
v_mfma_f32_16x16x32_bf16 v[138:141], a[20:23], v[186:189], v[138:141]
v_mfma_f32_16x16x32_bf16 v[142:145], a[44:47], v[186:189], v[142:145]
v_mfma_f32_16x16x32_bf16 v[146:149], a[68:71], v[186:189], v[146:149]
v_cvt_pk_bf16_f32 v102, v138, v139
v_cvt_pk_bf16_f32 v103, v140, v141
s_nop 0
v_cvt_pk_bf16_f32 v104, v142, v143
v_cvt_pk_bf16_f32 v105, v144, v145
s_nop 1
v_cvt_pk_bf16_f32 v106, v146, v147
v_cvt_pk_bf16_f32 v107, v148, v149
ds_read_b128 v[108:111], v215 offset:512
ds_read_b64 v[112:113], v215 offset:528
v_mov_b32 v181, 0
v_mfma_f32_16x16x16_bf16 v[138:141], v[82:83], v[76:77], 0
v_mfma_f32_16x16x16_bf16 v[142:145], v[100:101], v[76:77], 0
s_waitcnt lgkmcnt(0)
v_mfma_f32_16x16x16_bf16 v[150:153], v[112:113], v[76:77], v[206:209]
v_mfma_f32_16x16x16_bf16 v[146:149], v[106:107], v[76:77], 0
v_mfma_f32_16x16x32_bf16 v[138:141], v[78:81], v[72:75], v[138:141]
v_mfma_f32_16x16x32_bf16 v[142:145], v[96:99], v[72:75], v[142:145]
v_mfma_f32_16x16x32_bf16 v[150:153], v[108:111], v[72:75], v[150:153]
v_mfma_f32_16x16x32_bf16 v[146:149], v[102:105], v[72:75], v[146:149]
ds_read_b128 v[72:75], v215
ds_read_b64 v[76:77], v215 offset:16
v_mfma_f32_16x16x16_bf16 v[154:157], v[82:83], v[88:89], 0
v_mfma_f32_16x16x16_bf16 v[158:161], v[100:101], v[88:89], 0
v_mfma_f32_16x16x16_bf16 v[166:169], v[112:113], v[88:89], v[206:209]
v_mfma_f32_16x16x16_bf16 v[162:165], v[106:107], v[88:89], 0
v_mfma_f32_16x16x32_bf16 v[154:157], v[78:81], v[84:87], v[154:157]
v_mfma_f32_16x16x32_bf16 v[158:161], v[96:99], v[84:87], v[158:161]
v_mfma_f32_16x16x32_bf16 v[166:169], v[108:111], v[84:87], v[166:169]
v_mfma_f32_16x16x32_bf16 v[162:165], v[102:105], v[84:87], v[162:165]
ds_read_b128 v[182:185], v210 offset:12288
s_waitcnt lgkmcnt(0)
v_mfma_f32_16x16x32_bf16 v[118:121], v[182:185], a[72:75], 0
v_mfma_f32_16x16x32_bf16 v[126:129], v[182:185], a[96:99], 0
v_mfma_f32_16x16x32_bf16 v[134:137], v[182:185], a[120:123], 0
v_mfma_f32_16x16x32_bf16 v[90:93], a[216:219], v[182:185], 0
v_mfma_f32_16x16x32_bf16 v[170:173], a[240:243], v[182:185], 0
v_mfma_f32_16x16x32_bf16 v[220:223], v[232:235], v[182:185], 0
ds_read_b128 v[186:189], v210 offset:13312
s_waitcnt lgkmcnt(0)
v_mfma_f32_16x16x32_bf16 v[118:121], v[186:189], a[76:79], v[118:121]
v_mfma_f32_16x16x32_bf16 v[126:129], v[186:189], a[100:103], v[126:129]
v_mfma_f32_16x16x32_bf16 v[134:137], v[186:189], a[124:127], v[134:137]
v_mfma_f32_16x16x32_bf16 v[90:93], a[220:223], v[186:189], v[90:93]
v_mfma_f32_16x16x32_bf16 v[170:173], a[244:247], v[186:189], v[170:173]
v_mfma_f32_16x16x32_bf16 v[220:223], v[236:239], v[186:189], v[220:223]
ds_read_b128 v[182:185], v210 offset:14336
s_waitcnt lgkmcnt(0)
v_mfma_f32_16x16x32_bf16 v[118:121], v[182:185], a[80:83], v[118:121]
v_mfma_f32_16x16x32_bf16 v[126:129], v[182:185], a[104:107], v[126:129]
v_mfma_f32_16x16x32_bf16 v[134:137], v[182:185], a[128:131], v[134:137]
v_mfma_f32_16x16x32_bf16 v[90:93], a[224:227], v[182:185], v[90:93]
v_mfma_f32_16x16x32_bf16 v[170:173], a[248:251], v[182:185], v[170:173]
v_mfma_f32_16x16x32_bf16 v[220:223], v[240:243], v[182:185], v[220:223]
ds_read_b128 v[186:189], v210 offset:15360
s_waitcnt lgkmcnt(0)
v_mfma_f32_16x16x32_bf16 v[118:121], v[186:189], a[84:87], v[118:121]
v_mfma_f32_16x16x32_bf16 v[126:129], v[186:189], a[108:111], v[126:129]
v_mfma_f32_16x16x32_bf16 v[134:137], v[186:189], a[132:135], v[134:137]
v_mfma_f32_16x16x32_bf16 v[90:93], a[228:231], v[186:189], v[90:93]
v_mfma_f32_16x16x32_bf16 v[170:173], a[252:255], v[186:189], v[170:173]
v_mfma_f32_16x16x32_bf16 v[220:223], v[244:247], v[186:189], v[220:223]
ds_read_b128 v[182:185], v210 offset:16384
s_waitcnt lgkmcnt(0)
v_mfma_f32_16x16x32_bf16 v[118:121], v[182:185], a[88:91], v[118:121]
v_mfma_f32_16x16x32_bf16 v[126:129], v[182:185], a[112:115], v[126:129]
v_mfma_f32_16x16x32_bf16 v[134:137], v[182:185], a[136:139], v[134:137]
v_mfma_f32_16x16x32_bf16 v[90:93], a[232:235], v[182:185], v[90:93]
v_mfma_f32_16x16x32_bf16 v[170:173], v[224:227], v[182:185], v[170:173]
v_mfma_f32_16x16x32_bf16 v[220:223], v[248:251], v[182:185], v[220:223]
ds_read_b128 v[186:189], v210 offset:17408
s_waitcnt lgkmcnt(0)
v_mfma_f32_16x16x32_bf16 v[118:121], v[186:189], a[92:95], v[118:121]
v_mfma_f32_16x16x32_bf16 v[126:129], v[186:189], a[116:119], v[126:129]
v_mfma_f32_16x16x32_bf16 v[134:137], v[186:189], a[140:143], v[134:137]
v_mfma_f32_16x16x32_bf16 v[90:93], a[236:239], v[186:189], v[90:93]
v_mfma_f32_16x16x32_bf16 v[170:173], v[228:231], v[186:189], v[170:173]
v_mfma_f32_16x16x32_bf16 v[220:223], v[252:255], v[186:189], v[220:223]
v_cvt_pk_bf16_f32 v118, v118, v119
v_cvt_pk_bf16_f32 v119, v120, v121
ds_read_u16 v120, v214 offset:1024
v_mov_b32 v121, 0
v_cvt_pk_bf16_f32 v126, v126, v127
v_cvt_pk_bf16_f32 v127, v128, v129
ds_read_u16 v128, v214 offset:1032
v_mov_b32 v129, 0
v_cvt_pk_bf16_f32 v134, v134, v135
v_cvt_pk_bf16_f32 v135, v136, v137
ds_read_u16 v136, v214 offset:1040
v_mov_b32 v137, 0
v_cvt_pk_bf16_f32 v90, v90, v91
v_cvt_pk_bf16_f32 v91, v92, v93
v_cvt_pk_bf16_f32 v92, v170, v171
v_cvt_pk_bf16_f32 v93, v172, v173
v_cvt_pk_bf16_f32 v94, v220, v221
v_cvt_pk_bf16_f32 v95, v222, v223
v_max3_f32 v151, v138, v139, v140
v_max3_f32 v151, v151, v141, v142
v_max3_f32 v151, v151, v143, v144
v_max3_f32 v151, v151, v145, v146
v_max3_f32 v151, v151, v147, v148
v_max3_f32 v151, v151, v149, v150
v_mov_b32 v152, v151
s_nop 1
v_permlane16_swap_b32 v151, v152
v_max_f32 v151, v151, v152
v_mov_b32 v152, v151
s_nop 1
v_permlane32_swap_b32 v151, v152
v_max_f32 v151, v151, v152
v_sub_f32 v138, v138, v151
v_sub_f32 v139, v139, v151
v_sub_f32 v140, v140, v151
v_sub_f32 v141, v141, v151
v_sub_f32 v142, v142, v151
v_sub_f32 v143, v143, v151
v_sub_f32 v144, v144, v151
v_sub_f32 v145, v145, v151
v_sub_f32 v150, v150, v151
v_sub_f32 v146, v146, v151
v_sub_f32 v147, v147, v151
v_sub_f32 v148, v148, v151
v_sub_f32 v149, v149, v151
v_exp_f32 v138, v138
v_exp_f32 v139, v139
v_exp_f32 v140, v140
v_exp_f32 v141, v141
v_exp_f32 v142, v142
v_exp_f32 v143, v143
v_exp_f32 v144, v144
v_exp_f32 v145, v145
v_exp_f32 v150, v150
v_exp_f32 v146, v146
v_exp_f32 v147, v147
v_exp_f32 v148, v148
v_exp_f32 v149, v149
v_cvt_pk_bf16_f32 v174, v138, v139
v_cvt_pk_bf16_f32 v175, v140, v141
v_cvt_pk_bf16_f32 v176, v142, v143
v_cvt_pk_bf16_f32 v177, v144, v145
v_cvt_pk_bf16_f32 v178, v146, v147
v_cvt_pk_bf16_f32 v179, v148, v149
v_cvt_pk_bf16_f32 v180, v150, 0
v_mfma_f32_16x16x32_bf16 v[150:153], v[190:193], v[174:177], 0
v_mfma_f32_16x16x32_bf16 v[138:141], v[114:117], v[174:177], 0
v_mfma_f32_16x16x32_bf16 v[142:145], v[122:125], v[174:177], 0
v_mfma_f32_16x16x32_bf16 v[146:149], v[130:133], v[174:177], 0
v_mfma_f32_16x16x32_bf16 v[150:153], v[190:193], v[178:181], v[150:153]
s_waitcnt lgkmcnt(2)
v_mfma_f32_16x16x32_bf16 v[138:141], v[118:121], v[178:181], v[138:141]
s_waitcnt lgkmcnt(1)
v_mfma_f32_16x16x32_bf16 v[142:145], v[126:129], v[178:181], v[142:145]
s_waitcnt lgkmcnt(0)
v_mfma_f32_16x16x32_bf16 v[146:149], v[134:137], v[178:181], v[146:149]
v_max3_f32 v167, v154, v155, v156
v_max3_f32 v167, v167, v157, v158
v_max3_f32 v167, v167, v159, v160
v_max3_f32 v167, v167, v161, v162
v_max3_f32 v167, v167, v163, v164
v_max3_f32 v167, v167, v165, v166
v_mov_b32 v168, v167
s_nop 1
v_permlane16_swap_b32 v167, v168
v_max_f32 v167, v167, v168
v_mov_b32 v168, v167
s_nop 1
v_permlane32_swap_b32 v167, v168
v_max_f32 v167, v167, v168
v_sub_f32 v154, v154, v167
v_sub_f32 v155, v155, v167
v_sub_f32 v156, v156, v167
v_sub_f32 v157, v157, v167
v_sub_f32 v158, v158, v167
v_sub_f32 v159, v159, v167
v_sub_f32 v160, v160, v167
v_sub_f32 v161, v161, v167
v_sub_f32 v166, v166, v167
v_sub_f32 v162, v162, v167
v_sub_f32 v163, v163, v167
v_sub_f32 v164, v164, v167
v_sub_f32 v165, v165, v167
v_exp_f32 v154, v154
v_exp_f32 v155, v155
v_exp_f32 v156, v156
v_exp_f32 v157, v157
v_exp_f32 v158, v158
v_exp_f32 v159, v159
v_exp_f32 v160, v160
v_exp_f32 v161, v161
v_exp_f32 v166, v166
v_exp_f32 v162, v162
v_exp_f32 v163, v163
v_exp_f32 v164, v164
v_exp_f32 v165, v165
v_cvt_pk_bf16_f32 v174, v154, v155
v_cvt_pk_bf16_f32 v175, v156, v157
v_cvt_pk_bf16_f32 v176, v158, v159
v_cvt_pk_bf16_f32 v177, v160, v161
v_cvt_pk_bf16_f32 v178, v162, v163
v_cvt_pk_bf16_f32 v179, v164, v165
v_cvt_pk_bf16_f32 v180, v166, 0
v_mfma_f32_16x16x32_bf16 v[166:169], v[190:193], v[174:177], 0
v_mfma_f32_16x16x32_bf16 v[154:157], v[114:117], v[174:177], 0
v_mfma_f32_16x16x32_bf16 v[158:161], v[122:125], v[174:177], 0
v_mfma_f32_16x16x32_bf16 v[162:165], v[130:133], v[174:177], 0
v_mfma_f32_16x16x32_bf16 v[166:169], v[190:193], v[178:181], v[166:169]
v_mfma_f32_16x16x32_bf16 v[154:157], v[118:121], v[178:181], v[154:157]
v_mfma_f32_16x16x32_bf16 v[158:161], v[126:129], v[178:181], v[158:161]
v_mfma_f32_16x16x32_bf16 v[162:165], v[134:137], v[178:181], v[162:165]
v_rcp_f32 v151, v150
s_nop 0
v_mul_f32 v151, s3, v151
v_mul_f32 v138, v138, v151
v_mul_f32 v139, v139, v151
v_cvt_pk_bf16_f32 v138, v138, v139
v_mul_f32 v140, v140, v151
v_mul_f32 v141, v141, v151
v_cvt_pk_bf16_f32 v139, v140, v141
v_mul_f32 v142, v142, v151
v_mul_f32 v143, v143, v151
v_cvt_pk_bf16_f32 v140, v142, v143
v_mul_f32 v144, v144, v151
v_mul_f32 v145, v145, v151
v_cvt_pk_bf16_f32 v141, v144, v145
ds_write_b128 v211, v[138:141] offset:38912
v_mul_f32 v146, v146, v151
v_mul_f32 v147, v147, v151
v_cvt_pk_bf16_f32 v142, v146, v147
v_mul_f32 v148, v148, v151
v_mul_f32 v149, v149, v151
v_cvt_pk_bf16_f32 v143, v148, v149
ds_write_b64 v212, v[142:143] offset:38912
v_mfma_f32_16x16x32_bf16 v[138:141], v[78:81], v[90:93], 0
v_mfma_f32_16x16x32_bf16 v[142:145], v[96:99], v[90:93], 0
v_mfma_f32_16x16x32_bf16 v[150:153], v[108:111], v[90:93], v[206:209]
v_mfma_f32_16x16x32_bf16 v[146:149], v[102:105], v[90:93], 0
v_mfma_f32_16x16x16_bf16 v[138:141], v[82:83], v[94:95], v[138:141]
v_mfma_f32_16x16x16_bf16 v[142:145], v[100:101], v[94:95], v[142:145]
v_mfma_f32_16x16x16_bf16 v[150:153], v[112:113], v[94:95], v[150:153]
v_mfma_f32_16x16x16_bf16 v[146:149], v[106:107], v[94:95], v[146:149]
v_rcp_f32 v167, v166
s_nop 0
v_mul_f32 v167, s3, v167
v_mul_f32 v154, v154, v167
v_mul_f32 v155, v155, v167
v_cvt_pk_bf16_f32 v154, v154, v155
v_mul_f32 v156, v156, v167
v_mul_f32 v157, v157, v167
v_cvt_pk_bf16_f32 v155, v156, v157
v_mul_f32 v158, v158, v167
v_mul_f32 v159, v159, v167
v_cvt_pk_bf16_f32 v156, v158, v159
v_mul_f32 v160, v160, v167
v_mul_f32 v161, v161, v167
v_cvt_pk_bf16_f32 v157, v160, v161
ds_write_b128 v211, v[154:157] offset:45056
v_mul_f32 v162, v162, v167
v_mul_f32 v163, v163, v167
v_cvt_pk_bf16_f32 v158, v162, v163
v_mul_f32 v164, v164, v167
v_mul_f32 v165, v165, v167
v_cvt_pk_bf16_f32 v159, v164, v165
ds_write_b64 v212, v[158:159] offset:45056
v_mfma_f32_16x16x16_bf16 v[154:157], v[76:77], v[82:83], 0
v_mfma_f32_16x16x16_bf16 v[158:161], v[76:77], v[100:101], 0
v_mfma_f32_16x16x16_bf16 v[162:165], v[76:77], v[106:107], 0
v_mfma_f32_16x16x16_bf16 v[166:169], v[76:77], v[112:113], v[206:209]
v_mfma_f32_16x16x32_bf16 v[154:157], v[72:75], v[78:81], v[154:157]
v_mfma_f32_16x16x32_bf16 v[158:161], v[72:75], v[96:99], v[158:161]
v_mfma_f32_16x16x32_bf16 v[162:165], v[72:75], v[102:105], v[162:165]
v_mfma_f32_16x16x32_bf16 v[166:169], v[72:75], v[108:111], v[166:169]
v_mov_b32_dpp v154, v158 quad_perm:[0,1,2,3] row_mask:0x2 bank_mask:0xf
s_nop 1
v_mov_b32_dpp v154, v162 quad_perm:[0,1,2,3] row_mask:0x4 bank_mask:0xf
s_nop 2
v_mov_b32_dpp v154, v167 quad_perm:[0,1,2,3] row_mask:0x8 bank_mask:0xf
v_mov_b32 v155, v154
s_nop 1
v_max_f32_dpp v155, v155, v155 row_ror:8 row_mask:0xf bank_mask:0xf
s_nop 1
v_max_f32_dpp v155, v155, v155 row_ror:4 row_mask:0xf bank_mask:0xf
s_nop 1
v_max_f32_dpp v155, v155, v155 row_ror:2 row_mask:0xf bank_mask:0xf
s_nop 1
v_max_f32_dpp v155, v155, v155 row_ror:1 row_mask:0xf bank_mask:0xf
v_mov_b32 v156, v155
s_nop 1
v_permlane16_swap_b32 v155, v156
v_max_f32 v155, v155, v156
v_mov_b32 v156, v155
s_nop 1
v_permlane32_swap_b32 v155, v156
v_max_f32 v155, v155, v156
v_sub_f32 v154, v154, v155
v_exp_f32 v154, v154
s_nop 0
v_cvt_pk_bf16_f32 v154, v154, 0
ds_write_b16 v214, v154
s_waitcnt lgkmcnt(1)
ds_read_b128 v[84:87], v215
ds_read_b128 v[88:91], v215 offset:16
v_add_u32 v215, 1552, v215
s_barrier
ds_read_b128 v[170:173], v210 offset:38912
s_waitcnt lgkmcnt(0)
v_mfma_f32_16x16x32_bf16 v[0:3], a[144:147], v[170:173], v[0:3]
v_mfma_f32_16x16x32_bf16 v[4:7], a[168:171], v[170:173], v[4:7]
v_mfma_f32_16x16x32_bf16 v[8:11], a[192:195], v[170:173], v[8:11]
ds_read_b128 v[182:185], v210 offset:39936
s_waitcnt lgkmcnt(0)
v_mfma_f32_16x16x32_bf16 v[0:3], a[148:151], v[182:185], v[0:3]
v_mfma_f32_16x16x32_bf16 v[4:7], a[172:175], v[182:185], v[4:7]
v_mfma_f32_16x16x32_bf16 v[8:11], a[196:199], v[182:185], v[8:11]
ds_read_b128 v[186:189], v210 offset:40960
s_waitcnt lgkmcnt(0)
v_mfma_f32_16x16x32_bf16 v[0:3], a[152:155], v[186:189], v[0:3]
v_mfma_f32_16x16x32_bf16 v[4:7], a[176:179], v[186:189], v[4:7]
v_mfma_f32_16x16x32_bf16 v[8:11], a[200:203], v[186:189], v[8:11]
ds_read_b128 v[170:173], v210 offset:41984
s_waitcnt lgkmcnt(0)
v_mfma_f32_16x16x32_bf16 v[0:3], a[156:159], v[170:173], v[0:3]
v_mfma_f32_16x16x32_bf16 v[4:7], a[180:183], v[170:173], v[4:7]
v_mfma_f32_16x16x32_bf16 v[8:11], a[204:207], v[170:173], v[8:11]
ds_read_b128 v[182:185], v210 offset:43008
s_waitcnt lgkmcnt(0)
v_mfma_f32_16x16x32_bf16 v[0:3], a[160:163], v[182:185], v[0:3]
v_mfma_f32_16x16x32_bf16 v[4:7], a[184:187], v[182:185], v[4:7]
v_mfma_f32_16x16x32_bf16 v[8:11], a[208:211], v[182:185], v[8:11]
ds_read_b128 v[186:189], v210 offset:44032
s_waitcnt lgkmcnt(0)
v_mfma_f32_16x16x32_bf16 v[0:3], a[164:167], v[186:189], v[0:3]
v_mfma_f32_16x16x32_bf16 v[4:7], a[188:191], v[186:189], v[4:7]
v_mfma_f32_16x16x32_bf16 v[8:11], a[212:215], v[186:189], v[8:11]
v_cvt_pk_bf16_f32 v72, v0, v1
v_cvt_pk_bf16_f32 v73, v2, v3
buffer_store_dwordx2 v[72:73], v203, s[8:11], s38 offen
v_cvt_pk_bf16_f32 v74, v4, v5
v_cvt_pk_bf16_f32 v75, v6, v7
buffer_store_dwordx2 v[74:75], v203, s[8:11], s38 offen offset:32
s_nop 0
v_cvt_pk_bf16_f32 v76, v8, v9
v_cvt_pk_bf16_f32 v77, v10, v11
buffer_store_dwordx2 v[76:77], v203, s[8:11], s38 offen offset:64
v_max3_f32 v151, v138, v139, v140
v_max3_f32 v151, v151, v141, v142
v_max3_f32 v151, v151, v143, v144
v_max3_f32 v151, v151, v145, v146
v_max3_f32 v151, v151, v147, v148
v_max3_f32 v151, v151, v149, v150
v_mov_b32 v152, v151
s_nop 1
v_permlane16_swap_b32 v151, v152
v_max_f32 v151, v151, v152
v_mov_b32 v152, v151
s_nop 1
v_permlane32_swap_b32 v151, v152
v_max_f32 v151, v151, v152
v_sub_f32 v138, v138, v151
v_sub_f32 v139, v139, v151
v_sub_f32 v140, v140, v151
v_sub_f32 v141, v141, v151
v_sub_f32 v142, v142, v151
v_sub_f32 v143, v143, v151
v_sub_f32 v144, v144, v151
v_sub_f32 v145, v145, v151
v_sub_f32 v150, v150, v151
v_sub_f32 v146, v146, v151
v_sub_f32 v147, v147, v151
v_sub_f32 v148, v148, v151
v_sub_f32 v149, v149, v151
v_exp_f32 v138, v138
v_exp_f32 v139, v139
v_exp_f32 v140, v140
v_exp_f32 v141, v141
v_exp_f32 v142, v142
v_exp_f32 v143, v143
v_exp_f32 v144, v144
v_exp_f32 v145, v145
v_exp_f32 v150, v150
v_exp_f32 v146, v146
v_exp_f32 v147, v147
v_exp_f32 v148, v148
v_exp_f32 v149, v149
v_cvt_pk_bf16_f32 v174, v138, v139
v_cvt_pk_bf16_f32 v175, v140, v141
v_cvt_pk_bf16_f32 v176, v142, v143
v_cvt_pk_bf16_f32 v177, v144, v145
v_cvt_pk_bf16_f32 v178, v146, v147
v_cvt_pk_bf16_f32 v179, v148, v149
v_cvt_pk_bf16_f32 v180, v150, 0
v_mfma_f32_16x16x32_bf16 v[150:153], v[190:193], v[174:177], 0
v_mfma_f32_16x16x32_bf16 v[138:141], v[114:117], v[174:177], 0
v_mfma_f32_16x16x32_bf16 v[142:145], v[122:125], v[174:177], 0
v_mfma_f32_16x16x32_bf16 v[146:149], v[130:133], v[174:177], 0
v_mfma_f32_16x16x32_bf16 v[150:153], v[190:193], v[178:181], v[150:153]
v_mfma_f32_16x16x32_bf16 v[138:141], v[118:121], v[178:181], v[138:141]
v_mfma_f32_16x16x32_bf16 v[142:145], v[126:129], v[178:181], v[142:145]
v_mfma_f32_16x16x32_bf16 v[146:149], v[134:137], v[178:181], v[146:149]
v_mfma_f32_16x16x32_bf16 v[166:169], v[84:87], v[190:193], 0
v_mfma_f32_16x16x32_bf16 v[154:157], v[84:87], v[114:117], 0
v_mfma_f32_16x16x32_bf16 v[158:161], v[84:87], v[122:125], 0
v_mfma_f32_16x16x32_bf16 v[162:165], v[84:87], v[130:133], 0
v_mfma_f32_16x16x32_bf16 v[166:169], v[88:91], v[190:193], v[166:169]
v_mfma_f32_16x16x32_bf16 v[154:157], v[88:91], v[118:121], v[154:157]
v_mfma_f32_16x16x32_bf16 v[158:161], v[88:91], v[126:129], v[158:161]
v_mfma_f32_16x16x32_bf16 v[162:165], v[88:91], v[134:137], v[162:165]
v_rcp_f32 v167, v166
s_nop 1
v_mov_b32_dpp v154, v158 quad_perm:[0,1,2,3] row_mask:0x2 bank_mask:0xf
s_nop 2
v_mov_b32_dpp v154, v162 quad_perm:[0,1,2,3] row_mask:0x4 bank_mask:0xf
v_mul_f32 v167, s3, v167
v_mul_f32 v154, v154, v167
v_cvt_pk_bf16_f32 v154, v154, 0
ds_write_b16 v214, v154
v_add_u32 v214, 1552, v214
ds_read_b128 v[170:173], v210 offset:45056
s_waitcnt lgkmcnt(0)
v_mfma_f32_16x16x32_bf16 v[12:15], a[144:147], v[170:173], v[12:15]
v_mfma_f32_16x16x32_bf16 v[16:19], a[168:171], v[170:173], v[16:19]
v_mfma_f32_16x16x32_bf16 v[20:23], a[192:195], v[170:173], v[20:23]
ds_read_b128 v[182:185], v210 offset:46080
s_waitcnt lgkmcnt(0)
v_mfma_f32_16x16x32_bf16 v[12:15], a[148:151], v[182:185], v[12:15]
v_mfma_f32_16x16x32_bf16 v[16:19], a[172:175], v[182:185], v[16:19]
v_mfma_f32_16x16x32_bf16 v[20:23], a[196:199], v[182:185], v[20:23]
ds_read_b128 v[186:189], v210 offset:47104
s_waitcnt lgkmcnt(0)
v_mfma_f32_16x16x32_bf16 v[12:15], a[152:155], v[186:189], v[12:15]
v_mfma_f32_16x16x32_bf16 v[16:19], a[176:179], v[186:189], v[16:19]
v_mfma_f32_16x16x32_bf16 v[20:23], a[200:203], v[186:189], v[20:23]
ds_read_b128 v[170:173], v210 offset:48128
s_waitcnt lgkmcnt(0)
v_mfma_f32_16x16x32_bf16 v[12:15], a[156:159], v[170:173], v[12:15]
v_mfma_f32_16x16x32_bf16 v[16:19], a[180:183], v[170:173], v[16:19]
v_mfma_f32_16x16x32_bf16 v[20:23], a[204:207], v[170:173], v[20:23]
ds_read_b128 v[182:185], v210 offset:49152
s_waitcnt lgkmcnt(0)
v_mfma_f32_16x16x32_bf16 v[12:15], a[160:163], v[182:185], v[12:15]
v_mfma_f32_16x16x32_bf16 v[16:19], a[184:187], v[182:185], v[16:19]
v_mfma_f32_16x16x32_bf16 v[20:23], a[208:211], v[182:185], v[20:23]
ds_read_b128 v[186:189], v210 offset:50176
s_waitcnt lgkmcnt(0)
v_mfma_f32_16x16x32_bf16 v[12:15], a[164:167], v[186:189], v[12:15]
v_mfma_f32_16x16x32_bf16 v[16:19], a[188:191], v[186:189], v[16:19]
v_mfma_f32_16x16x32_bf16 v[20:23], a[212:215], v[186:189], v[20:23]
v_cvt_pk_bf16_f32 v78, v12, v13
v_cvt_pk_bf16_f32 v79, v14, v15
buffer_store_dwordx2 v[78:79], v204, s[8:11], s38 offen
v_cvt_pk_bf16_f32 v80, v16, v17
v_cvt_pk_bf16_f32 v81, v18, v19
buffer_store_dwordx2 v[80:81], v204, s[8:11], s38 offen offset:32
s_nop 0
v_cvt_pk_bf16_f32 v82, v20, v21
v_cvt_pk_bf16_f32 v83, v22, v23
buffer_store_dwordx2 v[82:83], v204, s[8:11], s38 offen offset:64
v_rcp_f32 v151, v150
s_nop 0
v_mul_f32 v151, s3, v151
v_mul_f32 v138, v138, v151
v_mul_f32 v139, v139, v151
v_cvt_pk_bf16_f32 v138, v138, v139
v_mul_f32 v140, v140, v151
v_mul_f32 v141, v141, v151
v_cvt_pk_bf16_f32 v139, v140, v141
v_mul_f32 v142, v142, v151
v_mul_f32 v143, v143, v151
v_cvt_pk_bf16_f32 v140, v142, v143
v_mul_f32 v144, v144, v151
v_mul_f32 v145, v145, v151
v_cvt_pk_bf16_f32 v141, v144, v145
ds_write_b128 v211, v[138:141] offset:51200
v_mul_f32 v146, v146, v151
v_mul_f32 v147, v147, v151
v_cvt_pk_bf16_f32 v142, v146, v147
v_mul_f32 v148, v148, v151
v_mul_f32 v149, v149, v151
v_cvt_pk_bf16_f32 v143, v148, v149
ds_write_b64 v212, v[142:143] offset:51200
s_mov_b32 s46, 8
.p2align 6
G_loop:
s_waitcnt vmcnt(6) lgkmcnt(0)
s_barrier
ds_read_b128 v[170:173], v210 offset:51200
s_waitcnt lgkmcnt(0)
v_mfma_f32_16x16x32_bf16 v[24:27], a[144:147], v[170:173], v[24:27]
v_mfma_f32_16x16x32_bf16 v[28:31], a[168:171], v[170:173], v[28:31]
v_mfma_f32_16x16x32_bf16 v[32:35], a[192:195], v[170:173], v[32:35]
ds_read_b128 v[182:185], v210 offset:52224
s_waitcnt lgkmcnt(0)
v_mfma_f32_16x16x32_bf16 v[24:27], a[148:151], v[182:185], v[24:27]
v_mfma_f32_16x16x32_bf16 v[28:31], a[172:175], v[182:185], v[28:31]
v_mfma_f32_16x16x32_bf16 v[32:35], a[196:199], v[182:185], v[32:35]
ds_read_b128 v[186:189], v210 offset:53248
s_waitcnt lgkmcnt(0)
v_mfma_f32_16x16x32_bf16 v[24:27], a[152:155], v[186:189], v[24:27]
v_mfma_f32_16x16x32_bf16 v[28:31], a[176:179], v[186:189], v[28:31]
v_mfma_f32_16x16x32_bf16 v[32:35], a[200:203], v[186:189], v[32:35]
ds_read_b128 v[170:173], v210 offset:54272
s_waitcnt lgkmcnt(0)
v_mfma_f32_16x16x32_bf16 v[24:27], a[156:159], v[170:173], v[24:27]
v_mfma_f32_16x16x32_bf16 v[28:31], a[180:183], v[170:173], v[28:31]
v_mfma_f32_16x16x32_bf16 v[32:35], a[204:207], v[170:173], v[32:35]
ds_read_b128 v[182:185], v210 offset:55296
s_waitcnt lgkmcnt(0)
v_mfma_f32_16x16x32_bf16 v[24:27], a[160:163], v[182:185], v[24:27]
v_mfma_f32_16x16x32_bf16 v[28:31], a[184:187], v[182:185], v[28:31]
v_mfma_f32_16x16x32_bf16 v[32:35], a[208:211], v[182:185], v[32:35]
ds_read_b128 v[186:189], v210 offset:56320
s_waitcnt lgkmcnt(0)
v_mfma_f32_16x16x32_bf16 v[24:27], a[164:167], v[186:189], v[24:27]
v_mfma_f32_16x16x32_bf16 v[28:31], a[188:191], v[186:189], v[28:31]
v_mfma_f32_16x16x32_bf16 v[32:35], a[212:215], v[186:189], v[32:35]
v_cvt_pk_bf16_f32 v116, v24, v25
v_cvt_pk_bf16_f32 v117, v26, v27
buffer_store_dwordx2 v[116:117], v205, s[8:11], s38 offen
v_cvt_pk_bf16_f32 v124, v28, v29
v_cvt_pk_bf16_f32 v125, v30, v31
buffer_store_dwordx2 v[124:125], v205, s[8:11], s38 offen offset:32
s_nop 0
v_cvt_pk_bf16_f32 v132, v32, v33
v_cvt_pk_bf16_f32 v133, v34, v35
buffer_store_dwordx2 v[132:133], v205, s[8:11], s38 offen offset:64
s_mov_b32 s39, s37
ds_read_b128 v[174:177], v217
ds_read_b128 v[84:87], v200
s_waitcnt lgkmcnt(0)
v_mfma_f32_16x16x32_bf16 v[0:3], v[174:177], v[84:87], 0
ds_read_b128 v[92:95], v201
s_waitcnt lgkmcnt(0)
v_mfma_f32_16x16x32_bf16 v[12:15], v[174:177], v[92:95], 0
ds_read_b128 v[100:103], v202
s_waitcnt lgkmcnt(0)
v_mfma_f32_16x16x32_bf16 v[24:27], v[174:177], v[100:103], 0
ds_read_b128 v[178:181], v217 offset:528
ds_read_b128 v[84:87], v194
ds_read_b128 v[88:91], v194 offset:16
s_waitcnt lgkmcnt(0)
v_smfmac_f32_16x16x64_bf16 v[0:3], v[178:181], v[84:91], v213
ds_read_b128 v[92:95], v195
ds_read_b128 v[96:99], v195 offset:16
s_waitcnt lgkmcnt(0)
v_smfmac_f32_16x16x64_bf16 v[12:15], v[178:181], v[92:99], v213
ds_read_b128 v[100:103], v196
ds_read_b128 v[104:107], v196 offset:16
s_waitcnt lgkmcnt(0)
v_smfmac_f32_16x16x64_bf16 v[24:27], v[178:181], v[100:107], v213
ds_read_b128 v[174:177], v217 offset:1056
ds_read_b128 v[84:87], v197
ds_read_b128 v[88:91], v197 offset:16
s_waitcnt lgkmcnt(0)
v_smfmac_f32_16x16x64_bf16 v[0:3], v[174:177], v[84:91], v213
ds_read_b128 v[92:95], v198
ds_read_b128 v[96:99], v198 offset:16
s_waitcnt lgkmcnt(0)
v_smfmac_f32_16x16x64_bf16 v[12:15], v[174:177], v[92:99], v213
ds_read_b128 v[100:103], v199
ds_read_b128 v[104:107], v199 offset:16
s_waitcnt lgkmcnt(0)
v_smfmac_f32_16x16x64_bf16 v[24:27], v[174:177], v[100:107], v213
ds_read_b128 v[178:181], v217 offset:1584
ds_read_b128 v[84:87], v200 offset:32
s_waitcnt lgkmcnt(0)
v_mfma_f32_16x16x32_bf16 v[4:7], v[178:181], v[84:87], 0
ds_read_b128 v[92:95], v201 offset:32
s_waitcnt lgkmcnt(0)
v_mfma_f32_16x16x32_bf16 v[16:19], v[178:181], v[92:95], 0
ds_read_b128 v[100:103], v202 offset:32
s_waitcnt lgkmcnt(0)
v_mfma_f32_16x16x32_bf16 v[28:31], v[178:181], v[100:103], 0
ds_read_b128 v[174:177], v217 offset:2112
ds_read_b128 v[84:87], v194 offset:32
ds_read_b128 v[88:91], v194 offset:48
s_waitcnt lgkmcnt(0)
v_smfmac_f32_16x16x64_bf16 v[4:7], v[174:177], v[84:91], v213
ds_read_b128 v[92:95], v195 offset:32
ds_read_b128 v[96:99], v195 offset:48
s_waitcnt lgkmcnt(0)
v_smfmac_f32_16x16x64_bf16 v[16:19], v[174:177], v[92:99], v213
ds_read_b128 v[100:103], v196 offset:32
ds_read_b128 v[104:107], v196 offset:48
s_waitcnt lgkmcnt(0)
v_smfmac_f32_16x16x64_bf16 v[28:31], v[174:177], v[100:107], v213
ds_read_b128 v[178:181], v217 offset:2640
ds_read_b128 v[84:87], v197 offset:32
ds_read_b128 v[88:91], v197 offset:48
s_waitcnt lgkmcnt(0)
v_smfmac_f32_16x16x64_bf16 v[4:7], v[178:181], v[84:91], v213
ds_read_b128 v[92:95], v198 offset:32
ds_read_b128 v[96:99], v198 offset:48
s_waitcnt lgkmcnt(0)
v_smfmac_f32_16x16x64_bf16 v[16:19], v[178:181], v[92:99], v213
ds_read_b128 v[100:103], v199 offset:32
ds_read_b128 v[104:107], v199 offset:48
s_waitcnt lgkmcnt(0)
v_smfmac_f32_16x16x64_bf16 v[28:31], v[178:181], v[100:107], v213
ds_read_b128 v[174:177], v217 offset:3168
ds_read_b128 v[84:87], v200 offset:64
s_waitcnt lgkmcnt(0)
v_mfma_f32_16x16x32_bf16 v[8:11], v[174:177], v[84:87], 0
ds_read_b128 v[92:95], v201 offset:64
s_waitcnt lgkmcnt(0)
v_mfma_f32_16x16x32_bf16 v[20:23], v[174:177], v[92:95], 0
ds_read_b128 v[100:103], v202 offset:64
s_waitcnt lgkmcnt(0)
v_mfma_f32_16x16x32_bf16 v[32:35], v[174:177], v[100:103], 0
ds_read_b128 v[178:181], v217 offset:3696
ds_read_b128 v[84:87], v194 offset:64
ds_read_b128 v[88:91], v194 offset:80
s_waitcnt lgkmcnt(0)
v_smfmac_f32_16x16x64_bf16 v[8:11], v[178:181], v[84:91], v213
ds_read_b128 v[92:95], v195 offset:64
ds_read_b128 v[96:99], v195 offset:80
s_waitcnt lgkmcnt(0)
v_smfmac_f32_16x16x64_bf16 v[20:23], v[178:181], v[92:99], v213
ds_read_b128 v[100:103], v196 offset:64
ds_read_b128 v[104:107], v196 offset:80
s_waitcnt lgkmcnt(0)
v_smfmac_f32_16x16x64_bf16 v[32:35], v[178:181], v[100:107], v213
ds_read_b128 v[174:177], v217 offset:4224
ds_read_b128 v[84:87], v197 offset:64
ds_read_b128 v[88:91], v197 offset:80
s_waitcnt lgkmcnt(0)
v_smfmac_f32_16x16x64_bf16 v[8:11], v[174:177], v[84:91], v213
ds_read_b128 v[92:95], v198 offset:64
ds_read_b128 v[96:99], v198 offset:80
s_waitcnt lgkmcnt(0)
v_smfmac_f32_16x16x64_bf16 v[20:23], v[174:177], v[92:99], v213
ds_read_b128 v[100:103], v199 offset:64
ds_read_b128 v[104:107], v199 offset:80
s_waitcnt lgkmcnt(0)
v_smfmac_f32_16x16x64_bf16 v[32:35], v[174:177], v[100:107], v213
v_add_f32 v118, v0, v1
v_mul_f32 v119, v0, v0
v_add_f32 v118, v118, v2
v_fmac_f32 v119, v1, v1
v_add_f32 v118, v118, v3
v_fmac_f32 v119, v2, v2
v_fmac_f32 v119, v3, v3
v_add_f32 v126, v12, v13
v_mul_f32 v127, v12, v12
v_add_f32 v126, v126, v14
v_fmac_f32 v127, v13, v13
v_add_f32 v126, v126, v15
v_fmac_f32 v127, v14, v14
v_fmac_f32 v127, v15, v15
v_add_f32 v134, v24, v25
v_mul_f32 v135, v24, v24
v_add_f32 v134, v134, v26
v_fmac_f32 v135, v25, v25
v_add_f32 v134, v134, v27
v_fmac_f32 v135, v26, v26
v_fmac_f32 v135, v27, v27
v_add_f32 v118, v118, v4
v_fmac_f32 v119, v4, v4
v_add_f32 v118, v118, v5
v_fmac_f32 v119, v5, v5
v_add_f32 v118, v118, v6
v_fmac_f32 v119, v6, v6
v_add_f32 v118, v118, v7
v_fmac_f32 v119, v7, v7
v_add_f32 v126, v126, v16
v_fmac_f32 v127, v16, v16
v_add_f32 v126, v126, v17
v_fmac_f32 v127, v17, v17
v_add_f32 v126, v126, v18
v_fmac_f32 v127, v18, v18
v_add_f32 v126, v126, v19
v_fmac_f32 v127, v19, v19
v_add_f32 v134, v134, v28
v_fmac_f32 v135, v28, v28
v_add_f32 v134, v134, v29
v_fmac_f32 v135, v29, v29
v_add_f32 v134, v134, v30
v_fmac_f32 v135, v30, v30
v_add_f32 v134, v134, v31
v_fmac_f32 v135, v31, v31
v_add_f32 v118, v118, v8
v_fmac_f32 v119, v8, v8
v_add_f32 v118, v118, v9
v_fmac_f32 v119, v9, v9
v_add_f32 v118, v118, v10
v_fmac_f32 v119, v10, v10
v_add_f32 v118, v118, v11
v_fmac_f32 v119, v11, v11
v_add_f32 v126, v126, v20
v_fmac_f32 v127, v20, v20
v_add_f32 v126, v126, v21
v_fmac_f32 v127, v21, v21
v_add_f32 v126, v126, v22
v_fmac_f32 v127, v22, v22
v_add_f32 v126, v126, v23
v_fmac_f32 v127, v23, v23
v_add_f32 v134, v134, v32
v_fmac_f32 v135, v32, v32
v_add_f32 v134, v134, v33
v_fmac_f32 v135, v33, v33
v_add_f32 v134, v134, v34
v_fmac_f32 v135, v34, v34
v_add_f32 v134, v134, v35
v_fmac_f32 v135, v35, v35
v_permlane16_swap_b32 v118, v119
v_add_f32 v118, v118, v119
v_permlane16_swap_b32 v126, v127
v_add_f32 v126, v126, v127
v_permlane16_swap_b32 v134, v135
v_add_f32 v134, v134, v135
v_permlane32_swap_b32 v118, v126
v_add_f32 v118, v118, v126
ds_write_b32 v209, v118
v_mov_b32 v135, v134
s_nop 1
v_permlane32_swap_b32 v134, v135
v_add_f32 v134, v134, v135
ds_write_b32 v209, v134 offset:512
s_waitcnt lgkmcnt(0)
s_barrier
s_mul_hi_u32 s41, s35, 58835169
s_mul_i32 s42, s41, 73
s_sub_u32 s42, s35, s42
s_mul_i32 s43, s41, 1373568
s_mul_i32 s51, s42, 2688
s_add_u32 s43, s43, s51
s_cmp_lt_u32 s35, s34
s_cselect_b32 s50, s43, 1879048192
s_add_u32 s35, s35, 32
s_cmp_eq_u32 s42, 0
s_cselect_b32 s44, 536870911, s72
s_cmp_eq_u32 s42, 72
s_cselect_b32 s44, 939524095, s44
s_cmp_eq_u32 s41, 0
s_cselect_b32 s52, 1879048192, s50
s_mov_b32 s37, s50
v_and_b32 v180, s44, v208
s_add_u32 m0, s45, 0
s_nop 0
buffer_load_dwordx4 v180, s[4:7], s52 offen nt lds
s_add_u32 m0, s45, 4112
s_add_u32 s40, s37, 196224
buffer_load_dwordx4 v180, s[4:7], s40 offen nt lds
s_add_u32 m0, s45, 8224
s_add_u32 s40, s37, 392448
buffer_load_dwordx4 v180, s[4:7], s40 offen nt lds
s_add_u32 m0, s45, 12336
s_add_u32 s40, s37, 588672
buffer_load_dwordx4 v180, s[4:7], s40 offen nt lds
s_add_u32 m0, s45, 16448
s_add_u32 s40, s37, 784896
buffer_load_dwordx4 v180, s[4:7], s40 offen nt lds
s_add_u32 m0, s45, 20560
s_add_u32 s40, s37, 981120
buffer_load_dwordx4 v180, s[4:7], s40 offen nt lds
s_add_u32 m0, s45, 24672
s_add_u32 s40, s37, 1177344
buffer_load_dwordx4 v180, s[4:7], s40 offen nt lds
s_add_u32 m0, s45, 28784
s_add_u32 s40, s37, 1373568
buffer_load_dwordx4 v180, s[4:7], s40 offen nt lds
s_add_u32 m0, s45, 32896
s_add_u32 s40, s37, 1569792
buffer_load_dwordx4 v180, s[4:7], s40 offen nt lds
ds_read_b128 v[102:105], v210 offset:18432
ds_read_b128 v[106:109], v210 offset:19456
s_waitcnt lgkmcnt(1)
v_add_f32 v102, v102, v103
s_waitcnt lgkmcnt(0)
v_add_f32 v106, v106, v107
v_add_f32 v104, v104, v105
v_add_f32 v108, v108, v109
v_add_f32 v102, v102, v104
v_add_f32 v106, v106, v108
v_mul_f32 v103, s48, v102
v_mul_f32 v104, s73, v102
v_mul_f32 v106, s73, v106
v_fma_f32 v106, -v103, v104, v106
v_max_f32 v106, 0, v106
v_add_f32 v106, s49, v106
v_rsq_f32 v102, v106
s_nop 0
v_mul_f32_e64 v103, -v103, v102
ds_write_b64 v211, v[102:103]
ds_read_b64 v[118:119], v219
ds_read_b64 v[126:127], v219 offset:256
ds_read_b64 v[134:135], v219 offset:512
s_waitcnt lgkmcnt(2)
v_fma_f32 v220, v0, v118, v119
v_fma_f32 v221, v1, v118, v119
v_cvt_pk_bf16_f32 v90, v220, v221
v_fma_f32 v222, v2, v118, v119
v_fma_f32 v223, v3, v118, v119
v_cvt_pk_bf16_f32 v91, v222, v223
v_fma_f32 v220, v4, v118, v119
v_fma_f32 v221, v5, v118, v119
v_cvt_pk_bf16_f32 v92, v220, v221
v_fma_f32 v222, v6, v118, v119
v_fma_f32 v223, v7, v118, v119
v_cvt_pk_bf16_f32 v93, v222, v223
ds_write_b128 v211, v[90:93]
v_fma_f32 v220, v8, v118, v119
v_fma_f32 v221, v9, v118, v119
v_cvt_pk_bf16_f32 v94, v220, v221
v_fma_f32 v222, v10, v118, v119
v_fma_f32 v223, v11, v118, v119
v_cvt_pk_bf16_f32 v95, v222, v223
s_waitcnt lgkmcnt(2)
ds_write_b64 v212, v[94:95]
v_fma_f32 v220, v12, v126, v127
v_fma_f32 v221, v13, v126, v127
v_cvt_pk_bf16_f32 v174, v220, v221
v_fma_f32 v222, v14, v126, v127
v_fma_f32 v223, v15, v126, v127
v_cvt_pk_bf16_f32 v175, v222, v223
v_fma_f32 v220, v16, v126, v127
v_fma_f32 v221, v17, v126, v127
v_cvt_pk_bf16_f32 v176, v220, v221
v_fma_f32 v222, v18, v126, v127
v_fma_f32 v223, v19, v126, v127
v_cvt_pk_bf16_f32 v177, v222, v223
ds_write_b128 v211, v[174:177] offset:6144
v_fma_f32 v220, v20, v126, v127
v_fma_f32 v221, v21, v126, v127
v_cvt_pk_bf16_f32 v178, v220, v221
v_fma_f32 v222, v22, v126, v127
v_fma_f32 v223, v23, v126, v127
v_cvt_pk_bf16_f32 v179, v222, v223
s_waitcnt lgkmcnt(3)
ds_write_b64 v212, v[178:179] offset:6144
v_fma_f32 v220, v24, v134, v135
v_fma_f32 v221, v25, v134, v135
v_cvt_pk_bf16_f32 v90, v220, v221
v_fma_f32 v222, v26, v134, v135
v_fma_f32 v223, v27, v134, v135
v_cvt_pk_bf16_f32 v91, v222, v223
v_fma_f32 v220, v28, v134, v135
v_fma_f32 v221, v29, v134, v135
v_cvt_pk_bf16_f32 v92, v220, v221
v_fma_f32 v222, v30, v134, v135
v_fma_f32 v223, v31, v134, v135
v_cvt_pk_bf16_f32 v93, v222, v223
ds_write_b128 v211, v[90:93] offset:12288
v_fma_f32 v220, v32, v134, v135
v_fma_f32 v221, v33, v134, v135
v_cvt_pk_bf16_f32 v94, v220, v221
v_fma_f32 v222, v34, v134, v135
v_fma_f32 v223, v35, v134, v135
v_cvt_pk_bf16_f32 v95, v222, v223
ds_write_b64 v212, v[94:95] offset:12288
ds_read_b128 v[182:185], v210 offset:20480
s_waitcnt lgkmcnt(0)
v_mfma_f32_16x16x32_bf16 v[138:141], a[0:3], v[182:185], 0
v_mfma_f32_16x16x32_bf16 v[142:145], a[24:27], v[182:185], 0
v_mfma_f32_16x16x32_bf16 v[146:149], a[48:51], v[182:185], 0
v_mfma_f32_16x16x32_bf16 v[150:153], a[216:219], v[182:185], 0
v_mfma_f32_16x16x32_bf16 v[154:157], a[240:243], v[182:185], 0
v_mfma_f32_16x16x32_bf16 v[158:161], v[232:235], v[182:185], 0
v_mfma_f32_16x16x32_bf16 v[162:165], v[182:185], a[72:75], 0
v_mfma_f32_16x16x32_bf16 v[166:169], v[182:185], a[96:99], 0
v_mfma_f32_16x16x32_bf16 v[170:173], v[182:185], a[120:123], 0
ds_read_b128 v[186:189], v210 offset:21504
s_waitcnt lgkmcnt(0)
v_mfma_f32_16x16x32_bf16 v[138:141], a[4:7], v[186:189], v[138:141]
v_mfma_f32_16x16x32_bf16 v[142:145], a[28:31], v[186:189], v[142:145]
v_mfma_f32_16x16x32_bf16 v[146:149], a[52:55], v[186:189], v[146:149]
v_mfma_f32_16x16x32_bf16 v[150:153], a[220:223], v[186:189], v[150:153]
v_mfma_f32_16x16x32_bf16 v[154:157], a[244:247], v[186:189], v[154:157]
v_mfma_f32_16x16x32_bf16 v[158:161], v[236:239], v[186:189], v[158:161]
v_mfma_f32_16x16x32_bf16 v[162:165], v[186:189], a[76:79], v[162:165]
v_mfma_f32_16x16x32_bf16 v[166:169], v[186:189], a[100:103], v[166:169]
v_mfma_f32_16x16x32_bf16 v[170:173], v[186:189], a[124:127], v[170:173]
ds_read_b128 v[182:185], v210 offset:22528
s_waitcnt lgkmcnt(0)
v_mfma_f32_16x16x32_bf16 v[138:141], a[8:11], v[182:185], v[138:141]
v_mfma_f32_16x16x32_bf16 v[142:145], a[32:35], v[182:185], v[142:145]
v_mfma_f32_16x16x32_bf16 v[146:149], a[56:59], v[182:185], v[146:149]
v_mfma_f32_16x16x32_bf16 v[150:153], a[224:227], v[182:185], v[150:153]
v_mfma_f32_16x16x32_bf16 v[154:157], a[248:251], v[182:185], v[154:157]
v_mfma_f32_16x16x32_bf16 v[158:161], v[240:243], v[182:185], v[158:161]
v_mfma_f32_16x16x32_bf16 v[162:165], v[182:185], a[80:83], v[162:165]
v_mfma_f32_16x16x32_bf16 v[166:169], v[182:185], a[104:107], v[166:169]
v_mfma_f32_16x16x32_bf16 v[170:173], v[182:185], a[128:131], v[170:173]
ds_read_b128 v[186:189], v210 offset:23552
s_waitcnt lgkmcnt(0)
v_mfma_f32_16x16x32_bf16 v[138:141], a[12:15], v[186:189], v[138:141]
v_mfma_f32_16x16x32_bf16 v[142:145], a[36:39], v[186:189], v[142:145]
v_mfma_f32_16x16x32_bf16 v[146:149], a[60:63], v[186:189], v[146:149]
v_mfma_f32_16x16x32_bf16 v[150:153], a[228:231], v[186:189], v[150:153]
v_mfma_f32_16x16x32_bf16 v[154:157], a[252:255], v[186:189], v[154:157]
v_mfma_f32_16x16x32_bf16 v[158:161], v[244:247], v[186:189], v[158:161]
v_mfma_f32_16x16x32_bf16 v[162:165], v[186:189], a[84:87], v[162:165]
v_mfma_f32_16x16x32_bf16 v[166:169], v[186:189], a[108:111], v[166:169]
v_mfma_f32_16x16x32_bf16 v[170:173], v[186:189], a[132:135], v[170:173]
ds_read_b128 v[182:185], v210 offset:24576
s_waitcnt lgkmcnt(0)
v_mfma_f32_16x16x32_bf16 v[138:141], a[16:19], v[182:185], v[138:141]
v_mfma_f32_16x16x32_bf16 v[142:145], a[40:43], v[182:185], v[142:145]
v_mfma_f32_16x16x32_bf16 v[146:149], a[64:67], v[182:185], v[146:149]
v_mfma_f32_16x16x32_bf16 v[150:153], a[232:235], v[182:185], v[150:153]
v_mfma_f32_16x16x32_bf16 v[154:157], v[224:227], v[182:185], v[154:157]
v_mfma_f32_16x16x32_bf16 v[158:161], v[248:251], v[182:185], v[158:161]
v_mfma_f32_16x16x32_bf16 v[162:165], v[182:185], a[88:91], v[162:165]
v_mfma_f32_16x16x32_bf16 v[166:169], v[182:185], a[112:115], v[166:169]
v_mfma_f32_16x16x32_bf16 v[170:173], v[182:185], a[136:139], v[170:173]
ds_read_b128 v[186:189], v210 offset:25600
s_waitcnt lgkmcnt(0)
v_mfma_f32_16x16x32_bf16 v[138:141], a[20:23], v[186:189], v[138:141]
v_mfma_f32_16x16x32_bf16 v[142:145], a[44:47], v[186:189], v[142:145]
v_mfma_f32_16x16x32_bf16 v[146:149], a[68:71], v[186:189], v[146:149]
v_mfma_f32_16x16x32_bf16 v[150:153], a[236:239], v[186:189], v[150:153]
v_mfma_f32_16x16x32_bf16 v[154:157], v[228:231], v[186:189], v[154:157]
v_mfma_f32_16x16x32_bf16 v[158:161], v[252:255], v[186:189], v[158:161]
v_mfma_f32_16x16x32_bf16 v[162:165], v[186:189], a[92:95], v[162:165]
v_mfma_f32_16x16x32_bf16 v[166:169], v[186:189], a[116:119], v[166:169]
v_mfma_f32_16x16x32_bf16 v[170:173], v[186:189], a[140:143], v[170:173]
v_cvt_pk_bf16_f32 v78, v138, v139
v_cvt_pk_bf16_f32 v79, v140, v141
v_cvt_pk_bf16_f32 v80, v142, v143
v_cvt_pk_bf16_f32 v81, v144, v145
v_cvt_pk_bf16_f32 v82, v146, v147
v_cvt_pk_bf16_f32 v83, v148, v149
v_cvt_pk_bf16_f32 v72, v150, v151
v_cvt_pk_bf16_f32 v73, v152, v153
v_cvt_pk_bf16_f32 v74, v154, v155
v_cvt_pk_bf16_f32 v75, v156, v157
v_cvt_pk_bf16_f32 v76, v158, v159
v_cvt_pk_bf16_f32 v77, v160, v161
v_cvt_pk_bf16_f32 v114, v162, v163
v_cvt_pk_bf16_f32 v115, v164, v165
v_cvt_pk_bf16_f32 v122, v166, v167
v_cvt_pk_bf16_f32 v123, v168, v169
v_cvt_pk_bf16_f32 v130, v170, v171
v_cvt_pk_bf16_f32 v131, v172, v173
ds_read_b128 v[182:185], v210 offset:26624
s_waitcnt lgkmcnt(0)
v_mfma_f32_16x16x32_bf16 v[138:141], a[0:3], v[182:185], 0
v_mfma_f32_16x16x32_bf16 v[142:145], a[24:27], v[182:185], 0
v_mfma_f32_16x16x32_bf16 v[146:149], a[48:51], v[182:185], 0
v_mfma_f32_16x16x32_bf16 v[150:153], a[216:219], v[182:185], 0
v_mfma_f32_16x16x32_bf16 v[154:157], a[240:243], v[182:185], 0
v_mfma_f32_16x16x32_bf16 v[158:161], v[232:235], v[182:185], 0
v_mfma_f32_16x16x32_bf16 v[162:165], v[182:185], a[72:75], 0
v_mfma_f32_16x16x32_bf16 v[166:169], v[182:185], a[96:99], 0
v_mfma_f32_16x16x32_bf16 v[170:173], v[182:185], a[120:123], 0
ds_read_b128 v[186:189], v210 offset:27648
s_waitcnt lgkmcnt(0)
v_mfma_f32_16x16x32_bf16 v[138:141], a[4:7], v[186:189], v[138:141]
v_mfma_f32_16x16x32_bf16 v[142:145], a[28:31], v[186:189], v[142:145]
v_mfma_f32_16x16x32_bf16 v[146:149], a[52:55], v[186:189], v[146:149]
v_mfma_f32_16x16x32_bf16 v[150:153], a[220:223], v[186:189], v[150:153]
v_mfma_f32_16x16x32_bf16 v[154:157], a[244:247], v[186:189], v[154:157]
v_mfma_f32_16x16x32_bf16 v[158:161], v[236:239], v[186:189], v[158:161]
v_mfma_f32_16x16x32_bf16 v[162:165], v[186:189], a[76:79], v[162:165]
v_mfma_f32_16x16x32_bf16 v[166:169], v[186:189], a[100:103], v[166:169]
v_mfma_f32_16x16x32_bf16 v[170:173], v[186:189], a[124:127], v[170:173]
ds_read_b128 v[182:185], v210 offset:28672
s_waitcnt lgkmcnt(0)
v_mfma_f32_16x16x32_bf16 v[138:141], a[8:11], v[182:185], v[138:141]
v_mfma_f32_16x16x32_bf16 v[142:145], a[32:35], v[182:185], v[142:145]
v_mfma_f32_16x16x32_bf16 v[146:149], a[56:59], v[182:185], v[146:149]
v_mfma_f32_16x16x32_bf16 v[150:153], a[224:227], v[182:185], v[150:153]
v_mfma_f32_16x16x32_bf16 v[154:157], a[248:251], v[182:185], v[154:157]
v_mfma_f32_16x16x32_bf16 v[158:161], v[240:243], v[182:185], v[158:161]
v_mfma_f32_16x16x32_bf16 v[162:165], v[182:185], a[80:83], v[162:165]
v_mfma_f32_16x16x32_bf16 v[166:169], v[182:185], a[104:107], v[166:169]
v_mfma_f32_16x16x32_bf16 v[170:173], v[182:185], a[128:131], v[170:173]
ds_read_b128 v[186:189], v210 offset:29696
s_waitcnt lgkmcnt(0)
v_mfma_f32_16x16x32_bf16 v[138:141], a[12:15], v[186:189], v[138:141]
v_mfma_f32_16x16x32_bf16 v[142:145], a[36:39], v[186:189], v[142:145]
v_mfma_f32_16x16x32_bf16 v[146:149], a[60:63], v[186:189], v[146:149]
v_mfma_f32_16x16x32_bf16 v[150:153], a[228:231], v[186:189], v[150:153]
v_mfma_f32_16x16x32_bf16 v[154:157], a[252:255], v[186:189], v[154:157]
v_mfma_f32_16x16x32_bf16 v[158:161], v[244:247], v[186:189], v[158:161]
v_mfma_f32_16x16x32_bf16 v[162:165], v[186:189], a[84:87], v[162:165]
v_mfma_f32_16x16x32_bf16 v[166:169], v[186:189], a[108:111], v[166:169]
v_mfma_f32_16x16x32_bf16 v[170:173], v[186:189], a[132:135], v[170:173]
ds_read_b128 v[182:185], v210 offset:30720
s_waitcnt lgkmcnt(0)
v_mfma_f32_16x16x32_bf16 v[138:141], a[16:19], v[182:185], v[138:141]
v_mfma_f32_16x16x32_bf16 v[142:145], a[40:43], v[182:185], v[142:145]
v_mfma_f32_16x16x32_bf16 v[146:149], a[64:67], v[182:185], v[146:149]
v_mfma_f32_16x16x32_bf16 v[150:153], a[232:235], v[182:185], v[150:153]
v_mfma_f32_16x16x32_bf16 v[154:157], v[224:227], v[182:185], v[154:157]
v_mfma_f32_16x16x32_bf16 v[158:161], v[248:251], v[182:185], v[158:161]
v_mfma_f32_16x16x32_bf16 v[162:165], v[182:185], a[88:91], v[162:165]
v_mfma_f32_16x16x32_bf16 v[166:169], v[182:185], a[112:115], v[166:169]
v_mfma_f32_16x16x32_bf16 v[170:173], v[182:185], a[136:139], v[170:173]
ds_read_b128 v[186:189], v210 offset:31744
s_waitcnt lgkmcnt(0)
v_mfma_f32_16x16x32_bf16 v[138:141], a[20:23], v[186:189], v[138:141]
v_mfma_f32_16x16x32_bf16 v[142:145], a[44:47], v[186:189], v[142:145]
v_mfma_f32_16x16x32_bf16 v[146:149], a[68:71], v[186:189], v[146:149]
v_mfma_f32_16x16x32_bf16 v[150:153], a[236:239], v[186:189], v[150:153]
v_mfma_f32_16x16x32_bf16 v[154:157], v[228:231], v[186:189], v[154:157]
v_mfma_f32_16x16x32_bf16 v[158:161], v[252:255], v[186:189], v[158:161]
v_mfma_f32_16x16x32_bf16 v[162:165], v[186:189], a[92:95], v[162:165]
v_mfma_f32_16x16x32_bf16 v[166:169], v[186:189], a[116:119], v[166:169]
v_mfma_f32_16x16x32_bf16 v[170:173], v[186:189], a[140:143], v[170:173]
v_cvt_pk_bf16_f32 v96, v138, v139
v_cvt_pk_bf16_f32 v97, v140, v141
v_cvt_pk_bf16_f32 v98, v142, v143
v_cvt_pk_bf16_f32 v99, v144, v145
v_cvt_pk_bf16_f32 v100, v146, v147
v_cvt_pk_bf16_f32 v101, v148, v149
v_cvt_pk_bf16_f32 v84, v150, v151
v_cvt_pk_bf16_f32 v85, v152, v153
v_cvt_pk_bf16_f32 v86, v154, v155
v_cvt_pk_bf16_f32 v87, v156, v157
v_cvt_pk_bf16_f32 v88, v158, v159
v_cvt_pk_bf16_f32 v89, v160, v161
v_cvt_pk_bf16_f32 v116, v162, v163
v_cvt_pk_bf16_f32 v117, v164, v165
v_cvt_pk_bf16_f32 v124, v166, v167
v_cvt_pk_bf16_f32 v125, v168, v169
v_cvt_pk_bf16_f32 v132, v170, v171
v_cvt_pk_bf16_f32 v133, v172, v173
ds_read_b128 v[182:185], v210 offset:32768
s_waitcnt lgkmcnt(0)
v_mfma_f32_16x16x32_bf16 v[138:141], a[0:3], v[182:185], 0
v_mfma_f32_16x16x32_bf16 v[142:145], a[24:27], v[182:185], 0
v_mfma_f32_16x16x32_bf16 v[146:149], a[48:51], v[182:185], 0
ds_read_b128 v[186:189], v210 offset:33792
s_waitcnt lgkmcnt(0)
v_mfma_f32_16x16x32_bf16 v[138:141], a[4:7], v[186:189], v[138:141]
v_mfma_f32_16x16x32_bf16 v[142:145], a[28:31], v[186:189], v[142:145]
v_mfma_f32_16x16x32_bf16 v[146:149], a[52:55], v[186:189], v[146:149]
ds_read_b128 v[182:185], v210 offset:34816
s_waitcnt lgkmcnt(0)
v_mfma_f32_16x16x32_bf16 v[138:141], a[8:11], v[182:185], v[138:141]
v_mfma_f32_16x16x32_bf16 v[142:145], a[32:35], v[182:185], v[142:145]
v_mfma_f32_16x16x32_bf16 v[146:149], a[56:59], v[182:185], v[146:149]
ds_read_b128 v[186:189], v210 offset:35840
s_waitcnt lgkmcnt(0)
v_mfma_f32_16x16x32_bf16 v[138:141], a[12:15], v[186:189], v[138:141]
v_mfma_f32_16x16x32_bf16 v[142:145], a[36:39], v[186:189], v[142:145]
v_mfma_f32_16x16x32_bf16 v[146:149], a[60:63], v[186:189], v[146:149]
ds_read_b128 v[182:185], v210 offset:36864
s_waitcnt lgkmcnt(0)
v_mfma_f32_16x16x32_bf16 v[138:141], a[16:19], v[182:185], v[138:141]
v_mfma_f32_16x16x32_bf16 v[142:145], a[40:43], v[182:185], v[142:145]
v_mfma_f32_16x16x32_bf16 v[146:149], a[64:67], v[182:185], v[146:149]
ds_read_b128 v[186:189], v210 offset:37888
s_waitcnt lgkmcnt(0)
v_mfma_f32_16x16x32_bf16 v[138:141], a[20:23], v[186:189], v[138:141]
v_mfma_f32_16x16x32_bf16 v[142:145], a[44:47], v[186:189], v[142:145]
v_mfma_f32_16x16x32_bf16 v[146:149], a[68:71], v[186:189], v[146:149]
v_cvt_pk_bf16_f32 v102, v138, v139
v_cvt_pk_bf16_f32 v103, v140, v141
s_nop 0
v_cvt_pk_bf16_f32 v104, v142, v143
v_cvt_pk_bf16_f32 v105, v144, v145
s_nop 1
v_cvt_pk_bf16_f32 v106, v146, v147
v_cvt_pk_bf16_f32 v107, v148, v149
ds_read_b128 v[108:111], v215 offset:512
ds_read_b64 v[112:113], v215 offset:528
v_mov_b32 v181, 0
v_mfma_f32_16x16x16_bf16 v[138:141], v[82:83], v[76:77], 0
v_mfma_f32_16x16x16_bf16 v[142:145], v[100:101], v[76:77], 0
s_waitcnt lgkmcnt(0)
v_mfma_f32_16x16x16_bf16 v[150:153], v[112:113], v[76:77], v[206:209]
v_mfma_f32_16x16x16_bf16 v[146:149], v[106:107], v[76:77], 0
v_mfma_f32_16x16x32_bf16 v[138:141], v[78:81], v[72:75], v[138:141]
v_mfma_f32_16x16x32_bf16 v[142:145], v[96:99], v[72:75], v[142:145]
v_mfma_f32_16x16x32_bf16 v[150:153], v[108:111], v[72:75], v[150:153]
v_mfma_f32_16x16x32_bf16 v[146:149], v[102:105], v[72:75], v[146:149]
ds_read_b128 v[72:75], v215
ds_read_b64 v[76:77], v215 offset:16
v_mfma_f32_16x16x16_bf16 v[154:157], v[82:83], v[88:89], 0
v_mfma_f32_16x16x16_bf16 v[158:161], v[100:101], v[88:89], 0
v_mfma_f32_16x16x16_bf16 v[166:169], v[112:113], v[88:89], v[206:209]
v_mfma_f32_16x16x16_bf16 v[162:165], v[106:107], v[88:89], 0
v_mfma_f32_16x16x32_bf16 v[154:157], v[78:81], v[84:87], v[154:157]
v_mfma_f32_16x16x32_bf16 v[158:161], v[96:99], v[84:87], v[158:161]
v_mfma_f32_16x16x32_bf16 v[166:169], v[108:111], v[84:87], v[166:169]
v_mfma_f32_16x16x32_bf16 v[162:165], v[102:105], v[84:87], v[162:165]
ds_read_b128 v[182:185], v210 offset:32768
s_waitcnt lgkmcnt(0)
v_mfma_f32_16x16x32_bf16 v[118:121], v[182:185], a[72:75], 0
v_mfma_f32_16x16x32_bf16 v[126:129], v[182:185], a[96:99], 0
v_mfma_f32_16x16x32_bf16 v[134:137], v[182:185], a[120:123], 0
v_mfma_f32_16x16x32_bf16 v[90:93], a[216:219], v[182:185], 0
v_mfma_f32_16x16x32_bf16 v[170:173], a[240:243], v[182:185], 0
v_mfma_f32_16x16x32_bf16 v[220:223], v[232:235], v[182:185], 0
ds_read_b128 v[186:189], v210 offset:33792
s_waitcnt lgkmcnt(0)
v_mfma_f32_16x16x32_bf16 v[118:121], v[186:189], a[76:79], v[118:121]
v_mfma_f32_16x16x32_bf16 v[126:129], v[186:189], a[100:103], v[126:129]
v_mfma_f32_16x16x32_bf16 v[134:137], v[186:189], a[124:127], v[134:137]
v_mfma_f32_16x16x32_bf16 v[90:93], a[220:223], v[186:189], v[90:93]
v_mfma_f32_16x16x32_bf16 v[170:173], a[244:247], v[186:189], v[170:173]
v_mfma_f32_16x16x32_bf16 v[220:223], v[236:239], v[186:189], v[220:223]
ds_read_b128 v[182:185], v210 offset:34816
s_waitcnt lgkmcnt(0)
v_mfma_f32_16x16x32_bf16 v[118:121], v[182:185], a[80:83], v[118:121]
v_mfma_f32_16x16x32_bf16 v[126:129], v[182:185], a[104:107], v[126:129]
v_mfma_f32_16x16x32_bf16 v[134:137], v[182:185], a[128:131], v[134:137]
v_mfma_f32_16x16x32_bf16 v[90:93], a[224:227], v[182:185], v[90:93]
v_mfma_f32_16x16x32_bf16 v[170:173], a[248:251], v[182:185], v[170:173]
v_mfma_f32_16x16x32_bf16 v[220:223], v[240:243], v[182:185], v[220:223]
ds_read_b128 v[186:189], v210 offset:35840
s_waitcnt lgkmcnt(0)
v_mfma_f32_16x16x32_bf16 v[118:121], v[186:189], a[84:87], v[118:121]
v_mfma_f32_16x16x32_bf16 v[126:129], v[186:189], a[108:111], v[126:129]
v_mfma_f32_16x16x32_bf16 v[134:137], v[186:189], a[132:135], v[134:137]
v_mfma_f32_16x16x32_bf16 v[90:93], a[228:231], v[186:189], v[90:93]
v_mfma_f32_16x16x32_bf16 v[170:173], a[252:255], v[186:189], v[170:173]
v_mfma_f32_16x16x32_bf16 v[220:223], v[244:247], v[186:189], v[220:223]
ds_read_b128 v[182:185], v210 offset:36864
s_waitcnt lgkmcnt(0)
v_mfma_f32_16x16x32_bf16 v[118:121], v[182:185], a[88:91], v[118:121]
v_mfma_f32_16x16x32_bf16 v[126:129], v[182:185], a[112:115], v[126:129]
v_mfma_f32_16x16x32_bf16 v[134:137], v[182:185], a[136:139], v[134:137]
v_mfma_f32_16x16x32_bf16 v[90:93], a[232:235], v[182:185], v[90:93]
v_mfma_f32_16x16x32_bf16 v[170:173], v[224:227], v[182:185], v[170:173]
v_mfma_f32_16x16x32_bf16 v[220:223], v[248:251], v[182:185], v[220:223]
ds_read_b128 v[186:189], v210 offset:37888
s_waitcnt lgkmcnt(0)
v_mfma_f32_16x16x32_bf16 v[118:121], v[186:189], a[92:95], v[118:121]
v_mfma_f32_16x16x32_bf16 v[126:129], v[186:189], a[116:119], v[126:129]
v_mfma_f32_16x16x32_bf16 v[134:137], v[186:189], a[140:143], v[134:137]
v_mfma_f32_16x16x32_bf16 v[90:93], a[236:239], v[186:189], v[90:93]
v_mfma_f32_16x16x32_bf16 v[170:173], v[228:231], v[186:189], v[170:173]
v_mfma_f32_16x16x32_bf16 v[220:223], v[252:255], v[186:189], v[220:223]
v_cvt_pk_bf16_f32 v118, v118, v119
v_cvt_pk_bf16_f32 v119, v120, v121
ds_read_u16 v120, v214 offset:1024
v_mov_b32 v121, 0
v_cvt_pk_bf16_f32 v126, v126, v127
v_cvt_pk_bf16_f32 v127, v128, v129
ds_read_u16 v128, v214 offset:1032
v_mov_b32 v129, 0
v_cvt_pk_bf16_f32 v134, v134, v135
v_cvt_pk_bf16_f32 v135, v136, v137
ds_read_u16 v136, v214 offset:1040
v_mov_b32 v137, 0
v_cvt_pk_bf16_f32 v90, v90, v91
v_cvt_pk_bf16_f32 v91, v92, v93
v_cvt_pk_bf16_f32 v92, v170, v171
v_cvt_pk_bf16_f32 v93, v172, v173
v_cvt_pk_bf16_f32 v94, v220, v221
v_cvt_pk_bf16_f32 v95, v222, v223
v_max3_f32 v151, v138, v139, v140
v_max3_f32 v151, v151, v141, v142
v_max3_f32 v151, v151, v143, v144
v_max3_f32 v151, v151, v145, v146
v_max3_f32 v151, v151, v147, v148
v_max3_f32 v151, v151, v149, v150
v_mov_b32 v152, v151
s_nop 1
v_permlane16_swap_b32 v151, v152
v_max_f32 v151, v151, v152
v_mov_b32 v152, v151
s_nop 1
v_permlane32_swap_b32 v151, v152
v_max_f32 v151, v151, v152
v_sub_f32 v138, v138, v151
v_sub_f32 v139, v139, v151
v_sub_f32 v140, v140, v151
v_sub_f32 v141, v141, v151
v_sub_f32 v142, v142, v151
v_sub_f32 v143, v143, v151
v_sub_f32 v144, v144, v151
v_sub_f32 v145, v145, v151
v_sub_f32 v150, v150, v151
v_sub_f32 v146, v146, v151
v_sub_f32 v147, v147, v151
v_sub_f32 v148, v148, v151
v_sub_f32 v149, v149, v151
v_exp_f32 v138, v138
v_exp_f32 v139, v139
v_exp_f32 v140, v140
v_exp_f32 v141, v141
v_exp_f32 v142, v142
v_exp_f32 v143, v143
v_exp_f32 v144, v144
v_exp_f32 v145, v145
v_exp_f32 v150, v150
v_exp_f32 v146, v146
v_exp_f32 v147, v147
v_exp_f32 v148, v148
v_exp_f32 v149, v149
v_cvt_pk_bf16_f32 v174, v138, v139
v_cvt_pk_bf16_f32 v175, v140, v141
v_cvt_pk_bf16_f32 v176, v142, v143
v_cvt_pk_bf16_f32 v177, v144, v145
v_cvt_pk_bf16_f32 v178, v146, v147
v_cvt_pk_bf16_f32 v179, v148, v149
v_cvt_pk_bf16_f32 v180, v150, 0
v_mfma_f32_16x16x32_bf16 v[150:153], v[190:193], v[174:177], 0
v_mfma_f32_16x16x32_bf16 v[138:141], v[114:117], v[174:177], 0
v_mfma_f32_16x16x32_bf16 v[142:145], v[122:125], v[174:177], 0
v_mfma_f32_16x16x32_bf16 v[146:149], v[130:133], v[174:177], 0
v_mfma_f32_16x16x32_bf16 v[150:153], v[190:193], v[178:181], v[150:153]
s_waitcnt lgkmcnt(2)
v_mfma_f32_16x16x32_bf16 v[138:141], v[118:121], v[178:181], v[138:141]
s_waitcnt lgkmcnt(1)
v_mfma_f32_16x16x32_bf16 v[142:145], v[126:129], v[178:181], v[142:145]
s_waitcnt lgkmcnt(0)
v_mfma_f32_16x16x32_bf16 v[146:149], v[134:137], v[178:181], v[146:149]
v_max3_f32 v167, v154, v155, v156
v_max3_f32 v167, v167, v157, v158
v_max3_f32 v167, v167, v159, v160
v_max3_f32 v167, v167, v161, v162
v_max3_f32 v167, v167, v163, v164
v_max3_f32 v167, v167, v165, v166
v_mov_b32 v168, v167
s_nop 1
v_permlane16_swap_b32 v167, v168
v_max_f32 v167, v167, v168
v_mov_b32 v168, v167
s_nop 1
v_permlane32_swap_b32 v167, v168
v_max_f32 v167, v167, v168
v_sub_f32 v154, v154, v167
v_sub_f32 v155, v155, v167
v_sub_f32 v156, v156, v167
v_sub_f32 v157, v157, v167
v_sub_f32 v158, v158, v167
v_sub_f32 v159, v159, v167
v_sub_f32 v160, v160, v167
v_sub_f32 v161, v161, v167
v_sub_f32 v166, v166, v167
v_sub_f32 v162, v162, v167
v_sub_f32 v163, v163, v167
v_sub_f32 v164, v164, v167
v_sub_f32 v165, v165, v167
v_exp_f32 v154, v154
v_exp_f32 v155, v155
v_exp_f32 v156, v156
v_exp_f32 v157, v157
v_exp_f32 v158, v158
v_exp_f32 v159, v159
v_exp_f32 v160, v160
v_exp_f32 v161, v161
v_exp_f32 v166, v166
v_exp_f32 v162, v162
v_exp_f32 v163, v163
v_exp_f32 v164, v164
v_exp_f32 v165, v165
v_cvt_pk_bf16_f32 v174, v154, v155
v_cvt_pk_bf16_f32 v175, v156, v157
v_cvt_pk_bf16_f32 v176, v158, v159
v_cvt_pk_bf16_f32 v177, v160, v161
v_cvt_pk_bf16_f32 v178, v162, v163
v_cvt_pk_bf16_f32 v179, v164, v165
v_cvt_pk_bf16_f32 v180, v166, 0
v_mfma_f32_16x16x32_bf16 v[166:169], v[190:193], v[174:177], 0
v_mfma_f32_16x16x32_bf16 v[154:157], v[114:117], v[174:177], 0
v_mfma_f32_16x16x32_bf16 v[158:161], v[122:125], v[174:177], 0
v_mfma_f32_16x16x32_bf16 v[162:165], v[130:133], v[174:177], 0
v_mfma_f32_16x16x32_bf16 v[166:169], v[190:193], v[178:181], v[166:169]
v_mfma_f32_16x16x32_bf16 v[154:157], v[118:121], v[178:181], v[154:157]
v_mfma_f32_16x16x32_bf16 v[158:161], v[126:129], v[178:181], v[158:161]
v_mfma_f32_16x16x32_bf16 v[162:165], v[134:137], v[178:181], v[162:165]
v_rcp_f32 v151, v150
s_nop 0
v_mul_f32 v151, s3, v151
v_mul_f32 v138, v138, v151
v_mul_f32 v139, v139, v151
v_cvt_pk_bf16_f32 v138, v138, v139
v_mul_f32 v140, v140, v151
v_mul_f32 v141, v141, v151
v_cvt_pk_bf16_f32 v139, v140, v141
v_mul_f32 v142, v142, v151
v_mul_f32 v143, v143, v151
v_cvt_pk_bf16_f32 v140, v142, v143
v_mul_f32 v144, v144, v151
v_mul_f32 v145, v145, v151
v_cvt_pk_bf16_f32 v141, v144, v145
ds_write_b128 v211, v[138:141] offset:38912
v_mul_f32 v146, v146, v151
v_mul_f32 v147, v147, v151
v_cvt_pk_bf16_f32 v142, v146, v147
v_mul_f32 v148, v148, v151
v_mul_f32 v149, v149, v151
v_cvt_pk_bf16_f32 v143, v148, v149
ds_write_b64 v212, v[142:143] offset:38912
v_mfma_f32_16x16x32_bf16 v[138:141], v[78:81], v[90:93], 0
v_mfma_f32_16x16x32_bf16 v[142:145], v[96:99], v[90:93], 0
v_mfma_f32_16x16x32_bf16 v[150:153], v[108:111], v[90:93], v[206:209]
v_mfma_f32_16x16x32_bf16 v[146:149], v[102:105], v[90:93], 0
v_mfma_f32_16x16x16_bf16 v[138:141], v[82:83], v[94:95], v[138:141]
v_mfma_f32_16x16x16_bf16 v[142:145], v[100:101], v[94:95], v[142:145]
v_mfma_f32_16x16x16_bf16 v[150:153], v[112:113], v[94:95], v[150:153]
v_mfma_f32_16x16x16_bf16 v[146:149], v[106:107], v[94:95], v[146:149]
v_rcp_f32 v167, v166
s_nop 0
v_mul_f32 v167, s3, v167
v_mul_f32 v154, v154, v167
v_mul_f32 v155, v155, v167
v_cvt_pk_bf16_f32 v154, v154, v155
v_mul_f32 v156, v156, v167
v_mul_f32 v157, v157, v167
v_cvt_pk_bf16_f32 v155, v156, v157
v_mul_f32 v158, v158, v167
v_mul_f32 v159, v159, v167
v_cvt_pk_bf16_f32 v156, v158, v159
v_mul_f32 v160, v160, v167
v_mul_f32 v161, v161, v167
v_cvt_pk_bf16_f32 v157, v160, v161
ds_write_b128 v211, v[154:157] offset:45056
v_mul_f32 v162, v162, v167
v_mul_f32 v163, v163, v167
v_cvt_pk_bf16_f32 v158, v162, v163
v_mul_f32 v164, v164, v167
v_mul_f32 v165, v165, v167
v_cvt_pk_bf16_f32 v159, v164, v165
ds_write_b64 v212, v[158:159] offset:45056
v_mfma_f32_16x16x16_bf16 v[154:157], v[76:77], v[82:83], 0
v_mfma_f32_16x16x16_bf16 v[158:161], v[76:77], v[100:101], 0
v_mfma_f32_16x16x16_bf16 v[162:165], v[76:77], v[106:107], 0
v_mfma_f32_16x16x16_bf16 v[166:169], v[76:77], v[112:113], v[206:209]
v_mfma_f32_16x16x32_bf16 v[154:157], v[72:75], v[78:81], v[154:157]
v_mfma_f32_16x16x32_bf16 v[158:161], v[72:75], v[96:99], v[158:161]
v_mfma_f32_16x16x32_bf16 v[162:165], v[72:75], v[102:105], v[162:165]
v_mfma_f32_16x16x32_bf16 v[166:169], v[72:75], v[108:111], v[166:169]
v_mov_b32_dpp v154, v158 quad_perm:[0,1,2,3] row_mask:0x2 bank_mask:0xf
s_nop 1
v_mov_b32_dpp v154, v162 quad_perm:[0,1,2,3] row_mask:0x4 bank_mask:0xf
s_nop 2
v_mov_b32_dpp v154, v167 quad_perm:[0,1,2,3] row_mask:0x8 bank_mask:0xf
v_mov_b32 v155, v154
s_nop 1
v_max_f32_dpp v155, v155, v155 row_ror:8 row_mask:0xf bank_mask:0xf
s_nop 1
v_max_f32_dpp v155, v155, v155 row_ror:4 row_mask:0xf bank_mask:0xf
s_nop 1
v_max_f32_dpp v155, v155, v155 row_ror:2 row_mask:0xf bank_mask:0xf
s_nop 1
v_max_f32_dpp v155, v155, v155 row_ror:1 row_mask:0xf bank_mask:0xf
v_mov_b32 v156, v155
s_nop 1
v_permlane16_swap_b32 v155, v156
v_max_f32 v155, v155, v156
v_mov_b32 v156, v155
s_nop 1
v_permlane32_swap_b32 v155, v156
v_max_f32 v155, v155, v156
v_sub_f32 v154, v154, v155
v_exp_f32 v154, v154
s_nop 0
v_cvt_pk_bf16_f32 v154, v154, 0
ds_write_b16 v214, v154
s_waitcnt lgkmcnt(1)
ds_read_b128 v[84:87], v215
ds_read_b128 v[88:91], v215 offset:16
v_add_u32 v215, 1552, v215
s_barrier
ds_read_b128 v[170:173], v210 offset:38912
s_waitcnt lgkmcnt(0)
v_mfma_f32_16x16x32_bf16 v[36:39], a[144:147], v[170:173], v[36:39]
v_mfma_f32_16x16x32_bf16 v[40:43], a[168:171], v[170:173], v[40:43]
v_mfma_f32_16x16x32_bf16 v[44:47], a[192:195], v[170:173], v[44:47]
ds_read_b128 v[182:185], v210 offset:39936
s_waitcnt lgkmcnt(0)
v_mfma_f32_16x16x32_bf16 v[36:39], a[148:151], v[182:185], v[36:39]
v_mfma_f32_16x16x32_bf16 v[40:43], a[172:175], v[182:185], v[40:43]
v_mfma_f32_16x16x32_bf16 v[44:47], a[196:199], v[182:185], v[44:47]
ds_read_b128 v[186:189], v210 offset:40960
s_waitcnt lgkmcnt(0)
v_mfma_f32_16x16x32_bf16 v[36:39], a[152:155], v[186:189], v[36:39]
v_mfma_f32_16x16x32_bf16 v[40:43], a[176:179], v[186:189], v[40:43]
v_mfma_f32_16x16x32_bf16 v[44:47], a[200:203], v[186:189], v[44:47]
ds_read_b128 v[170:173], v210 offset:41984
s_waitcnt lgkmcnt(0)
v_mfma_f32_16x16x32_bf16 v[36:39], a[156:159], v[170:173], v[36:39]
v_mfma_f32_16x16x32_bf16 v[40:43], a[180:183], v[170:173], v[40:43]
v_mfma_f32_16x16x32_bf16 v[44:47], a[204:207], v[170:173], v[44:47]
ds_read_b128 v[182:185], v210 offset:43008
s_waitcnt lgkmcnt(0)
v_mfma_f32_16x16x32_bf16 v[36:39], a[160:163], v[182:185], v[36:39]
v_mfma_f32_16x16x32_bf16 v[40:43], a[184:187], v[182:185], v[40:43]
v_mfma_f32_16x16x32_bf16 v[44:47], a[208:211], v[182:185], v[44:47]
ds_read_b128 v[186:189], v210 offset:44032
s_waitcnt lgkmcnt(0)
v_mfma_f32_16x16x32_bf16 v[36:39], a[164:167], v[186:189], v[36:39]
v_mfma_f32_16x16x32_bf16 v[40:43], a[188:191], v[186:189], v[40:43]
v_mfma_f32_16x16x32_bf16 v[44:47], a[212:215], v[186:189], v[44:47]
v_cvt_pk_bf16_f32 v72, v36, v37
v_cvt_pk_bf16_f32 v73, v38, v39
buffer_store_dwordx2 v[72:73], v203, s[8:11], s39 offen
v_cvt_pk_bf16_f32 v74, v40, v41
v_cvt_pk_bf16_f32 v75, v42, v43
buffer_store_dwordx2 v[74:75], v203, s[8:11], s39 offen offset:32
s_nop 0
v_cvt_pk_bf16_f32 v76, v44, v45
v_cvt_pk_bf16_f32 v77, v46, v47
buffer_store_dwordx2 v[76:77], v203, s[8:11], s39 offen offset:64
v_max3_f32 v151, v138, v139, v140
v_max3_f32 v151, v151, v141, v142
v_max3_f32 v151, v151, v143, v144
v_max3_f32 v151, v151, v145, v146
v_max3_f32 v151, v151, v147, v148
v_max3_f32 v151, v151, v149, v150
v_mov_b32 v152, v151
s_nop 1
v_permlane16_swap_b32 v151, v152
v_max_f32 v151, v151, v152
v_mov_b32 v152, v151
s_nop 1
v_permlane32_swap_b32 v151, v152
v_max_f32 v151, v151, v152
v_sub_f32 v138, v138, v151
v_sub_f32 v139, v139, v151
v_sub_f32 v140, v140, v151
v_sub_f32 v141, v141, v151
v_sub_f32 v142, v142, v151
v_sub_f32 v143, v143, v151
v_sub_f32 v144, v144, v151
v_sub_f32 v145, v145, v151
v_sub_f32 v150, v150, v151
v_sub_f32 v146, v146, v151
v_sub_f32 v147, v147, v151
v_sub_f32 v148, v148, v151
v_sub_f32 v149, v149, v151
v_exp_f32 v138, v138
v_exp_f32 v139, v139
v_exp_f32 v140, v140
v_exp_f32 v141, v141
v_exp_f32 v142, v142
v_exp_f32 v143, v143
v_exp_f32 v144, v144
v_exp_f32 v145, v145
v_exp_f32 v150, v150
v_exp_f32 v146, v146
v_exp_f32 v147, v147
v_exp_f32 v148, v148
v_exp_f32 v149, v149
v_cvt_pk_bf16_f32 v174, v138, v139
v_cvt_pk_bf16_f32 v175, v140, v141
v_cvt_pk_bf16_f32 v176, v142, v143
v_cvt_pk_bf16_f32 v177, v144, v145
v_cvt_pk_bf16_f32 v178, v146, v147
v_cvt_pk_bf16_f32 v179, v148, v149
v_cvt_pk_bf16_f32 v180, v150, 0
v_mfma_f32_16x16x32_bf16 v[150:153], v[190:193], v[174:177], 0
v_mfma_f32_16x16x32_bf16 v[138:141], v[114:117], v[174:177], 0
v_mfma_f32_16x16x32_bf16 v[142:145], v[122:125], v[174:177], 0
v_mfma_f32_16x16x32_bf16 v[146:149], v[130:133], v[174:177], 0
v_mfma_f32_16x16x32_bf16 v[150:153], v[190:193], v[178:181], v[150:153]
v_mfma_f32_16x16x32_bf16 v[138:141], v[118:121], v[178:181], v[138:141]
v_mfma_f32_16x16x32_bf16 v[142:145], v[126:129], v[178:181], v[142:145]
v_mfma_f32_16x16x32_bf16 v[146:149], v[134:137], v[178:181], v[146:149]
v_mfma_f32_16x16x32_bf16 v[166:169], v[84:87], v[190:193], 0
v_mfma_f32_16x16x32_bf16 v[154:157], v[84:87], v[114:117], 0
v_mfma_f32_16x16x32_bf16 v[158:161], v[84:87], v[122:125], 0
v_mfma_f32_16x16x32_bf16 v[162:165], v[84:87], v[130:133], 0
v_mfma_f32_16x16x32_bf16 v[166:169], v[88:91], v[190:193], v[166:169]
v_mfma_f32_16x16x32_bf16 v[154:157], v[88:91], v[118:121], v[154:157]
v_mfma_f32_16x16x32_bf16 v[158:161], v[88:91], v[126:129], v[158:161]
v_mfma_f32_16x16x32_bf16 v[162:165], v[88:91], v[134:137], v[162:165]
v_rcp_f32 v167, v166
s_nop 1
v_mov_b32_dpp v154, v158 quad_perm:[0,1,2,3] row_mask:0x2 bank_mask:0xf
s_nop 2
v_mov_b32_dpp v154, v162 quad_perm:[0,1,2,3] row_mask:0x4 bank_mask:0xf
v_mul_f32 v167, s3, v167
v_mul_f32 v154, v154, v167
v_cvt_pk_bf16_f32 v154, v154, 0
ds_write_b16 v214, v154
v_add_u32 v214, 1552, v214
ds_read_b128 v[170:173], v210 offset:45056
s_waitcnt lgkmcnt(0)
v_mfma_f32_16x16x32_bf16 v[48:51], a[144:147], v[170:173], v[48:51]
v_mfma_f32_16x16x32_bf16 v[52:55], a[168:171], v[170:173], v[52:55]
v_mfma_f32_16x16x32_bf16 v[56:59], a[192:195], v[170:173], v[56:59]
ds_read_b128 v[182:185], v210 offset:46080
s_waitcnt lgkmcnt(0)
v_mfma_f32_16x16x32_bf16 v[48:51], a[148:151], v[182:185], v[48:51]
v_mfma_f32_16x16x32_bf16 v[52:55], a[172:175], v[182:185], v[52:55]
v_mfma_f32_16x16x32_bf16 v[56:59], a[196:199], v[182:185], v[56:59]
ds_read_b128 v[186:189], v210 offset:47104
s_waitcnt lgkmcnt(0)
v_mfma_f32_16x16x32_bf16 v[48:51], a[152:155], v[186:189], v[48:51]
v_mfma_f32_16x16x32_bf16 v[52:55], a[176:179], v[186:189], v[52:55]
v_mfma_f32_16x16x32_bf16 v[56:59], a[200:203], v[186:189], v[56:59]
ds_read_b128 v[170:173], v210 offset:48128
s_waitcnt lgkmcnt(0)
v_mfma_f32_16x16x32_bf16 v[48:51], a[156:159], v[170:173], v[48:51]
v_mfma_f32_16x16x32_bf16 v[52:55], a[180:183], v[170:173], v[52:55]
v_mfma_f32_16x16x32_bf16 v[56:59], a[204:207], v[170:173], v[56:59]
ds_read_b128 v[182:185], v210 offset:49152
s_waitcnt lgkmcnt(0)
v_mfma_f32_16x16x32_bf16 v[48:51], a[160:163], v[182:185], v[48:51]
v_mfma_f32_16x16x32_bf16 v[52:55], a[184:187], v[182:185], v[52:55]
v_mfma_f32_16x16x32_bf16 v[56:59], a[208:211], v[182:185], v[56:59]
ds_read_b128 v[186:189], v210 offset:50176
s_waitcnt lgkmcnt(0)
v_mfma_f32_16x16x32_bf16 v[48:51], a[164:167], v[186:189], v[48:51]
v_mfma_f32_16x16x32_bf16 v[52:55], a[188:191], v[186:189], v[52:55]
v_mfma_f32_16x16x32_bf16 v[56:59], a[212:215], v[186:189], v[56:59]
v_cvt_pk_bf16_f32 v78, v48, v49
v_cvt_pk_bf16_f32 v79, v50, v51
buffer_store_dwordx2 v[78:79], v204, s[8:11], s39 offen
v_cvt_pk_bf16_f32 v80, v52, v53
v_cvt_pk_bf16_f32 v81, v54, v55
buffer_store_dwordx2 v[80:81], v204, s[8:11], s39 offen offset:32
s_nop 0
v_cvt_pk_bf16_f32 v82, v56, v57
v_cvt_pk_bf16_f32 v83, v58, v59
buffer_store_dwordx2 v[82:83], v204, s[8:11], s39 offen offset:64
v_rcp_f32 v151, v150
s_nop 0
v_mul_f32 v151, s3, v151
v_mul_f32 v138, v138, v151
v_mul_f32 v139, v139, v151
v_cvt_pk_bf16_f32 v138, v138, v139
v_mul_f32 v140, v140, v151
v_mul_f32 v141, v141, v151
v_cvt_pk_bf16_f32 v139, v140, v141
v_mul_f32 v142, v142, v151
v_mul_f32 v143, v143, v151
v_cvt_pk_bf16_f32 v140, v142, v143
v_mul_f32 v144, v144, v151
v_mul_f32 v145, v145, v151
v_cvt_pk_bf16_f32 v141, v144, v145
ds_write_b128 v211, v[138:141] offset:51200
v_mul_f32 v146, v146, v151
v_mul_f32 v147, v147, v151
v_cvt_pk_bf16_f32 v142, v146, v147
v_mul_f32 v148, v148, v151
v_mul_f32 v149, v149, v151
v_cvt_pk_bf16_f32 v143, v148, v149
ds_write_b64 v212, v[142:143] offset:51200
s_waitcnt vmcnt(6) lgkmcnt(0)
s_barrier
ds_read_b128 v[170:173], v210 offset:51200
s_waitcnt lgkmcnt(0)
v_mfma_f32_16x16x32_bf16 v[60:63], a[144:147], v[170:173], v[60:63]
v_mfma_f32_16x16x32_bf16 v[64:67], a[168:171], v[170:173], v[64:67]
v_mfma_f32_16x16x32_bf16 v[68:71], a[192:195], v[170:173], v[68:71]
ds_read_b128 v[182:185], v210 offset:52224
s_waitcnt lgkmcnt(0)
v_mfma_f32_16x16x32_bf16 v[60:63], a[148:151], v[182:185], v[60:63]
v_mfma_f32_16x16x32_bf16 v[64:67], a[172:175], v[182:185], v[64:67]
v_mfma_f32_16x16x32_bf16 v[68:71], a[196:199], v[182:185], v[68:71]
ds_read_b128 v[186:189], v210 offset:53248
s_waitcnt lgkmcnt(0)
v_mfma_f32_16x16x32_bf16 v[60:63], a[152:155], v[186:189], v[60:63]
v_mfma_f32_16x16x32_bf16 v[64:67], a[176:179], v[186:189], v[64:67]
v_mfma_f32_16x16x32_bf16 v[68:71], a[200:203], v[186:189], v[68:71]
ds_read_b128 v[170:173], v210 offset:54272
s_waitcnt lgkmcnt(0)
v_mfma_f32_16x16x32_bf16 v[60:63], a[156:159], v[170:173], v[60:63]
v_mfma_f32_16x16x32_bf16 v[64:67], a[180:183], v[170:173], v[64:67]
v_mfma_f32_16x16x32_bf16 v[68:71], a[204:207], v[170:173], v[68:71]
ds_read_b128 v[182:185], v210 offset:55296
s_waitcnt lgkmcnt(0)
v_mfma_f32_16x16x32_bf16 v[60:63], a[160:163], v[182:185], v[60:63]
v_mfma_f32_16x16x32_bf16 v[64:67], a[184:187], v[182:185], v[64:67]
v_mfma_f32_16x16x32_bf16 v[68:71], a[208:211], v[182:185], v[68:71]
ds_read_b128 v[186:189], v210 offset:56320
s_waitcnt lgkmcnt(0)
v_mfma_f32_16x16x32_bf16 v[60:63], a[164:167], v[186:189], v[60:63]
v_mfma_f32_16x16x32_bf16 v[64:67], a[188:191], v[186:189], v[64:67]
v_mfma_f32_16x16x32_bf16 v[68:71], a[212:215], v[186:189], v[68:71]
v_cvt_pk_bf16_f32 v116, v60, v61
v_cvt_pk_bf16_f32 v117, v62, v63
buffer_store_dwordx2 v[116:117], v205, s[8:11], s39 offen
v_cvt_pk_bf16_f32 v124, v64, v65
v_cvt_pk_bf16_f32 v125, v66, v67
buffer_store_dwordx2 v[124:125], v205, s[8:11], s39 offen offset:32
s_nop 0
v_cvt_pk_bf16_f32 v132, v68, v69
v_cvt_pk_bf16_f32 v133, v70, v71
buffer_store_dwordx2 v[132:133], v205, s[8:11], s39 offen offset:64
s_mov_b32 s38, s36
ds_read_b128 v[174:177], v217
ds_read_b128 v[84:87], v200
s_waitcnt lgkmcnt(0)
v_mfma_f32_16x16x32_bf16 v[36:39], v[174:177], v[84:87], 0
ds_read_b128 v[92:95], v201
s_waitcnt lgkmcnt(0)
v_mfma_f32_16x16x32_bf16 v[48:51], v[174:177], v[92:95], 0
ds_read_b128 v[100:103], v202
s_waitcnt lgkmcnt(0)
v_mfma_f32_16x16x32_bf16 v[60:63], v[174:177], v[100:103], 0
ds_read_b128 v[178:181], v217 offset:528
ds_read_b128 v[84:87], v194
ds_read_b128 v[88:91], v194 offset:16
s_waitcnt lgkmcnt(0)
v_smfmac_f32_16x16x64_bf16 v[36:39], v[178:181], v[84:91], v213
ds_read_b128 v[92:95], v195
ds_read_b128 v[96:99], v195 offset:16
s_waitcnt lgkmcnt(0)
v_smfmac_f32_16x16x64_bf16 v[48:51], v[178:181], v[92:99], v213
ds_read_b128 v[100:103], v196
ds_read_b128 v[104:107], v196 offset:16
s_waitcnt lgkmcnt(0)
v_smfmac_f32_16x16x64_bf16 v[60:63], v[178:181], v[100:107], v213
ds_read_b128 v[174:177], v217 offset:1056
ds_read_b128 v[84:87], v197
ds_read_b128 v[88:91], v197 offset:16
s_waitcnt lgkmcnt(0)
v_smfmac_f32_16x16x64_bf16 v[36:39], v[174:177], v[84:91], v213
ds_read_b128 v[92:95], v198
ds_read_b128 v[96:99], v198 offset:16
s_waitcnt lgkmcnt(0)
v_smfmac_f32_16x16x64_bf16 v[48:51], v[174:177], v[92:99], v213
ds_read_b128 v[100:103], v199
ds_read_b128 v[104:107], v199 offset:16
s_waitcnt lgkmcnt(0)
v_smfmac_f32_16x16x64_bf16 v[60:63], v[174:177], v[100:107], v213
ds_read_b128 v[178:181], v217 offset:1584
ds_read_b128 v[84:87], v200 offset:32
s_waitcnt lgkmcnt(0)
v_mfma_f32_16x16x32_bf16 v[40:43], v[178:181], v[84:87], 0
ds_read_b128 v[92:95], v201 offset:32
s_waitcnt lgkmcnt(0)
v_mfma_f32_16x16x32_bf16 v[52:55], v[178:181], v[92:95], 0
ds_read_b128 v[100:103], v202 offset:32
s_waitcnt lgkmcnt(0)
v_mfma_f32_16x16x32_bf16 v[64:67], v[178:181], v[100:103], 0
ds_read_b128 v[174:177], v217 offset:2112
ds_read_b128 v[84:87], v194 offset:32
ds_read_b128 v[88:91], v194 offset:48
s_waitcnt lgkmcnt(0)
v_smfmac_f32_16x16x64_bf16 v[40:43], v[174:177], v[84:91], v213
ds_read_b128 v[92:95], v195 offset:32
ds_read_b128 v[96:99], v195 offset:48
s_waitcnt lgkmcnt(0)
v_smfmac_f32_16x16x64_bf16 v[52:55], v[174:177], v[92:99], v213
ds_read_b128 v[100:103], v196 offset:32
ds_read_b128 v[104:107], v196 offset:48
s_waitcnt lgkmcnt(0)
v_smfmac_f32_16x16x64_bf16 v[64:67], v[174:177], v[100:107], v213
ds_read_b128 v[178:181], v217 offset:2640
ds_read_b128 v[84:87], v197 offset:32
ds_read_b128 v[88:91], v197 offset:48
s_waitcnt lgkmcnt(0)
v_smfmac_f32_16x16x64_bf16 v[40:43], v[178:181], v[84:91], v213
ds_read_b128 v[92:95], v198 offset:32
ds_read_b128 v[96:99], v198 offset:48
s_waitcnt lgkmcnt(0)
v_smfmac_f32_16x16x64_bf16 v[52:55], v[178:181], v[92:99], v213
ds_read_b128 v[100:103], v199 offset:32
ds_read_b128 v[104:107], v199 offset:48
s_waitcnt lgkmcnt(0)
v_smfmac_f32_16x16x64_bf16 v[64:67], v[178:181], v[100:107], v213
ds_read_b128 v[174:177], v217 offset:3168
ds_read_b128 v[84:87], v200 offset:64
s_waitcnt lgkmcnt(0)
v_mfma_f32_16x16x32_bf16 v[44:47], v[174:177], v[84:87], 0
ds_read_b128 v[92:95], v201 offset:64
s_waitcnt lgkmcnt(0)
v_mfma_f32_16x16x32_bf16 v[56:59], v[174:177], v[92:95], 0
ds_read_b128 v[100:103], v202 offset:64
s_waitcnt lgkmcnt(0)
v_mfma_f32_16x16x32_bf16 v[68:71], v[174:177], v[100:103], 0
ds_read_b128 v[178:181], v217 offset:3696
ds_read_b128 v[84:87], v194 offset:64
ds_read_b128 v[88:91], v194 offset:80
s_waitcnt lgkmcnt(0)
v_smfmac_f32_16x16x64_bf16 v[44:47], v[178:181], v[84:91], v213
ds_read_b128 v[92:95], v195 offset:64
ds_read_b128 v[96:99], v195 offset:80
s_waitcnt lgkmcnt(0)
v_smfmac_f32_16x16x64_bf16 v[56:59], v[178:181], v[92:99], v213
ds_read_b128 v[100:103], v196 offset:64
ds_read_b128 v[104:107], v196 offset:80
s_waitcnt lgkmcnt(0)
v_smfmac_f32_16x16x64_bf16 v[68:71], v[178:181], v[100:107], v213
ds_read_b128 v[174:177], v217 offset:4224
ds_read_b128 v[84:87], v197 offset:64
ds_read_b128 v[88:91], v197 offset:80
s_waitcnt lgkmcnt(0)
v_smfmac_f32_16x16x64_bf16 v[44:47], v[174:177], v[84:91], v213
ds_read_b128 v[92:95], v198 offset:64
ds_read_b128 v[96:99], v198 offset:80
s_waitcnt lgkmcnt(0)
v_smfmac_f32_16x16x64_bf16 v[56:59], v[174:177], v[92:99], v213
ds_read_b128 v[100:103], v199 offset:64
ds_read_b128 v[104:107], v199 offset:80
s_waitcnt lgkmcnt(0)
v_smfmac_f32_16x16x64_bf16 v[68:71], v[174:177], v[100:107], v213
v_add_f32 v118, v36, v37
v_mul_f32 v119, v36, v36
v_add_f32 v118, v118, v38
v_fmac_f32 v119, v37, v37
v_add_f32 v118, v118, v39
v_fmac_f32 v119, v38, v38
v_fmac_f32 v119, v39, v39
v_add_f32 v126, v48, v49
v_mul_f32 v127, v48, v48
v_add_f32 v126, v126, v50
v_fmac_f32 v127, v49, v49
v_add_f32 v126, v126, v51
v_fmac_f32 v127, v50, v50
v_fmac_f32 v127, v51, v51
v_add_f32 v134, v60, v61
v_mul_f32 v135, v60, v60
v_add_f32 v134, v134, v62
v_fmac_f32 v135, v61, v61
v_add_f32 v134, v134, v63
v_fmac_f32 v135, v62, v62
v_fmac_f32 v135, v63, v63
v_add_f32 v118, v118, v40
v_fmac_f32 v119, v40, v40
v_add_f32 v118, v118, v41
v_fmac_f32 v119, v41, v41
v_add_f32 v118, v118, v42
v_fmac_f32 v119, v42, v42
v_add_f32 v118, v118, v43
v_fmac_f32 v119, v43, v43
v_add_f32 v126, v126, v52
v_fmac_f32 v127, v52, v52
v_add_f32 v126, v126, v53
v_fmac_f32 v127, v53, v53
v_add_f32 v126, v126, v54
v_fmac_f32 v127, v54, v54
v_add_f32 v126, v126, v55
v_fmac_f32 v127, v55, v55
v_add_f32 v134, v134, v64
v_fmac_f32 v135, v64, v64
v_add_f32 v134, v134, v65
v_fmac_f32 v135, v65, v65
v_add_f32 v134, v134, v66
v_fmac_f32 v135, v66, v66
v_add_f32 v134, v134, v67
v_fmac_f32 v135, v67, v67
v_add_f32 v118, v118, v44
v_fmac_f32 v119, v44, v44
v_add_f32 v118, v118, v45
v_fmac_f32 v119, v45, v45
v_add_f32 v118, v118, v46
v_fmac_f32 v119, v46, v46
v_add_f32 v118, v118, v47
v_fmac_f32 v119, v47, v47
v_add_f32 v126, v126, v56
v_fmac_f32 v127, v56, v56
v_add_f32 v126, v126, v57
v_fmac_f32 v127, v57, v57
v_add_f32 v126, v126, v58
v_fmac_f32 v127, v58, v58
v_add_f32 v126, v126, v59
v_fmac_f32 v127, v59, v59
v_add_f32 v134, v134, v68
v_fmac_f32 v135, v68, v68
v_add_f32 v134, v134, v69
v_fmac_f32 v135, v69, v69
v_add_f32 v134, v134, v70
v_fmac_f32 v135, v70, v70
v_add_f32 v134, v134, v71
v_fmac_f32 v135, v71, v71
v_permlane16_swap_b32 v118, v119
v_add_f32 v118, v118, v119
v_permlane16_swap_b32 v126, v127
v_add_f32 v126, v126, v127
v_permlane16_swap_b32 v134, v135
v_add_f32 v134, v134, v135
v_permlane32_swap_b32 v118, v126
v_add_f32 v118, v118, v126
ds_write_b32 v209, v118
v_mov_b32 v135, v134
s_nop 1
v_permlane32_swap_b32 v134, v135
v_add_f32 v134, v134, v135
ds_write_b32 v209, v134 offset:512
s_waitcnt lgkmcnt(0)
s_barrier
s_mul_hi_u32 s41, s35, 58835169
s_mul_i32 s42, s41, 73
s_sub_u32 s42, s35, s42
s_mul_i32 s43, s41, 1373568
s_mul_i32 s51, s42, 2688
s_add_u32 s43, s43, s51
s_cmp_lt_u32 s35, s34
s_cselect_b32 s50, s43, 1879048192
s_add_u32 s35, s35, 32
s_cmp_eq_u32 s42, 0
s_cselect_b32 s44, 536870911, s72
s_cmp_eq_u32 s42, 72
s_cselect_b32 s44, 939524095, s44
s_cmp_eq_u32 s41, 0
s_cselect_b32 s52, 1879048192, s50
s_mov_b32 s36, s50
v_and_b32 v180, s44, v208
s_add_u32 m0, s45, 0
s_nop 0
buffer_load_dwordx4 v180, s[4:7], s52 offen nt lds
s_add_u32 m0, s45, 4112
s_add_u32 s40, s36, 196224
buffer_load_dwordx4 v180, s[4:7], s40 offen nt lds
s_add_u32 m0, s45, 8224
s_add_u32 s40, s36, 392448
buffer_load_dwordx4 v180, s[4:7], s40 offen nt lds
s_add_u32 m0, s45, 12336
s_add_u32 s40, s36, 588672
buffer_load_dwordx4 v180, s[4:7], s40 offen nt lds
s_add_u32 m0, s45, 16448
s_add_u32 s40, s36, 784896
buffer_load_dwordx4 v180, s[4:7], s40 offen nt lds
s_add_u32 m0, s45, 20560
s_add_u32 s40, s36, 981120
buffer_load_dwordx4 v180, s[4:7], s40 offen nt lds
s_add_u32 m0, s45, 24672
s_add_u32 s40, s36, 1177344
buffer_load_dwordx4 v180, s[4:7], s40 offen nt lds
s_add_u32 m0, s45, 28784
s_add_u32 s40, s36, 1373568
buffer_load_dwordx4 v180, s[4:7], s40 offen nt lds
s_add_u32 m0, s45, 32896
s_add_u32 s40, s36, 1569792
buffer_load_dwordx4 v180, s[4:7], s40 offen nt lds
ds_read_b128 v[102:105], v210 offset:18432
ds_read_b128 v[106:109], v210 offset:19456
s_waitcnt lgkmcnt(1)
v_add_f32 v102, v102, v103
s_waitcnt lgkmcnt(0)
v_add_f32 v106, v106, v107
v_add_f32 v104, v104, v105
v_add_f32 v108, v108, v109
v_add_f32 v102, v102, v104
v_add_f32 v106, v106, v108
v_mul_f32 v103, s48, v102
v_mul_f32 v104, s73, v102
v_mul_f32 v106, s73, v106
v_fma_f32 v106, -v103, v104, v106
v_max_f32 v106, 0, v106
v_add_f32 v106, s49, v106
v_rsq_f32 v102, v106
s_nop 0
v_mul_f32_e64 v103, -v103, v102
ds_write_b64 v211, v[102:103] offset:20480
ds_read_b64 v[118:119], v219 offset:20480
ds_read_b64 v[126:127], v219 offset:20736
ds_read_b64 v[134:135], v219 offset:20992
s_waitcnt lgkmcnt(2)
v_fma_f32 v220, v36, v118, v119
v_fma_f32 v221, v37, v118, v119
v_cvt_pk_bf16_f32 v90, v220, v221
v_fma_f32 v222, v38, v118, v119
v_fma_f32 v223, v39, v118, v119
v_cvt_pk_bf16_f32 v91, v222, v223
v_fma_f32 v220, v40, v118, v119
v_fma_f32 v221, v41, v118, v119
v_cvt_pk_bf16_f32 v92, v220, v221
v_fma_f32 v222, v42, v118, v119
v_fma_f32 v223, v43, v118, v119
v_cvt_pk_bf16_f32 v93, v222, v223
ds_write_b128 v211, v[90:93] offset:20480
v_fma_f32 v220, v44, v118, v119
v_fma_f32 v221, v45, v118, v119
v_cvt_pk_bf16_f32 v94, v220, v221
v_fma_f32 v222, v46, v118, v119
v_fma_f32 v223, v47, v118, v119
v_cvt_pk_bf16_f32 v95, v222, v223
s_waitcnt lgkmcnt(2)
ds_write_b64 v212, v[94:95] offset:20480
v_fma_f32 v220, v48, v126, v127
v_fma_f32 v221, v49, v126, v127
v_cvt_pk_bf16_f32 v174, v220, v221
v_fma_f32 v222, v50, v126, v127
v_fma_f32 v223, v51, v126, v127
v_cvt_pk_bf16_f32 v175, v222, v223
v_fma_f32 v220, v52, v126, v127
v_fma_f32 v221, v53, v126, v127
v_cvt_pk_bf16_f32 v176, v220, v221
v_fma_f32 v222, v54, v126, v127
v_fma_f32 v223, v55, v126, v127
v_cvt_pk_bf16_f32 v177, v222, v223
ds_write_b128 v211, v[174:177] offset:26624
v_fma_f32 v220, v56, v126, v127
v_fma_f32 v221, v57, v126, v127
v_cvt_pk_bf16_f32 v178, v220, v221
v_fma_f32 v222, v58, v126, v127
v_fma_f32 v223, v59, v126, v127
v_cvt_pk_bf16_f32 v179, v222, v223
s_waitcnt lgkmcnt(3)
ds_write_b64 v212, v[178:179] offset:26624
v_fma_f32 v220, v60, v134, v135
v_fma_f32 v221, v61, v134, v135
v_cvt_pk_bf16_f32 v90, v220, v221
v_fma_f32 v222, v62, v134, v135
v_fma_f32 v223, v63, v134, v135
v_cvt_pk_bf16_f32 v91, v222, v223
v_fma_f32 v220, v64, v134, v135
v_fma_f32 v221, v65, v134, v135
v_cvt_pk_bf16_f32 v92, v220, v221
v_fma_f32 v222, v66, v134, v135
v_fma_f32 v223, v67, v134, v135
v_cvt_pk_bf16_f32 v93, v222, v223
ds_write_b128 v211, v[90:93] offset:32768
v_fma_f32 v220, v68, v134, v135
v_fma_f32 v221, v69, v134, v135
v_cvt_pk_bf16_f32 v94, v220, v221
v_fma_f32 v222, v70, v134, v135
v_fma_f32 v223, v71, v134, v135
v_cvt_pk_bf16_f32 v95, v222, v223
ds_write_b64 v212, v[94:95] offset:32768
ds_read_b128 v[182:185], v210
s_waitcnt lgkmcnt(0)
v_mfma_f32_16x16x32_bf16 v[138:141], a[0:3], v[182:185], 0
v_mfma_f32_16x16x32_bf16 v[142:145], a[24:27], v[182:185], 0
v_mfma_f32_16x16x32_bf16 v[146:149], a[48:51], v[182:185], 0
v_mfma_f32_16x16x32_bf16 v[150:153], a[216:219], v[182:185], 0
v_mfma_f32_16x16x32_bf16 v[154:157], a[240:243], v[182:185], 0
v_mfma_f32_16x16x32_bf16 v[158:161], v[232:235], v[182:185], 0
v_mfma_f32_16x16x32_bf16 v[162:165], v[182:185], a[72:75], 0
v_mfma_f32_16x16x32_bf16 v[166:169], v[182:185], a[96:99], 0
v_mfma_f32_16x16x32_bf16 v[170:173], v[182:185], a[120:123], 0
ds_read_b128 v[186:189], v210 offset:1024
s_waitcnt lgkmcnt(0)
v_mfma_f32_16x16x32_bf16 v[138:141], a[4:7], v[186:189], v[138:141]
v_mfma_f32_16x16x32_bf16 v[142:145], a[28:31], v[186:189], v[142:145]
v_mfma_f32_16x16x32_bf16 v[146:149], a[52:55], v[186:189], v[146:149]
v_mfma_f32_16x16x32_bf16 v[150:153], a[220:223], v[186:189], v[150:153]
v_mfma_f32_16x16x32_bf16 v[154:157], a[244:247], v[186:189], v[154:157]
v_mfma_f32_16x16x32_bf16 v[158:161], v[236:239], v[186:189], v[158:161]
v_mfma_f32_16x16x32_bf16 v[162:165], v[186:189], a[76:79], v[162:165]
v_mfma_f32_16x16x32_bf16 v[166:169], v[186:189], a[100:103], v[166:169]
v_mfma_f32_16x16x32_bf16 v[170:173], v[186:189], a[124:127], v[170:173]
ds_read_b128 v[182:185], v210 offset:2048
s_waitcnt lgkmcnt(0)
v_mfma_f32_16x16x32_bf16 v[138:141], a[8:11], v[182:185], v[138:141]
v_mfma_f32_16x16x32_bf16 v[142:145], a[32:35], v[182:185], v[142:145]
v_mfma_f32_16x16x32_bf16 v[146:149], a[56:59], v[182:185], v[146:149]
v_mfma_f32_16x16x32_bf16 v[150:153], a[224:227], v[182:185], v[150:153]
v_mfma_f32_16x16x32_bf16 v[154:157], a[248:251], v[182:185], v[154:157]
v_mfma_f32_16x16x32_bf16 v[158:161], v[240:243], v[182:185], v[158:161]
v_mfma_f32_16x16x32_bf16 v[162:165], v[182:185], a[80:83], v[162:165]
v_mfma_f32_16x16x32_bf16 v[166:169], v[182:185], a[104:107], v[166:169]
v_mfma_f32_16x16x32_bf16 v[170:173], v[182:185], a[128:131], v[170:173]
ds_read_b128 v[186:189], v210 offset:3072
s_waitcnt lgkmcnt(0)
v_mfma_f32_16x16x32_bf16 v[138:141], a[12:15], v[186:189], v[138:141]
v_mfma_f32_16x16x32_bf16 v[142:145], a[36:39], v[186:189], v[142:145]
v_mfma_f32_16x16x32_bf16 v[146:149], a[60:63], v[186:189], v[146:149]
v_mfma_f32_16x16x32_bf16 v[150:153], a[228:231], v[186:189], v[150:153]
v_mfma_f32_16x16x32_bf16 v[154:157], a[252:255], v[186:189], v[154:157]
v_mfma_f32_16x16x32_bf16 v[158:161], v[244:247], v[186:189], v[158:161]
v_mfma_f32_16x16x32_bf16 v[162:165], v[186:189], a[84:87], v[162:165]
v_mfma_f32_16x16x32_bf16 v[166:169], v[186:189], a[108:111], v[166:169]
v_mfma_f32_16x16x32_bf16 v[170:173], v[186:189], a[132:135], v[170:173]
ds_read_b128 v[182:185], v210 offset:4096
s_waitcnt lgkmcnt(0)
v_mfma_f32_16x16x32_bf16 v[138:141], a[16:19], v[182:185], v[138:141]
v_mfma_f32_16x16x32_bf16 v[142:145], a[40:43], v[182:185], v[142:145]
v_mfma_f32_16x16x32_bf16 v[146:149], a[64:67], v[182:185], v[146:149]
v_mfma_f32_16x16x32_bf16 v[150:153], a[232:235], v[182:185], v[150:153]
v_mfma_f32_16x16x32_bf16 v[154:157], v[224:227], v[182:185], v[154:157]
v_mfma_f32_16x16x32_bf16 v[158:161], v[248:251], v[182:185], v[158:161]
v_mfma_f32_16x16x32_bf16 v[162:165], v[182:185], a[88:91], v[162:165]
v_mfma_f32_16x16x32_bf16 v[166:169], v[182:185], a[112:115], v[166:169]
v_mfma_f32_16x16x32_bf16 v[170:173], v[182:185], a[136:139], v[170:173]
ds_read_b128 v[186:189], v210 offset:5120
s_waitcnt lgkmcnt(0)
v_mfma_f32_16x16x32_bf16 v[138:141], a[20:23], v[186:189], v[138:141]
v_mfma_f32_16x16x32_bf16 v[142:145], a[44:47], v[186:189], v[142:145]
v_mfma_f32_16x16x32_bf16 v[146:149], a[68:71], v[186:189], v[146:149]
v_mfma_f32_16x16x32_bf16 v[150:153], a[236:239], v[186:189], v[150:153]
v_mfma_f32_16x16x32_bf16 v[154:157], v[228:231], v[186:189], v[154:157]
v_mfma_f32_16x16x32_bf16 v[158:161], v[252:255], v[186:189], v[158:161]
v_mfma_f32_16x16x32_bf16 v[162:165], v[186:189], a[92:95], v[162:165]
v_mfma_f32_16x16x32_bf16 v[166:169], v[186:189], a[116:119], v[166:169]
v_mfma_f32_16x16x32_bf16 v[170:173], v[186:189], a[140:143], v[170:173]
v_cvt_pk_bf16_f32 v78, v138, v139
v_cvt_pk_bf16_f32 v79, v140, v141
v_cvt_pk_bf16_f32 v80, v142, v143
v_cvt_pk_bf16_f32 v81, v144, v145
v_cvt_pk_bf16_f32 v82, v146, v147
v_cvt_pk_bf16_f32 v83, v148, v149
v_cvt_pk_bf16_f32 v72, v150, v151
v_cvt_pk_bf16_f32 v73, v152, v153
v_cvt_pk_bf16_f32 v74, v154, v155
v_cvt_pk_bf16_f32 v75, v156, v157
v_cvt_pk_bf16_f32 v76, v158, v159
v_cvt_pk_bf16_f32 v77, v160, v161
v_cvt_pk_bf16_f32 v114, v162, v163
v_cvt_pk_bf16_f32 v115, v164, v165
v_cvt_pk_bf16_f32 v122, v166, v167
v_cvt_pk_bf16_f32 v123, v168, v169
v_cvt_pk_bf16_f32 v130, v170, v171
v_cvt_pk_bf16_f32 v131, v172, v173
ds_read_b128 v[182:185], v210 offset:6144
s_waitcnt lgkmcnt(0)
v_mfma_f32_16x16x32_bf16 v[138:141], a[0:3], v[182:185], 0
v_mfma_f32_16x16x32_bf16 v[142:145], a[24:27], v[182:185], 0
v_mfma_f32_16x16x32_bf16 v[146:149], a[48:51], v[182:185], 0
v_mfma_f32_16x16x32_bf16 v[150:153], a[216:219], v[182:185], 0
v_mfma_f32_16x16x32_bf16 v[154:157], a[240:243], v[182:185], 0
v_mfma_f32_16x16x32_bf16 v[158:161], v[232:235], v[182:185], 0
v_mfma_f32_16x16x32_bf16 v[162:165], v[182:185], a[72:75], 0
v_mfma_f32_16x16x32_bf16 v[166:169], v[182:185], a[96:99], 0
v_mfma_f32_16x16x32_bf16 v[170:173], v[182:185], a[120:123], 0
ds_read_b128 v[186:189], v210 offset:7168
s_waitcnt lgkmcnt(0)
v_mfma_f32_16x16x32_bf16 v[138:141], a[4:7], v[186:189], v[138:141]
v_mfma_f32_16x16x32_bf16 v[142:145], a[28:31], v[186:189], v[142:145]
v_mfma_f32_16x16x32_bf16 v[146:149], a[52:55], v[186:189], v[146:149]
v_mfma_f32_16x16x32_bf16 v[150:153], a[220:223], v[186:189], v[150:153]
v_mfma_f32_16x16x32_bf16 v[154:157], a[244:247], v[186:189], v[154:157]
v_mfma_f32_16x16x32_bf16 v[158:161], v[236:239], v[186:189], v[158:161]
v_mfma_f32_16x16x32_bf16 v[162:165], v[186:189], a[76:79], v[162:165]
v_mfma_f32_16x16x32_bf16 v[166:169], v[186:189], a[100:103], v[166:169]
v_mfma_f32_16x16x32_bf16 v[170:173], v[186:189], a[124:127], v[170:173]
ds_read_b128 v[182:185], v210 offset:8192
s_waitcnt lgkmcnt(0)
v_mfma_f32_16x16x32_bf16 v[138:141], a[8:11], v[182:185], v[138:141]
v_mfma_f32_16x16x32_bf16 v[142:145], a[32:35], v[182:185], v[142:145]
v_mfma_f32_16x16x32_bf16 v[146:149], a[56:59], v[182:185], v[146:149]
v_mfma_f32_16x16x32_bf16 v[150:153], a[224:227], v[182:185], v[150:153]
v_mfma_f32_16x16x32_bf16 v[154:157], a[248:251], v[182:185], v[154:157]
v_mfma_f32_16x16x32_bf16 v[158:161], v[240:243], v[182:185], v[158:161]
v_mfma_f32_16x16x32_bf16 v[162:165], v[182:185], a[80:83], v[162:165]
v_mfma_f32_16x16x32_bf16 v[166:169], v[182:185], a[104:107], v[166:169]
v_mfma_f32_16x16x32_bf16 v[170:173], v[182:185], a[128:131], v[170:173]
ds_read_b128 v[186:189], v210 offset:9216
s_waitcnt lgkmcnt(0)
v_mfma_f32_16x16x32_bf16 v[138:141], a[12:15], v[186:189], v[138:141]
v_mfma_f32_16x16x32_bf16 v[142:145], a[36:39], v[186:189], v[142:145]
v_mfma_f32_16x16x32_bf16 v[146:149], a[60:63], v[186:189], v[146:149]
v_mfma_f32_16x16x32_bf16 v[150:153], a[228:231], v[186:189], v[150:153]
v_mfma_f32_16x16x32_bf16 v[154:157], a[252:255], v[186:189], v[154:157]
v_mfma_f32_16x16x32_bf16 v[158:161], v[244:247], v[186:189], v[158:161]
v_mfma_f32_16x16x32_bf16 v[162:165], v[186:189], a[84:87], v[162:165]
v_mfma_f32_16x16x32_bf16 v[166:169], v[186:189], a[108:111], v[166:169]
v_mfma_f32_16x16x32_bf16 v[170:173], v[186:189], a[132:135], v[170:173]
ds_read_b128 v[182:185], v210 offset:10240
s_waitcnt lgkmcnt(0)
v_mfma_f32_16x16x32_bf16 v[138:141], a[16:19], v[182:185], v[138:141]
v_mfma_f32_16x16x32_bf16 v[142:145], a[40:43], v[182:185], v[142:145]
v_mfma_f32_16x16x32_bf16 v[146:149], a[64:67], v[182:185], v[146:149]
v_mfma_f32_16x16x32_bf16 v[150:153], a[232:235], v[182:185], v[150:153]
v_mfma_f32_16x16x32_bf16 v[154:157], v[224:227], v[182:185], v[154:157]
v_mfma_f32_16x16x32_bf16 v[158:161], v[248:251], v[182:185], v[158:161]
v_mfma_f32_16x16x32_bf16 v[162:165], v[182:185], a[88:91], v[162:165]
v_mfma_f32_16x16x32_bf16 v[166:169], v[182:185], a[112:115], v[166:169]
v_mfma_f32_16x16x32_bf16 v[170:173], v[182:185], a[136:139], v[170:173]
ds_read_b128 v[186:189], v210 offset:11264
s_waitcnt lgkmcnt(0)
v_mfma_f32_16x16x32_bf16 v[138:141], a[20:23], v[186:189], v[138:141]
v_mfma_f32_16x16x32_bf16 v[142:145], a[44:47], v[186:189], v[142:145]
v_mfma_f32_16x16x32_bf16 v[146:149], a[68:71], v[186:189], v[146:149]
v_mfma_f32_16x16x32_bf16 v[150:153], a[236:239], v[186:189], v[150:153]
v_mfma_f32_16x16x32_bf16 v[154:157], v[228:231], v[186:189], v[154:157]
v_mfma_f32_16x16x32_bf16 v[158:161], v[252:255], v[186:189], v[158:161]
v_mfma_f32_16x16x32_bf16 v[162:165], v[186:189], a[92:95], v[162:165]
v_mfma_f32_16x16x32_bf16 v[166:169], v[186:189], a[116:119], v[166:169]
v_mfma_f32_16x16x32_bf16 v[170:173], v[186:189], a[140:143], v[170:173]
v_cvt_pk_bf16_f32 v96, v138, v139
v_cvt_pk_bf16_f32 v97, v140, v141
v_cvt_pk_bf16_f32 v98, v142, v143
v_cvt_pk_bf16_f32 v99, v144, v145
v_cvt_pk_bf16_f32 v100, v146, v147
v_cvt_pk_bf16_f32 v101, v148, v149
v_cvt_pk_bf16_f32 v84, v150, v151
v_cvt_pk_bf16_f32 v85, v152, v153
v_cvt_pk_bf16_f32 v86, v154, v155
v_cvt_pk_bf16_f32 v87, v156, v157
v_cvt_pk_bf16_f32 v88, v158, v159
v_cvt_pk_bf16_f32 v89, v160, v161
v_cvt_pk_bf16_f32 v116, v162, v163
v_cvt_pk_bf16_f32 v117, v164, v165
v_cvt_pk_bf16_f32 v124, v166, v167
v_cvt_pk_bf16_f32 v125, v168, v169
v_cvt_pk_bf16_f32 v132, v170, v171
v_cvt_pk_bf16_f32 v133, v172, v173
ds_read_b128 v[182:185], v210 offset:12288
s_waitcnt lgkmcnt(0)
v_mfma_f32_16x16x32_bf16 v[138:141], a[0:3], v[182:185], 0
v_mfma_f32_16x16x32_bf16 v[142:145], a[24:27], v[182:185], 0
v_mfma_f32_16x16x32_bf16 v[146:149], a[48:51], v[182:185], 0
ds_read_b128 v[186:189], v210 offset:13312
s_waitcnt lgkmcnt(0)
v_mfma_f32_16x16x32_bf16 v[138:141], a[4:7], v[186:189], v[138:141]
v_mfma_f32_16x16x32_bf16 v[142:145], a[28:31], v[186:189], v[142:145]
v_mfma_f32_16x16x32_bf16 v[146:149], a[52:55], v[186:189], v[146:149]
ds_read_b128 v[182:185], v210 offset:14336
s_waitcnt lgkmcnt(0)
v_mfma_f32_16x16x32_bf16 v[138:141], a[8:11], v[182:185], v[138:141]
v_mfma_f32_16x16x32_bf16 v[142:145], a[32:35], v[182:185], v[142:145]
v_mfma_f32_16x16x32_bf16 v[146:149], a[56:59], v[182:185], v[146:149]
ds_read_b128 v[186:189], v210 offset:15360
s_waitcnt lgkmcnt(0)
v_mfma_f32_16x16x32_bf16 v[138:141], a[12:15], v[186:189], v[138:141]
v_mfma_f32_16x16x32_bf16 v[142:145], a[36:39], v[186:189], v[142:145]
v_mfma_f32_16x16x32_bf16 v[146:149], a[60:63], v[186:189], v[146:149]
ds_read_b128 v[182:185], v210 offset:16384
s_waitcnt lgkmcnt(0)
v_mfma_f32_16x16x32_bf16 v[138:141], a[16:19], v[182:185], v[138:141]
v_mfma_f32_16x16x32_bf16 v[142:145], a[40:43], v[182:185], v[142:145]
v_mfma_f32_16x16x32_bf16 v[146:149], a[64:67], v[182:185], v[146:149]
ds_read_b128 v[186:189], v210 offset:17408
s_waitcnt lgkmcnt(0)
v_mfma_f32_16x16x32_bf16 v[138:141], a[20:23], v[186:189], v[138:141]
v_mfma_f32_16x16x32_bf16 v[142:145], a[44:47], v[186:189], v[142:145]
v_mfma_f32_16x16x32_bf16 v[146:149], a[68:71], v[186:189], v[146:149]
v_cvt_pk_bf16_f32 v102, v138, v139
v_cvt_pk_bf16_f32 v103, v140, v141
s_nop 0
v_cvt_pk_bf16_f32 v104, v142, v143
v_cvt_pk_bf16_f32 v105, v144, v145
s_nop 1
v_cvt_pk_bf16_f32 v106, v146, v147
v_cvt_pk_bf16_f32 v107, v148, v149
ds_read_b128 v[108:111], v215 offset:512
ds_read_b64 v[112:113], v215 offset:528
v_mov_b32 v181, 0
v_mfma_f32_16x16x16_bf16 v[138:141], v[82:83], v[76:77], 0
v_mfma_f32_16x16x16_bf16 v[142:145], v[100:101], v[76:77], 0
s_waitcnt lgkmcnt(0)
v_mfma_f32_16x16x16_bf16 v[150:153], v[112:113], v[76:77], v[206:209]
v_mfma_f32_16x16x16_bf16 v[146:149], v[106:107], v[76:77], 0
v_mfma_f32_16x16x32_bf16 v[138:141], v[78:81], v[72:75], v[138:141]
v_mfma_f32_16x16x32_bf16 v[142:145], v[96:99], v[72:75], v[142:145]
v_mfma_f32_16x16x32_bf16 v[150:153], v[108:111], v[72:75], v[150:153]
v_mfma_f32_16x16x32_bf16 v[146:149], v[102:105], v[72:75], v[146:149]
ds_read_b128 v[72:75], v215
ds_read_b64 v[76:77], v215 offset:16
v_mfma_f32_16x16x16_bf16 v[154:157], v[82:83], v[88:89], 0
v_mfma_f32_16x16x16_bf16 v[158:161], v[100:101], v[88:89], 0
v_mfma_f32_16x16x16_bf16 v[166:169], v[112:113], v[88:89], v[206:209]
v_mfma_f32_16x16x16_bf16 v[162:165], v[106:107], v[88:89], 0
v_mfma_f32_16x16x32_bf16 v[154:157], v[78:81], v[84:87], v[154:157]
v_mfma_f32_16x16x32_bf16 v[158:161], v[96:99], v[84:87], v[158:161]
v_mfma_f32_16x16x32_bf16 v[166:169], v[108:111], v[84:87], v[166:169]
v_mfma_f32_16x16x32_bf16 v[162:165], v[102:105], v[84:87], v[162:165]
ds_read_b128 v[182:185], v210 offset:12288
s_waitcnt lgkmcnt(0)
v_mfma_f32_16x16x32_bf16 v[118:121], v[182:185], a[72:75], 0
v_mfma_f32_16x16x32_bf16 v[126:129], v[182:185], a[96:99], 0
v_mfma_f32_16x16x32_bf16 v[134:137], v[182:185], a[120:123], 0
v_mfma_f32_16x16x32_bf16 v[90:93], a[216:219], v[182:185], 0
v_mfma_f32_16x16x32_bf16 v[170:173], a[240:243], v[182:185], 0
v_mfma_f32_16x16x32_bf16 v[220:223], v[232:235], v[182:185], 0
ds_read_b128 v[186:189], v210 offset:13312
s_waitcnt lgkmcnt(0)
v_mfma_f32_16x16x32_bf16 v[118:121], v[186:189], a[76:79], v[118:121]
v_mfma_f32_16x16x32_bf16 v[126:129], v[186:189], a[100:103], v[126:129]
v_mfma_f32_16x16x32_bf16 v[134:137], v[186:189], a[124:127], v[134:137]
v_mfma_f32_16x16x32_bf16 v[90:93], a[220:223], v[186:189], v[90:93]
v_mfma_f32_16x16x32_bf16 v[170:173], a[244:247], v[186:189], v[170:173]
v_mfma_f32_16x16x32_bf16 v[220:223], v[236:239], v[186:189], v[220:223]
ds_read_b128 v[182:185], v210 offset:14336
s_waitcnt lgkmcnt(0)
v_mfma_f32_16x16x32_bf16 v[118:121], v[182:185], a[80:83], v[118:121]
v_mfma_f32_16x16x32_bf16 v[126:129], v[182:185], a[104:107], v[126:129]
v_mfma_f32_16x16x32_bf16 v[134:137], v[182:185], a[128:131], v[134:137]
v_mfma_f32_16x16x32_bf16 v[90:93], a[224:227], v[182:185], v[90:93]
v_mfma_f32_16x16x32_bf16 v[170:173], a[248:251], v[182:185], v[170:173]
v_mfma_f32_16x16x32_bf16 v[220:223], v[240:243], v[182:185], v[220:223]
ds_read_b128 v[186:189], v210 offset:15360
s_waitcnt lgkmcnt(0)
v_mfma_f32_16x16x32_bf16 v[118:121], v[186:189], a[84:87], v[118:121]
v_mfma_f32_16x16x32_bf16 v[126:129], v[186:189], a[108:111], v[126:129]
v_mfma_f32_16x16x32_bf16 v[134:137], v[186:189], a[132:135], v[134:137]
v_mfma_f32_16x16x32_bf16 v[90:93], a[228:231], v[186:189], v[90:93]
v_mfma_f32_16x16x32_bf16 v[170:173], a[252:255], v[186:189], v[170:173]
v_mfma_f32_16x16x32_bf16 v[220:223], v[244:247], v[186:189], v[220:223]
ds_read_b128 v[182:185], v210 offset:16384
s_waitcnt lgkmcnt(0)
v_mfma_f32_16x16x32_bf16 v[118:121], v[182:185], a[88:91], v[118:121]
v_mfma_f32_16x16x32_bf16 v[126:129], v[182:185], a[112:115], v[126:129]
v_mfma_f32_16x16x32_bf16 v[134:137], v[182:185], a[136:139], v[134:137]
v_mfma_f32_16x16x32_bf16 v[90:93], a[232:235], v[182:185], v[90:93]
v_mfma_f32_16x16x32_bf16 v[170:173], v[224:227], v[182:185], v[170:173]
v_mfma_f32_16x16x32_bf16 v[220:223], v[248:251], v[182:185], v[220:223]
ds_read_b128 v[186:189], v210 offset:17408
s_waitcnt lgkmcnt(0)
v_mfma_f32_16x16x32_bf16 v[118:121], v[186:189], a[92:95], v[118:121]
v_mfma_f32_16x16x32_bf16 v[126:129], v[186:189], a[116:119], v[126:129]
v_mfma_f32_16x16x32_bf16 v[134:137], v[186:189], a[140:143], v[134:137]
v_mfma_f32_16x16x32_bf16 v[90:93], a[236:239], v[186:189], v[90:93]
v_mfma_f32_16x16x32_bf16 v[170:173], v[228:231], v[186:189], v[170:173]
v_mfma_f32_16x16x32_bf16 v[220:223], v[252:255], v[186:189], v[220:223]
v_cvt_pk_bf16_f32 v118, v118, v119
v_cvt_pk_bf16_f32 v119, v120, v121
ds_read_u16 v120, v214 offset:1024
v_mov_b32 v121, 0
v_cvt_pk_bf16_f32 v126, v126, v127
v_cvt_pk_bf16_f32 v127, v128, v129
ds_read_u16 v128, v214 offset:1032
v_mov_b32 v129, 0
v_cvt_pk_bf16_f32 v134, v134, v135
v_cvt_pk_bf16_f32 v135, v136, v137
ds_read_u16 v136, v214 offset:1040
v_mov_b32 v137, 0
v_cvt_pk_bf16_f32 v90, v90, v91
v_cvt_pk_bf16_f32 v91, v92, v93
v_cvt_pk_bf16_f32 v92, v170, v171
v_cvt_pk_bf16_f32 v93, v172, v173
v_cvt_pk_bf16_f32 v94, v220, v221
v_cvt_pk_bf16_f32 v95, v222, v223
v_max3_f32 v151, v138, v139, v140
v_max3_f32 v151, v151, v141, v142
v_max3_f32 v151, v151, v143, v144
v_max3_f32 v151, v151, v145, v146
v_max3_f32 v151, v151, v147, v148
v_max3_f32 v151, v151, v149, v150
v_mov_b32 v152, v151
s_nop 1
v_permlane16_swap_b32 v151, v152
v_max_f32 v151, v151, v152
v_mov_b32 v152, v151
s_nop 1
v_permlane32_swap_b32 v151, v152
v_max_f32 v151, v151, v152
v_sub_f32 v138, v138, v151
v_sub_f32 v139, v139, v151
v_sub_f32 v140, v140, v151
v_sub_f32 v141, v141, v151
v_sub_f32 v142, v142, v151
v_sub_f32 v143, v143, v151
v_sub_f32 v144, v144, v151
v_sub_f32 v145, v145, v151
v_sub_f32 v150, v150, v151
v_sub_f32 v146, v146, v151
v_sub_f32 v147, v147, v151
v_sub_f32 v148, v148, v151
v_sub_f32 v149, v149, v151
v_exp_f32 v138, v138
v_exp_f32 v139, v139
v_exp_f32 v140, v140
v_exp_f32 v141, v141
v_exp_f32 v142, v142
v_exp_f32 v143, v143
v_exp_f32 v144, v144
v_exp_f32 v145, v145
v_exp_f32 v150, v150
v_exp_f32 v146, v146
v_exp_f32 v147, v147
v_exp_f32 v148, v148
v_exp_f32 v149, v149
v_cvt_pk_bf16_f32 v174, v138, v139
v_cvt_pk_bf16_f32 v175, v140, v141
v_cvt_pk_bf16_f32 v176, v142, v143
v_cvt_pk_bf16_f32 v177, v144, v145
v_cvt_pk_bf16_f32 v178, v146, v147
v_cvt_pk_bf16_f32 v179, v148, v149
v_cvt_pk_bf16_f32 v180, v150, 0
v_mfma_f32_16x16x32_bf16 v[150:153], v[190:193], v[174:177], 0
v_mfma_f32_16x16x32_bf16 v[138:141], v[114:117], v[174:177], 0
v_mfma_f32_16x16x32_bf16 v[142:145], v[122:125], v[174:177], 0
v_mfma_f32_16x16x32_bf16 v[146:149], v[130:133], v[174:177], 0
v_mfma_f32_16x16x32_bf16 v[150:153], v[190:193], v[178:181], v[150:153]
s_waitcnt lgkmcnt(2)
v_mfma_f32_16x16x32_bf16 v[138:141], v[118:121], v[178:181], v[138:141]
s_waitcnt lgkmcnt(1)
v_mfma_f32_16x16x32_bf16 v[142:145], v[126:129], v[178:181], v[142:145]
s_waitcnt lgkmcnt(0)
v_mfma_f32_16x16x32_bf16 v[146:149], v[134:137], v[178:181], v[146:149]
v_max3_f32 v167, v154, v155, v156
v_max3_f32 v167, v167, v157, v158
v_max3_f32 v167, v167, v159, v160
v_max3_f32 v167, v167, v161, v162
v_max3_f32 v167, v167, v163, v164
v_max3_f32 v167, v167, v165, v166
v_mov_b32 v168, v167
s_nop 1
v_permlane16_swap_b32 v167, v168
v_max_f32 v167, v167, v168
v_mov_b32 v168, v167
s_nop 1
v_permlane32_swap_b32 v167, v168
v_max_f32 v167, v167, v168
v_sub_f32 v154, v154, v167
v_sub_f32 v155, v155, v167
v_sub_f32 v156, v156, v167
v_sub_f32 v157, v157, v167
v_sub_f32 v158, v158, v167
v_sub_f32 v159, v159, v167
v_sub_f32 v160, v160, v167
v_sub_f32 v161, v161, v167
v_sub_f32 v166, v166, v167
v_sub_f32 v162, v162, v167
v_sub_f32 v163, v163, v167
v_sub_f32 v164, v164, v167
v_sub_f32 v165, v165, v167
v_exp_f32 v154, v154
v_exp_f32 v155, v155
v_exp_f32 v156, v156
v_exp_f32 v157, v157
v_exp_f32 v158, v158
v_exp_f32 v159, v159
v_exp_f32 v160, v160
v_exp_f32 v161, v161
v_exp_f32 v166, v166
v_exp_f32 v162, v162
v_exp_f32 v163, v163
v_exp_f32 v164, v164
v_exp_f32 v165, v165
v_cvt_pk_bf16_f32 v174, v154, v155
v_cvt_pk_bf16_f32 v175, v156, v157
v_cvt_pk_bf16_f32 v176, v158, v159
v_cvt_pk_bf16_f32 v177, v160, v161
v_cvt_pk_bf16_f32 v178, v162, v163
v_cvt_pk_bf16_f32 v179, v164, v165
v_cvt_pk_bf16_f32 v180, v166, 0
v_mfma_f32_16x16x32_bf16 v[166:169], v[190:193], v[174:177], 0
v_mfma_f32_16x16x32_bf16 v[154:157], v[114:117], v[174:177], 0
v_mfma_f32_16x16x32_bf16 v[158:161], v[122:125], v[174:177], 0
v_mfma_f32_16x16x32_bf16 v[162:165], v[130:133], v[174:177], 0
v_mfma_f32_16x16x32_bf16 v[166:169], v[190:193], v[178:181], v[166:169]
v_mfma_f32_16x16x32_bf16 v[154:157], v[118:121], v[178:181], v[154:157]
v_mfma_f32_16x16x32_bf16 v[158:161], v[126:129], v[178:181], v[158:161]
v_mfma_f32_16x16x32_bf16 v[162:165], v[134:137], v[178:181], v[162:165]
v_rcp_f32 v151, v150
s_nop 0
v_mul_f32 v151, s3, v151
v_mul_f32 v138, v138, v151
v_mul_f32 v139, v139, v151
v_cvt_pk_bf16_f32 v138, v138, v139
v_mul_f32 v140, v140, v151
v_mul_f32 v141, v141, v151
v_cvt_pk_bf16_f32 v139, v140, v141
v_mul_f32 v142, v142, v151
v_mul_f32 v143, v143, v151
v_cvt_pk_bf16_f32 v140, v142, v143
v_mul_f32 v144, v144, v151
v_mul_f32 v145, v145, v151
v_cvt_pk_bf16_f32 v141, v144, v145
ds_write_b128 v211, v[138:141] offset:38912
v_mul_f32 v146, v146, v151
v_mul_f32 v147, v147, v151
v_cvt_pk_bf16_f32 v142, v146, v147
v_mul_f32 v148, v148, v151
v_mul_f32 v149, v149, v151
v_cvt_pk_bf16_f32 v143, v148, v149
ds_write_b64 v212, v[142:143] offset:38912
v_mfma_f32_16x16x32_bf16 v[138:141], v[78:81], v[90:93], 0
v_mfma_f32_16x16x32_bf16 v[142:145], v[96:99], v[90:93], 0
v_mfma_f32_16x16x32_bf16 v[150:153], v[108:111], v[90:93], v[206:209]
v_mfma_f32_16x16x32_bf16 v[146:149], v[102:105], v[90:93], 0
v_mfma_f32_16x16x16_bf16 v[138:141], v[82:83], v[94:95], v[138:141]
v_mfma_f32_16x16x16_bf16 v[142:145], v[100:101], v[94:95], v[142:145]
v_mfma_f32_16x16x16_bf16 v[150:153], v[112:113], v[94:95], v[150:153]
v_mfma_f32_16x16x16_bf16 v[146:149], v[106:107], v[94:95], v[146:149]
v_rcp_f32 v167, v166
s_nop 0
v_mul_f32 v167, s3, v167
v_mul_f32 v154, v154, v167
v_mul_f32 v155, v155, v167
v_cvt_pk_bf16_f32 v154, v154, v155
v_mul_f32 v156, v156, v167
v_mul_f32 v157, v157, v167
v_cvt_pk_bf16_f32 v155, v156, v157
v_mul_f32 v158, v158, v167
v_mul_f32 v159, v159, v167
v_cvt_pk_bf16_f32 v156, v158, v159
v_mul_f32 v160, v160, v167
v_mul_f32 v161, v161, v167
v_cvt_pk_bf16_f32 v157, v160, v161
ds_write_b128 v211, v[154:157] offset:45056
v_mul_f32 v162, v162, v167
v_mul_f32 v163, v163, v167
v_cvt_pk_bf16_f32 v158, v162, v163
v_mul_f32 v164, v164, v167
v_mul_f32 v165, v165, v167
v_cvt_pk_bf16_f32 v159, v164, v165
ds_write_b64 v212, v[158:159] offset:45056
v_mfma_f32_16x16x16_bf16 v[154:157], v[76:77], v[82:83], 0
v_mfma_f32_16x16x16_bf16 v[158:161], v[76:77], v[100:101], 0
v_mfma_f32_16x16x16_bf16 v[162:165], v[76:77], v[106:107], 0
v_mfma_f32_16x16x16_bf16 v[166:169], v[76:77], v[112:113], v[206:209]
v_mfma_f32_16x16x32_bf16 v[154:157], v[72:75], v[78:81], v[154:157]
v_mfma_f32_16x16x32_bf16 v[158:161], v[72:75], v[96:99], v[158:161]
v_mfma_f32_16x16x32_bf16 v[162:165], v[72:75], v[102:105], v[162:165]
v_mfma_f32_16x16x32_bf16 v[166:169], v[72:75], v[108:111], v[166:169]
v_mov_b32_dpp v154, v158 quad_perm:[0,1,2,3] row_mask:0x2 bank_mask:0xf
s_nop 1
v_mov_b32_dpp v154, v162 quad_perm:[0,1,2,3] row_mask:0x4 bank_mask:0xf
s_nop 2
v_mov_b32_dpp v154, v167 quad_perm:[0,1,2,3] row_mask:0x8 bank_mask:0xf
v_mov_b32 v155, v154
s_nop 1
v_max_f32_dpp v155, v155, v155 row_ror:8 row_mask:0xf bank_mask:0xf
s_nop 1
v_max_f32_dpp v155, v155, v155 row_ror:4 row_mask:0xf bank_mask:0xf
s_nop 1
v_max_f32_dpp v155, v155, v155 row_ror:2 row_mask:0xf bank_mask:0xf
s_nop 1
v_max_f32_dpp v155, v155, v155 row_ror:1 row_mask:0xf bank_mask:0xf
v_mov_b32 v156, v155
s_nop 1
v_permlane16_swap_b32 v155, v156
v_max_f32 v155, v155, v156
v_mov_b32 v156, v155
s_nop 1
v_permlane32_swap_b32 v155, v156
v_max_f32 v155, v155, v156
v_sub_f32 v154, v154, v155
v_exp_f32 v154, v154
s_nop 0
v_cvt_pk_bf16_f32 v154, v154, 0
ds_write_b16 v214, v154
s_waitcnt lgkmcnt(1)
ds_read_b128 v[84:87], v215
ds_read_b128 v[88:91], v215 offset:16
v_add_u32 v215, 1552, v215
s_barrier
ds_read_b128 v[170:173], v210 offset:38912
s_waitcnt lgkmcnt(0)
v_mfma_f32_16x16x32_bf16 v[0:3], a[144:147], v[170:173], v[0:3]
v_mfma_f32_16x16x32_bf16 v[4:7], a[168:171], v[170:173], v[4:7]
v_mfma_f32_16x16x32_bf16 v[8:11], a[192:195], v[170:173], v[8:11]
ds_read_b128 v[182:185], v210 offset:39936
s_waitcnt lgkmcnt(0)
v_mfma_f32_16x16x32_bf16 v[0:3], a[148:151], v[182:185], v[0:3]
v_mfma_f32_16x16x32_bf16 v[4:7], a[172:175], v[182:185], v[4:7]
v_mfma_f32_16x16x32_bf16 v[8:11], a[196:199], v[182:185], v[8:11]
ds_read_b128 v[186:189], v210 offset:40960
s_waitcnt lgkmcnt(0)
v_mfma_f32_16x16x32_bf16 v[0:3], a[152:155], v[186:189], v[0:3]
v_mfma_f32_16x16x32_bf16 v[4:7], a[176:179], v[186:189], v[4:7]
v_mfma_f32_16x16x32_bf16 v[8:11], a[200:203], v[186:189], v[8:11]
ds_read_b128 v[170:173], v210 offset:41984
s_waitcnt lgkmcnt(0)
v_mfma_f32_16x16x32_bf16 v[0:3], a[156:159], v[170:173], v[0:3]
v_mfma_f32_16x16x32_bf16 v[4:7], a[180:183], v[170:173], v[4:7]
v_mfma_f32_16x16x32_bf16 v[8:11], a[204:207], v[170:173], v[8:11]
ds_read_b128 v[182:185], v210 offset:43008
s_waitcnt lgkmcnt(0)
v_mfma_f32_16x16x32_bf16 v[0:3], a[160:163], v[182:185], v[0:3]
v_mfma_f32_16x16x32_bf16 v[4:7], a[184:187], v[182:185], v[4:7]
v_mfma_f32_16x16x32_bf16 v[8:11], a[208:211], v[182:185], v[8:11]
ds_read_b128 v[186:189], v210 offset:44032
s_waitcnt lgkmcnt(0)
v_mfma_f32_16x16x32_bf16 v[0:3], a[164:167], v[186:189], v[0:3]
v_mfma_f32_16x16x32_bf16 v[4:7], a[188:191], v[186:189], v[4:7]
v_mfma_f32_16x16x32_bf16 v[8:11], a[212:215], v[186:189], v[8:11]
v_cvt_pk_bf16_f32 v72, v0, v1
v_cvt_pk_bf16_f32 v73, v2, v3
buffer_store_dwordx2 v[72:73], v203, s[8:11], s38 offen
v_cvt_pk_bf16_f32 v74, v4, v5
v_cvt_pk_bf16_f32 v75, v6, v7
buffer_store_dwordx2 v[74:75], v203, s[8:11], s38 offen offset:32
s_nop 0
v_cvt_pk_bf16_f32 v76, v8, v9
v_cvt_pk_bf16_f32 v77, v10, v11
buffer_store_dwordx2 v[76:77], v203, s[8:11], s38 offen offset:64
v_max3_f32 v151, v138, v139, v140
v_max3_f32 v151, v151, v141, v142
v_max3_f32 v151, v151, v143, v144
v_max3_f32 v151, v151, v145, v146
v_max3_f32 v151, v151, v147, v148
v_max3_f32 v151, v151, v149, v150
v_mov_b32 v152, v151
s_nop 1
v_permlane16_swap_b32 v151, v152
v_max_f32 v151, v151, v152
v_mov_b32 v152, v151
s_nop 1
v_permlane32_swap_b32 v151, v152
v_max_f32 v151, v151, v152
v_sub_f32 v138, v138, v151
v_sub_f32 v139, v139, v151
v_sub_f32 v140, v140, v151
v_sub_f32 v141, v141, v151
v_sub_f32 v142, v142, v151
v_sub_f32 v143, v143, v151
v_sub_f32 v144, v144, v151
v_sub_f32 v145, v145, v151
v_sub_f32 v150, v150, v151
v_sub_f32 v146, v146, v151
v_sub_f32 v147, v147, v151
v_sub_f32 v148, v148, v151
v_sub_f32 v149, v149, v151
v_exp_f32 v138, v138
v_exp_f32 v139, v139
v_exp_f32 v140, v140
v_exp_f32 v141, v141
v_exp_f32 v142, v142
v_exp_f32 v143, v143
v_exp_f32 v144, v144
v_exp_f32 v145, v145
v_exp_f32 v150, v150
v_exp_f32 v146, v146
v_exp_f32 v147, v147
v_exp_f32 v148, v148
v_exp_f32 v149, v149
v_cvt_pk_bf16_f32 v174, v138, v139
v_cvt_pk_bf16_f32 v175, v140, v141
v_cvt_pk_bf16_f32 v176, v142, v143
v_cvt_pk_bf16_f32 v177, v144, v145
v_cvt_pk_bf16_f32 v178, v146, v147
v_cvt_pk_bf16_f32 v179, v148, v149
v_cvt_pk_bf16_f32 v180, v150, 0
v_mfma_f32_16x16x32_bf16 v[150:153], v[190:193], v[174:177], 0
v_mfma_f32_16x16x32_bf16 v[138:141], v[114:117], v[174:177], 0
v_mfma_f32_16x16x32_bf16 v[142:145], v[122:125], v[174:177], 0
v_mfma_f32_16x16x32_bf16 v[146:149], v[130:133], v[174:177], 0
v_mfma_f32_16x16x32_bf16 v[150:153], v[190:193], v[178:181], v[150:153]
v_mfma_f32_16x16x32_bf16 v[138:141], v[118:121], v[178:181], v[138:141]
v_mfma_f32_16x16x32_bf16 v[142:145], v[126:129], v[178:181], v[142:145]
v_mfma_f32_16x16x32_bf16 v[146:149], v[134:137], v[178:181], v[146:149]
v_mfma_f32_16x16x32_bf16 v[166:169], v[84:87], v[190:193], 0
v_mfma_f32_16x16x32_bf16 v[154:157], v[84:87], v[114:117], 0
v_mfma_f32_16x16x32_bf16 v[158:161], v[84:87], v[122:125], 0
v_mfma_f32_16x16x32_bf16 v[162:165], v[84:87], v[130:133], 0
v_mfma_f32_16x16x32_bf16 v[166:169], v[88:91], v[190:193], v[166:169]
v_mfma_f32_16x16x32_bf16 v[154:157], v[88:91], v[118:121], v[154:157]
v_mfma_f32_16x16x32_bf16 v[158:161], v[88:91], v[126:129], v[158:161]
v_mfma_f32_16x16x32_bf16 v[162:165], v[88:91], v[134:137], v[162:165]
v_rcp_f32 v167, v166
s_nop 1
v_mov_b32_dpp v154, v158 quad_perm:[0,1,2,3] row_mask:0x2 bank_mask:0xf
s_nop 2
v_mov_b32_dpp v154, v162 quad_perm:[0,1,2,3] row_mask:0x4 bank_mask:0xf
v_mul_f32 v167, s3, v167
v_mul_f32 v154, v154, v167
v_cvt_pk_bf16_f32 v154, v154, 0
ds_write_b16 v214, v154
v_add_u32 v214, 1552, v214
ds_read_b128 v[170:173], v210 offset:45056
s_waitcnt lgkmcnt(0)
v_mfma_f32_16x16x32_bf16 v[12:15], a[144:147], v[170:173], v[12:15]
v_mfma_f32_16x16x32_bf16 v[16:19], a[168:171], v[170:173], v[16:19]
v_mfma_f32_16x16x32_bf16 v[20:23], a[192:195], v[170:173], v[20:23]
ds_read_b128 v[182:185], v210 offset:46080
s_waitcnt lgkmcnt(0)
v_mfma_f32_16x16x32_bf16 v[12:15], a[148:151], v[182:185], v[12:15]
v_mfma_f32_16x16x32_bf16 v[16:19], a[172:175], v[182:185], v[16:19]
v_mfma_f32_16x16x32_bf16 v[20:23], a[196:199], v[182:185], v[20:23]
ds_read_b128 v[186:189], v210 offset:47104
s_waitcnt lgkmcnt(0)
v_mfma_f32_16x16x32_bf16 v[12:15], a[152:155], v[186:189], v[12:15]
v_mfma_f32_16x16x32_bf16 v[16:19], a[176:179], v[186:189], v[16:19]
v_mfma_f32_16x16x32_bf16 v[20:23], a[200:203], v[186:189], v[20:23]
ds_read_b128 v[170:173], v210 offset:48128
s_waitcnt lgkmcnt(0)
v_mfma_f32_16x16x32_bf16 v[12:15], a[156:159], v[170:173], v[12:15]
v_mfma_f32_16x16x32_bf16 v[16:19], a[180:183], v[170:173], v[16:19]
v_mfma_f32_16x16x32_bf16 v[20:23], a[204:207], v[170:173], v[20:23]
ds_read_b128 v[182:185], v210 offset:49152
s_waitcnt lgkmcnt(0)
v_mfma_f32_16x16x32_bf16 v[12:15], a[160:163], v[182:185], v[12:15]
v_mfma_f32_16x16x32_bf16 v[16:19], a[184:187], v[182:185], v[16:19]
v_mfma_f32_16x16x32_bf16 v[20:23], a[208:211], v[182:185], v[20:23]
ds_read_b128 v[186:189], v210 offset:50176
s_waitcnt lgkmcnt(0)
v_mfma_f32_16x16x32_bf16 v[12:15], a[164:167], v[186:189], v[12:15]
v_mfma_f32_16x16x32_bf16 v[16:19], a[188:191], v[186:189], v[16:19]
v_mfma_f32_16x16x32_bf16 v[20:23], a[212:215], v[186:189], v[20:23]
s_sub_u32 s46, s46, 1
v_cvt_pk_bf16_f32 v78, v12, v13
v_cvt_pk_bf16_f32 v79, v14, v15
buffer_store_dwordx2 v[78:79], v204, s[8:11], s38 offen
v_cvt_pk_bf16_f32 v80, v16, v17
v_cvt_pk_bf16_f32 v81, v18, v19
buffer_store_dwordx2 v[80:81], v204, s[8:11], s38 offen offset:32
s_nop 0
v_cvt_pk_bf16_f32 v82, v20, v21
v_cvt_pk_bf16_f32 v83, v22, v23
buffer_store_dwordx2 v[82:83], v204, s[8:11], s38 offen offset:64
v_rcp_f32 v151, v150
s_nop 0
v_mul_f32 v151, s3, v151
v_mul_f32 v138, v138, v151
v_mul_f32 v139, v139, v151
v_cvt_pk_bf16_f32 v138, v138, v139
v_mul_f32 v140, v140, v151
v_mul_f32 v141, v141, v151
v_cvt_pk_bf16_f32 v139, v140, v141
v_mul_f32 v142, v142, v151
v_mul_f32 v143, v143, v151
v_cvt_pk_bf16_f32 v140, v142, v143
v_mul_f32 v144, v144, v151
v_mul_f32 v145, v145, v151
v_cvt_pk_bf16_f32 v141, v144, v145
ds_write_b128 v211, v[138:141] offset:51200
v_mul_f32 v146, v146, v151
v_mul_f32 v147, v147, v151
v_cvt_pk_bf16_f32 v142, v146, v147
v_mul_f32 v148, v148, v151
v_mul_f32 v149, v149, v151
v_cvt_pk_bf16_f32 v143, v148, v149
ds_write_b64 v212, v[142:143] offset:51200
s_cbranch_scc0 G_loop
s_waitcnt vmcnt(6) lgkmcnt(0)
s_barrier
ds_read_b128 v[170:173], v210 offset:51200
s_waitcnt lgkmcnt(0)
v_mfma_f32_16x16x32_bf16 v[24:27], a[144:147], v[170:173], v[24:27]
v_mfma_f32_16x16x32_bf16 v[28:31], a[168:171], v[170:173], v[28:31]
v_mfma_f32_16x16x32_bf16 v[32:35], a[192:195], v[170:173], v[32:35]
ds_read_b128 v[182:185], v210 offset:52224
s_waitcnt lgkmcnt(0)
v_mfma_f32_16x16x32_bf16 v[24:27], a[148:151], v[182:185], v[24:27]
v_mfma_f32_16x16x32_bf16 v[28:31], a[172:175], v[182:185], v[28:31]
v_mfma_f32_16x16x32_bf16 v[32:35], a[196:199], v[182:185], v[32:35]
ds_read_b128 v[186:189], v210 offset:53248
s_waitcnt lgkmcnt(0)
v_mfma_f32_16x16x32_bf16 v[24:27], a[152:155], v[186:189], v[24:27]
v_mfma_f32_16x16x32_bf16 v[28:31], a[176:179], v[186:189], v[28:31]
v_mfma_f32_16x16x32_bf16 v[32:35], a[200:203], v[186:189], v[32:35]
ds_read_b128 v[170:173], v210 offset:54272
s_waitcnt lgkmcnt(0)
v_mfma_f32_16x16x32_bf16 v[24:27], a[156:159], v[170:173], v[24:27]
v_mfma_f32_16x16x32_bf16 v[28:31], a[180:183], v[170:173], v[28:31]
v_mfma_f32_16x16x32_bf16 v[32:35], a[204:207], v[170:173], v[32:35]
ds_read_b128 v[182:185], v210 offset:55296
s_waitcnt lgkmcnt(0)
v_mfma_f32_16x16x32_bf16 v[24:27], a[160:163], v[182:185], v[24:27]
v_mfma_f32_16x16x32_bf16 v[28:31], a[184:187], v[182:185], v[28:31]
v_mfma_f32_16x16x32_bf16 v[32:35], a[208:211], v[182:185], v[32:35]
ds_read_b128 v[186:189], v210 offset:56320
s_waitcnt lgkmcnt(0)
v_mfma_f32_16x16x32_bf16 v[24:27], a[164:167], v[186:189], v[24:27]
v_mfma_f32_16x16x32_bf16 v[28:31], a[188:191], v[186:189], v[28:31]
v_mfma_f32_16x16x32_bf16 v[32:35], a[212:215], v[186:189], v[32:35]
v_cvt_pk_bf16_f32 v116, v24, v25
v_cvt_pk_bf16_f32 v117, v26, v27
buffer_store_dwordx2 v[116:117], v205, s[8:11], s38 offen
v_cvt_pk_bf16_f32 v124, v28, v29
v_cvt_pk_bf16_f32 v125, v30, v31
buffer_store_dwordx2 v[124:125], v205, s[8:11], s38 offen offset:32
s_nop 0
v_cvt_pk_bf16_f32 v132, v32, v33
v_cvt_pk_bf16_f32 v133, v34, v35
buffer_store_dwordx2 v[132:133], v205, s[8:11], s38 offen offset:64
s_mov_b32 s39, s37
ds_read_b128 v[174:177], v217
ds_read_b128 v[84:87], v200
s_waitcnt lgkmcnt(0)
v_mfma_f32_16x16x32_bf16 v[0:3], v[174:177], v[84:87], 0
ds_read_b128 v[92:95], v201
s_waitcnt lgkmcnt(0)
v_mfma_f32_16x16x32_bf16 v[12:15], v[174:177], v[92:95], 0
ds_read_b128 v[100:103], v202
s_waitcnt lgkmcnt(0)
v_mfma_f32_16x16x32_bf16 v[24:27], v[174:177], v[100:103], 0
ds_read_b128 v[178:181], v217 offset:528
ds_read_b128 v[84:87], v194
ds_read_b128 v[88:91], v194 offset:16
s_waitcnt lgkmcnt(0)
v_smfmac_f32_16x16x64_bf16 v[0:3], v[178:181], v[84:91], v213
ds_read_b128 v[92:95], v195
ds_read_b128 v[96:99], v195 offset:16
s_waitcnt lgkmcnt(0)
v_smfmac_f32_16x16x64_bf16 v[12:15], v[178:181], v[92:99], v213
ds_read_b128 v[100:103], v196
ds_read_b128 v[104:107], v196 offset:16
s_waitcnt lgkmcnt(0)
v_smfmac_f32_16x16x64_bf16 v[24:27], v[178:181], v[100:107], v213
ds_read_b128 v[174:177], v217 offset:1056
ds_read_b128 v[84:87], v197
ds_read_b128 v[88:91], v197 offset:16
s_waitcnt lgkmcnt(0)
v_smfmac_f32_16x16x64_bf16 v[0:3], v[174:177], v[84:91], v213
ds_read_b128 v[92:95], v198
ds_read_b128 v[96:99], v198 offset:16
s_waitcnt lgkmcnt(0)
v_smfmac_f32_16x16x64_bf16 v[12:15], v[174:177], v[92:99], v213
ds_read_b128 v[100:103], v199
ds_read_b128 v[104:107], v199 offset:16
s_waitcnt lgkmcnt(0)
v_smfmac_f32_16x16x64_bf16 v[24:27], v[174:177], v[100:107], v213
ds_read_b128 v[178:181], v217 offset:1584
ds_read_b128 v[84:87], v200 offset:32
s_waitcnt lgkmcnt(0)
v_mfma_f32_16x16x32_bf16 v[4:7], v[178:181], v[84:87], 0
ds_read_b128 v[92:95], v201 offset:32
s_waitcnt lgkmcnt(0)
v_mfma_f32_16x16x32_bf16 v[16:19], v[178:181], v[92:95], 0
ds_read_b128 v[100:103], v202 offset:32
s_waitcnt lgkmcnt(0)
v_mfma_f32_16x16x32_bf16 v[28:31], v[178:181], v[100:103], 0
ds_read_b128 v[174:177], v217 offset:2112
ds_read_b128 v[84:87], v194 offset:32
ds_read_b128 v[88:91], v194 offset:48
s_waitcnt lgkmcnt(0)
v_smfmac_f32_16x16x64_bf16 v[4:7], v[174:177], v[84:91], v213
ds_read_b128 v[92:95], v195 offset:32
ds_read_b128 v[96:99], v195 offset:48
s_waitcnt lgkmcnt(0)
v_smfmac_f32_16x16x64_bf16 v[16:19], v[174:177], v[92:99], v213
ds_read_b128 v[100:103], v196 offset:32
ds_read_b128 v[104:107], v196 offset:48
s_waitcnt lgkmcnt(0)
v_smfmac_f32_16x16x64_bf16 v[28:31], v[174:177], v[100:107], v213
ds_read_b128 v[178:181], v217 offset:2640
ds_read_b128 v[84:87], v197 offset:32
ds_read_b128 v[88:91], v197 offset:48
s_waitcnt lgkmcnt(0)
v_smfmac_f32_16x16x64_bf16 v[4:7], v[178:181], v[84:91], v213
ds_read_b128 v[92:95], v198 offset:32
ds_read_b128 v[96:99], v198 offset:48
s_waitcnt lgkmcnt(0)
v_smfmac_f32_16x16x64_bf16 v[16:19], v[178:181], v[92:99], v213
ds_read_b128 v[100:103], v199 offset:32
ds_read_b128 v[104:107], v199 offset:48
s_waitcnt lgkmcnt(0)
v_smfmac_f32_16x16x64_bf16 v[28:31], v[178:181], v[100:107], v213
ds_read_b128 v[174:177], v217 offset:3168
ds_read_b128 v[84:87], v200 offset:64
s_waitcnt lgkmcnt(0)
v_mfma_f32_16x16x32_bf16 v[8:11], v[174:177], v[84:87], 0
ds_read_b128 v[92:95], v201 offset:64
s_waitcnt lgkmcnt(0)
v_mfma_f32_16x16x32_bf16 v[20:23], v[174:177], v[92:95], 0
ds_read_b128 v[100:103], v202 offset:64
s_waitcnt lgkmcnt(0)
v_mfma_f32_16x16x32_bf16 v[32:35], v[174:177], v[100:103], 0
ds_read_b128 v[178:181], v217 offset:3696
ds_read_b128 v[84:87], v194 offset:64
ds_read_b128 v[88:91], v194 offset:80
s_waitcnt lgkmcnt(0)
v_smfmac_f32_16x16x64_bf16 v[8:11], v[178:181], v[84:91], v213
ds_read_b128 v[92:95], v195 offset:64
ds_read_b128 v[96:99], v195 offset:80
s_waitcnt lgkmcnt(0)
v_smfmac_f32_16x16x64_bf16 v[20:23], v[178:181], v[92:99], v213
ds_read_b128 v[100:103], v196 offset:64
ds_read_b128 v[104:107], v196 offset:80
s_waitcnt lgkmcnt(0)
v_smfmac_f32_16x16x64_bf16 v[32:35], v[178:181], v[100:107], v213
ds_read_b128 v[174:177], v217 offset:4224
ds_read_b128 v[84:87], v197 offset:64
ds_read_b128 v[88:91], v197 offset:80
s_waitcnt lgkmcnt(0)
v_smfmac_f32_16x16x64_bf16 v[8:11], v[174:177], v[84:91], v213
ds_read_b128 v[92:95], v198 offset:64
ds_read_b128 v[96:99], v198 offset:80
s_waitcnt lgkmcnt(0)
v_smfmac_f32_16x16x64_bf16 v[20:23], v[174:177], v[92:99], v213
ds_read_b128 v[100:103], v199 offset:64
ds_read_b128 v[104:107], v199 offset:80
s_waitcnt lgkmcnt(0)
v_smfmac_f32_16x16x64_bf16 v[32:35], v[174:177], v[100:107], v213
v_add_f32 v118, v0, v1
v_mul_f32 v119, v0, v0
v_add_f32 v118, v118, v2
v_fmac_f32 v119, v1, v1
v_add_f32 v118, v118, v3
v_fmac_f32 v119, v2, v2
v_fmac_f32 v119, v3, v3
v_add_f32 v126, v12, v13
v_mul_f32 v127, v12, v12
v_add_f32 v126, v126, v14
v_fmac_f32 v127, v13, v13
v_add_f32 v126, v126, v15
v_fmac_f32 v127, v14, v14
v_fmac_f32 v127, v15, v15
v_add_f32 v134, v24, v25
v_mul_f32 v135, v24, v24
v_add_f32 v134, v134, v26
v_fmac_f32 v135, v25, v25
v_add_f32 v134, v134, v27
v_fmac_f32 v135, v26, v26
v_fmac_f32 v135, v27, v27
v_add_f32 v118, v118, v4
v_fmac_f32 v119, v4, v4
v_add_f32 v118, v118, v5
v_fmac_f32 v119, v5, v5
v_add_f32 v118, v118, v6
v_fmac_f32 v119, v6, v6
v_add_f32 v118, v118, v7
v_fmac_f32 v119, v7, v7
v_add_f32 v126, v126, v16
v_fmac_f32 v127, v16, v16
v_add_f32 v126, v126, v17
v_fmac_f32 v127, v17, v17
v_add_f32 v126, v126, v18
v_fmac_f32 v127, v18, v18
v_add_f32 v126, v126, v19
v_fmac_f32 v127, v19, v19
v_add_f32 v134, v134, v28
v_fmac_f32 v135, v28, v28
v_add_f32 v134, v134, v29
v_fmac_f32 v135, v29, v29
v_add_f32 v134, v134, v30
v_fmac_f32 v135, v30, v30
v_add_f32 v134, v134, v31
v_fmac_f32 v135, v31, v31
v_add_f32 v118, v118, v8
v_fmac_f32 v119, v8, v8
v_add_f32 v118, v118, v9
v_fmac_f32 v119, v9, v9
v_add_f32 v118, v118, v10
v_fmac_f32 v119, v10, v10
v_add_f32 v118, v118, v11
v_fmac_f32 v119, v11, v11
v_add_f32 v126, v126, v20
v_fmac_f32 v127, v20, v20
v_add_f32 v126, v126, v21
v_fmac_f32 v127, v21, v21
v_add_f32 v126, v126, v22
v_fmac_f32 v127, v22, v22
v_add_f32 v126, v126, v23
v_fmac_f32 v127, v23, v23
v_add_f32 v134, v134, v32
v_fmac_f32 v135, v32, v32
v_add_f32 v134, v134, v33
v_fmac_f32 v135, v33, v33
v_add_f32 v134, v134, v34
v_fmac_f32 v135, v34, v34
v_add_f32 v134, v134, v35
v_fmac_f32 v135, v35, v35
v_permlane16_swap_b32 v118, v119
v_add_f32 v118, v118, v119
v_permlane16_swap_b32 v126, v127
v_add_f32 v126, v126, v127
v_permlane16_swap_b32 v134, v135
v_add_f32 v134, v134, v135
v_permlane32_swap_b32 v118, v126
v_add_f32 v118, v118, v126
ds_write_b32 v209, v118
v_mov_b32 v135, v134
s_nop 1
v_permlane32_swap_b32 v134, v135
v_add_f32 v134, v134, v135
ds_write_b32 v209, v134 offset:512
s_waitcnt lgkmcnt(0)
s_barrier
ds_read_b128 v[102:105], v210 offset:18432
ds_read_b128 v[106:109], v210 offset:19456
s_waitcnt lgkmcnt(1)
v_add_f32 v102, v102, v103
s_waitcnt lgkmcnt(0)
v_add_f32 v106, v106, v107
v_add_f32 v104, v104, v105
v_add_f32 v108, v108, v109
v_add_f32 v102, v102, v104
v_add_f32 v106, v106, v108
v_mul_f32 v103, s48, v102
v_mul_f32 v104, s73, v102
v_mul_f32 v106, s73, v106
v_fma_f32 v106, -v103, v104, v106
v_max_f32 v106, 0, v106
v_add_f32 v106, s49, v106
v_rsq_f32 v102, v106
s_nop 0
v_mul_f32_e64 v103, -v103, v102
ds_write_b64 v211, v[102:103]
ds_read_b64 v[118:119], v219
ds_read_b64 v[126:127], v219 offset:256
ds_read_b64 v[134:135], v219 offset:512
s_waitcnt lgkmcnt(2)
v_fma_f32 v220, v0, v118, v119
v_fma_f32 v221, v1, v118, v119
v_cvt_pk_bf16_f32 v90, v220, v221
v_fma_f32 v222, v2, v118, v119
v_fma_f32 v223, v3, v118, v119
v_cvt_pk_bf16_f32 v91, v222, v223
v_fma_f32 v220, v4, v118, v119
v_fma_f32 v221, v5, v118, v119
v_cvt_pk_bf16_f32 v92, v220, v221
v_fma_f32 v222, v6, v118, v119
v_fma_f32 v223, v7, v118, v119
v_cvt_pk_bf16_f32 v93, v222, v223
ds_write_b128 v211, v[90:93]
v_fma_f32 v220, v8, v118, v119
v_fma_f32 v221, v9, v118, v119
v_cvt_pk_bf16_f32 v94, v220, v221
v_fma_f32 v222, v10, v118, v119
v_fma_f32 v223, v11, v118, v119
v_cvt_pk_bf16_f32 v95, v222, v223
s_waitcnt lgkmcnt(2)
ds_write_b64 v212, v[94:95]
v_fma_f32 v220, v12, v126, v127
v_fma_f32 v221, v13, v126, v127
v_cvt_pk_bf16_f32 v174, v220, v221
v_fma_f32 v222, v14, v126, v127
v_fma_f32 v223, v15, v126, v127
v_cvt_pk_bf16_f32 v175, v222, v223
v_fma_f32 v220, v16, v126, v127
v_fma_f32 v221, v17, v126, v127
v_cvt_pk_bf16_f32 v176, v220, v221
v_fma_f32 v222, v18, v126, v127
v_fma_f32 v223, v19, v126, v127
v_cvt_pk_bf16_f32 v177, v222, v223
ds_write_b128 v211, v[174:177] offset:6144
v_fma_f32 v220, v20, v126, v127
v_fma_f32 v221, v21, v126, v127
v_cvt_pk_bf16_f32 v178, v220, v221
v_fma_f32 v222, v22, v126, v127
v_fma_f32 v223, v23, v126, v127
v_cvt_pk_bf16_f32 v179, v222, v223
s_waitcnt lgkmcnt(3)
ds_write_b64 v212, v[178:179] offset:6144
v_fma_f32 v220, v24, v134, v135
v_fma_f32 v221, v25, v134, v135
v_cvt_pk_bf16_f32 v90, v220, v221
v_fma_f32 v222, v26, v134, v135
v_fma_f32 v223, v27, v134, v135
v_cvt_pk_bf16_f32 v91, v222, v223
v_fma_f32 v220, v28, v134, v135
v_fma_f32 v221, v29, v134, v135
v_cvt_pk_bf16_f32 v92, v220, v221
v_fma_f32 v222, v30, v134, v135
v_fma_f32 v223, v31, v134, v135
v_cvt_pk_bf16_f32 v93, v222, v223
ds_write_b128 v211, v[90:93] offset:12288
v_fma_f32 v220, v32, v134, v135
v_fma_f32 v221, v33, v134, v135
v_cvt_pk_bf16_f32 v94, v220, v221
v_fma_f32 v222, v34, v134, v135
v_fma_f32 v223, v35, v134, v135
v_cvt_pk_bf16_f32 v95, v222, v223
ds_write_b64 v212, v[94:95] offset:12288
ds_read_b128 v[182:185], v210 offset:20480
s_waitcnt lgkmcnt(0)
v_mfma_f32_16x16x32_bf16 v[138:141], a[0:3], v[182:185], 0
v_mfma_f32_16x16x32_bf16 v[142:145], a[24:27], v[182:185], 0
v_mfma_f32_16x16x32_bf16 v[146:149], a[48:51], v[182:185], 0
v_mfma_f32_16x16x32_bf16 v[150:153], a[216:219], v[182:185], 0
v_mfma_f32_16x16x32_bf16 v[154:157], a[240:243], v[182:185], 0
v_mfma_f32_16x16x32_bf16 v[158:161], v[232:235], v[182:185], 0
v_mfma_f32_16x16x32_bf16 v[162:165], v[182:185], a[72:75], 0
v_mfma_f32_16x16x32_bf16 v[166:169], v[182:185], a[96:99], 0
v_mfma_f32_16x16x32_bf16 v[170:173], v[182:185], a[120:123], 0
ds_read_b128 v[186:189], v210 offset:21504
s_waitcnt lgkmcnt(0)
v_mfma_f32_16x16x32_bf16 v[138:141], a[4:7], v[186:189], v[138:141]
v_mfma_f32_16x16x32_bf16 v[142:145], a[28:31], v[186:189], v[142:145]
v_mfma_f32_16x16x32_bf16 v[146:149], a[52:55], v[186:189], v[146:149]
v_mfma_f32_16x16x32_bf16 v[150:153], a[220:223], v[186:189], v[150:153]
v_mfma_f32_16x16x32_bf16 v[154:157], a[244:247], v[186:189], v[154:157]
v_mfma_f32_16x16x32_bf16 v[158:161], v[236:239], v[186:189], v[158:161]
v_mfma_f32_16x16x32_bf16 v[162:165], v[186:189], a[76:79], v[162:165]
v_mfma_f32_16x16x32_bf16 v[166:169], v[186:189], a[100:103], v[166:169]
v_mfma_f32_16x16x32_bf16 v[170:173], v[186:189], a[124:127], v[170:173]
ds_read_b128 v[182:185], v210 offset:22528
s_waitcnt lgkmcnt(0)
v_mfma_f32_16x16x32_bf16 v[138:141], a[8:11], v[182:185], v[138:141]
v_mfma_f32_16x16x32_bf16 v[142:145], a[32:35], v[182:185], v[142:145]
v_mfma_f32_16x16x32_bf16 v[146:149], a[56:59], v[182:185], v[146:149]
v_mfma_f32_16x16x32_bf16 v[150:153], a[224:227], v[182:185], v[150:153]
v_mfma_f32_16x16x32_bf16 v[154:157], a[248:251], v[182:185], v[154:157]
v_mfma_f32_16x16x32_bf16 v[158:161], v[240:243], v[182:185], v[158:161]
v_mfma_f32_16x16x32_bf16 v[162:165], v[182:185], a[80:83], v[162:165]
v_mfma_f32_16x16x32_bf16 v[166:169], v[182:185], a[104:107], v[166:169]
v_mfma_f32_16x16x32_bf16 v[170:173], v[182:185], a[128:131], v[170:173]
ds_read_b128 v[186:189], v210 offset:23552
s_waitcnt lgkmcnt(0)
v_mfma_f32_16x16x32_bf16 v[138:141], a[12:15], v[186:189], v[138:141]
v_mfma_f32_16x16x32_bf16 v[142:145], a[36:39], v[186:189], v[142:145]
v_mfma_f32_16x16x32_bf16 v[146:149], a[60:63], v[186:189], v[146:149]
v_mfma_f32_16x16x32_bf16 v[150:153], a[228:231], v[186:189], v[150:153]
v_mfma_f32_16x16x32_bf16 v[154:157], a[252:255], v[186:189], v[154:157]
v_mfma_f32_16x16x32_bf16 v[158:161], v[244:247], v[186:189], v[158:161]
v_mfma_f32_16x16x32_bf16 v[162:165], v[186:189], a[84:87], v[162:165]
v_mfma_f32_16x16x32_bf16 v[166:169], v[186:189], a[108:111], v[166:169]
v_mfma_f32_16x16x32_bf16 v[170:173], v[186:189], a[132:135], v[170:173]
ds_read_b128 v[182:185], v210 offset:24576
s_waitcnt lgkmcnt(0)
v_mfma_f32_16x16x32_bf16 v[138:141], a[16:19], v[182:185], v[138:141]
v_mfma_f32_16x16x32_bf16 v[142:145], a[40:43], v[182:185], v[142:145]
v_mfma_f32_16x16x32_bf16 v[146:149], a[64:67], v[182:185], v[146:149]
v_mfma_f32_16x16x32_bf16 v[150:153], a[232:235], v[182:185], v[150:153]
v_mfma_f32_16x16x32_bf16 v[154:157], v[224:227], v[182:185], v[154:157]
v_mfma_f32_16x16x32_bf16 v[158:161], v[248:251], v[182:185], v[158:161]
v_mfma_f32_16x16x32_bf16 v[162:165], v[182:185], a[88:91], v[162:165]
v_mfma_f32_16x16x32_bf16 v[166:169], v[182:185], a[112:115], v[166:169]
v_mfma_f32_16x16x32_bf16 v[170:173], v[182:185], a[136:139], v[170:173]
ds_read_b128 v[186:189], v210 offset:25600
s_waitcnt lgkmcnt(0)
v_mfma_f32_16x16x32_bf16 v[138:141], a[20:23], v[186:189], v[138:141]
v_mfma_f32_16x16x32_bf16 v[142:145], a[44:47], v[186:189], v[142:145]
v_mfma_f32_16x16x32_bf16 v[146:149], a[68:71], v[186:189], v[146:149]
v_mfma_f32_16x16x32_bf16 v[150:153], a[236:239], v[186:189], v[150:153]
v_mfma_f32_16x16x32_bf16 v[154:157], v[228:231], v[186:189], v[154:157]
v_mfma_f32_16x16x32_bf16 v[158:161], v[252:255], v[186:189], v[158:161]
v_mfma_f32_16x16x32_bf16 v[162:165], v[186:189], a[92:95], v[162:165]
v_mfma_f32_16x16x32_bf16 v[166:169], v[186:189], a[116:119], v[166:169]
v_mfma_f32_16x16x32_bf16 v[170:173], v[186:189], a[140:143], v[170:173]
v_cvt_pk_bf16_f32 v78, v138, v139
v_cvt_pk_bf16_f32 v79, v140, v141
v_cvt_pk_bf16_f32 v80, v142, v143
v_cvt_pk_bf16_f32 v81, v144, v145
v_cvt_pk_bf16_f32 v82, v146, v147
v_cvt_pk_bf16_f32 v83, v148, v149
v_cvt_pk_bf16_f32 v72, v150, v151
v_cvt_pk_bf16_f32 v73, v152, v153
v_cvt_pk_bf16_f32 v74, v154, v155
v_cvt_pk_bf16_f32 v75, v156, v157
v_cvt_pk_bf16_f32 v76, v158, v159
v_cvt_pk_bf16_f32 v77, v160, v161
v_cvt_pk_bf16_f32 v114, v162, v163
v_cvt_pk_bf16_f32 v115, v164, v165
v_cvt_pk_bf16_f32 v122, v166, v167
v_cvt_pk_bf16_f32 v123, v168, v169
v_cvt_pk_bf16_f32 v130, v170, v171
v_cvt_pk_bf16_f32 v131, v172, v173
ds_read_b128 v[182:185], v210 offset:26624
s_waitcnt lgkmcnt(0)
v_mfma_f32_16x16x32_bf16 v[138:141], a[0:3], v[182:185], 0
v_mfma_f32_16x16x32_bf16 v[142:145], a[24:27], v[182:185], 0
v_mfma_f32_16x16x32_bf16 v[146:149], a[48:51], v[182:185], 0
v_mfma_f32_16x16x32_bf16 v[150:153], a[216:219], v[182:185], 0
v_mfma_f32_16x16x32_bf16 v[154:157], a[240:243], v[182:185], 0
v_mfma_f32_16x16x32_bf16 v[158:161], v[232:235], v[182:185], 0
v_mfma_f32_16x16x32_bf16 v[162:165], v[182:185], a[72:75], 0
v_mfma_f32_16x16x32_bf16 v[166:169], v[182:185], a[96:99], 0
v_mfma_f32_16x16x32_bf16 v[170:173], v[182:185], a[120:123], 0
ds_read_b128 v[186:189], v210 offset:27648
s_waitcnt lgkmcnt(0)
v_mfma_f32_16x16x32_bf16 v[138:141], a[4:7], v[186:189], v[138:141]
v_mfma_f32_16x16x32_bf16 v[142:145], a[28:31], v[186:189], v[142:145]
v_mfma_f32_16x16x32_bf16 v[146:149], a[52:55], v[186:189], v[146:149]
v_mfma_f32_16x16x32_bf16 v[150:153], a[220:223], v[186:189], v[150:153]
v_mfma_f32_16x16x32_bf16 v[154:157], a[244:247], v[186:189], v[154:157]
v_mfma_f32_16x16x32_bf16 v[158:161], v[236:239], v[186:189], v[158:161]
v_mfma_f32_16x16x32_bf16 v[162:165], v[186:189], a[76:79], v[162:165]
v_mfma_f32_16x16x32_bf16 v[166:169], v[186:189], a[100:103], v[166:169]
v_mfma_f32_16x16x32_bf16 v[170:173], v[186:189], a[124:127], v[170:173]
ds_read_b128 v[182:185], v210 offset:28672
s_waitcnt lgkmcnt(0)
v_mfma_f32_16x16x32_bf16 v[138:141], a[8:11], v[182:185], v[138:141]
v_mfma_f32_16x16x32_bf16 v[142:145], a[32:35], v[182:185], v[142:145]
v_mfma_f32_16x16x32_bf16 v[146:149], a[56:59], v[182:185], v[146:149]
v_mfma_f32_16x16x32_bf16 v[150:153], a[224:227], v[182:185], v[150:153]
v_mfma_f32_16x16x32_bf16 v[154:157], a[248:251], v[182:185], v[154:157]
v_mfma_f32_16x16x32_bf16 v[158:161], v[240:243], v[182:185], v[158:161]
v_mfma_f32_16x16x32_bf16 v[162:165], v[182:185], a[80:83], v[162:165]
v_mfma_f32_16x16x32_bf16 v[166:169], v[182:185], a[104:107], v[166:169]
v_mfma_f32_16x16x32_bf16 v[170:173], v[182:185], a[128:131], v[170:173]
ds_read_b128 v[186:189], v210 offset:29696
s_waitcnt lgkmcnt(0)
v_mfma_f32_16x16x32_bf16 v[138:141], a[12:15], v[186:189], v[138:141]
v_mfma_f32_16x16x32_bf16 v[142:145], a[36:39], v[186:189], v[142:145]
v_mfma_f32_16x16x32_bf16 v[146:149], a[60:63], v[186:189], v[146:149]
v_mfma_f32_16x16x32_bf16 v[150:153], a[228:231], v[186:189], v[150:153]
v_mfma_f32_16x16x32_bf16 v[154:157], a[252:255], v[186:189], v[154:157]
v_mfma_f32_16x16x32_bf16 v[158:161], v[244:247], v[186:189], v[158:161]
v_mfma_f32_16x16x32_bf16 v[162:165], v[186:189], a[84:87], v[162:165]
v_mfma_f32_16x16x32_bf16 v[166:169], v[186:189], a[108:111], v[166:169]
v_mfma_f32_16x16x32_bf16 v[170:173], v[186:189], a[132:135], v[170:173]
ds_read_b128 v[182:185], v210 offset:30720
s_waitcnt lgkmcnt(0)
v_mfma_f32_16x16x32_bf16 v[138:141], a[16:19], v[182:185], v[138:141]
v_mfma_f32_16x16x32_bf16 v[142:145], a[40:43], v[182:185], v[142:145]
v_mfma_f32_16x16x32_bf16 v[146:149], a[64:67], v[182:185], v[146:149]
v_mfma_f32_16x16x32_bf16 v[150:153], a[232:235], v[182:185], v[150:153]
v_mfma_f32_16x16x32_bf16 v[154:157], v[224:227], v[182:185], v[154:157]
v_mfma_f32_16x16x32_bf16 v[158:161], v[248:251], v[182:185], v[158:161]
v_mfma_f32_16x16x32_bf16 v[162:165], v[182:185], a[88:91], v[162:165]
v_mfma_f32_16x16x32_bf16 v[166:169], v[182:185], a[112:115], v[166:169]
v_mfma_f32_16x16x32_bf16 v[170:173], v[182:185], a[136:139], v[170:173]
ds_read_b128 v[186:189], v210 offset:31744
s_waitcnt lgkmcnt(0)
v_mfma_f32_16x16x32_bf16 v[138:141], a[20:23], v[186:189], v[138:141]
v_mfma_f32_16x16x32_bf16 v[142:145], a[44:47], v[186:189], v[142:145]
v_mfma_f32_16x16x32_bf16 v[146:149], a[68:71], v[186:189], v[146:149]
v_mfma_f32_16x16x32_bf16 v[150:153], a[236:239], v[186:189], v[150:153]
v_mfma_f32_16x16x32_bf16 v[154:157], v[228:231], v[186:189], v[154:157]
v_mfma_f32_16x16x32_bf16 v[158:161], v[252:255], v[186:189], v[158:161]
v_mfma_f32_16x16x32_bf16 v[162:165], v[186:189], a[92:95], v[162:165]
v_mfma_f32_16x16x32_bf16 v[166:169], v[186:189], a[116:119], v[166:169]
v_mfma_f32_16x16x32_bf16 v[170:173], v[186:189], a[140:143], v[170:173]
v_cvt_pk_bf16_f32 v96, v138, v139
v_cvt_pk_bf16_f32 v97, v140, v141
v_cvt_pk_bf16_f32 v98, v142, v143
v_cvt_pk_bf16_f32 v99, v144, v145
v_cvt_pk_bf16_f32 v100, v146, v147
v_cvt_pk_bf16_f32 v101, v148, v149
v_cvt_pk_bf16_f32 v84, v150, v151
v_cvt_pk_bf16_f32 v85, v152, v153
v_cvt_pk_bf16_f32 v86, v154, v155
v_cvt_pk_bf16_f32 v87, v156, v157
v_cvt_pk_bf16_f32 v88, v158, v159
v_cvt_pk_bf16_f32 v89, v160, v161
v_cvt_pk_bf16_f32 v116, v162, v163
v_cvt_pk_bf16_f32 v117, v164, v165
v_cvt_pk_bf16_f32 v124, v166, v167
v_cvt_pk_bf16_f32 v125, v168, v169
v_cvt_pk_bf16_f32 v132, v170, v171
v_cvt_pk_bf16_f32 v133, v172, v173
ds_read_b128 v[182:185], v210 offset:32768
s_waitcnt lgkmcnt(0)
v_mfma_f32_16x16x32_bf16 v[138:141], a[0:3], v[182:185], 0
v_mfma_f32_16x16x32_bf16 v[142:145], a[24:27], v[182:185], 0
v_mfma_f32_16x16x32_bf16 v[146:149], a[48:51], v[182:185], 0
ds_read_b128 v[186:189], v210 offset:33792
s_waitcnt lgkmcnt(0)
v_mfma_f32_16x16x32_bf16 v[138:141], a[4:7], v[186:189], v[138:141]
v_mfma_f32_16x16x32_bf16 v[142:145], a[28:31], v[186:189], v[142:145]
v_mfma_f32_16x16x32_bf16 v[146:149], a[52:55], v[186:189], v[146:149]
ds_read_b128 v[182:185], v210 offset:34816
s_waitcnt lgkmcnt(0)
v_mfma_f32_16x16x32_bf16 v[138:141], a[8:11], v[182:185], v[138:141]
v_mfma_f32_16x16x32_bf16 v[142:145], a[32:35], v[182:185], v[142:145]
v_mfma_f32_16x16x32_bf16 v[146:149], a[56:59], v[182:185], v[146:149]
ds_read_b128 v[186:189], v210 offset:35840
s_waitcnt lgkmcnt(0)
v_mfma_f32_16x16x32_bf16 v[138:141], a[12:15], v[186:189], v[138:141]
v_mfma_f32_16x16x32_bf16 v[142:145], a[36:39], v[186:189], v[142:145]
v_mfma_f32_16x16x32_bf16 v[146:149], a[60:63], v[186:189], v[146:149]
ds_read_b128 v[182:185], v210 offset:36864
s_waitcnt lgkmcnt(0)
v_mfma_f32_16x16x32_bf16 v[138:141], a[16:19], v[182:185], v[138:141]
v_mfma_f32_16x16x32_bf16 v[142:145], a[40:43], v[182:185], v[142:145]
v_mfma_f32_16x16x32_bf16 v[146:149], a[64:67], v[182:185], v[146:149]
ds_read_b128 v[186:189], v210 offset:37888
s_waitcnt lgkmcnt(0)
v_mfma_f32_16x16x32_bf16 v[138:141], a[20:23], v[186:189], v[138:141]
v_mfma_f32_16x16x32_bf16 v[142:145], a[44:47], v[186:189], v[142:145]
v_mfma_f32_16x16x32_bf16 v[146:149], a[68:71], v[186:189], v[146:149]
v_cvt_pk_bf16_f32 v102, v138, v139
v_cvt_pk_bf16_f32 v103, v140, v141
s_nop 0
v_cvt_pk_bf16_f32 v104, v142, v143
v_cvt_pk_bf16_f32 v105, v144, v145
s_nop 1
v_cvt_pk_bf16_f32 v106, v146, v147
v_cvt_pk_bf16_f32 v107, v148, v149
ds_read_b128 v[108:111], v215 offset:512
ds_read_b64 v[112:113], v215 offset:528
v_mov_b32 v181, 0
v_mfma_f32_16x16x16_bf16 v[138:141], v[82:83], v[76:77], 0
v_mfma_f32_16x16x16_bf16 v[142:145], v[100:101], v[76:77], 0
s_waitcnt lgkmcnt(0)
v_mfma_f32_16x16x16_bf16 v[150:153], v[112:113], v[76:77], v[206:209]
v_mfma_f32_16x16x16_bf16 v[146:149], v[106:107], v[76:77], 0
v_mfma_f32_16x16x32_bf16 v[138:141], v[78:81], v[72:75], v[138:141]
v_mfma_f32_16x16x32_bf16 v[142:145], v[96:99], v[72:75], v[142:145]
v_mfma_f32_16x16x32_bf16 v[150:153], v[108:111], v[72:75], v[150:153]
v_mfma_f32_16x16x32_bf16 v[146:149], v[102:105], v[72:75], v[146:149]
ds_read_b128 v[72:75], v215
ds_read_b64 v[76:77], v215 offset:16
v_mfma_f32_16x16x16_bf16 v[154:157], v[82:83], v[88:89], 0
v_mfma_f32_16x16x16_bf16 v[158:161], v[100:101], v[88:89], 0
v_mfma_f32_16x16x16_bf16 v[166:169], v[112:113], v[88:89], v[206:209]
v_mfma_f32_16x16x16_bf16 v[162:165], v[106:107], v[88:89], 0
v_mfma_f32_16x16x32_bf16 v[154:157], v[78:81], v[84:87], v[154:157]
v_mfma_f32_16x16x32_bf16 v[158:161], v[96:99], v[84:87], v[158:161]
v_mfma_f32_16x16x32_bf16 v[166:169], v[108:111], v[84:87], v[166:169]
v_mfma_f32_16x16x32_bf16 v[162:165], v[102:105], v[84:87], v[162:165]
ds_read_b128 v[182:185], v210 offset:32768
s_waitcnt lgkmcnt(0)
v_mfma_f32_16x16x32_bf16 v[118:121], v[182:185], a[72:75], 0
v_mfma_f32_16x16x32_bf16 v[126:129], v[182:185], a[96:99], 0
v_mfma_f32_16x16x32_bf16 v[134:137], v[182:185], a[120:123], 0
v_mfma_f32_16x16x32_bf16 v[90:93], a[216:219], v[182:185], 0
v_mfma_f32_16x16x32_bf16 v[170:173], a[240:243], v[182:185], 0
v_mfma_f32_16x16x32_bf16 v[220:223], v[232:235], v[182:185], 0
ds_read_b128 v[186:189], v210 offset:33792
s_waitcnt lgkmcnt(0)
v_mfma_f32_16x16x32_bf16 v[118:121], v[186:189], a[76:79], v[118:121]
v_mfma_f32_16x16x32_bf16 v[126:129], v[186:189], a[100:103], v[126:129]
v_mfma_f32_16x16x32_bf16 v[134:137], v[186:189], a[124:127], v[134:137]
v_mfma_f32_16x16x32_bf16 v[90:93], a[220:223], v[186:189], v[90:93]
v_mfma_f32_16x16x32_bf16 v[170:173], a[244:247], v[186:189], v[170:173]
v_mfma_f32_16x16x32_bf16 v[220:223], v[236:239], v[186:189], v[220:223]
ds_read_b128 v[182:185], v210 offset:34816
s_waitcnt lgkmcnt(0)
v_mfma_f32_16x16x32_bf16 v[118:121], v[182:185], a[80:83], v[118:121]
v_mfma_f32_16x16x32_bf16 v[126:129], v[182:185], a[104:107], v[126:129]
v_mfma_f32_16x16x32_bf16 v[134:137], v[182:185], a[128:131], v[134:137]
v_mfma_f32_16x16x32_bf16 v[90:93], a[224:227], v[182:185], v[90:93]
v_mfma_f32_16x16x32_bf16 v[170:173], a[248:251], v[182:185], v[170:173]
v_mfma_f32_16x16x32_bf16 v[220:223], v[240:243], v[182:185], v[220:223]
ds_read_b128 v[186:189], v210 offset:35840
s_waitcnt lgkmcnt(0)
v_mfma_f32_16x16x32_bf16 v[118:121], v[186:189], a[84:87], v[118:121]
v_mfma_f32_16x16x32_bf16 v[126:129], v[186:189], a[108:111], v[126:129]
v_mfma_f32_16x16x32_bf16 v[134:137], v[186:189], a[132:135], v[134:137]
v_mfma_f32_16x16x32_bf16 v[90:93], a[228:231], v[186:189], v[90:93]
v_mfma_f32_16x16x32_bf16 v[170:173], a[252:255], v[186:189], v[170:173]
v_mfma_f32_16x16x32_bf16 v[220:223], v[244:247], v[186:189], v[220:223]
ds_read_b128 v[182:185], v210 offset:36864
s_waitcnt lgkmcnt(0)
v_mfma_f32_16x16x32_bf16 v[118:121], v[182:185], a[88:91], v[118:121]
v_mfma_f32_16x16x32_bf16 v[126:129], v[182:185], a[112:115], v[126:129]
v_mfma_f32_16x16x32_bf16 v[134:137], v[182:185], a[136:139], v[134:137]
v_mfma_f32_16x16x32_bf16 v[90:93], a[232:235], v[182:185], v[90:93]
v_mfma_f32_16x16x32_bf16 v[170:173], v[224:227], v[182:185], v[170:173]
v_mfma_f32_16x16x32_bf16 v[220:223], v[248:251], v[182:185], v[220:223]
ds_read_b128 v[186:189], v210 offset:37888
s_waitcnt lgkmcnt(0)
v_mfma_f32_16x16x32_bf16 v[118:121], v[186:189], a[92:95], v[118:121]
v_mfma_f32_16x16x32_bf16 v[126:129], v[186:189], a[116:119], v[126:129]
v_mfma_f32_16x16x32_bf16 v[134:137], v[186:189], a[140:143], v[134:137]
v_mfma_f32_16x16x32_bf16 v[90:93], a[236:239], v[186:189], v[90:93]
v_mfma_f32_16x16x32_bf16 v[170:173], v[228:231], v[186:189], v[170:173]
v_mfma_f32_16x16x32_bf16 v[220:223], v[252:255], v[186:189], v[220:223]
v_cvt_pk_bf16_f32 v118, v118, v119
v_cvt_pk_bf16_f32 v119, v120, v121
ds_read_u16 v120, v214 offset:1024
v_mov_b32 v121, 0
v_cvt_pk_bf16_f32 v126, v126, v127
v_cvt_pk_bf16_f32 v127, v128, v129
ds_read_u16 v128, v214 offset:1032
v_mov_b32 v129, 0
v_cvt_pk_bf16_f32 v134, v134, v135
v_cvt_pk_bf16_f32 v135, v136, v137
ds_read_u16 v136, v214 offset:1040
v_mov_b32 v137, 0
v_cvt_pk_bf16_f32 v90, v90, v91
v_cvt_pk_bf16_f32 v91, v92, v93
v_cvt_pk_bf16_f32 v92, v170, v171
v_cvt_pk_bf16_f32 v93, v172, v173
v_cvt_pk_bf16_f32 v94, v220, v221
v_cvt_pk_bf16_f32 v95, v222, v223
v_max3_f32 v151, v138, v139, v140
v_max3_f32 v151, v151, v141, v142
v_max3_f32 v151, v151, v143, v144
v_max3_f32 v151, v151, v145, v146
v_max3_f32 v151, v151, v147, v148
v_max3_f32 v151, v151, v149, v150
v_mov_b32 v152, v151
s_nop 1
v_permlane16_swap_b32 v151, v152
v_max_f32 v151, v151, v152
v_mov_b32 v152, v151
s_nop 1
v_permlane32_swap_b32 v151, v152
v_max_f32 v151, v151, v152
v_sub_f32 v138, v138, v151
v_sub_f32 v139, v139, v151
v_sub_f32 v140, v140, v151
v_sub_f32 v141, v141, v151
v_sub_f32 v142, v142, v151
v_sub_f32 v143, v143, v151
v_sub_f32 v144, v144, v151
v_sub_f32 v145, v145, v151
v_sub_f32 v150, v150, v151
v_sub_f32 v146, v146, v151
v_sub_f32 v147, v147, v151
v_sub_f32 v148, v148, v151
v_sub_f32 v149, v149, v151
v_exp_f32 v138, v138
v_exp_f32 v139, v139
v_exp_f32 v140, v140
v_exp_f32 v141, v141
v_exp_f32 v142, v142
v_exp_f32 v143, v143
v_exp_f32 v144, v144
v_exp_f32 v145, v145
v_exp_f32 v150, v150
v_exp_f32 v146, v146
v_exp_f32 v147, v147
v_exp_f32 v148, v148
v_exp_f32 v149, v149
v_cvt_pk_bf16_f32 v174, v138, v139
v_cvt_pk_bf16_f32 v175, v140, v141
v_cvt_pk_bf16_f32 v176, v142, v143
v_cvt_pk_bf16_f32 v177, v144, v145
v_cvt_pk_bf16_f32 v178, v146, v147
v_cvt_pk_bf16_f32 v179, v148, v149
v_cvt_pk_bf16_f32 v180, v150, 0
v_mfma_f32_16x16x32_bf16 v[150:153], v[190:193], v[174:177], 0
v_mfma_f32_16x16x32_bf16 v[138:141], v[114:117], v[174:177], 0
v_mfma_f32_16x16x32_bf16 v[142:145], v[122:125], v[174:177], 0
v_mfma_f32_16x16x32_bf16 v[146:149], v[130:133], v[174:177], 0
v_mfma_f32_16x16x32_bf16 v[150:153], v[190:193], v[178:181], v[150:153]
s_waitcnt lgkmcnt(2)
v_mfma_f32_16x16x32_bf16 v[138:141], v[118:121], v[178:181], v[138:141]
s_waitcnt lgkmcnt(1)
v_mfma_f32_16x16x32_bf16 v[142:145], v[126:129], v[178:181], v[142:145]
s_waitcnt lgkmcnt(0)
v_mfma_f32_16x16x32_bf16 v[146:149], v[134:137], v[178:181], v[146:149]
v_max3_f32 v167, v154, v155, v156
v_max3_f32 v167, v167, v157, v158
v_max3_f32 v167, v167, v159, v160
v_max3_f32 v167, v167, v161, v162
v_max3_f32 v167, v167, v163, v164
v_max3_f32 v167, v167, v165, v166
v_mov_b32 v168, v167
s_nop 1
v_permlane16_swap_b32 v167, v168
v_max_f32 v167, v167, v168
v_mov_b32 v168, v167
s_nop 1
v_permlane32_swap_b32 v167, v168
v_max_f32 v167, v167, v168
v_sub_f32 v154, v154, v167
v_sub_f32 v155, v155, v167
v_sub_f32 v156, v156, v167
v_sub_f32 v157, v157, v167
v_sub_f32 v158, v158, v167
v_sub_f32 v159, v159, v167
v_sub_f32 v160, v160, v167
v_sub_f32 v161, v161, v167
v_sub_f32 v166, v166, v167
v_sub_f32 v162, v162, v167
v_sub_f32 v163, v163, v167
v_sub_f32 v164, v164, v167
v_sub_f32 v165, v165, v167
v_exp_f32 v154, v154
v_exp_f32 v155, v155
v_exp_f32 v156, v156
v_exp_f32 v157, v157
v_exp_f32 v158, v158
v_exp_f32 v159, v159
v_exp_f32 v160, v160
v_exp_f32 v161, v161
v_exp_f32 v166, v166
v_exp_f32 v162, v162
v_exp_f32 v163, v163
v_exp_f32 v164, v164
v_exp_f32 v165, v165
v_cvt_pk_bf16_f32 v174, v154, v155
v_cvt_pk_bf16_f32 v175, v156, v157
v_cvt_pk_bf16_f32 v176, v158, v159
v_cvt_pk_bf16_f32 v177, v160, v161
v_cvt_pk_bf16_f32 v178, v162, v163
v_cvt_pk_bf16_f32 v179, v164, v165
v_cvt_pk_bf16_f32 v180, v166, 0
v_mfma_f32_16x16x32_bf16 v[166:169], v[190:193], v[174:177], 0
v_mfma_f32_16x16x32_bf16 v[154:157], v[114:117], v[174:177], 0
v_mfma_f32_16x16x32_bf16 v[158:161], v[122:125], v[174:177], 0
v_mfma_f32_16x16x32_bf16 v[162:165], v[130:133], v[174:177], 0
v_mfma_f32_16x16x32_bf16 v[166:169], v[190:193], v[178:181], v[166:169]
v_mfma_f32_16x16x32_bf16 v[154:157], v[118:121], v[178:181], v[154:157]
v_mfma_f32_16x16x32_bf16 v[158:161], v[126:129], v[178:181], v[158:161]
v_mfma_f32_16x16x32_bf16 v[162:165], v[134:137], v[178:181], v[162:165]
v_rcp_f32 v151, v150
s_nop 0
v_mul_f32 v151, s3, v151
v_mul_f32 v138, v138, v151
v_mul_f32 v139, v139, v151
v_cvt_pk_bf16_f32 v138, v138, v139
v_mul_f32 v140, v140, v151
v_mul_f32 v141, v141, v151
v_cvt_pk_bf16_f32 v139, v140, v141
v_mul_f32 v142, v142, v151
v_mul_f32 v143, v143, v151
v_cvt_pk_bf16_f32 v140, v142, v143
v_mul_f32 v144, v144, v151
v_mul_f32 v145, v145, v151
v_cvt_pk_bf16_f32 v141, v144, v145
ds_write_b128 v211, v[138:141] offset:38912
v_mul_f32 v146, v146, v151
v_mul_f32 v147, v147, v151
v_cvt_pk_bf16_f32 v142, v146, v147
v_mul_f32 v148, v148, v151
v_mul_f32 v149, v149, v151
v_cvt_pk_bf16_f32 v143, v148, v149
ds_write_b64 v212, v[142:143] offset:38912
v_mfma_f32_16x16x32_bf16 v[138:141], v[78:81], v[90:93], 0
v_mfma_f32_16x16x32_bf16 v[142:145], v[96:99], v[90:93], 0
v_mfma_f32_16x16x32_bf16 v[150:153], v[108:111], v[90:93], v[206:209]
v_mfma_f32_16x16x32_bf16 v[146:149], v[102:105], v[90:93], 0
v_mfma_f32_16x16x16_bf16 v[138:141], v[82:83], v[94:95], v[138:141]
v_mfma_f32_16x16x16_bf16 v[142:145], v[100:101], v[94:95], v[142:145]
v_mfma_f32_16x16x16_bf16 v[150:153], v[112:113], v[94:95], v[150:153]
v_mfma_f32_16x16x16_bf16 v[146:149], v[106:107], v[94:95], v[146:149]
v_rcp_f32 v167, v166
s_nop 0
v_mul_f32 v167, s3, v167
v_mul_f32 v154, v154, v167
v_mul_f32 v155, v155, v167
v_cvt_pk_bf16_f32 v154, v154, v155
v_mul_f32 v156, v156, v167
v_mul_f32 v157, v157, v167
v_cvt_pk_bf16_f32 v155, v156, v157
v_mul_f32 v158, v158, v167
v_mul_f32 v159, v159, v167
v_cvt_pk_bf16_f32 v156, v158, v159
v_mul_f32 v160, v160, v167
v_mul_f32 v161, v161, v167
v_cvt_pk_bf16_f32 v157, v160, v161
ds_write_b128 v211, v[154:157] offset:45056
v_mul_f32 v162, v162, v167
v_mul_f32 v163, v163, v167
v_cvt_pk_bf16_f32 v158, v162, v163
v_mul_f32 v164, v164, v167
v_mul_f32 v165, v165, v167
v_cvt_pk_bf16_f32 v159, v164, v165
ds_write_b64 v212, v[158:159] offset:45056
v_mfma_f32_16x16x16_bf16 v[154:157], v[76:77], v[82:83], 0
v_mfma_f32_16x16x16_bf16 v[158:161], v[76:77], v[100:101], 0
v_mfma_f32_16x16x16_bf16 v[162:165], v[76:77], v[106:107], 0
v_mfma_f32_16x16x16_bf16 v[166:169], v[76:77], v[112:113], v[206:209]
v_mfma_f32_16x16x32_bf16 v[154:157], v[72:75], v[78:81], v[154:157]
v_mfma_f32_16x16x32_bf16 v[158:161], v[72:75], v[96:99], v[158:161]
v_mfma_f32_16x16x32_bf16 v[162:165], v[72:75], v[102:105], v[162:165]
v_mfma_f32_16x16x32_bf16 v[166:169], v[72:75], v[108:111], v[166:169]
v_mov_b32_dpp v154, v158 quad_perm:[0,1,2,3] row_mask:0x2 bank_mask:0xf
s_nop 1
v_mov_b32_dpp v154, v162 quad_perm:[0,1,2,3] row_mask:0x4 bank_mask:0xf
s_nop 2
v_mov_b32_dpp v154, v167 quad_perm:[0,1,2,3] row_mask:0x8 bank_mask:0xf
v_mov_b32 v155, v154
s_nop 1
v_max_f32_dpp v155, v155, v155 row_ror:8 row_mask:0xf bank_mask:0xf
s_nop 1
v_max_f32_dpp v155, v155, v155 row_ror:4 row_mask:0xf bank_mask:0xf
s_nop 1
v_max_f32_dpp v155, v155, v155 row_ror:2 row_mask:0xf bank_mask:0xf
s_nop 1
v_max_f32_dpp v155, v155, v155 row_ror:1 row_mask:0xf bank_mask:0xf
v_mov_b32 v156, v155
s_nop 1
v_permlane16_swap_b32 v155, v156
v_max_f32 v155, v155, v156
v_mov_b32 v156, v155
s_nop 1
v_permlane32_swap_b32 v155, v156
v_max_f32 v155, v155, v156
v_sub_f32 v154, v154, v155
v_exp_f32 v154, v154
s_nop 0
v_cvt_pk_bf16_f32 v154, v154, 0
ds_write_b16 v214, v154
s_waitcnt lgkmcnt(1)
ds_read_b128 v[84:87], v215
ds_read_b128 v[88:91], v215 offset:16
v_add_u32 v215, 1552, v215
s_barrier
ds_read_b128 v[170:173], v210 offset:38912
s_waitcnt lgkmcnt(0)
v_mfma_f32_16x16x32_bf16 v[36:39], a[144:147], v[170:173], v[36:39]
v_mfma_f32_16x16x32_bf16 v[40:43], a[168:171], v[170:173], v[40:43]
v_mfma_f32_16x16x32_bf16 v[44:47], a[192:195], v[170:173], v[44:47]
ds_read_b128 v[182:185], v210 offset:39936
s_waitcnt lgkmcnt(0)
v_mfma_f32_16x16x32_bf16 v[36:39], a[148:151], v[182:185], v[36:39]
v_mfma_f32_16x16x32_bf16 v[40:43], a[172:175], v[182:185], v[40:43]
v_mfma_f32_16x16x32_bf16 v[44:47], a[196:199], v[182:185], v[44:47]
ds_read_b128 v[186:189], v210 offset:40960
s_waitcnt lgkmcnt(0)
v_mfma_f32_16x16x32_bf16 v[36:39], a[152:155], v[186:189], v[36:39]
v_mfma_f32_16x16x32_bf16 v[40:43], a[176:179], v[186:189], v[40:43]
v_mfma_f32_16x16x32_bf16 v[44:47], a[200:203], v[186:189], v[44:47]
ds_read_b128 v[170:173], v210 offset:41984
s_waitcnt lgkmcnt(0)
v_mfma_f32_16x16x32_bf16 v[36:39], a[156:159], v[170:173], v[36:39]
v_mfma_f32_16x16x32_bf16 v[40:43], a[180:183], v[170:173], v[40:43]
v_mfma_f32_16x16x32_bf16 v[44:47], a[204:207], v[170:173], v[44:47]
ds_read_b128 v[182:185], v210 offset:43008
s_waitcnt lgkmcnt(0)
v_mfma_f32_16x16x32_bf16 v[36:39], a[160:163], v[182:185], v[36:39]
v_mfma_f32_16x16x32_bf16 v[40:43], a[184:187], v[182:185], v[40:43]
v_mfma_f32_16x16x32_bf16 v[44:47], a[208:211], v[182:185], v[44:47]
ds_read_b128 v[186:189], v210 offset:44032
s_waitcnt lgkmcnt(0)
v_mfma_f32_16x16x32_bf16 v[36:39], a[164:167], v[186:189], v[36:39]
v_mfma_f32_16x16x32_bf16 v[40:43], a[188:191], v[186:189], v[40:43]
v_mfma_f32_16x16x32_bf16 v[44:47], a[212:215], v[186:189], v[44:47]
v_cvt_pk_bf16_f32 v72, v36, v37
v_cvt_pk_bf16_f32 v73, v38, v39
buffer_store_dwordx2 v[72:73], v203, s[8:11], s39 offen
v_cvt_pk_bf16_f32 v74, v40, v41
v_cvt_pk_bf16_f32 v75, v42, v43
buffer_store_dwordx2 v[74:75], v203, s[8:11], s39 offen offset:32
s_nop 0
v_cvt_pk_bf16_f32 v76, v44, v45
v_cvt_pk_bf16_f32 v77, v46, v47
buffer_store_dwordx2 v[76:77], v203, s[8:11], s39 offen offset:64
v_max3_f32 v151, v138, v139, v140
v_max3_f32 v151, v151, v141, v142
v_max3_f32 v151, v151, v143, v144
v_max3_f32 v151, v151, v145, v146
v_max3_f32 v151, v151, v147, v148
v_max3_f32 v151, v151, v149, v150
v_mov_b32 v152, v151
s_nop 1
v_permlane16_swap_b32 v151, v152
v_max_f32 v151, v151, v152
v_mov_b32 v152, v151
s_nop 1
v_permlane32_swap_b32 v151, v152
v_max_f32 v151, v151, v152
v_sub_f32 v138, v138, v151
v_sub_f32 v139, v139, v151
v_sub_f32 v140, v140, v151
v_sub_f32 v141, v141, v151
v_sub_f32 v142, v142, v151
v_sub_f32 v143, v143, v151
v_sub_f32 v144, v144, v151
v_sub_f32 v145, v145, v151
v_sub_f32 v150, v150, v151
v_sub_f32 v146, v146, v151
v_sub_f32 v147, v147, v151
v_sub_f32 v148, v148, v151
v_sub_f32 v149, v149, v151
v_exp_f32 v138, v138
v_exp_f32 v139, v139
v_exp_f32 v140, v140
v_exp_f32 v141, v141
v_exp_f32 v142, v142
v_exp_f32 v143, v143
v_exp_f32 v144, v144
v_exp_f32 v145, v145
v_exp_f32 v150, v150
v_exp_f32 v146, v146
v_exp_f32 v147, v147
v_exp_f32 v148, v148
v_exp_f32 v149, v149
v_cvt_pk_bf16_f32 v174, v138, v139
v_cvt_pk_bf16_f32 v175, v140, v141
v_cvt_pk_bf16_f32 v176, v142, v143
v_cvt_pk_bf16_f32 v177, v144, v145
v_cvt_pk_bf16_f32 v178, v146, v147
v_cvt_pk_bf16_f32 v179, v148, v149
v_cvt_pk_bf16_f32 v180, v150, 0
v_mfma_f32_16x16x32_bf16 v[150:153], v[190:193], v[174:177], 0
v_mfma_f32_16x16x32_bf16 v[138:141], v[114:117], v[174:177], 0
v_mfma_f32_16x16x32_bf16 v[142:145], v[122:125], v[174:177], 0
v_mfma_f32_16x16x32_bf16 v[146:149], v[130:133], v[174:177], 0
v_mfma_f32_16x16x32_bf16 v[150:153], v[190:193], v[178:181], v[150:153]
v_mfma_f32_16x16x32_bf16 v[138:141], v[118:121], v[178:181], v[138:141]
v_mfma_f32_16x16x32_bf16 v[142:145], v[126:129], v[178:181], v[142:145]
v_mfma_f32_16x16x32_bf16 v[146:149], v[134:137], v[178:181], v[146:149]
v_mfma_f32_16x16x32_bf16 v[166:169], v[84:87], v[190:193], 0
v_mfma_f32_16x16x32_bf16 v[154:157], v[84:87], v[114:117], 0
v_mfma_f32_16x16x32_bf16 v[158:161], v[84:87], v[122:125], 0
v_mfma_f32_16x16x32_bf16 v[162:165], v[84:87], v[130:133], 0
v_mfma_f32_16x16x32_bf16 v[166:169], v[88:91], v[190:193], v[166:169]
v_mfma_f32_16x16x32_bf16 v[154:157], v[88:91], v[118:121], v[154:157]
v_mfma_f32_16x16x32_bf16 v[158:161], v[88:91], v[126:129], v[158:161]
v_mfma_f32_16x16x32_bf16 v[162:165], v[88:91], v[134:137], v[162:165]
v_rcp_f32 v167, v166
s_nop 1
v_mov_b32_dpp v154, v158 quad_perm:[0,1,2,3] row_mask:0x2 bank_mask:0xf
s_nop 2
v_mov_b32_dpp v154, v162 quad_perm:[0,1,2,3] row_mask:0x4 bank_mask:0xf
v_mul_f32 v167, s3, v167
v_mul_f32 v154, v154, v167
v_cvt_pk_bf16_f32 v154, v154, 0
ds_write_b16 v214, v154
v_add_u32 v214, 1552, v214
ds_read_b128 v[170:173], v210 offset:45056
s_waitcnt lgkmcnt(0)
v_mfma_f32_16x16x32_bf16 v[48:51], a[144:147], v[170:173], v[48:51]
v_mfma_f32_16x16x32_bf16 v[52:55], a[168:171], v[170:173], v[52:55]
v_mfma_f32_16x16x32_bf16 v[56:59], a[192:195], v[170:173], v[56:59]
ds_read_b128 v[182:185], v210 offset:46080
s_waitcnt lgkmcnt(0)
v_mfma_f32_16x16x32_bf16 v[48:51], a[148:151], v[182:185], v[48:51]
v_mfma_f32_16x16x32_bf16 v[52:55], a[172:175], v[182:185], v[52:55]
v_mfma_f32_16x16x32_bf16 v[56:59], a[196:199], v[182:185], v[56:59]
ds_read_b128 v[186:189], v210 offset:47104
s_waitcnt lgkmcnt(0)
v_mfma_f32_16x16x32_bf16 v[48:51], a[152:155], v[186:189], v[48:51]
v_mfma_f32_16x16x32_bf16 v[52:55], a[176:179], v[186:189], v[52:55]
v_mfma_f32_16x16x32_bf16 v[56:59], a[200:203], v[186:189], v[56:59]
ds_read_b128 v[170:173], v210 offset:48128
s_waitcnt lgkmcnt(0)
v_mfma_f32_16x16x32_bf16 v[48:51], a[156:159], v[170:173], v[48:51]
v_mfma_f32_16x16x32_bf16 v[52:55], a[180:183], v[170:173], v[52:55]
v_mfma_f32_16x16x32_bf16 v[56:59], a[204:207], v[170:173], v[56:59]
ds_read_b128 v[182:185], v210 offset:49152
s_waitcnt lgkmcnt(0)
v_mfma_f32_16x16x32_bf16 v[48:51], a[160:163], v[182:185], v[48:51]
v_mfma_f32_16x16x32_bf16 v[52:55], a[184:187], v[182:185], v[52:55]
v_mfma_f32_16x16x32_bf16 v[56:59], a[208:211], v[182:185], v[56:59]
ds_read_b128 v[186:189], v210 offset:50176
s_waitcnt lgkmcnt(0)
v_mfma_f32_16x16x32_bf16 v[48:51], a[164:167], v[186:189], v[48:51]
v_mfma_f32_16x16x32_bf16 v[52:55], a[188:191], v[186:189], v[52:55]
v_mfma_f32_16x16x32_bf16 v[56:59], a[212:215], v[186:189], v[56:59]
v_cvt_pk_bf16_f32 v78, v48, v49
v_cvt_pk_bf16_f32 v79, v50, v51
buffer_store_dwordx2 v[78:79], v204, s[8:11], s39 offen
v_cvt_pk_bf16_f32 v80, v52, v53
v_cvt_pk_bf16_f32 v81, v54, v55
buffer_store_dwordx2 v[80:81], v204, s[8:11], s39 offen offset:32
s_nop 0
v_cvt_pk_bf16_f32 v82, v56, v57
v_cvt_pk_bf16_f32 v83, v58, v59
buffer_store_dwordx2 v[82:83], v204, s[8:11], s39 offen offset:64
v_rcp_f32 v151, v150
s_nop 0
v_mul_f32 v151, s3, v151
v_mul_f32 v138, v138, v151
v_mul_f32 v139, v139, v151
v_cvt_pk_bf16_f32 v138, v138, v139
v_mul_f32 v140, v140, v151
v_mul_f32 v141, v141, v151
v_cvt_pk_bf16_f32 v139, v140, v141
v_mul_f32 v142, v142, v151
v_mul_f32 v143, v143, v151
v_cvt_pk_bf16_f32 v140, v142, v143
v_mul_f32 v144, v144, v151
v_mul_f32 v145, v145, v151
v_cvt_pk_bf16_f32 v141, v144, v145
ds_write_b128 v211, v[138:141] offset:51200
v_mul_f32 v146, v146, v151
v_mul_f32 v147, v147, v151
v_cvt_pk_bf16_f32 v142, v146, v147
v_mul_f32 v148, v148, v151
v_mul_f32 v149, v149, v151
v_cvt_pk_bf16_f32 v143, v148, v149
ds_write_b64 v212, v[142:143] offset:51200
s_waitcnt lgkmcnt(0)
s_barrier
ds_read_b128 v[170:173], v210 offset:51200
s_waitcnt lgkmcnt(0)
v_mfma_f32_16x16x32_bf16 v[60:63], a[144:147], v[170:173], v[60:63]
v_mfma_f32_16x16x32_bf16 v[64:67], a[168:171], v[170:173], v[64:67]
v_mfma_f32_16x16x32_bf16 v[68:71], a[192:195], v[170:173], v[68:71]
ds_read_b128 v[182:185], v210 offset:52224
s_waitcnt lgkmcnt(0)
v_mfma_f32_16x16x32_bf16 v[60:63], a[148:151], v[182:185], v[60:63]
v_mfma_f32_16x16x32_bf16 v[64:67], a[172:175], v[182:185], v[64:67]
v_mfma_f32_16x16x32_bf16 v[68:71], a[196:199], v[182:185], v[68:71]
ds_read_b128 v[186:189], v210 offset:53248
s_waitcnt lgkmcnt(0)
v_mfma_f32_16x16x32_bf16 v[60:63], a[152:155], v[186:189], v[60:63]
v_mfma_f32_16x16x32_bf16 v[64:67], a[176:179], v[186:189], v[64:67]
v_mfma_f32_16x16x32_bf16 v[68:71], a[200:203], v[186:189], v[68:71]
ds_read_b128 v[170:173], v210 offset:54272
s_waitcnt lgkmcnt(0)
v_mfma_f32_16x16x32_bf16 v[60:63], a[156:159], v[170:173], v[60:63]
v_mfma_f32_16x16x32_bf16 v[64:67], a[180:183], v[170:173], v[64:67]
v_mfma_f32_16x16x32_bf16 v[68:71], a[204:207], v[170:173], v[68:71]
ds_read_b128 v[182:185], v210 offset:55296
s_waitcnt lgkmcnt(0)
v_mfma_f32_16x16x32_bf16 v[60:63], a[160:163], v[182:185], v[60:63]
v_mfma_f32_16x16x32_bf16 v[64:67], a[184:187], v[182:185], v[64:67]
v_mfma_f32_16x16x32_bf16 v[68:71], a[208:211], v[182:185], v[68:71]
ds_read_b128 v[186:189], v210 offset:56320
s_waitcnt lgkmcnt(0)
v_mfma_f32_16x16x32_bf16 v[60:63], a[164:167], v[186:189], v[60:63]
v_mfma_f32_16x16x32_bf16 v[64:67], a[188:191], v[186:189], v[64:67]
v_mfma_f32_16x16x32_bf16 v[68:71], a[212:215], v[186:189], v[68:71]
v_cvt_pk_bf16_f32 v116, v60, v61
v_cvt_pk_bf16_f32 v117, v62, v63
buffer_store_dwordx2 v[116:117], v205, s[8:11], s39 offen
v_cvt_pk_bf16_f32 v124, v64, v65
v_cvt_pk_bf16_f32 v125, v66, v67
buffer_store_dwordx2 v[124:125], v205, s[8:11], s39 offen offset:32
s_nop 0
v_cvt_pk_bf16_f32 v132, v68, v69
v_cvt_pk_bf16_f32 v133, v70, v71
buffer_store_dwordx2 v[132:133], v205, s[8:11], s39 offen offset:64
v_subrev_u32 v60, 37120, v210
v_lshrrev_b32 v61, 4, v60
v_and_b32 v61, 15, v61
v_lshrrev_b32 v62, 8, v60
v_mul_u32_u24 v63, 1552, v61
v_lshl_add_u32 v63, v62, 5, v63
v_add_u32 v63, 94464, v63
v_mul_u32_u24 v64, 784, v61
v_lshl_add_u32 v64, v62, 4, v64
s_mul_i32 s41, s32, 192
s_add_u32 s41, s41, 127056
v_add_u32 v64, s41, v64
ds_read_b128 v[36:39], v64
ds_read_b128 v[40:43], v64 offset:64
ds_read_b128 v[44:47], v64 offset:128
v_lshlrev_b32 v67, 5, v61
s_add_u32 s41, s33, 0
v_add_u32 v67, s41, v67
s_mov_b32 s42, 58835169
v_mul_hi_u32 v68, v67, s42
v_mul_u32_u24 v65, 73, v68
v_sub_u32 v65, v67, v65
v_mul_u32_u24 v65, 2688, v65
s_mov_b32 s42, 1373568
v_mul_lo_u32 v68, v68, s42
s_mul_i32 s42, s32, 96
v_add3_u32 v65, v65, v68, s42
v_cmp_gt_u32 vcc, s34, v67
v_mov_b32 v68, 1879048192
s_nop 0
v_cndmask_b32 v65, v68, v65, vcc
v_lshl_add_u32 v65, v62, 3, v65
v_add_u32 v65, 785664, v65
ds_read_b128 v[48:51], v64 offset:12544
ds_read_b128 v[52:55], v64 offset:12608
ds_read_b128 v[56:59], v64 offset:12672
v_lshlrev_b32 v67, 5, v61
s_add_u32 s41, s33, 512
v_add_u32 v67, s41, v67
s_mov_b32 s42, 58835169
v_mul_hi_u32 v68, v67, s42
v_mul_u32_u24 v66, 73, v68
v_sub_u32 v66, v67, v66
v_mul_u32_u24 v66, 2688, v66
s_mov_b32 s42, 1373568
v_mul_lo_u32 v68, v68, s42
s_mul_i32 s42, s32, 96
v_add3_u32 v66, v66, v68, s42
v_cmp_gt_u32 vcc, s34, v67
v_mov_b32 v68, 1879048192
s_nop 0
v_cndmask_b32 v66, v68, v66, vcc
v_lshl_add_u32 v66, v62, 3, v66
v_add_u32 v66, 785664, v66
ds_read_b128 v[84:87], v63
ds_read_b128 v[88:91], v63 offset:128
ds_read_b128 v[92:95], v63 offset:256
ds_read_b128 v[96:99], v63 offset:384
ds_read_b64 v[100:101], v63 offset:16
ds_read_b64 v[102:103], v63 offset:144
ds_read_b64 v[104:105], v63 offset:272
ds_read_b64 v[106:107], v63 offset:400
s_waitcnt lgkmcnt(7)
v_mfma_f32_16x16x32_bf16 v[36:39], a[144:147], v[84:87], v[36:39]
s_waitcnt lgkmcnt(6)
v_mfma_f32_16x16x32_bf16 v[36:39], a[148:151], v[88:91], v[36:39]
s_waitcnt lgkmcnt(5)
v_mfma_f32_16x16x32_bf16 v[36:39], a[152:155], v[92:95], v[36:39]
s_waitcnt lgkmcnt(4)
v_mfma_f32_16x16x32_bf16 v[36:39], a[156:159], v[96:99], v[36:39]
s_waitcnt lgkmcnt(2)
v_mfma_f32_16x16x32_bf16 v[36:39], a[160:163], v[100:103], v[36:39]
s_waitcnt lgkmcnt(0)
v_mfma_f32_16x16x32_bf16 v[36:39], a[164:167], v[104:107], v[36:39]
s_nop 7
v_cvt_pk_bf16_f32 v36, v36, v37
v_cvt_pk_bf16_f32 v37, v38, v39
buffer_store_dwordx2 v[36:37], v65, s[8:11], 0 offen
v_mfma_f32_16x16x32_bf16 v[40:43], a[168:171], v[84:87], v[40:43]
v_mfma_f32_16x16x32_bf16 v[40:43], a[172:175], v[88:91], v[40:43]
v_mfma_f32_16x16x32_bf16 v[40:43], a[176:179], v[92:95], v[40:43]
v_mfma_f32_16x16x32_bf16 v[40:43], a[180:183], v[96:99], v[40:43]
v_mfma_f32_16x16x32_bf16 v[40:43], a[184:187], v[100:103], v[40:43]
v_mfma_f32_16x16x32_bf16 v[40:43], a[188:191], v[104:107], v[40:43]
s_nop 7
v_cvt_pk_bf16_f32 v40, v40, v41
v_cvt_pk_bf16_f32 v41, v42, v43
buffer_store_dwordx2 v[40:41], v65, s[8:11], 0 offen offset:32
v_mfma_f32_16x16x32_bf16 v[44:47], a[192:195], v[84:87], v[44:47]
v_mfma_f32_16x16x32_bf16 v[44:47], a[196:199], v[88:91], v[44:47]
v_mfma_f32_16x16x32_bf16 v[44:47], a[200:203], v[92:95], v[44:47]
v_mfma_f32_16x16x32_bf16 v[44:47], a[204:207], v[96:99], v[44:47]
v_mfma_f32_16x16x32_bf16 v[44:47], a[208:211], v[100:103], v[44:47]
v_mfma_f32_16x16x32_bf16 v[44:47], a[212:215], v[104:107], v[44:47]
s_nop 7
v_cvt_pk_bf16_f32 v44, v44, v45
v_cvt_pk_bf16_f32 v45, v46, v47
buffer_store_dwordx2 v[44:45], v65, s[8:11], 0 offen offset:64
s_mov_b32 s38, s36
s_barrier
ds_read_b128 v[182:185], v210
s_waitcnt lgkmcnt(0)
v_mfma_f32_16x16x32_bf16 v[138:141], a[0:3], v[182:185], 0
v_mfma_f32_16x16x32_bf16 v[142:145], a[24:27], v[182:185], 0
v_mfma_f32_16x16x32_bf16 v[146:149], a[48:51], v[182:185], 0
v_mfma_f32_16x16x32_bf16 v[150:153], a[216:219], v[182:185], 0
v_mfma_f32_16x16x32_bf16 v[154:157], a[240:243], v[182:185], 0
v_mfma_f32_16x16x32_bf16 v[158:161], v[232:235], v[182:185], 0
v_mfma_f32_16x16x32_bf16 v[162:165], v[182:185], a[72:75], 0
v_mfma_f32_16x16x32_bf16 v[166:169], v[182:185], a[96:99], 0
v_mfma_f32_16x16x32_bf16 v[170:173], v[182:185], a[120:123], 0
ds_read_b128 v[186:189], v210 offset:1024
s_waitcnt lgkmcnt(0)
v_mfma_f32_16x16x32_bf16 v[138:141], a[4:7], v[186:189], v[138:141]
v_mfma_f32_16x16x32_bf16 v[142:145], a[28:31], v[186:189], v[142:145]
v_mfma_f32_16x16x32_bf16 v[146:149], a[52:55], v[186:189], v[146:149]
v_mfma_f32_16x16x32_bf16 v[150:153], a[220:223], v[186:189], v[150:153]
v_mfma_f32_16x16x32_bf16 v[154:157], a[244:247], v[186:189], v[154:157]
v_mfma_f32_16x16x32_bf16 v[158:161], v[236:239], v[186:189], v[158:161]
v_mfma_f32_16x16x32_bf16 v[162:165], v[186:189], a[76:79], v[162:165]
v_mfma_f32_16x16x32_bf16 v[166:169], v[186:189], a[100:103], v[166:169]
v_mfma_f32_16x16x32_bf16 v[170:173], v[186:189], a[124:127], v[170:173]
ds_read_b128 v[182:185], v210 offset:2048
s_waitcnt lgkmcnt(0)
v_mfma_f32_16x16x32_bf16 v[138:141], a[8:11], v[182:185], v[138:141]
v_mfma_f32_16x16x32_bf16 v[142:145], a[32:35], v[182:185], v[142:145]
v_mfma_f32_16x16x32_bf16 v[146:149], a[56:59], v[182:185], v[146:149]
v_mfma_f32_16x16x32_bf16 v[150:153], a[224:227], v[182:185], v[150:153]
v_mfma_f32_16x16x32_bf16 v[154:157], a[248:251], v[182:185], v[154:157]
v_mfma_f32_16x16x32_bf16 v[158:161], v[240:243], v[182:185], v[158:161]
v_mfma_f32_16x16x32_bf16 v[162:165], v[182:185], a[80:83], v[162:165]
v_mfma_f32_16x16x32_bf16 v[166:169], v[182:185], a[104:107], v[166:169]
v_mfma_f32_16x16x32_bf16 v[170:173], v[182:185], a[128:131], v[170:173]
ds_read_b128 v[186:189], v210 offset:3072
s_waitcnt lgkmcnt(0)
v_mfma_f32_16x16x32_bf16 v[138:141], a[12:15], v[186:189], v[138:141]
v_mfma_f32_16x16x32_bf16 v[142:145], a[36:39], v[186:189], v[142:145]
v_mfma_f32_16x16x32_bf16 v[146:149], a[60:63], v[186:189], v[146:149]
v_mfma_f32_16x16x32_bf16 v[150:153], a[228:231], v[186:189], v[150:153]
v_mfma_f32_16x16x32_bf16 v[154:157], a[252:255], v[186:189], v[154:157]
v_mfma_f32_16x16x32_bf16 v[158:161], v[244:247], v[186:189], v[158:161]
v_mfma_f32_16x16x32_bf16 v[162:165], v[186:189], a[84:87], v[162:165]
v_mfma_f32_16x16x32_bf16 v[166:169], v[186:189], a[108:111], v[166:169]
v_mfma_f32_16x16x32_bf16 v[170:173], v[186:189], a[132:135], v[170:173]
ds_read_b128 v[182:185], v210 offset:4096
s_waitcnt lgkmcnt(0)
v_mfma_f32_16x16x32_bf16 v[138:141], a[16:19], v[182:185], v[138:141]
v_mfma_f32_16x16x32_bf16 v[142:145], a[40:43], v[182:185], v[142:145]
v_mfma_f32_16x16x32_bf16 v[146:149], a[64:67], v[182:185], v[146:149]
v_mfma_f32_16x16x32_bf16 v[150:153], a[232:235], v[182:185], v[150:153]
v_mfma_f32_16x16x32_bf16 v[154:157], v[224:227], v[182:185], v[154:157]
v_mfma_f32_16x16x32_bf16 v[158:161], v[248:251], v[182:185], v[158:161]
v_mfma_f32_16x16x32_bf16 v[162:165], v[182:185], a[88:91], v[162:165]
v_mfma_f32_16x16x32_bf16 v[166:169], v[182:185], a[112:115], v[166:169]
v_mfma_f32_16x16x32_bf16 v[170:173], v[182:185], a[136:139], v[170:173]
ds_read_b128 v[186:189], v210 offset:5120
s_waitcnt lgkmcnt(0)
v_mfma_f32_16x16x32_bf16 v[138:141], a[20:23], v[186:189], v[138:141]
v_mfma_f32_16x16x32_bf16 v[142:145], a[44:47], v[186:189], v[142:145]
v_mfma_f32_16x16x32_bf16 v[146:149], a[68:71], v[186:189], v[146:149]
v_mfma_f32_16x16x32_bf16 v[150:153], a[236:239], v[186:189], v[150:153]
v_mfma_f32_16x16x32_bf16 v[154:157], v[228:231], v[186:189], v[154:157]
v_mfma_f32_16x16x32_bf16 v[158:161], v[252:255], v[186:189], v[158:161]
v_mfma_f32_16x16x32_bf16 v[162:165], v[186:189], a[92:95], v[162:165]
v_mfma_f32_16x16x32_bf16 v[166:169], v[186:189], a[116:119], v[166:169]
v_mfma_f32_16x16x32_bf16 v[170:173], v[186:189], a[140:143], v[170:173]
v_cvt_pk_bf16_f32 v78, v138, v139
v_cvt_pk_bf16_f32 v79, v140, v141
v_cvt_pk_bf16_f32 v80, v142, v143
v_cvt_pk_bf16_f32 v81, v144, v145
v_cvt_pk_bf16_f32 v82, v146, v147
v_cvt_pk_bf16_f32 v83, v148, v149
v_cvt_pk_bf16_f32 v72, v150, v151
v_cvt_pk_bf16_f32 v73, v152, v153
v_cvt_pk_bf16_f32 v74, v154, v155
v_cvt_pk_bf16_f32 v75, v156, v157
v_cvt_pk_bf16_f32 v76, v158, v159
v_cvt_pk_bf16_f32 v77, v160, v161
v_cvt_pk_bf16_f32 v114, v162, v163
v_cvt_pk_bf16_f32 v115, v164, v165
v_cvt_pk_bf16_f32 v122, v166, v167
v_cvt_pk_bf16_f32 v123, v168, v169
v_cvt_pk_bf16_f32 v130, v170, v171
v_cvt_pk_bf16_f32 v131, v172, v173
ds_read_b128 v[182:185], v210 offset:6144
s_waitcnt lgkmcnt(0)
v_mfma_f32_16x16x32_bf16 v[138:141], a[0:3], v[182:185], 0
v_mfma_f32_16x16x32_bf16 v[142:145], a[24:27], v[182:185], 0
v_mfma_f32_16x16x32_bf16 v[146:149], a[48:51], v[182:185], 0
v_mfma_f32_16x16x32_bf16 v[150:153], a[216:219], v[182:185], 0
v_mfma_f32_16x16x32_bf16 v[154:157], a[240:243], v[182:185], 0
v_mfma_f32_16x16x32_bf16 v[158:161], v[232:235], v[182:185], 0
v_mfma_f32_16x16x32_bf16 v[162:165], v[182:185], a[72:75], 0
v_mfma_f32_16x16x32_bf16 v[166:169], v[182:185], a[96:99], 0
v_mfma_f32_16x16x32_bf16 v[170:173], v[182:185], a[120:123], 0
ds_read_b128 v[186:189], v210 offset:7168
s_waitcnt lgkmcnt(0)
v_mfma_f32_16x16x32_bf16 v[138:141], a[4:7], v[186:189], v[138:141]
v_mfma_f32_16x16x32_bf16 v[142:145], a[28:31], v[186:189], v[142:145]
v_mfma_f32_16x16x32_bf16 v[146:149], a[52:55], v[186:189], v[146:149]
v_mfma_f32_16x16x32_bf16 v[150:153], a[220:223], v[186:189], v[150:153]
v_mfma_f32_16x16x32_bf16 v[154:157], a[244:247], v[186:189], v[154:157]
v_mfma_f32_16x16x32_bf16 v[158:161], v[236:239], v[186:189], v[158:161]
v_mfma_f32_16x16x32_bf16 v[162:165], v[186:189], a[76:79], v[162:165]
v_mfma_f32_16x16x32_bf16 v[166:169], v[186:189], a[100:103], v[166:169]
v_mfma_f32_16x16x32_bf16 v[170:173], v[186:189], a[124:127], v[170:173]
ds_read_b128 v[182:185], v210 offset:8192
s_waitcnt lgkmcnt(0)
v_mfma_f32_16x16x32_bf16 v[138:141], a[8:11], v[182:185], v[138:141]
v_mfma_f32_16x16x32_bf16 v[142:145], a[32:35], v[182:185], v[142:145]
v_mfma_f32_16x16x32_bf16 v[146:149], a[56:59], v[182:185], v[146:149]
v_mfma_f32_16x16x32_bf16 v[150:153], a[224:227], v[182:185], v[150:153]
v_mfma_f32_16x16x32_bf16 v[154:157], a[248:251], v[182:185], v[154:157]
v_mfma_f32_16x16x32_bf16 v[158:161], v[240:243], v[182:185], v[158:161]
v_mfma_f32_16x16x32_bf16 v[162:165], v[182:185], a[80:83], v[162:165]
v_mfma_f32_16x16x32_bf16 v[166:169], v[182:185], a[104:107], v[166:169]
v_mfma_f32_16x16x32_bf16 v[170:173], v[182:185], a[128:131], v[170:173]
ds_read_b128 v[186:189], v210 offset:9216
s_waitcnt lgkmcnt(0)
v_mfma_f32_16x16x32_bf16 v[138:141], a[12:15], v[186:189], v[138:141]
v_mfma_f32_16x16x32_bf16 v[142:145], a[36:39], v[186:189], v[142:145]
v_mfma_f32_16x16x32_bf16 v[146:149], a[60:63], v[186:189], v[146:149]
v_mfma_f32_16x16x32_bf16 v[150:153], a[228:231], v[186:189], v[150:153]
v_mfma_f32_16x16x32_bf16 v[154:157], a[252:255], v[186:189], v[154:157]
v_mfma_f32_16x16x32_bf16 v[158:161], v[244:247], v[186:189], v[158:161]
v_mfma_f32_16x16x32_bf16 v[162:165], v[186:189], a[84:87], v[162:165]
v_mfma_f32_16x16x32_bf16 v[166:169], v[186:189], a[108:111], v[166:169]
v_mfma_f32_16x16x32_bf16 v[170:173], v[186:189], a[132:135], v[170:173]
ds_read_b128 v[182:185], v210 offset:10240
s_waitcnt lgkmcnt(0)
v_mfma_f32_16x16x32_bf16 v[138:141], a[16:19], v[182:185], v[138:141]
v_mfma_f32_16x16x32_bf16 v[142:145], a[40:43], v[182:185], v[142:145]
v_mfma_f32_16x16x32_bf16 v[146:149], a[64:67], v[182:185], v[146:149]
v_mfma_f32_16x16x32_bf16 v[150:153], a[232:235], v[182:185], v[150:153]
v_mfma_f32_16x16x32_bf16 v[154:157], v[224:227], v[182:185], v[154:157]
v_mfma_f32_16x16x32_bf16 v[158:161], v[248:251], v[182:185], v[158:161]
v_mfma_f32_16x16x32_bf16 v[162:165], v[182:185], a[88:91], v[162:165]
v_mfma_f32_16x16x32_bf16 v[166:169], v[182:185], a[112:115], v[166:169]
v_mfma_f32_16x16x32_bf16 v[170:173], v[182:185], a[136:139], v[170:173]
ds_read_b128 v[186:189], v210 offset:11264
s_waitcnt lgkmcnt(0)
v_mfma_f32_16x16x32_bf16 v[138:141], a[20:23], v[186:189], v[138:141]
v_mfma_f32_16x16x32_bf16 v[142:145], a[44:47], v[186:189], v[142:145]
v_mfma_f32_16x16x32_bf16 v[146:149], a[68:71], v[186:189], v[146:149]
v_mfma_f32_16x16x32_bf16 v[150:153], a[236:239], v[186:189], v[150:153]
v_mfma_f32_16x16x32_bf16 v[154:157], v[228:231], v[186:189], v[154:157]
v_mfma_f32_16x16x32_bf16 v[158:161], v[252:255], v[186:189], v[158:161]
v_mfma_f32_16x16x32_bf16 v[162:165], v[186:189], a[92:95], v[162:165]
v_mfma_f32_16x16x32_bf16 v[166:169], v[186:189], a[116:119], v[166:169]
v_mfma_f32_16x16x32_bf16 v[170:173], v[186:189], a[140:143], v[170:173]
v_cvt_pk_bf16_f32 v96, v138, v139
v_cvt_pk_bf16_f32 v97, v140, v141
v_cvt_pk_bf16_f32 v98, v142, v143
v_cvt_pk_bf16_f32 v99, v144, v145
v_cvt_pk_bf16_f32 v100, v146, v147
v_cvt_pk_bf16_f32 v101, v148, v149
v_cvt_pk_bf16_f32 v84, v150, v151
v_cvt_pk_bf16_f32 v85, v152, v153
v_cvt_pk_bf16_f32 v86, v154, v155
v_cvt_pk_bf16_f32 v87, v156, v157
v_cvt_pk_bf16_f32 v88, v158, v159
v_cvt_pk_bf16_f32 v89, v160, v161
v_cvt_pk_bf16_f32 v116, v162, v163
v_cvt_pk_bf16_f32 v117, v164, v165
v_cvt_pk_bf16_f32 v124, v166, v167
v_cvt_pk_bf16_f32 v125, v168, v169
v_cvt_pk_bf16_f32 v132, v170, v171
v_cvt_pk_bf16_f32 v133, v172, v173
ds_read_b128 v[182:185], v210 offset:12288
s_waitcnt lgkmcnt(0)
v_mfma_f32_16x16x32_bf16 v[138:141], a[0:3], v[182:185], 0
v_mfma_f32_16x16x32_bf16 v[142:145], a[24:27], v[182:185], 0
v_mfma_f32_16x16x32_bf16 v[146:149], a[48:51], v[182:185], 0
ds_read_b128 v[186:189], v210 offset:13312
s_waitcnt lgkmcnt(0)
v_mfma_f32_16x16x32_bf16 v[138:141], a[4:7], v[186:189], v[138:141]
v_mfma_f32_16x16x32_bf16 v[142:145], a[28:31], v[186:189], v[142:145]
v_mfma_f32_16x16x32_bf16 v[146:149], a[52:55], v[186:189], v[146:149]
ds_read_b128 v[182:185], v210 offset:14336
s_waitcnt lgkmcnt(0)
v_mfma_f32_16x16x32_bf16 v[138:141], a[8:11], v[182:185], v[138:141]
v_mfma_f32_16x16x32_bf16 v[142:145], a[32:35], v[182:185], v[142:145]
v_mfma_f32_16x16x32_bf16 v[146:149], a[56:59], v[182:185], v[146:149]
ds_read_b128 v[186:189], v210 offset:15360
s_waitcnt lgkmcnt(0)
v_mfma_f32_16x16x32_bf16 v[138:141], a[12:15], v[186:189], v[138:141]
v_mfma_f32_16x16x32_bf16 v[142:145], a[36:39], v[186:189], v[142:145]
v_mfma_f32_16x16x32_bf16 v[146:149], a[60:63], v[186:189], v[146:149]
ds_read_b128 v[182:185], v210 offset:16384
s_waitcnt lgkmcnt(0)
v_mfma_f32_16x16x32_bf16 v[138:141], a[16:19], v[182:185], v[138:141]
v_mfma_f32_16x16x32_bf16 v[142:145], a[40:43], v[182:185], v[142:145]
v_mfma_f32_16x16x32_bf16 v[146:149], a[64:67], v[182:185], v[146:149]
ds_read_b128 v[186:189], v210 offset:17408
s_waitcnt lgkmcnt(0)
v_mfma_f32_16x16x32_bf16 v[138:141], a[20:23], v[186:189], v[138:141]
v_mfma_f32_16x16x32_bf16 v[142:145], a[44:47], v[186:189], v[142:145]
v_mfma_f32_16x16x32_bf16 v[146:149], a[68:71], v[186:189], v[146:149]
v_cvt_pk_bf16_f32 v102, v138, v139
v_cvt_pk_bf16_f32 v103, v140, v141
s_nop 0
v_cvt_pk_bf16_f32 v104, v142, v143
v_cvt_pk_bf16_f32 v105, v144, v145
s_nop 1
v_cvt_pk_bf16_f32 v106, v146, v147
v_cvt_pk_bf16_f32 v107, v148, v149
ds_read_b128 v[108:111], v215 offset:512
ds_read_b64 v[112:113], v215 offset:528
v_mov_b32 v181, 0
v_mfma_f32_16x16x16_bf16 v[138:141], v[82:83], v[76:77], 0
v_mfma_f32_16x16x16_bf16 v[142:145], v[100:101], v[76:77], 0
s_waitcnt lgkmcnt(0)
v_mfma_f32_16x16x16_bf16 v[150:153], v[112:113], v[76:77], v[206:209]
v_mfma_f32_16x16x16_bf16 v[146:149], v[106:107], v[76:77], 0
v_mfma_f32_16x16x32_bf16 v[138:141], v[78:81], v[72:75], v[138:141]
v_mfma_f32_16x16x32_bf16 v[142:145], v[96:99], v[72:75], v[142:145]
v_mfma_f32_16x16x32_bf16 v[150:153], v[108:111], v[72:75], v[150:153]
v_mfma_f32_16x16x32_bf16 v[146:149], v[102:105], v[72:75], v[146:149]
ds_read_b128 v[72:75], v215
ds_read_b64 v[76:77], v215 offset:16
v_mfma_f32_16x16x16_bf16 v[154:157], v[82:83], v[88:89], 0
v_mfma_f32_16x16x16_bf16 v[158:161], v[100:101], v[88:89], 0
v_mfma_f32_16x16x16_bf16 v[166:169], v[112:113], v[88:89], v[206:209]
v_mfma_f32_16x16x16_bf16 v[162:165], v[106:107], v[88:89], 0
v_mfma_f32_16x16x32_bf16 v[154:157], v[78:81], v[84:87], v[154:157]
v_mfma_f32_16x16x32_bf16 v[158:161], v[96:99], v[84:87], v[158:161]
v_mfma_f32_16x16x32_bf16 v[166:169], v[108:111], v[84:87], v[166:169]
v_mfma_f32_16x16x32_bf16 v[162:165], v[102:105], v[84:87], v[162:165]
ds_read_b128 v[182:185], v210 offset:12288
s_waitcnt lgkmcnt(0)
v_mfma_f32_16x16x32_bf16 v[118:121], v[182:185], a[72:75], 0
v_mfma_f32_16x16x32_bf16 v[126:129], v[182:185], a[96:99], 0
v_mfma_f32_16x16x32_bf16 v[134:137], v[182:185], a[120:123], 0
v_mfma_f32_16x16x32_bf16 v[90:93], a[216:219], v[182:185], 0
v_mfma_f32_16x16x32_bf16 v[170:173], a[240:243], v[182:185], 0
v_mfma_f32_16x16x32_bf16 v[220:223], v[232:235], v[182:185], 0
ds_read_b128 v[186:189], v210 offset:13312
s_waitcnt lgkmcnt(0)
v_mfma_f32_16x16x32_bf16 v[118:121], v[186:189], a[76:79], v[118:121]
v_mfma_f32_16x16x32_bf16 v[126:129], v[186:189], a[100:103], v[126:129]
v_mfma_f32_16x16x32_bf16 v[134:137], v[186:189], a[124:127], v[134:137]
v_mfma_f32_16x16x32_bf16 v[90:93], a[220:223], v[186:189], v[90:93]
v_mfma_f32_16x16x32_bf16 v[170:173], a[244:247], v[186:189], v[170:173]
v_mfma_f32_16x16x32_bf16 v[220:223], v[236:239], v[186:189], v[220:223]
ds_read_b128 v[182:185], v210 offset:14336
s_waitcnt lgkmcnt(0)
v_mfma_f32_16x16x32_bf16 v[118:121], v[182:185], a[80:83], v[118:121]
v_mfma_f32_16x16x32_bf16 v[126:129], v[182:185], a[104:107], v[126:129]
v_mfma_f32_16x16x32_bf16 v[134:137], v[182:185], a[128:131], v[134:137]
v_mfma_f32_16x16x32_bf16 v[90:93], a[224:227], v[182:185], v[90:93]
v_mfma_f32_16x16x32_bf16 v[170:173], a[248:251], v[182:185], v[170:173]
v_mfma_f32_16x16x32_bf16 v[220:223], v[240:243], v[182:185], v[220:223]
ds_read_b128 v[186:189], v210 offset:15360
s_waitcnt lgkmcnt(0)
v_mfma_f32_16x16x32_bf16 v[118:121], v[186:189], a[84:87], v[118:121]
v_mfma_f32_16x16x32_bf16 v[126:129], v[186:189], a[108:111], v[126:129]
v_mfma_f32_16x16x32_bf16 v[134:137], v[186:189], a[132:135], v[134:137]
v_mfma_f32_16x16x32_bf16 v[90:93], a[228:231], v[186:189], v[90:93]
v_mfma_f32_16x16x32_bf16 v[170:173], a[252:255], v[186:189], v[170:173]
v_mfma_f32_16x16x32_bf16 v[220:223], v[244:247], v[186:189], v[220:223]
ds_read_b128 v[182:185], v210 offset:16384
s_waitcnt lgkmcnt(0)
v_mfma_f32_16x16x32_bf16 v[118:121], v[182:185], a[88:91], v[118:121]
v_mfma_f32_16x16x32_bf16 v[126:129], v[182:185], a[112:115], v[126:129]
v_mfma_f32_16x16x32_bf16 v[134:137], v[182:185], a[136:139], v[134:137]
v_mfma_f32_16x16x32_bf16 v[90:93], a[232:235], v[182:185], v[90:93]
v_mfma_f32_16x16x32_bf16 v[170:173], v[224:227], v[182:185], v[170:173]
v_mfma_f32_16x16x32_bf16 v[220:223], v[248:251], v[182:185], v[220:223]
ds_read_b128 v[186:189], v210 offset:17408
s_waitcnt lgkmcnt(0)
v_mfma_f32_16x16x32_bf16 v[118:121], v[186:189], a[92:95], v[118:121]
v_mfma_f32_16x16x32_bf16 v[126:129], v[186:189], a[116:119], v[126:129]
v_mfma_f32_16x16x32_bf16 v[134:137], v[186:189], a[140:143], v[134:137]
v_mfma_f32_16x16x32_bf16 v[90:93], a[236:239], v[186:189], v[90:93]
v_mfma_f32_16x16x32_bf16 v[170:173], v[228:231], v[186:189], v[170:173]
v_mfma_f32_16x16x32_bf16 v[220:223], v[252:255], v[186:189], v[220:223]
v_cvt_pk_bf16_f32 v118, v118, v119
v_cvt_pk_bf16_f32 v119, v120, v121
ds_read_u16 v120, v214 offset:1024
v_mov_b32 v121, 0
v_cvt_pk_bf16_f32 v126, v126, v127
v_cvt_pk_bf16_f32 v127, v128, v129
ds_read_u16 v128, v214 offset:1032
v_mov_b32 v129, 0
v_cvt_pk_bf16_f32 v134, v134, v135
v_cvt_pk_bf16_f32 v135, v136, v137
ds_read_u16 v136, v214 offset:1040
v_mov_b32 v137, 0
v_cvt_pk_bf16_f32 v90, v90, v91
v_cvt_pk_bf16_f32 v91, v92, v93
v_cvt_pk_bf16_f32 v92, v170, v171
v_cvt_pk_bf16_f32 v93, v172, v173
v_cvt_pk_bf16_f32 v94, v220, v221
v_cvt_pk_bf16_f32 v95, v222, v223
v_max3_f32 v151, v138, v139, v140
v_max3_f32 v151, v151, v141, v142
v_max3_f32 v151, v151, v143, v144
v_max3_f32 v151, v151, v145, v146
v_max3_f32 v151, v151, v147, v148
v_max3_f32 v151, v151, v149, v150
v_mov_b32 v152, v151
s_nop 1
v_permlane16_swap_b32 v151, v152
v_max_f32 v151, v151, v152
v_mov_b32 v152, v151
s_nop 1
v_permlane32_swap_b32 v151, v152
v_max_f32 v151, v151, v152
v_sub_f32 v138, v138, v151
v_sub_f32 v139, v139, v151
v_sub_f32 v140, v140, v151
v_sub_f32 v141, v141, v151
v_sub_f32 v142, v142, v151
v_sub_f32 v143, v143, v151
v_sub_f32 v144, v144, v151
v_sub_f32 v145, v145, v151
v_sub_f32 v150, v150, v151
v_sub_f32 v146, v146, v151
v_sub_f32 v147, v147, v151
v_sub_f32 v148, v148, v151
v_sub_f32 v149, v149, v151
v_exp_f32 v138, v138
v_exp_f32 v139, v139
v_exp_f32 v140, v140
v_exp_f32 v141, v141
v_exp_f32 v142, v142
v_exp_f32 v143, v143
v_exp_f32 v144, v144
v_exp_f32 v145, v145
v_exp_f32 v150, v150
v_exp_f32 v146, v146
v_exp_f32 v147, v147
v_exp_f32 v148, v148
v_exp_f32 v149, v149
v_cvt_pk_bf16_f32 v174, v138, v139
v_cvt_pk_bf16_f32 v175, v140, v141
v_cvt_pk_bf16_f32 v176, v142, v143
v_cvt_pk_bf16_f32 v177, v144, v145
v_cvt_pk_bf16_f32 v178, v146, v147
v_cvt_pk_bf16_f32 v179, v148, v149
v_cvt_pk_bf16_f32 v180, v150, 0
v_mfma_f32_16x16x32_bf16 v[150:153], v[190:193], v[174:177], 0
v_mfma_f32_16x16x32_bf16 v[138:141], v[114:117], v[174:177], 0
v_mfma_f32_16x16x32_bf16 v[142:145], v[122:125], v[174:177], 0
v_mfma_f32_16x16x32_bf16 v[146:149], v[130:133], v[174:177], 0
v_mfma_f32_16x16x32_bf16 v[150:153], v[190:193], v[178:181], v[150:153]
s_waitcnt lgkmcnt(2)
v_mfma_f32_16x16x32_bf16 v[138:141], v[118:121], v[178:181], v[138:141]
s_waitcnt lgkmcnt(1)
v_mfma_f32_16x16x32_bf16 v[142:145], v[126:129], v[178:181], v[142:145]
s_waitcnt lgkmcnt(0)
v_mfma_f32_16x16x32_bf16 v[146:149], v[134:137], v[178:181], v[146:149]
v_max3_f32 v167, v154, v155, v156
v_max3_f32 v167, v167, v157, v158
v_max3_f32 v167, v167, v159, v160
v_max3_f32 v167, v167, v161, v162
v_max3_f32 v167, v167, v163, v164
v_max3_f32 v167, v167, v165, v166
v_mov_b32 v168, v167
s_nop 1
v_permlane16_swap_b32 v167, v168
v_max_f32 v167, v167, v168
v_mov_b32 v168, v167
s_nop 1
v_permlane32_swap_b32 v167, v168
v_max_f32 v167, v167, v168
v_sub_f32 v154, v154, v167
v_sub_f32 v155, v155, v167
v_sub_f32 v156, v156, v167
v_sub_f32 v157, v157, v167
v_sub_f32 v158, v158, v167
v_sub_f32 v159, v159, v167
v_sub_f32 v160, v160, v167
v_sub_f32 v161, v161, v167
v_sub_f32 v166, v166, v167
v_sub_f32 v162, v162, v167
v_sub_f32 v163, v163, v167
v_sub_f32 v164, v164, v167
v_sub_f32 v165, v165, v167
v_exp_f32 v154, v154
v_exp_f32 v155, v155
v_exp_f32 v156, v156
v_exp_f32 v157, v157
v_exp_f32 v158, v158
v_exp_f32 v159, v159
v_exp_f32 v160, v160
v_exp_f32 v161, v161
v_exp_f32 v166, v166
v_exp_f32 v162, v162
v_exp_f32 v163, v163
v_exp_f32 v164, v164
v_exp_f32 v165, v165
v_cvt_pk_bf16_f32 v174, v154, v155
v_cvt_pk_bf16_f32 v175, v156, v157
v_cvt_pk_bf16_f32 v176, v158, v159
v_cvt_pk_bf16_f32 v177, v160, v161
v_cvt_pk_bf16_f32 v178, v162, v163
v_cvt_pk_bf16_f32 v179, v164, v165
v_cvt_pk_bf16_f32 v180, v166, 0
v_mfma_f32_16x16x32_bf16 v[166:169], v[190:193], v[174:177], 0
v_mfma_f32_16x16x32_bf16 v[154:157], v[114:117], v[174:177], 0
v_mfma_f32_16x16x32_bf16 v[158:161], v[122:125], v[174:177], 0
v_mfma_f32_16x16x32_bf16 v[162:165], v[130:133], v[174:177], 0
v_mfma_f32_16x16x32_bf16 v[166:169], v[190:193], v[178:181], v[166:169]
v_mfma_f32_16x16x32_bf16 v[154:157], v[118:121], v[178:181], v[154:157]
v_mfma_f32_16x16x32_bf16 v[158:161], v[126:129], v[178:181], v[158:161]
v_mfma_f32_16x16x32_bf16 v[162:165], v[134:137], v[178:181], v[162:165]
v_rcp_f32 v151, v150
s_nop 0
v_mul_f32 v151, s3, v151
v_mul_f32 v138, v138, v151
v_mul_f32 v139, v139, v151
v_cvt_pk_bf16_f32 v138, v138, v139
v_mul_f32 v140, v140, v151
v_mul_f32 v141, v141, v151
v_cvt_pk_bf16_f32 v139, v140, v141
v_mul_f32 v142, v142, v151
v_mul_f32 v143, v143, v151
v_cvt_pk_bf16_f32 v140, v142, v143
v_mul_f32 v144, v144, v151
v_mul_f32 v145, v145, v151
v_cvt_pk_bf16_f32 v141, v144, v145
ds_write_b128 v211, v[138:141] offset:38912
v_mul_f32 v146, v146, v151
v_mul_f32 v147, v147, v151
v_cvt_pk_bf16_f32 v142, v146, v147
v_mul_f32 v148, v148, v151
v_mul_f32 v149, v149, v151
v_cvt_pk_bf16_f32 v143, v148, v149
ds_write_b64 v212, v[142:143] offset:38912
v_mfma_f32_16x16x32_bf16 v[138:141], v[78:81], v[90:93], 0
v_mfma_f32_16x16x32_bf16 v[142:145], v[96:99], v[90:93], 0
v_mfma_f32_16x16x32_bf16 v[150:153], v[108:111], v[90:93], v[206:209]
v_mfma_f32_16x16x32_bf16 v[146:149], v[102:105], v[90:93], 0
v_mfma_f32_16x16x16_bf16 v[138:141], v[82:83], v[94:95], v[138:141]
v_mfma_f32_16x16x16_bf16 v[142:145], v[100:101], v[94:95], v[142:145]
v_mfma_f32_16x16x16_bf16 v[150:153], v[112:113], v[94:95], v[150:153]
v_mfma_f32_16x16x16_bf16 v[146:149], v[106:107], v[94:95], v[146:149]
v_rcp_f32 v167, v166
s_nop 0
v_mul_f32 v167, s3, v167
v_mul_f32 v154, v154, v167
v_mul_f32 v155, v155, v167
v_cvt_pk_bf16_f32 v154, v154, v155
v_mul_f32 v156, v156, v167
v_mul_f32 v157, v157, v167
v_cvt_pk_bf16_f32 v155, v156, v157
v_mul_f32 v158, v158, v167
v_mul_f32 v159, v159, v167
v_cvt_pk_bf16_f32 v156, v158, v159
v_mul_f32 v160, v160, v167
v_mul_f32 v161, v161, v167
v_cvt_pk_bf16_f32 v157, v160, v161
ds_write_b128 v211, v[154:157] offset:45056
v_mul_f32 v162, v162, v167
v_mul_f32 v163, v163, v167
v_cvt_pk_bf16_f32 v158, v162, v163
v_mul_f32 v164, v164, v167
v_mul_f32 v165, v165, v167
v_cvt_pk_bf16_f32 v159, v164, v165
ds_write_b64 v212, v[158:159] offset:45056
v_mfma_f32_16x16x16_bf16 v[154:157], v[76:77], v[82:83], 0
v_mfma_f32_16x16x16_bf16 v[158:161], v[76:77], v[100:101], 0
v_mfma_f32_16x16x16_bf16 v[162:165], v[76:77], v[106:107], 0
v_mfma_f32_16x16x16_bf16 v[166:169], v[76:77], v[112:113], v[206:209]
v_mfma_f32_16x16x32_bf16 v[154:157], v[72:75], v[78:81], v[154:157]
v_mfma_f32_16x16x32_bf16 v[158:161], v[72:75], v[96:99], v[158:161]
v_mfma_f32_16x16x32_bf16 v[162:165], v[72:75], v[102:105], v[162:165]
v_mfma_f32_16x16x32_bf16 v[166:169], v[72:75], v[108:111], v[166:169]
v_mov_b32_dpp v154, v158 quad_perm:[0,1,2,3] row_mask:0x2 bank_mask:0xf
s_nop 1
v_mov_b32_dpp v154, v162 quad_perm:[0,1,2,3] row_mask:0x4 bank_mask:0xf
s_nop 2
v_mov_b32_dpp v154, v167 quad_perm:[0,1,2,3] row_mask:0x8 bank_mask:0xf
v_mov_b32 v155, v154
s_nop 1
v_max_f32_dpp v155, v155, v155 row_ror:8 row_mask:0xf bank_mask:0xf
s_nop 1
v_max_f32_dpp v155, v155, v155 row_ror:4 row_mask:0xf bank_mask:0xf
s_nop 1
v_max_f32_dpp v155, v155, v155 row_ror:2 row_mask:0xf bank_mask:0xf
s_nop 1
v_max_f32_dpp v155, v155, v155 row_ror:1 row_mask:0xf bank_mask:0xf
v_mov_b32 v156, v155
s_nop 1
v_permlane16_swap_b32 v155, v156
v_max_f32 v155, v155, v156
v_mov_b32 v156, v155
s_nop 1
v_permlane32_swap_b32 v155, v156
v_max_f32 v155, v155, v156
v_sub_f32 v154, v154, v155
v_exp_f32 v154, v154
s_nop 0
v_cvt_pk_bf16_f32 v154, v154, 0
ds_write_b16 v214, v154
s_waitcnt lgkmcnt(1)
ds_read_b128 v[84:87], v215
ds_read_b128 v[88:91], v215 offset:16
v_add_u32 v215, 1552, v215
s_barrier
ds_read_b128 v[170:173], v210 offset:38912
s_waitcnt lgkmcnt(0)
v_mfma_f32_16x16x32_bf16 v[0:3], a[144:147], v[170:173], v[0:3]
v_mfma_f32_16x16x32_bf16 v[4:7], a[168:171], v[170:173], v[4:7]
v_mfma_f32_16x16x32_bf16 v[8:11], a[192:195], v[170:173], v[8:11]
ds_read_b128 v[182:185], v210 offset:39936
s_waitcnt lgkmcnt(0)
v_mfma_f32_16x16x32_bf16 v[0:3], a[148:151], v[182:185], v[0:3]
v_mfma_f32_16x16x32_bf16 v[4:7], a[172:175], v[182:185], v[4:7]
v_mfma_f32_16x16x32_bf16 v[8:11], a[196:199], v[182:185], v[8:11]
ds_read_b128 v[186:189], v210 offset:40960
s_waitcnt lgkmcnt(0)
v_mfma_f32_16x16x32_bf16 v[0:3], a[152:155], v[186:189], v[0:3]
v_mfma_f32_16x16x32_bf16 v[4:7], a[176:179], v[186:189], v[4:7]
v_mfma_f32_16x16x32_bf16 v[8:11], a[200:203], v[186:189], v[8:11]
ds_read_b128 v[170:173], v210 offset:41984
s_waitcnt lgkmcnt(0)
v_mfma_f32_16x16x32_bf16 v[0:3], a[156:159], v[170:173], v[0:3]
v_mfma_f32_16x16x32_bf16 v[4:7], a[180:183], v[170:173], v[4:7]
v_mfma_f32_16x16x32_bf16 v[8:11], a[204:207], v[170:173], v[8:11]
ds_read_b128 v[182:185], v210 offset:43008
s_waitcnt lgkmcnt(0)
v_mfma_f32_16x16x32_bf16 v[0:3], a[160:163], v[182:185], v[0:3]
v_mfma_f32_16x16x32_bf16 v[4:7], a[184:187], v[182:185], v[4:7]
v_mfma_f32_16x16x32_bf16 v[8:11], a[208:211], v[182:185], v[8:11]
ds_read_b128 v[186:189], v210 offset:44032
s_waitcnt lgkmcnt(0)
v_mfma_f32_16x16x32_bf16 v[0:3], a[164:167], v[186:189], v[0:3]
v_mfma_f32_16x16x32_bf16 v[4:7], a[188:191], v[186:189], v[4:7]
v_mfma_f32_16x16x32_bf16 v[8:11], a[212:215], v[186:189], v[8:11]
v_cvt_pk_bf16_f32 v72, v0, v1
v_cvt_pk_bf16_f32 v73, v2, v3
buffer_store_dwordx2 v[72:73], v203, s[8:11], s38 offen
v_cvt_pk_bf16_f32 v74, v4, v5
v_cvt_pk_bf16_f32 v75, v6, v7
buffer_store_dwordx2 v[74:75], v203, s[8:11], s38 offen offset:32
s_nop 0
v_cvt_pk_bf16_f32 v76, v8, v9
v_cvt_pk_bf16_f32 v77, v10, v11
buffer_store_dwordx2 v[76:77], v203, s[8:11], s38 offen offset:64
v_max3_f32 v151, v138, v139, v140
v_max3_f32 v151, v151, v141, v142
v_max3_f32 v151, v151, v143, v144
v_max3_f32 v151, v151, v145, v146
v_max3_f32 v151, v151, v147, v148
v_max3_f32 v151, v151, v149, v150
v_mov_b32 v152, v151
s_nop 1
v_permlane16_swap_b32 v151, v152
v_max_f32 v151, v151, v152
v_mov_b32 v152, v151
s_nop 1
v_permlane32_swap_b32 v151, v152
v_max_f32 v151, v151, v152
v_sub_f32 v138, v138, v151
v_sub_f32 v139, v139, v151
v_sub_f32 v140, v140, v151
v_sub_f32 v141, v141, v151
v_sub_f32 v142, v142, v151
v_sub_f32 v143, v143, v151
v_sub_f32 v144, v144, v151
v_sub_f32 v145, v145, v151
v_sub_f32 v150, v150, v151
v_sub_f32 v146, v146, v151
v_sub_f32 v147, v147, v151
v_sub_f32 v148, v148, v151
v_sub_f32 v149, v149, v151
v_exp_f32 v138, v138
v_exp_f32 v139, v139
v_exp_f32 v140, v140
v_exp_f32 v141, v141
v_exp_f32 v142, v142
v_exp_f32 v143, v143
v_exp_f32 v144, v144
v_exp_f32 v145, v145
v_exp_f32 v150, v150
v_exp_f32 v146, v146
v_exp_f32 v147, v147
v_exp_f32 v148, v148
v_exp_f32 v149, v149
v_cvt_pk_bf16_f32 v174, v138, v139
v_cvt_pk_bf16_f32 v175, v140, v141
v_cvt_pk_bf16_f32 v176, v142, v143
v_cvt_pk_bf16_f32 v177, v144, v145
v_cvt_pk_bf16_f32 v178, v146, v147
v_cvt_pk_bf16_f32 v179, v148, v149
v_cvt_pk_bf16_f32 v180, v150, 0
v_mfma_f32_16x16x32_bf16 v[150:153], v[190:193], v[174:177], 0
v_mfma_f32_16x16x32_bf16 v[138:141], v[114:117], v[174:177], 0
v_mfma_f32_16x16x32_bf16 v[142:145], v[122:125], v[174:177], 0
v_mfma_f32_16x16x32_bf16 v[146:149], v[130:133], v[174:177], 0
v_mfma_f32_16x16x32_bf16 v[150:153], v[190:193], v[178:181], v[150:153]
v_mfma_f32_16x16x32_bf16 v[138:141], v[118:121], v[178:181], v[138:141]
v_mfma_f32_16x16x32_bf16 v[142:145], v[126:129], v[178:181], v[142:145]
v_mfma_f32_16x16x32_bf16 v[146:149], v[134:137], v[178:181], v[146:149]
v_mfma_f32_16x16x32_bf16 v[166:169], v[84:87], v[190:193], 0
v_mfma_f32_16x16x32_bf16 v[154:157], v[84:87], v[114:117], 0
v_mfma_f32_16x16x32_bf16 v[158:161], v[84:87], v[122:125], 0
v_mfma_f32_16x16x32_bf16 v[162:165], v[84:87], v[130:133], 0
v_mfma_f32_16x16x32_bf16 v[166:169], v[88:91], v[190:193], v[166:169]
v_mfma_f32_16x16x32_bf16 v[154:157], v[88:91], v[118:121], v[154:157]
v_mfma_f32_16x16x32_bf16 v[158:161], v[88:91], v[126:129], v[158:161]
v_mfma_f32_16x16x32_bf16 v[162:165], v[88:91], v[134:137], v[162:165]
v_rcp_f32 v167, v166
s_nop 1
v_mov_b32_dpp v154, v158 quad_perm:[0,1,2,3] row_mask:0x2 bank_mask:0xf
s_nop 2
v_mov_b32_dpp v154, v162 quad_perm:[0,1,2,3] row_mask:0x4 bank_mask:0xf
v_mul_f32 v167, s3, v167
v_mul_f32 v154, v154, v167
v_cvt_pk_bf16_f32 v154, v154, 0
ds_write_b16 v214, v154
v_add_u32 v214, 1552, v214
ds_read_b128 v[170:173], v210 offset:45056
s_waitcnt lgkmcnt(0)
v_mfma_f32_16x16x32_bf16 v[12:15], a[144:147], v[170:173], v[12:15]
v_mfma_f32_16x16x32_bf16 v[16:19], a[168:171], v[170:173], v[16:19]
v_mfma_f32_16x16x32_bf16 v[20:23], a[192:195], v[170:173], v[20:23]
ds_read_b128 v[182:185], v210 offset:46080
s_waitcnt lgkmcnt(0)
v_mfma_f32_16x16x32_bf16 v[12:15], a[148:151], v[182:185], v[12:15]
v_mfma_f32_16x16x32_bf16 v[16:19], a[172:175], v[182:185], v[16:19]
v_mfma_f32_16x16x32_bf16 v[20:23], a[196:199], v[182:185], v[20:23]
ds_read_b128 v[186:189], v210 offset:47104
s_waitcnt lgkmcnt(0)
v_mfma_f32_16x16x32_bf16 v[12:15], a[152:155], v[186:189], v[12:15]
v_mfma_f32_16x16x32_bf16 v[16:19], a[176:179], v[186:189], v[16:19]
v_mfma_f32_16x16x32_bf16 v[20:23], a[200:203], v[186:189], v[20:23]
ds_read_b128 v[170:173], v210 offset:48128
s_waitcnt lgkmcnt(0)
v_mfma_f32_16x16x32_bf16 v[12:15], a[156:159], v[170:173], v[12:15]
v_mfma_f32_16x16x32_bf16 v[16:19], a[180:183], v[170:173], v[16:19]
v_mfma_f32_16x16x32_bf16 v[20:23], a[204:207], v[170:173], v[20:23]
ds_read_b128 v[182:185], v210 offset:49152
s_waitcnt lgkmcnt(0)
v_mfma_f32_16x16x32_bf16 v[12:15], a[160:163], v[182:185], v[12:15]
v_mfma_f32_16x16x32_bf16 v[16:19], a[184:187], v[182:185], v[16:19]
v_mfma_f32_16x16x32_bf16 v[20:23], a[208:211], v[182:185], v[20:23]
ds_read_b128 v[186:189], v210 offset:50176
s_waitcnt lgkmcnt(0)
v_mfma_f32_16x16x32_bf16 v[12:15], a[164:167], v[186:189], v[12:15]
v_mfma_f32_16x16x32_bf16 v[16:19], a[188:191], v[186:189], v[16:19]
v_mfma_f32_16x16x32_bf16 v[20:23], a[212:215], v[186:189], v[20:23]
v_cvt_pk_bf16_f32 v78, v12, v13
v_cvt_pk_bf16_f32 v79, v14, v15
buffer_store_dwordx2 v[78:79], v204, s[8:11], s38 offen
v_cvt_pk_bf16_f32 v80, v16, v17
v_cvt_pk_bf16_f32 v81, v18, v19
buffer_store_dwordx2 v[80:81], v204, s[8:11], s38 offen offset:32
s_nop 0
v_cvt_pk_bf16_f32 v82, v20, v21
v_cvt_pk_bf16_f32 v83, v22, v23
buffer_store_dwordx2 v[82:83], v204, s[8:11], s38 offen offset:64
v_rcp_f32 v151, v150
s_nop 0
v_mul_f32 v151, s3, v151
v_mul_f32 v138, v138, v151
v_mul_f32 v139, v139, v151
v_cvt_pk_bf16_f32 v138, v138, v139
v_mul_f32 v140, v140, v151
v_mul_f32 v141, v141, v151
v_cvt_pk_bf16_f32 v139, v140, v141
v_mul_f32 v142, v142, v151
v_mul_f32 v143, v143, v151
v_cvt_pk_bf16_f32 v140, v142, v143
v_mul_f32 v144, v144, v151
v_mul_f32 v145, v145, v151
v_cvt_pk_bf16_f32 v141, v144, v145
ds_write_b128 v211, v[138:141] offset:51200
v_mul_f32 v146, v146, v151
v_mul_f32 v147, v147, v151
v_cvt_pk_bf16_f32 v142, v146, v147
v_mul_f32 v148, v148, v151
v_mul_f32 v149, v149, v151
v_cvt_pk_bf16_f32 v143, v148, v149
ds_write_b64 v212, v[142:143] offset:51200
v_cmp_lt_u32 vcc, 1602224128, v218
s_nop 0
s_or_b32 s41, vcc_lo, vcc_hi
v_mov_b32 v69, s41
ds_write_b32 v209, v69
s_waitcnt lgkmcnt(0)
s_barrier
ds_read_b128 v[170:173], v210 offset:51200
s_waitcnt lgkmcnt(0)
v_mfma_f32_16x16x32_bf16 v[24:27], a[144:147], v[170:173], v[24:27]
v_mfma_f32_16x16x32_bf16 v[28:31], a[168:171], v[170:173], v[28:31]
v_mfma_f32_16x16x32_bf16 v[32:35], a[192:195], v[170:173], v[32:35]
ds_read_b128 v[182:185], v210 offset:52224
s_waitcnt lgkmcnt(0)
v_mfma_f32_16x16x32_bf16 v[24:27], a[148:151], v[182:185], v[24:27]
v_mfma_f32_16x16x32_bf16 v[28:31], a[172:175], v[182:185], v[28:31]
v_mfma_f32_16x16x32_bf16 v[32:35], a[196:199], v[182:185], v[32:35]
ds_read_b128 v[186:189], v210 offset:53248
s_waitcnt lgkmcnt(0)
v_mfma_f32_16x16x32_bf16 v[24:27], a[152:155], v[186:189], v[24:27]
v_mfma_f32_16x16x32_bf16 v[28:31], a[176:179], v[186:189], v[28:31]
v_mfma_f32_16x16x32_bf16 v[32:35], a[200:203], v[186:189], v[32:35]
ds_read_b128 v[170:173], v210 offset:54272
s_waitcnt lgkmcnt(0)
v_mfma_f32_16x16x32_bf16 v[24:27], a[156:159], v[170:173], v[24:27]
v_mfma_f32_16x16x32_bf16 v[28:31], a[180:183], v[170:173], v[28:31]
v_mfma_f32_16x16x32_bf16 v[32:35], a[204:207], v[170:173], v[32:35]
ds_read_b128 v[182:185], v210 offset:55296
s_waitcnt lgkmcnt(0)
v_mfma_f32_16x16x32_bf16 v[24:27], a[160:163], v[182:185], v[24:27]
v_mfma_f32_16x16x32_bf16 v[28:31], a[184:187], v[182:185], v[28:31]
v_mfma_f32_16x16x32_bf16 v[32:35], a[208:211], v[182:185], v[32:35]
ds_read_b128 v[186:189], v210 offset:56320
s_waitcnt lgkmcnt(0)
v_mfma_f32_16x16x32_bf16 v[24:27], a[164:167], v[186:189], v[24:27]
v_mfma_f32_16x16x32_bf16 v[28:31], a[188:191], v[186:189], v[28:31]
v_mfma_f32_16x16x32_bf16 v[32:35], a[212:215], v[186:189], v[32:35]
v_cvt_pk_bf16_f32 v116, v24, v25
v_cvt_pk_bf16_f32 v117, v26, v27
buffer_store_dwordx2 v[116:117], v205, s[8:11], s38 offen
v_cvt_pk_bf16_f32 v124, v28, v29
v_cvt_pk_bf16_f32 v125, v30, v31
buffer_store_dwordx2 v[124:125], v205, s[8:11], s38 offen offset:32
s_nop 0
v_cvt_pk_bf16_f32 v132, v32, v33
v_cvt_pk_bf16_f32 v133, v34, v35
buffer_store_dwordx2 v[132:133], v205, s[8:11], s38 offen offset:64
ds_read_b128 v[84:87], v63 offset:24832
ds_read_b128 v[88:91], v63 offset:24960
ds_read_b128 v[92:95], v63 offset:25088
ds_read_b128 v[96:99], v63 offset:25216
ds_read_b64 v[100:101], v63 offset:24848
ds_read_b64 v[102:103], v63 offset:24976
ds_read_b64 v[104:105], v63 offset:25104
ds_read_b64 v[106:107], v63 offset:25232
s_waitcnt lgkmcnt(7)
v_mfma_f32_16x16x32_bf16 v[48:51], a[144:147], v[84:87], v[48:51]
s_waitcnt lgkmcnt(6)
v_mfma_f32_16x16x32_bf16 v[48:51], a[148:151], v[88:91], v[48:51]
s_waitcnt lgkmcnt(5)
v_mfma_f32_16x16x32_bf16 v[48:51], a[152:155], v[92:95], v[48:51]
s_waitcnt lgkmcnt(4)
v_mfma_f32_16x16x32_bf16 v[48:51], a[156:159], v[96:99], v[48:51]
s_waitcnt lgkmcnt(2)
v_mfma_f32_16x16x32_bf16 v[48:51], a[160:163], v[100:103], v[48:51]
s_waitcnt lgkmcnt(0)
v_mfma_f32_16x16x32_bf16 v[48:51], a[164:167], v[104:107], v[48:51]
s_nop 7
v_cvt_pk_bf16_f32 v48, v48, v49
v_cvt_pk_bf16_f32 v49, v50, v51
buffer_store_dwordx2 v[48:49], v66, s[8:11], 0 offen
v_mfma_f32_16x16x32_bf16 v[52:55], a[168:171], v[84:87], v[52:55]
v_mfma_f32_16x16x32_bf16 v[52:55], a[172:175], v[88:91], v[52:55]
v_mfma_f32_16x16x32_bf16 v[52:55], a[176:179], v[92:95], v[52:55]
v_mfma_f32_16x16x32_bf16 v[52:55], a[180:183], v[96:99], v[52:55]
v_mfma_f32_16x16x32_bf16 v[52:55], a[184:187], v[100:103], v[52:55]
v_mfma_f32_16x16x32_bf16 v[52:55], a[188:191], v[104:107], v[52:55]
s_nop 7
v_cvt_pk_bf16_f32 v52, v52, v53
v_cvt_pk_bf16_f32 v53, v54, v55
buffer_store_dwordx2 v[52:53], v66, s[8:11], 0 offen offset:32
v_mfma_f32_16x16x32_bf16 v[56:59], a[192:195], v[84:87], v[56:59]
v_mfma_f32_16x16x32_bf16 v[56:59], a[196:199], v[88:91], v[56:59]
v_mfma_f32_16x16x32_bf16 v[56:59], a[200:203], v[92:95], v[56:59]
v_mfma_f32_16x16x32_bf16 v[56:59], a[204:207], v[96:99], v[56:59]
v_mfma_f32_16x16x32_bf16 v[56:59], a[208:211], v[100:103], v[56:59]
v_mfma_f32_16x16x32_bf16 v[56:59], a[212:215], v[104:107], v[56:59]
s_nop 7
v_cvt_pk_bf16_f32 v56, v56, v57
v_cvt_pk_bf16_f32 v57, v58, v59
buffer_store_dwordx2 v[56:57], v66, s[8:11], 0 offen offset:64
ds_read_b128 v[174:177], v210 offset:18432
s_waitcnt lgkmcnt(0)
v_or3_b32 v174, v174, v175, v176
v_or_b32 v174, v174, v177
s_nop 0
v_readfirstlane_b32 s43, v174
s_endpgm
.p2align 6
.type L_tab,@object
L_tab:
.long 0x0,0x3800,0x5500,0x190,0x320,0x2020,0x5820,0x4b0,0x640,0x2340,0x4040,0x7d0,0x960,0x2660,0x6060,0xaf0
.long 0x1010,0x4810,0x6510,0x11a0,0x1330,0x3030,0x6830,0x14c0,0x1650,0x3350,0x5050,0x17e0,0x1970,0x3670,0x5370,0x1b00
.long 0x190,0x3990,0x5690,0x320,0x4b0,0x21b0,0x59b0,0x640,0x7d0,0x24d0,0x41d0,0x960,0x27f0,0x44f0,0x61f0,0x2980
.long 0x2980,0x4680,0x6380,0x2b10,0x11a0,0x49a0,0x66a0,0x1330,0x14c0,0x31c0,0x69c0,0x1650,0x17e0,0x34e0,0x51e0,0x1970
.long 0x320,0x3b20,0x5820,0x1010,0x640,0x2340,0x5b40,0x1330,0x960,0x2660,0x4360,0x1650,0xc80,0x2980,0x6380,0x1970
.long 0x1330,0x4b30,0x6830,0x2020,0x1650,0x3350,0x6b50,0x2340,0x1970,0x3670,0x5370,0x2660,0x1c90,0x3990,0x5690,0x2980
.long 0x4b0,0x3cb0,0x59b0,0x11a0,0x7d0,0x24d0,0x5cd0,0x14c0,0xaf0,0x27f0,0x44f0,0x17e0,0x2b10,0x4810,0x6510,0x3800
.long 0x2ca0,0x49a0,0x66a0,0x3990,0x14c0,0x4cc0,0x69c0,0x21b0,0x17e0,0x34e0,0x6ce0,0x24d0,0x1b00,0x3800,0x5500,0x27f0
.long 0x2020,0x5820,0x7520,0x1330,0x2340,0x4040,0x7840,0x1650,0x2660,0x4360,0x6060,0x1970,0x2980,0x4680,0x8080,0x1c90
.long 0x3030,0x6830,0x8530,0x2340,0x3350,0x5050,0x8850,0x2660,0x3670,0x5370,0x7070,0x2980,0x3990,0x5690,0x7390,0x2ca0
.long 0x21b0,0x59b0,0x76b0,0x14c0,0x24d0,0x41d0,0x79d0,0x17e0,0x27f0,0x44f0,0x61f0,0x1b00,0x4810,0x6510,0x8210,0x3b20
.long 0x49a0,0x66a0,0x83a0,0x3cb0,0x31c0,0x69c0,0x86c0,0x24d0,0x34e0,0x51e0,0x89e0,0x27f0,0x3800,0x5500,0x7200,0x2b10
.long 0x2340,0x5b40,0x7840,0x21b0,0x2660,0x4360,0x7b60,0x24d0,0x2980,0x4680,0x6380,0x27f0,0x2ca0,0x49a0,0x83a0,0x2b10
.long 0x3350,0x6b50,0x8850,0x31c0,0x3670,0x5370,0x8b70,0x34e0,0x3990,0x5690,0x7390,0x3800,0x3cb0,0x59b0,0x76b0,0x3b20
.long 0x24d0,0x5cd0,0x79d0,0x2340,0x27f0,0x44f0,0x7cf0,0x2660,0x2b10,0x4810,0x6510,0x2980,0x4b30,0x6830,0x8530,0x49a0
.long 0x4cc0,0x69c0,0x86c0,0x4b30,0x34e0,0x6ce0,0x89e0,0x3350,0x3800,0x5500,0x8d00,0x3670,0x3b20,0x5820,0x7520,0x3990
.long 0x3990,0x5690,0x11a0,0x49a0,0x21b0,0x59b0,0x14c0,0x31c0,0x24d0,0x41d0,0x17e0,0x34e0,0x27f0,0x61f0,0x1b00,0x3800
.long 0x49a0,0x66a0,0x21b0,0x59b0,0x31c0,0x69c0,0x24d0,0x41d0,0x34e0,0x51e0,0x27f0,0x44f0,0x3800,0x5500,0x2b10,0x4810
.long 0x3b20,0x5820,0x1330,0x4b30,0x2340,0x5b40,0x1650,0x3350,0x2660,0x4360,0x1970,0x3670,0x4680,0x6380,0x3990,0x5690
.long 0x4810,0x6510,0x3b20,0x5820,0x4b30,0x6830,0x2340,0x5b40,0x3350,0x6b50,0x2660,0x4360,0x3670,0x5370,0x2980,0x4680
.long 0x4810,0x6510,0x11a0,0x49a0,0x3030,0x6830,0x14c0,0x31c0,0x3350,0x5050,0x17e0,0x34e0,0x3670,0x7070,0x1b00,0x3800
.long 0x5820,0x7520,0x21b0,0x59b0,0x4040,0x7840,0x24d0,0x41d0,0x4360,0x6060,0x27f0,0x44f0,0x4680,0x6380,0x2b10,0x4810
.long 0x49a0,0x66a0,0x1330,0x4b30,0x31c0,0x69c0,0x1650,0x3350,0x34e0,0x51e0,0x1970,0x3670,0x5500,0x7200,0x3990,0x5690
.long 0x5690,0x7390,0x3b20,0x5820,0x59b0,0x76b0,0x2340,0x5b40,0x41d0,0x79d0,0x2660,0x4360,0x44f0,0x61f0,0x2980,0x4680
.long 0x4b30,0x6830,0x11b0,0x49b0,0x3350,0x6b50,0x14d0,0x31d0,0x3670,0x5370,0x17f0,0x34f0,0x3990,0x7390,0x1b10,0x3810
.long 0x5b40,0x7840,0x21c0,0x59c0,0x4360,0x7b60,0x24e0,0x41e0,0x4680,0x6380,0x2800,0x4500,0x49a0,0x66a0,0x2b20,0x4820
.long 0x4cc0,0x69c0,0x1340,0x4b40,0x34e0,0x6ce0,0x1660,0x3360,0x3800,0x5500,0x1980,0x3680,0x5820,0x7520,0x39a0,0x56a0
.long 0x59b0,0x76b0,0x3b30,0x5830,0x5cd0,0x79d0,0x2350,0x5b50,0x44f0,0x7cf0,0x2670,0x4370,0x4810,0x6510,0x2990,0x4690
.long 0x59b0,0x76b0,0x11b0,0x49b0,0x41d0,0x79d0,0x14d0,0x31d0,0x44f0,0x61f0,0x17f0,0x34f0,0x4810,0x8210,0x1b10,0x3810
.long 0x69c0,0x86c0,0x21c0,0x59c0,0x51e0,0x89e0,0x24e0,0x41e0,0x5500,0x7200,0x2800,0x4500,0x5820,0x7520,0x2b20,0x4820
.long 0x5b40,0x7840,0x1340,0x4b40,0x4360,0x7b60,0x1660,0x3360,0x4680,0x6380,0x1980,0x3680,0x66a0,0x83a0,0x39a0,0x56a0
.long 0x6830,0x8530,0x3b30,0x5830,0x6b50,0x8850,0x2350,0x5b50,0x5370,0x8b70,0x2670,0x4370,0x5690,0x7390,0x2990,0x4690
.long 0x66a0,0x0,0x90300,0xefd00,0x69c0,0x300,0x5fd00,0xf0000,0x51e0,0x600,0x60000,0xbfa00,0x7200,0x900,0x60300,0x11f700
.long 0x76b0,0x2fe80,0xc0180,0x11fb80,0x79d0,0x30180,0x8fb80,0x11fe80,0x61f0,0x30480,0x8fe80,0xef880,0x6510,0x30780,0x90180,0xefb80
.long 0x6830,0x180,0x90480,0xefe80,0x6b50,0x480,0x5fe80,0xf0180,0x5370,0x780,0x60180,0xbfb80,0x7390,0x60480,0xbfe80,0x11f880
.long 0x7520,0x60600,0xc0000,0x11fa00,0x7840,0x30000,0xc0300,0x11fd00,0x7b60,0x30300,0x8fd00,0x120000,0x6380,0x30600,0x90000,0xefa00
.long 0x66a0,0x8,0x90308,0xefd08,0x69c0,0x308,0x5fd08,0xf0008,0x51e0,0x608,0x60008,0xbfa08,0x7200,0x908,0x60308,0x11f708
.long 0x76b0,0x2fe88,0xc0188,0x11fb88,0x79d0,0x30188,0x8fb88,0x11fe88,0x61f0,0x30488,0x8fe88,0xef888,0x6510,0x30788,0x90188,0xefb88
.long 0x6830,0x188,0x90488,0xefe88,0x6b50,0x488,0x5fe88,0xf0188,0x5370,0x788,0x60188,0xbfb88,0x7390,0x60488,0xbfe88,0x11f888
.long 0x7520,0x60608,0xc0008,0x11fa08,0x7840,0x30008,0xc0308,0x11fd08,0x7b60,0x30308,0x8fd08,0x120008,0x6380,0x30608,0x90008,0xefa08
.long 0x66b0,0x10,0x90310,0xefd10,0x69d0,0x310,0x5fd10,0xf0010,0x51f0,0x610,0x60010,0xbfa10,0x7210,0x910,0x60310,0x11f710
.long 0x76c0,0x2fe90,0xc0190,0x11fb90,0x79e0,0x30190,0x8fb90,0x11fe90,0x6200,0x30490,0x8fe90,0xef890,0x6520,0x30790,0x90190,0xefb90
.long 0x6840,0x190,0x90490,0xefe90,0x6b60,0x490,0x5fe90,0xf0190,0x5380,0x790,0x60190,0xbfb90,0x73a0,0x60490,0xbfe90,0x11f890
.long 0x7530,0x60610,0xc0010,0x11fa10,0x7850,0x30010,0xc0310,0x11fd10,0x7b70,0x30310,0x8fd10,0x120010,0x6390,0x30610,0x90010,0xefa10
.long 0x66b0,0x18,0x90318,0xefd18,0x69d0,0x318,0x5fd18,0xf0018,0x51f0,0x618,0x60018,0xbfa18,0x7210,0x918,0x60318,0x11f718
.long 0x76c0,0x2fe98,0xc0198,0x11fb98,0x79e0,0x30198,0x8fb98,0x11fe98,0x6200,0x30498,0x8fe98,0xef898,0x6520,0x30798,0x90198,0xefb98
.long 0x6840,0x198,0x90498,0xefe98,0x6b60,0x498,0x5fe98,0xf0198,0x5380,0x798,0x60198,0xbfb98,0x73a0,0x60498,0xbfe98,0x11f898
.long 0x7530,0x60618,0xc0018,0x11fa18,0x7850,0x30018,0xc0318,0x11fd18,0x7b70,0x30318,0x8fd18,0x120018,0x6390,0x30618,0x90018,0xefa18
.long 0x0,0x0,0x9100,0xd900,0x0,0xff800000,0x9110,0xd910,0x0,0xff800000,0x9120,0xd920,0x0,0xff800000,0x9130,0xd930
.long 0x0,0xff800000,0x9140,0xd940,0x0,0xff800000,0x9150,0xd950,0x0,0xff800000,0x9160,0xd960,0x0,0xff800000,0x9170,0xd970
.long 0x0,0xff800000,0x9180,0xd980,0x0,0xff800000,0x9190,0xd990,0x0,0xff800000,0x91a0,0xd9a0,0x0,0xff800000,0x91b0,0xd9b0
.long 0x0,0xff800000,0x91c0,0xd9c0,0x0,0xff800000,0x91d0,0xd9d0,0x0,0xff800000,0x91e0,0xd9e0,0x0,0xff800000,0x91f0,0xd9f0
.long 0xff800000,0x0,0x9100,0xdd00,0xff800000,0xff800000,0x9110,0xdd10,0xff800000,0xff800000,0x9120,0xdd20,0xff800000,0xff800000,0x9130,0xdd30
.long 0xff800000,0xff800000,0x9140,0xdd40,0xff800000,0xff800000,0x9150,0xdd50,0xff800000,0xff800000,0x9160,0xdd60,0xff800000,0xff800000,0x9170,0xdd70
.long 0xff800000,0xff800000,0x9180,0xdd80,0xff800000,0xff800000,0x9190,0xdd90,0xff800000,0xff800000,0x91a0,0xdda0,0xff800000,0xff800000,0x91b0,0xddb0
.long 0xff800000,0xff800000,0x91c0,0xddc0,0xff800000,0xff800000,0x91d0,0xddd0,0xff800000,0xff800000,0x91e0,0xdde0,0xff800000,0xff800000,0x91f0,0xddf0
.long 0xff800000,0x0,0x9100,0xda00,0xff800000,0xff800000,0x9110,0xda10,0xff800000,0xff800000,0x9120,0xda20,0xff800000,0xff800000,0x9130,0xda30
.long 0xff800000,0xff800000,0x9140,0xda40,0xff800000,0xff800000,0x9150,0xda50,0xff800000,0xff800000,0x9160,0xda60,0xff800000,0xff800000,0x9170,0xda70
.long 0xff800000,0xff800000,0x9180,0xda80,0xff800000,0xff800000,0x9190,0xda90,0xff800000,0xff800000,0x91a0,0xdaa0,0xff800000,0xff800000,0x91b0,0xdab0
.long 0xff800000,0xff800000,0x91c0,0xdac0,0xff800000,0xff800000,0x91d0,0xdad0,0xff800000,0xff800000,0x91e0,0xdae0,0xff800000,0xff800000,0x91f0,0xdaf0
.long 0xff800000,0x0,0x9100,0xde00,0xff800000,0xff800000,0x9110,0xde10,0xff800000,0xff800000,0x9120,0xde20,0xff800000,0xff800000,0x9130,0xde30
.long 0xff800000,0xff800000,0x9140,0xde40,0xff800000,0xff800000,0x9150,0xde50,0xff800000,0xff800000,0x9160,0xde60,0xff800000,0xff800000,0x9170,0xde70
.long 0xff800000,0xff800000,0x9180,0xde80,0xff800000,0xff800000,0x9190,0xde90,0xff800000,0xff800000,0x91a0,0xdea0,0xff800000,0xff800000,0x91b0,0xdeb0
.long 0xff800000,0xff800000,0x91c0,0xdec0,0xff800000,0xff800000,0x91d0,0xded0,0xff800000,0xff800000,0x91e0,0xdee0,0xff800000,0xff800000,0x91f0,0xdef0
.long 0x9100,0x9100,0xa100,0x0,0x9110,0x9110,0xa110,0x55555555,0x9120,0x9120,0xa120,0xaaaaaaaa,0x9130,0x9130,0xa130,0xffffffff
.long 0x9140,0x9140,0xa140,0x0,0x9150,0x9150,0xa150,0x55555555,0x9160,0x9160,0xa160,0xaaaaaaaa,0x9170,0x9170,0xa170,0xffffffff
.long 0x9180,0x9180,0xa180,0x0,0x9190,0x9190,0xa190,0x55555555,0x91a0,0x91a0,0xa1a0,0xaaaaaaaa,0x91b0,0x91b0,0xa1b0,0xffffffff
.long 0x91c0,0x91c0,0xa1c0,0x0,0x91d0,0x91d0,0xa1d0,0x55555555,0x91e0,0x91e0,0xa1e0,0xaaaaaaaa,0x91f0,0x91f0,0xa1f0,0xffffffff
.long 0x9200,0x9200,0xa200,0x0,0x9210,0x9210,0xa210,0x55555555,0x9220,0x9220,0xa220,0xaaaaaaaa,0x9230,0x9230,0xa230,0xffffffff
.long 0x9240,0x9240,0xa240,0x0,0x9250,0x9250,0xa250,0x55555555,0x9260,0x9260,0xa260,0xaaaaaaaa,0x9270,0x9270,0xa270,0xffffffff
.long 0x9280,0x9280,0xa280,0x0,0x9290,0x9290,0xa290,0x55555555,0x92a0,0x92a0,0xa2a0,0xaaaaaaaa,0x92b0,0x92b0,0xa2b0,0xffffffff
.long 0x92c0,0x92c0,0xa2c0,0x0,0x92d0,0x92d0,0xa2d0,0x55555555,0x92e0,0x92e0,0xa2e0,0xaaaaaaaa,0x92f0,0x92f0,0xa2f0,0xffffffff
.long 0x9300,0x9300,0xa300,0x0,0x9310,0x9310,0xa310,0x55555555,0x9320,0x9320,0xa320,0xaaaaaaaa,0x9330,0x9330,0xa330,0xffffffff
.long 0x9340,0x9340,0xa340,0x0,0x9350,0x9350,0xa350,0x55555555,0x9360,0x9360,0xa360,0xaaaaaaaa,0x9370,0x9370,0xa370,0xffffffff
.long 0x9380,0x9380,0xa380,0x0,0x9390,0x9390,0xa390,0x55555555,0x93a0,0x93a0,0xa3a0,0xaaaaaaaa,0x93b0,0x93b0,0xa3b0,0xffffffff
.long 0x93c0,0x93c0,0xa3c0,0x0,0x93d0,0x93d0,0xa3d0,0x55555555,0x93e0,0x93e0,0xa3e0,0xaaaaaaaa,0x93f0,0x93f0,0xa3f0,0xffffffff
.long 0x9400,0x9400,0xa400,0x0,0x9410,0x9410,0xa410,0x55555555,0x9420,0x9420,0xa420,0xaaaaaaaa,0x9430,0x9430,0xa430,0xffffffff
.long 0x9440,0x9440,0xa440,0x0,0x9450,0x9450,0xa450,0x55555555,0x9460,0x9460,0xa460,0xaaaaaaaa,0x9470,0x9470,0xa470,0xffffffff
.long 0x9480,0x9480,0xa480,0x0,0x9490,0x9490,0xa490,0x55555555,0x94a0,0x94a0,0xa4a0,0xaaaaaaaa,0x94b0,0x94b0,0xa4b0,0xffffffff
.long 0x94c0,0x94c0,0xa4c0,0x0,0x94d0,0x94d0,0xa4d0,0x55555555,0x94e0,0x94e0,0xa4e0,0xaaaaaaaa,0x94f0,0x94f0,0xa4f0,0xffffffff
.long 0x17100,0x17100,0x0,0x23100,0x17102,0x17100,0x0,0x23110,0x17104,0x17100,0x0,0x23120,0x17106,0x17100,0x0,0x23130
.long 0x17120,0x17100,0x0,0x23140,0x17122,0x17100,0x0,0x23150,0x17124,0x17100,0x0,0x23160,0x17126,0x17100,0x0,0x23170
.long 0x17140,0x17100,0x0,0x23300,0x17142,0x17100,0x0,0x23300,0x17144,0x17100,0x0,0x23300,0x17146,0x17100,0x0,0x23300
.long 0x17160,0x17100,0x0,0x23300,0x17162,0x17100,0x0,0x23300,0x17164,0x17100,0x0,0x23300,0x17166,0x17100,0x0,0x23300
.long 0x17108,0x17120,0x0,0x23200,0x1710a,0x17120,0x0,0x23210,0x1710c,0x17120,0x0,0x23220,0x1710e,0x17120,0x0,0x23230
.long 0x17128,0x17120,0x0,0x23240,0x1712a,0x17120,0x0,0x23250,0x1712c,0x17120,0x0,0x23260,0x1712e,0x17120,0x0,0x23270
.long 0x17148,0x17120,0x0,0x23300,0x1714a,0x17120,0x0,0x23300,0x1714c,0x17120,0x0,0x23300,0x1714e,0x17120,0x0,0x23300
.long 0x17168,0x17120,0x0,0x23300,0x1716a,0x17120,0x0,0x23300,0x1716c,0x17120,0x0,0x23300,0x1716e,0x17120,0x0,0x23300
.long 0x17110,0x17140,0x0,0x23300,0x17112,0x17140,0x0,0x23300,0x17114,0x17140,0x0,0x23300,0x17116,0x17140,0x0,0x23300
.long 0x17130,0x17140,0x0,0x23300,0x17132,0x17140,0x0,0x23300,0x17134,0x17140,0x0,0x23300,0x17136,0x17140,0x0,0x23300
.long 0x17150,0x17140,0x0,0x23180,0x17152,0x17140,0x0,0x23190,0x17154,0x17140,0x0,0x231a0,0x17156,0x17140,0x0,0x231b0
.long 0x17170,0x17140,0x0,0x231c0,0x17172,0x17140,0x0,0x231d0,0x17174,0x17140,0x0,0x231e0,0x17176,0x17140,0x0,0x231f0
.long 0x17118,0x17160,0x0,0x23300,0x1711a,0x17160,0x0,0x23300,0x1711c,0x17160,0x0,0x23300,0x1711e,0x17160,0x0,0x23300
.long 0x17138,0x17160,0x0,0x23300,0x1713a,0x17160,0x0,0x23300,0x1713c,0x17160,0x0,0x23300,0x1713e,0x17160,0x0,0x23300
.long 0x17158,0x17160,0x0,0x23280,0x1715a,0x17160,0x0,0x23290,0x1715c,0x17160,0x0,0x232a0,0x1715e,0x17160,0x0,0x232b0
.long 0x17178,0x17160,0x0,0x232c0,0x1717a,0x17160,0x0,0x232d0,0x1717c,0x17160,0x0,0x232e0,0x1717e,0x17160,0x0,0x232f0
.long 0x17100,0xe100,0xe280,0xe700,0x17108,0xee90,0xf010,0xf490,0x17110,0xfc20,0xfda0,0x10220,0x17118,0x109b0,0x10b30,0x10fb0
.long 0x17160,0x11740,0x118c0,0x11d40,0x17168,0x124d0,0x12650,0x12ad0,0x17170,0x13260,0x133e0,0x13860,0x17178,0x13ff0,0x14170,0x145f0
.long 0x171c0,0x14d80,0x14f00,0x15380,0x171c8,0x15b10,0x15c90,0x16110,0x171d0,0x168a0,0x16a20,0x16ea0,0x171d8,0x17630,0x177b0,0x17c30
.long 0x17220,0x183c0,0x18540,0x189c0,0x17228,0x19150,0x192d0,0x19750,0x17230,0x19ee0,0x1a060,0x1a4e0,0x17238,0x1ac70,0x1adf0,0x1b270
.long 0x17280,0xe400,0xe580,0xe700,0x17288,0xf190,0xf310,0xf490,0x17290,0xff20,0x100a0,0x10220,0x17298,0x10cb0,0x10e30,0x10fb0
.long 0x172e0,0x11a40,0x11bc0,0x11d40,0x172e8,0x127d0,0x12950,0x12ad0,0x172f0,0x13560,0x136e0,0x13860,0x172f8,0x142f0,0x14470,0x145f0
.long 0x17340,0x15080,0x15200,0x15380,0x17348,0x15e10,0x15f90,0x16110,0x17350,0x16ba0,0x16d20,0x16ea0,0x17358,0x17930,0x17ab0,0x17c30
.long 0x173a0,0x186c0,0x18840,0x189c0,0x173a8,0x19450,0x195d0,0x19750,0x173b0,0x1a1e0,0x1a360,0x1a4e0,0x173b8,0x1af70,0x1b0f0,0x1b270
.long 0x17400,0xea00,0xe880,0xe710,0x17408,0xf790,0xf610,0xf4a0,0x17410,0x10520,0x103a0,0x10230,0x17418,0x112b0,0x11130,0x10fc0
.long 0x17460,0x12040,0x11ec0,0x11d50,0x17468,0x12dd0,0x12c50,0x12ae0,0x17470,0x13b60,0x139e0,0x13870,0x17478,0x148f0,0x14770,0x14600
.long 0x174c0,0x15680,0x15500,0x15390,0x174c8,0x16410,0x16290,0x16120,0x174d0,0x171a0,0x17020,0x16eb0,0x174d8,0x17f30,0x17db0,0x17c40
.long 0x17520,0x18cc0,0x18b40,0x189d0,0x17528,0x19a50,0x198d0,0x19760,0x17530,0x1a7e0,0x1a660,0x1a4f0,0x17538,0x1b570,0x1b3f0,0x1b280
.long 0x17580,0xed00,0xeb80,0xe710,0x17588,0xfa90,0xf910,0xf4a0,0x17590,0x10820,0x106a0,0x10230,0x17598,0x115b0,0x11430,0x10fc0
.long 0x175e0,0x12340,0x121c0,0x11d50,0x175e8,0x130d0,0x12f50,0x12ae0,0x175f0,0x13e60,0x13ce0,0x13870,0x175f8,0x14bf0,0x14a70,0x14600
.long 0x17640,0x15980,0x15800,0x15390,0x17648,0x16710,0x16590,0x16120,0x17650,0x174a0,0x17320,0x16eb0,0x17658,0x18230,0x180b0,0x17c40
.long 0x176a0,0x18fc0,0x18e40,0x189d0,0x176a8,0x19d50,0x19bd0,0x19760,0x176b0,0x1aae0,0x1a960,0x1a4f0,0x176b8,0x1b870,0x1b6f0,0x1b280
.long 0x17100,0x17500,0x1f050,0x0,0x17710,0x17b10,0x1f360,0x0,0x17d20,0x18120,0x1f670,0x0,0x18330,0x18730,0x1f980,0x0
.long 0x18940,0x18d40,0x1fc90,0x0,0x18f50,0x19350,0x1ffa0,0x0,0x19560,0x19960,0x202b0,0x0,0x19b70,0x19f70,0x205c0,0x0
.long 0x1a180,0x1a580,0x208d0,0x0,0x1a790,0x1ab90,0x20be0,0x0,0x1ada0,0x1b1a0,0x20ef0,0x0,0x1b3b0,0x1b7b0,0x21200,0x0
.long 0x1b9c0,0x1bdc0,0x21510,0x0,0x1bfd0,0x1c3d0,0x21820,0x0,0x1c5e0,0x1c9e0,0x21b30,0x0,0x1cbf0,0x1cff0,0x21e40,0x0
.long 0x17120,0x17508,0x1f060,0x0,0x17730,0x17b18,0x1f370,0x0,0x17d40,0x18128,0x1f680,0x0,0x18350,0x18738,0x1f990,0x0
.long 0x18960,0x18d48,0x1fca0,0x0,0x18f70,0x19358,0x1ffb0,0x0,0x19580,0x19968,0x202c0,0x0,0x19b90,0x19f78,0x205d0,0x0
.long 0x1a1a0,0x1a588,0x208e0,0x0,0x1a7b0,0x1ab98,0x20bf0,0x0,0x1adc0,0x1b1a8,0x20f00,0x0,0x1b3d0,0x1b7b8,0x21210,0x0
.long 0x1b9e0,0x1bdc8,0x21520,0x0,0x1bff0,0x1c3d8,0x21830,0x0,0x1c600,0x1c9e8,0x21b40,0x0,0x1cc10,0x1cff8,0x21e50,0x0
.long 0x17140,0x17510,0x1f070,0x0,0x17750,0x17b20,0x1f380,0x0,0x17d60,0x18130,0x1f690,0x0,0x18370,0x18740,0x1f9a0,0x0
.long 0x18980,0x18d50,0x1fcb0,0x0,0x18f90,0x19360,0x1ffc0,0x0,0x195a0,0x19970,0x202d0,0x0,0x19bb0,0x19f80,0x205e0,0x0
.long 0x1a1c0,0x1a590,0x208f0,0x0,0x1a7d0,0x1aba0,0x20c00,0x0,0x1ade0,0x1b1b0,0x20f10,0x0,0x1b3f0,0x1b7c0,0x21220,0x0
.long 0x1ba00,0x1bdd0,0x21530,0x0,0x1c010,0x1c3e0,0x21840,0x0,0x1c620,0x1c9f0,0x21b50,0x0,0x1cc30,0x1d000,0x21e60,0x0
.long 0x17160,0x17518,0x1f080,0x0,0x17770,0x17b28,0x1f390,0x0,0x17d80,0x18138,0x1f6a0,0x0,0x18390,0x18748,0x1f9b0,0x0
.long 0x189a0,0x18d58,0x1fcc0,0x0,0x18fb0,0x19368,0x1ffd0,0x0,0x195c0,0x19978,0x202e0,0x0,0x19bd0,0x19f88,0x205f0,0x0
.long 0x1a1e0,0x1a598,0x20900,0x0,0x1a7f0,0x1aba8,0x20c10,0x0,0x1ae00,0x1b1b8,0x20f20,0x0,0x1b410,0x1b7c8,0x21230,0x0
.long 0x1ba20,0x1bdd8,0x21540,0x0,0x1c030,0x1c3e8,0x21850,0x0,0x1c640,0x1c9f8,0x21b60,0x0,0x1cc50,0x1d008,0x21e70,0x0
.long 0x26100,0x26160,0x26280,0x0,0x26102,0x26162,0x26282,0x0,0x26104,0x26164,0x26284,0x0,0x26106,0x26166,0x26286,0x0
.long 0x26108,0x26168,0x26288,0x0,0x2610a,0x2616a,0x2628a,0x0,0x2610c,0x2616c,0x2628c,0x0,0x2610e,0x2616e,0x2628e,0x0
.long 0x26110,0x26170,0x26290,0x0,0x26112,0x26172,0x26292,0x0,0x26114,0x26174,0x26294,0x0,0x26116,0x26176,0x26296,0x0
.long 0x26118,0x26178,0x26298,0x0,0x2611a,0x2617a,0x2629a,0x0,0x2611c,0x2617c,0x2629c,0x0,0x2611e,0x2617e,0x2629e,0x0
.long 0x26340,0x262e0,0x26280,0x0,0x26342,0x262e2,0x26282,0x0,0x26344,0x262e4,0x26284,0x0,0x26346,0x262e6,0x26286,0x0
.long 0x26348,0x262e8,0x26288,0x0,0x2634a,0x262ea,0x2628a,0x0,0x2634c,0x262ec,0x2628c,0x0,0x2634e,0x262ee,0x2628e,0x0
.long 0x26350,0x262f0,0x26290,0x0,0x26352,0x262f2,0x26292,0x0,0x26354,0x262f4,0x26294,0x0,0x26356,0x262f6,0x26296,0x0
.long 0x26358,0x262f8,0x26298,0x0,0x2635a,0x262fa,0x2629a,0x0,0x2635c,0x262fc,0x2629c,0x0,0x2635e,0x262fe,0x2629e,0x0
.long 0x26100,0x26160,0x26280,0x0,0x26102,0x26162,0x26282,0x0,0x26104,0x26164,0x26284,0x0,0x26106,0x26166,0x26286,0x0
.long 0x26108,0x26168,0x26288,0x0,0x2610a,0x2616a,0x2628a,0x0,0x2610c,0x2616c,0x2628c,0x0,0x2610e,0x2616e,0x2628e,0x0
.long 0x26110,0x26170,0x26290,0x0,0x26112,0x26172,0x26292,0x0,0x26114,0x26174,0x26294,0x0,0x26116,0x26176,0x26296,0x0
.long 0x26118,0x26178,0x26298,0x0,0x2611a,0x2617a,0x2629a,0x0,0x2611c,0x2617c,0x2629c,0x0,0x2611e,0x2617e,0x2629e,0x0
.long 0x26340,0x262e0,0x26280,0x0,0x26342,0x262e2,0x26282,0x0,0x26344,0x262e4,0x26284,0x0,0x26346,0x262e6,0x26286,0x0
.long 0x26348,0x262e8,0x26288,0x0,0x2634a,0x262ea,0x2628a,0x0,0x2634c,0x262ec,0x2628c,0x0,0x2634e,0x262ee,0x2628e,0x0
.long 0x26350,0x262f0,0x26290,0x0,0x26352,0x262f2,0x26292,0x0,0x26354,0x262f4,0x26294,0x0,0x26356,0x262f6,0x26296,0x0
.long 0x26358,0x262f8,0x26298,0x0,0x2635a,0x262fa,0x2629a,0x0,0x2635c,0x262fc,0x2629c,0x0,0x2635e,0x262fe,0x2629e,0x0
.long 0xffffffff,0x0,0xffff,0x0,0xffffffff,0x0,0xffff,0x0,0xffffffff,0x0,0xffff,0x0,0xffffffff,0x0,0xffff,0x0
.long 0x0,0xffffffff,0xffff,0x0,0x0,0xffffffff,0xffff,0x0,0x0,0xffffffff,0xffff,0x0,0x0,0xffffffff,0xffff,0x0
.long 0x0,0x0,0xffff,0x0,0x0,0x0,0xffff,0x0,0x0,0x0,0xffff,0x0,0x0,0x0,0xffff,0x0
.long 0x0,0x0,0xffff,0x0,0x0,0x0,0xffff,0x0,0x0,0x0,0xffff,0x0,0x0,0x0,0xffff,0x0
.long 0xffffffff,0x0,0x0,0x3f80,0xffffffff,0x0,0x0,0x3f80,0xffffffff,0x0,0x0,0x3f80,0xffffffff,0x0,0x0,0x3f80
.long 0x0,0xffffffff,0x0,0x3f80,0x0,0xffffffff,0x0,0x3f80,0x0,0xffffffff,0x0,0x3f80,0x0,0xffffffff,0x0,0x3f80
.long 0x0,0x0,0x0,0x3f80,0x0,0x0,0x0,0x3f80,0x0,0x0,0x0,0x3f80,0x0,0x0,0x0,0x3f80
.long 0x0,0x0,0x0,0x3f80,0x0,0x0,0x0,0x3f80,0x0,0x0,0x0,0x3f80,0x0,0x0,0x0,0x3f80
.long 0x0,0x0,0xffff,0x0,0x0,0x0,0xffff,0x0,0x0,0x0,0xffff,0x0,0x0,0x0,0xffff,0x0
.long 0x0,0x0,0xffff,0x0,0x0,0x0,0xffff,0x0,0x0,0x0,0xffff,0x0,0x0,0x0,0xffff,0x0
.long 0xffffffff,0x0,0xffff,0x0,0xffffffff,0x0,0xffff,0x0,0xffffffff,0x0,0xffff,0x0,0xffffffff,0x0,0xffff,0x0
.long 0x0,0xffffffff,0xffff,0x0,0x0,0xffffffff,0xffff,0x0,0x0,0xffffffff,0xffff,0x0,0x0,0xffffffff,0xffff,0x0
.long 0x0,0x0,0x0,0x3f80,0x0,0x0,0x0,0x3f80,0x0,0x0,0x0,0x3f80,0x0,0x0,0x0,0x3f80
.long 0x0,0x0,0x0,0x3f80,0x0,0x0,0x0,0x3f80,0x0,0x0,0x0,0x3f80,0x0,0x0,0x0,0x3f80
.long 0xffffffff,0x0,0x0,0x3f80,0xffffffff,0x0,0x0,0x3f80,0xffffffff,0x0,0x0,0x3f80,0xffffffff,0x0,0x0,0x3f80
.long 0x0,0xffffffff,0x0,0x3f80,0x0,0xffffffff,0x0,0x3f80,0x0,0xffffffff,0x0,0x3f80,0x0,0xffffffff,0x0,0x3f80
.long 0xffff,0x0,0x0,0x0,0xffff0000,0x0,0x0,0x0,0x0,0xffff,0x0,0x0,0x0,0xffff0000,0x0,0x0
.long 0x0,0x0,0xffff,0x0,0x0,0x0,0xffff0000,0x0,0x0,0x0,0x0,0xffff,0x0,0x0,0x0,0xffff0000
.long 0x0,0x0,0x0,0x0,0x0,0x0,0x0,0x0,0x0,0x0,0x0,0x0,0x0,0x0,0x0,0x0
.long 0x0,0x0,0x0,0x0,0x0,0x0,0x0,0x0,0x0,0x0,0x0,0x0,0x0,0x0,0x0,0x0
.long 0xffff,0x0,0x0,0x0,0xffff0000,0x0,0x0,0x0,0x0,0xffff,0x0,0x0,0x0,0xffff0000,0x0,0x0
.long 0x0,0x0,0xffff,0x0,0x0,0x0,0xffff0000,0x0,0x0,0x0,0x0,0xffff,0x0,0x0,0x0,0xffff0000
.long 0x0,0x0,0x0,0x0,0x0,0x0,0x0,0x0,0x0,0x0,0x0,0x0,0x0,0x0,0x0,0x0
.long 0x0,0x0,0x0,0x0,0x0,0x0,0x0,0x0,0x0,0x0,0x0,0x0,0x0,0x0,0x0,0x0
.long 0x0,0x0,0x0,0x0,0x0,0x0,0x0,0x0,0x0,0x0,0x0,0x0,0x0,0x0,0x0,0x0
.long 0x0,0x0,0x0,0x0,0x0,0x0,0x0,0x0,0x0,0x0,0x0,0x0,0x0,0x0,0x0,0x0
.long 0xffff,0x0,0x0,0x0,0xffff0000,0x0,0x0,0x0,0x0,0xffff,0x0,0x0,0x0,0xffff0000,0x0,0x0
.long 0x0,0x0,0xffff,0x0,0x0,0x0,0xffff0000,0x0,0x0,0x0,0x0,0xffff,0x0,0x0,0x0,0xffff0000
.long 0x0,0x0,0x0,0x0,0x0,0x0,0x0,0x0,0x0,0x0,0x0,0x0,0x0,0x0,0x0,0x0
.long 0x0,0x0,0x0,0x0,0x0,0x0,0x0,0x0,0x0,0x0,0x0,0x0,0x0,0x0,0x0,0x0
.long 0xffff,0x0,0x0,0x0,0xffff0000,0x0,0x0,0x0,0x0,0xffff,0x0,0x0,0x0,0xffff0000,0x0,0x0
.long 0x0,0x0,0xffff,0x0,0x0,0x0,0xffff0000,0x0,0x0,0x0,0x0,0xffff,0x0,0x0,0x0,0xffff0000
.long 0x0,0x0,0x0,0x0,0x0,0x0,0x0,0x0,0x0,0x0,0x0,0x0,0x0,0x0,0x0,0x0
.long 0x0,0x0,0x0,0x0,0x0,0x0,0x0,0x0,0x0,0x0,0x0,0x0,0x0,0x0,0x0,0x0
.long 0x0,0x0,0x0,0x0,0x0,0x0,0x0,0x0,0x0,0x0,0x0,0x0,0x0,0x0,0x0,0x0
.long 0x0,0x0,0x0,0x0,0x0,0x0,0x0,0x0,0x0,0x0,0x0,0x0,0x0,0x0,0x0,0x0
.long 0x0,0x0,0x0,0x0,0x0,0x0,0x0,0x0,0x0,0x0,0x0,0x0,0x0,0x0,0x0,0x0
.long 0x0,0x0,0x0,0x0,0x0,0x0,0x0,0x0,0x0,0x0,0x0,0x0,0x0,0x0,0x0,0x0
.long 0x0,0x0,0x0,0x0,0x0,0x0,0x0,0x0,0x0,0x0,0x0,0x0,0x0,0x0,0x0,0x0
.long 0x0,0x0,0x0,0x0,0x0,0x0,0x0,0x0,0x0,0x0,0x0,0x0,0x0,0x0,0x0,0x0
.long 0x0,0x0,0x0,0x0,0x0,0x0,0x0,0x0,0x0,0x0,0x0,0x0,0x0,0x0,0x0,0x0
.long 0x0,0x0,0x0,0x0,0x0,0x0,0x0,0x0,0x0,0x0,0x0,0x0,0x0,0x0,0x0,0x0
.long 0x0,0x0,0x0,0x0,0x0,0x0,0x0,0x0,0x0,0x0,0x0,0x0,0x0,0x0,0x0,0x0
.long 0x0,0x0,0x0,0x0,0x0,0x0,0x0,0x0,0x0,0x0,0x0,0x0,0x0,0x0,0x0,0x0
.long 0x0,0x0,0x0,0x0,0x0,0x0,0x0,0x0,0x0,0x0,0x0,0x0,0x0,0x0,0x0,0x0
.long 0x0,0x0,0x0,0x0,0x0,0x0,0x0,0x0,0x0,0x0,0x0,0x0,0x0,0x0,0x0,0x0
.long 0x0,0x0,0x0,0x0,0x0,0x0,0x0,0x0,0x0,0x0,0x0,0x0,0x0,0x0,0x0,0x0
.long 0x0,0x0,0x0,0x0,0x0,0x0,0x0,0x0,0x0,0x0,0x0,0x0,0x0,0x0,0x0,0x0
.size L_tab, 12288
.section .rodata,"a"
.p2align 6
.amdhsa_kernel standalone__window_attn_davit__vision_kernel
  .amdhsa_next_free_vgpr 512
  .amdhsa_next_free_sgpr 102
  .amdhsa_accum_offset 256
  .amdhsa_group_segment_fixed_size 0
  .amdhsa_kernarg_size 56
  .amdhsa_user_sgpr_count 2
  .amdhsa_user_sgpr_kernarg_segment_ptr 1
  .amdhsa_system_sgpr_workgroup_id_x 1
.end_amdhsa_kernel
```

```asm
; @launch grid=(256,1,1) block=(256,1,1) lds=163840
.amdgcn_target "amdgcn-amd-amdhsa--gfx950"
.text
.globl standalone__window_attn_davit__vision_kernel
.p2align 8
.type standalone__window_attn_davit__vision_kernel,@function
standalone__window_attn_davit__vision_kernel:
s_cmp_ge_u32 s2, 256
s_cbranch_scc1 L_end
v_lshrrev_b32 v1, 6, v0
s_mov_b32 s53, s2
s_mov_b32 s47, 0
v_readfirstlane_b32 s32, v1
s_nop 3
L_start:

s_load_dwordx8 s[56:63], s[0:1], 0
s_load_dwordx2 s[64:65], s[0:1], 32
s_load_dwordx2 s[66:67], s[0:1], 48
s_load_dwordx2 s[100:101], s[0:1], 40
s_getpc_b64 s[68:69]
L_pc:
v_mbcnt_lo_u32_b32 v0, -1, 0
v_mbcnt_hi_u32_b32 v0, -1, v0
s_add_u32 s70, s68, L_tab-L_pc
s_addc_u32 s71, s69, 0
s_add_u32 s98, s68, F_tail-L_pc
s_addc_u32 s99, s69, 0
s_and_b32 s41, s53, 8
s_lshl_b32 s41, s41, 11
s_add_u32 s98, s98, s41
s_addc_u32 s99, s99, 0
s_lshl_b32 s45, s32, 10
v_lshl_add_u32 v1, v0, 4, s45
s_add_u32 m0, s45, 143616
s_nop 0
global_load_lds_dwordx4 v1, s[70:71]
v_add_u32 v1, 4096, v1
s_add_u32 m0, s45, 147712
s_nop 0
global_load_lds_dwordx4 v1, s[70:71]
v_add_u32 v1, 4096, v1
s_add_u32 m0, s45, 151808
s_nop 0
global_load_lds_dwordx4 v1, s[70:71]
s_lshr_b32 s42, s53, 3
s_and_b32 s41, s42, 1
s_lshl_b32 s41, s41, 2
s_add_u32 s41, s41, s32
s_lshl_b32 s41, s41, 13
v_lshlrev_b32 v2, 7, v0
v_add_u32 v3, s41, v2
s_cmp_lt_u32 s42, 4
s_cbranch_scc0 L_nopf
global_load_dword v255, v3, s[68:69]
L_nopf:
s_and_b32 s41, s53, 7
s_mul_i32 s43, s41, 640
s_mov_b32 s34, 5329
s_add_u32 s33, s43, s42
s_mov_b32 s35, s33
s_mov_b32 s72, 402653183
s_mul_i32 s54, s32, 96
s_mul_i32 s55, s32, 3072
s_mul_hi_u32 s41, s33, 58835169
s_mul_i32 s28, s41, 73
s_sub_u32 s28, s33, s28
s_mul_i32 s29, s41, 1373568
s_mul_i32 s41, s28, 2688
s_add_u32 s29, s29, s41
s_lshl_b32 s41, s32, 6
v_add_u32 v4, s41, v0
v_mul_u32_u24 v5, 2622, v4
v_lshrrev_b32 v5, 16, v5
v_mul_u32_u24 v6, 25, v5
v_sub_u32 v6, v4, v6
v_mul_u32_u24 v7, 384, v5
v_lshl_add_u32 v7, v6, 4, v7
v_cmp_eq_u32 vcc, 0, v5
v_or_b32 v10, 134217728, v7
s_nop 0
v_cndmask_b32 v7, v7, v10, vcc
v_cmp_eq_u32 vcc, 8, v5
v_or_b32 v10, 536870912, v7
s_nop 0
v_cndmask_b32 v7, v7, v10, vcc
v_cmp_lt_u32 vcc, 8, v5
v_or_b32 v10, 268435456, v7
s_nop 0
v_cndmask_b32 v7, v7, v10, vcc
v_cmp_eq_u32 vcc, 24, v6
v_or_b32 v10, 268435456, v7
s_nop 0
v_cndmask_b32 v7, v7, v10, vcc
v_mov_b32 v208, v7
v_add_u32 v4, 0, v0
v_mul_u32_u24 v5, 171, v4
v_lshrrev_b32 v5, 10, v5
v_mul_u32_u24 v6, 6, v5
v_sub_u32 v6, v4, v6
v_lshlrev_b32 v6, 4, v6
v_mul_u32_u24 v8, 1152, v5
v_add_u32 v72, v8, v6
v_mul_u32_u24 v8, 384, v5
v_add_u32 v136, v8, v6
s_lshl_b32 s96, s42, 13
s_mul_hi_u32 s41, s35, 58835169
s_mul_i32 s42, s41, 73
s_sub_u32 s42, s35, s42
s_mul_i32 s43, s41, 1373568
s_mul_i32 s51, s42, 2688
s_add_u32 s43, s43, s51
s_cmp_lt_u32 s35, s34
s_cselect_b32 s50, s43, 1879048192
s_add_u32 s35, s35, 32
s_cmp_eq_u32 s42, 0
s_cselect_b32 s44, 536870911, s72
s_cmp_eq_u32 s42, 72
s_cselect_b32 s44, 939524095, s44
s_cmp_eq_u32 s41, 0
s_cselect_b32 s52, 1879048192, s50
s_waitcnt lgkmcnt(0)
s_mov_b32 s12, s60
s_mov_b32 s13, s61
s_mov_b32 s14, 221184
s_mov_b32 s15, 131072
s_mov_b32 s16, s62
s_mov_b32 s17, s63
s_mov_b32 s18, 73728
s_mov_b32 s19, 131072
s_cmp_eq_u32 s32, 0
s_cbranch_scc0 L_nopf2
buffer_load_dword v255, v2, s[12:15], s96 offen
L_nopf2:
s_and_b32 s96, s96, 131071
s_cmp_eq_u32 s32, 1
s_cbranch_scc0 L_nopf3
buffer_load_dword v255, v2, s[16:19], s96 offen
L_nopf3:
s_sub_u32 s4, s56, 196608
s_subb_u32 s5, s57, 0
s_mov_b32 s6, 100467072
s_mov_b32 s7, 131072
s_mov_b32 s20, s58
s_mov_b32 s21, s59
s_mov_b32 s22, 3456
s_mov_b32 s23, 131072
s_mul_i32 s96, s32, 864
s_mov_b32 exec_hi, 4194303
s_add_u32 m0, s96, 155904
s_nop 0
buffer_load_dwordx4 v136, s[20:23], s54 offen lds
s_mov_b64 exec, -1
s_mov_b32 s36, s50
v_and_b32 v180, s44, v208
s_add_u32 m0, s45, 0
s_nop 0
buffer_load_dwordx4 v180, s[4:7], s52 offen nt lds
s_add_u32 m0, s45, 4112
s_add_u32 s40, s36, 196224
buffer_load_dwordx4 v180, s[4:7], s40 offen nt lds
s_add_u32 m0, s45, 8224
s_add_u32 s40, s36, 392448
buffer_load_dwordx4 v180, s[4:7], s40 offen nt lds
s_add_u32 m0, s45, 12336
s_add_u32 s40, s36, 588672
buffer_load_dwordx4 v180, s[4:7], s40 offen nt lds
s_add_u32 m0, s45, 16448
s_add_u32 s40, s36, 784896
buffer_load_dwordx4 v180, s[4:7], s40 offen nt lds
s_add_u32 m0, s45, 20560
s_add_u32 s40, s36, 981120
buffer_load_dwordx4 v180, s[4:7], s40 offen nt lds
s_add_u32 m0, s45, 24672
s_add_u32 s40, s36, 1177344
buffer_load_dwordx4 v180, s[4:7], s40 offen nt lds
s_add_u32 m0, s45, 28784
s_add_u32 s40, s36, 1373568
buffer_load_dwordx4 v180, s[4:7], s40 offen nt lds
s_add_u32 m0, s45, 32896
s_add_u32 s40, s36, 1569792
buffer_load_dwordx4 v180, s[4:7], s40 offen nt lds
s_mul_i32 s41, s32, 54
v_add_u32 v4, s41, v0
v_mul_u32_u24 v5, 911, v4
v_lshrrev_b32 v5, 16, v5
v_mul_u32_u24 v6, 72, v5
v_sub_u32 v6, v4, v6
s_mov_b32 s43, 196224
v_mul_lo_u32 v5, v5, s43
v_lshl_add_u32 v82, v6, 4, v5
s_add_u32 s20, s29, 785664
s_add_u32 m0, s96, 57600
s_mov_b32 exec_hi, 4194303
buffer_load_dwordx4 v82, s[4:7], s20 offen nt lds
s_mov_b32 exec_hi, -1
s_add_u32 s28, s28, 32
s_cmp_ge_u32 s28, 73
s_cselect_b32 s21, 73, 0
s_cselect_b32 s22, 1177344, 0
s_sub_u32 s28, s28, s21
s_add_u32 s20, s20, s22
s_add_u32 s20, s20, 86016
s_add_u32 m0, s96, 61072
s_mov_b32 exec_hi, 4194303
buffer_load_dwordx4 v82, s[4:7], s20 offen nt lds
s_mov_b32 exec_hi, -1
s_add_u32 s28, s28, 32
s_cmp_ge_u32 s28, 73
s_cselect_b32 s21, 73, 0
s_cselect_b32 s22, 1177344, 0
s_sub_u32 s28, s28, s21
s_add_u32 s20, s20, s22
s_add_u32 s20, s20, 86016
s_add_u32 m0, s96, 64544
s_mov_b32 exec_hi, 4194303
buffer_load_dwordx4 v82, s[4:7], s20 offen nt lds
s_mov_b32 exec_hi, -1
s_add_u32 s28, s28, 32
s_cmp_ge_u32 s28, 73
s_cselect_b32 s21, 73, 0
s_cselect_b32 s22, 1177344, 0
s_sub_u32 s28, s28, s21
s_add_u32 s20, s20, s22
s_add_u32 s20, s20, 86016
s_add_u32 m0, s96, 68016
s_mov_b32 exec_hi, 4194303
buffer_load_dwordx4 v82, s[4:7], s20 offen nt lds
s_mov_b32 exec_hi, -1
v_add_u32 v4, 64, v0
v_mul_u32_u24 v5, 171, v4
v_lshrrev_b32 v5, 10, v5
v_mul_u32_u24 v6, 6, v5
v_sub_u32 v6, v4, v6
v_lshlrev_b32 v6, 4, v6
v_mul_u32_u24 v8, 1152, v5
v_add_u32 v73, v8, v6
v_mul_u32_u24 v8, 384, v5
v_add_u32 v137, v8, v6
s_mov_b32 s8, s64
s_mov_b32 s9, s65
s_mov_b32 s10, 100270464
s_mov_b32 s11, 131072
s_mov_b32 s24, s66
s_mov_b32 s25, s67
s_mov_b32 s26, 6291456
s_mov_b32 s27, 131072
s_mov_b32 s48, 1001040555
s_mov_b32 s73, 1020061065
s_mov_b32 s49, 944335852
s_mov_b32 s3, 1074544643
v_lshlrev_b32 v11, 4, v0
v_add_u32 v11, 143616, v11
s_waitcnt vmcnt(13)
s_barrier
ds_read_b128 v[194:197], v11
ds_read_b128 v[198:201], v11 offset:1024
ds_read_b128 v[202:205], v11 offset:2048
ds_read_b128 v[206:209], v11 offset:3072
ds_read_b128 v[210:213], v11 offset:4096
ds_read_b128 v[214:217], v11 offset:5120
ds_read_b128 v[110:113], v11 offset:6144
ds_read_b128 v[78:81], v11 offset:7168
ds_read_b128 v[36:39], v11 offset:8192
ds_read_b128 v[40:43], v11 offset:9216
ds_read_b128 v[44:47], v11 offset:10240
s_waitcnt lgkmcnt(7)
v_add_u32 v219, s45, v208
v_mov_b32 v208, v7
v_add_u32 v4, 128, v0
v_mul_u32_u24 v5, 171, v4
v_lshrrev_b32 v5, 10, v5
v_mul_u32_u24 v6, 6, v5
v_sub_u32 v6, v4, v6
v_lshlrev_b32 v6, 4, v6
v_mul_u32_u24 v8, 1152, v5
v_add_u32 v74, v8, v6
v_mul_u32_u24 v8, 384, v5
s_waitcnt lgkmcnt(5)
v_add_u32 v216, v8, v6
s_waitcnt lgkmcnt(2)
v_add_u32 v36, s96, v36
v_add_u32 v37, s96, v37
v_add_u32 v38, s96, v38
ds_read_u16 v48, v36
ds_read_u16 v49, v36 offset:192
ds_read_u16 v50, v37
ds_read_u16 v51, v37 offset:192
ds_read_u16 v52, v38
ds_read_u16 v53, v36 offset:32
ds_read_u16 v54, v36 offset:224
ds_read_u16 v55, v37 offset:32
ds_read_u16 v56, v37 offset:224
ds_read_u16 v57, v38 offset:32
ds_read_u16 v58, v36 offset:64
ds_read_u16 v59, v36 offset:256
ds_read_u16 v60, v37 offset:64
ds_read_u16 v61, v37 offset:256
ds_read_u16 v62, v38 offset:64
v_add_u32 v194, s54, v194
v_add_u32 v195, s54, v195
v_add_u32 v196, s54, v196
v_add_u32 v197, s54, v197
v_add_u32 v198, s54, v198
v_add_u32 v199, s54, v199
v_add_u32 v200, s54, v200
v_add_u32 v201, s54, v201
v_add_u32 v202, s54, v202
v_add_u32 v203, s54, v203
v_add_u32 v204, s54, v204
v_add_u32 v205, s54, v205
v_add_u32 v111, s54, v111
v_add_u32 v112, s54, v112
v_add_u32 v113, s54, v113
v_add_u32 v211, s45, v211
v_add_u32 v110, s55, v110
v_subrev_u32 v128, 94464, v110
v_subrev_u32 v129, 24576, v110
s_lshl_b32 s41, s54, 1
v_add_u32 v121, s41, v80
s_lshr_b32 s41, s32, 1
s_lshl_b32 s41, s41, 10
s_and_b32 s42, s32, 1
s_lshl_b32 s42, s42, 3
s_add_u32 s41, s41, s42
v_add_u32 v212, s41, v212
s_lshl_b32 s41, s32, 2
v_add_u32 v209, s41, v209
s_lshl_b32 s41, s32, 7
v_add_u32 v215, s41, v215
v_add_u32 v214, s41, v214
v_add_u32 v120, s41, v78
s_mul_i32 s41, s32, 4752
v_add_u32 v217, s41, v217
s_waitcnt lgkmcnt(0)
v_and_or_b32 v52, v52, v42, v43
v_lshl_or_b32 v52, v52, 16, v52
v_and_b32 v138, v52, v44
v_and_b32 v139, v52, v45
v_and_b32 v140, v52, v46
v_and_b32 v141, v52, v47
v_and_b32 v142, v48, v40
v_and_b32 v143, v48, v41
v_and_b32 v144, v49, v40
v_and_b32 v145, v49, v41
v_and_b32 v146, v50, v40
v_and_b32 v147, v50, v41
v_and_b32 v148, v51, v40
v_and_b32 v149, v51, v41
v_and_or_b32 v57, v57, v42, v43
v_lshl_or_b32 v57, v57, 16, v57
v_and_b32 v150, v57, v44
v_and_b32 v151, v57, v45
v_and_b32 v152, v57, v46
v_and_b32 v153, v57, v47
v_and_b32 v154, v53, v40
v_and_b32 v155, v53, v41
v_and_b32 v156, v54, v40
v_and_b32 v157, v54, v41
v_and_b32 v158, v55, v40
v_and_b32 v159, v55, v41
v_and_b32 v160, v56, v40
v_and_b32 v161, v56, v41
v_and_or_b32 v62, v62, v42, v43
v_lshl_or_b32 v62, v62, 16, v62
v_and_b32 v162, v62, v44
v_and_b32 v163, v62, v45
v_and_b32 v164, v62, v46
v_and_b32 v165, v62, v47
v_and_b32 v166, v58, v40
v_and_b32 v167, v58, v41
v_and_b32 v168, v59, v40
v_and_b32 v169, v59, v41
v_and_b32 v170, v60, v40
v_and_b32 v171, v60, v41
v_and_b32 v172, v61, v40
v_and_b32 v173, v61, v41
v_mov_b32 v190, 1065369472
v_mov_b32 v191, 1065369472
v_mov_b32 v192, 1065369472
v_mov_b32 v193, 1065369472
v_mov_b32 v218, 0
s_mov_b32 s30, 16712191
s_mov_b32 s31, 4278255360
s_mov_b32 s56, 983055
s_mov_b32 s57, 983055
s_waitcnt vmcnt(4) lgkmcnt(0)
s_barrier

s_cmp_lg_u32 s47, 0
s_cbranch_scc1 L_safe
.p2align 3
s_add_u32 s28, s28, 32
s_cmp_ge_u32 s28, 73
s_cselect_b32 s21, 73, 0
s_cselect_b32 s22, 1177344, 0
s_sub_u32 s28, s28, s21
s_add_u32 s20, s20, s22
s_add_u32 s20, s20, 86016
s_add_u32 m0, s96, 71488
s_mov_b32 exec_hi, 4194303
buffer_load_dwordx4 v82, s[4:7], s20 offen nt lds
s_mov_b32 exec_hi, -1
s_add_u32 s28, s28, 32
s_cmp_ge_u32 s28, 73
s_cselect_b32 s21, 73, 0
s_cselect_b32 s22, 1177344, 0
s_sub_u32 s28, s28, s21
s_add_u32 s20, s20, s22
s_add_u32 s20, s20, 86016
s_add_u32 m0, s96, 74960
s_mov_b32 exec_hi, 4194303
buffer_load_dwordx4 v82, s[4:7], s20 offen nt lds
s_mov_b32 exec_hi, -1
s_add_u32 s28, s28, 32
s_cmp_ge_u32 s28, 73
s_cselect_b32 s21, 73, 0
s_cselect_b32 s22, 1177344, 0
s_sub_u32 s28, s28, s21
s_add_u32 s20, s20, s22
s_add_u32 s20, s20, 86016
s_add_u32 m0, s96, 78432
s_mov_b32 exec_hi, 4194303
buffer_load_dwordx4 v82, s[4:7], s20 offen nt lds
s_mov_b32 exec_hi, -1
s_add_u32 s28, s28, 32
s_cmp_ge_u32 s28, 73
s_cselect_b32 s21, 73, 0
s_cselect_b32 s22, 1177344, 0
s_sub_u32 s28, s28, s21
s_add_u32 s20, s20, s22
s_add_u32 s20, s20, 86016
s_add_u32 m0, s96, 81904
s_mov_b32 exec_hi, 4194303
buffer_load_dwordx4 v82, s[4:7], s20 offen nt lds
s_mov_b32 exec_hi, -1
s_add_u32 s28, s28, 32
s_cmp_ge_u32 s28, 73
s_cselect_b32 s21, 73, 0
s_cselect_b32 s22, 1177344, 0
s_sub_u32 s28, s28, s21
s_add_u32 s20, s20, s22
s_add_u32 s20, s20, 86016
s_add_u32 m0, s96, 85376
s_mov_b32 exec_hi, 4194303
buffer_load_dwordx4 v82, s[4:7], s20 offen nt lds
s_mov_b32 exec_hi, -1
s_add_u32 s28, s28, 32
s_cmp_ge_u32 s28, 73
s_cselect_b32 s21, 73, 0
s_cselect_b32 s22, 1177344, 0
s_sub_u32 s28, s28, s21
s_add_u32 s20, s20, s22
s_add_u32 s20, s20, 86016
s_add_u32 m0, s96, 88848
s_mov_b32 exec_hi, 4194303
buffer_load_dwordx4 v82, s[4:7], s20 offen nt lds
s_mov_b32 exec_hi, -1
s_add_u32 s28, s28, 32
s_cmp_ge_u32 s28, 73
s_cselect_b32 s21, 73, 0
s_cselect_b32 s22, 1177344, 0
s_sub_u32 s28, s28, s21
s_add_u32 s20, s20, s22
s_add_u32 s20, s20, 86016
s_add_u32 m0, s96, 92320
s_mov_b32 exec_hi, 4194303
buffer_load_dwordx4 v82, s[4:7], s20 offen nt lds
s_mov_b32 exec_hi, -1
s_add_u32 s28, s28, 32
s_cmp_ge_u32 s28, 73
s_cselect_b32 s21, 73, 0
s_cselect_b32 s22, 1177344, 0
s_sub_u32 s28, s28, s21
s_add_u32 s20, s20, s22
s_add_u32 s20, s20, 86016
s_add_u32 m0, s96, 95792
s_mov_b32 exec_hi, 4194303
buffer_load_dwordx4 v82, s[4:7], s20 offen nt lds
s_mov_b32 exec_hi, -1
ds_read_b128 v[84:87], v200
ds_read_b128 v[92:95], v201
ds_read_b128 v[100:103], v202
ds_read_b128 v[88:91], v194 offset:16
ds_read_b128 v[96:99], v195 offset:16
s_mul_hi_u32 s41, s35, 58835169
s_mul_i32 s42, s41, 73
s_sub_u32 s42, s35, s42
s_mul_i32 s43, s41, 1373568
s_mul_i32 s51, s42, 2688
s_add_u32 s43, s43, s51
s_cmp_lt_u32 s35, s34
s_cselect_b32 s50, s43, 1879048192
s_add_u32 s35, s35, 32
s_cmp_eq_u32 s42, 0
s_cselect_b32 s44, 536870911, s72
s_cmp_eq_u32 s42, 72
s_cselect_b32 s44, 939524095, s44
s_cmp_eq_u32 s41, 0
s_cselect_b32 s52, 1879048192, s50
v_and_b32 v180, s44, v208
s_mov_b32 s37, s50
s_mul_hi_u32 s41, s35, 58835169
ds_read_b128 v[104:107], v196 offset:16
s_waitcnt lgkmcnt(5)
v_mfma_f32_16x16x32_bf16 v[0:3], v[138:141], v[84:87], 0
s_waitcnt lgkmcnt(4)
ds_read_b128 v[84:87], v194
s_mov_b64 exec, s[30:31]
ds_write_b128 v217, v[138:141]
s_mov_b64 exec, -1
v_mfma_f32_16x16x32_bf16 v[12:15], v[138:141], v[92:95], 0
s_mul_i32 s42, s41, 73
s_mul_i32 s43, s41, 1373568
s_waitcnt lgkmcnt(5)
v_mfma_f32_16x16x32_bf16 v[24:27], v[138:141], v[100:103], 0
s_mov_b32 s38, s36
ds_read_b128 v[92:95], v195
ds_read_b128 v[100:103], v196
s_mov_b64 exec, s[30:31]
ds_write_b128 v217, v[142:145] offset:528
s_mov_b64 exec, -1
s_add_u32 s28, s28, 32
s_cmp_ge_u32 s28, 73
s_cselect_b32 s21, 73, 0
s_cselect_b32 s22, 1177344, 0
s_sub_u32 s28, s28, s21
s_add_u32 s20, s20, s22
s_add_u32 s20, s20, 86016
s_add_u32 m0, s96, 99264
s_mov_b32 exec_hi, 4194303
buffer_load_dwordx4 v82, s[4:7], s20 offen nt lds
s_mov_b32 exec_hi, -1
s_waitcnt lgkmcnt(4)
v_smfmac_f32_16x16x64_bf16 v[0:3], v[142:145], v[84:91], v213
s_mov_b32 s39, s37
ds_read_b128 v[84:87], v197
ds_read_b128 v[88:91], v197 offset:16
s_mov_b64 exec, s[30:31]
ds_write_b128 v217, v[146:149] offset:1056
s_mov_b64 exec, -1
s_waitcnt lgkmcnt(5)
v_smfmac_f32_16x16x64_bf16 v[12:15], v[142:145], v[92:99], v213
s_waitcnt lgkmcnt(4)
v_smfmac_f32_16x16x64_bf16 v[24:27], v[142:145], v[100:107], v213
ds_read_b128 v[92:95], v198
ds_read_b128 v[96:99], v198 offset:16
ds_read_b128 v[100:103], v199
ds_read_b128 v[104:107], v199 offset:16
s_waitcnt lgkmcnt(5)
v_smfmac_f32_16x16x64_bf16 v[0:3], v[146:149], v[84:91], v213
ds_read_b128 v[84:87], v200 offset:32
ds_read_b128 v[88:91], v194 offset:48
s_mov_b64 exec, s[30:31]
ds_write_b128 v217, v[150:153] offset:1584
s_mov_b64 exec, -1
v_add_f32 v118, v0, v1
v_mul_f32 v119, v0, v0
v_add_f32 v118, v118, v2
v_fmac_f32 v119, v1, v1
v_add_f32 v118, v118, v3
v_fmac_f32_e64 v119, v2, v2
v_fmac_f32 v119, v3, v3
s_waitcnt lgkmcnt(5)
v_smfmac_f32_16x16x64_bf16 v[12:15], v[146:149], v[92:99], v213
s_add_u32 s28, s28, 32
s_cmp_ge_u32 s28, 73
s_cselect_b32 s21, 73, 0
s_cselect_b32 s22, 1177344, 0
s_sub_u32 s28, s28, s21
s_add_u32 s20, s20, s22
s_add_u32 s20, s20, 86016
s_add_u32 m0, s96, 102736
s_mov_b32 exec_hi, 4194303
buffer_load_dwordx4 v82, s[4:7], s20 offen nt lds
s_mov_b32 exec_hi, -1
s_waitcnt lgkmcnt(3)
v_smfmac_f32_16x16x64_bf16 v[24:27], v[146:149], v[100:107], v213
s_waitcnt lgkmcnt(2)
ds_read_b128 v[92:95], v201 offset:32
ds_read_b128 v[100:103], v202 offset:32
v_mfma_f32_16x16x32_bf16 v[4:7], v[150:153], v[84:87], 0
ds_read_b128 v[84:87], v194 offset:32
ds_read_b128 v[96:99], v195 offset:48
ds_read_b128 v[104:107], v196 offset:48
v_add_f32 v126, v12, v13
v_mul_f32 v127, v12, v12
v_add_f32 v126, v126, v14
v_fmac_f32 v127, v13, v13
v_add_f32 v126, v126, v15
v_fmac_f32 v127, v14, v14
v_fmac_f32 v127, v15, v15
v_add_f32 v134, v24, v25
v_mul_f32 v135, v24, v24
v_add_f32 v134, v134, v26
v_fmac_f32 v135, v25, v25
v_add_f32 v134, v134, v27
v_fmac_f32_e64 v135, v26, v26
v_fmac_f32 v135, v27, v27
s_waitcnt lgkmcnt(4)
v_mfma_f32_16x16x32_bf16 v[16:19], v[150:153], v[92:95], 0
ds_read_b128 v[92:95], v195 offset:32
s_mov_b64 exec, s[30:31]
ds_write_b128 v217, v[154:157] offset:2112
s_mov_b64 exec, -1
s_waitcnt lgkmcnt(5)
v_mfma_f32_16x16x32_bf16 v[28:31], v[150:153], v[100:103], 0
s_waitcnt lgkmcnt(4)
v_smfmac_f32_16x16x64_bf16 v[4:7], v[154:157], v[84:91], v213
ds_read_b128 v[100:103], v196 offset:32
ds_read_b128 v[84:87], v197 offset:32
ds_read_b128 v[88:91], v197 offset:48
s_mov_b64 exec, s[30:31]
ds_write_b128 v217, v[158:161] offset:2640
s_mov_b64 exec, -1
s_waitcnt lgkmcnt(5)
v_smfmac_f32_16x16x64_bf16 v[16:19], v[154:157], v[92:99], v213
s_add_u32 s28, s28, 32
s_cmp_ge_u32 s28, 73
s_cselect_b32 s21, 73, 0
s_cselect_b32 s22, 1177344, 0
s_sub_u32 s28, s28, s21
s_add_u32 s20, s20, s22
s_add_u32 s20, s20, 86016
s_add_u32 m0, s96, 106208
s_mov_b32 exec_hi, 4194303
buffer_load_dwordx4 v82, s[4:7], s20 offen nt lds
s_mov_b32 exec_hi, -1
s_waitcnt lgkmcnt(3)
v_smfmac_f32_16x16x64_bf16 v[28:31], v[154:157], v[100:107], v213
ds_read_b128 v[92:95], v198 offset:32
ds_read_b128 v[96:99], v198 offset:48
ds_read_b128 v[100:103], v199 offset:32
ds_read_b128 v[104:107], v199 offset:48
s_waitcnt lgkmcnt(5)
v_smfmac_f32_16x16x64_bf16 v[4:7], v[158:161], v[84:91], v213
ds_read_b128 v[84:87], v200 offset:64
ds_read_b128 v[88:91], v194 offset:80
s_mov_b64 exec, s[30:31]
ds_write_b128 v217, v[162:165] offset:3168
s_mov_b64 exec, -1
v_add_f32 v118, v118, v4
v_fmac_f32 v119, v4, v4
v_add_f32 v118, v118, v5
v_fmac_f32 v119, v5, v5
v_add_f32 v118, v118, v6
v_fmac_f32 v119, v6, v6
v_add_f32 v118, v118, v7
v_fmac_f32 v119, v7, v7
s_waitcnt lgkmcnt(5)
v_smfmac_f32_16x16x64_bf16 v[16:19], v[158:161], v[92:99], v213
s_nop 0
ds_read_b128 v[92:95], v201 offset:64
ds_read_b128 v[96:99], v195 offset:80
s_waitcnt lgkmcnt(5)
v_smfmac_f32_16x16x64_bf16 v[28:31], v[158:161], v[100:107], v213
ds_read_b128 v[100:103], v202 offset:64
s_waitcnt lgkmcnt(5)
v_mfma_f32_16x16x32_bf16 v[8:11], v[162:165], v[84:87], 0
ds_read_b128 v[84:87], v194 offset:64
v_add_f32 v126, v126, v16
v_fmac_f32 v127, v16, v16
v_add_f32 v126, v126, v17
v_fmac_f32 v127, v17, v17
v_add_f32 v126, v126, v18
v_fmac_f32 v127, v18, v18
v_add_f32 v126, v126, v19
v_fmac_f32 v127, v19, v19
v_add_f32 v134, v134, v28
v_fmac_f32 v135, v28, v28
v_add_f32 v134, v134, v29
v_fmac_f32 v135, v29, v29
v_add_f32 v134, v134, v30
s_add_u32 s28, s28, 32
s_cmp_ge_u32 s28, 73
s_cselect_b32 s21, 73, 0
s_cselect_b32 s22, 1177344, 0
s_sub_u32 s28, s28, s21
s_add_u32 s20, s20, s22
s_add_u32 s20, s20, 86016
s_add_u32 m0, s96, 109680
s_mov_b32 exec_hi, 4194303
buffer_load_dwordx4 v82, s[4:7], s20 offen nt lds
s_mov_b32 exec_hi, -1
s_waitcnt lgkmcnt(3)
v_mfma_f32_16x16x32_bf16 v[20:23], v[162:165], v[92:95], 0
s_waitcnt lgkmcnt(1)
ds_read_b128 v[92:95], v195 offset:64
ds_read_b128 v[104:107], v196 offset:80
v_mfma_f32_16x16x32_bf16 v[32:35], v[162:165], v[100:103], 0
s_waitcnt lgkmcnt(2)
ds_read_b128 v[100:103], v196 offset:64
v_fmac_f32 v135, v30, v30
v_smfmac_f32_16x16x64_bf16 v[8:11], v[166:169], v[84:91], v213
ds_read_b128 v[84:87], v197 offset:64
ds_read_b128 v[88:91], v197 offset:80
v_add_f32_e64 v134, v134, v31
v_fmac_f32 v135, v31, v31
s_mov_b64 exec, s[30:31]
ds_write_b128 v217, v[166:169] offset:3696
s_mov_b64 exec, -1
s_waitcnt lgkmcnt(5)
v_smfmac_f32_16x16x64_bf16 v[20:23], v[166:169], v[92:99], v213
ds_read_b128 v[92:95], v198 offset:64
ds_read_b128 v[96:99], v198 offset:80
s_mov_b64 exec, s[30:31]
ds_write_b128 v217, v[170:173] offset:4224
s_mov_b64 exec, -1
s_waitcnt lgkmcnt(6)
v_smfmac_f32_16x16x64_bf16 v[32:35], v[166:169], v[100:107], v213
s_waitcnt lgkmcnt(4)
v_smfmac_f32_16x16x64_bf16 v[8:11], v[170:173], v[84:91], v213
ds_read_b128 v[100:103], v199 offset:64
ds_read_b128 v[104:107], v199 offset:80
s_nop 4
v_add_f32 v118, v118, v8
v_fmac_f32_e64 v119, v8, v8
v_add_f32 v118, v118, v9
s_add_u32 s28, s28, 32
s_cmp_ge_u32 s28, 73
s_cselect_b32 s21, 73, 0
s_cselect_b32 s22, 1177344, 0
s_sub_u32 s28, s28, s21
s_add_u32 s20, s20, s22
s_add_u32 s20, s20, 86016
s_add_u32 m0, s96, 113152
s_mov_b32 exec_hi, 4194303
buffer_load_dwordx4 v82, s[4:7], s20 offen nt lds
s_mov_b32 exec_hi, -1
s_waitcnt lgkmcnt(3)
v_smfmac_f32_16x16x64_bf16 v[20:23], v[170:173], v[92:99], v213
v_fmac_f32 v119, v9, v9
v_add_f32 v118, v118, v10
v_fmac_f32 v119, v10, v10
v_add_f32 v118, v118, v11
v_fmac_f32 v119, v11, v11
s_nop 1
v_add_f32 v126, v126, v20
v_fmac_f32 v127, v20, v20
v_add_f32 v126, v126, v21
v_fmac_f32 v127, v21, v21
v_add_f32 v126, v126, v22
s_waitcnt lgkmcnt(0)
v_smfmac_f32_16x16x64_bf16 v[32:35], v[170:173], v[100:107], v213
v_fmac_f32 v127, v22, v22
v_add_f32 v126, v126, v23
v_fmac_f32 v127, v23, v23
v_permlane16_swap_b32 v118, v119
v_add_f32 v118, v118, v119
s_nop 0
v_add_f32 v134, v134, v32
v_fmac_f32 v135, v32, v32
v_add_f32 v134, v134, v33
v_fmac_f32 v135, v33, v33
v_add_f32 v134, v134, v34
v_fmac_f32 v135, v34, v34
v_add_f32 v134, v134, v35
v_fmac_f32 v135, v35, v35
v_permlane16_swap_b32 v126, v127
v_add_f32 v126, v126, v127
v_permlane16_swap_b32 v134, v135
v_add_f32 v134, v134, v135
v_permlane32_swap_b32 v118, v126
v_add_f32 v118, v118, v126
v_mov_b32 v135, v134
ds_write_b32 v209, v118
v_permlane32_swap_b32 v134, v135
v_add_f32 v134, v134, v135
ds_write_b32 v209, v134 offset:512
s_add_u32 s28, s28, 32
s_cmp_ge_u32 s28, 73
s_cselect_b32 s21, 73, 0
s_cselect_b32 s22, 1177344, 0
s_sub_u32 s28, s28, s21
s_add_u32 s20, s20, s22
s_add_u32 s20, s20, 86016
s_add_u32 m0, s96, 116624
s_mov_b32 exec_hi, 4194303
buffer_load_dwordx4 v82, s[4:7], s20 offen nt lds
s_mov_b32 exec_hi, -1
s_waitcnt lgkmcnt(0)
s_barrier
ds_read_b128 v[102:105], v210 offset:18432
ds_read_b128 v[106:109], v210 offset:19456
s_waitcnt lgkmcnt(1)
v_add_f32 v102, v102, v103
v_add_f32 v104, v104, v105
v_add_f32 v102, v102, v104
v_mul_f32 v103, s48, v102
v_mul_f32 v104, s73, v102
s_waitcnt lgkmcnt(0)
v_add_f32 v106, v106, v107
v_add_f32 v108, v108, v109
v_add_f32 v106, v106, v108
v_mul_f32 v106, s73, v106
v_fma_f32 v106, -v103, v104, v106
v_max_f32 v106, 0, v106
v_add_f32 v106, s49, v106
v_rsq_f32 v102, v106
s_nop 0
v_mul_f32_e64 v103, -v103, v102
ds_write_b64 v211, v[102:103]
ds_read_b64 v[118:119], v219
ds_read_b64 v[126:127], v219 offset:256
ds_read_b64 v[134:135], v219 offset:512
s_add_u32 s28, s28, 32
s_cmp_ge_u32 s28, 73
s_cselect_b32 s21, 73, 0
s_cselect_b32 s22, 1177344, 0
s_sub_u32 s28, s28, s21
s_add_u32 s20, s20, s22
s_add_u32 s20, s20, 86016
s_add_u32 m0, s96, 120096
s_mov_b32 exec_hi, 4194303
buffer_load_dwordx4 v82, s[4:7], s20 offen nt lds
s_mov_b32 exec_hi, -1
s_waitcnt lgkmcnt(2)
v_fma_f32 v220, v0, v118, v119
v_fma_f32 v221, v1, v118, v119
v_cvt_pk_bf16_f32 v90, v220, v221
v_fma_f32 v222, v2, v118, v119
v_fma_f32 v223, v3, v118, v119
v_cvt_pk_bf16_f32 v91, v222, v223
v_fma_f32 v220, v4, v118, v119
v_fma_f32 v221, v5, v118, v119
v_cvt_pk_bf16_f32 v92, v220, v221
v_fma_f32 v222, v6, v118, v119
v_fma_f32 v223, v7, v118, v119
v_cvt_pk_bf16_f32 v93, v222, v223
v_fma_f32 v220, v8, v118, v119
v_fma_f32 v221, v9, v118, v119
v_cvt_pk_bf16_f32 v94, v220, v221
v_fma_f32 v222, v10, v118, v119
v_fma_f32 v223, v11, v118, v119
v_cvt_pk_bf16_f32 v95, v222, v223
s_waitcnt lgkmcnt(0)
v_fma_f32 v220, v12, v126, v127
v_fma_f32 v221, v13, v126, v127
v_cvt_pk_bf16_f32 v174, v220, v221
v_fma_f32 v222, v14, v126, v127
v_fma_f32 v223, v15, v126, v127
v_cvt_pk_bf16_f32 v175, v222, v223
v_fma_f32 v220, v16, v126, v127
v_fma_f32 v221, v17, v126, v127
v_cvt_pk_bf16_f32 v176, v220, v221
v_fma_f32 v222, v18, v126, v127
v_fma_f32 v223, v19, v126, v127
v_cvt_pk_bf16_f32 v177, v222, v223
v_fma_f32 v220, v20, v126, v127
v_fma_f32 v221, v21, v126, v127
v_cvt_pk_bf16_f32 v178, v220, v221
v_fma_f32 v222, v22, v126, v127
v_fma_f32 v223, v23, v126, v127
v_cvt_pk_bf16_f32 v179, v222, v223
v_fma_f32 v220, v24, v134, v135
v_fma_f32 v221, v25, v134, v135
v_fma_f32 v222, v26, v134, v135
v_fma_f32 v223, v27, v134, v135
ds_write_b128 v211, v[90:93]
v_cvt_pk_bf16_f32 v90, v220, v221
v_cvt_pk_bf16_f32 v91, v222, v223
v_fma_f32 v220, v28, v134, v135
v_fma_f32 v221, v29, v134, v135
v_cvt_pk_bf16_f32 v92, v220, v221
s_add_u32 s28, s28, 32
s_cmp_ge_u32 s28, 73
s_cselect_b32 s21, 73, 0
s_cselect_b32 s22, 1177344, 0
s_sub_u32 s28, s28, s21
s_add_u32 s20, s20, s22
s_add_u32 s20, s20, 86016
s_add_u32 m0, s96, 123568
s_mov_b32 exec_hi, 4194303
buffer_load_dwordx4 v82, s[4:7], s20 offen nt lds
s_mov_b32 exec_hi, -1
s_add_u32 m0, s55, 131328
s_add_u32 s29, s54, 384
buffer_load_dwordx4 v72, s[12:15], s29 offen lds
s_add_u32 m0, s55, 132352
s_add_u32 s29, s54, 384
buffer_load_dwordx4 v73, s[12:15], s29 offen lds
s_add_u32 m0, s55, 133376
s_add_u32 s29, s54, 384
buffer_load_dwordx4 v74, s[12:15], s29 offen lds
ds_write_b64 v212, v[94:95]
s_add_u32 m0, s55, 0
s_add_u32 s29, s54, 37248
buffer_load_dwordx4 v72, s[12:15], s29 offen lds
ds_write_b128 v211, v[174:177] offset:6144
s_add_u32 m0, s55, 1024
s_add_u32 s29, s54, 37248
buffer_load_dwordx4 v73, s[12:15], s29 offen lds
s_add_u32 m0, s55, 2048
s_add_u32 s29, s54, 37248
buffer_load_dwordx4 v74, s[12:15], s29 offen lds
ds_write_b64 v212, v[178:179] offset:6144
v_fma_f32 v222, v30, v134, v135
v_fma_f32 v223, v31, v134, v135
v_cvt_pk_bf16_f32 v93, v222, v223
v_fma_f32 v220, v32, v134, v135
v_fma_f32 v221, v33, v134, v135
v_cvt_pk_bf16_f32 v94, v220, v221
v_fma_f32 v222, v34, v134, v135
v_fma_f32 v223, v35, v134, v135
v_cvt_pk_bf16_f32 v95, v222, v223
ds_write_b128 v211, v[90:93] offset:12288
s_add_u32 m0, s55, 12288
s_add_u32 s29, s54, 74112
buffer_load_dwordx4 v72, s[12:15], s29 offen lds
ds_write_b64 v212, v[94:95] offset:12288
s_add_u32 m0, s55, 13312
s_add_u32 s29, s54, 74112
buffer_load_dwordx4 v73, s[12:15], s29 offen lds
s_add_u32 m0, s55, 14336
s_add_u32 s29, s54, 74112
buffer_load_dwordx4 v74, s[12:15], s29 offen lds
s_add_u32 m0, s55, 24576
s_add_u32 s29, s54, 110976
buffer_load_dwordx4 v72, s[12:15], s29 offen lds
s_add_u32 m0, s55, 25600
s_add_u32 s29, s54, 110976
buffer_load_dwordx4 v73, s[12:15], s29 offen lds
s_add_u32 m0, s55, 26624
s_add_u32 s29, s54, 110976
buffer_load_dwordx4 v74, s[12:15], s29 offen lds
s_waitcnt vmcnt(3) lgkmcnt(0)
ds_read_b64_tr_b16 a[0:1], v110 offset:36864
ds_read_b64_tr_b16 a[24:25], v110 offset:36896
ds_read_b64_tr_b16 a[48:49], v110 offset:36928
ds_read_b64_tr_b16 a[2:3], v110 offset:38400
ds_read_b64_tr_b16 a[26:27], v110 offset:38432
ds_read_b64_tr_b16 a[50:51], v110 offset:38464
ds_read_b64_tr_b16 a[4:5], v128 offset:1536
ds_read_b64_tr_b16 a[28:29], v128 offset:1568
ds_read_b64_tr_b16 a[52:53], v128 offset:1600
ds_read_b64_tr_b16 a[16:17], v128
ds_read_b64_tr_b16 a[40:41], v128 offset:32
ds_read_b64_tr_b16 a[64:65], v128 offset:64
ds_read_b64_tr_b16 a[6:7], v128 offset:12288
s_barrier
ds_read_b64_tr_b16 a[30:31], v128 offset:12320
ds_read_b64_tr_b16 a[54:55], v128 offset:12352
ds_read_b64_tr_b16 a[18:19], v128 offset:13824
ds_read_b64_tr_b16 a[42:43], v128 offset:13856
ds_read_b64_tr_b16 a[66:67], v128 offset:13888
s_waitcnt vmcnt(1)
ds_read_b64_tr_b16 a[8:9], v128 offset:24576
ds_read_b64_tr_b16 a[32:33], v128 offset:24608
ds_read_b64_tr_b16 a[56:57], v128 offset:24640
s_waitcnt vmcnt(0)
ds_read_b64_tr_b16 a[10:11], v128 offset:26112
ds_read_b64_tr_b16 a[34:35], v128 offset:26144
ds_read_b64_tr_b16 a[58:59], v128 offset:26176
ds_read_b128 v[84:87], v113
ds_read_b128 v[92:95], v113 offset:55552
ds_read_b128 v[100:103], v111
ds_read_b128 v[104:107], v111 offset:16
ds_read_b128 v[88:91], v111 offset:55568
ds_read_b128 v[96:99], v112 offset:16
s_waitcnt lgkmcnt(5)
v_mfma_f32_16x16x32_bf16 v[36:39], v[138:141], v[84:87], 0
ds_read_b128 v[84:87], v111 offset:55552
s_waitcnt lgkmcnt(5)
v_mfma_f32_16x16x32_bf16 v[48:51], v[138:141], v[92:95], 0
ds_read_b128 v[92:95], v112
s_waitcnt lgkmcnt(4)
v_smfmac_f32_16x16x64_bf16 v[36:39], v[142:145], v[100:107], v213
ds_read_b128 v[100:103], v112 offset:55552
ds_read_b128 v[104:107], v112 offset:55568
s_waitcnt lgkmcnt(3)
v_smfmac_f32_16x16x64_bf16 v[48:51], v[142:145], v[84:91], v213
ds_read_b128 v[84:87], v113 offset:32
ds_read_b128 v[88:91], v111 offset:55600
s_waitcnt lgkmcnt(4)
v_smfmac_f32_16x16x64_bf16 v[36:39], v[146:149], v[92:99], v213
ds_read_b128 v[92:95], v113 offset:55584
ds_read_b128 v[96:99], v112 offset:48
s_nop 4
v_add_f32 v118, v36, v37
v_mul_f32 v119, v36, v36
v_add_f32 v118, v118, v38
v_fmac_f32 v119, v37, v37
s_waitcnt lgkmcnt(4)
v_smfmac_f32_16x16x64_bf16 v[48:51], v[146:149], v[100:107], v213
ds_read_b128 v[100:103], v111 offset:32
ds_read_b128 v[104:107], v111 offset:48
v_add_f32 v118, v118, v39
v_fmac_f32 v119, v38, v38
v_fmac_f32 v119, v39, v39
s_waitcnt lgkmcnt(5)
v_mfma_f32_16x16x32_bf16 v[40:43], v[150:153], v[84:87], 0
ds_read_b128 v[84:87], v111 offset:55584
v_add_f32 v126, v48, v49
v_mul_f32 v127, v48, v48
v_add_f32_e64 v126, v126, v50
v_fmac_f32 v127, v49, v49
s_waitcnt lgkmcnt(4)
v_mfma_f32_16x16x32_bf16 v[52:55], v[150:153], v[92:95], 0
ds_read_b128 v[92:95], v112 offset:32
v_add_f32 v126, v126, v51
v_fmac_f32 v127, v50, v50
v_fmac_f32 v127, v51, v51
s_waitcnt lgkmcnt(2)
v_smfmac_f32_16x16x64_bf16 v[40:43], v[154:157], v[100:107], v213
s_nop 0
ds_read_b128 v[100:103], v112 offset:55584
ds_read_b128 v[104:107], v112 offset:55600
s_waitcnt lgkmcnt(3)
v_smfmac_f32_16x16x64_bf16 v[52:55], v[154:157], v[84:91], v213
ds_read_b128 v[84:87], v113 offset:64
ds_read_b128 v[88:91], v111 offset:55632
s_waitcnt lgkmcnt(4)
v_smfmac_f32_16x16x64_bf16 v[40:43], v[158:161], v[92:99], v213
ds_read_b128 v[92:95], v113 offset:55616
ds_read_b128 v[96:99], v112 offset:80
s_nop 4
v_add_f32 v118, v118, v40
v_fmac_f32 v119, v40, v40
v_add_f32 v118, v118, v41
v_fmac_f32 v119, v41, v41
v_add_f32 v118, v118, v42
v_fmac_f32 v119, v42, v42
v_add_f32 v118, v118, v43
v_fmac_f32 v119, v43, v43
s_waitcnt lgkmcnt(4)
v_smfmac_f32_16x16x64_bf16 v[52:55], v[158:161], v[100:107], v213
s_waitcnt lgkmcnt(3)
ds_read_b128 v[100:103], v111 offset:64
ds_read_b128 v[104:107], v111 offset:80
v_mfma_f32_16x16x32_bf16 v[44:47], v[162:165], v[84:87], 0
ds_read_b128 v[84:87], v111 offset:55616
s_waitcnt lgkmcnt(4)
v_mfma_f32_16x16x32_bf16 v[56:59], v[162:165], v[92:95], 0
ds_read_b128 v[92:95], v112 offset:64
v_add_f32 v126, v126, v52
v_fmac_f32 v127, v52, v52
v_add_f32 v126, v126, v53
v_fmac_f32 v127, v53, v53
v_add_f32 v126, v126, v54
v_fmac_f32 v127, v54, v54
v_add_f32 v126, v126, v55
v_fmac_f32 v127, v55, v55
s_waitcnt lgkmcnt(2)
v_smfmac_f32_16x16x64_bf16 v[44:47], v[166:169], v[100:107], v213
ds_read_b128 v[100:103], v112 offset:55616
ds_read_b128 v[104:107], v112 offset:55632
s_waitcnt lgkmcnt(3)
v_smfmac_f32_16x16x64_bf16 v[56:59], v[166:169], v[84:91], v213
s_waitcnt lgkmcnt(2)
v_smfmac_f32_16x16x64_bf16 v[44:47], v[170:173], v[92:99], v213
s_nop 7
v_add_f32 v118, v118, v44
v_fmac_f32 v119, v44, v44
v_add_f32 v118, v118, v45
v_fmac_f32 v119, v45, v45
v_add_f32 v118, v118, v46
v_fmac_f32 v119, v46, v46
v_add_f32 v118, v118, v47
v_fmac_f32 v119, v47, v47
s_waitcnt lgkmcnt(0)
v_smfmac_f32_16x16x64_bf16 v[56:59], v[170:173], v[100:107], v213
s_barrier
s_add_u32 m0, s55, 94464
s_add_u32 s29, s54, 147840
buffer_load_dwordx4 v72, s[12:15], s29 offen lds
s_add_u32 m0, s55, 95488
s_add_u32 s29, s54, 147840
buffer_load_dwordx4 v73, s[12:15], s29 offen lds
s_add_u32 m0, s55, 96512
s_add_u32 s29, s54, 147840
buffer_load_dwordx4 v74, s[12:15], s29 offen lds
s_add_u32 m0, s55, 106752
s_add_u32 s29, s54, 184704
buffer_load_dwordx4 v72, s[12:15], s29 offen lds
s_add_u32 m0, s55, 107776
s_add_u32 s29, s54, 184704
buffer_load_dwordx4 v73, s[12:15], s29 offen lds
s_nop 1
v_add_f32 v126, v126, v56
v_fmac_f32 v127, v56, v56
v_add_f32 v126, v126, v57
v_fmac_f32 v127, v57, v57
s_add_u32 m0, s55, 108800
s_add_u32 s29, s54, 184704
buffer_load_dwordx4 v74, s[12:15], s29 offen lds
v_add_f32 v126, v126, v58
v_fmac_f32 v127, v58, v58
v_add_f32 v126, v126, v59
v_fmac_f32 v127, v59, v59
v_permlane16_swap_b32 v118, v119
v_add_f32 v118, v118, v119
v_permlane16_swap_b32 v126, v127
v_add_f32 v126, v126, v127
s_add_u32 m0, s55, 119040
s_add_u32 s29, s54, 0
buffer_load_dwordx4 v72, s[12:15], s29 offen lds
s_nop 0
v_permlane32_swap_b32 v118, v126
v_add_f32 v118, v118, v126
ds_write_b32 v209, v118
s_add_u32 m0, s55, 120064
s_add_u32 s29, s54, 0
buffer_load_dwordx4 v73, s[12:15], s29 offen lds
s_waitcnt lgkmcnt(0)
s_barrier
ds_read_b128 v[102:105], v210 offset:18432
ds_read_b128 v[106:109], v210 offset:19456
s_add_u32 m0, s55, 121088
s_add_u32 s29, s54, 0
buffer_load_dwordx4 v74, s[12:15], s29 offen lds
s_add_u32 m0, s55, 69888
s_add_u32 s29, s54, 36864
buffer_load_dwordx4 v72, s[12:15], s29 offen lds
s_waitcnt lgkmcnt(0)
v_add_f32 v102, v102, v103
v_add_f32 v104, v104, v105
v_add_f32 v102, v102, v104
v_mul_f32 v103, s48, v102
v_mul_f32 v104, s73, v102
v_add_f32 v106, v106, v107
v_add_f32 v108, v108, v109
v_add_f32 v106, v106, v108
v_mul_f32 v106, s73, v106
v_fma_f32 v106, -v103, v104, v106
s_add_u32 m0, s55, 70912
s_add_u32 s29, s54, 36864
buffer_load_dwordx4 v73, s[12:15], s29 offen lds
v_max_f32 v106, 0, v106
v_add_f32 v106, s49, v106
v_rsq_f32_e64 v102, v106
s_nop 0
v_mul_f32_e64 v103, -v103, v102
ds_write_b64 v211, v[102:103] offset:20480
s_add_u32 m0, s55, 71936
s_add_u32 s29, s54, 36864
buffer_load_dwordx4 v74, s[12:15], s29 offen lds
ds_read_b64 v[118:119], v219 offset:20480
ds_read_b64 v[126:127], v219 offset:20736
s_add_u32 m0, s55, 82176
s_add_u32 s29, s54, 73728
buffer_load_dwordx4 v72, s[12:15], s29 offen lds
s_waitcnt vmcnt(11) lgkmcnt(1)
ds_read_b64_tr_b16 a[20:21], v110
ds_read_b64_tr_b16 a[44:45], v110 offset:32
ds_read_b64_tr_b16 a[68:69], v110 offset:64
v_fma_f32 v220, v36, v118, v119
v_fma_f32 v221, v37, v118, v119
v_cvt_pk_bf16_f32 v90, v220, v221
v_fma_f32 v222, v38, v118, v119
v_fma_f32 v223, v39, v118, v119
v_cvt_pk_bf16_f32 v91, v222, v223
v_fma_f32 v220, v40, v118, v119
v_fma_f32 v221, v41, v118, v119
s_add_u32 m0, s55, 83200
s_add_u32 s29, s54, 73728
buffer_load_dwordx4 v73, s[12:15], s29 offen lds
v_cvt_pk_bf16_f32 v92, v220, v221
v_fma_f32 v222, v42, v118, v119
s_waitcnt vmcnt(11)
ds_read_b64_tr_b16 a[12:13], v110 offset:1536
ds_read_b64_tr_b16 a[36:37], v110 offset:1568
ds_read_b64_tr_b16 a[60:61], v110 offset:1600
v_fma_f32 v223, v43, v118, v119
v_cvt_pk_bf16_f32 v93, v222, v223
v_fma_f32 v220, v44, v118, v119
v_fma_f32 v221, v45, v118, v119
v_cvt_pk_bf16_f32 v94, v220, v221
s_waitcnt lgkmcnt(6)
s_add_u32 m0, s55, 84224
s_add_u32 s29, s54, 73728
buffer_load_dwordx4 v74, s[12:15], s29 offen lds
ds_write_b128 v211, v[90:93] offset:20480
v_fma_f32 v222, v46, v118, v119
v_fma_f32 v223, v47, v118, v119
v_cvt_pk_bf16_f32 v95, v222, v223
v_fma_f32 v220, v48, v126, v127
v_fma_f32 v221, v49, v126, v127
v_cvt_pk_bf16_f32 v174, v220, v221
s_add_u32 m0, s55, 131328
s_add_u32 s29, s54, 110592
buffer_load_dwordx4 v72, s[12:15], s29 offen lds
ds_write_b64 v212, v[94:95] offset:20480
v_fma_f32 v222, v50, v126, v127
v_fma_f32 v223, v51, v126, v127
s_waitcnt vmcnt(11)
ds_read_b64_tr_b16 a[14:15], v110 offset:12288
ds_read_b64_tr_b16 a[38:39], v110 offset:12320
ds_read_b64_tr_b16 a[62:63], v110 offset:12352
v_cvt_pk_bf16_f32 v175, v222, v223
v_fma_f32 v220, v52, v126, v127
s_add_u32 m0, s55, 132352
s_add_u32 s29, s54, 110592
buffer_load_dwordx4 v73, s[12:15], s29 offen lds
v_fma_f32 v221, v53, v126, v127
v_cvt_pk_bf16_f32 v176, v220, v221
s_waitcnt vmcnt(11)
ds_read_b64_tr_b16 a[22:23], v110 offset:13824
ds_read_b64_tr_b16 a[46:47], v110 offset:13856
v_fma_f32 v222, v54, v126, v127
v_fma_f32 v223, v55, v126, v127
v_cvt_pk_bf16_f32 v177, v222, v223
v_fma_f32 v220, v56, v126, v127
v_fma_f32 v221, v57, v126, v127
v_cvt_pk_bf16_f32 v178, v220, v221
s_add_u32 m0, s55, 133376
s_add_u32 s29, s54, 110592
buffer_load_dwordx4 v74, s[12:15], s29 offen lds
v_fma_f32 v222, v58, v126, v127
v_fma_f32 v223, v59, v126, v127
v_cvt_pk_bf16_f32 v179, v222, v223
ds_read_b64_tr_b16 a[70:71], v110 offset:13888
ds_write_b128 v211, v[174:177] offset:26624
s_waitcnt lgkmcnt(9)
s_add_u32 m0, s55, 94464
s_add_u32 s29, s54, 147456
buffer_load_dwordx4 v72, s[12:15], s29 offen lds
s_waitcnt vmcnt(11)
ds_read_b64_tr_b16 a[216:217], v110 offset:24576
ds_read_b64_tr_b16 a[240:241], v110 offset:24608
ds_read_b64_tr_b16 v[232:233], v110 offset:24640
ds_write_b64 v212, v[178:179] offset:26624
ds_read_b128 v[174:177], v217
s_add_u32 m0, s55, 95488
s_add_u32 s29, s54, 147456
buffer_load_dwordx4 v73, s[12:15], s29 offen lds
s_waitcnt vmcnt(11)
ds_read_b64_tr_b16 a[218:219], v110 offset:26112
ds_read_b64_tr_b16 a[242:243], v110 offset:26144
ds_read_b64_tr_b16 v[234:235], v110 offset:26176
s_waitcnt lgkmcnt(4)
s_add_u32 m0, s55, 96512
s_add_u32 s29, s54, 147456
buffer_load_dwordx4 v74, s[12:15], s29 offen lds
s_barrier
ds_read_b128 v[182:185], v210 offset:20480
ds_read_b128 v[186:189], v210 offset:26624
ds_read_b128 v[114:117], v210 offset:21504
ds_read_b128 v[122:125], v210 offset:27648
s_add_u32 m0, s55, 106752
s_add_u32 s29, s54, 184320
buffer_load_dwordx4 v72, s[12:15], s29 offen lds
s_waitcnt vmcnt(11)
ds_read_b64_tr_b16 a[232:233], v129
ds_read_b64_tr_b16 v[224:225], v129 offset:32
ds_read_b64_tr_b16 v[248:249], v129 offset:64
s_waitcnt lgkmcnt(6)
v_mfma_f32_16x16x32_bf16 v[138:141], a[0:3], v[182:185], 0
v_mfma_f32_16x16x32_bf16 v[142:145], a[24:27], v[182:185], 0
s_add_u32 m0, s55, 107776
s_add_u32 s29, s54, 184320
buffer_load_dwordx4 v73, s[12:15], s29 offen lds
v_mfma_f32_16x16x32_bf16 v[146:149], a[48:51], v[182:185], 0
s_waitcnt vmcnt(11) lgkmcnt(5)
ds_read_b64_tr_b16 a[220:221], v129 offset:1536
ds_read_b64_tr_b16 a[244:245], v129 offset:1568
v_mfma_f32_16x16x32_bf16 v[150:153], a[0:3], v[186:189], 0
ds_read_b64_tr_b16 v[236:237], v129 offset:1600
ds_read_b128 v[182:185], v210 offset:24576
v_mfma_f32_16x16x32_bf16 v[154:157], a[24:27], v[186:189], 0
v_mfma_f32_16x16x32_bf16 v[158:161], a[48:51], v[186:189], 0
s_waitcnt lgkmcnt(8)
s_add_u32 m0, s55, 108800
s_add_u32 s29, s54, 184320
buffer_load_dwordx4 v74, s[12:15], s29 offen lds
v_mfma_f32_16x16x32_bf16 v[138:141], a[4:7], v[114:117], v[138:141]
ds_read_b128 v[186:189], v210 offset:30720
v_mfma_f32_16x16x32_bf16 v[142:145], a[28:31], v[114:117], v[142:145]
v_mfma_f32_16x16x32_bf16 v[146:149], a[52:55], v[114:117], v[146:149]
ds_read_b128 v[114:117], v210 offset:22528
s_waitcnt lgkmcnt(9)
v_mfma_f32_16x16x32_bf16 v[150:153], a[4:7], v[122:125], v[150:153]
s_add_u32 m0, s55, 119040
s_add_u32 s29, s54, 768
buffer_load_dwordx4 v72, s[12:15], s29 offen lds
v_mfma_f32_16x16x32_bf16 v[154:157], a[28:31], v[122:125], v[154:157]
s_waitcnt vmcnt(11)
ds_read_b64_tr_b16 a[222:223], v129 offset:12288
ds_read_b64_tr_b16 a[246:247], v129 offset:12320
v_mfma_f32_16x16x32_bf16 v[158:161], a[52:55], v[122:125], v[158:161]
s_waitcnt lgkmcnt(4)
ds_read_b64_tr_b16 v[238:239], v129 offset:12352
ds_read_b128 v[122:125], v210 offset:28672
v_mfma_f32_16x16x32_bf16 v[138:141], a[16:19], v[182:185], v[138:141]
v_mfma_f32_16x16x32_bf16 v[142:145], a[40:43], v[182:185], v[142:145]
s_nop 0
s_add_u32 m0, s55, 120064
s_add_u32 s29, s54, 768
buffer_load_dwordx4 v73, s[12:15], s29 offen lds
v_mfma_f32_16x16x32_bf16 v[146:149], a[64:67], v[182:185], v[146:149]
s_waitcnt vmcnt(11) lgkmcnt(5)
ds_read_b64_tr_b16 a[234:235], v129 offset:13824
ds_read_b64_tr_b16 v[226:227], v129 offset:13856
v_mfma_f32_16x16x32_bf16 v[150:153], a[16:19], v[186:189], v[150:153]
ds_read_b64_tr_b16 v[250:251], v129 offset:13888
ds_read_b128 v[182:185], v210 offset:23552
v_mfma_f32_16x16x32_bf16 v[154:157], a[40:43], v[186:189], v[154:157]
v_mfma_f32_16x16x32_bf16 v[158:161], a[64:67], v[186:189], v[158:161]
s_waitcnt lgkmcnt(8)
s_add_u32 m0, s55, 121088
s_add_u32 s29, s54, 768
buffer_load_dwordx4 v74, s[12:15], s29 offen lds
v_mfma_f32_16x16x32_bf16 v[138:141], a[8:11], v[114:117], v[138:141]
ds_read_b128 v[186:189], v210 offset:29696
v_mfma_f32_16x16x32_bf16 v[142:145], a[32:35], v[114:117], v[142:145]
v_mfma_f32_16x16x32_bf16 v[146:149], a[56:59], v[114:117], v[146:149]
ds_read_b128 v[114:117], v210 offset:25600
s_waitcnt lgkmcnt(6)
v_mfma_f32_16x16x32_bf16 v[150:153], a[8:11], v[122:125], v[150:153]
s_add_u32 m0, s55, 69888
s_add_u32 s29, s54, 37632
buffer_load_dwordx4 v72, s[12:15], s29 offen lds
v_mfma_f32_16x16x32_bf16 v[154:157], a[32:35], v[122:125], v[154:157]
s_waitcnt vmcnt(11)
ds_read_b64_tr_b16 a[224:225], v110 offset:36864
ds_read_b64_tr_b16 a[248:249], v110 offset:36896
v_mfma_f32_16x16x32_bf16 v[158:161], a[56:59], v[122:125], v[158:161]
s_waitcnt lgkmcnt(4)
ds_read_b64_tr_b16 v[240:241], v110 offset:36928
ds_read_b128 v[122:125], v210 offset:31744
v_mfma_f32_16x16x32_bf16 v[138:141], a[12:15], v[182:185], v[138:141]
v_mfma_f32_16x16x32_bf16 v[142:145], a[36:39], v[182:185], v[142:145]
s_nop 0
s_add_u32 m0, s55, 70912
s_add_u32 s29, s54, 37632
buffer_load_dwordx4 v73, s[12:15], s29 offen lds
v_mfma_f32_16x16x32_bf16 v[146:149], a[60:63], v[182:185], v[146:149]
s_waitcnt vmcnt(11) lgkmcnt(5)
ds_read_b64_tr_b16 a[226:227], v110 offset:38400
ds_read_b64_tr_b16 a[250:251], v110 offset:38432
v_mfma_f32_16x16x32_bf16 v[150:153], a[12:15], v[186:189], v[150:153]
ds_read_b64_tr_b16 v[242:243], v110 offset:38464
ds_read_b128 v[182:185], v210 offset:20480
v_mfma_f32_16x16x32_bf16 v[154:157], a[36:39], v[186:189], v[154:157]
v_mfma_f32_16x16x32_bf16 v[158:161], a[60:63], v[186:189], v[158:161]
s_waitcnt lgkmcnt(8)
s_add_u32 m0, s55, 71936
s_add_u32 s29, s54, 37632
buffer_load_dwordx4 v74, s[12:15], s29 offen lds
v_mfma_f32_16x16x32_bf16 v[138:141], a[20:23], v[114:117], v[138:141]
ds_read_b128 v[186:189], v210 offset:26624
v_mfma_f32_16x16x32_bf16 v[142:145], a[44:47], v[114:117], v[142:145]
v_mfma_f32_16x16x32_bf16 v[146:149], a[68:71], v[114:117], v[146:149]
s_waitcnt lgkmcnt(5)
ds_read_b128 v[114:117], v210 offset:21504
v_cvt_pk_bf16_f32 v60, v138, v139
v_mfma_f32_16x16x32_bf16 v[150:153], a[20:23], v[122:125], v[150:153]
s_add_u32 m0, s55, 82176
s_add_u32 s29, s54, 74496
buffer_load_dwordx4 v72, s[12:15], s29 offen lds
v_mfma_f32_16x16x32_bf16 v[154:157], a[44:47], v[122:125], v[154:157]
s_waitcnt vmcnt(11)
ds_read_b64_tr_b16 a[236:237], v110
ds_read_b64_tr_b16 v[228:229], v110 offset:32
v_mfma_f32_16x16x32_bf16 v[158:161], a[68:71], v[122:125], v[158:161]
s_waitcnt lgkmcnt(4)
ds_read_b64_tr_b16 v[252:253], v110 offset:64
ds_read_b128 v[122:125], v210 offset:27648
v_mfma_f32_16x16x32_bf16 v[162:165], a[216:219], v[182:185], 0
v_cvt_pk_bf16_f32 v61, v140, v141
v_cvt_pk_bf16_f32 v62, v142, v143
v_mfma_f32_16x16x32_bf16 v[166:169], a[240:243], v[182:185], 0
s_add_u32 m0, s55, 83200
s_add_u32 s29, s54, 74496
buffer_load_dwordx4 v73, s[12:15], s29 offen lds
v_mfma_f32_16x16x32_bf16 v[170:173], v[232:235], v[182:185], 0
s_waitcnt vmcnt(11) lgkmcnt(5)
ds_read_b64_tr_b16 a[228:229], v110 offset:1536
ds_read_b64_tr_b16 a[252:253], v110 offset:1568
v_mfma_f32_16x16x32_bf16 v[138:141], a[216:219], v[186:189], 0
s_waitcnt lgkmcnt(6)
ds_read_b64_tr_b16 v[244:245], v110 offset:1600
ds_read_b128 v[182:185], v210 offset:24576
v_mfma_f32_16x16x32_bf16 v[162:165], a[220:223], v[114:117], v[162:165]
v_cvt_pk_bf16_f32 v63, v144, v145
v_cvt_pk_bf16_f32 v64, v146, v147
v_mfma_f32_16x16x32_bf16 v[142:145], a[240:243], v[186:189], 0
s_add_u32 m0, s55, 84224
s_add_u32 s29, s54, 74496
buffer_load_dwordx4 v74, s[12:15], s29 offen lds
v_mfma_f32_16x16x32_bf16 v[166:169], a[244:247], v[114:117], v[166:169]
v_cvt_pk_bf16_f32 v65, v148, v149
v_cvt_pk_bf16_f32 v66, v150, v151
v_mfma_f32_16x16x32_bf16 v[146:149], v[232:235], v[186:189], 0
s_nop 0
ds_read_b128 v[186:189], v210 offset:30720
v_cvt_pk_bf16_f32 v67, v152, v153
v_mfma_f32_16x16x32_bf16 v[170:173], v[236:239], v[114:117], v[170:173]
s_waitcnt lgkmcnt(5)
ds_read_b128 v[114:117], v210 offset:22528
v_cvt_pk_bf16_f32 v68, v154, v155
v_mfma_f32_16x16x32_bf16 v[138:141], a[220:223], v[122:125], v[138:141]
s_add_u32 m0, s55, 131328
s_add_u32 s29, s54, 111360
buffer_load_dwordx4 v72, s[12:15], s29 offen lds
v_mfma_f32_16x16x32_bf16 v[142:145], a[244:247], v[122:125], v[142:145]
s_waitcnt vmcnt(11)
ds_read_b64_tr_b16 a[230:231], v110 offset:12288
ds_read_b64_tr_b16 a[254:255], v110 offset:12320
v_mfma_f32_16x16x32_bf16 v[146:149], v[236:239], v[122:125], v[146:149]
s_waitcnt lgkmcnt(4)
ds_read_b64_tr_b16 v[246:247], v110 offset:12352
ds_read_b128 v[122:125], v210 offset:28672
v_mfma_f32_16x16x32_bf16 v[162:165], a[232:235], v[182:185], v[162:165]
v_cvt_pk_bf16_f32 v69, v156, v157
v_cvt_pk_bf16_f32 v70, v158, v159
v_mfma_f32_16x16x32_bf16 v[166:169], v[224:227], v[182:185], v[166:169]
s_nop 0
s_add_u32 m0, s55, 132352
s_add_u32 s29, s54, 111360
buffer_load_dwordx4 v73, s[12:15], s29 offen lds
v_mfma_f32_16x16x32_bf16 v[170:173], v[248:251], v[182:185], v[170:173]
s_waitcnt vmcnt(11) lgkmcnt(5)
ds_read_b64_tr_b16 a[238:239], v110 offset:13824
ds_read_b64_tr_b16 v[230:231], v110 offset:13856
v_mfma_f32_16x16x32_bf16 v[138:141], a[232:235], v[186:189], v[138:141]
ds_read_b64_tr_b16 v[254:255], v110 offset:13888
ds_read_b128 v[182:185], v210 offset:23552
v_mfma_f32_16x16x32_bf16 v[142:145], v[224:227], v[186:189], v[142:145]
v_cvt_pk_bf16_f32 v71, v160, v161
v_mfma_f32_16x16x32_bf16 v[146:149], v[248:251], v[186:189], v[146:149]
s_waitcnt lgkmcnt(8)
s_add_u32 m0, s55, 133376
s_add_u32 s29, s54, 111360
buffer_load_dwordx4 v74, s[12:15], s29 offen lds
v_mfma_f32_16x16x32_bf16 v[162:165], a[224:227], v[114:117], v[162:165]
ds_read_b128 v[186:189], v210 offset:29696
v_mfma_f32_16x16x32_bf16 v[166:169], a[248:251], v[114:117], v[166:169]
v_mfma_f32_16x16x32_bf16 v[170:173], v[240:243], v[114:117], v[170:173]
ds_read_b128 v[114:117], v210 offset:25600
s_waitcnt lgkmcnt(6)
v_mfma_f32_16x16x32_bf16 v[138:141], a[224:227], v[122:125], v[138:141]
s_add_u32 m0, s55, 94464
s_add_u32 s29, s54, 148224
buffer_load_dwordx4 v72, s[12:15], s29 offen lds
v_mfma_f32_16x16x32_bf16 v[142:145], a[248:251], v[122:125], v[142:145]
s_waitcnt vmcnt(11)
ds_read_b64_tr_b16 a[72:73], v110 offset:24576
ds_read_b64_tr_b16 a[96:97], v110 offset:24608
v_mfma_f32_16x16x32_bf16 v[146:149], v[240:243], v[122:125], v[146:149]
s_waitcnt lgkmcnt(4)
ds_read_b64_tr_b16 a[120:121], v110 offset:24640
ds_read_b128 v[122:125], v210 offset:31744
v_mfma_f32_16x16x32_bf16 v[162:165], a[228:231], v[182:185], v[162:165]
v_mfma_f32_16x16x32_bf16 v[166:169], a[252:255], v[182:185], v[166:169]
s_nop 0
s_add_u32 m0, s55, 95488
s_add_u32 s29, s54, 148224
buffer_load_dwordx4 v73, s[12:15], s29 offen lds
v_mfma_f32_16x16x32_bf16 v[170:173], v[244:247], v[182:185], v[170:173]
s_waitcnt vmcnt(11) lgkmcnt(5)
ds_read_b64_tr_b16 a[74:75], v110 offset:26112
ds_read_b64_tr_b16 a[98:99], v110 offset:26144
v_mfma_f32_16x16x32_bf16 v[138:141], a[228:231], v[186:189], v[138:141]
ds_read_b64_tr_b16 a[122:123], v110 offset:26176
ds_read_b128 v[182:185], v210 offset:20480
v_mfma_f32_16x16x32_bf16 v[142:145], a[252:255], v[186:189], v[142:145]
v_mfma_f32_16x16x32_bf16 v[146:149], v[244:247], v[186:189], v[146:149]
s_waitcnt lgkmcnt(8)
s_add_u32 m0, s55, 96512
s_add_u32 s29, s54, 148224
buffer_load_dwordx4 v74, s[12:15], s29 offen lds
v_mfma_f32_16x16x32_bf16 v[162:165], a[236:239], v[114:117], v[162:165]
ds_read_b128 v[186:189], v210 offset:26624
v_mfma_f32_16x16x32_bf16 v[166:169], v[228:231], v[114:117], v[166:169]
v_mfma_f32_16x16x32_bf16 v[170:173], v[252:255], v[114:117], v[170:173]
s_waitcnt lgkmcnt(5)
ds_read_b128 v[114:117], v210 offset:21504
v_cvt_pk_bf16_f32 v84, v162, v163
v_mfma_f32_16x16x32_bf16 v[138:141], a[236:239], v[122:125], v[138:141]
s_add_u32 m0, s55, 106752
s_add_u32 s29, s54, 185088
buffer_load_dwordx4 v72, s[12:15], s29 offen lds
v_mfma_f32_16x16x32_bf16 v[142:145], v[228:231], v[122:125], v[142:145]
s_waitcnt vmcnt(11)
ds_read_b64_tr_b16 a[88:89], v129
ds_read_b64_tr_b16 a[112:113], v129 offset:32
v_mfma_f32_16x16x32_bf16 v[146:149], v[252:255], v[122:125], v[146:149]
s_waitcnt lgkmcnt(4)
ds_read_b64_tr_b16 a[136:137], v129 offset:64
ds_read_b128 v[122:125], v210 offset:27648
v_mfma_f32_16x16x32_bf16 v[150:153], a[72:75], v[182:185], 0
v_cvt_pk_bf16_f32 v85, v164, v165
v_cvt_pk_bf16_f32 v86, v166, v167
v_mfma_f32_16x16x32_bf16 v[154:157], a[96:99], v[182:185], 0
s_nop 0
s_add_u32 m0, s55, 107776
s_add_u32 s29, s54, 185088
buffer_load_dwordx4 v73, s[12:15], s29 offen lds
v_mfma_f32_16x16x32_bf16 v[158:161], a[120:123], v[182:185], 0
s_waitcnt vmcnt(11) lgkmcnt(5)
ds_read_b64_tr_b16 a[76:77], v129 offset:1536
ds_read_b64_tr_b16 a[100:101], v129 offset:1568
v_mfma_f32_16x16x32_bf16 v[162:165], a[72:75], v[186:189], 0
ds_read_b64_tr_b16 a[124:125], v129 offset:1600
ds_read_b128 v[182:185], v210 offset:24576
v_cvt_pk_bf16_f32 v87, v168, v169
v_mfma_f32_16x16x32_bf16 v[166:169], a[96:99], v[186:189], 0
v_cvt_pk_bf16_f32 v88, v170, v171
s_add_u32 m0, s55, 108800
s_add_u32 s29, s54, 185088
buffer_load_dwordx4 v74, s[12:15], s29 offen lds
v_cvt_pk_bf16_f32 v89, v172, v173
v_mfma_f32_16x16x32_bf16 v[170:173], a[120:123], v[186:189], 0
ds_read_b128 v[186:189], v210 offset:30720
v_cvt_pk_bf16_f32 v96, v138, v139
v_cvt_pk_bf16_f32 v97, v140, v141
v_cvt_pk_bf16_f32 v98, v142, v143
v_cvt_pk_bf16_f32 v99, v144, v145
v_cvt_pk_bf16_f32 v100, v146, v147
v_cvt_pk_bf16_f32 v101, v148, v149
s_add_u32 m0, s45, 0
s_nop 0
buffer_load_dwordx4 v180, s[4:7], s52 offen nt lds
s_waitcnt vmcnt(11)
ds_read_b64_tr_b16 a[78:79], v129 offset:12288
ds_read_b64_tr_b16 a[102:103], v129 offset:12320
ds_read_b64_tr_b16 a[126:127], v129 offset:12352
s_add_u32 m0, s45, 4112
s_add_u32 s40, s37, 196224
buffer_load_dwordx4 v180, s[4:7], s40 offen nt lds
s_waitcnt vmcnt(11)
ds_read_b64_tr_b16 a[90:91], v129 offset:13824
ds_read_b64_tr_b16 a[114:115], v129 offset:13856
ds_read_b64_tr_b16 a[138:139], v129 offset:13888
s_waitcnt lgkmcnt(5)
v_mfma_f32_16x16x32_bf16 v[150:153], a[76:79], v[114:117], v[150:153]
s_waitcnt lgkmcnt(4)
v_mfma_f32_16x16x32_bf16 v[154:157], a[100:103], v[114:117], v[154:157]
s_waitcnt lgkmcnt(3)
s_add_u32 m0, s45, 8224
s_add_u32 s40, s37, 392448
buffer_load_dwordx4 v180, s[4:7], s40 offen nt lds
v_mfma_f32_16x16x32_bf16 v[158:161], a[124:127], v[114:117], v[158:161]
ds_read_b128 v[114:117], v210 offset:22528
v_mfma_f32_16x16x32_bf16 v[162:165], a[76:79], v[122:125], v[162:165]
v_mfma_f32_16x16x32_bf16 v[166:169], a[100:103], v[122:125], v[166:169]
s_add_u32 m0, s45, 12336
s_add_u32 s40, s37, 588672
buffer_load_dwordx4 v180, s[4:7], s40 offen nt lds
v_mfma_f32_16x16x32_bf16 v[170:173], a[124:127], v[122:125], v[170:173]
ds_read_b128 v[122:125], v210 offset:28672
s_waitcnt lgkmcnt(4)
v_mfma_f32_16x16x32_bf16 v[150:153], a[88:91], v[182:185], v[150:153]
s_waitcnt vmcnt(11) lgkmcnt(3)
ds_read_b64_tr_b16 a[80:81], v110 offset:36864
v_mfma_f32_16x16x32_bf16 v[154:157], a[112:115], v[182:185], v[154:157]
s_waitcnt lgkmcnt(3)
ds_read_b64_tr_b16 a[104:105], v110 offset:36896
ds_read_b64_tr_b16 a[128:129], v110 offset:36928
v_mfma_f32_16x16x32_bf16 v[158:161], a[136:139], v[182:185], v[158:161]
s_add_u32 m0, s45, 16448
s_add_u32 s40, s37, 784896
buffer_load_dwordx4 v180, s[4:7], s40 offen nt lds
v_mfma_f32_16x16x32_bf16 v[162:165], a[88:91], v[186:189], v[162:165]
s_nop 0
ds_read_b128 v[182:185], v210 offset:23552
v_mfma_f32_16x16x32_bf16 v[166:169], a[112:115], v[186:189], v[166:169]
s_waitcnt vmcnt(11)
ds_read_b64_tr_b16 a[82:83], v110 offset:38400
v_mfma_f32_16x16x32_bf16 v[170:173], a[136:139], v[186:189], v[170:173]
s_add_u32 m0, s45, 20560
s_add_u32 s40, s37, 981120
buffer_load_dwordx4 v180, s[4:7], s40 offen nt lds
ds_read_b64_tr_b16 a[106:107], v110 offset:38432
ds_read_b64_tr_b16 a[130:131], v110 offset:38464
ds_read_b128 v[186:189], v210 offset:29696
s_waitcnt lgkmcnt(3)
v_mfma_f32_16x16x32_bf16 v[150:153], a[80:83], v[114:117], v[150:153]
s_add_u32 m0, s45, 24672
s_add_u32 s40, s37, 1177344
buffer_load_dwordx4 v180, s[4:7], s40 offen nt lds
v_mfma_f32_16x16x32_bf16 v[162:165], a[80:83], v[122:125], v[162:165]
s_waitcnt lgkmcnt(2)
v_mfma_f32_16x16x32_bf16 v[154:157], a[104:107], v[114:117], v[154:157]
s_waitcnt lgkmcnt(1)
v_mfma_f32_16x16x32_bf16 v[158:161], a[128:131], v[114:117], v[158:161]
s_add_u32 m0, s45, 28784
s_add_u32 s40, s37, 1373568
buffer_load_dwordx4 v180, s[4:7], s40 offen nt lds
v_mfma_f32_16x16x32_bf16 v[166:169], a[104:107], v[122:125], v[166:169]
s_waitcnt vmcnt(12)
ds_read_b64_tr_b16 a[92:93], v110
ds_read_b64_tr_b16 a[116:117], v110 offset:32
v_mfma_f32_16x16x32_bf16 v[170:173], a[128:131], v[122:125], v[170:173]
ds_read_b64_tr_b16 a[140:141], v110 offset:64
ds_read_b128 v[114:117], v210 offset:25600
ds_read_b128 v[122:125], v210 offset:31744
s_add_u32 m0, s45, 32896
s_add_u32 s40, s37, 1569792
buffer_load_dwordx4 v180, s[4:7], s40 offen nt lds
ds_read_b128 v[178:181], v217 offset:528
s_waitcnt vmcnt(12)
ds_read_b64_tr_b16 a[84:85], v110 offset:1536
ds_read_b64_tr_b16 a[108:109], v110 offset:1568
ds_read_b64_tr_b16 a[132:133], v110 offset:1600
s_add_u32 m0, s55, 69888
s_add_u32 s29, s54, 0
buffer_load_dwordx4 v136, s[16:19], s29 offen lds
s_add_u32 m0, s55, 70912
s_add_u32 s29, s54, 0
buffer_load_dwordx4 v137, s[16:19], s29 offen lds
s_waitcnt vmcnt(12)
ds_read_b64_tr_b16 a[86:87], v110 offset:12288
ds_read_b64_tr_b16 a[110:111], v110 offset:12320
ds_read_b64_tr_b16 a[134:135], v110 offset:12352
s_add_u32 m0, s55, 71936
s_add_u32 s29, s54, 0
buffer_load_dwordx4 v216, s[16:19], s29 offen lds
s_waitcnt vmcnt(12)
ds_read_b64_tr_b16 a[94:95], v110 offset:13824
ds_read_b64_tr_b16 a[118:119], v110 offset:13856
ds_read_b64_tr_b16 a[142:143], v110 offset:13888
s_waitcnt lgkmcnt(5)
v_mfma_f32_16x16x32_bf16 v[150:153], a[84:87], v[182:185], v[150:153]
s_waitcnt lgkmcnt(4)
v_mfma_f32_16x16x32_bf16 v[154:157], a[108:111], v[182:185], v[154:157]
s_waitcnt lgkmcnt(3)
v_mfma_f32_16x16x32_bf16 v[158:161], a[132:135], v[182:185], v[158:161]
s_nop 0
s_add_u32 m0, s55, 82176
s_add_u32 s29, s54, 12288
buffer_load_dwordx4 v136, s[16:19], s29 offen lds
v_mfma_f32_16x16x32_bf16 v[162:165], a[84:87], v[186:189], v[162:165]
ds_read_b128 v[182:185], v210
v_mfma_f32_16x16x32_bf16 v[166:169], a[108:111], v[186:189], v[166:169]
s_waitcnt lgkmcnt(1)
s_barrier
v_mfma_f32_16x16x32_bf16 v[170:173], a[132:135], v[186:189], v[170:173]
ds_read_b128 v[186:189], v210 offset:1024
s_add_u32 m0, s55, 83200
s_add_u32 s29, s54, 12288
buffer_load_dwordx4 v137, s[16:19], s29 offen lds
v_mfma_f32_16x16x32_bf16 v[150:153], a[92:95], v[114:117], v[150:153]
ds_write_b128 v121, v[36:39]
v_mfma_f32_16x16x32_bf16 v[154:157], a[116:119], v[114:117], v[154:157]
v_cvt_pk_bf16_f32 v90, v150, v151
v_cvt_pk_bf16_f32 v91, v152, v153
v_mfma_f32_16x16x32_bf16 v[158:161], a[140:143], v[114:117], v[158:161]
s_add_u32 m0, s55, 84224
s_add_u32 s29, s54, 12288
buffer_load_dwordx4 v216, s[16:19], s29 offen lds
v_mfma_f32_16x16x32_bf16 v[162:165], a[92:95], v[122:125], v[162:165]
v_cvt_pk_bf16_f32 v92, v154, v155
v_cvt_pk_bf16_f32 v93, v156, v157
v_mfma_f32_16x16x32_bf16 v[166:169], a[116:119], v[122:125], v[166:169]
s_nop 0
v_cvt_pk_bf16_f32 v94, v158, v159
v_cvt_pk_bf16_f32 v95, v160, v161
v_mfma_f32_16x16x32_bf16 v[170:173], a[140:143], v[122:125], v[170:173]
s_waitcnt lgkmcnt(2)
v_cvt_pk_bf16_f32 v102, v162, v163
v_cvt_pk_bf16_f32 v103, v164, v165
v_mfma_f32_16x16x32_bf16 v[138:141], a[0:3], v[182:185], 0
v_cvt_pk_bf16_f32 v104, v166, v167
v_cvt_pk_bf16_f32 v105, v168, v169
v_mfma_f32_16x16x32_bf16 v[142:145], a[24:27], v[182:185], 0
v_cvt_pk_bf16_f32 v106, v170, v171
v_cvt_pk_bf16_f32 v107, v172, v173
v_mfma_f32_16x16x32_bf16 v[146:149], a[48:51], v[182:185], 0
ds_write_b128 v121, v[40:43] offset:64
v_mfma_f32_16x16x32_bf16 v[150:153], a[216:219], v[182:185], 0
v_mfma_f32_16x16x32_bf16 v[154:157], a[240:243], v[182:185], 0
v_mfma_f32_16x16x32_bf16 v[158:161], v[232:235], v[182:185], 0
ds_write_b128 v121, v[44:47] offset:128
v_mfma_f32_16x16x32_bf16 v[162:165], v[182:185], a[72:75], 0
v_mfma_f32_16x16x32_bf16 v[166:169], v[182:185], a[96:99], 0
s_nop 0
v_mfma_f32_16x16x32_bf16 v[170:173], v[182:185], a[120:123], 0
s_waitcnt lgkmcnt(3)
ds_read_b128 v[182:185], v210 offset:2048
ds_write_b128 v120, v[84:87]
v_mfma_f32_16x16x32_bf16 v[138:141], a[4:7], v[186:189], v[138:141]
v_mfma_f32_16x16x32_bf16 v[142:145], a[28:31], v[186:189], v[142:145]
v_mfma_f32_16x16x32_bf16 v[146:149], a[52:55], v[186:189], v[146:149]
ds_write_b64 v120, v[88:89] offset:16
v_mfma_f32_16x16x32_bf16 v[150:153], a[220:223], v[186:189], v[150:153]
v_mfma_f32_16x16x32_bf16 v[154:157], a[244:247], v[186:189], v[154:157]
ds_write_b128 v120, v[60:63] offset:512
v_mfma_f32_16x16x32_bf16 v[158:161], v[236:239], v[186:189], v[158:161]
v_mfma_f32_16x16x32_bf16 v[162:165], v[186:189], a[76:79], v[162:165]
v_mfma_f32_16x16x32_bf16 v[166:169], v[186:189], a[100:103], v[166:169]
ds_write_b64 v120, v[64:65] offset:528
v_mfma_f32_16x16x32_bf16 v[170:173], v[186:189], a[124:127], v[170:173]
s_waitcnt lgkmcnt(4)
v_mfma_f32_16x16x32_bf16 v[138:141], a[8:11], v[182:185], v[138:141]
ds_read_b128 v[186:189], v210 offset:3072
ds_write_b128 v120, v[90:93] offset:1024
v_mfma_f32_16x16x32_bf16 v[142:145], a[32:35], v[182:185], v[142:145]
v_mfma_f32_16x16x32_bf16 v[146:149], a[56:59], v[182:185], v[146:149]
v_mfma_f32_16x16x32_bf16 v[150:153], a[224:227], v[182:185], v[150:153]
ds_write_b64 v120, v[94:95] offset:1040
v_mfma_f32_16x16x32_bf16 v[154:157], a[248:251], v[182:185], v[154:157]
v_mfma_f32_16x16x32_bf16 v[158:161], v[240:243], v[182:185], v[158:161]
s_mov_b64 exec, s[56:57]
ds_write_b128 v121, v[48:51] offset:12544
s_mov_b64 exec, -1
v_mfma_f32_16x16x32_bf16 v[162:165], v[182:185], a[80:83], v[162:165]
v_mfma_f32_16x16x32_bf16 v[166:169], v[182:185], a[104:107], v[166:169]
s_mov_b64 exec, s[56:57]
ds_write_b128 v121, v[52:55] offset:12608
s_mov_b64 exec, -1
v_mfma_f32_16x16x32_bf16 v[170:173], v[182:185], a[128:131], v[170:173]
s_waitcnt lgkmcnt(4)
v_mfma_f32_16x16x32_bf16 v[138:141], a[12:15], v[186:189], v[138:141]
ds_read_b128 v[182:185], v210 offset:4096
s_mov_b64 exec, s[56:57]
ds_write_b128 v121, v[56:59] offset:12672
s_mov_b64 exec, -1
v_mfma_f32_16x16x32_bf16 v[142:145], a[36:39], v[186:189], v[142:145]
v_mfma_f32_16x16x32_bf16 v[146:149], a[60:63], v[186:189], v[146:149]
s_mov_b64 exec, s[56:57]
ds_write_b128 v120, v[96:99] offset:24832
s_mov_b64 exec, -1
v_mfma_f32_16x16x32_bf16 v[150:153], a[228:231], v[186:189], v[150:153]
v_mfma_f32_16x16x32_bf16 v[154:157], a[252:255], v[186:189], v[154:157]
s_mov_b64 exec, s[56:57]
ds_write_b64 v120, v[100:101] offset:24848
s_mov_b64 exec, -1
v_mfma_f32_16x16x32_bf16 v[158:161], v[244:247], v[186:189], v[158:161]
s_mov_b64 exec, s[56:57]
ds_write_b128 v120, v[66:69] offset:25344
s_mov_b64 exec, -1
v_mfma_f32_16x16x32_bf16 v[162:165], v[186:189], a[84:87], v[162:165]
v_mfma_f32_16x16x32_bf16 v[166:169], v[186:189], a[108:111], v[166:169]
s_nop 0
s_mov_b64 exec, s[56:57]
ds_write_b64 v120, v[70:71] offset:25360
s_mov_b64 exec, -1
v_mfma_f32_16x16x32_bf16 v[170:173], v[186:189], a[132:135], v[170:173]
s_waitcnt lgkmcnt(5)
ds_read_b128 v[186:189], v210 offset:5120
s_mov_b64 exec, s[56:57]
ds_write_b128 v120, v[102:105] offset:25856
s_mov_b64 exec, -1
v_mfma_f32_16x16x32_bf16 v[138:141], a[16:19], v[182:185], v[138:141]
v_mfma_f32_16x16x32_bf16 v[142:145], a[40:43], v[182:185], v[142:145]
s_nop 0
s_mov_b64 exec, s[56:57]
ds_write_b64 v120, v[106:107] offset:25872
s_mov_b64 exec, -1
v_mfma_f32_16x16x32_bf16 v[146:149], a[64:67], v[182:185], v[146:149]
s_waitcnt vmcnt(4)
ds_read_b64_tr_b16 a[144:145], v129
ds_read_b64_tr_b16 a[168:169], v129 offset:32
v_mfma_f32_16x16x32_bf16 v[150:153], a[232:235], v[182:185], v[150:153]
s_barrier
v_mfma_f32_16x16x32_bf16 v[154:157], v[224:227], v[182:185], v[154:157]
s_waitcnt vmcnt(3)
ds_read_b64_tr_b16 a[192:193], v129 offset:64
ds_read_b64_tr_b16 a[146:147], v129 offset:1536
v_mfma_f32_16x16x32_bf16 v[158:161], v[248:251], v[182:185], v[158:161]
s_nop 0
ds_read_b64_tr_b16 a[170:171], v129 offset:1568
ds_read_b64_tr_b16 a[194:195], v129 offset:1600
v_mfma_f32_16x16x32_bf16 v[162:165], v[182:185], a[88:91], v[162:165]
s_waitcnt vmcnt(0)
ds_read_b64_tr_b16 a[148:149], v129 offset:13824
ds_read_b64_tr_b16 a[172:173], v129 offset:13856
v_mfma_f32_16x16x32_bf16 v[166:169], v[182:185], a[112:115], v[166:169]
s_nop 0
ds_read_b64_tr_b16 a[196:197], v129 offset:13888
ds_read_b64_tr_b16 a[160:161], v129 offset:12288
v_mfma_f32_16x16x32_bf16 v[170:173], v[182:185], a[136:139], v[170:173]
s_waitcnt lgkmcnt(12)
ds_read_b64_tr_b16 a[184:185], v129 offset:12320
ds_read_b64_tr_b16 a[208:209], v129 offset:12352
v_mfma_f32_16x16x32_bf16 v[138:141], a[20:23], v[186:189], v[138:141]
ds_read_b128 v[84:87], v200
ds_read_b128 v[92:95], v201
v_mfma_f32_16x16x32_bf16 v[142:145], a[44:47], v[186:189], v[142:145]
ds_read_b128 v[100:103], v202
ds_read_b128 v[88:91], v194 offset:16
v_mfma_f32_16x16x32_bf16 v[146:149], a[68:71], v[186:189], v[146:149]
s_waitcnt lgkmcnt(10)
s_add_u32 m0, s55, 69888
s_add_u32 s29, s54, 24576
buffer_load_dwordx4 v136, s[16:19], s29 offen lds
v_mfma_f32_16x16x32_bf16 v[150:153], a[236:239], v[186:189], v[150:153]
s_add_u32 m0, s55, 70912
s_add_u32 s29, s54, 24576
buffer_load_dwordx4 v137, s[16:19], s29 offen lds
v_mfma_f32_16x16x32_bf16 v[154:157], v[228:231], v[186:189], v[154:157]
s_add_u32 m0, s55, 71936
s_add_u32 s29, s54, 24576
buffer_load_dwordx4 v216, s[16:19], s29 offen lds
ds_read_b128 v[96:99], v195 offset:16
s_waitcnt lgkmcnt(4)
v_mfma_f32_16x16x32_bf16 v[36:39], v[174:177], v[84:87], 0
s_waitcnt lgkmcnt(3)
s_add_u32 m0, s55, 82176
s_add_u32 s29, s54, 36864
buffer_load_dwordx4 v136, s[16:19], s29 offen lds
v_mfma_f32_16x16x32_bf16 v[48:51], v[174:177], v[92:95], 0
s_waitcnt lgkmcnt(2)
s_add_u32 m0, s55, 83200
s_add_u32 s29, s54, 36864
buffer_load_dwordx4 v137, s[16:19], s29 offen lds
v_mfma_f32_16x16x32_bf16 v[60:63], v[174:177], v[100:103], 0
s_add_u32 m0, s55, 84224
s_add_u32 s29, s54, 36864
buffer_load_dwordx4 v216, s[16:19], s29 offen lds
v_mfma_f32_16x16x32_bf16 v[158:161], v[252:255], v[186:189], v[158:161]
ds_read_b128 v[84:87], v194
ds_read_b128 v[92:95], v195
v_mfma_f32_16x16x32_bf16 v[162:165], v[186:189], a[92:95], v[162:165]
ds_read_b128 v[100:103], v196
ds_read_b128 v[104:107], v196 offset:16
v_mfma_f32_16x16x32_bf16 v[166:169], v[186:189], a[116:119], v[166:169]
ds_read_b128 v[174:177], v217 offset:1056
ds_read_b128 v[182:185], v210 offset:6144
v_mfma_f32_16x16x32_bf16 v[170:173], v[186:189], a[140:143], v[170:173]
ds_read_b128 v[186:189], v210 offset:7168
v_cvt_pk_bf16_f32 v78, v138, v139
v_cvt_pk_bf16_f32 v79, v140, v141
v_cvt_pk_bf16_f32 v80, v142, v143
v_cvt_pk_bf16_f32 v81, v144, v145
v_cvt_pk_bf16_f32 v82, v146, v147
v_cvt_pk_bf16_f32 v83, v148, v149
v_cvt_pk_bf16_f32 v72, v150, v151
v_cvt_pk_bf16_f32 v73, v152, v153
v_cvt_pk_bf16_f32 v74, v154, v155
v_cvt_pk_bf16_f32 v75, v156, v157
v_cvt_pk_bf16_f32 v76, v158, v159
s_waitcnt lgkmcnt(6)
v_smfmac_f32_16x16x64_bf16 v[36:39], v[178:181], v[84:91], v213
s_waitcnt lgkmcnt(5)
ds_read_b128 v[84:87], v197
ds_read_b128 v[88:91], v197 offset:16
v_smfmac_f32_16x16x64_bf16 v[48:51], v[178:181], v[92:99], v213
ds_read_b128 v[92:95], v198
ds_read_b128 v[96:99], v198 offset:16
v_cvt_pk_bf16_f32 v77, v160, v161
v_cvt_pk_bf16_f32 v114, v162, v163
v_cvt_pk_bf16_f32 v115, v164, v165
s_waitcnt lgkmcnt(7)
v_smfmac_f32_16x16x64_bf16 v[60:63], v[178:181], v[100:107], v213
s_nop 0
ds_read_b128 v[100:103], v199
ds_read_b128 v[104:107], v199 offset:16
ds_read_b128 v[178:181], v217 offset:1584
v_cvt_pk_bf16_f32 v122, v166, v167
v_cvt_pk_bf16_f32 v123, v168, v169
s_waitcnt lgkmcnt(8)
v_mfma_f32_16x16x32_bf16 v[138:141], a[0:3], v[182:185], 0
s_nop 0
v_cvt_pk_bf16_f32 v130, v170, v171
v_cvt_pk_bf16_f32 v131, v172, v173
v_mfma_f32_16x16x32_bf16 v[142:145], a[24:27], v[182:185], 0
s_nop 0
ds_read_b64 v[112:113], v215 offset:528
s_waitcnt lgkmcnt(6)
v_smfmac_f32_16x16x64_bf16 v[36:39], v[174:177], v[84:91], v213
ds_read_b128 v[84:87], v200 offset:32
ds_read_b128 v[88:91], v194 offset:48
v_mfma_f32_16x16x32_bf16 v[146:149], a[48:51], v[182:185], 0
s_waitcnt lgkmcnt(6)
v_smfmac_f32_16x16x64_bf16 v[48:51], v[174:177], v[92:99], v213
s_nop 0
ds_read_b128 v[92:95], v201 offset:32
ds_read_b128 v[96:99], v195 offset:48
v_mfma_f32_16x16x32_bf16 v[150:153], a[216:219], v[182:185], 0
v_mul_f32 v119, v36, v36
v_add_f32 v118, v36, v37
v_mfma_f32_16x16x32_bf16 v[154:157], a[240:243], v[182:185], 0
s_waitcnt lgkmcnt(6)
v_mul_f32 v127, v48, v48
v_add_f32_e64 v126, v48, v49
v_smfmac_f32_16x16x64_bf16 v[60:63], v[174:177], v[100:107], v213
ds_read_b128 v[100:103], v202 offset:32
ds_read_b128 v[174:177], v217 offset:2112
v_mfma_f32_16x16x32_bf16 v[158:161], v[232:235], v[182:185], 0
s_waitcnt lgkmcnt(5)
ds_read_b128 v[104:107], v196 offset:48
v_fmac_f32 v119, v37, v37
v_mfma_f32_16x16x32_bf16 v[40:43], v[178:181], v[84:87], 0
ds_read_b128 v[84:87], v194 offset:32
v_mul_f32_e64 v135, v60, v60
v_mfma_f32_16x16x32_bf16 v[162:165], v[182:185], a[72:75], 0
s_waitcnt lgkmcnt(5)
v_add_f32 v134, v60, v61
v_fmac_f32_e64 v135, v61, v61
v_mfma_f32_16x16x32_bf16 v[52:55], v[178:181], v[92:95], 0
ds_read_b128 v[92:95], v195 offset:32
v_fmac_f32_e64 v127, v49, v49
v_mfma_f32_16x16x32_bf16 v[166:169], v[182:185], a[96:99], 0
v_add_f32_e64 v134, v134, v62
v_fmac_f32 v135, v62, v62
v_mfma_f32_16x16x32_bf16 v[170:173], v[182:185], a[120:123], 0
s_waitcnt lgkmcnt(4)
ds_read_b128 v[182:185], v210 offset:8192
v_add_f32_e64 v118, v118, v38
v_mfma_f32_16x16x32_bf16 v[64:67], v[178:181], v[100:103], 0
ds_read_b128 v[100:103], v196 offset:32
ds_read_b128 v[178:181], v217 offset:2640
v_mfma_f32_16x16x32_bf16 v[138:141], a[4:7], v[186:189], v[138:141]
v_add_f32 v126, v126, v50
v_fmac_f32 v119, v38, v38
v_mfma_f32_16x16x32_bf16 v[142:145], a[28:31], v[186:189], v[142:145]
s_waitcnt lgkmcnt(4)
v_fmac_f32 v127, v50, v50
v_add_f32_e64 v134, v134, v63
v_smfmac_f32_16x16x64_bf16 v[40:43], v[174:177], v[84:91], v213
s_waitcnt lgkmcnt(3)
ds_read_b128 v[84:87], v197 offset:32
ds_read_b128 v[88:91], v197 offset:48
v_smfmac_f32_16x16x64_bf16 v[52:55], v[174:177], v[92:99], v213
s_waitcnt vmcnt(4)
ds_read_b64_tr_b16 a[150:151], v129
ds_read_b64_tr_b16 a[174:175], v129 offset:32
v_mfma_f32_16x16x32_bf16 v[146:149], a[52:55], v[186:189], v[146:149]
ds_read_b64_tr_b16 a[198:199], v129 offset:64
ds_read_b128 v[92:95], v198 offset:32
v_mfma_f32_16x16x32_bf16 v[150:153], a[220:223], v[186:189], v[150:153]
s_waitcnt lgkmcnt(7)
ds_read_b128 v[96:99], v198 offset:48
v_fmac_f32 v135, v63, v63
v_smfmac_f32_16x16x64_bf16 v[64:67], v[174:177], v[100:107], v213
ds_read_b128 v[100:103], v199 offset:32
ds_read_b128 v[104:107], v199 offset:48
v_mfma_f32_16x16x32_bf16 v[154:157], a[244:247], v[186:189], v[154:157]
ds_read_b128 v[174:177], v217 offset:3168
v_add_f32 v118, v118, v39
v_mfma_f32_16x16x32_bf16 v[158:161], v[236:239], v[186:189], v[158:161]
s_waitcnt vmcnt(3)
ds_read_b64_tr_b16 a[162:163], v129 offset:1536
ds_read_b64_tr_b16 a[186:187], v129 offset:1568
v_mfma_f32_16x16x32_bf16 v[162:165], v[186:189], a[76:79], v[162:165]
s_waitcnt lgkmcnt(10)
ds_read_b64_tr_b16 a[210:211], v129 offset:1600
v_add_f32 v126, v126, v51
v_smfmac_f32_16x16x64_bf16 v[40:43], v[178:181], v[84:91], v213
ds_read_b128 v[84:87], v200 offset:64
ds_read_b128 v[88:91], v194 offset:80
v_mfma_f32_16x16x32_bf16 v[166:169], v[186:189], a[100:103], v[166:169]
v_fmac_f32_e64 v119, v39, v39
v_fmac_f32 v127, v51, v51
v_mfma_f32_16x16x32_bf16 v[170:173], v[186:189], a[124:127], v[170:173]
s_waitcnt lgkmcnt(8)
ds_read_b128 v[186:189], v210 offset:9216
v_add_f32_e64 v118, v118, v40
v_smfmac_f32_16x16x64_bf16 v[52:55], v[178:181], v[92:99], v213
ds_read_b128 v[92:95], v201 offset:64
ds_read_b128 v[96:99], v195 offset:80
v_mfma_f32_16x16x32_bf16 v[138:141], a[8:11], v[182:185], v[138:141]
s_waitcnt lgkmcnt(9)
v_fmac_f32 v119, v40, v40
v_add_f32_e64 v118, v118, v41
v_smfmac_f32_16x16x64_bf16 v[64:67], v[178:181], v[100:107], v213
ds_read_b128 v[100:103], v202 offset:64
ds_read_b128 v[178:181], v217 offset:3696
v_mfma_f32_16x16x32_bf16 v[142:145], a[32:35], v[182:185], v[142:145]
ds_read_b128 v[104:107], v196 offset:80
v_add_f32 v126, v126, v52
v_mfma_f32_16x16x32_bf16 v[146:149], a[56:59], v[182:185], v[146:149]
s_waitcnt lgkmcnt(8)
s_add_u32 m0, s55, 69888
s_add_u32 s29, s54, 49152
buffer_load_dwordx4 v136, s[16:19], s29 offen lds
s_waitcnt lgkmcnt(7)
v_mfma_f32_16x16x32_bf16 v[44:47], v[174:177], v[84:87], 0
s_add_u32 m0, s55, 70912
s_add_u32 s29, s54, 49152
buffer_load_dwordx4 v137, s[16:19], s29 offen lds
v_mfma_f32_16x16x32_bf16 v[150:153], a[224:227], v[182:185], v[150:153]
s_waitcnt lgkmcnt(4)
s_add_u32 m0, s55, 71936
s_add_u32 s29, s54, 49152
buffer_load_dwordx4 v216, s[16:19], s29 offen lds
v_mfma_f32_16x16x32_bf16 v[56:59], v[174:177], v[92:95], 0
s_waitcnt vmcnt(4)
ds_read_b64_tr_b16 a[152:153], v129 offset:12288
ds_read_b64_tr_b16 a[176:177], v129 offset:12320
v_mfma_f32_16x16x32_bf16 v[154:157], a[248:251], v[182:185], v[154:157]
s_waitcnt vmcnt(3) lgkmcnt(4)
ds_read_b64_tr_b16 a[200:201], v129 offset:12352
ds_read_b64_tr_b16 a[154:155], v129 offset:13824
v_mfma_f32_16x16x32_bf16 v[68:71], v[174:177], v[100:103], 0
ds_read_b64_tr_b16 a[178:179], v129 offset:13856
ds_read_b64_tr_b16 a[202:203], v129 offset:13888
v_mfma_f32_16x16x32_bf16 v[158:161], v[240:243], v[182:185], v[158:161]
ds_read_b128 v[84:87], v194 offset:64
ds_read_b128 v[92:95], v195 offset:64
v_mfma_f32_16x16x32_bf16 v[162:165], v[182:185], a[80:83], v[162:165]
ds_read_b128 v[100:103], v196 offset:64
ds_read_b128 v[174:177], v217 offset:4224
v_mfma_f32_16x16x32_bf16 v[166:169], v[182:185], a[104:107], v[166:169]
v_add_f32 v134, v134, v64
v_fmac_f32 v135, v64, v64
v_mfma_f32_16x16x32_bf16 v[170:173], v[182:185], a[128:131], v[170:173]
ds_read_b128 v[182:185], v210 offset:10240
v_fmac_f32_e64 v127, v52, v52
v_mfma_f32_16x16x32_bf16 v[138:141], a[12:15], v[186:189], v[138:141]
v_add_f32_e64 v134, v134, v65
v_fmac_f32 v135, v65, v65
v_mfma_f32_16x16x32_bf16 v[142:145], a[36:39], v[186:189], v[142:145]
s_waitcnt lgkmcnt(5)
s_add_u32 m0, s55, 82176
s_add_u32 s29, s54, 61440
buffer_load_dwordx4 v136, s[16:19], s29 offen lds
s_waitcnt lgkmcnt(4)
v_smfmac_f32_16x16x64_bf16 v[44:47], v[178:181], v[84:91], v213
s_waitcnt lgkmcnt(3)
s_add_u32 m0, s55, 83200
s_add_u32 s29, s54, 61440
buffer_load_dwordx4 v137, s[16:19], s29 offen lds
v_smfmac_f32_16x16x64_bf16 v[56:59], v[178:181], v[92:99], v213
s_waitcnt lgkmcnt(2)
s_add_u32 m0, s55, 84224
s_add_u32 s29, s54, 61440
buffer_load_dwordx4 v216, s[16:19], s29 offen lds
v_smfmac_f32_16x16x64_bf16 v[68:71], v[178:181], v[100:107], v213
ds_read_b128 v[84:87], v197 offset:64
ds_read_b128 v[88:91], v197 offset:80
v_mfma_f32_16x16x32_bf16 v[146:149], a[60:63], v[186:189], v[146:149]
s_sub_u32 s42, s35, s42
ds_read_b128 v[92:95], v198 offset:64
ds_read_b128 v[96:99], v198 offset:80
v_mfma_f32_16x16x32_bf16 v[150:153], a[228:231], v[186:189], v[150:153]
s_mul_i32 s51, s42, 2688
ds_read_b128 v[100:103], v199 offset:64
ds_read_b128 v[104:107], v199 offset:80
v_mfma_f32_16x16x32_bf16 v[154:157], a[252:255], v[186:189], v[154:157]
s_add_u32 s43, s43, s51
v_fmac_f32 v119, v41, v41
v_add_f32_e64 v126, v126, v53
v_mfma_f32_16x16x32_bf16 v[158:161], v[244:247], v[186:189], v[158:161]
s_cmp_lt_u32 s35, s34
v_fmac_f32 v127, v53, v53
v_add_f32_e64 v134, v134, v66
v_mfma_f32_16x16x32_bf16 v[162:165], v[186:189], a[84:87], v[162:165]
s_cselect_b32 s50, s43, 1879048192
v_fmac_f32 v135, v66, v66
v_add_f32 v118, v118, v42
v_mfma_f32_16x16x32_bf16 v[166:169], v[186:189], a[108:111], v[166:169]
s_add_u32 s35, s35, 32
v_fmac_f32 v119, v42, v42
v_add_f32 v126, v126, v54
v_mfma_f32_16x16x32_bf16 v[170:173], v[186:189], a[132:135], v[170:173]
s_waitcnt lgkmcnt(4)
ds_read_b128 v[186:189], v210 offset:11264
v_fmac_f32 v127, v54, v54
v_smfmac_f32_16x16x64_bf16 v[44:47], v[174:177], v[84:91], v213
s_cmp_eq_u32 s42, 0
s_cselect_b32 s44, 536870911, s72
v_add_f32_e64 v134, v134, v67
v_mfma_f32_16x16x32_bf16 v[138:141], a[16:19], v[182:185], v[138:141]
s_waitcnt lgkmcnt(3)
v_fmac_f32 v135, v67, v67
v_add_f32_e64 v118, v118, v43
v_smfmac_f32_16x16x64_bf16 v[56:59], v[174:177], v[92:99], v213
s_cmp_eq_u32 s42, 72
s_cselect_b32 s44, 939524095, s44
v_fmac_f32_e64 v119, v43, v43
v_mfma_f32_16x16x32_bf16 v[142:145], a[40:43], v[182:185], v[142:145]
s_waitcnt lgkmcnt(1)
v_add_f32 v126, v126, v55
v_fmac_f32 v127, v55, v55
v_smfmac_f32_16x16x64_bf16 v[68:71], v[174:177], v[100:107], v213
s_cmp_eq_u32 s41, 0
s_cselect_b32 s52, 1879048192, s50
v_add_f32_e64 v118, v118, v44
v_mfma_f32_16x16x32_bf16 v[146:149], a[64:67], v[182:185], v[146:149]
v_fmac_f32 v119, v44, v44
v_add_f32 v126, v126, v56
v_mfma_f32_16x16x32_bf16 v[150:153], a[232:235], v[182:185], v[150:153]
s_add_u32 m0, s45, 0
v_add_f32 v134, v134, v68
v_fmac_f32_e64 v135, v68, v68
v_mfma_f32_16x16x32_bf16 v[154:157], v[224:227], v[182:185], v[154:157]
s_mov_b32 s36, s50
v_fmac_f32 v127, v56, v56
v_add_f32_e64 v134, v134, v69
v_mfma_f32_16x16x32_bf16 v[158:161], v[248:251], v[182:185], v[158:161]
s_mul_hi_u32 s41, s35, 58835169
v_fmac_f32 v135, v69, v69
v_add_f32 v118, v118, v45
v_mfma_f32_16x16x32_bf16 v[162:165], v[182:185], a[88:91], v[162:165]
s_mul_i32 s42, s41, 73
v_fmac_f32 v119, v45, v45
v_add_f32 v126, v126, v57
v_mfma_f32_16x16x32_bf16 v[166:169], v[182:185], a[112:115], v[166:169]
s_mul_i32 s43, s41, 1373568
v_fmac_f32 v127, v57, v57
v_add_f32 v134, v134, v70
v_mfma_f32_16x16x32_bf16 v[170:173], v[182:185], a[136:139], v[170:173]
s_waitcnt lgkmcnt(0)
ds_read_b128 v[182:185], v210 offset:12288
v_fmac_f32 v135, v70, v70
v_mfma_f32_16x16x32_bf16 v[138:141], a[20:23], v[186:189], v[138:141]
v_add_f32 v118, v118, v46
v_fmac_f32 v119, v46, v46
v_mfma_f32_16x16x32_bf16 v[142:145], a[44:47], v[186:189], v[142:145]
v_add_f32_e64 v126, v126, v58
v_fmac_f32 v127, v58, v58
v_mfma_f32_16x16x32_bf16 v[146:149], a[68:71], v[186:189], v[146:149]
s_waitcnt vmcnt(4)
ds_read_b64_tr_b16 a[164:165], v129
ds_read_b64_tr_b16 a[188:189], v129 offset:32
v_mfma_f32_16x16x32_bf16 v[150:153], a[236:239], v[186:189], v[150:153]
ds_read_b64_tr_b16 a[212:213], v129 offset:64
v_add_f32_e64 v134, v134, v71
v_mfma_f32_16x16x32_bf16 v[154:157], v[228:231], v[186:189], v[154:157]
v_fmac_f32 v135, v71, v71
v_add_f32 v118, v118, v47
v_mfma_f32_16x16x32_bf16 v[158:161], v[252:255], v[186:189], v[158:161]
v_fmac_f32 v119, v47, v47
v_add_f32 v126, v126, v59
v_mfma_f32_16x16x32_bf16 v[162:165], v[186:189], a[92:95], v[162:165]
v_fmac_f32_e64 v127, v59, v59
v_and_b32 v180, s44, v208
v_mfma_f32_16x16x32_bf16 v[166:169], v[186:189], a[116:119], v[166:169]
s_waitcnt vmcnt(3)
ds_read_b64_tr_b16 a[156:157], v129 offset:1536
ds_read_b64_tr_b16 a[180:181], v129 offset:1568
v_mfma_f32_16x16x32_bf16 v[170:173], v[186:189], a[140:143], v[170:173]
s_waitcnt lgkmcnt(5)
ds_read_b64_tr_b16 a[204:205], v129 offset:1600
ds_read_b128 v[186:189], v210 offset:13312
v_permlane16_swap_b32 v134, v135
v_permlane16_swap_b32 v118, v119
v_permlane16_swap_b32 v126, v127
v_add_f32 v134, v134, v135
v_add_f32 v118, v118, v119
v_add_f32 v126, v126, v127
v_mov_b32 v135, v134
v_cvt_pk_bf16_f32 v96, v138, v139
v_permlane32_swap_b32 v118, v126
v_permlane32_swap_b32 v134, v135
v_add_f32 v118, v118, v126
v_add_f32 v134, v134, v135
v_cvt_pk_bf16_f32 v97, v140, v141
v_mfma_f32_16x16x32_bf16 v[138:141], a[0:3], v[182:185], 0
ds_write_b32 v209, v118
v_cvt_pk_bf16_f32 v98, v142, v143
v_cvt_pk_bf16_f32 v99, v144, v145
v_mfma_f32_16x16x32_bf16 v[142:145], a[24:27], v[182:185], 0
s_waitcnt lgkmcnt(1)
ds_write_b32 v209, v134 offset:512
v_mfma_f32_16x16x32_bf16 v[138:141], a[4:7], v[186:189], v[138:141]
s_waitcnt vmcnt(1)
ds_read_b64_tr_b16 a[158:159], v129 offset:12288
ds_read_b64_tr_b16 a[182:183], v129 offset:12320
v_mfma_f32_16x16x32_bf16 v[142:145], a[28:31], v[186:189], v[142:145]
ds_read_b64_tr_b16 a[206:207], v129 offset:12352
v_cvt_pk_bf16_f32 v100, v146, v147
v_cvt_pk_bf16_f32 v101, v148, v149
v_mfma_f32_16x16x32_bf16 v[146:149], a[48:51], v[182:185], 0
ds_read_b128 v[182:185], v210 offset:14336
v_cvt_pk_bf16_f32 v88, v158, v159
v_mfma_f32_16x16x32_bf16 v[146:149], a[52:55], v[186:189], v[146:149]
ds_read_b128 v[186:189], v210 offset:15360
v_cvt_pk_bf16_f32 v89, v160, v161
v_cvt_pk_bf16_f32 v86, v154, v155
v_cvt_pk_bf16_f32 v87, v156, v157
v_mfma_f32_16x16x16_bf16 v[154:157], v[82:83], v[88:89], 0
v_cvt_pk_bf16_f32 v124, v166, v167
v_cvt_pk_bf16_f32 v125, v168, v169
v_cvt_pk_bf16_f32 v84, v150, v151
v_mfma_f32_16x16x16_bf16 v[158:161], v[100:101], v[88:89], 0
v_cvt_pk_bf16_f32 v85, v152, v153
v_cvt_pk_bf16_f32 v116, v162, v163
v_cvt_pk_bf16_f32 v117, v164, v165
v_mfma_f32_16x16x16_bf16 v[166:169], v[112:113], v[88:89], v[206:209]
v_cvt_pk_bf16_f32 v132, v170, v171
v_cvt_pk_bf16_f32 v133, v172, v173
v_mov_b32 v181, 0
v_mfma_f32_16x16x16_bf16 v[150:153], v[112:113], v[76:77], v[206:209]
s_waitcnt vmcnt(0) lgkmcnt(1)
ds_read_b64_tr_b16 a[166:167], v129 offset:13824
ds_read_b64_tr_b16 a[190:191], v129 offset:13856
ds_read_b64_tr_b16 a[214:215], v129 offset:13888
v_mfma_f32_16x16x32_bf16 v[138:141], a[8:11], v[182:185], v[138:141]
v_mfma_f32_16x16x32_bf16 v[142:145], a[32:35], v[182:185], v[142:145]
v_mfma_f32_16x16x32_bf16 v[146:149], a[56:59], v[182:185], v[146:149]
s_nop 0
ds_read_b128 v[182:185], v210 offset:16384
s_waitcnt lgkmcnt(4)
v_mfma_f32_16x16x32_bf16 v[138:141], a[12:15], v[186:189], v[138:141]
v_mfma_f32_16x16x32_bf16 v[142:145], a[36:39], v[186:189], v[142:145]
s_waitcnt lgkmcnt(1)
v_mfma_f32_16x16x32_bf16 v[146:149], a[60:63], v[186:189], v[146:149]
s_barrier
v_mfma_f32_16x16x32_bf16 v[154:157], v[78:81], v[84:87], v[154:157]
buffer_load_dwordx4 v180, s[4:7], s52 offen nt lds
v_mfma_f32_16x16x32_bf16 v[158:161], v[96:99], v[84:87], v[158:161]
s_add_u32 m0, s45, 4112
ds_read_b128 v[102:105], v210 offset:18432
ds_read_b128 v[106:109], v210 offset:19456
ds_read_b128 v[186:189], v210 offset:17408
s_waitcnt lgkmcnt(3)
v_mfma_f32_16x16x32_bf16 v[138:141], a[16:19], v[182:185], v[138:141]
s_add_u32 s40, s36, 196224
v_exp_f32 v154, v154
v_mfma_f32_16x16x32_bf16 v[142:145], a[40:43], v[182:185], v[142:145]
v_exp_f32 v155, v155
v_mfma_f32_16x16x32_bf16 v[146:149], a[64:67], v[182:185], v[146:149]
ds_read_b128 v[182:185], v210 offset:12288
v_exp_f32 v156, v156
v_exp_f32 v157, v157
s_waitcnt lgkmcnt(3)
buffer_load_dwordx4 v180, s[4:7], s40 offen nt lds
s_add_u32 m0, s45, 8224
v_add_f32 v102, v102, v103
v_add_f32 v104, v104, v105
v_add_f32 v102, v102, v104
v_mul_f32 v103, s48, v102
v_mul_f32 v104, s73, v102
s_waitcnt lgkmcnt(1)
v_add_f32_e64 v106, v106, v107
v_mfma_f32_16x16x32_bf16 v[138:141], a[20:23], v[186:189], v[138:141]
s_add_u32 s40, s36, 392448
v_add_f32 v108, v108, v109
v_add_f32 v106, v106, v108
v_mul_f32 v106, s73, v106
v_mfma_f32_16x16x32_bf16 v[142:145], a[44:47], v[186:189], v[142:145]
s_waitcnt lgkmcnt(0)
ds_read_b128 v[108:111], v215 offset:512
v_fma_f32 v106, -v103, v104, v106
v_mfma_f32_16x16x32_bf16 v[170:173], a[240:243], v[182:185], 0
v_max_f32 v106, 0, v106
v_add_f32 v106, s49, v106
v_mfma_f32_16x16x32_bf16 v[146:149], a[68:71], v[186:189], v[146:149]
ds_read_b128 v[186:189], v210 offset:13312
v_rsq_f32 v102, v106
s_nop 0
v_mul_f32_e64 v103, -v103, v102
v_cvt_pk_bf16_f32 v105, v144, v145
v_cvt_pk_bf16_f32 v104, v142, v143
v_mfma_f32_16x16x16_bf16 v[142:145], v[100:101], v[76:77], 0
v_cvt_pk_bf16_f32 v107, v148, v149
v_cvt_pk_bf16_f32 v106, v146, v147
v_exp_f32 v158, v158
v_mfma_f32_16x16x16_bf16 v[162:165], v[106:107], v[88:89], 0
v_exp_f32 v159, v159
v_exp_f32 v160, v160
v_mfma_f32_16x16x16_bf16 v[146:149], v[106:107], v[76:77], 0
buffer_load_dwordx4 v180, s[4:7], s40 offen nt lds
ds_write_b64 v211, v[102:103] offset:20480
v_mfma_f32_16x16x32_bf16 v[142:145], v[96:99], v[72:75], v[142:145]
s_waitcnt lgkmcnt(2)
v_cvt_pk_bf16_f32 v102, v138, v139
v_cvt_pk_bf16_f32 v103, v140, v141
s_add_u32 m0, s45, 12336
v_mfma_f32_16x16x16_bf16 v[138:141], v[82:83], v[76:77], 0
ds_read_b64 v[118:119], v219 offset:20480
ds_read_b64 v[126:127], v219 offset:20736
ds_read_b64 v[134:135], v219 offset:20992
ds_read_b64 v[76:77], v215 offset:16
v_mfma_f32_16x16x32_bf16 v[150:153], v[108:111], v[72:75], v[150:153]
s_add_u32 s40, s36, 588672
v_exp_f32 v142, v142
v_mfma_f32_16x16x32_bf16 v[138:141], v[78:81], v[72:75], v[138:141]
v_exp_f32 v143, v143
v_mfma_f32_16x16x32_bf16 v[146:149], v[102:105], v[72:75], v[146:149]
s_waitcnt lgkmcnt(5)
v_exp_f32 v144, v144
v_mfma_f32_16x16x32_bf16 v[170:173], a[244:247], v[186:189], v[170:173]
v_exp_f32_e64 v145, v145
v_mfma_f32_16x16x32_bf16 v[166:169], v[108:111], v[84:87], v[166:169]
s_waitcnt lgkmcnt(3)
v_fma_f32 v220, v36, v118, v119
v_fma_f32 v221, v37, v118, v119
v_mfma_f32_16x16x32_bf16 v[162:165], v[102:105], v[84:87], v[162:165]
s_waitcnt lgkmcnt(2)
buffer_load_dwordx4 v180, s[4:7], s40 offen nt lds
v_fma_f32 v222, v38, v118, v119
v_fma_f32 v223, v39, v118, v119
v_cvt_pk_bf16_f32 v90, v220, v221
v_cvt_pk_bf16_f32 v91, v222, v223
v_fma_f32 v220, v40, v118, v119
v_fma_f32 v221, v41, v118, v119
v_fma_f32 v222, v42, v118, v119
v_fma_f32 v223, v43, v118, v119
v_cvt_pk_bf16_f32 v92, v220, v221
v_cvt_pk_bf16_f32 v93, v222, v223
v_fma_f32 v220, v44, v118, v119
v_fma_f32 v221, v45, v118, v119
v_fma_f32 v222, v46, v118, v119
v_fma_f32 v223, v47, v118, v119
v_mfma_f32_16x16x32_bf16 v[118:121], v[182:185], a[72:75], 0
s_add_u32 m0, s45, 16448
ds_write_b128 v211, v[90:93] offset:20480
v_mfma_f32_16x16x32_bf16 v[118:121], v[186:189], a[76:79], v[118:121]
s_add_u32 s40, s36, 784896
v_cvt_pk_bf16_f32 v94, v220, v221
v_cvt_pk_bf16_f32 v95, v222, v223
v_fma_f32 v220, v48, v126, v127
v_fma_f32 v221, v49, v126, v127
v_fma_f32 v222, v50, v126, v127
v_fma_f32 v223, v51, v126, v127
v_cvt_pk_bf16_f32 v174, v220, v221
v_cvt_pk_bf16_f32 v175, v222, v223
v_fma_f32 v220, v52, v126, v127
v_fma_f32 v221, v53, v126, v127
v_fma_f32 v222, v54, v126, v127
v_fma_f32 v223, v55, v126, v127
v_cvt_pk_bf16_f32 v176, v220, v221
v_cvt_pk_bf16_f32 v177, v222, v223
v_fma_f32 v220, v56, v126, v127
v_fma_f32 v221, v57, v126, v127
v_fma_f32 v222, v58, v126, v127
v_fma_f32 v223, v59, v126, v127
v_mfma_f32_16x16x32_bf16 v[126:129], v[182:185], a[96:99], 0
s_waitcnt lgkmcnt(2)
buffer_load_dwordx4 v180, s[4:7], s40 offen nt lds
v_mfma_f32_16x16x32_bf16 v[126:129], v[186:189], a[100:103], v[126:129]
s_add_u32 m0, s45, 20560
ds_write_b64 v212, v[94:95] offset:20480
v_cvt_pk_bf16_f32 v178, v220, v221
v_cvt_pk_bf16_f32 v179, v222, v223
v_fma_f32 v220, v60, v134, v135
v_fma_f32 v221, v61, v134, v135
v_fma_f32 v222, v62, v134, v135
v_fma_f32 v223, v63, v134, v135
v_cvt_pk_bf16_f32 v90, v220, v221
v_cvt_pk_bf16_f32 v91, v222, v223
v_fma_f32 v220, v64, v134, v135
v_fma_f32 v221, v65, v134, v135
v_fma_f32 v222, v66, v134, v135
v_fma_f32 v223, v67, v134, v135
v_cvt_pk_bf16_f32 v92, v220, v221
v_cvt_pk_bf16_f32 v93, v222, v223
v_fma_f32 v220, v68, v134, v135
v_fma_f32 v221, v69, v134, v135
v_fma_f32 v222, v70, v134, v135
v_fma_f32 v223, v71, v134, v135
v_mfma_f32_16x16x32_bf16 v[134:137], v[182:185], a[120:123], 0
s_add_u32 s40, s36, 981120
ds_write_b128 v211, v[90:93] offset:32768
v_mfma_f32_16x16x32_bf16 v[90:93], a[216:219], v[182:185], 0
s_nop 0
buffer_load_dwordx4 v180, s[4:7], s40 offen nt lds
v_mfma_f32_16x16x32_bf16 v[134:137], v[186:189], a[124:127], v[134:137]
s_add_u32 m0, s45, 24672
v_cvt_pk_bf16_f32 v94, v220, v221
v_cvt_pk_bf16_f32 v95, v222, v223
v_mfma_f32_16x16x32_bf16 v[220:223], v[232:235], v[182:185], 0
s_add_u32 s40, s36, 1177344
ds_read_b128 v[182:185], v210 offset:14336
ds_write_b128 v211, v[174:177] offset:26624
v_mfma_f32_16x16x32_bf16 v[90:93], a[220:223], v[186:189], v[90:93]
v_exp_f32_e64 v138, v138
v_mfma_f32_16x16x32_bf16 v[220:223], v[236:239], v[186:189], v[220:223]
ds_read_b128 v[186:189], v210 offset:15360
ds_write_b64 v212, v[178:179] offset:26624
v_exp_f32 v139, v139
v_exp_f32 v140, v140
v_exp_f32 v141, v141
s_waitcnt lgkmcnt(3)
v_mfma_f32_16x16x32_bf16 v[118:121], v[182:185], a[80:83], v[118:121]
ds_write_b64 v212, v[94:95] offset:32768
v_mfma_f32_16x16x32_bf16 v[126:129], v[182:185], a[104:107], v[126:129]
buffer_load_dwordx4 v180, s[4:7], s40 offen nt lds
v_mfma_f32_16x16x32_bf16 v[134:137], v[182:185], a[128:131], v[134:137]
s_add_u32 m0, s45, 28784
v_exp_f32_e64 v150, v150
v_mfma_f32_16x16x32_bf16 v[90:93], a[224:227], v[182:185], v[90:93]
v_cvt_pk_bf16_f32 v176, v142, v143
v_cvt_pk_bf16_f32 v177, v144, v145
v_mfma_f32_16x16x32_bf16 v[170:173], a[248:251], v[182:185], v[170:173]
s_add_u32 s40, s36, 1373568
v_cvt_pk_bf16_f32 v174, v138, v139
v_cvt_pk_bf16_f32 v175, v140, v141
v_mfma_f32_16x16x32_bf16 v[220:223], v[240:243], v[182:185], v[220:223]
s_waitcnt lgkmcnt(2)
ds_read_b128 v[182:185], v210 offset:16384
ds_read_b128 v[72:75], v215
v_mfma_f32_16x16x32_bf16 v[118:121], v[186:189], a[84:87], v[118:121]
v_exp_f32 v161, v161
v_mfma_f32_16x16x32_bf16 v[126:129], v[186:189], a[108:111], v[126:129]
v_exp_f32 v166, v166
v_mfma_f32_16x16x32_bf16 v[134:137], v[186:189], a[132:135], v[134:137]
v_exp_f32 v146, v146
v_mfma_f32_16x16x32_bf16 v[90:93], a[228:231], v[186:189], v[90:93]
v_exp_f32_e64 v147, v147
v_mfma_f32_16x16x32_bf16 v[170:173], a[252:255], v[186:189], v[170:173]
v_exp_f32 v148, v148
v_mfma_f32_16x16x32_bf16 v[220:223], v[244:247], v[186:189], v[220:223]
s_waitcnt lgkmcnt(1)
ds_read_b128 v[186:189], v210 offset:17408
buffer_load_dwordx4 v180, s[4:7], s40 offen nt lds
v_mfma_f32_16x16x32_bf16 v[118:121], v[182:185], a[88:91], v[118:121]
s_add_u32 m0, s45, 32896
v_exp_f32 v149, v149
v_mfma_f32_16x16x32_bf16 v[126:129], v[182:185], a[112:115], v[126:129]
s_add_u32 s40, s36, 1569792
v_exp_f32 v162, v162
v_mfma_f32_16x16x32_bf16 v[134:137], v[182:185], a[136:139], v[134:137]
s_sub_u32 s42, s35, s42
v_exp_f32 v163, v163
v_mfma_f32_16x16x32_bf16 v[90:93], a[232:235], v[182:185], v[90:93]
s_mul_i32 s51, s42, 2688
v_exp_f32 v164, v164
v_mfma_f32_16x16x32_bf16 v[170:173], v[224:227], v[182:185], v[170:173]
s_add_u32 s43, s43, s51
v_exp_f32_e64 v165, v165
v_mfma_f32_16x16x32_bf16 v[220:223], v[248:251], v[182:185], v[220:223]
s_waitcnt lgkmcnt(0)
v_cvt_pk_bf16_f32 v178, v146, v147
v_cvt_pk_bf16_f32 v179, v148, v149
v_mfma_f32_16x16x32_bf16 v[118:121], v[186:189], a[92:95], v[118:121]
s_cmp_lt_u32 s35, s34
s_cselect_b32 s50, s43, 1879048192
s_add_u32 s35, s35, 32
v_mfma_f32_16x16x32_bf16 v[126:129], v[186:189], a[116:119], v[126:129]
s_cmp_eq_u32 s42, 0
s_cselect_b32 s44, 536870911, s72
s_cmp_eq_u32 s42, 72
v_mfma_f32_16x16x32_bf16 v[134:137], v[186:189], a[140:143], v[134:137]
s_cselect_b32 s44, 939524095, s44
v_cvt_pk_bf16_f32 v118, v118, v119
v_cvt_pk_bf16_f32 v119, v120, v121
v_mfma_f32_16x16x32_bf16 v[90:93], a[236:239], v[186:189], v[90:93]
s_cmp_eq_u32 s41, 0
buffer_load_dwordx4 v180, s[4:7], s40 offen nt lds
v_mfma_f32_16x16x32_bf16 v[170:173], v[228:231], v[186:189], v[170:173]
s_cselect_b32 s52, 1879048192, s50
ds_read_u16 v120, v214 offset:1024
v_cvt_pk_bf16_f32 v180, v150, 0
v_mfma_f32_16x16x32_bf16 v[220:223], v[252:255], v[186:189], v[220:223]
s_mov_b32 s37, s50
v_cvt_pk_bf16_f32 v90, v90, v91
v_cvt_pk_bf16_f32 v91, v92, v93
v_mfma_f32_16x16x32_bf16 v[150:153], v[190:193], v[174:177], 0
s_add_u32 m0, s45, 0
v_cvt_pk_bf16_f32 v92, v170, v171
v_cvt_pk_bf16_f32 v93, v172, v173
v_mfma_f32_16x16x32_bf16 v[138:141], v[114:117], v[174:177], 0
s_nop 0
v_cvt_pk_bf16_f32 v126, v126, v127
v_cvt_pk_bf16_f32 v127, v128, v129
v_mfma_f32_16x16x32_bf16 v[142:145], v[122:125], v[174:177], 0
ds_read_u16 v128, v214 offset:1032
v_cvt_pk_bf16_f32 v134, v134, v135
v_mfma_f32_16x16x32_bf16 v[146:149], v[130:133], v[174:177], 0
v_cvt_pk_bf16_f32 v174, v154, v155
v_cvt_pk_bf16_f32 v175, v156, v157
v_mfma_f32_16x16x32_bf16 v[150:153], v[190:193], v[178:181], v[150:153]
v_cvt_pk_bf16_f32 v176, v158, v159
v_cvt_pk_bf16_f32 v177, v160, v161
v_cvt_pk_bf16_f32 v135, v136, v137
v_mov_b32_e64 v121, 0
v_mfma_f32_16x16x32_bf16 v[154:157], v[114:117], v[174:177], 0
ds_read_u16 v136, v214 offset:1040
v_mov_b32 v129, 0
v_mfma_f32_16x16x32_bf16 v[158:161], v[122:125], v[174:177], 0
s_waitcnt lgkmcnt(2)
v_rcp_f32 v151, v150
v_mfma_f32_16x16x32_bf16 v[138:141], v[118:121], v[178:181], v[138:141]
s_waitcnt lgkmcnt(1)
v_max3_u32 v218, v218, v150, v151
v_mul_f32_e64 v151, s3, v151
v_mfma_f32_16x16x32_bf16 v[142:145], v[126:129], v[178:181], v[142:145]
v_mov_b32_e64 v137, 0
v_cvt_pk_bf16_f32 v94, v220, v221
v_cvt_pk_bf16_f32 v95, v222, v223
v_mul_f32 v138, v138, v151
v_mul_f32 v139, v139, v151
v_mul_f32 v140, v140, v151
v_mul_f32 v141, v141, v151
v_cvt_pk_bf16_f32 v138, v138, v139
v_mul_f32_e64 v142, v142, v151
v_mul_f32 v143, v143, v151
s_waitcnt lgkmcnt(0)
v_mfma_f32_16x16x32_bf16 v[146:149], v[134:137], v[178:181], v[146:149]
v_cvt_pk_bf16_f32 v180, v166, 0
v_mul_f32_e64 v144, v144, v151
v_mfma_f32_16x16x32_bf16 v[166:169], v[190:193], v[174:177], 0
v_mul_f32_e64 v145, v145, v151
v_cvt_pk_bf16_f32 v139, v140, v141
v_cvt_pk_bf16_f32 v140, v142, v143
v_cvt_pk_bf16_f32 v141, v144, v145
v_cvt_pk_bf16_f32 v178, v162, v163
v_cvt_pk_bf16_f32 v179, v164, v165
v_mfma_f32_16x16x32_bf16 v[162:165], v[130:133], v[174:177], 0
ds_write_b128 v211, v[138:141] offset:38912
v_mfma_f32_16x16x32_bf16 v[138:141], v[78:81], v[90:93], 0
v_mul_f32 v146, v146, v151
v_mul_f32 v147, v147, v151
v_mfma_f32_16x16x32_bf16 v[166:169], v[190:193], v[178:181], v[166:169]
v_mul_f32 v148, v148, v151
v_mul_f32 v149, v149, v151
v_mfma_f32_16x16x32_bf16 v[154:157], v[118:121], v[178:181], v[154:157]
v_cvt_pk_bf16_f32 v142, v146, v147
v_cvt_pk_bf16_f32 v143, v148, v149
v_mfma_f32_16x16x32_bf16 v[158:161], v[126:129], v[178:181], v[158:161]
ds_write_b64 v212, v[142:143] offset:38912
v_mfma_f32_16x16x32_bf16 v[142:145], v[96:99], v[90:93], 0
v_rcp_f32 v167, v166
v_mfma_f32_16x16x32_bf16 v[162:165], v[134:137], v[178:181], v[162:165]
v_max3_u32 v218, v218, v166, v167
v_mul_f32 v167, s3, v167
v_mfma_f32_16x16x32_bf16 v[150:153], v[108:111], v[90:93], v[206:209]
v_mul_f32 v154, v154, v167
v_mul_f32 v155, v155, v167
v_mfma_f32_16x16x32_bf16 v[146:149], v[102:105], v[90:93], 0
v_mul_f32 v156, v156, v167
v_mul_f32 v157, v157, v167
v_cvt_pk_bf16_f32 v154, v154, v155
v_mfma_f32_16x16x16_bf16 v[138:141], v[82:83], v[94:95], v[138:141]
v_mul_f32 v158, v158, v167
v_mul_f32 v159, v159, v167
v_mul_f32_e64 v160, v160, v167
v_mfma_f32_16x16x16_bf16 v[142:145], v[100:101], v[94:95], v[142:145]
v_mul_f32_e64 v161, v161, v167
v_cvt_pk_bf16_f32 v155, v156, v157
v_cvt_pk_bf16_f32 v156, v158, v159
v_mfma_f32_16x16x16_bf16 v[150:153], v[112:113], v[94:95], v[150:153]
v_cvt_pk_bf16_f32 v157, v160, v161
v_mul_f32 v162, v162, v167
v_mul_f32 v163, v163, v167
v_mfma_f32_16x16x16_bf16 v[146:149], v[106:107], v[94:95], v[146:149]
v_mul_f32 v164, v164, v167
v_mul_f32 v165, v165, v167
v_cvt_pk_bf16_f32 v158, v162, v163
v_mfma_f32_16x16x16_bf16 v[166:169], v[76:77], v[112:113], v[206:209]
v_cvt_pk_bf16_f32 v159, v164, v165
v_exp_f32 v138, v138
v_mfma_f32_16x16x16_bf16 v[162:165], v[76:77], v[106:107], 0
v_exp_f32 v139, v139
v_exp_f32 v140, v140
v_mfma_f32_16x16x32_bf16 v[166:169], v[72:75], v[108:111], v[166:169]
ds_write_b128 v211, v[154:157] offset:45056
v_mfma_f32_16x16x16_bf16 v[154:157], v[76:77], v[82:83], 0
v_exp_f32 v141, v141
v_exp_f32 v142, v142
v_mfma_f32_16x16x32_bf16 v[162:165], v[72:75], v[102:105], v[162:165]
v_exp_f32 v143, v143
v_mfma_f32_16x16x32_bf16 v[154:157], v[72:75], v[78:81], v[154:157]
ds_write_b64 v212, v[158:159] offset:45056
v_mfma_f32_16x16x16_bf16 v[158:161], v[76:77], v[100:101], 0
v_exp_f32 v144, v144
v_exp_f32 v145, v145
v_exp_f32_e64 v150, v150
v_mfma_f32_16x16x32_bf16 v[158:161], v[72:75], v[96:99], v[158:161]
v_cvt_pk_bf16_f32 v174, v138, v139
v_cvt_pk_bf16_f32 v175, v140, v141
v_cvt_pk_bf16_f32 v176, v142, v143
v_cvt_pk_bf16_f32 v177, v144, v145
v_cvt_pk_bf16_f32 v180, v150, 0
v_exp_f32_e64 v146, v146
v_mfma_f32_16x16x32_bf16 v[150:153], v[190:193], v[174:177], 0
v_exp_f32 v147, v147
v_mfma_f32_16x16x32_bf16 v[138:141], v[114:117], v[174:177], 0
s_waitcnt lgkmcnt(0)
v_exp_f32 v148, v148
v_mfma_f32_16x16x32_bf16 v[142:145], v[122:125], v[174:177], 0
s_barrier
ds_read_b128 v[170:173], v210 offset:38912
ds_read_b128 v[182:185], v210 offset:39936
ds_read_b128 v[186:189], v210 offset:40960
v_exp_f32_e64 v149, v149
v_cvt_pk_bf16_f32 v178, v146, v147
v_cvt_pk_bf16_f32 v179, v148, v149
v_mfma_f32_16x16x32_bf16 v[146:149], v[130:133], v[174:177], 0
v_mov_b32_dpp v154, v158 quad_perm:[0,1,2,3] row_mask:0x2 bank_mask:0xf
v_mfma_f32_16x16x32_bf16 v[150:153], v[190:193], v[178:181], v[150:153]
v_mov_b32_dpp v154, v162 quad_perm:[0,1,2,3] row_mask:0x4 bank_mask:0xf
v_mfma_f32_16x16x32_bf16 v[138:141], v[118:121], v[178:181], v[138:141]
v_mov_b32_dpp v154, v167 quad_perm:[0,1,2,3] row_mask:0x8 bank_mask:0xf
v_exp_f32_e64 v154, v154
v_mfma_f32_16x16x32_bf16 v[142:145], v[126:129], v[178:181], v[142:145]
v_cvt_pk_bf16_f32 v154, v154, 0
v_rcp_f32 v151, v150
v_mfma_f32_16x16x32_bf16 v[146:149], v[134:137], v[178:181], v[146:149]
s_waitcnt lgkmcnt(2)
ds_write_b16 v214, v154
v_mfma_f32_16x16x32_bf16 v[0:3], a[144:147], v[170:173], v[0:3]
ds_read_b128 v[84:87], v215
ds_read_b128 v[88:91], v215 offset:16
v_mfma_f32_16x16x32_bf16 v[4:7], a[168:171], v[170:173], v[4:7]
s_nop 0
ds_read_b128 v[174:177], v217
ds_read_b128 v[178:181], v217 offset:528
v_mfma_f32_16x16x32_bf16 v[8:11], a[192:195], v[170:173], v[8:11]
s_waitcnt lgkmcnt(6)
ds_read_b128 v[170:173], v210 offset:41984
v_add_u32 v215, 1552, v215
v_mfma_f32_16x16x32_bf16 v[0:3], a[148:151], v[182:185], v[0:3]
ds_read_b64 v[112:113], v215 offset:528
v_mfma_f32_16x16x32_bf16 v[4:7], a[172:175], v[182:185], v[4:7]
v_mfma_f32_16x16x32_bf16 v[8:11], a[196:199], v[182:185], v[8:11]
s_nop 0
ds_read_b128 v[182:185], v210 offset:43008
s_waitcnt lgkmcnt(6)
v_mfma_f32_16x16x32_bf16 v[166:169], v[84:87], v[190:193], 0
v_mfma_f32_16x16x32_bf16 v[154:157], v[84:87], v[114:117], 0
v_mfma_f32_16x16x32_bf16 v[158:161], v[84:87], v[122:125], 0
v_mfma_f32_16x16x32_bf16 v[162:165], v[84:87], v[130:133], 0
s_waitcnt lgkmcnt(5)
v_mfma_f32_16x16x32_bf16 v[166:169], v[88:91], v[190:193], v[166:169]
v_mfma_f32_16x16x32_bf16 v[154:157], v[88:91], v[118:121], v[154:157]
v_mfma_f32_16x16x32_bf16 v[158:161], v[88:91], v[126:129], v[158:161]
v_rcp_f32 v167, v166
v_mfma_f32_16x16x32_bf16 v[162:165], v[88:91], v[134:137], v[162:165]
v_max3_u32 v218, v218, v166, v167
v_max3_u32 v218, v218, v150, v151
v_mfma_f32_16x16x32_bf16 v[0:3], a[152:155], v[186:189], v[0:3]
v_mul_f32 v151, s3, v151
v_mul_f32 v138, v138, v151
v_mfma_f32_16x16x32_bf16 v[4:7], a[176:179], v[186:189], v[4:7]
v_mul_f32_e64 v139, v139, v151
v_mul_f32 v140, v140, v151
v_mfma_f32_16x16x32_bf16 v[8:11], a[200:203], v[186:189], v[8:11]
s_waitcnt lgkmcnt(2)
ds_read_b128 v[186:189], v210 offset:44032
v_mul_f32_e64 v141, v141, v151
v_mfma_f32_16x16x32_bf16 v[0:3], a[156:159], v[170:173], v[0:3]
v_cvt_pk_bf16_f32 v138, v138, v139
v_mul_f32_e64 v142, v142, v151
v_mfma_f32_16x16x32_bf16 v[4:7], a[180:183], v[170:173], v[4:7]
v_mul_f32_e64 v143, v143, v151
v_mul_f32 v144, v144, v151
v_mfma_f32_16x16x32_bf16 v[8:11], a[204:207], v[170:173], v[8:11]
s_waitcnt lgkmcnt(1)
ds_read_b128 v[170:173], v210 offset:45056
v_mul_f32_e64 v145, v145, v151
v_mfma_f32_16x16x32_bf16 v[0:3], a[160:163], v[182:185], v[0:3]
v_cvt_pk_bf16_f32 v139, v140, v141
v_cvt_pk_bf16_f32 v140, v142, v143
v_mfma_f32_16x16x32_bf16 v[4:7], a[184:187], v[182:185], v[4:7]
v_cvt_pk_bf16_f32 v141, v144, v145
v_mul_f32 v146, v146, v151
v_mfma_f32_16x16x32_bf16 v[8:11], a[208:211], v[182:185], v[8:11]
s_waitcnt lgkmcnt(1)
ds_read_b128 v[182:185], v210 offset:46080
ds_write_b128 v211, v[138:141] offset:51200
v_mfma_f32_16x16x32_bf16 v[0:3], a[164:167], v[186:189], v[0:3]
v_mul_f32 v147, v147, v151
v_mul_f32 v148, v148, v151
v_mfma_f32_16x16x32_bf16 v[4:7], a[188:191], v[186:189], v[4:7]
v_mul_f32 v149, v149, v151
v_cvt_pk_bf16_f32 v142, v146, v147
v_mfma_f32_16x16x32_bf16 v[8:11], a[212:215], v[186:189], v[8:11]
s_waitcnt lgkmcnt(2)
ds_read_b128 v[186:189], v210 offset:47104
v_cvt_pk_bf16_f32 v143, v148, v149
v_mfma_f32_16x16x32_bf16 v[12:15], a[144:147], v[170:173], v[12:15]
ds_write_b64 v212, v[142:143] offset:51200
v_mfma_f32_16x16x32_bf16 v[16:19], a[168:171], v[170:173], v[16:19]
s_nop 0
v_cvt_pk_bf16_f32 v72, v0, v1
v_cvt_pk_bf16_f32 v73, v2, v3
v_mfma_f32_16x16x32_bf16 v[20:23], a[192:195], v[170:173], v[20:23]
s_waitcnt lgkmcnt(3)
ds_read_b128 v[170:173], v210 offset:48128
buffer_store_dwordx2 v[72:73], v203, s[8:11], s38 offen
v_cvt_pk_bf16_f32 v74, v4, v5
v_mfma_f32_16x16x32_bf16 v[12:15], a[148:151], v[182:185], v[12:15]
v_cvt_pk_bf16_f32 v75, v6, v7
v_mov_b32_dpp v154, v158 quad_perm:[0,1,2,3] row_mask:0x2 bank_mask:0xf
v_mfma_f32_16x16x32_bf16 v[16:19], a[172:175], v[182:185], v[16:19]
v_mul_f32 v167, s3, v167
v_mov_b32_dpp v154, v162 quad_perm:[0,1,2,3] row_mask:0x4 bank_mask:0xf
v_mfma_f32_16x16x32_bf16 v[20:23], a[196:199], v[182:185], v[20:23]
s_waitcnt lgkmcnt(2)
ds_read_b128 v[182:185], v210 offset:49152
v_mul_f32_e64 v154, v154, v167
v_mfma_f32_16x16x32_bf16 v[12:15], a[152:155], v[186:189], v[12:15]
s_nop 0
v_cvt_pk_bf16_f32 v76, v8, v9
v_cvt_pk_bf16_f32 v77, v10, v11
v_mfma_f32_16x16x32_bf16 v[16:19], a[176:179], v[186:189], v[16:19]
s_waitcnt vmcnt(1) lgkmcnt(2)
v_cvt_pk_bf16_f32 v154, v154, 0
s_barrier
v_mfma_f32_16x16x32_bf16 v[20:23], a[200:203], v[186:189], v[20:23]
s_waitcnt lgkmcnt(1)
ds_read_b128 v[186:189], v210 offset:50176
ds_read_b128 v[84:87], v200
v_mfma_f32_16x16x32_bf16 v[12:15], a[156:159], v[170:173], v[12:15]
ds_read_b128 v[92:95], v201
ds_read_b128 v[100:103], v202
v_mfma_f32_16x16x32_bf16 v[16:19], a[180:183], v[170:173], v[16:19]
ds_read_b128 v[88:91], v194 offset:16
ds_read_b128 v[96:99], v195 offset:16
v_mfma_f32_16x16x32_bf16 v[20:23], a[204:207], v[170:173], v[20:23]
ds_read_b128 v[170:173], v210 offset:51200
s_waitcnt lgkmcnt(7)
v_mfma_f32_16x16x32_bf16 v[12:15], a[160:163], v[182:185], v[12:15]
ds_read_b128 v[104:107], v196 offset:16
v_mfma_f32_16x16x32_bf16 v[16:19], a[184:187], v[182:185], v[16:19]
buffer_store_dwordx2 v[74:75], v203, s[8:11], s38 offen offset:32
ds_write_b16 v214, v154
v_mfma_f32_16x16x32_bf16 v[20:23], a[208:211], v[182:185], v[20:23]
s_waitcnt lgkmcnt(8)
ds_read_b128 v[182:185], v210 offset:52224
v_add_u32 v214, 1552, v214
v_mfma_f32_16x16x32_bf16 v[12:15], a[164:167], v[186:189], v[12:15]
v_mfma_f32_16x16x32_bf16 v[16:19], a[188:191], v[186:189], v[16:19]
s_nop 0
v_mfma_f32_16x16x32_bf16 v[20:23], a[212:215], v[186:189], v[20:23]
s_waitcnt lgkmcnt(8)
ds_read_b128 v[186:189], v210 offset:53248
v_cvt_pk_bf16_f32 v78, v12, v13
v_mfma_f32_16x16x32_bf16 v[0:3], v[174:177], v[84:87], 0
s_waitcnt lgkmcnt(8)
ds_read_b128 v[84:87], v194
v_cvt_pk_bf16_f32 v79, v14, v15
v_mfma_f32_16x16x32_bf16 v[12:15], v[174:177], v[92:95], 0
s_waitcnt lgkmcnt(5)
ds_read_b128 v[92:95], v195
v_cvt_pk_bf16_f32 v80, v16, v17
v_mfma_f32_16x16x32_bf16 v[24:27], a[144:147], v[170:173], v[24:27]
v_cvt_pk_bf16_f32 v81, v18, v19
v_cvt_pk_bf16_f32 v82, v20, v21
v_mfma_f32_16x16x32_bf16 v[28:31], a[168:171], v[170:173], v[28:31]
v_cvt_pk_bf16_f32 v83, v22, v23
v_mfma_f32_16x16x32_bf16 v[32:35], a[192:195], v[170:173], v[32:35]
ds_read_b128 v[170:173], v210 offset:54272
s_waitcnt lgkmcnt(4)
v_mfma_f32_16x16x32_bf16 v[24:27], a[148:151], v[182:185], v[24:27]
v_mfma_f32_16x16x32_bf16 v[28:31], a[172:175], v[182:185], v[28:31]
v_mfma_f32_16x16x32_bf16 v[32:35], a[196:199], v[182:185], v[32:35]
ds_read_b128 v[182:185], v210 offset:55296
s_waitcnt lgkmcnt(4)
v_mfma_f32_16x16x32_bf16 v[24:27], a[152:155], v[186:189], v[24:27]
v_mfma_f32_16x16x32_bf16 v[28:31], a[176:179], v[186:189], v[28:31]
v_mfma_f32_16x16x32_bf16 v[32:35], a[200:203], v[186:189], v[32:35]
s_nop 0
ds_read_b128 v[186:189], v210 offset:56320
s_waitcnt lgkmcnt(2)
v_mfma_f32_16x16x32_bf16 v[24:27], a[156:159], v[170:173], v[24:27]
buffer_store_dwordx2 v[76:77], v203, s[8:11], s38 offen offset:64
v_mfma_f32_16x16x32_bf16 v[28:31], a[180:183], v[170:173], v[28:31]
v_mfma_f32_16x16x32_bf16 v[32:35], a[204:207], v[170:173], v[32:35]
s_waitcnt lgkmcnt(1)
v_mfma_f32_16x16x32_bf16 v[24:27], a[160:163], v[182:185], v[24:27]
v_mfma_f32_16x16x32_bf16 v[28:31], a[184:187], v[182:185], v[28:31]
v_mfma_f32_16x16x32_bf16 v[32:35], a[208:211], v[182:185], v[32:35]
ds_read_b128 v[182:185], v210 offset:20480
s_waitcnt lgkmcnt(1)
v_mfma_f32_16x16x32_bf16 v[24:27], a[164:167], v[186:189], v[24:27]
v_smfmac_f32_16x16x64_bf16 v[0:3], v[178:181], v[84:91], v213
ds_read_b128 v[84:87], v197
ds_read_b128 v[88:91], v197 offset:16
v_mfma_f32_16x16x32_bf16 v[28:31], a[188:191], v[186:189], v[28:31]
v_cvt_pk_bf16_f32 v116, v24, v25
v_cvt_pk_bf16_f32 v117, v26, v27
v_mfma_f32_16x16x32_bf16 v[24:27], v[174:177], v[100:103], 0
ds_read_b128 v[100:103], v196
ds_read_b128 v[174:177], v217 offset:1056
v_mfma_f32_16x16x32_bf16 v[32:35], a[212:215], v[186:189], v[32:35]
s_nop 0
ds_read_b128 v[186:189], v210 offset:21504
v_cvt_pk_bf16_f32 v124, v28, v29
v_smfmac_f32_16x16x64_bf16 v[12:15], v[178:181], v[92:99], v213
s_waitcnt lgkmcnt(5)
ds_read_b128 v[92:95], v198
ds_read_b128 v[96:99], v198 offset:16
v_mfma_f32_16x16x32_bf16 v[138:141], a[0:3], v[182:185], 0
v_cvt_pk_bf16_f32 v125, v30, v31
v_cvt_pk_bf16_f32 v132, v32, v33
v_mfma_f32_16x16x32_bf16 v[142:145], a[24:27], v[182:185], 0
s_nop 0
v_cvt_pk_bf16_f32 v133, v34, v35
v_mfma_f32_16x16x32_bf16 v[146:149], a[48:51], v[182:185], 0
s_waitcnt lgkmcnt(4)
v_smfmac_f32_16x16x64_bf16 v[24:27], v[178:181], v[100:107], v213
ds_read_b128 v[100:103], v199
ds_read_b128 v[104:107], v199 offset:16
v_mfma_f32_16x16x32_bf16 v[150:153], a[216:219], v[182:185], 0
ds_read_b128 v[178:181], v217 offset:1584
buffer_store_dwordx2 v[78:79], v204, s[8:11], s38 offen
s_waitcnt lgkmcnt(6)
v_smfmac_f32_16x16x64_bf16 v[0:3], v[174:177], v[84:91], v213
ds_read_b128 v[84:87], v200 offset:32
ds_read_b128 v[88:91], v194 offset:48
v_mfma_f32_16x16x32_bf16 v[154:157], a[240:243], v[182:185], 0
s_waitcnt lgkmcnt(5)
v_smfmac_f32_16x16x64_bf16 v[12:15], v[174:177], v[92:99], v213
ds_read_b128 v[92:95], v201 offset:32
ds_read_b128 v[96:99], v195 offset:48
v_mfma_f32_16x16x32_bf16 v[158:161], v[232:235], v[182:185], 0
v_mul_f32 v119, v0, v0
v_add_f32 v118, v0, v1
v_mfma_f32_16x16x32_bf16 v[162:165], v[182:185], a[72:75], 0
s_waitcnt lgkmcnt(5)
v_mul_f32 v127, v12, v12
v_add_f32_e64 v126, v12, v13
v_smfmac_f32_16x16x64_bf16 v[24:27], v[174:177], v[100:107], v213
ds_read_b128 v[100:103], v202 offset:32
ds_read_b128 v[174:177], v217 offset:2112
v_mfma_f32_16x16x32_bf16 v[166:169], v[182:185], a[96:99], 0
s_waitcnt lgkmcnt(5)
ds_read_b128 v[104:107], v196 offset:48
v_fmac_f32 v119, v1, v1
v_mfma_f32_16x16x32_bf16 v[4:7], v[178:181], v[84:87], 0
ds_read_b128 v[84:87], v194 offset:32
v_mul_f32 v135, v24, v24
v_mfma_f32_16x16x32_bf16 v[170:173], v[182:185], a[120:123], 0
s_waitcnt lgkmcnt(5)
ds_read_b128 v[182:185], v210 offset:22528
v_add_f32_e64 v134, v24, v25
v_mfma_f32_16x16x32_bf16 v[16:19], v[178:181], v[92:95], 0
ds_read_b128 v[92:95], v195 offset:32
v_fmac_f32_e64 v135, v25, v25
v_mfma_f32_16x16x32_bf16 v[138:141], a[4:7], v[186:189], v[138:141]
v_fmac_f32 v127, v13, v13
v_add_f32 v134, v134, v26
v_mfma_f32_16x16x32_bf16 v[142:145], a[28:31], v[186:189], v[142:145]
s_waitcnt lgkmcnt(5)
v_fmac_f32 v135, v26, v26
v_add_f32_e64 v118, v118, v2
v_mfma_f32_16x16x32_bf16 v[28:31], v[178:181], v[100:103], 0
ds_read_b128 v[100:103], v196 offset:32
ds_read_b128 v[178:181], v217 offset:2640
v_mfma_f32_16x16x32_bf16 v[146:149], a[52:55], v[186:189], v[146:149]
v_add_f32_e64 v126, v126, v14
v_fmac_f32 v119, v2, v2
v_mfma_f32_16x16x32_bf16 v[150:153], a[220:223], v[186:189], v[150:153]
s_waitcnt lgkmcnt(4)
buffer_store_dwordx2 v[80:81], v204, s[8:11], s38 offen offset:32
v_fmac_f32 v127, v14, v14
v_smfmac_f32_16x16x64_bf16 v[4:7], v[174:177], v[84:91], v213
s_waitcnt lgkmcnt(2)
ds_read_b128 v[84:87], v197 offset:32
ds_read_b128 v[88:91], v197 offset:48
v_smfmac_f32_16x16x64_bf16 v[16:19], v[174:177], v[92:99], v213
ds_read_b128 v[92:95], v198 offset:32
ds_read_b128 v[96:99], v198 offset:48
v_mfma_f32_16x16x32_bf16 v[154:157], a[244:247], v[186:189], v[154:157]
s_waitcnt lgkmcnt(5)
v_add_f32 v134, v134, v27
v_fmac_f32_e64 v135, v27, v27
v_smfmac_f32_16x16x64_bf16 v[28:31], v[174:177], v[100:107], v213
ds_read_b128 v[100:103], v199 offset:32
ds_read_b128 v[104:107], v199 offset:48
v_mfma_f32_16x16x32_bf16 v[158:161], v[236:239], v[186:189], v[158:161]
ds_read_b128 v[174:177], v217 offset:3168
v_add_f32_e64 v118, v118, v3
v_mfma_f32_16x16x32_bf16 v[162:165], v[186:189], a[76:79], v[162:165]
v_add_f32 v126, v126, v15
v_fmac_f32 v119, v3, v3
v_mfma_f32_16x16x32_bf16 v[166:169], v[186:189], a[100:103], v[166:169]
v_fmac_f32 v127, v15, v15
s_waitcnt lgkmcnt(5)
v_smfmac_f32_16x16x64_bf16 v[4:7], v[178:181], v[84:91], v213
ds_read_b128 v[84:87], v200 offset:64
ds_read_b128 v[88:91], v194 offset:80
v_mfma_f32_16x16x32_bf16 v[170:173], v[186:189], a[124:127], v[170:173]
s_nop 0
ds_read_b128 v[186:189], v210 offset:23552
s_waitcnt lgkmcnt(6)
v_smfmac_f32_16x16x64_bf16 v[16:19], v[178:181], v[92:99], v213
ds_read_b128 v[92:95], v201 offset:64
ds_read_b128 v[96:99], v195 offset:80
v_mfma_f32_16x16x32_bf16 v[138:141], a[8:11], v[182:185], v[138:141]
v_add_f32 v118, v118, v4
v_fmac_f32 v119, v4, v4
v_mfma_f32_16x16x32_bf16 v[142:145], a[32:35], v[182:185], v[142:145]
s_waitcnt lgkmcnt(6)
v_add_f32 v126, v126, v16
v_fmac_f32_e64 v127, v16, v16
v_smfmac_f32_16x16x64_bf16 v[28:31], v[178:181], v[100:107], v213
ds_read_b128 v[100:103], v202 offset:64
ds_read_b128 v[178:181], v217 offset:3696
v_mfma_f32_16x16x32_bf16 v[146:149], a[56:59], v[182:185], v[146:149]
s_waitcnt lgkmcnt(6)
ds_read_b128 v[104:107], v196 offset:80
v_add_f32 v118, v118, v5
v_mfma_f32_16x16x32_bf16 v[8:11], v[174:177], v[84:87], 0
ds_read_b128 v[84:87], v194 offset:64
v_add_f32_e64 v134, v134, v28
v_mfma_f32_16x16x32_bf16 v[150:153], a[224:227], v[182:185], v[150:153]
buffer_store_dwordx2 v[82:83], v204, s[8:11], s38 offen offset:64
v_fmac_f32 v135, v28, v28
v_mfma_f32_16x16x32_bf16 v[154:157], a[248:251], v[182:185], v[154:157]
s_waitcnt lgkmcnt(5)
v_add_f32 v134, v134, v29
v_fmac_f32 v135, v29, v29
v_mfma_f32_16x16x32_bf16 v[20:23], v[174:177], v[92:95], 0
s_waitcnt lgkmcnt(3)
ds_read_b128 v[92:95], v195 offset:64
v_fmac_f32 v119, v5, v5
v_mfma_f32_16x16x32_bf16 v[32:35], v[174:177], v[100:103], 0
ds_read_b128 v[100:103], v196 offset:64
ds_read_b128 v[174:177], v217 offset:4224
v_mfma_f32_16x16x32_bf16 v[158:161], v[240:243], v[182:185], v[158:161]
v_add_f32 v126, v126, v17
v_fmac_f32 v127, v17, v17
v_mfma_f32_16x16x32_bf16 v[162:165], v[182:185], a[80:83], v[162:165]
s_waitcnt lgkmcnt(3)
v_add_f32 v134, v134, v30
v_fmac_f32_e64 v135, v30, v30
v_smfmac_f32_16x16x64_bf16 v[8:11], v[178:181], v[84:91], v213
ds_read_b128 v[84:87], v197 offset:64
ds_read_b128 v[88:91], v197 offset:80
v_mfma_f32_16x16x32_bf16 v[166:169], v[182:185], a[104:107], v[166:169]
v_add_f32_e64 v118, v118, v6
v_fmac_f32 v119, v6, v6
v_mfma_f32_16x16x32_bf16 v[170:173], v[182:185], a[128:131], v[170:173]
s_waitcnt lgkmcnt(4)
ds_read_b128 v[182:185], v210 offset:24576
v_add_f32_e64 v126, v126, v18
v_smfmac_f32_16x16x64_bf16 v[20:23], v[178:181], v[92:99], v213
ds_read_b128 v[92:95], v198 offset:64
ds_read_b128 v[96:99], v198 offset:80
v_mfma_f32_16x16x32_bf16 v[138:141], a[12:15], v[186:189], v[138:141]
s_waitcnt lgkmcnt(6)
v_fmac_f32 v127, v18, v18
v_add_f32_e64 v134, v134, v31
v_smfmac_f32_16x16x64_bf16 v[32:35], v[178:181], v[100:107], v213
ds_read_b128 v[100:103], v199 offset:64
ds_read_b128 v[104:107], v199 offset:80
v_mfma_f32_16x16x32_bf16 v[142:145], a[36:39], v[186:189], v[142:145]
v_fmac_f32 v135, v31, v31
v_add_f32 v118, v118, v7
v_mfma_f32_16x16x32_bf16 v[146:149], a[60:63], v[186:189], v[146:149]
v_fmac_f32 v119, v7, v7
v_add_f32 v126, v126, v19
v_mfma_f32_16x16x32_bf16 v[150:153], a[228:231], v[186:189], v[150:153]
v_fmac_f32 v127, v19, v19
v_and_b32 v180, s44, v208
v_mfma_f32_16x16x32_bf16 v[154:157], a[252:255], v[186:189], v[154:157]
v_mov_b32 v181, 0
s_waitcnt lgkmcnt(5)
v_smfmac_f32_16x16x64_bf16 v[8:11], v[174:177], v[84:91], v213
buffer_store_dwordx2 v[116:117], v205, s[8:11], s38 offen
v_mfma_f32_16x16x32_bf16 v[158:161], v[244:247], v[186:189], v[158:161]
v_mfma_f32_16x16x32_bf16 v[162:165], v[186:189], a[84:87], v[162:165]
s_waitcnt lgkmcnt(2)
v_add_f32 v118, v118, v8
v_fmac_f32_e64 v119, v8, v8
v_smfmac_f32_16x16x64_bf16 v[20:23], v[174:177], v[92:99], v213
v_add_f32 v118, v118, v9
v_mfma_f32_16x16x32_bf16 v[166:169], v[186:189], a[108:111], v[166:169]
v_fmac_f32 v119, v9, v9
v_add_f32 v118, v118, v10
v_mfma_f32_16x16x32_bf16 v[170:173], v[186:189], a[132:135], v[170:173]
s_waitcnt lgkmcnt(0)
ds_read_b128 v[186:189], v210 offset:25600
v_add_f32_e64 v126, v126, v20
v_smfmac_f32_16x16x64_bf16 v[32:35], v[174:177], v[100:107], v213
v_fmac_f32_e64 v127, v20, v20
v_mfma_f32_16x16x32_bf16 v[138:141], a[16:19], v[182:185], v[138:141]
v_add_f32 v126, v126, v21
v_fmac_f32 v127, v21, v21
v_mfma_f32_16x16x32_bf16 v[142:145], a[40:43], v[182:185], v[142:145]
v_add_f32 v134, v134, v32
v_fmac_f32 v135, v32, v32
v_mfma_f32_16x16x32_bf16 v[146:149], a[64:67], v[182:185], v[146:149]
v_add_f32 v134, v134, v33
v_fmac_f32 v135, v33, v33
v_mfma_f32_16x16x32_bf16 v[150:153], a[232:235], v[182:185], v[150:153]
v_add_f32 v134, v134, v34
v_fmac_f32 v135, v34, v34
v_mfma_f32_16x16x32_bf16 v[154:157], v[224:227], v[182:185], v[154:157]
v_fmac_f32 v119, v10, v10
v_add_f32 v126, v126, v22
v_mfma_f32_16x16x32_bf16 v[158:161], v[248:251], v[182:185], v[158:161]
v_fmac_f32 v127, v22, v22
v_add_f32 v134, v134, v35
v_mfma_f32_16x16x32_bf16 v[162:165], v[182:185], a[88:91], v[162:165]
v_fmac_f32 v135, v35, v35
v_add_f32 v118, v118, v11
v_mfma_f32_16x16x32_bf16 v[166:169], v[182:185], a[112:115], v[166:169]
v_fmac_f32_e64 v119, v11, v11
v_add_f32 v126, v126, v23
v_mfma_f32_16x16x32_bf16 v[170:173], v[182:185], a[136:139], v[170:173]
s_waitcnt lgkmcnt(0)
ds_read_b128 v[182:185], v210 offset:26624
buffer_store_dwordx2 v[124:125], v205, s[8:11], s38 offen offset:32
v_fmac_f32_e64 v127, v23, v23
v_mfma_f32_16x16x32_bf16 v[138:141], a[20:23], v[186:189], v[138:141]
v_permlane16_swap_b32 v134, v135
v_mfma_f32_16x16x32_bf16 v[142:145], a[44:47], v[186:189], v[142:145]
v_permlane16_swap_b32 v118, v119
v_mfma_f32_16x16x32_bf16 v[146:149], a[68:71], v[186:189], v[146:149]
v_cvt_pk_bf16_f32 v78, v138, v139
v_cvt_pk_bf16_f32 v79, v140, v141
v_mfma_f32_16x16x32_bf16 v[150:153], a[236:239], v[186:189], v[150:153]
v_cvt_pk_bf16_f32 v80, v142, v143
v_cvt_pk_bf16_f32 v81, v144, v145
v_mfma_f32_16x16x32_bf16 v[154:157], v[228:231], v[186:189], v[154:157]
v_cvt_pk_bf16_f32 v82, v146, v147
v_cvt_pk_bf16_f32 v83, v148, v149
v_mfma_f32_16x16x32_bf16 v[158:161], v[252:255], v[186:189], v[158:161]
v_cvt_pk_bf16_f32 v72, v150, v151
v_cvt_pk_bf16_f32 v73, v152, v153
v_mfma_f32_16x16x32_bf16 v[162:165], v[186:189], a[92:95], v[162:165]
v_cvt_pk_bf16_f32 v74, v154, v155
v_cvt_pk_bf16_f32 v75, v156, v157
v_mfma_f32_16x16x32_bf16 v[166:169], v[186:189], a[116:119], v[166:169]
s_nop 0
v_cvt_pk_bf16_f32 v76, v158, v159
v_cvt_pk_bf16_f32 v77, v160, v161
v_mfma_f32_16x16x32_bf16 v[170:173], v[186:189], a[140:143], v[170:173]
s_waitcnt lgkmcnt(0)
ds_read_b128 v[186:189], v210 offset:27648
v_cvt_pk_bf16_f32 v114, v162, v163
v_mfma_f32_16x16x32_bf16 v[138:141], a[0:3], v[182:185], 0
v_cvt_pk_bf16_f32 v115, v164, v165
v_cvt_pk_bf16_f32 v122, v166, v167
v_mfma_f32_16x16x32_bf16 v[142:145], a[24:27], v[182:185], 0
v_cvt_pk_bf16_f32 v123, v168, v169
v_cvt_pk_bf16_f32 v130, v170, v171
v_mfma_f32_16x16x32_bf16 v[146:149], a[48:51], v[182:185], 0
v_cvt_pk_bf16_f32 v131, v172, v173
v_add_f32_e64 v134, v134, v135
v_mfma_f32_16x16x32_bf16 v[150:153], a[216:219], v[182:185], 0
v_permlane16_swap_b32 v126, v127
v_mfma_f32_16x16x32_bf16 v[154:157], a[240:243], v[182:185], 0
v_add_f32 v118, v118, v119
v_mov_b32_e64 v135, v134
v_mfma_f32_16x16x32_bf16 v[158:161], v[232:235], v[182:185], 0
v_add_f32 v126, v126, v127
v_permlane32_swap_b32 v134, v135
v_mfma_f32_16x16x32_bf16 v[162:165], v[182:185], a[72:75], 0
buffer_store_dwordx2 v[132:133], v205, s[8:11], s38 offen offset:64
v_permlane32_swap_b32 v118, v126
v_mfma_f32_16x16x32_bf16 v[166:169], v[182:185], a[96:99], 0
v_add_f32 v134, v134, v135
v_add_f32 v118, v118, v126
v_mfma_f32_16x16x32_bf16 v[170:173], v[182:185], a[120:123], 0
s_waitcnt lgkmcnt(0)
ds_write_b32 v209, v134 offset:512
v_mfma_f32_16x16x32_bf16 v[138:141], a[4:7], v[186:189], v[138:141]
ds_write_b32 v209, v118
v_mfma_f32_16x16x32_bf16 v[142:145], a[28:31], v[186:189], v[142:145]
ds_read_b128 v[182:185], v210 offset:28672
v_mfma_f32_16x16x32_bf16 v[146:149], a[52:55], v[186:189], v[146:149]
v_mfma_f32_16x16x32_bf16 v[150:153], a[220:223], v[186:189], v[150:153]
v_mfma_f32_16x16x32_bf16 v[154:157], a[244:247], v[186:189], v[154:157]
v_mfma_f32_16x16x32_bf16 v[158:161], v[236:239], v[186:189], v[158:161]
s_waitcnt lgkmcnt(1)
s_barrier
v_mfma_f32_16x16x32_bf16 v[162:165], v[186:189], a[76:79], v[162:165]
ds_read_b128 v[102:105], v210 offset:18432
ds_read_b128 v[106:109], v210 offset:19456
v_mfma_f32_16x16x32_bf16 v[166:169], v[186:189], a[100:103], v[166:169]
v_mfma_f32_16x16x32_bf16 v[170:173], v[186:189], a[124:127], v[170:173]
s_waitcnt lgkmcnt(0)
s_nop 6
v_subrev_u32 v216, 37120, v211
v_lshlrev_b32 v216, 3, v216
s_mov_b32 s46, 7
.p2align 6
F_loop:
ds_read_b128 v[186:189], v210 offset:29696
v_mfma_f32_16x16x32_bf16 v[138:141], a[8:11], v[182:185], v[138:141]
v_mfma_f32_16x16x32_bf16 v[142:145], a[32:35], v[182:185], v[142:145]
v_mfma_f32_16x16x32_bf16 v[146:149], a[56:59], v[182:185], v[146:149]
v_mfma_f32_16x16x32_bf16 v[150:153], a[224:227], v[182:185], v[150:153]
buffer_load_dwordx4 v180, s[4:7], s52 offen nt lds
v_mfma_f32_16x16x32_bf16 v[154:157], a[248:251], v[182:185], v[154:157]
s_waitcnt lgkmcnt(2)
v_add_f32 v102, v102, v103
v_add_f32_e64 v104, v104, v105
v_mfma_f32_16x16x32_bf16 v[158:161], v[240:243], v[182:185], v[158:161]
s_waitcnt lgkmcnt(1)
v_add_f32 v106, v106, v107
v_add_f32_e64 v108, v108, v109
v_mfma_f32_16x16x32_bf16 v[162:165], v[182:185], a[80:83], v[162:165]
s_waitcnt lgkmcnt(0)
v_add_f32 v102, v102, v104
v_add_f32_e64 v106, v106, v108
v_mfma_f32_16x16x32_bf16 v[166:169], v[182:185], a[104:107], v[166:169]
s_add_u32 m0, s45, 4112
ds_read_b128 v[108:111], v215 offset:512
v_mul_f32_e64 v103, s48, v102
v_mfma_f32_16x16x32_bf16 v[170:173], v[182:185], a[128:131], v[170:173]
s_add_u32 s40, s37, 196224
ds_read_b128 v[182:185], v210 offset:30720
v_mul_f32_e64 v104, s73, v102
v_mfma_f32_16x16x32_bf16 v[138:141], a[12:15], v[186:189], v[138:141]
v_mul_f32_e64 v106, s73, v106
v_fma_f32 v106, -v103, v104, v106
v_mfma_f32_16x16x32_bf16 v[142:145], a[36:39], v[186:189], v[142:145]
v_max_f32 v106, 0, v106
v_add_f32 v106, s49, v106
v_mfma_f32_16x16x32_bf16 v[146:149], a[60:63], v[186:189], v[146:149]
v_rsq_f32_e64 v102, v106
v_mfma_f32_16x16x32_bf16 v[150:153], a[228:231], v[186:189], v[150:153]
v_mul_f32_e64 v103, -v103, v102
v_mfma_f32_16x16x32_bf16 v[154:157], a[252:255], v[186:189], v[154:157]
buffer_load_dwordx4 v180, s[4:7], s40 offen nt lds
v_mfma_f32_16x16x32_bf16 v[158:161], v[244:247], v[186:189], v[158:161]
ds_write_b64 v211, v[102:103]
v_mfma_f32_16x16x32_bf16 v[162:165], v[186:189], a[84:87], v[162:165]
s_add_u32 m0, s45, 8224
s_add_u32 s40, s37, 392448
v_mfma_f32_16x16x32_bf16 v[166:169], v[186:189], a[108:111], v[166:169]
s_nop 0
ds_read_b64 v[118:119], v219
ds_read_b64 v[126:127], v219 offset:256
v_mfma_f32_16x16x32_bf16 v[170:173], v[186:189], a[132:135], v[170:173]
s_waitcnt lgkmcnt(3)
ds_read_b128 v[186:189], v210 offset:31744
ds_read_b64 v[134:135], v219 offset:512
v_mfma_f32_16x16x32_bf16 v[138:141], a[16:19], v[182:185], v[138:141]
v_mfma_f32_16x16x32_bf16 v[142:145], a[40:43], v[182:185], v[142:145]
v_mfma_f32_16x16x32_bf16 v[146:149], a[64:67], v[182:185], v[146:149]
s_nop 0
v_mfma_f32_16x16x32_bf16 v[150:153], a[232:235], v[182:185], v[150:153]
s_waitcnt lgkmcnt(3)
v_fma_f32 v220, v0, v118, v119
v_fma_f32 v221, v1, v118, v119
v_mfma_f32_16x16x32_bf16 v[154:157], v[224:227], v[182:185], v[154:157]
v_fma_f32 v222, v2, v118, v119
v_fma_f32 v223, v3, v118, v119
v_mfma_f32_16x16x32_bf16 v[158:161], v[248:251], v[182:185], v[158:161]
buffer_load_dwordx4 v180, s[4:7], s40 offen nt lds
v_mfma_f32_16x16x32_bf16 v[162:165], v[182:185], a[88:91], v[162:165]
s_add_u32 m0, s45, 12336
v_cvt_pk_bf16_f32 v90, v220, v221
v_cvt_pk_bf16_f32 v91, v222, v223
v_mfma_f32_16x16x32_bf16 v[166:169], v[182:185], a[112:115], v[166:169]
s_add_u32 s40, s37, 588672
v_fma_f32 v220, v4, v118, v119
v_fma_f32 v221, v5, v118, v119
v_mfma_f32_16x16x32_bf16 v[170:173], v[182:185], a[136:139], v[170:173]
s_waitcnt lgkmcnt(1)
ds_read_b128 v[182:185], v210 offset:32768
v_fma_f32 v222, v6, v118, v119
v_mfma_f32_16x16x32_bf16 v[138:141], a[20:23], v[186:189], v[138:141]
s_nop 0
v_fma_f32 v223, v7, v118, v119
v_cvt_pk_bf16_f32 v92, v220, v221
v_mfma_f32_16x16x32_bf16 v[142:145], a[44:47], v[186:189], v[142:145]
v_cvt_pk_bf16_f32 v93, v222, v223
v_fma_f32 v220, v8, v118, v119
v_mfma_f32_16x16x32_bf16 v[146:149], a[68:71], v[186:189], v[146:149]
ds_write_b128 v211, v[90:93]
v_mfma_f32_16x16x32_bf16 v[150:153], a[236:239], v[186:189], v[150:153]
v_cvt_pk_bf16_f32 v96, v138, v139
v_cvt_pk_bf16_f32 v97, v140, v141
v_mfma_f32_16x16x32_bf16 v[154:157], v[228:231], v[186:189], v[154:157]
v_cvt_pk_bf16_f32 v98, v142, v143
v_cvt_pk_bf16_f32 v99, v144, v145
v_mfma_f32_16x16x32_bf16 v[158:161], v[252:255], v[186:189], v[158:161]
buffer_load_dwordx4 v180, s[4:7], s40 offen nt lds
v_mfma_f32_16x16x32_bf16 v[162:165], v[186:189], a[92:95], v[162:165]
s_add_u32 m0, s45, 16448
v_cvt_pk_bf16_f32 v100, v146, v147
v_cvt_pk_bf16_f32 v101, v148, v149
v_mfma_f32_16x16x32_bf16 v[166:169], v[186:189], a[116:119], v[166:169]
s_add_u32 s40, s37, 784896
v_cvt_pk_bf16_f32 v88, v158, v159
v_cvt_pk_bf16_f32 v89, v160, v161
v_mfma_f32_16x16x32_bf16 v[170:173], v[186:189], a[140:143], v[170:173]
s_waitcnt lgkmcnt(1)
ds_read_b128 v[186:189], v210 offset:33792
v_cvt_pk_bf16_f32 v86, v154, v155
v_mfma_f32_16x16x32_bf16 v[138:141], a[0:3], v[182:185], 0
s_nop 0
v_cvt_pk_bf16_f32 v87, v156, v157
v_cvt_pk_bf16_f32 v124, v166, v167
v_mfma_f32_16x16x32_bf16 v[142:145], a[24:27], v[182:185], 0
v_cvt_pk_bf16_f32 v125, v168, v169
v_cvt_pk_bf16_f32 v84, v150, v151
v_mfma_f32_16x16x32_bf16 v[146:149], a[48:51], v[182:185], 0
ds_read_b128 v[182:185], v210 offset:34816
v_cvt_pk_bf16_f32 v85, v152, v153
v_cvt_pk_bf16_f32 v116, v162, v163
v_mfma_f32_16x16x16_bf16 v[154:157], v[82:83], v[88:89], 0
v_cvt_pk_bf16_f32 v117, v164, v165
v_fma_f32 v221, v9, v118, v119
v_fma_f32 v222, v10, v118, v119
v_mfma_f32_16x16x16_bf16 v[158:161], v[100:101], v[88:89], 0
v_fma_f32 v223, v11, v118, v119
v_cvt_pk_bf16_f32 v94, v220, v221
v_cvt_pk_bf16_f32 v95, v222, v223
v_fma_f32 v220, v12, v126, v127
s_waitcnt lgkmcnt(1)
v_mfma_f32_16x16x32_bf16 v[138:141], a[4:7], v[186:189], v[138:141]
buffer_load_dwordx4 v180, s[4:7], s40 offen nt lds
v_mfma_f32_16x16x32_bf16 v[142:145], a[28:31], v[186:189], v[142:145]
s_add_u32 m0, s45, 20560
ds_write_b64 v212, v[94:95]
v_mfma_f32_16x16x32_bf16 v[146:149], a[52:55], v[186:189], v[146:149]
s_waitcnt lgkmcnt(1)
v_fma_f32 v221, v13, v126, v127
v_fma_f32 v222, v14, v126, v127
v_mfma_f32_16x16x32_bf16 v[138:141], a[8:11], v[182:185], v[138:141]
s_add_u32 s40, s37, 981120
ds_read_b128 v[186:189], v210 offset:35840
v_fma_f32 v223, v15, v126, v127
v_mfma_f32_16x16x32_bf16 v[142:145], a[32:35], v[182:185], v[142:145]
v_cvt_pk_bf16_f32 v174, v220, v221
v_cvt_pk_bf16_f32 v175, v222, v223
v_mfma_f32_16x16x32_bf16 v[146:149], a[56:59], v[182:185], v[146:149]
ds_read_b128 v[182:185], v210 offset:36864
v_fma_f32 v220, v16, v126, v127
v_fma_f32 v221, v17, v126, v127
v_mfma_f32_16x16x16_bf16 v[166:169], v[112:113], v[88:89], v[206:209]
v_fma_f32 v222, v18, v126, v127
v_fma_f32 v223, v19, v126, v127
v_cvt_pk_bf16_f32 v176, v220, v221
v_mfma_f32_16x16x16_bf16 v[150:153], v[112:113], v[76:77], v[206:209]
v_cvt_pk_bf16_f32 v177, v222, v223
v_fma_f32 v220, v20, v126, v127
v_fma_f32 v221, v21, v126, v127
v_fma_f32 v222, v22, v126, v127
v_mfma_f32_16x16x32_bf16 v[154:157], v[78:81], v[84:87], v[154:157]
s_waitcnt lgkmcnt(1)
ds_write_b128 v211, v[174:177] offset:6144
v_mfma_f32_16x16x32_bf16 v[138:141], a[12:15], v[186:189], v[138:141]
s_waitcnt lgkmcnt(1)
buffer_load_dwordx4 v180, s[4:7], s40 offen nt lds
v_mfma_f32_16x16x32_bf16 v[142:145], a[36:39], v[186:189], v[142:145]
s_add_u32 m0, s45, 24672
v_fma_f32 v223, v23, v126, v127
v_cvt_pk_bf16_f32 v178, v220, v221
v_mfma_f32_16x16x32_bf16 v[146:149], a[60:63], v[186:189], v[146:149]
s_add_u32 s40, s37, 1177344
ds_read_b128 v[186:189], v210 offset:37888
v_cvt_pk_bf16_f32 v179, v222, v223
v_mfma_f32_16x16x32_bf16 v[138:141], a[16:19], v[182:185], v[138:141]
ds_write_b64 v212, v[178:179] offset:6144
v_mfma_f32_16x16x32_bf16 v[142:145], a[40:43], v[182:185], v[142:145]
v_fma_f32 v220, v24, v134, v135
v_fma_f32 v221, v25, v134, v135
v_mfma_f32_16x16x32_bf16 v[150:153], v[108:111], v[72:75], v[150:153]
v_fma_f32 v222, v26, v134, v135
v_fma_f32 v223, v27, v134, v135
v_mfma_f32_16x16x32_bf16 v[146:149], a[64:67], v[182:185], v[146:149]
s_nop 0
ds_read_b128 v[182:185], v210 offset:32768
v_cvt_pk_bf16_f32 v90, v220, v221
v_mfma_f32_16x16x32_bf16 v[158:161], v[96:99], v[84:87], v[158:161]
s_waitcnt lgkmcnt(2)
v_cvt_pk_bf16_f32 v91, v222, v223
v_fma_f32 v220, v28, v134, v135
v_mfma_f32_16x16x32_bf16 v[138:141], a[20:23], v[186:189], v[138:141]
v_fma_f32 v221, v29, v134, v135
v_fma_f32 v222, v30, v134, v135
v_mfma_f32_16x16x32_bf16 v[142:145], a[44:47], v[186:189], v[142:145]
buffer_load_dwordx4 v180, s[4:7], s40 offen nt lds
v_mfma_f32_16x16x32_bf16 v[146:149], a[68:71], v[186:189], v[146:149]
s_add_u32 m0, s45, 28784
ds_read_b128 v[186:189], v210 offset:33792
v_cvt_pk_bf16_f32 v102, v138, v139
v_mfma_f32_16x16x32_bf16 v[166:169], v[108:111], v[84:87], v[166:169]
s_add_u32 s40, s37, 1373568
v_cvt_pk_bf16_f32 v103, v140, v141
v_cvt_pk_bf16_f32 v104, v142, v143
v_cvt_pk_bf16_f32 v105, v144, v145
v_mfma_f32_16x16x16_bf16 v[138:141], v[82:83], v[76:77], 0
v_cvt_pk_bf16_f32 v106, v146, v147
v_cvt_pk_bf16_f32 v107, v148, v149
v_fma_f32 v223, v31, v134, v135
v_mfma_f32_16x16x16_bf16 v[142:145], v[100:101], v[76:77], 0
v_cvt_pk_bf16_f32 v92, v220, v221
v_cvt_pk_bf16_f32 v93, v222, v223
v_fma_f32 v220, v32, v134, v135
v_mfma_f32_16x16x16_bf16 v[162:165], v[106:107], v[88:89], 0
v_fma_f32 v221, v33, v134, v135
v_fma_f32 v222, v34, v134, v135
v_fma_f32 v223, v35, v134, v135
v_mfma_f32_16x16x16_bf16 v[146:149], v[106:107], v[76:77], 0
v_cvt_pk_bf16_f32 v132, v170, v171
v_cvt_pk_bf16_f32 v133, v172, v173
v_cvt_pk_bf16_f32 v94, v220, v221
v_cvt_pk_bf16_f32 v95, v222, v223
v_mfma_f32_16x16x32_bf16 v[138:141], v[78:81], v[72:75], v[138:141]
ds_write_b128 v211, v[90:93] offset:12288
v_mfma_f32_16x16x32_bf16 v[142:145], v[96:99], v[72:75], v[142:145]
s_waitcnt lgkmcnt(2)
v_exp_f32 v138, v138
v_mfma_f32_16x16x32_bf16 v[118:121], v[182:185], a[72:75], 0
buffer_load_dwordx4 v180, s[4:7], s40 offen nt lds
v_mfma_f32_16x16x32_bf16 v[126:129], v[182:185], a[96:99], 0
s_add_u32 m0, s45, 32896
ds_write_b64 v212, v[94:95] offset:12288
v_mfma_f32_16x16x32_bf16 v[134:137], v[182:185], a[120:123], 0
s_add_u32 s40, s37, 1569792
v_exp_f32_e64 v139, v139
v_mfma_f32_16x16x32_bf16 v[146:149], v[102:105], v[72:75], v[146:149]
ds_read_b64 v[76:77], v215 offset:16
v_cvt_pk_bf16_f32 v174, v138, v139
v_mfma_f32_16x16x32_bf16 v[90:93], a[216:219], v[182:185], 0
v_exp_f32_e64 v140, v140
v_mfma_f32_16x16x32_bf16 v[170:173], a[240:243], v[182:185], 0
v_exp_f32 v141, v141
v_mfma_f32_16x16x32_bf16 v[220:223], v[232:235], v[182:185], 0
s_waitcnt lgkmcnt(3)
ds_read_b128 v[182:185], v210 offset:34816
v_cvt_pk_bf16_f32 v175, v140, v141
v_mfma_f32_16x16x32_bf16 v[118:121], v[186:189], a[76:79], v[118:121]
v_exp_f32 v142, v142
v_mfma_f32_16x16x32_bf16 v[126:129], v[186:189], a[100:103], v[126:129]
v_exp_f32 v143, v143
v_mfma_f32_16x16x32_bf16 v[134:137], v[186:189], a[124:127], v[134:137]
v_exp_f32_e64 v144, v144
v_mfma_f32_16x16x32_bf16 v[90:93], a[220:223], v[186:189], v[90:93]
buffer_load_dwordx4 v180, s[4:7], s40 offen nt lds
v_mfma_f32_16x16x32_bf16 v[170:173], a[244:247], v[186:189], v[170:173]
v_exp_f32 v145, v145
v_mfma_f32_16x16x32_bf16 v[220:223], v[236:239], v[186:189], v[220:223]
s_waitcnt lgkmcnt(0)
ds_read_b128 v[186:189], v210 offset:35840
v_cvt_pk_bf16_f32 v176, v142, v143
v_mfma_f32_16x16x32_bf16 v[118:121], v[182:185], a[80:83], v[118:121]
v_exp_f32_e64 v150, v150
v_mfma_f32_16x16x32_bf16 v[126:129], v[182:185], a[104:107], v[126:129]
v_cvt_pk_bf16_f32 v177, v144, v145
v_cvt_pk_bf16_f32 v180, v150, 0
v_mfma_f32_16x16x32_bf16 v[134:137], v[182:185], a[128:131], v[134:137]
v_exp_f32 v154, v154
v_mfma_f32_16x16x32_bf16 v[90:93], a[224:227], v[182:185], v[90:93]
v_exp_f32 v155, v155
v_mfma_f32_16x16x32_bf16 v[162:165], v[102:105], v[84:87], v[162:165]
v_exp_f32_e64 v156, v156
v_mfma_f32_16x16x32_bf16 v[170:173], a[248:251], v[182:185], v[170:173]
v_exp_f32 v157, v157
v_mfma_f32_16x16x32_bf16 v[220:223], v[240:243], v[182:185], v[220:223]
s_waitcnt lgkmcnt(0)
ds_read_b128 v[182:185], v210 offset:36864
ds_read_b128 v[72:75], v215
v_mfma_f32_16x16x32_bf16 v[118:121], v[186:189], a[84:87], v[118:121]
v_exp_f32 v158, v158
v_mfma_f32_16x16x32_bf16 v[126:129], v[186:189], a[108:111], v[126:129]
v_exp_f32 v159, v159
v_mfma_f32_16x16x32_bf16 v[134:137], v[186:189], a[132:135], v[134:137]
v_exp_f32 v160, v160
v_mfma_f32_16x16x32_bf16 v[90:93], a[228:231], v[186:189], v[90:93]
v_exp_f32 v161, v161
v_mfma_f32_16x16x32_bf16 v[170:173], a[252:255], v[186:189], v[170:173]
v_exp_f32 v166, v166
v_mfma_f32_16x16x32_bf16 v[220:223], v[244:247], v[186:189], v[220:223]
s_waitcnt lgkmcnt(1)
ds_read_b128 v[186:189], v210 offset:37888
v_exp_f32 v146, v146
v_mfma_f32_16x16x32_bf16 v[118:121], v[182:185], a[88:91], v[118:121]
v_exp_f32 v147, v147
v_mfma_f32_16x16x32_bf16 v[126:129], v[182:185], a[112:115], v[126:129]
v_exp_f32 v148, v148
v_mfma_f32_16x16x32_bf16 v[134:137], v[182:185], a[136:139], v[134:137]
v_exp_f32 v149, v149
v_mfma_f32_16x16x32_bf16 v[90:93], a[232:235], v[182:185], v[90:93]
v_exp_f32 v162, v162
v_mfma_f32_16x16x32_bf16 v[170:173], v[224:227], v[182:185], v[170:173]
v_exp_f32 v163, v163
v_mfma_f32_16x16x32_bf16 v[220:223], v[248:251], v[182:185], v[220:223]
s_waitcnt lgkmcnt(0)
v_exp_f32 v164, v164
v_mfma_f32_16x16x32_bf16 v[118:121], v[186:189], a[92:95], v[118:121]
v_exp_f32_e64 v165, v165
v_mfma_f32_16x16x32_bf16 v[126:129], v[186:189], a[116:119], v[126:129]
v_cvt_pk_bf16_f32 v178, v146, v147
v_cvt_pk_bf16_f32 v179, v148, v149
v_mfma_f32_16x16x32_bf16 v[134:137], v[186:189], a[140:143], v[134:137]
v_cvt_pk_bf16_f32 v118, v118, v119
v_cvt_pk_bf16_f32 v119, v120, v121
v_mfma_f32_16x16x32_bf16 v[90:93], a[236:239], v[186:189], v[90:93]
ds_read_u16 v120, v214 offset:1024
v_cvt_pk_bf16_f32 v126, v126, v127
v_mfma_f32_16x16x32_bf16 v[170:173], v[228:231], v[186:189], v[170:173]
v_cvt_pk_bf16_f32 v127, v128, v129
v_cvt_pk_bf16_f32 v134, v134, v135
v_mfma_f32_16x16x32_bf16 v[220:223], v[252:255], v[186:189], v[220:223]
ds_read_u16 v128, v214 offset:1032
v_cvt_pk_bf16_f32 v90, v90, v91
v_mfma_f32_16x16x32_bf16 v[150:153], v[190:193], v[174:177], 0
v_cvt_pk_bf16_f32 v91, v92, v93
v_cvt_pk_bf16_f32 v92, v170, v171
v_mfma_f32_16x16x32_bf16 v[138:141], v[114:117], v[174:177], 0
v_cvt_pk_bf16_f32 v93, v172, v173
v_cvt_pk_bf16_f32 v135, v136, v137
v_mfma_f32_16x16x32_bf16 v[142:145], v[122:125], v[174:177], 0
ds_read_u16 v136, v214 offset:1040
v_mov_b32 v121, 0
v_mfma_f32_16x16x32_bf16 v[146:149], v[130:133], v[174:177], 0
v_cvt_pk_bf16_f32 v174, v154, v155
v_cvt_pk_bf16_f32 v175, v156, v157
v_mfma_f32_16x16x32_bf16 v[150:153], v[190:193], v[178:181], v[150:153]
s_waitcnt lgkmcnt(2)
v_cvt_pk_bf16_f32 v176, v158, v159
v_cvt_pk_bf16_f32 v177, v160, v161
v_mfma_f32_16x16x32_bf16 v[138:141], v[118:121], v[178:181], v[138:141]
v_mov_b32 v129, 0
v_mov_b32 v137, 0
v_mfma_f32_16x16x32_bf16 v[154:157], v[114:117], v[174:177], 0
v_rcp_f32 v151, v150
v_mfma_f32_16x16x32_bf16 v[158:161], v[122:125], v[174:177], 0
s_waitcnt lgkmcnt(1)
v_max3_u32 v218, v218, v150, v151
v_mul_f32_e64 v151, s3, v151
v_mfma_f32_16x16x32_bf16 v[142:145], v[126:129], v[178:181], v[142:145]
s_waitcnt lgkmcnt(0)
v_mul_f32 v138, v138, v151
v_mul_f32_e64 v139, v139, v151
v_mfma_f32_16x16x32_bf16 v[146:149], v[134:137], v[178:181], v[146:149]
v_cvt_pk_bf16_f32 v180, v166, 0
v_mul_f32_e64 v140, v140, v151
v_mfma_f32_16x16x32_bf16 v[166:169], v[190:193], v[174:177], 0
v_mul_f32_e64 v141, v141, v151
v_cvt_pk_bf16_f32 v138, v138, v139
v_mul_f32 v142, v142, v151
v_mul_f32 v143, v143, v151
v_mul_f32 v144, v144, v151
v_mul_f32 v145, v145, v151
v_cvt_pk_bf16_f32 v139, v140, v141
v_cvt_pk_bf16_f32 v140, v142, v143
v_cvt_pk_bf16_f32 v141, v144, v145
v_cvt_pk_bf16_f32 v178, v162, v163
v_cvt_pk_bf16_f32 v179, v164, v165
v_mfma_f32_16x16x32_bf16 v[162:165], v[130:133], v[174:177], 0
ds_write_b128 v211, v[138:141] offset:38912
v_mfma_f32_16x16x32_bf16 v[138:141], v[78:81], v[90:93], 0
v_mul_f32 v146, v146, v151
v_mul_f32 v147, v147, v151
v_mfma_f32_16x16x32_bf16 v[166:169], v[190:193], v[178:181], v[166:169]
v_mul_f32 v148, v148, v151
v_mul_f32 v149, v149, v151
v_mfma_f32_16x16x32_bf16 v[154:157], v[118:121], v[178:181], v[154:157]
v_cvt_pk_bf16_f32 v142, v146, v147
v_cvt_pk_bf16_f32 v143, v148, v149
v_mfma_f32_16x16x32_bf16 v[158:161], v[126:129], v[178:181], v[158:161]
ds_write_b64 v212, v[142:143] offset:38912
v_mfma_f32_16x16x32_bf16 v[142:145], v[96:99], v[90:93], 0
v_rcp_f32_e64 v167, v166
v_mfma_f32_16x16x32_bf16 v[162:165], v[134:137], v[178:181], v[162:165]
v_max3_u32 v218, v218, v166, v167
v_cvt_pk_bf16_f32 v94, v220, v221
v_mfma_f32_16x16x32_bf16 v[150:153], v[108:111], v[90:93], v[206:209]
v_cvt_pk_bf16_f32 v95, v222, v223
v_mul_f32_e64 v167, s3, v167
v_mfma_f32_16x16x32_bf16 v[146:149], v[102:105], v[90:93], 0
v_mul_f32 v154, v154, v167
v_mul_f32 v155, v155, v167
v_mul_f32_e64 v156, v156, v167
v_mfma_f32_16x16x16_bf16 v[138:141], v[82:83], v[94:95], v[138:141]
v_mul_f32_e64 v157, v157, v167
v_cvt_pk_bf16_f32 v154, v154, v155
v_mul_f32_e64 v158, v158, v167
v_mfma_f32_16x16x16_bf16 v[142:145], v[100:101], v[94:95], v[142:145]
v_mul_f32 v159, v159, v167
v_mul_f32 v160, v160, v167
v_mul_f32_e64 v161, v161, v167
v_mfma_f32_16x16x16_bf16 v[150:153], v[112:113], v[94:95], v[150:153]
v_cvt_pk_bf16_f32 v155, v156, v157
v_cvt_pk_bf16_f32 v156, v158, v159
v_cvt_pk_bf16_f32 v157, v160, v161
v_mfma_f32_16x16x16_bf16 v[146:149], v[106:107], v[94:95], v[146:149]
v_mul_f32 v162, v162, v167
v_mul_f32 v163, v163, v167
v_mul_f32 v164, v164, v167
v_mul_f32 v165, v165, v167
v_mfma_f32_16x16x16_bf16 v[166:169], v[76:77], v[112:113], v[206:209]
v_cvt_pk_bf16_f32 v158, v162, v163
v_cvt_pk_bf16_f32 v159, v164, v165
v_exp_f32 v138, v138
v_mfma_f32_16x16x16_bf16 v[162:165], v[76:77], v[106:107], 0
v_exp_f32 v139, v139
v_exp_f32 v140, v140
v_mfma_f32_16x16x32_bf16 v[166:169], v[72:75], v[108:111], v[166:169]
ds_write_b128 v211, v[154:157] offset:45056
v_mfma_f32_16x16x16_bf16 v[154:157], v[76:77], v[82:83], 0
v_exp_f32 v141, v141
v_exp_f32 v142, v142
v_mfma_f32_16x16x32_bf16 v[162:165], v[72:75], v[102:105], v[162:165]
v_exp_f32 v143, v143
v_mfma_f32_16x16x32_bf16 v[154:157], v[72:75], v[78:81], v[154:157]
ds_write_b64 v212, v[158:159] offset:45056
v_mfma_f32_16x16x16_bf16 v[158:161], v[76:77], v[100:101], 0
v_exp_f32 v144, v144
v_exp_f32 v145, v145
v_exp_f32_e64 v150, v150
v_mfma_f32_16x16x32_bf16 v[158:161], v[72:75], v[96:99], v[158:161]
v_cvt_pk_bf16_f32 v174, v138, v139
v_cvt_pk_bf16_f32 v175, v140, v141
v_cvt_pk_bf16_f32 v176, v142, v143
v_cvt_pk_bf16_f32 v177, v144, v145
v_cvt_pk_bf16_f32 v180, v150, 0
v_exp_f32_e64 v146, v146
v_mfma_f32_16x16x32_bf16 v[150:153], v[190:193], v[174:177], 0
v_exp_f32 v147, v147
v_mfma_f32_16x16x32_bf16 v[138:141], v[114:117], v[174:177], 0
s_waitcnt lgkmcnt(0)
v_exp_f32 v148, v148
v_mfma_f32_16x16x32_bf16 v[142:145], v[122:125], v[174:177], 0
s_barrier
ds_read_b128 v[170:173], v210 offset:38912
ds_read_b128 v[182:185], v210 offset:39936
ds_read_b128 v[186:189], v210 offset:40960
v_exp_f32_e64 v149, v149
v_cvt_pk_bf16_f32 v178, v146, v147
v_cvt_pk_bf16_f32 v179, v148, v149
v_mfma_f32_16x16x32_bf16 v[146:149], v[130:133], v[174:177], 0
v_mov_b32_dpp v154, v158 quad_perm:[0,1,2,3] row_mask:0x2 bank_mask:0xf
v_mfma_f32_16x16x32_bf16 v[150:153], v[190:193], v[178:181], v[150:153]
v_mov_b32_dpp v154, v162 quad_perm:[0,1,2,3] row_mask:0x4 bank_mask:0xf
v_mfma_f32_16x16x32_bf16 v[138:141], v[118:121], v[178:181], v[138:141]
v_mov_b32_dpp v154, v167 quad_perm:[0,1,2,3] row_mask:0x8 bank_mask:0xf
v_exp_f32_e64 v154, v154
v_mfma_f32_16x16x32_bf16 v[142:145], v[126:129], v[178:181], v[142:145]
v_cvt_pk_bf16_f32 v154, v154, 0
v_rcp_f32 v151, v150
v_mfma_f32_16x16x32_bf16 v[146:149], v[134:137], v[178:181], v[146:149]
s_waitcnt lgkmcnt(2)
ds_write_b16 v214, v154
v_mfma_f32_16x16x32_bf16 v[36:39], a[144:147], v[170:173], v[36:39]
ds_read_b128 v[84:87], v215
ds_read_b128 v[88:91], v215 offset:16
v_mfma_f32_16x16x32_bf16 v[40:43], a[168:171], v[170:173], v[40:43]
ds_read_b128 v[174:177], v217
ds_read_b128 v[178:181], v217 offset:528
v_mfma_f32_16x16x32_bf16 v[44:47], a[192:195], v[170:173], v[44:47]
ds_read_b128 v[170:173], v210 offset:41984
s_waitcnt lgkmcnt(7)
v_mfma_f32_16x16x32_bf16 v[36:39], a[148:151], v[182:185], v[36:39]
v_mfma_f32_16x16x32_bf16 v[40:43], a[172:175], v[182:185], v[40:43]
v_mfma_f32_16x16x32_bf16 v[44:47], a[196:199], v[182:185], v[44:47]
ds_read_b128 v[182:185], v210 offset:43008
s_waitcnt lgkmcnt(5)
v_mfma_f32_16x16x32_bf16 v[166:169], v[84:87], v[190:193], 0
v_mfma_f32_16x16x32_bf16 v[154:157], v[84:87], v[114:117], 0
v_mfma_f32_16x16x32_bf16 v[158:161], v[84:87], v[122:125], 0
s_mul_hi_u32 s41, s35, 58835169
s_mul_i32 s42, s41, 73
s_waitcnt lgkmcnt(4)
v_mfma_f32_16x16x32_bf16 v[162:165], v[84:87], v[130:133], 0
s_sub_u32 s42, s35, s42
s_mul_i32 s43, s41, 1373568
s_mul_i32 s51, s42, 2688
v_mfma_f32_16x16x32_bf16 v[166:169], v[88:91], v[190:193], v[166:169]
s_add_u32 s43, s43, s51
v_mfma_f32_16x16x32_bf16 v[154:157], v[88:91], v[118:121], v[154:157]
s_cmp_lt_u32 s35, s34
s_cselect_b32 s50, s43, 1879048192
s_waitcnt lgkmcnt(0)
v_mfma_f32_16x16x32_bf16 v[158:161], v[88:91], v[126:129], v[158:161]
s_add_u32 s35, s35, 32
v_rcp_f32 v167, v166
v_mfma_f32_16x16x32_bf16 v[162:165], v[88:91], v[134:137], v[162:165]
s_cmp_eq_u32 s42, 0
v_max3_u32 v218, v218, v166, v167
v_max3_u32 v218, v218, v150, v151
v_mfma_f32_16x16x32_bf16 v[36:39], a[152:155], v[186:189], v[36:39]
s_cselect_b32 s44, 536870911, s72
v_mul_f32 v151, s3, v151
v_mul_f32 v138, v138, v151
v_mfma_f32_16x16x32_bf16 v[40:43], a[176:179], v[186:189], v[40:43]
s_cmp_eq_u32 s42, 72
v_mul_f32 v139, v139, v151
v_mul_f32 v140, v140, v151
v_mfma_f32_16x16x32_bf16 v[44:47], a[200:203], v[186:189], v[44:47]
s_cselect_b32 s44, 939524095, s44
ds_read_b128 v[186:189], v210 offset:44032
v_mul_f32 v141, v141, v151
v_mfma_f32_16x16x32_bf16 v[36:39], a[156:159], v[170:173], v[36:39]
s_cmp_eq_u32 s41, 0
v_cvt_pk_bf16_f32 v138, v138, v139
v_mul_f32_e64 v142, v142, v151
v_mfma_f32_16x16x32_bf16 v[40:43], a[180:183], v[170:173], v[40:43]
s_cselect_b32 s52, 1879048192, s50
v_mul_f32 v143, v143, v151
v_mul_f32 v144, v144, v151
v_mfma_f32_16x16x32_bf16 v[44:47], a[204:207], v[170:173], v[44:47]
s_add_u32 m0, s45, 0
ds_read_b128 v[170:173], v210 offset:45056
v_mul_f32 v145, v145, v151
v_mfma_f32_16x16x32_bf16 v[36:39], a[160:163], v[182:185], v[36:39]
v_cvt_pk_bf16_f32 v139, v140, v141
v_cvt_pk_bf16_f32 v140, v142, v143
v_mfma_f32_16x16x32_bf16 v[40:43], a[184:187], v[182:185], v[40:43]
v_cvt_pk_bf16_f32 v141, v144, v145
v_mul_f32 v146, v146, v151
v_mfma_f32_16x16x32_bf16 v[44:47], a[208:211], v[182:185], v[44:47]
s_waitcnt lgkmcnt(1)
ds_read_b128 v[182:185], v210 offset:46080
ds_write_b128 v211, v[138:141] offset:51200
v_mfma_f32_16x16x32_bf16 v[36:39], a[164:167], v[186:189], v[36:39]
s_mov_b32 s38, s36
v_mul_f32 v147, v147, v151
v_mul_f32_e64 v148, v148, v151
v_mfma_f32_16x16x32_bf16 v[40:43], a[188:191], v[186:189], v[40:43]
s_waitcnt lgkmcnt(2)
v_mul_f32 v149, v149, v151
v_cvt_pk_bf16_f32 v142, v146, v147
v_mfma_f32_16x16x32_bf16 v[44:47], a[212:215], v[186:189], v[44:47]
s_mov_b32 s36, s50
ds_read_b128 v[186:189], v210 offset:47104
v_cvt_pk_bf16_f32 v143, v148, v149
v_mfma_f32_16x16x32_bf16 v[48:51], a[144:147], v[170:173], v[48:51]
ds_write_b64 v212, v[142:143] offset:51200
v_mfma_f32_16x16x32_bf16 v[52:55], a[168:171], v[170:173], v[52:55]
v_cvt_pk_bf16_f32 v72, v36, v37
v_cvt_pk_bf16_f32 v73, v38, v39
v_mfma_f32_16x16x32_bf16 v[56:59], a[192:195], v[170:173], v[56:59]
s_waitcnt lgkmcnt(3)
ds_read_b128 v[170:173], v210 offset:48128
buffer_store_dwordx2 v[72:73], v203, s[8:11], s39 offen
v_cvt_pk_bf16_f32 v74, v40, v41
v_mfma_f32_16x16x32_bf16 v[48:51], a[148:151], v[182:185], v[48:51]
v_cvt_pk_bf16_f32 v75, v42, v43
v_mov_b32_dpp v154, v158 quad_perm:[0,1,2,3] row_mask:0x2 bank_mask:0xf
v_mfma_f32_16x16x32_bf16 v[52:55], a[172:175], v[182:185], v[52:55]
v_mul_f32 v167, s3, v167
v_mov_b32_dpp v154, v162 quad_perm:[0,1,2,3] row_mask:0x4 bank_mask:0xf
v_mfma_f32_16x16x32_bf16 v[56:59], a[196:199], v[182:185], v[56:59]
s_waitcnt lgkmcnt(2)
ds_read_b128 v[182:185], v210 offset:49152
v_mul_f32_e64 v154, v154, v167
v_mfma_f32_16x16x32_bf16 v[48:51], a[152:155], v[186:189], v[48:51]
v_cvt_pk_bf16_f32 v154, v154, 0
v_cvt_pk_bf16_f32 v76, v44, v45
v_mfma_f32_16x16x32_bf16 v[52:55], a[176:179], v[186:189], v[52:55]
s_waitcnt vmcnt(1) lgkmcnt(1)
ds_write_b16 v214, v154
v_mfma_f32_16x16x32_bf16 v[56:59], a[200:203], v[186:189], v[56:59]
s_barrier
v_mfma_f32_16x16x32_bf16 v[48:51], a[156:159], v[170:173], v[48:51]
ds_read_b128 v[186:189], v210 offset:50176
ds_read_b128 v[84:87], v200
v_mfma_f32_16x16x32_bf16 v[52:55], a[180:183], v[170:173], v[52:55]
s_nop 0
ds_read_b128 v[92:95], v201
ds_read_b128 v[100:103], v202
v_mfma_f32_16x16x32_bf16 v[56:59], a[204:207], v[170:173], v[56:59]
s_waitcnt lgkmcnt(5)
ds_read_b128 v[170:173], v210 offset:51200
ds_read_b128 v[88:91], v194 offset:16
v_mfma_f32_16x16x32_bf16 v[48:51], a[160:163], v[182:185], v[48:51]
ds_read_b128 v[96:99], v195 offset:16
v_cvt_pk_bf16_f32 v77, v46, v47
v_mfma_f32_16x16x32_bf16 v[52:55], a[184:187], v[182:185], v[52:55]
ds_read_b128 v[104:107], v196 offset:16
v_add_u32 v215, 1552, v215
v_mfma_f32_16x16x32_bf16 v[56:59], a[208:211], v[182:185], v[56:59]
s_nop 0
ds_read_b128 v[182:185], v210 offset:52224
buffer_store_dwordx2 v[74:75], v203, s[8:11], s39 offen offset:32
s_waitcnt lgkmcnt(8)
v_mfma_f32_16x16x32_bf16 v[48:51], a[164:167], v[186:189], v[48:51]
ds_read_b64 v[112:113], v215 offset:528
v_mfma_f32_16x16x32_bf16 v[52:55], a[188:191], v[186:189], v[52:55]
v_mfma_f32_16x16x32_bf16 v[56:59], a[212:215], v[186:189], v[56:59]
s_waitcnt lgkmcnt(8)
ds_read_b128 v[186:189], v210 offset:53248
v_cvt_pk_bf16_f32 v78, v48, v49
v_mfma_f32_16x16x32_bf16 v[36:39], v[174:177], v[84:87], 0
s_waitcnt lgkmcnt(6)
ds_read_b128 v[84:87], v194
v_cvt_pk_bf16_f32 v79, v50, v51
v_mfma_f32_16x16x32_bf16 v[60:63], a[144:147], v[170:173], v[60:63]
v_cvt_pk_bf16_f32 v80, v52, v53
v_cvt_pk_bf16_f32 v81, v54, v55
v_mfma_f32_16x16x32_bf16 v[64:67], a[168:171], v[170:173], v[64:67]
v_cvt_pk_bf16_f32 v82, v56, v57
v_cvt_pk_bf16_f32 v83, v58, v59
v_mfma_f32_16x16x32_bf16 v[68:71], a[192:195], v[170:173], v[68:71]
ds_read_b128 v[170:173], v210 offset:54272
v_mfma_f32_16x16x32_bf16 v[48:51], v[174:177], v[92:95], 0
ds_read_b128 v[92:95], v195
s_waitcnt lgkmcnt(5)
v_mfma_f32_16x16x32_bf16 v[60:63], a[148:151], v[182:185], v[60:63]
v_mfma_f32_16x16x32_bf16 v[64:67], a[172:175], v[182:185], v[64:67]
v_mfma_f32_16x16x32_bf16 v[68:71], a[196:199], v[182:185], v[68:71]
ds_read_b128 v[182:185], v210 offset:55296
s_waitcnt lgkmcnt(4)
v_mfma_f32_16x16x32_bf16 v[60:63], a[152:155], v[186:189], v[60:63]
v_mfma_f32_16x16x32_bf16 v[64:67], a[176:179], v[186:189], v[64:67]
v_mfma_f32_16x16x32_bf16 v[68:71], a[200:203], v[186:189], v[68:71]
s_nop 0
ds_read_b128 v[186:189], v210 offset:56320
s_waitcnt lgkmcnt(3)
v_mfma_f32_16x16x32_bf16 v[60:63], a[156:159], v[170:173], v[60:63]
buffer_store_dwordx2 v[76:77], v203, s[8:11], s39 offen offset:64
v_mfma_f32_16x16x32_bf16 v[64:67], a[180:183], v[170:173], v[64:67]
v_mfma_f32_16x16x32_bf16 v[68:71], a[204:207], v[170:173], v[68:71]
s_waitcnt lgkmcnt(1)
v_mfma_f32_16x16x32_bf16 v[60:63], a[160:163], v[182:185], v[60:63]
v_mfma_f32_16x16x32_bf16 v[64:67], a[184:187], v[182:185], v[64:67]
v_mfma_f32_16x16x32_bf16 v[68:71], a[208:211], v[182:185], v[68:71]
ds_read_b128 v[182:185], v210
s_waitcnt lgkmcnt(1)
v_mfma_f32_16x16x32_bf16 v[60:63], a[164:167], v[186:189], v[60:63]
v_smfmac_f32_16x16x64_bf16 v[36:39], v[178:181], v[84:91], v213
ds_read_b128 v[84:87], v197
ds_read_b128 v[88:91], v197 offset:16
v_mfma_f32_16x16x32_bf16 v[64:67], a[188:191], v[186:189], v[64:67]
v_cvt_pk_bf16_f32 v116, v60, v61
v_cvt_pk_bf16_f32 v117, v62, v63
v_mfma_f32_16x16x32_bf16 v[60:63], v[174:177], v[100:103], 0
ds_read_b128 v[100:103], v196
ds_read_b128 v[174:177], v217 offset:1056
v_mfma_f32_16x16x32_bf16 v[68:71], a[212:215], v[186:189], v[68:71]
s_nop 0
ds_read_b128 v[186:189], v210 offset:1024
v_cvt_pk_bf16_f32 v124, v64, v65
v_smfmac_f32_16x16x64_bf16 v[48:51], v[178:181], v[92:99], v213
s_waitcnt lgkmcnt(5)
ds_read_b128 v[92:95], v198
ds_read_b128 v[96:99], v198 offset:16
v_mfma_f32_16x16x32_bf16 v[138:141], a[0:3], v[182:185], 0
v_cvt_pk_bf16_f32 v125, v66, v67
v_cvt_pk_bf16_f32 v132, v68, v69
v_mfma_f32_16x16x32_bf16 v[142:145], a[24:27], v[182:185], 0
s_nop 0
v_cvt_pk_bf16_f32 v133, v70, v71
v_mfma_f32_16x16x32_bf16 v[146:149], a[48:51], v[182:185], 0
s_waitcnt lgkmcnt(4)
v_smfmac_f32_16x16x64_bf16 v[60:63], v[178:181], v[100:107], v213
ds_read_b128 v[100:103], v199
ds_read_b128 v[104:107], v199 offset:16
v_mfma_f32_16x16x32_bf16 v[150:153], a[216:219], v[182:185], 0
ds_read_b128 v[178:181], v217 offset:1584
buffer_store_dwordx2 v[78:79], v204, s[8:11], s39 offen
s_waitcnt lgkmcnt(6)
v_smfmac_f32_16x16x64_bf16 v[36:39], v[174:177], v[84:91], v213
ds_read_b128 v[84:87], v200 offset:32
ds_read_b128 v[88:91], v194 offset:48
v_mfma_f32_16x16x32_bf16 v[154:157], a[240:243], v[182:185], 0
s_waitcnt lgkmcnt(5)
v_smfmac_f32_16x16x64_bf16 v[48:51], v[174:177], v[92:99], v213
ds_read_b128 v[92:95], v201 offset:32
ds_read_b128 v[96:99], v195 offset:48
v_mfma_f32_16x16x32_bf16 v[158:161], v[232:235], v[182:185], 0
v_mul_f32 v119, v36, v36
v_add_f32 v118, v36, v37
v_mfma_f32_16x16x32_bf16 v[162:165], v[182:185], a[72:75], 0
s_waitcnt lgkmcnt(5)
v_mul_f32 v127, v48, v48
v_add_f32_e64 v126, v48, v49
v_smfmac_f32_16x16x64_bf16 v[60:63], v[174:177], v[100:107], v213
ds_read_b128 v[100:103], v202 offset:32
ds_read_b128 v[174:177], v217 offset:2112
v_mfma_f32_16x16x32_bf16 v[166:169], v[182:185], a[96:99], 0
s_waitcnt lgkmcnt(5)
ds_read_b128 v[104:107], v196 offset:48
v_fmac_f32 v119, v37, v37
v_mfma_f32_16x16x32_bf16 v[40:43], v[178:181], v[84:87], 0
ds_read_b128 v[84:87], v194 offset:32
v_mul_f32 v135, v60, v60
v_mfma_f32_16x16x32_bf16 v[170:173], v[182:185], a[120:123], 0
s_waitcnt lgkmcnt(5)
ds_read_b128 v[182:185], v210 offset:2048
v_add_f32_e64 v134, v60, v61
v_mfma_f32_16x16x32_bf16 v[52:55], v[178:181], v[92:95], 0
ds_read_b128 v[92:95], v195 offset:32
v_fmac_f32_e64 v135, v61, v61
v_mfma_f32_16x16x32_bf16 v[138:141], a[4:7], v[186:189], v[138:141]
v_fmac_f32 v127, v49, v49
v_add_f32 v134, v134, v62
v_mfma_f32_16x16x32_bf16 v[142:145], a[28:31], v[186:189], v[142:145]
s_waitcnt lgkmcnt(5)
v_fmac_f32 v135, v62, v62
v_add_f32_e64 v118, v118, v38
v_mfma_f32_16x16x32_bf16 v[64:67], v[178:181], v[100:103], 0
ds_read_b128 v[100:103], v196 offset:32
ds_read_b128 v[178:181], v217 offset:2640
v_mfma_f32_16x16x32_bf16 v[146:149], a[52:55], v[186:189], v[146:149]
v_add_f32 v126, v126, v50
v_fmac_f32 v119, v38, v38
v_mfma_f32_16x16x32_bf16 v[150:153], a[220:223], v[186:189], v[150:153]
s_waitcnt lgkmcnt(4)
v_fmac_f32 v127, v50, v50
v_add_f32_e64 v134, v134, v63
v_smfmac_f32_16x16x64_bf16 v[40:43], v[174:177], v[84:91], v213
s_nop 0
ds_read_b128 v[84:87], v197 offset:32
ds_read_b128 v[88:91], v197 offset:48
v_mfma_f32_16x16x32_bf16 v[154:157], a[244:247], v[186:189], v[154:157]
s_waitcnt lgkmcnt(4)
buffer_store_dwordx2 v[80:81], v204, s[8:11], s39 offen offset:32
v_fmac_f32 v135, v63, v63
v_smfmac_f32_16x16x64_bf16 v[52:55], v[174:177], v[92:99], v213
s_waitcnt lgkmcnt(3)
ds_read_b128 v[92:95], v198 offset:32
ds_read_b128 v[96:99], v198 offset:48
v_smfmac_f32_16x16x64_bf16 v[64:67], v[174:177], v[100:107], v213
ds_read_b128 v[100:103], v199 offset:32
ds_read_b128 v[104:107], v199 offset:48
v_mfma_f32_16x16x32_bf16 v[158:161], v[236:239], v[186:189], v[158:161]
ds_read_b128 v[174:177], v217 offset:3168
v_add_f32_e64 v118, v118, v39
v_mfma_f32_16x16x32_bf16 v[162:165], v[186:189], a[76:79], v[162:165]
v_add_f32 v126, v126, v51
v_fmac_f32 v119, v39, v39
v_mfma_f32_16x16x32_bf16 v[166:169], v[186:189], a[100:103], v[166:169]
v_fmac_f32 v127, v51, v51
s_waitcnt lgkmcnt(5)
v_smfmac_f32_16x16x64_bf16 v[40:43], v[178:181], v[84:91], v213
ds_read_b128 v[84:87], v200 offset:64
ds_read_b128 v[88:91], v194 offset:80
v_mfma_f32_16x16x32_bf16 v[170:173], v[186:189], a[124:127], v[170:173]
s_nop 0
ds_read_b128 v[186:189], v210 offset:3072
s_waitcnt lgkmcnt(6)
v_smfmac_f32_16x16x64_bf16 v[52:55], v[178:181], v[92:99], v213
ds_read_b128 v[92:95], v201 offset:64
ds_read_b128 v[96:99], v195 offset:80
v_mfma_f32_16x16x32_bf16 v[138:141], a[8:11], v[182:185], v[138:141]
v_add_f32 v118, v118, v40
v_fmac_f32 v119, v40, v40
v_mfma_f32_16x16x32_bf16 v[142:145], a[32:35], v[182:185], v[142:145]
s_waitcnt lgkmcnt(6)
v_add_f32 v126, v126, v52
v_fmac_f32_e64 v127, v52, v52
v_smfmac_f32_16x16x64_bf16 v[64:67], v[178:181], v[100:107], v213
ds_read_b128 v[100:103], v202 offset:64
ds_read_b128 v[178:181], v217 offset:3696
v_mfma_f32_16x16x32_bf16 v[146:149], a[56:59], v[182:185], v[146:149]
s_waitcnt lgkmcnt(6)
ds_read_b128 v[104:107], v196 offset:80
v_add_f32 v118, v118, v41
v_mfma_f32_16x16x32_bf16 v[44:47], v[174:177], v[84:87], 0
ds_read_b128 v[84:87], v194 offset:64
v_add_f32_e64 v134, v134, v64
v_mfma_f32_16x16x32_bf16 v[150:153], a[224:227], v[182:185], v[150:153]
buffer_store_dwordx2 v[82:83], v204, s[8:11], s39 offen offset:64
v_fmac_f32 v135, v64, v64
v_mfma_f32_16x16x32_bf16 v[154:157], a[248:251], v[182:185], v[154:157]
s_waitcnt lgkmcnt(5)
v_add_f32 v134, v134, v65
v_fmac_f32 v135, v65, v65
v_mfma_f32_16x16x32_bf16 v[56:59], v[174:177], v[92:95], 0
s_waitcnt lgkmcnt(3)
ds_read_b128 v[92:95], v195 offset:64
v_fmac_f32 v119, v41, v41
v_mfma_f32_16x16x32_bf16 v[68:71], v[174:177], v[100:103], 0
ds_read_b128 v[100:103], v196 offset:64
ds_read_b128 v[174:177], v217 offset:4224
v_mfma_f32_16x16x32_bf16 v[158:161], v[240:243], v[182:185], v[158:161]
v_add_f32 v126, v126, v53
v_fmac_f32 v127, v53, v53
v_mfma_f32_16x16x32_bf16 v[162:165], v[182:185], a[80:83], v[162:165]
s_waitcnt lgkmcnt(3)
v_add_f32 v134, v134, v66
v_fmac_f32_e64 v135, v66, v66
v_smfmac_f32_16x16x64_bf16 v[44:47], v[178:181], v[84:91], v213
ds_read_b128 v[84:87], v197 offset:64
ds_read_b128 v[88:91], v197 offset:80
v_mfma_f32_16x16x32_bf16 v[166:169], v[182:185], a[104:107], v[166:169]
v_add_f32_e64 v118, v118, v42
v_fmac_f32 v119, v42, v42
v_mfma_f32_16x16x32_bf16 v[170:173], v[182:185], a[128:131], v[170:173]
s_waitcnt lgkmcnt(4)
ds_read_b128 v[182:185], v210 offset:4096
v_add_f32_e64 v126, v126, v54
v_smfmac_f32_16x16x64_bf16 v[56:59], v[178:181], v[92:99], v213
ds_read_b128 v[92:95], v198 offset:64
ds_read_b128 v[96:99], v198 offset:80
v_mfma_f32_16x16x32_bf16 v[138:141], a[12:15], v[186:189], v[138:141]
s_waitcnt lgkmcnt(6)
v_fmac_f32 v127, v54, v54
v_add_f32_e64 v134, v134, v67
v_smfmac_f32_16x16x64_bf16 v[68:71], v[178:181], v[100:107], v213
ds_read_b128 v[100:103], v199 offset:64
ds_read_b128 v[104:107], v199 offset:80
v_mfma_f32_16x16x32_bf16 v[142:145], a[36:39], v[186:189], v[142:145]
v_fmac_f32 v135, v67, v67
v_add_f32 v118, v118, v43
v_mfma_f32_16x16x32_bf16 v[146:149], a[60:63], v[186:189], v[146:149]
v_fmac_f32 v119, v43, v43
v_add_f32 v126, v126, v55
v_mfma_f32_16x16x32_bf16 v[150:153], a[228:231], v[186:189], v[150:153]
v_fmac_f32_e64 v127, v55, v55
v_and_b32 v180, s44, v208
v_mfma_f32_16x16x32_bf16 v[154:157], a[252:255], v[186:189], v[154:157]
s_waitcnt lgkmcnt(5)
v_add_u32 v214, 1552, v214
v_mov_b32_e64 v181, 0
v_smfmac_f32_16x16x64_bf16 v[44:47], v[174:177], v[84:91], v213
buffer_store_dwordx2 v[116:117], v205, s[8:11], s39 offen
v_mfma_f32_16x16x32_bf16 v[158:161], v[244:247], v[186:189], v[158:161]
v_mfma_f32_16x16x32_bf16 v[162:165], v[186:189], a[84:87], v[162:165]
s_waitcnt lgkmcnt(2)
v_add_f32 v118, v118, v44
v_fmac_f32_e64 v119, v44, v44
v_smfmac_f32_16x16x64_bf16 v[56:59], v[174:177], v[92:99], v213
v_add_f32 v118, v118, v45
v_mfma_f32_16x16x32_bf16 v[166:169], v[186:189], a[108:111], v[166:169]
v_fmac_f32 v119, v45, v45
v_add_f32 v118, v118, v46
v_mfma_f32_16x16x32_bf16 v[170:173], v[186:189], a[132:135], v[170:173]
s_waitcnt lgkmcnt(0)
ds_read_b128 v[186:189], v210 offset:5120
v_add_f32_e64 v126, v126, v56
v_smfmac_f32_16x16x64_bf16 v[68:71], v[174:177], v[100:107], v213
v_fmac_f32_e64 v127, v56, v56
v_mfma_f32_16x16x32_bf16 v[138:141], a[16:19], v[182:185], v[138:141]
v_add_f32 v126, v126, v57
v_fmac_f32 v127, v57, v57
v_mfma_f32_16x16x32_bf16 v[142:145], a[40:43], v[182:185], v[142:145]
v_add_f32 v134, v134, v68
v_fmac_f32 v135, v68, v68
v_mfma_f32_16x16x32_bf16 v[146:149], a[64:67], v[182:185], v[146:149]
v_add_f32 v134, v134, v69
v_fmac_f32 v135, v69, v69
v_mfma_f32_16x16x32_bf16 v[150:153], a[232:235], v[182:185], v[150:153]
v_add_f32 v134, v134, v70
v_fmac_f32 v135, v70, v70
v_mfma_f32_16x16x32_bf16 v[154:157], v[224:227], v[182:185], v[154:157]
v_fmac_f32 v119, v46, v46
v_add_f32 v126, v126, v58
v_mfma_f32_16x16x32_bf16 v[158:161], v[248:251], v[182:185], v[158:161]
v_fmac_f32 v127, v58, v58
v_add_f32 v134, v134, v71
v_mfma_f32_16x16x32_bf16 v[162:165], v[182:185], a[88:91], v[162:165]
v_fmac_f32 v135, v71, v71
v_add_f32 v118, v118, v47
v_mfma_f32_16x16x32_bf16 v[166:169], v[182:185], a[112:115], v[166:169]
v_fmac_f32_e64 v119, v47, v47
v_add_f32 v126, v126, v59
v_mfma_f32_16x16x32_bf16 v[170:173], v[182:185], a[136:139], v[170:173]
s_waitcnt lgkmcnt(0)
ds_read_b128 v[182:185], v210 offset:6144
v_fmac_f32_e64 v127, v59, v59
v_mfma_f32_16x16x32_bf16 v[138:141], a[20:23], v[186:189], v[138:141]
buffer_store_dwordx2 v[124:125], v205, s[8:11], s39 offen offset:32
v_permlane16_swap_b32 v134, v135
v_mfma_f32_16x16x32_bf16 v[142:145], a[44:47], v[186:189], v[142:145]
v_permlane16_swap_b32 v118, v119
v_mfma_f32_16x16x32_bf16 v[146:149], a[68:71], v[186:189], v[146:149]
v_cvt_pk_bf16_f32 v78, v138, v139
v_cvt_pk_bf16_f32 v79, v140, v141
v_mfma_f32_16x16x32_bf16 v[150:153], a[236:239], v[186:189], v[150:153]
v_cvt_pk_bf16_f32 v80, v142, v143
v_cvt_pk_bf16_f32 v81, v144, v145
v_mfma_f32_16x16x32_bf16 v[154:157], v[228:231], v[186:189], v[154:157]
v_cvt_pk_bf16_f32 v82, v146, v147
v_cvt_pk_bf16_f32 v83, v148, v149
v_mfma_f32_16x16x32_bf16 v[158:161], v[252:255], v[186:189], v[158:161]
v_cvt_pk_bf16_f32 v72, v150, v151
v_cvt_pk_bf16_f32 v73, v152, v153
v_mfma_f32_16x16x32_bf16 v[162:165], v[186:189], a[92:95], v[162:165]
v_cvt_pk_bf16_f32 v74, v154, v155
v_cvt_pk_bf16_f32 v75, v156, v157
v_mfma_f32_16x16x32_bf16 v[166:169], v[186:189], a[116:119], v[166:169]
s_nop 0
v_cvt_pk_bf16_f32 v76, v158, v159
v_cvt_pk_bf16_f32 v77, v160, v161
v_mfma_f32_16x16x32_bf16 v[170:173], v[186:189], a[140:143], v[170:173]
s_waitcnt lgkmcnt(0)
ds_read_b128 v[186:189], v210 offset:7168
v_cvt_pk_bf16_f32 v114, v162, v163
v_mfma_f32_16x16x32_bf16 v[138:141], a[0:3], v[182:185], 0
v_cvt_pk_bf16_f32 v115, v164, v165
v_cvt_pk_bf16_f32 v122, v166, v167
v_mfma_f32_16x16x32_bf16 v[142:145], a[24:27], v[182:185], 0
v_cvt_pk_bf16_f32 v123, v168, v169
v_cvt_pk_bf16_f32 v130, v170, v171
v_mfma_f32_16x16x32_bf16 v[146:149], a[48:51], v[182:185], 0
v_cvt_pk_bf16_f32 v131, v172, v173
v_add_f32_e64 v134, v134, v135
v_mfma_f32_16x16x32_bf16 v[150:153], a[216:219], v[182:185], 0
v_permlane16_swap_b32 v126, v127
v_mfma_f32_16x16x32_bf16 v[154:157], a[240:243], v[182:185], 0
v_add_f32 v118, v118, v119
v_mov_b32_e64 v135, v134
v_mfma_f32_16x16x32_bf16 v[158:161], v[232:235], v[182:185], 0
v_add_f32 v126, v126, v127
v_permlane32_swap_b32 v134, v135
v_mfma_f32_16x16x32_bf16 v[162:165], v[182:185], a[72:75], 0
buffer_store_dwordx2 v[132:133], v205, s[8:11], s39 offen offset:64
v_permlane32_swap_b32 v118, v126
v_mfma_f32_16x16x32_bf16 v[166:169], v[182:185], a[96:99], 0
v_add_f32 v134, v134, v135
v_add_f32 v118, v118, v126
v_mfma_f32_16x16x32_bf16 v[170:173], v[182:185], a[120:123], 0
s_waitcnt lgkmcnt(0)
ds_read_b128 v[182:185], v210 offset:8192
ds_write_b32 v209, v134 offset:512
v_mfma_f32_16x16x32_bf16 v[138:141], a[4:7], v[186:189], v[138:141]
ds_write_b32 v209, v118
v_mfma_f32_16x16x32_bf16 v[142:145], a[28:31], v[186:189], v[142:145]
v_mfma_f32_16x16x32_bf16 v[146:149], a[52:55], v[186:189], v[146:149]
v_mfma_f32_16x16x32_bf16 v[150:153], a[220:223], v[186:189], v[150:153]
v_mfma_f32_16x16x32_bf16 v[154:157], a[244:247], v[186:189], v[154:157]
v_mfma_f32_16x16x32_bf16 v[158:161], v[236:239], v[186:189], v[158:161]
v_mfma_f32_16x16x32_bf16 v[162:165], v[186:189], a[76:79], v[162:165]
s_waitcnt lgkmcnt(0)
s_barrier
v_mfma_f32_16x16x32_bf16 v[166:169], v[186:189], a[100:103], v[166:169]
ds_read_b128 v[102:105], v210 offset:18432
ds_read_b128 v[106:109], v210 offset:19456
v_mfma_f32_16x16x32_bf16 v[170:173], v[186:189], a[124:127], v[170:173]
s_cmp_eq_u32 s46, 1
s_cbranch_scc1 F_pf
F_nopf:
ds_read_b128 v[186:189], v210 offset:9216
v_mfma_f32_16x16x32_bf16 v[138:141], a[8:11], v[182:185], v[138:141]
v_mfma_f32_16x16x32_bf16 v[142:145], a[32:35], v[182:185], v[142:145]
v_mfma_f32_16x16x32_bf16 v[146:149], a[56:59], v[182:185], v[146:149]
v_mfma_f32_16x16x32_bf16 v[150:153], a[224:227], v[182:185], v[150:153]
buffer_load_dwordx4 v180, s[4:7], s52 offen nt lds
v_mfma_f32_16x16x32_bf16 v[154:157], a[248:251], v[182:185], v[154:157]
s_waitcnt lgkmcnt(2)
v_add_f32 v102, v102, v103
v_add_f32_e64 v104, v104, v105
v_mfma_f32_16x16x32_bf16 v[158:161], v[240:243], v[182:185], v[158:161]
s_waitcnt lgkmcnt(1)
v_add_f32 v106, v106, v107
v_add_f32_e64 v108, v108, v109
v_mfma_f32_16x16x32_bf16 v[162:165], v[182:185], a[80:83], v[162:165]
s_waitcnt lgkmcnt(0)
v_add_f32 v102, v102, v104
v_add_f32_e64 v106, v106, v108
v_mfma_f32_16x16x32_bf16 v[166:169], v[182:185], a[104:107], v[166:169]
s_add_u32 m0, s45, 4112
ds_read_b128 v[108:111], v215 offset:512
v_mul_f32_e64 v103, s48, v102
v_mfma_f32_16x16x32_bf16 v[170:173], v[182:185], a[128:131], v[170:173]
s_add_u32 s40, s36, 196224
ds_read_b128 v[182:185], v210 offset:10240
v_mul_f32_e64 v104, s73, v102
v_mfma_f32_16x16x32_bf16 v[138:141], a[12:15], v[186:189], v[138:141]
v_mul_f32_e64 v106, s73, v106
v_fma_f32 v106, -v103, v104, v106
v_mfma_f32_16x16x32_bf16 v[142:145], a[36:39], v[186:189], v[142:145]
v_max_f32 v106, 0, v106
v_add_f32 v106, s49, v106
v_mfma_f32_16x16x32_bf16 v[146:149], a[60:63], v[186:189], v[146:149]
v_rsq_f32_e64 v102, v106
v_mfma_f32_16x16x32_bf16 v[150:153], a[228:231], v[186:189], v[150:153]
v_mul_f32_e64 v103, -v103, v102
v_mfma_f32_16x16x32_bf16 v[154:157], a[252:255], v[186:189], v[154:157]
buffer_load_dwordx4 v180, s[4:7], s40 offen nt lds
v_mfma_f32_16x16x32_bf16 v[158:161], v[244:247], v[186:189], v[158:161]
ds_write_b64 v211, v[102:103] offset:20480
v_mfma_f32_16x16x32_bf16 v[162:165], v[186:189], a[84:87], v[162:165]
s_add_u32 m0, s45, 8224
s_add_u32 s40, s36, 392448
v_mfma_f32_16x16x32_bf16 v[166:169], v[186:189], a[108:111], v[166:169]
s_nop 0
ds_read_b64 v[118:119], v219 offset:20480
ds_read_b64 v[126:127], v219 offset:20736
v_mfma_f32_16x16x32_bf16 v[170:173], v[186:189], a[132:135], v[170:173]
s_waitcnt lgkmcnt(3)
ds_read_b128 v[186:189], v210 offset:11264
ds_read_b64 v[134:135], v219 offset:20992
v_mfma_f32_16x16x32_bf16 v[138:141], a[16:19], v[182:185], v[138:141]
v_mfma_f32_16x16x32_bf16 v[142:145], a[40:43], v[182:185], v[142:145]
v_mfma_f32_16x16x32_bf16 v[146:149], a[64:67], v[182:185], v[146:149]
s_nop 0
v_mfma_f32_16x16x32_bf16 v[150:153], a[232:235], v[182:185], v[150:153]
s_waitcnt lgkmcnt(3)
v_fma_f32 v220, v36, v118, v119
v_fma_f32 v221, v37, v118, v119
v_mfma_f32_16x16x32_bf16 v[154:157], v[224:227], v[182:185], v[154:157]
v_fma_f32 v222, v38, v118, v119
v_fma_f32 v223, v39, v118, v119
v_mfma_f32_16x16x32_bf16 v[158:161], v[248:251], v[182:185], v[158:161]
buffer_load_dwordx4 v180, s[4:7], s40 offen nt lds
v_mfma_f32_16x16x32_bf16 v[162:165], v[182:185], a[88:91], v[162:165]
s_add_u32 m0, s45, 12336
v_cvt_pk_bf16_f32 v90, v220, v221
v_cvt_pk_bf16_f32 v91, v222, v223
v_mfma_f32_16x16x32_bf16 v[166:169], v[182:185], a[112:115], v[166:169]
s_add_u32 s40, s36, 588672
v_fma_f32 v220, v40, v118, v119
v_fma_f32 v221, v41, v118, v119
v_mfma_f32_16x16x32_bf16 v[170:173], v[182:185], a[136:139], v[170:173]
s_waitcnt lgkmcnt(1)
ds_read_b128 v[182:185], v210 offset:12288
v_fma_f32 v222, v42, v118, v119
v_mfma_f32_16x16x32_bf16 v[138:141], a[20:23], v[186:189], v[138:141]
s_nop 0
v_fma_f32 v223, v43, v118, v119
v_cvt_pk_bf16_f32 v92, v220, v221
v_mfma_f32_16x16x32_bf16 v[142:145], a[44:47], v[186:189], v[142:145]
v_cvt_pk_bf16_f32 v93, v222, v223
v_fma_f32 v220, v44, v118, v119
v_mfma_f32_16x16x32_bf16 v[146:149], a[68:71], v[186:189], v[146:149]
ds_write_b128 v211, v[90:93] offset:20480
v_mfma_f32_16x16x32_bf16 v[150:153], a[236:239], v[186:189], v[150:153]
v_cvt_pk_bf16_f32 v96, v138, v139
v_cvt_pk_bf16_f32 v97, v140, v141
v_mfma_f32_16x16x32_bf16 v[154:157], v[228:231], v[186:189], v[154:157]
v_cvt_pk_bf16_f32 v98, v142, v143
v_cvt_pk_bf16_f32 v99, v144, v145
v_mfma_f32_16x16x32_bf16 v[158:161], v[252:255], v[186:189], v[158:161]
buffer_load_dwordx4 v180, s[4:7], s40 offen nt lds
v_mfma_f32_16x16x32_bf16 v[162:165], v[186:189], a[92:95], v[162:165]
s_add_u32 m0, s45, 16448
v_cvt_pk_bf16_f32 v100, v146, v147
v_cvt_pk_bf16_f32 v101, v148, v149
v_mfma_f32_16x16x32_bf16 v[166:169], v[186:189], a[116:119], v[166:169]
s_add_u32 s40, s36, 784896
v_cvt_pk_bf16_f32 v88, v158, v159
v_cvt_pk_bf16_f32 v89, v160, v161
v_mfma_f32_16x16x32_bf16 v[170:173], v[186:189], a[140:143], v[170:173]
s_waitcnt lgkmcnt(1)
ds_read_b128 v[186:189], v210 offset:13312
v_cvt_pk_bf16_f32 v86, v154, v155
v_mfma_f32_16x16x32_bf16 v[138:141], a[0:3], v[182:185], 0
s_nop 0
v_cvt_pk_bf16_f32 v87, v156, v157
v_cvt_pk_bf16_f32 v124, v166, v167
v_mfma_f32_16x16x32_bf16 v[142:145], a[24:27], v[182:185], 0
v_cvt_pk_bf16_f32 v125, v168, v169
v_cvt_pk_bf16_f32 v84, v150, v151
v_mfma_f32_16x16x32_bf16 v[146:149], a[48:51], v[182:185], 0
ds_read_b128 v[182:185], v210 offset:14336
v_cvt_pk_bf16_f32 v85, v152, v153
v_cvt_pk_bf16_f32 v116, v162, v163
v_mfma_f32_16x16x16_bf16 v[154:157], v[82:83], v[88:89], 0
v_cvt_pk_bf16_f32 v117, v164, v165
v_fma_f32 v221, v45, v118, v119
v_fma_f32 v222, v46, v118, v119
v_mfma_f32_16x16x16_bf16 v[158:161], v[100:101], v[88:89], 0
v_fma_f32 v223, v47, v118, v119
v_cvt_pk_bf16_f32 v94, v220, v221
v_cvt_pk_bf16_f32 v95, v222, v223
v_fma_f32 v220, v48, v126, v127
s_waitcnt lgkmcnt(1)
v_mfma_f32_16x16x32_bf16 v[138:141], a[4:7], v[186:189], v[138:141]
buffer_load_dwordx4 v180, s[4:7], s40 offen nt lds
v_mfma_f32_16x16x32_bf16 v[142:145], a[28:31], v[186:189], v[142:145]
s_add_u32 m0, s45, 20560
ds_write_b64 v212, v[94:95] offset:20480
v_mfma_f32_16x16x32_bf16 v[146:149], a[52:55], v[186:189], v[146:149]
s_waitcnt lgkmcnt(1)
v_fma_f32 v221, v49, v126, v127
v_fma_f32 v222, v50, v126, v127
v_mfma_f32_16x16x32_bf16 v[138:141], a[8:11], v[182:185], v[138:141]
s_add_u32 s40, s36, 981120
ds_read_b128 v[186:189], v210 offset:15360
v_fma_f32 v223, v51, v126, v127
v_mfma_f32_16x16x32_bf16 v[142:145], a[32:35], v[182:185], v[142:145]
v_cvt_pk_bf16_f32 v174, v220, v221
v_cvt_pk_bf16_f32 v175, v222, v223
v_mfma_f32_16x16x32_bf16 v[146:149], a[56:59], v[182:185], v[146:149]
ds_read_b128 v[182:185], v210 offset:16384
v_fma_f32 v220, v52, v126, v127
v_fma_f32 v221, v53, v126, v127
v_mfma_f32_16x16x16_bf16 v[166:169], v[112:113], v[88:89], v[206:209]
v_fma_f32 v222, v54, v126, v127
v_fma_f32 v223, v55, v126, v127
v_cvt_pk_bf16_f32 v176, v220, v221
v_mfma_f32_16x16x16_bf16 v[150:153], v[112:113], v[76:77], v[206:209]
v_cvt_pk_bf16_f32 v177, v222, v223
v_fma_f32 v220, v56, v126, v127
v_fma_f32 v221, v57, v126, v127
v_fma_f32 v222, v58, v126, v127
v_mfma_f32_16x16x32_bf16 v[154:157], v[78:81], v[84:87], v[154:157]
s_waitcnt lgkmcnt(1)
ds_write_b128 v211, v[174:177] offset:26624
v_mfma_f32_16x16x32_bf16 v[138:141], a[12:15], v[186:189], v[138:141]
s_waitcnt lgkmcnt(1)
buffer_load_dwordx4 v180, s[4:7], s40 offen nt lds
v_mfma_f32_16x16x32_bf16 v[142:145], a[36:39], v[186:189], v[142:145]
s_add_u32 m0, s45, 24672
v_fma_f32 v223, v59, v126, v127
v_cvt_pk_bf16_f32 v178, v220, v221
v_mfma_f32_16x16x32_bf16 v[146:149], a[60:63], v[186:189], v[146:149]
s_add_u32 s40, s36, 1177344
ds_read_b128 v[186:189], v210 offset:17408
v_cvt_pk_bf16_f32 v179, v222, v223
v_mfma_f32_16x16x32_bf16 v[138:141], a[16:19], v[182:185], v[138:141]
ds_write_b64 v212, v[178:179] offset:26624
v_mfma_f32_16x16x32_bf16 v[142:145], a[40:43], v[182:185], v[142:145]
v_fma_f32 v220, v60, v134, v135
v_fma_f32 v221, v61, v134, v135
v_mfma_f32_16x16x32_bf16 v[150:153], v[108:111], v[72:75], v[150:153]
v_fma_f32 v222, v62, v134, v135
v_fma_f32 v223, v63, v134, v135
v_mfma_f32_16x16x32_bf16 v[146:149], a[64:67], v[182:185], v[146:149]
s_nop 0
ds_read_b128 v[182:185], v210 offset:12288
v_cvt_pk_bf16_f32 v90, v220, v221
v_mfma_f32_16x16x32_bf16 v[158:161], v[96:99], v[84:87], v[158:161]
s_waitcnt lgkmcnt(2)
v_cvt_pk_bf16_f32 v91, v222, v223
v_fma_f32 v220, v64, v134, v135
v_mfma_f32_16x16x32_bf16 v[138:141], a[20:23], v[186:189], v[138:141]
v_fma_f32 v221, v65, v134, v135
v_fma_f32 v222, v66, v134, v135
v_mfma_f32_16x16x32_bf16 v[142:145], a[44:47], v[186:189], v[142:145]
buffer_load_dwordx4 v180, s[4:7], s40 offen nt lds
v_mfma_f32_16x16x32_bf16 v[146:149], a[68:71], v[186:189], v[146:149]
s_add_u32 m0, s45, 28784
ds_read_b128 v[186:189], v210 offset:13312
v_cvt_pk_bf16_f32 v102, v138, v139
v_mfma_f32_16x16x32_bf16 v[166:169], v[108:111], v[84:87], v[166:169]
s_add_u32 s40, s36, 1373568
v_cvt_pk_bf16_f32 v103, v140, v141
v_cvt_pk_bf16_f32 v104, v142, v143
v_cvt_pk_bf16_f32 v105, v144, v145
v_mfma_f32_16x16x16_bf16 v[138:141], v[82:83], v[76:77], 0
v_cvt_pk_bf16_f32 v106, v146, v147
v_cvt_pk_bf16_f32 v107, v148, v149
v_fma_f32 v223, v67, v134, v135
v_mfma_f32_16x16x16_bf16 v[142:145], v[100:101], v[76:77], 0
v_cvt_pk_bf16_f32 v92, v220, v221
v_cvt_pk_bf16_f32 v93, v222, v223
v_fma_f32 v220, v68, v134, v135
v_mfma_f32_16x16x16_bf16 v[162:165], v[106:107], v[88:89], 0
v_fma_f32 v221, v69, v134, v135
v_fma_f32 v222, v70, v134, v135
v_fma_f32 v223, v71, v134, v135
v_mfma_f32_16x16x16_bf16 v[146:149], v[106:107], v[76:77], 0
v_cvt_pk_bf16_f32 v132, v170, v171
v_cvt_pk_bf16_f32 v133, v172, v173
v_cvt_pk_bf16_f32 v94, v220, v221
v_cvt_pk_bf16_f32 v95, v222, v223
v_mfma_f32_16x16x32_bf16 v[138:141], v[78:81], v[72:75], v[138:141]
ds_write_b128 v211, v[90:93] offset:32768
v_mfma_f32_16x16x32_bf16 v[142:145], v[96:99], v[72:75], v[142:145]
s_waitcnt lgkmcnt(2)
v_exp_f32 v138, v138
v_mfma_f32_16x16x32_bf16 v[118:121], v[182:185], a[72:75], 0
buffer_load_dwordx4 v180, s[4:7], s40 offen nt lds
v_mfma_f32_16x16x32_bf16 v[126:129], v[182:185], a[96:99], 0
s_add_u32 m0, s45, 32896
ds_write_b64 v212, v[94:95] offset:32768
v_mfma_f32_16x16x32_bf16 v[134:137], v[182:185], a[120:123], 0
s_add_u32 s40, s36, 1569792
v_exp_f32_e64 v139, v139
v_mfma_f32_16x16x32_bf16 v[146:149], v[102:105], v[72:75], v[146:149]
ds_read_b64 v[76:77], v215 offset:16
v_cvt_pk_bf16_f32 v174, v138, v139
v_mfma_f32_16x16x32_bf16 v[90:93], a[216:219], v[182:185], 0
v_exp_f32_e64 v140, v140
v_mfma_f32_16x16x32_bf16 v[170:173], a[240:243], v[182:185], 0
v_exp_f32 v141, v141
v_mfma_f32_16x16x32_bf16 v[220:223], v[232:235], v[182:185], 0
s_waitcnt lgkmcnt(3)
ds_read_b128 v[182:185], v210 offset:14336
v_cvt_pk_bf16_f32 v175, v140, v141
v_mfma_f32_16x16x32_bf16 v[118:121], v[186:189], a[76:79], v[118:121]
v_exp_f32 v142, v142
v_mfma_f32_16x16x32_bf16 v[126:129], v[186:189], a[100:103], v[126:129]
v_exp_f32 v143, v143
v_mfma_f32_16x16x32_bf16 v[134:137], v[186:189], a[124:127], v[134:137]
v_exp_f32_e64 v144, v144
v_mfma_f32_16x16x32_bf16 v[90:93], a[220:223], v[186:189], v[90:93]
buffer_load_dwordx4 v180, s[4:7], s40 offen nt lds
v_mfma_f32_16x16x32_bf16 v[170:173], a[244:247], v[186:189], v[170:173]
v_exp_f32 v145, v145
v_mfma_f32_16x16x32_bf16 v[220:223], v[236:239], v[186:189], v[220:223]
s_waitcnt lgkmcnt(0)
ds_read_b128 v[186:189], v210 offset:15360
v_cvt_pk_bf16_f32 v176, v142, v143
v_mfma_f32_16x16x32_bf16 v[118:121], v[182:185], a[80:83], v[118:121]
v_exp_f32_e64 v150, v150
v_mfma_f32_16x16x32_bf16 v[126:129], v[182:185], a[104:107], v[126:129]
v_cvt_pk_bf16_f32 v177, v144, v145
v_cvt_pk_bf16_f32 v180, v150, 0
v_mfma_f32_16x16x32_bf16 v[134:137], v[182:185], a[128:131], v[134:137]
v_exp_f32 v154, v154
v_mfma_f32_16x16x32_bf16 v[90:93], a[224:227], v[182:185], v[90:93]
v_exp_f32 v155, v155
v_mfma_f32_16x16x32_bf16 v[162:165], v[102:105], v[84:87], v[162:165]
v_exp_f32_e64 v156, v156
v_mfma_f32_16x16x32_bf16 v[170:173], a[248:251], v[182:185], v[170:173]
v_exp_f32 v157, v157
v_mfma_f32_16x16x32_bf16 v[220:223], v[240:243], v[182:185], v[220:223]
s_waitcnt lgkmcnt(0)
ds_read_b128 v[182:185], v210 offset:16384
ds_read_b128 v[72:75], v215
v_mfma_f32_16x16x32_bf16 v[118:121], v[186:189], a[84:87], v[118:121]
v_exp_f32 v158, v158
v_mfma_f32_16x16x32_bf16 v[126:129], v[186:189], a[108:111], v[126:129]
v_exp_f32 v159, v159
v_mfma_f32_16x16x32_bf16 v[134:137], v[186:189], a[132:135], v[134:137]
v_exp_f32 v160, v160
v_mfma_f32_16x16x32_bf16 v[90:93], a[228:231], v[186:189], v[90:93]
v_exp_f32 v161, v161
v_mfma_f32_16x16x32_bf16 v[170:173], a[252:255], v[186:189], v[170:173]
v_exp_f32 v166, v166
v_mfma_f32_16x16x32_bf16 v[220:223], v[244:247], v[186:189], v[220:223]
s_waitcnt lgkmcnt(1)
ds_read_b128 v[186:189], v210 offset:17408
v_exp_f32 v146, v146
v_mfma_f32_16x16x32_bf16 v[118:121], v[182:185], a[88:91], v[118:121]
v_exp_f32 v147, v147
v_mfma_f32_16x16x32_bf16 v[126:129], v[182:185], a[112:115], v[126:129]
v_exp_f32 v148, v148
v_mfma_f32_16x16x32_bf16 v[134:137], v[182:185], a[136:139], v[134:137]
v_exp_f32 v149, v149
v_mfma_f32_16x16x32_bf16 v[90:93], a[232:235], v[182:185], v[90:93]
v_exp_f32 v162, v162
v_mfma_f32_16x16x32_bf16 v[170:173], v[224:227], v[182:185], v[170:173]
v_exp_f32 v163, v163
v_mfma_f32_16x16x32_bf16 v[220:223], v[248:251], v[182:185], v[220:223]
s_waitcnt lgkmcnt(0)
v_exp_f32 v164, v164
v_mfma_f32_16x16x32_bf16 v[118:121], v[186:189], a[92:95], v[118:121]
v_exp_f32_e64 v165, v165
v_mfma_f32_16x16x32_bf16 v[126:129], v[186:189], a[116:119], v[126:129]
v_cvt_pk_bf16_f32 v178, v146, v147
v_cvt_pk_bf16_f32 v179, v148, v149
v_mfma_f32_16x16x32_bf16 v[134:137], v[186:189], a[140:143], v[134:137]
v_cvt_pk_bf16_f32 v118, v118, v119
v_cvt_pk_bf16_f32 v119, v120, v121
v_mfma_f32_16x16x32_bf16 v[90:93], a[236:239], v[186:189], v[90:93]
ds_read_u16 v120, v214 offset:1024
v_cvt_pk_bf16_f32 v126, v126, v127
v_mfma_f32_16x16x32_bf16 v[170:173], v[228:231], v[186:189], v[170:173]
v_cvt_pk_bf16_f32 v127, v128, v129
v_cvt_pk_bf16_f32 v134, v134, v135
v_mfma_f32_16x16x32_bf16 v[220:223], v[252:255], v[186:189], v[220:223]
ds_read_u16 v128, v214 offset:1032
v_cvt_pk_bf16_f32 v90, v90, v91
v_mfma_f32_16x16x32_bf16 v[150:153], v[190:193], v[174:177], 0
v_cvt_pk_bf16_f32 v91, v92, v93
v_cvt_pk_bf16_f32 v92, v170, v171
v_mfma_f32_16x16x32_bf16 v[138:141], v[114:117], v[174:177], 0
v_cvt_pk_bf16_f32 v93, v172, v173
v_cvt_pk_bf16_f32 v135, v136, v137
v_mfma_f32_16x16x32_bf16 v[142:145], v[122:125], v[174:177], 0
ds_read_u16 v136, v214 offset:1040
v_mov_b32 v121, 0
v_mfma_f32_16x16x32_bf16 v[146:149], v[130:133], v[174:177], 0
v_cvt_pk_bf16_f32 v174, v154, v155
v_cvt_pk_bf16_f32 v175, v156, v157
v_mfma_f32_16x16x32_bf16 v[150:153], v[190:193], v[178:181], v[150:153]
s_waitcnt lgkmcnt(2)
v_cvt_pk_bf16_f32 v176, v158, v159
v_cvt_pk_bf16_f32 v177, v160, v161
v_mfma_f32_16x16x32_bf16 v[138:141], v[118:121], v[178:181], v[138:141]
v_mov_b32 v129, 0
v_mov_b32 v137, 0
v_mfma_f32_16x16x32_bf16 v[154:157], v[114:117], v[174:177], 0
v_rcp_f32 v151, v150
v_mfma_f32_16x16x32_bf16 v[158:161], v[122:125], v[174:177], 0
s_waitcnt lgkmcnt(1)
v_max3_u32 v218, v218, v150, v151
v_mul_f32_e64 v151, s3, v151
v_mfma_f32_16x16x32_bf16 v[142:145], v[126:129], v[178:181], v[142:145]
s_waitcnt lgkmcnt(0)
v_mul_f32 v138, v138, v151
v_mul_f32_e64 v139, v139, v151
v_mfma_f32_16x16x32_bf16 v[146:149], v[134:137], v[178:181], v[146:149]
v_cvt_pk_bf16_f32 v180, v166, 0
v_mul_f32_e64 v140, v140, v151
v_mfma_f32_16x16x32_bf16 v[166:169], v[190:193], v[174:177], 0
v_mul_f32_e64 v141, v141, v151
v_cvt_pk_bf16_f32 v138, v138, v139
v_mul_f32 v142, v142, v151
v_mul_f32 v143, v143, v151
v_mul_f32 v144, v144, v151
v_mul_f32 v145, v145, v151
v_cvt_pk_bf16_f32 v139, v140, v141
v_cvt_pk_bf16_f32 v140, v142, v143
v_cvt_pk_bf16_f32 v141, v144, v145
v_cvt_pk_bf16_f32 v178, v162, v163
v_cvt_pk_bf16_f32 v179, v164, v165
v_mfma_f32_16x16x32_bf16 v[162:165], v[130:133], v[174:177], 0
ds_write_b128 v211, v[138:141] offset:38912
v_mfma_f32_16x16x32_bf16 v[138:141], v[78:81], v[90:93], 0
v_mul_f32 v146, v146, v151
v_mul_f32 v147, v147, v151
v_mfma_f32_16x16x32_bf16 v[166:169], v[190:193], v[178:181], v[166:169]
v_mul_f32 v148, v148, v151
v_mul_f32 v149, v149, v151
v_mfma_f32_16x16x32_bf16 v[154:157], v[118:121], v[178:181], v[154:157]
v_cvt_pk_bf16_f32 v142, v146, v147
v_cvt_pk_bf16_f32 v143, v148, v149
v_mfma_f32_16x16x32_bf16 v[158:161], v[126:129], v[178:181], v[158:161]
ds_write_b64 v212, v[142:143] offset:38912
v_mfma_f32_16x16x32_bf16 v[142:145], v[96:99], v[90:93], 0
v_rcp_f32_e64 v167, v166
v_mfma_f32_16x16x32_bf16 v[162:165], v[134:137], v[178:181], v[162:165]
v_max3_u32 v218, v218, v166, v167
v_cvt_pk_bf16_f32 v94, v220, v221
v_mfma_f32_16x16x32_bf16 v[150:153], v[108:111], v[90:93], v[206:209]
v_cvt_pk_bf16_f32 v95, v222, v223
v_mul_f32_e64 v167, s3, v167
v_mfma_f32_16x16x32_bf16 v[146:149], v[102:105], v[90:93], 0
v_mul_f32 v154, v154, v167
v_mul_f32 v155, v155, v167
v_mul_f32_e64 v156, v156, v167
v_mfma_f32_16x16x16_bf16 v[138:141], v[82:83], v[94:95], v[138:141]
v_mul_f32_e64 v157, v157, v167
v_cvt_pk_bf16_f32 v154, v154, v155
v_mul_f32_e64 v158, v158, v167
v_mfma_f32_16x16x16_bf16 v[142:145], v[100:101], v[94:95], v[142:145]
v_mul_f32 v159, v159, v167
v_mul_f32 v160, v160, v167
v_mul_f32_e64 v161, v161, v167
v_mfma_f32_16x16x16_bf16 v[150:153], v[112:113], v[94:95], v[150:153]
v_cvt_pk_bf16_f32 v155, v156, v157
v_cvt_pk_bf16_f32 v156, v158, v159
v_cvt_pk_bf16_f32 v157, v160, v161
v_mfma_f32_16x16x16_bf16 v[146:149], v[106:107], v[94:95], v[146:149]
v_mul_f32 v162, v162, v167
v_mul_f32 v163, v163, v167
v_mul_f32 v164, v164, v167
v_mul_f32 v165, v165, v167
v_mfma_f32_16x16x16_bf16 v[166:169], v[76:77], v[112:113], v[206:209]
v_cvt_pk_bf16_f32 v158, v162, v163
v_cvt_pk_bf16_f32 v159, v164, v165
v_exp_f32 v138, v138
v_mfma_f32_16x16x16_bf16 v[162:165], v[76:77], v[106:107], 0
v_exp_f32 v139, v139
v_exp_f32 v140, v140
v_mfma_f32_16x16x32_bf16 v[166:169], v[72:75], v[108:111], v[166:169]
ds_write_b128 v211, v[154:157] offset:45056
v_mfma_f32_16x16x16_bf16 v[154:157], v[76:77], v[82:83], 0
v_exp_f32 v141, v141
v_exp_f32 v142, v142
v_mfma_f32_16x16x32_bf16 v[162:165], v[72:75], v[102:105], v[162:165]
v_exp_f32 v143, v143
v_mfma_f32_16x16x32_bf16 v[154:157], v[72:75], v[78:81], v[154:157]
ds_write_b64 v212, v[158:159] offset:45056
v_mfma_f32_16x16x16_bf16 v[158:161], v[76:77], v[100:101], 0
v_exp_f32 v144, v144
v_exp_f32 v145, v145
v_exp_f32_e64 v150, v150
v_mfma_f32_16x16x32_bf16 v[158:161], v[72:75], v[96:99], v[158:161]
v_cvt_pk_bf16_f32 v174, v138, v139
v_cvt_pk_bf16_f32 v175, v140, v141
v_cvt_pk_bf16_f32 v176, v142, v143
v_cvt_pk_bf16_f32 v177, v144, v145
v_cvt_pk_bf16_f32 v180, v150, 0
v_exp_f32_e64 v146, v146
v_mfma_f32_16x16x32_bf16 v[150:153], v[190:193], v[174:177], 0
v_exp_f32 v147, v147
v_mfma_f32_16x16x32_bf16 v[138:141], v[114:117], v[174:177], 0
s_waitcnt lgkmcnt(0)
v_exp_f32 v148, v148
v_mfma_f32_16x16x32_bf16 v[142:145], v[122:125], v[174:177], 0
s_barrier
ds_read_b128 v[170:173], v210 offset:38912
ds_read_b128 v[182:185], v210 offset:39936
ds_read_b128 v[186:189], v210 offset:40960
v_exp_f32_e64 v149, v149
v_cvt_pk_bf16_f32 v178, v146, v147
v_cvt_pk_bf16_f32 v179, v148, v149
v_mfma_f32_16x16x32_bf16 v[146:149], v[130:133], v[174:177], 0
v_mov_b32_dpp v154, v158 quad_perm:[0,1,2,3] row_mask:0x2 bank_mask:0xf
v_mfma_f32_16x16x32_bf16 v[150:153], v[190:193], v[178:181], v[150:153]
v_mov_b32_dpp v154, v162 quad_perm:[0,1,2,3] row_mask:0x4 bank_mask:0xf
v_mfma_f32_16x16x32_bf16 v[138:141], v[118:121], v[178:181], v[138:141]
v_mov_b32_dpp v154, v167 quad_perm:[0,1,2,3] row_mask:0x8 bank_mask:0xf
v_exp_f32_e64 v154, v154
v_mfma_f32_16x16x32_bf16 v[142:145], v[126:129], v[178:181], v[142:145]
v_cvt_pk_bf16_f32 v154, v154, 0
v_rcp_f32 v151, v150
v_mfma_f32_16x16x32_bf16 v[146:149], v[134:137], v[178:181], v[146:149]
s_waitcnt lgkmcnt(2)
ds_write_b16 v214, v154
v_mfma_f32_16x16x32_bf16 v[0:3], a[144:147], v[170:173], v[0:3]
ds_read_b128 v[84:87], v215
ds_read_b128 v[88:91], v215 offset:16
v_mfma_f32_16x16x32_bf16 v[4:7], a[168:171], v[170:173], v[4:7]
ds_read_b128 v[174:177], v217
ds_read_b128 v[178:181], v217 offset:528
v_mfma_f32_16x16x32_bf16 v[8:11], a[192:195], v[170:173], v[8:11]
ds_read_b128 v[170:173], v210 offset:41984
s_waitcnt lgkmcnt(7)
v_mfma_f32_16x16x32_bf16 v[0:3], a[148:151], v[182:185], v[0:3]
v_mfma_f32_16x16x32_bf16 v[4:7], a[172:175], v[182:185], v[4:7]
v_mfma_f32_16x16x32_bf16 v[8:11], a[196:199], v[182:185], v[8:11]
ds_read_b128 v[182:185], v210 offset:43008
s_waitcnt lgkmcnt(5)
v_mfma_f32_16x16x32_bf16 v[166:169], v[84:87], v[190:193], 0
v_mfma_f32_16x16x32_bf16 v[154:157], v[84:87], v[114:117], 0
v_mfma_f32_16x16x32_bf16 v[158:161], v[84:87], v[122:125], 0
s_mul_hi_u32 s41, s35, 58835169
s_mul_i32 s42, s41, 73
s_waitcnt lgkmcnt(4)
v_mfma_f32_16x16x32_bf16 v[162:165], v[84:87], v[130:133], 0
s_sub_u32 s42, s35, s42
s_mul_i32 s43, s41, 1373568
s_mul_i32 s51, s42, 2688
v_mfma_f32_16x16x32_bf16 v[166:169], v[88:91], v[190:193], v[166:169]
s_add_u32 s43, s43, s51
v_mfma_f32_16x16x32_bf16 v[154:157], v[88:91], v[118:121], v[154:157]
s_cmp_lt_u32 s35, s34
s_cselect_b32 s50, s43, 1879048192
s_waitcnt lgkmcnt(0)
v_mfma_f32_16x16x32_bf16 v[158:161], v[88:91], v[126:129], v[158:161]
s_add_u32 s35, s35, 32
v_rcp_f32 v167, v166
v_mfma_f32_16x16x32_bf16 v[162:165], v[88:91], v[134:137], v[162:165]
s_cmp_eq_u32 s42, 0
v_max3_u32 v218, v218, v166, v167
v_max3_u32 v218, v218, v150, v151
v_mfma_f32_16x16x32_bf16 v[0:3], a[152:155], v[186:189], v[0:3]
s_cselect_b32 s44, 536870911, s72
v_mul_f32 v151, s3, v151
v_mul_f32 v138, v138, v151
v_mfma_f32_16x16x32_bf16 v[4:7], a[176:179], v[186:189], v[4:7]
s_cmp_eq_u32 s42, 72
v_mul_f32 v139, v139, v151
v_mul_f32 v140, v140, v151
v_mfma_f32_16x16x32_bf16 v[8:11], a[200:203], v[186:189], v[8:11]
s_cselect_b32 s44, 939524095, s44
ds_read_b128 v[186:189], v210 offset:44032
v_mul_f32 v141, v141, v151
v_mfma_f32_16x16x32_bf16 v[0:3], a[156:159], v[170:173], v[0:3]
s_cmp_eq_u32 s41, 0
v_cvt_pk_bf16_f32 v138, v138, v139
v_mul_f32_e64 v142, v142, v151
v_mfma_f32_16x16x32_bf16 v[4:7], a[180:183], v[170:173], v[4:7]
s_cselect_b32 s52, 1879048192, s50
v_mul_f32 v143, v143, v151
v_mul_f32 v144, v144, v151
v_mfma_f32_16x16x32_bf16 v[8:11], a[204:207], v[170:173], v[8:11]
s_add_u32 m0, s45, 0
ds_read_b128 v[170:173], v210 offset:45056
v_mul_f32 v145, v145, v151
v_mfma_f32_16x16x32_bf16 v[0:3], a[160:163], v[182:185], v[0:3]
v_cvt_pk_bf16_f32 v139, v140, v141
v_cvt_pk_bf16_f32 v140, v142, v143
v_mfma_f32_16x16x32_bf16 v[4:7], a[184:187], v[182:185], v[4:7]
v_cvt_pk_bf16_f32 v141, v144, v145
v_mul_f32 v146, v146, v151
v_mfma_f32_16x16x32_bf16 v[8:11], a[208:211], v[182:185], v[8:11]
s_waitcnt lgkmcnt(1)
ds_read_b128 v[182:185], v210 offset:46080
ds_write_b128 v211, v[138:141] offset:51200
v_mfma_f32_16x16x32_bf16 v[0:3], a[164:167], v[186:189], v[0:3]
s_mov_b32 s39, s37
v_mul_f32 v147, v147, v151
v_mul_f32_e64 v148, v148, v151
v_mfma_f32_16x16x32_bf16 v[4:7], a[188:191], v[186:189], v[4:7]
s_waitcnt lgkmcnt(2)
v_mul_f32 v149, v149, v151
v_cvt_pk_bf16_f32 v142, v146, v147
v_mfma_f32_16x16x32_bf16 v[8:11], a[212:215], v[186:189], v[8:11]
s_mov_b32 s37, s50
ds_read_b128 v[186:189], v210 offset:47104
v_cvt_pk_bf16_f32 v143, v148, v149
v_mfma_f32_16x16x32_bf16 v[12:15], a[144:147], v[170:173], v[12:15]
ds_write_b64 v212, v[142:143] offset:51200
v_mfma_f32_16x16x32_bf16 v[16:19], a[168:171], v[170:173], v[16:19]
v_cvt_pk_bf16_f32 v72, v0, v1
v_cvt_pk_bf16_f32 v73, v2, v3
v_mfma_f32_16x16x32_bf16 v[20:23], a[192:195], v[170:173], v[20:23]
s_waitcnt lgkmcnt(3)
ds_read_b128 v[170:173], v210 offset:48128
buffer_store_dwordx2 v[72:73], v203, s[8:11], s38 offen
v_cvt_pk_bf16_f32 v74, v4, v5
v_mfma_f32_16x16x32_bf16 v[12:15], a[148:151], v[182:185], v[12:15]
v_cvt_pk_bf16_f32 v75, v6, v7
v_mov_b32_dpp v154, v158 quad_perm:[0,1,2,3] row_mask:0x2 bank_mask:0xf
v_mfma_f32_16x16x32_bf16 v[16:19], a[172:175], v[182:185], v[16:19]
v_mul_f32 v167, s3, v167
v_mov_b32_dpp v154, v162 quad_perm:[0,1,2,3] row_mask:0x4 bank_mask:0xf
v_mfma_f32_16x16x32_bf16 v[20:23], a[196:199], v[182:185], v[20:23]
s_waitcnt lgkmcnt(2)
ds_read_b128 v[182:185], v210 offset:49152
v_mul_f32_e64 v154, v154, v167
v_mfma_f32_16x16x32_bf16 v[12:15], a[152:155], v[186:189], v[12:15]
v_cvt_pk_bf16_f32 v154, v154, 0
v_cvt_pk_bf16_f32 v76, v8, v9
v_mfma_f32_16x16x32_bf16 v[16:19], a[176:179], v[186:189], v[16:19]
s_waitcnt vmcnt(1) lgkmcnt(1)
ds_write_b16 v214, v154
v_mfma_f32_16x16x32_bf16 v[20:23], a[200:203], v[186:189], v[20:23]
s_barrier
v_mfma_f32_16x16x32_bf16 v[12:15], a[156:159], v[170:173], v[12:15]
ds_read_b128 v[186:189], v210 offset:50176
ds_read_b128 v[84:87], v200
v_mfma_f32_16x16x32_bf16 v[16:19], a[180:183], v[170:173], v[16:19]
s_nop 0
ds_read_b128 v[92:95], v201
ds_read_b128 v[100:103], v202
v_mfma_f32_16x16x32_bf16 v[20:23], a[204:207], v[170:173], v[20:23]
s_waitcnt lgkmcnt(5)
ds_read_b128 v[170:173], v210 offset:51200
ds_read_b128 v[88:91], v194 offset:16
v_mfma_f32_16x16x32_bf16 v[12:15], a[160:163], v[182:185], v[12:15]
ds_read_b128 v[96:99], v195 offset:16
v_cvt_pk_bf16_f32 v77, v10, v11
v_mfma_f32_16x16x32_bf16 v[16:19], a[184:187], v[182:185], v[16:19]
ds_read_b128 v[104:107], v196 offset:16
v_add_u32 v215, 1552, v215
v_mfma_f32_16x16x32_bf16 v[20:23], a[208:211], v[182:185], v[20:23]
s_nop 0
ds_read_b128 v[182:185], v210 offset:52224
buffer_store_dwordx2 v[74:75], v203, s[8:11], s38 offen offset:32
s_waitcnt lgkmcnt(8)
v_mfma_f32_16x16x32_bf16 v[12:15], a[164:167], v[186:189], v[12:15]
ds_read_b64 v[112:113], v215 offset:528
v_mfma_f32_16x16x32_bf16 v[16:19], a[188:191], v[186:189], v[16:19]
v_mfma_f32_16x16x32_bf16 v[20:23], a[212:215], v[186:189], v[20:23]
s_waitcnt lgkmcnt(8)
ds_read_b128 v[186:189], v210 offset:53248
v_cvt_pk_bf16_f32 v78, v12, v13
v_mfma_f32_16x16x32_bf16 v[0:3], v[174:177], v[84:87], 0
s_waitcnt lgkmcnt(6)
ds_read_b128 v[84:87], v194
v_cvt_pk_bf16_f32 v79, v14, v15
v_mfma_f32_16x16x32_bf16 v[24:27], a[144:147], v[170:173], v[24:27]
v_cvt_pk_bf16_f32 v80, v16, v17
v_cvt_pk_bf16_f32 v81, v18, v19
v_mfma_f32_16x16x32_bf16 v[28:31], a[168:171], v[170:173], v[28:31]
v_cvt_pk_bf16_f32 v82, v20, v21
v_cvt_pk_bf16_f32 v83, v22, v23
v_mfma_f32_16x16x32_bf16 v[32:35], a[192:195], v[170:173], v[32:35]
ds_read_b128 v[170:173], v210 offset:54272
v_mfma_f32_16x16x32_bf16 v[12:15], v[174:177], v[92:95], 0
ds_read_b128 v[92:95], v195
s_waitcnt lgkmcnt(5)
v_mfma_f32_16x16x32_bf16 v[24:27], a[148:151], v[182:185], v[24:27]
v_mfma_f32_16x16x32_bf16 v[28:31], a[172:175], v[182:185], v[28:31]
v_mfma_f32_16x16x32_bf16 v[32:35], a[196:199], v[182:185], v[32:35]
ds_read_b128 v[182:185], v210 offset:55296
s_waitcnt lgkmcnt(4)
v_mfma_f32_16x16x32_bf16 v[24:27], a[152:155], v[186:189], v[24:27]
v_mfma_f32_16x16x32_bf16 v[28:31], a[176:179], v[186:189], v[28:31]
v_mfma_f32_16x16x32_bf16 v[32:35], a[200:203], v[186:189], v[32:35]
s_nop 0
ds_read_b128 v[186:189], v210 offset:56320
s_waitcnt lgkmcnt(3)
v_mfma_f32_16x16x32_bf16 v[24:27], a[156:159], v[170:173], v[24:27]
buffer_store_dwordx2 v[76:77], v203, s[8:11], s38 offen offset:64
v_mfma_f32_16x16x32_bf16 v[28:31], a[180:183], v[170:173], v[28:31]
v_mfma_f32_16x16x32_bf16 v[32:35], a[204:207], v[170:173], v[32:35]
s_waitcnt lgkmcnt(1)
v_mfma_f32_16x16x32_bf16 v[24:27], a[160:163], v[182:185], v[24:27]
v_mfma_f32_16x16x32_bf16 v[28:31], a[184:187], v[182:185], v[28:31]
v_mfma_f32_16x16x32_bf16 v[32:35], a[208:211], v[182:185], v[32:35]
ds_read_b128 v[182:185], v210 offset:20480
s_waitcnt lgkmcnt(1)
v_mfma_f32_16x16x32_bf16 v[24:27], a[164:167], v[186:189], v[24:27]
v_smfmac_f32_16x16x64_bf16 v[0:3], v[178:181], v[84:91], v213
ds_read_b128 v[84:87], v197
ds_read_b128 v[88:91], v197 offset:16
v_mfma_f32_16x16x32_bf16 v[28:31], a[188:191], v[186:189], v[28:31]
v_cvt_pk_bf16_f32 v116, v24, v25
v_cvt_pk_bf16_f32 v117, v26, v27
v_mfma_f32_16x16x32_bf16 v[24:27], v[174:177], v[100:103], 0
ds_read_b128 v[100:103], v196
ds_read_b128 v[174:177], v217 offset:1056
v_mfma_f32_16x16x32_bf16 v[32:35], a[212:215], v[186:189], v[32:35]
s_nop 0
ds_read_b128 v[186:189], v210 offset:21504
v_cvt_pk_bf16_f32 v124, v28, v29
v_smfmac_f32_16x16x64_bf16 v[12:15], v[178:181], v[92:99], v213
s_waitcnt lgkmcnt(5)
ds_read_b128 v[92:95], v198
ds_read_b128 v[96:99], v198 offset:16
v_mfma_f32_16x16x32_bf16 v[138:141], a[0:3], v[182:185], 0
v_cvt_pk_bf16_f32 v125, v30, v31
v_cvt_pk_bf16_f32 v132, v32, v33
v_mfma_f32_16x16x32_bf16 v[142:145], a[24:27], v[182:185], 0
s_nop 0
v_cvt_pk_bf16_f32 v133, v34, v35
v_mfma_f32_16x16x32_bf16 v[146:149], a[48:51], v[182:185], 0
s_waitcnt lgkmcnt(4)
v_smfmac_f32_16x16x64_bf16 v[24:27], v[178:181], v[100:107], v213
ds_read_b128 v[100:103], v199
ds_read_b128 v[104:107], v199 offset:16
v_mfma_f32_16x16x32_bf16 v[150:153], a[216:219], v[182:185], 0
ds_read_b128 v[178:181], v217 offset:1584
buffer_store_dwordx2 v[78:79], v204, s[8:11], s38 offen
s_waitcnt lgkmcnt(6)
v_smfmac_f32_16x16x64_bf16 v[0:3], v[174:177], v[84:91], v213
ds_read_b128 v[84:87], v200 offset:32
ds_read_b128 v[88:91], v194 offset:48
v_mfma_f32_16x16x32_bf16 v[154:157], a[240:243], v[182:185], 0
s_waitcnt lgkmcnt(5)
v_smfmac_f32_16x16x64_bf16 v[12:15], v[174:177], v[92:99], v213
ds_read_b128 v[92:95], v201 offset:32
ds_read_b128 v[96:99], v195 offset:48
v_mfma_f32_16x16x32_bf16 v[158:161], v[232:235], v[182:185], 0
v_mul_f32 v119, v0, v0
v_add_f32 v118, v0, v1
v_mfma_f32_16x16x32_bf16 v[162:165], v[182:185], a[72:75], 0
s_waitcnt lgkmcnt(5)
v_mul_f32 v127, v12, v12
v_add_f32_e64 v126, v12, v13
v_smfmac_f32_16x16x64_bf16 v[24:27], v[174:177], v[100:107], v213
ds_read_b128 v[100:103], v202 offset:32
ds_read_b128 v[174:177], v217 offset:2112
v_mfma_f32_16x16x32_bf16 v[166:169], v[182:185], a[96:99], 0
s_waitcnt lgkmcnt(5)
ds_read_b128 v[104:107], v196 offset:48
v_fmac_f32 v119, v1, v1
v_mfma_f32_16x16x32_bf16 v[4:7], v[178:181], v[84:87], 0
ds_read_b128 v[84:87], v194 offset:32
v_mul_f32 v135, v24, v24
v_mfma_f32_16x16x32_bf16 v[170:173], v[182:185], a[120:123], 0
s_waitcnt lgkmcnt(5)
ds_read_b128 v[182:185], v210 offset:22528
v_add_f32_e64 v134, v24, v25
v_mfma_f32_16x16x32_bf16 v[16:19], v[178:181], v[92:95], 0
ds_read_b128 v[92:95], v195 offset:32
v_fmac_f32_e64 v135, v25, v25
v_mfma_f32_16x16x32_bf16 v[138:141], a[4:7], v[186:189], v[138:141]
v_fmac_f32 v127, v13, v13
v_add_f32 v134, v134, v26
v_mfma_f32_16x16x32_bf16 v[142:145], a[28:31], v[186:189], v[142:145]
s_waitcnt lgkmcnt(5)
v_fmac_f32 v135, v26, v26
v_add_f32_e64 v118, v118, v2
v_mfma_f32_16x16x32_bf16 v[28:31], v[178:181], v[100:103], 0
ds_read_b128 v[100:103], v196 offset:32
ds_read_b128 v[178:181], v217 offset:2640
v_mfma_f32_16x16x32_bf16 v[146:149], a[52:55], v[186:189], v[146:149]
v_add_f32 v126, v126, v14
v_fmac_f32 v119, v2, v2
v_mfma_f32_16x16x32_bf16 v[150:153], a[220:223], v[186:189], v[150:153]
s_waitcnt lgkmcnt(4)
v_fmac_f32 v127, v14, v14
v_add_f32_e64 v134, v134, v27
v_smfmac_f32_16x16x64_bf16 v[4:7], v[174:177], v[84:91], v213
s_nop 0
ds_read_b128 v[84:87], v197 offset:32
ds_read_b128 v[88:91], v197 offset:48
v_mfma_f32_16x16x32_bf16 v[154:157], a[244:247], v[186:189], v[154:157]
s_waitcnt lgkmcnt(4)
buffer_store_dwordx2 v[80:81], v204, s[8:11], s38 offen offset:32
v_fmac_f32 v135, v27, v27
v_smfmac_f32_16x16x64_bf16 v[16:19], v[174:177], v[92:99], v213
s_waitcnt lgkmcnt(3)
ds_read_b128 v[92:95], v198 offset:32
ds_read_b128 v[96:99], v198 offset:48
v_smfmac_f32_16x16x64_bf16 v[28:31], v[174:177], v[100:107], v213
ds_read_b128 v[100:103], v199 offset:32
ds_read_b128 v[104:107], v199 offset:48
v_mfma_f32_16x16x32_bf16 v[158:161], v[236:239], v[186:189], v[158:161]
ds_read_b128 v[174:177], v217 offset:3168
v_add_f32_e64 v118, v118, v3
v_mfma_f32_16x16x32_bf16 v[162:165], v[186:189], a[76:79], v[162:165]
v_add_f32 v126, v126, v15
v_fmac_f32 v119, v3, v3
v_mfma_f32_16x16x32_bf16 v[166:169], v[186:189], a[100:103], v[166:169]
v_fmac_f32 v127, v15, v15
s_waitcnt lgkmcnt(5)
v_smfmac_f32_16x16x64_bf16 v[4:7], v[178:181], v[84:91], v213
ds_read_b128 v[84:87], v200 offset:64
ds_read_b128 v[88:91], v194 offset:80
v_mfma_f32_16x16x32_bf16 v[170:173], v[186:189], a[124:127], v[170:173]
s_nop 0
ds_read_b128 v[186:189], v210 offset:23552
s_waitcnt lgkmcnt(6)
v_smfmac_f32_16x16x64_bf16 v[16:19], v[178:181], v[92:99], v213
ds_read_b128 v[92:95], v201 offset:64
ds_read_b128 v[96:99], v195 offset:80
v_mfma_f32_16x16x32_bf16 v[138:141], a[8:11], v[182:185], v[138:141]
v_add_f32 v118, v118, v4
v_fmac_f32 v119, v4, v4
v_mfma_f32_16x16x32_bf16 v[142:145], a[32:35], v[182:185], v[142:145]
s_waitcnt lgkmcnt(6)
v_add_f32 v126, v126, v16
v_fmac_f32_e64 v127, v16, v16
v_smfmac_f32_16x16x64_bf16 v[28:31], v[178:181], v[100:107], v213
ds_read_b128 v[100:103], v202 offset:64
ds_read_b128 v[178:181], v217 offset:3696
v_mfma_f32_16x16x32_bf16 v[146:149], a[56:59], v[182:185], v[146:149]
s_waitcnt lgkmcnt(6)
ds_read_b128 v[104:107], v196 offset:80
v_add_f32 v118, v118, v5
v_mfma_f32_16x16x32_bf16 v[8:11], v[174:177], v[84:87], 0
ds_read_b128 v[84:87], v194 offset:64
v_add_f32_e64 v134, v134, v28
v_mfma_f32_16x16x32_bf16 v[150:153], a[224:227], v[182:185], v[150:153]
buffer_store_dwordx2 v[82:83], v204, s[8:11], s38 offen offset:64
v_fmac_f32 v135, v28, v28
v_mfma_f32_16x16x32_bf16 v[154:157], a[248:251], v[182:185], v[154:157]
s_waitcnt lgkmcnt(5)
v_add_f32 v134, v134, v29
v_fmac_f32 v135, v29, v29
v_mfma_f32_16x16x32_bf16 v[20:23], v[174:177], v[92:95], 0
s_waitcnt lgkmcnt(3)
ds_read_b128 v[92:95], v195 offset:64
v_fmac_f32 v119, v5, v5
v_mfma_f32_16x16x32_bf16 v[32:35], v[174:177], v[100:103], 0
ds_read_b128 v[100:103], v196 offset:64
ds_read_b128 v[174:177], v217 offset:4224
v_mfma_f32_16x16x32_bf16 v[158:161], v[240:243], v[182:185], v[158:161]
v_add_f32 v126, v126, v17
v_fmac_f32 v127, v17, v17
v_mfma_f32_16x16x32_bf16 v[162:165], v[182:185], a[80:83], v[162:165]
s_waitcnt lgkmcnt(3)
v_add_f32 v134, v134, v30
v_fmac_f32_e64 v135, v30, v30
v_smfmac_f32_16x16x64_bf16 v[8:11], v[178:181], v[84:91], v213
ds_read_b128 v[84:87], v197 offset:64
ds_read_b128 v[88:91], v197 offset:80
v_mfma_f32_16x16x32_bf16 v[166:169], v[182:185], a[104:107], v[166:169]
v_add_f32_e64 v118, v118, v6
v_fmac_f32 v119, v6, v6
v_mfma_f32_16x16x32_bf16 v[170:173], v[182:185], a[128:131], v[170:173]
s_waitcnt lgkmcnt(4)
ds_read_b128 v[182:185], v210 offset:24576
v_add_f32_e64 v126, v126, v18
v_smfmac_f32_16x16x64_bf16 v[20:23], v[178:181], v[92:99], v213
ds_read_b128 v[92:95], v198 offset:64
ds_read_b128 v[96:99], v198 offset:80
v_mfma_f32_16x16x32_bf16 v[138:141], a[12:15], v[186:189], v[138:141]
s_waitcnt lgkmcnt(6)
v_fmac_f32 v127, v18, v18
v_add_f32_e64 v134, v134, v31
v_smfmac_f32_16x16x64_bf16 v[32:35], v[178:181], v[100:107], v213
ds_read_b128 v[100:103], v199 offset:64
ds_read_b128 v[104:107], v199 offset:80
v_mfma_f32_16x16x32_bf16 v[142:145], a[36:39], v[186:189], v[142:145]
v_fmac_f32 v135, v31, v31
v_add_f32 v118, v118, v7
v_mfma_f32_16x16x32_bf16 v[146:149], a[60:63], v[186:189], v[146:149]
v_fmac_f32 v119, v7, v7
v_add_f32 v126, v126, v19
v_mfma_f32_16x16x32_bf16 v[150:153], a[228:231], v[186:189], v[150:153]
v_fmac_f32_e64 v127, v19, v19
v_and_b32 v180, s44, v208
v_mfma_f32_16x16x32_bf16 v[154:157], a[252:255], v[186:189], v[154:157]
s_waitcnt lgkmcnt(5)
v_add_u32 v214, 1552, v214
v_mov_b32_e64 v181, 0
v_smfmac_f32_16x16x64_bf16 v[8:11], v[174:177], v[84:91], v213
buffer_store_dwordx2 v[116:117], v205, s[8:11], s38 offen
v_mfma_f32_16x16x32_bf16 v[158:161], v[244:247], v[186:189], v[158:161]
v_mfma_f32_16x16x32_bf16 v[162:165], v[186:189], a[84:87], v[162:165]
s_waitcnt lgkmcnt(2)
v_add_f32 v118, v118, v8
v_fmac_f32_e64 v119, v8, v8
v_smfmac_f32_16x16x64_bf16 v[20:23], v[174:177], v[92:99], v213
v_add_f32 v118, v118, v9
v_mfma_f32_16x16x32_bf16 v[166:169], v[186:189], a[108:111], v[166:169]
v_fmac_f32 v119, v9, v9
v_add_f32 v118, v118, v10
v_mfma_f32_16x16x32_bf16 v[170:173], v[186:189], a[132:135], v[170:173]
s_waitcnt lgkmcnt(0)
ds_read_b128 v[186:189], v210 offset:25600
v_add_f32_e64 v126, v126, v20
v_smfmac_f32_16x16x64_bf16 v[32:35], v[174:177], v[100:107], v213
v_fmac_f32_e64 v127, v20, v20
v_mfma_f32_16x16x32_bf16 v[138:141], a[16:19], v[182:185], v[138:141]
v_add_f32 v126, v126, v21
v_fmac_f32 v127, v21, v21
v_mfma_f32_16x16x32_bf16 v[142:145], a[40:43], v[182:185], v[142:145]
v_add_f32 v134, v134, v32
v_fmac_f32 v135, v32, v32
v_mfma_f32_16x16x32_bf16 v[146:149], a[64:67], v[182:185], v[146:149]
v_add_f32 v134, v134, v33
v_fmac_f32 v135, v33, v33
v_mfma_f32_16x16x32_bf16 v[150:153], a[232:235], v[182:185], v[150:153]
v_add_f32 v134, v134, v34
v_fmac_f32 v135, v34, v34
v_mfma_f32_16x16x32_bf16 v[154:157], v[224:227], v[182:185], v[154:157]
v_fmac_f32 v119, v10, v10
v_add_f32 v126, v126, v22
v_mfma_f32_16x16x32_bf16 v[158:161], v[248:251], v[182:185], v[158:161]
v_fmac_f32 v127, v22, v22
v_add_f32 v134, v134, v35
v_mfma_f32_16x16x32_bf16 v[162:165], v[182:185], a[88:91], v[162:165]
v_fmac_f32 v135, v35, v35
v_add_f32 v118, v118, v11
v_mfma_f32_16x16x32_bf16 v[166:169], v[182:185], a[112:115], v[166:169]
v_fmac_f32_e64 v119, v11, v11
v_add_f32 v126, v126, v23
v_mfma_f32_16x16x32_bf16 v[170:173], v[182:185], a[136:139], v[170:173]
s_waitcnt lgkmcnt(0)
ds_read_b128 v[182:185], v210 offset:26624
v_fmac_f32_e64 v127, v23, v23
v_mfma_f32_16x16x32_bf16 v[138:141], a[20:23], v[186:189], v[138:141]
buffer_store_dwordx2 v[124:125], v205, s[8:11], s38 offen offset:32
v_permlane16_swap_b32 v134, v135
v_mfma_f32_16x16x32_bf16 v[142:145], a[44:47], v[186:189], v[142:145]
v_permlane16_swap_b32 v118, v119
v_mfma_f32_16x16x32_bf16 v[146:149], a[68:71], v[186:189], v[146:149]
v_cvt_pk_bf16_f32 v78, v138, v139
v_cvt_pk_bf16_f32 v79, v140, v141
v_mfma_f32_16x16x32_bf16 v[150:153], a[236:239], v[186:189], v[150:153]
v_cvt_pk_bf16_f32 v80, v142, v143
v_cvt_pk_bf16_f32 v81, v144, v145
v_mfma_f32_16x16x32_bf16 v[154:157], v[228:231], v[186:189], v[154:157]
v_cvt_pk_bf16_f32 v82, v146, v147
v_cvt_pk_bf16_f32 v83, v148, v149
v_mfma_f32_16x16x32_bf16 v[158:161], v[252:255], v[186:189], v[158:161]
v_cvt_pk_bf16_f32 v72, v150, v151
v_cvt_pk_bf16_f32 v73, v152, v153
v_mfma_f32_16x16x32_bf16 v[162:165], v[186:189], a[92:95], v[162:165]
v_cvt_pk_bf16_f32 v74, v154, v155
v_cvt_pk_bf16_f32 v75, v156, v157
v_mfma_f32_16x16x32_bf16 v[166:169], v[186:189], a[116:119], v[166:169]
s_nop 0
v_cvt_pk_bf16_f32 v76, v158, v159
v_cvt_pk_bf16_f32 v77, v160, v161
v_mfma_f32_16x16x32_bf16 v[170:173], v[186:189], a[140:143], v[170:173]
s_waitcnt lgkmcnt(0)
ds_read_b128 v[186:189], v210 offset:27648
v_cvt_pk_bf16_f32 v114, v162, v163
v_mfma_f32_16x16x32_bf16 v[138:141], a[0:3], v[182:185], 0
v_cvt_pk_bf16_f32 v115, v164, v165
v_cvt_pk_bf16_f32 v122, v166, v167
v_mfma_f32_16x16x32_bf16 v[142:145], a[24:27], v[182:185], 0
v_cvt_pk_bf16_f32 v123, v168, v169
v_cvt_pk_bf16_f32 v130, v170, v171
v_mfma_f32_16x16x32_bf16 v[146:149], a[48:51], v[182:185], 0
v_cvt_pk_bf16_f32 v131, v172, v173
v_add_f32_e64 v134, v134, v135
v_mfma_f32_16x16x32_bf16 v[150:153], a[216:219], v[182:185], 0
v_permlane16_swap_b32 v126, v127
v_mfma_f32_16x16x32_bf16 v[154:157], a[240:243], v[182:185], 0
v_add_f32 v118, v118, v119
v_mov_b32_e64 v135, v134
v_mfma_f32_16x16x32_bf16 v[158:161], v[232:235], v[182:185], 0
v_add_f32 v126, v126, v127
v_permlane32_swap_b32 v134, v135
v_mfma_f32_16x16x32_bf16 v[162:165], v[182:185], a[72:75], 0
buffer_store_dwordx2 v[132:133], v205, s[8:11], s38 offen offset:64
v_permlane32_swap_b32 v118, v126
v_mfma_f32_16x16x32_bf16 v[166:169], v[182:185], a[96:99], 0
v_add_f32 v134, v134, v135
v_add_f32 v118, v118, v126
v_mfma_f32_16x16x32_bf16 v[170:173], v[182:185], a[120:123], 0
s_waitcnt lgkmcnt(0)
ds_read_b128 v[182:185], v210 offset:28672
ds_write_b32 v209, v134 offset:512
v_mfma_f32_16x16x32_bf16 v[138:141], a[4:7], v[186:189], v[138:141]
ds_write_b32 v209, v118
v_mfma_f32_16x16x32_bf16 v[142:145], a[28:31], v[186:189], v[142:145]
v_mfma_f32_16x16x32_bf16 v[146:149], a[52:55], v[186:189], v[146:149]
v_mfma_f32_16x16x32_bf16 v[150:153], a[220:223], v[186:189], v[150:153]
v_mfma_f32_16x16x32_bf16 v[154:157], a[244:247], v[186:189], v[154:157]
v_mfma_f32_16x16x32_bf16 v[158:161], v[236:239], v[186:189], v[158:161]
v_mfma_f32_16x16x32_bf16 v[162:165], v[186:189], a[76:79], v[162:165]
s_waitcnt lgkmcnt(0)
s_barrier
v_mfma_f32_16x16x32_bf16 v[166:169], v[186:189], a[100:103], v[166:169]
s_sub_u32 s46, s46, 1
ds_read_b128 v[102:105], v210 offset:18432
ds_read_b128 v[106:109], v210 offset:19456
v_mfma_f32_16x16x32_bf16 v[170:173], v[186:189], a[124:127], v[170:173]
s_cbranch_scc0 F_loop
F_tail:
v_mfma_f32_16x16x32_bf16 v[138:141], a[8:11], v[182:185], v[138:141]
s_mov_b32 s20, s100
ds_read_b128 v[186:189], v210 offset:29696
v_mov_b32 v216, 1
v_mfma_f32_16x16x32_bf16 v[142:145], a[32:35], v[182:185], v[142:145]
s_mov_b32 s21, s101
s_waitcnt lgkmcnt(2)
v_add_f32 v102, v102, v103
s_waitcnt lgkmcnt(1)
v_add_f32_e64 v106, v106, v107
v_mfma_f32_16x16x32_bf16 v[146:149], a[56:59], v[182:185], v[146:149]
s_mov_b32 s22, 256
v_add_f32 v104, v104, v105
v_add_f32 v108, v108, v109
v_mfma_f32_16x16x32_bf16 v[150:153], a[224:227], v[182:185], v[150:153]
s_mov_b32 s23, 131072
v_add_f32 v102, v102, v104
v_add_f32 v106, v106, v108
v_mfma_f32_16x16x32_bf16 v[154:157], a[248:251], v[182:185], v[154:157]
s_mov_b32 s30, 1
ds_read_b128 v[108:111], v215 offset:512
v_mul_f32 v103, s48, v102
v_mfma_f32_16x16x32_bf16 v[158:161], v[240:243], v[182:185], v[158:161]
s_mov_b32 s31, 0
s_mov_b64 exec, s[30:31]
buffer_atomic_add v216, off, s[20:23], s45 sc0
s_mov_b64 exec, -1
v_mfma_f32_16x16x32_bf16 v[162:165], v[182:185], a[80:83], v[162:165]
s_waitcnt lgkmcnt(1)
buffer_load_dwordx4 v180, s[4:7], s52 offen nt lds
v_mfma_f32_16x16x32_bf16 v[166:169], v[182:185], a[104:107], v[166:169]
s_add_u32 m0, s45, 4112
v_mul_f32 v104, s73, v102
v_mul_f32 v106, s73, v106
v_mfma_f32_16x16x32_bf16 v[170:173], v[182:185], a[128:131], v[170:173]
s_add_u32 s40, s37, 196224
ds_read_b128 v[182:185], v210 offset:30720
v_fma_f32 v106, -v103, v104, v106
v_mfma_f32_16x16x32_bf16 v[138:141], a[12:15], v[186:189], v[138:141]
s_mov_b32 s38, s36
v_max_f32 v106, 0, v106
v_add_f32_e64 v106, s49, v106
v_mfma_f32_16x16x32_bf16 v[142:145], a[36:39], v[186:189], v[142:145]
v_rsq_f32_e64 v102, v106
v_mfma_f32_16x16x32_bf16 v[146:149], a[60:63], v[186:189], v[146:149]
v_mul_f32_e64 v103, -v103, v102
v_mfma_f32_16x16x32_bf16 v[150:153], a[228:231], v[186:189], v[150:153]
ds_write_b64 v211, v[102:103]
v_mfma_f32_16x16x32_bf16 v[154:157], a[252:255], v[186:189], v[154:157]
v_mfma_f32_16x16x32_bf16 v[158:161], v[244:247], v[186:189], v[158:161]
ds_read_b64 v[118:119], v219
buffer_load_dwordx4 v180, s[4:7], s40 offen nt lds
v_mfma_f32_16x16x32_bf16 v[162:165], v[186:189], a[84:87], v[162:165]
s_add_u32 m0, s45, 8224
ds_read_b64 v[126:127], v219 offset:256
ds_read_b64 v[134:135], v219 offset:512
v_mfma_f32_16x16x32_bf16 v[166:169], v[186:189], a[108:111], v[166:169]
s_add_u32 s40, s37, 392448
v_mfma_f32_16x16x32_bf16 v[170:173], v[186:189], a[132:135], v[170:173]
ds_read_b128 v[186:189], v210 offset:31744
s_waitcnt lgkmcnt(5)
v_mfma_f32_16x16x32_bf16 v[138:141], a[16:19], v[182:185], v[138:141]
v_mfma_f32_16x16x32_bf16 v[142:145], a[40:43], v[182:185], v[142:145]
s_waitcnt lgkmcnt(3)
v_fma_f32 v220, v0, v118, v119
v_fma_f32 v221, v1, v118, v119
v_mfma_f32_16x16x32_bf16 v[146:149], a[64:67], v[182:185], v[146:149]
v_fma_f32 v222, v2, v118, v119
v_fma_f32 v223, v3, v118, v119
v_mfma_f32_16x16x32_bf16 v[150:153], a[232:235], v[182:185], v[150:153]
v_cvt_pk_bf16_f32 v90, v220, v221
v_cvt_pk_bf16_f32 v91, v222, v223
v_mfma_f32_16x16x32_bf16 v[154:157], v[224:227], v[182:185], v[154:157]
v_fma_f32 v220, v4, v118, v119
v_fma_f32 v221, v5, v118, v119
v_mfma_f32_16x16x32_bf16 v[158:161], v[248:251], v[182:185], v[158:161]
s_nop 0
v_fma_f32 v222, v6, v118, v119
v_fma_f32 v223, v7, v118, v119
v_mfma_f32_16x16x32_bf16 v[162:165], v[182:185], a[88:91], v[162:165]
s_waitcnt lgkmcnt(0)
buffer_load_dwordx4 v180, s[4:7], s40 offen nt lds
v_mfma_f32_16x16x32_bf16 v[166:169], v[182:185], a[112:115], v[166:169]
s_add_u32 m0, s45, 12336
v_cvt_pk_bf16_f32 v92, v220, v221
v_cvt_pk_bf16_f32 v93, v222, v223
v_mfma_f32_16x16x32_bf16 v[170:173], v[182:185], a[136:139], v[170:173]
s_add_u32 s40, s37, 588672
ds_read_b128 v[182:185], v210 offset:32768
ds_write_b128 v211, v[90:93]
v_mfma_f32_16x16x32_bf16 v[138:141], a[20:23], v[186:189], v[138:141]
v_fma_f32 v220, v8, v118, v119
v_fma_f32 v221, v9, v118, v119
v_mfma_f32_16x16x32_bf16 v[142:145], a[44:47], v[186:189], v[142:145]
v_fma_f32 v222, v10, v118, v119
v_fma_f32 v223, v11, v118, v119
v_mfma_f32_16x16x32_bf16 v[146:149], a[68:71], v[186:189], v[146:149]
v_cvt_pk_bf16_f32 v96, v138, v139
v_cvt_pk_bf16_f32 v97, v140, v141
v_mfma_f32_16x16x32_bf16 v[150:153], a[236:239], v[186:189], v[150:153]
v_cvt_pk_bf16_f32 v98, v142, v143
v_cvt_pk_bf16_f32 v99, v144, v145
v_mfma_f32_16x16x32_bf16 v[154:157], v[228:231], v[186:189], v[154:157]
v_cvt_pk_bf16_f32 v100, v146, v147
v_cvt_pk_bf16_f32 v101, v148, v149
v_mfma_f32_16x16x32_bf16 v[158:161], v[252:255], v[186:189], v[158:161]
s_nop 0
v_cvt_pk_bf16_f32 v84, v150, v151
v_cvt_pk_bf16_f32 v85, v152, v153
v_mfma_f32_16x16x32_bf16 v[162:165], v[186:189], a[92:95], v[162:165]
s_waitcnt lgkmcnt(1)
buffer_load_dwordx4 v180, s[4:7], s40 offen nt lds
v_mfma_f32_16x16x32_bf16 v[166:169], v[186:189], a[116:119], v[166:169]
s_add_u32 m0, s45, 16448
v_cvt_pk_bf16_f32 v88, v158, v159
v_cvt_pk_bf16_f32 v89, v160, v161
v_mfma_f32_16x16x32_bf16 v[170:173], v[186:189], a[140:143], v[170:173]
s_add_u32 s40, s37, 784896
ds_read_b128 v[186:189], v210 offset:33792
v_cvt_pk_bf16_f32 v86, v154, v155
v_mfma_f32_16x16x32_bf16 v[138:141], a[0:3], v[182:185], 0
v_cvt_pk_bf16_f32 v87, v156, v157
v_cvt_pk_bf16_f32 v124, v166, v167
v_mfma_f32_16x16x32_bf16 v[142:145], a[24:27], v[182:185], 0
v_cvt_pk_bf16_f32 v125, v168, v169
v_cvt_pk_bf16_f32 v116, v162, v163
v_mfma_f32_16x16x32_bf16 v[146:149], a[48:51], v[182:185], 0
ds_read_b128 v[182:185], v210 offset:34816
v_cvt_pk_bf16_f32 v117, v164, v165
v_cvt_pk_bf16_f32 v94, v220, v221
v_mfma_f32_16x16x16_bf16 v[154:157], v[82:83], v[88:89], 0
v_cvt_pk_bf16_f32 v95, v222, v223
v_fma_f32 v220, v12, v126, v127
v_fma_f32 v221, v13, v126, v127
v_mfma_f32_16x16x16_bf16 v[158:161], v[100:101], v[88:89], 0
v_fma_f32 v222, v14, v126, v127
v_fma_f32 v223, v15, v126, v127
v_cvt_pk_bf16_f32 v174, v220, v221
v_cvt_pk_bf16_f32 v175, v222, v223
s_waitcnt lgkmcnt(1)
v_mfma_f32_16x16x32_bf16 v[138:141], a[4:7], v[186:189], v[138:141]
ds_write_b64 v212, v[94:95]
v_mfma_f32_16x16x32_bf16 v[142:145], a[28:31], v[186:189], v[142:145]
buffer_load_dwordx4 v180, s[4:7], s40 offen nt lds
v_mfma_f32_16x16x32_bf16 v[146:149], a[52:55], v[186:189], v[146:149]
s_waitcnt lgkmcnt(1)
ds_read_b128 v[186:189], v210 offset:35840
v_fma_f32 v220, v16, v126, v127
v_mfma_f32_16x16x32_bf16 v[138:141], a[8:11], v[182:185], v[138:141]
s_add_u32 m0, s45, 20560
v_fma_f32 v221, v17, v126, v127
v_fma_f32 v222, v18, v126, v127
v_mfma_f32_16x16x32_bf16 v[142:145], a[32:35], v[182:185], v[142:145]
s_add_u32 s40, s37, 981120
v_fma_f32 v223, v19, v126, v127
v_cvt_pk_bf16_f32 v176, v220, v221
v_mfma_f32_16x16x32_bf16 v[146:149], a[56:59], v[182:185], v[146:149]
ds_read_b128 v[182:185], v210 offset:36864
v_cvt_pk_bf16_f32 v177, v222, v223
v_fma_f32 v220, v20, v126, v127
v_mfma_f32_16x16x16_bf16 v[166:169], v[112:113], v[88:89], v[206:209]
v_fma_f32 v221, v21, v126, v127
v_fma_f32 v222, v22, v126, v127
v_fma_f32 v223, v23, v126, v127
v_mfma_f32_16x16x16_bf16 v[150:153], v[112:113], v[76:77], v[206:209]
v_cvt_pk_bf16_f32 v178, v220, v221
v_cvt_pk_bf16_f32 v179, v222, v223
v_fma_f32 v220, v24, v134, v135
v_fma_f32 v221, v25, v134, v135
s_waitcnt lgkmcnt(1)
v_mfma_f32_16x16x32_bf16 v[138:141], a[12:15], v[186:189], v[138:141]
ds_write_b128 v211, v[174:177] offset:6144
v_mfma_f32_16x16x32_bf16 v[142:145], a[36:39], v[186:189], v[142:145]
v_fma_f32 v222, v26, v134, v135
v_fma_f32 v223, v27, v134, v135
v_mfma_f32_16x16x32_bf16 v[146:149], a[60:63], v[186:189], v[146:149]
s_waitcnt lgkmcnt(1)
buffer_load_dwordx4 v180, s[4:7], s40 offen nt lds
v_mfma_f32_16x16x32_bf16 v[138:141], a[16:19], v[182:185], v[138:141]
s_add_u32 m0, s45, 24672
ds_read_b128 v[186:189], v210 offset:37888
ds_write_b64 v212, v[178:179] offset:6144
v_mfma_f32_16x16x32_bf16 v[142:145], a[40:43], v[182:185], v[142:145]
s_add_u32 s40, s37, 1177344
v_cvt_pk_bf16_f32 v90, v220, v221
v_cvt_pk_bf16_f32 v91, v222, v223
v_mfma_f32_16x16x32_bf16 v[154:157], v[78:81], v[84:87], v[154:157]
v_fma_f32 v220, v28, v134, v135
v_fma_f32 v221, v29, v134, v135
v_mfma_f32_16x16x32_bf16 v[150:153], v[108:111], v[72:75], v[150:153]
v_fma_f32 v222, v30, v134, v135
v_fma_f32 v223, v31, v134, v135
v_mfma_f32_16x16x32_bf16 v[146:149], a[64:67], v[182:185], v[146:149]
s_nop 0
ds_read_b128 v[182:185], v210 offset:32768
v_cvt_pk_bf16_f32 v92, v220, v221
v_mfma_f32_16x16x32_bf16 v[158:161], v[96:99], v[84:87], v[158:161]
s_waitcnt lgkmcnt(2)
v_cvt_pk_bf16_f32 v93, v222, v223
v_fma_f32 v220, v32, v134, v135
v_mfma_f32_16x16x32_bf16 v[138:141], a[20:23], v[186:189], v[138:141]
ds_write_b128 v211, v[90:93] offset:12288
v_mfma_f32_16x16x32_bf16 v[142:145], a[44:47], v[186:189], v[142:145]
v_cvt_pk_bf16_f32 v102, v138, v139
v_cvt_pk_bf16_f32 v103, v140, v141
v_fma_f32 v221, v33, v134, v135
v_mfma_f32_16x16x16_bf16 v[138:141], v[82:83], v[76:77], 0
v_fma_f32 v222, v34, v134, v135
v_fma_f32 v223, v35, v134, v135
v_cvt_pk_bf16_f32 v132, v170, v171
v_cvt_pk_bf16_f32 v104, v142, v143
v_cvt_pk_bf16_f32 v105, v144, v145
v_mfma_f32_16x16x16_bf16 v[142:145], v[100:101], v[76:77], 0
v_cvt_pk_bf16_f32 v133, v172, v173
v_cvt_pk_bf16_f32 v94, v220, v221
v_cvt_pk_bf16_f32 v95, v222, v223
v_exp_f32 v150, v150
v_mfma_f32_16x16x32_bf16 v[138:141], v[78:81], v[72:75], v[138:141]
s_waitcnt lgkmcnt(1)
buffer_load_dwordx4 v180, s[4:7], s40 offen nt lds
v_mfma_f32_16x16x32_bf16 v[142:145], v[96:99], v[72:75], v[142:145]
s_add_u32 m0, s45, 28784
ds_write_b64 v212, v[94:95] offset:12288
v_mfma_f32_16x16x32_bf16 v[118:121], v[182:185], a[72:75], 0
s_add_u32 s40, s37, 1373568
v_exp_f32 v138, v138
v_mfma_f32_16x16x32_bf16 v[126:129], v[182:185], a[96:99], 0
v_exp_f32 v139, v139
v_mfma_f32_16x16x32_bf16 v[134:137], v[182:185], a[120:123], 0
v_exp_f32 v140, v140
v_mfma_f32_16x16x32_bf16 v[90:93], a[216:219], v[182:185], 0
v_exp_f32 v141, v141
v_mfma_f32_16x16x32_bf16 v[170:173], a[240:243], v[182:185], 0
buffer_load_dwordx4 v180, s[4:7], s40 offen nt lds
v_mfma_f32_16x16x32_bf16 v[220:223], v[232:235], v[182:185], 0
s_add_u32 m0, s45, 32896
ds_read_b128 v[182:185], v210 offset:34816
v_cvt_pk_bf16_f32 v174, v138, v139
v_mfma_f32_16x16x32_bf16 v[146:149], a[68:71], v[186:189], v[146:149]
s_add_u32 s40, s37, 1569792
ds_read_b128 v[186:189], v210 offset:33792
v_cvt_pk_bf16_f32 v175, v140, v141
v_mfma_f32_16x16x32_bf16 v[166:169], v[108:111], v[84:87], v[166:169]
v_exp_f32 v142, v142
v_exp_f32 v143, v143
v_cvt_pk_bf16_f32 v106, v146, v147
v_cvt_pk_bf16_f32 v107, v148, v149
v_exp_f32 v144, v144
v_mfma_f32_16x16x16_bf16 v[162:165], v[106:107], v[88:89], 0
v_exp_f32 v145, v145
v_cvt_pk_bf16_f32 v176, v142, v143
v_mfma_f32_16x16x16_bf16 v[146:149], v[106:107], v[76:77], 0
v_cvt_pk_bf16_f32 v177, v144, v145
v_exp_f32 v154, v154
v_exp_f32 v155, v155
s_nop 1
v_mfma_f32_16x16x32_bf16 v[146:149], v[102:105], v[72:75], v[146:149]
s_waitcnt lgkmcnt(0)
ds_read_b64 v[76:77], v215 offset:16
ds_read_b128 v[72:75], v215
v_mfma_f32_16x16x32_bf16 v[118:121], v[186:189], a[76:79], v[118:121]
v_exp_f32 v156, v156
v_mfma_f32_16x16x32_bf16 v[126:129], v[186:189], a[100:103], v[126:129]
buffer_load_dwordx4 v180, s[4:7], s40 offen nt lds
v_mfma_f32_16x16x32_bf16 v[134:137], v[186:189], a[124:127], v[134:137]
v_cvt_pk_bf16_f32 v180, v150, 0
v_exp_f32 v157, v157
v_mfma_f32_16x16x32_bf16 v[90:93], a[220:223], v[186:189], v[90:93]
v_exp_f32 v158, v158
v_mfma_f32_16x16x32_bf16 v[170:173], a[244:247], v[186:189], v[170:173]
v_exp_f32 v159, v159
v_mfma_f32_16x16x32_bf16 v[220:223], v[236:239], v[186:189], v[220:223]
ds_read_b128 v[186:189], v210 offset:35840
v_exp_f32 v160, v160
v_mfma_f32_16x16x32_bf16 v[118:121], v[182:185], a[80:83], v[118:121]
v_exp_f32 v161, v161
v_mfma_f32_16x16x32_bf16 v[126:129], v[182:185], a[104:107], v[126:129]
v_exp_f32 v166, v166
v_mfma_f32_16x16x32_bf16 v[134:137], v[182:185], a[128:131], v[134:137]
v_exp_f32 v146, v146
v_mfma_f32_16x16x32_bf16 v[90:93], a[224:227], v[182:185], v[90:93]
v_exp_f32 v147, v147
v_mfma_f32_16x16x32_bf16 v[162:165], v[102:105], v[84:87], v[162:165]
v_exp_f32 v148, v148
v_mfma_f32_16x16x32_bf16 v[170:173], a[248:251], v[182:185], v[170:173]
v_exp_f32 v149, v149
v_mfma_f32_16x16x32_bf16 v[220:223], v[240:243], v[182:185], v[220:223]
s_waitcnt lgkmcnt(0)
ds_read_b128 v[182:185], v210 offset:36864
v_cvt_pk_bf16_f32 v178, v146, v147
v_mfma_f32_16x16x32_bf16 v[118:121], v[186:189], a[84:87], v[118:121]
v_exp_f32 v162, v162
v_mfma_f32_16x16x32_bf16 v[126:129], v[186:189], a[108:111], v[126:129]
v_exp_f32 v163, v163
v_mfma_f32_16x16x32_bf16 v[134:137], v[186:189], a[132:135], v[134:137]
v_exp_f32 v164, v164
v_mfma_f32_16x16x32_bf16 v[90:93], a[228:231], v[186:189], v[90:93]
v_exp_f32 v165, v165
v_mfma_f32_16x16x32_bf16 v[170:173], a[252:255], v[186:189], v[170:173]
v_cvt_pk_bf16_f32 v179, v148, v149
v_mfma_f32_16x16x32_bf16 v[220:223], v[244:247], v[186:189], v[220:223]
ds_read_b128 v[186:189], v210 offset:37888
s_waitcnt lgkmcnt(1)
v_mfma_f32_16x16x32_bf16 v[118:121], v[182:185], a[88:91], v[118:121]
v_mfma_f32_16x16x32_bf16 v[126:129], v[182:185], a[112:115], v[126:129]
v_mfma_f32_16x16x32_bf16 v[134:137], v[182:185], a[136:139], v[134:137]
v_mfma_f32_16x16x32_bf16 v[90:93], a[232:235], v[182:185], v[90:93]
v_mfma_f32_16x16x32_bf16 v[170:173], v[224:227], v[182:185], v[170:173]
v_mfma_f32_16x16x32_bf16 v[220:223], v[248:251], v[182:185], v[220:223]
s_waitcnt lgkmcnt(0)
v_mfma_f32_16x16x32_bf16 v[118:121], v[186:189], a[92:95], v[118:121]
v_mfma_f32_16x16x32_bf16 v[126:129], v[186:189], a[116:119], v[126:129]
v_mfma_f32_16x16x32_bf16 v[134:137], v[186:189], a[140:143], v[134:137]
v_cvt_pk_bf16_f32 v118, v118, v119
v_cvt_pk_bf16_f32 v119, v120, v121
v_mfma_f32_16x16x32_bf16 v[90:93], a[236:239], v[186:189], v[90:93]
ds_read_u16 v120, v214 offset:1024
v_cvt_pk_bf16_f32 v126, v126, v127
v_mfma_f32_16x16x32_bf16 v[170:173], v[228:231], v[186:189], v[170:173]
v_cvt_pk_bf16_f32 v127, v128, v129
v_cvt_pk_bf16_f32 v134, v134, v135
v_mfma_f32_16x16x32_bf16 v[220:223], v[252:255], v[186:189], v[220:223]
ds_read_u16 v128, v214 offset:1032
v_cvt_pk_bf16_f32 v90, v90, v91
v_mfma_f32_16x16x32_bf16 v[150:153], v[190:193], v[174:177], 0
v_cvt_pk_bf16_f32 v91, v92, v93
v_cvt_pk_bf16_f32 v92, v170, v171
v_mfma_f32_16x16x32_bf16 v[138:141], v[114:117], v[174:177], 0
v_cvt_pk_bf16_f32 v93, v172, v173
v_cvt_pk_bf16_f32 v135, v136, v137
v_mfma_f32_16x16x32_bf16 v[142:145], v[122:125], v[174:177], 0
ds_read_u16 v136, v214 offset:1040
v_mov_b32 v121, 0
v_mfma_f32_16x16x32_bf16 v[146:149], v[130:133], v[174:177], 0
v_cvt_pk_bf16_f32 v174, v154, v155
v_cvt_pk_bf16_f32 v175, v156, v157
v_mfma_f32_16x16x32_bf16 v[150:153], v[190:193], v[178:181], v[150:153]
s_waitcnt lgkmcnt(2)
v_cvt_pk_bf16_f32 v176, v158, v159
v_cvt_pk_bf16_f32 v177, v160, v161
v_mfma_f32_16x16x32_bf16 v[138:141], v[118:121], v[178:181], v[138:141]
v_mov_b32 v129, 0
v_mov_b32 v137, 0
v_mfma_f32_16x16x32_bf16 v[154:157], v[114:117], v[174:177], 0
v_rcp_f32 v151, v150
v_mfma_f32_16x16x32_bf16 v[158:161], v[122:125], v[174:177], 0
s_waitcnt lgkmcnt(1)
v_max3_u32 v218, v218, v150, v151
v_mul_f32_e64 v151, s3, v151
v_mfma_f32_16x16x32_bf16 v[142:145], v[126:129], v[178:181], v[142:145]
s_waitcnt lgkmcnt(0)
v_mul_f32 v138, v138, v151
v_mul_f32_e64 v139, v139, v151
v_mfma_f32_16x16x32_bf16 v[146:149], v[134:137], v[178:181], v[146:149]
v_cvt_pk_bf16_f32 v180, v166, 0
v_mul_f32_e64 v140, v140, v151
v_mfma_f32_16x16x32_bf16 v[166:169], v[190:193], v[174:177], 0
v_mul_f32_e64 v141, v141, v151
v_cvt_pk_bf16_f32 v138, v138, v139
v_mul_f32 v142, v142, v151
v_mul_f32 v143, v143, v151
v_mul_f32 v144, v144, v151
v_mul_f32 v145, v145, v151
v_cvt_pk_bf16_f32 v139, v140, v141
v_cvt_pk_bf16_f32 v140, v142, v143
v_cvt_pk_bf16_f32 v141, v144, v145
v_cvt_pk_bf16_f32 v178, v162, v163
v_cvt_pk_bf16_f32 v179, v164, v165
v_mfma_f32_16x16x32_bf16 v[162:165], v[130:133], v[174:177], 0
ds_write_b128 v211, v[138:141] offset:38912
v_mfma_f32_16x16x32_bf16 v[138:141], v[78:81], v[90:93], 0
v_mul_f32 v146, v146, v151
v_mul_f32 v147, v147, v151
v_mfma_f32_16x16x32_bf16 v[166:169], v[190:193], v[178:181], v[166:169]
v_mul_f32 v148, v148, v151
v_mul_f32 v149, v149, v151
v_mfma_f32_16x16x32_bf16 v[154:157], v[118:121], v[178:181], v[154:157]
v_cvt_pk_bf16_f32 v142, v146, v147
v_cvt_pk_bf16_f32 v143, v148, v149
v_mfma_f32_16x16x32_bf16 v[158:161], v[126:129], v[178:181], v[158:161]
ds_write_b64 v212, v[142:143] offset:38912
v_mfma_f32_16x16x32_bf16 v[142:145], v[96:99], v[90:93], 0
v_rcp_f32_e64 v167, v166
v_mfma_f32_16x16x32_bf16 v[162:165], v[134:137], v[178:181], v[162:165]
v_max3_u32 v218, v218, v166, v167
v_cvt_pk_bf16_f32 v94, v220, v221
v_mfma_f32_16x16x32_bf16 v[150:153], v[108:111], v[90:93], v[206:209]
v_cvt_pk_bf16_f32 v95, v222, v223
v_mul_f32_e64 v167, s3, v167
v_mfma_f32_16x16x32_bf16 v[146:149], v[102:105], v[90:93], 0
v_mul_f32 v154, v154, v167
v_mul_f32 v155, v155, v167
v_mul_f32_e64 v156, v156, v167
v_mfma_f32_16x16x16_bf16 v[138:141], v[82:83], v[94:95], v[138:141]
v_mul_f32_e64 v157, v157, v167
v_cvt_pk_bf16_f32 v154, v154, v155
v_mul_f32_e64 v158, v158, v167
v_mfma_f32_16x16x16_bf16 v[142:145], v[100:101], v[94:95], v[142:145]
v_mul_f32 v159, v159, v167
v_mul_f32 v160, v160, v167
v_mul_f32_e64 v161, v161, v167
v_mfma_f32_16x16x16_bf16 v[150:153], v[112:113], v[94:95], v[150:153]
v_cvt_pk_bf16_f32 v155, v156, v157
v_cvt_pk_bf16_f32 v156, v158, v159
v_cvt_pk_bf16_f32 v157, v160, v161
v_mfma_f32_16x16x16_bf16 v[146:149], v[106:107], v[94:95], v[146:149]
v_mul_f32 v162, v162, v167
v_mul_f32 v163, v163, v167
v_mul_f32 v164, v164, v167
v_mul_f32 v165, v165, v167
v_mfma_f32_16x16x16_bf16 v[166:169], v[76:77], v[112:113], v[206:209]
v_cvt_pk_bf16_f32 v158, v162, v163
v_cvt_pk_bf16_f32 v159, v164, v165
v_exp_f32 v138, v138
v_mfma_f32_16x16x16_bf16 v[162:165], v[76:77], v[106:107], 0
v_exp_f32 v139, v139
v_exp_f32 v140, v140
v_mfma_f32_16x16x32_bf16 v[166:169], v[72:75], v[108:111], v[166:169]
ds_write_b128 v211, v[154:157] offset:45056
v_mfma_f32_16x16x16_bf16 v[154:157], v[76:77], v[82:83], 0
v_exp_f32 v141, v141
v_exp_f32 v142, v142
v_mfma_f32_16x16x32_bf16 v[162:165], v[72:75], v[102:105], v[162:165]
v_exp_f32 v143, v143
v_mfma_f32_16x16x32_bf16 v[154:157], v[72:75], v[78:81], v[154:157]
ds_write_b64 v212, v[158:159] offset:45056
v_mfma_f32_16x16x16_bf16 v[158:161], v[76:77], v[100:101], 0
v_exp_f32 v144, v144
v_exp_f32 v145, v145
v_exp_f32_e64 v150, v150
v_mfma_f32_16x16x32_bf16 v[158:161], v[72:75], v[96:99], v[158:161]
v_cvt_pk_bf16_f32 v174, v138, v139
v_cvt_pk_bf16_f32 v175, v140, v141
v_cvt_pk_bf16_f32 v176, v142, v143
v_cvt_pk_bf16_f32 v177, v144, v145
v_cvt_pk_bf16_f32 v180, v150, 0
v_exp_f32_e64 v146, v146
v_mfma_f32_16x16x32_bf16 v[150:153], v[190:193], v[174:177], 0
v_exp_f32 v147, v147
v_mfma_f32_16x16x32_bf16 v[138:141], v[114:117], v[174:177], 0
s_waitcnt lgkmcnt(0)
v_exp_f32 v148, v148
v_mfma_f32_16x16x32_bf16 v[142:145], v[122:125], v[174:177], 0
s_barrier
ds_read_b128 v[170:173], v210 offset:38912
ds_read_b128 v[182:185], v210 offset:39936
ds_read_b128 v[186:189], v210 offset:40960
v_exp_f32_e64 v149, v149
v_cvt_pk_bf16_f32 v178, v146, v147
v_cvt_pk_bf16_f32 v179, v148, v149
v_mfma_f32_16x16x32_bf16 v[146:149], v[130:133], v[174:177], 0
v_mov_b32_dpp v154, v158 quad_perm:[0,1,2,3] row_mask:0x2 bank_mask:0xf
v_mfma_f32_16x16x32_bf16 v[150:153], v[190:193], v[178:181], v[150:153]
v_mov_b32_dpp v154, v162 quad_perm:[0,1,2,3] row_mask:0x4 bank_mask:0xf
v_mfma_f32_16x16x32_bf16 v[138:141], v[118:121], v[178:181], v[138:141]
v_mov_b32_dpp v154, v167 quad_perm:[0,1,2,3] row_mask:0x8 bank_mask:0xf
v_exp_f32_e64 v154, v154
v_mfma_f32_16x16x32_bf16 v[142:145], v[126:129], v[178:181], v[142:145]
v_cvt_pk_bf16_f32 v154, v154, 0
v_rcp_f32 v151, v150
v_mfma_f32_16x16x32_bf16 v[146:149], v[134:137], v[178:181], v[146:149]
s_waitcnt lgkmcnt(2)
ds_write_b16 v214, v154
v_mfma_f32_16x16x32_bf16 v[36:39], a[144:147], v[170:173], v[36:39]
ds_read_b128 v[84:87], v215
ds_read_b128 v[88:91], v215 offset:16
v_mfma_f32_16x16x32_bf16 v[40:43], a[168:171], v[170:173], v[40:43]
s_nop 0
ds_read_b128 v[174:177], v217
ds_read_b128 v[178:181], v217 offset:528
v_mfma_f32_16x16x32_bf16 v[44:47], a[192:195], v[170:173], v[44:47]
s_waitcnt lgkmcnt(6)
ds_read_b128 v[170:173], v210 offset:41984
v_add_u32 v215, 1552, v215
v_mfma_f32_16x16x32_bf16 v[36:39], a[148:151], v[182:185], v[36:39]
ds_read_b64 v[112:113], v215 offset:528
v_mfma_f32_16x16x32_bf16 v[40:43], a[172:175], v[182:185], v[40:43]
v_mfma_f32_16x16x32_bf16 v[44:47], a[196:199], v[182:185], v[44:47]
ds_read_b128 v[182:185], v210 offset:43008
s_waitcnt lgkmcnt(6)
v_mfma_f32_16x16x32_bf16 v[166:169], v[84:87], v[190:193], 0
s_waitcnt vmcnt(9)
s_mov_b64 exec, s[30:31]
ds_write_b32 v209, v216 offset:39424
s_mov_b64 exec, -1
v_mfma_f32_16x16x32_bf16 v[154:157], v[84:87], v[114:117], 0
v_mfma_f32_16x16x32_bf16 v[158:161], v[84:87], v[122:125], 0
v_mfma_f32_16x16x32_bf16 v[162:165], v[84:87], v[130:133], 0
s_waitcnt lgkmcnt(6)
v_mfma_f32_16x16x32_bf16 v[166:169], v[88:91], v[190:193], v[166:169]
v_mfma_f32_16x16x32_bf16 v[154:157], v[88:91], v[118:121], v[154:157]
v_mfma_f32_16x16x32_bf16 v[158:161], v[88:91], v[126:129], v[158:161]
v_rcp_f32 v167, v166
v_mfma_f32_16x16x32_bf16 v[162:165], v[88:91], v[134:137], v[162:165]
v_max3_u32 v218, v218, v166, v167
v_max3_u32 v218, v218, v150, v151
v_mfma_f32_16x16x32_bf16 v[36:39], a[152:155], v[186:189], v[36:39]
v_mul_f32 v151, s3, v151
v_mul_f32 v138, v138, v151
v_mfma_f32_16x16x32_bf16 v[40:43], a[176:179], v[186:189], v[40:43]
v_mul_f32_e64 v139, v139, v151
v_mul_f32 v140, v140, v151
v_mfma_f32_16x16x32_bf16 v[44:47], a[200:203], v[186:189], v[44:47]
s_waitcnt lgkmcnt(3)
ds_read_b128 v[186:189], v210 offset:44032
v_mul_f32_e64 v141, v141, v151
v_mfma_f32_16x16x32_bf16 v[36:39], a[156:159], v[170:173], v[36:39]
v_cvt_pk_bf16_f32 v138, v138, v139
v_mul_f32_e64 v142, v142, v151
v_mfma_f32_16x16x32_bf16 v[40:43], a[180:183], v[170:173], v[40:43]
v_mul_f32_e64 v143, v143, v151
v_mul_f32 v144, v144, v151
v_mfma_f32_16x16x32_bf16 v[44:47], a[204:207], v[170:173], v[44:47]
s_waitcnt lgkmcnt(2)
ds_read_b128 v[170:173], v210 offset:45056
v_mul_f32_e64 v145, v145, v151
v_mfma_f32_16x16x32_bf16 v[36:39], a[160:163], v[182:185], v[36:39]
v_cvt_pk_bf16_f32 v139, v140, v141
v_cvt_pk_bf16_f32 v140, v142, v143
v_mfma_f32_16x16x32_bf16 v[40:43], a[184:187], v[182:185], v[40:43]
v_cvt_pk_bf16_f32 v141, v144, v145
v_mul_f32 v146, v146, v151
v_mfma_f32_16x16x32_bf16 v[44:47], a[208:211], v[182:185], v[44:47]
s_waitcnt lgkmcnt(1)
ds_read_b128 v[182:185], v210 offset:46080
ds_write_b128 v211, v[138:141] offset:51200
v_mfma_f32_16x16x32_bf16 v[36:39], a[164:167], v[186:189], v[36:39]
v_mul_f32 v147, v147, v151
v_mul_f32 v148, v148, v151
v_mfma_f32_16x16x32_bf16 v[40:43], a[188:191], v[186:189], v[40:43]
v_mul_f32 v149, v149, v151
v_cvt_pk_bf16_f32 v142, v146, v147
v_mfma_f32_16x16x32_bf16 v[44:47], a[212:215], v[186:189], v[44:47]
s_waitcnt lgkmcnt(2)
ds_read_b128 v[186:189], v210 offset:47104
v_cvt_pk_bf16_f32 v143, v148, v149
v_mfma_f32_16x16x32_bf16 v[48:51], a[144:147], v[170:173], v[48:51]
ds_write_b64 v212, v[142:143] offset:51200
v_mfma_f32_16x16x32_bf16 v[52:55], a[168:171], v[170:173], v[52:55]
s_nop 0
v_cvt_pk_bf16_f32 v72, v36, v37
v_cvt_pk_bf16_f32 v73, v38, v39
v_mfma_f32_16x16x32_bf16 v[56:59], a[192:195], v[170:173], v[56:59]
s_waitcnt lgkmcnt(3)
ds_read_b128 v[170:173], v210 offset:48128
buffer_store_dwordx2 v[72:73], v203, s[8:11], s39 offen
v_cvt_pk_bf16_f32 v74, v40, v41
v_mfma_f32_16x16x32_bf16 v[48:51], a[148:151], v[182:185], v[48:51]
v_cvt_pk_bf16_f32 v75, v42, v43
v_mov_b32_dpp v154, v158 quad_perm:[0,1,2,3] row_mask:0x2 bank_mask:0xf
v_mfma_f32_16x16x32_bf16 v[52:55], a[172:175], v[182:185], v[52:55]
v_mul_f32 v167, s3, v167
v_mov_b32_dpp v154, v162 quad_perm:[0,1,2,3] row_mask:0x4 bank_mask:0xf
v_mfma_f32_16x16x32_bf16 v[56:59], a[196:199], v[182:185], v[56:59]
s_waitcnt lgkmcnt(2)
ds_read_b128 v[182:185], v210 offset:49152
v_mul_f32_e64 v154, v154, v167
v_mfma_f32_16x16x32_bf16 v[48:51], a[152:155], v[186:189], v[48:51]
s_nop 0
v_cvt_pk_bf16_f32 v76, v44, v45
v_cvt_pk_bf16_f32 v77, v46, v47
v_mfma_f32_16x16x32_bf16 v[52:55], a[176:179], v[186:189], v[52:55]
s_waitcnt vmcnt(1) lgkmcnt(2)
v_cvt_pk_bf16_f32 v154, v154, 0
s_barrier
v_mfma_f32_16x16x32_bf16 v[56:59], a[200:203], v[186:189], v[56:59]
s_waitcnt lgkmcnt(1)
ds_read_b128 v[186:189], v210 offset:50176
ds_read_b128 v[84:87], v200
v_mfma_f32_16x16x32_bf16 v[48:51], a[156:159], v[170:173], v[48:51]
ds_read_b128 v[92:95], v201
ds_read_b128 v[100:103], v202
v_mfma_f32_16x16x32_bf16 v[52:55], a[180:183], v[170:173], v[52:55]
ds_read_b128 v[88:91], v194 offset:16
ds_read_b128 v[96:99], v195 offset:16
v_mfma_f32_16x16x32_bf16 v[56:59], a[204:207], v[170:173], v[56:59]
ds_read_b128 v[170:173], v210 offset:51200
s_waitcnt lgkmcnt(7)
v_mfma_f32_16x16x32_bf16 v[48:51], a[160:163], v[182:185], v[48:51]
ds_read_b128 v[104:107], v196 offset:16
v_mfma_f32_16x16x32_bf16 v[52:55], a[184:187], v[182:185], v[52:55]
buffer_store_dwordx2 v[74:75], v203, s[8:11], s39 offen offset:32
ds_write_b16 v214, v154
v_mfma_f32_16x16x32_bf16 v[56:59], a[208:211], v[182:185], v[56:59]
s_waitcnt lgkmcnt(8)
ds_read_b128 v[182:185], v210 offset:52224
v_add_u32 v214, 1552, v214
v_mfma_f32_16x16x32_bf16 v[48:51], a[164:167], v[186:189], v[48:51]
ds_read_b32 v216, v210 offset:57856
v_mfma_f32_16x16x32_bf16 v[52:55], a[188:191], v[186:189], v[52:55]
s_nop 0
v_mfma_f32_16x16x32_bf16 v[56:59], a[212:215], v[186:189], v[56:59]
s_waitcnt lgkmcnt(9)
ds_read_b128 v[186:189], v210 offset:53248
v_cvt_pk_bf16_f32 v78, v48, v49
v_mfma_f32_16x16x32_bf16 v[36:39], v[174:177], v[84:87], 0
s_waitcnt lgkmcnt(9)
ds_read_b128 v[84:87], v194
v_cvt_pk_bf16_f32 v79, v50, v51
v_mfma_f32_16x16x32_bf16 v[48:51], v[174:177], v[92:95], 0
s_waitcnt lgkmcnt(6)
ds_read_b128 v[92:95], v195
v_cvt_pk_bf16_f32 v80, v52, v53
v_mfma_f32_16x16x32_bf16 v[60:63], a[144:147], v[170:173], v[60:63]
v_cvt_pk_bf16_f32 v81, v54, v55
v_cvt_pk_bf16_f32 v82, v56, v57
v_mfma_f32_16x16x32_bf16 v[64:67], a[168:171], v[170:173], v[64:67]
v_cvt_pk_bf16_f32 v83, v58, v59
v_mfma_f32_16x16x32_bf16 v[68:71], a[192:195], v[170:173], v[68:71]
s_nop 0
ds_read_b128 v[170:173], v210 offset:54272
s_waitcnt lgkmcnt(5)
v_mfma_f32_16x16x32_bf16 v[60:63], a[148:151], v[182:185], v[60:63]
s_waitcnt lgkmcnt(4)
v_readfirstlane_b32 s97, v216
v_mfma_f32_16x16x32_bf16 v[64:67], a[172:175], v[182:185], v[64:67]
s_and_b32 s97, s97, 255
s_add_u32 s97, s97, 5120
v_mfma_f32_16x16x32_bf16 v[68:71], a[196:199], v[182:185], v[68:71]
ds_read_b128 v[182:185], v210 offset:55296
s_waitcnt lgkmcnt(4)
v_mfma_f32_16x16x32_bf16 v[60:63], a[152:155], v[186:189], v[60:63]
v_mfma_f32_16x16x32_bf16 v[64:67], a[176:179], v[186:189], v[64:67]
v_mfma_f32_16x16x32_bf16 v[68:71], a[200:203], v[186:189], v[68:71]
ds_read_b128 v[186:189], v210 offset:56320
s_waitcnt lgkmcnt(2)
v_mfma_f32_16x16x32_bf16 v[60:63], a[156:159], v[170:173], v[60:63]
buffer_store_dwordx2 v[76:77], v203, s[8:11], s39 offen offset:64
v_mfma_f32_16x16x32_bf16 v[64:67], a[180:183], v[170:173], v[64:67]
v_mfma_f32_16x16x32_bf16 v[68:71], a[204:207], v[170:173], v[68:71]
s_waitcnt lgkmcnt(1)
v_mfma_f32_16x16x32_bf16 v[60:63], a[160:163], v[182:185], v[60:63]
v_mfma_f32_16x16x32_bf16 v[64:67], a[184:187], v[182:185], v[64:67]
v_mfma_f32_16x16x32_bf16 v[68:71], a[208:211], v[182:185], v[68:71]
ds_read_b128 v[182:185], v210
s_waitcnt lgkmcnt(1)
v_mfma_f32_16x16x32_bf16 v[60:63], a[164:167], v[186:189], v[60:63]
v_smfmac_f32_16x16x64_bf16 v[36:39], v[178:181], v[84:91], v213
ds_read_b128 v[84:87], v197
ds_read_b128 v[88:91], v197 offset:16
v_mfma_f32_16x16x32_bf16 v[64:67], a[188:191], v[186:189], v[64:67]
v_cvt_pk_bf16_f32 v116, v60, v61
v_cvt_pk_bf16_f32 v117, v62, v63
v_mfma_f32_16x16x32_bf16 v[60:63], v[174:177], v[100:103], 0
ds_read_b128 v[100:103], v196
ds_read_b128 v[174:177], v217 offset:1056
v_mfma_f32_16x16x32_bf16 v[68:71], a[212:215], v[186:189], v[68:71]
s_nop 0
ds_read_b128 v[186:189], v210 offset:1024
v_cvt_pk_bf16_f32 v124, v64, v65
v_smfmac_f32_16x16x64_bf16 v[48:51], v[178:181], v[92:99], v213
s_waitcnt lgkmcnt(5)
ds_read_b128 v[92:95], v198
ds_read_b128 v[96:99], v198 offset:16
v_mfma_f32_16x16x32_bf16 v[138:141], a[0:3], v[182:185], 0
v_cvt_pk_bf16_f32 v125, v66, v67
v_cvt_pk_bf16_f32 v132, v68, v69
v_mfma_f32_16x16x32_bf16 v[142:145], a[24:27], v[182:185], 0
s_nop 0
v_cvt_pk_bf16_f32 v133, v70, v71
v_mfma_f32_16x16x32_bf16 v[146:149], a[48:51], v[182:185], 0
s_waitcnt lgkmcnt(4)
v_smfmac_f32_16x16x64_bf16 v[60:63], v[178:181], v[100:107], v213
ds_read_b128 v[100:103], v199
ds_read_b128 v[104:107], v199 offset:16
v_mfma_f32_16x16x32_bf16 v[150:153], a[216:219], v[182:185], 0
ds_read_b128 v[178:181], v217 offset:1584
buffer_store_dwordx2 v[78:79], v204, s[8:11], s39 offen
s_waitcnt lgkmcnt(6)
v_smfmac_f32_16x16x64_bf16 v[36:39], v[174:177], v[84:91], v213
ds_read_b128 v[84:87], v200 offset:32
ds_read_b128 v[88:91], v194 offset:48
v_mfma_f32_16x16x32_bf16 v[154:157], a[240:243], v[182:185], 0
s_waitcnt lgkmcnt(5)
v_smfmac_f32_16x16x64_bf16 v[48:51], v[174:177], v[92:99], v213
ds_read_b128 v[92:95], v201 offset:32
ds_read_b128 v[96:99], v195 offset:48
v_mfma_f32_16x16x32_bf16 v[158:161], v[232:235], v[182:185], 0
v_mul_f32 v119, v36, v36
v_add_f32 v118, v36, v37
v_mfma_f32_16x16x32_bf16 v[162:165], v[182:185], a[72:75], 0
s_waitcnt lgkmcnt(5)
v_mul_f32 v127, v48, v48
v_add_f32_e64 v126, v48, v49
v_smfmac_f32_16x16x64_bf16 v[60:63], v[174:177], v[100:107], v213
ds_read_b128 v[100:103], v202 offset:32
ds_read_b128 v[174:177], v217 offset:2112
v_mfma_f32_16x16x32_bf16 v[166:169], v[182:185], a[96:99], 0
s_waitcnt lgkmcnt(5)
ds_read_b128 v[104:107], v196 offset:48
v_fmac_f32 v119, v37, v37
v_mfma_f32_16x16x32_bf16 v[40:43], v[178:181], v[84:87], 0
ds_read_b128 v[84:87], v194 offset:32
v_mul_f32 v135, v60, v60
v_mfma_f32_16x16x32_bf16 v[170:173], v[182:185], a[120:123], 0
s_waitcnt lgkmcnt(5)
ds_read_b128 v[182:185], v210 offset:2048
v_add_f32_e64 v134, v60, v61
v_mfma_f32_16x16x32_bf16 v[52:55], v[178:181], v[92:95], 0
ds_read_b128 v[92:95], v195 offset:32
v_fmac_f32_e64 v135, v61, v61
v_mfma_f32_16x16x32_bf16 v[138:141], a[4:7], v[186:189], v[138:141]
v_fmac_f32 v127, v49, v49
v_add_f32 v134, v134, v62
v_mfma_f32_16x16x32_bf16 v[142:145], a[28:31], v[186:189], v[142:145]
s_waitcnt lgkmcnt(5)
v_fmac_f32 v135, v62, v62
v_add_f32_e64 v118, v118, v38
v_mfma_f32_16x16x32_bf16 v[64:67], v[178:181], v[100:103], 0
ds_read_b128 v[100:103], v196 offset:32
ds_read_b128 v[178:181], v217 offset:2640
v_mfma_f32_16x16x32_bf16 v[146:149], a[52:55], v[186:189], v[146:149]
v_add_f32_e64 v126, v126, v50
v_fmac_f32 v119, v38, v38
v_mfma_f32_16x16x32_bf16 v[150:153], a[220:223], v[186:189], v[150:153]
s_waitcnt lgkmcnt(4)
buffer_store_dwordx2 v[80:81], v204, s[8:11], s39 offen offset:32
v_fmac_f32 v127, v50, v50
v_smfmac_f32_16x16x64_bf16 v[40:43], v[174:177], v[84:91], v213
s_waitcnt lgkmcnt(2)
ds_read_b128 v[84:87], v197 offset:32
ds_read_b128 v[88:91], v197 offset:48
v_smfmac_f32_16x16x64_bf16 v[52:55], v[174:177], v[92:99], v213
ds_read_b128 v[92:95], v198 offset:32
ds_read_b128 v[96:99], v198 offset:48
v_mfma_f32_16x16x32_bf16 v[154:157], a[244:247], v[186:189], v[154:157]
s_waitcnt lgkmcnt(5)
v_add_f32 v134, v134, v63
v_fmac_f32_e64 v135, v63, v63
v_smfmac_f32_16x16x64_bf16 v[64:67], v[174:177], v[100:107], v213
ds_read_b128 v[100:103], v199 offset:32
ds_read_b128 v[104:107], v199 offset:48
v_mfma_f32_16x16x32_bf16 v[158:161], v[236:239], v[186:189], v[158:161]
ds_read_b128 v[174:177], v217 offset:3168
v_add_f32_e64 v118, v118, v39
v_mfma_f32_16x16x32_bf16 v[162:165], v[186:189], a[76:79], v[162:165]
v_add_f32 v126, v126, v51
v_fmac_f32 v119, v39, v39
v_mfma_f32_16x16x32_bf16 v[166:169], v[186:189], a[100:103], v[166:169]
v_fmac_f32 v127, v51, v51
s_waitcnt lgkmcnt(5)
v_smfmac_f32_16x16x64_bf16 v[40:43], v[178:181], v[84:91], v213
ds_read_b128 v[84:87], v200 offset:64
ds_read_b128 v[88:91], v194 offset:80
v_mfma_f32_16x16x32_bf16 v[170:173], v[186:189], a[124:127], v[170:173]
s_nop 0
ds_read_b128 v[186:189], v210 offset:3072
s_waitcnt lgkmcnt(6)
v_smfmac_f32_16x16x64_bf16 v[52:55], v[178:181], v[92:99], v213
ds_read_b128 v[92:95], v201 offset:64
ds_read_b128 v[96:99], v195 offset:80
v_mfma_f32_16x16x32_bf16 v[138:141], a[8:11], v[182:185], v[138:141]
v_add_f32 v118, v118, v40
v_fmac_f32 v119, v40, v40
v_mfma_f32_16x16x32_bf16 v[142:145], a[32:35], v[182:185], v[142:145]
s_waitcnt lgkmcnt(6)
v_add_f32 v126, v126, v52
v_fmac_f32_e64 v127, v52, v52
v_smfmac_f32_16x16x64_bf16 v[64:67], v[178:181], v[100:107], v213
ds_read_b128 v[100:103], v202 offset:64
ds_read_b128 v[178:181], v217 offset:3696
v_mfma_f32_16x16x32_bf16 v[146:149], a[56:59], v[182:185], v[146:149]
s_waitcnt lgkmcnt(6)
ds_read_b128 v[104:107], v196 offset:80
v_add_f32 v118, v118, v41
v_mfma_f32_16x16x32_bf16 v[44:47], v[174:177], v[84:87], 0
ds_read_b128 v[84:87], v194 offset:64
v_add_f32_e64 v134, v134, v64
v_mfma_f32_16x16x32_bf16 v[150:153], a[224:227], v[182:185], v[150:153]
buffer_store_dwordx2 v[82:83], v204, s[8:11], s39 offen offset:64
v_fmac_f32 v135, v64, v64
v_mfma_f32_16x16x32_bf16 v[154:157], a[248:251], v[182:185], v[154:157]
s_waitcnt lgkmcnt(5)
v_add_f32 v134, v134, v65
v_fmac_f32 v135, v65, v65
v_mfma_f32_16x16x32_bf16 v[56:59], v[174:177], v[92:95], 0
s_waitcnt lgkmcnt(3)
ds_read_b128 v[92:95], v195 offset:64
v_fmac_f32 v119, v41, v41
v_mfma_f32_16x16x32_bf16 v[68:71], v[174:177], v[100:103], 0
ds_read_b128 v[100:103], v196 offset:64
ds_read_b128 v[174:177], v217 offset:4224
v_mfma_f32_16x16x32_bf16 v[158:161], v[240:243], v[182:185], v[158:161]
v_add_f32 v126, v126, v53
v_fmac_f32 v127, v53, v53
v_mfma_f32_16x16x32_bf16 v[162:165], v[182:185], a[80:83], v[162:165]
s_waitcnt lgkmcnt(3)
v_add_f32 v134, v134, v66
v_fmac_f32_e64 v135, v66, v66
v_smfmac_f32_16x16x64_bf16 v[44:47], v[178:181], v[84:91], v213
ds_read_b128 v[84:87], v197 offset:64
ds_read_b128 v[88:91], v197 offset:80
v_mfma_f32_16x16x32_bf16 v[166:169], v[182:185], a[104:107], v[166:169]
v_add_f32_e64 v118, v118, v42
v_fmac_f32 v119, v42, v42
v_mfma_f32_16x16x32_bf16 v[170:173], v[182:185], a[128:131], v[170:173]
s_waitcnt lgkmcnt(4)
ds_read_b128 v[182:185], v210 offset:4096
v_add_f32_e64 v126, v126, v54
v_smfmac_f32_16x16x64_bf16 v[56:59], v[178:181], v[92:99], v213
ds_read_b128 v[92:95], v198 offset:64
ds_read_b128 v[96:99], v198 offset:80
v_mfma_f32_16x16x32_bf16 v[138:141], a[12:15], v[186:189], v[138:141]
s_waitcnt lgkmcnt(6)
v_fmac_f32 v127, v54, v54
v_add_f32_e64 v134, v134, v67
v_smfmac_f32_16x16x64_bf16 v[68:71], v[178:181], v[100:107], v213
ds_read_b128 v[100:103], v199 offset:64
ds_read_b128 v[104:107], v199 offset:80
v_mfma_f32_16x16x32_bf16 v[142:145], a[36:39], v[186:189], v[142:145]
v_fmac_f32 v135, v67, v67
v_add_f32 v118, v118, v43
v_mfma_f32_16x16x32_bf16 v[146:149], a[60:63], v[186:189], v[146:149]
v_fmac_f32 v119, v43, v43
v_add_f32 v126, v126, v55
v_mfma_f32_16x16x32_bf16 v[150:153], a[228:231], v[186:189], v[150:153]
v_fmac_f32 v127, v55, v55
v_mov_b32 v181, 0
v_mfma_f32_16x16x32_bf16 v[154:157], a[252:255], v[186:189], v[154:157]
buffer_store_dwordx2 v[116:117], v205, s[8:11], s39 offen
s_waitcnt lgkmcnt(5)
v_smfmac_f32_16x16x64_bf16 v[44:47], v[174:177], v[84:91], v213
v_mfma_f32_16x16x32_bf16 v[158:161], v[244:247], v[186:189], v[158:161]
v_mfma_f32_16x16x32_bf16 v[162:165], v[186:189], a[84:87], v[162:165]
s_waitcnt lgkmcnt(2)
v_add_f32 v118, v118, v44
v_fmac_f32 v119, v44, v44
v_smfmac_f32_16x16x64_bf16 v[56:59], v[174:177], v[92:99], v213
v_add_f32 v118, v118, v45
v_mfma_f32_16x16x32_bf16 v[166:169], v[186:189], a[108:111], v[166:169]
v_fmac_f32 v119, v45, v45
v_add_f32 v118, v118, v46
v_mfma_f32_16x16x32_bf16 v[170:173], v[186:189], a[132:135], v[170:173]
s_waitcnt lgkmcnt(0)
ds_read_b128 v[186:189], v210 offset:5120
v_add_f32_e64 v126, v126, v56
v_smfmac_f32_16x16x64_bf16 v[68:71], v[174:177], v[100:107], v213
v_fmac_f32_e64 v127, v56, v56
v_mfma_f32_16x16x32_bf16 v[138:141], a[16:19], v[182:185], v[138:141]
v_add_f32 v126, v126, v57
v_fmac_f32 v127, v57, v57
v_mfma_f32_16x16x32_bf16 v[142:145], a[40:43], v[182:185], v[142:145]
v_add_f32 v134, v134, v68
v_fmac_f32 v135, v68, v68
v_mfma_f32_16x16x32_bf16 v[146:149], a[64:67], v[182:185], v[146:149]
v_add_f32 v134, v134, v69
v_fmac_f32 v135, v69, v69
v_mfma_f32_16x16x32_bf16 v[150:153], a[232:235], v[182:185], v[150:153]
v_add_f32 v134, v134, v70
v_fmac_f32 v135, v70, v70
v_mfma_f32_16x16x32_bf16 v[154:157], v[224:227], v[182:185], v[154:157]
v_fmac_f32 v119, v46, v46
v_add_f32 v126, v126, v58
v_mfma_f32_16x16x32_bf16 v[158:161], v[248:251], v[182:185], v[158:161]
v_fmac_f32 v127, v58, v58
v_add_f32 v134, v134, v71
v_mfma_f32_16x16x32_bf16 v[162:165], v[182:185], a[88:91], v[162:165]
v_fmac_f32 v135, v71, v71
v_add_f32 v118, v118, v47
v_mfma_f32_16x16x32_bf16 v[166:169], v[182:185], a[112:115], v[166:169]
v_fmac_f32_e64 v119, v47, v47
v_add_f32 v126, v126, v59
v_mfma_f32_16x16x32_bf16 v[170:173], v[182:185], a[136:139], v[170:173]
s_waitcnt lgkmcnt(0)
ds_read_b128 v[182:185], v210 offset:6144
buffer_store_dwordx2 v[124:125], v205, s[8:11], s39 offen offset:32
v_fmac_f32_e64 v127, v59, v59
v_mfma_f32_16x16x32_bf16 v[138:141], a[20:23], v[186:189], v[138:141]
v_permlane16_swap_b32 v134, v135
v_mfma_f32_16x16x32_bf16 v[142:145], a[44:47], v[186:189], v[142:145]
v_permlane16_swap_b32 v118, v119
v_mfma_f32_16x16x32_bf16 v[146:149], a[68:71], v[186:189], v[146:149]
v_cvt_pk_bf16_f32 v78, v138, v139
v_cvt_pk_bf16_f32 v79, v140, v141
v_mfma_f32_16x16x32_bf16 v[150:153], a[236:239], v[186:189], v[150:153]
v_cvt_pk_bf16_f32 v80, v142, v143
v_cvt_pk_bf16_f32 v81, v144, v145
v_mfma_f32_16x16x32_bf16 v[154:157], v[228:231], v[186:189], v[154:157]
v_cvt_pk_bf16_f32 v82, v146, v147
v_cvt_pk_bf16_f32 v83, v148, v149
v_mfma_f32_16x16x32_bf16 v[158:161], v[252:255], v[186:189], v[158:161]
v_cvt_pk_bf16_f32 v72, v150, v151
v_cvt_pk_bf16_f32 v73, v152, v153
v_mfma_f32_16x16x32_bf16 v[162:165], v[186:189], a[92:95], v[162:165]
v_cvt_pk_bf16_f32 v74, v154, v155
v_cvt_pk_bf16_f32 v75, v156, v157
v_mfma_f32_16x16x32_bf16 v[166:169], v[186:189], a[116:119], v[166:169]
s_nop 0
v_cvt_pk_bf16_f32 v76, v158, v159
v_cvt_pk_bf16_f32 v77, v160, v161
v_mfma_f32_16x16x32_bf16 v[170:173], v[186:189], a[140:143], v[170:173]
s_waitcnt lgkmcnt(0)
ds_read_b128 v[186:189], v210 offset:7168
v_cvt_pk_bf16_f32 v114, v162, v163
v_mfma_f32_16x16x32_bf16 v[138:141], a[0:3], v[182:185], 0
v_cvt_pk_bf16_f32 v115, v164, v165
v_cvt_pk_bf16_f32 v122, v166, v167
v_mfma_f32_16x16x32_bf16 v[142:145], a[24:27], v[182:185], 0
v_cvt_pk_bf16_f32 v123, v168, v169
v_cvt_pk_bf16_f32 v130, v170, v171
v_mfma_f32_16x16x32_bf16 v[146:149], a[48:51], v[182:185], 0
v_cvt_pk_bf16_f32 v131, v172, v173
v_add_f32_e64 v134, v134, v135
v_mfma_f32_16x16x32_bf16 v[150:153], a[216:219], v[182:185], 0
v_permlane16_swap_b32 v126, v127
v_mfma_f32_16x16x32_bf16 v[154:157], a[240:243], v[182:185], 0
v_add_f32 v118, v118, v119
v_mov_b32_e64 v135, v134
v_mfma_f32_16x16x32_bf16 v[158:161], v[232:235], v[182:185], 0
v_add_f32 v126, v126, v127
v_permlane32_swap_b32 v134, v135
v_mfma_f32_16x16x32_bf16 v[162:165], v[182:185], a[72:75], 0
buffer_store_dwordx2 v[132:133], v205, s[8:11], s39 offen offset:64
v_permlane32_swap_b32 v118, v126
v_mfma_f32_16x16x32_bf16 v[166:169], v[182:185], a[96:99], 0
v_add_f32 v134, v134, v135
v_add_f32 v118, v118, v126
v_mfma_f32_16x16x32_bf16 v[170:173], v[182:185], a[120:123], 0
s_waitcnt lgkmcnt(0)
ds_write_b32 v209, v134 offset:512
v_mfma_f32_16x16x32_bf16 v[138:141], a[4:7], v[186:189], v[138:141]
ds_write_b32 v209, v118
v_mfma_f32_16x16x32_bf16 v[142:145], a[28:31], v[186:189], v[142:145]
ds_read_b128 v[182:185], v210 offset:8192
v_mfma_f32_16x16x32_bf16 v[146:149], a[52:55], v[186:189], v[146:149]
v_mfma_f32_16x16x32_bf16 v[150:153], a[220:223], v[186:189], v[150:153]
v_mfma_f32_16x16x32_bf16 v[154:157], a[244:247], v[186:189], v[154:157]
v_mfma_f32_16x16x32_bf16 v[158:161], v[236:239], v[186:189], v[158:161]
s_waitcnt lgkmcnt(1)
s_barrier
v_mfma_f32_16x16x32_bf16 v[162:165], v[186:189], a[76:79], v[162:165]
ds_read_b128 v[102:105], v210 offset:18432
ds_read_b128 v[106:109], v210 offset:19456
v_mfma_f32_16x16x32_bf16 v[166:169], v[186:189], a[100:103], v[166:169]
v_mfma_f32_16x16x32_bf16 v[170:173], v[186:189], a[124:127], v[170:173]
s_cmp_lt_u32 s97, s34
s_cbranch_scc0 L_tailb
s_waitcnt lgkmcnt(2)
v_mfma_f32_16x16x32_bf16 v[138:141], a[8:11], v[182:185], v[138:141]
s_mov_b32 s35, s97
ds_read_b128 v[186:189], v210 offset:9216
s_waitcnt lgkmcnt(2)
v_add_f32 v102, v102, v103
v_mfma_f32_16x16x32_bf16 v[142:145], a[32:35], v[182:185], v[142:145]
s_mul_hi_u32 s41, s35, 58835169
s_waitcnt lgkmcnt(1)
v_add_f32 v106, v106, v107
v_add_f32_e64 v104, v104, v105
v_mfma_f32_16x16x32_bf16 v[146:149], a[56:59], v[182:185], v[146:149]
s_mul_i32 s42, s41, 73
v_add_f32 v108, v108, v109
v_add_f32 v102, v102, v104
v_mfma_f32_16x16x32_bf16 v[150:153], a[224:227], v[182:185], v[150:153]
s_sub_u32 s42, s35, s42
v_add_f32 v106, v106, v108
v_mul_f32_e64 v103, s48, v102
v_mfma_f32_16x16x32_bf16 v[154:157], a[248:251], v[182:185], v[154:157]
s_mul_i32 s43, s41, 1373568
ds_read_b128 v[108:111], v215 offset:512
v_mul_f32_e64 v104, s73, v102
v_mfma_f32_16x16x32_bf16 v[158:161], v[240:243], v[182:185], v[158:161]
s_mul_i32 s51, s42, 2688
v_mul_f32_e64 v106, s73, v106
v_fma_f32 v106, -v103, v104, v106
v_mfma_f32_16x16x32_bf16 v[162:165], v[182:185], a[80:83], v[162:165]
s_waitcnt lgkmcnt(1)
v_max_f32 v106, 0, v106
v_add_f32 v106, s49, v106
v_mfma_f32_16x16x32_bf16 v[166:169], v[182:185], a[104:107], v[166:169]
s_add_u32 s43, s43, s51
v_rsq_f32 v102, v106
v_mfma_f32_16x16x32_bf16 v[170:173], v[182:185], a[128:131], v[170:173]
s_cmp_lt_u32 s35, s34
ds_read_b128 v[182:185], v210 offset:10240
v_mul_f32_e64 v103, -v103, v102
v_mfma_f32_16x16x32_bf16 v[138:141], a[12:15], v[186:189], v[138:141]
s_cselect_b32 s50, s43, 1879048192
ds_write_b64 v211, v[102:103] offset:20480
v_mfma_f32_16x16x32_bf16 v[142:145], a[36:39], v[186:189], v[142:145]
s_add_u32 s35, s35, 32
s_cmp_eq_u32 s42, 0
s_cselect_b32 s44, 536870911, s72
v_mfma_f32_16x16x32_bf16 v[146:149], a[60:63], v[186:189], v[146:149]
s_cmp_eq_u32 s42, 72
ds_read_b64 v[118:119], v219 offset:20480
ds_read_b64 v[126:127], v219 offset:20736
v_mfma_f32_16x16x32_bf16 v[150:153], a[228:231], v[186:189], v[150:153]
s_cselect_b32 s44, 939524095, s44
ds_read_b64 v[134:135], v219 offset:20992
v_and_b32_e64 v180, s44, v208
v_mfma_f32_16x16x32_bf16 v[154:157], a[252:255], v[186:189], v[154:157]
s_cmp_eq_u32 s41, 0
s_cselect_b32 s52, 1879048192, s50
s_add_u32 m0, s45, 0
v_mfma_f32_16x16x32_bf16 v[158:161], v[244:247], v[186:189], v[158:161]
s_nop 0
buffer_load_dwordx4 v180, s[4:7], s52 offen nt lds
v_mfma_f32_16x16x32_bf16 v[162:165], v[186:189], a[84:87], v[162:165]
s_mov_b32 s36, s50
s_add_u32 m0, s45, 4112
s_add_u32 s40, s36, 196224
v_mfma_f32_16x16x32_bf16 v[166:169], v[186:189], a[108:111], v[166:169]
s_waitcnt lgkmcnt(2)
v_fma_f32 v220, v36, v118, v119
v_fma_f32 v221, v37, v118, v119
v_mfma_f32_16x16x32_bf16 v[170:173], v[186:189], a[132:135], v[170:173]
s_mov_b32 s39, s37
ds_read_b128 v[186:189], v210 offset:11264
v_fma_f32 v222, v38, v118, v119
v_mfma_f32_16x16x32_bf16 v[138:141], a[16:19], v[182:185], v[138:141]
s_mul_i32 s41, s32, 192
v_fma_f32 v223, v39, v118, v119
v_cvt_pk_bf16_f32 v90, v220, v221
v_mfma_f32_16x16x32_bf16 v[142:145], a[40:43], v[182:185], v[142:145]
s_mov_b32 s30, 65537
v_cvt_pk_bf16_f32 v91, v222, v223
v_fma_f32 v220, v40, v118, v119
v_mfma_f32_16x16x32_bf16 v[146:149], a[64:67], v[182:185], v[146:149]
s_mov_b32 s31, 65537
buffer_load_dwordx4 v180, s[4:7], s40 offen nt lds
v_mfma_f32_16x16x32_bf16 v[150:153], a[232:235], v[182:185], v[150:153]
s_add_u32 m0, s45, 8224
v_fma_f32 v221, v41, v118, v119
v_fma_f32 v222, v42, v118, v119
v_mfma_f32_16x16x32_bf16 v[154:157], v[224:227], v[182:185], v[154:157]
s_add_u32 s40, s36, 392448
v_fma_f32 v223, v43, v118, v119
v_cvt_pk_bf16_f32 v92, v220, v221
v_mfma_f32_16x16x32_bf16 v[158:161], v[248:251], v[182:185], v[158:161]
v_cvt_pk_bf16_f32 v93, v222, v223
v_fma_f32 v220, v44, v118, v119
v_mfma_f32_16x16x32_bf16 v[162:165], v[182:185], a[88:91], v[162:165]
s_mov_b32 s42, 58835169
ds_write_b128 v211, v[90:93] offset:20480
v_mfma_f32_16x16x32_bf16 v[166:169], v[182:185], a[112:115], v[166:169]
s_nop 0
v_fma_f32 v221, v45, v118, v119
v_fma_f32 v222, v46, v118, v119
v_mfma_f32_16x16x32_bf16 v[170:173], v[182:185], a[136:139], v[170:173]
s_waitcnt lgkmcnt(1)
v_fma_f32 v223, v47, v118, v119
v_cvt_pk_bf16_f32 v94, v220, v221
v_mfma_f32_16x16x32_bf16 v[138:141], a[20:23], v[186:189], v[138:141]
ds_read_b128 v[182:185], v210 offset:12288
v_cvt_pk_bf16_f32 v95, v222, v223
v_mfma_f32_16x16x32_bf16 v[142:145], a[44:47], v[186:189], v[142:145]
ds_write_b64 v212, v[94:95] offset:20480
v_mfma_f32_16x16x32_bf16 v[146:149], a[68:71], v[186:189], v[146:149]
buffer_load_dwordx4 v180, s[4:7], s40 offen nt lds
v_mfma_f32_16x16x32_bf16 v[150:153], a[236:239], v[186:189], v[150:153]
s_add_u32 m0, s45, 12336
v_cvt_pk_bf16_f32 v96, v138, v139
v_cvt_pk_bf16_f32 v97, v140, v141
v_mfma_f32_16x16x32_bf16 v[154:157], v[228:231], v[186:189], v[154:157]
s_add_u32 s40, s36, 588672
v_cvt_pk_bf16_f32 v98, v142, v143
v_cvt_pk_bf16_f32 v99, v144, v145
v_mfma_f32_16x16x32_bf16 v[158:161], v[252:255], v[186:189], v[158:161]
v_cvt_pk_bf16_f32 v100, v146, v147
v_cvt_pk_bf16_f32 v101, v148, v149
v_mfma_f32_16x16x32_bf16 v[162:165], v[186:189], a[92:95], v[162:165]
v_cvt_pk_bf16_f32 v86, v154, v155
v_cvt_pk_bf16_f32 v87, v156, v157
v_mfma_f32_16x16x32_bf16 v[166:169], v[186:189], a[116:119], v[166:169]
s_nop 0
v_cvt_pk_bf16_f32 v88, v158, v159
v_cvt_pk_bf16_f32 v89, v160, v161
v_mfma_f32_16x16x32_bf16 v[170:173], v[186:189], a[140:143], v[170:173]
s_waitcnt lgkmcnt(1)
ds_read_b128 v[186:189], v210 offset:13312
v_cvt_pk_bf16_f32 v84, v150, v151
v_mfma_f32_16x16x32_bf16 v[138:141], a[0:3], v[182:185], 0
v_cvt_pk_bf16_f32 v124, v166, v167
v_cvt_pk_bf16_f32 v125, v168, v169
v_mfma_f32_16x16x32_bf16 v[142:145], a[24:27], v[182:185], 0
v_cvt_pk_bf16_f32 v85, v152, v153
v_cvt_pk_bf16_f32 v116, v162, v163
v_mfma_f32_16x16x32_bf16 v[146:149], a[48:51], v[182:185], 0
ds_read_b128 v[182:185], v210 offset:14336
v_cvt_pk_bf16_f32 v117, v164, v165
v_fma_f32 v220, v48, v126, v127
v_mfma_f32_16x16x16_bf16 v[154:157], v[82:83], v[88:89], 0
v_fma_f32 v221, v49, v126, v127
v_fma_f32 v222, v50, v126, v127
v_fma_f32 v223, v51, v126, v127
v_mfma_f32_16x16x16_bf16 v[158:161], v[100:101], v[88:89], 0
v_cvt_pk_bf16_f32 v174, v220, v221
v_cvt_pk_bf16_f32 v175, v222, v223
v_fma_f32 v220, v52, v126, v127
v_fma_f32 v221, v53, v126, v127
s_waitcnt lgkmcnt(1)
v_mfma_f32_16x16x32_bf16 v[138:141], a[4:7], v[186:189], v[138:141]
buffer_load_dwordx4 v180, s[4:7], s40 offen nt lds
v_mfma_f32_16x16x32_bf16 v[142:145], a[28:31], v[186:189], v[142:145]
s_add_u32 m0, s45, 16448
v_fma_f32 v222, v54, v126, v127
v_fma_f32 v223, v55, v126, v127
v_mfma_f32_16x16x32_bf16 v[146:149], a[52:55], v[186:189], v[146:149]
s_waitcnt lgkmcnt(0)
ds_read_b128 v[186:189], v210 offset:15360
v_cvt_pk_bf16_f32 v176, v220, v221
v_mfma_f32_16x16x32_bf16 v[138:141], a[8:11], v[182:185], v[138:141]
s_add_u32 s40, s36, 784896
v_cvt_pk_bf16_f32 v177, v222, v223
v_fma_f32 v220, v56, v126, v127
v_mfma_f32_16x16x32_bf16 v[142:145], a[32:35], v[182:185], v[142:145]
ds_write_b128 v211, v[174:177] offset:26624
v_mfma_f32_16x16x32_bf16 v[146:149], a[56:59], v[182:185], v[146:149]
v_fma_f32 v221, v57, v126, v127
v_fma_f32 v222, v58, v126, v127
v_fma_f32 v223, v59, v126, v127
v_mfma_f32_16x16x16_bf16 v[166:169], v[112:113], v[88:89], v[206:209]
v_cvt_pk_bf16_f32 v178, v220, v221
v_cvt_pk_bf16_f32 v179, v222, v223
v_fma_f32 v220, v60, v134, v135
v_mfma_f32_16x16x16_bf16 v[150:153], v[112:113], v[76:77], v[206:209]
v_fma_f32 v221, v61, v134, v135
v_fma_f32 v222, v62, v134, v135
v_fma_f32 v223, v63, v134, v135
v_cvt_pk_bf16_f32 v90, v220, v221
s_waitcnt lgkmcnt(1)
v_mfma_f32_16x16x32_bf16 v[138:141], a[12:15], v[186:189], v[138:141]
s_nop 0
ds_read_b128 v[182:185], v210 offset:16384
buffer_load_dwordx4 v180, s[4:7], s40 offen nt lds
v_mfma_f32_16x16x32_bf16 v[142:145], a[36:39], v[186:189], v[142:145]
s_add_u32 m0, s45, 20560
ds_write_b64 v212, v[178:179] offset:26624
v_mfma_f32_16x16x32_bf16 v[146:149], a[60:63], v[186:189], v[146:149]
s_add_u32 s40, s36, 981120
v_cvt_pk_bf16_f32 v91, v222, v223
v_fma_f32 v220, v64, v134, v135
v_mfma_f32_16x16x32_bf16 v[154:157], v[78:81], v[84:87], v[154:157]
ds_read_b128 v[186:189], v210 offset:17408
v_fma_f32 v221, v65, v134, v135
v_mfma_f32_16x16x32_bf16 v[150:153], v[108:111], v[72:75], v[150:153]
s_nop 0
v_fma_f32 v222, v66, v134, v135
v_fma_f32 v223, v67, v134, v135
v_mfma_f32_16x16x32_bf16 v[158:161], v[96:99], v[84:87], v[158:161]
s_waitcnt lgkmcnt(2)
v_cvt_pk_bf16_f32 v92, v220, v221
v_cvt_pk_bf16_f32 v93, v222, v223
v_mfma_f32_16x16x32_bf16 v[138:141], a[16:19], v[182:185], v[138:141]
ds_write_b128 v211, v[90:93] offset:32768
v_mfma_f32_16x16x32_bf16 v[142:145], a[40:43], v[182:185], v[142:145]
s_nop 0
buffer_load_dwordx4 v180, s[4:7], s40 offen nt lds
v_mfma_f32_16x16x32_bf16 v[146:149], a[64:67], v[182:185], v[146:149]
s_waitcnt lgkmcnt(1)
v_fma_f32 v220, v68, v134, v135
v_fma_f32 v221, v69, v134, v135
v_mfma_f32_16x16x32_bf16 v[138:141], a[20:23], v[186:189], v[138:141]
s_add_u32 m0, s45, 24672
ds_read_b128 v[182:185], v210 offset:12288
v_fma_f32 v222, v70, v134, v135
v_mfma_f32_16x16x32_bf16 v[142:145], a[44:47], v[186:189], v[142:145]
s_add_u32 s40, s36, 1177344
v_fma_f32 v223, v71, v134, v135
v_cvt_pk_bf16_f32 v132, v170, v171
v_mfma_f32_16x16x32_bf16 v[146:149], a[68:71], v[186:189], v[146:149]
ds_read_b128 v[186:189], v210 offset:13312
v_cvt_pk_bf16_f32 v102, v138, v139
v_mfma_f32_16x16x32_bf16 v[166:169], v[108:111], v[84:87], v[166:169]
v_cvt_pk_bf16_f32 v103, v140, v141
v_cvt_pk_bf16_f32 v104, v142, v143
v_cvt_pk_bf16_f32 v105, v144, v145
v_mfma_f32_16x16x16_bf16 v[138:141], v[82:83], v[76:77], 0
v_cvt_pk_bf16_f32 v106, v146, v147
v_cvt_pk_bf16_f32 v107, v148, v149
v_cvt_pk_bf16_f32 v133, v172, v173
v_mfma_f32_16x16x16_bf16 v[142:145], v[100:101], v[76:77], 0
v_cvt_pk_bf16_f32 v94, v220, v221
v_cvt_pk_bf16_f32 v95, v222, v223
v_exp_f32 v150, v150
v_mfma_f32_16x16x16_bf16 v[162:165], v[106:107], v[88:89], 0
v_exp_f32 v154, v154
v_exp_f32 v155, v155
v_mfma_f32_16x16x16_bf16 v[146:149], v[106:107], v[76:77], 0
buffer_load_dwordx4 v180, s[4:7], s40 offen nt lds
ds_write_b64 v212, v[94:95] offset:32768
v_mfma_f32_16x16x32_bf16 v[138:141], v[78:81], v[72:75], v[138:141]
s_waitcnt lgkmcnt(2)
v_exp_f32_e64 v156, v156
v_mfma_f32_16x16x32_bf16 v[142:145], v[96:99], v[72:75], v[142:145]
s_add_u32 m0, s45, 28784
ds_read_b64 v[76:77], v215 offset:16
v_exp_f32 v157, v157
v_mfma_f32_16x16x32_bf16 v[118:121], v[182:185], a[72:75], 0
s_add_u32 s40, s36, 1373568
v_exp_f32 v138, v138
v_mfma_f32_16x16x32_bf16 v[126:129], v[182:185], a[96:99], 0
v_exp_f32 v139, v139
v_mfma_f32_16x16x32_bf16 v[134:137], v[182:185], a[120:123], 0
v_exp_f32 v140, v140
v_mfma_f32_16x16x32_bf16 v[146:149], v[102:105], v[72:75], v[146:149]
v_exp_f32 v141, v141
v_mfma_f32_16x16x32_bf16 v[90:93], a[216:219], v[182:185], 0
v_exp_f32 v142, v142
v_mfma_f32_16x16x32_bf16 v[170:173], a[240:243], v[182:185], 0
v_exp_f32 v143, v143
v_mfma_f32_16x16x32_bf16 v[220:223], v[232:235], v[182:185], 0
s_waitcnt lgkmcnt(2)
ds_read_b128 v[182:185], v210 offset:14336
buffer_load_dwordx4 v180, s[4:7], s40 offen nt lds
v_mfma_f32_16x16x32_bf16 v[118:121], v[186:189], a[76:79], v[118:121]
s_add_u32 m0, s45, 32896
v_exp_f32 v144, v144
v_mfma_f32_16x16x32_bf16 v[126:129], v[186:189], a[100:103], v[126:129]
s_add_u32 s40, s36, 1569792
v_exp_f32 v145, v145
v_mfma_f32_16x16x32_bf16 v[134:137], v[186:189], a[124:127], v[134:137]
s_add_u32 s41, s41, 127056
v_cvt_pk_bf16_f32 v174, v138, v139
v_cvt_pk_bf16_f32 v175, v140, v141
v_mfma_f32_16x16x32_bf16 v[90:93], a[220:223], v[186:189], v[90:93]
v_cvt_pk_bf16_f32 v176, v142, v143
v_cvt_pk_bf16_f32 v177, v144, v145
v_mfma_f32_16x16x32_bf16 v[170:173], a[244:247], v[186:189], v[170:173]
v_exp_f32 v158, v158
v_mfma_f32_16x16x32_bf16 v[220:223], v[236:239], v[186:189], v[220:223]
s_waitcnt lgkmcnt(0)
ds_read_b128 v[186:189], v210 offset:15360
ds_read_b128 v[72:75], v215
v_mfma_f32_16x16x32_bf16 v[118:121], v[182:185], a[80:83], v[118:121]
v_exp_f32 v159, v159
v_mfma_f32_16x16x32_bf16 v[126:129], v[182:185], a[104:107], v[126:129]
v_exp_f32 v160, v160
v_mfma_f32_16x16x32_bf16 v[134:137], v[182:185], a[128:131], v[134:137]
v_exp_f32 v161, v161
v_mfma_f32_16x16x32_bf16 v[90:93], a[224:227], v[182:185], v[90:93]
buffer_load_dwordx4 v180, s[4:7], s40 offen nt lds
v_mfma_f32_16x16x32_bf16 v[162:165], v[102:105], v[84:87], v[162:165]
v_cvt_pk_bf16_f32 v180, v150, 0
v_exp_f32 v166, v166
v_mfma_f32_16x16x32_bf16 v[170:173], a[248:251], v[182:185], v[170:173]
v_exp_f32 v146, v146
v_mfma_f32_16x16x32_bf16 v[220:223], v[240:243], v[182:185], v[220:223]
s_waitcnt lgkmcnt(1)
ds_read_b128 v[182:185], v210 offset:16384
v_exp_f32 v147, v147
v_mfma_f32_16x16x32_bf16 v[118:121], v[186:189], a[84:87], v[118:121]
v_exp_f32 v148, v148
v_mfma_f32_16x16x32_bf16 v[126:129], v[186:189], a[108:111], v[126:129]
v_exp_f32 v149, v149
v_mfma_f32_16x16x32_bf16 v[134:137], v[186:189], a[132:135], v[134:137]
v_exp_f32 v162, v162
v_mfma_f32_16x16x32_bf16 v[90:93], a[228:231], v[186:189], v[90:93]
v_exp_f32_e64 v163, v163
v_mfma_f32_16x16x32_bf16 v[170:173], a[252:255], v[186:189], v[170:173]
v_exp_f32 v164, v164
v_mfma_f32_16x16x32_bf16 v[220:223], v[244:247], v[186:189], v[220:223]
s_waitcnt lgkmcnt(0)
ds_read_b128 v[186:189], v210 offset:17408
v_cvt_pk_bf16_f32 v178, v146, v147
v_mfma_f32_16x16x32_bf16 v[118:121], v[182:185], a[88:91], v[118:121]
v_exp_f32 v165, v165
v_mfma_f32_16x16x32_bf16 v[126:129], v[182:185], a[112:115], v[126:129]
v_cvt_pk_bf16_f32 v179, v148, v149
v_mfma_f32_16x16x32_bf16 v[134:137], v[182:185], a[136:139], v[134:137]
v_mfma_f32_16x16x32_bf16 v[90:93], a[232:235], v[182:185], v[90:93]
v_mfma_f32_16x16x32_bf16 v[170:173], v[224:227], v[182:185], v[170:173]
v_mfma_f32_16x16x32_bf16 v[220:223], v[248:251], v[182:185], v[220:223]
s_waitcnt lgkmcnt(0)
v_mfma_f32_16x16x32_bf16 v[118:121], v[186:189], a[92:95], v[118:121]
v_mfma_f32_16x16x32_bf16 v[126:129], v[186:189], a[116:119], v[126:129]
v_mfma_f32_16x16x32_bf16 v[134:137], v[186:189], a[140:143], v[134:137]
v_cvt_pk_bf16_f32 v118, v118, v119
v_cvt_pk_bf16_f32 v119, v120, v121
v_mfma_f32_16x16x32_bf16 v[90:93], a[236:239], v[186:189], v[90:93]
ds_read_u16 v120, v214 offset:1024
v_cvt_pk_bf16_f32 v126, v126, v127
v_mfma_f32_16x16x32_bf16 v[170:173], v[228:231], v[186:189], v[170:173]
v_cvt_pk_bf16_f32 v127, v128, v129
v_cvt_pk_bf16_f32 v134, v134, v135
v_mfma_f32_16x16x32_bf16 v[220:223], v[252:255], v[186:189], v[220:223]
ds_read_u16 v128, v214 offset:1032
v_cvt_pk_bf16_f32 v90, v90, v91
v_mfma_f32_16x16x32_bf16 v[150:153], v[190:193], v[174:177], 0
v_cvt_pk_bf16_f32 v91, v92, v93
v_cvt_pk_bf16_f32 v92, v170, v171
v_mfma_f32_16x16x32_bf16 v[138:141], v[114:117], v[174:177], 0
v_cvt_pk_bf16_f32 v93, v172, v173
v_cvt_pk_bf16_f32 v135, v136, v137
v_mfma_f32_16x16x32_bf16 v[142:145], v[122:125], v[174:177], 0
ds_read_u16 v136, v214 offset:1040
v_mov_b32 v121, 0
v_mfma_f32_16x16x32_bf16 v[146:149], v[130:133], v[174:177], 0
v_cvt_pk_bf16_f32 v174, v154, v155
v_cvt_pk_bf16_f32 v175, v156, v157
v_mfma_f32_16x16x32_bf16 v[150:153], v[190:193], v[178:181], v[150:153]
s_waitcnt lgkmcnt(2)
v_cvt_pk_bf16_f32 v176, v158, v159
v_cvt_pk_bf16_f32 v177, v160, v161
v_mfma_f32_16x16x32_bf16 v[138:141], v[118:121], v[178:181], v[138:141]
v_mov_b32 v129, 0
v_mov_b32 v137, 0
v_mfma_f32_16x16x32_bf16 v[154:157], v[114:117], v[174:177], 0
v_rcp_f32 v151, v150
v_mfma_f32_16x16x32_bf16 v[158:161], v[122:125], v[174:177], 0
s_waitcnt lgkmcnt(1)
v_max3_u32 v218, v218, v150, v151
v_mul_f32_e64 v151, s3, v151
v_mfma_f32_16x16x32_bf16 v[142:145], v[126:129], v[178:181], v[142:145]
s_waitcnt lgkmcnt(0)
v_mul_f32 v138, v138, v151
v_mul_f32_e64 v139, v139, v151
v_mfma_f32_16x16x32_bf16 v[146:149], v[134:137], v[178:181], v[146:149]
v_cvt_pk_bf16_f32 v180, v166, 0
v_mul_f32_e64 v140, v140, v151
v_mfma_f32_16x16x32_bf16 v[166:169], v[190:193], v[174:177], 0
v_mul_f32_e64 v141, v141, v151
v_cvt_pk_bf16_f32 v138, v138, v139
v_mul_f32 v142, v142, v151
v_mul_f32 v143, v143, v151
v_mul_f32 v144, v144, v151
v_mul_f32 v145, v145, v151
v_cvt_pk_bf16_f32 v139, v140, v141
v_cvt_pk_bf16_f32 v140, v142, v143
v_cvt_pk_bf16_f32 v141, v144, v145
v_cvt_pk_bf16_f32 v178, v162, v163
v_cvt_pk_bf16_f32 v179, v164, v165
v_mfma_f32_16x16x32_bf16 v[162:165], v[130:133], v[174:177], 0
ds_write_b128 v211, v[138:141] offset:38912
v_mfma_f32_16x16x32_bf16 v[138:141], v[78:81], v[90:93], 0
v_mul_f32 v146, v146, v151
v_mul_f32 v147, v147, v151
v_mfma_f32_16x16x32_bf16 v[166:169], v[190:193], v[178:181], v[166:169]
v_mul_f32 v148, v148, v151
v_mul_f32 v149, v149, v151
v_mfma_f32_16x16x32_bf16 v[154:157], v[118:121], v[178:181], v[154:157]
v_cvt_pk_bf16_f32 v142, v146, v147
v_cvt_pk_bf16_f32 v143, v148, v149
v_mfma_f32_16x16x32_bf16 v[158:161], v[126:129], v[178:181], v[158:161]
ds_write_b64 v212, v[142:143] offset:38912
v_mfma_f32_16x16x32_bf16 v[142:145], v[96:99], v[90:93], 0
v_rcp_f32_e64 v167, v166
v_mfma_f32_16x16x32_bf16 v[162:165], v[134:137], v[178:181], v[162:165]
v_max3_u32 v218, v218, v166, v167
v_cvt_pk_bf16_f32 v94, v220, v221
v_mfma_f32_16x16x32_bf16 v[150:153], v[108:111], v[90:93], v[206:209]
v_cvt_pk_bf16_f32 v95, v222, v223
v_mul_f32_e64 v167, s3, v167
v_mfma_f32_16x16x32_bf16 v[146:149], v[102:105], v[90:93], 0
v_mul_f32 v154, v154, v167
v_mul_f32 v155, v155, v167
v_mul_f32_e64 v156, v156, v167
v_mfma_f32_16x16x16_bf16 v[138:141], v[82:83], v[94:95], v[138:141]
v_mul_f32_e64 v157, v157, v167
v_cvt_pk_bf16_f32 v154, v154, v155
v_mul_f32_e64 v158, v158, v167
v_mfma_f32_16x16x16_bf16 v[142:145], v[100:101], v[94:95], v[142:145]
v_mul_f32 v159, v159, v167
v_mul_f32 v160, v160, v167
v_mul_f32_e64 v161, v161, v167
v_mfma_f32_16x16x16_bf16 v[150:153], v[112:113], v[94:95], v[150:153]
v_cvt_pk_bf16_f32 v155, v156, v157
v_cvt_pk_bf16_f32 v156, v158, v159
v_cvt_pk_bf16_f32 v157, v160, v161
v_mfma_f32_16x16x16_bf16 v[146:149], v[106:107], v[94:95], v[146:149]
v_mul_f32 v162, v162, v167
v_mul_f32 v163, v163, v167
v_mul_f32 v164, v164, v167
v_mul_f32 v165, v165, v167
v_mfma_f32_16x16x16_bf16 v[166:169], v[76:77], v[112:113], v[206:209]
v_cvt_pk_bf16_f32 v158, v162, v163
v_cvt_pk_bf16_f32 v159, v164, v165
v_exp_f32 v138, v138
v_mfma_f32_16x16x16_bf16 v[162:165], v[76:77], v[106:107], 0
v_exp_f32 v139, v139
v_exp_f32 v140, v140
v_mfma_f32_16x16x32_bf16 v[166:169], v[72:75], v[108:111], v[166:169]
ds_write_b128 v211, v[154:157] offset:45056
v_mfma_f32_16x16x16_bf16 v[154:157], v[76:77], v[82:83], 0
v_exp_f32 v141, v141
v_exp_f32 v142, v142
v_mfma_f32_16x16x32_bf16 v[162:165], v[72:75], v[102:105], v[162:165]
v_exp_f32 v143, v143
v_mfma_f32_16x16x32_bf16 v[154:157], v[72:75], v[78:81], v[154:157]
ds_write_b64 v212, v[158:159] offset:45056
v_mfma_f32_16x16x16_bf16 v[158:161], v[76:77], v[100:101], 0
v_exp_f32 v144, v144
v_exp_f32 v145, v145
v_exp_f32_e64 v150, v150
v_mfma_f32_16x16x32_bf16 v[158:161], v[72:75], v[96:99], v[158:161]
v_cvt_pk_bf16_f32 v174, v138, v139
v_cvt_pk_bf16_f32 v175, v140, v141
v_cvt_pk_bf16_f32 v176, v142, v143
v_cvt_pk_bf16_f32 v177, v144, v145
v_cvt_pk_bf16_f32 v180, v150, 0
v_exp_f32_e64 v146, v146
v_mfma_f32_16x16x32_bf16 v[150:153], v[190:193], v[174:177], 0
v_exp_f32 v147, v147
v_mfma_f32_16x16x32_bf16 v[138:141], v[114:117], v[174:177], 0
s_waitcnt lgkmcnt(0)
v_exp_f32 v148, v148
v_mfma_f32_16x16x32_bf16 v[142:145], v[122:125], v[174:177], 0
s_barrier
ds_read_b128 v[170:173], v210 offset:38912
ds_read_b128 v[182:185], v210 offset:39936
ds_read_b128 v[186:189], v210 offset:40960
v_exp_f32_e64 v149, v149
v_cvt_pk_bf16_f32 v178, v146, v147
v_cvt_pk_bf16_f32 v179, v148, v149
v_mfma_f32_16x16x32_bf16 v[146:149], v[130:133], v[174:177], 0
v_mov_b32_dpp v154, v158 quad_perm:[0,1,2,3] row_mask:0x2 bank_mask:0xf
v_mfma_f32_16x16x32_bf16 v[150:153], v[190:193], v[178:181], v[150:153]
v_mov_b32_dpp v154, v162 quad_perm:[0,1,2,3] row_mask:0x4 bank_mask:0xf
v_mfma_f32_16x16x32_bf16 v[138:141], v[118:121], v[178:181], v[138:141]
v_mov_b32_dpp v154, v167 quad_perm:[0,1,2,3] row_mask:0x8 bank_mask:0xf
v_exp_f32_e64 v154, v154
v_mfma_f32_16x16x32_bf16 v[142:145], v[126:129], v[178:181], v[142:145]
v_cvt_pk_bf16_f32 v154, v154, 0
v_rcp_f32 v151, v150
v_mfma_f32_16x16x32_bf16 v[146:149], v[134:137], v[178:181], v[146:149]
s_waitcnt lgkmcnt(2)
ds_write_b16 v214, v154
v_mfma_f32_16x16x32_bf16 v[0:3], a[144:147], v[170:173], v[0:3]
ds_read_b128 v[84:87], v215
ds_read_b128 v[88:91], v215 offset:16
v_mfma_f32_16x16x32_bf16 v[4:7], a[168:171], v[170:173], v[4:7]
s_nop 0
ds_read_b128 v[174:177], v217
ds_read_b128 v[178:181], v217 offset:528
v_mfma_f32_16x16x32_bf16 v[8:11], a[192:195], v[170:173], v[8:11]
s_waitcnt lgkmcnt(6)
ds_read_b128 v[170:173], v210 offset:41984
v_add_u32 v215, 1552, v215
v_mfma_f32_16x16x32_bf16 v[0:3], a[148:151], v[182:185], v[0:3]
ds_read_b64 v[112:113], v215 offset:528
v_mfma_f32_16x16x32_bf16 v[4:7], a[172:175], v[182:185], v[4:7]
v_mfma_f32_16x16x32_bf16 v[8:11], a[196:199], v[182:185], v[8:11]
s_nop 0
ds_read_b128 v[182:185], v210 offset:43008
s_waitcnt lgkmcnt(6)
v_mfma_f32_16x16x32_bf16 v[166:169], v[84:87], v[190:193], 0
v_mfma_f32_16x16x32_bf16 v[154:157], v[84:87], v[114:117], 0
v_mfma_f32_16x16x32_bf16 v[158:161], v[84:87], v[122:125], 0
v_mfma_f32_16x16x32_bf16 v[162:165], v[84:87], v[130:133], 0
s_waitcnt lgkmcnt(5)
v_mfma_f32_16x16x32_bf16 v[166:169], v[88:91], v[190:193], v[166:169]
v_mfma_f32_16x16x32_bf16 v[154:157], v[88:91], v[118:121], v[154:157]
v_mfma_f32_16x16x32_bf16 v[158:161], v[88:91], v[126:129], v[158:161]
v_rcp_f32 v167, v166
v_mfma_f32_16x16x32_bf16 v[162:165], v[88:91], v[134:137], v[162:165]
v_max3_u32 v218, v218, v166, v167
v_max3_u32 v218, v218, v150, v151
v_mfma_f32_16x16x32_bf16 v[0:3], a[152:155], v[186:189], v[0:3]
v_mul_f32 v151, s3, v151
v_mul_f32 v138, v138, v151
v_mfma_f32_16x16x32_bf16 v[4:7], a[176:179], v[186:189], v[4:7]
v_mul_f32_e64 v139, v139, v151
v_mul_f32 v140, v140, v151
v_mfma_f32_16x16x32_bf16 v[8:11], a[200:203], v[186:189], v[8:11]
s_waitcnt lgkmcnt(2)
ds_read_b128 v[186:189], v210 offset:44032
v_mul_f32_e64 v141, v141, v151
v_mfma_f32_16x16x32_bf16 v[0:3], a[156:159], v[170:173], v[0:3]
v_cvt_pk_bf16_f32 v138, v138, v139
v_mul_f32_e64 v142, v142, v151
v_mfma_f32_16x16x32_bf16 v[4:7], a[180:183], v[170:173], v[4:7]
v_mul_f32_e64 v143, v143, v151
v_mul_f32 v144, v144, v151
v_mfma_f32_16x16x32_bf16 v[8:11], a[204:207], v[170:173], v[8:11]
s_waitcnt lgkmcnt(1)
ds_read_b128 v[170:173], v210 offset:45056
v_mul_f32_e64 v145, v145, v151
v_mfma_f32_16x16x32_bf16 v[0:3], a[160:163], v[182:185], v[0:3]
v_cvt_pk_bf16_f32 v139, v140, v141
v_cvt_pk_bf16_f32 v140, v142, v143
v_mfma_f32_16x16x32_bf16 v[4:7], a[184:187], v[182:185], v[4:7]
v_cvt_pk_bf16_f32 v141, v144, v145
v_mul_f32 v146, v146, v151
v_mfma_f32_16x16x32_bf16 v[8:11], a[208:211], v[182:185], v[8:11]
s_waitcnt lgkmcnt(1)
ds_read_b128 v[182:185], v210 offset:46080
ds_write_b128 v211, v[138:141] offset:51200
v_mfma_f32_16x16x32_bf16 v[0:3], a[164:167], v[186:189], v[0:3]
v_mul_f32 v147, v147, v151
v_mul_f32 v148, v148, v151
v_mfma_f32_16x16x32_bf16 v[4:7], a[188:191], v[186:189], v[4:7]
v_mul_f32 v149, v149, v151
v_cvt_pk_bf16_f32 v142, v146, v147
v_mfma_f32_16x16x32_bf16 v[8:11], a[212:215], v[186:189], v[8:11]
s_waitcnt lgkmcnt(2)
ds_read_b128 v[186:189], v210 offset:47104
v_cvt_pk_bf16_f32 v143, v148, v149
v_mfma_f32_16x16x32_bf16 v[12:15], a[144:147], v[170:173], v[12:15]
ds_write_b64 v212, v[142:143] offset:51200
v_mfma_f32_16x16x32_bf16 v[16:19], a[168:171], v[170:173], v[16:19]
s_nop 0
v_cvt_pk_bf16_f32 v72, v0, v1
v_cvt_pk_bf16_f32 v73, v2, v3
v_mfma_f32_16x16x32_bf16 v[20:23], a[192:195], v[170:173], v[20:23]
s_waitcnt lgkmcnt(3)
ds_read_b128 v[170:173], v210 offset:48128
buffer_store_dwordx2 v[72:73], v203, s[8:11], s38 offen
v_cvt_pk_bf16_f32 v74, v4, v5
v_mfma_f32_16x16x32_bf16 v[12:15], a[148:151], v[182:185], v[12:15]
v_cvt_pk_bf16_f32 v75, v6, v7
v_mov_b32_dpp v154, v158 quad_perm:[0,1,2,3] row_mask:0x2 bank_mask:0xf
v_mfma_f32_16x16x32_bf16 v[16:19], a[172:175], v[182:185], v[16:19]
v_mul_f32 v167, s3, v167
v_mov_b32_dpp v154, v162 quad_perm:[0,1,2,3] row_mask:0x4 bank_mask:0xf
v_mfma_f32_16x16x32_bf16 v[20:23], a[196:199], v[182:185], v[20:23]
s_waitcnt lgkmcnt(2)
ds_read_b128 v[182:185], v210 offset:49152
v_mul_f32_e64 v154, v154, v167
v_mfma_f32_16x16x32_bf16 v[12:15], a[152:155], v[186:189], v[12:15]
v_cvt_pk_bf16_f32 v154, v154, 0
v_cvt_pk_bf16_f32 v76, v8, v9
v_mfma_f32_16x16x32_bf16 v[16:19], a[176:179], v[186:189], v[16:19]
s_waitcnt vmcnt(1) lgkmcnt(1)
ds_write_b16 v214, v154
v_mfma_f32_16x16x32_bf16 v[20:23], a[200:203], v[186:189], v[20:23]
s_barrier
v_mfma_f32_16x16x32_bf16 v[12:15], a[156:159], v[170:173], v[12:15]
ds_read_b128 v[186:189], v210 offset:50176
ds_read_b128 v[84:87], v200
v_mfma_f32_16x16x32_bf16 v[16:19], a[180:183], v[170:173], v[16:19]
s_nop 0
ds_read_b128 v[92:95], v201
ds_read_b128 v[100:103], v202
v_mfma_f32_16x16x32_bf16 v[20:23], a[204:207], v[170:173], v[20:23]
s_waitcnt lgkmcnt(5)
ds_read_b128 v[170:173], v210 offset:51200
ds_read_b128 v[88:91], v194 offset:16
v_mfma_f32_16x16x32_bf16 v[12:15], a[160:163], v[182:185], v[12:15]
ds_read_b128 v[96:99], v195 offset:16
v_cvt_pk_bf16_f32 v77, v10, v11
v_mfma_f32_16x16x32_bf16 v[16:19], a[184:187], v[182:185], v[16:19]
ds_read_b128 v[104:107], v196 offset:16
v_add_u32 v214, 1552, v214
v_mfma_f32_16x16x32_bf16 v[20:23], a[208:211], v[182:185], v[20:23]
s_nop 0
ds_read_b128 v[182:185], v210 offset:52224
buffer_store_dwordx2 v[74:75], v203, s[8:11], s38 offen offset:32
s_waitcnt lgkmcnt(8)
v_mfma_f32_16x16x32_bf16 v[12:15], a[164:167], v[186:189], v[12:15]
v_mfma_f32_16x16x32_bf16 v[16:19], a[188:191], v[186:189], v[16:19]
v_mfma_f32_16x16x32_bf16 v[20:23], a[212:215], v[186:189], v[20:23]
s_waitcnt lgkmcnt(7)
ds_read_b128 v[186:189], v210 offset:53248
v_cvt_pk_bf16_f32 v78, v12, v13
v_mfma_f32_16x16x32_bf16 v[0:3], v[174:177], v[84:87], 0
s_waitcnt lgkmcnt(5)
ds_read_b128 v[84:87], v194
v_cvt_pk_bf16_f32 v79, v14, v15
v_mfma_f32_16x16x32_bf16 v[24:27], a[144:147], v[170:173], v[24:27]
v_cvt_pk_bf16_f32 v80, v16, v17
v_cvt_pk_bf16_f32 v81, v18, v19
v_mfma_f32_16x16x32_bf16 v[28:31], a[168:171], v[170:173], v[28:31]
v_cvt_pk_bf16_f32 v82, v20, v21
v_cvt_pk_bf16_f32 v83, v22, v23
v_mfma_f32_16x16x32_bf16 v[32:35], a[192:195], v[170:173], v[32:35]
ds_read_b128 v[170:173], v210 offset:54272
v_mfma_f32_16x16x32_bf16 v[12:15], v[174:177], v[92:95], 0
ds_read_b128 v[92:95], v195
s_waitcnt lgkmcnt(4)
v_mfma_f32_16x16x32_bf16 v[24:27], a[148:151], v[182:185], v[24:27]
v_mfma_f32_16x16x32_bf16 v[28:31], a[172:175], v[182:185], v[28:31]
v_mfma_f32_16x16x32_bf16 v[32:35], a[196:199], v[182:185], v[32:35]
ds_read_b128 v[182:185], v210 offset:55296
s_waitcnt lgkmcnt(4)
v_mfma_f32_16x16x32_bf16 v[24:27], a[152:155], v[186:189], v[24:27]
v_mfma_f32_16x16x32_bf16 v[28:31], a[176:179], v[186:189], v[28:31]
v_mfma_f32_16x16x32_bf16 v[32:35], a[200:203], v[186:189], v[32:35]
s_nop 0
ds_read_b128 v[186:189], v210 offset:56320
s_waitcnt lgkmcnt(3)
v_mfma_f32_16x16x32_bf16 v[24:27], a[156:159], v[170:173], v[24:27]
buffer_store_dwordx2 v[76:77], v203, s[8:11], s38 offen offset:64
v_mfma_f32_16x16x32_bf16 v[28:31], a[180:183], v[170:173], v[28:31]
v_mfma_f32_16x16x32_bf16 v[32:35], a[204:207], v[170:173], v[32:35]
s_waitcnt lgkmcnt(1)
v_mfma_f32_16x16x32_bf16 v[24:27], a[160:163], v[182:185], v[24:27]
v_mfma_f32_16x16x32_bf16 v[28:31], a[184:187], v[182:185], v[28:31]
v_mfma_f32_16x16x32_bf16 v[32:35], a[208:211], v[182:185], v[32:35]
ds_read_b128 v[182:185], v210 offset:20480
s_waitcnt lgkmcnt(1)
v_mfma_f32_16x16x32_bf16 v[24:27], a[164:167], v[186:189], v[24:27]
v_smfmac_f32_16x16x64_bf16 v[0:3], v[178:181], v[84:91], v213
ds_read_b128 v[84:87], v197
ds_read_b128 v[88:91], v197 offset:16
v_mfma_f32_16x16x32_bf16 v[28:31], a[188:191], v[186:189], v[28:31]
v_cvt_pk_bf16_f32 v116, v24, v25
v_cvt_pk_bf16_f32 v117, v26, v27
v_mfma_f32_16x16x32_bf16 v[24:27], v[174:177], v[100:103], 0
ds_read_b128 v[100:103], v196
ds_read_b128 v[174:177], v217 offset:1056
v_mfma_f32_16x16x32_bf16 v[32:35], a[212:215], v[186:189], v[32:35]
s_nop 0
ds_read_b128 v[186:189], v210 offset:21504
v_cvt_pk_bf16_f32 v124, v28, v29
v_smfmac_f32_16x16x64_bf16 v[12:15], v[178:181], v[92:99], v213
s_waitcnt lgkmcnt(5)
ds_read_b128 v[92:95], v198
ds_read_b128 v[96:99], v198 offset:16
v_mfma_f32_16x16x32_bf16 v[138:141], a[0:3], v[182:185], 0
v_cvt_pk_bf16_f32 v125, v30, v31
v_cvt_pk_bf16_f32 v132, v32, v33
v_mfma_f32_16x16x32_bf16 v[142:145], a[24:27], v[182:185], 0
s_nop 0
v_cvt_pk_bf16_f32 v133, v34, v35
v_mfma_f32_16x16x32_bf16 v[146:149], a[48:51], v[182:185], 0
s_waitcnt lgkmcnt(4)
v_smfmac_f32_16x16x64_bf16 v[24:27], v[178:181], v[100:107], v213
ds_read_b128 v[100:103], v199
ds_read_b128 v[104:107], v199 offset:16
v_mfma_f32_16x16x32_bf16 v[150:153], a[216:219], v[182:185], 0
ds_read_b128 v[178:181], v217 offset:1584
buffer_store_dwordx2 v[78:79], v204, s[8:11], s38 offen
s_waitcnt lgkmcnt(6)
v_smfmac_f32_16x16x64_bf16 v[0:3], v[174:177], v[84:91], v213
ds_read_b128 v[84:87], v200 offset:32
ds_read_b128 v[88:91], v194 offset:48
v_mfma_f32_16x16x32_bf16 v[154:157], a[240:243], v[182:185], 0
s_waitcnt lgkmcnt(5)
v_smfmac_f32_16x16x64_bf16 v[12:15], v[174:177], v[92:99], v213
ds_read_b128 v[92:95], v201 offset:32
ds_read_b128 v[96:99], v195 offset:48
v_mfma_f32_16x16x32_bf16 v[158:161], v[232:235], v[182:185], 0
v_mul_f32 v119, v0, v0
v_add_f32 v118, v0, v1
v_mfma_f32_16x16x32_bf16 v[162:165], v[182:185], a[72:75], 0
s_waitcnt lgkmcnt(5)
v_mul_f32 v127, v12, v12
v_add_f32_e64 v126, v12, v13
v_smfmac_f32_16x16x64_bf16 v[24:27], v[174:177], v[100:107], v213
ds_read_b128 v[100:103], v202 offset:32
ds_read_b128 v[174:177], v217 offset:2112
v_mfma_f32_16x16x32_bf16 v[166:169], v[182:185], a[96:99], 0
s_waitcnt lgkmcnt(5)
ds_read_b128 v[104:107], v196 offset:48
v_fmac_f32 v119, v1, v1
v_mfma_f32_16x16x32_bf16 v[4:7], v[178:181], v[84:87], 0
ds_read_b128 v[84:87], v194 offset:32
v_mul_f32 v135, v24, v24
v_mfma_f32_16x16x32_bf16 v[170:173], v[182:185], a[120:123], 0
s_waitcnt lgkmcnt(5)
ds_read_b128 v[182:185], v210 offset:22528
v_add_f32_e64 v134, v24, v25
v_mfma_f32_16x16x32_bf16 v[16:19], v[178:181], v[92:95], 0
ds_read_b128 v[92:95], v195 offset:32
v_fmac_f32_e64 v135, v25, v25
v_mfma_f32_16x16x32_bf16 v[138:141], a[4:7], v[186:189], v[138:141]
v_fmac_f32 v127, v13, v13
v_add_f32 v134, v134, v26
v_mfma_f32_16x16x32_bf16 v[142:145], a[28:31], v[186:189], v[142:145]
s_waitcnt lgkmcnt(5)
v_fmac_f32 v135, v26, v26
v_add_f32_e64 v118, v118, v2
v_mfma_f32_16x16x32_bf16 v[28:31], v[178:181], v[100:103], 0
ds_read_b128 v[100:103], v196 offset:32
ds_read_b128 v[178:181], v217 offset:2640
v_mfma_f32_16x16x32_bf16 v[146:149], a[52:55], v[186:189], v[146:149]
v_add_f32 v126, v126, v14
v_fmac_f32 v119, v2, v2
v_mfma_f32_16x16x32_bf16 v[150:153], a[220:223], v[186:189], v[150:153]
s_waitcnt lgkmcnt(4)
v_fmac_f32 v127, v14, v14
v_add_f32_e64 v134, v134, v27
v_smfmac_f32_16x16x64_bf16 v[4:7], v[174:177], v[84:91], v213
s_nop 0
ds_read_b128 v[84:87], v197 offset:32
ds_read_b128 v[88:91], v197 offset:48
v_mfma_f32_16x16x32_bf16 v[154:157], a[244:247], v[186:189], v[154:157]
s_waitcnt lgkmcnt(4)
buffer_store_dwordx2 v[80:81], v204, s[8:11], s38 offen offset:32
v_fmac_f32 v135, v27, v27
v_smfmac_f32_16x16x64_bf16 v[16:19], v[174:177], v[92:99], v213
s_waitcnt lgkmcnt(3)
ds_read_b128 v[92:95], v198 offset:32
ds_read_b128 v[96:99], v198 offset:48
v_smfmac_f32_16x16x64_bf16 v[28:31], v[174:177], v[100:107], v213
ds_read_b128 v[100:103], v199 offset:32
ds_read_b128 v[104:107], v199 offset:48
v_mfma_f32_16x16x32_bf16 v[158:161], v[236:239], v[186:189], v[158:161]
ds_read_b128 v[174:177], v217 offset:3168
v_add_f32_e64 v118, v118, v3
v_mfma_f32_16x16x32_bf16 v[162:165], v[186:189], a[76:79], v[162:165]
v_add_f32 v126, v126, v15
v_fmac_f32 v119, v3, v3
v_mfma_f32_16x16x32_bf16 v[166:169], v[186:189], a[100:103], v[166:169]
v_fmac_f32 v127, v15, v15
s_waitcnt lgkmcnt(5)
v_smfmac_f32_16x16x64_bf16 v[4:7], v[178:181], v[84:91], v213
ds_read_b128 v[84:87], v200 offset:64
ds_read_b128 v[88:91], v194 offset:80
v_mfma_f32_16x16x32_bf16 v[170:173], v[186:189], a[124:127], v[170:173]
s_nop 0
ds_read_b128 v[186:189], v210 offset:23552
s_waitcnt lgkmcnt(6)
v_smfmac_f32_16x16x64_bf16 v[16:19], v[178:181], v[92:99], v213
ds_read_b128 v[92:95], v201 offset:64
ds_read_b128 v[96:99], v195 offset:80
v_mfma_f32_16x16x32_bf16 v[138:141], a[8:11], v[182:185], v[138:141]
v_add_f32 v118, v118, v4
v_fmac_f32 v119, v4, v4
v_mfma_f32_16x16x32_bf16 v[142:145], a[32:35], v[182:185], v[142:145]
s_waitcnt lgkmcnt(6)
v_add_f32 v126, v126, v16
v_fmac_f32_e64 v127, v16, v16
v_smfmac_f32_16x16x64_bf16 v[28:31], v[178:181], v[100:107], v213
ds_read_b128 v[100:103], v202 offset:64
ds_read_b128 v[178:181], v217 offset:3696
v_mfma_f32_16x16x32_bf16 v[146:149], a[56:59], v[182:185], v[146:149]
s_waitcnt lgkmcnt(6)
ds_read_b128 v[104:107], v196 offset:80
v_add_f32 v118, v118, v5
v_mfma_f32_16x16x32_bf16 v[8:11], v[174:177], v[84:87], 0
ds_read_b128 v[84:87], v194 offset:64
v_add_f32_e64 v134, v134, v28
v_mfma_f32_16x16x32_bf16 v[150:153], a[224:227], v[182:185], v[150:153]
buffer_store_dwordx2 v[82:83], v204, s[8:11], s38 offen offset:64
v_fmac_f32 v135, v28, v28
v_mfma_f32_16x16x32_bf16 v[154:157], a[248:251], v[182:185], v[154:157]
s_waitcnt lgkmcnt(5)
v_add_f32 v134, v134, v29
v_fmac_f32 v135, v29, v29
v_mfma_f32_16x16x32_bf16 v[20:23], v[174:177], v[92:95], 0
s_waitcnt lgkmcnt(3)
ds_read_b128 v[92:95], v195 offset:64
v_fmac_f32 v119, v5, v5
v_mfma_f32_16x16x32_bf16 v[32:35], v[174:177], v[100:103], 0
ds_read_b128 v[100:103], v196 offset:64
ds_read_b128 v[174:177], v217 offset:4224
v_mfma_f32_16x16x32_bf16 v[158:161], v[240:243], v[182:185], v[158:161]
v_add_f32 v126, v126, v17
v_fmac_f32 v127, v17, v17
v_mfma_f32_16x16x32_bf16 v[162:165], v[182:185], a[80:83], v[162:165]
s_waitcnt lgkmcnt(3)
v_add_f32 v134, v134, v30
v_fmac_f32_e64 v135, v30, v30
v_smfmac_f32_16x16x64_bf16 v[8:11], v[178:181], v[84:91], v213
ds_read_b128 v[84:87], v197 offset:64
ds_read_b128 v[88:91], v197 offset:80
v_mfma_f32_16x16x32_bf16 v[166:169], v[182:185], a[104:107], v[166:169]
v_add_f32_e64 v118, v118, v6
v_fmac_f32 v119, v6, v6
v_mfma_f32_16x16x32_bf16 v[170:173], v[182:185], a[128:131], v[170:173]
s_waitcnt lgkmcnt(4)
ds_read_b128 v[182:185], v210 offset:24576
v_add_f32_e64 v126, v126, v18
v_smfmac_f32_16x16x64_bf16 v[20:23], v[178:181], v[92:99], v213
ds_read_b128 v[92:95], v198 offset:64
ds_read_b128 v[96:99], v198 offset:80
v_mfma_f32_16x16x32_bf16 v[138:141], a[12:15], v[186:189], v[138:141]
s_waitcnt lgkmcnt(6)
v_fmac_f32 v127, v18, v18
v_add_f32_e64 v134, v134, v31
v_smfmac_f32_16x16x64_bf16 v[32:35], v[178:181], v[100:107], v213
ds_read_b128 v[100:103], v199 offset:64
ds_read_b128 v[104:107], v199 offset:80
v_mfma_f32_16x16x32_bf16 v[142:145], a[36:39], v[186:189], v[142:145]
v_fmac_f32 v135, v31, v31
v_add_f32 v118, v118, v7
v_mfma_f32_16x16x32_bf16 v[146:149], a[60:63], v[186:189], v[146:149]
v_fmac_f32 v119, v7, v7
v_add_f32 v126, v126, v19
v_mfma_f32_16x16x32_bf16 v[150:153], a[228:231], v[186:189], v[150:153]
v_fmac_f32 v127, v19, v19
v_mov_b32 v181, 0
v_mfma_f32_16x16x32_bf16 v[154:157], a[252:255], v[186:189], v[154:157]
s_waitcnt lgkmcnt(5)
v_smfmac_f32_16x16x64_bf16 v[8:11], v[174:177], v[84:91], v213
buffer_store_dwordx2 v[116:117], v205, s[8:11], s38 offen
v_mfma_f32_16x16x32_bf16 v[158:161], v[244:247], v[186:189], v[158:161]
v_mfma_f32_16x16x32_bf16 v[162:165], v[186:189], a[84:87], v[162:165]
s_waitcnt lgkmcnt(2)
v_add_f32 v118, v118, v8
v_fmac_f32 v119, v8, v8
v_smfmac_f32_16x16x64_bf16 v[20:23], v[174:177], v[92:99], v213
v_add_f32 v118, v118, v9
v_mfma_f32_16x16x32_bf16 v[166:169], v[186:189], a[108:111], v[166:169]
v_fmac_f32 v119, v9, v9
v_add_f32 v118, v118, v10
v_mfma_f32_16x16x32_bf16 v[170:173], v[186:189], a[132:135], v[170:173]
s_waitcnt lgkmcnt(0)
ds_read_b128 v[186:189], v210 offset:25600
v_add_f32_e64 v126, v126, v20
v_smfmac_f32_16x16x64_bf16 v[32:35], v[174:177], v[100:107], v213
v_fmac_f32_e64 v127, v20, v20
v_mfma_f32_16x16x32_bf16 v[138:141], a[16:19], v[182:185], v[138:141]
v_add_f32 v126, v126, v21
v_fmac_f32 v127, v21, v21
v_mfma_f32_16x16x32_bf16 v[142:145], a[40:43], v[182:185], v[142:145]
v_add_f32 v134, v134, v32
v_fmac_f32 v135, v32, v32
v_mfma_f32_16x16x32_bf16 v[146:149], a[64:67], v[182:185], v[146:149]
v_add_f32 v134, v134, v33
v_fmac_f32 v135, v33, v33
v_mfma_f32_16x16x32_bf16 v[150:153], a[232:235], v[182:185], v[150:153]
v_add_f32 v134, v134, v34
v_fmac_f32 v135, v34, v34
v_mfma_f32_16x16x32_bf16 v[154:157], v[224:227], v[182:185], v[154:157]
v_fmac_f32 v119, v10, v10
v_add_f32 v126, v126, v22
v_mfma_f32_16x16x32_bf16 v[158:161], v[248:251], v[182:185], v[158:161]
v_fmac_f32 v127, v22, v22
v_add_f32 v134, v134, v35
v_mfma_f32_16x16x32_bf16 v[162:165], v[182:185], a[88:91], v[162:165]
v_fmac_f32 v135, v35, v35
v_add_f32 v118, v118, v11
v_mfma_f32_16x16x32_bf16 v[166:169], v[182:185], a[112:115], v[166:169]
v_fmac_f32_e64 v119, v11, v11
v_add_f32 v126, v126, v23
v_mfma_f32_16x16x32_bf16 v[170:173], v[182:185], a[136:139], v[170:173]
s_waitcnt lgkmcnt(0)
ds_read_b128 v[182:185], v210 offset:26624
v_fmac_f32_e64 v127, v23, v23
v_mfma_f32_16x16x32_bf16 v[138:141], a[20:23], v[186:189], v[138:141]
buffer_store_dwordx2 v[124:125], v205, s[8:11], s38 offen offset:32
v_permlane16_swap_b32 v134, v135
v_mfma_f32_16x16x32_bf16 v[142:145], a[44:47], v[186:189], v[142:145]
v_permlane16_swap_b32 v118, v119
v_mfma_f32_16x16x32_bf16 v[146:149], a[68:71], v[186:189], v[146:149]
v_cvt_pk_bf16_f32 v78, v138, v139
v_cvt_pk_bf16_f32 v79, v140, v141
v_mfma_f32_16x16x32_bf16 v[150:153], a[236:239], v[186:189], v[150:153]
v_cvt_pk_bf16_f32 v80, v142, v143
v_cvt_pk_bf16_f32 v81, v144, v145
v_mfma_f32_16x16x32_bf16 v[154:157], v[228:231], v[186:189], v[154:157]
v_cvt_pk_bf16_f32 v82, v146, v147
v_cvt_pk_bf16_f32 v83, v148, v149
v_mfma_f32_16x16x32_bf16 v[158:161], v[252:255], v[186:189], v[158:161]
v_cvt_pk_bf16_f32 v72, v150, v151
v_cvt_pk_bf16_f32 v73, v152, v153
v_mfma_f32_16x16x32_bf16 v[162:165], v[186:189], a[92:95], v[162:165]
v_cvt_pk_bf16_f32 v74, v154, v155
v_cvt_pk_bf16_f32 v75, v156, v157
v_mfma_f32_16x16x32_bf16 v[166:169], v[186:189], a[116:119], v[166:169]
s_nop 0
v_cvt_pk_bf16_f32 v76, v158, v159
v_cvt_pk_bf16_f32 v77, v160, v161
v_mfma_f32_16x16x32_bf16 v[170:173], v[186:189], a[140:143], v[170:173]
s_waitcnt lgkmcnt(0)
ds_read_b128 v[186:189], v210 offset:27648
v_cvt_pk_bf16_f32 v114, v162, v163
v_mfma_f32_16x16x32_bf16 v[138:141], a[0:3], v[182:185], 0
v_cvt_pk_bf16_f32 v115, v164, v165
v_cvt_pk_bf16_f32 v122, v166, v167
v_mfma_f32_16x16x32_bf16 v[142:145], a[24:27], v[182:185], 0
v_cvt_pk_bf16_f32 v123, v168, v169
v_cvt_pk_bf16_f32 v130, v170, v171
v_mfma_f32_16x16x32_bf16 v[146:149], a[48:51], v[182:185], 0
v_cvt_pk_bf16_f32 v131, v172, v173
v_add_f32_e64 v134, v134, v135
v_mfma_f32_16x16x32_bf16 v[150:153], a[216:219], v[182:185], 0
v_permlane16_swap_b32 v126, v127
v_mfma_f32_16x16x32_bf16 v[154:157], a[240:243], v[182:185], 0
v_add_f32 v118, v118, v119
v_mov_b32_e64 v135, v134
v_mfma_f32_16x16x32_bf16 v[158:161], v[232:235], v[182:185], 0
v_add_f32 v126, v126, v127
v_permlane32_swap_b32 v134, v135
v_mfma_f32_16x16x32_bf16 v[162:165], v[182:185], a[72:75], 0
buffer_store_dwordx2 v[132:133], v205, s[8:11], s38 offen offset:64
v_permlane32_swap_b32 v118, v126
v_mfma_f32_16x16x32_bf16 v[166:169], v[182:185], a[96:99], 0
s_mov_b32 s38, s36
v_add_f32_e64 v134, v134, v135
v_add_f32 v118, v118, v126
v_mfma_f32_16x16x32_bf16 v[170:173], v[182:185], a[120:123], 0
s_waitcnt lgkmcnt(0)
ds_read_b128 v[182:185], v210 offset:28672
ds_write_b32 v209, v134 offset:512
v_mfma_f32_16x16x32_bf16 v[138:141], a[4:7], v[186:189], v[138:141]
ds_write_b32 v209, v118
v_mfma_f32_16x16x32_bf16 v[142:145], a[28:31], v[186:189], v[142:145]
v_mfma_f32_16x16x32_bf16 v[146:149], a[52:55], v[186:189], v[146:149]
v_mfma_f32_16x16x32_bf16 v[150:153], a[220:223], v[186:189], v[150:153]
v_mfma_f32_16x16x32_bf16 v[154:157], a[244:247], v[186:189], v[154:157]
v_mfma_f32_16x16x32_bf16 v[158:161], v[236:239], v[186:189], v[158:161]
v_mfma_f32_16x16x32_bf16 v[162:165], v[186:189], a[76:79], v[162:165]
s_waitcnt lgkmcnt(0)
s_barrier
v_mfma_f32_16x16x32_bf16 v[166:169], v[186:189], a[100:103], v[166:169]
ds_read_b128 v[102:105], v210 offset:18432
ds_read_b128 v[106:109], v210 offset:19456
v_mfma_f32_16x16x32_bf16 v[170:173], v[186:189], a[124:127], v[170:173]
ds_read_b128 v[186:189], v210 offset:29696
v_mfma_f32_16x16x32_bf16 v[138:141], a[8:11], v[182:185], v[138:141]
v_mfma_f32_16x16x32_bf16 v[142:145], a[32:35], v[182:185], v[142:145]
v_mfma_f32_16x16x32_bf16 v[146:149], a[56:59], v[182:185], v[146:149]
v_mfma_f32_16x16x32_bf16 v[150:153], a[224:227], v[182:185], v[150:153]
s_waitcnt lgkmcnt(2)
v_add_f32 v102, v102, v103
v_mfma_f32_16x16x32_bf16 v[154:157], a[248:251], v[182:185], v[154:157]
v_add_f32 v104, v104, v105
v_add_f32 v102, v102, v104
v_mfma_f32_16x16x32_bf16 v[158:161], v[240:243], v[182:185], v[158:161]
s_waitcnt lgkmcnt(1)
v_add_f32 v106, v106, v107
v_add_f32_e64 v108, v108, v109
v_mfma_f32_16x16x32_bf16 v[162:165], v[182:185], a[80:83], v[162:165]
v_add_f32 v106, v106, v108
v_mul_f32 v103, s48, v102
v_mfma_f32_16x16x32_bf16 v[166:169], v[182:185], a[104:107], v[166:169]
ds_read_b128 v[108:111], v215 offset:512
v_mul_f32 v104, s73, v102
v_mfma_f32_16x16x32_bf16 v[170:173], v[182:185], a[128:131], v[170:173]
s_waitcnt lgkmcnt(1)
ds_read_b128 v[182:185], v210 offset:30720
v_mul_f32_e64 v106, s73, v106
v_mfma_f32_16x16x32_bf16 v[138:141], a[12:15], v[186:189], v[138:141]
v_fma_f32 v106, -v103, v104, v106
v_max_f32_e64 v106, 0, v106
v_mfma_f32_16x16x32_bf16 v[142:145], a[36:39], v[186:189], v[142:145]
v_add_f32 v106, s49, v106
v_rsq_f32 v102, v106
v_mfma_f32_16x16x32_bf16 v[146:149], a[60:63], v[186:189], v[146:149]
v_mul_f32_e64 v103, -v103, v102
v_mfma_f32_16x16x32_bf16 v[150:153], a[228:231], v[186:189], v[150:153]
ds_write_b64 v211, v[102:103]
v_mfma_f32_16x16x32_bf16 v[154:157], a[252:255], v[186:189], v[154:157]
v_mfma_f32_16x16x32_bf16 v[158:161], v[244:247], v[186:189], v[158:161]
ds_read_b64 v[118:119], v219
ds_read_b64 v[126:127], v219 offset:256
v_mfma_f32_16x16x32_bf16 v[162:165], v[186:189], a[84:87], v[162:165]
ds_read_b64 v[134:135], v219 offset:512
v_mfma_f32_16x16x32_bf16 v[166:169], v[186:189], a[108:111], v[166:169]
v_mfma_f32_16x16x32_bf16 v[170:173], v[186:189], a[132:135], v[170:173]
ds_read_b128 v[186:189], v210 offset:31744
s_waitcnt lgkmcnt(5)
v_mfma_f32_16x16x32_bf16 v[138:141], a[16:19], v[182:185], v[138:141]
v_mfma_f32_16x16x32_bf16 v[142:145], a[40:43], v[182:185], v[142:145]
s_waitcnt lgkmcnt(3)
v_fma_f32 v220, v0, v118, v119
v_fma_f32 v221, v1, v118, v119
v_mfma_f32_16x16x32_bf16 v[146:149], a[64:67], v[182:185], v[146:149]
v_fma_f32 v222, v2, v118, v119
v_fma_f32 v223, v3, v118, v119
v_mfma_f32_16x16x32_bf16 v[150:153], a[232:235], v[182:185], v[150:153]
v_cvt_pk_bf16_f32 v90, v220, v221
v_cvt_pk_bf16_f32 v91, v222, v223
v_mfma_f32_16x16x32_bf16 v[154:157], v[224:227], v[182:185], v[154:157]
v_fma_f32 v220, v4, v118, v119
v_fma_f32 v221, v5, v118, v119
v_mfma_f32_16x16x32_bf16 v[158:161], v[248:251], v[182:185], v[158:161]
v_fma_f32 v222, v6, v118, v119
v_fma_f32 v223, v7, v118, v119
v_mfma_f32_16x16x32_bf16 v[162:165], v[182:185], a[88:91], v[162:165]
v_cvt_pk_bf16_f32 v92, v220, v221
v_cvt_pk_bf16_f32 v93, v222, v223
v_mfma_f32_16x16x32_bf16 v[166:169], v[182:185], a[112:115], v[166:169]
s_nop 0
ds_write_b128 v211, v[90:93]
v_mfma_f32_16x16x32_bf16 v[170:173], v[182:185], a[136:139], v[170:173]
s_waitcnt lgkmcnt(1)
v_fma_f32 v220, v8, v118, v119
v_fma_f32 v221, v9, v118, v119
v_mfma_f32_16x16x32_bf16 v[138:141], a[20:23], v[186:189], v[138:141]
v_fma_f32 v222, v10, v118, v119
v_fma_f32 v223, v11, v118, v119
v_mfma_f32_16x16x32_bf16 v[142:145], a[44:47], v[186:189], v[142:145]
ds_read_b128 v[182:185], v210 offset:32768
v_cvt_pk_bf16_f32 v94, v220, v221
v_mfma_f32_16x16x32_bf16 v[146:149], a[68:71], v[186:189], v[146:149]
v_cvt_pk_bf16_f32 v96, v138, v139
v_cvt_pk_bf16_f32 v97, v140, v141
v_mfma_f32_16x16x32_bf16 v[150:153], a[236:239], v[186:189], v[150:153]
v_cvt_pk_bf16_f32 v98, v142, v143
v_cvt_pk_bf16_f32 v99, v144, v145
v_mfma_f32_16x16x32_bf16 v[154:157], v[228:231], v[186:189], v[154:157]
v_cvt_pk_bf16_f32 v100, v146, v147
v_cvt_pk_bf16_f32 v101, v148, v149
v_mfma_f32_16x16x32_bf16 v[158:161], v[252:255], v[186:189], v[158:161]
v_cvt_pk_bf16_f32 v84, v150, v151
v_cvt_pk_bf16_f32 v85, v152, v153
v_mfma_f32_16x16x32_bf16 v[162:165], v[186:189], a[92:95], v[162:165]
v_cvt_pk_bf16_f32 v86, v154, v155
v_cvt_pk_bf16_f32 v87, v156, v157
v_mfma_f32_16x16x32_bf16 v[166:169], v[186:189], a[116:119], v[166:169]
s_nop 0
v_cvt_pk_bf16_f32 v88, v158, v159
v_cvt_pk_bf16_f32 v89, v160, v161
v_mfma_f32_16x16x32_bf16 v[170:173], v[186:189], a[140:143], v[170:173]
s_waitcnt lgkmcnt(0)
ds_read_b128 v[186:189], v210 offset:33792
v_cvt_pk_bf16_f32 v116, v162, v163
v_mfma_f32_16x16x32_bf16 v[138:141], a[0:3], v[182:185], 0
v_cvt_pk_bf16_f32 v124, v166, v167
v_cvt_pk_bf16_f32 v125, v168, v169
v_mfma_f32_16x16x32_bf16 v[142:145], a[24:27], v[182:185], 0
v_cvt_pk_bf16_f32 v117, v164, v165
v_cvt_pk_bf16_f32 v95, v222, v223
v_mfma_f32_16x16x32_bf16 v[146:149], a[48:51], v[182:185], 0
ds_read_b128 v[182:185], v210 offset:34816
ds_write_b64 v212, v[94:95]
v_mfma_f32_16x16x16_bf16 v[154:157], v[82:83], v[88:89], 0
v_fma_f32 v220, v12, v126, v127
v_fma_f32 v221, v13, v126, v127
v_fma_f32 v222, v14, v126, v127
v_mfma_f32_16x16x16_bf16 v[158:161], v[100:101], v[88:89], 0
v_fma_f32 v223, v15, v126, v127
v_cvt_pk_bf16_f32 v174, v220, v221
v_cvt_pk_bf16_f32 v175, v222, v223
v_fma_f32 v220, v16, v126, v127
s_waitcnt lgkmcnt(2)
v_mfma_f32_16x16x32_bf16 v[138:141], a[4:7], v[186:189], v[138:141]
s_nop 0
v_fma_f32 v221, v17, v126, v127
v_fma_f32 v222, v18, v126, v127
v_mfma_f32_16x16x32_bf16 v[142:145], a[28:31], v[186:189], v[142:145]
s_nop 0
v_fma_f32 v223, v19, v126, v127
v_cvt_pk_bf16_f32 v176, v220, v221
v_mfma_f32_16x16x32_bf16 v[146:149], a[52:55], v[186:189], v[146:149]
s_waitcnt lgkmcnt(1)
ds_read_b128 v[186:189], v210 offset:35840
v_cvt_pk_bf16_f32 v177, v222, v223
v_mfma_f32_16x16x32_bf16 v[138:141], a[8:11], v[182:185], v[138:141]
ds_write_b128 v211, v[174:177] offset:6144
v_mfma_f32_16x16x32_bf16 v[142:145], a[32:35], v[182:185], v[142:145]
v_fma_f32 v220, v20, v126, v127
v_fma_f32 v221, v21, v126, v127
v_mfma_f32_16x16x32_bf16 v[146:149], a[56:59], v[182:185], v[146:149]
v_fma_f32 v222, v22, v126, v127
v_fma_f32 v223, v23, v126, v127
v_cvt_pk_bf16_f32 v178, v220, v221
v_mfma_f32_16x16x16_bf16 v[166:169], v[112:113], v[88:89], v[206:209]
v_cvt_pk_bf16_f32 v179, v222, v223
v_fma_f32 v220, v24, v134, v135
v_fma_f32 v221, v25, v134, v135
v_mfma_f32_16x16x16_bf16 v[150:153], v[112:113], v[76:77], v[206:209]
v_fma_f32 v222, v26, v134, v135
v_fma_f32 v223, v27, v134, v135
v_cvt_pk_bf16_f32 v90, v220, v221
v_cvt_pk_bf16_f32 v91, v222, v223
s_waitcnt lgkmcnt(1)
v_mfma_f32_16x16x32_bf16 v[138:141], a[12:15], v[186:189], v[138:141]
s_nop 0
ds_read_b128 v[182:185], v210 offset:36864
ds_write_b64 v212, v[178:179] offset:6144
v_mfma_f32_16x16x32_bf16 v[142:145], a[36:39], v[186:189], v[142:145]
v_fma_f32 v220, v28, v134, v135
v_fma_f32 v221, v29, v134, v135
v_mfma_f32_16x16x32_bf16 v[146:149], a[60:63], v[186:189], v[146:149]
ds_read_b128 v[186:189], v210 offset:37888
v_fma_f32 v222, v30, v134, v135
v_mfma_f32_16x16x32_bf16 v[154:157], v[78:81], v[84:87], v[154:157]
v_fma_f32 v223, v31, v134, v135
v_cvt_pk_bf16_f32 v92, v220, v221
v_mfma_f32_16x16x32_bf16 v[150:153], v[108:111], v[72:75], v[150:153]
s_nop 0
v_cvt_pk_bf16_f32 v93, v222, v223
v_fma_f32 v220, v32, v134, v135
v_mfma_f32_16x16x32_bf16 v[158:161], v[96:99], v[84:87], v[158:161]
s_waitcnt lgkmcnt(2)
ds_write_b128 v211, v[90:93] offset:12288
v_mfma_f32_16x16x32_bf16 v[138:141], a[16:19], v[182:185], v[138:141]
v_fma_f32 v221, v33, v134, v135
v_fma_f32 v222, v34, v134, v135
v_mfma_f32_16x16x32_bf16 v[142:145], a[40:43], v[182:185], v[142:145]
s_nop 0
v_fma_f32 v223, v35, v134, v135
v_cvt_pk_bf16_f32 v132, v170, v171
v_mfma_f32_16x16x32_bf16 v[146:149], a[64:67], v[182:185], v[146:149]
s_waitcnt lgkmcnt(1)
ds_read_b128 v[182:185], v210 offset:32768
v_cvt_pk_bf16_f32 v133, v172, v173
v_mfma_f32_16x16x32_bf16 v[138:141], a[20:23], v[186:189], v[138:141]
v_cvt_pk_bf16_f32 v94, v220, v221
v_cvt_pk_bf16_f32 v95, v222, v223
v_mfma_f32_16x16x32_bf16 v[142:145], a[44:47], v[186:189], v[142:145]
ds_write_b64 v212, v[94:95] offset:12288
v_mfma_f32_16x16x32_bf16 v[146:149], a[68:71], v[186:189], v[146:149]
v_cvt_pk_bf16_f32 v102, v138, v139
v_cvt_pk_bf16_f32 v103, v140, v141
v_cvt_pk_bf16_f32 v104, v142, v143
v_mfma_f32_16x16x16_bf16 v[138:141], v[82:83], v[76:77], 0
v_cvt_pk_bf16_f32 v105, v144, v145
v_exp_f32_e64 v150, v150
v_mfma_f32_16x16x16_bf16 v[142:145], v[100:101], v[76:77], 0
v_cvt_pk_bf16_f32 v106, v146, v147
v_cvt_pk_bf16_f32 v107, v148, v149
v_cvt_pk_bf16_f32 v180, v150, 0
v_exp_f32 v154, v154
v_mfma_f32_16x16x16_bf16 v[162:165], v[106:107], v[88:89], 0
v_exp_f32 v155, v155
v_exp_f32 v156, v156
v_mfma_f32_16x16x16_bf16 v[146:149], v[106:107], v[76:77], 0
ds_read_b128 v[186:189], v210 offset:33792
ds_read_b64 v[76:77], v215 offset:16
v_exp_f32 v157, v157
v_mfma_f32_16x16x32_bf16 v[138:141], v[78:81], v[72:75], v[138:141]
v_exp_f32 v158, v158
v_mfma_f32_16x16x32_bf16 v[142:145], v[96:99], v[72:75], v[142:145]
s_waitcnt lgkmcnt(3)
v_exp_f32 v159, v159
v_mfma_f32_16x16x32_bf16 v[118:121], v[182:185], a[72:75], 0
v_exp_f32 v138, v138
v_mfma_f32_16x16x32_bf16 v[126:129], v[182:185], a[96:99], 0
v_exp_f32 v139, v139
v_mfma_f32_16x16x32_bf16 v[134:137], v[182:185], a[120:123], 0
v_exp_f32 v140, v140
v_mfma_f32_16x16x32_bf16 v[146:149], v[102:105], v[72:75], v[146:149]
v_exp_f32 v141, v141
v_mfma_f32_16x16x32_bf16 v[90:93], a[216:219], v[182:185], 0
v_exp_f32 v142, v142
v_mfma_f32_16x16x32_bf16 v[170:173], a[240:243], v[182:185], 0
v_exp_f32 v143, v143
v_mfma_f32_16x16x32_bf16 v[220:223], v[232:235], v[182:185], 0
s_waitcnt lgkmcnt(1)
ds_read_b128 v[182:185], v210 offset:34816
v_cvt_pk_bf16_f32 v174, v138, v139
v_mfma_f32_16x16x32_bf16 v[118:121], v[186:189], a[76:79], v[118:121]
v_exp_f32 v144, v144
v_mfma_f32_16x16x32_bf16 v[126:129], v[186:189], a[100:103], v[126:129]
v_exp_f32 v145, v145
v_mfma_f32_16x16x32_bf16 v[134:137], v[186:189], a[124:127], v[134:137]
v_cvt_pk_bf16_f32 v175, v140, v141
v_cvt_pk_bf16_f32 v176, v142, v143
v_mfma_f32_16x16x32_bf16 v[90:93], a[220:223], v[186:189], v[90:93]
v_cvt_pk_bf16_f32 v177, v144, v145
v_exp_f32 v160, v160
v_mfma_f32_16x16x32_bf16 v[170:173], a[244:247], v[186:189], v[170:173]
v_exp_f32 v161, v161
v_mfma_f32_16x16x32_bf16 v[166:169], v[108:111], v[84:87], v[166:169]
v_exp_f32 v146, v146
v_mfma_f32_16x16x32_bf16 v[220:223], v[236:239], v[186:189], v[220:223]
s_waitcnt lgkmcnt(0)
ds_read_b128 v[186:189], v210 offset:35840
ds_read_b128 v[72:75], v215
v_mfma_f32_16x16x32_bf16 v[118:121], v[182:185], a[80:83], v[118:121]
v_exp_f32 v166, v166
v_mfma_f32_16x16x32_bf16 v[126:129], v[182:185], a[104:107], v[126:129]
v_exp_f32 v147, v147
v_mfma_f32_16x16x32_bf16 v[134:137], v[182:185], a[128:131], v[134:137]
v_exp_f32 v148, v148
v_mfma_f32_16x16x32_bf16 v[90:93], a[224:227], v[182:185], v[90:93]
v_exp_f32 v149, v149
v_mfma_f32_16x16x32_bf16 v[162:165], v[102:105], v[84:87], v[162:165]
v_cvt_pk_bf16_f32 v178, v146, v147
v_cvt_pk_bf16_f32 v179, v148, v149
v_mfma_f32_16x16x32_bf16 v[170:173], a[248:251], v[182:185], v[170:173]
v_mfma_f32_16x16x32_bf16 v[220:223], v[240:243], v[182:185], v[220:223]
s_waitcnt lgkmcnt(1)
ds_read_b128 v[182:185], v210 offset:36864
v_exp_f32 v162, v162
v_mfma_f32_16x16x32_bf16 v[118:121], v[186:189], a[84:87], v[118:121]
v_exp_f32 v163, v163
v_mfma_f32_16x16x32_bf16 v[126:129], v[186:189], a[108:111], v[126:129]
v_exp_f32 v164, v164
v_mfma_f32_16x16x32_bf16 v[134:137], v[186:189], a[132:135], v[134:137]
v_exp_f32 v165, v165
v_mfma_f32_16x16x32_bf16 v[90:93], a[228:231], v[186:189], v[90:93]
v_mfma_f32_16x16x32_bf16 v[170:173], a[252:255], v[186:189], v[170:173]
v_mfma_f32_16x16x32_bf16 v[220:223], v[244:247], v[186:189], v[220:223]
ds_read_b128 v[186:189], v210 offset:37888
s_waitcnt lgkmcnt(1)
v_mfma_f32_16x16x32_bf16 v[118:121], v[182:185], a[88:91], v[118:121]
v_mfma_f32_16x16x32_bf16 v[126:129], v[182:185], a[112:115], v[126:129]
v_mfma_f32_16x16x32_bf16 v[134:137], v[182:185], a[136:139], v[134:137]
v_mfma_f32_16x16x32_bf16 v[90:93], a[232:235], v[182:185], v[90:93]
v_mfma_f32_16x16x32_bf16 v[170:173], v[224:227], v[182:185], v[170:173]
s_nop 0
v_mfma_f32_16x16x32_bf16 v[220:223], v[248:251], v[182:185], v[220:223]
s_waitcnt lgkmcnt(0)
v_mfma_f32_16x16x32_bf16 v[118:121], v[186:189], a[92:95], v[118:121]
v_mfma_f32_16x16x32_bf16 v[126:129], v[186:189], a[116:119], v[126:129]
v_mfma_f32_16x16x32_bf16 v[134:137], v[186:189], a[140:143], v[134:137]
v_cvt_pk_bf16_f32 v118, v118, v119
v_cvt_pk_bf16_f32 v119, v120, v121
v_mfma_f32_16x16x32_bf16 v[90:93], a[236:239], v[186:189], v[90:93]
ds_read_u16 v120, v214 offset:1024
v_cvt_pk_bf16_f32 v126, v126, v127
v_mfma_f32_16x16x32_bf16 v[170:173], v[228:231], v[186:189], v[170:173]
v_cvt_pk_bf16_f32 v127, v128, v129
v_cvt_pk_bf16_f32 v134, v134, v135
v_mfma_f32_16x16x32_bf16 v[220:223], v[252:255], v[186:189], v[220:223]
ds_read_u16 v128, v214 offset:1032
v_cvt_pk_bf16_f32 v90, v90, v91
v_mfma_f32_16x16x32_bf16 v[150:153], v[190:193], v[174:177], 0
v_cvt_pk_bf16_f32 v91, v92, v93
v_cvt_pk_bf16_f32 v92, v170, v171
v_mfma_f32_16x16x32_bf16 v[138:141], v[114:117], v[174:177], 0
v_cvt_pk_bf16_f32 v93, v172, v173
v_cvt_pk_bf16_f32 v135, v136, v137
v_mfma_f32_16x16x32_bf16 v[142:145], v[122:125], v[174:177], 0
ds_read_u16 v136, v214 offset:1040
v_mov_b32 v121, 0
v_mfma_f32_16x16x32_bf16 v[146:149], v[130:133], v[174:177], 0
v_cvt_pk_bf16_f32 v174, v154, v155
v_cvt_pk_bf16_f32 v175, v156, v157
v_mfma_f32_16x16x32_bf16 v[150:153], v[190:193], v[178:181], v[150:153]
s_waitcnt lgkmcnt(2)
v_cvt_pk_bf16_f32 v176, v158, v159
v_cvt_pk_bf16_f32 v177, v160, v161
v_mfma_f32_16x16x32_bf16 v[138:141], v[118:121], v[178:181], v[138:141]
v_mov_b32 v129, 0
v_mov_b32 v137, 0
v_mfma_f32_16x16x32_bf16 v[154:157], v[114:117], v[174:177], 0
v_rcp_f32 v151, v150
v_mfma_f32_16x16x32_bf16 v[158:161], v[122:125], v[174:177], 0
s_waitcnt lgkmcnt(1)
v_max3_u32 v218, v218, v150, v151
v_mul_f32_e64 v151, s3, v151
v_mfma_f32_16x16x32_bf16 v[142:145], v[126:129], v[178:181], v[142:145]
s_waitcnt lgkmcnt(0)
v_mul_f32 v138, v138, v151
v_mul_f32_e64 v139, v139, v151
v_mfma_f32_16x16x32_bf16 v[146:149], v[134:137], v[178:181], v[146:149]
v_cvt_pk_bf16_f32 v180, v166, 0
v_mul_f32_e64 v140, v140, v151
v_mfma_f32_16x16x32_bf16 v[166:169], v[190:193], v[174:177], 0
v_mul_f32_e64 v141, v141, v151
v_cvt_pk_bf16_f32 v138, v138, v139
v_mul_f32 v142, v142, v151
v_mul_f32 v143, v143, v151
v_mul_f32 v144, v144, v151
v_mul_f32 v145, v145, v151
v_cvt_pk_bf16_f32 v139, v140, v141
v_cvt_pk_bf16_f32 v140, v142, v143
v_cvt_pk_bf16_f32 v141, v144, v145
v_cvt_pk_bf16_f32 v178, v162, v163
v_cvt_pk_bf16_f32 v179, v164, v165
v_mfma_f32_16x16x32_bf16 v[162:165], v[130:133], v[174:177], 0
ds_write_b128 v211, v[138:141] offset:38912
v_mfma_f32_16x16x32_bf16 v[138:141], v[78:81], v[90:93], 0
v_mul_f32 v146, v146, v151
v_mul_f32 v147, v147, v151
v_mfma_f32_16x16x32_bf16 v[166:169], v[190:193], v[178:181], v[166:169]
v_mul_f32 v148, v148, v151
v_mul_f32 v149, v149, v151
v_mfma_f32_16x16x32_bf16 v[154:157], v[118:121], v[178:181], v[154:157]
v_cvt_pk_bf16_f32 v142, v146, v147
v_cvt_pk_bf16_f32 v143, v148, v149
v_mfma_f32_16x16x32_bf16 v[158:161], v[126:129], v[178:181], v[158:161]
ds_write_b64 v212, v[142:143] offset:38912
v_mfma_f32_16x16x32_bf16 v[142:145], v[96:99], v[90:93], 0
v_rcp_f32_e64 v167, v166
v_mfma_f32_16x16x32_bf16 v[162:165], v[134:137], v[178:181], v[162:165]
v_max3_u32 v218, v218, v166, v167
v_cvt_pk_bf16_f32 v94, v220, v221
v_mfma_f32_16x16x32_bf16 v[150:153], v[108:111], v[90:93], v[206:209]
v_cvt_pk_bf16_f32 v95, v222, v223
v_mul_f32_e64 v167, s3, v167
v_mfma_f32_16x16x32_bf16 v[146:149], v[102:105], v[90:93], 0
v_mul_f32 v154, v154, v167
v_mul_f32 v155, v155, v167
v_mul_f32_e64 v156, v156, v167
v_mfma_f32_16x16x16_bf16 v[138:141], v[82:83], v[94:95], v[138:141]
v_mul_f32_e64 v157, v157, v167
v_cvt_pk_bf16_f32 v154, v154, v155
v_mul_f32_e64 v158, v158, v167
v_mfma_f32_16x16x16_bf16 v[142:145], v[100:101], v[94:95], v[142:145]
v_mul_f32 v159, v159, v167
v_mul_f32 v160, v160, v167
v_mul_f32_e64 v161, v161, v167
v_mfma_f32_16x16x16_bf16 v[150:153], v[112:113], v[94:95], v[150:153]
v_cvt_pk_bf16_f32 v155, v156, v157
v_cvt_pk_bf16_f32 v156, v158, v159
v_cvt_pk_bf16_f32 v157, v160, v161
v_mfma_f32_16x16x16_bf16 v[146:149], v[106:107], v[94:95], v[146:149]
v_mul_f32 v162, v162, v167
v_mul_f32 v163, v163, v167
v_mul_f32 v164, v164, v167
v_mul_f32 v165, v165, v167
v_mfma_f32_16x16x16_bf16 v[166:169], v[76:77], v[112:113], v[206:209]
v_cvt_pk_bf16_f32 v158, v162, v163
v_cvt_pk_bf16_f32 v159, v164, v165
v_exp_f32 v138, v138
v_mfma_f32_16x16x16_bf16 v[162:165], v[76:77], v[106:107], 0
v_exp_f32 v139, v139
v_exp_f32 v140, v140
v_mfma_f32_16x16x32_bf16 v[166:169], v[72:75], v[108:111], v[166:169]
ds_write_b128 v211, v[154:157] offset:45056
v_mfma_f32_16x16x16_bf16 v[154:157], v[76:77], v[82:83], 0
v_exp_f32 v141, v141
v_exp_f32 v142, v142
v_mfma_f32_16x16x32_bf16 v[162:165], v[72:75], v[102:105], v[162:165]
v_exp_f32 v143, v143
v_mfma_f32_16x16x32_bf16 v[154:157], v[72:75], v[78:81], v[154:157]
ds_write_b64 v212, v[158:159] offset:45056
v_mfma_f32_16x16x16_bf16 v[158:161], v[76:77], v[100:101], 0
v_exp_f32 v144, v144
v_exp_f32 v145, v145
v_exp_f32_e64 v150, v150
v_mfma_f32_16x16x32_bf16 v[158:161], v[72:75], v[96:99], v[158:161]
v_cvt_pk_bf16_f32 v174, v138, v139
v_cvt_pk_bf16_f32 v175, v140, v141
v_cvt_pk_bf16_f32 v176, v142, v143
v_cvt_pk_bf16_f32 v177, v144, v145
v_cvt_pk_bf16_f32 v180, v150, 0
v_exp_f32_e64 v146, v146
v_mfma_f32_16x16x32_bf16 v[150:153], v[190:193], v[174:177], 0
v_exp_f32 v147, v147
v_mfma_f32_16x16x32_bf16 v[138:141], v[114:117], v[174:177], 0
s_waitcnt lgkmcnt(0)
v_exp_f32 v148, v148
v_mfma_f32_16x16x32_bf16 v[142:145], v[122:125], v[174:177], 0
s_barrier
ds_read_b128 v[170:173], v210 offset:38912
ds_read_b128 v[182:185], v210 offset:39936
ds_read_b128 v[186:189], v210 offset:40960
v_exp_f32_e64 v149, v149
v_cvt_pk_bf16_f32 v178, v146, v147
v_cvt_pk_bf16_f32 v179, v148, v149
v_mfma_f32_16x16x32_bf16 v[146:149], v[130:133], v[174:177], 0
v_mov_b32_dpp v154, v158 quad_perm:[0,1,2,3] row_mask:0x2 bank_mask:0xf
v_mfma_f32_16x16x32_bf16 v[150:153], v[190:193], v[178:181], v[150:153]
v_mov_b32_dpp v154, v162 quad_perm:[0,1,2,3] row_mask:0x4 bank_mask:0xf
v_mfma_f32_16x16x32_bf16 v[138:141], v[118:121], v[178:181], v[138:141]
v_mov_b32_dpp v154, v167 quad_perm:[0,1,2,3] row_mask:0x8 bank_mask:0xf
v_exp_f32_e64 v154, v154
v_mfma_f32_16x16x32_bf16 v[142:145], v[126:129], v[178:181], v[142:145]
v_cvt_pk_bf16_f32 v154, v154, 0
v_rcp_f32 v151, v150
v_mfma_f32_16x16x32_bf16 v[146:149], v[134:137], v[178:181], v[146:149]
s_waitcnt lgkmcnt(2)
ds_write_b16 v214, v154
v_mfma_f32_16x16x32_bf16 v[36:39], a[144:147], v[170:173], v[36:39]
ds_read_b128 v[84:87], v215
ds_read_b128 v[88:91], v215 offset:16
v_mfma_f32_16x16x32_bf16 v[40:43], a[168:171], v[170:173], v[40:43]
s_nop 0
ds_read_b128 v[174:177], v217
ds_read_b128 v[178:181], v217 offset:528
v_mfma_f32_16x16x32_bf16 v[44:47], a[192:195], v[170:173], v[44:47]
s_waitcnt lgkmcnt(6)
ds_read_b128 v[170:173], v210 offset:41984
v_add_u32 v215, 1552, v215
v_mfma_f32_16x16x32_bf16 v[36:39], a[148:151], v[182:185], v[36:39]
v_mfma_f32_16x16x32_bf16 v[40:43], a[172:175], v[182:185], v[40:43]
v_mfma_f32_16x16x32_bf16 v[44:47], a[196:199], v[182:185], v[44:47]
s_nop 0
ds_read_b128 v[182:185], v210 offset:43008
s_waitcnt lgkmcnt(5)
v_mfma_f32_16x16x32_bf16 v[166:169], v[84:87], v[190:193], 0
v_mfma_f32_16x16x32_bf16 v[154:157], v[84:87], v[114:117], 0
v_mfma_f32_16x16x32_bf16 v[158:161], v[84:87], v[122:125], 0
v_mfma_f32_16x16x32_bf16 v[162:165], v[84:87], v[130:133], 0
s_waitcnt lgkmcnt(4)
v_mfma_f32_16x16x32_bf16 v[166:169], v[88:91], v[190:193], v[166:169]
v_mfma_f32_16x16x32_bf16 v[154:157], v[88:91], v[118:121], v[154:157]
v_mfma_f32_16x16x32_bf16 v[158:161], v[88:91], v[126:129], v[158:161]
v_rcp_f32 v167, v166
v_mfma_f32_16x16x32_bf16 v[162:165], v[88:91], v[134:137], v[162:165]
v_max3_u32 v218, v218, v166, v167
v_max3_u32 v218, v218, v150, v151
v_mfma_f32_16x16x32_bf16 v[36:39], a[152:155], v[186:189], v[36:39]
v_mul_f32 v151, s3, v151
v_mul_f32 v138, v138, v151
v_mfma_f32_16x16x32_bf16 v[40:43], a[176:179], v[186:189], v[40:43]
v_mul_f32_e64 v139, v139, v151
v_mul_f32 v140, v140, v151
v_mfma_f32_16x16x32_bf16 v[44:47], a[200:203], v[186:189], v[44:47]
s_waitcnt lgkmcnt(1)
ds_read_b128 v[186:189], v210 offset:44032
v_mul_f32_e64 v141, v141, v151
v_mfma_f32_16x16x32_bf16 v[36:39], a[156:159], v[170:173], v[36:39]
v_cvt_pk_bf16_f32 v138, v138, v139
v_mul_f32_e64 v142, v142, v151
v_mfma_f32_16x16x32_bf16 v[40:43], a[180:183], v[170:173], v[40:43]
v_mul_f32_e64 v143, v143, v151
v_mul_f32 v144, v144, v151
v_mfma_f32_16x16x32_bf16 v[44:47], a[204:207], v[170:173], v[44:47]
s_waitcnt lgkmcnt(1)
ds_read_b128 v[170:173], v210 offset:45056
v_mul_f32_e64 v145, v145, v151
v_mfma_f32_16x16x32_bf16 v[36:39], a[160:163], v[182:185], v[36:39]
v_cvt_pk_bf16_f32 v139, v140, v141
v_cvt_pk_bf16_f32 v140, v142, v143
v_mfma_f32_16x16x32_bf16 v[40:43], a[184:187], v[182:185], v[40:43]
v_cvt_pk_bf16_f32 v141, v144, v145
v_mul_f32 v146, v146, v151
v_mfma_f32_16x16x32_bf16 v[44:47], a[208:211], v[182:185], v[44:47]
s_waitcnt lgkmcnt(1)
ds_read_b128 v[182:185], v210 offset:46080
ds_write_b128 v211, v[138:141] offset:51200
v_mfma_f32_16x16x32_bf16 v[36:39], a[164:167], v[186:189], v[36:39]
v_mul_f32 v147, v147, v151
v_mul_f32 v148, v148, v151
v_mfma_f32_16x16x32_bf16 v[40:43], a[188:191], v[186:189], v[40:43]
v_mul_f32 v149, v149, v151
v_cvt_pk_bf16_f32 v142, v146, v147
v_mfma_f32_16x16x32_bf16 v[44:47], a[212:215], v[186:189], v[44:47]
s_waitcnt lgkmcnt(2)
ds_read_b128 v[186:189], v210 offset:47104
v_cvt_pk_bf16_f32 v143, v148, v149
v_mfma_f32_16x16x32_bf16 v[48:51], a[144:147], v[170:173], v[48:51]
ds_write_b64 v212, v[142:143] offset:51200
v_mfma_f32_16x16x32_bf16 v[52:55], a[168:171], v[170:173], v[52:55]
s_nop 0
v_cvt_pk_bf16_f32 v72, v36, v37
v_cvt_pk_bf16_f32 v73, v38, v39
v_mfma_f32_16x16x32_bf16 v[56:59], a[192:195], v[170:173], v[56:59]
s_waitcnt lgkmcnt(3)
ds_read_b128 v[170:173], v210 offset:48128
buffer_store_dwordx2 v[72:73], v203, s[8:11], s39 offen
v_mov_b32_dpp v154, v158 quad_perm:[0,1,2,3] row_mask:0x2 bank_mask:0xf
v_mfma_f32_16x16x32_bf16 v[48:51], a[148:151], v[182:185], v[48:51]
v_mul_f32_e64 v167, s3, v167
v_mov_b32_dpp v154, v162 quad_perm:[0,1,2,3] row_mask:0x4 bank_mask:0xf
v_mfma_f32_16x16x32_bf16 v[52:55], a[172:175], v[182:185], v[52:55]
v_mul_f32 v154, v154, v167
v_cvt_pk_bf16_f32 v154, v154, 0
v_mfma_f32_16x16x32_bf16 v[56:59], a[196:199], v[182:185], v[56:59]
s_waitcnt lgkmcnt(2)
ds_read_b128 v[182:185], v210 offset:49152
ds_write_b16 v214, v154
v_mfma_f32_16x16x32_bf16 v[48:51], a[152:155], v[186:189], v[48:51]
s_nop 0
v_cvt_pk_bf16_f32 v74, v40, v41
v_cvt_pk_bf16_f32 v75, v42, v43
v_mfma_f32_16x16x32_bf16 v[52:55], a[176:179], v[186:189], v[52:55]
s_waitcnt lgkmcnt(2)
v_cvt_pk_bf16_f32 v76, v44, v45
v_cvt_pk_bf16_f32 v77, v46, v47
v_mfma_f32_16x16x32_bf16 v[56:59], a[200:203], v[186:189], v[56:59]
s_barrier
v_mfma_f32_16x16x32_bf16 v[48:51], a[156:159], v[170:173], v[48:51]
s_nop 0
ds_read_b128 v[186:189], v210 offset:50176
v_add_u32 v214, 1552, v214
v_mfma_f32_16x16x32_bf16 v[52:55], a[180:183], v[170:173], v[52:55]
v_mfma_f32_16x16x32_bf16 v[56:59], a[204:207], v[170:173], v[56:59]
ds_read_b128 v[170:173], v210 offset:51200
s_waitcnt lgkmcnt(3)
v_mfma_f32_16x16x32_bf16 v[48:51], a[160:163], v[182:185], v[48:51]
v_mfma_f32_16x16x32_bf16 v[52:55], a[184:187], v[182:185], v[52:55]
buffer_store_dwordx2 v[74:75], v203, s[8:11], s39 offen offset:32
v_mfma_f32_16x16x32_bf16 v[56:59], a[208:211], v[182:185], v[56:59]
ds_read_b128 v[182:185], v210 offset:52224
s_waitcnt lgkmcnt(2)
v_mfma_f32_16x16x32_bf16 v[48:51], a[164:167], v[186:189], v[48:51]
v_mfma_f32_16x16x32_bf16 v[52:55], a[188:191], v[186:189], v[52:55]
s_nop 0
v_mfma_f32_16x16x32_bf16 v[56:59], a[212:215], v[186:189], v[56:59]
s_waitcnt lgkmcnt(1)
ds_read_b128 v[186:189], v210 offset:53248
v_cvt_pk_bf16_f32 v78, v48, v49
v_mfma_f32_16x16x32_bf16 v[60:63], a[144:147], v[170:173], v[60:63]
v_cvt_pk_bf16_f32 v79, v50, v51
v_cvt_pk_bf16_f32 v80, v52, v53
v_mfma_f32_16x16x32_bf16 v[64:67], a[168:171], v[170:173], v[64:67]
s_nop 0
v_cvt_pk_bf16_f32 v81, v54, v55
v_cvt_pk_bf16_f32 v82, v56, v57
v_mfma_f32_16x16x32_bf16 v[68:71], a[192:195], v[170:173], v[68:71]
s_waitcnt lgkmcnt(1)
ds_read_b128 v[170:173], v210 offset:54272
v_cvt_pk_bf16_f32 v83, v58, v59
v_mfma_f32_16x16x32_bf16 v[60:63], a[148:151], v[182:185], v[60:63]
v_mfma_f32_16x16x32_bf16 v[64:67], a[172:175], v[182:185], v[64:67]
v_mfma_f32_16x16x32_bf16 v[68:71], a[196:199], v[182:185], v[68:71]
ds_read_b128 v[182:185], v210 offset:55296
s_waitcnt lgkmcnt(2)
v_mfma_f32_16x16x32_bf16 v[60:63], a[152:155], v[186:189], v[60:63]
v_mfma_f32_16x16x32_bf16 v[64:67], a[176:179], v[186:189], v[64:67]
v_mfma_f32_16x16x32_bf16 v[68:71], a[200:203], v[186:189], v[68:71]
ds_read_b128 v[186:189], v210 offset:56320
s_waitcnt lgkmcnt(2)
v_mfma_f32_16x16x32_bf16 v[60:63], a[156:159], v[170:173], v[60:63]
v_mfma_f32_16x16x32_bf16 v[64:67], a[180:183], v[170:173], v[64:67]
v_mfma_f32_16x16x32_bf16 v[68:71], a[204:207], v[170:173], v[68:71]
buffer_store_dwordx2 v[76:77], v203, s[8:11], s39 offen offset:64
s_waitcnt lgkmcnt(1)
v_mfma_f32_16x16x32_bf16 v[60:63], a[160:163], v[182:185], v[60:63]
v_mfma_f32_16x16x32_bf16 v[64:67], a[184:187], v[182:185], v[64:67]
v_mfma_f32_16x16x32_bf16 v[68:71], a[208:211], v[182:185], v[68:71]
ds_read_b128 v[182:185], v210
s_waitcnt lgkmcnt(1)
v_mfma_f32_16x16x32_bf16 v[60:63], a[164:167], v[186:189], v[60:63]
v_mfma_f32_16x16x32_bf16 v[64:67], a[188:191], v[186:189], v[64:67]
v_mfma_f32_16x16x32_bf16 v[68:71], a[212:215], v[186:189], v[68:71]
s_nop 0
ds_read_b128 v[186:189], v210 offset:1024
v_cvt_pk_bf16_f32 v116, v60, v61
v_subrev_u32 v60, 37120, v210
v_lshrrev_b32 v61, 4, v60
v_cvt_pk_bf16_f32 v117, v62, v63
v_cvt_pk_bf16_f32 v124, v64, v65
v_and_b32_e64 v61, 15, v61
v_cvt_pk_bf16_f32 v133, v70, v71
v_mov_b32_dpp v70, v197 row_newbcast:0 row_mask:0xf bank_mask:0xf
v_add_u32 v70, 17248, v70
v_mov_b32_dpp v71, v200 row_newbcast:0 row_mask:0xf bank_mask:0xf
v_add_u32 v71, 17248, v71
s_waitcnt lgkmcnt(1)
v_mfma_f32_16x16x32_bf16 v[138:141], a[0:3], v[182:185], 0
s_nop 0
ds_read_b128 v[100:103], v70
ds_read_b128 v[104:107], v70 offset:16
v_mfma_f32_16x16x32_bf16 v[142:145], a[24:27], v[182:185], 0
ds_read_b128 v[84:87], v71
v_cvt_pk_bf16_f32 v132, v68, v69
v_mfma_f32_16x16x32_bf16 v[146:149], a[48:51], v[182:185], 0
v_mov_b32_dpp v69, v194 row_newbcast:0 row_mask:0xf bank_mask:0xf
v_add_u32 v69, 17248, v69
v_mfma_f32_16x16x32_bf16 v[150:153], a[216:219], v[182:185], 0
ds_read_b128 v[92:95], v69
ds_read_b128 v[96:99], v69 offset:16
v_mfma_f32_16x16x32_bf16 v[154:157], a[240:243], v[182:185], 0
s_nop 0
v_lshrrev_b32 v62, 8, v60
v_mul_u32_u24 v63, 1552, v61
v_mfma_f32_16x16x32_bf16 v[158:161], v[232:235], v[182:185], 0
v_mul_u32_u24 v64, 784, v61
v_lshl_add_u32 v63, v62, 5, v63
v_mfma_f32_16x16x32_bf16 v[162:165], v[182:185], a[72:75], 0
buffer_store_dwordx2 v[78:79], v204, s[8:11], s39 offen
v_lshl_add_u32 v64, v62, 4, v64
v_mfma_f32_16x16x32_bf16 v[166:169], v[182:185], a[96:99], 0
s_waitcnt lgkmcnt(2)
v_add_u32 v63, 94464, v63
v_add_u32 v64, s41, v64
v_mfma_f32_16x16x32_bf16 v[48:51], v[174:177], v[84:87], 0
s_add_u32 s41, s33, 0
ds_read_b128 v[174:177], v217 offset:1056
ds_read_b128 v[84:87], v71 offset:32
v_mfma_f32_16x16x32_bf16 v[170:173], v[182:185], a[120:123], 0
s_waitcnt lgkmcnt(2)
ds_read_b128 v[36:39], v64
ds_read_b128 v[40:43], v64 offset:64
v_smfmac_f32_16x16x64_bf16 v[48:51], v[178:181], v[92:99], v213
ds_read_b128 v[178:181], v217 offset:1584
ds_read_b128 v[92:95], v69 offset:32
v_mfma_f32_16x16x32_bf16 v[138:141], a[4:7], v[186:189], v[138:141]
ds_read_b128 v[96:99], v69 offset:48
v_cvt_pk_bf16_f32 v125, v66, v67
v_mfma_f32_16x16x32_bf16 v[142:145], a[28:31], v[186:189], v[142:145]
s_nop 0
ds_read_b128 v[182:185], v210 offset:2048
v_lshlrev_b32 v67, 5, v61
v_mfma_f32_16x16x32_bf16 v[146:149], a[52:55], v[186:189], v[146:149]
ds_read_b128 v[44:47], v64 offset:128
v_add_u32 v67, s41, v67
v_mfma_f32_16x16x32_bf16 v[150:153], a[220:223], v[186:189], v[150:153]
s_waitcnt lgkmcnt(8)
v_mul_hi_u32 v68, v67, s42
v_mul_u32_u24 v65, 73, v68
v_smfmac_f32_16x16x64_bf16 v[48:51], v[174:177], v[100:107], v213
s_mov_b32 s42, 1373568
ds_read_b128 v[100:103], v70 offset:32
ds_read_b128 v[104:107], v70 offset:48
v_mfma_f32_16x16x32_bf16 v[154:157], a[244:247], v[186:189], v[154:157]
s_add_u32 s41, s33, 512
ds_read_b128 v[174:177], v217 offset:2112
v_mul_lo_u32 v68, v68, s42
v_mfma_f32_16x16x32_bf16 v[158:161], v[236:239], v[186:189], v[158:161]
s_mul_i32 s42, s32, 96
v_mul_f32 v119, v48, v48
v_add_f32 v118, v48, v49
v_mfma_f32_16x16x32_bf16 v[162:165], v[186:189], a[76:79], v[162:165]
s_waitcnt lgkmcnt(7)
v_fmac_f32 v119, v49, v49
v_add_f32_e64 v118, v118, v50
v_mfma_f32_16x16x32_bf16 v[52:55], v[178:181], v[84:87], 0
ds_read_b128 v[178:181], v217 offset:2640
ds_read_b128 v[84:87], v71 offset:64
v_mfma_f32_16x16x32_bf16 v[166:169], v[186:189], a[100:103], v[166:169]
v_fmac_f32_e64 v119, v50, v50
v_add_f32 v118, v118, v51
v_mfma_f32_16x16x32_bf16 v[170:173], v[186:189], a[124:127], v[170:173]
s_waitcnt lgkmcnt(6)
v_fmac_f32 v119, v51, v51
v_sub_u32 v65, v67, v65
v_mfma_f32_16x16x32_bf16 v[138:141], a[8:11], v[182:185], v[138:141]
ds_read_b128 v[186:189], v210 offset:3072
buffer_store_dwordx2 v[80:81], v204, s[8:11], s39 offen offset:32
v_cmp_gt_u32 vcc, s34, v67
v_mfma_f32_16x16x32_bf16 v[142:145], a[32:35], v[182:185], v[142:145]
v_mul_u32_u24 v65, 2688, v65
v_add3_u32 v65, v65, v68, s42
v_mfma_f32_16x16x32_bf16 v[146:149], a[56:59], v[182:185], v[146:149]
s_waitcnt lgkmcnt(3)
v_mov_b32 v68, 1879048192
v_cndmask_b32 v65, v68, v65, vcc
v_smfmac_f32_16x16x64_bf16 v[52:55], v[174:177], v[92:99], v213
s_waitcnt lgkmcnt(2)
ds_read_b128 v[174:177], v217 offset:3168
ds_read_b128 v[92:95], v69 offset:64
v_smfmac_f32_16x16x64_bf16 v[52:55], v[178:181], v[100:107], v213
s_mov_b32 s42, 58835169
ds_read_b128 v[100:103], v70 offset:64
ds_read_b128 v[104:107], v70 offset:80
v_mfma_f32_16x16x32_bf16 v[150:153], a[224:227], v[182:185], v[150:153]
ds_read_b128 v[96:99], v69 offset:80
ds_read_b128 v[178:181], v217 offset:3696
v_mfma_f32_16x16x32_bf16 v[154:157], a[248:251], v[182:185], v[154:157]
v_add_f32 v118, v118, v52
v_fmac_f32 v119, v52, v52
v_mfma_f32_16x16x32_bf16 v[158:161], v[240:243], v[182:185], v[158:161]
v_add_f32 v118, v118, v53
v_fmac_f32 v119, v53, v53
v_mfma_f32_16x16x32_bf16 v[162:165], v[182:185], a[80:83], v[162:165]
v_add_f32 v118, v118, v54
v_fmac_f32 v119, v54, v54
v_mfma_f32_16x16x32_bf16 v[166:169], v[182:185], a[104:107], v[166:169]
s_waitcnt lgkmcnt(5)
v_add_f32 v118, v118, v55
v_fmac_f32_e64 v119, v55, v55
v_mfma_f32_16x16x32_bf16 v[56:59], v[174:177], v[84:87], 0
ds_read_b128 v[174:177], v217 offset:4224
ds_read_b128 v[84:87], v63
v_mfma_f32_16x16x32_bf16 v[170:173], v[182:185], a[128:131], v[170:173]
s_nop 0
ds_read_b128 v[182:185], v210 offset:4096
v_cmp_gt_u32 vcc, 4, v61
v_mfma_f32_16x16x32_bf16 v[138:141], a[12:15], v[186:189], v[138:141]
v_lshlrev_b32 v67, 5, v61
v_mov_b32 v68, s97
v_mfma_f32_16x16x32_bf16 v[142:145], a[36:39], v[186:189], v[142:145]
v_add_u32 v67, s41, v67
v_cndmask_b32 v67, v68, v67, vcc
v_mfma_f32_16x16x32_bf16 v[146:149], a[60:63], v[186:189], v[146:149]
s_waitcnt lgkmcnt(3)
v_cmp_gt_u32 vcc, 5, v61
v_mov_b32 v68, 6000
v_smfmac_f32_16x16x64_bf16 v[56:59], v[178:181], v[92:99], v213
ds_read_b128 v[96:99], v63 offset:384
buffer_store_dwordx2 v[82:83], v204, s[8:11], s39 offen offset:64
v_mov_b32 v181, 0
s_waitcnt lgkmcnt(3)
v_smfmac_f32_16x16x64_bf16 v[56:59], v[174:177], v[100:107], v213
s_waitcnt lgkmcnt(2)
ds_read_b64 v[100:101], v63 offset:16
v_cndmask_b32 v67, v68, v67, vcc
v_mfma_f32_16x16x32_bf16 v[36:39], a[144:147], v[84:87], v[36:39]
v_mul_hi_u32 v68, v67, s42
v_mul_u32_u24 v66, 73, v68
v_mfma_f32_16x16x32_bf16 v[40:43], a[168:171], v[84:87], v[40:43]
s_mov_b32 s42, 1373568
v_add_f32 v118, v118, v56
v_fmac_f32 v119, v56, v56
v_mfma_f32_16x16x32_bf16 v[44:47], a[192:195], v[84:87], v[44:47]
v_add_f32 v118, v118, v57
v_fmac_f32 v119, v57, v57
v_mfma_f32_16x16x32_bf16 v[150:153], a[228:231], v[186:189], v[150:153]
v_add_f32 v118, v118, v58
v_fmac_f32 v119, v58, v58
v_mfma_f32_16x16x32_bf16 v[154:157], a[252:255], v[186:189], v[154:157]
v_add_f32 v118, v118, v59
v_fmac_f32 v119, v59, v59
v_mfma_f32_16x16x32_bf16 v[158:161], v[244:247], v[186:189], v[158:161]
v_permlane16_swap_b32 v118, v119
v_mfma_f32_16x16x32_bf16 v[162:165], v[186:189], a[84:87], v[162:165]
v_add_f32 v118, v118, v119
v_mov_b32_e64 v126, v118
v_mfma_f32_16x16x32_bf16 v[166:169], v[186:189], a[108:111], v[166:169]
v_permlane32_swap_b32 v118, v126
v_mfma_f32_16x16x32_bf16 v[170:173], v[186:189], a[132:135], v[170:173]
s_waitcnt lgkmcnt(2)
v_add_f32_e64 v118, v118, v126
v_mul_lo_u32 v68, v68, s42
v_mfma_f32_16x16x32_bf16 v[138:141], a[16:19], v[182:185], v[138:141]
s_mul_i32 s42, s32, 96
ds_write_b32 v209, v118
v_mfma_f32_16x16x32_bf16 v[142:145], a[40:43], v[182:185], v[142:145]
ds_read_b128 v[186:189], v210 offset:5120
v_sub_u32 v66, v67, v66
v_mfma_f32_16x16x32_bf16 v[146:149], a[64:67], v[182:185], v[146:149]
v_cmp_gt_u32 vcc, s34, v67
v_mul_u32_u24 v66, 2688, v66
v_mfma_f32_16x16x32_bf16 v[150:153], a[232:235], v[182:185], v[150:153]
v_add3_u32 v66, v66, v68, s42
v_mov_b32 v68, 1879048192
v_mfma_f32_16x16x32_bf16 v[154:157], v[224:227], v[182:185], v[154:157]
s_nop 0
v_cndmask_b32 v66, v68, v66, vcc
v_lshl_add_u32 v65, v62, 3, v65
v_mfma_f32_16x16x32_bf16 v[158:161], v[248:251], v[182:185], v[158:161]
s_nop 0
buffer_store_dwordx2 v[116:117], v205, s[8:11], s39 offen
v_lshl_add_u32 v66, v62, 3, v66
v_mfma_f32_16x16x32_bf16 v[162:165], v[182:185], a[88:91], v[162:165]
s_waitcnt lgkmcnt(1)
v_add_u32 v65, 785664, v65
v_add_u32 v66, 785664, v66
v_mfma_f32_16x16x32_bf16 v[166:169], v[182:185], a[112:115], v[166:169]
s_barrier
v_mfma_f32_16x16x32_bf16 v[170:173], v[182:185], a[136:139], v[170:173]
s_waitcnt lgkmcnt(0)
ds_read_b128 v[102:105], v210 offset:18432
ds_read_b128 v[106:109], v210 offset:19456
v_mfma_f32_16x16x32_bf16 v[138:141], a[20:23], v[186:189], v[138:141]
ds_read_b128 v[182:185], v210 offset:6144
v_mfma_f32_16x16x32_bf16 v[142:145], a[44:47], v[186:189], v[142:145]
v_mfma_f32_16x16x32_bf16 v[146:149], a[68:71], v[186:189], v[146:149]
v_cvt_pk_bf16_f32 v78, v138, v139
v_cvt_pk_bf16_f32 v79, v140, v141
v_mfma_f32_16x16x32_bf16 v[150:153], a[236:239], v[186:189], v[150:153]
v_cvt_pk_bf16_f32 v80, v142, v143
v_cvt_pk_bf16_f32 v81, v144, v145
v_mfma_f32_16x16x32_bf16 v[154:157], v[228:231], v[186:189], v[154:157]
v_cvt_pk_bf16_f32 v82, v146, v147
v_cvt_pk_bf16_f32 v83, v148, v149
v_mfma_f32_16x16x32_bf16 v[158:161], v[252:255], v[186:189], v[158:161]
s_waitcnt lgkmcnt(2)
v_add_f32 v102, v102, v103
v_add_f32_e64 v104, v104, v105
v_mfma_f32_16x16x32_bf16 v[162:165], v[186:189], a[92:95], v[162:165]
s_waitcnt lgkmcnt(1)
v_add_f32 v106, v106, v107
v_add_f32_e64 v108, v108, v109
v_mfma_f32_16x16x32_bf16 v[166:169], v[186:189], a[116:119], v[166:169]
v_add_f32 v102, v102, v104
v_add_f32 v106, v106, v108
v_mfma_f32_16x16x32_bf16 v[170:173], v[186:189], a[140:143], v[170:173]
s_waitcnt lgkmcnt(0)
v_mul_f32 v103, s48, v102
v_mul_f32_e64 v104, s73, v102
v_mfma_f32_16x16x32_bf16 v[138:141], a[0:3], v[182:185], 0
v_mul_f32_e64 v106, s73, v106
v_fma_f32 v106, -v103, v104, v106
v_mfma_f32_16x16x32_bf16 v[142:145], a[24:27], v[182:185], 0
ds_read_b64 v[104:105], v63 offset:272
v_max_f32_e64 v106, 0, v106
v_mfma_f32_16x16x32_bf16 v[146:149], a[48:51], v[182:185], 0
v_add_f32_e64 v106, s49, v106
v_rsq_f32 v102, v106
s_nop 0
v_mul_f32_e64 v103, -v103, v102
ds_write_b64 v211, v[102:103] offset:20480
buffer_store_dwordx2 v[124:125], v205, s[8:11], s39 offen offset:32
ds_read_b64 v[118:119], v219 offset:20480
ds_read_b64 v[102:103], v63 offset:144
ds_read_b64 v[106:107], v63 offset:400
ds_read_b128 v[186:189], v210 offset:7168
v_cvt_pk_bf16_f32 v72, v150, v151
v_cvt_pk_bf16_f32 v73, v152, v153
v_mfma_f32_16x16x32_bf16 v[150:153], a[216:219], v[182:185], 0
v_cvt_pk_bf16_f32 v74, v154, v155
v_cvt_pk_bf16_f32 v75, v156, v157
v_mfma_f32_16x16x32_bf16 v[154:157], a[240:243], v[182:185], 0
v_cvt_pk_bf16_f32 v76, v158, v159
v_cvt_pk_bf16_f32 v77, v160, v161
v_mfma_f32_16x16x32_bf16 v[158:161], v[232:235], v[182:185], 0
s_nop 0
v_cvt_pk_bf16_f32 v114, v162, v163
v_cvt_pk_bf16_f32 v115, v164, v165
v_mfma_f32_16x16x32_bf16 v[162:165], v[182:185], a[72:75], 0
s_waitcnt lgkmcnt(3)
v_fma_f32 v220, v48, v118, v119
v_fma_f32 v221, v49, v118, v119
v_fma_f32 v222, v50, v118, v119
v_fma_f32 v223, v51, v118, v119
v_cvt_pk_bf16_f32 v90, v220, v221
v_cvt_pk_bf16_f32 v91, v222, v223
v_fma_f32 v220, v52, v118, v119
v_fma_f32 v221, v53, v118, v119
v_fma_f32 v222, v54, v118, v119
v_fma_f32 v223, v55, v118, v119
s_waitcnt lgkmcnt(0)
v_mfma_f32_16x16x32_bf16 v[138:141], a[4:7], v[186:189], v[138:141]
s_nop 0
v_cvt_pk_bf16_f32 v92, v220, v221
v_cvt_pk_bf16_f32 v93, v222, v223
v_mfma_f32_16x16x32_bf16 v[142:145], a[28:31], v[186:189], v[142:145]
ds_write_b128 v211, v[90:93] offset:20480
v_mfma_f32_16x16x32_bf16 v[146:149], a[52:55], v[186:189], v[146:149]
v_fma_f32 v220, v56, v118, v119
v_fma_f32 v221, v57, v118, v119
v_mfma_f32_16x16x32_bf16 v[150:153], a[220:223], v[186:189], v[150:153]
v_fma_f32 v222, v58, v118, v119
v_fma_f32 v223, v59, v118, v119
v_mfma_f32_16x16x32_bf16 v[154:157], a[244:247], v[186:189], v[154:157]
ds_read_b128 v[88:91], v63 offset:128
v_cvt_pk_bf16_f32 v94, v220, v221
v_mfma_f32_16x16x32_bf16 v[158:161], v[236:239], v[186:189], v[158:161]
v_cvt_pk_bf16_f32 v95, v222, v223
v_cvt_pk_bf16_f32 v122, v166, v167
v_mfma_f32_16x16x32_bf16 v[162:165], v[186:189], a[76:79], v[162:165]
ds_write_b64 v212, v[94:95] offset:20480
v_cvt_pk_bf16_f32 v123, v168, v169
v_mfma_f32_16x16x32_bf16 v[166:169], v[182:185], a[96:99], 0
v_cvt_pk_bf16_f32 v130, v170, v171
v_cvt_pk_bf16_f32 v131, v172, v173
v_mfma_f32_16x16x32_bf16 v[170:173], v[182:185], a[120:123], 0
ds_read_b128 v[92:95], v63 offset:256
ds_read_b128 v[182:185], v210 offset:8192
v_mfma_f32_16x16x32_bf16 v[166:169], v[186:189], a[100:103], v[166:169]
s_waitcnt lgkmcnt(3)
buffer_store_dwordx2 v[132:133], v205, s[8:11], s39 offen offset:64
s_mov_b64 exec, s[56:57]
ds_read_b128 v[48:51], v64 offset:12544
s_mov_b64 exec, -1
v_mfma_f32_16x16x32_bf16 v[36:39], a[148:151], v[88:91], v[36:39]
s_mov_b64 exec, s[56:57]
ds_read_b128 v[52:55], v64 offset:12608
s_mov_b64 exec, -1
v_mfma_f32_16x16x32_bf16 v[40:43], a[172:175], v[88:91], v[40:43]
s_waitcnt lgkmcnt(4)
s_mov_b64 exec, s[56:57]
ds_read_b128 v[56:59], v64 offset:12672
s_mov_b64 exec, -1
v_mfma_f32_16x16x32_bf16 v[44:47], a[196:199], v[88:91], v[44:47]
s_barrier
s_waitcnt lgkmcnt(4)
v_mfma_f32_16x16x32_bf16 v[36:39], a[152:155], v[92:95], v[36:39]
v_mfma_f32_16x16x32_bf16 v[36:39], a[156:159], v[96:99], v[36:39]
v_mfma_f32_16x16x32_bf16 v[36:39], a[160:163], v[100:103], v[36:39]
v_mfma_f32_16x16x32_bf16 v[36:39], a[164:167], v[104:107], v[36:39]
v_mfma_f32_16x16x32_bf16 v[40:43], a[176:179], v[92:95], v[40:43]
v_mfma_f32_16x16x32_bf16 v[40:43], a[180:183], v[96:99], v[40:43]
v_cvt_pk_bf16_f32 v36, v36, v37
v_cvt_pk_bf16_f32 v37, v38, v39
v_mfma_f32_16x16x32_bf16 v[40:43], a[184:187], v[100:103], v[40:43]
buffer_store_dwordx2 v[36:37], v65, s[8:11], 0 offen
v_mfma_f32_16x16x32_bf16 v[40:43], a[188:191], v[104:107], v[40:43]
v_mfma_f32_16x16x32_bf16 v[44:47], a[200:203], v[92:95], v[44:47]
v_mfma_f32_16x16x32_bf16 v[44:47], a[204:207], v[96:99], v[44:47]
v_cvt_pk_bf16_f32 v40, v40, v41
v_cvt_pk_bf16_f32 v41, v42, v43
v_mfma_f32_16x16x32_bf16 v[44:47], a[208:211], v[100:103], v[44:47]
v_mfma_f32_16x16x32_bf16 v[44:47], a[212:215], v[104:107], v[44:47]
v_mfma_f32_16x16x32_bf16 v[170:173], v[186:189], a[124:127], v[170:173]
s_nop 0
ds_read_b128 v[186:189], v210 offset:9216
s_waitcnt lgkmcnt(4)
v_mfma_f32_16x16x32_bf16 v[138:141], a[8:11], v[182:185], v[138:141]
v_cvt_pk_bf16_f32 v44, v44, v45
v_cvt_pk_bf16_f32 v45, v46, v47
v_mfma_f32_16x16x32_bf16 v[142:145], a[32:35], v[182:185], v[142:145]
v_mfma_f32_16x16x32_bf16 v[146:149], a[56:59], v[182:185], v[146:149]
v_mfma_f32_16x16x32_bf16 v[150:153], a[224:227], v[182:185], v[150:153]
v_mfma_f32_16x16x32_bf16 v[154:157], a[248:251], v[182:185], v[154:157]
v_mfma_f32_16x16x32_bf16 v[158:161], v[240:243], v[182:185], v[158:161]
v_mfma_f32_16x16x32_bf16 v[162:165], v[182:185], a[80:83], v[162:165]
v_mfma_f32_16x16x32_bf16 v[166:169], v[182:185], a[104:107], v[166:169]
v_mfma_f32_16x16x32_bf16 v[170:173], v[182:185], a[128:131], v[170:173]
ds_read_b128 v[182:185], v210 offset:10240
s_waitcnt lgkmcnt(1)
v_mfma_f32_16x16x32_bf16 v[138:141], a[12:15], v[186:189], v[138:141]
buffer_store_dwordx2 v[40:41], v65, s[8:11], 0 offen offset:32
v_mfma_f32_16x16x32_bf16 v[142:145], a[36:39], v[186:189], v[142:145]
v_mfma_f32_16x16x32_bf16 v[146:149], a[60:63], v[186:189], v[146:149]
v_mfma_f32_16x16x32_bf16 v[150:153], a[228:231], v[186:189], v[150:153]
v_mfma_f32_16x16x32_bf16 v[154:157], a[252:255], v[186:189], v[154:157]
v_mfma_f32_16x16x32_bf16 v[158:161], v[244:247], v[186:189], v[158:161]
v_mfma_f32_16x16x32_bf16 v[162:165], v[186:189], a[84:87], v[162:165]
v_mfma_f32_16x16x32_bf16 v[166:169], v[186:189], a[108:111], v[166:169]
v_mfma_f32_16x16x32_bf16 v[170:173], v[186:189], a[132:135], v[170:173]
ds_read_b128 v[186:189], v210 offset:11264
s_waitcnt lgkmcnt(1)
v_mfma_f32_16x16x32_bf16 v[138:141], a[16:19], v[182:185], v[138:141]
v_mfma_f32_16x16x32_bf16 v[142:145], a[40:43], v[182:185], v[142:145]
v_mfma_f32_16x16x32_bf16 v[146:149], a[64:67], v[182:185], v[146:149]
v_mfma_f32_16x16x32_bf16 v[150:153], a[232:235], v[182:185], v[150:153]
v_mfma_f32_16x16x32_bf16 v[154:157], v[224:227], v[182:185], v[154:157]
v_mfma_f32_16x16x32_bf16 v[158:161], v[248:251], v[182:185], v[158:161]
v_mfma_f32_16x16x32_bf16 v[162:165], v[182:185], a[88:91], v[162:165]
v_mfma_f32_16x16x32_bf16 v[166:169], v[182:185], a[112:115], v[166:169]
buffer_store_dwordx2 v[44:45], v65, s[8:11], 0 offen offset:64
v_mfma_f32_16x16x32_bf16 v[170:173], v[182:185], a[136:139], v[170:173]
s_nop 0
ds_read_b128 v[182:185], v210 offset:20480
s_waitcnt lgkmcnt(1)
v_mfma_f32_16x16x32_bf16 v[138:141], a[20:23], v[186:189], v[138:141]
v_mfma_f32_16x16x32_bf16 v[142:145], a[44:47], v[186:189], v[142:145]
v_mfma_f32_16x16x32_bf16 v[146:149], a[68:71], v[186:189], v[146:149]
v_cvt_pk_bf16_f32 v96, v138, v139
v_cvt_pk_bf16_f32 v97, v140, v141
v_mfma_f32_16x16x32_bf16 v[150:153], a[236:239], v[186:189], v[150:153]
v_cvt_pk_bf16_f32 v98, v142, v143
v_cvt_pk_bf16_f32 v99, v144, v145
v_mfma_f32_16x16x32_bf16 v[154:157], v[228:231], v[186:189], v[154:157]
v_cvt_pk_bf16_f32 v100, v146, v147
v_cvt_pk_bf16_f32 v101, v148, v149
v_mfma_f32_16x16x32_bf16 v[158:161], v[252:255], v[186:189], v[158:161]
v_cvt_pk_bf16_f32 v84, v150, v151
v_cvt_pk_bf16_f32 v85, v152, v153
v_mfma_f32_16x16x32_bf16 v[162:165], v[186:189], a[92:95], v[162:165]
s_nop 0
v_cvt_pk_bf16_f32 v86, v154, v155
v_cvt_pk_bf16_f32 v87, v156, v157
v_mfma_f32_16x16x32_bf16 v[166:169], v[186:189], a[116:119], v[166:169]
s_waitcnt lgkmcnt(0)
v_cvt_pk_bf16_f32 v88, v158, v159
v_cvt_pk_bf16_f32 v89, v160, v161
v_mfma_f32_16x16x32_bf16 v[138:141], a[216:219], v[182:185], 0
v_cvt_pk_bf16_f32 v116, v162, v163
v_cvt_pk_bf16_f32 v117, v164, v165
v_mfma_f32_16x16x32_bf16 v[142:145], a[240:243], v[182:185], 0
v_cvt_pk_bf16_f32 v124, v166, v167
v_cvt_pk_bf16_f32 v125, v168, v169
v_mfma_f32_16x16x32_bf16 v[146:149], v[232:235], v[182:185], 0
v_mfma_f32_16x16x32_bf16 v[150:153], a[0:3], v[182:185], 0
v_mfma_f32_16x16x32_bf16 v[154:157], a[24:27], v[182:185], 0
v_mfma_f32_16x16x32_bf16 v[158:161], a[48:51], v[182:185], 0
v_mfma_f32_16x16x32_bf16 v[162:165], a[72:75], v[182:185], 0
v_mfma_f32_16x16x32_bf16 v[166:169], a[96:99], v[182:185], 0
v_mfma_f32_16x16x32_bf16 v[170:173], v[186:189], a[140:143], v[170:173]
s_nop 0
ds_read_b128 v[186:189], v210 offset:21504
s_nop 5
v_cvt_pk_bf16_f32 v132, v170, v171
v_cvt_pk_bf16_f32 v133, v172, v173
v_mfma_f32_16x16x32_bf16 v[170:173], a[120:123], v[182:185], 0
ds_read_b128 v[182:185], v210 offset:22528
s_waitcnt lgkmcnt(1)
v_mfma_f32_16x16x32_bf16 v[138:141], a[220:223], v[186:189], v[138:141]
v_mfma_f32_16x16x32_bf16 v[142:145], a[244:247], v[186:189], v[142:145]
v_mfma_f32_16x16x32_bf16 v[146:149], v[236:239], v[186:189], v[146:149]
v_mfma_f32_16x16x32_bf16 v[150:153], a[4:7], v[186:189], v[150:153]
v_mfma_f32_16x16x32_bf16 v[154:157], a[28:31], v[186:189], v[154:157]
v_mfma_f32_16x16x32_bf16 v[158:161], a[52:55], v[186:189], v[158:161]
v_mfma_f32_16x16x32_bf16 v[162:165], a[76:79], v[186:189], v[162:165]
v_mfma_f32_16x16x32_bf16 v[166:169], a[100:103], v[186:189], v[166:169]
v_mfma_f32_16x16x32_bf16 v[170:173], a[124:127], v[186:189], v[170:173]
ds_read_b128 v[186:189], v210 offset:23552
s_waitcnt lgkmcnt(1)
v_mfma_f32_16x16x32_bf16 v[138:141], a[224:227], v[182:185], v[138:141]
v_mfma_f32_16x16x32_bf16 v[142:145], a[248:251], v[182:185], v[142:145]
v_mfma_f32_16x16x32_bf16 v[146:149], v[240:243], v[182:185], v[146:149]
v_mfma_f32_16x16x32_bf16 v[150:153], a[8:11], v[182:185], v[150:153]
v_mfma_f32_16x16x32_bf16 v[154:157], a[32:35], v[182:185], v[154:157]
v_mfma_f32_16x16x32_bf16 v[158:161], a[56:59], v[182:185], v[158:161]
v_mfma_f32_16x16x32_bf16 v[162:165], a[80:83], v[182:185], v[162:165]
v_mfma_f32_16x16x32_bf16 v[166:169], a[104:107], v[182:185], v[166:169]
v_mfma_f32_16x16x32_bf16 v[170:173], a[128:131], v[182:185], v[170:173]
ds_read_b128 v[182:185], v210 offset:24576
s_waitcnt lgkmcnt(1)
v_mfma_f32_16x16x32_bf16 v[138:141], a[228:231], v[186:189], v[138:141]
v_mfma_f32_16x16x32_bf16 v[142:145], a[252:255], v[186:189], v[142:145]
v_mfma_f32_16x16x32_bf16 v[146:149], v[244:247], v[186:189], v[146:149]
v_mfma_f32_16x16x32_bf16 v[150:153], a[12:15], v[186:189], v[150:153]
v_mfma_f32_16x16x32_bf16 v[154:157], a[36:39], v[186:189], v[154:157]
v_mfma_f32_16x16x32_bf16 v[158:161], a[60:63], v[186:189], v[158:161]
v_mfma_f32_16x16x32_bf16 v[162:165], a[84:87], v[186:189], v[162:165]
v_mfma_f32_16x16x32_bf16 v[166:169], a[108:111], v[186:189], v[166:169]
v_mfma_f32_16x16x32_bf16 v[170:173], a[132:135], v[186:189], v[170:173]
ds_read_b128 v[186:189], v210 offset:25600
s_waitcnt lgkmcnt(1)
v_mfma_f32_16x16x32_bf16 v[138:141], a[232:235], v[182:185], v[138:141]
v_mfma_f32_16x16x32_bf16 v[142:145], v[224:227], v[182:185], v[142:145]
v_mfma_f32_16x16x32_bf16 v[146:149], v[248:251], v[182:185], v[146:149]
v_mfma_f32_16x16x32_bf16 v[150:153], a[16:19], v[182:185], v[150:153]
v_mfma_f32_16x16x32_bf16 v[154:157], a[40:43], v[182:185], v[154:157]
v_mfma_f32_16x16x32_bf16 v[158:161], a[64:67], v[182:185], v[158:161]
v_mfma_f32_16x16x32_bf16 v[162:165], a[88:91], v[182:185], v[162:165]
v_mfma_f32_16x16x32_bf16 v[166:169], a[112:115], v[182:185], v[166:169]
v_mfma_f32_16x16x32_bf16 v[170:173], a[136:139], v[182:185], v[170:173]
s_nop 0
ds_read_b128 v[182:185], v210 offset:12288
s_waitcnt lgkmcnt(1)
v_mfma_f32_16x16x32_bf16 v[138:141], a[236:239], v[186:189], v[138:141]
v_mfma_f32_16x16x32_bf16 v[142:145], v[228:231], v[186:189], v[142:145]
v_mfma_f32_16x16x32_bf16 v[146:149], v[252:255], v[186:189], v[146:149]
v_cvt_pk_bf16_f32 v90, v138, v139
v_cvt_pk_bf16_f32 v91, v140, v141
v_mfma_f32_16x16x32_bf16 v[150:153], a[20:23], v[186:189], v[150:153]
v_cvt_pk_bf16_f32 v92, v142, v143
v_cvt_pk_bf16_f32 v93, v144, v145
v_mfma_f32_16x16x32_bf16 v[154:157], a[44:47], v[186:189], v[154:157]
s_mov_b64 exec, s[30:31]
ds_write_b128 v215, v[90:93]
s_mov_b64 exec, -1
v_mfma_f32_16x16x32_bf16 v[158:161], a[68:71], v[186:189], v[158:161]
v_cvt_pk_bf16_f32 v94, v146, v147
v_cvt_pk_bf16_f32 v95, v148, v149
v_mfma_f32_16x16x32_bf16 v[162:165], a[92:95], v[186:189], v[162:165]
s_mov_b64 exec, s[30:31]
ds_write_b64 v215, v[94:95] offset:16
s_mov_b64 exec, -1
v_mfma_f32_16x16x32_bf16 v[166:169], a[116:119], v[186:189], v[166:169]
s_nop 0
v_cvt_pk_bf16_f32 v102, v150, v151
v_cvt_pk_bf16_f32 v103, v152, v153
v_mfma_f32_16x16x32_bf16 v[170:173], a[140:143], v[186:189], v[170:173]
s_waitcnt lgkmcnt(2)
ds_read_b128 v[186:189], v210 offset:13312
v_cvt_pk_bf16_f32 v104, v154, v155
v_mfma_f32_16x16x32_bf16 v[138:141], a[0:3], v[182:185], 0
v_cvt_pk_bf16_f32 v105, v156, v157
v_cvt_pk_bf16_f32 v106, v158, v159
v_mfma_f32_16x16x32_bf16 v[142:145], a[24:27], v[182:185], 0
s_mov_b64 exec, s[30:31]
ds_write_b128 v215, v[102:105] offset:512
s_mov_b64 exec, -1
v_mfma_f32_16x16x32_bf16 v[146:149], a[48:51], v[182:185], 0
v_cvt_pk_bf16_f32 v107, v160, v161
v_cvt_pk_bf16_f32 v108, v162, v163
v_cvt_pk_bf16_f32 v109, v164, v165
v_mfma_f32_16x16x16_bf16 v[154:157], v[82:83], v[88:89], 0
v_cvt_pk_bf16_f32 v110, v166, v167
v_cvt_pk_bf16_f32 v111, v168, v169
v_cvt_pk_bf16_f32 v112, v170, v171
v_cvt_pk_bf16_f32 v113, v172, v173
v_mfma_f32_16x16x16_bf16 v[158:161], v[100:101], v[88:89], 0
s_waitcnt lgkmcnt(1)
ds_read_b128 v[182:185], v210 offset:14336
s_mov_b64 exec, s[30:31]
ds_write_b64 v215, v[106:107] offset:528
s_mov_b64 exec, -1
v_mfma_f32_16x16x32_bf16 v[138:141], a[4:7], v[186:189], v[138:141]
s_mov_b64 exec, s[30:31]
ds_write_b128 v215, v[108:111] offset:1024
s_mov_b64 exec, -1
v_mfma_f32_16x16x32_bf16 v[142:145], a[28:31], v[186:189], v[142:145]
v_mfma_f32_16x16x32_bf16 v[146:149], a[52:55], v[186:189], v[146:149]
s_waitcnt lgkmcnt(2)
s_mov_b64 exec, s[30:31]
ds_write_b64 v215, v[112:113] offset:1040
s_mov_b64 exec, -1
v_mfma_f32_16x16x32_bf16 v[138:141], a[8:11], v[182:185], v[138:141]
ds_read_b64 v[112:113], v215 offset:528
ds_read_b128 v[186:189], v210 offset:15360
v_mfma_f32_16x16x32_bf16 v[142:145], a[32:35], v[182:185], v[142:145]
ds_read_b128 v[108:111], v215 offset:512
v_mfma_f32_16x16x32_bf16 v[146:149], a[56:59], v[182:185], v[146:149]
ds_read_b128 v[182:185], v210 offset:16384
v_mfma_f32_16x16x32_bf16 v[154:157], v[78:81], v[84:87], v[154:157]
v_mfma_f32_16x16x32_bf16 v[158:161], v[96:99], v[84:87], v[158:161]
s_nop 3
v_exp_f32 v154, v154
v_exp_f32_e64 v155, v155
v_exp_f32 v156, v156
s_waitcnt lgkmcnt(2)
v_mfma_f32_16x16x16_bf16 v[166:169], v[112:113], v[88:89], v[206:209]
v_exp_f32 v157, v157
v_exp_f32 v158, v158
v_mfma_f32_16x16x16_bf16 v[150:153], v[112:113], v[76:77], v[206:209]
v_exp_f32 v159, v159
v_exp_f32 v160, v160
v_mfma_f32_16x16x32_bf16 v[138:141], a[12:15], v[186:189], v[138:141]
v_exp_f32 v161, v161
v_mfma_f32_16x16x32_bf16 v[142:145], a[36:39], v[186:189], v[142:145]
v_mfma_f32_16x16x32_bf16 v[146:149], a[60:63], v[186:189], v[146:149]
ds_read_b128 v[186:189], v210 offset:17408
s_waitcnt lgkmcnt(1)
v_mfma_f32_16x16x32_bf16 v[138:141], a[16:19], v[182:185], v[138:141]
v_mfma_f32_16x16x32_bf16 v[142:145], a[40:43], v[182:185], v[142:145]
v_mfma_f32_16x16x32_bf16 v[150:153], v[108:111], v[72:75], v[150:153]
v_mfma_f32_16x16x32_bf16 v[146:149], a[64:67], v[182:185], v[146:149]
ds_read_b128 v[182:185], v210 offset:12288
v_mfma_f32_16x16x32_bf16 v[166:169], v[108:111], v[84:87], v[166:169]
v_exp_f32_e64 v150, v150
s_nop 0
v_cvt_pk_bf16_f32 v180, v150, 0
s_waitcnt lgkmcnt(1)
v_mfma_f32_16x16x32_bf16 v[138:141], a[20:23], v[186:189], v[138:141]
s_nop 1
v_exp_f32 v166, v166
v_mfma_f32_16x16x32_bf16 v[142:145], a[44:47], v[186:189], v[142:145]
v_mfma_f32_16x16x32_bf16 v[146:149], a[68:71], v[186:189], v[146:149]
ds_read_b128 v[186:189], v210 offset:13312
v_cvt_pk_bf16_f32 v102, v138, v139
v_cvt_pk_bf16_f32 v103, v140, v141
v_mfma_f32_16x16x16_bf16 v[138:141], v[82:83], v[76:77], 0
v_cvt_pk_bf16_f32 v104, v142, v143
v_cvt_pk_bf16_f32 v105, v144, v145
v_mfma_f32_16x16x16_bf16 v[142:145], v[100:101], v[76:77], 0
v_cvt_pk_bf16_f32 v106, v146, v147
v_cvt_pk_bf16_f32 v107, v148, v149
s_nop 1
v_mfma_f32_16x16x16_bf16 v[162:165], v[106:107], v[88:89], 0
v_mfma_f32_16x16x16_bf16 v[146:149], v[106:107], v[76:77], 0
ds_read_b64 v[76:77], v215 offset:16
v_mfma_f32_16x16x32_bf16 v[138:141], v[78:81], v[72:75], v[138:141]
v_mfma_f32_16x16x32_bf16 v[142:145], v[96:99], v[72:75], v[142:145]
s_waitcnt lgkmcnt(2)
v_mfma_f32_16x16x32_bf16 v[118:121], v[182:185], a[72:75], 0
v_exp_f32 v138, v138
v_mfma_f32_16x16x32_bf16 v[126:129], v[182:185], a[96:99], 0
v_exp_f32 v139, v139
v_mfma_f32_16x16x32_bf16 v[134:137], v[182:185], a[120:123], 0
v_exp_f32_e64 v140, v140
v_mfma_f32_16x16x32_bf16 v[146:149], v[102:105], v[72:75], v[146:149]
ds_read_b128 v[72:75], v215
v_cvt_pk_bf16_f32 v174, v138, v139
v_mfma_f32_16x16x32_bf16 v[90:93], a[216:219], v[182:185], 0
v_exp_f32_e64 v141, v141
v_mfma_f32_16x16x32_bf16 v[170:173], a[240:243], v[182:185], 0
v_exp_f32 v142, v142
v_mfma_f32_16x16x32_bf16 v[220:223], v[232:235], v[182:185], 0
s_waitcnt lgkmcnt(2)
ds_read_b128 v[182:185], v210 offset:14336
v_cvt_pk_bf16_f32 v175, v140, v141
v_mfma_f32_16x16x32_bf16 v[118:121], v[186:189], a[76:79], v[118:121]
v_exp_f32 v143, v143
v_mfma_f32_16x16x32_bf16 v[126:129], v[186:189], a[100:103], v[126:129]
v_exp_f32 v144, v144
v_mfma_f32_16x16x32_bf16 v[134:137], v[186:189], a[124:127], v[134:137]
v_exp_f32_e64 v145, v145
v_mfma_f32_16x16x32_bf16 v[90:93], a[220:223], v[186:189], v[90:93]
v_cvt_pk_bf16_f32 v176, v142, v143
v_cvt_pk_bf16_f32 v177, v144, v145
v_mfma_f32_16x16x32_bf16 v[170:173], a[244:247], v[186:189], v[170:173]
v_exp_f32 v146, v146
v_mfma_f32_16x16x32_bf16 v[220:223], v[236:239], v[186:189], v[220:223]
s_waitcnt lgkmcnt(0)
ds_read_b128 v[186:189], v210 offset:15360
v_exp_f32 v147, v147
v_mfma_f32_16x16x32_bf16 v[118:121], v[182:185], a[80:83], v[118:121]
v_exp_f32 v148, v148
v_mfma_f32_16x16x32_bf16 v[126:129], v[182:185], a[104:107], v[126:129]
v_exp_f32_e64 v149, v149
v_mfma_f32_16x16x32_bf16 v[134:137], v[182:185], a[128:131], v[134:137]
v_cvt_pk_bf16_f32 v178, v146, v147
v_cvt_pk_bf16_f32 v179, v148, v149
v_mfma_f32_16x16x32_bf16 v[90:93], a[224:227], v[182:185], v[90:93]
v_mfma_f32_16x16x32_bf16 v[162:165], v[102:105], v[84:87], v[162:165]
v_mfma_f32_16x16x32_bf16 v[170:173], a[248:251], v[182:185], v[170:173]
v_mfma_f32_16x16x32_bf16 v[220:223], v[240:243], v[182:185], v[220:223]
s_waitcnt lgkmcnt(0)
ds_read_b128 v[182:185], v210 offset:16384
v_exp_f32 v162, v162
v_mfma_f32_16x16x32_bf16 v[118:121], v[186:189], a[84:87], v[118:121]
v_exp_f32 v163, v163
v_mfma_f32_16x16x32_bf16 v[126:129], v[186:189], a[108:111], v[126:129]
v_exp_f32 v164, v164
v_mfma_f32_16x16x32_bf16 v[134:137], v[186:189], a[132:135], v[134:137]
v_exp_f32 v165, v165
v_mfma_f32_16x16x32_bf16 v[90:93], a[228:231], v[186:189], v[90:93]
v_mfma_f32_16x16x32_bf16 v[170:173], a[252:255], v[186:189], v[170:173]
v_mfma_f32_16x16x32_bf16 v[220:223], v[244:247], v[186:189], v[220:223]
ds_read_b128 v[186:189], v210 offset:17408
s_waitcnt lgkmcnt(1)
v_mfma_f32_16x16x32_bf16 v[118:121], v[182:185], a[88:91], v[118:121]
v_mfma_f32_16x16x32_bf16 v[126:129], v[182:185], a[112:115], v[126:129]
v_mfma_f32_16x16x32_bf16 v[134:137], v[182:185], a[136:139], v[134:137]
v_mfma_f32_16x16x32_bf16 v[90:93], a[232:235], v[182:185], v[90:93]
v_mfma_f32_16x16x32_bf16 v[170:173], v[224:227], v[182:185], v[170:173]
s_nop 0
v_mfma_f32_16x16x32_bf16 v[220:223], v[248:251], v[182:185], v[220:223]
s_waitcnt lgkmcnt(0)
v_mfma_f32_16x16x32_bf16 v[118:121], v[186:189], a[92:95], v[118:121]
v_mfma_f32_16x16x32_bf16 v[126:129], v[186:189], a[116:119], v[126:129]
v_mfma_f32_16x16x32_bf16 v[134:137], v[186:189], a[140:143], v[134:137]
v_cvt_pk_bf16_f32 v118, v118, v119
v_cvt_pk_bf16_f32 v119, v120, v121
v_mfma_f32_16x16x32_bf16 v[90:93], a[236:239], v[186:189], v[90:93]
ds_read_u16 v120, v214 offset:1024
v_cvt_pk_bf16_f32 v126, v126, v127
v_mfma_f32_16x16x32_bf16 v[170:173], v[228:231], v[186:189], v[170:173]
v_cvt_pk_bf16_f32 v127, v128, v129
v_cvt_pk_bf16_f32 v134, v134, v135
v_mfma_f32_16x16x32_bf16 v[220:223], v[252:255], v[186:189], v[220:223]
ds_read_u16 v128, v214 offset:1032
v_cvt_pk_bf16_f32 v90, v90, v91
v_mfma_f32_16x16x32_bf16 v[150:153], v[190:193], v[174:177], 0
v_cvt_pk_bf16_f32 v91, v92, v93
v_cvt_pk_bf16_f32 v92, v170, v171
v_mfma_f32_16x16x32_bf16 v[138:141], v[114:117], v[174:177], 0
v_cvt_pk_bf16_f32 v93, v172, v173
v_cvt_pk_bf16_f32 v135, v136, v137
v_mfma_f32_16x16x32_bf16 v[142:145], v[122:125], v[174:177], 0
ds_read_u16 v136, v214 offset:1040
v_mov_b32 v121, 0
v_mfma_f32_16x16x32_bf16 v[146:149], v[130:133], v[174:177], 0
v_cvt_pk_bf16_f32 v174, v154, v155
v_cvt_pk_bf16_f32 v175, v156, v157
v_mfma_f32_16x16x32_bf16 v[150:153], v[190:193], v[178:181], v[150:153]
s_waitcnt lgkmcnt(2)
v_cvt_pk_bf16_f32 v176, v158, v159
v_cvt_pk_bf16_f32 v177, v160, v161
v_mfma_f32_16x16x32_bf16 v[138:141], v[118:121], v[178:181], v[138:141]
v_mov_b32 v129, 0
v_mov_b32 v137, 0
v_mfma_f32_16x16x32_bf16 v[154:157], v[114:117], v[174:177], 0
v_rcp_f32 v151, v150
v_mfma_f32_16x16x32_bf16 v[158:161], v[122:125], v[174:177], 0
s_waitcnt lgkmcnt(1)
v_max3_u32 v218, v218, v150, v151
v_mul_f32_e64 v151, s3, v151
v_mfma_f32_16x16x32_bf16 v[142:145], v[126:129], v[178:181], v[142:145]
s_waitcnt lgkmcnt(0)
v_mul_f32 v138, v138, v151
v_mul_f32_e64 v139, v139, v151
v_mfma_f32_16x16x32_bf16 v[146:149], v[134:137], v[178:181], v[146:149]
v_cvt_pk_bf16_f32 v180, v166, 0
v_mul_f32_e64 v140, v140, v151
v_mfma_f32_16x16x32_bf16 v[166:169], v[190:193], v[174:177], 0
v_mul_f32_e64 v141, v141, v151
v_cvt_pk_bf16_f32 v138, v138, v139
v_mul_f32 v142, v142, v151
v_mul_f32 v143, v143, v151
v_mul_f32 v144, v144, v151
v_mul_f32 v145, v145, v151
v_cvt_pk_bf16_f32 v139, v140, v141
v_cvt_pk_bf16_f32 v140, v142, v143
v_cvt_pk_bf16_f32 v141, v144, v145
v_cvt_pk_bf16_f32 v178, v162, v163
v_cvt_pk_bf16_f32 v179, v164, v165
v_mfma_f32_16x16x32_bf16 v[162:165], v[130:133], v[174:177], 0
ds_write_b128 v211, v[138:141] offset:38912
v_mfma_f32_16x16x32_bf16 v[138:141], v[78:81], v[90:93], 0
v_mul_f32 v146, v146, v151
v_mul_f32 v147, v147, v151
v_mfma_f32_16x16x32_bf16 v[166:169], v[190:193], v[178:181], v[166:169]
v_mul_f32 v148, v148, v151
v_mul_f32 v149, v149, v151
v_mfma_f32_16x16x32_bf16 v[154:157], v[118:121], v[178:181], v[154:157]
v_cvt_pk_bf16_f32 v142, v146, v147
v_cvt_pk_bf16_f32 v143, v148, v149
v_mfma_f32_16x16x32_bf16 v[158:161], v[126:129], v[178:181], v[158:161]
ds_write_b64 v212, v[142:143] offset:38912
v_mfma_f32_16x16x32_bf16 v[142:145], v[96:99], v[90:93], 0
v_rcp_f32_e64 v167, v166
v_mfma_f32_16x16x32_bf16 v[162:165], v[134:137], v[178:181], v[162:165]
v_max3_u32 v218, v218, v166, v167
v_cvt_pk_bf16_f32 v94, v220, v221
v_mfma_f32_16x16x32_bf16 v[150:153], v[108:111], v[90:93], v[206:209]
v_cvt_pk_bf16_f32 v95, v222, v223
v_mul_f32_e64 v167, s3, v167
v_mfma_f32_16x16x32_bf16 v[146:149], v[102:105], v[90:93], 0
v_mul_f32 v154, v154, v167
v_mul_f32 v155, v155, v167
v_mul_f32_e64 v156, v156, v167
v_mfma_f32_16x16x16_bf16 v[138:141], v[82:83], v[94:95], v[138:141]
v_mul_f32_e64 v157, v157, v167
v_cvt_pk_bf16_f32 v154, v154, v155
v_mul_f32_e64 v158, v158, v167
v_mfma_f32_16x16x16_bf16 v[142:145], v[100:101], v[94:95], v[142:145]
v_mul_f32 v159, v159, v167
v_mul_f32 v160, v160, v167
v_mul_f32_e64 v161, v161, v167
v_mfma_f32_16x16x16_bf16 v[150:153], v[112:113], v[94:95], v[150:153]
v_cvt_pk_bf16_f32 v155, v156, v157
v_cvt_pk_bf16_f32 v156, v158, v159
v_cvt_pk_bf16_f32 v157, v160, v161
v_mfma_f32_16x16x16_bf16 v[146:149], v[106:107], v[94:95], v[146:149]
v_mul_f32 v162, v162, v167
v_mul_f32 v163, v163, v167
v_mul_f32 v164, v164, v167
v_mul_f32 v165, v165, v167
v_mfma_f32_16x16x16_bf16 v[166:169], v[76:77], v[112:113], v[206:209]
v_cvt_pk_bf16_f32 v158, v162, v163
v_cvt_pk_bf16_f32 v159, v164, v165
v_exp_f32 v138, v138
v_mfma_f32_16x16x16_bf16 v[162:165], v[76:77], v[106:107], 0
v_exp_f32 v139, v139
v_exp_f32 v140, v140
v_mfma_f32_16x16x32_bf16 v[166:169], v[72:75], v[108:111], v[166:169]
ds_write_b128 v211, v[154:157] offset:45056
v_mfma_f32_16x16x16_bf16 v[154:157], v[76:77], v[82:83], 0
v_exp_f32 v141, v141
v_exp_f32 v142, v142
v_mfma_f32_16x16x32_bf16 v[162:165], v[72:75], v[102:105], v[162:165]
v_exp_f32 v143, v143
v_mfma_f32_16x16x32_bf16 v[154:157], v[72:75], v[78:81], v[154:157]
ds_write_b64 v212, v[158:159] offset:45056
v_mfma_f32_16x16x16_bf16 v[158:161], v[76:77], v[100:101], 0
v_exp_f32 v144, v144
v_exp_f32 v145, v145
v_exp_f32_e64 v150, v150
v_mfma_f32_16x16x32_bf16 v[158:161], v[72:75], v[96:99], v[158:161]
v_cvt_pk_bf16_f32 v174, v138, v139
v_cvt_pk_bf16_f32 v175, v140, v141
v_cvt_pk_bf16_f32 v176, v142, v143
v_cvt_pk_bf16_f32 v177, v144, v145
v_cvt_pk_bf16_f32 v180, v150, 0
v_exp_f32_e64 v146, v146
v_mfma_f32_16x16x32_bf16 v[150:153], v[190:193], v[174:177], 0
v_exp_f32 v147, v147
v_mfma_f32_16x16x32_bf16 v[138:141], v[114:117], v[174:177], 0
s_waitcnt lgkmcnt(0)
v_exp_f32 v148, v148
v_mfma_f32_16x16x32_bf16 v[142:145], v[122:125], v[174:177], 0
s_barrier
ds_read_b128 v[170:173], v210 offset:38912
ds_read_b128 v[182:185], v210 offset:39936
ds_read_b128 v[186:189], v210 offset:40960
v_exp_f32_e64 v149, v149
v_cvt_pk_bf16_f32 v178, v146, v147
v_cvt_pk_bf16_f32 v179, v148, v149
v_mfma_f32_16x16x32_bf16 v[146:149], v[130:133], v[174:177], 0
v_mov_b32_dpp v154, v158 quad_perm:[0,1,2,3] row_mask:0x2 bank_mask:0xf
v_mfma_f32_16x16x32_bf16 v[150:153], v[190:193], v[178:181], v[150:153]
v_mov_b32_dpp v154, v162 quad_perm:[0,1,2,3] row_mask:0x4 bank_mask:0xf
v_mfma_f32_16x16x32_bf16 v[138:141], v[118:121], v[178:181], v[138:141]
v_mov_b32_dpp v154, v167 quad_perm:[0,1,2,3] row_mask:0x8 bank_mask:0xf
v_exp_f32_e64 v154, v154
v_mfma_f32_16x16x32_bf16 v[142:145], v[126:129], v[178:181], v[142:145]
v_cvt_pk_bf16_f32 v154, v154, 0
v_rcp_f32 v151, v150
v_mfma_f32_16x16x32_bf16 v[146:149], v[134:137], v[178:181], v[146:149]
s_waitcnt lgkmcnt(2)
ds_write_b16 v214, v154
v_mfma_f32_16x16x32_bf16 v[0:3], a[144:147], v[170:173], v[0:3]
ds_read_b128 v[84:87], v215
ds_read_b128 v[88:91], v215 offset:16
v_mfma_f32_16x16x32_bf16 v[4:7], a[168:171], v[170:173], v[4:7]
v_add_u32 v215, 1552, v215
v_mfma_f32_16x16x32_bf16 v[8:11], a[192:195], v[170:173], v[8:11]
ds_read_b128 v[170:173], v210 offset:41984
s_waitcnt lgkmcnt(5)
v_mfma_f32_16x16x32_bf16 v[0:3], a[148:151], v[182:185], v[0:3]
v_mfma_f32_16x16x32_bf16 v[4:7], a[172:175], v[182:185], v[4:7]
v_mfma_f32_16x16x32_bf16 v[8:11], a[196:199], v[182:185], v[8:11]
ds_read_b128 v[182:185], v210 offset:43008
s_waitcnt lgkmcnt(3)
v_mfma_f32_16x16x32_bf16 v[166:169], v[84:87], v[190:193], 0
v_mfma_f32_16x16x32_bf16 v[154:157], v[84:87], v[114:117], 0
v_mfma_f32_16x16x32_bf16 v[158:161], v[84:87], v[122:125], 0
v_mfma_f32_16x16x32_bf16 v[162:165], v[84:87], v[130:133], 0
s_waitcnt lgkmcnt(2)
v_mfma_f32_16x16x32_bf16 v[166:169], v[88:91], v[190:193], v[166:169]
v_mfma_f32_16x16x32_bf16 v[154:157], v[88:91], v[118:121], v[154:157]
v_mfma_f32_16x16x32_bf16 v[158:161], v[88:91], v[126:129], v[158:161]
v_rcp_f32 v167, v166
v_mfma_f32_16x16x32_bf16 v[162:165], v[88:91], v[134:137], v[162:165]
v_max3_u32 v218, v218, v166, v167
v_max3_u32 v218, v218, v150, v151
v_mfma_f32_16x16x32_bf16 v[0:3], a[152:155], v[186:189], v[0:3]
v_mul_f32 v151, s3, v151
v_mul_f32 v138, v138, v151
v_mfma_f32_16x16x32_bf16 v[4:7], a[176:179], v[186:189], v[4:7]
v_mul_f32_e64 v139, v139, v151
v_mul_f32 v140, v140, v151
v_mfma_f32_16x16x32_bf16 v[8:11], a[200:203], v[186:189], v[8:11]
s_waitcnt lgkmcnt(1)
ds_read_b128 v[186:189], v210 offset:44032
v_mul_f32_e64 v141, v141, v151
v_mfma_f32_16x16x32_bf16 v[0:3], a[156:159], v[170:173], v[0:3]
v_cvt_pk_bf16_f32 v138, v138, v139
v_mul_f32_e64 v142, v142, v151
v_mfma_f32_16x16x32_bf16 v[4:7], a[180:183], v[170:173], v[4:7]
v_mul_f32_e64 v143, v143, v151
v_mul_f32 v144, v144, v151
v_mfma_f32_16x16x32_bf16 v[8:11], a[204:207], v[170:173], v[8:11]
s_waitcnt lgkmcnt(1)
ds_read_b128 v[170:173], v210 offset:45056
v_mul_f32_e64 v145, v145, v151
v_mfma_f32_16x16x32_bf16 v[0:3], a[160:163], v[182:185], v[0:3]
v_cvt_pk_bf16_f32 v139, v140, v141
v_cvt_pk_bf16_f32 v140, v142, v143
v_mfma_f32_16x16x32_bf16 v[4:7], a[184:187], v[182:185], v[4:7]
s_nop 0
v_cvt_pk_bf16_f32 v141, v144, v145
v_cmp_lt_u32 vcc, 1602224128, v218
v_mfma_f32_16x16x32_bf16 v[8:11], a[208:211], v[182:185], v[8:11]
s_waitcnt lgkmcnt(1)
ds_read_b128 v[182:185], v210 offset:46080
ds_write_b128 v211, v[138:141] offset:51200
v_mfma_f32_16x16x32_bf16 v[0:3], a[164:167], v[186:189], v[0:3]
s_or_b32 s41, vcc_lo, vcc_hi
v_mov_b32_dpp v154, v158 quad_perm:[0,1,2,3] row_mask:0x2 bank_mask:0xf
v_mul_f32 v146, v146, v151
v_mfma_f32_16x16x32_bf16 v[4:7], a[188:191], v[186:189], v[4:7]
v_mul_f32_e64 v147, v147, v151
v_mul_f32 v148, v148, v151
v_mfma_f32_16x16x32_bf16 v[8:11], a[212:215], v[186:189], v[8:11]
s_waitcnt lgkmcnt(2)
v_cvt_pk_bf16_f32 v72, v0, v1
v_cvt_pk_bf16_f32 v73, v2, v3
v_mfma_f32_16x16x32_bf16 v[12:15], a[144:147], v[170:173], v[12:15]
buffer_store_dwordx2 v[72:73], v203, s[8:11], s38 offen
ds_read_b128 v[186:189], v210 offset:47104
v_mfma_f32_16x16x32_bf16 v[16:19], a[168:171], v[170:173], v[16:19]
s_nop 0
v_cvt_pk_bf16_f32 v74, v4, v5
v_cvt_pk_bf16_f32 v75, v6, v7
v_mfma_f32_16x16x32_bf16 v[20:23], a[192:195], v[170:173], v[20:23]
s_waitcnt lgkmcnt(2)
ds_read_b128 v[170:173], v210 offset:48128
v_cvt_pk_bf16_f32 v76, v8, v9
v_mfma_f32_16x16x32_bf16 v[12:15], a[148:151], v[182:185], v[12:15]
v_cvt_pk_bf16_f32 v77, v10, v11
v_mul_f32_e64 v149, v149, v151
v_mfma_f32_16x16x32_bf16 v[16:19], a[172:175], v[182:185], v[16:19]
v_cvt_pk_bf16_f32 v142, v146, v147
v_cvt_pk_bf16_f32 v143, v148, v149
v_mfma_f32_16x16x32_bf16 v[20:23], a[196:199], v[182:185], v[20:23]
ds_write_b64 v212, v[142:143] offset:51200
v_mul_f32 v167, s3, v167
v_mov_b32_dpp v154, v162 quad_perm:[0,1,2,3] row_mask:0x4 bank_mask:0xf
s_waitcnt lgkmcnt(2)
v_mfma_f32_16x16x32_bf16 v[12:15], a[152:155], v[186:189], v[12:15]
ds_read_b128 v[182:185], v210 offset:49152
v_mul_f32_e64 v154, v154, v167
v_mfma_f32_16x16x32_bf16 v[16:19], a[176:179], v[186:189], v[16:19]
v_mov_b32 v69, s41
v_cvt_pk_bf16_f32 v154, v154, 0
v_mfma_f32_16x16x32_bf16 v[20:23], a[200:203], v[186:189], v[20:23]
s_waitcnt lgkmcnt(2)
ds_write_b32 v209, v69
v_mfma_f32_16x16x32_bf16 v[12:15], a[156:159], v[170:173], v[12:15]
ds_write_b16 v214, v154
v_mfma_f32_16x16x32_bf16 v[16:19], a[180:183], v[170:173], v[16:19]
ds_read_b128 v[186:189], v210 offset:50176
v_add_u32 v214, 1552, v214
v_mfma_f32_16x16x32_bf16 v[20:23], a[204:207], v[170:173], v[20:23]
buffer_store_dwordx2 v[74:75], v203, s[8:11], s38 offen offset:32
s_waitcnt lgkmcnt(3)
v_mfma_f32_16x16x32_bf16 v[12:15], a[160:163], v[182:185], v[12:15]
v_mfma_f32_16x16x32_bf16 v[16:19], a[184:187], v[182:185], v[16:19]
v_mfma_f32_16x16x32_bf16 v[20:23], a[208:211], v[182:185], v[20:23]
s_waitcnt lgkmcnt(1)
s_barrier
ds_read_b128 v[170:173], v210 offset:51200
ds_read_b128 v[182:185], v210 offset:52224
ds_read_b128 v[84:87], v63 offset:24832
s_waitcnt lgkmcnt(3)
v_mfma_f32_16x16x32_bf16 v[12:15], a[164:167], v[186:189], v[12:15]
ds_read_b128 v[88:91], v63 offset:24960
ds_read_b128 v[92:95], v63 offset:25088
v_mfma_f32_16x16x32_bf16 v[16:19], a[188:191], v[186:189], v[16:19]
ds_read_b128 v[96:99], v63 offset:25216
v_mfma_f32_16x16x32_bf16 v[20:23], a[212:215], v[186:189], v[20:23]
ds_read_b64 v[100:101], v63 offset:24848
ds_read_b64 v[102:103], v63 offset:24976
ds_read_b64 v[104:105], v63 offset:25104
v_cvt_pk_bf16_f32 v78, v12, v13
v_cvt_pk_bf16_f32 v79, v14, v15
v_cvt_pk_bf16_f32 v80, v16, v17
v_cvt_pk_bf16_f32 v81, v18, v19
v_cvt_pk_bf16_f32 v82, v20, v21
v_cvt_pk_bf16_f32 v83, v22, v23
s_waitcnt lgkmcnt(8)
v_mfma_f32_16x16x32_bf16 v[24:27], a[144:147], v[170:173], v[24:27]
s_nop 0
ds_read_b64 v[106:107], v63 offset:25232
ds_read_b128 v[186:189], v210 offset:53248
v_mfma_f32_16x16x32_bf16 v[28:31], a[168:171], v[170:173], v[28:31]
ds_read_b128 v[174:177], v210 offset:18432
v_mfma_f32_16x16x32_bf16 v[32:35], a[192:195], v[170:173], v[32:35]
s_nop 0
ds_read_b128 v[170:173], v210 offset:54272
s_waitcnt lgkmcnt(11)
v_mfma_f32_16x16x32_bf16 v[24:27], a[148:151], v[182:185], v[24:27]
s_waitcnt lgkmcnt(10)
v_mfma_f32_16x16x32_bf16 v[48:51], a[144:147], v[84:87], v[48:51]
v_mfma_f32_16x16x32_bf16 v[28:31], a[172:175], v[182:185], v[28:31]
buffer_store_dwordx2 v[76:77], v203, s[8:11], s38 offen offset:64
s_waitcnt lgkmcnt(9)
v_mfma_f32_16x16x32_bf16 v[48:51], a[148:151], v[88:91], v[48:51]
s_waitcnt lgkmcnt(8)
v_mfma_f32_16x16x32_bf16 v[48:51], a[152:155], v[92:95], v[48:51]
v_mfma_f32_16x16x32_bf16 v[32:35], a[196:199], v[182:185], v[32:35]
s_waitcnt lgkmcnt(1)
ds_read_b128 v[182:185], v210 offset:55296
v_or3_b32 v174, v174, v175, v176
v_mfma_f32_16x16x32_bf16 v[48:51], a[156:159], v[96:99], v[48:51]
v_or_b32 v174, v174, v177
v_mfma_f32_16x16x32_bf16 v[48:51], a[160:163], v[100:103], v[48:51]
v_readfirstlane_b32 s43, v174
v_mfma_f32_16x16x32_bf16 v[48:51], a[164:167], v[104:107], v[48:51]
v_mfma_f32_16x16x32_bf16 v[24:27], a[152:155], v[186:189], v[24:27]
v_mfma_f32_16x16x32_bf16 v[28:31], a[176:179], v[186:189], v[28:31]
v_cvt_pk_bf16_f32 v48, v48, v49
v_cvt_pk_bf16_f32 v49, v50, v51
v_mfma_f32_16x16x32_bf16 v[32:35], a[200:203], v[186:189], v[32:35]
ds_read_b128 v[186:189], v210 offset:56320
v_mfma_f32_16x16x32_bf16 v[52:55], a[168:171], v[84:87], v[52:55]
v_mfma_f32_16x16x32_bf16 v[52:55], a[172:175], v[88:91], v[52:55]
v_mfma_f32_16x16x32_bf16 v[52:55], a[176:179], v[92:95], v[52:55]
s_waitcnt lgkmcnt(2)
v_mfma_f32_16x16x32_bf16 v[24:27], a[156:159], v[170:173], v[24:27]
v_mfma_f32_16x16x32_bf16 v[52:55], a[180:183], v[96:99], v[52:55]
v_mfma_f32_16x16x32_bf16 v[28:31], a[180:183], v[170:173], v[28:31]
v_mfma_f32_16x16x32_bf16 v[52:55], a[184:187], v[100:103], v[52:55]
buffer_store_dwordx2 v[78:79], v204, s[8:11], s38 offen
v_mfma_f32_16x16x32_bf16 v[52:55], a[188:191], v[104:107], v[52:55]
v_mfma_f32_16x16x32_bf16 v[32:35], a[204:207], v[170:173], v[32:35]
s_waitcnt lgkmcnt(1)
v_mfma_f32_16x16x32_bf16 v[24:27], a[160:163], v[182:185], v[24:27]
v_cvt_pk_bf16_f32 v52, v52, v53
v_cvt_pk_bf16_f32 v53, v54, v55
v_mfma_f32_16x16x32_bf16 v[56:59], a[192:195], v[84:87], v[56:59]
v_mfma_f32_16x16x32_bf16 v[28:31], a[184:187], v[182:185], v[28:31]
v_mfma_f32_16x16x32_bf16 v[56:59], a[196:199], v[88:91], v[56:59]
v_mfma_f32_16x16x32_bf16 v[56:59], a[200:203], v[92:95], v[56:59]
v_mfma_f32_16x16x32_bf16 v[32:35], a[208:211], v[182:185], v[32:35]
v_mfma_f32_16x16x32_bf16 v[56:59], a[204:207], v[96:99], v[56:59]
v_mfma_f32_16x16x32_bf16 v[56:59], a[208:211], v[100:103], v[56:59]
s_nop 0
v_mfma_f32_16x16x32_bf16 v[56:59], a[212:215], v[104:107], v[56:59]
s_waitcnt lgkmcnt(0)
v_mfma_f32_16x16x32_bf16 v[24:27], a[164:167], v[186:189], v[24:27]
v_mfma_f32_16x16x32_bf16 v[28:31], a[188:191], v[186:189], v[28:31]
v_cvt_pk_bf16_f32 v56, v56, v57
v_cvt_pk_bf16_f32 v57, v58, v59
v_mfma_f32_16x16x32_bf16 v[32:35], a[212:215], v[186:189], v[32:35]
v_cvt_pk_bf16_f32 v116, v24, v25
v_cvt_pk_bf16_f32 v117, v26, v27
s_nop 0
v_cvt_pk_bf16_f32 v124, v28, v29
buffer_store_dwordx2 v[80:81], v204, s[8:11], s38 offen offset:32
v_cvt_pk_bf16_f32 v125, v30, v31
s_nop 0
v_cvt_pk_bf16_f32 v132, v32, v33
v_cvt_pk_bf16_f32 v133, v34, v35
buffer_store_dwordx2 v[82:83], v204, s[8:11], s38 offen offset:64
buffer_store_dwordx2 v[116:117], v205, s[8:11], s38 offen
buffer_store_dwordx2 v[124:125], v205, s[8:11], s38 offen offset:32
buffer_store_dwordx2 v[48:49], v66, s[8:11], 0 offen
buffer_store_dwordx2 v[52:53], v66, s[8:11], 0 offen offset:32
buffer_store_dwordx2 v[56:57], v66, s[8:11], 0 offen offset:64
buffer_store_dwordx2 v[132:133], v205, s[8:11], s38 offen offset:64
L_fin:
s_nop 1
s_cmp_lg_u32 s43, 0
s_cbranch_scc1 L_redo
L_end:
s_endpgm
.p2align 3
L_tailb:
s_waitcnt lgkmcnt(2)
v_mfma_f32_16x16x32_bf16 v[138:141], a[8:11], v[182:185], v[138:141]
s_mul_i32 s41, s32, 192
ds_read_b128 v[186:189], v210 offset:9216
s_waitcnt lgkmcnt(2)
v_add_f32_e64 v102, v102, v103
v_mfma_f32_16x16x32_bf16 v[142:145], a[32:35], v[182:185], v[142:145]
s_add_u32 s41, s41, 127056
s_waitcnt lgkmcnt(1)
v_add_f32 v106, v106, v107
v_add_f32_e64 v104, v104, v105
v_mfma_f32_16x16x32_bf16 v[146:149], a[56:59], v[182:185], v[146:149]
s_mov_b32 s39, s37
v_add_f32 v108, v108, v109
v_add_f32_e64 v102, v102, v104
v_mfma_f32_16x16x32_bf16 v[150:153], a[224:227], v[182:185], v[150:153]
s_mov_b32 s42, 58835169
v_add_f32 v106, v106, v108
v_mul_f32 v103, s48, v102
v_mfma_f32_16x16x32_bf16 v[154:157], a[248:251], v[182:185], v[154:157]
ds_read_b128 v[108:111], v215 offset:512
v_mul_f32_e64 v104, s73, v102
v_mfma_f32_16x16x32_bf16 v[158:161], v[240:243], v[182:185], v[158:161]
v_mul_f32_e64 v106, s73, v106
v_fma_f32 v106, -v103, v104, v106
v_mfma_f32_16x16x32_bf16 v[162:165], v[182:185], a[80:83], v[162:165]
v_max_f32 v106, 0, v106
v_add_f32 v106, s49, v106
v_mfma_f32_16x16x32_bf16 v[166:169], v[182:185], a[104:107], v[166:169]
v_rsq_f32 v102, v106
v_mfma_f32_16x16x32_bf16 v[170:173], v[182:185], a[128:131], v[170:173]
s_waitcnt lgkmcnt(1)
ds_read_b128 v[182:185], v210 offset:10240
v_mul_f32_e64 v103, -v103, v102
v_mfma_f32_16x16x32_bf16 v[138:141], a[12:15], v[186:189], v[138:141]
ds_write_b64 v211, v[102:103] offset:20480
v_mfma_f32_16x16x32_bf16 v[142:145], a[36:39], v[186:189], v[142:145]
v_mfma_f32_16x16x32_bf16 v[146:149], a[60:63], v[186:189], v[146:149]
ds_read_b64 v[118:119], v219 offset:20480
ds_read_b64 v[126:127], v219 offset:20736
v_mfma_f32_16x16x32_bf16 v[150:153], a[228:231], v[186:189], v[150:153]
ds_read_b64 v[134:135], v219 offset:20992
v_mfma_f32_16x16x32_bf16 v[154:157], a[252:255], v[186:189], v[154:157]
v_mfma_f32_16x16x32_bf16 v[158:161], v[244:247], v[186:189], v[158:161]
v_mfma_f32_16x16x32_bf16 v[162:165], v[186:189], a[84:87], v[162:165]
s_nop 0
v_mfma_f32_16x16x32_bf16 v[166:169], v[186:189], a[108:111], v[166:169]
s_waitcnt lgkmcnt(2)
v_fma_f32 v220, v36, v118, v119
v_fma_f32 v221, v37, v118, v119
v_mfma_f32_16x16x32_bf16 v[170:173], v[186:189], a[132:135], v[170:173]
ds_read_b128 v[186:189], v210 offset:11264
v_fma_f32 v222, v38, v118, v119
v_mfma_f32_16x16x32_bf16 v[138:141], a[16:19], v[182:185], v[138:141]
v_fma_f32 v223, v39, v118, v119
v_cvt_pk_bf16_f32 v90, v220, v221
v_mfma_f32_16x16x32_bf16 v[142:145], a[40:43], v[182:185], v[142:145]
v_cvt_pk_bf16_f32 v91, v222, v223
v_fma_f32 v220, v40, v118, v119
v_mfma_f32_16x16x32_bf16 v[146:149], a[64:67], v[182:185], v[146:149]
v_fma_f32 v221, v41, v118, v119
v_fma_f32 v222, v42, v118, v119
v_mfma_f32_16x16x32_bf16 v[150:153], a[232:235], v[182:185], v[150:153]
v_fma_f32 v223, v43, v118, v119
v_cvt_pk_bf16_f32 v92, v220, v221
v_mfma_f32_16x16x32_bf16 v[154:157], v[224:227], v[182:185], v[154:157]
v_cvt_pk_bf16_f32 v93, v222, v223
v_fma_f32 v220, v44, v118, v119
v_mfma_f32_16x16x32_bf16 v[158:161], v[248:251], v[182:185], v[158:161]
ds_write_b128 v211, v[90:93] offset:20480
v_mfma_f32_16x16x32_bf16 v[162:165], v[182:185], a[88:91], v[162:165]
v_fma_f32 v221, v45, v118, v119
v_fma_f32 v222, v46, v118, v119
v_mfma_f32_16x16x32_bf16 v[166:169], v[182:185], a[112:115], v[166:169]
s_nop 0
v_fma_f32 v223, v47, v118, v119
v_cvt_pk_bf16_f32 v94, v220, v221
v_mfma_f32_16x16x32_bf16 v[170:173], v[182:185], a[136:139], v[170:173]
s_waitcnt lgkmcnt(1)
ds_read_b128 v[182:185], v210 offset:12288
v_cvt_pk_bf16_f32 v95, v222, v223
v_mfma_f32_16x16x32_bf16 v[138:141], a[20:23], v[186:189], v[138:141]
ds_write_b64 v212, v[94:95] offset:20480
v_mfma_f32_16x16x32_bf16 v[142:145], a[44:47], v[186:189], v[142:145]
v_fma_f32 v220, v48, v126, v127
v_fma_f32 v221, v49, v126, v127
v_mfma_f32_16x16x32_bf16 v[146:149], a[68:71], v[186:189], v[146:149]
v_cvt_pk_bf16_f32 v96, v138, v139
v_cvt_pk_bf16_f32 v97, v140, v141
v_mfma_f32_16x16x32_bf16 v[150:153], a[236:239], v[186:189], v[150:153]
v_cvt_pk_bf16_f32 v98, v142, v143
v_cvt_pk_bf16_f32 v99, v144, v145
v_mfma_f32_16x16x32_bf16 v[154:157], v[228:231], v[186:189], v[154:157]
v_cvt_pk_bf16_f32 v100, v146, v147
v_cvt_pk_bf16_f32 v101, v148, v149
v_mfma_f32_16x16x32_bf16 v[158:161], v[252:255], v[186:189], v[158:161]
v_cvt_pk_bf16_f32 v84, v150, v151
v_cvt_pk_bf16_f32 v85, v152, v153
v_mfma_f32_16x16x32_bf16 v[162:165], v[186:189], a[92:95], v[162:165]
v_cvt_pk_bf16_f32 v86, v154, v155
v_cvt_pk_bf16_f32 v87, v156, v157
v_mfma_f32_16x16x32_bf16 v[166:169], v[186:189], a[116:119], v[166:169]
s_nop 0
v_cvt_pk_bf16_f32 v88, v158, v159
v_cvt_pk_bf16_f32 v89, v160, v161
v_mfma_f32_16x16x32_bf16 v[170:173], v[186:189], a[140:143], v[170:173]
s_waitcnt lgkmcnt(1)
ds_read_b128 v[186:189], v210 offset:13312
v_cvt_pk_bf16_f32 v116, v162, v163
v_mfma_f32_16x16x32_bf16 v[138:141], a[0:3], v[182:185], 0
v_cvt_pk_bf16_f32 v124, v166, v167
v_cvt_pk_bf16_f32 v125, v168, v169
v_mfma_f32_16x16x32_bf16 v[142:145], a[24:27], v[182:185], 0
v_cvt_pk_bf16_f32 v117, v164, v165
v_fma_f32 v222, v50, v126, v127
v_mfma_f32_16x16x32_bf16 v[146:149], a[48:51], v[182:185], 0
ds_read_b128 v[182:185], v210 offset:14336
v_fma_f32 v223, v51, v126, v127
v_cvt_pk_bf16_f32 v174, v220, v221
v_mfma_f32_16x16x16_bf16 v[154:157], v[82:83], v[88:89], 0
v_cvt_pk_bf16_f32 v175, v222, v223
v_fma_f32 v220, v52, v126, v127
v_fma_f32 v221, v53, v126, v127
v_mfma_f32_16x16x16_bf16 v[158:161], v[100:101], v[88:89], 0
v_fma_f32 v222, v54, v126, v127
v_fma_f32 v223, v55, v126, v127
v_cvt_pk_bf16_f32 v176, v220, v221
v_cvt_pk_bf16_f32 v177, v222, v223
s_waitcnt lgkmcnt(1)
v_mfma_f32_16x16x32_bf16 v[138:141], a[4:7], v[186:189], v[138:141]
ds_write_b128 v211, v[174:177] offset:26624
v_mfma_f32_16x16x32_bf16 v[142:145], a[28:31], v[186:189], v[142:145]
v_fma_f32 v220, v56, v126, v127
v_fma_f32 v221, v57, v126, v127
v_mfma_f32_16x16x32_bf16 v[146:149], a[52:55], v[186:189], v[146:149]
s_waitcnt lgkmcnt(1)
v_fma_f32 v222, v58, v126, v127
v_fma_f32 v223, v59, v126, v127
v_mfma_f32_16x16x32_bf16 v[138:141], a[8:11], v[182:185], v[138:141]
ds_read_b128 v[186:189], v210 offset:15360
v_cvt_pk_bf16_f32 v178, v220, v221
v_mfma_f32_16x16x32_bf16 v[142:145], a[32:35], v[182:185], v[142:145]
v_cvt_pk_bf16_f32 v179, v222, v223
v_fma_f32 v220, v60, v134, v135
v_mfma_f32_16x16x32_bf16 v[146:149], a[56:59], v[182:185], v[146:149]
ds_read_b128 v[182:185], v210 offset:16384
ds_write_b64 v212, v[178:179] offset:26624
v_mfma_f32_16x16x16_bf16 v[166:169], v[112:113], v[88:89], v[206:209]
v_fma_f32 v221, v61, v134, v135
v_fma_f32 v222, v62, v134, v135
v_fma_f32 v223, v63, v134, v135
v_mfma_f32_16x16x16_bf16 v[150:153], v[112:113], v[76:77], v[206:209]
v_cvt_pk_bf16_f32 v90, v220, v221
v_cvt_pk_bf16_f32 v91, v222, v223
v_fma_f32 v220, v64, v134, v135
v_fma_f32 v221, v65, v134, v135
v_mfma_f32_16x16x32_bf16 v[154:157], v[78:81], v[84:87], v[154:157]
s_waitcnt lgkmcnt(2)
v_fma_f32 v222, v66, v134, v135
v_fma_f32 v223, v67, v134, v135
v_mfma_f32_16x16x32_bf16 v[138:141], a[12:15], v[186:189], v[138:141]
s_nop 0
v_cvt_pk_bf16_f32 v92, v220, v221
v_cvt_pk_bf16_f32 v93, v222, v223
v_mfma_f32_16x16x32_bf16 v[142:145], a[36:39], v[186:189], v[142:145]
s_nop 0
ds_write_b128 v211, v[90:93] offset:32768
v_mfma_f32_16x16x32_bf16 v[146:149], a[60:63], v[186:189], v[146:149]
s_waitcnt lgkmcnt(2)
v_fma_f32 v220, v68, v134, v135
v_fma_f32 v221, v69, v134, v135
v_mfma_f32_16x16x32_bf16 v[138:141], a[16:19], v[182:185], v[138:141]
v_fma_f32 v222, v70, v134, v135
v_fma_f32 v223, v71, v134, v135
v_mfma_f32_16x16x32_bf16 v[142:145], a[40:43], v[182:185], v[142:145]
ds_read_b128 v[186:189], v210 offset:17408
v_cvt_pk_bf16_f32 v132, v170, v171
v_mfma_f32_16x16x32_bf16 v[150:153], v[108:111], v[72:75], v[150:153]
v_cvt_pk_bf16_f32 v133, v172, v173
v_cvt_pk_bf16_f32 v94, v220, v221
v_mfma_f32_16x16x32_bf16 v[146:149], a[64:67], v[182:185], v[146:149]
ds_read_b128 v[182:185], v210 offset:12288
v_cvt_pk_bf16_f32 v95, v222, v223
v_mfma_f32_16x16x32_bf16 v[158:161], v[96:99], v[84:87], v[158:161]
ds_write_b64 v212, v[94:95] offset:32768
v_mfma_f32_16x16x32_bf16 v[166:169], v[108:111], v[84:87], v[166:169]
v_exp_f32 v150, v150
s_nop 0
v_cvt_pk_bf16_f32 v180, v150, 0
v_exp_f32 v154, v154
v_exp_f32 v155, v155
s_waitcnt lgkmcnt(2)
v_mfma_f32_16x16x32_bf16 v[138:141], a[20:23], v[186:189], v[138:141]
v_exp_f32 v156, v156
v_mfma_f32_16x16x32_bf16 v[142:145], a[44:47], v[186:189], v[142:145]
s_waitcnt lgkmcnt(1)
v_exp_f32 v157, v157
v_mfma_f32_16x16x32_bf16 v[118:121], v[182:185], a[72:75], 0
v_cvt_pk_bf16_f32 v102, v138, v139
v_cvt_pk_bf16_f32 v103, v140, v141
v_mfma_f32_16x16x16_bf16 v[138:141], v[82:83], v[76:77], 0
v_cvt_pk_bf16_f32 v104, v142, v143
v_cvt_pk_bf16_f32 v105, v144, v145
v_exp_f32 v158, v158
v_mfma_f32_16x16x16_bf16 v[142:145], v[100:101], v[76:77], 0
v_exp_f32 v159, v159
v_exp_f32 v160, v160
v_mfma_f32_16x16x32_bf16 v[138:141], v[78:81], v[72:75], v[138:141]
v_exp_f32 v161, v161
v_mfma_f32_16x16x32_bf16 v[142:145], v[96:99], v[72:75], v[142:145]
v_exp_f32 v166, v166
v_mfma_f32_16x16x32_bf16 v[126:129], v[182:185], a[96:99], 0
v_exp_f32 v138, v138
v_mfma_f32_16x16x32_bf16 v[134:137], v[182:185], a[120:123], 0
v_exp_f32 v139, v139
v_mfma_f32_16x16x32_bf16 v[90:93], a[216:219], v[182:185], 0
v_exp_f32 v140, v140
v_mfma_f32_16x16x32_bf16 v[170:173], a[240:243], v[182:185], 0
v_exp_f32_e64 v141, v141
v_mfma_f32_16x16x32_bf16 v[220:223], v[232:235], v[182:185], 0
ds_read_b128 v[182:185], v210 offset:14336
v_cvt_pk_bf16_f32 v174, v138, v139
v_mfma_f32_16x16x32_bf16 v[146:149], a[68:71], v[186:189], v[146:149]
ds_read_b128 v[186:189], v210 offset:13312
v_exp_f32 v142, v142
v_exp_f32 v143, v143
v_exp_f32 v144, v144
v_cvt_pk_bf16_f32 v106, v146, v147
v_cvt_pk_bf16_f32 v107, v148, v149
v_exp_f32 v145, v145
v_mfma_f32_16x16x16_bf16 v[162:165], v[106:107], v[88:89], 0
v_cvt_pk_bf16_f32 v175, v140, v141
v_cvt_pk_bf16_f32 v176, v142, v143
v_cvt_pk_bf16_f32 v177, v144, v145
v_mfma_f32_16x16x16_bf16 v[146:149], v[106:107], v[76:77], 0
ds_read_b64 v[76:77], v215 offset:16
v_mfma_f32_16x16x32_bf16 v[162:165], v[102:105], v[84:87], v[162:165]
v_mfma_f32_16x16x32_bf16 v[146:149], v[102:105], v[72:75], v[146:149]
ds_read_b128 v[72:75], v215
s_waitcnt lgkmcnt(2)
v_mfma_f32_16x16x32_bf16 v[118:121], v[186:189], a[76:79], v[118:121]
v_exp_f32 v162, v162
v_mfma_f32_16x16x32_bf16 v[126:129], v[186:189], a[100:103], v[126:129]
v_exp_f32 v146, v146
v_mfma_f32_16x16x32_bf16 v[134:137], v[186:189], a[124:127], v[134:137]
v_exp_f32 v147, v147
v_mfma_f32_16x16x32_bf16 v[90:93], a[220:223], v[186:189], v[90:93]
v_exp_f32 v148, v148
v_mfma_f32_16x16x32_bf16 v[170:173], a[244:247], v[186:189], v[170:173]
v_exp_f32 v149, v149
v_mfma_f32_16x16x32_bf16 v[220:223], v[236:239], v[186:189], v[220:223]
ds_read_b128 v[186:189], v210 offset:15360
v_cvt_pk_bf16_f32 v178, v146, v147
v_mfma_f32_16x16x32_bf16 v[118:121], v[182:185], a[80:83], v[118:121]
v_exp_f32 v163, v163
v_mfma_f32_16x16x32_bf16 v[126:129], v[182:185], a[104:107], v[126:129]
v_exp_f32 v164, v164
v_mfma_f32_16x16x32_bf16 v[134:137], v[182:185], a[128:131], v[134:137]
v_exp_f32 v165, v165
v_mfma_f32_16x16x32_bf16 v[90:93], a[224:227], v[182:185], v[90:93]
v_cvt_pk_bf16_f32 v179, v148, v149
v_mfma_f32_16x16x32_bf16 v[170:173], a[248:251], v[182:185], v[170:173]
v_mfma_f32_16x16x32_bf16 v[220:223], v[240:243], v[182:185], v[220:223]
ds_read_b128 v[182:185], v210 offset:16384
s_waitcnt lgkmcnt(1)
v_mfma_f32_16x16x32_bf16 v[118:121], v[186:189], a[84:87], v[118:121]
v_mfma_f32_16x16x32_bf16 v[126:129], v[186:189], a[108:111], v[126:129]
v_mfma_f32_16x16x32_bf16 v[134:137], v[186:189], a[132:135], v[134:137]
v_mfma_f32_16x16x32_bf16 v[90:93], a[228:231], v[186:189], v[90:93]
v_mfma_f32_16x16x32_bf16 v[170:173], a[252:255], v[186:189], v[170:173]
v_mfma_f32_16x16x32_bf16 v[220:223], v[244:247], v[186:189], v[220:223]
ds_read_b128 v[186:189], v210 offset:17408
s_waitcnt lgkmcnt(1)
v_mfma_f32_16x16x32_bf16 v[118:121], v[182:185], a[88:91], v[118:121]
v_mfma_f32_16x16x32_bf16 v[126:129], v[182:185], a[112:115], v[126:129]
v_mfma_f32_16x16x32_bf16 v[134:137], v[182:185], a[136:139], v[134:137]
v_mfma_f32_16x16x32_bf16 v[90:93], a[232:235], v[182:185], v[90:93]
v_mfma_f32_16x16x32_bf16 v[170:173], v[224:227], v[182:185], v[170:173]
v_mfma_f32_16x16x32_bf16 v[220:223], v[248:251], v[182:185], v[220:223]
s_waitcnt lgkmcnt(0)
v_mfma_f32_16x16x32_bf16 v[118:121], v[186:189], a[92:95], v[118:121]
v_mfma_f32_16x16x32_bf16 v[126:129], v[186:189], a[116:119], v[126:129]
v_mfma_f32_16x16x32_bf16 v[134:137], v[186:189], a[140:143], v[134:137]
v_cvt_pk_bf16_f32 v118, v118, v119
v_cvt_pk_bf16_f32 v119, v120, v121
v_mfma_f32_16x16x32_bf16 v[90:93], a[236:239], v[186:189], v[90:93]
ds_read_u16 v120, v214 offset:1024
v_cvt_pk_bf16_f32 v126, v126, v127
v_mfma_f32_16x16x32_bf16 v[170:173], v[228:231], v[186:189], v[170:173]
v_cvt_pk_bf16_f32 v127, v128, v129
v_cvt_pk_bf16_f32 v134, v134, v135
v_mfma_f32_16x16x32_bf16 v[220:223], v[252:255], v[186:189], v[220:223]
ds_read_u16 v128, v214 offset:1032
v_cvt_pk_bf16_f32 v90, v90, v91
v_mfma_f32_16x16x32_bf16 v[150:153], v[190:193], v[174:177], 0
v_cvt_pk_bf16_f32 v91, v92, v93
v_cvt_pk_bf16_f32 v92, v170, v171
v_mfma_f32_16x16x32_bf16 v[138:141], v[114:117], v[174:177], 0
v_cvt_pk_bf16_f32 v93, v172, v173
v_cvt_pk_bf16_f32 v135, v136, v137
v_mfma_f32_16x16x32_bf16 v[142:145], v[122:125], v[174:177], 0
ds_read_u16 v136, v214 offset:1040
v_mov_b32 v121, 0
v_mfma_f32_16x16x32_bf16 v[146:149], v[130:133], v[174:177], 0
v_cvt_pk_bf16_f32 v174, v154, v155
v_cvt_pk_bf16_f32 v175, v156, v157
v_mfma_f32_16x16x32_bf16 v[150:153], v[190:193], v[178:181], v[150:153]
s_waitcnt lgkmcnt(2)
v_cvt_pk_bf16_f32 v176, v158, v159
v_cvt_pk_bf16_f32 v177, v160, v161
v_mfma_f32_16x16x32_bf16 v[138:141], v[118:121], v[178:181], v[138:141]
v_mov_b32 v129, 0
v_mov_b32 v137, 0
v_mfma_f32_16x16x32_bf16 v[154:157], v[114:117], v[174:177], 0
v_rcp_f32 v151, v150
v_mfma_f32_16x16x32_bf16 v[158:161], v[122:125], v[174:177], 0
s_waitcnt lgkmcnt(1)
v_max3_u32 v218, v218, v150, v151
v_mul_f32_e64 v151, s3, v151
v_mfma_f32_16x16x32_bf16 v[142:145], v[126:129], v[178:181], v[142:145]
s_waitcnt lgkmcnt(0)
v_mul_f32 v138, v138, v151
v_mul_f32_e64 v139, v139, v151
v_mfma_f32_16x16x32_bf16 v[146:149], v[134:137], v[178:181], v[146:149]
v_cvt_pk_bf16_f32 v180, v166, 0
v_mul_f32_e64 v140, v140, v151
v_mfma_f32_16x16x32_bf16 v[166:169], v[190:193], v[174:177], 0
v_mul_f32_e64 v141, v141, v151
v_cvt_pk_bf16_f32 v138, v138, v139
v_mul_f32 v142, v142, v151
v_mul_f32 v143, v143, v151
v_mul_f32 v144, v144, v151
v_mul_f32 v145, v145, v151
v_cvt_pk_bf16_f32 v139, v140, v141
v_cvt_pk_bf16_f32 v140, v142, v143
v_cvt_pk_bf16_f32 v141, v144, v145
v_cvt_pk_bf16_f32 v178, v162, v163
v_cvt_pk_bf16_f32 v179, v164, v165
v_mfma_f32_16x16x32_bf16 v[162:165], v[130:133], v[174:177], 0
ds_write_b128 v211, v[138:141] offset:38912
v_mfma_f32_16x16x32_bf16 v[138:141], v[78:81], v[90:93], 0
v_mul_f32 v146, v146, v151
v_mul_f32 v147, v147, v151
v_mfma_f32_16x16x32_bf16 v[166:169], v[190:193], v[178:181], v[166:169]
v_mul_f32 v148, v148, v151
v_mul_f32 v149, v149, v151
v_mfma_f32_16x16x32_bf16 v[154:157], v[118:121], v[178:181], v[154:157]
v_cvt_pk_bf16_f32 v142, v146, v147
v_cvt_pk_bf16_f32 v143, v148, v149
v_mfma_f32_16x16x32_bf16 v[158:161], v[126:129], v[178:181], v[158:161]
ds_write_b64 v212, v[142:143] offset:38912
v_mfma_f32_16x16x32_bf16 v[142:145], v[96:99], v[90:93], 0
v_rcp_f32_e64 v167, v166
v_mfma_f32_16x16x32_bf16 v[162:165], v[134:137], v[178:181], v[162:165]
v_max3_u32 v218, v218, v166, v167
v_cvt_pk_bf16_f32 v94, v220, v221
v_mfma_f32_16x16x32_bf16 v[150:153], v[108:111], v[90:93], v[206:209]
v_cvt_pk_bf16_f32 v95, v222, v223
v_mul_f32_e64 v167, s3, v167
v_mfma_f32_16x16x32_bf16 v[146:149], v[102:105], v[90:93], 0
v_mul_f32 v154, v154, v167
v_mul_f32 v155, v155, v167
v_mul_f32_e64 v156, v156, v167
v_mfma_f32_16x16x16_bf16 v[138:141], v[82:83], v[94:95], v[138:141]
v_mul_f32_e64 v157, v157, v167
v_cvt_pk_bf16_f32 v154, v154, v155
v_mul_f32_e64 v158, v158, v167
v_mfma_f32_16x16x16_bf16 v[142:145], v[100:101], v[94:95], v[142:145]
v_mul_f32 v159, v159, v167
v_mul_f32 v160, v160, v167
v_mul_f32_e64 v161, v161, v167
v_mfma_f32_16x16x16_bf16 v[150:153], v[112:113], v[94:95], v[150:153]
v_cvt_pk_bf16_f32 v155, v156, v157
v_cvt_pk_bf16_f32 v156, v158, v159
v_cvt_pk_bf16_f32 v157, v160, v161
v_mfma_f32_16x16x16_bf16 v[146:149], v[106:107], v[94:95], v[146:149]
v_mul_f32 v162, v162, v167
v_mul_f32 v163, v163, v167
v_mul_f32 v164, v164, v167
v_mul_f32 v165, v165, v167
v_mfma_f32_16x16x16_bf16 v[166:169], v[76:77], v[112:113], v[206:209]
v_cvt_pk_bf16_f32 v158, v162, v163
v_cvt_pk_bf16_f32 v159, v164, v165
v_exp_f32 v138, v138
v_mfma_f32_16x16x16_bf16 v[162:165], v[76:77], v[106:107], 0
v_exp_f32 v139, v139
v_exp_f32 v140, v140
v_mfma_f32_16x16x32_bf16 v[166:169], v[72:75], v[108:111], v[166:169]
ds_write_b128 v211, v[154:157] offset:45056
v_mfma_f32_16x16x16_bf16 v[154:157], v[76:77], v[82:83], 0
v_exp_f32 v141, v141
v_exp_f32 v142, v142
v_mfma_f32_16x16x32_bf16 v[162:165], v[72:75], v[102:105], v[162:165]
v_exp_f32 v143, v143
v_mfma_f32_16x16x32_bf16 v[154:157], v[72:75], v[78:81], v[154:157]
ds_write_b64 v212, v[158:159] offset:45056
v_mfma_f32_16x16x16_bf16 v[158:161], v[76:77], v[100:101], 0
v_exp_f32 v144, v144
v_exp_f32 v145, v145
v_exp_f32_e64 v150, v150
v_mfma_f32_16x16x32_bf16 v[158:161], v[72:75], v[96:99], v[158:161]
v_cvt_pk_bf16_f32 v174, v138, v139
v_cvt_pk_bf16_f32 v175, v140, v141
v_cvt_pk_bf16_f32 v176, v142, v143
v_cvt_pk_bf16_f32 v177, v144, v145
v_cvt_pk_bf16_f32 v180, v150, 0
v_exp_f32_e64 v146, v146
v_mfma_f32_16x16x32_bf16 v[150:153], v[190:193], v[174:177], 0
v_exp_f32 v147, v147
v_mfma_f32_16x16x32_bf16 v[138:141], v[114:117], v[174:177], 0
s_waitcnt lgkmcnt(0)
v_exp_f32 v148, v148
v_mfma_f32_16x16x32_bf16 v[142:145], v[122:125], v[174:177], 0
s_barrier
ds_read_b128 v[170:173], v210 offset:38912
ds_read_b128 v[182:185], v210 offset:39936
ds_read_b128 v[186:189], v210 offset:40960
v_exp_f32_e64 v149, v149
v_cvt_pk_bf16_f32 v178, v146, v147
v_cvt_pk_bf16_f32 v179, v148, v149
v_mfma_f32_16x16x32_bf16 v[146:149], v[130:133], v[174:177], 0
v_mov_b32_dpp v154, v158 quad_perm:[0,1,2,3] row_mask:0x2 bank_mask:0xf
v_mfma_f32_16x16x32_bf16 v[150:153], v[190:193], v[178:181], v[150:153]
v_mov_b32_dpp v154, v162 quad_perm:[0,1,2,3] row_mask:0x4 bank_mask:0xf
v_mfma_f32_16x16x32_bf16 v[138:141], v[118:121], v[178:181], v[138:141]
v_mov_b32_dpp v154, v167 quad_perm:[0,1,2,3] row_mask:0x8 bank_mask:0xf
v_exp_f32_e64 v154, v154
v_mfma_f32_16x16x32_bf16 v[142:145], v[126:129], v[178:181], v[142:145]
v_cvt_pk_bf16_f32 v154, v154, 0
v_rcp_f32 v151, v150
v_mfma_f32_16x16x32_bf16 v[146:149], v[134:137], v[178:181], v[146:149]
s_waitcnt lgkmcnt(2)
ds_write_b16 v214, v154
v_mfma_f32_16x16x32_bf16 v[0:3], a[144:147], v[170:173], v[0:3]
ds_read_b128 v[84:87], v215
ds_read_b128 v[88:91], v215 offset:16
v_mfma_f32_16x16x32_bf16 v[4:7], a[168:171], v[170:173], v[4:7]
v_add_u32 v215, 1552, v215
v_mov_b32 v181, 0
v_mfma_f32_16x16x32_bf16 v[8:11], a[192:195], v[170:173], v[8:11]
s_waitcnt lgkmcnt(4)
ds_read_b128 v[170:173], v210 offset:41984
ds_read_b64 v[112:113], v215 offset:528
v_mfma_f32_16x16x32_bf16 v[0:3], a[148:151], v[182:185], v[0:3]
ds_read_b128 v[108:111], v215 offset:512
v_mfma_f32_16x16x32_bf16 v[4:7], a[172:175], v[182:185], v[4:7]
v_mfma_f32_16x16x32_bf16 v[8:11], a[196:199], v[182:185], v[8:11]
s_nop 0
ds_read_b128 v[182:185], v210 offset:43008
s_waitcnt lgkmcnt(5)
v_mfma_f32_16x16x32_bf16 v[166:169], v[84:87], v[190:193], 0
v_mfma_f32_16x16x32_bf16 v[154:157], v[84:87], v[114:117], 0
v_mfma_f32_16x16x32_bf16 v[158:161], v[84:87], v[122:125], 0
v_mfma_f32_16x16x32_bf16 v[162:165], v[84:87], v[130:133], 0
s_waitcnt lgkmcnt(4)
v_mfma_f32_16x16x32_bf16 v[166:169], v[88:91], v[190:193], v[166:169]
v_mfma_f32_16x16x32_bf16 v[154:157], v[88:91], v[118:121], v[154:157]
v_mfma_f32_16x16x32_bf16 v[158:161], v[88:91], v[126:129], v[158:161]
v_rcp_f32 v167, v166
v_mfma_f32_16x16x32_bf16 v[162:165], v[88:91], v[134:137], v[162:165]
v_max3_u32 v218, v218, v166, v167
v_max3_u32 v218, v218, v150, v151
v_mfma_f32_16x16x32_bf16 v[0:3], a[152:155], v[186:189], v[0:3]
v_mul_f32 v151, s3, v151
v_mul_f32 v138, v138, v151
v_mfma_f32_16x16x32_bf16 v[4:7], a[176:179], v[186:189], v[4:7]
v_mul_f32_e64 v139, v139, v151
v_mul_f32 v140, v140, v151
v_mfma_f32_16x16x32_bf16 v[8:11], a[200:203], v[186:189], v[8:11]
s_waitcnt lgkmcnt(3)
ds_read_b128 v[186:189], v210 offset:44032
v_mul_f32_e64 v141, v141, v151
v_mfma_f32_16x16x32_bf16 v[0:3], a[156:159], v[170:173], v[0:3]
v_cvt_pk_bf16_f32 v138, v138, v139
v_mul_f32_e64 v142, v142, v151
v_mfma_f32_16x16x32_bf16 v[4:7], a[180:183], v[170:173], v[4:7]
v_mul_f32_e64 v143, v143, v151
v_mul_f32 v144, v144, v151
v_mfma_f32_16x16x32_bf16 v[8:11], a[204:207], v[170:173], v[8:11]
s_waitcnt lgkmcnt(1)
ds_read_b128 v[170:173], v210 offset:45056
v_mul_f32_e64 v145, v145, v151
v_mfma_f32_16x16x32_bf16 v[0:3], a[160:163], v[182:185], v[0:3]
v_cvt_pk_bf16_f32 v139, v140, v141
v_cvt_pk_bf16_f32 v140, v142, v143
v_mfma_f32_16x16x32_bf16 v[4:7], a[184:187], v[182:185], v[4:7]
v_cvt_pk_bf16_f32 v141, v144, v145
v_mul_f32 v146, v146, v151
v_mfma_f32_16x16x32_bf16 v[8:11], a[208:211], v[182:185], v[8:11]
s_waitcnt lgkmcnt(1)
ds_read_b128 v[182:185], v210 offset:46080
ds_write_b128 v211, v[138:141] offset:51200
v_mfma_f32_16x16x32_bf16 v[0:3], a[164:167], v[186:189], v[0:3]
v_mul_f32 v147, v147, v151
v_mul_f32 v148, v148, v151
v_mfma_f32_16x16x32_bf16 v[4:7], a[188:191], v[186:189], v[4:7]
v_mul_f32 v149, v149, v151
v_cvt_pk_bf16_f32 v142, v146, v147
v_mfma_f32_16x16x32_bf16 v[8:11], a[212:215], v[186:189], v[8:11]
s_waitcnt lgkmcnt(2)
ds_read_b128 v[186:189], v210 offset:47104
v_cvt_pk_bf16_f32 v143, v148, v149
v_mfma_f32_16x16x32_bf16 v[12:15], a[144:147], v[170:173], v[12:15]
ds_write_b64 v212, v[142:143] offset:51200
v_mfma_f32_16x16x32_bf16 v[16:19], a[168:171], v[170:173], v[16:19]
s_nop 0
v_cvt_pk_bf16_f32 v72, v0, v1
v_cvt_pk_bf16_f32 v73, v2, v3
v_mfma_f32_16x16x32_bf16 v[20:23], a[192:195], v[170:173], v[20:23]
s_waitcnt lgkmcnt(3)
ds_read_b128 v[170:173], v210 offset:48128
buffer_store_dwordx2 v[72:73], v203, s[8:11], s38 offen
v_mov_b32_dpp v154, v158 quad_perm:[0,1,2,3] row_mask:0x2 bank_mask:0xf
v_mfma_f32_16x16x32_bf16 v[12:15], a[148:151], v[182:185], v[12:15]
v_mul_f32_e64 v167, s3, v167
v_mov_b32_dpp v154, v162 quad_perm:[0,1,2,3] row_mask:0x4 bank_mask:0xf
v_mfma_f32_16x16x32_bf16 v[16:19], a[172:175], v[182:185], v[16:19]
v_mul_f32 v154, v154, v167
v_cvt_pk_bf16_f32 v154, v154, 0
v_mfma_f32_16x16x32_bf16 v[20:23], a[196:199], v[182:185], v[20:23]
s_waitcnt lgkmcnt(2)
ds_read_b128 v[182:185], v210 offset:49152
ds_write_b16 v214, v154
v_mfma_f32_16x16x32_bf16 v[12:15], a[152:155], v[186:189], v[12:15]
s_nop 0
v_cvt_pk_bf16_f32 v74, v4, v5
v_cvt_pk_bf16_f32 v75, v6, v7
v_mfma_f32_16x16x32_bf16 v[16:19], a[176:179], v[186:189], v[16:19]
s_waitcnt lgkmcnt(2)
v_cvt_pk_bf16_f32 v76, v8, v9
v_cvt_pk_bf16_f32 v77, v10, v11
v_mfma_f32_16x16x32_bf16 v[20:23], a[200:203], v[186:189], v[20:23]
s_barrier
v_mfma_f32_16x16x32_bf16 v[12:15], a[156:159], v[170:173], v[12:15]
s_nop 0
ds_read_b128 v[186:189], v210 offset:50176
v_add_u32 v214, 1552, v214
v_mfma_f32_16x16x32_bf16 v[16:19], a[180:183], v[170:173], v[16:19]
v_mfma_f32_16x16x32_bf16 v[20:23], a[204:207], v[170:173], v[20:23]
ds_read_b128 v[170:173], v210 offset:51200
s_waitcnt lgkmcnt(3)
v_mfma_f32_16x16x32_bf16 v[12:15], a[160:163], v[182:185], v[12:15]
v_mfma_f32_16x16x32_bf16 v[16:19], a[184:187], v[182:185], v[16:19]
buffer_store_dwordx2 v[74:75], v203, s[8:11], s38 offen offset:32
v_mfma_f32_16x16x32_bf16 v[20:23], a[208:211], v[182:185], v[20:23]
ds_read_b128 v[182:185], v210 offset:52224
s_waitcnt lgkmcnt(2)
v_mfma_f32_16x16x32_bf16 v[12:15], a[164:167], v[186:189], v[12:15]
v_mfma_f32_16x16x32_bf16 v[16:19], a[188:191], v[186:189], v[16:19]
s_nop 0
v_mfma_f32_16x16x32_bf16 v[20:23], a[212:215], v[186:189], v[20:23]
s_waitcnt lgkmcnt(1)
ds_read_b128 v[186:189], v210 offset:53248
v_cvt_pk_bf16_f32 v78, v12, v13
v_mfma_f32_16x16x32_bf16 v[24:27], a[144:147], v[170:173], v[24:27]
v_cvt_pk_bf16_f32 v79, v14, v15
v_cvt_pk_bf16_f32 v80, v16, v17
v_mfma_f32_16x16x32_bf16 v[28:31], a[168:171], v[170:173], v[28:31]
s_nop 0
v_cvt_pk_bf16_f32 v81, v18, v19
v_cvt_pk_bf16_f32 v82, v20, v21
v_mfma_f32_16x16x32_bf16 v[32:35], a[192:195], v[170:173], v[32:35]
s_waitcnt lgkmcnt(1)
ds_read_b128 v[170:173], v210 offset:54272
v_cvt_pk_bf16_f32 v83, v22, v23
v_mfma_f32_16x16x32_bf16 v[24:27], a[148:151], v[182:185], v[24:27]
v_mfma_f32_16x16x32_bf16 v[28:31], a[172:175], v[182:185], v[28:31]
v_mfma_f32_16x16x32_bf16 v[32:35], a[196:199], v[182:185], v[32:35]
ds_read_b128 v[182:185], v210 offset:55296
s_waitcnt lgkmcnt(2)
v_mfma_f32_16x16x32_bf16 v[24:27], a[152:155], v[186:189], v[24:27]
v_mfma_f32_16x16x32_bf16 v[28:31], a[176:179], v[186:189], v[28:31]
v_mfma_f32_16x16x32_bf16 v[32:35], a[200:203], v[186:189], v[32:35]
ds_read_b128 v[186:189], v210 offset:56320
s_waitcnt lgkmcnt(2)
v_mfma_f32_16x16x32_bf16 v[24:27], a[156:159], v[170:173], v[24:27]
v_mfma_f32_16x16x32_bf16 v[28:31], a[180:183], v[170:173], v[28:31]
v_mfma_f32_16x16x32_bf16 v[32:35], a[204:207], v[170:173], v[32:35]
buffer_store_dwordx2 v[76:77], v203, s[8:11], s38 offen offset:64
s_waitcnt lgkmcnt(1)
v_mfma_f32_16x16x32_bf16 v[24:27], a[160:163], v[182:185], v[24:27]
v_mfma_f32_16x16x32_bf16 v[28:31], a[184:187], v[182:185], v[28:31]
s_waitcnt lgkmcnt(0)
s_barrier
v_mfma_f32_16x16x32_bf16 v[32:35], a[208:211], v[182:185], v[32:35]
ds_read_b128 v[182:185], v210 offset:20480
v_mfma_f32_16x16x32_bf16 v[24:27], a[164:167], v[186:189], v[24:27]
v_mfma_f32_16x16x32_bf16 v[28:31], a[188:191], v[186:189], v[28:31]
v_mfma_f32_16x16x32_bf16 v[32:35], a[212:215], v[186:189], v[32:35]
ds_read_b128 v[186:189], v210 offset:21504
v_cvt_pk_bf16_f32 v116, v24, v25
v_subrev_u32 v24, 37120, v210
v_lshrrev_b32 v25, 4, v24
v_cvt_pk_bf16_f32 v117, v26, v27
v_cvt_pk_bf16_f32 v124, v28, v29
v_and_b32 v25, 15, v25
v_lshrrev_b32 v26, 8, v24
v_mul_u32_u24 v27, 1552, v25
v_mul_u32_u24 v28, 784, v25
v_lshl_add_u32 v27, v26, 5, v27
v_lshl_add_u32 v28, v26, 4, v28
s_waitcnt lgkmcnt(1)
v_mfma_f32_16x16x32_bf16 v[138:141], a[0:3], v[182:185], 0
s_nop 0
v_add_u32 v27, 94464, v27
v_add_u32 v28, s41, v28
v_mfma_f32_16x16x32_bf16 v[142:145], a[24:27], v[182:185], 0
s_add_u32 s41, s33, 0
ds_read_b128 v[84:87], v27
ds_read_b128 v[0:3], v28
v_mfma_f32_16x16x32_bf16 v[146:149], a[48:51], v[182:185], 0
ds_read_b128 v[88:91], v27 offset:128
ds_read_b128 v[92:95], v27 offset:256
v_mfma_f32_16x16x32_bf16 v[150:153], a[216:219], v[182:185], 0
ds_read_b128 v[96:99], v27 offset:384
ds_read_b64 v[100:101], v27 offset:16
v_mfma_f32_16x16x32_bf16 v[154:157], a[240:243], v[182:185], 0
ds_read_b64 v[102:103], v27 offset:144
ds_read_b64 v[104:105], v27 offset:272
v_mfma_f32_16x16x32_bf16 v[158:161], v[232:235], v[182:185], 0
ds_read_b64 v[106:107], v27 offset:400
ds_read_b128 v[4:7], v28 offset:64
v_mfma_f32_16x16x32_bf16 v[162:165], v[182:185], a[72:75], 0
ds_read_b128 v[8:11], v28 offset:128
buffer_store_dwordx2 v[78:79], v204, s[8:11], s38 offen
v_cvt_pk_bf16_f32 v125, v30, v31
v_mfma_f32_16x16x32_bf16 v[166:169], v[182:185], a[96:99], 0
s_nop 0
v_cvt_pk_bf16_f32 v132, v32, v33
v_cvt_pk_bf16_f32 v133, v34, v35
v_mfma_f32_16x16x32_bf16 v[170:173], v[182:185], a[120:123], 0
s_waitcnt lgkmcnt(11)
ds_read_b128 v[182:185], v210 offset:22528
ds_read_b128 v[12:15], v28 offset:12544
v_mfma_f32_16x16x32_bf16 v[138:141], a[4:7], v[186:189], v[138:141]
s_nop 0
ds_read_b128 v[16:19], v28 offset:12608
v_lshlrev_b32 v31, 5, v25
v_mfma_f32_16x16x32_bf16 v[142:145], a[28:31], v[186:189], v[142:145]
s_waitcnt lgkmcnt(11)
ds_read_b128 v[20:23], v28 offset:12672
v_add_u32 v31, s41, v31
v_mfma_f32_16x16x32_bf16 v[0:3], a[144:147], v[84:87], v[0:3]
s_add_u32 s41, s33, 512
v_mul_hi_u32 v32, v31, s42
v_mul_u32_u24 v29, 73, v32
v_mfma_f32_16x16x32_bf16 v[146:149], a[52:55], v[186:189], v[146:149]
s_mov_b32 s42, 1373568
v_mul_lo_u32 v32, v32, s42
v_sub_u32 v29, v31, v29
v_mfma_f32_16x16x32_bf16 v[0:3], a[148:151], v[88:91], v[0:3]
v_cmp_gt_u32 vcc, s34, v31
v_mul_u32_u24 v29, 2688, v29
v_mfma_f32_16x16x32_bf16 v[150:153], a[220:223], v[186:189], v[150:153]
s_waitcnt lgkmcnt(11)
v_lshlrev_b32 v31, 5, v25
v_add_u32 v31, s41, v31
v_mfma_f32_16x16x32_bf16 v[0:3], a[152:155], v[92:95], v[0:3]
s_mul_i32 s42, s32, 96
v_add3_u32 v29, v29, v32, s42
s_waitcnt lgkmcnt(10)
v_mfma_f32_16x16x32_bf16 v[154:157], a[244:247], v[186:189], v[154:157]
s_mov_b32 s42, 58835169
v_mov_b32 v32, 1879048192
v_cndmask_b32 v29, v32, v29, vcc
v_mfma_f32_16x16x32_bf16 v[0:3], a[156:159], v[96:99], v[0:3]
v_cmp_gt_u32 vcc, 4, v25
v_mov_b32 v32, 6000
v_mfma_f32_16x16x32_bf16 v[158:161], v[236:239], v[186:189], v[158:161]
s_waitcnt lgkmcnt(6)
v_cndmask_b32 v31, v32, v31, vcc
v_mul_hi_u32 v32, v31, s42
v_mfma_f32_16x16x32_bf16 v[0:3], a[160:163], v[100:103], v[0:3]
s_mov_b32 s42, 1373568
v_mul_u32_u24 v30, 73, v32
v_mul_lo_u32 v32, v32, s42
v_mfma_f32_16x16x32_bf16 v[0:3], a[164:167], v[104:107], v[0:3]
s_mul_i32 s42, s32, 96
v_sub_u32 v30, v31, v30
v_cmp_gt_u32 vcc, s34, v31
v_mfma_f32_16x16x32_bf16 v[162:165], v[186:189], a[76:79], v[162:165]
buffer_store_dwordx2 v[80:81], v204, s[8:11], s38 offen offset:32
v_mul_u32_u24 v30, 2688, v30
v_mfma_f32_16x16x32_bf16 v[166:169], v[186:189], a[100:103], v[166:169]
v_add3_u32 v30, v30, v32, s42
v_mov_b32 v32, 1879048192
v_mfma_f32_16x16x32_bf16 v[170:173], v[186:189], a[124:127], v[170:173]
s_waitcnt lgkmcnt(5)
ds_read_b128 v[186:189], v210 offset:23552
v_cndmask_b32 v30, v32, v30, vcc
v_mfma_f32_16x16x32_bf16 v[4:7], a[168:171], v[84:87], v[4:7]
s_nop 0
v_lshl_add_u32 v29, v26, 3, v29
v_cvt_pk_bf16_f32 v0, v0, v1
v_mfma_f32_16x16x32_bf16 v[4:7], a[172:175], v[88:91], v[4:7]
s_waitcnt lgkmcnt(4)
v_lshl_add_u32 v30, v26, 3, v30
v_add_u32 v29, 785664, v29
v_mfma_f32_16x16x32_bf16 v[138:141], a[8:11], v[182:185], v[138:141]
v_cvt_pk_bf16_f32 v1, v2, v3
v_add_u32 v30, 785664, v30
v_mfma_f32_16x16x32_bf16 v[4:7], a[176:179], v[92:95], v[4:7]
v_mfma_f32_16x16x32_bf16 v[142:145], a[32:35], v[182:185], v[142:145]
v_mfma_f32_16x16x32_bf16 v[4:7], a[180:183], v[96:99], v[4:7]
v_mfma_f32_16x16x32_bf16 v[146:149], a[56:59], v[182:185], v[146:149]
v_mfma_f32_16x16x32_bf16 v[4:7], a[184:187], v[100:103], v[4:7]
v_mfma_f32_16x16x32_bf16 v[4:7], a[188:191], v[104:107], v[4:7]
v_mfma_f32_16x16x32_bf16 v[150:153], a[224:227], v[182:185], v[150:153]
v_mfma_f32_16x16x32_bf16 v[154:157], a[248:251], v[182:185], v[154:157]
v_cvt_pk_bf16_f32 v4, v4, v5
v_cvt_pk_bf16_f32 v5, v6, v7
v_mfma_f32_16x16x32_bf16 v[158:161], v[240:243], v[182:185], v[158:161]
v_mfma_f32_16x16x32_bf16 v[8:11], a[192:195], v[84:87], v[8:11]
v_mfma_f32_16x16x32_bf16 v[162:165], v[182:185], a[80:83], v[162:165]
buffer_store_dwordx2 v[82:83], v204, s[8:11], s38 offen offset:64
v_mfma_f32_16x16x32_bf16 v[8:11], a[196:199], v[88:91], v[8:11]
v_mfma_f32_16x16x32_bf16 v[166:169], v[182:185], a[104:107], v[166:169]
v_mfma_f32_16x16x32_bf16 v[8:11], a[200:203], v[92:95], v[8:11]
v_mfma_f32_16x16x32_bf16 v[170:173], v[182:185], a[128:131], v[170:173]
ds_read_b128 v[182:185], v210 offset:24576
v_mfma_f32_16x16x32_bf16 v[8:11], a[204:207], v[96:99], v[8:11]
v_mfma_f32_16x16x32_bf16 v[8:11], a[208:211], v[100:103], v[8:11]
s_nop 0
v_mfma_f32_16x16x32_bf16 v[8:11], a[212:215], v[104:107], v[8:11]
s_waitcnt lgkmcnt(1)
v_mfma_f32_16x16x32_bf16 v[138:141], a[12:15], v[186:189], v[138:141]
v_mfma_f32_16x16x32_bf16 v[142:145], a[36:39], v[186:189], v[142:145]
v_cvt_pk_bf16_f32 v8, v8, v9
v_cvt_pk_bf16_f32 v9, v10, v11
v_mfma_f32_16x16x32_bf16 v[146:149], a[60:63], v[186:189], v[146:149]
v_mfma_f32_16x16x32_bf16 v[150:153], a[228:231], v[186:189], v[150:153]
v_mfma_f32_16x16x32_bf16 v[154:157], a[252:255], v[186:189], v[154:157]
v_mfma_f32_16x16x32_bf16 v[158:161], v[244:247], v[186:189], v[158:161]
v_mfma_f32_16x16x32_bf16 v[162:165], v[186:189], a[84:87], v[162:165]
v_mfma_f32_16x16x32_bf16 v[166:169], v[186:189], a[108:111], v[166:169]
buffer_store_dwordx2 v[116:117], v205, s[8:11], s38 offen
v_mfma_f32_16x16x32_bf16 v[170:173], v[186:189], a[132:135], v[170:173]
ds_read_b128 v[186:189], v210 offset:25600
s_waitcnt lgkmcnt(1)
v_mfma_f32_16x16x32_bf16 v[138:141], a[16:19], v[182:185], v[138:141]
v_mfma_f32_16x16x32_bf16 v[142:145], a[40:43], v[182:185], v[142:145]
v_mfma_f32_16x16x32_bf16 v[146:149], a[64:67], v[182:185], v[146:149]
v_mfma_f32_16x16x32_bf16 v[150:153], a[232:235], v[182:185], v[150:153]
v_mfma_f32_16x16x32_bf16 v[154:157], v[224:227], v[182:185], v[154:157]
v_mfma_f32_16x16x32_bf16 v[158:161], v[248:251], v[182:185], v[158:161]
v_mfma_f32_16x16x32_bf16 v[162:165], v[182:185], a[88:91], v[162:165]
v_mfma_f32_16x16x32_bf16 v[166:169], v[182:185], a[112:115], v[166:169]
v_mfma_f32_16x16x32_bf16 v[170:173], v[182:185], a[136:139], v[170:173]
ds_read_b128 v[182:185], v210 offset:26624
s_waitcnt lgkmcnt(1)
v_mfma_f32_16x16x32_bf16 v[138:141], a[20:23], v[186:189], v[138:141]
v_mfma_f32_16x16x32_bf16 v[142:145], a[44:47], v[186:189], v[142:145]
v_mfma_f32_16x16x32_bf16 v[146:149], a[68:71], v[186:189], v[146:149]
v_cvt_pk_bf16_f32 v78, v138, v139
v_cvt_pk_bf16_f32 v79, v140, v141
v_mfma_f32_16x16x32_bf16 v[150:153], a[236:239], v[186:189], v[150:153]
v_cvt_pk_bf16_f32 v80, v142, v143
v_cvt_pk_bf16_f32 v81, v144, v145
v_mfma_f32_16x16x32_bf16 v[154:157], v[228:231], v[186:189], v[154:157]
v_cvt_pk_bf16_f32 v82, v146, v147
v_cvt_pk_bf16_f32 v83, v148, v149
v_mfma_f32_16x16x32_bf16 v[158:161], v[252:255], v[186:189], v[158:161]
v_cvt_pk_bf16_f32 v72, v150, v151
v_cvt_pk_bf16_f32 v73, v152, v153
v_mfma_f32_16x16x32_bf16 v[162:165], v[186:189], a[92:95], v[162:165]
v_cvt_pk_bf16_f32 v74, v154, v155
v_cvt_pk_bf16_f32 v75, v156, v157
v_mfma_f32_16x16x32_bf16 v[166:169], v[186:189], a[116:119], v[166:169]
s_nop 0
v_cvt_pk_bf16_f32 v76, v158, v159
v_cvt_pk_bf16_f32 v77, v160, v161
v_mfma_f32_16x16x32_bf16 v[170:173], v[186:189], a[140:143], v[170:173]
s_waitcnt lgkmcnt(0)
ds_read_b128 v[186:189], v210 offset:27648
v_cvt_pk_bf16_f32 v114, v162, v163
v_mfma_f32_16x16x32_bf16 v[138:141], a[0:3], v[182:185], 0
v_cvt_pk_bf16_f32 v115, v164, v165
v_cvt_pk_bf16_f32 v122, v166, v167
v_mfma_f32_16x16x32_bf16 v[142:145], a[24:27], v[182:185], 0
v_cvt_pk_bf16_f32 v123, v168, v169
v_cvt_pk_bf16_f32 v130, v170, v171
v_mfma_f32_16x16x32_bf16 v[146:149], a[48:51], v[182:185], 0
v_cvt_pk_bf16_f32 v131, v172, v173
v_mfma_f32_16x16x32_bf16 v[150:153], a[216:219], v[182:185], 0
buffer_store_dwordx2 v[124:125], v205, s[8:11], s38 offen offset:32
v_mfma_f32_16x16x32_bf16 v[154:157], a[240:243], v[182:185], 0
v_mfma_f32_16x16x32_bf16 v[158:161], v[232:235], v[182:185], 0
v_mfma_f32_16x16x32_bf16 v[162:165], v[182:185], a[72:75], 0
v_mfma_f32_16x16x32_bf16 v[166:169], v[182:185], a[96:99], 0
v_mfma_f32_16x16x32_bf16 v[170:173], v[182:185], a[120:123], 0
ds_read_b128 v[182:185], v210 offset:28672
s_waitcnt lgkmcnt(1)
v_mfma_f32_16x16x32_bf16 v[138:141], a[4:7], v[186:189], v[138:141]
v_mfma_f32_16x16x32_bf16 v[142:145], a[28:31], v[186:189], v[142:145]
v_mfma_f32_16x16x32_bf16 v[146:149], a[52:55], v[186:189], v[146:149]
v_mfma_f32_16x16x32_bf16 v[150:153], a[220:223], v[186:189], v[150:153]
v_mfma_f32_16x16x32_bf16 v[154:157], a[244:247], v[186:189], v[154:157]
v_mfma_f32_16x16x32_bf16 v[158:161], v[236:239], v[186:189], v[158:161]
v_mfma_f32_16x16x32_bf16 v[162:165], v[186:189], a[76:79], v[162:165]
buffer_store_dwordx2 v[132:133], v205, s[8:11], s38 offen offset:64
v_mfma_f32_16x16x32_bf16 v[166:169], v[186:189], a[100:103], v[166:169]
v_mfma_f32_16x16x32_bf16 v[170:173], v[186:189], a[124:127], v[170:173]
ds_read_b128 v[186:189], v210 offset:29696
s_waitcnt lgkmcnt(1)
v_mfma_f32_16x16x32_bf16 v[138:141], a[8:11], v[182:185], v[138:141]
v_mfma_f32_16x16x32_bf16 v[142:145], a[32:35], v[182:185], v[142:145]
v_mfma_f32_16x16x32_bf16 v[146:149], a[56:59], v[182:185], v[146:149]
v_mfma_f32_16x16x32_bf16 v[150:153], a[224:227], v[182:185], v[150:153]
v_mfma_f32_16x16x32_bf16 v[154:157], a[248:251], v[182:185], v[154:157]
v_mfma_f32_16x16x32_bf16 v[158:161], v[240:243], v[182:185], v[158:161]
v_mfma_f32_16x16x32_bf16 v[162:165], v[182:185], a[80:83], v[162:165]
v_mfma_f32_16x16x32_bf16 v[166:169], v[182:185], a[104:107], v[166:169]
v_mfma_f32_16x16x32_bf16 v[170:173], v[182:185], a[128:131], v[170:173]
ds_read_b128 v[182:185], v210 offset:30720
s_waitcnt lgkmcnt(1)
v_mfma_f32_16x16x32_bf16 v[138:141], a[12:15], v[186:189], v[138:141]
v_mfma_f32_16x16x32_bf16 v[142:145], a[36:39], v[186:189], v[142:145]
v_mfma_f32_16x16x32_bf16 v[146:149], a[60:63], v[186:189], v[146:149]
v_mfma_f32_16x16x32_bf16 v[150:153], a[228:231], v[186:189], v[150:153]
v_mfma_f32_16x16x32_bf16 v[154:157], a[252:255], v[186:189], v[154:157]
buffer_store_dwordx2 v[0:1], v29, s[8:11], 0 offen
v_mfma_f32_16x16x32_bf16 v[158:161], v[244:247], v[186:189], v[158:161]
v_mfma_f32_16x16x32_bf16 v[162:165], v[186:189], a[84:87], v[162:165]
v_mfma_f32_16x16x32_bf16 v[166:169], v[186:189], a[108:111], v[166:169]
v_mfma_f32_16x16x32_bf16 v[170:173], v[186:189], a[132:135], v[170:173]
ds_read_b128 v[186:189], v210 offset:31744
s_waitcnt lgkmcnt(1)
v_mfma_f32_16x16x32_bf16 v[138:141], a[16:19], v[182:185], v[138:141]
v_mfma_f32_16x16x32_bf16 v[142:145], a[40:43], v[182:185], v[142:145]
v_mfma_f32_16x16x32_bf16 v[146:149], a[64:67], v[182:185], v[146:149]
v_mfma_f32_16x16x32_bf16 v[150:153], a[232:235], v[182:185], v[150:153]
v_mfma_f32_16x16x32_bf16 v[154:157], v[224:227], v[182:185], v[154:157]
v_mfma_f32_16x16x32_bf16 v[158:161], v[248:251], v[182:185], v[158:161]
v_mfma_f32_16x16x32_bf16 v[162:165], v[182:185], a[88:91], v[162:165]
v_mfma_f32_16x16x32_bf16 v[166:169], v[182:185], a[112:115], v[166:169]
v_mfma_f32_16x16x32_bf16 v[170:173], v[182:185], a[136:139], v[170:173]
ds_read_b128 v[182:185], v210 offset:32768
s_waitcnt lgkmcnt(1)
v_mfma_f32_16x16x32_bf16 v[138:141], a[20:23], v[186:189], v[138:141]
v_mfma_f32_16x16x32_bf16 v[142:145], a[44:47], v[186:189], v[142:145]
buffer_store_dwordx2 v[4:5], v29, s[8:11], 0 offen offset:32
s_nop 1
v_cvt_pk_bf16_f32 v96, v138, v139
v_mfma_f32_16x16x32_bf16 v[146:149], a[68:71], v[186:189], v[146:149]
v_cvt_pk_bf16_f32 v97, v140, v141
v_cvt_pk_bf16_f32 v98, v142, v143
v_mfma_f32_16x16x32_bf16 v[150:153], a[236:239], v[186:189], v[150:153]
v_cvt_pk_bf16_f32 v99, v144, v145
v_mfma_f32_16x16x32_bf16 v[154:157], v[228:231], v[186:189], v[154:157]
v_cvt_pk_bf16_f32 v100, v146, v147
v_cvt_pk_bf16_f32 v101, v148, v149
v_mfma_f32_16x16x32_bf16 v[158:161], v[252:255], v[186:189], v[158:161]
v_cvt_pk_bf16_f32 v84, v150, v151
v_cvt_pk_bf16_f32 v85, v152, v153
v_mfma_f32_16x16x32_bf16 v[162:165], v[186:189], a[92:95], v[162:165]
v_cvt_pk_bf16_f32 v86, v154, v155
v_cvt_pk_bf16_f32 v87, v156, v157
v_mfma_f32_16x16x32_bf16 v[166:169], v[186:189], a[116:119], v[166:169]
s_nop 0
v_cvt_pk_bf16_f32 v88, v158, v159
v_cvt_pk_bf16_f32 v89, v160, v161
v_mfma_f32_16x16x32_bf16 v[170:173], v[186:189], a[140:143], v[170:173]
s_waitcnt lgkmcnt(0)
ds_read_b128 v[186:189], v210 offset:33792
v_cvt_pk_bf16_f32 v116, v162, v163
v_mfma_f32_16x16x32_bf16 v[138:141], a[0:3], v[182:185], 0
v_cvt_pk_bf16_f32 v124, v166, v167
v_cvt_pk_bf16_f32 v125, v168, v169
v_mfma_f32_16x16x32_bf16 v[142:145], a[24:27], v[182:185], 0
v_cvt_pk_bf16_f32 v117, v164, v165
v_cvt_pk_bf16_f32 v132, v170, v171
v_mfma_f32_16x16x32_bf16 v[146:149], a[48:51], v[182:185], 0
ds_read_b128 v[182:185], v210 offset:34816
v_cvt_pk_bf16_f32 v133, v172, v173
v_mfma_f32_16x16x16_bf16 v[154:157], v[82:83], v[88:89], 0
v_mfma_f32_16x16x16_bf16 v[158:161], v[100:101], v[88:89], 0
s_waitcnt lgkmcnt(1)
v_mfma_f32_16x16x32_bf16 v[138:141], a[4:7], v[186:189], v[138:141]
v_mfma_f32_16x16x32_bf16 v[142:145], a[28:31], v[186:189], v[142:145]
v_mfma_f32_16x16x32_bf16 v[146:149], a[52:55], v[186:189], v[146:149]
ds_read_b128 v[186:189], v210 offset:35840
buffer_store_dwordx2 v[8:9], v29, s[8:11], 0 offen offset:64
s_waitcnt lgkmcnt(1)
v_mfma_f32_16x16x32_bf16 v[138:141], a[8:11], v[182:185], v[138:141]
v_mfma_f32_16x16x32_bf16 v[142:145], a[32:35], v[182:185], v[142:145]
v_mfma_f32_16x16x32_bf16 v[146:149], a[56:59], v[182:185], v[146:149]
ds_read_b128 v[182:185], v210 offset:36864
v_mfma_f32_16x16x16_bf16 v[166:169], v[112:113], v[88:89], v[206:209]
v_mfma_f32_16x16x16_bf16 v[150:153], v[112:113], v[76:77], v[206:209]
s_waitcnt lgkmcnt(1)
v_mfma_f32_16x16x32_bf16 v[138:141], a[12:15], v[186:189], v[138:141]
v_mfma_f32_16x16x32_bf16 v[142:145], a[36:39], v[186:189], v[142:145]
v_mfma_f32_16x16x32_bf16 v[146:149], a[60:63], v[186:189], v[146:149]
ds_read_b128 v[186:189], v210 offset:37888
s_waitcnt lgkmcnt(1)
v_mfma_f32_16x16x32_bf16 v[138:141], a[16:19], v[182:185], v[138:141]
v_mfma_f32_16x16x32_bf16 v[142:145], a[40:43], v[182:185], v[142:145]
v_mfma_f32_16x16x32_bf16 v[154:157], v[78:81], v[84:87], v[154:157]
v_mfma_f32_16x16x32_bf16 v[150:153], v[108:111], v[72:75], v[150:153]
v_mfma_f32_16x16x32_bf16 v[146:149], a[64:67], v[182:185], v[146:149]
ds_read_b128 v[182:185], v210 offset:32768
v_exp_f32 v154, v154
v_mfma_f32_16x16x32_bf16 v[158:161], v[96:99], v[84:87], v[158:161]
s_waitcnt lgkmcnt(1)
v_exp_f32 v150, v150
v_mfma_f32_16x16x32_bf16 v[138:141], a[20:23], v[186:189], v[138:141]
v_cvt_pk_bf16_f32 v180, v150, 0
v_exp_f32 v155, v155
v_mfma_f32_16x16x32_bf16 v[142:145], a[44:47], v[186:189], v[142:145]
v_exp_f32_e64 v156, v156
v_mfma_f32_16x16x32_bf16 v[146:149], a[68:71], v[186:189], v[146:149]
ds_read_b128 v[186:189], v210 offset:33792
v_cvt_pk_bf16_f32 v102, v138, v139
v_mfma_f32_16x16x32_bf16 v[166:169], v[108:111], v[84:87], v[166:169]
v_cvt_pk_bf16_f32 v103, v140, v141
v_cvt_pk_bf16_f32 v104, v142, v143
v_cvt_pk_bf16_f32 v105, v144, v145
v_mfma_f32_16x16x16_bf16 v[138:141], v[82:83], v[76:77], 0
v_cvt_pk_bf16_f32 v106, v146, v147
v_cvt_pk_bf16_f32 v107, v148, v149
v_exp_f32 v157, v157
v_mfma_f32_16x16x16_bf16 v[142:145], v[100:101], v[76:77], 0
v_exp_f32 v158, v158
v_exp_f32 v159, v159
v_mfma_f32_16x16x16_bf16 v[162:165], v[106:107], v[88:89], 0
v_exp_f32 v160, v160
v_exp_f32 v161, v161
v_mfma_f32_16x16x16_bf16 v[146:149], v[106:107], v[76:77], 0
v_exp_f32 v166, v166
v_mfma_f32_16x16x32_bf16 v[138:141], v[78:81], v[72:75], v[138:141]
ds_read_b64 v[76:77], v215 offset:16
v_mfma_f32_16x16x32_bf16 v[142:145], v[96:99], v[72:75], v[142:145]
s_waitcnt lgkmcnt(2)
v_mfma_f32_16x16x32_bf16 v[118:121], v[182:185], a[72:75], 0
v_exp_f32 v138, v138
v_mfma_f32_16x16x32_bf16 v[126:129], v[182:185], a[96:99], 0
v_exp_f32 v139, v139
v_mfma_f32_16x16x32_bf16 v[134:137], v[182:185], a[120:123], 0
v_exp_f32 v140, v140
v_mfma_f32_16x16x32_bf16 v[146:149], v[102:105], v[72:75], v[146:149]
ds_read_b128 v[72:75], v215
v_cvt_pk_bf16_f32 v174, v138, v139
v_mfma_f32_16x16x32_bf16 v[90:93], a[216:219], v[182:185], 0
v_exp_f32_e64 v141, v141
v_mfma_f32_16x16x32_bf16 v[170:173], a[240:243], v[182:185], 0
v_exp_f32 v142, v142
v_mfma_f32_16x16x32_bf16 v[220:223], v[232:235], v[182:185], 0
s_waitcnt lgkmcnt(2)
ds_read_b128 v[182:185], v210 offset:34816
v_cvt_pk_bf16_f32 v175, v140, v141
v_mfma_f32_16x16x32_bf16 v[118:121], v[186:189], a[76:79], v[118:121]
v_exp_f32 v143, v143
v_mfma_f32_16x16x32_bf16 v[126:129], v[186:189], a[100:103], v[126:129]
v_exp_f32 v144, v144
v_mfma_f32_16x16x32_bf16 v[134:137], v[186:189], a[124:127], v[134:137]
v_exp_f32_e64 v145, v145
v_mfma_f32_16x16x32_bf16 v[90:93], a[220:223], v[186:189], v[90:93]
v_cvt_pk_bf16_f32 v176, v142, v143
v_cvt_pk_bf16_f32 v177, v144, v145
v_mfma_f32_16x16x32_bf16 v[170:173], a[244:247], v[186:189], v[170:173]
v_exp_f32 v146, v146
v_mfma_f32_16x16x32_bf16 v[220:223], v[236:239], v[186:189], v[220:223]
s_waitcnt lgkmcnt(0)
ds_read_b128 v[186:189], v210 offset:35840
v_exp_f32 v147, v147
v_mfma_f32_16x16x32_bf16 v[118:121], v[182:185], a[80:83], v[118:121]
v_exp_f32 v148, v148
v_mfma_f32_16x16x32_bf16 v[126:129], v[182:185], a[104:107], v[126:129]
v_exp_f32_e64 v149, v149
v_mfma_f32_16x16x32_bf16 v[134:137], v[182:185], a[128:131], v[134:137]
v_cvt_pk_bf16_f32 v178, v146, v147
v_cvt_pk_bf16_f32 v179, v148, v149
v_mfma_f32_16x16x32_bf16 v[90:93], a[224:227], v[182:185], v[90:93]
v_mfma_f32_16x16x32_bf16 v[162:165], v[102:105], v[84:87], v[162:165]
v_mfma_f32_16x16x32_bf16 v[170:173], a[248:251], v[182:185], v[170:173]
v_mfma_f32_16x16x32_bf16 v[220:223], v[240:243], v[182:185], v[220:223]
s_waitcnt lgkmcnt(0)
ds_read_b128 v[182:185], v210 offset:36864
v_exp_f32 v162, v162
v_mfma_f32_16x16x32_bf16 v[118:121], v[186:189], a[84:87], v[118:121]
v_exp_f32 v163, v163
v_mfma_f32_16x16x32_bf16 v[126:129], v[186:189], a[108:111], v[126:129]
v_exp_f32 v164, v164
v_mfma_f32_16x16x32_bf16 v[134:137], v[186:189], a[132:135], v[134:137]
v_exp_f32 v165, v165
v_mfma_f32_16x16x32_bf16 v[90:93], a[228:231], v[186:189], v[90:93]
v_mfma_f32_16x16x32_bf16 v[170:173], a[252:255], v[186:189], v[170:173]
v_mfma_f32_16x16x32_bf16 v[220:223], v[244:247], v[186:189], v[220:223]
ds_read_b128 v[186:189], v210 offset:37888
s_waitcnt lgkmcnt(1)
v_mfma_f32_16x16x32_bf16 v[118:121], v[182:185], a[88:91], v[118:121]
v_mfma_f32_16x16x32_bf16 v[126:129], v[182:185], a[112:115], v[126:129]
v_mfma_f32_16x16x32_bf16 v[134:137], v[182:185], a[136:139], v[134:137]
v_mfma_f32_16x16x32_bf16 v[90:93], a[232:235], v[182:185], v[90:93]
v_mfma_f32_16x16x32_bf16 v[170:173], v[224:227], v[182:185], v[170:173]
s_nop 0
v_mfma_f32_16x16x32_bf16 v[220:223], v[248:251], v[182:185], v[220:223]
s_waitcnt lgkmcnt(0)
v_mfma_f32_16x16x32_bf16 v[118:121], v[186:189], a[92:95], v[118:121]
v_mfma_f32_16x16x32_bf16 v[126:129], v[186:189], a[116:119], v[126:129]
v_mfma_f32_16x16x32_bf16 v[134:137], v[186:189], a[140:143], v[134:137]
v_cvt_pk_bf16_f32 v118, v118, v119
v_cvt_pk_bf16_f32 v119, v120, v121
v_mfma_f32_16x16x32_bf16 v[90:93], a[236:239], v[186:189], v[90:93]
ds_read_u16 v120, v214 offset:1024
v_cvt_pk_bf16_f32 v126, v126, v127
v_mfma_f32_16x16x32_bf16 v[170:173], v[228:231], v[186:189], v[170:173]
v_cvt_pk_bf16_f32 v127, v128, v129
v_cvt_pk_bf16_f32 v134, v134, v135
v_mfma_f32_16x16x32_bf16 v[220:223], v[252:255], v[186:189], v[220:223]
ds_read_u16 v128, v214 offset:1032
v_cvt_pk_bf16_f32 v90, v90, v91
v_mfma_f32_16x16x32_bf16 v[150:153], v[190:193], v[174:177], 0
v_cvt_pk_bf16_f32 v91, v92, v93
v_cvt_pk_bf16_f32 v92, v170, v171
v_mfma_f32_16x16x32_bf16 v[138:141], v[114:117], v[174:177], 0
v_cvt_pk_bf16_f32 v93, v172, v173
v_cvt_pk_bf16_f32 v135, v136, v137
v_mfma_f32_16x16x32_bf16 v[142:145], v[122:125], v[174:177], 0
ds_read_u16 v136, v214 offset:1040
v_mov_b32 v121, 0
v_mfma_f32_16x16x32_bf16 v[146:149], v[130:133], v[174:177], 0
v_cvt_pk_bf16_f32 v174, v154, v155
v_cvt_pk_bf16_f32 v175, v156, v157
v_mfma_f32_16x16x32_bf16 v[150:153], v[190:193], v[178:181], v[150:153]
s_waitcnt lgkmcnt(2)
v_cvt_pk_bf16_f32 v176, v158, v159
v_cvt_pk_bf16_f32 v177, v160, v161
v_mfma_f32_16x16x32_bf16 v[138:141], v[118:121], v[178:181], v[138:141]
v_mov_b32 v129, 0
v_mov_b32 v137, 0
v_mfma_f32_16x16x32_bf16 v[154:157], v[114:117], v[174:177], 0
v_rcp_f32 v151, v150
v_mfma_f32_16x16x32_bf16 v[158:161], v[122:125], v[174:177], 0
s_waitcnt lgkmcnt(1)
v_max3_u32 v218, v218, v150, v151
v_mul_f32_e64 v151, s3, v151
v_mfma_f32_16x16x32_bf16 v[142:145], v[126:129], v[178:181], v[142:145]
s_waitcnt lgkmcnt(0)
v_mul_f32 v138, v138, v151
v_mul_f32_e64 v139, v139, v151
v_mfma_f32_16x16x32_bf16 v[146:149], v[134:137], v[178:181], v[146:149]
v_cvt_pk_bf16_f32 v180, v166, 0
v_mul_f32_e64 v140, v140, v151
v_mfma_f32_16x16x32_bf16 v[166:169], v[190:193], v[174:177], 0
v_mul_f32_e64 v141, v141, v151
v_cvt_pk_bf16_f32 v138, v138, v139
v_mul_f32 v142, v142, v151
v_mul_f32 v143, v143, v151
v_mul_f32 v144, v144, v151
v_mul_f32 v145, v145, v151
v_cvt_pk_bf16_f32 v139, v140, v141
v_cvt_pk_bf16_f32 v140, v142, v143
v_cvt_pk_bf16_f32 v141, v144, v145
v_cvt_pk_bf16_f32 v178, v162, v163
v_cvt_pk_bf16_f32 v179, v164, v165
v_mfma_f32_16x16x32_bf16 v[162:165], v[130:133], v[174:177], 0
ds_write_b128 v211, v[138:141] offset:38912
v_mfma_f32_16x16x32_bf16 v[138:141], v[78:81], v[90:93], 0
v_mul_f32 v146, v146, v151
v_mul_f32 v147, v147, v151
v_mfma_f32_16x16x32_bf16 v[166:169], v[190:193], v[178:181], v[166:169]
v_mul_f32 v148, v148, v151
v_mul_f32 v149, v149, v151
v_mfma_f32_16x16x32_bf16 v[154:157], v[118:121], v[178:181], v[154:157]
v_cvt_pk_bf16_f32 v142, v146, v147
v_cvt_pk_bf16_f32 v143, v148, v149
v_mfma_f32_16x16x32_bf16 v[158:161], v[126:129], v[178:181], v[158:161]
ds_write_b64 v212, v[142:143] offset:38912
v_mfma_f32_16x16x32_bf16 v[142:145], v[96:99], v[90:93], 0
v_rcp_f32_e64 v167, v166
v_mfma_f32_16x16x32_bf16 v[162:165], v[134:137], v[178:181], v[162:165]
v_max3_u32 v218, v218, v166, v167
v_cvt_pk_bf16_f32 v94, v220, v221
v_mfma_f32_16x16x32_bf16 v[150:153], v[108:111], v[90:93], v[206:209]
v_cvt_pk_bf16_f32 v95, v222, v223
v_mul_f32_e64 v167, s3, v167
v_mfma_f32_16x16x32_bf16 v[146:149], v[102:105], v[90:93], 0
v_mul_f32 v154, v154, v167
v_mul_f32 v155, v155, v167
v_mul_f32_e64 v156, v156, v167
v_mfma_f32_16x16x16_bf16 v[138:141], v[82:83], v[94:95], v[138:141]
v_mul_f32_e64 v157, v157, v167
v_cvt_pk_bf16_f32 v154, v154, v155
v_mul_f32_e64 v158, v158, v167
v_mfma_f32_16x16x16_bf16 v[142:145], v[100:101], v[94:95], v[142:145]
v_mul_f32 v159, v159, v167
v_mul_f32 v160, v160, v167
v_mul_f32_e64 v161, v161, v167
v_mfma_f32_16x16x16_bf16 v[150:153], v[112:113], v[94:95], v[150:153]
v_cvt_pk_bf16_f32 v155, v156, v157
v_cvt_pk_bf16_f32 v156, v158, v159
v_cvt_pk_bf16_f32 v157, v160, v161
v_mfma_f32_16x16x16_bf16 v[146:149], v[106:107], v[94:95], v[146:149]
v_mul_f32 v162, v162, v167
v_mul_f32 v163, v163, v167
v_mul_f32 v164, v164, v167
v_mul_f32 v165, v165, v167
v_mfma_f32_16x16x16_bf16 v[166:169], v[76:77], v[112:113], v[206:209]
v_cvt_pk_bf16_f32 v158, v162, v163
v_cvt_pk_bf16_f32 v159, v164, v165
v_exp_f32 v138, v138
v_mfma_f32_16x16x16_bf16 v[162:165], v[76:77], v[106:107], 0
v_exp_f32 v139, v139
v_exp_f32 v140, v140
v_mfma_f32_16x16x32_bf16 v[166:169], v[72:75], v[108:111], v[166:169]
ds_write_b128 v211, v[154:157] offset:45056
v_mfma_f32_16x16x16_bf16 v[154:157], v[76:77], v[82:83], 0
v_exp_f32 v141, v141
v_exp_f32 v142, v142
v_mfma_f32_16x16x32_bf16 v[162:165], v[72:75], v[102:105], v[162:165]
v_exp_f32 v143, v143
v_mfma_f32_16x16x32_bf16 v[154:157], v[72:75], v[78:81], v[154:157]
ds_write_b64 v212, v[158:159] offset:45056
v_mfma_f32_16x16x16_bf16 v[158:161], v[76:77], v[100:101], 0
v_exp_f32 v144, v144
v_exp_f32 v145, v145
v_exp_f32_e64 v150, v150
v_mfma_f32_16x16x32_bf16 v[158:161], v[72:75], v[96:99], v[158:161]
v_cvt_pk_bf16_f32 v174, v138, v139
v_cvt_pk_bf16_f32 v175, v140, v141
v_cvt_pk_bf16_f32 v176, v142, v143
v_cvt_pk_bf16_f32 v177, v144, v145
v_cvt_pk_bf16_f32 v180, v150, 0
v_exp_f32_e64 v146, v146
v_mfma_f32_16x16x32_bf16 v[150:153], v[190:193], v[174:177], 0
v_exp_f32 v147, v147
v_mfma_f32_16x16x32_bf16 v[138:141], v[114:117], v[174:177], 0
s_waitcnt lgkmcnt(0)
v_exp_f32 v148, v148
v_mfma_f32_16x16x32_bf16 v[142:145], v[122:125], v[174:177], 0
s_barrier
ds_read_b128 v[170:173], v210 offset:38912
ds_read_b128 v[182:185], v210 offset:39936
ds_read_b128 v[186:189], v210 offset:40960
v_exp_f32_e64 v149, v149
v_cvt_pk_bf16_f32 v178, v146, v147
v_cvt_pk_bf16_f32 v179, v148, v149
v_mfma_f32_16x16x32_bf16 v[146:149], v[130:133], v[174:177], 0
v_mov_b32_dpp v154, v158 quad_perm:[0,1,2,3] row_mask:0x2 bank_mask:0xf
v_mfma_f32_16x16x32_bf16 v[150:153], v[190:193], v[178:181], v[150:153]
v_mov_b32_dpp v154, v162 quad_perm:[0,1,2,3] row_mask:0x4 bank_mask:0xf
v_mfma_f32_16x16x32_bf16 v[138:141], v[118:121], v[178:181], v[138:141]
v_mov_b32_dpp v154, v167 quad_perm:[0,1,2,3] row_mask:0x8 bank_mask:0xf
v_exp_f32_e64 v154, v154
v_mfma_f32_16x16x32_bf16 v[142:145], v[126:129], v[178:181], v[142:145]
v_cvt_pk_bf16_f32 v154, v154, 0
v_rcp_f32 v151, v150
v_mfma_f32_16x16x32_bf16 v[146:149], v[134:137], v[178:181], v[146:149]
s_waitcnt lgkmcnt(2)
ds_write_b16 v214, v154
v_mfma_f32_16x16x32_bf16 v[36:39], a[144:147], v[170:173], v[36:39]
ds_read_b128 v[84:87], v215
ds_read_b128 v[88:91], v215 offset:16
v_mfma_f32_16x16x32_bf16 v[40:43], a[168:171], v[170:173], v[40:43]
v_add_u32 v215, 1552, v215
v_mfma_f32_16x16x32_bf16 v[44:47], a[192:195], v[170:173], v[44:47]
ds_read_b128 v[170:173], v210 offset:41984
s_waitcnt lgkmcnt(5)
v_mfma_f32_16x16x32_bf16 v[36:39], a[148:151], v[182:185], v[36:39]
v_mfma_f32_16x16x32_bf16 v[40:43], a[172:175], v[182:185], v[40:43]
v_mfma_f32_16x16x32_bf16 v[44:47], a[196:199], v[182:185], v[44:47]
ds_read_b128 v[182:185], v210 offset:43008
s_waitcnt lgkmcnt(3)
v_mfma_f32_16x16x32_bf16 v[166:169], v[84:87], v[190:193], 0
v_mfma_f32_16x16x32_bf16 v[154:157], v[84:87], v[114:117], 0
v_mfma_f32_16x16x32_bf16 v[158:161], v[84:87], v[122:125], 0
v_mfma_f32_16x16x32_bf16 v[162:165], v[84:87], v[130:133], 0
s_waitcnt lgkmcnt(2)
v_mfma_f32_16x16x32_bf16 v[166:169], v[88:91], v[190:193], v[166:169]
v_mfma_f32_16x16x32_bf16 v[154:157], v[88:91], v[118:121], v[154:157]
v_mfma_f32_16x16x32_bf16 v[158:161], v[88:91], v[126:129], v[158:161]
v_rcp_f32 v167, v166
v_mfma_f32_16x16x32_bf16 v[162:165], v[88:91], v[134:137], v[162:165]
v_max3_u32 v218, v218, v166, v167
v_max3_u32 v218, v218, v150, v151
v_mfma_f32_16x16x32_bf16 v[36:39], a[152:155], v[186:189], v[36:39]
v_mul_f32 v151, s3, v151
v_mul_f32 v138, v138, v151
v_mfma_f32_16x16x32_bf16 v[40:43], a[176:179], v[186:189], v[40:43]
v_mul_f32_e64 v139, v139, v151
v_mul_f32 v140, v140, v151
v_mfma_f32_16x16x32_bf16 v[44:47], a[200:203], v[186:189], v[44:47]
s_waitcnt lgkmcnt(1)
ds_read_b128 v[186:189], v210 offset:44032
v_mul_f32_e64 v141, v141, v151
v_mfma_f32_16x16x32_bf16 v[36:39], a[156:159], v[170:173], v[36:39]
v_cvt_pk_bf16_f32 v138, v138, v139
v_mul_f32_e64 v142, v142, v151
v_mfma_f32_16x16x32_bf16 v[40:43], a[180:183], v[170:173], v[40:43]
v_mul_f32_e64 v143, v143, v151
v_mul_f32 v144, v144, v151
v_mfma_f32_16x16x32_bf16 v[44:47], a[204:207], v[170:173], v[44:47]
s_waitcnt lgkmcnt(1)
ds_read_b128 v[170:173], v210 offset:45056
v_mul_f32_e64 v145, v145, v151
v_mfma_f32_16x16x32_bf16 v[36:39], a[160:163], v[182:185], v[36:39]
v_cvt_pk_bf16_f32 v139, v140, v141
v_cvt_pk_bf16_f32 v140, v142, v143
v_mfma_f32_16x16x32_bf16 v[40:43], a[184:187], v[182:185], v[40:43]
s_nop 0
v_cvt_pk_bf16_f32 v141, v144, v145
v_cmp_lt_u32 vcc, 1602224128, v218
v_mfma_f32_16x16x32_bf16 v[44:47], a[208:211], v[182:185], v[44:47]
s_waitcnt lgkmcnt(1)
ds_read_b128 v[182:185], v210 offset:46080
ds_write_b128 v211, v[138:141] offset:51200
v_mfma_f32_16x16x32_bf16 v[36:39], a[164:167], v[186:189], v[36:39]
s_or_b32 s41, vcc_lo, vcc_hi
v_mov_b32_dpp v154, v158 quad_perm:[0,1,2,3] row_mask:0x2 bank_mask:0xf
v_mul_f32 v146, v146, v151
v_mfma_f32_16x16x32_bf16 v[40:43], a[188:191], v[186:189], v[40:43]
v_mul_f32_e64 v147, v147, v151
v_mul_f32 v148, v148, v151
v_mfma_f32_16x16x32_bf16 v[44:47], a[212:215], v[186:189], v[44:47]
s_waitcnt lgkmcnt(2)
v_cvt_pk_bf16_f32 v72, v36, v37
v_cvt_pk_bf16_f32 v73, v38, v39
v_mfma_f32_16x16x32_bf16 v[48:51], a[144:147], v[170:173], v[48:51]
buffer_store_dwordx2 v[72:73], v203, s[8:11], s39 offen
ds_read_b128 v[186:189], v210 offset:47104
v_mfma_f32_16x16x32_bf16 v[52:55], a[168:171], v[170:173], v[52:55]
s_nop 0
v_cvt_pk_bf16_f32 v74, v40, v41
v_cvt_pk_bf16_f32 v75, v42, v43
v_mfma_f32_16x16x32_bf16 v[56:59], a[192:195], v[170:173], v[56:59]
s_waitcnt lgkmcnt(2)
ds_read_b128 v[170:173], v210 offset:48128
v_cvt_pk_bf16_f32 v76, v44, v45
v_mfma_f32_16x16x32_bf16 v[48:51], a[148:151], v[182:185], v[48:51]
v_cvt_pk_bf16_f32 v77, v46, v47
v_mul_f32_e64 v149, v149, v151
v_mfma_f32_16x16x32_bf16 v[52:55], a[172:175], v[182:185], v[52:55]
v_cvt_pk_bf16_f32 v142, v146, v147
v_cvt_pk_bf16_f32 v143, v148, v149
v_mfma_f32_16x16x32_bf16 v[56:59], a[196:199], v[182:185], v[56:59]
ds_write_b64 v212, v[142:143] offset:51200
v_mul_f32 v167, s3, v167
v_mov_b32_dpp v154, v162 quad_perm:[0,1,2,3] row_mask:0x4 bank_mask:0xf
s_waitcnt lgkmcnt(2)
v_mfma_f32_16x16x32_bf16 v[48:51], a[152:155], v[186:189], v[48:51]
ds_read_b128 v[182:185], v210 offset:49152
v_mul_f32_e64 v154, v154, v167
v_mfma_f32_16x16x32_bf16 v[52:55], a[176:179], v[186:189], v[52:55]
v_mov_b32 v33, s41
v_cvt_pk_bf16_f32 v154, v154, 0
v_mfma_f32_16x16x32_bf16 v[56:59], a[200:203], v[186:189], v[56:59]
s_waitcnt lgkmcnt(2)
ds_write_b32 v209, v33
v_mfma_f32_16x16x32_bf16 v[48:51], a[156:159], v[170:173], v[48:51]
ds_write_b16 v214, v154
v_mfma_f32_16x16x32_bf16 v[52:55], a[180:183], v[170:173], v[52:55]
ds_read_b128 v[186:189], v210 offset:50176
v_add_u32 v214, 1552, v214
v_mfma_f32_16x16x32_bf16 v[56:59], a[204:207], v[170:173], v[56:59]
buffer_store_dwordx2 v[74:75], v203, s[8:11], s39 offen offset:32
s_waitcnt lgkmcnt(3)
v_mfma_f32_16x16x32_bf16 v[48:51], a[160:163], v[182:185], v[48:51]
v_mfma_f32_16x16x32_bf16 v[52:55], a[184:187], v[182:185], v[52:55]
v_mfma_f32_16x16x32_bf16 v[56:59], a[208:211], v[182:185], v[56:59]
s_waitcnt lgkmcnt(1)
s_barrier
ds_read_b128 v[170:173], v210 offset:51200
ds_read_b128 v[182:185], v210 offset:52224
ds_read_b128 v[84:87], v27 offset:24832
s_waitcnt lgkmcnt(3)
v_mfma_f32_16x16x32_bf16 v[48:51], a[164:167], v[186:189], v[48:51]
ds_read_b128 v[88:91], v27 offset:24960
ds_read_b128 v[92:95], v27 offset:25088
v_mfma_f32_16x16x32_bf16 v[52:55], a[188:191], v[186:189], v[52:55]
ds_read_b128 v[96:99], v27 offset:25216
v_mfma_f32_16x16x32_bf16 v[56:59], a[212:215], v[186:189], v[56:59]
ds_read_b64 v[100:101], v27 offset:24848
ds_read_b64 v[102:103], v27 offset:24976
ds_read_b64 v[104:105], v27 offset:25104
v_cvt_pk_bf16_f32 v78, v48, v49
v_cvt_pk_bf16_f32 v79, v50, v51
v_cvt_pk_bf16_f32 v80, v52, v53
v_cvt_pk_bf16_f32 v81, v54, v55
v_cvt_pk_bf16_f32 v82, v56, v57
v_cvt_pk_bf16_f32 v83, v58, v59
s_waitcnt lgkmcnt(8)
v_mfma_f32_16x16x32_bf16 v[60:63], a[144:147], v[170:173], v[60:63]
s_nop 0
ds_read_b64 v[106:107], v27 offset:25232
ds_read_b128 v[186:189], v210 offset:53248
v_mfma_f32_16x16x32_bf16 v[64:67], a[168:171], v[170:173], v[64:67]
ds_read_b128 v[174:177], v210 offset:18432
v_mfma_f32_16x16x32_bf16 v[68:71], a[192:195], v[170:173], v[68:71]
s_nop 0
ds_read_b128 v[170:173], v210 offset:54272
s_waitcnt lgkmcnt(11)
v_mfma_f32_16x16x32_bf16 v[60:63], a[148:151], v[182:185], v[60:63]
s_waitcnt lgkmcnt(10)
v_mfma_f32_16x16x32_bf16 v[12:15], a[144:147], v[84:87], v[12:15]
v_mfma_f32_16x16x32_bf16 v[64:67], a[172:175], v[182:185], v[64:67]
buffer_store_dwordx2 v[76:77], v203, s[8:11], s39 offen offset:64
s_waitcnt lgkmcnt(9)
v_mfma_f32_16x16x32_bf16 v[12:15], a[148:151], v[88:91], v[12:15]
s_waitcnt lgkmcnt(8)
v_mfma_f32_16x16x32_bf16 v[12:15], a[152:155], v[92:95], v[12:15]
v_mfma_f32_16x16x32_bf16 v[68:71], a[196:199], v[182:185], v[68:71]
s_waitcnt lgkmcnt(1)
ds_read_b128 v[182:185], v210 offset:55296
v_or3_b32 v174, v174, v175, v176
v_mfma_f32_16x16x32_bf16 v[12:15], a[156:159], v[96:99], v[12:15]
v_or_b32 v174, v174, v177
v_mfma_f32_16x16x32_bf16 v[12:15], a[160:163], v[100:103], v[12:15]
v_readfirstlane_b32 s43, v174
v_mfma_f32_16x16x32_bf16 v[12:15], a[164:167], v[104:107], v[12:15]
v_mfma_f32_16x16x32_bf16 v[60:63], a[152:155], v[186:189], v[60:63]
v_mfma_f32_16x16x32_bf16 v[64:67], a[176:179], v[186:189], v[64:67]
v_cvt_pk_bf16_f32 v12, v12, v13
v_cvt_pk_bf16_f32 v13, v14, v15
v_mfma_f32_16x16x32_bf16 v[68:71], a[200:203], v[186:189], v[68:71]
ds_read_b128 v[186:189], v210 offset:56320
v_mfma_f32_16x16x32_bf16 v[16:19], a[168:171], v[84:87], v[16:19]
v_mfma_f32_16x16x32_bf16 v[16:19], a[172:175], v[88:91], v[16:19]
v_mfma_f32_16x16x32_bf16 v[16:19], a[176:179], v[92:95], v[16:19]
s_waitcnt lgkmcnt(2)
v_mfma_f32_16x16x32_bf16 v[60:63], a[156:159], v[170:173], v[60:63]
v_mfma_f32_16x16x32_bf16 v[16:19], a[180:183], v[96:99], v[16:19]
v_mfma_f32_16x16x32_bf16 v[64:67], a[180:183], v[170:173], v[64:67]
v_mfma_f32_16x16x32_bf16 v[16:19], a[184:187], v[100:103], v[16:19]
buffer_store_dwordx2 v[78:79], v204, s[8:11], s39 offen
v_mfma_f32_16x16x32_bf16 v[16:19], a[188:191], v[104:107], v[16:19]
v_mfma_f32_16x16x32_bf16 v[68:71], a[204:207], v[170:173], v[68:71]
s_waitcnt lgkmcnt(1)
v_mfma_f32_16x16x32_bf16 v[60:63], a[160:163], v[182:185], v[60:63]
v_cvt_pk_bf16_f32 v16, v16, v17
v_cvt_pk_bf16_f32 v17, v18, v19
v_mfma_f32_16x16x32_bf16 v[20:23], a[192:195], v[84:87], v[20:23]
v_mfma_f32_16x16x32_bf16 v[64:67], a[184:187], v[182:185], v[64:67]
v_mfma_f32_16x16x32_bf16 v[20:23], a[196:199], v[88:91], v[20:23]
v_mfma_f32_16x16x32_bf16 v[20:23], a[200:203], v[92:95], v[20:23]
v_mfma_f32_16x16x32_bf16 v[68:71], a[208:211], v[182:185], v[68:71]
v_mfma_f32_16x16x32_bf16 v[20:23], a[204:207], v[96:99], v[20:23]
v_mfma_f32_16x16x32_bf16 v[20:23], a[208:211], v[100:103], v[20:23]
s_nop 0
v_mfma_f32_16x16x32_bf16 v[20:23], a[212:215], v[104:107], v[20:23]
s_waitcnt lgkmcnt(0)
v_mfma_f32_16x16x32_bf16 v[60:63], a[164:167], v[186:189], v[60:63]
v_mfma_f32_16x16x32_bf16 v[64:67], a[188:191], v[186:189], v[64:67]
v_cvt_pk_bf16_f32 v20, v20, v21
v_cvt_pk_bf16_f32 v21, v22, v23
v_mfma_f32_16x16x32_bf16 v[68:71], a[212:215], v[186:189], v[68:71]
v_cvt_pk_bf16_f32 v116, v60, v61
v_cvt_pk_bf16_f32 v117, v62, v63
s_nop 0
v_cvt_pk_bf16_f32 v124, v64, v65
buffer_store_dwordx2 v[80:81], v204, s[8:11], s39 offen offset:32
v_cvt_pk_bf16_f32 v125, v66, v67
s_nop 0
v_cvt_pk_bf16_f32 v132, v68, v69
v_cvt_pk_bf16_f32 v133, v70, v71
buffer_store_dwordx2 v[82:83], v204, s[8:11], s39 offen offset:64
buffer_store_dwordx2 v[116:117], v205, s[8:11], s39 offen
buffer_store_dwordx2 v[124:125], v205, s[8:11], s39 offen offset:32
buffer_store_dwordx2 v[12:13], v30, s[8:11], 0 offen
buffer_store_dwordx2 v[16:17], v30, s[8:11], 0 offen offset:32
buffer_store_dwordx2 v[20:21], v30, s[8:11], 0 offen offset:64
buffer_store_dwordx2 v[132:133], v205, s[8:11], s39 offen offset:64
s_branch L_fin
F_pf:
global_load_dword v216, v216, s[98:99]
s_branch F_nopf
L_redo:
s_mov_b32 s47, 1
s_waitcnt vmcnt(0) lgkmcnt(0)
s_barrier
s_branch L_start
L_safe:
.p2align 3
s_add_u32 s28, s28, 32
s_cmp_ge_u32 s28, 73
s_cselect_b32 s21, 73, 0
s_cselect_b32 s22, 1177344, 0
s_sub_u32 s28, s28, s21
s_add_u32 s20, s20, s22
s_add_u32 s20, s20, 86016
s_add_u32 m0, s96, 71488
s_mov_b32 exec_hi, 4194303
buffer_load_dwordx4 v82, s[4:7], s20 offen nt lds
s_mov_b32 exec_hi, -1
s_add_u32 s28, s28, 32
s_cmp_ge_u32 s28, 73
s_cselect_b32 s21, 73, 0
s_cselect_b32 s22, 1177344, 0
s_sub_u32 s28, s28, s21
s_add_u32 s20, s20, s22
s_add_u32 s20, s20, 86016
s_add_u32 m0, s96, 74960
s_mov_b32 exec_hi, 4194303
buffer_load_dwordx4 v82, s[4:7], s20 offen nt lds
s_mov_b32 exec_hi, -1
s_add_u32 s28, s28, 32
s_cmp_ge_u32 s28, 73
s_cselect_b32 s21, 73, 0
s_cselect_b32 s22, 1177344, 0
s_sub_u32 s28, s28, s21
s_add_u32 s20, s20, s22
s_add_u32 s20, s20, 86016
s_add_u32 m0, s96, 78432
s_mov_b32 exec_hi, 4194303
buffer_load_dwordx4 v82, s[4:7], s20 offen nt lds
s_mov_b32 exec_hi, -1
s_add_u32 s28, s28, 32
s_cmp_ge_u32 s28, 73
s_cselect_b32 s21, 73, 0
s_cselect_b32 s22, 1177344, 0
s_sub_u32 s28, s28, s21
s_add_u32 s20, s20, s22
s_add_u32 s20, s20, 86016
s_add_u32 m0, s96, 81904
s_mov_b32 exec_hi, 4194303
buffer_load_dwordx4 v82, s[4:7], s20 offen nt lds
s_mov_b32 exec_hi, -1
s_add_u32 s28, s28, 32
s_cmp_ge_u32 s28, 73
s_cselect_b32 s21, 73, 0
s_cselect_b32 s22, 1177344, 0
s_sub_u32 s28, s28, s21
s_add_u32 s20, s20, s22
s_add_u32 s20, s20, 86016
s_add_u32 m0, s96, 85376
s_mov_b32 exec_hi, 4194303
buffer_load_dwordx4 v82, s[4:7], s20 offen nt lds
s_mov_b32 exec_hi, -1
s_add_u32 s28, s28, 32
s_cmp_ge_u32 s28, 73
s_cselect_b32 s21, 73, 0
s_cselect_b32 s22, 1177344, 0
s_sub_u32 s28, s28, s21
s_add_u32 s20, s20, s22
s_add_u32 s20, s20, 86016
s_add_u32 m0, s96, 88848
s_mov_b32 exec_hi, 4194303
buffer_load_dwordx4 v82, s[4:7], s20 offen nt lds
s_mov_b32 exec_hi, -1
s_add_u32 s28, s28, 32
s_cmp_ge_u32 s28, 73
s_cselect_b32 s21, 73, 0
s_cselect_b32 s22, 1177344, 0
s_sub_u32 s28, s28, s21
s_add_u32 s20, s20, s22
s_add_u32 s20, s20, 86016
s_add_u32 m0, s96, 92320
s_mov_b32 exec_hi, 4194303
buffer_load_dwordx4 v82, s[4:7], s20 offen nt lds
s_mov_b32 exec_hi, -1
s_add_u32 s28, s28, 32
s_cmp_ge_u32 s28, 73
s_cselect_b32 s21, 73, 0
s_cselect_b32 s22, 1177344, 0
s_sub_u32 s28, s28, s21
s_add_u32 s20, s20, s22
s_add_u32 s20, s20, 86016
s_add_u32 m0, s96, 95792
s_mov_b32 exec_hi, 4194303
buffer_load_dwordx4 v82, s[4:7], s20 offen nt lds
s_mov_b32 exec_hi, -1
s_add_u32 s28, s28, 32
s_cmp_ge_u32 s28, 73
s_cselect_b32 s21, 73, 0
s_cselect_b32 s22, 1177344, 0
s_sub_u32 s28, s28, s21
s_add_u32 s20, s20, s22
s_add_u32 s20, s20, 86016
s_add_u32 m0, s96, 99264
s_mov_b32 exec_hi, 4194303
buffer_load_dwordx4 v82, s[4:7], s20 offen nt lds
s_mov_b32 exec_hi, -1
s_add_u32 s28, s28, 32
s_cmp_ge_u32 s28, 73
s_cselect_b32 s21, 73, 0
s_cselect_b32 s22, 1177344, 0
s_sub_u32 s28, s28, s21
s_add_u32 s20, s20, s22
s_add_u32 s20, s20, 86016
s_add_u32 m0, s96, 102736
s_mov_b32 exec_hi, 4194303
buffer_load_dwordx4 v82, s[4:7], s20 offen nt lds
s_mov_b32 exec_hi, -1
s_add_u32 s28, s28, 32
s_cmp_ge_u32 s28, 73
s_cselect_b32 s21, 73, 0
s_cselect_b32 s22, 1177344, 0
s_sub_u32 s28, s28, s21
s_add_u32 s20, s20, s22
s_add_u32 s20, s20, 86016
s_add_u32 m0, s96, 106208
s_mov_b32 exec_hi, 4194303
buffer_load_dwordx4 v82, s[4:7], s20 offen nt lds
s_mov_b32 exec_hi, -1
s_add_u32 s28, s28, 32
s_cmp_ge_u32 s28, 73
s_cselect_b32 s21, 73, 0
s_cselect_b32 s22, 1177344, 0
s_sub_u32 s28, s28, s21
s_add_u32 s20, s20, s22
s_add_u32 s20, s20, 86016
s_add_u32 m0, s96, 109680
s_mov_b32 exec_hi, 4194303
buffer_load_dwordx4 v82, s[4:7], s20 offen nt lds
s_mov_b32 exec_hi, -1
s_add_u32 s28, s28, 32
s_cmp_ge_u32 s28, 73
s_cselect_b32 s21, 73, 0
s_cselect_b32 s22, 1177344, 0
s_sub_u32 s28, s28, s21
s_add_u32 s20, s20, s22
s_add_u32 s20, s20, 86016
s_add_u32 m0, s96, 113152
s_mov_b32 exec_hi, 4194303
buffer_load_dwordx4 v82, s[4:7], s20 offen nt lds
s_mov_b32 exec_hi, -1
s_add_u32 s28, s28, 32
s_cmp_ge_u32 s28, 73
s_cselect_b32 s21, 73, 0
s_cselect_b32 s22, 1177344, 0
s_sub_u32 s28, s28, s21
s_add_u32 s20, s20, s22
s_add_u32 s20, s20, 86016
s_add_u32 m0, s96, 116624
s_mov_b32 exec_hi, 4194303
buffer_load_dwordx4 v82, s[4:7], s20 offen nt lds
s_mov_b32 exec_hi, -1
s_add_u32 s28, s28, 32
s_cmp_ge_u32 s28, 73
s_cselect_b32 s21, 73, 0
s_cselect_b32 s22, 1177344, 0
s_sub_u32 s28, s28, s21
s_add_u32 s20, s20, s22
s_add_u32 s20, s20, 86016
s_add_u32 m0, s96, 120096
s_mov_b32 exec_hi, 4194303
buffer_load_dwordx4 v82, s[4:7], s20 offen nt lds
s_mov_b32 exec_hi, -1
s_add_u32 s28, s28, 32
s_cmp_ge_u32 s28, 73
s_cselect_b32 s21, 73, 0
s_cselect_b32 s22, 1177344, 0
s_sub_u32 s28, s28, s21
s_add_u32 s20, s20, s22
s_add_u32 s20, s20, 86016
s_add_u32 m0, s96, 123568
s_mov_b32 exec_hi, 4194303
buffer_load_dwordx4 v82, s[4:7], s20 offen nt lds
s_mov_b32 exec_hi, -1
s_add_u32 m0, s55, 131328
s_add_u32 s29, s54, 384
buffer_load_dwordx4 v72, s[12:15], s29 offen lds
s_add_u32 m0, s55, 132352
s_add_u32 s29, s54, 384
buffer_load_dwordx4 v73, s[12:15], s29 offen lds
s_add_u32 m0, s55, 133376
s_add_u32 s29, s54, 384
buffer_load_dwordx4 v74, s[12:15], s29 offen lds
ds_read_b128 v[84:87], v200
s_waitcnt lgkmcnt(0)
v_mfma_f32_16x16x32_bf16 v[0:3], v[138:141], v[84:87], 0
ds_read_b128 v[92:95], v201
s_waitcnt lgkmcnt(0)
v_mfma_f32_16x16x32_bf16 v[12:15], v[138:141], v[92:95], 0
ds_read_b128 v[100:103], v202
s_waitcnt lgkmcnt(0)
v_mfma_f32_16x16x32_bf16 v[24:27], v[138:141], v[100:103], 0
ds_read_b128 v[84:87], v194
ds_read_b128 v[88:91], v194 offset:16
s_waitcnt lgkmcnt(0)
v_smfmac_f32_16x16x64_bf16 v[0:3], v[142:145], v[84:91], v213
ds_read_b128 v[92:95], v195
ds_read_b128 v[96:99], v195 offset:16
s_waitcnt lgkmcnt(0)
v_smfmac_f32_16x16x64_bf16 v[12:15], v[142:145], v[92:99], v213
ds_read_b128 v[100:103], v196
ds_read_b128 v[104:107], v196 offset:16
s_waitcnt lgkmcnt(0)
v_smfmac_f32_16x16x64_bf16 v[24:27], v[142:145], v[100:107], v213
ds_read_b128 v[84:87], v197
ds_read_b128 v[88:91], v197 offset:16
s_waitcnt lgkmcnt(0)
v_smfmac_f32_16x16x64_bf16 v[0:3], v[146:149], v[84:91], v213
ds_read_b128 v[92:95], v198
ds_read_b128 v[96:99], v198 offset:16
s_waitcnt lgkmcnt(0)
v_smfmac_f32_16x16x64_bf16 v[12:15], v[146:149], v[92:99], v213
ds_read_b128 v[100:103], v199
ds_read_b128 v[104:107], v199 offset:16
s_waitcnt lgkmcnt(0)
v_smfmac_f32_16x16x64_bf16 v[24:27], v[146:149], v[100:107], v213
ds_read_b128 v[84:87], v200 offset:32
s_waitcnt lgkmcnt(0)
v_mfma_f32_16x16x32_bf16 v[4:7], v[150:153], v[84:87], 0
ds_read_b128 v[92:95], v201 offset:32
s_waitcnt lgkmcnt(0)
v_mfma_f32_16x16x32_bf16 v[16:19], v[150:153], v[92:95], 0
ds_read_b128 v[100:103], v202 offset:32
s_waitcnt lgkmcnt(0)
v_mfma_f32_16x16x32_bf16 v[28:31], v[150:153], v[100:103], 0
ds_read_b128 v[84:87], v194 offset:32
ds_read_b128 v[88:91], v194 offset:48
s_waitcnt lgkmcnt(0)
v_smfmac_f32_16x16x64_bf16 v[4:7], v[154:157], v[84:91], v213
ds_read_b128 v[92:95], v195 offset:32
ds_read_b128 v[96:99], v195 offset:48
s_waitcnt lgkmcnt(0)
v_smfmac_f32_16x16x64_bf16 v[16:19], v[154:157], v[92:99], v213
ds_read_b128 v[100:103], v196 offset:32
ds_read_b128 v[104:107], v196 offset:48
s_waitcnt lgkmcnt(0)
v_smfmac_f32_16x16x64_bf16 v[28:31], v[154:157], v[100:107], v213
ds_read_b128 v[84:87], v197 offset:32
ds_read_b128 v[88:91], v197 offset:48
s_waitcnt lgkmcnt(0)
v_smfmac_f32_16x16x64_bf16 v[4:7], v[158:161], v[84:91], v213
ds_read_b128 v[92:95], v198 offset:32
ds_read_b128 v[96:99], v198 offset:48
s_waitcnt lgkmcnt(0)
v_smfmac_f32_16x16x64_bf16 v[16:19], v[158:161], v[92:99], v213
ds_read_b128 v[100:103], v199 offset:32
ds_read_b128 v[104:107], v199 offset:48
s_waitcnt lgkmcnt(0)
v_smfmac_f32_16x16x64_bf16 v[28:31], v[158:161], v[100:107], v213
ds_read_b128 v[84:87], v200 offset:64
s_waitcnt lgkmcnt(0)
v_mfma_f32_16x16x32_bf16 v[8:11], v[162:165], v[84:87], 0
ds_read_b128 v[92:95], v201 offset:64
s_waitcnt lgkmcnt(0)
v_mfma_f32_16x16x32_bf16 v[20:23], v[162:165], v[92:95], 0
ds_read_b128 v[100:103], v202 offset:64
s_waitcnt lgkmcnt(0)
v_mfma_f32_16x16x32_bf16 v[32:35], v[162:165], v[100:103], 0
ds_read_b128 v[84:87], v194 offset:64
ds_read_b128 v[88:91], v194 offset:80
s_waitcnt lgkmcnt(0)
v_smfmac_f32_16x16x64_bf16 v[8:11], v[166:169], v[84:91], v213
ds_read_b128 v[92:95], v195 offset:64
ds_read_b128 v[96:99], v195 offset:80
s_waitcnt lgkmcnt(0)
v_smfmac_f32_16x16x64_bf16 v[20:23], v[166:169], v[92:99], v213
ds_read_b128 v[100:103], v196 offset:64
ds_read_b128 v[104:107], v196 offset:80
s_waitcnt lgkmcnt(0)
v_smfmac_f32_16x16x64_bf16 v[32:35], v[166:169], v[100:107], v213
ds_read_b128 v[84:87], v197 offset:64
ds_read_b128 v[88:91], v197 offset:80
s_waitcnt lgkmcnt(0)
v_smfmac_f32_16x16x64_bf16 v[8:11], v[170:173], v[84:91], v213
ds_read_b128 v[92:95], v198 offset:64
ds_read_b128 v[96:99], v198 offset:80
s_waitcnt lgkmcnt(0)
v_smfmac_f32_16x16x64_bf16 v[20:23], v[170:173], v[92:99], v213
ds_read_b128 v[100:103], v199 offset:64
ds_read_b128 v[104:107], v199 offset:80
s_waitcnt lgkmcnt(0)
v_smfmac_f32_16x16x64_bf16 v[32:35], v[170:173], v[100:107], v213
v_add_f32 v118, v0, v1
v_mul_f32 v119, v0, v0
v_add_f32 v118, v118, v2
v_fmac_f32 v119, v1, v1
v_add_f32 v118, v118, v3
v_fmac_f32 v119, v2, v2
v_fmac_f32 v119, v3, v3
v_add_f32 v126, v12, v13
v_mul_f32 v127, v12, v12
v_add_f32 v126, v126, v14
v_fmac_f32 v127, v13, v13
v_add_f32 v126, v126, v15
v_fmac_f32 v127, v14, v14
v_fmac_f32 v127, v15, v15
v_add_f32 v134, v24, v25
v_mul_f32 v135, v24, v24
v_add_f32 v134, v134, v26
v_fmac_f32 v135, v25, v25
v_add_f32 v134, v134, v27
v_fmac_f32 v135, v26, v26
v_fmac_f32 v135, v27, v27
v_add_f32 v118, v118, v4
v_fmac_f32 v119, v4, v4
v_add_f32 v118, v118, v5
v_fmac_f32 v119, v5, v5
v_add_f32 v118, v118, v6
v_fmac_f32 v119, v6, v6
v_add_f32 v118, v118, v7
v_fmac_f32 v119, v7, v7
v_add_f32 v126, v126, v16
v_fmac_f32 v127, v16, v16
v_add_f32 v126, v126, v17
v_fmac_f32 v127, v17, v17
v_add_f32 v126, v126, v18
v_fmac_f32 v127, v18, v18
v_add_f32 v126, v126, v19
v_fmac_f32 v127, v19, v19
v_add_f32 v134, v134, v28
v_fmac_f32 v135, v28, v28
v_add_f32 v134, v134, v29
v_fmac_f32 v135, v29, v29
v_add_f32 v134, v134, v30
v_fmac_f32 v135, v30, v30
v_add_f32 v134, v134, v31
v_fmac_f32 v135, v31, v31
v_add_f32 v118, v118, v8
v_fmac_f32 v119, v8, v8
v_add_f32 v118, v118, v9
v_fmac_f32 v119, v9, v9
v_add_f32 v118, v118, v10
v_fmac_f32 v119, v10, v10
v_add_f32 v118, v118, v11
v_fmac_f32 v119, v11, v11
v_add_f32 v126, v126, v20
v_fmac_f32 v127, v20, v20
v_add_f32 v126, v126, v21
v_fmac_f32 v127, v21, v21
v_add_f32 v126, v126, v22
v_fmac_f32 v127, v22, v22
v_add_f32 v126, v126, v23
v_fmac_f32 v127, v23, v23
v_add_f32 v134, v134, v32
v_fmac_f32 v135, v32, v32
v_add_f32 v134, v134, v33
v_fmac_f32 v135, v33, v33
v_add_f32 v134, v134, v34
v_fmac_f32 v135, v34, v34
v_add_f32 v134, v134, v35
v_fmac_f32 v135, v35, v35
v_permlane16_swap_b32 v118, v119
v_add_f32 v118, v118, v119
v_permlane16_swap_b32 v126, v127
v_add_f32 v126, v126, v127
v_permlane16_swap_b32 v134, v135
v_add_f32 v134, v134, v135
v_permlane32_swap_b32 v118, v126
v_add_f32 v118, v118, v126
ds_write_b32 v209, v118
v_mov_b32 v135, v134
s_nop 1
v_permlane32_swap_b32 v134, v135
v_add_f32 v134, v134, v135
ds_write_b32 v209, v134 offset:512
s_waitcnt lgkmcnt(0)
s_barrier
ds_read_b128 v[102:105], v210 offset:18432
ds_read_b128 v[106:109], v210 offset:19456
s_waitcnt lgkmcnt(1)
v_add_f32 v102, v102, v103
s_waitcnt lgkmcnt(0)
v_add_f32 v106, v106, v107
v_add_f32 v104, v104, v105
v_add_f32 v108, v108, v109
v_add_f32 v102, v102, v104
v_add_f32 v106, v106, v108
v_mul_f32 v103, s48, v102
v_mul_f32 v104, s73, v102
v_mul_f32 v106, s73, v106
v_fma_f32 v106, -v103, v104, v106
v_max_f32 v106, 0, v106
v_add_f32 v106, s49, v106
v_rsq_f32 v102, v106
s_nop 0
v_mul_f32_e64 v103, -v103, v102
ds_write_b64 v211, v[102:103]
ds_read_b64 v[118:119], v219
ds_read_b64 v[126:127], v219 offset:256
ds_read_b64 v[134:135], v219 offset:512
s_waitcnt lgkmcnt(2)
v_fma_f32 v220, v0, v118, v119
v_fma_f32 v221, v1, v118, v119
v_cvt_pk_bf16_f32 v90, v220, v221
v_fma_f32 v222, v2, v118, v119
v_fma_f32 v223, v3, v118, v119
v_cvt_pk_bf16_f32 v91, v222, v223
v_fma_f32 v220, v4, v118, v119
v_fma_f32 v221, v5, v118, v119
v_cvt_pk_bf16_f32 v92, v220, v221
v_fma_f32 v222, v6, v118, v119
v_fma_f32 v223, v7, v118, v119
v_cvt_pk_bf16_f32 v93, v222, v223
ds_write_b128 v211, v[90:93]
v_fma_f32 v220, v8, v118, v119
v_fma_f32 v221, v9, v118, v119
v_cvt_pk_bf16_f32 v94, v220, v221
v_fma_f32 v222, v10, v118, v119
v_fma_f32 v223, v11, v118, v119
v_cvt_pk_bf16_f32 v95, v222, v223
s_waitcnt lgkmcnt(2)
ds_write_b64 v212, v[94:95]
v_fma_f32 v220, v12, v126, v127
v_fma_f32 v221, v13, v126, v127
v_cvt_pk_bf16_f32 v174, v220, v221
v_fma_f32 v222, v14, v126, v127
v_fma_f32 v223, v15, v126, v127
v_cvt_pk_bf16_f32 v175, v222, v223
v_fma_f32 v220, v16, v126, v127
v_fma_f32 v221, v17, v126, v127
v_cvt_pk_bf16_f32 v176, v220, v221
v_fma_f32 v222, v18, v126, v127
v_fma_f32 v223, v19, v126, v127
v_cvt_pk_bf16_f32 v177, v222, v223
ds_write_b128 v211, v[174:177] offset:6144
v_fma_f32 v220, v20, v126, v127
v_fma_f32 v221, v21, v126, v127
v_cvt_pk_bf16_f32 v178, v220, v221
v_fma_f32 v222, v22, v126, v127
v_fma_f32 v223, v23, v126, v127
v_cvt_pk_bf16_f32 v179, v222, v223
s_waitcnt lgkmcnt(3)
ds_write_b64 v212, v[178:179] offset:6144
v_fma_f32 v220, v24, v134, v135
v_fma_f32 v221, v25, v134, v135
v_cvt_pk_bf16_f32 v90, v220, v221
v_fma_f32 v222, v26, v134, v135
v_fma_f32 v223, v27, v134, v135
v_cvt_pk_bf16_f32 v91, v222, v223
v_fma_f32 v220, v28, v134, v135
v_fma_f32 v221, v29, v134, v135
v_cvt_pk_bf16_f32 v92, v220, v221
v_fma_f32 v222, v30, v134, v135
v_fma_f32 v223, v31, v134, v135
v_cvt_pk_bf16_f32 v93, v222, v223
ds_write_b128 v211, v[90:93] offset:12288
v_fma_f32 v220, v32, v134, v135
v_fma_f32 v221, v33, v134, v135
v_cvt_pk_bf16_f32 v94, v220, v221
v_fma_f32 v222, v34, v134, v135
v_fma_f32 v223, v35, v134, v135
v_cvt_pk_bf16_f32 v95, v222, v223
ds_write_b64 v212, v[94:95] offset:12288
s_mov_b64 exec, s[30:31]
ds_write_b128 v217, v[138:141]
s_mov_b64 exec, -1
s_mov_b64 exec, s[30:31]
ds_write_b128 v217, v[142:145] offset:528
s_mov_b64 exec, -1
s_mov_b64 exec, s[30:31]
ds_write_b128 v217, v[146:149] offset:1056
s_mov_b64 exec, -1
s_mov_b64 exec, s[30:31]
ds_write_b128 v217, v[150:153] offset:1584
s_mov_b64 exec, -1
s_mov_b64 exec, s[30:31]
ds_write_b128 v217, v[154:157] offset:2112
s_mov_b64 exec, -1
s_mov_b64 exec, s[30:31]
ds_write_b128 v217, v[158:161] offset:2640
s_mov_b64 exec, -1
s_mov_b64 exec, s[30:31]
ds_write_b128 v217, v[162:165] offset:3168
s_mov_b64 exec, -1
s_mov_b64 exec, s[30:31]
ds_write_b128 v217, v[166:169] offset:3696
s_mov_b64 exec, -1
s_mov_b64 exec, s[30:31]
ds_write_b128 v217, v[170:173] offset:4224
s_mov_b64 exec, -1
s_add_u32 m0, s55, 0
s_add_u32 s29, s54, 37248
buffer_load_dwordx4 v72, s[12:15], s29 offen lds
s_add_u32 m0, s55, 1024
s_add_u32 s29, s54, 37248
buffer_load_dwordx4 v73, s[12:15], s29 offen lds
s_add_u32 m0, s55, 2048
s_add_u32 s29, s54, 37248
buffer_load_dwordx4 v74, s[12:15], s29 offen lds
s_add_u32 m0, s55, 12288
s_add_u32 s29, s54, 74112
buffer_load_dwordx4 v72, s[12:15], s29 offen lds
s_add_u32 m0, s55, 13312
s_add_u32 s29, s54, 74112
buffer_load_dwordx4 v73, s[12:15], s29 offen lds
s_add_u32 m0, s55, 14336
s_add_u32 s29, s54, 74112
buffer_load_dwordx4 v74, s[12:15], s29 offen lds
s_add_u32 m0, s55, 24576
s_add_u32 s29, s54, 110976
buffer_load_dwordx4 v72, s[12:15], s29 offen lds
s_add_u32 m0, s55, 25600
s_add_u32 s29, s54, 110976
buffer_load_dwordx4 v73, s[12:15], s29 offen lds
s_waitcnt vmcnt(11) lgkmcnt(9)
s_add_u32 m0, s55, 26624
s_add_u32 s29, s54, 110976
buffer_load_dwordx4 v74, s[12:15], s29 offen lds
s_barrier
ds_read_b128 v[84:87], v113
s_waitcnt lgkmcnt(0)
v_mfma_f32_16x16x32_bf16 v[36:39], v[138:141], v[84:87], 0
ds_read_b128 v[92:95], v113 offset:55552
s_waitcnt lgkmcnt(0)
v_mfma_f32_16x16x32_bf16 v[48:51], v[138:141], v[92:95], 0
ds_read_b128 v[100:103], v111
ds_read_b128 v[104:107], v111 offset:16
s_waitcnt lgkmcnt(0)
v_smfmac_f32_16x16x64_bf16 v[36:39], v[142:145], v[100:107], v213
ds_read_b128 v[84:87], v111 offset:55552
ds_read_b128 v[88:91], v111 offset:55568
s_waitcnt lgkmcnt(0)
v_smfmac_f32_16x16x64_bf16 v[48:51], v[142:145], v[84:91], v213
ds_read_b128 v[92:95], v112
ds_read_b128 v[96:99], v112 offset:16
s_waitcnt lgkmcnt(0)
v_smfmac_f32_16x16x64_bf16 v[36:39], v[146:149], v[92:99], v213
ds_read_b128 v[100:103], v112 offset:55552
ds_read_b128 v[104:107], v112 offset:55568
s_waitcnt lgkmcnt(0)
v_smfmac_f32_16x16x64_bf16 v[48:51], v[146:149], v[100:107], v213
ds_read_b128 v[84:87], v113 offset:32
s_waitcnt lgkmcnt(0)
v_mfma_f32_16x16x32_bf16 v[40:43], v[150:153], v[84:87], 0
ds_read_b128 v[92:95], v113 offset:55584
s_waitcnt lgkmcnt(0)
v_mfma_f32_16x16x32_bf16 v[52:55], v[150:153], v[92:95], 0
ds_read_b128 v[100:103], v111 offset:32
ds_read_b128 v[104:107], v111 offset:48
s_waitcnt lgkmcnt(0)
v_smfmac_f32_16x16x64_bf16 v[40:43], v[154:157], v[100:107], v213
ds_read_b128 v[84:87], v111 offset:55584
ds_read_b128 v[88:91], v111 offset:55600
s_waitcnt lgkmcnt(0)
v_smfmac_f32_16x16x64_bf16 v[52:55], v[154:157], v[84:91], v213
ds_read_b128 v[92:95], v112 offset:32
ds_read_b128 v[96:99], v112 offset:48
s_waitcnt lgkmcnt(0)
v_smfmac_f32_16x16x64_bf16 v[40:43], v[158:161], v[92:99], v213
ds_read_b128 v[100:103], v112 offset:55584
ds_read_b128 v[104:107], v112 offset:55600
s_waitcnt lgkmcnt(0)
v_smfmac_f32_16x16x64_bf16 v[52:55], v[158:161], v[100:107], v213
ds_read_b128 v[84:87], v113 offset:64
s_waitcnt lgkmcnt(0)
v_mfma_f32_16x16x32_bf16 v[44:47], v[162:165], v[84:87], 0
ds_read_b128 v[92:95], v113 offset:55616
s_waitcnt lgkmcnt(0)
v_mfma_f32_16x16x32_bf16 v[56:59], v[162:165], v[92:95], 0
ds_read_b128 v[100:103], v111 offset:64
ds_read_b128 v[104:107], v111 offset:80
s_waitcnt lgkmcnt(0)
v_smfmac_f32_16x16x64_bf16 v[44:47], v[166:169], v[100:107], v213
ds_read_b128 v[84:87], v111 offset:55616
ds_read_b128 v[88:91], v111 offset:55632
s_waitcnt lgkmcnt(0)
v_smfmac_f32_16x16x64_bf16 v[56:59], v[166:169], v[84:91], v213
ds_read_b128 v[92:95], v112 offset:64
ds_read_b128 v[96:99], v112 offset:80
s_waitcnt lgkmcnt(0)
v_smfmac_f32_16x16x64_bf16 v[44:47], v[170:173], v[92:99], v213
ds_read_b128 v[100:103], v112 offset:55616
ds_read_b128 v[104:107], v112 offset:55632
s_waitcnt lgkmcnt(0)
v_smfmac_f32_16x16x64_bf16 v[56:59], v[170:173], v[100:107], v213
s_barrier
v_add_f32 v118, v36, v37
v_mul_f32 v119, v36, v36
v_add_f32 v118, v118, v38
v_fmac_f32 v119, v37, v37
v_add_f32 v118, v118, v39
v_fmac_f32 v119, v38, v38
v_fmac_f32 v119, v39, v39
v_add_f32 v126, v48, v49
v_mul_f32 v127, v48, v48
v_add_f32 v126, v126, v50
v_fmac_f32 v127, v49, v49
v_add_f32 v126, v126, v51
v_fmac_f32 v127, v50, v50
v_fmac_f32 v127, v51, v51
v_add_f32 v118, v118, v40
v_fmac_f32 v119, v40, v40
v_add_f32 v118, v118, v41
v_fmac_f32 v119, v41, v41
v_add_f32 v118, v118, v42
v_fmac_f32 v119, v42, v42
v_add_f32 v118, v118, v43
v_fmac_f32 v119, v43, v43
v_add_f32 v126, v126, v52
v_fmac_f32 v127, v52, v52
v_add_f32 v126, v126, v53
v_fmac_f32 v127, v53, v53
v_add_f32 v126, v126, v54
v_fmac_f32 v127, v54, v54
v_add_f32 v126, v126, v55
v_fmac_f32 v127, v55, v55
v_add_f32 v118, v118, v44
v_fmac_f32 v119, v44, v44
v_add_f32 v118, v118, v45
v_fmac_f32 v119, v45, v45
v_add_f32 v118, v118, v46
v_fmac_f32 v119, v46, v46
v_add_f32 v118, v118, v47
v_fmac_f32 v119, v47, v47
v_add_f32 v126, v126, v56
v_fmac_f32 v127, v56, v56
v_add_f32 v126, v126, v57
v_fmac_f32 v127, v57, v57
v_add_f32 v126, v126, v58
v_fmac_f32 v127, v58, v58
v_add_f32 v126, v126, v59
v_fmac_f32 v127, v59, v59
v_permlane16_swap_b32 v118, v119
v_add_f32 v118, v118, v119
v_permlane16_swap_b32 v126, v127
v_add_f32 v126, v126, v127
s_nop 1
v_permlane32_swap_b32 v118, v126
v_add_f32 v118, v118, v126
ds_write_b32 v209, v118
s_add_u32 m0, s55, 94464
s_add_u32 s29, s54, 147840
buffer_load_dwordx4 v72, s[12:15], s29 offen lds
s_add_u32 m0, s55, 95488
s_add_u32 s29, s54, 147840
buffer_load_dwordx4 v73, s[12:15], s29 offen lds
s_add_u32 m0, s55, 96512
s_add_u32 s29, s54, 147840
buffer_load_dwordx4 v74, s[12:15], s29 offen lds
s_add_u32 m0, s55, 106752
s_add_u32 s29, s54, 184704
buffer_load_dwordx4 v72, s[12:15], s29 offen lds
s_add_u32 m0, s55, 107776
s_add_u32 s29, s54, 184704
buffer_load_dwordx4 v73, s[12:15], s29 offen lds
s_add_u32 m0, s55, 108800
s_add_u32 s29, s54, 184704
buffer_load_dwordx4 v74, s[12:15], s29 offen lds
s_add_u32 m0, s55, 119040
s_add_u32 s29, s54, 0
buffer_load_dwordx4 v72, s[12:15], s29 offen lds
s_add_u32 m0, s55, 120064
s_add_u32 s29, s54, 0
buffer_load_dwordx4 v73, s[12:15], s29 offen lds
s_add_u32 m0, s55, 121088
s_add_u32 s29, s54, 0
buffer_load_dwordx4 v74, s[12:15], s29 offen lds
s_add_u32 m0, s55, 69888
s_add_u32 s29, s54, 36864
buffer_load_dwordx4 v72, s[12:15], s29 offen lds
s_add_u32 m0, s55, 70912
s_add_u32 s29, s54, 36864
buffer_load_dwordx4 v73, s[12:15], s29 offen lds
s_add_u32 m0, s55, 71936
s_add_u32 s29, s54, 36864
buffer_load_dwordx4 v74, s[12:15], s29 offen lds
s_add_u32 m0, s55, 82176
s_add_u32 s29, s54, 73728
buffer_load_dwordx4 v72, s[12:15], s29 offen lds
s_add_u32 m0, s55, 83200
s_add_u32 s29, s54, 73728
buffer_load_dwordx4 v73, s[12:15], s29 offen lds
s_waitcnt vmcnt(18)
s_add_u32 m0, s55, 84224
s_add_u32 s29, s54, 73728
buffer_load_dwordx4 v74, s[12:15], s29 offen lds
ds_read_b64_tr_b16 a[0:1], v110 offset:36864
ds_read_b64_tr_b16 a[24:25], v110 offset:36896
ds_read_b64_tr_b16 a[48:49], v110 offset:36928
ds_read_b64_tr_b16 a[2:3], v110 offset:38400
ds_read_b64_tr_b16 a[26:27], v110 offset:38432
ds_read_b64_tr_b16 a[50:51], v110 offset:38464
ds_read_b64_tr_b16 a[4:5], v128 offset:1536
ds_read_b64_tr_b16 a[28:29], v128 offset:1568
ds_read_b64_tr_b16 a[52:53], v128 offset:1600
ds_read_b64_tr_b16 a[16:17], v128
ds_read_b64_tr_b16 a[40:41], v128 offset:32
ds_read_b64_tr_b16 a[64:65], v128 offset:64
ds_read_b64_tr_b16 a[6:7], v128 offset:12288
ds_read_b64_tr_b16 a[30:31], v128 offset:12320
ds_read_b64_tr_b16 a[54:55], v128 offset:12352
s_waitcnt vmcnt(18)
ds_read_b64_tr_b16 a[18:19], v128 offset:13824
ds_read_b64_tr_b16 a[42:43], v128 offset:13856
ds_read_b64_tr_b16 a[66:67], v128 offset:13888
s_waitcnt vmcnt(16)
ds_read_b64_tr_b16 a[8:9], v128 offset:24576
ds_read_b64_tr_b16 a[32:33], v128 offset:24608
ds_read_b64_tr_b16 a[56:57], v128 offset:24640
s_waitcnt vmcnt(15)
ds_read_b64_tr_b16 a[10:11], v128 offset:26112
ds_read_b64_tr_b16 a[34:35], v128 offset:26144
s_waitcnt lgkmcnt(14)
ds_read_b64_tr_b16 a[58:59], v128 offset:26176
s_add_u32 m0, s55, 131328
s_add_u32 s29, s54, 110592
buffer_load_dwordx4 v72, s[12:15], s29 offen lds
s_add_u32 m0, s55, 132352
s_add_u32 s29, s54, 110592
buffer_load_dwordx4 v73, s[12:15], s29 offen lds
s_add_u32 m0, s55, 133376
s_add_u32 s29, s54, 110592
buffer_load_dwordx4 v74, s[12:15], s29 offen lds
s_barrier
ds_read_b128 v[102:105], v210 offset:18432
ds_read_b128 v[106:109], v210 offset:19456
s_waitcnt lgkmcnt(1)
v_add_f32 v102, v102, v103
s_waitcnt lgkmcnt(0)
v_add_f32 v106, v106, v107
v_add_f32 v104, v104, v105
v_add_f32 v108, v108, v109
v_add_f32 v102, v102, v104
v_add_f32 v106, v106, v108
v_mul_f32 v103, s48, v102
v_mul_f32 v104, s73, v102
v_mul_f32 v106, s73, v106
v_fma_f32 v106, -v103, v104, v106
v_max_f32 v106, 0, v106
v_add_f32 v106, s49, v106
v_rsq_f32 v102, v106
s_nop 0
v_mul_f32_e64 v103, -v103, v102
ds_write_b64 v211, v[102:103] offset:20480
ds_read_b64 v[118:119], v219 offset:20480
ds_read_b64 v[126:127], v219 offset:20736
s_waitcnt lgkmcnt(1)
v_fma_f32 v220, v36, v118, v119
v_fma_f32 v221, v37, v118, v119
v_cvt_pk_bf16_f32 v90, v220, v221
v_fma_f32 v222, v38, v118, v119
v_fma_f32 v223, v39, v118, v119
v_cvt_pk_bf16_f32 v91, v222, v223
v_fma_f32 v220, v40, v118, v119
v_fma_f32 v221, v41, v118, v119
v_cvt_pk_bf16_f32 v92, v220, v221
v_fma_f32 v222, v42, v118, v119
v_fma_f32 v223, v43, v118, v119
v_cvt_pk_bf16_f32 v93, v222, v223
ds_write_b128 v211, v[90:93] offset:20480
v_fma_f32 v220, v44, v118, v119
v_fma_f32 v221, v45, v118, v119
v_cvt_pk_bf16_f32 v94, v220, v221
v_fma_f32 v222, v46, v118, v119
v_fma_f32 v223, v47, v118, v119
v_cvt_pk_bf16_f32 v95, v222, v223
s_waitcnt lgkmcnt(1)
ds_write_b64 v212, v[94:95] offset:20480
v_fma_f32 v220, v48, v126, v127
v_fma_f32 v221, v49, v126, v127
v_cvt_pk_bf16_f32 v174, v220, v221
v_fma_f32 v222, v50, v126, v127
v_fma_f32 v223, v51, v126, v127
v_cvt_pk_bf16_f32 v175, v222, v223
v_fma_f32 v220, v52, v126, v127
v_fma_f32 v221, v53, v126, v127
v_cvt_pk_bf16_f32 v176, v220, v221
v_fma_f32 v222, v54, v126, v127
v_fma_f32 v223, v55, v126, v127
v_cvt_pk_bf16_f32 v177, v222, v223
ds_write_b128 v211, v[174:177] offset:26624
v_fma_f32 v220, v56, v126, v127
v_fma_f32 v221, v57, v126, v127
v_cvt_pk_bf16_f32 v178, v220, v221
v_fma_f32 v222, v58, v126, v127
v_fma_f32 v223, v59, v126, v127
v_cvt_pk_bf16_f32 v179, v222, v223
ds_write_b64 v212, v[178:179] offset:26624
s_waitcnt vmcnt(15) lgkmcnt(0)
s_barrier
ds_read_b64_tr_b16 a[12:13], v110 offset:1536
ds_read_b64_tr_b16 a[36:37], v110 offset:1568
ds_read_b64_tr_b16 a[60:61], v110 offset:1600
ds_read_b64_tr_b16 a[20:21], v110
ds_read_b64_tr_b16 a[44:45], v110 offset:32
ds_read_b64_tr_b16 a[68:69], v110 offset:64
s_waitcnt vmcnt(12) lgkmcnt(0)
s_add_u32 m0, s55, 94464
s_add_u32 s29, s54, 147456
buffer_load_dwordx4 v72, s[12:15], s29 offen lds
s_add_u32 m0, s55, 95488
s_add_u32 s29, s54, 147456
buffer_load_dwordx4 v73, s[12:15], s29 offen lds
s_add_u32 m0, s55, 96512
s_add_u32 s29, s54, 147456
buffer_load_dwordx4 v74, s[12:15], s29 offen lds
ds_read_b64_tr_b16 a[14:15], v110 offset:12288
ds_read_b64_tr_b16 a[38:39], v110 offset:12320
ds_read_b64_tr_b16 a[62:63], v110 offset:12352
ds_read_b64_tr_b16 a[22:23], v110 offset:13824
ds_read_b64_tr_b16 a[46:47], v110 offset:13856
ds_read_b64_tr_b16 a[70:71], v110 offset:13888
s_waitcnt vmcnt(12) lgkmcnt(0)
s_add_u32 m0, s55, 106752
s_add_u32 s29, s54, 184320
buffer_load_dwordx4 v72, s[12:15], s29 offen lds
s_add_u32 m0, s55, 107776
s_add_u32 s29, s54, 184320
buffer_load_dwordx4 v73, s[12:15], s29 offen lds
s_add_u32 m0, s55, 108800
s_add_u32 s29, s54, 184320
buffer_load_dwordx4 v74, s[12:15], s29 offen lds
ds_read_b64_tr_b16 a[216:217], v110 offset:24576
ds_read_b64_tr_b16 a[240:241], v110 offset:24608
ds_read_b64_tr_b16 v[232:233], v110 offset:24640
ds_read_b64_tr_b16 a[218:219], v110 offset:26112
ds_read_b64_tr_b16 a[242:243], v110 offset:26144
ds_read_b64_tr_b16 v[234:235], v110 offset:26176
s_waitcnt vmcnt(12) lgkmcnt(0)
s_add_u32 m0, s55, 119040
s_add_u32 s29, s54, 768
buffer_load_dwordx4 v72, s[12:15], s29 offen lds
s_add_u32 m0, s55, 120064
s_add_u32 s29, s54, 768
buffer_load_dwordx4 v73, s[12:15], s29 offen lds
s_add_u32 m0, s55, 121088
s_add_u32 s29, s54, 768
buffer_load_dwordx4 v74, s[12:15], s29 offen lds
ds_read_b64_tr_b16 a[220:221], v129 offset:1536
ds_read_b64_tr_b16 a[244:245], v129 offset:1568
ds_read_b64_tr_b16 v[236:237], v129 offset:1600
ds_read_b64_tr_b16 a[232:233], v129
ds_read_b64_tr_b16 v[224:225], v129 offset:32
ds_read_b64_tr_b16 v[248:249], v129 offset:64
s_waitcnt lgkmcnt(0)
s_add_u32 m0, s55, 69888
s_add_u32 s29, s54, 37632
buffer_load_dwordx4 v72, s[12:15], s29 offen lds
s_add_u32 m0, s55, 70912
s_add_u32 s29, s54, 37632
buffer_load_dwordx4 v73, s[12:15], s29 offen lds
s_waitcnt vmcnt(14)
s_add_u32 m0, s55, 71936
s_add_u32 s29, s54, 37632
buffer_load_dwordx4 v74, s[12:15], s29 offen lds
ds_read_b64_tr_b16 a[222:223], v129 offset:12288
ds_read_b64_tr_b16 a[246:247], v129 offset:12320
ds_read_b64_tr_b16 v[238:239], v129 offset:12352
ds_read_b64_tr_b16 a[234:235], v129 offset:13824
ds_read_b64_tr_b16 v[226:227], v129 offset:13856
ds_read_b64_tr_b16 v[250:251], v129 offset:13888
s_waitcnt lgkmcnt(0)
s_add_u32 m0, s55, 82176
s_add_u32 s29, s54, 74496
buffer_load_dwordx4 v72, s[12:15], s29 offen lds
s_add_u32 m0, s55, 83200
s_add_u32 s29, s54, 74496
buffer_load_dwordx4 v73, s[12:15], s29 offen lds
s_waitcnt vmcnt(14)
s_add_u32 m0, s55, 84224
s_add_u32 s29, s54, 74496
buffer_load_dwordx4 v74, s[12:15], s29 offen lds
ds_read_b64_tr_b16 a[224:225], v110 offset:36864
ds_read_b64_tr_b16 a[248:249], v110 offset:36896
ds_read_b64_tr_b16 v[240:241], v110 offset:36928
ds_read_b64_tr_b16 a[226:227], v110 offset:38400
ds_read_b64_tr_b16 a[250:251], v110 offset:38432
ds_read_b64_tr_b16 v[242:243], v110 offset:38464
s_waitcnt lgkmcnt(0)
s_add_u32 m0, s55, 131328
s_add_u32 s29, s54, 111360
buffer_load_dwordx4 v72, s[12:15], s29 offen lds
s_add_u32 m0, s55, 132352
s_add_u32 s29, s54, 111360
buffer_load_dwordx4 v73, s[12:15], s29 offen lds
s_waitcnt vmcnt(14)
s_add_u32 m0, s55, 133376
s_add_u32 s29, s54, 111360
buffer_load_dwordx4 v74, s[12:15], s29 offen lds
ds_read_b64_tr_b16 a[228:229], v110 offset:1536
ds_read_b64_tr_b16 a[252:253], v110 offset:1568
ds_read_b64_tr_b16 v[244:245], v110 offset:1600
ds_read_b64_tr_b16 a[236:237], v110
ds_read_b64_tr_b16 v[228:229], v110 offset:32
ds_read_b64_tr_b16 v[252:253], v110 offset:64
s_waitcnt lgkmcnt(0)
s_add_u32 m0, s55, 94464
s_add_u32 s29, s54, 148224
buffer_load_dwordx4 v72, s[12:15], s29 offen lds
s_add_u32 m0, s55, 95488
s_add_u32 s29, s54, 148224
buffer_load_dwordx4 v73, s[12:15], s29 offen lds
s_waitcnt vmcnt(14)
s_add_u32 m0, s55, 96512
s_add_u32 s29, s54, 148224
buffer_load_dwordx4 v74, s[12:15], s29 offen lds
ds_read_b64_tr_b16 a[230:231], v110 offset:12288
ds_read_b64_tr_b16 a[254:255], v110 offset:12320
ds_read_b64_tr_b16 v[246:247], v110 offset:12352
ds_read_b64_tr_b16 a[238:239], v110 offset:13824
ds_read_b64_tr_b16 v[230:231], v110 offset:13856
ds_read_b64_tr_b16 v[254:255], v110 offset:13888
s_waitcnt lgkmcnt(0)
s_add_u32 m0, s55, 106752
s_add_u32 s29, s54, 185088
buffer_load_dwordx4 v72, s[12:15], s29 offen lds
s_add_u32 m0, s55, 107776
s_add_u32 s29, s54, 185088
buffer_load_dwordx4 v73, s[12:15], s29 offen lds
s_add_u32 m0, s55, 108800
s_add_u32 s29, s54, 185088
buffer_load_dwordx4 v74, s[12:15], s29 offen lds
s_mul_hi_u32 s41, s35, 58835169
s_mul_i32 s42, s41, 73
s_sub_u32 s42, s35, s42
s_mul_i32 s43, s41, 1373568
s_mul_i32 s51, s42, 2688
s_add_u32 s43, s43, s51
s_cmp_lt_u32 s35, s34
s_cselect_b32 s50, s43, 1879048192
s_add_u32 s35, s35, 32
s_cmp_eq_u32 s42, 0
s_cselect_b32 s44, 536870911, s72
s_cmp_eq_u32 s42, 72
s_cselect_b32 s44, 939524095, s44
s_cmp_eq_u32 s41, 0
s_cselect_b32 s52, 1879048192, s50
s_mov_b32 s37, s50
v_and_b32 v180, s44, v208
s_add_u32 m0, s45, 0
s_nop 0
buffer_load_dwordx4 v180, s[4:7], s52 offen nt lds
s_add_u32 m0, s45, 4112
s_add_u32 s40, s37, 196224
buffer_load_dwordx4 v180, s[4:7], s40 offen nt lds
s_add_u32 m0, s45, 8224
s_add_u32 s40, s37, 392448
buffer_load_dwordx4 v180, s[4:7], s40 offen nt lds
s_add_u32 m0, s45, 12336
s_add_u32 s40, s37, 588672
buffer_load_dwordx4 v180, s[4:7], s40 offen nt lds
s_add_u32 m0, s45, 16448
s_add_u32 s40, s37, 784896
buffer_load_dwordx4 v180, s[4:7], s40 offen nt lds
s_add_u32 m0, s45, 20560
s_add_u32 s40, s37, 981120
buffer_load_dwordx4 v180, s[4:7], s40 offen nt lds
s_add_u32 m0, s45, 24672
s_add_u32 s40, s37, 1177344
buffer_load_dwordx4 v180, s[4:7], s40 offen nt lds
s_add_u32 m0, s45, 28784
s_add_u32 s40, s37, 1373568
buffer_load_dwordx4 v180, s[4:7], s40 offen nt lds
s_waitcnt vmcnt(20)
s_add_u32 m0, s45, 32896
s_add_u32 s40, s37, 1569792
buffer_load_dwordx4 v180, s[4:7], s40 offen nt lds
ds_read_b64_tr_b16 a[72:73], v110 offset:24576
ds_read_b64_tr_b16 a[96:97], v110 offset:24608
ds_read_b64_tr_b16 a[120:121], v110 offset:24640
ds_read_b64_tr_b16 a[74:75], v110 offset:26112
ds_read_b64_tr_b16 a[98:99], v110 offset:26144
ds_read_b64_tr_b16 a[122:123], v110 offset:26176
ds_read_b64_tr_b16 a[76:77], v129 offset:1536
ds_read_b64_tr_b16 a[100:101], v129 offset:1568
ds_read_b64_tr_b16 a[124:125], v129 offset:1600
ds_read_b64_tr_b16 a[88:89], v129
ds_read_b64_tr_b16 a[112:113], v129 offset:32
ds_read_b64_tr_b16 a[136:137], v129 offset:64
s_waitcnt vmcnt(18) lgkmcnt(0)
s_add_u32 m0, s55, 69888
s_add_u32 s29, s54, 0
buffer_load_dwordx4 v136, s[16:19], s29 offen lds
s_add_u32 m0, s55, 70912
s_add_u32 s29, s54, 0
buffer_load_dwordx4 v137, s[16:19], s29 offen lds
s_add_u32 m0, s55, 71936
s_add_u32 s29, s54, 0
buffer_load_dwordx4 v216, s[16:19], s29 offen lds
ds_read_b64_tr_b16 a[78:79], v129 offset:12288
ds_read_b64_tr_b16 a[102:103], v129 offset:12320
ds_read_b64_tr_b16 a[126:127], v129 offset:12352
ds_read_b64_tr_b16 a[90:91], v129 offset:13824
ds_read_b64_tr_b16 a[114:115], v129 offset:13856
ds_read_b64_tr_b16 a[138:139], v129 offset:13888
s_waitcnt lgkmcnt(0)
s_add_u32 m0, s55, 82176
s_add_u32 s29, s54, 12288
buffer_load_dwordx4 v136, s[16:19], s29 offen lds
s_add_u32 m0, s55, 83200
s_add_u32 s29, s54, 12288
buffer_load_dwordx4 v137, s[16:19], s29 offen lds
s_waitcnt vmcnt(15)
s_add_u32 m0, s55, 84224
s_add_u32 s29, s54, 12288
buffer_load_dwordx4 v216, s[16:19], s29 offen lds
ds_read_b64_tr_b16 a[80:81], v110 offset:36864
ds_read_b64_tr_b16 a[104:105], v110 offset:36896
ds_read_b64_tr_b16 a[128:129], v110 offset:36928
ds_read_b64_tr_b16 a[82:83], v110 offset:38400
ds_read_b64_tr_b16 a[106:107], v110 offset:38432
ds_read_b64_tr_b16 a[130:131], v110 offset:38464
ds_read_b64_tr_b16 a[84:85], v110 offset:1536
ds_read_b64_tr_b16 a[108:109], v110 offset:1568
ds_read_b64_tr_b16 a[132:133], v110 offset:1600
ds_read_b64_tr_b16 a[92:93], v110
ds_read_b64_tr_b16 a[116:117], v110 offset:32
ds_read_b64_tr_b16 a[140:141], v110 offset:64
ds_read_b64_tr_b16 a[86:87], v110 offset:12288
ds_read_b64_tr_b16 a[110:111], v110 offset:12320
ds_read_b64_tr_b16 a[134:135], v110 offset:12352
s_waitcnt vmcnt(15)
ds_read_b64_tr_b16 a[94:95], v110 offset:13824
ds_read_b64_tr_b16 a[118:119], v110 offset:13856
ds_read_b64_tr_b16 a[142:143], v110 offset:13888
s_waitcnt vmcnt(3)
ds_read_b64_tr_b16 a[144:145], v129
ds_read_b64_tr_b16 a[168:169], v129 offset:32
ds_read_b64_tr_b16 a[192:193], v129 offset:64
ds_read_b64_tr_b16 a[146:147], v129 offset:1536
ds_read_b64_tr_b16 a[170:171], v129 offset:1568
ds_read_b64_tr_b16 a[194:195], v129 offset:1600
s_waitcnt vmcnt(0) lgkmcnt(0)
s_add_u32 m0, s55, 69888
s_add_u32 s29, s54, 24576
buffer_load_dwordx4 v136, s[16:19], s29 offen lds
s_add_u32 m0, s55, 70912
s_add_u32 s29, s54, 24576
buffer_load_dwordx4 v137, s[16:19], s29 offen lds
s_add_u32 m0, s55, 71936
s_add_u32 s29, s54, 24576
buffer_load_dwordx4 v216, s[16:19], s29 offen lds
ds_read_b64_tr_b16 a[148:149], v129 offset:13824
ds_read_b64_tr_b16 a[172:173], v129 offset:13856
ds_read_b64_tr_b16 a[196:197], v129 offset:13888
ds_read_b64_tr_b16 a[160:161], v129 offset:12288
ds_read_b64_tr_b16 a[184:185], v129 offset:12320
ds_read_b64_tr_b16 a[208:209], v129 offset:12352
s_waitcnt lgkmcnt(0)
s_add_u32 m0, s55, 82176
s_add_u32 s29, s54, 36864
buffer_load_dwordx4 v136, s[16:19], s29 offen lds
s_add_u32 m0, s55, 83200
s_add_u32 s29, s54, 36864
buffer_load_dwordx4 v137, s[16:19], s29 offen lds
s_add_u32 m0, s55, 84224
s_add_u32 s29, s54, 36864
buffer_load_dwordx4 v216, s[16:19], s29 offen lds
s_waitcnt vmcnt(4)
ds_read_b64_tr_b16 a[150:151], v129
ds_read_b64_tr_b16 a[174:175], v129 offset:32
ds_read_b64_tr_b16 a[198:199], v129 offset:64
s_waitcnt vmcnt(3)
ds_read_b64_tr_b16 a[162:163], v129 offset:1536
ds_read_b64_tr_b16 a[186:187], v129 offset:1568
ds_read_b64_tr_b16 a[210:211], v129 offset:1600
s_waitcnt lgkmcnt(0)
s_add_u32 m0, s55, 69888
s_add_u32 s29, s54, 49152
buffer_load_dwordx4 v136, s[16:19], s29 offen lds
s_add_u32 m0, s55, 70912
s_add_u32 s29, s54, 49152
buffer_load_dwordx4 v137, s[16:19], s29 offen lds
s_add_u32 m0, s55, 71936
s_add_u32 s29, s54, 49152
buffer_load_dwordx4 v216, s[16:19], s29 offen lds
s_waitcnt vmcnt(4)
ds_read_b64_tr_b16 a[152:153], v129 offset:12288
ds_read_b64_tr_b16 a[176:177], v129 offset:12320
ds_read_b64_tr_b16 a[200:201], v129 offset:12352
s_waitcnt vmcnt(3)
ds_read_b64_tr_b16 a[154:155], v129 offset:13824
ds_read_b64_tr_b16 a[178:179], v129 offset:13856
ds_read_b64_tr_b16 a[202:203], v129 offset:13888
s_waitcnt lgkmcnt(0)
s_add_u32 m0, s55, 82176
s_add_u32 s29, s54, 61440
buffer_load_dwordx4 v136, s[16:19], s29 offen lds
s_add_u32 m0, s55, 83200
s_add_u32 s29, s54, 61440
buffer_load_dwordx4 v137, s[16:19], s29 offen lds
s_add_u32 m0, s55, 84224
s_add_u32 s29, s54, 61440
buffer_load_dwordx4 v216, s[16:19], s29 offen lds
s_waitcnt vmcnt(3)
ds_read_b64_tr_b16 a[156:157], v129 offset:1536
ds_read_b64_tr_b16 a[180:181], v129 offset:1568
ds_read_b64_tr_b16 a[204:205], v129 offset:1600
ds_read_b64_tr_b16 a[164:165], v129
ds_read_b64_tr_b16 a[188:189], v129 offset:32
ds_read_b64_tr_b16 a[212:213], v129 offset:64
s_waitcnt vmcnt(1)
ds_read_b64_tr_b16 a[158:159], v129 offset:12288
ds_read_b64_tr_b16 a[182:183], v129 offset:12320
ds_read_b64_tr_b16 a[206:207], v129 offset:12352
s_waitcnt vmcnt(0)
ds_read_b64_tr_b16 a[166:167], v129 offset:13824
ds_read_b64_tr_b16 a[190:191], v129 offset:13856
ds_read_b64_tr_b16 a[214:215], v129 offset:13888
ds_read_b128 v[182:185], v210 offset:20480
s_waitcnt lgkmcnt(0)
v_mfma_f32_16x16x32_bf16 v[138:141], a[0:3], v[182:185], 0
v_mfma_f32_16x16x32_bf16 v[142:145], a[24:27], v[182:185], 0
v_mfma_f32_16x16x32_bf16 v[146:149], a[48:51], v[182:185], 0
ds_read_b128 v[186:189], v210 offset:26624
s_waitcnt lgkmcnt(0)
v_mfma_f32_16x16x32_bf16 v[150:153], a[0:3], v[186:189], 0
v_mfma_f32_16x16x32_bf16 v[154:157], a[24:27], v[186:189], 0
v_mfma_f32_16x16x32_bf16 v[158:161], a[48:51], v[186:189], 0
ds_read_b128 v[114:117], v210 offset:21504
s_waitcnt lgkmcnt(0)
v_mfma_f32_16x16x32_bf16 v[138:141], a[4:7], v[114:117], v[138:141]
v_mfma_f32_16x16x32_bf16 v[142:145], a[28:31], v[114:117], v[142:145]
v_mfma_f32_16x16x32_bf16 v[146:149], a[52:55], v[114:117], v[146:149]
ds_read_b128 v[122:125], v210 offset:27648
s_waitcnt lgkmcnt(0)
v_mfma_f32_16x16x32_bf16 v[150:153], a[4:7], v[122:125], v[150:153]
v_mfma_f32_16x16x32_bf16 v[154:157], a[28:31], v[122:125], v[154:157]
v_mfma_f32_16x16x32_bf16 v[158:161], a[52:55], v[122:125], v[158:161]
ds_read_b128 v[182:185], v210 offset:24576
s_waitcnt lgkmcnt(0)
v_mfma_f32_16x16x32_bf16 v[138:141], a[16:19], v[182:185], v[138:141]
v_mfma_f32_16x16x32_bf16 v[142:145], a[40:43], v[182:185], v[142:145]
v_mfma_f32_16x16x32_bf16 v[146:149], a[64:67], v[182:185], v[146:149]
ds_read_b128 v[186:189], v210 offset:30720
s_waitcnt lgkmcnt(0)
v_mfma_f32_16x16x32_bf16 v[150:153], a[16:19], v[186:189], v[150:153]
v_mfma_f32_16x16x32_bf16 v[154:157], a[40:43], v[186:189], v[154:157]
v_mfma_f32_16x16x32_bf16 v[158:161], a[64:67], v[186:189], v[158:161]
ds_read_b128 v[114:117], v210 offset:22528
s_waitcnt lgkmcnt(0)
v_mfma_f32_16x16x32_bf16 v[138:141], a[8:11], v[114:117], v[138:141]
v_mfma_f32_16x16x32_bf16 v[142:145], a[32:35], v[114:117], v[142:145]
v_mfma_f32_16x16x32_bf16 v[146:149], a[56:59], v[114:117], v[146:149]
ds_read_b128 v[122:125], v210 offset:28672
s_waitcnt lgkmcnt(0)
v_mfma_f32_16x16x32_bf16 v[150:153], a[8:11], v[122:125], v[150:153]
v_mfma_f32_16x16x32_bf16 v[154:157], a[32:35], v[122:125], v[154:157]
v_mfma_f32_16x16x32_bf16 v[158:161], a[56:59], v[122:125], v[158:161]
ds_read_b128 v[182:185], v210 offset:23552
s_waitcnt lgkmcnt(0)
v_mfma_f32_16x16x32_bf16 v[138:141], a[12:15], v[182:185], v[138:141]
v_mfma_f32_16x16x32_bf16 v[142:145], a[36:39], v[182:185], v[142:145]
v_mfma_f32_16x16x32_bf16 v[146:149], a[60:63], v[182:185], v[146:149]
ds_read_b128 v[186:189], v210 offset:29696
s_waitcnt lgkmcnt(0)
v_mfma_f32_16x16x32_bf16 v[150:153], a[12:15], v[186:189], v[150:153]
v_mfma_f32_16x16x32_bf16 v[154:157], a[36:39], v[186:189], v[154:157]
v_mfma_f32_16x16x32_bf16 v[158:161], a[60:63], v[186:189], v[158:161]
ds_read_b128 v[114:117], v210 offset:25600
s_waitcnt lgkmcnt(0)
v_mfma_f32_16x16x32_bf16 v[138:141], a[20:23], v[114:117], v[138:141]
v_mfma_f32_16x16x32_bf16 v[142:145], a[44:47], v[114:117], v[142:145]
v_mfma_f32_16x16x32_bf16 v[146:149], a[68:71], v[114:117], v[146:149]
ds_read_b128 v[122:125], v210 offset:31744
s_waitcnt lgkmcnt(0)
v_mfma_f32_16x16x32_bf16 v[150:153], a[20:23], v[122:125], v[150:153]
v_mfma_f32_16x16x32_bf16 v[154:157], a[44:47], v[122:125], v[154:157]
v_mfma_f32_16x16x32_bf16 v[158:161], a[68:71], v[122:125], v[158:161]
v_cvt_pk_bf16_f32 v60, v138, v139
v_cvt_pk_bf16_f32 v61, v140, v141
v_cvt_pk_bf16_f32 v62, v142, v143
v_cvt_pk_bf16_f32 v63, v144, v145
v_cvt_pk_bf16_f32 v64, v146, v147
v_cvt_pk_bf16_f32 v65, v148, v149
v_cvt_pk_bf16_f32 v66, v150, v151
v_cvt_pk_bf16_f32 v67, v152, v153
v_cvt_pk_bf16_f32 v68, v154, v155
v_cvt_pk_bf16_f32 v69, v156, v157
v_cvt_pk_bf16_f32 v70, v158, v159
v_cvt_pk_bf16_f32 v71, v160, v161
ds_read_b128 v[182:185], v210 offset:20480
s_waitcnt lgkmcnt(0)
v_mfma_f32_16x16x32_bf16 v[162:165], a[216:219], v[182:185], 0
v_mfma_f32_16x16x32_bf16 v[166:169], a[240:243], v[182:185], 0
v_mfma_f32_16x16x32_bf16 v[170:173], v[232:235], v[182:185], 0
ds_read_b128 v[186:189], v210 offset:26624
s_waitcnt lgkmcnt(0)
v_mfma_f32_16x16x32_bf16 v[138:141], a[216:219], v[186:189], 0
v_mfma_f32_16x16x32_bf16 v[142:145], a[240:243], v[186:189], 0
v_mfma_f32_16x16x32_bf16 v[146:149], v[232:235], v[186:189], 0
ds_read_b128 v[114:117], v210 offset:21504
s_waitcnt lgkmcnt(0)
v_mfma_f32_16x16x32_bf16 v[162:165], a[220:223], v[114:117], v[162:165]
v_mfma_f32_16x16x32_bf16 v[166:169], a[244:247], v[114:117], v[166:169]
v_mfma_f32_16x16x32_bf16 v[170:173], v[236:239], v[114:117], v[170:173]
ds_read_b128 v[122:125], v210 offset:27648
s_waitcnt lgkmcnt(0)
v_mfma_f32_16x16x32_bf16 v[138:141], a[220:223], v[122:125], v[138:141]
v_mfma_f32_16x16x32_bf16 v[142:145], a[244:247], v[122:125], v[142:145]
v_mfma_f32_16x16x32_bf16 v[146:149], v[236:239], v[122:125], v[146:149]
ds_read_b128 v[182:185], v210 offset:24576
s_waitcnt lgkmcnt(0)
v_mfma_f32_16x16x32_bf16 v[162:165], a[232:235], v[182:185], v[162:165]
v_mfma_f32_16x16x32_bf16 v[166:169], v[224:227], v[182:185], v[166:169]
v_mfma_f32_16x16x32_bf16 v[170:173], v[248:251], v[182:185], v[170:173]
ds_read_b128 v[186:189], v210 offset:30720
s_waitcnt lgkmcnt(0)
v_mfma_f32_16x16x32_bf16 v[138:141], a[232:235], v[186:189], v[138:141]
v_mfma_f32_16x16x32_bf16 v[142:145], v[224:227], v[186:189], v[142:145]
v_mfma_f32_16x16x32_bf16 v[146:149], v[248:251], v[186:189], v[146:149]
ds_read_b128 v[114:117], v210 offset:22528
s_waitcnt lgkmcnt(0)
v_mfma_f32_16x16x32_bf16 v[162:165], a[224:227], v[114:117], v[162:165]
v_mfma_f32_16x16x32_bf16 v[166:169], a[248:251], v[114:117], v[166:169]
v_mfma_f32_16x16x32_bf16 v[170:173], v[240:243], v[114:117], v[170:173]
ds_read_b128 v[122:125], v210 offset:28672
s_waitcnt lgkmcnt(0)
v_mfma_f32_16x16x32_bf16 v[138:141], a[224:227], v[122:125], v[138:141]
v_mfma_f32_16x16x32_bf16 v[142:145], a[248:251], v[122:125], v[142:145]
v_mfma_f32_16x16x32_bf16 v[146:149], v[240:243], v[122:125], v[146:149]
ds_read_b128 v[182:185], v210 offset:23552
s_waitcnt lgkmcnt(0)
v_mfma_f32_16x16x32_bf16 v[162:165], a[228:231], v[182:185], v[162:165]
v_mfma_f32_16x16x32_bf16 v[166:169], a[252:255], v[182:185], v[166:169]
v_mfma_f32_16x16x32_bf16 v[170:173], v[244:247], v[182:185], v[170:173]
ds_read_b128 v[186:189], v210 offset:29696
s_waitcnt lgkmcnt(0)
v_mfma_f32_16x16x32_bf16 v[138:141], a[228:231], v[186:189], v[138:141]
v_mfma_f32_16x16x32_bf16 v[142:145], a[252:255], v[186:189], v[142:145]
v_mfma_f32_16x16x32_bf16 v[146:149], v[244:247], v[186:189], v[146:149]
ds_read_b128 v[114:117], v210 offset:25600
s_waitcnt lgkmcnt(0)
v_mfma_f32_16x16x32_bf16 v[162:165], a[236:239], v[114:117], v[162:165]
v_mfma_f32_16x16x32_bf16 v[166:169], v[228:231], v[114:117], v[166:169]
v_mfma_f32_16x16x32_bf16 v[170:173], v[252:255], v[114:117], v[170:173]
ds_read_b128 v[122:125], v210 offset:31744
s_waitcnt lgkmcnt(0)
v_mfma_f32_16x16x32_bf16 v[138:141], a[236:239], v[122:125], v[138:141]
v_mfma_f32_16x16x32_bf16 v[142:145], v[228:231], v[122:125], v[142:145]
v_mfma_f32_16x16x32_bf16 v[146:149], v[252:255], v[122:125], v[146:149]
v_cvt_pk_bf16_f32 v84, v162, v163
v_cvt_pk_bf16_f32 v85, v164, v165
v_cvt_pk_bf16_f32 v86, v166, v167
v_cvt_pk_bf16_f32 v87, v168, v169
v_cvt_pk_bf16_f32 v88, v170, v171
v_cvt_pk_bf16_f32 v89, v172, v173
v_cvt_pk_bf16_f32 v96, v138, v139
v_cvt_pk_bf16_f32 v97, v140, v141
v_cvt_pk_bf16_f32 v98, v142, v143
v_cvt_pk_bf16_f32 v99, v144, v145
v_cvt_pk_bf16_f32 v100, v146, v147
v_cvt_pk_bf16_f32 v101, v148, v149
ds_read_b128 v[182:185], v210 offset:20480
s_waitcnt lgkmcnt(0)
v_mfma_f32_16x16x32_bf16 v[150:153], a[72:75], v[182:185], 0
v_mfma_f32_16x16x32_bf16 v[154:157], a[96:99], v[182:185], 0
v_mfma_f32_16x16x32_bf16 v[158:161], a[120:123], v[182:185], 0
ds_read_b128 v[186:189], v210 offset:26624
s_waitcnt lgkmcnt(0)
v_mfma_f32_16x16x32_bf16 v[162:165], a[72:75], v[186:189], 0
v_mfma_f32_16x16x32_bf16 v[166:169], a[96:99], v[186:189], 0
v_mfma_f32_16x16x32_bf16 v[170:173], a[120:123], v[186:189], 0
ds_read_b128 v[114:117], v210 offset:21504
s_waitcnt lgkmcnt(0)
v_mfma_f32_16x16x32_bf16 v[150:153], a[76:79], v[114:117], v[150:153]
v_mfma_f32_16x16x32_bf16 v[154:157], a[100:103], v[114:117], v[154:157]
v_mfma_f32_16x16x32_bf16 v[158:161], a[124:127], v[114:117], v[158:161]
ds_read_b128 v[122:125], v210 offset:27648
s_waitcnt lgkmcnt(0)
v_mfma_f32_16x16x32_bf16 v[162:165], a[76:79], v[122:125], v[162:165]
v_mfma_f32_16x16x32_bf16 v[166:169], a[100:103], v[122:125], v[166:169]
v_mfma_f32_16x16x32_bf16 v[170:173], a[124:127], v[122:125], v[170:173]
ds_read_b128 v[182:185], v210 offset:24576
s_waitcnt lgkmcnt(0)
v_mfma_f32_16x16x32_bf16 v[150:153], a[88:91], v[182:185], v[150:153]
v_mfma_f32_16x16x32_bf16 v[154:157], a[112:115], v[182:185], v[154:157]
v_mfma_f32_16x16x32_bf16 v[158:161], a[136:139], v[182:185], v[158:161]
ds_read_b128 v[186:189], v210 offset:30720
s_waitcnt lgkmcnt(0)
v_mfma_f32_16x16x32_bf16 v[162:165], a[88:91], v[186:189], v[162:165]
v_mfma_f32_16x16x32_bf16 v[166:169], a[112:115], v[186:189], v[166:169]
v_mfma_f32_16x16x32_bf16 v[170:173], a[136:139], v[186:189], v[170:173]
ds_read_b128 v[114:117], v210 offset:22528
s_waitcnt lgkmcnt(0)
v_mfma_f32_16x16x32_bf16 v[150:153], a[80:83], v[114:117], v[150:153]
v_mfma_f32_16x16x32_bf16 v[154:157], a[104:107], v[114:117], v[154:157]
v_mfma_f32_16x16x32_bf16 v[158:161], a[128:131], v[114:117], v[158:161]
ds_read_b128 v[122:125], v210 offset:28672
s_waitcnt lgkmcnt(0)
v_mfma_f32_16x16x32_bf16 v[162:165], a[80:83], v[122:125], v[162:165]
v_mfma_f32_16x16x32_bf16 v[166:169], a[104:107], v[122:125], v[166:169]
v_mfma_f32_16x16x32_bf16 v[170:173], a[128:131], v[122:125], v[170:173]
ds_read_b128 v[182:185], v210 offset:23552
s_waitcnt lgkmcnt(0)
v_mfma_f32_16x16x32_bf16 v[150:153], a[84:87], v[182:185], v[150:153]
v_mfma_f32_16x16x32_bf16 v[154:157], a[108:111], v[182:185], v[154:157]
v_mfma_f32_16x16x32_bf16 v[158:161], a[132:135], v[182:185], v[158:161]
ds_read_b128 v[186:189], v210 offset:29696
s_waitcnt lgkmcnt(0)
v_mfma_f32_16x16x32_bf16 v[162:165], a[84:87], v[186:189], v[162:165]
v_mfma_f32_16x16x32_bf16 v[166:169], a[108:111], v[186:189], v[166:169]
v_mfma_f32_16x16x32_bf16 v[170:173], a[132:135], v[186:189], v[170:173]
ds_read_b128 v[114:117], v210 offset:25600
s_waitcnt lgkmcnt(0)
v_mfma_f32_16x16x32_bf16 v[150:153], a[92:95], v[114:117], v[150:153]
v_mfma_f32_16x16x32_bf16 v[154:157], a[116:119], v[114:117], v[154:157]
v_mfma_f32_16x16x32_bf16 v[158:161], a[140:143], v[114:117], v[158:161]
ds_read_b128 v[122:125], v210 offset:31744
s_waitcnt lgkmcnt(0)
v_mfma_f32_16x16x32_bf16 v[162:165], a[92:95], v[122:125], v[162:165]
v_mfma_f32_16x16x32_bf16 v[166:169], a[116:119], v[122:125], v[166:169]
v_mfma_f32_16x16x32_bf16 v[170:173], a[140:143], v[122:125], v[170:173]
v_cvt_pk_bf16_f32 v90, v150, v151
v_cvt_pk_bf16_f32 v91, v152, v153
v_cvt_pk_bf16_f32 v92, v154, v155
v_cvt_pk_bf16_f32 v93, v156, v157
v_cvt_pk_bf16_f32 v94, v158, v159
v_cvt_pk_bf16_f32 v95, v160, v161
v_cvt_pk_bf16_f32 v102, v162, v163
v_cvt_pk_bf16_f32 v103, v164, v165
v_cvt_pk_bf16_f32 v104, v166, v167
v_cvt_pk_bf16_f32 v105, v168, v169
v_cvt_pk_bf16_f32 v106, v170, v171
v_cvt_pk_bf16_f32 v107, v172, v173
s_barrier
ds_write_b128 v121, v[36:39]
ds_write_b128 v121, v[40:43] offset:64
ds_write_b128 v121, v[44:47] offset:128
ds_write_b128 v120, v[84:87]
ds_write_b64 v120, v[88:89] offset:16
ds_write_b128 v120, v[60:63] offset:512
ds_write_b64 v120, v[64:65] offset:528
ds_write_b128 v120, v[90:93] offset:1024
ds_write_b64 v120, v[94:95] offset:1040
s_mov_b64 exec, s[56:57]
ds_write_b128 v121, v[48:51] offset:12544
s_mov_b64 exec, -1
s_mov_b64 exec, s[56:57]
ds_write_b128 v121, v[52:55] offset:12608
s_mov_b64 exec, -1
s_mov_b64 exec, s[56:57]
ds_write_b128 v121, v[56:59] offset:12672
s_mov_b64 exec, -1
s_mov_b64 exec, s[56:57]
ds_write_b128 v120, v[96:99] offset:24832
s_mov_b64 exec, -1
s_mov_b64 exec, s[56:57]
ds_write_b64 v120, v[100:101] offset:24848
s_mov_b64 exec, -1
s_mov_b64 exec, s[56:57]
ds_write_b128 v120, v[66:69] offset:25344
s_mov_b64 exec, -1
s_mov_b64 exec, s[56:57]
ds_write_b64 v120, v[70:71] offset:25360
s_mov_b64 exec, -1
s_mov_b64 exec, s[56:57]
ds_write_b128 v120, v[102:105] offset:25856
s_mov_b64 exec, -1
s_mov_b64 exec, s[56:57]
ds_write_b64 v120, v[106:107] offset:25872
s_mov_b64 exec, -1
s_nop 0
s_barrier
s_mov_b32 s38, s36
ds_read_b128 v[174:177], v217
ds_read_b128 v[84:87], v200
s_waitcnt lgkmcnt(0)
v_mfma_f32_16x16x32_bf16 v[36:39], v[174:177], v[84:87], 0
ds_read_b128 v[92:95], v201
s_waitcnt lgkmcnt(0)
v_mfma_f32_16x16x32_bf16 v[48:51], v[174:177], v[92:95], 0
ds_read_b128 v[100:103], v202
s_waitcnt lgkmcnt(0)
v_mfma_f32_16x16x32_bf16 v[60:63], v[174:177], v[100:103], 0
ds_read_b128 v[178:181], v217 offset:528
ds_read_b128 v[84:87], v194
ds_read_b128 v[88:91], v194 offset:16
s_waitcnt lgkmcnt(0)
v_smfmac_f32_16x16x64_bf16 v[36:39], v[178:181], v[84:91], v213
ds_read_b128 v[92:95], v195
ds_read_b128 v[96:99], v195 offset:16
s_waitcnt lgkmcnt(0)
v_smfmac_f32_16x16x64_bf16 v[48:51], v[178:181], v[92:99], v213
ds_read_b128 v[100:103], v196
ds_read_b128 v[104:107], v196 offset:16
s_waitcnt lgkmcnt(0)
v_smfmac_f32_16x16x64_bf16 v[60:63], v[178:181], v[100:107], v213
ds_read_b128 v[174:177], v217 offset:1056
ds_read_b128 v[84:87], v197
ds_read_b128 v[88:91], v197 offset:16
s_waitcnt lgkmcnt(0)
v_smfmac_f32_16x16x64_bf16 v[36:39], v[174:177], v[84:91], v213
ds_read_b128 v[92:95], v198
ds_read_b128 v[96:99], v198 offset:16
s_waitcnt lgkmcnt(0)
v_smfmac_f32_16x16x64_bf16 v[48:51], v[174:177], v[92:99], v213
ds_read_b128 v[100:103], v199
ds_read_b128 v[104:107], v199 offset:16
s_waitcnt lgkmcnt(0)
v_smfmac_f32_16x16x64_bf16 v[60:63], v[174:177], v[100:107], v213
ds_read_b128 v[178:181], v217 offset:1584
ds_read_b128 v[84:87], v200 offset:32
s_waitcnt lgkmcnt(0)
v_mfma_f32_16x16x32_bf16 v[40:43], v[178:181], v[84:87], 0
ds_read_b128 v[92:95], v201 offset:32
s_waitcnt lgkmcnt(0)
v_mfma_f32_16x16x32_bf16 v[52:55], v[178:181], v[92:95], 0
ds_read_b128 v[100:103], v202 offset:32
s_waitcnt lgkmcnt(0)
v_mfma_f32_16x16x32_bf16 v[64:67], v[178:181], v[100:103], 0
ds_read_b128 v[174:177], v217 offset:2112
ds_read_b128 v[84:87], v194 offset:32
ds_read_b128 v[88:91], v194 offset:48
s_waitcnt lgkmcnt(0)
v_smfmac_f32_16x16x64_bf16 v[40:43], v[174:177], v[84:91], v213
ds_read_b128 v[92:95], v195 offset:32
ds_read_b128 v[96:99], v195 offset:48
s_waitcnt lgkmcnt(0)
v_smfmac_f32_16x16x64_bf16 v[52:55], v[174:177], v[92:99], v213
ds_read_b128 v[100:103], v196 offset:32
ds_read_b128 v[104:107], v196 offset:48
s_waitcnt lgkmcnt(0)
v_smfmac_f32_16x16x64_bf16 v[64:67], v[174:177], v[100:107], v213
ds_read_b128 v[178:181], v217 offset:2640
ds_read_b128 v[84:87], v197 offset:32
ds_read_b128 v[88:91], v197 offset:48
s_waitcnt lgkmcnt(0)
v_smfmac_f32_16x16x64_bf16 v[40:43], v[178:181], v[84:91], v213
ds_read_b128 v[92:95], v198 offset:32
ds_read_b128 v[96:99], v198 offset:48
s_waitcnt lgkmcnt(0)
v_smfmac_f32_16x16x64_bf16 v[52:55], v[178:181], v[92:99], v213
ds_read_b128 v[100:103], v199 offset:32
ds_read_b128 v[104:107], v199 offset:48
s_waitcnt lgkmcnt(0)
v_smfmac_f32_16x16x64_bf16 v[64:67], v[178:181], v[100:107], v213
ds_read_b128 v[174:177], v217 offset:3168
ds_read_b128 v[84:87], v200 offset:64
s_waitcnt lgkmcnt(0)
v_mfma_f32_16x16x32_bf16 v[44:47], v[174:177], v[84:87], 0
ds_read_b128 v[92:95], v201 offset:64
s_waitcnt lgkmcnt(0)
v_mfma_f32_16x16x32_bf16 v[56:59], v[174:177], v[92:95], 0
ds_read_b128 v[100:103], v202 offset:64
s_waitcnt lgkmcnt(0)
v_mfma_f32_16x16x32_bf16 v[68:71], v[174:177], v[100:103], 0
ds_read_b128 v[178:181], v217 offset:3696
ds_read_b128 v[84:87], v194 offset:64
ds_read_b128 v[88:91], v194 offset:80
s_waitcnt lgkmcnt(0)
v_smfmac_f32_16x16x64_bf16 v[44:47], v[178:181], v[84:91], v213
ds_read_b128 v[92:95], v195 offset:64
ds_read_b128 v[96:99], v195 offset:80
s_waitcnt lgkmcnt(0)
v_smfmac_f32_16x16x64_bf16 v[56:59], v[178:181], v[92:99], v213
ds_read_b128 v[100:103], v196 offset:64
ds_read_b128 v[104:107], v196 offset:80
s_waitcnt lgkmcnt(0)
v_smfmac_f32_16x16x64_bf16 v[68:71], v[178:181], v[100:107], v213
ds_read_b128 v[174:177], v217 offset:4224
ds_read_b128 v[84:87], v197 offset:64
ds_read_b128 v[88:91], v197 offset:80
s_waitcnt lgkmcnt(0)
v_smfmac_f32_16x16x64_bf16 v[44:47], v[174:177], v[84:91], v213
ds_read_b128 v[92:95], v198 offset:64
ds_read_b128 v[96:99], v198 offset:80
s_waitcnt lgkmcnt(0)
v_smfmac_f32_16x16x64_bf16 v[56:59], v[174:177], v[92:99], v213
ds_read_b128 v[100:103], v199 offset:64
ds_read_b128 v[104:107], v199 offset:80
s_waitcnt lgkmcnt(0)
v_smfmac_f32_16x16x64_bf16 v[68:71], v[174:177], v[100:107], v213
v_add_f32 v118, v36, v37
v_mul_f32 v119, v36, v36
v_add_f32 v118, v118, v38
v_fmac_f32 v119, v37, v37
v_add_f32 v118, v118, v39
v_fmac_f32 v119, v38, v38
v_fmac_f32 v119, v39, v39
v_add_f32 v126, v48, v49
v_mul_f32 v127, v48, v48
v_add_f32 v126, v126, v50
v_fmac_f32 v127, v49, v49
v_add_f32 v126, v126, v51
v_fmac_f32 v127, v50, v50
v_fmac_f32 v127, v51, v51
v_add_f32 v134, v60, v61
v_mul_f32 v135, v60, v60
v_add_f32 v134, v134, v62
v_fmac_f32 v135, v61, v61
v_add_f32 v134, v134, v63
v_fmac_f32 v135, v62, v62
v_fmac_f32 v135, v63, v63
v_add_f32 v118, v118, v40
v_fmac_f32 v119, v40, v40
v_add_f32 v118, v118, v41
v_fmac_f32 v119, v41, v41
v_add_f32 v118, v118, v42
v_fmac_f32 v119, v42, v42
v_add_f32 v118, v118, v43
v_fmac_f32 v119, v43, v43
v_add_f32 v126, v126, v52
v_fmac_f32 v127, v52, v52
v_add_f32 v126, v126, v53
v_fmac_f32 v127, v53, v53
v_add_f32 v126, v126, v54
v_fmac_f32 v127, v54, v54
v_add_f32 v126, v126, v55
v_fmac_f32 v127, v55, v55
v_add_f32 v134, v134, v64
v_fmac_f32 v135, v64, v64
v_add_f32 v134, v134, v65
v_fmac_f32 v135, v65, v65
v_add_f32 v134, v134, v66
v_fmac_f32 v135, v66, v66
v_add_f32 v134, v134, v67
v_fmac_f32 v135, v67, v67
v_add_f32 v118, v118, v44
v_fmac_f32 v119, v44, v44
v_add_f32 v118, v118, v45
v_fmac_f32 v119, v45, v45
v_add_f32 v118, v118, v46
v_fmac_f32 v119, v46, v46
v_add_f32 v118, v118, v47
v_fmac_f32 v119, v47, v47
v_add_f32 v126, v126, v56
v_fmac_f32 v127, v56, v56
v_add_f32 v126, v126, v57
v_fmac_f32 v127, v57, v57
v_add_f32 v126, v126, v58
v_fmac_f32 v127, v58, v58
v_add_f32 v126, v126, v59
v_fmac_f32 v127, v59, v59
v_add_f32 v134, v134, v68
v_fmac_f32 v135, v68, v68
v_add_f32 v134, v134, v69
v_fmac_f32 v135, v69, v69
v_add_f32 v134, v134, v70
v_fmac_f32 v135, v70, v70
v_add_f32 v134, v134, v71
v_fmac_f32 v135, v71, v71
v_permlane16_swap_b32 v118, v119
v_add_f32 v118, v118, v119
v_permlane16_swap_b32 v126, v127
v_add_f32 v126, v126, v127
v_permlane16_swap_b32 v134, v135
v_add_f32 v134, v134, v135
v_permlane32_swap_b32 v118, v126
v_add_f32 v118, v118, v126
ds_write_b32 v209, v118
v_mov_b32 v135, v134
s_nop 1
v_permlane32_swap_b32 v134, v135
v_add_f32 v134, v134, v135
ds_write_b32 v209, v134 offset:512
s_waitcnt lgkmcnt(0)
s_barrier
s_mul_hi_u32 s41, s35, 58835169
s_mul_i32 s42, s41, 73
s_sub_u32 s42, s35, s42
s_mul_i32 s43, s41, 1373568
s_mul_i32 s51, s42, 2688
s_add_u32 s43, s43, s51
s_cmp_lt_u32 s35, s34
s_cselect_b32 s50, s43, 1879048192
s_add_u32 s35, s35, 32
s_cmp_eq_u32 s42, 0
s_cselect_b32 s44, 536870911, s72
s_cmp_eq_u32 s42, 72
s_cselect_b32 s44, 939524095, s44
s_cmp_eq_u32 s41, 0
s_cselect_b32 s52, 1879048192, s50
s_mov_b32 s36, s50
v_and_b32 v180, s44, v208
s_add_u32 m0, s45, 0
s_nop 0
buffer_load_dwordx4 v180, s[4:7], s52 offen nt lds
s_add_u32 m0, s45, 4112
s_add_u32 s40, s36, 196224
buffer_load_dwordx4 v180, s[4:7], s40 offen nt lds
s_add_u32 m0, s45, 8224
s_add_u32 s40, s36, 392448
buffer_load_dwordx4 v180, s[4:7], s40 offen nt lds
s_add_u32 m0, s45, 12336
s_add_u32 s40, s36, 588672
buffer_load_dwordx4 v180, s[4:7], s40 offen nt lds
s_add_u32 m0, s45, 16448
s_add_u32 s40, s36, 784896
buffer_load_dwordx4 v180, s[4:7], s40 offen nt lds
s_add_u32 m0, s45, 20560
s_add_u32 s40, s36, 981120
buffer_load_dwordx4 v180, s[4:7], s40 offen nt lds
s_add_u32 m0, s45, 24672
s_add_u32 s40, s36, 1177344
buffer_load_dwordx4 v180, s[4:7], s40 offen nt lds
s_add_u32 m0, s45, 28784
s_add_u32 s40, s36, 1373568
buffer_load_dwordx4 v180, s[4:7], s40 offen nt lds
s_add_u32 m0, s45, 32896
s_add_u32 s40, s36, 1569792
buffer_load_dwordx4 v180, s[4:7], s40 offen nt lds
ds_read_b128 v[102:105], v210 offset:18432
ds_read_b128 v[106:109], v210 offset:19456
s_waitcnt lgkmcnt(1)
v_add_f32 v102, v102, v103
s_waitcnt lgkmcnt(0)
v_add_f32 v106, v106, v107
v_add_f32 v104, v104, v105
v_add_f32 v108, v108, v109
v_add_f32 v102, v102, v104
v_add_f32 v106, v106, v108
v_mul_f32 v103, s48, v102
v_mul_f32 v104, s73, v102
v_mul_f32 v106, s73, v106
v_fma_f32 v106, -v103, v104, v106
v_max_f32 v106, 0, v106
v_add_f32 v106, s49, v106
v_rsq_f32 v102, v106
s_nop 0
v_mul_f32_e64 v103, -v103, v102
ds_write_b64 v211, v[102:103] offset:20480
ds_read_b64 v[118:119], v219 offset:20480
ds_read_b64 v[126:127], v219 offset:20736
ds_read_b64 v[134:135], v219 offset:20992
s_waitcnt lgkmcnt(2)
v_fma_f32 v220, v36, v118, v119
v_fma_f32 v221, v37, v118, v119
v_cvt_pk_bf16_f32 v90, v220, v221
v_fma_f32 v222, v38, v118, v119
v_fma_f32 v223, v39, v118, v119
v_cvt_pk_bf16_f32 v91, v222, v223
v_fma_f32 v220, v40, v118, v119
v_fma_f32 v221, v41, v118, v119
v_cvt_pk_bf16_f32 v92, v220, v221
v_fma_f32 v222, v42, v118, v119
v_fma_f32 v223, v43, v118, v119
v_cvt_pk_bf16_f32 v93, v222, v223
ds_write_b128 v211, v[90:93] offset:20480
v_fma_f32 v220, v44, v118, v119
v_fma_f32 v221, v45, v118, v119
v_cvt_pk_bf16_f32 v94, v220, v221
v_fma_f32 v222, v46, v118, v119
v_fma_f32 v223, v47, v118, v119
v_cvt_pk_bf16_f32 v95, v222, v223
s_waitcnt lgkmcnt(2)
ds_write_b64 v212, v[94:95] offset:20480
v_fma_f32 v220, v48, v126, v127
v_fma_f32 v221, v49, v126, v127
v_cvt_pk_bf16_f32 v174, v220, v221
v_fma_f32 v222, v50, v126, v127
v_fma_f32 v223, v51, v126, v127
v_cvt_pk_bf16_f32 v175, v222, v223
v_fma_f32 v220, v52, v126, v127
v_fma_f32 v221, v53, v126, v127
v_cvt_pk_bf16_f32 v176, v220, v221
v_fma_f32 v222, v54, v126, v127
v_fma_f32 v223, v55, v126, v127
v_cvt_pk_bf16_f32 v177, v222, v223
ds_write_b128 v211, v[174:177] offset:26624
v_fma_f32 v220, v56, v126, v127
v_fma_f32 v221, v57, v126, v127
v_cvt_pk_bf16_f32 v178, v220, v221
v_fma_f32 v222, v58, v126, v127
v_fma_f32 v223, v59, v126, v127
v_cvt_pk_bf16_f32 v179, v222, v223
s_waitcnt lgkmcnt(3)
ds_write_b64 v212, v[178:179] offset:26624
v_fma_f32 v220, v60, v134, v135
v_fma_f32 v221, v61, v134, v135
v_cvt_pk_bf16_f32 v90, v220, v221
v_fma_f32 v222, v62, v134, v135
v_fma_f32 v223, v63, v134, v135
v_cvt_pk_bf16_f32 v91, v222, v223
v_fma_f32 v220, v64, v134, v135
v_fma_f32 v221, v65, v134, v135
v_cvt_pk_bf16_f32 v92, v220, v221
v_fma_f32 v222, v66, v134, v135
v_fma_f32 v223, v67, v134, v135
v_cvt_pk_bf16_f32 v93, v222, v223
ds_write_b128 v211, v[90:93] offset:32768
v_fma_f32 v220, v68, v134, v135
v_fma_f32 v221, v69, v134, v135
v_cvt_pk_bf16_f32 v94, v220, v221
v_fma_f32 v222, v70, v134, v135
v_fma_f32 v223, v71, v134, v135
v_cvt_pk_bf16_f32 v95, v222, v223
ds_write_b64 v212, v[94:95] offset:32768
ds_read_b128 v[182:185], v210
s_waitcnt lgkmcnt(0)
v_mfma_f32_16x16x32_bf16 v[138:141], a[0:3], v[182:185], 0
v_mfma_f32_16x16x32_bf16 v[142:145], a[24:27], v[182:185], 0
v_mfma_f32_16x16x32_bf16 v[146:149], a[48:51], v[182:185], 0
v_mfma_f32_16x16x32_bf16 v[150:153], a[216:219], v[182:185], 0
v_mfma_f32_16x16x32_bf16 v[154:157], a[240:243], v[182:185], 0
v_mfma_f32_16x16x32_bf16 v[158:161], v[232:235], v[182:185], 0
v_mfma_f32_16x16x32_bf16 v[162:165], v[182:185], a[72:75], 0
v_mfma_f32_16x16x32_bf16 v[166:169], v[182:185], a[96:99], 0
v_mfma_f32_16x16x32_bf16 v[170:173], v[182:185], a[120:123], 0
ds_read_b128 v[186:189], v210 offset:1024
s_waitcnt lgkmcnt(0)
v_mfma_f32_16x16x32_bf16 v[138:141], a[4:7], v[186:189], v[138:141]
v_mfma_f32_16x16x32_bf16 v[142:145], a[28:31], v[186:189], v[142:145]
v_mfma_f32_16x16x32_bf16 v[146:149], a[52:55], v[186:189], v[146:149]
v_mfma_f32_16x16x32_bf16 v[150:153], a[220:223], v[186:189], v[150:153]
v_mfma_f32_16x16x32_bf16 v[154:157], a[244:247], v[186:189], v[154:157]
v_mfma_f32_16x16x32_bf16 v[158:161], v[236:239], v[186:189], v[158:161]
v_mfma_f32_16x16x32_bf16 v[162:165], v[186:189], a[76:79], v[162:165]
v_mfma_f32_16x16x32_bf16 v[166:169], v[186:189], a[100:103], v[166:169]
v_mfma_f32_16x16x32_bf16 v[170:173], v[186:189], a[124:127], v[170:173]
ds_read_b128 v[182:185], v210 offset:2048
s_waitcnt lgkmcnt(0)
v_mfma_f32_16x16x32_bf16 v[138:141], a[8:11], v[182:185], v[138:141]
v_mfma_f32_16x16x32_bf16 v[142:145], a[32:35], v[182:185], v[142:145]
v_mfma_f32_16x16x32_bf16 v[146:149], a[56:59], v[182:185], v[146:149]
v_mfma_f32_16x16x32_bf16 v[150:153], a[224:227], v[182:185], v[150:153]
v_mfma_f32_16x16x32_bf16 v[154:157], a[248:251], v[182:185], v[154:157]
v_mfma_f32_16x16x32_bf16 v[158:161], v[240:243], v[182:185], v[158:161]
v_mfma_f32_16x16x32_bf16 v[162:165], v[182:185], a[80:83], v[162:165]
v_mfma_f32_16x16x32_bf16 v[166:169], v[182:185], a[104:107], v[166:169]
v_mfma_f32_16x16x32_bf16 v[170:173], v[182:185], a[128:131], v[170:173]
ds_read_b128 v[186:189], v210 offset:3072
s_waitcnt lgkmcnt(0)
v_mfma_f32_16x16x32_bf16 v[138:141], a[12:15], v[186:189], v[138:141]
v_mfma_f32_16x16x32_bf16 v[142:145], a[36:39], v[186:189], v[142:145]
v_mfma_f32_16x16x32_bf16 v[146:149], a[60:63], v[186:189], v[146:149]
v_mfma_f32_16x16x32_bf16 v[150:153], a[228:231], v[186:189], v[150:153]
v_mfma_f32_16x16x32_bf16 v[154:157], a[252:255], v[186:189], v[154:157]
v_mfma_f32_16x16x32_bf16 v[158:161], v[244:247], v[186:189], v[158:161]
v_mfma_f32_16x16x32_bf16 v[162:165], v[186:189], a[84:87], v[162:165]
v_mfma_f32_16x16x32_bf16 v[166:169], v[186:189], a[108:111], v[166:169]
v_mfma_f32_16x16x32_bf16 v[170:173], v[186:189], a[132:135], v[170:173]
ds_read_b128 v[182:185], v210 offset:4096
s_waitcnt lgkmcnt(0)
v_mfma_f32_16x16x32_bf16 v[138:141], a[16:19], v[182:185], v[138:141]
v_mfma_f32_16x16x32_bf16 v[142:145], a[40:43], v[182:185], v[142:145]
v_mfma_f32_16x16x32_bf16 v[146:149], a[64:67], v[182:185], v[146:149]
v_mfma_f32_16x16x32_bf16 v[150:153], a[232:235], v[182:185], v[150:153]
v_mfma_f32_16x16x32_bf16 v[154:157], v[224:227], v[182:185], v[154:157]
v_mfma_f32_16x16x32_bf16 v[158:161], v[248:251], v[182:185], v[158:161]
v_mfma_f32_16x16x32_bf16 v[162:165], v[182:185], a[88:91], v[162:165]
v_mfma_f32_16x16x32_bf16 v[166:169], v[182:185], a[112:115], v[166:169]
v_mfma_f32_16x16x32_bf16 v[170:173], v[182:185], a[136:139], v[170:173]
ds_read_b128 v[186:189], v210 offset:5120
s_waitcnt lgkmcnt(0)
v_mfma_f32_16x16x32_bf16 v[138:141], a[20:23], v[186:189], v[138:141]
v_mfma_f32_16x16x32_bf16 v[142:145], a[44:47], v[186:189], v[142:145]
v_mfma_f32_16x16x32_bf16 v[146:149], a[68:71], v[186:189], v[146:149]
v_mfma_f32_16x16x32_bf16 v[150:153], a[236:239], v[186:189], v[150:153]
v_mfma_f32_16x16x32_bf16 v[154:157], v[228:231], v[186:189], v[154:157]
v_mfma_f32_16x16x32_bf16 v[158:161], v[252:255], v[186:189], v[158:161]
v_mfma_f32_16x16x32_bf16 v[162:165], v[186:189], a[92:95], v[162:165]
v_mfma_f32_16x16x32_bf16 v[166:169], v[186:189], a[116:119], v[166:169]
v_mfma_f32_16x16x32_bf16 v[170:173], v[186:189], a[140:143], v[170:173]
v_cvt_pk_bf16_f32 v78, v138, v139
v_cvt_pk_bf16_f32 v79, v140, v141
v_cvt_pk_bf16_f32 v80, v142, v143
v_cvt_pk_bf16_f32 v81, v144, v145
v_cvt_pk_bf16_f32 v82, v146, v147
v_cvt_pk_bf16_f32 v83, v148, v149
v_cvt_pk_bf16_f32 v72, v150, v151
v_cvt_pk_bf16_f32 v73, v152, v153
v_cvt_pk_bf16_f32 v74, v154, v155
v_cvt_pk_bf16_f32 v75, v156, v157
v_cvt_pk_bf16_f32 v76, v158, v159
v_cvt_pk_bf16_f32 v77, v160, v161
v_cvt_pk_bf16_f32 v114, v162, v163
v_cvt_pk_bf16_f32 v115, v164, v165
v_cvt_pk_bf16_f32 v122, v166, v167
v_cvt_pk_bf16_f32 v123, v168, v169
v_cvt_pk_bf16_f32 v130, v170, v171
v_cvt_pk_bf16_f32 v131, v172, v173
ds_read_b128 v[182:185], v210 offset:6144
s_waitcnt lgkmcnt(0)
v_mfma_f32_16x16x32_bf16 v[138:141], a[0:3], v[182:185], 0
v_mfma_f32_16x16x32_bf16 v[142:145], a[24:27], v[182:185], 0
v_mfma_f32_16x16x32_bf16 v[146:149], a[48:51], v[182:185], 0
v_mfma_f32_16x16x32_bf16 v[150:153], a[216:219], v[182:185], 0
v_mfma_f32_16x16x32_bf16 v[154:157], a[240:243], v[182:185], 0
v_mfma_f32_16x16x32_bf16 v[158:161], v[232:235], v[182:185], 0
v_mfma_f32_16x16x32_bf16 v[162:165], v[182:185], a[72:75], 0
v_mfma_f32_16x16x32_bf16 v[166:169], v[182:185], a[96:99], 0
v_mfma_f32_16x16x32_bf16 v[170:173], v[182:185], a[120:123], 0
ds_read_b128 v[186:189], v210 offset:7168
s_waitcnt lgkmcnt(0)
v_mfma_f32_16x16x32_bf16 v[138:141], a[4:7], v[186:189], v[138:141]
v_mfma_f32_16x16x32_bf16 v[142:145], a[28:31], v[186:189], v[142:145]
v_mfma_f32_16x16x32_bf16 v[146:149], a[52:55], v[186:189], v[146:149]
v_mfma_f32_16x16x32_bf16 v[150:153], a[220:223], v[186:189], v[150:153]
v_mfma_f32_16x16x32_bf16 v[154:157], a[244:247], v[186:189], v[154:157]
v_mfma_f32_16x16x32_bf16 v[158:161], v[236:239], v[186:189], v[158:161]
v_mfma_f32_16x16x32_bf16 v[162:165], v[186:189], a[76:79], v[162:165]
v_mfma_f32_16x16x32_bf16 v[166:169], v[186:189], a[100:103], v[166:169]
v_mfma_f32_16x16x32_bf16 v[170:173], v[186:189], a[124:127], v[170:173]
ds_read_b128 v[182:185], v210 offset:8192
s_waitcnt lgkmcnt(0)
v_mfma_f32_16x16x32_bf16 v[138:141], a[8:11], v[182:185], v[138:141]
v_mfma_f32_16x16x32_bf16 v[142:145], a[32:35], v[182:185], v[142:145]
v_mfma_f32_16x16x32_bf16 v[146:149], a[56:59], v[182:185], v[146:149]
v_mfma_f32_16x16x32_bf16 v[150:153], a[224:227], v[182:185], v[150:153]
v_mfma_f32_16x16x32_bf16 v[154:157], a[248:251], v[182:185], v[154:157]
v_mfma_f32_16x16x32_bf16 v[158:161], v[240:243], v[182:185], v[158:161]
v_mfma_f32_16x16x32_bf16 v[162:165], v[182:185], a[80:83], v[162:165]
v_mfma_f32_16x16x32_bf16 v[166:169], v[182:185], a[104:107], v[166:169]
v_mfma_f32_16x16x32_bf16 v[170:173], v[182:185], a[128:131], v[170:173]
ds_read_b128 v[186:189], v210 offset:9216
s_waitcnt lgkmcnt(0)
v_mfma_f32_16x16x32_bf16 v[138:141], a[12:15], v[186:189], v[138:141]
v_mfma_f32_16x16x32_bf16 v[142:145], a[36:39], v[186:189], v[142:145]
v_mfma_f32_16x16x32_bf16 v[146:149], a[60:63], v[186:189], v[146:149]
v_mfma_f32_16x16x32_bf16 v[150:153], a[228:231], v[186:189], v[150:153]
v_mfma_f32_16x16x32_bf16 v[154:157], a[252:255], v[186:189], v[154:157]
v_mfma_f32_16x16x32_bf16 v[158:161], v[244:247], v[186:189], v[158:161]
v_mfma_f32_16x16x32_bf16 v[162:165], v[186:189], a[84:87], v[162:165]
v_mfma_f32_16x16x32_bf16 v[166:169], v[186:189], a[108:111], v[166:169]
v_mfma_f32_16x16x32_bf16 v[170:173], v[186:189], a[132:135], v[170:173]
ds_read_b128 v[182:185], v210 offset:10240
s_waitcnt lgkmcnt(0)
v_mfma_f32_16x16x32_bf16 v[138:141], a[16:19], v[182:185], v[138:141]
v_mfma_f32_16x16x32_bf16 v[142:145], a[40:43], v[182:185], v[142:145]
v_mfma_f32_16x16x32_bf16 v[146:149], a[64:67], v[182:185], v[146:149]
v_mfma_f32_16x16x32_bf16 v[150:153], a[232:235], v[182:185], v[150:153]
v_mfma_f32_16x16x32_bf16 v[154:157], v[224:227], v[182:185], v[154:157]
v_mfma_f32_16x16x32_bf16 v[158:161], v[248:251], v[182:185], v[158:161]
v_mfma_f32_16x16x32_bf16 v[162:165], v[182:185], a[88:91], v[162:165]
v_mfma_f32_16x16x32_bf16 v[166:169], v[182:185], a[112:115], v[166:169]
v_mfma_f32_16x16x32_bf16 v[170:173], v[182:185], a[136:139], v[170:173]
ds_read_b128 v[186:189], v210 offset:11264
s_waitcnt lgkmcnt(0)
v_mfma_f32_16x16x32_bf16 v[138:141], a[20:23], v[186:189], v[138:141]
v_mfma_f32_16x16x32_bf16 v[142:145], a[44:47], v[186:189], v[142:145]
v_mfma_f32_16x16x32_bf16 v[146:149], a[68:71], v[186:189], v[146:149]
v_mfma_f32_16x16x32_bf16 v[150:153], a[236:239], v[186:189], v[150:153]
v_mfma_f32_16x16x32_bf16 v[154:157], v[228:231], v[186:189], v[154:157]
v_mfma_f32_16x16x32_bf16 v[158:161], v[252:255], v[186:189], v[158:161]
v_mfma_f32_16x16x32_bf16 v[162:165], v[186:189], a[92:95], v[162:165]
v_mfma_f32_16x16x32_bf16 v[166:169], v[186:189], a[116:119], v[166:169]
v_mfma_f32_16x16x32_bf16 v[170:173], v[186:189], a[140:143], v[170:173]
v_cvt_pk_bf16_f32 v96, v138, v139
v_cvt_pk_bf16_f32 v97, v140, v141
v_cvt_pk_bf16_f32 v98, v142, v143
v_cvt_pk_bf16_f32 v99, v144, v145
v_cvt_pk_bf16_f32 v100, v146, v147
v_cvt_pk_bf16_f32 v101, v148, v149
v_cvt_pk_bf16_f32 v84, v150, v151
v_cvt_pk_bf16_f32 v85, v152, v153
v_cvt_pk_bf16_f32 v86, v154, v155
v_cvt_pk_bf16_f32 v87, v156, v157
v_cvt_pk_bf16_f32 v88, v158, v159
v_cvt_pk_bf16_f32 v89, v160, v161
v_cvt_pk_bf16_f32 v116, v162, v163
v_cvt_pk_bf16_f32 v117, v164, v165
v_cvt_pk_bf16_f32 v124, v166, v167
v_cvt_pk_bf16_f32 v125, v168, v169
v_cvt_pk_bf16_f32 v132, v170, v171
v_cvt_pk_bf16_f32 v133, v172, v173
ds_read_b128 v[182:185], v210 offset:12288
s_waitcnt lgkmcnt(0)
v_mfma_f32_16x16x32_bf16 v[138:141], a[0:3], v[182:185], 0
v_mfma_f32_16x16x32_bf16 v[142:145], a[24:27], v[182:185], 0
v_mfma_f32_16x16x32_bf16 v[146:149], a[48:51], v[182:185], 0
ds_read_b128 v[186:189], v210 offset:13312
s_waitcnt lgkmcnt(0)
v_mfma_f32_16x16x32_bf16 v[138:141], a[4:7], v[186:189], v[138:141]
v_mfma_f32_16x16x32_bf16 v[142:145], a[28:31], v[186:189], v[142:145]
v_mfma_f32_16x16x32_bf16 v[146:149], a[52:55], v[186:189], v[146:149]
ds_read_b128 v[182:185], v210 offset:14336
s_waitcnt lgkmcnt(0)
v_mfma_f32_16x16x32_bf16 v[138:141], a[8:11], v[182:185], v[138:141]
v_mfma_f32_16x16x32_bf16 v[142:145], a[32:35], v[182:185], v[142:145]
v_mfma_f32_16x16x32_bf16 v[146:149], a[56:59], v[182:185], v[146:149]
ds_read_b128 v[186:189], v210 offset:15360
s_waitcnt lgkmcnt(0)
v_mfma_f32_16x16x32_bf16 v[138:141], a[12:15], v[186:189], v[138:141]
v_mfma_f32_16x16x32_bf16 v[142:145], a[36:39], v[186:189], v[142:145]
v_mfma_f32_16x16x32_bf16 v[146:149], a[60:63], v[186:189], v[146:149]
ds_read_b128 v[182:185], v210 offset:16384
s_waitcnt lgkmcnt(0)
v_mfma_f32_16x16x32_bf16 v[138:141], a[16:19], v[182:185], v[138:141]
v_mfma_f32_16x16x32_bf16 v[142:145], a[40:43], v[182:185], v[142:145]
v_mfma_f32_16x16x32_bf16 v[146:149], a[64:67], v[182:185], v[146:149]
ds_read_b128 v[186:189], v210 offset:17408
s_waitcnt lgkmcnt(0)
v_mfma_f32_16x16x32_bf16 v[138:141], a[20:23], v[186:189], v[138:141]
v_mfma_f32_16x16x32_bf16 v[142:145], a[44:47], v[186:189], v[142:145]
v_mfma_f32_16x16x32_bf16 v[146:149], a[68:71], v[186:189], v[146:149]
v_cvt_pk_bf16_f32 v102, v138, v139
v_cvt_pk_bf16_f32 v103, v140, v141
s_nop 0
v_cvt_pk_bf16_f32 v104, v142, v143
v_cvt_pk_bf16_f32 v105, v144, v145
s_nop 1
v_cvt_pk_bf16_f32 v106, v146, v147
v_cvt_pk_bf16_f32 v107, v148, v149
ds_read_b128 v[108:111], v215 offset:512
ds_read_b64 v[112:113], v215 offset:528
v_mov_b32 v181, 0
v_mfma_f32_16x16x16_bf16 v[138:141], v[82:83], v[76:77], 0
v_mfma_f32_16x16x16_bf16 v[142:145], v[100:101], v[76:77], 0
s_waitcnt lgkmcnt(0)
v_mfma_f32_16x16x16_bf16 v[150:153], v[112:113], v[76:77], v[206:209]
v_mfma_f32_16x16x16_bf16 v[146:149], v[106:107], v[76:77], 0
v_mfma_f32_16x16x32_bf16 v[138:141], v[78:81], v[72:75], v[138:141]
v_mfma_f32_16x16x32_bf16 v[142:145], v[96:99], v[72:75], v[142:145]
v_mfma_f32_16x16x32_bf16 v[150:153], v[108:111], v[72:75], v[150:153]
v_mfma_f32_16x16x32_bf16 v[146:149], v[102:105], v[72:75], v[146:149]
ds_read_b128 v[72:75], v215
ds_read_b64 v[76:77], v215 offset:16
v_mfma_f32_16x16x16_bf16 v[154:157], v[82:83], v[88:89], 0
v_mfma_f32_16x16x16_bf16 v[158:161], v[100:101], v[88:89], 0
v_mfma_f32_16x16x16_bf16 v[166:169], v[112:113], v[88:89], v[206:209]
v_mfma_f32_16x16x16_bf16 v[162:165], v[106:107], v[88:89], 0
v_mfma_f32_16x16x32_bf16 v[154:157], v[78:81], v[84:87], v[154:157]
v_mfma_f32_16x16x32_bf16 v[158:161], v[96:99], v[84:87], v[158:161]
v_mfma_f32_16x16x32_bf16 v[166:169], v[108:111], v[84:87], v[166:169]
v_mfma_f32_16x16x32_bf16 v[162:165], v[102:105], v[84:87], v[162:165]
ds_read_b128 v[182:185], v210 offset:12288
s_waitcnt lgkmcnt(0)
v_mfma_f32_16x16x32_bf16 v[118:121], v[182:185], a[72:75], 0
v_mfma_f32_16x16x32_bf16 v[126:129], v[182:185], a[96:99], 0
v_mfma_f32_16x16x32_bf16 v[134:137], v[182:185], a[120:123], 0
v_mfma_f32_16x16x32_bf16 v[90:93], a[216:219], v[182:185], 0
v_mfma_f32_16x16x32_bf16 v[170:173], a[240:243], v[182:185], 0
v_mfma_f32_16x16x32_bf16 v[220:223], v[232:235], v[182:185], 0
ds_read_b128 v[186:189], v210 offset:13312
s_waitcnt lgkmcnt(0)
v_mfma_f32_16x16x32_bf16 v[118:121], v[186:189], a[76:79], v[118:121]
v_mfma_f32_16x16x32_bf16 v[126:129], v[186:189], a[100:103], v[126:129]
v_mfma_f32_16x16x32_bf16 v[134:137], v[186:189], a[124:127], v[134:137]
v_mfma_f32_16x16x32_bf16 v[90:93], a[220:223], v[186:189], v[90:93]
v_mfma_f32_16x16x32_bf16 v[170:173], a[244:247], v[186:189], v[170:173]
v_mfma_f32_16x16x32_bf16 v[220:223], v[236:239], v[186:189], v[220:223]
ds_read_b128 v[182:185], v210 offset:14336
s_waitcnt lgkmcnt(0)
v_mfma_f32_16x16x32_bf16 v[118:121], v[182:185], a[80:83], v[118:121]
v_mfma_f32_16x16x32_bf16 v[126:129], v[182:185], a[104:107], v[126:129]
v_mfma_f32_16x16x32_bf16 v[134:137], v[182:185], a[128:131], v[134:137]
v_mfma_f32_16x16x32_bf16 v[90:93], a[224:227], v[182:185], v[90:93]
v_mfma_f32_16x16x32_bf16 v[170:173], a[248:251], v[182:185], v[170:173]
v_mfma_f32_16x16x32_bf16 v[220:223], v[240:243], v[182:185], v[220:223]
ds_read_b128 v[186:189], v210 offset:15360
s_waitcnt lgkmcnt(0)
v_mfma_f32_16x16x32_bf16 v[118:121], v[186:189], a[84:87], v[118:121]
v_mfma_f32_16x16x32_bf16 v[126:129], v[186:189], a[108:111], v[126:129]
v_mfma_f32_16x16x32_bf16 v[134:137], v[186:189], a[132:135], v[134:137]
v_mfma_f32_16x16x32_bf16 v[90:93], a[228:231], v[186:189], v[90:93]
v_mfma_f32_16x16x32_bf16 v[170:173], a[252:255], v[186:189], v[170:173]
v_mfma_f32_16x16x32_bf16 v[220:223], v[244:247], v[186:189], v[220:223]
ds_read_b128 v[182:185], v210 offset:16384
s_waitcnt lgkmcnt(0)
v_mfma_f32_16x16x32_bf16 v[118:121], v[182:185], a[88:91], v[118:121]
v_mfma_f32_16x16x32_bf16 v[126:129], v[182:185], a[112:115], v[126:129]
v_mfma_f32_16x16x32_bf16 v[134:137], v[182:185], a[136:139], v[134:137]
v_mfma_f32_16x16x32_bf16 v[90:93], a[232:235], v[182:185], v[90:93]
v_mfma_f32_16x16x32_bf16 v[170:173], v[224:227], v[182:185], v[170:173]
v_mfma_f32_16x16x32_bf16 v[220:223], v[248:251], v[182:185], v[220:223]
ds_read_b128 v[186:189], v210 offset:17408
s_waitcnt lgkmcnt(0)
v_mfma_f32_16x16x32_bf16 v[118:121], v[186:189], a[92:95], v[118:121]
v_mfma_f32_16x16x32_bf16 v[126:129], v[186:189], a[116:119], v[126:129]
v_mfma_f32_16x16x32_bf16 v[134:137], v[186:189], a[140:143], v[134:137]
v_mfma_f32_16x16x32_bf16 v[90:93], a[236:239], v[186:189], v[90:93]
v_mfma_f32_16x16x32_bf16 v[170:173], v[228:231], v[186:189], v[170:173]
v_mfma_f32_16x16x32_bf16 v[220:223], v[252:255], v[186:189], v[220:223]
v_cvt_pk_bf16_f32 v118, v118, v119
v_cvt_pk_bf16_f32 v119, v120, v121
ds_read_u16 v120, v214 offset:1024
v_mov_b32 v121, 0
v_cvt_pk_bf16_f32 v126, v126, v127
v_cvt_pk_bf16_f32 v127, v128, v129
ds_read_u16 v128, v214 offset:1032
v_mov_b32 v129, 0
v_cvt_pk_bf16_f32 v134, v134, v135
v_cvt_pk_bf16_f32 v135, v136, v137
ds_read_u16 v136, v214 offset:1040
v_mov_b32 v137, 0
v_cvt_pk_bf16_f32 v90, v90, v91
v_cvt_pk_bf16_f32 v91, v92, v93
v_cvt_pk_bf16_f32 v92, v170, v171
v_cvt_pk_bf16_f32 v93, v172, v173
v_cvt_pk_bf16_f32 v94, v220, v221
v_cvt_pk_bf16_f32 v95, v222, v223
v_max3_f32 v151, v138, v139, v140
v_max3_f32 v151, v151, v141, v142
v_max3_f32 v151, v151, v143, v144
v_max3_f32 v151, v151, v145, v146
v_max3_f32 v151, v151, v147, v148
v_max3_f32 v151, v151, v149, v150
v_mov_b32 v152, v151
s_nop 1
v_permlane16_swap_b32 v151, v152
v_max_f32 v151, v151, v152
v_mov_b32 v152, v151
s_nop 1
v_permlane32_swap_b32 v151, v152
v_max_f32 v151, v151, v152
v_sub_f32 v138, v138, v151
v_sub_f32 v139, v139, v151
v_sub_f32 v140, v140, v151
v_sub_f32 v141, v141, v151
v_sub_f32 v142, v142, v151
v_sub_f32 v143, v143, v151
v_sub_f32 v144, v144, v151
v_sub_f32 v145, v145, v151
v_sub_f32 v150, v150, v151
v_sub_f32 v146, v146, v151
v_sub_f32 v147, v147, v151
v_sub_f32 v148, v148, v151
v_sub_f32 v149, v149, v151
v_exp_f32 v138, v138
v_exp_f32 v139, v139
v_exp_f32 v140, v140
v_exp_f32 v141, v141
v_exp_f32 v142, v142
v_exp_f32 v143, v143
v_exp_f32 v144, v144
v_exp_f32 v145, v145
v_exp_f32 v150, v150
v_exp_f32 v146, v146
v_exp_f32 v147, v147
v_exp_f32 v148, v148
v_exp_f32 v149, v149
v_cvt_pk_bf16_f32 v174, v138, v139
v_cvt_pk_bf16_f32 v175, v140, v141
v_cvt_pk_bf16_f32 v176, v142, v143
v_cvt_pk_bf16_f32 v177, v144, v145
v_cvt_pk_bf16_f32 v178, v146, v147
v_cvt_pk_bf16_f32 v179, v148, v149
v_cvt_pk_bf16_f32 v180, v150, 0
v_mfma_f32_16x16x32_bf16 v[150:153], v[190:193], v[174:177], 0
v_mfma_f32_16x16x32_bf16 v[138:141], v[114:117], v[174:177], 0
v_mfma_f32_16x16x32_bf16 v[142:145], v[122:125], v[174:177], 0
v_mfma_f32_16x16x32_bf16 v[146:149], v[130:133], v[174:177], 0
v_mfma_f32_16x16x32_bf16 v[150:153], v[190:193], v[178:181], v[150:153]
s_waitcnt lgkmcnt(2)
v_mfma_f32_16x16x32_bf16 v[138:141], v[118:121], v[178:181], v[138:141]
s_waitcnt lgkmcnt(1)
v_mfma_f32_16x16x32_bf16 v[142:145], v[126:129], v[178:181], v[142:145]
s_waitcnt lgkmcnt(0)
v_mfma_f32_16x16x32_bf16 v[146:149], v[134:137], v[178:181], v[146:149]
v_max3_f32 v167, v154, v155, v156
v_max3_f32 v167, v167, v157, v158
v_max3_f32 v167, v167, v159, v160
v_max3_f32 v167, v167, v161, v162
v_max3_f32 v167, v167, v163, v164
v_max3_f32 v167, v167, v165, v166
v_mov_b32 v168, v167
s_nop 1
v_permlane16_swap_b32 v167, v168
v_max_f32 v167, v167, v168
v_mov_b32 v168, v167
s_nop 1
v_permlane32_swap_b32 v167, v168
v_max_f32 v167, v167, v168
v_sub_f32 v154, v154, v167
v_sub_f32 v155, v155, v167
v_sub_f32 v156, v156, v167
v_sub_f32 v157, v157, v167
v_sub_f32 v158, v158, v167
v_sub_f32 v159, v159, v167
v_sub_f32 v160, v160, v167
v_sub_f32 v161, v161, v167
v_sub_f32 v166, v166, v167
v_sub_f32 v162, v162, v167
v_sub_f32 v163, v163, v167
v_sub_f32 v164, v164, v167
v_sub_f32 v165, v165, v167
v_exp_f32 v154, v154
v_exp_f32 v155, v155
v_exp_f32 v156, v156
v_exp_f32 v157, v157
v_exp_f32 v158, v158
v_exp_f32 v159, v159
v_exp_f32 v160, v160
v_exp_f32 v161, v161
v_exp_f32 v166, v166
v_exp_f32 v162, v162
v_exp_f32 v163, v163
v_exp_f32 v164, v164
v_exp_f32 v165, v165
v_cvt_pk_bf16_f32 v174, v154, v155
v_cvt_pk_bf16_f32 v175, v156, v157
v_cvt_pk_bf16_f32 v176, v158, v159
v_cvt_pk_bf16_f32 v177, v160, v161
v_cvt_pk_bf16_f32 v178, v162, v163
v_cvt_pk_bf16_f32 v179, v164, v165
v_cvt_pk_bf16_f32 v180, v166, 0
v_mfma_f32_16x16x32_bf16 v[166:169], v[190:193], v[174:177], 0
v_mfma_f32_16x16x32_bf16 v[154:157], v[114:117], v[174:177], 0
v_mfma_f32_16x16x32_bf16 v[158:161], v[122:125], v[174:177], 0
v_mfma_f32_16x16x32_bf16 v[162:165], v[130:133], v[174:177], 0
v_mfma_f32_16x16x32_bf16 v[166:169], v[190:193], v[178:181], v[166:169]
v_mfma_f32_16x16x32_bf16 v[154:157], v[118:121], v[178:181], v[154:157]
v_mfma_f32_16x16x32_bf16 v[158:161], v[126:129], v[178:181], v[158:161]
v_mfma_f32_16x16x32_bf16 v[162:165], v[134:137], v[178:181], v[162:165]
v_rcp_f32 v151, v150
s_nop 0
v_mul_f32 v151, s3, v151
v_mul_f32 v138, v138, v151
v_mul_f32 v139, v139, v151
v_cvt_pk_bf16_f32 v138, v138, v139
v_mul_f32 v140, v140, v151
v_mul_f32 v141, v141, v151
v_cvt_pk_bf16_f32 v139, v140, v141
v_mul_f32 v142, v142, v151
v_mul_f32 v143, v143, v151
v_cvt_pk_bf16_f32 v140, v142, v143
v_mul_f32 v144, v144, v151
v_mul_f32 v145, v145, v151
v_cvt_pk_bf16_f32 v141, v144, v145
ds_write_b128 v211, v[138:141] offset:38912
v_mul_f32 v146, v146, v151
v_mul_f32 v147, v147, v151
v_cvt_pk_bf16_f32 v142, v146, v147
v_mul_f32 v148, v148, v151
v_mul_f32 v149, v149, v151
v_cvt_pk_bf16_f32 v143, v148, v149
ds_write_b64 v212, v[142:143] offset:38912
v_mfma_f32_16x16x32_bf16 v[138:141], v[78:81], v[90:93], 0
v_mfma_f32_16x16x32_bf16 v[142:145], v[96:99], v[90:93], 0
v_mfma_f32_16x16x32_bf16 v[150:153], v[108:111], v[90:93], v[206:209]
v_mfma_f32_16x16x32_bf16 v[146:149], v[102:105], v[90:93], 0
v_mfma_f32_16x16x16_bf16 v[138:141], v[82:83], v[94:95], v[138:141]
v_mfma_f32_16x16x16_bf16 v[142:145], v[100:101], v[94:95], v[142:145]
v_mfma_f32_16x16x16_bf16 v[150:153], v[112:113], v[94:95], v[150:153]
v_mfma_f32_16x16x16_bf16 v[146:149], v[106:107], v[94:95], v[146:149]
v_rcp_f32 v167, v166
s_nop 0
v_mul_f32 v167, s3, v167
v_mul_f32 v154, v154, v167
v_mul_f32 v155, v155, v167
v_cvt_pk_bf16_f32 v154, v154, v155
v_mul_f32 v156, v156, v167
v_mul_f32 v157, v157, v167
v_cvt_pk_bf16_f32 v155, v156, v157
v_mul_f32 v158, v158, v167
v_mul_f32 v159, v159, v167
v_cvt_pk_bf16_f32 v156, v158, v159
v_mul_f32 v160, v160, v167
v_mul_f32 v161, v161, v167
v_cvt_pk_bf16_f32 v157, v160, v161
ds_write_b128 v211, v[154:157] offset:45056
v_mul_f32 v162, v162, v167
v_mul_f32 v163, v163, v167
v_cvt_pk_bf16_f32 v158, v162, v163
v_mul_f32 v164, v164, v167
v_mul_f32 v165, v165, v167
v_cvt_pk_bf16_f32 v159, v164, v165
ds_write_b64 v212, v[158:159] offset:45056
v_mfma_f32_16x16x16_bf16 v[154:157], v[76:77], v[82:83], 0
v_mfma_f32_16x16x16_bf16 v[158:161], v[76:77], v[100:101], 0
v_mfma_f32_16x16x16_bf16 v[162:165], v[76:77], v[106:107], 0
v_mfma_f32_16x16x16_bf16 v[166:169], v[76:77], v[112:113], v[206:209]
v_mfma_f32_16x16x32_bf16 v[154:157], v[72:75], v[78:81], v[154:157]
v_mfma_f32_16x16x32_bf16 v[158:161], v[72:75], v[96:99], v[158:161]
v_mfma_f32_16x16x32_bf16 v[162:165], v[72:75], v[102:105], v[162:165]
v_mfma_f32_16x16x32_bf16 v[166:169], v[72:75], v[108:111], v[166:169]
v_mov_b32_dpp v154, v158 quad_perm:[0,1,2,3] row_mask:0x2 bank_mask:0xf
s_nop 1
v_mov_b32_dpp v154, v162 quad_perm:[0,1,2,3] row_mask:0x4 bank_mask:0xf
s_nop 2
v_mov_b32_dpp v154, v167 quad_perm:[0,1,2,3] row_mask:0x8 bank_mask:0xf
v_mov_b32 v155, v154
s_nop 1
v_max_f32_dpp v155, v155, v155 row_ror:8 row_mask:0xf bank_mask:0xf
s_nop 1
v_max_f32_dpp v155, v155, v155 row_ror:4 row_mask:0xf bank_mask:0xf
s_nop 1
v_max_f32_dpp v155, v155, v155 row_ror:2 row_mask:0xf bank_mask:0xf
s_nop 1
v_max_f32_dpp v155, v155, v155 row_ror:1 row_mask:0xf bank_mask:0xf
v_mov_b32 v156, v155
s_nop 1
v_permlane16_swap_b32 v155, v156
v_max_f32 v155, v155, v156
v_mov_b32 v156, v155
s_nop 1
v_permlane32_swap_b32 v155, v156
v_max_f32 v155, v155, v156
v_sub_f32 v154, v154, v155
v_exp_f32 v154, v154
s_nop 0
v_cvt_pk_bf16_f32 v154, v154, 0
ds_write_b16 v214, v154
s_waitcnt lgkmcnt(1)
ds_read_b128 v[84:87], v215
ds_read_b128 v[88:91], v215 offset:16
v_add_u32 v215, 1552, v215
s_barrier
ds_read_b128 v[170:173], v210 offset:38912
s_waitcnt lgkmcnt(0)
v_mfma_f32_16x16x32_bf16 v[0:3], a[144:147], v[170:173], v[0:3]
v_mfma_f32_16x16x32_bf16 v[4:7], a[168:171], v[170:173], v[4:7]
v_mfma_f32_16x16x32_bf16 v[8:11], a[192:195], v[170:173], v[8:11]
ds_read_b128 v[182:185], v210 offset:39936
s_waitcnt lgkmcnt(0)
v_mfma_f32_16x16x32_bf16 v[0:3], a[148:151], v[182:185], v[0:3]
v_mfma_f32_16x16x32_bf16 v[4:7], a[172:175], v[182:185], v[4:7]
v_mfma_f32_16x16x32_bf16 v[8:11], a[196:199], v[182:185], v[8:11]
ds_read_b128 v[186:189], v210 offset:40960
s_waitcnt lgkmcnt(0)
v_mfma_f32_16x16x32_bf16 v[0:3], a[152:155], v[186:189], v[0:3]
v_mfma_f32_16x16x32_bf16 v[4:7], a[176:179], v[186:189], v[4:7]
v_mfma_f32_16x16x32_bf16 v[8:11], a[200:203], v[186:189], v[8:11]
ds_read_b128 v[170:173], v210 offset:41984
s_waitcnt lgkmcnt(0)
v_mfma_f32_16x16x32_bf16 v[0:3], a[156:159], v[170:173], v[0:3]
v_mfma_f32_16x16x32_bf16 v[4:7], a[180:183], v[170:173], v[4:7]
v_mfma_f32_16x16x32_bf16 v[8:11], a[204:207], v[170:173], v[8:11]
ds_read_b128 v[182:185], v210 offset:43008
s_waitcnt lgkmcnt(0)
v_mfma_f32_16x16x32_bf16 v[0:3], a[160:163], v[182:185], v[0:3]
v_mfma_f32_16x16x32_bf16 v[4:7], a[184:187], v[182:185], v[4:7]
v_mfma_f32_16x16x32_bf16 v[8:11], a[208:211], v[182:185], v[8:11]
ds_read_b128 v[186:189], v210 offset:44032
s_waitcnt lgkmcnt(0)
v_mfma_f32_16x16x32_bf16 v[0:3], a[164:167], v[186:189], v[0:3]
v_mfma_f32_16x16x32_bf16 v[4:7], a[188:191], v[186:189], v[4:7]
v_mfma_f32_16x16x32_bf16 v[8:11], a[212:215], v[186:189], v[8:11]
v_cvt_pk_bf16_f32 v72, v0, v1
v_cvt_pk_bf16_f32 v73, v2, v3
buffer_store_dwordx2 v[72:73], v203, s[8:11], s38 offen
v_cvt_pk_bf16_f32 v74, v4, v5
v_cvt_pk_bf16_f32 v75, v6, v7
buffer_store_dwordx2 v[74:75], v203, s[8:11], s38 offen offset:32
s_nop 0
v_cvt_pk_bf16_f32 v76, v8, v9
v_cvt_pk_bf16_f32 v77, v10, v11
buffer_store_dwordx2 v[76:77], v203, s[8:11], s38 offen offset:64
v_max3_f32 v151, v138, v139, v140
v_max3_f32 v151, v151, v141, v142
v_max3_f32 v151, v151, v143, v144
v_max3_f32 v151, v151, v145, v146
v_max3_f32 v151, v151, v147, v148
v_max3_f32 v151, v151, v149, v150
v_mov_b32 v152, v151
s_nop 1
v_permlane16_swap_b32 v151, v152
v_max_f32 v151, v151, v152
v_mov_b32 v152, v151
s_nop 1
v_permlane32_swap_b32 v151, v152
v_max_f32 v151, v151, v152
v_sub_f32 v138, v138, v151
v_sub_f32 v139, v139, v151
v_sub_f32 v140, v140, v151
v_sub_f32 v141, v141, v151
v_sub_f32 v142, v142, v151
v_sub_f32 v143, v143, v151
v_sub_f32 v144, v144, v151
v_sub_f32 v145, v145, v151
v_sub_f32 v150, v150, v151
v_sub_f32 v146, v146, v151
v_sub_f32 v147, v147, v151
v_sub_f32 v148, v148, v151
v_sub_f32 v149, v149, v151
v_exp_f32 v138, v138
v_exp_f32 v139, v139
v_exp_f32 v140, v140
v_exp_f32 v141, v141
v_exp_f32 v142, v142
v_exp_f32 v143, v143
v_exp_f32 v144, v144
v_exp_f32 v145, v145
v_exp_f32 v150, v150
v_exp_f32 v146, v146
v_exp_f32 v147, v147
v_exp_f32 v148, v148
v_exp_f32 v149, v149
v_cvt_pk_bf16_f32 v174, v138, v139
v_cvt_pk_bf16_f32 v175, v140, v141
v_cvt_pk_bf16_f32 v176, v142, v143
v_cvt_pk_bf16_f32 v177, v144, v145
v_cvt_pk_bf16_f32 v178, v146, v147
v_cvt_pk_bf16_f32 v179, v148, v149
v_cvt_pk_bf16_f32 v180, v150, 0
v_mfma_f32_16x16x32_bf16 v[150:153], v[190:193], v[174:177], 0
v_mfma_f32_16x16x32_bf16 v[138:141], v[114:117], v[174:177], 0
v_mfma_f32_16x16x32_bf16 v[142:145], v[122:125], v[174:177], 0
v_mfma_f32_16x16x32_bf16 v[146:149], v[130:133], v[174:177], 0
v_mfma_f32_16x16x32_bf16 v[150:153], v[190:193], v[178:181], v[150:153]
v_mfma_f32_16x16x32_bf16 v[138:141], v[118:121], v[178:181], v[138:141]
v_mfma_f32_16x16x32_bf16 v[142:145], v[126:129], v[178:181], v[142:145]
v_mfma_f32_16x16x32_bf16 v[146:149], v[134:137], v[178:181], v[146:149]
v_mfma_f32_16x16x32_bf16 v[166:169], v[84:87], v[190:193], 0
v_mfma_f32_16x16x32_bf16 v[154:157], v[84:87], v[114:117], 0
v_mfma_f32_16x16x32_bf16 v[158:161], v[84:87], v[122:125], 0
v_mfma_f32_16x16x32_bf16 v[162:165], v[84:87], v[130:133], 0
v_mfma_f32_16x16x32_bf16 v[166:169], v[88:91], v[190:193], v[166:169]
v_mfma_f32_16x16x32_bf16 v[154:157], v[88:91], v[118:121], v[154:157]
v_mfma_f32_16x16x32_bf16 v[158:161], v[88:91], v[126:129], v[158:161]
v_mfma_f32_16x16x32_bf16 v[162:165], v[88:91], v[134:137], v[162:165]
v_rcp_f32 v167, v166
s_nop 1
v_mov_b32_dpp v154, v158 quad_perm:[0,1,2,3] row_mask:0x2 bank_mask:0xf
s_nop 2
v_mov_b32_dpp v154, v162 quad_perm:[0,1,2,3] row_mask:0x4 bank_mask:0xf
v_mul_f32 v167, s3, v167
v_mul_f32 v154, v154, v167
v_cvt_pk_bf16_f32 v154, v154, 0
ds_write_b16 v214, v154
v_add_u32 v214, 1552, v214
ds_read_b128 v[170:173], v210 offset:45056
s_waitcnt lgkmcnt(0)
v_mfma_f32_16x16x32_bf16 v[12:15], a[144:147], v[170:173], v[12:15]
v_mfma_f32_16x16x32_bf16 v[16:19], a[168:171], v[170:173], v[16:19]
v_mfma_f32_16x16x32_bf16 v[20:23], a[192:195], v[170:173], v[20:23]
ds_read_b128 v[182:185], v210 offset:46080
s_waitcnt lgkmcnt(0)
v_mfma_f32_16x16x32_bf16 v[12:15], a[148:151], v[182:185], v[12:15]
v_mfma_f32_16x16x32_bf16 v[16:19], a[172:175], v[182:185], v[16:19]
v_mfma_f32_16x16x32_bf16 v[20:23], a[196:199], v[182:185], v[20:23]
ds_read_b128 v[186:189], v210 offset:47104
s_waitcnt lgkmcnt(0)
v_mfma_f32_16x16x32_bf16 v[12:15], a[152:155], v[186:189], v[12:15]
v_mfma_f32_16x16x32_bf16 v[16:19], a[176:179], v[186:189], v[16:19]
v_mfma_f32_16x16x32_bf16 v[20:23], a[200:203], v[186:189], v[20:23]
ds_read_b128 v[170:173], v210 offset:48128
s_waitcnt lgkmcnt(0)
v_mfma_f32_16x16x32_bf16 v[12:15], a[156:159], v[170:173], v[12:15]
v_mfma_f32_16x16x32_bf16 v[16:19], a[180:183], v[170:173], v[16:19]
v_mfma_f32_16x16x32_bf16 v[20:23], a[204:207], v[170:173], v[20:23]
ds_read_b128 v[182:185], v210 offset:49152
s_waitcnt lgkmcnt(0)
v_mfma_f32_16x16x32_bf16 v[12:15], a[160:163], v[182:185], v[12:15]
v_mfma_f32_16x16x32_bf16 v[16:19], a[184:187], v[182:185], v[16:19]
v_mfma_f32_16x16x32_bf16 v[20:23], a[208:211], v[182:185], v[20:23]
ds_read_b128 v[186:189], v210 offset:50176
s_waitcnt lgkmcnt(0)
v_mfma_f32_16x16x32_bf16 v[12:15], a[164:167], v[186:189], v[12:15]
v_mfma_f32_16x16x32_bf16 v[16:19], a[188:191], v[186:189], v[16:19]
v_mfma_f32_16x16x32_bf16 v[20:23], a[212:215], v[186:189], v[20:23]
v_cvt_pk_bf16_f32 v78, v12, v13
v_cvt_pk_bf16_f32 v79, v14, v15
buffer_store_dwordx2 v[78:79], v204, s[8:11], s38 offen
v_cvt_pk_bf16_f32 v80, v16, v17
v_cvt_pk_bf16_f32 v81, v18, v19
buffer_store_dwordx2 v[80:81], v204, s[8:11], s38 offen offset:32
s_nop 0
v_cvt_pk_bf16_f32 v82, v20, v21
v_cvt_pk_bf16_f32 v83, v22, v23
buffer_store_dwordx2 v[82:83], v204, s[8:11], s38 offen offset:64
v_rcp_f32 v151, v150
s_nop 0
v_mul_f32 v151, s3, v151
v_mul_f32 v138, v138, v151
v_mul_f32 v139, v139, v151
v_cvt_pk_bf16_f32 v138, v138, v139
v_mul_f32 v140, v140, v151
v_mul_f32 v141, v141, v151
v_cvt_pk_bf16_f32 v139, v140, v141
v_mul_f32 v142, v142, v151
v_mul_f32 v143, v143, v151
v_cvt_pk_bf16_f32 v140, v142, v143
v_mul_f32 v144, v144, v151
v_mul_f32 v145, v145, v151
v_cvt_pk_bf16_f32 v141, v144, v145
ds_write_b128 v211, v[138:141] offset:51200
v_mul_f32 v146, v146, v151
v_mul_f32 v147, v147, v151
v_cvt_pk_bf16_f32 v142, v146, v147
v_mul_f32 v148, v148, v151
v_mul_f32 v149, v149, v151
v_cvt_pk_bf16_f32 v143, v148, v149
ds_write_b64 v212, v[142:143] offset:51200
s_mov_b32 s46, 7
.p2align 6
G_loop:
s_waitcnt vmcnt(6) lgkmcnt(0)
s_barrier
ds_read_b128 v[170:173], v210 offset:51200
s_waitcnt lgkmcnt(0)
v_mfma_f32_16x16x32_bf16 v[24:27], a[144:147], v[170:173], v[24:27]
v_mfma_f32_16x16x32_bf16 v[28:31], a[168:171], v[170:173], v[28:31]
v_mfma_f32_16x16x32_bf16 v[32:35], a[192:195], v[170:173], v[32:35]
ds_read_b128 v[182:185], v210 offset:52224
s_waitcnt lgkmcnt(0)
v_mfma_f32_16x16x32_bf16 v[24:27], a[148:151], v[182:185], v[24:27]
v_mfma_f32_16x16x32_bf16 v[28:31], a[172:175], v[182:185], v[28:31]
v_mfma_f32_16x16x32_bf16 v[32:35], a[196:199], v[182:185], v[32:35]
ds_read_b128 v[186:189], v210 offset:53248
s_waitcnt lgkmcnt(0)
v_mfma_f32_16x16x32_bf16 v[24:27], a[152:155], v[186:189], v[24:27]
v_mfma_f32_16x16x32_bf16 v[28:31], a[176:179], v[186:189], v[28:31]
v_mfma_f32_16x16x32_bf16 v[32:35], a[200:203], v[186:189], v[32:35]
ds_read_b128 v[170:173], v210 offset:54272
s_waitcnt lgkmcnt(0)
v_mfma_f32_16x16x32_bf16 v[24:27], a[156:159], v[170:173], v[24:27]
v_mfma_f32_16x16x32_bf16 v[28:31], a[180:183], v[170:173], v[28:31]
v_mfma_f32_16x16x32_bf16 v[32:35], a[204:207], v[170:173], v[32:35]
ds_read_b128 v[182:185], v210 offset:55296
s_waitcnt lgkmcnt(0)
v_mfma_f32_16x16x32_bf16 v[24:27], a[160:163], v[182:185], v[24:27]
v_mfma_f32_16x16x32_bf16 v[28:31], a[184:187], v[182:185], v[28:31]
v_mfma_f32_16x16x32_bf16 v[32:35], a[208:211], v[182:185], v[32:35]
ds_read_b128 v[186:189], v210 offset:56320
s_waitcnt lgkmcnt(0)
v_mfma_f32_16x16x32_bf16 v[24:27], a[164:167], v[186:189], v[24:27]
v_mfma_f32_16x16x32_bf16 v[28:31], a[188:191], v[186:189], v[28:31]
v_mfma_f32_16x16x32_bf16 v[32:35], a[212:215], v[186:189], v[32:35]
v_cvt_pk_bf16_f32 v116, v24, v25
v_cvt_pk_bf16_f32 v117, v26, v27
buffer_store_dwordx2 v[116:117], v205, s[8:11], s38 offen
v_cvt_pk_bf16_f32 v124, v28, v29
v_cvt_pk_bf16_f32 v125, v30, v31
buffer_store_dwordx2 v[124:125], v205, s[8:11], s38 offen offset:32
s_nop 0
v_cvt_pk_bf16_f32 v132, v32, v33
v_cvt_pk_bf16_f32 v133, v34, v35
buffer_store_dwordx2 v[132:133], v205, s[8:11], s38 offen offset:64
s_mov_b32 s39, s37
ds_read_b128 v[174:177], v217
ds_read_b128 v[84:87], v200
s_waitcnt lgkmcnt(0)
v_mfma_f32_16x16x32_bf16 v[0:3], v[174:177], v[84:87], 0
ds_read_b128 v[92:95], v201
s_waitcnt lgkmcnt(0)
v_mfma_f32_16x16x32_bf16 v[12:15], v[174:177], v[92:95], 0
ds_read_b128 v[100:103], v202
s_waitcnt lgkmcnt(0)
v_mfma_f32_16x16x32_bf16 v[24:27], v[174:177], v[100:103], 0
ds_read_b128 v[178:181], v217 offset:528
ds_read_b128 v[84:87], v194
ds_read_b128 v[88:91], v194 offset:16
s_waitcnt lgkmcnt(0)
v_smfmac_f32_16x16x64_bf16 v[0:3], v[178:181], v[84:91], v213
ds_read_b128 v[92:95], v195
ds_read_b128 v[96:99], v195 offset:16
s_waitcnt lgkmcnt(0)
v_smfmac_f32_16x16x64_bf16 v[12:15], v[178:181], v[92:99], v213
ds_read_b128 v[100:103], v196
ds_read_b128 v[104:107], v196 offset:16
s_waitcnt lgkmcnt(0)
v_smfmac_f32_16x16x64_bf16 v[24:27], v[178:181], v[100:107], v213
ds_read_b128 v[174:177], v217 offset:1056
ds_read_b128 v[84:87], v197
ds_read_b128 v[88:91], v197 offset:16
s_waitcnt lgkmcnt(0)
v_smfmac_f32_16x16x64_bf16 v[0:3], v[174:177], v[84:91], v213
ds_read_b128 v[92:95], v198
ds_read_b128 v[96:99], v198 offset:16
s_waitcnt lgkmcnt(0)
v_smfmac_f32_16x16x64_bf16 v[12:15], v[174:177], v[92:99], v213
ds_read_b128 v[100:103], v199
ds_read_b128 v[104:107], v199 offset:16
s_waitcnt lgkmcnt(0)
v_smfmac_f32_16x16x64_bf16 v[24:27], v[174:177], v[100:107], v213
ds_read_b128 v[178:181], v217 offset:1584
ds_read_b128 v[84:87], v200 offset:32
s_waitcnt lgkmcnt(0)
v_mfma_f32_16x16x32_bf16 v[4:7], v[178:181], v[84:87], 0
ds_read_b128 v[92:95], v201 offset:32
s_waitcnt lgkmcnt(0)
v_mfma_f32_16x16x32_bf16 v[16:19], v[178:181], v[92:95], 0
ds_read_b128 v[100:103], v202 offset:32
s_waitcnt lgkmcnt(0)
v_mfma_f32_16x16x32_bf16 v[28:31], v[178:181], v[100:103], 0
ds_read_b128 v[174:177], v217 offset:2112
ds_read_b128 v[84:87], v194 offset:32
ds_read_b128 v[88:91], v194 offset:48
s_waitcnt lgkmcnt(0)
v_smfmac_f32_16x16x64_bf16 v[4:7], v[174:177], v[84:91], v213
ds_read_b128 v[92:95], v195 offset:32
ds_read_b128 v[96:99], v195 offset:48
s_waitcnt lgkmcnt(0)
v_smfmac_f32_16x16x64_bf16 v[16:19], v[174:177], v[92:99], v213
ds_read_b128 v[100:103], v196 offset:32
ds_read_b128 v[104:107], v196 offset:48
s_waitcnt lgkmcnt(0)
v_smfmac_f32_16x16x64_bf16 v[28:31], v[174:177], v[100:107], v213
ds_read_b128 v[178:181], v217 offset:2640
ds_read_b128 v[84:87], v197 offset:32
ds_read_b128 v[88:91], v197 offset:48
s_waitcnt lgkmcnt(0)
v_smfmac_f32_16x16x64_bf16 v[4:7], v[178:181], v[84:91], v213
ds_read_b128 v[92:95], v198 offset:32
ds_read_b128 v[96:99], v198 offset:48
s_waitcnt lgkmcnt(0)
v_smfmac_f32_16x16x64_bf16 v[16:19], v[178:181], v[92:99], v213
ds_read_b128 v[100:103], v199 offset:32
ds_read_b128 v[104:107], v199 offset:48
s_waitcnt lgkmcnt(0)
v_smfmac_f32_16x16x64_bf16 v[28:31], v[178:181], v[100:107], v213
ds_read_b128 v[174:177], v217 offset:3168
ds_read_b128 v[84:87], v200 offset:64
s_waitcnt lgkmcnt(0)
v_mfma_f32_16x16x32_bf16 v[8:11], v[174:177], v[84:87], 0
ds_read_b128 v[92:95], v201 offset:64
s_waitcnt lgkmcnt(0)
v_mfma_f32_16x16x32_bf16 v[20:23], v[174:177], v[92:95], 0
ds_read_b128 v[100:103], v202 offset:64
s_waitcnt lgkmcnt(0)
v_mfma_f32_16x16x32_bf16 v[32:35], v[174:177], v[100:103], 0
ds_read_b128 v[178:181], v217 offset:3696
ds_read_b128 v[84:87], v194 offset:64
ds_read_b128 v[88:91], v194 offset:80
s_waitcnt lgkmcnt(0)
v_smfmac_f32_16x16x64_bf16 v[8:11], v[178:181], v[84:91], v213
ds_read_b128 v[92:95], v195 offset:64
ds_read_b128 v[96:99], v195 offset:80
s_waitcnt lgkmcnt(0)
v_smfmac_f32_16x16x64_bf16 v[20:23], v[178:181], v[92:99], v213
ds_read_b128 v[100:103], v196 offset:64
ds_read_b128 v[104:107], v196 offset:80
s_waitcnt lgkmcnt(0)
v_smfmac_f32_16x16x64_bf16 v[32:35], v[178:181], v[100:107], v213
ds_read_b128 v[174:177], v217 offset:4224
ds_read_b128 v[84:87], v197 offset:64
ds_read_b128 v[88:91], v197 offset:80
s_waitcnt lgkmcnt(0)
v_smfmac_f32_16x16x64_bf16 v[8:11], v[174:177], v[84:91], v213
ds_read_b128 v[92:95], v198 offset:64
ds_read_b128 v[96:99], v198 offset:80
s_waitcnt lgkmcnt(0)
v_smfmac_f32_16x16x64_bf16 v[20:23], v[174:177], v[92:99], v213
ds_read_b128 v[100:103], v199 offset:64
ds_read_b128 v[104:107], v199 offset:80
s_waitcnt lgkmcnt(0)
v_smfmac_f32_16x16x64_bf16 v[32:35], v[174:177], v[100:107], v213
v_add_f32 v118, v0, v1
v_mul_f32 v119, v0, v0
v_add_f32 v118, v118, v2
v_fmac_f32 v119, v1, v1
v_add_f32 v118, v118, v3
v_fmac_f32 v119, v2, v2
v_fmac_f32 v119, v3, v3
v_add_f32 v126, v12, v13
v_mul_f32 v127, v12, v12
v_add_f32 v126, v126, v14
v_fmac_f32 v127, v13, v13
v_add_f32 v126, v126, v15
v_fmac_f32 v127, v14, v14
v_fmac_f32 v127, v15, v15
v_add_f32 v134, v24, v25
v_mul_f32 v135, v24, v24
v_add_f32 v134, v134, v26
v_fmac_f32 v135, v25, v25
v_add_f32 v134, v134, v27
v_fmac_f32 v135, v26, v26
v_fmac_f32 v135, v27, v27
v_add_f32 v118, v118, v4
v_fmac_f32 v119, v4, v4
v_add_f32 v118, v118, v5
v_fmac_f32 v119, v5, v5
v_add_f32 v118, v118, v6
v_fmac_f32 v119, v6, v6
v_add_f32 v118, v118, v7
v_fmac_f32 v119, v7, v7
v_add_f32 v126, v126, v16
v_fmac_f32 v127, v16, v16
v_add_f32 v126, v126, v17
v_fmac_f32 v127, v17, v17
v_add_f32 v126, v126, v18
v_fmac_f32 v127, v18, v18
v_add_f32 v126, v126, v19
v_fmac_f32 v127, v19, v19
v_add_f32 v134, v134, v28
v_fmac_f32 v135, v28, v28
v_add_f32 v134, v134, v29
v_fmac_f32 v135, v29, v29
v_add_f32 v134, v134, v30
v_fmac_f32 v135, v30, v30
v_add_f32 v134, v134, v31
v_fmac_f32 v135, v31, v31
v_add_f32 v118, v118, v8
v_fmac_f32 v119, v8, v8
v_add_f32 v118, v118, v9
v_fmac_f32 v119, v9, v9
v_add_f32 v118, v118, v10
v_fmac_f32 v119, v10, v10
v_add_f32 v118, v118, v11
v_fmac_f32 v119, v11, v11
v_add_f32 v126, v126, v20
v_fmac_f32 v127, v20, v20
v_add_f32 v126, v126, v21
v_fmac_f32 v127, v21, v21
v_add_f32 v126, v126, v22
v_fmac_f32 v127, v22, v22
v_add_f32 v126, v126, v23
v_fmac_f32 v127, v23, v23
v_add_f32 v134, v134, v32
v_fmac_f32 v135, v32, v32
v_add_f32 v134, v134, v33
v_fmac_f32 v135, v33, v33
v_add_f32 v134, v134, v34
v_fmac_f32 v135, v34, v34
v_add_f32 v134, v134, v35
v_fmac_f32 v135, v35, v35
v_permlane16_swap_b32 v118, v119
v_add_f32 v118, v118, v119
v_permlane16_swap_b32 v126, v127
v_add_f32 v126, v126, v127
v_permlane16_swap_b32 v134, v135
v_add_f32 v134, v134, v135
v_permlane32_swap_b32 v118, v126
v_add_f32 v118, v118, v126
ds_write_b32 v209, v118
v_mov_b32 v135, v134
s_nop 1
v_permlane32_swap_b32 v134, v135
v_add_f32 v134, v134, v135
ds_write_b32 v209, v134 offset:512
s_waitcnt lgkmcnt(0)
s_barrier
s_mul_hi_u32 s41, s35, 58835169
s_mul_i32 s42, s41, 73
s_sub_u32 s42, s35, s42
s_mul_i32 s43, s41, 1373568
s_mul_i32 s51, s42, 2688
s_add_u32 s43, s43, s51
s_cmp_lt_u32 s35, s34
s_cselect_b32 s50, s43, 1879048192
s_add_u32 s35, s35, 32
s_cmp_eq_u32 s42, 0
s_cselect_b32 s44, 536870911, s72
s_cmp_eq_u32 s42, 72
s_cselect_b32 s44, 939524095, s44
s_cmp_eq_u32 s41, 0
s_cselect_b32 s52, 1879048192, s50
s_mov_b32 s37, s50
v_and_b32 v180, s44, v208
s_add_u32 m0, s45, 0
s_nop 0
buffer_load_dwordx4 v180, s[4:7], s52 offen nt lds
s_add_u32 m0, s45, 4112
s_add_u32 s40, s37, 196224
buffer_load_dwordx4 v180, s[4:7], s40 offen nt lds
s_add_u32 m0, s45, 8224
s_add_u32 s40, s37, 392448
buffer_load_dwordx4 v180, s[4:7], s40 offen nt lds
s_add_u32 m0, s45, 12336
s_add_u32 s40, s37, 588672
buffer_load_dwordx4 v180, s[4:7], s40 offen nt lds
s_add_u32 m0, s45, 16448
s_add_u32 s40, s37, 784896
buffer_load_dwordx4 v180, s[4:7], s40 offen nt lds
s_add_u32 m0, s45, 20560
s_add_u32 s40, s37, 981120
buffer_load_dwordx4 v180, s[4:7], s40 offen nt lds
s_add_u32 m0, s45, 24672
s_add_u32 s40, s37, 1177344
buffer_load_dwordx4 v180, s[4:7], s40 offen nt lds
s_add_u32 m0, s45, 28784
s_add_u32 s40, s37, 1373568
buffer_load_dwordx4 v180, s[4:7], s40 offen nt lds
s_add_u32 m0, s45, 32896
s_add_u32 s40, s37, 1569792
buffer_load_dwordx4 v180, s[4:7], s40 offen nt lds
ds_read_b128 v[102:105], v210 offset:18432
ds_read_b128 v[106:109], v210 offset:19456
s_waitcnt lgkmcnt(1)
v_add_f32 v102, v102, v103
s_waitcnt lgkmcnt(0)
v_add_f32 v106, v106, v107
v_add_f32 v104, v104, v105
v_add_f32 v108, v108, v109
v_add_f32 v102, v102, v104
v_add_f32 v106, v106, v108
v_mul_f32 v103, s48, v102
v_mul_f32 v104, s73, v102
v_mul_f32 v106, s73, v106
v_fma_f32 v106, -v103, v104, v106
v_max_f32 v106, 0, v106
v_add_f32 v106, s49, v106
v_rsq_f32 v102, v106
s_nop 0
v_mul_f32_e64 v103, -v103, v102
ds_write_b64 v211, v[102:103]
ds_read_b64 v[118:119], v219
ds_read_b64 v[126:127], v219 offset:256
ds_read_b64 v[134:135], v219 offset:512
s_waitcnt lgkmcnt(2)
v_fma_f32 v220, v0, v118, v119
v_fma_f32 v221, v1, v118, v119
v_cvt_pk_bf16_f32 v90, v220, v221
v_fma_f32 v222, v2, v118, v119
v_fma_f32 v223, v3, v118, v119
v_cvt_pk_bf16_f32 v91, v222, v223
v_fma_f32 v220, v4, v118, v119
v_fma_f32 v221, v5, v118, v119
v_cvt_pk_bf16_f32 v92, v220, v221
v_fma_f32 v222, v6, v118, v119
v_fma_f32 v223, v7, v118, v119
v_cvt_pk_bf16_f32 v93, v222, v223
ds_write_b128 v211, v[90:93]
v_fma_f32 v220, v8, v118, v119
v_fma_f32 v221, v9, v118, v119
v_cvt_pk_bf16_f32 v94, v220, v221
v_fma_f32 v222, v10, v118, v119
v_fma_f32 v223, v11, v118, v119
v_cvt_pk_bf16_f32 v95, v222, v223
s_waitcnt lgkmcnt(2)
ds_write_b64 v212, v[94:95]
v_fma_f32 v220, v12, v126, v127
v_fma_f32 v221, v13, v126, v127
v_cvt_pk_bf16_f32 v174, v220, v221
v_fma_f32 v222, v14, v126, v127
v_fma_f32 v223, v15, v126, v127
v_cvt_pk_bf16_f32 v175, v222, v223
v_fma_f32 v220, v16, v126, v127
v_fma_f32 v221, v17, v126, v127
v_cvt_pk_bf16_f32 v176, v220, v221
v_fma_f32 v222, v18, v126, v127
v_fma_f32 v223, v19, v126, v127
v_cvt_pk_bf16_f32 v177, v222, v223
ds_write_b128 v211, v[174:177] offset:6144
v_fma_f32 v220, v20, v126, v127
v_fma_f32 v221, v21, v126, v127
v_cvt_pk_bf16_f32 v178, v220, v221
v_fma_f32 v222, v22, v126, v127
v_fma_f32 v223, v23, v126, v127
v_cvt_pk_bf16_f32 v179, v222, v223
s_waitcnt lgkmcnt(3)
ds_write_b64 v212, v[178:179] offset:6144
v_fma_f32 v220, v24, v134, v135
v_fma_f32 v221, v25, v134, v135
v_cvt_pk_bf16_f32 v90, v220, v221
v_fma_f32 v222, v26, v134, v135
v_fma_f32 v223, v27, v134, v135
v_cvt_pk_bf16_f32 v91, v222, v223
v_fma_f32 v220, v28, v134, v135
v_fma_f32 v221, v29, v134, v135
v_cvt_pk_bf16_f32 v92, v220, v221
v_fma_f32 v222, v30, v134, v135
v_fma_f32 v223, v31, v134, v135
v_cvt_pk_bf16_f32 v93, v222, v223
ds_write_b128 v211, v[90:93] offset:12288
v_fma_f32 v220, v32, v134, v135
v_fma_f32 v221, v33, v134, v135
v_cvt_pk_bf16_f32 v94, v220, v221
v_fma_f32 v222, v34, v134, v135
v_fma_f32 v223, v35, v134, v135
v_cvt_pk_bf16_f32 v95, v222, v223
ds_write_b64 v212, v[94:95] offset:12288
ds_read_b128 v[182:185], v210 offset:20480
s_waitcnt lgkmcnt(0)
v_mfma_f32_16x16x32_bf16 v[138:141], a[0:3], v[182:185], 0
v_mfma_f32_16x16x32_bf16 v[142:145], a[24:27], v[182:185], 0
v_mfma_f32_16x16x32_bf16 v[146:149], a[48:51], v[182:185], 0
v_mfma_f32_16x16x32_bf16 v[150:153], a[216:219], v[182:185], 0
v_mfma_f32_16x16x32_bf16 v[154:157], a[240:243], v[182:185], 0
v_mfma_f32_16x16x32_bf16 v[158:161], v[232:235], v[182:185], 0
v_mfma_f32_16x16x32_bf16 v[162:165], v[182:185], a[72:75], 0
v_mfma_f32_16x16x32_bf16 v[166:169], v[182:185], a[96:99], 0
v_mfma_f32_16x16x32_bf16 v[170:173], v[182:185], a[120:123], 0
ds_read_b128 v[186:189], v210 offset:21504
s_waitcnt lgkmcnt(0)
v_mfma_f32_16x16x32_bf16 v[138:141], a[4:7], v[186:189], v[138:141]
v_mfma_f32_16x16x32_bf16 v[142:145], a[28:31], v[186:189], v[142:145]
v_mfma_f32_16x16x32_bf16 v[146:149], a[52:55], v[186:189], v[146:149]
v_mfma_f32_16x16x32_bf16 v[150:153], a[220:223], v[186:189], v[150:153]
v_mfma_f32_16x16x32_bf16 v[154:157], a[244:247], v[186:189], v[154:157]
v_mfma_f32_16x16x32_bf16 v[158:161], v[236:239], v[186:189], v[158:161]
v_mfma_f32_16x16x32_bf16 v[162:165], v[186:189], a[76:79], v[162:165]
v_mfma_f32_16x16x32_bf16 v[166:169], v[186:189], a[100:103], v[166:169]
v_mfma_f32_16x16x32_bf16 v[170:173], v[186:189], a[124:127], v[170:173]
ds_read_b128 v[182:185], v210 offset:22528
s_waitcnt lgkmcnt(0)
v_mfma_f32_16x16x32_bf16 v[138:141], a[8:11], v[182:185], v[138:141]
v_mfma_f32_16x16x32_bf16 v[142:145], a[32:35], v[182:185], v[142:145]
v_mfma_f32_16x16x32_bf16 v[146:149], a[56:59], v[182:185], v[146:149]
v_mfma_f32_16x16x32_bf16 v[150:153], a[224:227], v[182:185], v[150:153]
v_mfma_f32_16x16x32_bf16 v[154:157], a[248:251], v[182:185], v[154:157]
v_mfma_f32_16x16x32_bf16 v[158:161], v[240:243], v[182:185], v[158:161]
v_mfma_f32_16x16x32_bf16 v[162:165], v[182:185], a[80:83], v[162:165]
v_mfma_f32_16x16x32_bf16 v[166:169], v[182:185], a[104:107], v[166:169]
v_mfma_f32_16x16x32_bf16 v[170:173], v[182:185], a[128:131], v[170:173]
ds_read_b128 v[186:189], v210 offset:23552
s_waitcnt lgkmcnt(0)
v_mfma_f32_16x16x32_bf16 v[138:141], a[12:15], v[186:189], v[138:141]
v_mfma_f32_16x16x32_bf16 v[142:145], a[36:39], v[186:189], v[142:145]
v_mfma_f32_16x16x32_bf16 v[146:149], a[60:63], v[186:189], v[146:149]
v_mfma_f32_16x16x32_bf16 v[150:153], a[228:231], v[186:189], v[150:153]
v_mfma_f32_16x16x32_bf16 v[154:157], a[252:255], v[186:189], v[154:157]
v_mfma_f32_16x16x32_bf16 v[158:161], v[244:247], v[186:189], v[158:161]
v_mfma_f32_16x16x32_bf16 v[162:165], v[186:189], a[84:87], v[162:165]
v_mfma_f32_16x16x32_bf16 v[166:169], v[186:189], a[108:111], v[166:169]
v_mfma_f32_16x16x32_bf16 v[170:173], v[186:189], a[132:135], v[170:173]
ds_read_b128 v[182:185], v210 offset:24576
s_waitcnt lgkmcnt(0)
v_mfma_f32_16x16x32_bf16 v[138:141], a[16:19], v[182:185], v[138:141]
v_mfma_f32_16x16x32_bf16 v[142:145], a[40:43], v[182:185], v[142:145]
v_mfma_f32_16x16x32_bf16 v[146:149], a[64:67], v[182:185], v[146:149]
v_mfma_f32_16x16x32_bf16 v[150:153], a[232:235], v[182:185], v[150:153]
v_mfma_f32_16x16x32_bf16 v[154:157], v[224:227], v[182:185], v[154:157]
v_mfma_f32_16x16x32_bf16 v[158:161], v[248:251], v[182:185], v[158:161]
v_mfma_f32_16x16x32_bf16 v[162:165], v[182:185], a[88:91], v[162:165]
v_mfma_f32_16x16x32_bf16 v[166:169], v[182:185], a[112:115], v[166:169]
v_mfma_f32_16x16x32_bf16 v[170:173], v[182:185], a[136:139], v[170:173]
ds_read_b128 v[186:189], v210 offset:25600
s_waitcnt lgkmcnt(0)
v_mfma_f32_16x16x32_bf16 v[138:141], a[20:23], v[186:189], v[138:141]
v_mfma_f32_16x16x32_bf16 v[142:145], a[44:47], v[186:189], v[142:145]
v_mfma_f32_16x16x32_bf16 v[146:149], a[68:71], v[186:189], v[146:149]
v_mfma_f32_16x16x32_bf16 v[150:153], a[236:239], v[186:189], v[150:153]
v_mfma_f32_16x16x32_bf16 v[154:157], v[228:231], v[186:189], v[154:157]
v_mfma_f32_16x16x32_bf16 v[158:161], v[252:255], v[186:189], v[158:161]
v_mfma_f32_16x16x32_bf16 v[162:165], v[186:189], a[92:95], v[162:165]
v_mfma_f32_16x16x32_bf16 v[166:169], v[186:189], a[116:119], v[166:169]
v_mfma_f32_16x16x32_bf16 v[170:173], v[186:189], a[140:143], v[170:173]
v_cvt_pk_bf16_f32 v78, v138, v139
v_cvt_pk_bf16_f32 v79, v140, v141
v_cvt_pk_bf16_f32 v80, v142, v143
v_cvt_pk_bf16_f32 v81, v144, v145
v_cvt_pk_bf16_f32 v82, v146, v147
v_cvt_pk_bf16_f32 v83, v148, v149
v_cvt_pk_bf16_f32 v72, v150, v151
v_cvt_pk_bf16_f32 v73, v152, v153
v_cvt_pk_bf16_f32 v74, v154, v155
v_cvt_pk_bf16_f32 v75, v156, v157
v_cvt_pk_bf16_f32 v76, v158, v159
v_cvt_pk_bf16_f32 v77, v160, v161
v_cvt_pk_bf16_f32 v114, v162, v163
v_cvt_pk_bf16_f32 v115, v164, v165
v_cvt_pk_bf16_f32 v122, v166, v167
v_cvt_pk_bf16_f32 v123, v168, v169
v_cvt_pk_bf16_f32 v130, v170, v171
v_cvt_pk_bf16_f32 v131, v172, v173
ds_read_b128 v[182:185], v210 offset:26624
s_waitcnt lgkmcnt(0)
v_mfma_f32_16x16x32_bf16 v[138:141], a[0:3], v[182:185], 0
v_mfma_f32_16x16x32_bf16 v[142:145], a[24:27], v[182:185], 0
v_mfma_f32_16x16x32_bf16 v[146:149], a[48:51], v[182:185], 0
v_mfma_f32_16x16x32_bf16 v[150:153], a[216:219], v[182:185], 0
v_mfma_f32_16x16x32_bf16 v[154:157], a[240:243], v[182:185], 0
v_mfma_f32_16x16x32_bf16 v[158:161], v[232:235], v[182:185], 0
v_mfma_f32_16x16x32_bf16 v[162:165], v[182:185], a[72:75], 0
v_mfma_f32_16x16x32_bf16 v[166:169], v[182:185], a[96:99], 0
v_mfma_f32_16x16x32_bf16 v[170:173], v[182:185], a[120:123], 0
ds_read_b128 v[186:189], v210 offset:27648
s_waitcnt lgkmcnt(0)
v_mfma_f32_16x16x32_bf16 v[138:141], a[4:7], v[186:189], v[138:141]
v_mfma_f32_16x16x32_bf16 v[142:145], a[28:31], v[186:189], v[142:145]
v_mfma_f32_16x16x32_bf16 v[146:149], a[52:55], v[186:189], v[146:149]
v_mfma_f32_16x16x32_bf16 v[150:153], a[220:223], v[186:189], v[150:153]
v_mfma_f32_16x16x32_bf16 v[154:157], a[244:247], v[186:189], v[154:157]
v_mfma_f32_16x16x32_bf16 v[158:161], v[236:239], v[186:189], v[158:161]
v_mfma_f32_16x16x32_bf16 v[162:165], v[186:189], a[76:79], v[162:165]
v_mfma_f32_16x16x32_bf16 v[166:169], v[186:189], a[100:103], v[166:169]
v_mfma_f32_16x16x32_bf16 v[170:173], v[186:189], a[124:127], v[170:173]
ds_read_b128 v[182:185], v210 offset:28672
s_waitcnt lgkmcnt(0)
v_mfma_f32_16x16x32_bf16 v[138:141], a[8:11], v[182:185], v[138:141]
v_mfma_f32_16x16x32_bf16 v[142:145], a[32:35], v[182:185], v[142:145]
v_mfma_f32_16x16x32_bf16 v[146:149], a[56:59], v[182:185], v[146:149]
v_mfma_f32_16x16x32_bf16 v[150:153], a[224:227], v[182:185], v[150:153]
v_mfma_f32_16x16x32_bf16 v[154:157], a[248:251], v[182:185], v[154:157]
v_mfma_f32_16x16x32_bf16 v[158:161], v[240:243], v[182:185], v[158:161]
v_mfma_f32_16x16x32_bf16 v[162:165], v[182:185], a[80:83], v[162:165]
v_mfma_f32_16x16x32_bf16 v[166:169], v[182:185], a[104:107], v[166:169]
v_mfma_f32_16x16x32_bf16 v[170:173], v[182:185], a[128:131], v[170:173]
ds_read_b128 v[186:189], v210 offset:29696
s_waitcnt lgkmcnt(0)
v_mfma_f32_16x16x32_bf16 v[138:141], a[12:15], v[186:189], v[138:141]
v_mfma_f32_16x16x32_bf16 v[142:145], a[36:39], v[186:189], v[142:145]
v_mfma_f32_16x16x32_bf16 v[146:149], a[60:63], v[186:189], v[146:149]
v_mfma_f32_16x16x32_bf16 v[150:153], a[228:231], v[186:189], v[150:153]
v_mfma_f32_16x16x32_bf16 v[154:157], a[252:255], v[186:189], v[154:157]
v_mfma_f32_16x16x32_bf16 v[158:161], v[244:247], v[186:189], v[158:161]
v_mfma_f32_16x16x32_bf16 v[162:165], v[186:189], a[84:87], v[162:165]
v_mfma_f32_16x16x32_bf16 v[166:169], v[186:189], a[108:111], v[166:169]
v_mfma_f32_16x16x32_bf16 v[170:173], v[186:189], a[132:135], v[170:173]
ds_read_b128 v[182:185], v210 offset:30720
s_waitcnt lgkmcnt(0)
v_mfma_f32_16x16x32_bf16 v[138:141], a[16:19], v[182:185], v[138:141]
v_mfma_f32_16x16x32_bf16 v[142:145], a[40:43], v[182:185], v[142:145]
v_mfma_f32_16x16x32_bf16 v[146:149], a[64:67], v[182:185], v[146:149]
v_mfma_f32_16x16x32_bf16 v[150:153], a[232:235], v[182:185], v[150:153]
v_mfma_f32_16x16x32_bf16 v[154:157], v[224:227], v[182:185], v[154:157]
v_mfma_f32_16x16x32_bf16 v[158:161], v[248:251], v[182:185], v[158:161]
v_mfma_f32_16x16x32_bf16 v[162:165], v[182:185], a[88:91], v[162:165]
v_mfma_f32_16x16x32_bf16 v[166:169], v[182:185], a[112:115], v[166:169]
v_mfma_f32_16x16x32_bf16 v[170:173], v[182:185], a[136:139], v[170:173]
ds_read_b128 v[186:189], v210 offset:31744
s_waitcnt lgkmcnt(0)
v_mfma_f32_16x16x32_bf16 v[138:141], a[20:23], v[186:189], v[138:141]
v_mfma_f32_16x16x32_bf16 v[142:145], a[44:47], v[186:189], v[142:145]
v_mfma_f32_16x16x32_bf16 v[146:149], a[68:71], v[186:189], v[146:149]
v_mfma_f32_16x16x32_bf16 v[150:153], a[236:239], v[186:189], v[150:153]
v_mfma_f32_16x16x32_bf16 v[154:157], v[228:231], v[186:189], v[154:157]
v_mfma_f32_16x16x32_bf16 v[158:161], v[252:255], v[186:189], v[158:161]
v_mfma_f32_16x16x32_bf16 v[162:165], v[186:189], a[92:95], v[162:165]
v_mfma_f32_16x16x32_bf16 v[166:169], v[186:189], a[116:119], v[166:169]
v_mfma_f32_16x16x32_bf16 v[170:173], v[186:189], a[140:143], v[170:173]
v_cvt_pk_bf16_f32 v96, v138, v139
v_cvt_pk_bf16_f32 v97, v140, v141
v_cvt_pk_bf16_f32 v98, v142, v143
v_cvt_pk_bf16_f32 v99, v144, v145
v_cvt_pk_bf16_f32 v100, v146, v147
v_cvt_pk_bf16_f32 v101, v148, v149
v_cvt_pk_bf16_f32 v84, v150, v151
v_cvt_pk_bf16_f32 v85, v152, v153
v_cvt_pk_bf16_f32 v86, v154, v155
v_cvt_pk_bf16_f32 v87, v156, v157
v_cvt_pk_bf16_f32 v88, v158, v159
v_cvt_pk_bf16_f32 v89, v160, v161
v_cvt_pk_bf16_f32 v116, v162, v163
v_cvt_pk_bf16_f32 v117, v164, v165
v_cvt_pk_bf16_f32 v124, v166, v167
v_cvt_pk_bf16_f32 v125, v168, v169
v_cvt_pk_bf16_f32 v132, v170, v171
v_cvt_pk_bf16_f32 v133, v172, v173
ds_read_b128 v[182:185], v210 offset:32768
s_waitcnt lgkmcnt(0)
v_mfma_f32_16x16x32_bf16 v[138:141], a[0:3], v[182:185], 0
v_mfma_f32_16x16x32_bf16 v[142:145], a[24:27], v[182:185], 0
v_mfma_f32_16x16x32_bf16 v[146:149], a[48:51], v[182:185], 0
ds_read_b128 v[186:189], v210 offset:33792
s_waitcnt lgkmcnt(0)
v_mfma_f32_16x16x32_bf16 v[138:141], a[4:7], v[186:189], v[138:141]
v_mfma_f32_16x16x32_bf16 v[142:145], a[28:31], v[186:189], v[142:145]
v_mfma_f32_16x16x32_bf16 v[146:149], a[52:55], v[186:189], v[146:149]
ds_read_b128 v[182:185], v210 offset:34816
s_waitcnt lgkmcnt(0)
v_mfma_f32_16x16x32_bf16 v[138:141], a[8:11], v[182:185], v[138:141]
v_mfma_f32_16x16x32_bf16 v[142:145], a[32:35], v[182:185], v[142:145]
v_mfma_f32_16x16x32_bf16 v[146:149], a[56:59], v[182:185], v[146:149]
ds_read_b128 v[186:189], v210 offset:35840
s_waitcnt lgkmcnt(0)
v_mfma_f32_16x16x32_bf16 v[138:141], a[12:15], v[186:189], v[138:141]
v_mfma_f32_16x16x32_bf16 v[142:145], a[36:39], v[186:189], v[142:145]
v_mfma_f32_16x16x32_bf16 v[146:149], a[60:63], v[186:189], v[146:149]
ds_read_b128 v[182:185], v210 offset:36864
s_waitcnt lgkmcnt(0)
v_mfma_f32_16x16x32_bf16 v[138:141], a[16:19], v[182:185], v[138:141]
v_mfma_f32_16x16x32_bf16 v[142:145], a[40:43], v[182:185], v[142:145]
v_mfma_f32_16x16x32_bf16 v[146:149], a[64:67], v[182:185], v[146:149]
ds_read_b128 v[186:189], v210 offset:37888
s_waitcnt lgkmcnt(0)
v_mfma_f32_16x16x32_bf16 v[138:141], a[20:23], v[186:189], v[138:141]
v_mfma_f32_16x16x32_bf16 v[142:145], a[44:47], v[186:189], v[142:145]
v_mfma_f32_16x16x32_bf16 v[146:149], a[68:71], v[186:189], v[146:149]
v_cvt_pk_bf16_f32 v102, v138, v139
v_cvt_pk_bf16_f32 v103, v140, v141
s_nop 0
v_cvt_pk_bf16_f32 v104, v142, v143
v_cvt_pk_bf16_f32 v105, v144, v145
s_nop 1
v_cvt_pk_bf16_f32 v106, v146, v147
v_cvt_pk_bf16_f32 v107, v148, v149
ds_read_b128 v[108:111], v215 offset:512
ds_read_b64 v[112:113], v215 offset:528
v_mov_b32 v181, 0
v_mfma_f32_16x16x16_bf16 v[138:141], v[82:83], v[76:77], 0
v_mfma_f32_16x16x16_bf16 v[142:145], v[100:101], v[76:77], 0
s_waitcnt lgkmcnt(0)
v_mfma_f32_16x16x16_bf16 v[150:153], v[112:113], v[76:77], v[206:209]
v_mfma_f32_16x16x16_bf16 v[146:149], v[106:107], v[76:77], 0
v_mfma_f32_16x16x32_bf16 v[138:141], v[78:81], v[72:75], v[138:141]
v_mfma_f32_16x16x32_bf16 v[142:145], v[96:99], v[72:75], v[142:145]
v_mfma_f32_16x16x32_bf16 v[150:153], v[108:111], v[72:75], v[150:153]
v_mfma_f32_16x16x32_bf16 v[146:149], v[102:105], v[72:75], v[146:149]
ds_read_b128 v[72:75], v215
ds_read_b64 v[76:77], v215 offset:16
v_mfma_f32_16x16x16_bf16 v[154:157], v[82:83], v[88:89], 0
v_mfma_f32_16x16x16_bf16 v[158:161], v[100:101], v[88:89], 0
v_mfma_f32_16x16x16_bf16 v[166:169], v[112:113], v[88:89], v[206:209]
v_mfma_f32_16x16x16_bf16 v[162:165], v[106:107], v[88:89], 0
v_mfma_f32_16x16x32_bf16 v[154:157], v[78:81], v[84:87], v[154:157]
v_mfma_f32_16x16x32_bf16 v[158:161], v[96:99], v[84:87], v[158:161]
v_mfma_f32_16x16x32_bf16 v[166:169], v[108:111], v[84:87], v[166:169]
v_mfma_f32_16x16x32_bf16 v[162:165], v[102:105], v[84:87], v[162:165]
ds_read_b128 v[182:185], v210 offset:32768
s_waitcnt lgkmcnt(0)
v_mfma_f32_16x16x32_bf16 v[118:121], v[182:185], a[72:75], 0
v_mfma_f32_16x16x32_bf16 v[126:129], v[182:185], a[96:99], 0
v_mfma_f32_16x16x32_bf16 v[134:137], v[182:185], a[120:123], 0
v_mfma_f32_16x16x32_bf16 v[90:93], a[216:219], v[182:185], 0
v_mfma_f32_16x16x32_bf16 v[170:173], a[240:243], v[182:185], 0
v_mfma_f32_16x16x32_bf16 v[220:223], v[232:235], v[182:185], 0
ds_read_b128 v[186:189], v210 offset:33792
s_waitcnt lgkmcnt(0)
v_mfma_f32_16x16x32_bf16 v[118:121], v[186:189], a[76:79], v[118:121]
v_mfma_f32_16x16x32_bf16 v[126:129], v[186:189], a[100:103], v[126:129]
v_mfma_f32_16x16x32_bf16 v[134:137], v[186:189], a[124:127], v[134:137]
v_mfma_f32_16x16x32_bf16 v[90:93], a[220:223], v[186:189], v[90:93]
v_mfma_f32_16x16x32_bf16 v[170:173], a[244:247], v[186:189], v[170:173]
v_mfma_f32_16x16x32_bf16 v[220:223], v[236:239], v[186:189], v[220:223]
ds_read_b128 v[182:185], v210 offset:34816
s_waitcnt lgkmcnt(0)
v_mfma_f32_16x16x32_bf16 v[118:121], v[182:185], a[80:83], v[118:121]
v_mfma_f32_16x16x32_bf16 v[126:129], v[182:185], a[104:107], v[126:129]
v_mfma_f32_16x16x32_bf16 v[134:137], v[182:185], a[128:131], v[134:137]
v_mfma_f32_16x16x32_bf16 v[90:93], a[224:227], v[182:185], v[90:93]
v_mfma_f32_16x16x32_bf16 v[170:173], a[248:251], v[182:185], v[170:173]
v_mfma_f32_16x16x32_bf16 v[220:223], v[240:243], v[182:185], v[220:223]
ds_read_b128 v[186:189], v210 offset:35840
s_waitcnt lgkmcnt(0)
v_mfma_f32_16x16x32_bf16 v[118:121], v[186:189], a[84:87], v[118:121]
v_mfma_f32_16x16x32_bf16 v[126:129], v[186:189], a[108:111], v[126:129]
v_mfma_f32_16x16x32_bf16 v[134:137], v[186:189], a[132:135], v[134:137]
v_mfma_f32_16x16x32_bf16 v[90:93], a[228:231], v[186:189], v[90:93]
v_mfma_f32_16x16x32_bf16 v[170:173], a[252:255], v[186:189], v[170:173]
v_mfma_f32_16x16x32_bf16 v[220:223], v[244:247], v[186:189], v[220:223]
ds_read_b128 v[182:185], v210 offset:36864
s_waitcnt lgkmcnt(0)
v_mfma_f32_16x16x32_bf16 v[118:121], v[182:185], a[88:91], v[118:121]
v_mfma_f32_16x16x32_bf16 v[126:129], v[182:185], a[112:115], v[126:129]
v_mfma_f32_16x16x32_bf16 v[134:137], v[182:185], a[136:139], v[134:137]
v_mfma_f32_16x16x32_bf16 v[90:93], a[232:235], v[182:185], v[90:93]
v_mfma_f32_16x16x32_bf16 v[170:173], v[224:227], v[182:185], v[170:173]
v_mfma_f32_16x16x32_bf16 v[220:223], v[248:251], v[182:185], v[220:223]
ds_read_b128 v[186:189], v210 offset:37888
s_waitcnt lgkmcnt(0)
v_mfma_f32_16x16x32_bf16 v[118:121], v[186:189], a[92:95], v[118:121]
v_mfma_f32_16x16x32_bf16 v[126:129], v[186:189], a[116:119], v[126:129]
v_mfma_f32_16x16x32_bf16 v[134:137], v[186:189], a[140:143], v[134:137]
v_mfma_f32_16x16x32_bf16 v[90:93], a[236:239], v[186:189], v[90:93]
v_mfma_f32_16x16x32_bf16 v[170:173], v[228:231], v[186:189], v[170:173]
v_mfma_f32_16x16x32_bf16 v[220:223], v[252:255], v[186:189], v[220:223]
v_cvt_pk_bf16_f32 v118, v118, v119
v_cvt_pk_bf16_f32 v119, v120, v121
ds_read_u16 v120, v214 offset:1024
v_mov_b32 v121, 0
v_cvt_pk_bf16_f32 v126, v126, v127
v_cvt_pk_bf16_f32 v127, v128, v129
ds_read_u16 v128, v214 offset:1032
v_mov_b32 v129, 0
v_cvt_pk_bf16_f32 v134, v134, v135
v_cvt_pk_bf16_f32 v135, v136, v137
ds_read_u16 v136, v214 offset:1040
v_mov_b32 v137, 0
v_cvt_pk_bf16_f32 v90, v90, v91
v_cvt_pk_bf16_f32 v91, v92, v93
v_cvt_pk_bf16_f32 v92, v170, v171
v_cvt_pk_bf16_f32 v93, v172, v173
v_cvt_pk_bf16_f32 v94, v220, v221
v_cvt_pk_bf16_f32 v95, v222, v223
v_max3_f32 v151, v138, v139, v140
v_max3_f32 v151, v151, v141, v142
v_max3_f32 v151, v151, v143, v144
v_max3_f32 v151, v151, v145, v146
v_max3_f32 v151, v151, v147, v148
v_max3_f32 v151, v151, v149, v150
v_mov_b32 v152, v151
s_nop 1
v_permlane16_swap_b32 v151, v152
v_max_f32 v151, v151, v152
v_mov_b32 v152, v151
s_nop 1
v_permlane32_swap_b32 v151, v152
v_max_f32 v151, v151, v152
v_sub_f32 v138, v138, v151
v_sub_f32 v139, v139, v151
v_sub_f32 v140, v140, v151
v_sub_f32 v141, v141, v151
v_sub_f32 v142, v142, v151
v_sub_f32 v143, v143, v151
v_sub_f32 v144, v144, v151
v_sub_f32 v145, v145, v151
v_sub_f32 v150, v150, v151
v_sub_f32 v146, v146, v151
v_sub_f32 v147, v147, v151
v_sub_f32 v148, v148, v151
v_sub_f32 v149, v149, v151
v_exp_f32 v138, v138
v_exp_f32 v139, v139
v_exp_f32 v140, v140
v_exp_f32 v141, v141
v_exp_f32 v142, v142
v_exp_f32 v143, v143
v_exp_f32 v144, v144
v_exp_f32 v145, v145
v_exp_f32 v150, v150
v_exp_f32 v146, v146
v_exp_f32 v147, v147
v_exp_f32 v148, v148
v_exp_f32 v149, v149
v_cvt_pk_bf16_f32 v174, v138, v139
v_cvt_pk_bf16_f32 v175, v140, v141
v_cvt_pk_bf16_f32 v176, v142, v143
v_cvt_pk_bf16_f32 v177, v144, v145
v_cvt_pk_bf16_f32 v178, v146, v147
v_cvt_pk_bf16_f32 v179, v148, v149
v_cvt_pk_bf16_f32 v180, v150, 0
v_mfma_f32_16x16x32_bf16 v[150:153], v[190:193], v[174:177], 0
v_mfma_f32_16x16x32_bf16 v[138:141], v[114:117], v[174:177], 0
v_mfma_f32_16x16x32_bf16 v[142:145], v[122:125], v[174:177], 0
v_mfma_f32_16x16x32_bf16 v[146:149], v[130:133], v[174:177], 0
v_mfma_f32_16x16x32_bf16 v[150:153], v[190:193], v[178:181], v[150:153]
s_waitcnt lgkmcnt(2)
v_mfma_f32_16x16x32_bf16 v[138:141], v[118:121], v[178:181], v[138:141]
s_waitcnt lgkmcnt(1)
v_mfma_f32_16x16x32_bf16 v[142:145], v[126:129], v[178:181], v[142:145]
s_waitcnt lgkmcnt(0)
v_mfma_f32_16x16x32_bf16 v[146:149], v[134:137], v[178:181], v[146:149]
v_max3_f32 v167, v154, v155, v156
v_max3_f32 v167, v167, v157, v158
v_max3_f32 v167, v167, v159, v160
v_max3_f32 v167, v167, v161, v162
v_max3_f32 v167, v167, v163, v164
v_max3_f32 v167, v167, v165, v166
v_mov_b32 v168, v167
s_nop 1
v_permlane16_swap_b32 v167, v168
v_max_f32 v167, v167, v168
v_mov_b32 v168, v167
s_nop 1
v_permlane32_swap_b32 v167, v168
v_max_f32 v167, v167, v168
v_sub_f32 v154, v154, v167
v_sub_f32 v155, v155, v167
v_sub_f32 v156, v156, v167
v_sub_f32 v157, v157, v167
v_sub_f32 v158, v158, v167
v_sub_f32 v159, v159, v167
v_sub_f32 v160, v160, v167
v_sub_f32 v161, v161, v167
v_sub_f32 v166, v166, v167
v_sub_f32 v162, v162, v167
v_sub_f32 v163, v163, v167
v_sub_f32 v164, v164, v167
v_sub_f32 v165, v165, v167
v_exp_f32 v154, v154
v_exp_f32 v155, v155
v_exp_f32 v156, v156
v_exp_f32 v157, v157
v_exp_f32 v158, v158
v_exp_f32 v159, v159
v_exp_f32 v160, v160
v_exp_f32 v161, v161
v_exp_f32 v166, v166
v_exp_f32 v162, v162
v_exp_f32 v163, v163
v_exp_f32 v164, v164
v_exp_f32 v165, v165
v_cvt_pk_bf16_f32 v174, v154, v155
v_cvt_pk_bf16_f32 v175, v156, v157
v_cvt_pk_bf16_f32 v176, v158, v159
v_cvt_pk_bf16_f32 v177, v160, v161
v_cvt_pk_bf16_f32 v178, v162, v163
v_cvt_pk_bf16_f32 v179, v164, v165
v_cvt_pk_bf16_f32 v180, v166, 0
v_mfma_f32_16x16x32_bf16 v[166:169], v[190:193], v[174:177], 0
v_mfma_f32_16x16x32_bf16 v[154:157], v[114:117], v[174:177], 0
v_mfma_f32_16x16x32_bf16 v[158:161], v[122:125], v[174:177], 0
v_mfma_f32_16x16x32_bf16 v[162:165], v[130:133], v[174:177], 0
v_mfma_f32_16x16x32_bf16 v[166:169], v[190:193], v[178:181], v[166:169]
v_mfma_f32_16x16x32_bf16 v[154:157], v[118:121], v[178:181], v[154:157]
v_mfma_f32_16x16x32_bf16 v[158:161], v[126:129], v[178:181], v[158:161]
v_mfma_f32_16x16x32_bf16 v[162:165], v[134:137], v[178:181], v[162:165]
v_rcp_f32 v151, v150
s_nop 0
v_mul_f32 v151, s3, v151
v_mul_f32 v138, v138, v151
v_mul_f32 v139, v139, v151
v_cvt_pk_bf16_f32 v138, v138, v139
v_mul_f32 v140, v140, v151
v_mul_f32 v141, v141, v151
v_cvt_pk_bf16_f32 v139, v140, v141
v_mul_f32 v142, v142, v151
v_mul_f32 v143, v143, v151
v_cvt_pk_bf16_f32 v140, v142, v143
v_mul_f32 v144, v144, v151
v_mul_f32 v145, v145, v151
v_cvt_pk_bf16_f32 v141, v144, v145
ds_write_b128 v211, v[138:141] offset:38912
v_mul_f32 v146, v146, v151
v_mul_f32 v147, v147, v151
v_cvt_pk_bf16_f32 v142, v146, v147
v_mul_f32 v148, v148, v151
v_mul_f32 v149, v149, v151
v_cvt_pk_bf16_f32 v143, v148, v149
ds_write_b64 v212, v[142:143] offset:38912
v_mfma_f32_16x16x32_bf16 v[138:141], v[78:81], v[90:93], 0
v_mfma_f32_16x16x32_bf16 v[142:145], v[96:99], v[90:93], 0
v_mfma_f32_16x16x32_bf16 v[150:153], v[108:111], v[90:93], v[206:209]
v_mfma_f32_16x16x32_bf16 v[146:149], v[102:105], v[90:93], 0
v_mfma_f32_16x16x16_bf16 v[138:141], v[82:83], v[94:95], v[138:141]
v_mfma_f32_16x16x16_bf16 v[142:145], v[100:101], v[94:95], v[142:145]
v_mfma_f32_16x16x16_bf16 v[150:153], v[112:113], v[94:95], v[150:153]
v_mfma_f32_16x16x16_bf16 v[146:149], v[106:107], v[94:95], v[146:149]
v_rcp_f32 v167, v166
s_nop 0
v_mul_f32 v167, s3, v167
v_mul_f32 v154, v154, v167
v_mul_f32 v155, v155, v167
v_cvt_pk_bf16_f32 v154, v154, v155
v_mul_f32 v156, v156, v167
v_mul_f32 v157, v157, v167
v_cvt_pk_bf16_f32 v155, v156, v157
v_mul_f32 v158, v158, v167
v_mul_f32 v159, v159, v167
v_cvt_pk_bf16_f32 v156, v158, v159
v_mul_f32 v160, v160, v167
v_mul_f32 v161, v161, v167
v_cvt_pk_bf16_f32 v157, v160, v161
ds_write_b128 v211, v[154:157] offset:45056
v_mul_f32 v162, v162, v167
v_mul_f32 v163, v163, v167
v_cvt_pk_bf16_f32 v158, v162, v163
v_mul_f32 v164, v164, v167
v_mul_f32 v165, v165, v167
v_cvt_pk_bf16_f32 v159, v164, v165
ds_write_b64 v212, v[158:159] offset:45056
v_mfma_f32_16x16x16_bf16 v[154:157], v[76:77], v[82:83], 0
v_mfma_f32_16x16x16_bf16 v[158:161], v[76:77], v[100:101], 0
v_mfma_f32_16x16x16_bf16 v[162:165], v[76:77], v[106:107], 0
v_mfma_f32_16x16x16_bf16 v[166:169], v[76:77], v[112:113], v[206:209]
v_mfma_f32_16x16x32_bf16 v[154:157], v[72:75], v[78:81], v[154:157]
v_mfma_f32_16x16x32_bf16 v[158:161], v[72:75], v[96:99], v[158:161]
v_mfma_f32_16x16x32_bf16 v[162:165], v[72:75], v[102:105], v[162:165]
v_mfma_f32_16x16x32_bf16 v[166:169], v[72:75], v[108:111], v[166:169]
v_mov_b32_dpp v154, v158 quad_perm:[0,1,2,3] row_mask:0x2 bank_mask:0xf
s_nop 1
v_mov_b32_dpp v154, v162 quad_perm:[0,1,2,3] row_mask:0x4 bank_mask:0xf
s_nop 2
v_mov_b32_dpp v154, v167 quad_perm:[0,1,2,3] row_mask:0x8 bank_mask:0xf
v_mov_b32 v155, v154
s_nop 1
v_max_f32_dpp v155, v155, v155 row_ror:8 row_mask:0xf bank_mask:0xf
s_nop 1
v_max_f32_dpp v155, v155, v155 row_ror:4 row_mask:0xf bank_mask:0xf
s_nop 1
v_max_f32_dpp v155, v155, v155 row_ror:2 row_mask:0xf bank_mask:0xf
s_nop 1
v_max_f32_dpp v155, v155, v155 row_ror:1 row_mask:0xf bank_mask:0xf
v_mov_b32 v156, v155
s_nop 1
v_permlane16_swap_b32 v155, v156
v_max_f32 v155, v155, v156
v_mov_b32 v156, v155
s_nop 1
v_permlane32_swap_b32 v155, v156
v_max_f32 v155, v155, v156
v_sub_f32 v154, v154, v155
v_exp_f32 v154, v154
s_nop 0
v_cvt_pk_bf16_f32 v154, v154, 0
ds_write_b16 v214, v154
s_waitcnt lgkmcnt(1)
ds_read_b128 v[84:87], v215
ds_read_b128 v[88:91], v215 offset:16
v_add_u32 v215, 1552, v215
s_barrier
ds_read_b128 v[170:173], v210 offset:38912
s_waitcnt lgkmcnt(0)
v_mfma_f32_16x16x32_bf16 v[36:39], a[144:147], v[170:173], v[36:39]
v_mfma_f32_16x16x32_bf16 v[40:43], a[168:171], v[170:173], v[40:43]
v_mfma_f32_16x16x32_bf16 v[44:47], a[192:195], v[170:173], v[44:47]
ds_read_b128 v[182:185], v210 offset:39936
s_waitcnt lgkmcnt(0)
v_mfma_f32_16x16x32_bf16 v[36:39], a[148:151], v[182:185], v[36:39]
v_mfma_f32_16x16x32_bf16 v[40:43], a[172:175], v[182:185], v[40:43]
v_mfma_f32_16x16x32_bf16 v[44:47], a[196:199], v[182:185], v[44:47]
ds_read_b128 v[186:189], v210 offset:40960
s_waitcnt lgkmcnt(0)
v_mfma_f32_16x16x32_bf16 v[36:39], a[152:155], v[186:189], v[36:39]
v_mfma_f32_16x16x32_bf16 v[40:43], a[176:179], v[186:189], v[40:43]
v_mfma_f32_16x16x32_bf16 v[44:47], a[200:203], v[186:189], v[44:47]
ds_read_b128 v[170:173], v210 offset:41984
s_waitcnt lgkmcnt(0)
v_mfma_f32_16x16x32_bf16 v[36:39], a[156:159], v[170:173], v[36:39]
v_mfma_f32_16x16x32_bf16 v[40:43], a[180:183], v[170:173], v[40:43]
v_mfma_f32_16x16x32_bf16 v[44:47], a[204:207], v[170:173], v[44:47]
ds_read_b128 v[182:185], v210 offset:43008
s_waitcnt lgkmcnt(0)
v_mfma_f32_16x16x32_bf16 v[36:39], a[160:163], v[182:185], v[36:39]
v_mfma_f32_16x16x32_bf16 v[40:43], a[184:187], v[182:185], v[40:43]
v_mfma_f32_16x16x32_bf16 v[44:47], a[208:211], v[182:185], v[44:47]
ds_read_b128 v[186:189], v210 offset:44032
s_waitcnt lgkmcnt(0)
v_mfma_f32_16x16x32_bf16 v[36:39], a[164:167], v[186:189], v[36:39]
v_mfma_f32_16x16x32_bf16 v[40:43], a[188:191], v[186:189], v[40:43]
v_mfma_f32_16x16x32_bf16 v[44:47], a[212:215], v[186:189], v[44:47]
v_cvt_pk_bf16_f32 v72, v36, v37
v_cvt_pk_bf16_f32 v73, v38, v39
buffer_store_dwordx2 v[72:73], v203, s[8:11], s39 offen
v_cvt_pk_bf16_f32 v74, v40, v41
v_cvt_pk_bf16_f32 v75, v42, v43
buffer_store_dwordx2 v[74:75], v203, s[8:11], s39 offen offset:32
s_nop 0
v_cvt_pk_bf16_f32 v76, v44, v45
v_cvt_pk_bf16_f32 v77, v46, v47
buffer_store_dwordx2 v[76:77], v203, s[8:11], s39 offen offset:64
v_max3_f32 v151, v138, v139, v140
v_max3_f32 v151, v151, v141, v142
v_max3_f32 v151, v151, v143, v144
v_max3_f32 v151, v151, v145, v146
v_max3_f32 v151, v151, v147, v148
v_max3_f32 v151, v151, v149, v150
v_mov_b32 v152, v151
s_nop 1
v_permlane16_swap_b32 v151, v152
v_max_f32 v151, v151, v152
v_mov_b32 v152, v151
s_nop 1
v_permlane32_swap_b32 v151, v152
v_max_f32 v151, v151, v152
v_sub_f32 v138, v138, v151
v_sub_f32 v139, v139, v151
v_sub_f32 v140, v140, v151
v_sub_f32 v141, v141, v151
v_sub_f32 v142, v142, v151
v_sub_f32 v143, v143, v151
v_sub_f32 v144, v144, v151
v_sub_f32 v145, v145, v151
v_sub_f32 v150, v150, v151
v_sub_f32 v146, v146, v151
v_sub_f32 v147, v147, v151
v_sub_f32 v148, v148, v151
v_sub_f32 v149, v149, v151
v_exp_f32 v138, v138
v_exp_f32 v139, v139
v_exp_f32 v140, v140
v_exp_f32 v141, v141
v_exp_f32 v142, v142
v_exp_f32 v143, v143
v_exp_f32 v144, v144
v_exp_f32 v145, v145
v_exp_f32 v150, v150
v_exp_f32 v146, v146
v_exp_f32 v147, v147
v_exp_f32 v148, v148
v_exp_f32 v149, v149
v_cvt_pk_bf16_f32 v174, v138, v139
v_cvt_pk_bf16_f32 v175, v140, v141
v_cvt_pk_bf16_f32 v176, v142, v143
v_cvt_pk_bf16_f32 v177, v144, v145
v_cvt_pk_bf16_f32 v178, v146, v147
v_cvt_pk_bf16_f32 v179, v148, v149
v_cvt_pk_bf16_f32 v180, v150, 0
v_mfma_f32_16x16x32_bf16 v[150:153], v[190:193], v[174:177], 0
v_mfma_f32_16x16x32_bf16 v[138:141], v[114:117], v[174:177], 0
v_mfma_f32_16x16x32_bf16 v[142:145], v[122:125], v[174:177], 0
v_mfma_f32_16x16x32_bf16 v[146:149], v[130:133], v[174:177], 0
v_mfma_f32_16x16x32_bf16 v[150:153], v[190:193], v[178:181], v[150:153]
v_mfma_f32_16x16x32_bf16 v[138:141], v[118:121], v[178:181], v[138:141]
v_mfma_f32_16x16x32_bf16 v[142:145], v[126:129], v[178:181], v[142:145]
v_mfma_f32_16x16x32_bf16 v[146:149], v[134:137], v[178:181], v[146:149]
v_mfma_f32_16x16x32_bf16 v[166:169], v[84:87], v[190:193], 0
v_mfma_f32_16x16x32_bf16 v[154:157], v[84:87], v[114:117], 0
v_mfma_f32_16x16x32_bf16 v[158:161], v[84:87], v[122:125], 0
v_mfma_f32_16x16x32_bf16 v[162:165], v[84:87], v[130:133], 0
v_mfma_f32_16x16x32_bf16 v[166:169], v[88:91], v[190:193], v[166:169]
v_mfma_f32_16x16x32_bf16 v[154:157], v[88:91], v[118:121], v[154:157]
v_mfma_f32_16x16x32_bf16 v[158:161], v[88:91], v[126:129], v[158:161]
v_mfma_f32_16x16x32_bf16 v[162:165], v[88:91], v[134:137], v[162:165]
v_rcp_f32 v167, v166
s_nop 1
v_mov_b32_dpp v154, v158 quad_perm:[0,1,2,3] row_mask:0x2 bank_mask:0xf
s_nop 2
v_mov_b32_dpp v154, v162 quad_perm:[0,1,2,3] row_mask:0x4 bank_mask:0xf
v_mul_f32 v167, s3, v167
v_mul_f32 v154, v154, v167
v_cvt_pk_bf16_f32 v154, v154, 0
ds_write_b16 v214, v154
v_add_u32 v214, 1552, v214
ds_read_b128 v[170:173], v210 offset:45056
s_waitcnt lgkmcnt(0)
v_mfma_f32_16x16x32_bf16 v[48:51], a[144:147], v[170:173], v[48:51]
v_mfma_f32_16x16x32_bf16 v[52:55], a[168:171], v[170:173], v[52:55]
v_mfma_f32_16x16x32_bf16 v[56:59], a[192:195], v[170:173], v[56:59]
ds_read_b128 v[182:185], v210 offset:46080
s_waitcnt lgkmcnt(0)
v_mfma_f32_16x16x32_bf16 v[48:51], a[148:151], v[182:185], v[48:51]
v_mfma_f32_16x16x32_bf16 v[52:55], a[172:175], v[182:185], v[52:55]
v_mfma_f32_16x16x32_bf16 v[56:59], a[196:199], v[182:185], v[56:59]
ds_read_b128 v[186:189], v210 offset:47104
s_waitcnt lgkmcnt(0)
v_mfma_f32_16x16x32_bf16 v[48:51], a[152:155], v[186:189], v[48:51]
v_mfma_f32_16x16x32_bf16 v[52:55], a[176:179], v[186:189], v[52:55]
v_mfma_f32_16x16x32_bf16 v[56:59], a[200:203], v[186:189], v[56:59]
ds_read_b128 v[170:173], v210 offset:48128
s_waitcnt lgkmcnt(0)
v_mfma_f32_16x16x32_bf16 v[48:51], a[156:159], v[170:173], v[48:51]
v_mfma_f32_16x16x32_bf16 v[52:55], a[180:183], v[170:173], v[52:55]
v_mfma_f32_16x16x32_bf16 v[56:59], a[204:207], v[170:173], v[56:59]
ds_read_b128 v[182:185], v210 offset:49152
s_waitcnt lgkmcnt(0)
v_mfma_f32_16x16x32_bf16 v[48:51], a[160:163], v[182:185], v[48:51]
v_mfma_f32_16x16x32_bf16 v[52:55], a[184:187], v[182:185], v[52:55]
v_mfma_f32_16x16x32_bf16 v[56:59], a[208:211], v[182:185], v[56:59]
ds_read_b128 v[186:189], v210 offset:50176
s_waitcnt lgkmcnt(0)
v_mfma_f32_16x16x32_bf16 v[48:51], a[164:167], v[186:189], v[48:51]
v_mfma_f32_16x16x32_bf16 v[52:55], a[188:191], v[186:189], v[52:55]
v_mfma_f32_16x16x32_bf16 v[56:59], a[212:215], v[186:189], v[56:59]
v_cvt_pk_bf16_f32 v78, v48, v49
v_cvt_pk_bf16_f32 v79, v50, v51
buffer_store_dwordx2 v[78:79], v204, s[8:11], s39 offen
v_cvt_pk_bf16_f32 v80, v52, v53
v_cvt_pk_bf16_f32 v81, v54, v55
buffer_store_dwordx2 v[80:81], v204, s[8:11], s39 offen offset:32
s_nop 0
v_cvt_pk_bf16_f32 v82, v56, v57
v_cvt_pk_bf16_f32 v83, v58, v59
buffer_store_dwordx2 v[82:83], v204, s[8:11], s39 offen offset:64
v_rcp_f32 v151, v150
s_nop 0
v_mul_f32 v151, s3, v151
v_mul_f32 v138, v138, v151
v_mul_f32 v139, v139, v151
v_cvt_pk_bf16_f32 v138, v138, v139
v_mul_f32 v140, v140, v151
v_mul_f32 v141, v141, v151
v_cvt_pk_bf16_f32 v139, v140, v141
v_mul_f32 v142, v142, v151
v_mul_f32 v143, v143, v151
v_cvt_pk_bf16_f32 v140, v142, v143
v_mul_f32 v144, v144, v151
v_mul_f32 v145, v145, v151
v_cvt_pk_bf16_f32 v141, v144, v145
ds_write_b128 v211, v[138:141] offset:51200
v_mul_f32 v146, v146, v151
v_mul_f32 v147, v147, v151
v_cvt_pk_bf16_f32 v142, v146, v147
v_mul_f32 v148, v148, v151
v_mul_f32 v149, v149, v151
v_cvt_pk_bf16_f32 v143, v148, v149
ds_write_b64 v212, v[142:143] offset:51200
s_waitcnt vmcnt(6) lgkmcnt(0)
s_barrier
ds_read_b128 v[170:173], v210 offset:51200
s_waitcnt lgkmcnt(0)
v_mfma_f32_16x16x32_bf16 v[60:63], a[144:147], v[170:173], v[60:63]
v_mfma_f32_16x16x32_bf16 v[64:67], a[168:171], v[170:173], v[64:67]
v_mfma_f32_16x16x32_bf16 v[68:71], a[192:195], v[170:173], v[68:71]
ds_read_b128 v[182:185], v210 offset:52224
s_waitcnt lgkmcnt(0)
v_mfma_f32_16x16x32_bf16 v[60:63], a[148:151], v[182:185], v[60:63]
v_mfma_f32_16x16x32_bf16 v[64:67], a[172:175], v[182:185], v[64:67]
v_mfma_f32_16x16x32_bf16 v[68:71], a[196:199], v[182:185], v[68:71]
ds_read_b128 v[186:189], v210 offset:53248
s_waitcnt lgkmcnt(0)
v_mfma_f32_16x16x32_bf16 v[60:63], a[152:155], v[186:189], v[60:63]
v_mfma_f32_16x16x32_bf16 v[64:67], a[176:179], v[186:189], v[64:67]
v_mfma_f32_16x16x32_bf16 v[68:71], a[200:203], v[186:189], v[68:71]
ds_read_b128 v[170:173], v210 offset:54272
s_waitcnt lgkmcnt(0)
v_mfma_f32_16x16x32_bf16 v[60:63], a[156:159], v[170:173], v[60:63]
v_mfma_f32_16x16x32_bf16 v[64:67], a[180:183], v[170:173], v[64:67]
v_mfma_f32_16x16x32_bf16 v[68:71], a[204:207], v[170:173], v[68:71]
ds_read_b128 v[182:185], v210 offset:55296
s_waitcnt lgkmcnt(0)
v_mfma_f32_16x16x32_bf16 v[60:63], a[160:163], v[182:185], v[60:63]
v_mfma_f32_16x16x32_bf16 v[64:67], a[184:187], v[182:185], v[64:67]
v_mfma_f32_16x16x32_bf16 v[68:71], a[208:211], v[182:185], v[68:71]
ds_read_b128 v[186:189], v210 offset:56320
s_waitcnt lgkmcnt(0)
v_mfma_f32_16x16x32_bf16 v[60:63], a[164:167], v[186:189], v[60:63]
v_mfma_f32_16x16x32_bf16 v[64:67], a[188:191], v[186:189], v[64:67]
v_mfma_f32_16x16x32_bf16 v[68:71], a[212:215], v[186:189], v[68:71]
v_cvt_pk_bf16_f32 v116, v60, v61
v_cvt_pk_bf16_f32 v117, v62, v63
buffer_store_dwordx2 v[116:117], v205, s[8:11], s39 offen
v_cvt_pk_bf16_f32 v124, v64, v65
v_cvt_pk_bf16_f32 v125, v66, v67
buffer_store_dwordx2 v[124:125], v205, s[8:11], s39 offen offset:32
s_nop 0
v_cvt_pk_bf16_f32 v132, v68, v69
v_cvt_pk_bf16_f32 v133, v70, v71
buffer_store_dwordx2 v[132:133], v205, s[8:11], s39 offen offset:64
s_mov_b32 s38, s36
ds_read_b128 v[174:177], v217
ds_read_b128 v[84:87], v200
s_waitcnt lgkmcnt(0)
v_mfma_f32_16x16x32_bf16 v[36:39], v[174:177], v[84:87], 0
ds_read_b128 v[92:95], v201
s_waitcnt lgkmcnt(0)
v_mfma_f32_16x16x32_bf16 v[48:51], v[174:177], v[92:95], 0
ds_read_b128 v[100:103], v202
s_waitcnt lgkmcnt(0)
v_mfma_f32_16x16x32_bf16 v[60:63], v[174:177], v[100:103], 0
ds_read_b128 v[178:181], v217 offset:528
ds_read_b128 v[84:87], v194
ds_read_b128 v[88:91], v194 offset:16
s_waitcnt lgkmcnt(0)
v_smfmac_f32_16x16x64_bf16 v[36:39], v[178:181], v[84:91], v213
ds_read_b128 v[92:95], v195
ds_read_b128 v[96:99], v195 offset:16
s_waitcnt lgkmcnt(0)
v_smfmac_f32_16x16x64_bf16 v[48:51], v[178:181], v[92:99], v213
ds_read_b128 v[100:103], v196
ds_read_b128 v[104:107], v196 offset:16
s_waitcnt lgkmcnt(0)
v_smfmac_f32_16x16x64_bf16 v[60:63], v[178:181], v[100:107], v213
ds_read_b128 v[174:177], v217 offset:1056
ds_read_b128 v[84:87], v197
ds_read_b128 v[88:91], v197 offset:16
s_waitcnt lgkmcnt(0)
v_smfmac_f32_16x16x64_bf16 v[36:39], v[174:177], v[84:91], v213
ds_read_b128 v[92:95], v198
ds_read_b128 v[96:99], v198 offset:16
s_waitcnt lgkmcnt(0)
v_smfmac_f32_16x16x64_bf16 v[48:51], v[174:177], v[92:99], v213
ds_read_b128 v[100:103], v199
ds_read_b128 v[104:107], v199 offset:16
s_waitcnt lgkmcnt(0)
v_smfmac_f32_16x16x64_bf16 v[60:63], v[174:177], v[100:107], v213
ds_read_b128 v[178:181], v217 offset:1584
ds_read_b128 v[84:87], v200 offset:32
s_waitcnt lgkmcnt(0)
v_mfma_f32_16x16x32_bf16 v[40:43], v[178:181], v[84:87], 0
ds_read_b128 v[92:95], v201 offset:32
s_waitcnt lgkmcnt(0)
v_mfma_f32_16x16x32_bf16 v[52:55], v[178:181], v[92:95], 0
ds_read_b128 v[100:103], v202 offset:32
s_waitcnt lgkmcnt(0)
v_mfma_f32_16x16x32_bf16 v[64:67], v[178:181], v[100:103], 0
ds_read_b128 v[174:177], v217 offset:2112
ds_read_b128 v[84:87], v194 offset:32
ds_read_b128 v[88:91], v194 offset:48
s_waitcnt lgkmcnt(0)
v_smfmac_f32_16x16x64_bf16 v[40:43], v[174:177], v[84:91], v213
ds_read_b128 v[92:95], v195 offset:32
ds_read_b128 v[96:99], v195 offset:48
s_waitcnt lgkmcnt(0)
v_smfmac_f32_16x16x64_bf16 v[52:55], v[174:177], v[92:99], v213
ds_read_b128 v[100:103], v196 offset:32
ds_read_b128 v[104:107], v196 offset:48
s_waitcnt lgkmcnt(0)
v_smfmac_f32_16x16x64_bf16 v[64:67], v[174:177], v[100:107], v213
ds_read_b128 v[178:181], v217 offset:2640
ds_read_b128 v[84:87], v197 offset:32
ds_read_b128 v[88:91], v197 offset:48
s_waitcnt lgkmcnt(0)
v_smfmac_f32_16x16x64_bf16 v[40:43], v[178:181], v[84:91], v213
ds_read_b128 v[92:95], v198 offset:32
ds_read_b128 v[96:99], v198 offset:48
s_waitcnt lgkmcnt(0)
v_smfmac_f32_16x16x64_bf16 v[52:55], v[178:181], v[92:99], v213
ds_read_b128 v[100:103], v199 offset:32
ds_read_b128 v[104:107], v199 offset:48
s_waitcnt lgkmcnt(0)
v_smfmac_f32_16x16x64_bf16 v[64:67], v[178:181], v[100:107], v213
ds_read_b128 v[174:177], v217 offset:3168
ds_read_b128 v[84:87], v200 offset:64
s_waitcnt lgkmcnt(0)
v_mfma_f32_16x16x32_bf16 v[44:47], v[174:177], v[84:87], 0
ds_read_b128 v[92:95], v201 offset:64
s_waitcnt lgkmcnt(0)
v_mfma_f32_16x16x32_bf16 v[56:59], v[174:177], v[92:95], 0
ds_read_b128 v[100:103], v202 offset:64
s_waitcnt lgkmcnt(0)
v_mfma_f32_16x16x32_bf16 v[68:71], v[174:177], v[100:103], 0
ds_read_b128 v[178:181], v217 offset:3696
ds_read_b128 v[84:87], v194 offset:64
ds_read_b128 v[88:91], v194 offset:80
s_waitcnt lgkmcnt(0)
v_smfmac_f32_16x16x64_bf16 v[44:47], v[178:181], v[84:91], v213
ds_read_b128 v[92:95], v195 offset:64
ds_read_b128 v[96:99], v195 offset:80
s_waitcnt lgkmcnt(0)
v_smfmac_f32_16x16x64_bf16 v[56:59], v[178:181], v[92:99], v213
ds_read_b128 v[100:103], v196 offset:64
ds_read_b128 v[104:107], v196 offset:80
s_waitcnt lgkmcnt(0)
v_smfmac_f32_16x16x64_bf16 v[68:71], v[178:181], v[100:107], v213
ds_read_b128 v[174:177], v217 offset:4224
ds_read_b128 v[84:87], v197 offset:64
ds_read_b128 v[88:91], v197 offset:80
s_waitcnt lgkmcnt(0)
v_smfmac_f32_16x16x64_bf16 v[44:47], v[174:177], v[84:91], v213
ds_read_b128 v[92:95], v198 offset:64
ds_read_b128 v[96:99], v198 offset:80
s_waitcnt lgkmcnt(0)
v_smfmac_f32_16x16x64_bf16 v[56:59], v[174:177], v[92:99], v213
ds_read_b128 v[100:103], v199 offset:64
ds_read_b128 v[104:107], v199 offset:80
s_waitcnt lgkmcnt(0)
v_smfmac_f32_16x16x64_bf16 v[68:71], v[174:177], v[100:107], v213
v_add_f32 v118, v36, v37
v_mul_f32 v119, v36, v36
v_add_f32 v118, v118, v38
v_fmac_f32 v119, v37, v37
v_add_f32 v118, v118, v39
v_fmac_f32 v119, v38, v38
v_fmac_f32 v119, v39, v39
v_add_f32 v126, v48, v49
v_mul_f32 v127, v48, v48
v_add_f32 v126, v126, v50
v_fmac_f32 v127, v49, v49
v_add_f32 v126, v126, v51
v_fmac_f32 v127, v50, v50
v_fmac_f32 v127, v51, v51
v_add_f32 v134, v60, v61
v_mul_f32 v135, v60, v60
v_add_f32 v134, v134, v62
v_fmac_f32 v135, v61, v61
v_add_f32 v134, v134, v63
v_fmac_f32 v135, v62, v62
v_fmac_f32 v135, v63, v63
v_add_f32 v118, v118, v40
v_fmac_f32 v119, v40, v40
v_add_f32 v118, v118, v41
v_fmac_f32 v119, v41, v41
v_add_f32 v118, v118, v42
v_fmac_f32 v119, v42, v42
v_add_f32 v118, v118, v43
v_fmac_f32 v119, v43, v43
v_add_f32 v126, v126, v52
v_fmac_f32 v127, v52, v52
v_add_f32 v126, v126, v53
v_fmac_f32 v127, v53, v53
v_add_f32 v126, v126, v54
v_fmac_f32 v127, v54, v54
v_add_f32 v126, v126, v55
v_fmac_f32 v127, v55, v55
v_add_f32 v134, v134, v64
v_fmac_f32 v135, v64, v64
v_add_f32 v134, v134, v65
v_fmac_f32 v135, v65, v65
v_add_f32 v134, v134, v66
v_fmac_f32 v135, v66, v66
v_add_f32 v134, v134, v67
v_fmac_f32 v135, v67, v67
v_add_f32 v118, v118, v44
v_fmac_f32 v119, v44, v44
v_add_f32 v118, v118, v45
v_fmac_f32 v119, v45, v45
v_add_f32 v118, v118, v46
v_fmac_f32 v119, v46, v46
v_add_f32 v118, v118, v47
v_fmac_f32 v119, v47, v47
v_add_f32 v126, v126, v56
v_fmac_f32 v127, v56, v56
v_add_f32 v126, v126, v57
v_fmac_f32 v127, v57, v57
v_add_f32 v126, v126, v58
v_fmac_f32 v127, v58, v58
v_add_f32 v126, v126, v59
v_fmac_f32 v127, v59, v59
v_add_f32 v134, v134, v68
v_fmac_f32 v135, v68, v68
v_add_f32 v134, v134, v69
v_fmac_f32 v135, v69, v69
v_add_f32 v134, v134, v70
v_fmac_f32 v135, v70, v70
v_add_f32 v134, v134, v71
v_fmac_f32 v135, v71, v71
v_permlane16_swap_b32 v118, v119
v_add_f32 v118, v118, v119
v_permlane16_swap_b32 v126, v127
v_add_f32 v126, v126, v127
v_permlane16_swap_b32 v134, v135
v_add_f32 v134, v134, v135
v_permlane32_swap_b32 v118, v126
v_add_f32 v118, v118, v126
ds_write_b32 v209, v118
v_mov_b32 v135, v134
s_nop 1
v_permlane32_swap_b32 v134, v135
v_add_f32 v134, v134, v135
ds_write_b32 v209, v134 offset:512
s_waitcnt lgkmcnt(0)
s_barrier
s_mul_hi_u32 s41, s35, 58835169
s_mul_i32 s42, s41, 73
s_sub_u32 s42, s35, s42
s_mul_i32 s43, s41, 1373568
s_mul_i32 s51, s42, 2688
s_add_u32 s43, s43, s51
s_cmp_lt_u32 s35, s34
s_cselect_b32 s50, s43, 1879048192
s_add_u32 s35, s35, 32
s_cmp_eq_u32 s42, 0
s_cselect_b32 s44, 536870911, s72
s_cmp_eq_u32 s42, 72
s_cselect_b32 s44, 939524095, s44
s_cmp_eq_u32 s41, 0
s_cselect_b32 s52, 1879048192, s50
s_mov_b32 s36, s50
v_and_b32 v180, s44, v208
s_add_u32 m0, s45, 0
s_nop 0
buffer_load_dwordx4 v180, s[4:7], s52 offen nt lds
s_add_u32 m0, s45, 4112
s_add_u32 s40, s36, 196224
buffer_load_dwordx4 v180, s[4:7], s40 offen nt lds
s_add_u32 m0, s45, 8224
s_add_u32 s40, s36, 392448
buffer_load_dwordx4 v180, s[4:7], s40 offen nt lds
s_add_u32 m0, s45, 12336
s_add_u32 s40, s36, 588672
buffer_load_dwordx4 v180, s[4:7], s40 offen nt lds
s_add_u32 m0, s45, 16448
s_add_u32 s40, s36, 784896
buffer_load_dwordx4 v180, s[4:7], s40 offen nt lds
s_add_u32 m0, s45, 20560
s_add_u32 s40, s36, 981120
buffer_load_dwordx4 v180, s[4:7], s40 offen nt lds
s_add_u32 m0, s45, 24672
s_add_u32 s40, s36, 1177344
buffer_load_dwordx4 v180, s[4:7], s40 offen nt lds
s_add_u32 m0, s45, 28784
s_add_u32 s40, s36, 1373568
buffer_load_dwordx4 v180, s[4:7], s40 offen nt lds
s_add_u32 m0, s45, 32896
s_add_u32 s40, s36, 1569792
buffer_load_dwordx4 v180, s[4:7], s40 offen nt lds
ds_read_b128 v[102:105], v210 offset:18432
ds_read_b128 v[106:109], v210 offset:19456
s_waitcnt lgkmcnt(1)
v_add_f32 v102, v102, v103
s_waitcnt lgkmcnt(0)
v_add_f32 v106, v106, v107
v_add_f32 v104, v104, v105
v_add_f32 v108, v108, v109
v_add_f32 v102, v102, v104
v_add_f32 v106, v106, v108
v_mul_f32 v103, s48, v102
v_mul_f32 v104, s73, v102
v_mul_f32 v106, s73, v106
v_fma_f32 v106, -v103, v104, v106
v_max_f32 v106, 0, v106
v_add_f32 v106, s49, v106
v_rsq_f32 v102, v106
s_nop 0
v_mul_f32_e64 v103, -v103, v102
ds_write_b64 v211, v[102:103] offset:20480
ds_read_b64 v[118:119], v219 offset:20480
ds_read_b64 v[126:127], v219 offset:20736
ds_read_b64 v[134:135], v219 offset:20992
s_waitcnt lgkmcnt(2)
v_fma_f32 v220, v36, v118, v119
v_fma_f32 v221, v37, v118, v119
v_cvt_pk_bf16_f32 v90, v220, v221
v_fma_f32 v222, v38, v118, v119
v_fma_f32 v223, v39, v118, v119
v_cvt_pk_bf16_f32 v91, v222, v223
v_fma_f32 v220, v40, v118, v119
v_fma_f32 v221, v41, v118, v119
v_cvt_pk_bf16_f32 v92, v220, v221
v_fma_f32 v222, v42, v118, v119
v_fma_f32 v223, v43, v118, v119
v_cvt_pk_bf16_f32 v93, v222, v223
ds_write_b128 v211, v[90:93] offset:20480
v_fma_f32 v220, v44, v118, v119
v_fma_f32 v221, v45, v118, v119
v_cvt_pk_bf16_f32 v94, v220, v221
v_fma_f32 v222, v46, v118, v119
v_fma_f32 v223, v47, v118, v119
v_cvt_pk_bf16_f32 v95, v222, v223
s_waitcnt lgkmcnt(2)
ds_write_b64 v212, v[94:95] offset:20480
v_fma_f32 v220, v48, v126, v127
v_fma_f32 v221, v49, v126, v127
v_cvt_pk_bf16_f32 v174, v220, v221
v_fma_f32 v222, v50, v126, v127
v_fma_f32 v223, v51, v126, v127
v_cvt_pk_bf16_f32 v175, v222, v223
v_fma_f32 v220, v52, v126, v127
v_fma_f32 v221, v53, v126, v127
v_cvt_pk_bf16_f32 v176, v220, v221
v_fma_f32 v222, v54, v126, v127
v_fma_f32 v223, v55, v126, v127
v_cvt_pk_bf16_f32 v177, v222, v223
ds_write_b128 v211, v[174:177] offset:26624
v_fma_f32 v220, v56, v126, v127
v_fma_f32 v221, v57, v126, v127
v_cvt_pk_bf16_f32 v178, v220, v221
v_fma_f32 v222, v58, v126, v127
v_fma_f32 v223, v59, v126, v127
v_cvt_pk_bf16_f32 v179, v222, v223
s_waitcnt lgkmcnt(3)
ds_write_b64 v212, v[178:179] offset:26624
v_fma_f32 v220, v60, v134, v135
v_fma_f32 v221, v61, v134, v135
v_cvt_pk_bf16_f32 v90, v220, v221
v_fma_f32 v222, v62, v134, v135
v_fma_f32 v223, v63, v134, v135
v_cvt_pk_bf16_f32 v91, v222, v223
v_fma_f32 v220, v64, v134, v135
v_fma_f32 v221, v65, v134, v135
v_cvt_pk_bf16_f32 v92, v220, v221
v_fma_f32 v222, v66, v134, v135
v_fma_f32 v223, v67, v134, v135
v_cvt_pk_bf16_f32 v93, v222, v223
ds_write_b128 v211, v[90:93] offset:32768
v_fma_f32 v220, v68, v134, v135
v_fma_f32 v221, v69, v134, v135
v_cvt_pk_bf16_f32 v94, v220, v221
v_fma_f32 v222, v70, v134, v135
v_fma_f32 v223, v71, v134, v135
v_cvt_pk_bf16_f32 v95, v222, v223
ds_write_b64 v212, v[94:95] offset:32768
ds_read_b128 v[182:185], v210
s_waitcnt lgkmcnt(0)
v_mfma_f32_16x16x32_bf16 v[138:141], a[0:3], v[182:185], 0
v_mfma_f32_16x16x32_bf16 v[142:145], a[24:27], v[182:185], 0
v_mfma_f32_16x16x32_bf16 v[146:149], a[48:51], v[182:185], 0
v_mfma_f32_16x16x32_bf16 v[150:153], a[216:219], v[182:185], 0
v_mfma_f32_16x16x32_bf16 v[154:157], a[240:243], v[182:185], 0
v_mfma_f32_16x16x32_bf16 v[158:161], v[232:235], v[182:185], 0
v_mfma_f32_16x16x32_bf16 v[162:165], v[182:185], a[72:75], 0
v_mfma_f32_16x16x32_bf16 v[166:169], v[182:185], a[96:99], 0
v_mfma_f32_16x16x32_bf16 v[170:173], v[182:185], a[120:123], 0
ds_read_b128 v[186:189], v210 offset:1024
s_waitcnt lgkmcnt(0)
v_mfma_f32_16x16x32_bf16 v[138:141], a[4:7], v[186:189], v[138:141]
v_mfma_f32_16x16x32_bf16 v[142:145], a[28:31], v[186:189], v[142:145]
v_mfma_f32_16x16x32_bf16 v[146:149], a[52:55], v[186:189], v[146:149]
v_mfma_f32_16x16x32_bf16 v[150:153], a[220:223], v[186:189], v[150:153]
v_mfma_f32_16x16x32_bf16 v[154:157], a[244:247], v[186:189], v[154:157]
v_mfma_f32_16x16x32_bf16 v[158:161], v[236:239], v[186:189], v[158:161]
v_mfma_f32_16x16x32_bf16 v[162:165], v[186:189], a[76:79], v[162:165]
v_mfma_f32_16x16x32_bf16 v[166:169], v[186:189], a[100:103], v[166:169]
v_mfma_f32_16x16x32_bf16 v[170:173], v[186:189], a[124:127], v[170:173]
ds_read_b128 v[182:185], v210 offset:2048
s_waitcnt lgkmcnt(0)
v_mfma_f32_16x16x32_bf16 v[138:141], a[8:11], v[182:185], v[138:141]
v_mfma_f32_16x16x32_bf16 v[142:145], a[32:35], v[182:185], v[142:145]
v_mfma_f32_16x16x32_bf16 v[146:149], a[56:59], v[182:185], v[146:149]
v_mfma_f32_16x16x32_bf16 v[150:153], a[224:227], v[182:185], v[150:153]
v_mfma_f32_16x16x32_bf16 v[154:157], a[248:251], v[182:185], v[154:157]
v_mfma_f32_16x16x32_bf16 v[158:161], v[240:243], v[182:185], v[158:161]
v_mfma_f32_16x16x32_bf16 v[162:165], v[182:185], a[80:83], v[162:165]
v_mfma_f32_16x16x32_bf16 v[166:169], v[182:185], a[104:107], v[166:169]
v_mfma_f32_16x16x32_bf16 v[170:173], v[182:185], a[128:131], v[170:173]
ds_read_b128 v[186:189], v210 offset:3072
s_waitcnt lgkmcnt(0)
v_mfma_f32_16x16x32_bf16 v[138:141], a[12:15], v[186:189], v[138:141]
v_mfma_f32_16x16x32_bf16 v[142:145], a[36:39], v[186:189], v[142:145]
v_mfma_f32_16x16x32_bf16 v[146:149], a[60:63], v[186:189], v[146:149]
v_mfma_f32_16x16x32_bf16 v[150:153], a[228:231], v[186:189], v[150:153]
v_mfma_f32_16x16x32_bf16 v[154:157], a[252:255], v[186:189], v[154:157]
v_mfma_f32_16x16x32_bf16 v[158:161], v[244:247], v[186:189], v[158:161]
v_mfma_f32_16x16x32_bf16 v[162:165], v[186:189], a[84:87], v[162:165]
v_mfma_f32_16x16x32_bf16 v[166:169], v[186:189], a[108:111], v[166:169]
v_mfma_f32_16x16x32_bf16 v[170:173], v[186:189], a[132:135], v[170:173]
ds_read_b128 v[182:185], v210 offset:4096
s_waitcnt lgkmcnt(0)
v_mfma_f32_16x16x32_bf16 v[138:141], a[16:19], v[182:185], v[138:141]
v_mfma_f32_16x16x32_bf16 v[142:145], a[40:43], v[182:185], v[142:145]
v_mfma_f32_16x16x32_bf16 v[146:149], a[64:67], v[182:185], v[146:149]
v_mfma_f32_16x16x32_bf16 v[150:153], a[232:235], v[182:185], v[150:153]
v_mfma_f32_16x16x32_bf16 v[154:157], v[224:227], v[182:185], v[154:157]
v_mfma_f32_16x16x32_bf16 v[158:161], v[248:251], v[182:185], v[158:161]
v_mfma_f32_16x16x32_bf16 v[162:165], v[182:185], a[88:91], v[162:165]
v_mfma_f32_16x16x32_bf16 v[166:169], v[182:185], a[112:115], v[166:169]
v_mfma_f32_16x16x32_bf16 v[170:173], v[182:185], a[136:139], v[170:173]
ds_read_b128 v[186:189], v210 offset:5120
s_waitcnt lgkmcnt(0)
v_mfma_f32_16x16x32_bf16 v[138:141], a[20:23], v[186:189], v[138:141]
v_mfma_f32_16x16x32_bf16 v[142:145], a[44:47], v[186:189], v[142:145]
v_mfma_f32_16x16x32_bf16 v[146:149], a[68:71], v[186:189], v[146:149]
v_mfma_f32_16x16x32_bf16 v[150:153], a[236:239], v[186:189], v[150:153]
v_mfma_f32_16x16x32_bf16 v[154:157], v[228:231], v[186:189], v[154:157]
v_mfma_f32_16x16x32_bf16 v[158:161], v[252:255], v[186:189], v[158:161]
v_mfma_f32_16x16x32_bf16 v[162:165], v[186:189], a[92:95], v[162:165]
v_mfma_f32_16x16x32_bf16 v[166:169], v[186:189], a[116:119], v[166:169]
v_mfma_f32_16x16x32_bf16 v[170:173], v[186:189], a[140:143], v[170:173]
v_cvt_pk_bf16_f32 v78, v138, v139
v_cvt_pk_bf16_f32 v79, v140, v141
v_cvt_pk_bf16_f32 v80, v142, v143
v_cvt_pk_bf16_f32 v81, v144, v145
v_cvt_pk_bf16_f32 v82, v146, v147
v_cvt_pk_bf16_f32 v83, v148, v149
v_cvt_pk_bf16_f32 v72, v150, v151
v_cvt_pk_bf16_f32 v73, v152, v153
v_cvt_pk_bf16_f32 v74, v154, v155
v_cvt_pk_bf16_f32 v75, v156, v157
v_cvt_pk_bf16_f32 v76, v158, v159
v_cvt_pk_bf16_f32 v77, v160, v161
v_cvt_pk_bf16_f32 v114, v162, v163
v_cvt_pk_bf16_f32 v115, v164, v165
v_cvt_pk_bf16_f32 v122, v166, v167
v_cvt_pk_bf16_f32 v123, v168, v169
v_cvt_pk_bf16_f32 v130, v170, v171
v_cvt_pk_bf16_f32 v131, v172, v173
ds_read_b128 v[182:185], v210 offset:6144
s_waitcnt lgkmcnt(0)
v_mfma_f32_16x16x32_bf16 v[138:141], a[0:3], v[182:185], 0
v_mfma_f32_16x16x32_bf16 v[142:145], a[24:27], v[182:185], 0
v_mfma_f32_16x16x32_bf16 v[146:149], a[48:51], v[182:185], 0
v_mfma_f32_16x16x32_bf16 v[150:153], a[216:219], v[182:185], 0
v_mfma_f32_16x16x32_bf16 v[154:157], a[240:243], v[182:185], 0
v_mfma_f32_16x16x32_bf16 v[158:161], v[232:235], v[182:185], 0
v_mfma_f32_16x16x32_bf16 v[162:165], v[182:185], a[72:75], 0
v_mfma_f32_16x16x32_bf16 v[166:169], v[182:185], a[96:99], 0
v_mfma_f32_16x16x32_bf16 v[170:173], v[182:185], a[120:123], 0
ds_read_b128 v[186:189], v210 offset:7168
s_waitcnt lgkmcnt(0)
v_mfma_f32_16x16x32_bf16 v[138:141], a[4:7], v[186:189], v[138:141]
v_mfma_f32_16x16x32_bf16 v[142:145], a[28:31], v[186:189], v[142:145]
v_mfma_f32_16x16x32_bf16 v[146:149], a[52:55], v[186:189], v[146:149]
v_mfma_f32_16x16x32_bf16 v[150:153], a[220:223], v[186:189], v[150:153]
v_mfma_f32_16x16x32_bf16 v[154:157], a[244:247], v[186:189], v[154:157]
v_mfma_f32_16x16x32_bf16 v[158:161], v[236:239], v[186:189], v[158:161]
v_mfma_f32_16x16x32_bf16 v[162:165], v[186:189], a[76:79], v[162:165]
v_mfma_f32_16x16x32_bf16 v[166:169], v[186:189], a[100:103], v[166:169]
v_mfma_f32_16x16x32_bf16 v[170:173], v[186:189], a[124:127], v[170:173]
ds_read_b128 v[182:185], v210 offset:8192
s_waitcnt lgkmcnt(0)
v_mfma_f32_16x16x32_bf16 v[138:141], a[8:11], v[182:185], v[138:141]
v_mfma_f32_16x16x32_bf16 v[142:145], a[32:35], v[182:185], v[142:145]
v_mfma_f32_16x16x32_bf16 v[146:149], a[56:59], v[182:185], v[146:149]
v_mfma_f32_16x16x32_bf16 v[150:153], a[224:227], v[182:185], v[150:153]
v_mfma_f32_16x16x32_bf16 v[154:157], a[248:251], v[182:185], v[154:157]
v_mfma_f32_16x16x32_bf16 v[158:161], v[240:243], v[182:185], v[158:161]
v_mfma_f32_16x16x32_bf16 v[162:165], v[182:185], a[80:83], v[162:165]
v_mfma_f32_16x16x32_bf16 v[166:169], v[182:185], a[104:107], v[166:169]
v_mfma_f32_16x16x32_bf16 v[170:173], v[182:185], a[128:131], v[170:173]
ds_read_b128 v[186:189], v210 offset:9216
s_waitcnt lgkmcnt(0)
v_mfma_f32_16x16x32_bf16 v[138:141], a[12:15], v[186:189], v[138:141]
v_mfma_f32_16x16x32_bf16 v[142:145], a[36:39], v[186:189], v[142:145]
v_mfma_f32_16x16x32_bf16 v[146:149], a[60:63], v[186:189], v[146:149]
v_mfma_f32_16x16x32_bf16 v[150:153], a[228:231], v[186:189], v[150:153]
v_mfma_f32_16x16x32_bf16 v[154:157], a[252:255], v[186:189], v[154:157]
v_mfma_f32_16x16x32_bf16 v[158:161], v[244:247], v[186:189], v[158:161]
v_mfma_f32_16x16x32_bf16 v[162:165], v[186:189], a[84:87], v[162:165]
v_mfma_f32_16x16x32_bf16 v[166:169], v[186:189], a[108:111], v[166:169]
v_mfma_f32_16x16x32_bf16 v[170:173], v[186:189], a[132:135], v[170:173]
ds_read_b128 v[182:185], v210 offset:10240
s_waitcnt lgkmcnt(0)
v_mfma_f32_16x16x32_bf16 v[138:141], a[16:19], v[182:185], v[138:141]
v_mfma_f32_16x16x32_bf16 v[142:145], a[40:43], v[182:185], v[142:145]
v_mfma_f32_16x16x32_bf16 v[146:149], a[64:67], v[182:185], v[146:149]
v_mfma_f32_16x16x32_bf16 v[150:153], a[232:235], v[182:185], v[150:153]
v_mfma_f32_16x16x32_bf16 v[154:157], v[224:227], v[182:185], v[154:157]
v_mfma_f32_16x16x32_bf16 v[158:161], v[248:251], v[182:185], v[158:161]
v_mfma_f32_16x16x32_bf16 v[162:165], v[182:185], a[88:91], v[162:165]
v_mfma_f32_16x16x32_bf16 v[166:169], v[182:185], a[112:115], v[166:169]
v_mfma_f32_16x16x32_bf16 v[170:173], v[182:185], a[136:139], v[170:173]
ds_read_b128 v[186:189], v210 offset:11264
s_waitcnt lgkmcnt(0)
v_mfma_f32_16x16x32_bf16 v[138:141], a[20:23], v[186:189], v[138:141]
v_mfma_f32_16x16x32_bf16 v[142:145], a[44:47], v[186:189], v[142:145]
v_mfma_f32_16x16x32_bf16 v[146:149], a[68:71], v[186:189], v[146:149]
v_mfma_f32_16x16x32_bf16 v[150:153], a[236:239], v[186:189], v[150:153]
v_mfma_f32_16x16x32_bf16 v[154:157], v[228:231], v[186:189], v[154:157]
v_mfma_f32_16x16x32_bf16 v[158:161], v[252:255], v[186:189], v[158:161]
v_mfma_f32_16x16x32_bf16 v[162:165], v[186:189], a[92:95], v[162:165]
v_mfma_f32_16x16x32_bf16 v[166:169], v[186:189], a[116:119], v[166:169]
v_mfma_f32_16x16x32_bf16 v[170:173], v[186:189], a[140:143], v[170:173]
v_cvt_pk_bf16_f32 v96, v138, v139
v_cvt_pk_bf16_f32 v97, v140, v141
v_cvt_pk_bf16_f32 v98, v142, v143
v_cvt_pk_bf16_f32 v99, v144, v145
v_cvt_pk_bf16_f32 v100, v146, v147
v_cvt_pk_bf16_f32 v101, v148, v149
v_cvt_pk_bf16_f32 v84, v150, v151
v_cvt_pk_bf16_f32 v85, v152, v153
v_cvt_pk_bf16_f32 v86, v154, v155
v_cvt_pk_bf16_f32 v87, v156, v157
v_cvt_pk_bf16_f32 v88, v158, v159
v_cvt_pk_bf16_f32 v89, v160, v161
v_cvt_pk_bf16_f32 v116, v162, v163
v_cvt_pk_bf16_f32 v117, v164, v165
v_cvt_pk_bf16_f32 v124, v166, v167
v_cvt_pk_bf16_f32 v125, v168, v169
v_cvt_pk_bf16_f32 v132, v170, v171
v_cvt_pk_bf16_f32 v133, v172, v173
ds_read_b128 v[182:185], v210 offset:12288
s_waitcnt lgkmcnt(0)
v_mfma_f32_16x16x32_bf16 v[138:141], a[0:3], v[182:185], 0
v_mfma_f32_16x16x32_bf16 v[142:145], a[24:27], v[182:185], 0
v_mfma_f32_16x16x32_bf16 v[146:149], a[48:51], v[182:185], 0
ds_read_b128 v[186:189], v210 offset:13312
s_waitcnt lgkmcnt(0)
v_mfma_f32_16x16x32_bf16 v[138:141], a[4:7], v[186:189], v[138:141]
v_mfma_f32_16x16x32_bf16 v[142:145], a[28:31], v[186:189], v[142:145]
v_mfma_f32_16x16x32_bf16 v[146:149], a[52:55], v[186:189], v[146:149]
ds_read_b128 v[182:185], v210 offset:14336
s_waitcnt lgkmcnt(0)
v_mfma_f32_16x16x32_bf16 v[138:141], a[8:11], v[182:185], v[138:141]
v_mfma_f32_16x16x32_bf16 v[142:145], a[32:35], v[182:185], v[142:145]
v_mfma_f32_16x16x32_bf16 v[146:149], a[56:59], v[182:185], v[146:149]
ds_read_b128 v[186:189], v210 offset:15360
s_waitcnt lgkmcnt(0)
v_mfma_f32_16x16x32_bf16 v[138:141], a[12:15], v[186:189], v[138:141]
v_mfma_f32_16x16x32_bf16 v[142:145], a[36:39], v[186:189], v[142:145]
v_mfma_f32_16x16x32_bf16 v[146:149], a[60:63], v[186:189], v[146:149]
ds_read_b128 v[182:185], v210 offset:16384
s_waitcnt lgkmcnt(0)
v_mfma_f32_16x16x32_bf16 v[138:141], a[16:19], v[182:185], v[138:141]
v_mfma_f32_16x16x32_bf16 v[142:145], a[40:43], v[182:185], v[142:145]
v_mfma_f32_16x16x32_bf16 v[146:149], a[64:67], v[182:185], v[146:149]
ds_read_b128 v[186:189], v210 offset:17408
s_waitcnt lgkmcnt(0)
v_mfma_f32_16x16x32_bf16 v[138:141], a[20:23], v[186:189], v[138:141]
v_mfma_f32_16x16x32_bf16 v[142:145], a[44:47], v[186:189], v[142:145]
v_mfma_f32_16x16x32_bf16 v[146:149], a[68:71], v[186:189], v[146:149]
v_cvt_pk_bf16_f32 v102, v138, v139
v_cvt_pk_bf16_f32 v103, v140, v141
s_nop 0
v_cvt_pk_bf16_f32 v104, v142, v143
v_cvt_pk_bf16_f32 v105, v144, v145
s_nop 1
v_cvt_pk_bf16_f32 v106, v146, v147
v_cvt_pk_bf16_f32 v107, v148, v149
ds_read_b128 v[108:111], v215 offset:512
ds_read_b64 v[112:113], v215 offset:528
v_mov_b32 v181, 0
v_mfma_f32_16x16x16_bf16 v[138:141], v[82:83], v[76:77], 0
v_mfma_f32_16x16x16_bf16 v[142:145], v[100:101], v[76:77], 0
s_waitcnt lgkmcnt(0)
v_mfma_f32_16x16x16_bf16 v[150:153], v[112:113], v[76:77], v[206:209]
v_mfma_f32_16x16x16_bf16 v[146:149], v[106:107], v[76:77], 0
v_mfma_f32_16x16x32_bf16 v[138:141], v[78:81], v[72:75], v[138:141]
v_mfma_f32_16x16x32_bf16 v[142:145], v[96:99], v[72:75], v[142:145]
v_mfma_f32_16x16x32_bf16 v[150:153], v[108:111], v[72:75], v[150:153]
v_mfma_f32_16x16x32_bf16 v[146:149], v[102:105], v[72:75], v[146:149]
ds_read_b128 v[72:75], v215
ds_read_b64 v[76:77], v215 offset:16
v_mfma_f32_16x16x16_bf16 v[154:157], v[82:83], v[88:89], 0
v_mfma_f32_16x16x16_bf16 v[158:161], v[100:101], v[88:89], 0
v_mfma_f32_16x16x16_bf16 v[166:169], v[112:113], v[88:89], v[206:209]
v_mfma_f32_16x16x16_bf16 v[162:165], v[106:107], v[88:89], 0
v_mfma_f32_16x16x32_bf16 v[154:157], v[78:81], v[84:87], v[154:157]
v_mfma_f32_16x16x32_bf16 v[158:161], v[96:99], v[84:87], v[158:161]
v_mfma_f32_16x16x32_bf16 v[166:169], v[108:111], v[84:87], v[166:169]
v_mfma_f32_16x16x32_bf16 v[162:165], v[102:105], v[84:87], v[162:165]
ds_read_b128 v[182:185], v210 offset:12288
s_waitcnt lgkmcnt(0)
v_mfma_f32_16x16x32_bf16 v[118:121], v[182:185], a[72:75], 0
v_mfma_f32_16x16x32_bf16 v[126:129], v[182:185], a[96:99], 0
v_mfma_f32_16x16x32_bf16 v[134:137], v[182:185], a[120:123], 0
v_mfma_f32_16x16x32_bf16 v[90:93], a[216:219], v[182:185], 0
v_mfma_f32_16x16x32_bf16 v[170:173], a[240:243], v[182:185], 0
v_mfma_f32_16x16x32_bf16 v[220:223], v[232:235], v[182:185], 0
ds_read_b128 v[186:189], v210 offset:13312
s_waitcnt lgkmcnt(0)
v_mfma_f32_16x16x32_bf16 v[118:121], v[186:189], a[76:79], v[118:121]
v_mfma_f32_16x16x32_bf16 v[126:129], v[186:189], a[100:103], v[126:129]
v_mfma_f32_16x16x32_bf16 v[134:137], v[186:189], a[124:127], v[134:137]
v_mfma_f32_16x16x32_bf16 v[90:93], a[220:223], v[186:189], v[90:93]
v_mfma_f32_16x16x32_bf16 v[170:173], a[244:247], v[186:189], v[170:173]
v_mfma_f32_16x16x32_bf16 v[220:223], v[236:239], v[186:189], v[220:223]
ds_read_b128 v[182:185], v210 offset:14336
s_waitcnt lgkmcnt(0)
v_mfma_f32_16x16x32_bf16 v[118:121], v[182:185], a[80:83], v[118:121]
v_mfma_f32_16x16x32_bf16 v[126:129], v[182:185], a[104:107], v[126:129]
v_mfma_f32_16x16x32_bf16 v[134:137], v[182:185], a[128:131], v[134:137]
v_mfma_f32_16x16x32_bf16 v[90:93], a[224:227], v[182:185], v[90:93]
v_mfma_f32_16x16x32_bf16 v[170:173], a[248:251], v[182:185], v[170:173]
v_mfma_f32_16x16x32_bf16 v[220:223], v[240:243], v[182:185], v[220:223]
ds_read_b128 v[186:189], v210 offset:15360
s_waitcnt lgkmcnt(0)
v_mfma_f32_16x16x32_bf16 v[118:121], v[186:189], a[84:87], v[118:121]
v_mfma_f32_16x16x32_bf16 v[126:129], v[186:189], a[108:111], v[126:129]
v_mfma_f32_16x16x32_bf16 v[134:137], v[186:189], a[132:135], v[134:137]
v_mfma_f32_16x16x32_bf16 v[90:93], a[228:231], v[186:189], v[90:93]
v_mfma_f32_16x16x32_bf16 v[170:173], a[252:255], v[186:189], v[170:173]
v_mfma_f32_16x16x32_bf16 v[220:223], v[244:247], v[186:189], v[220:223]
ds_read_b128 v[182:185], v210 offset:16384
s_waitcnt lgkmcnt(0)
v_mfma_f32_16x16x32_bf16 v[118:121], v[182:185], a[88:91], v[118:121]
v_mfma_f32_16x16x32_bf16 v[126:129], v[182:185], a[112:115], v[126:129]
v_mfma_f32_16x16x32_bf16 v[134:137], v[182:185], a[136:139], v[134:137]
v_mfma_f32_16x16x32_bf16 v[90:93], a[232:235], v[182:185], v[90:93]
v_mfma_f32_16x16x32_bf16 v[170:173], v[224:227], v[182:185], v[170:173]
v_mfma_f32_16x16x32_bf16 v[220:223], v[248:251], v[182:185], v[220:223]
ds_read_b128 v[186:189], v210 offset:17408
s_waitcnt lgkmcnt(0)
v_mfma_f32_16x16x32_bf16 v[118:121], v[186:189], a[92:95], v[118:121]
v_mfma_f32_16x16x32_bf16 v[126:129], v[186:189], a[116:119], v[126:129]
v_mfma_f32_16x16x32_bf16 v[134:137], v[186:189], a[140:143], v[134:137]
v_mfma_f32_16x16x32_bf16 v[90:93], a[236:239], v[186:189], v[90:93]
v_mfma_f32_16x16x32_bf16 v[170:173], v[228:231], v[186:189], v[170:173]
v_mfma_f32_16x16x32_bf16 v[220:223], v[252:255], v[186:189], v[220:223]
v_cvt_pk_bf16_f32 v118, v118, v119
v_cvt_pk_bf16_f32 v119, v120, v121
ds_read_u16 v120, v214 offset:1024
v_mov_b32 v121, 0
v_cvt_pk_bf16_f32 v126, v126, v127
v_cvt_pk_bf16_f32 v127, v128, v129
ds_read_u16 v128, v214 offset:1032
v_mov_b32 v129, 0
v_cvt_pk_bf16_f32 v134, v134, v135
v_cvt_pk_bf16_f32 v135, v136, v137
ds_read_u16 v136, v214 offset:1040
v_mov_b32 v137, 0
v_cvt_pk_bf16_f32 v90, v90, v91
v_cvt_pk_bf16_f32 v91, v92, v93
v_cvt_pk_bf16_f32 v92, v170, v171
v_cvt_pk_bf16_f32 v93, v172, v173
v_cvt_pk_bf16_f32 v94, v220, v221
v_cvt_pk_bf16_f32 v95, v222, v223
v_max3_f32 v151, v138, v139, v140
v_max3_f32 v151, v151, v141, v142
v_max3_f32 v151, v151, v143, v144
v_max3_f32 v151, v151, v145, v146
v_max3_f32 v151, v151, v147, v148
v_max3_f32 v151, v151, v149, v150
v_mov_b32 v152, v151
s_nop 1
v_permlane16_swap_b32 v151, v152
v_max_f32 v151, v151, v152
v_mov_b32 v152, v151
s_nop 1
v_permlane32_swap_b32 v151, v152
v_max_f32 v151, v151, v152
v_sub_f32 v138, v138, v151
v_sub_f32 v139, v139, v151
v_sub_f32 v140, v140, v151
v_sub_f32 v141, v141, v151
v_sub_f32 v142, v142, v151
v_sub_f32 v143, v143, v151
v_sub_f32 v144, v144, v151
v_sub_f32 v145, v145, v151
v_sub_f32 v150, v150, v151
v_sub_f32 v146, v146, v151
v_sub_f32 v147, v147, v151
v_sub_f32 v148, v148, v151
v_sub_f32 v149, v149, v151
v_exp_f32 v138, v138
v_exp_f32 v139, v139
v_exp_f32 v140, v140
v_exp_f32 v141, v141
v_exp_f32 v142, v142
v_exp_f32 v143, v143
v_exp_f32 v144, v144
v_exp_f32 v145, v145
v_exp_f32 v150, v150
v_exp_f32 v146, v146
v_exp_f32 v147, v147
v_exp_f32 v148, v148
v_exp_f32 v149, v149
v_cvt_pk_bf16_f32 v174, v138, v139
v_cvt_pk_bf16_f32 v175, v140, v141
v_cvt_pk_bf16_f32 v176, v142, v143
v_cvt_pk_bf16_f32 v177, v144, v145
v_cvt_pk_bf16_f32 v178, v146, v147
v_cvt_pk_bf16_f32 v179, v148, v149
v_cvt_pk_bf16_f32 v180, v150, 0
v_mfma_f32_16x16x32_bf16 v[150:153], v[190:193], v[174:177], 0
v_mfma_f32_16x16x32_bf16 v[138:141], v[114:117], v[174:177], 0
v_mfma_f32_16x16x32_bf16 v[142:145], v[122:125], v[174:177], 0
v_mfma_f32_16x16x32_bf16 v[146:149], v[130:133], v[174:177], 0
v_mfma_f32_16x16x32_bf16 v[150:153], v[190:193], v[178:181], v[150:153]
s_waitcnt lgkmcnt(2)
v_mfma_f32_16x16x32_bf16 v[138:141], v[118:121], v[178:181], v[138:141]
s_waitcnt lgkmcnt(1)
v_mfma_f32_16x16x32_bf16 v[142:145], v[126:129], v[178:181], v[142:145]
s_waitcnt lgkmcnt(0)
v_mfma_f32_16x16x32_bf16 v[146:149], v[134:137], v[178:181], v[146:149]
v_max3_f32 v167, v154, v155, v156
v_max3_f32 v167, v167, v157, v158
v_max3_f32 v167, v167, v159, v160
v_max3_f32 v167, v167, v161, v162
v_max3_f32 v167, v167, v163, v164
v_max3_f32 v167, v167, v165, v166
v_mov_b32 v168, v167
s_nop 1
v_permlane16_swap_b32 v167, v168
v_max_f32 v167, v167, v168
v_mov_b32 v168, v167
s_nop 1
v_permlane32_swap_b32 v167, v168
v_max_f32 v167, v167, v168
v_sub_f32 v154, v154, v167
v_sub_f32 v155, v155, v167
v_sub_f32 v156, v156, v167
v_sub_f32 v157, v157, v167
v_sub_f32 v158, v158, v167
v_sub_f32 v159, v159, v167
v_sub_f32 v160, v160, v167
v_sub_f32 v161, v161, v167
v_sub_f32 v166, v166, v167
v_sub_f32 v162, v162, v167
v_sub_f32 v163, v163, v167
v_sub_f32 v164, v164, v167
v_sub_f32 v165, v165, v167
v_exp_f32 v154, v154
v_exp_f32 v155, v155
v_exp_f32 v156, v156
v_exp_f32 v157, v157
v_exp_f32 v158, v158
v_exp_f32 v159, v159
v_exp_f32 v160, v160
v_exp_f32 v161, v161
v_exp_f32 v166, v166
v_exp_f32 v162, v162
v_exp_f32 v163, v163
v_exp_f32 v164, v164
v_exp_f32 v165, v165
v_cvt_pk_bf16_f32 v174, v154, v155
v_cvt_pk_bf16_f32 v175, v156, v157
v_cvt_pk_bf16_f32 v176, v158, v159
v_cvt_pk_bf16_f32 v177, v160, v161
v_cvt_pk_bf16_f32 v178, v162, v163
v_cvt_pk_bf16_f32 v179, v164, v165
v_cvt_pk_bf16_f32 v180, v166, 0
v_mfma_f32_16x16x32_bf16 v[166:169], v[190:193], v[174:177], 0
v_mfma_f32_16x16x32_bf16 v[154:157], v[114:117], v[174:177], 0
v_mfma_f32_16x16x32_bf16 v[158:161], v[122:125], v[174:177], 0
v_mfma_f32_16x16x32_bf16 v[162:165], v[130:133], v[174:177], 0
v_mfma_f32_16x16x32_bf16 v[166:169], v[190:193], v[178:181], v[166:169]
v_mfma_f32_16x16x32_bf16 v[154:157], v[118:121], v[178:181], v[154:157]
v_mfma_f32_16x16x32_bf16 v[158:161], v[126:129], v[178:181], v[158:161]
v_mfma_f32_16x16x32_bf16 v[162:165], v[134:137], v[178:181], v[162:165]
v_rcp_f32 v151, v150
s_nop 0
v_mul_f32 v151, s3, v151
v_mul_f32 v138, v138, v151
v_mul_f32 v139, v139, v151
v_cvt_pk_bf16_f32 v138, v138, v139
v_mul_f32 v140, v140, v151
v_mul_f32 v141, v141, v151
v_cvt_pk_bf16_f32 v139, v140, v141
v_mul_f32 v142, v142, v151
v_mul_f32 v143, v143, v151
v_cvt_pk_bf16_f32 v140, v142, v143
v_mul_f32 v144, v144, v151
v_mul_f32 v145, v145, v151
v_cvt_pk_bf16_f32 v141, v144, v145
ds_write_b128 v211, v[138:141] offset:38912
v_mul_f32 v146, v146, v151
v_mul_f32 v147, v147, v151
v_cvt_pk_bf16_f32 v142, v146, v147
v_mul_f32 v148, v148, v151
v_mul_f32 v149, v149, v151
v_cvt_pk_bf16_f32 v143, v148, v149
ds_write_b64 v212, v[142:143] offset:38912
v_mfma_f32_16x16x32_bf16 v[138:141], v[78:81], v[90:93], 0
v_mfma_f32_16x16x32_bf16 v[142:145], v[96:99], v[90:93], 0
v_mfma_f32_16x16x32_bf16 v[150:153], v[108:111], v[90:93], v[206:209]
v_mfma_f32_16x16x32_bf16 v[146:149], v[102:105], v[90:93], 0
v_mfma_f32_16x16x16_bf16 v[138:141], v[82:83], v[94:95], v[138:141]
v_mfma_f32_16x16x16_bf16 v[142:145], v[100:101], v[94:95], v[142:145]
v_mfma_f32_16x16x16_bf16 v[150:153], v[112:113], v[94:95], v[150:153]
v_mfma_f32_16x16x16_bf16 v[146:149], v[106:107], v[94:95], v[146:149]
v_rcp_f32 v167, v166
s_nop 0
v_mul_f32 v167, s3, v167
v_mul_f32 v154, v154, v167
v_mul_f32 v155, v155, v167
v_cvt_pk_bf16_f32 v154, v154, v155
v_mul_f32 v156, v156, v167
v_mul_f32 v157, v157, v167
v_cvt_pk_bf16_f32 v155, v156, v157
v_mul_f32 v158, v158, v167
v_mul_f32 v159, v159, v167
v_cvt_pk_bf16_f32 v156, v158, v159
v_mul_f32 v160, v160, v167
v_mul_f32 v161, v161, v167
v_cvt_pk_bf16_f32 v157, v160, v161
ds_write_b128 v211, v[154:157] offset:45056
v_mul_f32 v162, v162, v167
v_mul_f32 v163, v163, v167
v_cvt_pk_bf16_f32 v158, v162, v163
v_mul_f32 v164, v164, v167
v_mul_f32 v165, v165, v167
v_cvt_pk_bf16_f32 v159, v164, v165
ds_write_b64 v212, v[158:159] offset:45056
v_mfma_f32_16x16x16_bf16 v[154:157], v[76:77], v[82:83], 0
v_mfma_f32_16x16x16_bf16 v[158:161], v[76:77], v[100:101], 0
v_mfma_f32_16x16x16_bf16 v[162:165], v[76:77], v[106:107], 0
v_mfma_f32_16x16x16_bf16 v[166:169], v[76:77], v[112:113], v[206:209]
v_mfma_f32_16x16x32_bf16 v[154:157], v[72:75], v[78:81], v[154:157]
v_mfma_f32_16x16x32_bf16 v[158:161], v[72:75], v[96:99], v[158:161]
v_mfma_f32_16x16x32_bf16 v[162:165], v[72:75], v[102:105], v[162:165]
v_mfma_f32_16x16x32_bf16 v[166:169], v[72:75], v[108:111], v[166:169]
v_mov_b32_dpp v154, v158 quad_perm:[0,1,2,3] row_mask:0x2 bank_mask:0xf
s_nop 1
v_mov_b32_dpp v154, v162 quad_perm:[0,1,2,3] row_mask:0x4 bank_mask:0xf
s_nop 2
v_mov_b32_dpp v154, v167 quad_perm:[0,1,2,3] row_mask:0x8 bank_mask:0xf
v_mov_b32 v155, v154
s_nop 1
v_max_f32_dpp v155, v155, v155 row_ror:8 row_mask:0xf bank_mask:0xf
s_nop 1
v_max_f32_dpp v155, v155, v155 row_ror:4 row_mask:0xf bank_mask:0xf
s_nop 1
v_max_f32_dpp v155, v155, v155 row_ror:2 row_mask:0xf bank_mask:0xf
s_nop 1
v_max_f32_dpp v155, v155, v155 row_ror:1 row_mask:0xf bank_mask:0xf
v_mov_b32 v156, v155
s_nop 1
v_permlane16_swap_b32 v155, v156
v_max_f32 v155, v155, v156
v_mov_b32 v156, v155
s_nop 1
v_permlane32_swap_b32 v155, v156
v_max_f32 v155, v155, v156
v_sub_f32 v154, v154, v155
v_exp_f32 v154, v154
s_nop 0
v_cvt_pk_bf16_f32 v154, v154, 0
ds_write_b16 v214, v154
s_waitcnt lgkmcnt(1)
ds_read_b128 v[84:87], v215
ds_read_b128 v[88:91], v215 offset:16
v_add_u32 v215, 1552, v215
s_barrier
ds_read_b128 v[170:173], v210 offset:38912
s_waitcnt lgkmcnt(0)
v_mfma_f32_16x16x32_bf16 v[0:3], a[144:147], v[170:173], v[0:3]
v_mfma_f32_16x16x32_bf16 v[4:7], a[168:171], v[170:173], v[4:7]
v_mfma_f32_16x16x32_bf16 v[8:11], a[192:195], v[170:173], v[8:11]
ds_read_b128 v[182:185], v210 offset:39936
s_waitcnt lgkmcnt(0)
v_mfma_f32_16x16x32_bf16 v[0:3], a[148:151], v[182:185], v[0:3]
v_mfma_f32_16x16x32_bf16 v[4:7], a[172:175], v[182:185], v[4:7]
v_mfma_f32_16x16x32_bf16 v[8:11], a[196:199], v[182:185], v[8:11]
ds_read_b128 v[186:189], v210 offset:40960
s_waitcnt lgkmcnt(0)
v_mfma_f32_16x16x32_bf16 v[0:3], a[152:155], v[186:189], v[0:3]
v_mfma_f32_16x16x32_bf16 v[4:7], a[176:179], v[186:189], v[4:7]
v_mfma_f32_16x16x32_bf16 v[8:11], a[200:203], v[186:189], v[8:11]
ds_read_b128 v[170:173], v210 offset:41984
s_waitcnt lgkmcnt(0)
v_mfma_f32_16x16x32_bf16 v[0:3], a[156:159], v[170:173], v[0:3]
v_mfma_f32_16x16x32_bf16 v[4:7], a[180:183], v[170:173], v[4:7]
v_mfma_f32_16x16x32_bf16 v[8:11], a[204:207], v[170:173], v[8:11]
ds_read_b128 v[182:185], v210 offset:43008
s_waitcnt lgkmcnt(0)
v_mfma_f32_16x16x32_bf16 v[0:3], a[160:163], v[182:185], v[0:3]
v_mfma_f32_16x16x32_bf16 v[4:7], a[184:187], v[182:185], v[4:7]
v_mfma_f32_16x16x32_bf16 v[8:11], a[208:211], v[182:185], v[8:11]
ds_read_b128 v[186:189], v210 offset:44032
s_waitcnt lgkmcnt(0)
v_mfma_f32_16x16x32_bf16 v[0:3], a[164:167], v[186:189], v[0:3]
v_mfma_f32_16x16x32_bf16 v[4:7], a[188:191], v[186:189], v[4:7]
v_mfma_f32_16x16x32_bf16 v[8:11], a[212:215], v[186:189], v[8:11]
v_cvt_pk_bf16_f32 v72, v0, v1
v_cvt_pk_bf16_f32 v73, v2, v3
buffer_store_dwordx2 v[72:73], v203, s[8:11], s38 offen
v_cvt_pk_bf16_f32 v74, v4, v5
v_cvt_pk_bf16_f32 v75, v6, v7
buffer_store_dwordx2 v[74:75], v203, s[8:11], s38 offen offset:32
s_nop 0
v_cvt_pk_bf16_f32 v76, v8, v9
v_cvt_pk_bf16_f32 v77, v10, v11
buffer_store_dwordx2 v[76:77], v203, s[8:11], s38 offen offset:64
v_max3_f32 v151, v138, v139, v140
v_max3_f32 v151, v151, v141, v142
v_max3_f32 v151, v151, v143, v144
v_max3_f32 v151, v151, v145, v146
v_max3_f32 v151, v151, v147, v148
v_max3_f32 v151, v151, v149, v150
v_mov_b32 v152, v151
s_nop 1
v_permlane16_swap_b32 v151, v152
v_max_f32 v151, v151, v152
v_mov_b32 v152, v151
s_nop 1
v_permlane32_swap_b32 v151, v152
v_max_f32 v151, v151, v152
v_sub_f32 v138, v138, v151
v_sub_f32 v139, v139, v151
v_sub_f32 v140, v140, v151
v_sub_f32 v141, v141, v151
v_sub_f32 v142, v142, v151
v_sub_f32 v143, v143, v151
v_sub_f32 v144, v144, v151
v_sub_f32 v145, v145, v151
v_sub_f32 v150, v150, v151
v_sub_f32 v146, v146, v151
v_sub_f32 v147, v147, v151
v_sub_f32 v148, v148, v151
v_sub_f32 v149, v149, v151
v_exp_f32 v138, v138
v_exp_f32 v139, v139
v_exp_f32 v140, v140
v_exp_f32 v141, v141
v_exp_f32 v142, v142
v_exp_f32 v143, v143
v_exp_f32 v144, v144
v_exp_f32 v145, v145
v_exp_f32 v150, v150
v_exp_f32 v146, v146
v_exp_f32 v147, v147
v_exp_f32 v148, v148
v_exp_f32 v149, v149
v_cvt_pk_bf16_f32 v174, v138, v139
v_cvt_pk_bf16_f32 v175, v140, v141
v_cvt_pk_bf16_f32 v176, v142, v143
v_cvt_pk_bf16_f32 v177, v144, v145
v_cvt_pk_bf16_f32 v178, v146, v147
v_cvt_pk_bf16_f32 v179, v148, v149
v_cvt_pk_bf16_f32 v180, v150, 0
v_mfma_f32_16x16x32_bf16 v[150:153], v[190:193], v[174:177], 0
v_mfma_f32_16x16x32_bf16 v[138:141], v[114:117], v[174:177], 0
v_mfma_f32_16x16x32_bf16 v[142:145], v[122:125], v[174:177], 0
v_mfma_f32_16x16x32_bf16 v[146:149], v[130:133], v[174:177], 0
v_mfma_f32_16x16x32_bf16 v[150:153], v[190:193], v[178:181], v[150:153]
v_mfma_f32_16x16x32_bf16 v[138:141], v[118:121], v[178:181], v[138:141]
v_mfma_f32_16x16x32_bf16 v[142:145], v[126:129], v[178:181], v[142:145]
v_mfma_f32_16x16x32_bf16 v[146:149], v[134:137], v[178:181], v[146:149]
v_mfma_f32_16x16x32_bf16 v[166:169], v[84:87], v[190:193], 0
v_mfma_f32_16x16x32_bf16 v[154:157], v[84:87], v[114:117], 0
v_mfma_f32_16x16x32_bf16 v[158:161], v[84:87], v[122:125], 0
v_mfma_f32_16x16x32_bf16 v[162:165], v[84:87], v[130:133], 0
v_mfma_f32_16x16x32_bf16 v[166:169], v[88:91], v[190:193], v[166:169]
v_mfma_f32_16x16x32_bf16 v[154:157], v[88:91], v[118:121], v[154:157]
v_mfma_f32_16x16x32_bf16 v[158:161], v[88:91], v[126:129], v[158:161]
v_mfma_f32_16x16x32_bf16 v[162:165], v[88:91], v[134:137], v[162:165]
v_rcp_f32 v167, v166
s_nop 1
v_mov_b32_dpp v154, v158 quad_perm:[0,1,2,3] row_mask:0x2 bank_mask:0xf
s_nop 2
v_mov_b32_dpp v154, v162 quad_perm:[0,1,2,3] row_mask:0x4 bank_mask:0xf
v_mul_f32 v167, s3, v167
v_mul_f32 v154, v154, v167
v_cvt_pk_bf16_f32 v154, v154, 0
ds_write_b16 v214, v154
v_add_u32 v214, 1552, v214
ds_read_b128 v[170:173], v210 offset:45056
s_waitcnt lgkmcnt(0)
v_mfma_f32_16x16x32_bf16 v[12:15], a[144:147], v[170:173], v[12:15]
v_mfma_f32_16x16x32_bf16 v[16:19], a[168:171], v[170:173], v[16:19]
v_mfma_f32_16x16x32_bf16 v[20:23], a[192:195], v[170:173], v[20:23]
ds_read_b128 v[182:185], v210 offset:46080
s_waitcnt lgkmcnt(0)
v_mfma_f32_16x16x32_bf16 v[12:15], a[148:151], v[182:185], v[12:15]
v_mfma_f32_16x16x32_bf16 v[16:19], a[172:175], v[182:185], v[16:19]
v_mfma_f32_16x16x32_bf16 v[20:23], a[196:199], v[182:185], v[20:23]
ds_read_b128 v[186:189], v210 offset:47104
s_waitcnt lgkmcnt(0)
v_mfma_f32_16x16x32_bf16 v[12:15], a[152:155], v[186:189], v[12:15]
v_mfma_f32_16x16x32_bf16 v[16:19], a[176:179], v[186:189], v[16:19]
v_mfma_f32_16x16x32_bf16 v[20:23], a[200:203], v[186:189], v[20:23]
ds_read_b128 v[170:173], v210 offset:48128
s_waitcnt lgkmcnt(0)
v_mfma_f32_16x16x32_bf16 v[12:15], a[156:159], v[170:173], v[12:15]
v_mfma_f32_16x16x32_bf16 v[16:19], a[180:183], v[170:173], v[16:19]
v_mfma_f32_16x16x32_bf16 v[20:23], a[204:207], v[170:173], v[20:23]
ds_read_b128 v[182:185], v210 offset:49152
s_waitcnt lgkmcnt(0)
v_mfma_f32_16x16x32_bf16 v[12:15], a[160:163], v[182:185], v[12:15]
v_mfma_f32_16x16x32_bf16 v[16:19], a[184:187], v[182:185], v[16:19]
v_mfma_f32_16x16x32_bf16 v[20:23], a[208:211], v[182:185], v[20:23]
ds_read_b128 v[186:189], v210 offset:50176
s_waitcnt lgkmcnt(0)
v_mfma_f32_16x16x32_bf16 v[12:15], a[164:167], v[186:189], v[12:15]
v_mfma_f32_16x16x32_bf16 v[16:19], a[188:191], v[186:189], v[16:19]
v_mfma_f32_16x16x32_bf16 v[20:23], a[212:215], v[186:189], v[20:23]
s_sub_u32 s46, s46, 1
v_cvt_pk_bf16_f32 v78, v12, v13
v_cvt_pk_bf16_f32 v79, v14, v15
buffer_store_dwordx2 v[78:79], v204, s[8:11], s38 offen
v_cvt_pk_bf16_f32 v80, v16, v17
v_cvt_pk_bf16_f32 v81, v18, v19
buffer_store_dwordx2 v[80:81], v204, s[8:11], s38 offen offset:32
s_nop 0
v_cvt_pk_bf16_f32 v82, v20, v21
v_cvt_pk_bf16_f32 v83, v22, v23
buffer_store_dwordx2 v[82:83], v204, s[8:11], s38 offen offset:64
v_rcp_f32 v151, v150
s_nop 0
v_mul_f32 v151, s3, v151
v_mul_f32 v138, v138, v151
v_mul_f32 v139, v139, v151
v_cvt_pk_bf16_f32 v138, v138, v139
v_mul_f32 v140, v140, v151
v_mul_f32 v141, v141, v151
v_cvt_pk_bf16_f32 v139, v140, v141
v_mul_f32 v142, v142, v151
v_mul_f32 v143, v143, v151
v_cvt_pk_bf16_f32 v140, v142, v143
v_mul_f32 v144, v144, v151
v_mul_f32 v145, v145, v151
v_cvt_pk_bf16_f32 v141, v144, v145
ds_write_b128 v211, v[138:141] offset:51200
v_mul_f32 v146, v146, v151
v_mul_f32 v147, v147, v151
v_cvt_pk_bf16_f32 v142, v146, v147
v_mul_f32 v148, v148, v151
v_mul_f32 v149, v149, v151
v_cvt_pk_bf16_f32 v143, v148, v149
ds_write_b64 v212, v[142:143] offset:51200
s_cbranch_scc0 G_loop
G_tail:
s_waitcnt vmcnt(6) lgkmcnt(0)
s_barrier
ds_read_b128 v[170:173], v210 offset:51200
s_waitcnt lgkmcnt(0)
v_mfma_f32_16x16x32_bf16 v[24:27], a[144:147], v[170:173], v[24:27]
v_mfma_f32_16x16x32_bf16 v[28:31], a[168:171], v[170:173], v[28:31]
v_mfma_f32_16x16x32_bf16 v[32:35], a[192:195], v[170:173], v[32:35]
ds_read_b128 v[182:185], v210 offset:52224
s_waitcnt lgkmcnt(0)
v_mfma_f32_16x16x32_bf16 v[24:27], a[148:151], v[182:185], v[24:27]
v_mfma_f32_16x16x32_bf16 v[28:31], a[172:175], v[182:185], v[28:31]
v_mfma_f32_16x16x32_bf16 v[32:35], a[196:199], v[182:185], v[32:35]
ds_read_b128 v[186:189], v210 offset:53248
s_waitcnt lgkmcnt(0)
v_mfma_f32_16x16x32_bf16 v[24:27], a[152:155], v[186:189], v[24:27]
v_mfma_f32_16x16x32_bf16 v[28:31], a[176:179], v[186:189], v[28:31]
v_mfma_f32_16x16x32_bf16 v[32:35], a[200:203], v[186:189], v[32:35]
ds_read_b128 v[170:173], v210 offset:54272
s_waitcnt lgkmcnt(0)
v_mfma_f32_16x16x32_bf16 v[24:27], a[156:159], v[170:173], v[24:27]
v_mfma_f32_16x16x32_bf16 v[28:31], a[180:183], v[170:173], v[28:31]
v_mfma_f32_16x16x32_bf16 v[32:35], a[204:207], v[170:173], v[32:35]
ds_read_b128 v[182:185], v210 offset:55296
s_waitcnt lgkmcnt(0)
v_mfma_f32_16x16x32_bf16 v[24:27], a[160:163], v[182:185], v[24:27]
v_mfma_f32_16x16x32_bf16 v[28:31], a[184:187], v[182:185], v[28:31]
v_mfma_f32_16x16x32_bf16 v[32:35], a[208:211], v[182:185], v[32:35]
ds_read_b128 v[186:189], v210 offset:56320
s_waitcnt lgkmcnt(0)
v_mfma_f32_16x16x32_bf16 v[24:27], a[164:167], v[186:189], v[24:27]
v_mfma_f32_16x16x32_bf16 v[28:31], a[188:191], v[186:189], v[28:31]
v_mfma_f32_16x16x32_bf16 v[32:35], a[212:215], v[186:189], v[32:35]
v_cvt_pk_bf16_f32 v116, v24, v25
v_cvt_pk_bf16_f32 v117, v26, v27
buffer_store_dwordx2 v[116:117], v205, s[8:11], s38 offen
v_cvt_pk_bf16_f32 v124, v28, v29
v_cvt_pk_bf16_f32 v125, v30, v31
buffer_store_dwordx2 v[124:125], v205, s[8:11], s38 offen offset:32
s_nop 0
v_cvt_pk_bf16_f32 v132, v32, v33
v_cvt_pk_bf16_f32 v133, v34, v35
buffer_store_dwordx2 v[132:133], v205, s[8:11], s38 offen offset:64
s_mov_b32 s39, s37
ds_read_b128 v[174:177], v217
ds_read_b128 v[84:87], v200
s_waitcnt lgkmcnt(0)
v_mfma_f32_16x16x32_bf16 v[0:3], v[174:177], v[84:87], 0
ds_read_b128 v[92:95], v201
s_waitcnt lgkmcnt(0)
v_mfma_f32_16x16x32_bf16 v[12:15], v[174:177], v[92:95], 0
ds_read_b128 v[100:103], v202
s_waitcnt lgkmcnt(0)
v_mfma_f32_16x16x32_bf16 v[24:27], v[174:177], v[100:103], 0
ds_read_b128 v[178:181], v217 offset:528
ds_read_b128 v[84:87], v194
ds_read_b128 v[88:91], v194 offset:16
s_waitcnt lgkmcnt(0)
v_smfmac_f32_16x16x64_bf16 v[0:3], v[178:181], v[84:91], v213
ds_read_b128 v[92:95], v195
ds_read_b128 v[96:99], v195 offset:16
s_waitcnt lgkmcnt(0)
v_smfmac_f32_16x16x64_bf16 v[12:15], v[178:181], v[92:99], v213
ds_read_b128 v[100:103], v196
ds_read_b128 v[104:107], v196 offset:16
s_waitcnt lgkmcnt(0)
v_smfmac_f32_16x16x64_bf16 v[24:27], v[178:181], v[100:107], v213
ds_read_b128 v[174:177], v217 offset:1056
ds_read_b128 v[84:87], v197
ds_read_b128 v[88:91], v197 offset:16
s_waitcnt lgkmcnt(0)
v_smfmac_f32_16x16x64_bf16 v[0:3], v[174:177], v[84:91], v213
ds_read_b128 v[92:95], v198
ds_read_b128 v[96:99], v198 offset:16
s_waitcnt lgkmcnt(0)
v_smfmac_f32_16x16x64_bf16 v[12:15], v[174:177], v[92:99], v213
ds_read_b128 v[100:103], v199
ds_read_b128 v[104:107], v199 offset:16
s_waitcnt lgkmcnt(0)
v_smfmac_f32_16x16x64_bf16 v[24:27], v[174:177], v[100:107], v213
ds_read_b128 v[178:181], v217 offset:1584
ds_read_b128 v[84:87], v200 offset:32
s_waitcnt lgkmcnt(0)
v_mfma_f32_16x16x32_bf16 v[4:7], v[178:181], v[84:87], 0
ds_read_b128 v[92:95], v201 offset:32
s_waitcnt lgkmcnt(0)
v_mfma_f32_16x16x32_bf16 v[16:19], v[178:181], v[92:95], 0
ds_read_b128 v[100:103], v202 offset:32
s_waitcnt lgkmcnt(0)
v_mfma_f32_16x16x32_bf16 v[28:31], v[178:181], v[100:103], 0
ds_read_b128 v[174:177], v217 offset:2112
ds_read_b128 v[84:87], v194 offset:32
ds_read_b128 v[88:91], v194 offset:48
s_waitcnt lgkmcnt(0)
v_smfmac_f32_16x16x64_bf16 v[4:7], v[174:177], v[84:91], v213
ds_read_b128 v[92:95], v195 offset:32
ds_read_b128 v[96:99], v195 offset:48
s_waitcnt lgkmcnt(0)
v_smfmac_f32_16x16x64_bf16 v[16:19], v[174:177], v[92:99], v213
ds_read_b128 v[100:103], v196 offset:32
ds_read_b128 v[104:107], v196 offset:48
s_waitcnt lgkmcnt(0)
v_smfmac_f32_16x16x64_bf16 v[28:31], v[174:177], v[100:107], v213
ds_read_b128 v[178:181], v217 offset:2640
ds_read_b128 v[84:87], v197 offset:32
ds_read_b128 v[88:91], v197 offset:48
s_waitcnt lgkmcnt(0)
v_smfmac_f32_16x16x64_bf16 v[4:7], v[178:181], v[84:91], v213
ds_read_b128 v[92:95], v198 offset:32
ds_read_b128 v[96:99], v198 offset:48
s_waitcnt lgkmcnt(0)
v_smfmac_f32_16x16x64_bf16 v[16:19], v[178:181], v[92:99], v213
ds_read_b128 v[100:103], v199 offset:32
ds_read_b128 v[104:107], v199 offset:48
s_waitcnt lgkmcnt(0)
v_smfmac_f32_16x16x64_bf16 v[28:31], v[178:181], v[100:107], v213
ds_read_b128 v[174:177], v217 offset:3168
ds_read_b128 v[84:87], v200 offset:64
s_waitcnt lgkmcnt(0)
v_mfma_f32_16x16x32_bf16 v[8:11], v[174:177], v[84:87], 0
ds_read_b128 v[92:95], v201 offset:64
s_waitcnt lgkmcnt(0)
v_mfma_f32_16x16x32_bf16 v[20:23], v[174:177], v[92:95], 0
ds_read_b128 v[100:103], v202 offset:64
s_waitcnt lgkmcnt(0)
v_mfma_f32_16x16x32_bf16 v[32:35], v[174:177], v[100:103], 0
ds_read_b128 v[178:181], v217 offset:3696
ds_read_b128 v[84:87], v194 offset:64
ds_read_b128 v[88:91], v194 offset:80
s_waitcnt lgkmcnt(0)
v_smfmac_f32_16x16x64_bf16 v[8:11], v[178:181], v[84:91], v213
ds_read_b128 v[92:95], v195 offset:64
ds_read_b128 v[96:99], v195 offset:80
s_waitcnt lgkmcnt(0)
v_smfmac_f32_16x16x64_bf16 v[20:23], v[178:181], v[92:99], v213
ds_read_b128 v[100:103], v196 offset:64
ds_read_b128 v[104:107], v196 offset:80
s_waitcnt lgkmcnt(0)
v_smfmac_f32_16x16x64_bf16 v[32:35], v[178:181], v[100:107], v213
ds_read_b128 v[174:177], v217 offset:4224
ds_read_b128 v[84:87], v197 offset:64
ds_read_b128 v[88:91], v197 offset:80
s_waitcnt lgkmcnt(0)
v_smfmac_f32_16x16x64_bf16 v[8:11], v[174:177], v[84:91], v213
ds_read_b128 v[92:95], v198 offset:64
ds_read_b128 v[96:99], v198 offset:80
s_waitcnt lgkmcnt(0)
v_smfmac_f32_16x16x64_bf16 v[20:23], v[174:177], v[92:99], v213
ds_read_b128 v[100:103], v199 offset:64
ds_read_b128 v[104:107], v199 offset:80
s_waitcnt lgkmcnt(0)
v_smfmac_f32_16x16x64_bf16 v[32:35], v[174:177], v[100:107], v213
v_add_f32 v118, v0, v1
v_mul_f32 v119, v0, v0
v_add_f32 v118, v118, v2
v_fmac_f32 v119, v1, v1
v_add_f32 v118, v118, v3
v_fmac_f32 v119, v2, v2
v_fmac_f32 v119, v3, v3
v_add_f32 v126, v12, v13
v_mul_f32 v127, v12, v12
v_add_f32 v126, v126, v14
v_fmac_f32 v127, v13, v13
v_add_f32 v126, v126, v15
v_fmac_f32 v127, v14, v14
v_fmac_f32 v127, v15, v15
v_add_f32 v134, v24, v25
v_mul_f32 v135, v24, v24
v_add_f32 v134, v134, v26
v_fmac_f32 v135, v25, v25
v_add_f32 v134, v134, v27
v_fmac_f32 v135, v26, v26
v_fmac_f32 v135, v27, v27
v_add_f32 v118, v118, v4
v_fmac_f32 v119, v4, v4
v_add_f32 v118, v118, v5
v_fmac_f32 v119, v5, v5
v_add_f32 v118, v118, v6
v_fmac_f32 v119, v6, v6
v_add_f32 v118, v118, v7
v_fmac_f32 v119, v7, v7
v_add_f32 v126, v126, v16
v_fmac_f32 v127, v16, v16
v_add_f32 v126, v126, v17
v_fmac_f32 v127, v17, v17
v_add_f32 v126, v126, v18
v_fmac_f32 v127, v18, v18
v_add_f32 v126, v126, v19
v_fmac_f32 v127, v19, v19
v_add_f32 v134, v134, v28
v_fmac_f32 v135, v28, v28
v_add_f32 v134, v134, v29
v_fmac_f32 v135, v29, v29
v_add_f32 v134, v134, v30
v_fmac_f32 v135, v30, v30
v_add_f32 v134, v134, v31
v_fmac_f32 v135, v31, v31
v_add_f32 v118, v118, v8
v_fmac_f32 v119, v8, v8
v_add_f32 v118, v118, v9
v_fmac_f32 v119, v9, v9
v_add_f32 v118, v118, v10
v_fmac_f32 v119, v10, v10
v_add_f32 v118, v118, v11
v_fmac_f32 v119, v11, v11
v_add_f32 v126, v126, v20
v_fmac_f32 v127, v20, v20
v_add_f32 v126, v126, v21
v_fmac_f32 v127, v21, v21
v_add_f32 v126, v126, v22
v_fmac_f32 v127, v22, v22
v_add_f32 v126, v126, v23
v_fmac_f32 v127, v23, v23
v_add_f32 v134, v134, v32
v_fmac_f32 v135, v32, v32
v_add_f32 v134, v134, v33
v_fmac_f32 v135, v33, v33
v_add_f32 v134, v134, v34
v_fmac_f32 v135, v34, v34
v_add_f32 v134, v134, v35
v_fmac_f32 v135, v35, v35
v_permlane16_swap_b32 v118, v119
v_add_f32 v118, v118, v119
v_permlane16_swap_b32 v126, v127
v_add_f32 v126, v126, v127
v_permlane16_swap_b32 v134, v135
v_add_f32 v134, v134, v135
v_permlane32_swap_b32 v118, v126
v_add_f32 v118, v118, v126
ds_write_b32 v209, v118
v_mov_b32 v135, v134
s_nop 1
v_permlane32_swap_b32 v134, v135
v_add_f32 v134, v134, v135
ds_write_b32 v209, v134 offset:512
s_waitcnt lgkmcnt(0)
s_barrier
s_mul_hi_u32 s41, s35, 58835169
s_mul_i32 s42, s41, 73
s_sub_u32 s42, s35, s42
s_mul_i32 s43, s41, 1373568
s_mul_i32 s51, s42, 2688
s_add_u32 s43, s43, s51
s_cmp_lt_u32 s35, s34
s_cselect_b32 s50, s43, 1879048192
s_add_u32 s35, s35, 32
s_cmp_eq_u32 s42, 0
s_cselect_b32 s44, 536870911, s72
s_cmp_eq_u32 s42, 72
s_cselect_b32 s44, 939524095, s44
s_cmp_eq_u32 s41, 0
s_cselect_b32 s52, 1879048192, s50
s_mov_b32 s37, s50
v_and_b32 v180, s44, v208
s_add_u32 m0, s45, 0
s_nop 0
buffer_load_dwordx4 v180, s[4:7], s52 offen nt lds
s_add_u32 m0, s45, 4112
s_add_u32 s40, s37, 196224
buffer_load_dwordx4 v180, s[4:7], s40 offen nt lds
s_add_u32 m0, s45, 8224
s_add_u32 s40, s37, 392448
buffer_load_dwordx4 v180, s[4:7], s40 offen nt lds
s_add_u32 m0, s45, 12336
s_add_u32 s40, s37, 588672
buffer_load_dwordx4 v180, s[4:7], s40 offen nt lds
s_add_u32 m0, s45, 16448
s_add_u32 s40, s37, 784896
buffer_load_dwordx4 v180, s[4:7], s40 offen nt lds
s_add_u32 m0, s45, 20560
s_add_u32 s40, s37, 981120
buffer_load_dwordx4 v180, s[4:7], s40 offen nt lds
s_add_u32 m0, s45, 24672
s_add_u32 s40, s37, 1177344
buffer_load_dwordx4 v180, s[4:7], s40 offen nt lds
s_add_u32 m0, s45, 28784
s_add_u32 s40, s37, 1373568
buffer_load_dwordx4 v180, s[4:7], s40 offen nt lds
s_add_u32 m0, s45, 32896
s_add_u32 s40, s37, 1569792
buffer_load_dwordx4 v180, s[4:7], s40 offen nt lds
ds_read_b128 v[102:105], v210 offset:18432
ds_read_b128 v[106:109], v210 offset:19456
s_waitcnt lgkmcnt(1)
v_add_f32 v102, v102, v103
s_waitcnt lgkmcnt(0)
v_add_f32 v106, v106, v107
v_add_f32 v104, v104, v105
v_add_f32 v108, v108, v109
v_add_f32 v102, v102, v104
v_add_f32 v106, v106, v108
v_mul_f32 v103, s48, v102
v_mul_f32 v104, s73, v102
v_mul_f32 v106, s73, v106
v_fma_f32 v106, -v103, v104, v106
v_max_f32 v106, 0, v106
v_add_f32 v106, s49, v106
v_rsq_f32 v102, v106
s_nop 0
v_mul_f32_e64 v103, -v103, v102
ds_write_b64 v211, v[102:103]
ds_read_b64 v[118:119], v219
ds_read_b64 v[126:127], v219 offset:256
ds_read_b64 v[134:135], v219 offset:512
s_waitcnt lgkmcnt(2)
v_fma_f32 v220, v0, v118, v119
v_fma_f32 v221, v1, v118, v119
v_cvt_pk_bf16_f32 v90, v220, v221
v_fma_f32 v222, v2, v118, v119
v_fma_f32 v223, v3, v118, v119
v_cvt_pk_bf16_f32 v91, v222, v223
v_fma_f32 v220, v4, v118, v119
v_fma_f32 v221, v5, v118, v119
v_cvt_pk_bf16_f32 v92, v220, v221
v_fma_f32 v222, v6, v118, v119
v_fma_f32 v223, v7, v118, v119
v_cvt_pk_bf16_f32 v93, v222, v223
ds_write_b128 v211, v[90:93]
v_fma_f32 v220, v8, v118, v119
v_fma_f32 v221, v9, v118, v119
v_cvt_pk_bf16_f32 v94, v220, v221
v_fma_f32 v222, v10, v118, v119
v_fma_f32 v223, v11, v118, v119
v_cvt_pk_bf16_f32 v95, v222, v223
s_waitcnt lgkmcnt(2)
ds_write_b64 v212, v[94:95]
v_fma_f32 v220, v12, v126, v127
v_fma_f32 v221, v13, v126, v127
v_cvt_pk_bf16_f32 v174, v220, v221
v_fma_f32 v222, v14, v126, v127
v_fma_f32 v223, v15, v126, v127
v_cvt_pk_bf16_f32 v175, v222, v223
v_fma_f32 v220, v16, v126, v127
v_fma_f32 v221, v17, v126, v127
v_cvt_pk_bf16_f32 v176, v220, v221
v_fma_f32 v222, v18, v126, v127
v_fma_f32 v223, v19, v126, v127
v_cvt_pk_bf16_f32 v177, v222, v223
ds_write_b128 v211, v[174:177] offset:6144
v_fma_f32 v220, v20, v126, v127
v_fma_f32 v221, v21, v126, v127
v_cvt_pk_bf16_f32 v178, v220, v221
v_fma_f32 v222, v22, v126, v127
v_fma_f32 v223, v23, v126, v127
v_cvt_pk_bf16_f32 v179, v222, v223
s_waitcnt lgkmcnt(3)
ds_write_b64 v212, v[178:179] offset:6144
v_fma_f32 v220, v24, v134, v135
v_fma_f32 v221, v25, v134, v135
v_cvt_pk_bf16_f32 v90, v220, v221
v_fma_f32 v222, v26, v134, v135
v_fma_f32 v223, v27, v134, v135
v_cvt_pk_bf16_f32 v91, v222, v223
v_fma_f32 v220, v28, v134, v135
v_fma_f32 v221, v29, v134, v135
v_cvt_pk_bf16_f32 v92, v220, v221
v_fma_f32 v222, v30, v134, v135
v_fma_f32 v223, v31, v134, v135
v_cvt_pk_bf16_f32 v93, v222, v223
ds_write_b128 v211, v[90:93] offset:12288
v_fma_f32 v220, v32, v134, v135
v_fma_f32 v221, v33, v134, v135
v_cvt_pk_bf16_f32 v94, v220, v221
v_fma_f32 v222, v34, v134, v135
v_fma_f32 v223, v35, v134, v135
v_cvt_pk_bf16_f32 v95, v222, v223
ds_write_b64 v212, v[94:95] offset:12288
ds_read_b128 v[182:185], v210 offset:20480
s_waitcnt lgkmcnt(0)
v_mfma_f32_16x16x32_bf16 v[138:141], a[0:3], v[182:185], 0
v_mfma_f32_16x16x32_bf16 v[142:145], a[24:27], v[182:185], 0
v_mfma_f32_16x16x32_bf16 v[146:149], a[48:51], v[182:185], 0
v_mfma_f32_16x16x32_bf16 v[150:153], a[216:219], v[182:185], 0
v_mfma_f32_16x16x32_bf16 v[154:157], a[240:243], v[182:185], 0
v_mfma_f32_16x16x32_bf16 v[158:161], v[232:235], v[182:185], 0
v_mfma_f32_16x16x32_bf16 v[162:165], v[182:185], a[72:75], 0
v_mfma_f32_16x16x32_bf16 v[166:169], v[182:185], a[96:99], 0
v_mfma_f32_16x16x32_bf16 v[170:173], v[182:185], a[120:123], 0
ds_read_b128 v[186:189], v210 offset:21504
s_waitcnt lgkmcnt(0)
v_mfma_f32_16x16x32_bf16 v[138:141], a[4:7], v[186:189], v[138:141]
v_mfma_f32_16x16x32_bf16 v[142:145], a[28:31], v[186:189], v[142:145]
v_mfma_f32_16x16x32_bf16 v[146:149], a[52:55], v[186:189], v[146:149]
v_mfma_f32_16x16x32_bf16 v[150:153], a[220:223], v[186:189], v[150:153]
v_mfma_f32_16x16x32_bf16 v[154:157], a[244:247], v[186:189], v[154:157]
v_mfma_f32_16x16x32_bf16 v[158:161], v[236:239], v[186:189], v[158:161]
v_mfma_f32_16x16x32_bf16 v[162:165], v[186:189], a[76:79], v[162:165]
v_mfma_f32_16x16x32_bf16 v[166:169], v[186:189], a[100:103], v[166:169]
v_mfma_f32_16x16x32_bf16 v[170:173], v[186:189], a[124:127], v[170:173]
ds_read_b128 v[182:185], v210 offset:22528
s_waitcnt lgkmcnt(0)
v_mfma_f32_16x16x32_bf16 v[138:141], a[8:11], v[182:185], v[138:141]
v_mfma_f32_16x16x32_bf16 v[142:145], a[32:35], v[182:185], v[142:145]
v_mfma_f32_16x16x32_bf16 v[146:149], a[56:59], v[182:185], v[146:149]
v_mfma_f32_16x16x32_bf16 v[150:153], a[224:227], v[182:185], v[150:153]
v_mfma_f32_16x16x32_bf16 v[154:157], a[248:251], v[182:185], v[154:157]
v_mfma_f32_16x16x32_bf16 v[158:161], v[240:243], v[182:185], v[158:161]
v_mfma_f32_16x16x32_bf16 v[162:165], v[182:185], a[80:83], v[162:165]
v_mfma_f32_16x16x32_bf16 v[166:169], v[182:185], a[104:107], v[166:169]
v_mfma_f32_16x16x32_bf16 v[170:173], v[182:185], a[128:131], v[170:173]
ds_read_b128 v[186:189], v210 offset:23552
s_waitcnt lgkmcnt(0)
v_mfma_f32_16x16x32_bf16 v[138:141], a[12:15], v[186:189], v[138:141]
v_mfma_f32_16x16x32_bf16 v[142:145], a[36:39], v[186:189], v[142:145]
v_mfma_f32_16x16x32_bf16 v[146:149], a[60:63], v[186:189], v[146:149]
v_mfma_f32_16x16x32_bf16 v[150:153], a[228:231], v[186:189], v[150:153]
v_mfma_f32_16x16x32_bf16 v[154:157], a[252:255], v[186:189], v[154:157]
v_mfma_f32_16x16x32_bf16 v[158:161], v[244:247], v[186:189], v[158:161]
v_mfma_f32_16x16x32_bf16 v[162:165], v[186:189], a[84:87], v[162:165]
v_mfma_f32_16x16x32_bf16 v[166:169], v[186:189], a[108:111], v[166:169]
v_mfma_f32_16x16x32_bf16 v[170:173], v[186:189], a[132:135], v[170:173]
ds_read_b128 v[182:185], v210 offset:24576
s_waitcnt lgkmcnt(0)
v_mfma_f32_16x16x32_bf16 v[138:141], a[16:19], v[182:185], v[138:141]
v_mfma_f32_16x16x32_bf16 v[142:145], a[40:43], v[182:185], v[142:145]
v_mfma_f32_16x16x32_bf16 v[146:149], a[64:67], v[182:185], v[146:149]
v_mfma_f32_16x16x32_bf16 v[150:153], a[232:235], v[182:185], v[150:153]
v_mfma_f32_16x16x32_bf16 v[154:157], v[224:227], v[182:185], v[154:157]
v_mfma_f32_16x16x32_bf16 v[158:161], v[248:251], v[182:185], v[158:161]
v_mfma_f32_16x16x32_bf16 v[162:165], v[182:185], a[88:91], v[162:165]
v_mfma_f32_16x16x32_bf16 v[166:169], v[182:185], a[112:115], v[166:169]
v_mfma_f32_16x16x32_bf16 v[170:173], v[182:185], a[136:139], v[170:173]
ds_read_b128 v[186:189], v210 offset:25600
s_waitcnt lgkmcnt(0)
v_mfma_f32_16x16x32_bf16 v[138:141], a[20:23], v[186:189], v[138:141]
v_mfma_f32_16x16x32_bf16 v[142:145], a[44:47], v[186:189], v[142:145]
v_mfma_f32_16x16x32_bf16 v[146:149], a[68:71], v[186:189], v[146:149]
v_mfma_f32_16x16x32_bf16 v[150:153], a[236:239], v[186:189], v[150:153]
v_mfma_f32_16x16x32_bf16 v[154:157], v[228:231], v[186:189], v[154:157]
v_mfma_f32_16x16x32_bf16 v[158:161], v[252:255], v[186:189], v[158:161]
v_mfma_f32_16x16x32_bf16 v[162:165], v[186:189], a[92:95], v[162:165]
v_mfma_f32_16x16x32_bf16 v[166:169], v[186:189], a[116:119], v[166:169]
v_mfma_f32_16x16x32_bf16 v[170:173], v[186:189], a[140:143], v[170:173]
v_cvt_pk_bf16_f32 v78, v138, v139
v_cvt_pk_bf16_f32 v79, v140, v141
v_cvt_pk_bf16_f32 v80, v142, v143
v_cvt_pk_bf16_f32 v81, v144, v145
v_cvt_pk_bf16_f32 v82, v146, v147
v_cvt_pk_bf16_f32 v83, v148, v149
v_cvt_pk_bf16_f32 v72, v150, v151
v_cvt_pk_bf16_f32 v73, v152, v153
v_cvt_pk_bf16_f32 v74, v154, v155
v_cvt_pk_bf16_f32 v75, v156, v157
v_cvt_pk_bf16_f32 v76, v158, v159
v_cvt_pk_bf16_f32 v77, v160, v161
v_cvt_pk_bf16_f32 v114, v162, v163
v_cvt_pk_bf16_f32 v115, v164, v165
v_cvt_pk_bf16_f32 v122, v166, v167
v_cvt_pk_bf16_f32 v123, v168, v169
v_cvt_pk_bf16_f32 v130, v170, v171
v_cvt_pk_bf16_f32 v131, v172, v173
ds_read_b128 v[182:185], v210 offset:26624
s_waitcnt lgkmcnt(0)
v_mfma_f32_16x16x32_bf16 v[138:141], a[0:3], v[182:185], 0
v_mfma_f32_16x16x32_bf16 v[142:145], a[24:27], v[182:185], 0
v_mfma_f32_16x16x32_bf16 v[146:149], a[48:51], v[182:185], 0
v_mfma_f32_16x16x32_bf16 v[150:153], a[216:219], v[182:185], 0
v_mfma_f32_16x16x32_bf16 v[154:157], a[240:243], v[182:185], 0
v_mfma_f32_16x16x32_bf16 v[158:161], v[232:235], v[182:185], 0
v_mfma_f32_16x16x32_bf16 v[162:165], v[182:185], a[72:75], 0
v_mfma_f32_16x16x32_bf16 v[166:169], v[182:185], a[96:99], 0
v_mfma_f32_16x16x32_bf16 v[170:173], v[182:185], a[120:123], 0
ds_read_b128 v[186:189], v210 offset:27648
s_waitcnt lgkmcnt(0)
v_mfma_f32_16x16x32_bf16 v[138:141], a[4:7], v[186:189], v[138:141]
v_mfma_f32_16x16x32_bf16 v[142:145], a[28:31], v[186:189], v[142:145]
v_mfma_f32_16x16x32_bf16 v[146:149], a[52:55], v[186:189], v[146:149]
v_mfma_f32_16x16x32_bf16 v[150:153], a[220:223], v[186:189], v[150:153]
v_mfma_f32_16x16x32_bf16 v[154:157], a[244:247], v[186:189], v[154:157]
v_mfma_f32_16x16x32_bf16 v[158:161], v[236:239], v[186:189], v[158:161]
v_mfma_f32_16x16x32_bf16 v[162:165], v[186:189], a[76:79], v[162:165]
v_mfma_f32_16x16x32_bf16 v[166:169], v[186:189], a[100:103], v[166:169]
v_mfma_f32_16x16x32_bf16 v[170:173], v[186:189], a[124:127], v[170:173]
ds_read_b128 v[182:185], v210 offset:28672
s_waitcnt lgkmcnt(0)
v_mfma_f32_16x16x32_bf16 v[138:141], a[8:11], v[182:185], v[138:141]
v_mfma_f32_16x16x32_bf16 v[142:145], a[32:35], v[182:185], v[142:145]
v_mfma_f32_16x16x32_bf16 v[146:149], a[56:59], v[182:185], v[146:149]
v_mfma_f32_16x16x32_bf16 v[150:153], a[224:227], v[182:185], v[150:153]
v_mfma_f32_16x16x32_bf16 v[154:157], a[248:251], v[182:185], v[154:157]
v_mfma_f32_16x16x32_bf16 v[158:161], v[240:243], v[182:185], v[158:161]
v_mfma_f32_16x16x32_bf16 v[162:165], v[182:185], a[80:83], v[162:165]
v_mfma_f32_16x16x32_bf16 v[166:169], v[182:185], a[104:107], v[166:169]
v_mfma_f32_16x16x32_bf16 v[170:173], v[182:185], a[128:131], v[170:173]
ds_read_b128 v[186:189], v210 offset:29696
s_waitcnt lgkmcnt(0)
v_mfma_f32_16x16x32_bf16 v[138:141], a[12:15], v[186:189], v[138:141]
v_mfma_f32_16x16x32_bf16 v[142:145], a[36:39], v[186:189], v[142:145]
v_mfma_f32_16x16x32_bf16 v[146:149], a[60:63], v[186:189], v[146:149]
v_mfma_f32_16x16x32_bf16 v[150:153], a[228:231], v[186:189], v[150:153]
v_mfma_f32_16x16x32_bf16 v[154:157], a[252:255], v[186:189], v[154:157]
v_mfma_f32_16x16x32_bf16 v[158:161], v[244:247], v[186:189], v[158:161]
v_mfma_f32_16x16x32_bf16 v[162:165], v[186:189], a[84:87], v[162:165]
v_mfma_f32_16x16x32_bf16 v[166:169], v[186:189], a[108:111], v[166:169]
v_mfma_f32_16x16x32_bf16 v[170:173], v[186:189], a[132:135], v[170:173]
ds_read_b128 v[182:185], v210 offset:30720
s_waitcnt lgkmcnt(0)
v_mfma_f32_16x16x32_bf16 v[138:141], a[16:19], v[182:185], v[138:141]
v_mfma_f32_16x16x32_bf16 v[142:145], a[40:43], v[182:185], v[142:145]
v_mfma_f32_16x16x32_bf16 v[146:149], a[64:67], v[182:185], v[146:149]
v_mfma_f32_16x16x32_bf16 v[150:153], a[232:235], v[182:185], v[150:153]
v_mfma_f32_16x16x32_bf16 v[154:157], v[224:227], v[182:185], v[154:157]
v_mfma_f32_16x16x32_bf16 v[158:161], v[248:251], v[182:185], v[158:161]
v_mfma_f32_16x16x32_bf16 v[162:165], v[182:185], a[88:91], v[162:165]
v_mfma_f32_16x16x32_bf16 v[166:169], v[182:185], a[112:115], v[166:169]
v_mfma_f32_16x16x32_bf16 v[170:173], v[182:185], a[136:139], v[170:173]
ds_read_b128 v[186:189], v210 offset:31744
s_waitcnt lgkmcnt(0)
v_mfma_f32_16x16x32_bf16 v[138:141], a[20:23], v[186:189], v[138:141]
v_mfma_f32_16x16x32_bf16 v[142:145], a[44:47], v[186:189], v[142:145]
v_mfma_f32_16x16x32_bf16 v[146:149], a[68:71], v[186:189], v[146:149]
v_mfma_f32_16x16x32_bf16 v[150:153], a[236:239], v[186:189], v[150:153]
v_mfma_f32_16x16x32_bf16 v[154:157], v[228:231], v[186:189], v[154:157]
v_mfma_f32_16x16x32_bf16 v[158:161], v[252:255], v[186:189], v[158:161]
v_mfma_f32_16x16x32_bf16 v[162:165], v[186:189], a[92:95], v[162:165]
v_mfma_f32_16x16x32_bf16 v[166:169], v[186:189], a[116:119], v[166:169]
v_mfma_f32_16x16x32_bf16 v[170:173], v[186:189], a[140:143], v[170:173]
v_cvt_pk_bf16_f32 v96, v138, v139
v_cvt_pk_bf16_f32 v97, v140, v141
v_cvt_pk_bf16_f32 v98, v142, v143
v_cvt_pk_bf16_f32 v99, v144, v145
v_cvt_pk_bf16_f32 v100, v146, v147
v_cvt_pk_bf16_f32 v101, v148, v149
v_cvt_pk_bf16_f32 v84, v150, v151
v_cvt_pk_bf16_f32 v85, v152, v153
v_cvt_pk_bf16_f32 v86, v154, v155
v_cvt_pk_bf16_f32 v87, v156, v157
v_cvt_pk_bf16_f32 v88, v158, v159
v_cvt_pk_bf16_f32 v89, v160, v161
v_cvt_pk_bf16_f32 v116, v162, v163
v_cvt_pk_bf16_f32 v117, v164, v165
v_cvt_pk_bf16_f32 v124, v166, v167
v_cvt_pk_bf16_f32 v125, v168, v169
v_cvt_pk_bf16_f32 v132, v170, v171
v_cvt_pk_bf16_f32 v133, v172, v173
ds_read_b128 v[182:185], v210 offset:32768
s_waitcnt lgkmcnt(0)
v_mfma_f32_16x16x32_bf16 v[138:141], a[0:3], v[182:185], 0
v_mfma_f32_16x16x32_bf16 v[142:145], a[24:27], v[182:185], 0
v_mfma_f32_16x16x32_bf16 v[146:149], a[48:51], v[182:185], 0
ds_read_b128 v[186:189], v210 offset:33792
s_waitcnt lgkmcnt(0)
v_mfma_f32_16x16x32_bf16 v[138:141], a[4:7], v[186:189], v[138:141]
v_mfma_f32_16x16x32_bf16 v[142:145], a[28:31], v[186:189], v[142:145]
v_mfma_f32_16x16x32_bf16 v[146:149], a[52:55], v[186:189], v[146:149]
ds_read_b128 v[182:185], v210 offset:34816
s_waitcnt lgkmcnt(0)
v_mfma_f32_16x16x32_bf16 v[138:141], a[8:11], v[182:185], v[138:141]
v_mfma_f32_16x16x32_bf16 v[142:145], a[32:35], v[182:185], v[142:145]
v_mfma_f32_16x16x32_bf16 v[146:149], a[56:59], v[182:185], v[146:149]
ds_read_b128 v[186:189], v210 offset:35840
s_waitcnt lgkmcnt(0)
v_mfma_f32_16x16x32_bf16 v[138:141], a[12:15], v[186:189], v[138:141]
v_mfma_f32_16x16x32_bf16 v[142:145], a[36:39], v[186:189], v[142:145]
v_mfma_f32_16x16x32_bf16 v[146:149], a[60:63], v[186:189], v[146:149]
ds_read_b128 v[182:185], v210 offset:36864
s_waitcnt lgkmcnt(0)
v_mfma_f32_16x16x32_bf16 v[138:141], a[16:19], v[182:185], v[138:141]
v_mfma_f32_16x16x32_bf16 v[142:145], a[40:43], v[182:185], v[142:145]
v_mfma_f32_16x16x32_bf16 v[146:149], a[64:67], v[182:185], v[146:149]
ds_read_b128 v[186:189], v210 offset:37888
s_waitcnt lgkmcnt(0)
v_mfma_f32_16x16x32_bf16 v[138:141], a[20:23], v[186:189], v[138:141]
v_mfma_f32_16x16x32_bf16 v[142:145], a[44:47], v[186:189], v[142:145]
v_mfma_f32_16x16x32_bf16 v[146:149], a[68:71], v[186:189], v[146:149]
v_cvt_pk_bf16_f32 v102, v138, v139
v_cvt_pk_bf16_f32 v103, v140, v141
s_nop 0
v_cvt_pk_bf16_f32 v104, v142, v143
v_cvt_pk_bf16_f32 v105, v144, v145
s_nop 1
v_cvt_pk_bf16_f32 v106, v146, v147
v_cvt_pk_bf16_f32 v107, v148, v149
ds_read_b128 v[108:111], v215 offset:512
ds_read_b64 v[112:113], v215 offset:528
v_mov_b32 v181, 0
v_mfma_f32_16x16x16_bf16 v[138:141], v[82:83], v[76:77], 0
v_mfma_f32_16x16x16_bf16 v[142:145], v[100:101], v[76:77], 0
s_waitcnt lgkmcnt(0)
v_mfma_f32_16x16x16_bf16 v[150:153], v[112:113], v[76:77], v[206:209]
v_mfma_f32_16x16x16_bf16 v[146:149], v[106:107], v[76:77], 0
v_mfma_f32_16x16x32_bf16 v[138:141], v[78:81], v[72:75], v[138:141]
v_mfma_f32_16x16x32_bf16 v[142:145], v[96:99], v[72:75], v[142:145]
v_mfma_f32_16x16x32_bf16 v[150:153], v[108:111], v[72:75], v[150:153]
v_mfma_f32_16x16x32_bf16 v[146:149], v[102:105], v[72:75], v[146:149]
ds_read_b128 v[72:75], v215
ds_read_b64 v[76:77], v215 offset:16
v_mfma_f32_16x16x16_bf16 v[154:157], v[82:83], v[88:89], 0
v_mfma_f32_16x16x16_bf16 v[158:161], v[100:101], v[88:89], 0
v_mfma_f32_16x16x16_bf16 v[166:169], v[112:113], v[88:89], v[206:209]
v_mfma_f32_16x16x16_bf16 v[162:165], v[106:107], v[88:89], 0
v_mfma_f32_16x16x32_bf16 v[154:157], v[78:81], v[84:87], v[154:157]
v_mfma_f32_16x16x32_bf16 v[158:161], v[96:99], v[84:87], v[158:161]
v_mfma_f32_16x16x32_bf16 v[166:169], v[108:111], v[84:87], v[166:169]
v_mfma_f32_16x16x32_bf16 v[162:165], v[102:105], v[84:87], v[162:165]
ds_read_b128 v[182:185], v210 offset:32768
s_waitcnt lgkmcnt(0)
v_mfma_f32_16x16x32_bf16 v[118:121], v[182:185], a[72:75], 0
v_mfma_f32_16x16x32_bf16 v[126:129], v[182:185], a[96:99], 0
v_mfma_f32_16x16x32_bf16 v[134:137], v[182:185], a[120:123], 0
v_mfma_f32_16x16x32_bf16 v[90:93], a[216:219], v[182:185], 0
v_mfma_f32_16x16x32_bf16 v[170:173], a[240:243], v[182:185], 0
v_mfma_f32_16x16x32_bf16 v[220:223], v[232:235], v[182:185], 0
ds_read_b128 v[186:189], v210 offset:33792
s_waitcnt lgkmcnt(0)
v_mfma_f32_16x16x32_bf16 v[118:121], v[186:189], a[76:79], v[118:121]
v_mfma_f32_16x16x32_bf16 v[126:129], v[186:189], a[100:103], v[126:129]
v_mfma_f32_16x16x32_bf16 v[134:137], v[186:189], a[124:127], v[134:137]
v_mfma_f32_16x16x32_bf16 v[90:93], a[220:223], v[186:189], v[90:93]
v_mfma_f32_16x16x32_bf16 v[170:173], a[244:247], v[186:189], v[170:173]
v_mfma_f32_16x16x32_bf16 v[220:223], v[236:239], v[186:189], v[220:223]
ds_read_b128 v[182:185], v210 offset:34816
s_waitcnt lgkmcnt(0)
v_mfma_f32_16x16x32_bf16 v[118:121], v[182:185], a[80:83], v[118:121]
v_mfma_f32_16x16x32_bf16 v[126:129], v[182:185], a[104:107], v[126:129]
v_mfma_f32_16x16x32_bf16 v[134:137], v[182:185], a[128:131], v[134:137]
v_mfma_f32_16x16x32_bf16 v[90:93], a[224:227], v[182:185], v[90:93]
v_mfma_f32_16x16x32_bf16 v[170:173], a[248:251], v[182:185], v[170:173]
v_mfma_f32_16x16x32_bf16 v[220:223], v[240:243], v[182:185], v[220:223]
ds_read_b128 v[186:189], v210 offset:35840
s_waitcnt lgkmcnt(0)
v_mfma_f32_16x16x32_bf16 v[118:121], v[186:189], a[84:87], v[118:121]
v_mfma_f32_16x16x32_bf16 v[126:129], v[186:189], a[108:111], v[126:129]
v_mfma_f32_16x16x32_bf16 v[134:137], v[186:189], a[132:135], v[134:137]
v_mfma_f32_16x16x32_bf16 v[90:93], a[228:231], v[186:189], v[90:93]
v_mfma_f32_16x16x32_bf16 v[170:173], a[252:255], v[186:189], v[170:173]
v_mfma_f32_16x16x32_bf16 v[220:223], v[244:247], v[186:189], v[220:223]
ds_read_b128 v[182:185], v210 offset:36864
s_waitcnt lgkmcnt(0)
v_mfma_f32_16x16x32_bf16 v[118:121], v[182:185], a[88:91], v[118:121]
v_mfma_f32_16x16x32_bf16 v[126:129], v[182:185], a[112:115], v[126:129]
v_mfma_f32_16x16x32_bf16 v[134:137], v[182:185], a[136:139], v[134:137]
v_mfma_f32_16x16x32_bf16 v[90:93], a[232:235], v[182:185], v[90:93]
v_mfma_f32_16x16x32_bf16 v[170:173], v[224:227], v[182:185], v[170:173]
v_mfma_f32_16x16x32_bf16 v[220:223], v[248:251], v[182:185], v[220:223]
ds_read_b128 v[186:189], v210 offset:37888
s_waitcnt lgkmcnt(0)
v_mfma_f32_16x16x32_bf16 v[118:121], v[186:189], a[92:95], v[118:121]
v_mfma_f32_16x16x32_bf16 v[126:129], v[186:189], a[116:119], v[126:129]
v_mfma_f32_16x16x32_bf16 v[134:137], v[186:189], a[140:143], v[134:137]
v_mfma_f32_16x16x32_bf16 v[90:93], a[236:239], v[186:189], v[90:93]
v_mfma_f32_16x16x32_bf16 v[170:173], v[228:231], v[186:189], v[170:173]
v_mfma_f32_16x16x32_bf16 v[220:223], v[252:255], v[186:189], v[220:223]
v_cvt_pk_bf16_f32 v118, v118, v119
v_cvt_pk_bf16_f32 v119, v120, v121
ds_read_u16 v120, v214 offset:1024
v_mov_b32 v121, 0
v_cvt_pk_bf16_f32 v126, v126, v127
v_cvt_pk_bf16_f32 v127, v128, v129
ds_read_u16 v128, v214 offset:1032
v_mov_b32 v129, 0
v_cvt_pk_bf16_f32 v134, v134, v135
v_cvt_pk_bf16_f32 v135, v136, v137
ds_read_u16 v136, v214 offset:1040
v_mov_b32 v137, 0
v_cvt_pk_bf16_f32 v90, v90, v91
v_cvt_pk_bf16_f32 v91, v92, v93
v_cvt_pk_bf16_f32 v92, v170, v171
v_cvt_pk_bf16_f32 v93, v172, v173
v_cvt_pk_bf16_f32 v94, v220, v221
v_cvt_pk_bf16_f32 v95, v222, v223
v_max3_f32 v151, v138, v139, v140
v_max3_f32 v151, v151, v141, v142
v_max3_f32 v151, v151, v143, v144
v_max3_f32 v151, v151, v145, v146
v_max3_f32 v151, v151, v147, v148
v_max3_f32 v151, v151, v149, v150
v_mov_b32 v152, v151
s_nop 1
v_permlane16_swap_b32 v151, v152
v_max_f32 v151, v151, v152
v_mov_b32 v152, v151
s_nop 1
v_permlane32_swap_b32 v151, v152
v_max_f32 v151, v151, v152
v_sub_f32 v138, v138, v151
v_sub_f32 v139, v139, v151
v_sub_f32 v140, v140, v151
v_sub_f32 v141, v141, v151
v_sub_f32 v142, v142, v151
v_sub_f32 v143, v143, v151
v_sub_f32 v144, v144, v151
v_sub_f32 v145, v145, v151
v_sub_f32 v150, v150, v151
v_sub_f32 v146, v146, v151
v_sub_f32 v147, v147, v151
v_sub_f32 v148, v148, v151
v_sub_f32 v149, v149, v151
v_exp_f32 v138, v138
v_exp_f32 v139, v139
v_exp_f32 v140, v140
v_exp_f32 v141, v141
v_exp_f32 v142, v142
v_exp_f32 v143, v143
v_exp_f32 v144, v144
v_exp_f32 v145, v145
v_exp_f32 v150, v150
v_exp_f32 v146, v146
v_exp_f32 v147, v147
v_exp_f32 v148, v148
v_exp_f32 v149, v149
v_cvt_pk_bf16_f32 v174, v138, v139
v_cvt_pk_bf16_f32 v175, v140, v141
v_cvt_pk_bf16_f32 v176, v142, v143
v_cvt_pk_bf16_f32 v177, v144, v145
v_cvt_pk_bf16_f32 v178, v146, v147
v_cvt_pk_bf16_f32 v179, v148, v149
v_cvt_pk_bf16_f32 v180, v150, 0
v_mfma_f32_16x16x32_bf16 v[150:153], v[190:193], v[174:177], 0
v_mfma_f32_16x16x32_bf16 v[138:141], v[114:117], v[174:177], 0
v_mfma_f32_16x16x32_bf16 v[142:145], v[122:125], v[174:177], 0
v_mfma_f32_16x16x32_bf16 v[146:149], v[130:133], v[174:177], 0
v_mfma_f32_16x16x32_bf16 v[150:153], v[190:193], v[178:181], v[150:153]
s_waitcnt lgkmcnt(2)
v_mfma_f32_16x16x32_bf16 v[138:141], v[118:121], v[178:181], v[138:141]
s_waitcnt lgkmcnt(1)
v_mfma_f32_16x16x32_bf16 v[142:145], v[126:129], v[178:181], v[142:145]
s_waitcnt lgkmcnt(0)
v_mfma_f32_16x16x32_bf16 v[146:149], v[134:137], v[178:181], v[146:149]
v_max3_f32 v167, v154, v155, v156
v_max3_f32 v167, v167, v157, v158
v_max3_f32 v167, v167, v159, v160
v_max3_f32 v167, v167, v161, v162
v_max3_f32 v167, v167, v163, v164
v_max3_f32 v167, v167, v165, v166
v_mov_b32 v168, v167
s_nop 1
v_permlane16_swap_b32 v167, v168
v_max_f32 v167, v167, v168
v_mov_b32 v168, v167
s_nop 1
v_permlane32_swap_b32 v167, v168
v_max_f32 v167, v167, v168
v_sub_f32 v154, v154, v167
v_sub_f32 v155, v155, v167
v_sub_f32 v156, v156, v167
v_sub_f32 v157, v157, v167
v_sub_f32 v158, v158, v167
v_sub_f32 v159, v159, v167
v_sub_f32 v160, v160, v167
v_sub_f32 v161, v161, v167
v_sub_f32 v166, v166, v167
v_sub_f32 v162, v162, v167
v_sub_f32 v163, v163, v167
v_sub_f32 v164, v164, v167
v_sub_f32 v165, v165, v167
v_exp_f32 v154, v154
v_exp_f32 v155, v155
v_exp_f32 v156, v156
v_exp_f32 v157, v157
v_exp_f32 v158, v158
v_exp_f32 v159, v159
v_exp_f32 v160, v160
v_exp_f32 v161, v161
v_exp_f32 v166, v166
v_exp_f32 v162, v162
v_exp_f32 v163, v163
v_exp_f32 v164, v164
v_exp_f32 v165, v165
v_cvt_pk_bf16_f32 v174, v154, v155
v_cvt_pk_bf16_f32 v175, v156, v157
v_cvt_pk_bf16_f32 v176, v158, v159
v_cvt_pk_bf16_f32 v177, v160, v161
v_cvt_pk_bf16_f32 v178, v162, v163
v_cvt_pk_bf16_f32 v179, v164, v165
v_cvt_pk_bf16_f32 v180, v166, 0
v_mfma_f32_16x16x32_bf16 v[166:169], v[190:193], v[174:177], 0
v_mfma_f32_16x16x32_bf16 v[154:157], v[114:117], v[174:177], 0
v_mfma_f32_16x16x32_bf16 v[158:161], v[122:125], v[174:177], 0
v_mfma_f32_16x16x32_bf16 v[162:165], v[130:133], v[174:177], 0
v_mfma_f32_16x16x32_bf16 v[166:169], v[190:193], v[178:181], v[166:169]
v_mfma_f32_16x16x32_bf16 v[154:157], v[118:121], v[178:181], v[154:157]
v_mfma_f32_16x16x32_bf16 v[158:161], v[126:129], v[178:181], v[158:161]
v_mfma_f32_16x16x32_bf16 v[162:165], v[134:137], v[178:181], v[162:165]
v_rcp_f32 v151, v150
s_nop 0
v_mul_f32 v151, s3, v151
v_mul_f32 v138, v138, v151
v_mul_f32 v139, v139, v151
v_cvt_pk_bf16_f32 v138, v138, v139
v_mul_f32 v140, v140, v151
v_mul_f32 v141, v141, v151
v_cvt_pk_bf16_f32 v139, v140, v141
v_mul_f32 v142, v142, v151
v_mul_f32 v143, v143, v151
v_cvt_pk_bf16_f32 v140, v142, v143
v_mul_f32 v144, v144, v151
v_mul_f32 v145, v145, v151
v_cvt_pk_bf16_f32 v141, v144, v145
ds_write_b128 v211, v[138:141] offset:38912
v_mul_f32 v146, v146, v151
v_mul_f32 v147, v147, v151
v_cvt_pk_bf16_f32 v142, v146, v147
v_mul_f32 v148, v148, v151
v_mul_f32 v149, v149, v151
v_cvt_pk_bf16_f32 v143, v148, v149
ds_write_b64 v212, v[142:143] offset:38912
v_mfma_f32_16x16x32_bf16 v[138:141], v[78:81], v[90:93], 0
v_mfma_f32_16x16x32_bf16 v[142:145], v[96:99], v[90:93], 0
v_mfma_f32_16x16x32_bf16 v[150:153], v[108:111], v[90:93], v[206:209]
v_mfma_f32_16x16x32_bf16 v[146:149], v[102:105], v[90:93], 0
v_mfma_f32_16x16x16_bf16 v[138:141], v[82:83], v[94:95], v[138:141]
v_mfma_f32_16x16x16_bf16 v[142:145], v[100:101], v[94:95], v[142:145]
v_mfma_f32_16x16x16_bf16 v[150:153], v[112:113], v[94:95], v[150:153]
v_mfma_f32_16x16x16_bf16 v[146:149], v[106:107], v[94:95], v[146:149]
v_rcp_f32 v167, v166
s_nop 0
v_mul_f32 v167, s3, v167
v_mul_f32 v154, v154, v167
v_mul_f32 v155, v155, v167
v_cvt_pk_bf16_f32 v154, v154, v155
v_mul_f32 v156, v156, v167
v_mul_f32 v157, v157, v167
v_cvt_pk_bf16_f32 v155, v156, v157
v_mul_f32 v158, v158, v167
v_mul_f32 v159, v159, v167
v_cvt_pk_bf16_f32 v156, v158, v159
v_mul_f32 v160, v160, v167
v_mul_f32 v161, v161, v167
v_cvt_pk_bf16_f32 v157, v160, v161
ds_write_b128 v211, v[154:157] offset:45056
v_mul_f32 v162, v162, v167
v_mul_f32 v163, v163, v167
v_cvt_pk_bf16_f32 v158, v162, v163
v_mul_f32 v164, v164, v167
v_mul_f32 v165, v165, v167
v_cvt_pk_bf16_f32 v159, v164, v165
ds_write_b64 v212, v[158:159] offset:45056
v_mfma_f32_16x16x16_bf16 v[154:157], v[76:77], v[82:83], 0
v_mfma_f32_16x16x16_bf16 v[158:161], v[76:77], v[100:101], 0
v_mfma_f32_16x16x16_bf16 v[162:165], v[76:77], v[106:107], 0
v_mfma_f32_16x16x16_bf16 v[166:169], v[76:77], v[112:113], v[206:209]
v_mfma_f32_16x16x32_bf16 v[154:157], v[72:75], v[78:81], v[154:157]
v_mfma_f32_16x16x32_bf16 v[158:161], v[72:75], v[96:99], v[158:161]
v_mfma_f32_16x16x32_bf16 v[162:165], v[72:75], v[102:105], v[162:165]
v_mfma_f32_16x16x32_bf16 v[166:169], v[72:75], v[108:111], v[166:169]
v_mov_b32_dpp v154, v158 quad_perm:[0,1,2,3] row_mask:0x2 bank_mask:0xf
s_nop 1
v_mov_b32_dpp v154, v162 quad_perm:[0,1,2,3] row_mask:0x4 bank_mask:0xf
s_nop 2
v_mov_b32_dpp v154, v167 quad_perm:[0,1,2,3] row_mask:0x8 bank_mask:0xf
v_mov_b32 v155, v154
s_nop 1
v_max_f32_dpp v155, v155, v155 row_ror:8 row_mask:0xf bank_mask:0xf
s_nop 1
v_max_f32_dpp v155, v155, v155 row_ror:4 row_mask:0xf bank_mask:0xf
s_nop 1
v_max_f32_dpp v155, v155, v155 row_ror:2 row_mask:0xf bank_mask:0xf
s_nop 1
v_max_f32_dpp v155, v155, v155 row_ror:1 row_mask:0xf bank_mask:0xf
v_mov_b32 v156, v155
s_nop 1
v_permlane16_swap_b32 v155, v156
v_max_f32 v155, v155, v156
v_mov_b32 v156, v155
s_nop 1
v_permlane32_swap_b32 v155, v156
v_max_f32 v155, v155, v156
v_sub_f32 v154, v154, v155
v_exp_f32 v154, v154
s_nop 0
v_cvt_pk_bf16_f32 v154, v154, 0
ds_write_b16 v214, v154
s_waitcnt lgkmcnt(1)
ds_read_b128 v[84:87], v215
ds_read_b128 v[88:91], v215 offset:16
v_add_u32 v215, 1552, v215
s_barrier
ds_read_b128 v[170:173], v210 offset:38912
s_waitcnt lgkmcnt(0)
v_mfma_f32_16x16x32_bf16 v[36:39], a[144:147], v[170:173], v[36:39]
v_mfma_f32_16x16x32_bf16 v[40:43], a[168:171], v[170:173], v[40:43]
v_mfma_f32_16x16x32_bf16 v[44:47], a[192:195], v[170:173], v[44:47]
ds_read_b128 v[182:185], v210 offset:39936
s_waitcnt lgkmcnt(0)
v_mfma_f32_16x16x32_bf16 v[36:39], a[148:151], v[182:185], v[36:39]
v_mfma_f32_16x16x32_bf16 v[40:43], a[172:175], v[182:185], v[40:43]
v_mfma_f32_16x16x32_bf16 v[44:47], a[196:199], v[182:185], v[44:47]
ds_read_b128 v[186:189], v210 offset:40960
s_waitcnt lgkmcnt(0)
v_mfma_f32_16x16x32_bf16 v[36:39], a[152:155], v[186:189], v[36:39]
v_mfma_f32_16x16x32_bf16 v[40:43], a[176:179], v[186:189], v[40:43]
v_mfma_f32_16x16x32_bf16 v[44:47], a[200:203], v[186:189], v[44:47]
ds_read_b128 v[170:173], v210 offset:41984
s_waitcnt lgkmcnt(0)
v_mfma_f32_16x16x32_bf16 v[36:39], a[156:159], v[170:173], v[36:39]
v_mfma_f32_16x16x32_bf16 v[40:43], a[180:183], v[170:173], v[40:43]
v_mfma_f32_16x16x32_bf16 v[44:47], a[204:207], v[170:173], v[44:47]
ds_read_b128 v[182:185], v210 offset:43008
s_waitcnt lgkmcnt(0)
v_mfma_f32_16x16x32_bf16 v[36:39], a[160:163], v[182:185], v[36:39]
v_mfma_f32_16x16x32_bf16 v[40:43], a[184:187], v[182:185], v[40:43]
v_mfma_f32_16x16x32_bf16 v[44:47], a[208:211], v[182:185], v[44:47]
ds_read_b128 v[186:189], v210 offset:44032
s_waitcnt lgkmcnt(0)
v_mfma_f32_16x16x32_bf16 v[36:39], a[164:167], v[186:189], v[36:39]
v_mfma_f32_16x16x32_bf16 v[40:43], a[188:191], v[186:189], v[40:43]
v_mfma_f32_16x16x32_bf16 v[44:47], a[212:215], v[186:189], v[44:47]
v_cvt_pk_bf16_f32 v72, v36, v37
v_cvt_pk_bf16_f32 v73, v38, v39
buffer_store_dwordx2 v[72:73], v203, s[8:11], s39 offen
v_cvt_pk_bf16_f32 v74, v40, v41
v_cvt_pk_bf16_f32 v75, v42, v43
buffer_store_dwordx2 v[74:75], v203, s[8:11], s39 offen offset:32
s_nop 0
v_cvt_pk_bf16_f32 v76, v44, v45
v_cvt_pk_bf16_f32 v77, v46, v47
buffer_store_dwordx2 v[76:77], v203, s[8:11], s39 offen offset:64
v_max3_f32 v151, v138, v139, v140
v_max3_f32 v151, v151, v141, v142
v_max3_f32 v151, v151, v143, v144
v_max3_f32 v151, v151, v145, v146
v_max3_f32 v151, v151, v147, v148
v_max3_f32 v151, v151, v149, v150
v_mov_b32 v152, v151
s_nop 1
v_permlane16_swap_b32 v151, v152
v_max_f32 v151, v151, v152
v_mov_b32 v152, v151
s_nop 1
v_permlane32_swap_b32 v151, v152
v_max_f32 v151, v151, v152
v_sub_f32 v138, v138, v151
v_sub_f32 v139, v139, v151
v_sub_f32 v140, v140, v151
v_sub_f32 v141, v141, v151
v_sub_f32 v142, v142, v151
v_sub_f32 v143, v143, v151
v_sub_f32 v144, v144, v151
v_sub_f32 v145, v145, v151
v_sub_f32 v150, v150, v151
v_sub_f32 v146, v146, v151
v_sub_f32 v147, v147, v151
v_sub_f32 v148, v148, v151
v_sub_f32 v149, v149, v151
v_exp_f32 v138, v138
v_exp_f32 v139, v139
v_exp_f32 v140, v140
v_exp_f32 v141, v141
v_exp_f32 v142, v142
v_exp_f32 v143, v143
v_exp_f32 v144, v144
v_exp_f32 v145, v145
v_exp_f32 v150, v150
v_exp_f32 v146, v146
v_exp_f32 v147, v147
v_exp_f32 v148, v148
v_exp_f32 v149, v149
v_cvt_pk_bf16_f32 v174, v138, v139
v_cvt_pk_bf16_f32 v175, v140, v141
v_cvt_pk_bf16_f32 v176, v142, v143
v_cvt_pk_bf16_f32 v177, v144, v145
v_cvt_pk_bf16_f32 v178, v146, v147
v_cvt_pk_bf16_f32 v179, v148, v149
v_cvt_pk_bf16_f32 v180, v150, 0
v_mfma_f32_16x16x32_bf16 v[150:153], v[190:193], v[174:177], 0
v_mfma_f32_16x16x32_bf16 v[138:141], v[114:117], v[174:177], 0
v_mfma_f32_16x16x32_bf16 v[142:145], v[122:125], v[174:177], 0
v_mfma_f32_16x16x32_bf16 v[146:149], v[130:133], v[174:177], 0
v_mfma_f32_16x16x32_bf16 v[150:153], v[190:193], v[178:181], v[150:153]
v_mfma_f32_16x16x32_bf16 v[138:141], v[118:121], v[178:181], v[138:141]
v_mfma_f32_16x16x32_bf16 v[142:145], v[126:129], v[178:181], v[142:145]
v_mfma_f32_16x16x32_bf16 v[146:149], v[134:137], v[178:181], v[146:149]
v_mfma_f32_16x16x32_bf16 v[166:169], v[84:87], v[190:193], 0
v_mfma_f32_16x16x32_bf16 v[154:157], v[84:87], v[114:117], 0
v_mfma_f32_16x16x32_bf16 v[158:161], v[84:87], v[122:125], 0
v_mfma_f32_16x16x32_bf16 v[162:165], v[84:87], v[130:133], 0
v_mfma_f32_16x16x32_bf16 v[166:169], v[88:91], v[190:193], v[166:169]
v_mfma_f32_16x16x32_bf16 v[154:157], v[88:91], v[118:121], v[154:157]
v_mfma_f32_16x16x32_bf16 v[158:161], v[88:91], v[126:129], v[158:161]
v_mfma_f32_16x16x32_bf16 v[162:165], v[88:91], v[134:137], v[162:165]
v_rcp_f32 v167, v166
s_nop 1
v_mov_b32_dpp v154, v158 quad_perm:[0,1,2,3] row_mask:0x2 bank_mask:0xf
s_nop 2
v_mov_b32_dpp v154, v162 quad_perm:[0,1,2,3] row_mask:0x4 bank_mask:0xf
v_mul_f32 v167, s3, v167
v_mul_f32 v154, v154, v167
v_cvt_pk_bf16_f32 v154, v154, 0
ds_write_b16 v214, v154
v_add_u32 v214, 1552, v214
ds_read_b128 v[170:173], v210 offset:45056
s_waitcnt lgkmcnt(0)
v_mfma_f32_16x16x32_bf16 v[48:51], a[144:147], v[170:173], v[48:51]
v_mfma_f32_16x16x32_bf16 v[52:55], a[168:171], v[170:173], v[52:55]
v_mfma_f32_16x16x32_bf16 v[56:59], a[192:195], v[170:173], v[56:59]
ds_read_b128 v[182:185], v210 offset:46080
s_waitcnt lgkmcnt(0)
v_mfma_f32_16x16x32_bf16 v[48:51], a[148:151], v[182:185], v[48:51]
v_mfma_f32_16x16x32_bf16 v[52:55], a[172:175], v[182:185], v[52:55]
v_mfma_f32_16x16x32_bf16 v[56:59], a[196:199], v[182:185], v[56:59]
ds_read_b128 v[186:189], v210 offset:47104
s_waitcnt lgkmcnt(0)
v_mfma_f32_16x16x32_bf16 v[48:51], a[152:155], v[186:189], v[48:51]
v_mfma_f32_16x16x32_bf16 v[52:55], a[176:179], v[186:189], v[52:55]
v_mfma_f32_16x16x32_bf16 v[56:59], a[200:203], v[186:189], v[56:59]
ds_read_b128 v[170:173], v210 offset:48128
s_waitcnt lgkmcnt(0)
v_mfma_f32_16x16x32_bf16 v[48:51], a[156:159], v[170:173], v[48:51]
v_mfma_f32_16x16x32_bf16 v[52:55], a[180:183], v[170:173], v[52:55]
v_mfma_f32_16x16x32_bf16 v[56:59], a[204:207], v[170:173], v[56:59]
ds_read_b128 v[182:185], v210 offset:49152
s_waitcnt lgkmcnt(0)
v_mfma_f32_16x16x32_bf16 v[48:51], a[160:163], v[182:185], v[48:51]
v_mfma_f32_16x16x32_bf16 v[52:55], a[184:187], v[182:185], v[52:55]
v_mfma_f32_16x16x32_bf16 v[56:59], a[208:211], v[182:185], v[56:59]
ds_read_b128 v[186:189], v210 offset:50176
s_waitcnt lgkmcnt(0)
v_mfma_f32_16x16x32_bf16 v[48:51], a[164:167], v[186:189], v[48:51]
v_mfma_f32_16x16x32_bf16 v[52:55], a[188:191], v[186:189], v[52:55]
v_mfma_f32_16x16x32_bf16 v[56:59], a[212:215], v[186:189], v[56:59]
v_cvt_pk_bf16_f32 v78, v48, v49
v_cvt_pk_bf16_f32 v79, v50, v51
buffer_store_dwordx2 v[78:79], v204, s[8:11], s39 offen
v_cvt_pk_bf16_f32 v80, v52, v53
v_cvt_pk_bf16_f32 v81, v54, v55
buffer_store_dwordx2 v[80:81], v204, s[8:11], s39 offen offset:32
s_nop 0
v_cvt_pk_bf16_f32 v82, v56, v57
v_cvt_pk_bf16_f32 v83, v58, v59
buffer_store_dwordx2 v[82:83], v204, s[8:11], s39 offen offset:64
v_rcp_f32 v151, v150
s_nop 0
v_mul_f32 v151, s3, v151
v_mul_f32 v138, v138, v151
v_mul_f32 v139, v139, v151
v_cvt_pk_bf16_f32 v138, v138, v139
v_mul_f32 v140, v140, v151
v_mul_f32 v141, v141, v151
v_cvt_pk_bf16_f32 v139, v140, v141
v_mul_f32 v142, v142, v151
v_mul_f32 v143, v143, v151
v_cvt_pk_bf16_f32 v140, v142, v143
v_mul_f32 v144, v144, v151
v_mul_f32 v145, v145, v151
v_cvt_pk_bf16_f32 v141, v144, v145
ds_write_b128 v211, v[138:141] offset:51200
v_mul_f32 v146, v146, v151
v_mul_f32 v147, v147, v151
v_cvt_pk_bf16_f32 v142, v146, v147
v_mul_f32 v148, v148, v151
v_mul_f32 v149, v149, v151
v_cvt_pk_bf16_f32 v143, v148, v149
ds_write_b64 v212, v[142:143] offset:51200
s_waitcnt vmcnt(6) lgkmcnt(0)
s_barrier
ds_read_b128 v[170:173], v210 offset:51200
s_waitcnt lgkmcnt(0)
v_mfma_f32_16x16x32_bf16 v[60:63], a[144:147], v[170:173], v[60:63]
v_mfma_f32_16x16x32_bf16 v[64:67], a[168:171], v[170:173], v[64:67]
v_mfma_f32_16x16x32_bf16 v[68:71], a[192:195], v[170:173], v[68:71]
ds_read_b128 v[182:185], v210 offset:52224
s_waitcnt lgkmcnt(0)
v_mfma_f32_16x16x32_bf16 v[60:63], a[148:151], v[182:185], v[60:63]
v_mfma_f32_16x16x32_bf16 v[64:67], a[172:175], v[182:185], v[64:67]
v_mfma_f32_16x16x32_bf16 v[68:71], a[196:199], v[182:185], v[68:71]
ds_read_b128 v[186:189], v210 offset:53248
s_waitcnt lgkmcnt(0)
v_mfma_f32_16x16x32_bf16 v[60:63], a[152:155], v[186:189], v[60:63]
v_mfma_f32_16x16x32_bf16 v[64:67], a[176:179], v[186:189], v[64:67]
v_mfma_f32_16x16x32_bf16 v[68:71], a[200:203], v[186:189], v[68:71]
ds_read_b128 v[170:173], v210 offset:54272
s_waitcnt lgkmcnt(0)
v_mfma_f32_16x16x32_bf16 v[60:63], a[156:159], v[170:173], v[60:63]
v_mfma_f32_16x16x32_bf16 v[64:67], a[180:183], v[170:173], v[64:67]
v_mfma_f32_16x16x32_bf16 v[68:71], a[204:207], v[170:173], v[68:71]
ds_read_b128 v[182:185], v210 offset:55296
s_waitcnt lgkmcnt(0)
v_mfma_f32_16x16x32_bf16 v[60:63], a[160:163], v[182:185], v[60:63]
v_mfma_f32_16x16x32_bf16 v[64:67], a[184:187], v[182:185], v[64:67]
v_mfma_f32_16x16x32_bf16 v[68:71], a[208:211], v[182:185], v[68:71]
ds_read_b128 v[186:189], v210 offset:56320
s_waitcnt lgkmcnt(0)
v_mfma_f32_16x16x32_bf16 v[60:63], a[164:167], v[186:189], v[60:63]
v_mfma_f32_16x16x32_bf16 v[64:67], a[188:191], v[186:189], v[64:67]
v_mfma_f32_16x16x32_bf16 v[68:71], a[212:215], v[186:189], v[68:71]
v_cvt_pk_bf16_f32 v116, v60, v61
v_cvt_pk_bf16_f32 v117, v62, v63
buffer_store_dwordx2 v[116:117], v205, s[8:11], s39 offen
v_cvt_pk_bf16_f32 v124, v64, v65
v_cvt_pk_bf16_f32 v125, v66, v67
buffer_store_dwordx2 v[124:125], v205, s[8:11], s39 offen offset:32
s_nop 0
v_cvt_pk_bf16_f32 v132, v68, v69
v_cvt_pk_bf16_f32 v133, v70, v71
buffer_store_dwordx2 v[132:133], v205, s[8:11], s39 offen offset:64
s_mov_b32 s38, s36
ds_read_b128 v[174:177], v217
ds_read_b128 v[84:87], v200
s_waitcnt lgkmcnt(0)
v_mfma_f32_16x16x32_bf16 v[36:39], v[174:177], v[84:87], 0
ds_read_b128 v[92:95], v201
s_waitcnt lgkmcnt(0)
v_mfma_f32_16x16x32_bf16 v[48:51], v[174:177], v[92:95], 0
ds_read_b128 v[100:103], v202
s_waitcnt lgkmcnt(0)
v_mfma_f32_16x16x32_bf16 v[60:63], v[174:177], v[100:103], 0
ds_read_b128 v[178:181], v217 offset:528
ds_read_b128 v[84:87], v194
ds_read_b128 v[88:91], v194 offset:16
s_waitcnt lgkmcnt(0)
v_smfmac_f32_16x16x64_bf16 v[36:39], v[178:181], v[84:91], v213
ds_read_b128 v[92:95], v195
ds_read_b128 v[96:99], v195 offset:16
s_waitcnt lgkmcnt(0)
v_smfmac_f32_16x16x64_bf16 v[48:51], v[178:181], v[92:99], v213
ds_read_b128 v[100:103], v196
ds_read_b128 v[104:107], v196 offset:16
s_waitcnt lgkmcnt(0)
v_smfmac_f32_16x16x64_bf16 v[60:63], v[178:181], v[100:107], v213
ds_read_b128 v[174:177], v217 offset:1056
ds_read_b128 v[84:87], v197
ds_read_b128 v[88:91], v197 offset:16
s_waitcnt lgkmcnt(0)
v_smfmac_f32_16x16x64_bf16 v[36:39], v[174:177], v[84:91], v213
ds_read_b128 v[92:95], v198
ds_read_b128 v[96:99], v198 offset:16
s_waitcnt lgkmcnt(0)
v_smfmac_f32_16x16x64_bf16 v[48:51], v[174:177], v[92:99], v213
ds_read_b128 v[100:103], v199
ds_read_b128 v[104:107], v199 offset:16
s_waitcnt lgkmcnt(0)
v_smfmac_f32_16x16x64_bf16 v[60:63], v[174:177], v[100:107], v213
ds_read_b128 v[178:181], v217 offset:1584
ds_read_b128 v[84:87], v200 offset:32
s_waitcnt lgkmcnt(0)
v_mfma_f32_16x16x32_bf16 v[40:43], v[178:181], v[84:87], 0
ds_read_b128 v[92:95], v201 offset:32
s_waitcnt lgkmcnt(0)
v_mfma_f32_16x16x32_bf16 v[52:55], v[178:181], v[92:95], 0
ds_read_b128 v[100:103], v202 offset:32
s_waitcnt lgkmcnt(0)
v_mfma_f32_16x16x32_bf16 v[64:67], v[178:181], v[100:103], 0
ds_read_b128 v[174:177], v217 offset:2112
ds_read_b128 v[84:87], v194 offset:32
ds_read_b128 v[88:91], v194 offset:48
s_waitcnt lgkmcnt(0)
v_smfmac_f32_16x16x64_bf16 v[40:43], v[174:177], v[84:91], v213
ds_read_b128 v[92:95], v195 offset:32
ds_read_b128 v[96:99], v195 offset:48
s_waitcnt lgkmcnt(0)
v_smfmac_f32_16x16x64_bf16 v[52:55], v[174:177], v[92:99], v213
ds_read_b128 v[100:103], v196 offset:32
ds_read_b128 v[104:107], v196 offset:48
s_waitcnt lgkmcnt(0)
v_smfmac_f32_16x16x64_bf16 v[64:67], v[174:177], v[100:107], v213
ds_read_b128 v[178:181], v217 offset:2640
ds_read_b128 v[84:87], v197 offset:32
ds_read_b128 v[88:91], v197 offset:48
s_waitcnt lgkmcnt(0)
v_smfmac_f32_16x16x64_bf16 v[40:43], v[178:181], v[84:91], v213
ds_read_b128 v[92:95], v198 offset:32
ds_read_b128 v[96:99], v198 offset:48
s_waitcnt lgkmcnt(0)
v_smfmac_f32_16x16x64_bf16 v[52:55], v[178:181], v[92:99], v213
ds_read_b128 v[100:103], v199 offset:32
ds_read_b128 v[104:107], v199 offset:48
s_waitcnt lgkmcnt(0)
v_smfmac_f32_16x16x64_bf16 v[64:67], v[178:181], v[100:107], v213
ds_read_b128 v[174:177], v217 offset:3168
ds_read_b128 v[84:87], v200 offset:64
s_waitcnt lgkmcnt(0)
v_mfma_f32_16x16x32_bf16 v[44:47], v[174:177], v[84:87], 0
ds_read_b128 v[92:95], v201 offset:64
s_waitcnt lgkmcnt(0)
v_mfma_f32_16x16x32_bf16 v[56:59], v[174:177], v[92:95], 0
ds_read_b128 v[100:103], v202 offset:64
s_waitcnt lgkmcnt(0)
v_mfma_f32_16x16x32_bf16 v[68:71], v[174:177], v[100:103], 0
ds_read_b128 v[178:181], v217 offset:3696
ds_read_b128 v[84:87], v194 offset:64
ds_read_b128 v[88:91], v194 offset:80
s_waitcnt lgkmcnt(0)
v_smfmac_f32_16x16x64_bf16 v[44:47], v[178:181], v[84:91], v213
ds_read_b128 v[92:95], v195 offset:64
ds_read_b128 v[96:99], v195 offset:80
s_waitcnt lgkmcnt(0)
v_smfmac_f32_16x16x64_bf16 v[56:59], v[178:181], v[92:99], v213
ds_read_b128 v[100:103], v196 offset:64
ds_read_b128 v[104:107], v196 offset:80
s_waitcnt lgkmcnt(0)
v_smfmac_f32_16x16x64_bf16 v[68:71], v[178:181], v[100:107], v213
ds_read_b128 v[174:177], v217 offset:4224
ds_read_b128 v[84:87], v197 offset:64
ds_read_b128 v[88:91], v197 offset:80
s_waitcnt lgkmcnt(0)
v_smfmac_f32_16x16x64_bf16 v[44:47], v[174:177], v[84:91], v213
ds_read_b128 v[92:95], v198 offset:64
ds_read_b128 v[96:99], v198 offset:80
s_waitcnt lgkmcnt(0)
v_smfmac_f32_16x16x64_bf16 v[56:59], v[174:177], v[92:99], v213
ds_read_b128 v[100:103], v199 offset:64
ds_read_b128 v[104:107], v199 offset:80
s_waitcnt lgkmcnt(0)
v_smfmac_f32_16x16x64_bf16 v[68:71], v[174:177], v[100:107], v213
v_add_f32 v118, v36, v37
v_mul_f32 v119, v36, v36
v_add_f32 v118, v118, v38
v_fmac_f32 v119, v37, v37
v_add_f32 v118, v118, v39
v_fmac_f32 v119, v38, v38
v_fmac_f32 v119, v39, v39
v_add_f32 v126, v48, v49
v_mul_f32 v127, v48, v48
v_add_f32 v126, v126, v50
v_fmac_f32 v127, v49, v49
v_add_f32 v126, v126, v51
v_fmac_f32 v127, v50, v50
v_fmac_f32 v127, v51, v51
v_add_f32 v134, v60, v61
v_mul_f32 v135, v60, v60
v_add_f32 v134, v134, v62
v_fmac_f32 v135, v61, v61
v_add_f32 v134, v134, v63
v_fmac_f32 v135, v62, v62
v_fmac_f32 v135, v63, v63
v_add_f32 v118, v118, v40
v_fmac_f32 v119, v40, v40
v_add_f32 v118, v118, v41
v_fmac_f32 v119, v41, v41
v_add_f32 v118, v118, v42
v_fmac_f32 v119, v42, v42
v_add_f32 v118, v118, v43
v_fmac_f32 v119, v43, v43
v_add_f32 v126, v126, v52
v_fmac_f32 v127, v52, v52
v_add_f32 v126, v126, v53
v_fmac_f32 v127, v53, v53
v_add_f32 v126, v126, v54
v_fmac_f32 v127, v54, v54
v_add_f32 v126, v126, v55
v_fmac_f32 v127, v55, v55
v_add_f32 v134, v134, v64
v_fmac_f32 v135, v64, v64
v_add_f32 v134, v134, v65
v_fmac_f32 v135, v65, v65
v_add_f32 v134, v134, v66
v_fmac_f32 v135, v66, v66
v_add_f32 v134, v134, v67
v_fmac_f32 v135, v67, v67
v_add_f32 v118, v118, v44
v_fmac_f32 v119, v44, v44
v_add_f32 v118, v118, v45
v_fmac_f32 v119, v45, v45
v_add_f32 v118, v118, v46
v_fmac_f32 v119, v46, v46
v_add_f32 v118, v118, v47
v_fmac_f32 v119, v47, v47
v_add_f32 v126, v126, v56
v_fmac_f32 v127, v56, v56
v_add_f32 v126, v126, v57
v_fmac_f32 v127, v57, v57
v_add_f32 v126, v126, v58
v_fmac_f32 v127, v58, v58
v_add_f32 v126, v126, v59
v_fmac_f32 v127, v59, v59
v_add_f32 v134, v134, v68
v_fmac_f32 v135, v68, v68
v_add_f32 v134, v134, v69
v_fmac_f32 v135, v69, v69
v_add_f32 v134, v134, v70
v_fmac_f32 v135, v70, v70
v_add_f32 v134, v134, v71
v_fmac_f32 v135, v71, v71
v_permlane16_swap_b32 v118, v119
v_add_f32 v118, v118, v119
v_permlane16_swap_b32 v126, v127
v_add_f32 v126, v126, v127
v_permlane16_swap_b32 v134, v135
v_add_f32 v134, v134, v135
v_permlane32_swap_b32 v118, v126
v_add_f32 v118, v118, v126
ds_write_b32 v209, v118
v_mov_b32 v135, v134
s_nop 1
v_permlane32_swap_b32 v134, v135
v_add_f32 v134, v134, v135
ds_write_b32 v209, v134 offset:512
s_waitcnt lgkmcnt(0)
s_barrier
s_mov_b32 s35, s97
s_mul_hi_u32 s41, s35, 58835169
s_mul_i32 s42, s41, 73
s_sub_u32 s42, s35, s42
s_mul_i32 s43, s41, 1373568
s_mul_i32 s51, s42, 2688
s_add_u32 s43, s43, s51
s_cmp_lt_u32 s35, s34
s_cselect_b32 s50, s43, 1879048192
s_add_u32 s35, s35, 32
s_cmp_eq_u32 s42, 0
s_cselect_b32 s44, 536870911, s72
s_cmp_eq_u32 s42, 72
s_cselect_b32 s44, 939524095, s44
s_cmp_eq_u32 s41, 0
s_cselect_b32 s52, 1879048192, s50
s_mov_b32 s36, s50
v_and_b32 v180, s44, v208
s_add_u32 m0, s45, 0
s_nop 0
buffer_load_dwordx4 v180, s[4:7], s52 offen nt lds
s_add_u32 m0, s45, 4112
s_add_u32 s40, s36, 196224
buffer_load_dwordx4 v180, s[4:7], s40 offen nt lds
s_add_u32 m0, s45, 8224
s_add_u32 s40, s36, 392448
buffer_load_dwordx4 v180, s[4:7], s40 offen nt lds
s_add_u32 m0, s45, 12336
s_add_u32 s40, s36, 588672
buffer_load_dwordx4 v180, s[4:7], s40 offen nt lds
s_add_u32 m0, s45, 16448
s_add_u32 s40, s36, 784896
buffer_load_dwordx4 v180, s[4:7], s40 offen nt lds
s_add_u32 m0, s45, 20560
s_add_u32 s40, s36, 981120
buffer_load_dwordx4 v180, s[4:7], s40 offen nt lds
s_add_u32 m0, s45, 24672
s_add_u32 s40, s36, 1177344
buffer_load_dwordx4 v180, s[4:7], s40 offen nt lds
s_add_u32 m0, s45, 28784
s_add_u32 s40, s36, 1373568
buffer_load_dwordx4 v180, s[4:7], s40 offen nt lds
s_add_u32 m0, s45, 32896
s_add_u32 s40, s36, 1569792
buffer_load_dwordx4 v180, s[4:7], s40 offen nt lds
ds_read_b128 v[102:105], v210 offset:18432
ds_read_b128 v[106:109], v210 offset:19456
s_waitcnt lgkmcnt(1)
v_add_f32 v102, v102, v103
s_waitcnt lgkmcnt(0)
v_add_f32 v106, v106, v107
v_add_f32 v104, v104, v105
v_add_f32 v108, v108, v109
v_add_f32 v102, v102, v104
v_add_f32 v106, v106, v108
v_mul_f32 v103, s48, v102
v_mul_f32 v104, s73, v102
v_mul_f32 v106, s73, v106
v_fma_f32 v106, -v103, v104, v106
v_max_f32 v106, 0, v106
v_add_f32 v106, s49, v106
v_rsq_f32 v102, v106
s_nop 0
v_mul_f32_e64 v103, -v103, v102
ds_write_b64 v211, v[102:103] offset:20480
ds_read_b64 v[118:119], v219 offset:20480
ds_read_b64 v[126:127], v219 offset:20736
ds_read_b64 v[134:135], v219 offset:20992
s_waitcnt lgkmcnt(2)
v_fma_f32 v220, v36, v118, v119
v_fma_f32 v221, v37, v118, v119
v_cvt_pk_bf16_f32 v90, v220, v221
v_fma_f32 v222, v38, v118, v119
v_fma_f32 v223, v39, v118, v119
v_cvt_pk_bf16_f32 v91, v222, v223
v_fma_f32 v220, v40, v118, v119
v_fma_f32 v221, v41, v118, v119
v_cvt_pk_bf16_f32 v92, v220, v221
v_fma_f32 v222, v42, v118, v119
v_fma_f32 v223, v43, v118, v119
v_cvt_pk_bf16_f32 v93, v222, v223
ds_write_b128 v211, v[90:93] offset:20480
v_fma_f32 v220, v44, v118, v119
v_fma_f32 v221, v45, v118, v119
v_cvt_pk_bf16_f32 v94, v220, v221
v_fma_f32 v222, v46, v118, v119
v_fma_f32 v223, v47, v118, v119
v_cvt_pk_bf16_f32 v95, v222, v223
s_waitcnt lgkmcnt(2)
ds_write_b64 v212, v[94:95] offset:20480
v_fma_f32 v220, v48, v126, v127
v_fma_f32 v221, v49, v126, v127
v_cvt_pk_bf16_f32 v174, v220, v221
v_fma_f32 v222, v50, v126, v127
v_fma_f32 v223, v51, v126, v127
v_cvt_pk_bf16_f32 v175, v222, v223
v_fma_f32 v220, v52, v126, v127
v_fma_f32 v221, v53, v126, v127
v_cvt_pk_bf16_f32 v176, v220, v221
v_fma_f32 v222, v54, v126, v127
v_fma_f32 v223, v55, v126, v127
v_cvt_pk_bf16_f32 v177, v222, v223
ds_write_b128 v211, v[174:177] offset:26624
v_fma_f32 v220, v56, v126, v127
v_fma_f32 v221, v57, v126, v127
v_cvt_pk_bf16_f32 v178, v220, v221
v_fma_f32 v222, v58, v126, v127
v_fma_f32 v223, v59, v126, v127
v_cvt_pk_bf16_f32 v179, v222, v223
s_waitcnt lgkmcnt(3)
ds_write_b64 v212, v[178:179] offset:26624
v_fma_f32 v220, v60, v134, v135
v_fma_f32 v221, v61, v134, v135
v_cvt_pk_bf16_f32 v90, v220, v221
v_fma_f32 v222, v62, v134, v135
v_fma_f32 v223, v63, v134, v135
v_cvt_pk_bf16_f32 v91, v222, v223
v_fma_f32 v220, v64, v134, v135
v_fma_f32 v221, v65, v134, v135
v_cvt_pk_bf16_f32 v92, v220, v221
v_fma_f32 v222, v66, v134, v135
v_fma_f32 v223, v67, v134, v135
v_cvt_pk_bf16_f32 v93, v222, v223
ds_write_b128 v211, v[90:93] offset:32768
v_fma_f32 v220, v68, v134, v135
v_fma_f32 v221, v69, v134, v135
v_cvt_pk_bf16_f32 v94, v220, v221
v_fma_f32 v222, v70, v134, v135
v_fma_f32 v223, v71, v134, v135
v_cvt_pk_bf16_f32 v95, v222, v223
ds_write_b64 v212, v[94:95] offset:32768
ds_read_b128 v[182:185], v210
s_waitcnt lgkmcnt(0)
v_mfma_f32_16x16x32_bf16 v[138:141], a[0:3], v[182:185], 0
v_mfma_f32_16x16x32_bf16 v[142:145], a[24:27], v[182:185], 0
v_mfma_f32_16x16x32_bf16 v[146:149], a[48:51], v[182:185], 0
v_mfma_f32_16x16x32_bf16 v[150:153], a[216:219], v[182:185], 0
v_mfma_f32_16x16x32_bf16 v[154:157], a[240:243], v[182:185], 0
v_mfma_f32_16x16x32_bf16 v[158:161], v[232:235], v[182:185], 0
v_mfma_f32_16x16x32_bf16 v[162:165], v[182:185], a[72:75], 0
v_mfma_f32_16x16x32_bf16 v[166:169], v[182:185], a[96:99], 0
v_mfma_f32_16x16x32_bf16 v[170:173], v[182:185], a[120:123], 0
ds_read_b128 v[186:189], v210 offset:1024
s_waitcnt lgkmcnt(0)
v_mfma_f32_16x16x32_bf16 v[138:141], a[4:7], v[186:189], v[138:141]
v_mfma_f32_16x16x32_bf16 v[142:145], a[28:31], v[186:189], v[142:145]
v_mfma_f32_16x16x32_bf16 v[146:149], a[52:55], v[186:189], v[146:149]
v_mfma_f32_16x16x32_bf16 v[150:153], a[220:223], v[186:189], v[150:153]
v_mfma_f32_16x16x32_bf16 v[154:157], a[244:247], v[186:189], v[154:157]
v_mfma_f32_16x16x32_bf16 v[158:161], v[236:239], v[186:189], v[158:161]
v_mfma_f32_16x16x32_bf16 v[162:165], v[186:189], a[76:79], v[162:165]
v_mfma_f32_16x16x32_bf16 v[166:169], v[186:189], a[100:103], v[166:169]
v_mfma_f32_16x16x32_bf16 v[170:173], v[186:189], a[124:127], v[170:173]
ds_read_b128 v[182:185], v210 offset:2048
s_waitcnt lgkmcnt(0)
v_mfma_f32_16x16x32_bf16 v[138:141], a[8:11], v[182:185], v[138:141]
v_mfma_f32_16x16x32_bf16 v[142:145], a[32:35], v[182:185], v[142:145]
v_mfma_f32_16x16x32_bf16 v[146:149], a[56:59], v[182:185], v[146:149]
v_mfma_f32_16x16x32_bf16 v[150:153], a[224:227], v[182:185], v[150:153]
v_mfma_f32_16x16x32_bf16 v[154:157], a[248:251], v[182:185], v[154:157]
v_mfma_f32_16x16x32_bf16 v[158:161], v[240:243], v[182:185], v[158:161]
v_mfma_f32_16x16x32_bf16 v[162:165], v[182:185], a[80:83], v[162:165]
v_mfma_f32_16x16x32_bf16 v[166:169], v[182:185], a[104:107], v[166:169]
v_mfma_f32_16x16x32_bf16 v[170:173], v[182:185], a[128:131], v[170:173]
ds_read_b128 v[186:189], v210 offset:3072
s_waitcnt lgkmcnt(0)
v_mfma_f32_16x16x32_bf16 v[138:141], a[12:15], v[186:189], v[138:141]
v_mfma_f32_16x16x32_bf16 v[142:145], a[36:39], v[186:189], v[142:145]
v_mfma_f32_16x16x32_bf16 v[146:149], a[60:63], v[186:189], v[146:149]
v_mfma_f32_16x16x32_bf16 v[150:153], a[228:231], v[186:189], v[150:153]
v_mfma_f32_16x16x32_bf16 v[154:157], a[252:255], v[186:189], v[154:157]
v_mfma_f32_16x16x32_bf16 v[158:161], v[244:247], v[186:189], v[158:161]
v_mfma_f32_16x16x32_bf16 v[162:165], v[186:189], a[84:87], v[162:165]
v_mfma_f32_16x16x32_bf16 v[166:169], v[186:189], a[108:111], v[166:169]
v_mfma_f32_16x16x32_bf16 v[170:173], v[186:189], a[132:135], v[170:173]
ds_read_b128 v[182:185], v210 offset:4096
s_waitcnt lgkmcnt(0)
v_mfma_f32_16x16x32_bf16 v[138:141], a[16:19], v[182:185], v[138:141]
v_mfma_f32_16x16x32_bf16 v[142:145], a[40:43], v[182:185], v[142:145]
v_mfma_f32_16x16x32_bf16 v[146:149], a[64:67], v[182:185], v[146:149]
v_mfma_f32_16x16x32_bf16 v[150:153], a[232:235], v[182:185], v[150:153]
v_mfma_f32_16x16x32_bf16 v[154:157], v[224:227], v[182:185], v[154:157]
v_mfma_f32_16x16x32_bf16 v[158:161], v[248:251], v[182:185], v[158:161]
v_mfma_f32_16x16x32_bf16 v[162:165], v[182:185], a[88:91], v[162:165]
v_mfma_f32_16x16x32_bf16 v[166:169], v[182:185], a[112:115], v[166:169]
v_mfma_f32_16x16x32_bf16 v[170:173], v[182:185], a[136:139], v[170:173]
ds_read_b128 v[186:189], v210 offset:5120
s_waitcnt lgkmcnt(0)
v_mfma_f32_16x16x32_bf16 v[138:141], a[20:23], v[186:189], v[138:141]
v_mfma_f32_16x16x32_bf16 v[142:145], a[44:47], v[186:189], v[142:145]
v_mfma_f32_16x16x32_bf16 v[146:149], a[68:71], v[186:189], v[146:149]
v_mfma_f32_16x16x32_bf16 v[150:153], a[236:239], v[186:189], v[150:153]
v_mfma_f32_16x16x32_bf16 v[154:157], v[228:231], v[186:189], v[154:157]
v_mfma_f32_16x16x32_bf16 v[158:161], v[252:255], v[186:189], v[158:161]
v_mfma_f32_16x16x32_bf16 v[162:165], v[186:189], a[92:95], v[162:165]
v_mfma_f32_16x16x32_bf16 v[166:169], v[186:189], a[116:119], v[166:169]
v_mfma_f32_16x16x32_bf16 v[170:173], v[186:189], a[140:143], v[170:173]
v_cvt_pk_bf16_f32 v78, v138, v139
v_cvt_pk_bf16_f32 v79, v140, v141
v_cvt_pk_bf16_f32 v80, v142, v143
v_cvt_pk_bf16_f32 v81, v144, v145
v_cvt_pk_bf16_f32 v82, v146, v147
v_cvt_pk_bf16_f32 v83, v148, v149
v_cvt_pk_bf16_f32 v72, v150, v151
v_cvt_pk_bf16_f32 v73, v152, v153
v_cvt_pk_bf16_f32 v74, v154, v155
v_cvt_pk_bf16_f32 v75, v156, v157
v_cvt_pk_bf16_f32 v76, v158, v159
v_cvt_pk_bf16_f32 v77, v160, v161
v_cvt_pk_bf16_f32 v114, v162, v163
v_cvt_pk_bf16_f32 v115, v164, v165
v_cvt_pk_bf16_f32 v122, v166, v167
v_cvt_pk_bf16_f32 v123, v168, v169
v_cvt_pk_bf16_f32 v130, v170, v171
v_cvt_pk_bf16_f32 v131, v172, v173
ds_read_b128 v[182:185], v210 offset:6144
s_waitcnt lgkmcnt(0)
v_mfma_f32_16x16x32_bf16 v[138:141], a[0:3], v[182:185], 0
v_mfma_f32_16x16x32_bf16 v[142:145], a[24:27], v[182:185], 0
v_mfma_f32_16x16x32_bf16 v[146:149], a[48:51], v[182:185], 0
v_mfma_f32_16x16x32_bf16 v[150:153], a[216:219], v[182:185], 0
v_mfma_f32_16x16x32_bf16 v[154:157], a[240:243], v[182:185], 0
v_mfma_f32_16x16x32_bf16 v[158:161], v[232:235], v[182:185], 0
v_mfma_f32_16x16x32_bf16 v[162:165], v[182:185], a[72:75], 0
v_mfma_f32_16x16x32_bf16 v[166:169], v[182:185], a[96:99], 0
v_mfma_f32_16x16x32_bf16 v[170:173], v[182:185], a[120:123], 0
ds_read_b128 v[186:189], v210 offset:7168
s_waitcnt lgkmcnt(0)
v_mfma_f32_16x16x32_bf16 v[138:141], a[4:7], v[186:189], v[138:141]
v_mfma_f32_16x16x32_bf16 v[142:145], a[28:31], v[186:189], v[142:145]
v_mfma_f32_16x16x32_bf16 v[146:149], a[52:55], v[186:189], v[146:149]
v_mfma_f32_16x16x32_bf16 v[150:153], a[220:223], v[186:189], v[150:153]
v_mfma_f32_16x16x32_bf16 v[154:157], a[244:247], v[186:189], v[154:157]
v_mfma_f32_16x16x32_bf16 v[158:161], v[236:239], v[186:189], v[158:161]
v_mfma_f32_16x16x32_bf16 v[162:165], v[186:189], a[76:79], v[162:165]
v_mfma_f32_16x16x32_bf16 v[166:169], v[186:189], a[100:103], v[166:169]
v_mfma_f32_16x16x32_bf16 v[170:173], v[186:189], a[124:127], v[170:173]
ds_read_b128 v[182:185], v210 offset:8192
s_waitcnt lgkmcnt(0)
v_mfma_f32_16x16x32_bf16 v[138:141], a[8:11], v[182:185], v[138:141]
v_mfma_f32_16x16x32_bf16 v[142:145], a[32:35], v[182:185], v[142:145]
v_mfma_f32_16x16x32_bf16 v[146:149], a[56:59], v[182:185], v[146:149]
v_mfma_f32_16x16x32_bf16 v[150:153], a[224:227], v[182:185], v[150:153]
v_mfma_f32_16x16x32_bf16 v[154:157], a[248:251], v[182:185], v[154:157]
v_mfma_f32_16x16x32_bf16 v[158:161], v[240:243], v[182:185], v[158:161]
v_mfma_f32_16x16x32_bf16 v[162:165], v[182:185], a[80:83], v[162:165]
v_mfma_f32_16x16x32_bf16 v[166:169], v[182:185], a[104:107], v[166:169]
v_mfma_f32_16x16x32_bf16 v[170:173], v[182:185], a[128:131], v[170:173]
ds_read_b128 v[186:189], v210 offset:9216
s_waitcnt lgkmcnt(0)
v_mfma_f32_16x16x32_bf16 v[138:141], a[12:15], v[186:189], v[138:141]
v_mfma_f32_16x16x32_bf16 v[142:145], a[36:39], v[186:189], v[142:145]
v_mfma_f32_16x16x32_bf16 v[146:149], a[60:63], v[186:189], v[146:149]
v_mfma_f32_16x16x32_bf16 v[150:153], a[228:231], v[186:189], v[150:153]
v_mfma_f32_16x16x32_bf16 v[154:157], a[252:255], v[186:189], v[154:157]
v_mfma_f32_16x16x32_bf16 v[158:161], v[244:247], v[186:189], v[158:161]
v_mfma_f32_16x16x32_bf16 v[162:165], v[186:189], a[84:87], v[162:165]
v_mfma_f32_16x16x32_bf16 v[166:169], v[186:189], a[108:111], v[166:169]
v_mfma_f32_16x16x32_bf16 v[170:173], v[186:189], a[132:135], v[170:173]
ds_read_b128 v[182:185], v210 offset:10240
s_waitcnt lgkmcnt(0)
v_mfma_f32_16x16x32_bf16 v[138:141], a[16:19], v[182:185], v[138:141]
v_mfma_f32_16x16x32_bf16 v[142:145], a[40:43], v[182:185], v[142:145]
v_mfma_f32_16x16x32_bf16 v[146:149], a[64:67], v[182:185], v[146:149]
v_mfma_f32_16x16x32_bf16 v[150:153], a[232:235], v[182:185], v[150:153]
v_mfma_f32_16x16x32_bf16 v[154:157], v[224:227], v[182:185], v[154:157]
v_mfma_f32_16x16x32_bf16 v[158:161], v[248:251], v[182:185], v[158:161]
v_mfma_f32_16x16x32_bf16 v[162:165], v[182:185], a[88:91], v[162:165]
v_mfma_f32_16x16x32_bf16 v[166:169], v[182:185], a[112:115], v[166:169]
v_mfma_f32_16x16x32_bf16 v[170:173], v[182:185], a[136:139], v[170:173]
ds_read_b128 v[186:189], v210 offset:11264
s_waitcnt lgkmcnt(0)
v_mfma_f32_16x16x32_bf16 v[138:141], a[20:23], v[186:189], v[138:141]
v_mfma_f32_16x16x32_bf16 v[142:145], a[44:47], v[186:189], v[142:145]
v_mfma_f32_16x16x32_bf16 v[146:149], a[68:71], v[186:189], v[146:149]
v_mfma_f32_16x16x32_bf16 v[150:153], a[236:239], v[186:189], v[150:153]
v_mfma_f32_16x16x32_bf16 v[154:157], v[228:231], v[186:189], v[154:157]
v_mfma_f32_16x16x32_bf16 v[158:161], v[252:255], v[186:189], v[158:161]
v_mfma_f32_16x16x32_bf16 v[162:165], v[186:189], a[92:95], v[162:165]
v_mfma_f32_16x16x32_bf16 v[166:169], v[186:189], a[116:119], v[166:169]
v_mfma_f32_16x16x32_bf16 v[170:173], v[186:189], a[140:143], v[170:173]
v_cvt_pk_bf16_f32 v96, v138, v139
v_cvt_pk_bf16_f32 v97, v140, v141
v_cvt_pk_bf16_f32 v98, v142, v143
v_cvt_pk_bf16_f32 v99, v144, v145
v_cvt_pk_bf16_f32 v100, v146, v147
v_cvt_pk_bf16_f32 v101, v148, v149
v_cvt_pk_bf16_f32 v84, v150, v151
v_cvt_pk_bf16_f32 v85, v152, v153
v_cvt_pk_bf16_f32 v86, v154, v155
v_cvt_pk_bf16_f32 v87, v156, v157
v_cvt_pk_bf16_f32 v88, v158, v159
v_cvt_pk_bf16_f32 v89, v160, v161
v_cvt_pk_bf16_f32 v116, v162, v163
v_cvt_pk_bf16_f32 v117, v164, v165
v_cvt_pk_bf16_f32 v124, v166, v167
v_cvt_pk_bf16_f32 v125, v168, v169
v_cvt_pk_bf16_f32 v132, v170, v171
v_cvt_pk_bf16_f32 v133, v172, v173
ds_read_b128 v[182:185], v210 offset:12288
s_waitcnt lgkmcnt(0)
v_mfma_f32_16x16x32_bf16 v[138:141], a[0:3], v[182:185], 0
v_mfma_f32_16x16x32_bf16 v[142:145], a[24:27], v[182:185], 0
v_mfma_f32_16x16x32_bf16 v[146:149], a[48:51], v[182:185], 0
ds_read_b128 v[186:189], v210 offset:13312
s_waitcnt lgkmcnt(0)
v_mfma_f32_16x16x32_bf16 v[138:141], a[4:7], v[186:189], v[138:141]
v_mfma_f32_16x16x32_bf16 v[142:145], a[28:31], v[186:189], v[142:145]
v_mfma_f32_16x16x32_bf16 v[146:149], a[52:55], v[186:189], v[146:149]
ds_read_b128 v[182:185], v210 offset:14336
s_waitcnt lgkmcnt(0)
v_mfma_f32_16x16x32_bf16 v[138:141], a[8:11], v[182:185], v[138:141]
v_mfma_f32_16x16x32_bf16 v[142:145], a[32:35], v[182:185], v[142:145]
v_mfma_f32_16x16x32_bf16 v[146:149], a[56:59], v[182:185], v[146:149]
ds_read_b128 v[186:189], v210 offset:15360
s_waitcnt lgkmcnt(0)
v_mfma_f32_16x16x32_bf16 v[138:141], a[12:15], v[186:189], v[138:141]
v_mfma_f32_16x16x32_bf16 v[142:145], a[36:39], v[186:189], v[142:145]
v_mfma_f32_16x16x32_bf16 v[146:149], a[60:63], v[186:189], v[146:149]
ds_read_b128 v[182:185], v210 offset:16384
s_waitcnt lgkmcnt(0)
v_mfma_f32_16x16x32_bf16 v[138:141], a[16:19], v[182:185], v[138:141]
v_mfma_f32_16x16x32_bf16 v[142:145], a[40:43], v[182:185], v[142:145]
v_mfma_f32_16x16x32_bf16 v[146:149], a[64:67], v[182:185], v[146:149]
ds_read_b128 v[186:189], v210 offset:17408
s_waitcnt lgkmcnt(0)
v_mfma_f32_16x16x32_bf16 v[138:141], a[20:23], v[186:189], v[138:141]
v_mfma_f32_16x16x32_bf16 v[142:145], a[44:47], v[186:189], v[142:145]
v_mfma_f32_16x16x32_bf16 v[146:149], a[68:71], v[186:189], v[146:149]
v_cvt_pk_bf16_f32 v102, v138, v139
v_cvt_pk_bf16_f32 v103, v140, v141
s_nop 0
v_cvt_pk_bf16_f32 v104, v142, v143
v_cvt_pk_bf16_f32 v105, v144, v145
s_nop 1
v_cvt_pk_bf16_f32 v106, v146, v147
v_cvt_pk_bf16_f32 v107, v148, v149
ds_read_b128 v[108:111], v215 offset:512
ds_read_b64 v[112:113], v215 offset:528
v_mov_b32 v181, 0
v_mfma_f32_16x16x16_bf16 v[138:141], v[82:83], v[76:77], 0
v_mfma_f32_16x16x16_bf16 v[142:145], v[100:101], v[76:77], 0
s_waitcnt lgkmcnt(0)
v_mfma_f32_16x16x16_bf16 v[150:153], v[112:113], v[76:77], v[206:209]
v_mfma_f32_16x16x16_bf16 v[146:149], v[106:107], v[76:77], 0
v_mfma_f32_16x16x32_bf16 v[138:141], v[78:81], v[72:75], v[138:141]
v_mfma_f32_16x16x32_bf16 v[142:145], v[96:99], v[72:75], v[142:145]
v_mfma_f32_16x16x32_bf16 v[150:153], v[108:111], v[72:75], v[150:153]
v_mfma_f32_16x16x32_bf16 v[146:149], v[102:105], v[72:75], v[146:149]
ds_read_b128 v[72:75], v215
ds_read_b64 v[76:77], v215 offset:16
v_mfma_f32_16x16x16_bf16 v[154:157], v[82:83], v[88:89], 0
v_mfma_f32_16x16x16_bf16 v[158:161], v[100:101], v[88:89], 0
v_mfma_f32_16x16x16_bf16 v[166:169], v[112:113], v[88:89], v[206:209]
v_mfma_f32_16x16x16_bf16 v[162:165], v[106:107], v[88:89], 0
v_mfma_f32_16x16x32_bf16 v[154:157], v[78:81], v[84:87], v[154:157]
v_mfma_f32_16x16x32_bf16 v[158:161], v[96:99], v[84:87], v[158:161]
v_mfma_f32_16x16x32_bf16 v[166:169], v[108:111], v[84:87], v[166:169]
v_mfma_f32_16x16x32_bf16 v[162:165], v[102:105], v[84:87], v[162:165]
ds_read_b128 v[182:185], v210 offset:12288
s_waitcnt lgkmcnt(0)
v_mfma_f32_16x16x32_bf16 v[118:121], v[182:185], a[72:75], 0
v_mfma_f32_16x16x32_bf16 v[126:129], v[182:185], a[96:99], 0
v_mfma_f32_16x16x32_bf16 v[134:137], v[182:185], a[120:123], 0
v_mfma_f32_16x16x32_bf16 v[90:93], a[216:219], v[182:185], 0
v_mfma_f32_16x16x32_bf16 v[170:173], a[240:243], v[182:185], 0
v_mfma_f32_16x16x32_bf16 v[220:223], v[232:235], v[182:185], 0
ds_read_b128 v[186:189], v210 offset:13312
s_waitcnt lgkmcnt(0)
v_mfma_f32_16x16x32_bf16 v[118:121], v[186:189], a[76:79], v[118:121]
v_mfma_f32_16x16x32_bf16 v[126:129], v[186:189], a[100:103], v[126:129]
v_mfma_f32_16x16x32_bf16 v[134:137], v[186:189], a[124:127], v[134:137]
v_mfma_f32_16x16x32_bf16 v[90:93], a[220:223], v[186:189], v[90:93]
v_mfma_f32_16x16x32_bf16 v[170:173], a[244:247], v[186:189], v[170:173]
v_mfma_f32_16x16x32_bf16 v[220:223], v[236:239], v[186:189], v[220:223]
ds_read_b128 v[182:185], v210 offset:14336
s_waitcnt lgkmcnt(0)
v_mfma_f32_16x16x32_bf16 v[118:121], v[182:185], a[80:83], v[118:121]
v_mfma_f32_16x16x32_bf16 v[126:129], v[182:185], a[104:107], v[126:129]
v_mfma_f32_16x16x32_bf16 v[134:137], v[182:185], a[128:131], v[134:137]
v_mfma_f32_16x16x32_bf16 v[90:93], a[224:227], v[182:185], v[90:93]
v_mfma_f32_16x16x32_bf16 v[170:173], a[248:251], v[182:185], v[170:173]
v_mfma_f32_16x16x32_bf16 v[220:223], v[240:243], v[182:185], v[220:223]
ds_read_b128 v[186:189], v210 offset:15360
s_waitcnt lgkmcnt(0)
v_mfma_f32_16x16x32_bf16 v[118:121], v[186:189], a[84:87], v[118:121]
v_mfma_f32_16x16x32_bf16 v[126:129], v[186:189], a[108:111], v[126:129]
v_mfma_f32_16x16x32_bf16 v[134:137], v[186:189], a[132:135], v[134:137]
v_mfma_f32_16x16x32_bf16 v[90:93], a[228:231], v[186:189], v[90:93]
v_mfma_f32_16x16x32_bf16 v[170:173], a[252:255], v[186:189], v[170:173]
v_mfma_f32_16x16x32_bf16 v[220:223], v[244:247], v[186:189], v[220:223]
ds_read_b128 v[182:185], v210 offset:16384
s_waitcnt lgkmcnt(0)
v_mfma_f32_16x16x32_bf16 v[118:121], v[182:185], a[88:91], v[118:121]
v_mfma_f32_16x16x32_bf16 v[126:129], v[182:185], a[112:115], v[126:129]
v_mfma_f32_16x16x32_bf16 v[134:137], v[182:185], a[136:139], v[134:137]
v_mfma_f32_16x16x32_bf16 v[90:93], a[232:235], v[182:185], v[90:93]
v_mfma_f32_16x16x32_bf16 v[170:173], v[224:227], v[182:185], v[170:173]
v_mfma_f32_16x16x32_bf16 v[220:223], v[248:251], v[182:185], v[220:223]
ds_read_b128 v[186:189], v210 offset:17408
s_waitcnt lgkmcnt(0)
v_mfma_f32_16x16x32_bf16 v[118:121], v[186:189], a[92:95], v[118:121]
v_mfma_f32_16x16x32_bf16 v[126:129], v[186:189], a[116:119], v[126:129]
v_mfma_f32_16x16x32_bf16 v[134:137], v[186:189], a[140:143], v[134:137]
v_mfma_f32_16x16x32_bf16 v[90:93], a[236:239], v[186:189], v[90:93]
v_mfma_f32_16x16x32_bf16 v[170:173], v[228:231], v[186:189], v[170:173]
v_mfma_f32_16x16x32_bf16 v[220:223], v[252:255], v[186:189], v[220:223]
v_cvt_pk_bf16_f32 v118, v118, v119
v_cvt_pk_bf16_f32 v119, v120, v121
ds_read_u16 v120, v214 offset:1024
v_mov_b32 v121, 0
v_cvt_pk_bf16_f32 v126, v126, v127
v_cvt_pk_bf16_f32 v127, v128, v129
ds_read_u16 v128, v214 offset:1032
v_mov_b32 v129, 0
v_cvt_pk_bf16_f32 v134, v134, v135
v_cvt_pk_bf16_f32 v135, v136, v137
ds_read_u16 v136, v214 offset:1040
v_mov_b32 v137, 0
v_cvt_pk_bf16_f32 v90, v90, v91
v_cvt_pk_bf16_f32 v91, v92, v93
v_cvt_pk_bf16_f32 v92, v170, v171
v_cvt_pk_bf16_f32 v93, v172, v173
v_cvt_pk_bf16_f32 v94, v220, v221
v_cvt_pk_bf16_f32 v95, v222, v223
v_max3_f32 v151, v138, v139, v140
v_max3_f32 v151, v151, v141, v142
v_max3_f32 v151, v151, v143, v144
v_max3_f32 v151, v151, v145, v146
v_max3_f32 v151, v151, v147, v148
v_max3_f32 v151, v151, v149, v150
v_mov_b32 v152, v151
s_nop 1
v_permlane16_swap_b32 v151, v152
v_max_f32 v151, v151, v152
v_mov_b32 v152, v151
s_nop 1
v_permlane32_swap_b32 v151, v152
v_max_f32 v151, v151, v152
v_sub_f32 v138, v138, v151
v_sub_f32 v139, v139, v151
v_sub_f32 v140, v140, v151
v_sub_f32 v141, v141, v151
v_sub_f32 v142, v142, v151
v_sub_f32 v143, v143, v151
v_sub_f32 v144, v144, v151
v_sub_f32 v145, v145, v151
v_sub_f32 v150, v150, v151
v_sub_f32 v146, v146, v151
v_sub_f32 v147, v147, v151
v_sub_f32 v148, v148, v151
v_sub_f32 v149, v149, v151
v_exp_f32 v138, v138
v_exp_f32 v139, v139
v_exp_f32 v140, v140
v_exp_f32 v141, v141
v_exp_f32 v142, v142
v_exp_f32 v143, v143
v_exp_f32 v144, v144
v_exp_f32 v145, v145
v_exp_f32 v150, v150
v_exp_f32 v146, v146
v_exp_f32 v147, v147
v_exp_f32 v148, v148
v_exp_f32 v149, v149
v_cvt_pk_bf16_f32 v174, v138, v139
v_cvt_pk_bf16_f32 v175, v140, v141
v_cvt_pk_bf16_f32 v176, v142, v143
v_cvt_pk_bf16_f32 v177, v144, v145
v_cvt_pk_bf16_f32 v178, v146, v147
v_cvt_pk_bf16_f32 v179, v148, v149
v_cvt_pk_bf16_f32 v180, v150, 0
v_mfma_f32_16x16x32_bf16 v[150:153], v[190:193], v[174:177], 0
v_mfma_f32_16x16x32_bf16 v[138:141], v[114:117], v[174:177], 0
v_mfma_f32_16x16x32_bf16 v[142:145], v[122:125], v[174:177], 0
v_mfma_f32_16x16x32_bf16 v[146:149], v[130:133], v[174:177], 0
v_mfma_f32_16x16x32_bf16 v[150:153], v[190:193], v[178:181], v[150:153]
s_waitcnt lgkmcnt(2)
v_mfma_f32_16x16x32_bf16 v[138:141], v[118:121], v[178:181], v[138:141]
s_waitcnt lgkmcnt(1)
v_mfma_f32_16x16x32_bf16 v[142:145], v[126:129], v[178:181], v[142:145]
s_waitcnt lgkmcnt(0)
v_mfma_f32_16x16x32_bf16 v[146:149], v[134:137], v[178:181], v[146:149]
v_max3_f32 v167, v154, v155, v156
v_max3_f32 v167, v167, v157, v158
v_max3_f32 v167, v167, v159, v160
v_max3_f32 v167, v167, v161, v162
v_max3_f32 v167, v167, v163, v164
v_max3_f32 v167, v167, v165, v166
v_mov_b32 v168, v167
s_nop 1
v_permlane16_swap_b32 v167, v168
v_max_f32 v167, v167, v168
v_mov_b32 v168, v167
s_nop 1
v_permlane32_swap_b32 v167, v168
v_max_f32 v167, v167, v168
v_sub_f32 v154, v154, v167
v_sub_f32 v155, v155, v167
v_sub_f32 v156, v156, v167
v_sub_f32 v157, v157, v167
v_sub_f32 v158, v158, v167
v_sub_f32 v159, v159, v167
v_sub_f32 v160, v160, v167
v_sub_f32 v161, v161, v167
v_sub_f32 v166, v166, v167
v_sub_f32 v162, v162, v167
v_sub_f32 v163, v163, v167
v_sub_f32 v164, v164, v167
v_sub_f32 v165, v165, v167
v_exp_f32 v154, v154
v_exp_f32 v155, v155
v_exp_f32 v156, v156
v_exp_f32 v157, v157
v_exp_f32 v158, v158
v_exp_f32 v159, v159
v_exp_f32 v160, v160
v_exp_f32 v161, v161
v_exp_f32 v166, v166
v_exp_f32 v162, v162
v_exp_f32 v163, v163
v_exp_f32 v164, v164
v_exp_f32 v165, v165
v_cvt_pk_bf16_f32 v174, v154, v155
v_cvt_pk_bf16_f32 v175, v156, v157
v_cvt_pk_bf16_f32 v176, v158, v159
v_cvt_pk_bf16_f32 v177, v160, v161
v_cvt_pk_bf16_f32 v178, v162, v163
v_cvt_pk_bf16_f32 v179, v164, v165
v_cvt_pk_bf16_f32 v180, v166, 0
v_mfma_f32_16x16x32_bf16 v[166:169], v[190:193], v[174:177], 0
v_mfma_f32_16x16x32_bf16 v[154:157], v[114:117], v[174:177], 0
v_mfma_f32_16x16x32_bf16 v[158:161], v[122:125], v[174:177], 0
v_mfma_f32_16x16x32_bf16 v[162:165], v[130:133], v[174:177], 0
v_mfma_f32_16x16x32_bf16 v[166:169], v[190:193], v[178:181], v[166:169]
v_mfma_f32_16x16x32_bf16 v[154:157], v[118:121], v[178:181], v[154:157]
v_mfma_f32_16x16x32_bf16 v[158:161], v[126:129], v[178:181], v[158:161]
v_mfma_f32_16x16x32_bf16 v[162:165], v[134:137], v[178:181], v[162:165]
v_rcp_f32 v151, v150
s_nop 0
v_mul_f32 v151, s3, v151
v_mul_f32 v138, v138, v151
v_mul_f32 v139, v139, v151
v_cvt_pk_bf16_f32 v138, v138, v139
v_mul_f32 v140, v140, v151
v_mul_f32 v141, v141, v151
v_cvt_pk_bf16_f32 v139, v140, v141
v_mul_f32 v142, v142, v151
v_mul_f32 v143, v143, v151
v_cvt_pk_bf16_f32 v140, v142, v143
v_mul_f32 v144, v144, v151
v_mul_f32 v145, v145, v151
v_cvt_pk_bf16_f32 v141, v144, v145
ds_write_b128 v211, v[138:141] offset:38912
v_mul_f32 v146, v146, v151
v_mul_f32 v147, v147, v151
v_cvt_pk_bf16_f32 v142, v146, v147
v_mul_f32 v148, v148, v151
v_mul_f32 v149, v149, v151
v_cvt_pk_bf16_f32 v143, v148, v149
ds_write_b64 v212, v[142:143] offset:38912
v_mfma_f32_16x16x32_bf16 v[138:141], v[78:81], v[90:93], 0
v_mfma_f32_16x16x32_bf16 v[142:145], v[96:99], v[90:93], 0
v_mfma_f32_16x16x32_bf16 v[150:153], v[108:111], v[90:93], v[206:209]
v_mfma_f32_16x16x32_bf16 v[146:149], v[102:105], v[90:93], 0
v_mfma_f32_16x16x16_bf16 v[138:141], v[82:83], v[94:95], v[138:141]
v_mfma_f32_16x16x16_bf16 v[142:145], v[100:101], v[94:95], v[142:145]
v_mfma_f32_16x16x16_bf16 v[150:153], v[112:113], v[94:95], v[150:153]
v_mfma_f32_16x16x16_bf16 v[146:149], v[106:107], v[94:95], v[146:149]
v_rcp_f32 v167, v166
s_nop 0
v_mul_f32 v167, s3, v167
v_mul_f32 v154, v154, v167
v_mul_f32 v155, v155, v167
v_cvt_pk_bf16_f32 v154, v154, v155
v_mul_f32 v156, v156, v167
v_mul_f32 v157, v157, v167
v_cvt_pk_bf16_f32 v155, v156, v157
v_mul_f32 v158, v158, v167
v_mul_f32 v159, v159, v167
v_cvt_pk_bf16_f32 v156, v158, v159
v_mul_f32 v160, v160, v167
v_mul_f32 v161, v161, v167
v_cvt_pk_bf16_f32 v157, v160, v161
ds_write_b128 v211, v[154:157] offset:45056
v_mul_f32 v162, v162, v167
v_mul_f32 v163, v163, v167
v_cvt_pk_bf16_f32 v158, v162, v163
v_mul_f32 v164, v164, v167
v_mul_f32 v165, v165, v167
v_cvt_pk_bf16_f32 v159, v164, v165
ds_write_b64 v212, v[158:159] offset:45056
v_mfma_f32_16x16x16_bf16 v[154:157], v[76:77], v[82:83], 0
v_mfma_f32_16x16x16_bf16 v[158:161], v[76:77], v[100:101], 0
v_mfma_f32_16x16x16_bf16 v[162:165], v[76:77], v[106:107], 0
v_mfma_f32_16x16x16_bf16 v[166:169], v[76:77], v[112:113], v[206:209]
v_mfma_f32_16x16x32_bf16 v[154:157], v[72:75], v[78:81], v[154:157]
v_mfma_f32_16x16x32_bf16 v[158:161], v[72:75], v[96:99], v[158:161]
v_mfma_f32_16x16x32_bf16 v[162:165], v[72:75], v[102:105], v[162:165]
v_mfma_f32_16x16x32_bf16 v[166:169], v[72:75], v[108:111], v[166:169]
v_mov_b32_dpp v154, v158 quad_perm:[0,1,2,3] row_mask:0x2 bank_mask:0xf
s_nop 1
v_mov_b32_dpp v154, v162 quad_perm:[0,1,2,3] row_mask:0x4 bank_mask:0xf
s_nop 2
v_mov_b32_dpp v154, v167 quad_perm:[0,1,2,3] row_mask:0x8 bank_mask:0xf
v_mov_b32 v155, v154
s_nop 1
v_max_f32_dpp v155, v155, v155 row_ror:8 row_mask:0xf bank_mask:0xf
s_nop 1
v_max_f32_dpp v155, v155, v155 row_ror:4 row_mask:0xf bank_mask:0xf
s_nop 1
v_max_f32_dpp v155, v155, v155 row_ror:2 row_mask:0xf bank_mask:0xf
s_nop 1
v_max_f32_dpp v155, v155, v155 row_ror:1 row_mask:0xf bank_mask:0xf
v_mov_b32 v156, v155
s_nop 1
v_permlane16_swap_b32 v155, v156
v_max_f32 v155, v155, v156
v_mov_b32 v156, v155
s_nop 1
v_permlane32_swap_b32 v155, v156
v_max_f32 v155, v155, v156
v_sub_f32 v154, v154, v155
v_exp_f32 v154, v154
s_nop 0
v_cvt_pk_bf16_f32 v154, v154, 0
ds_write_b16 v214, v154
s_waitcnt lgkmcnt(1)
ds_read_b128 v[84:87], v215
ds_read_b128 v[88:91], v215 offset:16
v_add_u32 v215, 1552, v215
s_barrier
ds_read_b128 v[170:173], v210 offset:38912
s_waitcnt lgkmcnt(0)
v_mfma_f32_16x16x32_bf16 v[0:3], a[144:147], v[170:173], v[0:3]
v_mfma_f32_16x16x32_bf16 v[4:7], a[168:171], v[170:173], v[4:7]
v_mfma_f32_16x16x32_bf16 v[8:11], a[192:195], v[170:173], v[8:11]
ds_read_b128 v[182:185], v210 offset:39936
s_waitcnt lgkmcnt(0)
v_mfma_f32_16x16x32_bf16 v[0:3], a[148:151], v[182:185], v[0:3]
v_mfma_f32_16x16x32_bf16 v[4:7], a[172:175], v[182:185], v[4:7]
v_mfma_f32_16x16x32_bf16 v[8:11], a[196:199], v[182:185], v[8:11]
ds_read_b128 v[186:189], v210 offset:40960
s_waitcnt lgkmcnt(0)
v_mfma_f32_16x16x32_bf16 v[0:3], a[152:155], v[186:189], v[0:3]
v_mfma_f32_16x16x32_bf16 v[4:7], a[176:179], v[186:189], v[4:7]
v_mfma_f32_16x16x32_bf16 v[8:11], a[200:203], v[186:189], v[8:11]
ds_read_b128 v[170:173], v210 offset:41984
s_waitcnt lgkmcnt(0)
v_mfma_f32_16x16x32_bf16 v[0:3], a[156:159], v[170:173], v[0:3]
v_mfma_f32_16x16x32_bf16 v[4:7], a[180:183], v[170:173], v[4:7]
v_mfma_f32_16x16x32_bf16 v[8:11], a[204:207], v[170:173], v[8:11]
ds_read_b128 v[182:185], v210 offset:43008
s_waitcnt lgkmcnt(0)
v_mfma_f32_16x16x32_bf16 v[0:3], a[160:163], v[182:185], v[0:3]
v_mfma_f32_16x16x32_bf16 v[4:7], a[184:187], v[182:185], v[4:7]
v_mfma_f32_16x16x32_bf16 v[8:11], a[208:211], v[182:185], v[8:11]
ds_read_b128 v[186:189], v210 offset:44032
s_waitcnt lgkmcnt(0)
v_mfma_f32_16x16x32_bf16 v[0:3], a[164:167], v[186:189], v[0:3]
v_mfma_f32_16x16x32_bf16 v[4:7], a[188:191], v[186:189], v[4:7]
v_mfma_f32_16x16x32_bf16 v[8:11], a[212:215], v[186:189], v[8:11]
v_cvt_pk_bf16_f32 v72, v0, v1
v_cvt_pk_bf16_f32 v73, v2, v3
buffer_store_dwordx2 v[72:73], v203, s[8:11], s38 offen
v_cvt_pk_bf16_f32 v74, v4, v5
v_cvt_pk_bf16_f32 v75, v6, v7
buffer_store_dwordx2 v[74:75], v203, s[8:11], s38 offen offset:32
s_nop 0
v_cvt_pk_bf16_f32 v76, v8, v9
v_cvt_pk_bf16_f32 v77, v10, v11
buffer_store_dwordx2 v[76:77], v203, s[8:11], s38 offen offset:64
v_max3_f32 v151, v138, v139, v140
v_max3_f32 v151, v151, v141, v142
v_max3_f32 v151, v151, v143, v144
v_max3_f32 v151, v151, v145, v146
v_max3_f32 v151, v151, v147, v148
v_max3_f32 v151, v151, v149, v150
v_mov_b32 v152, v151
s_nop 1
v_permlane16_swap_b32 v151, v152
v_max_f32 v151, v151, v152
v_mov_b32 v152, v151
s_nop 1
v_permlane32_swap_b32 v151, v152
v_max_f32 v151, v151, v152
v_sub_f32 v138, v138, v151
v_sub_f32 v139, v139, v151
v_sub_f32 v140, v140, v151
v_sub_f32 v141, v141, v151
v_sub_f32 v142, v142, v151
v_sub_f32 v143, v143, v151
v_sub_f32 v144, v144, v151
v_sub_f32 v145, v145, v151
v_sub_f32 v150, v150, v151
v_sub_f32 v146, v146, v151
v_sub_f32 v147, v147, v151
v_sub_f32 v148, v148, v151
v_sub_f32 v149, v149, v151
v_exp_f32 v138, v138
v_exp_f32 v139, v139
v_exp_f32 v140, v140
v_exp_f32 v141, v141
v_exp_f32 v142, v142
v_exp_f32 v143, v143
v_exp_f32 v144, v144
v_exp_f32 v145, v145
v_exp_f32 v150, v150
v_exp_f32 v146, v146
v_exp_f32 v147, v147
v_exp_f32 v148, v148
v_exp_f32 v149, v149
v_cvt_pk_bf16_f32 v174, v138, v139
v_cvt_pk_bf16_f32 v175, v140, v141
v_cvt_pk_bf16_f32 v176, v142, v143
v_cvt_pk_bf16_f32 v177, v144, v145
v_cvt_pk_bf16_f32 v178, v146, v147
v_cvt_pk_bf16_f32 v179, v148, v149
v_cvt_pk_bf16_f32 v180, v150, 0
v_mfma_f32_16x16x32_bf16 v[150:153], v[190:193], v[174:177], 0
v_mfma_f32_16x16x32_bf16 v[138:141], v[114:117], v[174:177], 0
v_mfma_f32_16x16x32_bf16 v[142:145], v[122:125], v[174:177], 0
v_mfma_f32_16x16x32_bf16 v[146:149], v[130:133], v[174:177], 0
v_mfma_f32_16x16x32_bf16 v[150:153], v[190:193], v[178:181], v[150:153]
v_mfma_f32_16x16x32_bf16 v[138:141], v[118:121], v[178:181], v[138:141]
v_mfma_f32_16x16x32_bf16 v[142:145], v[126:129], v[178:181], v[142:145]
v_mfma_f32_16x16x32_bf16 v[146:149], v[134:137], v[178:181], v[146:149]
v_mfma_f32_16x16x32_bf16 v[166:169], v[84:87], v[190:193], 0
v_mfma_f32_16x16x32_bf16 v[154:157], v[84:87], v[114:117], 0
v_mfma_f32_16x16x32_bf16 v[158:161], v[84:87], v[122:125], 0
v_mfma_f32_16x16x32_bf16 v[162:165], v[84:87], v[130:133], 0
v_mfma_f32_16x16x32_bf16 v[166:169], v[88:91], v[190:193], v[166:169]
v_mfma_f32_16x16x32_bf16 v[154:157], v[88:91], v[118:121], v[154:157]
v_mfma_f32_16x16x32_bf16 v[158:161], v[88:91], v[126:129], v[158:161]
v_mfma_f32_16x16x32_bf16 v[162:165], v[88:91], v[134:137], v[162:165]
v_rcp_f32 v167, v166
s_nop 1
v_mov_b32_dpp v154, v158 quad_perm:[0,1,2,3] row_mask:0x2 bank_mask:0xf
s_nop 2
v_mov_b32_dpp v154, v162 quad_perm:[0,1,2,3] row_mask:0x4 bank_mask:0xf
v_mul_f32 v167, s3, v167
v_mul_f32 v154, v154, v167
v_cvt_pk_bf16_f32 v154, v154, 0
ds_write_b16 v214, v154
v_add_u32 v214, 1552, v214
ds_read_b128 v[170:173], v210 offset:45056
s_waitcnt lgkmcnt(0)
v_mfma_f32_16x16x32_bf16 v[12:15], a[144:147], v[170:173], v[12:15]
v_mfma_f32_16x16x32_bf16 v[16:19], a[168:171], v[170:173], v[16:19]
v_mfma_f32_16x16x32_bf16 v[20:23], a[192:195], v[170:173], v[20:23]
ds_read_b128 v[182:185], v210 offset:46080
s_waitcnt lgkmcnt(0)
v_mfma_f32_16x16x32_bf16 v[12:15], a[148:151], v[182:185], v[12:15]
v_mfma_f32_16x16x32_bf16 v[16:19], a[172:175], v[182:185], v[16:19]
v_mfma_f32_16x16x32_bf16 v[20:23], a[196:199], v[182:185], v[20:23]
ds_read_b128 v[186:189], v210 offset:47104
s_waitcnt lgkmcnt(0)
v_mfma_f32_16x16x32_bf16 v[12:15], a[152:155], v[186:189], v[12:15]
v_mfma_f32_16x16x32_bf16 v[16:19], a[176:179], v[186:189], v[16:19]
v_mfma_f32_16x16x32_bf16 v[20:23], a[200:203], v[186:189], v[20:23]
ds_read_b128 v[170:173], v210 offset:48128
s_waitcnt lgkmcnt(0)
v_mfma_f32_16x16x32_bf16 v[12:15], a[156:159], v[170:173], v[12:15]
v_mfma_f32_16x16x32_bf16 v[16:19], a[180:183], v[170:173], v[16:19]
v_mfma_f32_16x16x32_bf16 v[20:23], a[204:207], v[170:173], v[20:23]
ds_read_b128 v[182:185], v210 offset:49152
s_waitcnt lgkmcnt(0)
v_mfma_f32_16x16x32_bf16 v[12:15], a[160:163], v[182:185], v[12:15]
v_mfma_f32_16x16x32_bf16 v[16:19], a[184:187], v[182:185], v[16:19]
v_mfma_f32_16x16x32_bf16 v[20:23], a[208:211], v[182:185], v[20:23]
ds_read_b128 v[186:189], v210 offset:50176
s_waitcnt lgkmcnt(0)
v_mfma_f32_16x16x32_bf16 v[12:15], a[164:167], v[186:189], v[12:15]
v_mfma_f32_16x16x32_bf16 v[16:19], a[188:191], v[186:189], v[16:19]
v_mfma_f32_16x16x32_bf16 v[20:23], a[212:215], v[186:189], v[20:23]
v_cvt_pk_bf16_f32 v78, v12, v13
v_cvt_pk_bf16_f32 v79, v14, v15
buffer_store_dwordx2 v[78:79], v204, s[8:11], s38 offen
v_cvt_pk_bf16_f32 v80, v16, v17
v_cvt_pk_bf16_f32 v81, v18, v19
buffer_store_dwordx2 v[80:81], v204, s[8:11], s38 offen offset:32
s_nop 0
v_cvt_pk_bf16_f32 v82, v20, v21
v_cvt_pk_bf16_f32 v83, v22, v23
buffer_store_dwordx2 v[82:83], v204, s[8:11], s38 offen offset:64
v_rcp_f32 v151, v150
s_nop 0
v_mul_f32 v151, s3, v151
v_mul_f32 v138, v138, v151
v_mul_f32 v139, v139, v151
v_cvt_pk_bf16_f32 v138, v138, v139
v_mul_f32 v140, v140, v151
v_mul_f32 v141, v141, v151
v_cvt_pk_bf16_f32 v139, v140, v141
v_mul_f32 v142, v142, v151
v_mul_f32 v143, v143, v151
v_cvt_pk_bf16_f32 v140, v142, v143
v_mul_f32 v144, v144, v151
v_mul_f32 v145, v145, v151
v_cvt_pk_bf16_f32 v141, v144, v145
ds_write_b128 v211, v[138:141] offset:51200
v_mul_f32 v146, v146, v151
v_mul_f32 v147, v147, v151
v_cvt_pk_bf16_f32 v142, v146, v147
v_mul_f32 v148, v148, v151
v_mul_f32 v149, v149, v151
v_cvt_pk_bf16_f32 v143, v148, v149
ds_write_b64 v212, v[142:143] offset:51200
s_waitcnt vmcnt(6) lgkmcnt(0)
s_barrier
ds_read_b128 v[170:173], v210 offset:51200
s_waitcnt lgkmcnt(0)
v_mfma_f32_16x16x32_bf16 v[24:27], a[144:147], v[170:173], v[24:27]
v_mfma_f32_16x16x32_bf16 v[28:31], a[168:171], v[170:173], v[28:31]
v_mfma_f32_16x16x32_bf16 v[32:35], a[192:195], v[170:173], v[32:35]
ds_read_b128 v[182:185], v210 offset:52224
s_waitcnt lgkmcnt(0)
v_mfma_f32_16x16x32_bf16 v[24:27], a[148:151], v[182:185], v[24:27]
v_mfma_f32_16x16x32_bf16 v[28:31], a[172:175], v[182:185], v[28:31]
v_mfma_f32_16x16x32_bf16 v[32:35], a[196:199], v[182:185], v[32:35]
ds_read_b128 v[186:189], v210 offset:53248
s_waitcnt lgkmcnt(0)
v_mfma_f32_16x16x32_bf16 v[24:27], a[152:155], v[186:189], v[24:27]
v_mfma_f32_16x16x32_bf16 v[28:31], a[176:179], v[186:189], v[28:31]
v_mfma_f32_16x16x32_bf16 v[32:35], a[200:203], v[186:189], v[32:35]
ds_read_b128 v[170:173], v210 offset:54272
s_waitcnt lgkmcnt(0)
v_mfma_f32_16x16x32_bf16 v[24:27], a[156:159], v[170:173], v[24:27]
v_mfma_f32_16x16x32_bf16 v[28:31], a[180:183], v[170:173], v[28:31]
v_mfma_f32_16x16x32_bf16 v[32:35], a[204:207], v[170:173], v[32:35]
ds_read_b128 v[182:185], v210 offset:55296
s_waitcnt lgkmcnt(0)
v_mfma_f32_16x16x32_bf16 v[24:27], a[160:163], v[182:185], v[24:27]
v_mfma_f32_16x16x32_bf16 v[28:31], a[184:187], v[182:185], v[28:31]
v_mfma_f32_16x16x32_bf16 v[32:35], a[208:211], v[182:185], v[32:35]
ds_read_b128 v[186:189], v210 offset:56320
s_waitcnt lgkmcnt(0)
v_mfma_f32_16x16x32_bf16 v[24:27], a[164:167], v[186:189], v[24:27]
v_mfma_f32_16x16x32_bf16 v[28:31], a[188:191], v[186:189], v[28:31]
v_mfma_f32_16x16x32_bf16 v[32:35], a[212:215], v[186:189], v[32:35]
v_cvt_pk_bf16_f32 v116, v24, v25
v_cvt_pk_bf16_f32 v117, v26, v27
buffer_store_dwordx2 v[116:117], v205, s[8:11], s38 offen
v_cvt_pk_bf16_f32 v124, v28, v29
v_cvt_pk_bf16_f32 v125, v30, v31
buffer_store_dwordx2 v[124:125], v205, s[8:11], s38 offen offset:32
s_nop 0
v_cvt_pk_bf16_f32 v132, v32, v33
v_cvt_pk_bf16_f32 v133, v34, v35
buffer_store_dwordx2 v[132:133], v205, s[8:11], s38 offen offset:64
s_mov_b32 s39, s37
ds_read_b128 v[174:177], v217
ds_read_b128 v[84:87], v200
s_waitcnt lgkmcnt(0)
v_mfma_f32_16x16x32_bf16 v[0:3], v[174:177], v[84:87], 0
ds_read_b128 v[92:95], v201
s_waitcnt lgkmcnt(0)
v_mfma_f32_16x16x32_bf16 v[12:15], v[174:177], v[92:95], 0
ds_read_b128 v[100:103], v202
s_waitcnt lgkmcnt(0)
v_mfma_f32_16x16x32_bf16 v[24:27], v[174:177], v[100:103], 0
ds_read_b128 v[178:181], v217 offset:528
ds_read_b128 v[84:87], v194
ds_read_b128 v[88:91], v194 offset:16
s_waitcnt lgkmcnt(0)
v_smfmac_f32_16x16x64_bf16 v[0:3], v[178:181], v[84:91], v213
ds_read_b128 v[92:95], v195
ds_read_b128 v[96:99], v195 offset:16
s_waitcnt lgkmcnt(0)
v_smfmac_f32_16x16x64_bf16 v[12:15], v[178:181], v[92:99], v213
ds_read_b128 v[100:103], v196
ds_read_b128 v[104:107], v196 offset:16
s_waitcnt lgkmcnt(0)
v_smfmac_f32_16x16x64_bf16 v[24:27], v[178:181], v[100:107], v213
ds_read_b128 v[174:177], v217 offset:1056
ds_read_b128 v[84:87], v197
ds_read_b128 v[88:91], v197 offset:16
s_waitcnt lgkmcnt(0)
v_smfmac_f32_16x16x64_bf16 v[0:3], v[174:177], v[84:91], v213
ds_read_b128 v[92:95], v198
ds_read_b128 v[96:99], v198 offset:16
s_waitcnt lgkmcnt(0)
v_smfmac_f32_16x16x64_bf16 v[12:15], v[174:177], v[92:99], v213
ds_read_b128 v[100:103], v199
ds_read_b128 v[104:107], v199 offset:16
s_waitcnt lgkmcnt(0)
v_smfmac_f32_16x16x64_bf16 v[24:27], v[174:177], v[100:107], v213
ds_read_b128 v[178:181], v217 offset:1584
ds_read_b128 v[84:87], v200 offset:32
s_waitcnt lgkmcnt(0)
v_mfma_f32_16x16x32_bf16 v[4:7], v[178:181], v[84:87], 0
ds_read_b128 v[92:95], v201 offset:32
s_waitcnt lgkmcnt(0)
v_mfma_f32_16x16x32_bf16 v[16:19], v[178:181], v[92:95], 0
ds_read_b128 v[100:103], v202 offset:32
s_waitcnt lgkmcnt(0)
v_mfma_f32_16x16x32_bf16 v[28:31], v[178:181], v[100:103], 0
ds_read_b128 v[174:177], v217 offset:2112
ds_read_b128 v[84:87], v194 offset:32
ds_read_b128 v[88:91], v194 offset:48
s_waitcnt lgkmcnt(0)
v_smfmac_f32_16x16x64_bf16 v[4:7], v[174:177], v[84:91], v213
ds_read_b128 v[92:95], v195 offset:32
ds_read_b128 v[96:99], v195 offset:48
s_waitcnt lgkmcnt(0)
v_smfmac_f32_16x16x64_bf16 v[16:19], v[174:177], v[92:99], v213
ds_read_b128 v[100:103], v196 offset:32
ds_read_b128 v[104:107], v196 offset:48
s_waitcnt lgkmcnt(0)
v_smfmac_f32_16x16x64_bf16 v[28:31], v[174:177], v[100:107], v213
ds_read_b128 v[178:181], v217 offset:2640
ds_read_b128 v[84:87], v197 offset:32
ds_read_b128 v[88:91], v197 offset:48
s_waitcnt lgkmcnt(0)
v_smfmac_f32_16x16x64_bf16 v[4:7], v[178:181], v[84:91], v213
ds_read_b128 v[92:95], v198 offset:32
ds_read_b128 v[96:99], v198 offset:48
s_waitcnt lgkmcnt(0)
v_smfmac_f32_16x16x64_bf16 v[16:19], v[178:181], v[92:99], v213
ds_read_b128 v[100:103], v199 offset:32
ds_read_b128 v[104:107], v199 offset:48
s_waitcnt lgkmcnt(0)
v_smfmac_f32_16x16x64_bf16 v[28:31], v[178:181], v[100:107], v213
ds_read_b128 v[174:177], v217 offset:3168
ds_read_b128 v[84:87], v200 offset:64
s_waitcnt lgkmcnt(0)
v_mfma_f32_16x16x32_bf16 v[8:11], v[174:177], v[84:87], 0
ds_read_b128 v[92:95], v201 offset:64
s_waitcnt lgkmcnt(0)
v_mfma_f32_16x16x32_bf16 v[20:23], v[174:177], v[92:95], 0
ds_read_b128 v[100:103], v202 offset:64
s_waitcnt lgkmcnt(0)
v_mfma_f32_16x16x32_bf16 v[32:35], v[174:177], v[100:103], 0
ds_read_b128 v[178:181], v217 offset:3696
ds_read_b128 v[84:87], v194 offset:64
ds_read_b128 v[88:91], v194 offset:80
s_waitcnt lgkmcnt(0)
v_smfmac_f32_16x16x64_bf16 v[8:11], v[178:181], v[84:91], v213
ds_read_b128 v[92:95], v195 offset:64
ds_read_b128 v[96:99], v195 offset:80
s_waitcnt lgkmcnt(0)
v_smfmac_f32_16x16x64_bf16 v[20:23], v[178:181], v[92:99], v213
ds_read_b128 v[100:103], v196 offset:64
ds_read_b128 v[104:107], v196 offset:80
s_waitcnt lgkmcnt(0)
v_smfmac_f32_16x16x64_bf16 v[32:35], v[178:181], v[100:107], v213
ds_read_b128 v[174:177], v217 offset:4224
ds_read_b128 v[84:87], v197 offset:64
ds_read_b128 v[88:91], v197 offset:80
s_waitcnt lgkmcnt(0)
v_smfmac_f32_16x16x64_bf16 v[8:11], v[174:177], v[84:91], v213
ds_read_b128 v[92:95], v198 offset:64
ds_read_b128 v[96:99], v198 offset:80
s_waitcnt lgkmcnt(0)
v_smfmac_f32_16x16x64_bf16 v[20:23], v[174:177], v[92:99], v213
ds_read_b128 v[100:103], v199 offset:64
ds_read_b128 v[104:107], v199 offset:80
s_waitcnt lgkmcnt(0)
v_smfmac_f32_16x16x64_bf16 v[32:35], v[174:177], v[100:107], v213
v_add_f32 v118, v0, v1
v_mul_f32 v119, v0, v0
v_add_f32 v118, v118, v2
v_fmac_f32 v119, v1, v1
v_add_f32 v118, v118, v3
v_fmac_f32 v119, v2, v2
v_fmac_f32 v119, v3, v3
v_add_f32 v126, v12, v13
v_mul_f32 v127, v12, v12
v_add_f32 v126, v126, v14
v_fmac_f32 v127, v13, v13
v_add_f32 v126, v126, v15
v_fmac_f32 v127, v14, v14
v_fmac_f32 v127, v15, v15
v_add_f32 v134, v24, v25
v_mul_f32 v135, v24, v24
v_add_f32 v134, v134, v26
v_fmac_f32 v135, v25, v25
v_add_f32 v134, v134, v27
v_fmac_f32 v135, v26, v26
v_fmac_f32 v135, v27, v27
v_add_f32 v118, v118, v4
v_fmac_f32 v119, v4, v4
v_add_f32 v118, v118, v5
v_fmac_f32 v119, v5, v5
v_add_f32 v118, v118, v6
v_fmac_f32 v119, v6, v6
v_add_f32 v118, v118, v7
v_fmac_f32 v119, v7, v7
v_add_f32 v126, v126, v16
v_fmac_f32 v127, v16, v16
v_add_f32 v126, v126, v17
v_fmac_f32 v127, v17, v17
v_add_f32 v126, v126, v18
v_fmac_f32 v127, v18, v18
v_add_f32 v126, v126, v19
v_fmac_f32 v127, v19, v19
v_add_f32 v134, v134, v28
v_fmac_f32 v135, v28, v28
v_add_f32 v134, v134, v29
v_fmac_f32 v135, v29, v29
v_add_f32 v134, v134, v30
v_fmac_f32 v135, v30, v30
v_add_f32 v134, v134, v31
v_fmac_f32 v135, v31, v31
v_add_f32 v118, v118, v8
v_fmac_f32 v119, v8, v8
v_add_f32 v118, v118, v9
v_fmac_f32 v119, v9, v9
v_add_f32 v118, v118, v10
v_fmac_f32 v119, v10, v10
v_add_f32 v118, v118, v11
v_fmac_f32 v119, v11, v11
v_add_f32 v126, v126, v20
v_fmac_f32 v127, v20, v20
v_add_f32 v126, v126, v21
v_fmac_f32 v127, v21, v21
v_add_f32 v126, v126, v22
v_fmac_f32 v127, v22, v22
v_add_f32 v126, v126, v23
v_fmac_f32 v127, v23, v23
v_add_f32 v134, v134, v32
v_fmac_f32 v135, v32, v32
v_add_f32 v134, v134, v33
v_fmac_f32 v135, v33, v33
v_add_f32 v134, v134, v34
v_fmac_f32 v135, v34, v34
v_add_f32 v134, v134, v35
v_fmac_f32 v135, v35, v35
v_permlane16_swap_b32 v118, v119
v_add_f32 v118, v118, v119
v_permlane16_swap_b32 v126, v127
v_add_f32 v126, v126, v127
v_permlane16_swap_b32 v134, v135
v_add_f32 v134, v134, v135
v_permlane32_swap_b32 v118, v126
v_add_f32 v118, v118, v126
ds_write_b32 v209, v118
v_mov_b32 v135, v134
s_nop 1
v_permlane32_swap_b32 v134, v135
v_add_f32 v134, v134, v135
ds_write_b32 v209, v134 offset:512
s_waitcnt lgkmcnt(0)
s_barrier
ds_read_b128 v[102:105], v210 offset:18432
ds_read_b128 v[106:109], v210 offset:19456
s_waitcnt lgkmcnt(1)
v_add_f32 v102, v102, v103
s_waitcnt lgkmcnt(0)
v_add_f32 v106, v106, v107
v_add_f32 v104, v104, v105
v_add_f32 v108, v108, v109
v_add_f32 v102, v102, v104
v_add_f32 v106, v106, v108
v_mul_f32 v103, s48, v102
v_mul_f32 v104, s73, v102
v_mul_f32 v106, s73, v106
v_fma_f32 v106, -v103, v104, v106
v_max_f32 v106, 0, v106
v_add_f32 v106, s49, v106
v_rsq_f32 v102, v106
s_nop 0
v_mul_f32_e64 v103, -v103, v102
ds_write_b64 v211, v[102:103]
ds_read_b64 v[118:119], v219
ds_read_b64 v[126:127], v219 offset:256
ds_read_b64 v[134:135], v219 offset:512
s_waitcnt lgkmcnt(2)
v_fma_f32 v220, v0, v118, v119
v_fma_f32 v221, v1, v118, v119
v_cvt_pk_bf16_f32 v90, v220, v221
v_fma_f32 v222, v2, v118, v119
v_fma_f32 v223, v3, v118, v119
v_cvt_pk_bf16_f32 v91, v222, v223
v_fma_f32 v220, v4, v118, v119
v_fma_f32 v221, v5, v118, v119
v_cvt_pk_bf16_f32 v92, v220, v221
v_fma_f32 v222, v6, v118, v119
v_fma_f32 v223, v7, v118, v119
v_cvt_pk_bf16_f32 v93, v222, v223
ds_write_b128 v211, v[90:93]
v_fma_f32 v220, v8, v118, v119
v_fma_f32 v221, v9, v118, v119
v_cvt_pk_bf16_f32 v94, v220, v221
v_fma_f32 v222, v10, v118, v119
v_fma_f32 v223, v11, v118, v119
v_cvt_pk_bf16_f32 v95, v222, v223
s_waitcnt lgkmcnt(2)
ds_write_b64 v212, v[94:95]
v_fma_f32 v220, v12, v126, v127
v_fma_f32 v221, v13, v126, v127
v_cvt_pk_bf16_f32 v174, v220, v221
v_fma_f32 v222, v14, v126, v127
v_fma_f32 v223, v15, v126, v127
v_cvt_pk_bf16_f32 v175, v222, v223
v_fma_f32 v220, v16, v126, v127
v_fma_f32 v221, v17, v126, v127
v_cvt_pk_bf16_f32 v176, v220, v221
v_fma_f32 v222, v18, v126, v127
v_fma_f32 v223, v19, v126, v127
v_cvt_pk_bf16_f32 v177, v222, v223
ds_write_b128 v211, v[174:177] offset:6144
v_fma_f32 v220, v20, v126, v127
v_fma_f32 v221, v21, v126, v127
v_cvt_pk_bf16_f32 v178, v220, v221
v_fma_f32 v222, v22, v126, v127
v_fma_f32 v223, v23, v126, v127
v_cvt_pk_bf16_f32 v179, v222, v223
s_waitcnt lgkmcnt(3)
ds_write_b64 v212, v[178:179] offset:6144
v_fma_f32 v220, v24, v134, v135
v_fma_f32 v221, v25, v134, v135
v_cvt_pk_bf16_f32 v90, v220, v221
v_fma_f32 v222, v26, v134, v135
v_fma_f32 v223, v27, v134, v135
v_cvt_pk_bf16_f32 v91, v222, v223
v_fma_f32 v220, v28, v134, v135
v_fma_f32 v221, v29, v134, v135
v_cvt_pk_bf16_f32 v92, v220, v221
v_fma_f32 v222, v30, v134, v135
v_fma_f32 v223, v31, v134, v135
v_cvt_pk_bf16_f32 v93, v222, v223
ds_write_b128 v211, v[90:93] offset:12288
v_fma_f32 v220, v32, v134, v135
v_fma_f32 v221, v33, v134, v135
v_cvt_pk_bf16_f32 v94, v220, v221
v_fma_f32 v222, v34, v134, v135
v_fma_f32 v223, v35, v134, v135
v_cvt_pk_bf16_f32 v95, v222, v223
ds_write_b64 v212, v[94:95] offset:12288
ds_read_b128 v[182:185], v210 offset:20480
s_waitcnt lgkmcnt(0)
v_mfma_f32_16x16x32_bf16 v[138:141], a[0:3], v[182:185], 0
v_mfma_f32_16x16x32_bf16 v[142:145], a[24:27], v[182:185], 0
v_mfma_f32_16x16x32_bf16 v[146:149], a[48:51], v[182:185], 0
v_mfma_f32_16x16x32_bf16 v[150:153], a[216:219], v[182:185], 0
v_mfma_f32_16x16x32_bf16 v[154:157], a[240:243], v[182:185], 0
v_mfma_f32_16x16x32_bf16 v[158:161], v[232:235], v[182:185], 0
v_mfma_f32_16x16x32_bf16 v[162:165], v[182:185], a[72:75], 0
v_mfma_f32_16x16x32_bf16 v[166:169], v[182:185], a[96:99], 0
v_mfma_f32_16x16x32_bf16 v[170:173], v[182:185], a[120:123], 0
ds_read_b128 v[186:189], v210 offset:21504
s_waitcnt lgkmcnt(0)
v_mfma_f32_16x16x32_bf16 v[138:141], a[4:7], v[186:189], v[138:141]
v_mfma_f32_16x16x32_bf16 v[142:145], a[28:31], v[186:189], v[142:145]
v_mfma_f32_16x16x32_bf16 v[146:149], a[52:55], v[186:189], v[146:149]
v_mfma_f32_16x16x32_bf16 v[150:153], a[220:223], v[186:189], v[150:153]
v_mfma_f32_16x16x32_bf16 v[154:157], a[244:247], v[186:189], v[154:157]
v_mfma_f32_16x16x32_bf16 v[158:161], v[236:239], v[186:189], v[158:161]
v_mfma_f32_16x16x32_bf16 v[162:165], v[186:189], a[76:79], v[162:165]
v_mfma_f32_16x16x32_bf16 v[166:169], v[186:189], a[100:103], v[166:169]
v_mfma_f32_16x16x32_bf16 v[170:173], v[186:189], a[124:127], v[170:173]
ds_read_b128 v[182:185], v210 offset:22528
s_waitcnt lgkmcnt(0)
v_mfma_f32_16x16x32_bf16 v[138:141], a[8:11], v[182:185], v[138:141]
v_mfma_f32_16x16x32_bf16 v[142:145], a[32:35], v[182:185], v[142:145]
v_mfma_f32_16x16x32_bf16 v[146:149], a[56:59], v[182:185], v[146:149]
v_mfma_f32_16x16x32_bf16 v[150:153], a[224:227], v[182:185], v[150:153]
v_mfma_f32_16x16x32_bf16 v[154:157], a[248:251], v[182:185], v[154:157]
v_mfma_f32_16x16x32_bf16 v[158:161], v[240:243], v[182:185], v[158:161]
v_mfma_f32_16x16x32_bf16 v[162:165], v[182:185], a[80:83], v[162:165]
v_mfma_f32_16x16x32_bf16 v[166:169], v[182:185], a[104:107], v[166:169]
v_mfma_f32_16x16x32_bf16 v[170:173], v[182:185], a[128:131], v[170:173]
ds_read_b128 v[186:189], v210 offset:23552
s_waitcnt lgkmcnt(0)
v_mfma_f32_16x16x32_bf16 v[138:141], a[12:15], v[186:189], v[138:141]
v_mfma_f32_16x16x32_bf16 v[142:145], a[36:39], v[186:189], v[142:145]
v_mfma_f32_16x16x32_bf16 v[146:149], a[60:63], v[186:189], v[146:149]
v_mfma_f32_16x16x32_bf16 v[150:153], a[228:231], v[186:189], v[150:153]
v_mfma_f32_16x16x32_bf16 v[154:157], a[252:255], v[186:189], v[154:157]
v_mfma_f32_16x16x32_bf16 v[158:161], v[244:247], v[186:189], v[158:161]
v_mfma_f32_16x16x32_bf16 v[162:165], v[186:189], a[84:87], v[162:165]
v_mfma_f32_16x16x32_bf16 v[166:169], v[186:189], a[108:111], v[166:169]
v_mfma_f32_16x16x32_bf16 v[170:173], v[186:189], a[132:135], v[170:173]
ds_read_b128 v[182:185], v210 offset:24576
s_waitcnt lgkmcnt(0)
v_mfma_f32_16x16x32_bf16 v[138:141], a[16:19], v[182:185], v[138:141]
v_mfma_f32_16x16x32_bf16 v[142:145], a[40:43], v[182:185], v[142:145]
v_mfma_f32_16x16x32_bf16 v[146:149], a[64:67], v[182:185], v[146:149]
v_mfma_f32_16x16x32_bf16 v[150:153], a[232:235], v[182:185], v[150:153]
v_mfma_f32_16x16x32_bf16 v[154:157], v[224:227], v[182:185], v[154:157]
v_mfma_f32_16x16x32_bf16 v[158:161], v[248:251], v[182:185], v[158:161]
v_mfma_f32_16x16x32_bf16 v[162:165], v[182:185], a[88:91], v[162:165]
v_mfma_f32_16x16x32_bf16 v[166:169], v[182:185], a[112:115], v[166:169]
v_mfma_f32_16x16x32_bf16 v[170:173], v[182:185], a[136:139], v[170:173]
ds_read_b128 v[186:189], v210 offset:25600
s_waitcnt lgkmcnt(0)
v_mfma_f32_16x16x32_bf16 v[138:141], a[20:23], v[186:189], v[138:141]
v_mfma_f32_16x16x32_bf16 v[142:145], a[44:47], v[186:189], v[142:145]
v_mfma_f32_16x16x32_bf16 v[146:149], a[68:71], v[186:189], v[146:149]
v_mfma_f32_16x16x32_bf16 v[150:153], a[236:239], v[186:189], v[150:153]
v_mfma_f32_16x16x32_bf16 v[154:157], v[228:231], v[186:189], v[154:157]
v_mfma_f32_16x16x32_bf16 v[158:161], v[252:255], v[186:189], v[158:161]
v_mfma_f32_16x16x32_bf16 v[162:165], v[186:189], a[92:95], v[162:165]
v_mfma_f32_16x16x32_bf16 v[166:169], v[186:189], a[116:119], v[166:169]
v_mfma_f32_16x16x32_bf16 v[170:173], v[186:189], a[140:143], v[170:173]
v_cvt_pk_bf16_f32 v78, v138, v139
v_cvt_pk_bf16_f32 v79, v140, v141
v_cvt_pk_bf16_f32 v80, v142, v143
v_cvt_pk_bf16_f32 v81, v144, v145
v_cvt_pk_bf16_f32 v82, v146, v147
v_cvt_pk_bf16_f32 v83, v148, v149
v_cvt_pk_bf16_f32 v72, v150, v151
v_cvt_pk_bf16_f32 v73, v152, v153
v_cvt_pk_bf16_f32 v74, v154, v155
v_cvt_pk_bf16_f32 v75, v156, v157
v_cvt_pk_bf16_f32 v76, v158, v159
v_cvt_pk_bf16_f32 v77, v160, v161
v_cvt_pk_bf16_f32 v114, v162, v163
v_cvt_pk_bf16_f32 v115, v164, v165
v_cvt_pk_bf16_f32 v122, v166, v167
v_cvt_pk_bf16_f32 v123, v168, v169
v_cvt_pk_bf16_f32 v130, v170, v171
v_cvt_pk_bf16_f32 v131, v172, v173
ds_read_b128 v[182:185], v210 offset:26624
s_waitcnt lgkmcnt(0)
v_mfma_f32_16x16x32_bf16 v[138:141], a[0:3], v[182:185], 0
v_mfma_f32_16x16x32_bf16 v[142:145], a[24:27], v[182:185], 0
v_mfma_f32_16x16x32_bf16 v[146:149], a[48:51], v[182:185], 0
v_mfma_f32_16x16x32_bf16 v[150:153], a[216:219], v[182:185], 0
v_mfma_f32_16x16x32_bf16 v[154:157], a[240:243], v[182:185], 0
v_mfma_f32_16x16x32_bf16 v[158:161], v[232:235], v[182:185], 0
v_mfma_f32_16x16x32_bf16 v[162:165], v[182:185], a[72:75], 0
v_mfma_f32_16x16x32_bf16 v[166:169], v[182:185], a[96:99], 0
v_mfma_f32_16x16x32_bf16 v[170:173], v[182:185], a[120:123], 0
ds_read_b128 v[186:189], v210 offset:27648
s_waitcnt lgkmcnt(0)
v_mfma_f32_16x16x32_bf16 v[138:141], a[4:7], v[186:189], v[138:141]
v_mfma_f32_16x16x32_bf16 v[142:145], a[28:31], v[186:189], v[142:145]
v_mfma_f32_16x16x32_bf16 v[146:149], a[52:55], v[186:189], v[146:149]
v_mfma_f32_16x16x32_bf16 v[150:153], a[220:223], v[186:189], v[150:153]
v_mfma_f32_16x16x32_bf16 v[154:157], a[244:247], v[186:189], v[154:157]
v_mfma_f32_16x16x32_bf16 v[158:161], v[236:239], v[186:189], v[158:161]
v_mfma_f32_16x16x32_bf16 v[162:165], v[186:189], a[76:79], v[162:165]
v_mfma_f32_16x16x32_bf16 v[166:169], v[186:189], a[100:103], v[166:169]
v_mfma_f32_16x16x32_bf16 v[170:173], v[186:189], a[124:127], v[170:173]
ds_read_b128 v[182:185], v210 offset:28672
s_waitcnt lgkmcnt(0)
v_mfma_f32_16x16x32_bf16 v[138:141], a[8:11], v[182:185], v[138:141]
v_mfma_f32_16x16x32_bf16 v[142:145], a[32:35], v[182:185], v[142:145]
v_mfma_f32_16x16x32_bf16 v[146:149], a[56:59], v[182:185], v[146:149]
v_mfma_f32_16x16x32_bf16 v[150:153], a[224:227], v[182:185], v[150:153]
v_mfma_f32_16x16x32_bf16 v[154:157], a[248:251], v[182:185], v[154:157]
v_mfma_f32_16x16x32_bf16 v[158:161], v[240:243], v[182:185], v[158:161]
v_mfma_f32_16x16x32_bf16 v[162:165], v[182:185], a[80:83], v[162:165]
v_mfma_f32_16x16x32_bf16 v[166:169], v[182:185], a[104:107], v[166:169]
v_mfma_f32_16x16x32_bf16 v[170:173], v[182:185], a[128:131], v[170:173]
ds_read_b128 v[186:189], v210 offset:29696
s_waitcnt lgkmcnt(0)
v_mfma_f32_16x16x32_bf16 v[138:141], a[12:15], v[186:189], v[138:141]
v_mfma_f32_16x16x32_bf16 v[142:145], a[36:39], v[186:189], v[142:145]
v_mfma_f32_16x16x32_bf16 v[146:149], a[60:63], v[186:189], v[146:149]
v_mfma_f32_16x16x32_bf16 v[150:153], a[228:231], v[186:189], v[150:153]
v_mfma_f32_16x16x32_bf16 v[154:157], a[252:255], v[186:189], v[154:157]
v_mfma_f32_16x16x32_bf16 v[158:161], v[244:247], v[186:189], v[158:161]
v_mfma_f32_16x16x32_bf16 v[162:165], v[186:189], a[84:87], v[162:165]
v_mfma_f32_16x16x32_bf16 v[166:169], v[186:189], a[108:111], v[166:169]
v_mfma_f32_16x16x32_bf16 v[170:173], v[186:189], a[132:135], v[170:173]
ds_read_b128 v[182:185], v210 offset:30720
s_waitcnt lgkmcnt(0)
v_mfma_f32_16x16x32_bf16 v[138:141], a[16:19], v[182:185], v[138:141]
v_mfma_f32_16x16x32_bf16 v[142:145], a[40:43], v[182:185], v[142:145]
v_mfma_f32_16x16x32_bf16 v[146:149], a[64:67], v[182:185], v[146:149]
v_mfma_f32_16x16x32_bf16 v[150:153], a[232:235], v[182:185], v[150:153]
v_mfma_f32_16x16x32_bf16 v[154:157], v[224:227], v[182:185], v[154:157]
v_mfma_f32_16x16x32_bf16 v[158:161], v[248:251], v[182:185], v[158:161]
v_mfma_f32_16x16x32_bf16 v[162:165], v[182:185], a[88:91], v[162:165]
v_mfma_f32_16x16x32_bf16 v[166:169], v[182:185], a[112:115], v[166:169]
v_mfma_f32_16x16x32_bf16 v[170:173], v[182:185], a[136:139], v[170:173]
ds_read_b128 v[186:189], v210 offset:31744
s_waitcnt lgkmcnt(0)
v_mfma_f32_16x16x32_bf16 v[138:141], a[20:23], v[186:189], v[138:141]
v_mfma_f32_16x16x32_bf16 v[142:145], a[44:47], v[186:189], v[142:145]
v_mfma_f32_16x16x32_bf16 v[146:149], a[68:71], v[186:189], v[146:149]
v_mfma_f32_16x16x32_bf16 v[150:153], a[236:239], v[186:189], v[150:153]
v_mfma_f32_16x16x32_bf16 v[154:157], v[228:231], v[186:189], v[154:157]
v_mfma_f32_16x16x32_bf16 v[158:161], v[252:255], v[186:189], v[158:161]
v_mfma_f32_16x16x32_bf16 v[162:165], v[186:189], a[92:95], v[162:165]
v_mfma_f32_16x16x32_bf16 v[166:169], v[186:189], a[116:119], v[166:169]
v_mfma_f32_16x16x32_bf16 v[170:173], v[186:189], a[140:143], v[170:173]
v_cvt_pk_bf16_f32 v96, v138, v139
v_cvt_pk_bf16_f32 v97, v140, v141
v_cvt_pk_bf16_f32 v98, v142, v143
v_cvt_pk_bf16_f32 v99, v144, v145
v_cvt_pk_bf16_f32 v100, v146, v147
v_cvt_pk_bf16_f32 v101, v148, v149
v_cvt_pk_bf16_f32 v84, v150, v151
v_cvt_pk_bf16_f32 v85, v152, v153
v_cvt_pk_bf16_f32 v86, v154, v155
v_cvt_pk_bf16_f32 v87, v156, v157
v_cvt_pk_bf16_f32 v88, v158, v159
v_cvt_pk_bf16_f32 v89, v160, v161
v_cvt_pk_bf16_f32 v116, v162, v163
v_cvt_pk_bf16_f32 v117, v164, v165
v_cvt_pk_bf16_f32 v124, v166, v167
v_cvt_pk_bf16_f32 v125, v168, v169
v_cvt_pk_bf16_f32 v132, v170, v171
v_cvt_pk_bf16_f32 v133, v172, v173
ds_read_b128 v[182:185], v210 offset:32768
s_waitcnt lgkmcnt(0)
v_mfma_f32_16x16x32_bf16 v[138:141], a[0:3], v[182:185], 0
v_mfma_f32_16x16x32_bf16 v[142:145], a[24:27], v[182:185], 0
v_mfma_f32_16x16x32_bf16 v[146:149], a[48:51], v[182:185], 0
ds_read_b128 v[186:189], v210 offset:33792
s_waitcnt lgkmcnt(0)
v_mfma_f32_16x16x32_bf16 v[138:141], a[4:7], v[186:189], v[138:141]
v_mfma_f32_16x16x32_bf16 v[142:145], a[28:31], v[186:189], v[142:145]
v_mfma_f32_16x16x32_bf16 v[146:149], a[52:55], v[186:189], v[146:149]
ds_read_b128 v[182:185], v210 offset:34816
s_waitcnt lgkmcnt(0)
v_mfma_f32_16x16x32_bf16 v[138:141], a[8:11], v[182:185], v[138:141]
v_mfma_f32_16x16x32_bf16 v[142:145], a[32:35], v[182:185], v[142:145]
v_mfma_f32_16x16x32_bf16 v[146:149], a[56:59], v[182:185], v[146:149]
ds_read_b128 v[186:189], v210 offset:35840
s_waitcnt lgkmcnt(0)
v_mfma_f32_16x16x32_bf16 v[138:141], a[12:15], v[186:189], v[138:141]
v_mfma_f32_16x16x32_bf16 v[142:145], a[36:39], v[186:189], v[142:145]
v_mfma_f32_16x16x32_bf16 v[146:149], a[60:63], v[186:189], v[146:149]
ds_read_b128 v[182:185], v210 offset:36864
s_waitcnt lgkmcnt(0)
v_mfma_f32_16x16x32_bf16 v[138:141], a[16:19], v[182:185], v[138:141]
v_mfma_f32_16x16x32_bf16 v[142:145], a[40:43], v[182:185], v[142:145]
v_mfma_f32_16x16x32_bf16 v[146:149], a[64:67], v[182:185], v[146:149]
ds_read_b128 v[186:189], v210 offset:37888
s_waitcnt lgkmcnt(0)
v_mfma_f32_16x16x32_bf16 v[138:141], a[20:23], v[186:189], v[138:141]
v_mfma_f32_16x16x32_bf16 v[142:145], a[44:47], v[186:189], v[142:145]
v_mfma_f32_16x16x32_bf16 v[146:149], a[68:71], v[186:189], v[146:149]
v_cvt_pk_bf16_f32 v102, v138, v139
v_cvt_pk_bf16_f32 v103, v140, v141
s_nop 0
v_cvt_pk_bf16_f32 v104, v142, v143
v_cvt_pk_bf16_f32 v105, v144, v145
s_nop 1
v_cvt_pk_bf16_f32 v106, v146, v147
v_cvt_pk_bf16_f32 v107, v148, v149
ds_read_b128 v[108:111], v215 offset:512
ds_read_b64 v[112:113], v215 offset:528
v_mov_b32 v181, 0
v_mfma_f32_16x16x16_bf16 v[138:141], v[82:83], v[76:77], 0
v_mfma_f32_16x16x16_bf16 v[142:145], v[100:101], v[76:77], 0
s_waitcnt lgkmcnt(0)
v_mfma_f32_16x16x16_bf16 v[150:153], v[112:113], v[76:77], v[206:209]
v_mfma_f32_16x16x16_bf16 v[146:149], v[106:107], v[76:77], 0
v_mfma_f32_16x16x32_bf16 v[138:141], v[78:81], v[72:75], v[138:141]
v_mfma_f32_16x16x32_bf16 v[142:145], v[96:99], v[72:75], v[142:145]
v_mfma_f32_16x16x32_bf16 v[150:153], v[108:111], v[72:75], v[150:153]
v_mfma_f32_16x16x32_bf16 v[146:149], v[102:105], v[72:75], v[146:149]
ds_read_b128 v[72:75], v215
ds_read_b64 v[76:77], v215 offset:16
v_mfma_f32_16x16x16_bf16 v[154:157], v[82:83], v[88:89], 0
v_mfma_f32_16x16x16_bf16 v[158:161], v[100:101], v[88:89], 0
v_mfma_f32_16x16x16_bf16 v[166:169], v[112:113], v[88:89], v[206:209]
v_mfma_f32_16x16x16_bf16 v[162:165], v[106:107], v[88:89], 0
v_mfma_f32_16x16x32_bf16 v[154:157], v[78:81], v[84:87], v[154:157]
v_mfma_f32_16x16x32_bf16 v[158:161], v[96:99], v[84:87], v[158:161]
v_mfma_f32_16x16x32_bf16 v[166:169], v[108:111], v[84:87], v[166:169]
v_mfma_f32_16x16x32_bf16 v[162:165], v[102:105], v[84:87], v[162:165]
ds_read_b128 v[182:185], v210 offset:32768
s_waitcnt lgkmcnt(0)
v_mfma_f32_16x16x32_bf16 v[118:121], v[182:185], a[72:75], 0
v_mfma_f32_16x16x32_bf16 v[126:129], v[182:185], a[96:99], 0
v_mfma_f32_16x16x32_bf16 v[134:137], v[182:185], a[120:123], 0
v_mfma_f32_16x16x32_bf16 v[90:93], a[216:219], v[182:185], 0
v_mfma_f32_16x16x32_bf16 v[170:173], a[240:243], v[182:185], 0
v_mfma_f32_16x16x32_bf16 v[220:223], v[232:235], v[182:185], 0
ds_read_b128 v[186:189], v210 offset:33792
s_waitcnt lgkmcnt(0)
v_mfma_f32_16x16x32_bf16 v[118:121], v[186:189], a[76:79], v[118:121]
v_mfma_f32_16x16x32_bf16 v[126:129], v[186:189], a[100:103], v[126:129]
v_mfma_f32_16x16x32_bf16 v[134:137], v[186:189], a[124:127], v[134:137]
v_mfma_f32_16x16x32_bf16 v[90:93], a[220:223], v[186:189], v[90:93]
v_mfma_f32_16x16x32_bf16 v[170:173], a[244:247], v[186:189], v[170:173]
v_mfma_f32_16x16x32_bf16 v[220:223], v[236:239], v[186:189], v[220:223]
ds_read_b128 v[182:185], v210 offset:34816
s_waitcnt lgkmcnt(0)
v_mfma_f32_16x16x32_bf16 v[118:121], v[182:185], a[80:83], v[118:121]
v_mfma_f32_16x16x32_bf16 v[126:129], v[182:185], a[104:107], v[126:129]
v_mfma_f32_16x16x32_bf16 v[134:137], v[182:185], a[128:131], v[134:137]
v_mfma_f32_16x16x32_bf16 v[90:93], a[224:227], v[182:185], v[90:93]
v_mfma_f32_16x16x32_bf16 v[170:173], a[248:251], v[182:185], v[170:173]
v_mfma_f32_16x16x32_bf16 v[220:223], v[240:243], v[182:185], v[220:223]
ds_read_b128 v[186:189], v210 offset:35840
s_waitcnt lgkmcnt(0)
v_mfma_f32_16x16x32_bf16 v[118:121], v[186:189], a[84:87], v[118:121]
v_mfma_f32_16x16x32_bf16 v[126:129], v[186:189], a[108:111], v[126:129]
v_mfma_f32_16x16x32_bf16 v[134:137], v[186:189], a[132:135], v[134:137]
v_mfma_f32_16x16x32_bf16 v[90:93], a[228:231], v[186:189], v[90:93]
v_mfma_f32_16x16x32_bf16 v[170:173], a[252:255], v[186:189], v[170:173]
v_mfma_f32_16x16x32_bf16 v[220:223], v[244:247], v[186:189], v[220:223]
ds_read_b128 v[182:185], v210 offset:36864
s_waitcnt lgkmcnt(0)
v_mfma_f32_16x16x32_bf16 v[118:121], v[182:185], a[88:91], v[118:121]
v_mfma_f32_16x16x32_bf16 v[126:129], v[182:185], a[112:115], v[126:129]
v_mfma_f32_16x16x32_bf16 v[134:137], v[182:185], a[136:139], v[134:137]
v_mfma_f32_16x16x32_bf16 v[90:93], a[232:235], v[182:185], v[90:93]
v_mfma_f32_16x16x32_bf16 v[170:173], v[224:227], v[182:185], v[170:173]
v_mfma_f32_16x16x32_bf16 v[220:223], v[248:251], v[182:185], v[220:223]
ds_read_b128 v[186:189], v210 offset:37888
s_waitcnt lgkmcnt(0)
v_mfma_f32_16x16x32_bf16 v[118:121], v[186:189], a[92:95], v[118:121]
v_mfma_f32_16x16x32_bf16 v[126:129], v[186:189], a[116:119], v[126:129]
v_mfma_f32_16x16x32_bf16 v[134:137], v[186:189], a[140:143], v[134:137]
v_mfma_f32_16x16x32_bf16 v[90:93], a[236:239], v[186:189], v[90:93]
v_mfma_f32_16x16x32_bf16 v[170:173], v[228:231], v[186:189], v[170:173]
v_mfma_f32_16x16x32_bf16 v[220:223], v[252:255], v[186:189], v[220:223]
v_cvt_pk_bf16_f32 v118, v118, v119
v_cvt_pk_bf16_f32 v119, v120, v121
ds_read_u16 v120, v214 offset:1024
v_mov_b32 v121, 0
v_cvt_pk_bf16_f32 v126, v126, v127
v_cvt_pk_bf16_f32 v127, v128, v129
ds_read_u16 v128, v214 offset:1032
v_mov_b32 v129, 0
v_cvt_pk_bf16_f32 v134, v134, v135
v_cvt_pk_bf16_f32 v135, v136, v137
ds_read_u16 v136, v214 offset:1040
v_mov_b32 v137, 0
v_cvt_pk_bf16_f32 v90, v90, v91
v_cvt_pk_bf16_f32 v91, v92, v93
v_cvt_pk_bf16_f32 v92, v170, v171
v_cvt_pk_bf16_f32 v93, v172, v173
v_cvt_pk_bf16_f32 v94, v220, v221
v_cvt_pk_bf16_f32 v95, v222, v223
v_max3_f32 v151, v138, v139, v140
v_max3_f32 v151, v151, v141, v142
v_max3_f32 v151, v151, v143, v144
v_max3_f32 v151, v151, v145, v146
v_max3_f32 v151, v151, v147, v148
v_max3_f32 v151, v151, v149, v150
v_mov_b32 v152, v151
s_nop 1
v_permlane16_swap_b32 v151, v152
v_max_f32 v151, v151, v152
v_mov_b32 v152, v151
s_nop 1
v_permlane32_swap_b32 v151, v152
v_max_f32 v151, v151, v152
v_sub_f32 v138, v138, v151
v_sub_f32 v139, v139, v151
v_sub_f32 v140, v140, v151
v_sub_f32 v141, v141, v151
v_sub_f32 v142, v142, v151
v_sub_f32 v143, v143, v151
v_sub_f32 v144, v144, v151
v_sub_f32 v145, v145, v151
v_sub_f32 v150, v150, v151
v_sub_f32 v146, v146, v151
v_sub_f32 v147, v147, v151
v_sub_f32 v148, v148, v151
v_sub_f32 v149, v149, v151
v_exp_f32 v138, v138
v_exp_f32 v139, v139
v_exp_f32 v140, v140
v_exp_f32 v141, v141
v_exp_f32 v142, v142
v_exp_f32 v143, v143
v_exp_f32 v144, v144
v_exp_f32 v145, v145
v_exp_f32 v150, v150
v_exp_f32 v146, v146
v_exp_f32 v147, v147
v_exp_f32 v148, v148
v_exp_f32 v149, v149
v_cvt_pk_bf16_f32 v174, v138, v139
v_cvt_pk_bf16_f32 v175, v140, v141
v_cvt_pk_bf16_f32 v176, v142, v143
v_cvt_pk_bf16_f32 v177, v144, v145
v_cvt_pk_bf16_f32 v178, v146, v147
v_cvt_pk_bf16_f32 v179, v148, v149
v_cvt_pk_bf16_f32 v180, v150, 0
v_mfma_f32_16x16x32_bf16 v[150:153], v[190:193], v[174:177], 0
v_mfma_f32_16x16x32_bf16 v[138:141], v[114:117], v[174:177], 0
v_mfma_f32_16x16x32_bf16 v[142:145], v[122:125], v[174:177], 0
v_mfma_f32_16x16x32_bf16 v[146:149], v[130:133], v[174:177], 0
v_mfma_f32_16x16x32_bf16 v[150:153], v[190:193], v[178:181], v[150:153]
s_waitcnt lgkmcnt(2)
v_mfma_f32_16x16x32_bf16 v[138:141], v[118:121], v[178:181], v[138:141]
s_waitcnt lgkmcnt(1)
v_mfma_f32_16x16x32_bf16 v[142:145], v[126:129], v[178:181], v[142:145]
s_waitcnt lgkmcnt(0)
v_mfma_f32_16x16x32_bf16 v[146:149], v[134:137], v[178:181], v[146:149]
v_max3_f32 v167, v154, v155, v156
v_max3_f32 v167, v167, v157, v158
v_max3_f32 v167, v167, v159, v160
v_max3_f32 v167, v167, v161, v162
v_max3_f32 v167, v167, v163, v164
v_max3_f32 v167, v167, v165, v166
v_mov_b32 v168, v167
s_nop 1
v_permlane16_swap_b32 v167, v168
v_max_f32 v167, v167, v168
v_mov_b32 v168, v167
s_nop 1
v_permlane32_swap_b32 v167, v168
v_max_f32 v167, v167, v168
v_sub_f32 v154, v154, v167
v_sub_f32 v155, v155, v167
v_sub_f32 v156, v156, v167
v_sub_f32 v157, v157, v167
v_sub_f32 v158, v158, v167
v_sub_f32 v159, v159, v167
v_sub_f32 v160, v160, v167
v_sub_f32 v161, v161, v167
v_sub_f32 v166, v166, v167
v_sub_f32 v162, v162, v167
v_sub_f32 v163, v163, v167
v_sub_f32 v164, v164, v167
v_sub_f32 v165, v165, v167
v_exp_f32 v154, v154
v_exp_f32 v155, v155
v_exp_f32 v156, v156
v_exp_f32 v157, v157
v_exp_f32 v158, v158
v_exp_f32 v159, v159
v_exp_f32 v160, v160
v_exp_f32 v161, v161
v_exp_f32 v166, v166
v_exp_f32 v162, v162
v_exp_f32 v163, v163
v_exp_f32 v164, v164
v_exp_f32 v165, v165
v_cvt_pk_bf16_f32 v174, v154, v155
v_cvt_pk_bf16_f32 v175, v156, v157
v_cvt_pk_bf16_f32 v176, v158, v159
v_cvt_pk_bf16_f32 v177, v160, v161
v_cvt_pk_bf16_f32 v178, v162, v163
v_cvt_pk_bf16_f32 v179, v164, v165
v_cvt_pk_bf16_f32 v180, v166, 0
v_mfma_f32_16x16x32_bf16 v[166:169], v[190:193], v[174:177], 0
v_mfma_f32_16x16x32_bf16 v[154:157], v[114:117], v[174:177], 0
v_mfma_f32_16x16x32_bf16 v[158:161], v[122:125], v[174:177], 0
v_mfma_f32_16x16x32_bf16 v[162:165], v[130:133], v[174:177], 0
v_mfma_f32_16x16x32_bf16 v[166:169], v[190:193], v[178:181], v[166:169]
v_mfma_f32_16x16x32_bf16 v[154:157], v[118:121], v[178:181], v[154:157]
v_mfma_f32_16x16x32_bf16 v[158:161], v[126:129], v[178:181], v[158:161]
v_mfma_f32_16x16x32_bf16 v[162:165], v[134:137], v[178:181], v[162:165]
v_rcp_f32 v151, v150
s_nop 0
v_mul_f32 v151, s3, v151
v_mul_f32 v138, v138, v151
v_mul_f32 v139, v139, v151
v_cvt_pk_bf16_f32 v138, v138, v139
v_mul_f32 v140, v140, v151
v_mul_f32 v141, v141, v151
v_cvt_pk_bf16_f32 v139, v140, v141
v_mul_f32 v142, v142, v151
v_mul_f32 v143, v143, v151
v_cvt_pk_bf16_f32 v140, v142, v143
v_mul_f32 v144, v144, v151
v_mul_f32 v145, v145, v151
v_cvt_pk_bf16_f32 v141, v144, v145
ds_write_b128 v211, v[138:141] offset:38912
v_mul_f32 v146, v146, v151
v_mul_f32 v147, v147, v151
v_cvt_pk_bf16_f32 v142, v146, v147
v_mul_f32 v148, v148, v151
v_mul_f32 v149, v149, v151
v_cvt_pk_bf16_f32 v143, v148, v149
ds_write_b64 v212, v[142:143] offset:38912
v_mfma_f32_16x16x32_bf16 v[138:141], v[78:81], v[90:93], 0
v_mfma_f32_16x16x32_bf16 v[142:145], v[96:99], v[90:93], 0
v_mfma_f32_16x16x32_bf16 v[150:153], v[108:111], v[90:93], v[206:209]
v_mfma_f32_16x16x32_bf16 v[146:149], v[102:105], v[90:93], 0
v_mfma_f32_16x16x16_bf16 v[138:141], v[82:83], v[94:95], v[138:141]
v_mfma_f32_16x16x16_bf16 v[142:145], v[100:101], v[94:95], v[142:145]
v_mfma_f32_16x16x16_bf16 v[150:153], v[112:113], v[94:95], v[150:153]
v_mfma_f32_16x16x16_bf16 v[146:149], v[106:107], v[94:95], v[146:149]
v_rcp_f32 v167, v166
s_nop 0
v_mul_f32 v167, s3, v167
v_mul_f32 v154, v154, v167
v_mul_f32 v155, v155, v167
v_cvt_pk_bf16_f32 v154, v154, v155
v_mul_f32 v156, v156, v167
v_mul_f32 v157, v157, v167
v_cvt_pk_bf16_f32 v155, v156, v157
v_mul_f32 v158, v158, v167
v_mul_f32 v159, v159, v167
v_cvt_pk_bf16_f32 v156, v158, v159
v_mul_f32 v160, v160, v167
v_mul_f32 v161, v161, v167
v_cvt_pk_bf16_f32 v157, v160, v161
ds_write_b128 v211, v[154:157] offset:45056
v_mul_f32 v162, v162, v167
v_mul_f32 v163, v163, v167
v_cvt_pk_bf16_f32 v158, v162, v163
v_mul_f32 v164, v164, v167
v_mul_f32 v165, v165, v167
v_cvt_pk_bf16_f32 v159, v164, v165
ds_write_b64 v212, v[158:159] offset:45056
v_mfma_f32_16x16x16_bf16 v[154:157], v[76:77], v[82:83], 0
v_mfma_f32_16x16x16_bf16 v[158:161], v[76:77], v[100:101], 0
v_mfma_f32_16x16x16_bf16 v[162:165], v[76:77], v[106:107], 0
v_mfma_f32_16x16x16_bf16 v[166:169], v[76:77], v[112:113], v[206:209]
v_mfma_f32_16x16x32_bf16 v[154:157], v[72:75], v[78:81], v[154:157]
v_mfma_f32_16x16x32_bf16 v[158:161], v[72:75], v[96:99], v[158:161]
v_mfma_f32_16x16x32_bf16 v[162:165], v[72:75], v[102:105], v[162:165]
v_mfma_f32_16x16x32_bf16 v[166:169], v[72:75], v[108:111], v[166:169]
v_mov_b32_dpp v154, v158 quad_perm:[0,1,2,3] row_mask:0x2 bank_mask:0xf
s_nop 1
v_mov_b32_dpp v154, v162 quad_perm:[0,1,2,3] row_mask:0x4 bank_mask:0xf
s_nop 2
v_mov_b32_dpp v154, v167 quad_perm:[0,1,2,3] row_mask:0x8 bank_mask:0xf
v_mov_b32 v155, v154
s_nop 1
v_max_f32_dpp v155, v155, v155 row_ror:8 row_mask:0xf bank_mask:0xf
s_nop 1
v_max_f32_dpp v155, v155, v155 row_ror:4 row_mask:0xf bank_mask:0xf
s_nop 1
v_max_f32_dpp v155, v155, v155 row_ror:2 row_mask:0xf bank_mask:0xf
s_nop 1
v_max_f32_dpp v155, v155, v155 row_ror:1 row_mask:0xf bank_mask:0xf
v_mov_b32 v156, v155
s_nop 1
v_permlane16_swap_b32 v155, v156
v_max_f32 v155, v155, v156
v_mov_b32 v156, v155
s_nop 1
v_permlane32_swap_b32 v155, v156
v_max_f32 v155, v155, v156
v_sub_f32 v154, v154, v155
v_exp_f32 v154, v154
s_nop 0
v_cvt_pk_bf16_f32 v154, v154, 0
ds_write_b16 v214, v154
s_waitcnt lgkmcnt(1)
ds_read_b128 v[84:87], v215
ds_read_b128 v[88:91], v215 offset:16
v_add_u32 v215, 1552, v215
s_barrier
ds_read_b128 v[170:173], v210 offset:38912
s_waitcnt lgkmcnt(0)
v_mfma_f32_16x16x32_bf16 v[36:39], a[144:147], v[170:173], v[36:39]
v_mfma_f32_16x16x32_bf16 v[40:43], a[168:171], v[170:173], v[40:43]
v_mfma_f32_16x16x32_bf16 v[44:47], a[192:195], v[170:173], v[44:47]
ds_read_b128 v[182:185], v210 offset:39936
s_waitcnt lgkmcnt(0)
v_mfma_f32_16x16x32_bf16 v[36:39], a[148:151], v[182:185], v[36:39]
v_mfma_f32_16x16x32_bf16 v[40:43], a[172:175], v[182:185], v[40:43]
v_mfma_f32_16x16x32_bf16 v[44:47], a[196:199], v[182:185], v[44:47]
ds_read_b128 v[186:189], v210 offset:40960
s_waitcnt lgkmcnt(0)
v_mfma_f32_16x16x32_bf16 v[36:39], a[152:155], v[186:189], v[36:39]
v_mfma_f32_16x16x32_bf16 v[40:43], a[176:179], v[186:189], v[40:43]
v_mfma_f32_16x16x32_bf16 v[44:47], a[200:203], v[186:189], v[44:47]
ds_read_b128 v[170:173], v210 offset:41984
s_waitcnt lgkmcnt(0)
v_mfma_f32_16x16x32_bf16 v[36:39], a[156:159], v[170:173], v[36:39]
v_mfma_f32_16x16x32_bf16 v[40:43], a[180:183], v[170:173], v[40:43]
v_mfma_f32_16x16x32_bf16 v[44:47], a[204:207], v[170:173], v[44:47]
ds_read_b128 v[182:185], v210 offset:43008
s_waitcnt lgkmcnt(0)
v_mfma_f32_16x16x32_bf16 v[36:39], a[160:163], v[182:185], v[36:39]
v_mfma_f32_16x16x32_bf16 v[40:43], a[184:187], v[182:185], v[40:43]
v_mfma_f32_16x16x32_bf16 v[44:47], a[208:211], v[182:185], v[44:47]
ds_read_b128 v[186:189], v210 offset:44032
s_waitcnt lgkmcnt(0)
v_mfma_f32_16x16x32_bf16 v[36:39], a[164:167], v[186:189], v[36:39]
v_mfma_f32_16x16x32_bf16 v[40:43], a[188:191], v[186:189], v[40:43]
v_mfma_f32_16x16x32_bf16 v[44:47], a[212:215], v[186:189], v[44:47]
v_cvt_pk_bf16_f32 v72, v36, v37
v_cvt_pk_bf16_f32 v73, v38, v39
buffer_store_dwordx2 v[72:73], v203, s[8:11], s39 offen
v_cvt_pk_bf16_f32 v74, v40, v41
v_cvt_pk_bf16_f32 v75, v42, v43
buffer_store_dwordx2 v[74:75], v203, s[8:11], s39 offen offset:32
s_nop 0
v_cvt_pk_bf16_f32 v76, v44, v45
v_cvt_pk_bf16_f32 v77, v46, v47
buffer_store_dwordx2 v[76:77], v203, s[8:11], s39 offen offset:64
v_max3_f32 v151, v138, v139, v140
v_max3_f32 v151, v151, v141, v142
v_max3_f32 v151, v151, v143, v144
v_max3_f32 v151, v151, v145, v146
v_max3_f32 v151, v151, v147, v148
v_max3_f32 v151, v151, v149, v150
v_mov_b32 v152, v151
s_nop 1
v_permlane16_swap_b32 v151, v152
v_max_f32 v151, v151, v152
v_mov_b32 v152, v151
s_nop 1
v_permlane32_swap_b32 v151, v152
v_max_f32 v151, v151, v152
v_sub_f32 v138, v138, v151
v_sub_f32 v139, v139, v151
v_sub_f32 v140, v140, v151
v_sub_f32 v141, v141, v151
v_sub_f32 v142, v142, v151
v_sub_f32 v143, v143, v151
v_sub_f32 v144, v144, v151
v_sub_f32 v145, v145, v151
v_sub_f32 v150, v150, v151
v_sub_f32 v146, v146, v151
v_sub_f32 v147, v147, v151
v_sub_f32 v148, v148, v151
v_sub_f32 v149, v149, v151
v_exp_f32 v138, v138
v_exp_f32 v139, v139
v_exp_f32 v140, v140
v_exp_f32 v141, v141
v_exp_f32 v142, v142
v_exp_f32 v143, v143
v_exp_f32 v144, v144
v_exp_f32 v145, v145
v_exp_f32 v150, v150
v_exp_f32 v146, v146
v_exp_f32 v147, v147
v_exp_f32 v148, v148
v_exp_f32 v149, v149
v_cvt_pk_bf16_f32 v174, v138, v139
v_cvt_pk_bf16_f32 v175, v140, v141
v_cvt_pk_bf16_f32 v176, v142, v143
v_cvt_pk_bf16_f32 v177, v144, v145
v_cvt_pk_bf16_f32 v178, v146, v147
v_cvt_pk_bf16_f32 v179, v148, v149
v_cvt_pk_bf16_f32 v180, v150, 0
v_mfma_f32_16x16x32_bf16 v[150:153], v[190:193], v[174:177], 0
v_mfma_f32_16x16x32_bf16 v[138:141], v[114:117], v[174:177], 0
v_mfma_f32_16x16x32_bf16 v[142:145], v[122:125], v[174:177], 0
v_mfma_f32_16x16x32_bf16 v[146:149], v[130:133], v[174:177], 0
v_mfma_f32_16x16x32_bf16 v[150:153], v[190:193], v[178:181], v[150:153]
v_mfma_f32_16x16x32_bf16 v[138:141], v[118:121], v[178:181], v[138:141]
v_mfma_f32_16x16x32_bf16 v[142:145], v[126:129], v[178:181], v[142:145]
v_mfma_f32_16x16x32_bf16 v[146:149], v[134:137], v[178:181], v[146:149]
v_mfma_f32_16x16x32_bf16 v[166:169], v[84:87], v[190:193], 0
v_mfma_f32_16x16x32_bf16 v[154:157], v[84:87], v[114:117], 0
v_mfma_f32_16x16x32_bf16 v[158:161], v[84:87], v[122:125], 0
v_mfma_f32_16x16x32_bf16 v[162:165], v[84:87], v[130:133], 0
v_mfma_f32_16x16x32_bf16 v[166:169], v[88:91], v[190:193], v[166:169]
v_mfma_f32_16x16x32_bf16 v[154:157], v[88:91], v[118:121], v[154:157]
v_mfma_f32_16x16x32_bf16 v[158:161], v[88:91], v[126:129], v[158:161]
v_mfma_f32_16x16x32_bf16 v[162:165], v[88:91], v[134:137], v[162:165]
v_rcp_f32 v167, v166
s_nop 1
v_mov_b32_dpp v154, v158 quad_perm:[0,1,2,3] row_mask:0x2 bank_mask:0xf
s_nop 2
v_mov_b32_dpp v154, v162 quad_perm:[0,1,2,3] row_mask:0x4 bank_mask:0xf
v_mul_f32 v167, s3, v167
v_mul_f32 v154, v154, v167
v_cvt_pk_bf16_f32 v154, v154, 0
ds_write_b16 v214, v154
v_add_u32 v214, 1552, v214
ds_read_b128 v[170:173], v210 offset:45056
s_waitcnt lgkmcnt(0)
v_mfma_f32_16x16x32_bf16 v[48:51], a[144:147], v[170:173], v[48:51]
v_mfma_f32_16x16x32_bf16 v[52:55], a[168:171], v[170:173], v[52:55]
v_mfma_f32_16x16x32_bf16 v[56:59], a[192:195], v[170:173], v[56:59]
ds_read_b128 v[182:185], v210 offset:46080
s_waitcnt lgkmcnt(0)
v_mfma_f32_16x16x32_bf16 v[48:51], a[148:151], v[182:185], v[48:51]
v_mfma_f32_16x16x32_bf16 v[52:55], a[172:175], v[182:185], v[52:55]
v_mfma_f32_16x16x32_bf16 v[56:59], a[196:199], v[182:185], v[56:59]
ds_read_b128 v[186:189], v210 offset:47104
s_waitcnt lgkmcnt(0)
v_mfma_f32_16x16x32_bf16 v[48:51], a[152:155], v[186:189], v[48:51]
v_mfma_f32_16x16x32_bf16 v[52:55], a[176:179], v[186:189], v[52:55]
v_mfma_f32_16x16x32_bf16 v[56:59], a[200:203], v[186:189], v[56:59]
ds_read_b128 v[170:173], v210 offset:48128
s_waitcnt lgkmcnt(0)
v_mfma_f32_16x16x32_bf16 v[48:51], a[156:159], v[170:173], v[48:51]
v_mfma_f32_16x16x32_bf16 v[52:55], a[180:183], v[170:173], v[52:55]
v_mfma_f32_16x16x32_bf16 v[56:59], a[204:207], v[170:173], v[56:59]
ds_read_b128 v[182:185], v210 offset:49152
s_waitcnt lgkmcnt(0)
v_mfma_f32_16x16x32_bf16 v[48:51], a[160:163], v[182:185], v[48:51]
v_mfma_f32_16x16x32_bf16 v[52:55], a[184:187], v[182:185], v[52:55]
v_mfma_f32_16x16x32_bf16 v[56:59], a[208:211], v[182:185], v[56:59]
ds_read_b128 v[186:189], v210 offset:50176
s_waitcnt lgkmcnt(0)
v_mfma_f32_16x16x32_bf16 v[48:51], a[164:167], v[186:189], v[48:51]
v_mfma_f32_16x16x32_bf16 v[52:55], a[188:191], v[186:189], v[52:55]
v_mfma_f32_16x16x32_bf16 v[56:59], a[212:215], v[186:189], v[56:59]
v_cvt_pk_bf16_f32 v78, v48, v49
v_cvt_pk_bf16_f32 v79, v50, v51
buffer_store_dwordx2 v[78:79], v204, s[8:11], s39 offen
v_cvt_pk_bf16_f32 v80, v52, v53
v_cvt_pk_bf16_f32 v81, v54, v55
buffer_store_dwordx2 v[80:81], v204, s[8:11], s39 offen offset:32
s_nop 0
v_cvt_pk_bf16_f32 v82, v56, v57
v_cvt_pk_bf16_f32 v83, v58, v59
buffer_store_dwordx2 v[82:83], v204, s[8:11], s39 offen offset:64
v_rcp_f32 v151, v150
s_nop 0
v_mul_f32 v151, s3, v151
v_mul_f32 v138, v138, v151
v_mul_f32 v139, v139, v151
v_cvt_pk_bf16_f32 v138, v138, v139
v_mul_f32 v140, v140, v151
v_mul_f32 v141, v141, v151
v_cvt_pk_bf16_f32 v139, v140, v141
v_mul_f32 v142, v142, v151
v_mul_f32 v143, v143, v151
v_cvt_pk_bf16_f32 v140, v142, v143
v_mul_f32 v144, v144, v151
v_mul_f32 v145, v145, v151
v_cvt_pk_bf16_f32 v141, v144, v145
ds_write_b128 v211, v[138:141] offset:51200
v_mul_f32 v146, v146, v151
v_mul_f32 v147, v147, v151
v_cvt_pk_bf16_f32 v142, v146, v147
v_mul_f32 v148, v148, v151
v_mul_f32 v149, v149, v151
v_cvt_pk_bf16_f32 v143, v148, v149
ds_write_b64 v212, v[142:143] offset:51200
s_waitcnt lgkmcnt(0)
s_barrier
ds_read_b128 v[170:173], v210 offset:51200
s_waitcnt lgkmcnt(0)
v_mfma_f32_16x16x32_bf16 v[60:63], a[144:147], v[170:173], v[60:63]
v_mfma_f32_16x16x32_bf16 v[64:67], a[168:171], v[170:173], v[64:67]
v_mfma_f32_16x16x32_bf16 v[68:71], a[192:195], v[170:173], v[68:71]
ds_read_b128 v[182:185], v210 offset:52224
s_waitcnt lgkmcnt(0)
v_mfma_f32_16x16x32_bf16 v[60:63], a[148:151], v[182:185], v[60:63]
v_mfma_f32_16x16x32_bf16 v[64:67], a[172:175], v[182:185], v[64:67]
v_mfma_f32_16x16x32_bf16 v[68:71], a[196:199], v[182:185], v[68:71]
ds_read_b128 v[186:189], v210 offset:53248
s_waitcnt lgkmcnt(0)
v_mfma_f32_16x16x32_bf16 v[60:63], a[152:155], v[186:189], v[60:63]
v_mfma_f32_16x16x32_bf16 v[64:67], a[176:179], v[186:189], v[64:67]
v_mfma_f32_16x16x32_bf16 v[68:71], a[200:203], v[186:189], v[68:71]
ds_read_b128 v[170:173], v210 offset:54272
s_waitcnt lgkmcnt(0)
v_mfma_f32_16x16x32_bf16 v[60:63], a[156:159], v[170:173], v[60:63]
v_mfma_f32_16x16x32_bf16 v[64:67], a[180:183], v[170:173], v[64:67]
v_mfma_f32_16x16x32_bf16 v[68:71], a[204:207], v[170:173], v[68:71]
ds_read_b128 v[182:185], v210 offset:55296
s_waitcnt lgkmcnt(0)
v_mfma_f32_16x16x32_bf16 v[60:63], a[160:163], v[182:185], v[60:63]
v_mfma_f32_16x16x32_bf16 v[64:67], a[184:187], v[182:185], v[64:67]
v_mfma_f32_16x16x32_bf16 v[68:71], a[208:211], v[182:185], v[68:71]
ds_read_b128 v[186:189], v210 offset:56320
s_waitcnt lgkmcnt(0)
v_mfma_f32_16x16x32_bf16 v[60:63], a[164:167], v[186:189], v[60:63]
v_mfma_f32_16x16x32_bf16 v[64:67], a[188:191], v[186:189], v[64:67]
v_mfma_f32_16x16x32_bf16 v[68:71], a[212:215], v[186:189], v[68:71]
v_cvt_pk_bf16_f32 v116, v60, v61
v_cvt_pk_bf16_f32 v117, v62, v63
buffer_store_dwordx2 v[116:117], v205, s[8:11], s39 offen
v_cvt_pk_bf16_f32 v124, v64, v65
v_cvt_pk_bf16_f32 v125, v66, v67
buffer_store_dwordx2 v[124:125], v205, s[8:11], s39 offen offset:32
s_nop 0
v_cvt_pk_bf16_f32 v132, v68, v69
v_cvt_pk_bf16_f32 v133, v70, v71
buffer_store_dwordx2 v[132:133], v205, s[8:11], s39 offen offset:64
v_subrev_u32 v60, 37120, v210
v_lshrrev_b32 v61, 4, v60
v_and_b32 v61, 15, v61
v_lshrrev_b32 v62, 8, v60
v_mul_u32_u24 v63, 1552, v61
v_lshl_add_u32 v63, v62, 5, v63
v_add_u32 v63, 94464, v63
v_mul_u32_u24 v64, 784, v61
v_lshl_add_u32 v64, v62, 4, v64
s_mul_i32 s41, s32, 192
s_add_u32 s41, s41, 127056
v_add_u32 v64, s41, v64
ds_read_b128 v[36:39], v64
ds_read_b128 v[40:43], v64 offset:64
ds_read_b128 v[44:47], v64 offset:128
v_lshlrev_b32 v67, 5, v61
s_add_u32 s41, s33, 0
v_add_u32 v67, s41, v67
s_mov_b32 s42, 58835169
v_mul_hi_u32 v68, v67, s42
v_mul_u32_u24 v65, 73, v68
v_sub_u32 v65, v67, v65
v_mul_u32_u24 v65, 2688, v65
s_mov_b32 s42, 1373568
v_mul_lo_u32 v68, v68, s42
s_mul_i32 s42, s32, 96
v_add3_u32 v65, v65, v68, s42
v_cmp_gt_u32 vcc, s34, v67
v_mov_b32 v68, 1879048192
s_nop 0
v_cndmask_b32 v65, v68, v65, vcc
v_lshl_add_u32 v65, v62, 3, v65
v_add_u32 v65, 785664, v65
v_lshlrev_b32 v67, 5, v61
s_add_u32 s41, s33, 512
v_add_u32 v67, s41, v67
v_mov_b32 v68, s97
v_cmp_gt_u32 vcc, 4, v61
s_nop 1
v_cndmask_b32 v67, v68, v67, vcc
v_mov_b32 v68, 6000
v_cmp_gt_u32 vcc, 5, v61
s_nop 1
v_cndmask_b32 v67, v68, v67, vcc
s_mov_b32 s42, 58835169
v_mul_hi_u32 v68, v67, s42
v_mul_u32_u24 v66, 73, v68
v_sub_u32 v66, v67, v66
v_mul_u32_u24 v66, 2688, v66
s_mov_b32 s42, 1373568
v_mul_lo_u32 v68, v68, s42
s_mul_i32 s42, s32, 96
v_add3_u32 v66, v66, v68, s42
v_cmp_gt_u32 vcc, s34, v67
v_mov_b32 v68, 1879048192
s_nop 0
v_cndmask_b32 v66, v68, v66, vcc
v_lshl_add_u32 v66, v62, 3, v66
v_add_u32 v66, 785664, v66
v_mov_b32_dpp v69, v194 row_newbcast:0 row_mask:0xf bank_mask:0xf
v_add_u32 v69, 17248, v69
v_mov_b32_dpp v70, v197 row_newbcast:0 row_mask:0xf bank_mask:0xf
v_add_u32 v70, 17248, v70
v_mov_b32_dpp v71, v200 row_newbcast:0 row_mask:0xf bank_mask:0xf
v_add_u32 v71, 17248, v71
ds_read_b128 v[174:177], v217
ds_read_b128 v[84:87], v71
s_waitcnt lgkmcnt(0)
v_mfma_f32_16x16x32_bf16 v[48:51], v[174:177], v[84:87], 0
ds_read_b128 v[178:181], v217 offset:528
ds_read_b128 v[92:95], v69
ds_read_b128 v[96:99], v69 offset:16
s_waitcnt lgkmcnt(0)
s_nop 0
v_smfmac_f32_16x16x64_bf16 v[48:51], v[178:181], v[92:99], v213
ds_read_b128 v[174:177], v217 offset:1056
ds_read_b128 v[100:103], v70
ds_read_b128 v[104:107], v70 offset:16
s_waitcnt lgkmcnt(0)
v_smfmac_f32_16x16x64_bf16 v[48:51], v[174:177], v[100:107], v213
ds_read_b128 v[178:181], v217 offset:1584
ds_read_b128 v[84:87], v71 offset:32
s_waitcnt lgkmcnt(0)
v_mfma_f32_16x16x32_bf16 v[52:55], v[178:181], v[84:87], 0
ds_read_b128 v[174:177], v217 offset:2112
ds_read_b128 v[92:95], v69 offset:32
ds_read_b128 v[96:99], v69 offset:48
s_waitcnt lgkmcnt(0)
s_nop 0
v_smfmac_f32_16x16x64_bf16 v[52:55], v[174:177], v[92:99], v213
ds_read_b128 v[178:181], v217 offset:2640
ds_read_b128 v[100:103], v70 offset:32
ds_read_b128 v[104:107], v70 offset:48
s_waitcnt lgkmcnt(0)
v_smfmac_f32_16x16x64_bf16 v[52:55], v[178:181], v[100:107], v213
ds_read_b128 v[174:177], v217 offset:3168
ds_read_b128 v[84:87], v71 offset:64
s_waitcnt lgkmcnt(0)
v_mfma_f32_16x16x32_bf16 v[56:59], v[174:177], v[84:87], 0
ds_read_b128 v[178:181], v217 offset:3696
ds_read_b128 v[92:95], v69 offset:64
ds_read_b128 v[96:99], v69 offset:80
s_waitcnt lgkmcnt(0)
s_nop 0
v_smfmac_f32_16x16x64_bf16 v[56:59], v[178:181], v[92:99], v213
ds_read_b128 v[174:177], v217 offset:4224
ds_read_b128 v[100:103], v70 offset:64
ds_read_b128 v[104:107], v70 offset:80
s_waitcnt lgkmcnt(0)
v_smfmac_f32_16x16x64_bf16 v[56:59], v[174:177], v[100:107], v213
v_add_f32 v118, v48, v49
v_mul_f32 v119, v48, v48
v_add_f32 v118, v118, v50
v_fmac_f32 v119, v49, v49
v_add_f32 v118, v118, v51
v_fmac_f32 v119, v50, v50
v_fmac_f32 v119, v51, v51
v_add_f32 v118, v118, v52
v_fmac_f32 v119, v52, v52
v_add_f32 v118, v118, v53
v_fmac_f32 v119, v53, v53
v_add_f32 v118, v118, v54
v_fmac_f32 v119, v54, v54
v_add_f32 v118, v118, v55
v_fmac_f32 v119, v55, v55
v_add_f32 v118, v118, v56
v_fmac_f32 v119, v56, v56
v_add_f32 v118, v118, v57
v_fmac_f32 v119, v57, v57
v_add_f32 v118, v118, v58
v_fmac_f32 v119, v58, v58
v_add_f32 v118, v118, v59
v_fmac_f32 v119, v59, v59
s_nop 1
v_permlane16_swap_b32 v118, v119
v_add_f32 v118, v118, v119
v_mov_b32 v126, v118
s_nop 1
v_permlane32_swap_b32 v118, v126
v_add_f32 v118, v118, v126
ds_write_b32 v209, v118
s_mov_b32 s38, s36
s_waitcnt lgkmcnt(0)
s_barrier
ds_read_b128 v[102:105], v210 offset:18432
ds_read_b128 v[106:109], v210 offset:19456
s_waitcnt lgkmcnt(1)
v_add_f32 v102, v102, v103
s_waitcnt lgkmcnt(0)
v_add_f32 v106, v106, v107
v_add_f32 v104, v104, v105
v_add_f32 v108, v108, v109
v_add_f32 v102, v102, v104
v_add_f32 v106, v106, v108
v_mul_f32 v103, s48, v102
v_mul_f32 v104, s73, v102
v_mul_f32 v106, s73, v106
v_fma_f32 v106, -v103, v104, v106
v_max_f32 v106, 0, v106
v_add_f32 v106, s49, v106
v_rsq_f32 v102, v106
s_nop 0
v_mul_f32_e64 v103, -v103, v102
ds_write_b64 v211, v[102:103] offset:20480
ds_read_b64 v[118:119], v219 offset:20480
s_waitcnt lgkmcnt(0)
v_fma_f32 v220, v48, v118, v119
v_fma_f32 v221, v49, v118, v119
v_cvt_pk_bf16_f32 v90, v220, v221
v_fma_f32 v222, v50, v118, v119
v_fma_f32 v223, v51, v118, v119
v_cvt_pk_bf16_f32 v91, v222, v223
v_fma_f32 v220, v52, v118, v119
v_fma_f32 v221, v53, v118, v119
v_cvt_pk_bf16_f32 v92, v220, v221
v_fma_f32 v222, v54, v118, v119
v_fma_f32 v223, v55, v118, v119
v_cvt_pk_bf16_f32 v93, v222, v223
ds_write_b128 v211, v[90:93] offset:20480
v_fma_f32 v220, v56, v118, v119
v_fma_f32 v221, v57, v118, v119
v_cvt_pk_bf16_f32 v94, v220, v221
v_fma_f32 v222, v58, v118, v119
v_fma_f32 v223, v59, v118, v119
v_cvt_pk_bf16_f32 v95, v222, v223
ds_write_b64 v212, v[94:95] offset:20480
s_mov_b64 exec, s[56:57]
ds_read_b128 v[48:51], v64 offset:12544
s_mov_b64 exec, -1
s_mov_b64 exec, s[56:57]
ds_read_b128 v[52:55], v64 offset:12608
s_mov_b64 exec, -1
s_mov_b64 exec, s[56:57]
ds_read_b128 v[56:59], v64 offset:12672
s_mov_b64 exec, -1
s_waitcnt lgkmcnt(3)
s_barrier
ds_read_b128 v[84:87], v63
ds_read_b128 v[88:91], v63 offset:128
ds_read_b128 v[92:95], v63 offset:256
ds_read_b128 v[96:99], v63 offset:384
ds_read_b64 v[100:101], v63 offset:16
ds_read_b64 v[102:103], v63 offset:144
ds_read_b64 v[104:105], v63 offset:272
ds_read_b64 v[106:107], v63 offset:400
s_waitcnt lgkmcnt(7)
v_mfma_f32_16x16x32_bf16 v[36:39], a[144:147], v[84:87], v[36:39]
s_waitcnt lgkmcnt(6)
v_mfma_f32_16x16x32_bf16 v[36:39], a[148:151], v[88:91], v[36:39]
s_waitcnt lgkmcnt(5)
v_mfma_f32_16x16x32_bf16 v[36:39], a[152:155], v[92:95], v[36:39]
s_waitcnt lgkmcnt(4)
v_mfma_f32_16x16x32_bf16 v[36:39], a[156:159], v[96:99], v[36:39]
s_waitcnt lgkmcnt(2)
v_mfma_f32_16x16x32_bf16 v[36:39], a[160:163], v[100:103], v[36:39]
s_waitcnt lgkmcnt(0)
v_mfma_f32_16x16x32_bf16 v[36:39], a[164:167], v[104:107], v[36:39]
s_nop 7
v_cvt_pk_bf16_f32 v36, v36, v37
v_cvt_pk_bf16_f32 v37, v38, v39
buffer_store_dwordx2 v[36:37], v65, s[8:11], 0 offen
v_mfma_f32_16x16x32_bf16 v[40:43], a[168:171], v[84:87], v[40:43]
v_mfma_f32_16x16x32_bf16 v[40:43], a[172:175], v[88:91], v[40:43]
v_mfma_f32_16x16x32_bf16 v[40:43], a[176:179], v[92:95], v[40:43]
v_mfma_f32_16x16x32_bf16 v[40:43], a[180:183], v[96:99], v[40:43]
v_mfma_f32_16x16x32_bf16 v[40:43], a[184:187], v[100:103], v[40:43]
v_mfma_f32_16x16x32_bf16 v[40:43], a[188:191], v[104:107], v[40:43]
s_nop 7
v_cvt_pk_bf16_f32 v40, v40, v41
v_cvt_pk_bf16_f32 v41, v42, v43
buffer_store_dwordx2 v[40:41], v65, s[8:11], 0 offen offset:32
v_mfma_f32_16x16x32_bf16 v[44:47], a[192:195], v[84:87], v[44:47]
v_mfma_f32_16x16x32_bf16 v[44:47], a[196:199], v[88:91], v[44:47]
v_mfma_f32_16x16x32_bf16 v[44:47], a[200:203], v[92:95], v[44:47]
v_mfma_f32_16x16x32_bf16 v[44:47], a[204:207], v[96:99], v[44:47]
v_mfma_f32_16x16x32_bf16 v[44:47], a[208:211], v[100:103], v[44:47]
v_mfma_f32_16x16x32_bf16 v[44:47], a[212:215], v[104:107], v[44:47]
s_nop 7
v_cvt_pk_bf16_f32 v44, v44, v45
v_cvt_pk_bf16_f32 v45, v46, v47
buffer_store_dwordx2 v[44:45], v65, s[8:11], 0 offen offset:64
ds_read_b128 v[182:185], v210
s_waitcnt lgkmcnt(0)
v_mfma_f32_16x16x32_bf16 v[138:141], a[0:3], v[182:185], 0
v_mfma_f32_16x16x32_bf16 v[142:145], a[24:27], v[182:185], 0
v_mfma_f32_16x16x32_bf16 v[146:149], a[48:51], v[182:185], 0
v_mfma_f32_16x16x32_bf16 v[150:153], a[216:219], v[182:185], 0
v_mfma_f32_16x16x32_bf16 v[154:157], a[240:243], v[182:185], 0
v_mfma_f32_16x16x32_bf16 v[158:161], v[232:235], v[182:185], 0
v_mfma_f32_16x16x32_bf16 v[162:165], v[182:185], a[72:75], 0
v_mfma_f32_16x16x32_bf16 v[166:169], v[182:185], a[96:99], 0
v_mfma_f32_16x16x32_bf16 v[170:173], v[182:185], a[120:123], 0
ds_read_b128 v[186:189], v210 offset:1024
s_waitcnt lgkmcnt(0)
v_mfma_f32_16x16x32_bf16 v[138:141], a[4:7], v[186:189], v[138:141]
v_mfma_f32_16x16x32_bf16 v[142:145], a[28:31], v[186:189], v[142:145]
v_mfma_f32_16x16x32_bf16 v[146:149], a[52:55], v[186:189], v[146:149]
v_mfma_f32_16x16x32_bf16 v[150:153], a[220:223], v[186:189], v[150:153]
v_mfma_f32_16x16x32_bf16 v[154:157], a[244:247], v[186:189], v[154:157]
v_mfma_f32_16x16x32_bf16 v[158:161], v[236:239], v[186:189], v[158:161]
v_mfma_f32_16x16x32_bf16 v[162:165], v[186:189], a[76:79], v[162:165]
v_mfma_f32_16x16x32_bf16 v[166:169], v[186:189], a[100:103], v[166:169]
v_mfma_f32_16x16x32_bf16 v[170:173], v[186:189], a[124:127], v[170:173]
ds_read_b128 v[182:185], v210 offset:2048
s_waitcnt lgkmcnt(0)
v_mfma_f32_16x16x32_bf16 v[138:141], a[8:11], v[182:185], v[138:141]
v_mfma_f32_16x16x32_bf16 v[142:145], a[32:35], v[182:185], v[142:145]
v_mfma_f32_16x16x32_bf16 v[146:149], a[56:59], v[182:185], v[146:149]
v_mfma_f32_16x16x32_bf16 v[150:153], a[224:227], v[182:185], v[150:153]
v_mfma_f32_16x16x32_bf16 v[154:157], a[248:251], v[182:185], v[154:157]
v_mfma_f32_16x16x32_bf16 v[158:161], v[240:243], v[182:185], v[158:161]
v_mfma_f32_16x16x32_bf16 v[162:165], v[182:185], a[80:83], v[162:165]
v_mfma_f32_16x16x32_bf16 v[166:169], v[182:185], a[104:107], v[166:169]
v_mfma_f32_16x16x32_bf16 v[170:173], v[182:185], a[128:131], v[170:173]
ds_read_b128 v[186:189], v210 offset:3072
s_waitcnt lgkmcnt(0)
v_mfma_f32_16x16x32_bf16 v[138:141], a[12:15], v[186:189], v[138:141]
v_mfma_f32_16x16x32_bf16 v[142:145], a[36:39], v[186:189], v[142:145]
v_mfma_f32_16x16x32_bf16 v[146:149], a[60:63], v[186:189], v[146:149]
v_mfma_f32_16x16x32_bf16 v[150:153], a[228:231], v[186:189], v[150:153]
v_mfma_f32_16x16x32_bf16 v[154:157], a[252:255], v[186:189], v[154:157]
v_mfma_f32_16x16x32_bf16 v[158:161], v[244:247], v[186:189], v[158:161]
v_mfma_f32_16x16x32_bf16 v[162:165], v[186:189], a[84:87], v[162:165]
v_mfma_f32_16x16x32_bf16 v[166:169], v[186:189], a[108:111], v[166:169]
v_mfma_f32_16x16x32_bf16 v[170:173], v[186:189], a[132:135], v[170:173]
ds_read_b128 v[182:185], v210 offset:4096
s_waitcnt lgkmcnt(0)
v_mfma_f32_16x16x32_bf16 v[138:141], a[16:19], v[182:185], v[138:141]
v_mfma_f32_16x16x32_bf16 v[142:145], a[40:43], v[182:185], v[142:145]
v_mfma_f32_16x16x32_bf16 v[146:149], a[64:67], v[182:185], v[146:149]
v_mfma_f32_16x16x32_bf16 v[150:153], a[232:235], v[182:185], v[150:153]
v_mfma_f32_16x16x32_bf16 v[154:157], v[224:227], v[182:185], v[154:157]
v_mfma_f32_16x16x32_bf16 v[158:161], v[248:251], v[182:185], v[158:161]
v_mfma_f32_16x16x32_bf16 v[162:165], v[182:185], a[88:91], v[162:165]
v_mfma_f32_16x16x32_bf16 v[166:169], v[182:185], a[112:115], v[166:169]
v_mfma_f32_16x16x32_bf16 v[170:173], v[182:185], a[136:139], v[170:173]
ds_read_b128 v[186:189], v210 offset:5120
s_waitcnt lgkmcnt(0)
v_mfma_f32_16x16x32_bf16 v[138:141], a[20:23], v[186:189], v[138:141]
v_mfma_f32_16x16x32_bf16 v[142:145], a[44:47], v[186:189], v[142:145]
v_mfma_f32_16x16x32_bf16 v[146:149], a[68:71], v[186:189], v[146:149]
v_mfma_f32_16x16x32_bf16 v[150:153], a[236:239], v[186:189], v[150:153]
v_mfma_f32_16x16x32_bf16 v[154:157], v[228:231], v[186:189], v[154:157]
v_mfma_f32_16x16x32_bf16 v[158:161], v[252:255], v[186:189], v[158:161]
v_mfma_f32_16x16x32_bf16 v[162:165], v[186:189], a[92:95], v[162:165]
v_mfma_f32_16x16x32_bf16 v[166:169], v[186:189], a[116:119], v[166:169]
v_mfma_f32_16x16x32_bf16 v[170:173], v[186:189], a[140:143], v[170:173]
v_cvt_pk_bf16_f32 v78, v138, v139
v_cvt_pk_bf16_f32 v79, v140, v141
v_cvt_pk_bf16_f32 v80, v142, v143
v_cvt_pk_bf16_f32 v81, v144, v145
v_cvt_pk_bf16_f32 v82, v146, v147
v_cvt_pk_bf16_f32 v83, v148, v149
v_cvt_pk_bf16_f32 v72, v150, v151
v_cvt_pk_bf16_f32 v73, v152, v153
v_cvt_pk_bf16_f32 v74, v154, v155
v_cvt_pk_bf16_f32 v75, v156, v157
v_cvt_pk_bf16_f32 v76, v158, v159
v_cvt_pk_bf16_f32 v77, v160, v161
v_cvt_pk_bf16_f32 v114, v162, v163
v_cvt_pk_bf16_f32 v115, v164, v165
v_cvt_pk_bf16_f32 v122, v166, v167
v_cvt_pk_bf16_f32 v123, v168, v169
v_cvt_pk_bf16_f32 v130, v170, v171
v_cvt_pk_bf16_f32 v131, v172, v173
ds_read_b128 v[182:185], v210 offset:6144
s_waitcnt lgkmcnt(0)
v_mfma_f32_16x16x32_bf16 v[138:141], a[0:3], v[182:185], 0
v_mfma_f32_16x16x32_bf16 v[142:145], a[24:27], v[182:185], 0
v_mfma_f32_16x16x32_bf16 v[146:149], a[48:51], v[182:185], 0
v_mfma_f32_16x16x32_bf16 v[150:153], a[216:219], v[182:185], 0
v_mfma_f32_16x16x32_bf16 v[154:157], a[240:243], v[182:185], 0
v_mfma_f32_16x16x32_bf16 v[158:161], v[232:235], v[182:185], 0
v_mfma_f32_16x16x32_bf16 v[162:165], v[182:185], a[72:75], 0
v_mfma_f32_16x16x32_bf16 v[166:169], v[182:185], a[96:99], 0
v_mfma_f32_16x16x32_bf16 v[170:173], v[182:185], a[120:123], 0
ds_read_b128 v[186:189], v210 offset:7168
s_waitcnt lgkmcnt(0)
v_mfma_f32_16x16x32_bf16 v[138:141], a[4:7], v[186:189], v[138:141]
v_mfma_f32_16x16x32_bf16 v[142:145], a[28:31], v[186:189], v[142:145]
v_mfma_f32_16x16x32_bf16 v[146:149], a[52:55], v[186:189], v[146:149]
v_mfma_f32_16x16x32_bf16 v[150:153], a[220:223], v[186:189], v[150:153]
v_mfma_f32_16x16x32_bf16 v[154:157], a[244:247], v[186:189], v[154:157]
v_mfma_f32_16x16x32_bf16 v[158:161], v[236:239], v[186:189], v[158:161]
v_mfma_f32_16x16x32_bf16 v[162:165], v[186:189], a[76:79], v[162:165]
v_mfma_f32_16x16x32_bf16 v[166:169], v[186:189], a[100:103], v[166:169]
v_mfma_f32_16x16x32_bf16 v[170:173], v[186:189], a[124:127], v[170:173]
ds_read_b128 v[182:185], v210 offset:8192
s_waitcnt lgkmcnt(0)
v_mfma_f32_16x16x32_bf16 v[138:141], a[8:11], v[182:185], v[138:141]
v_mfma_f32_16x16x32_bf16 v[142:145], a[32:35], v[182:185], v[142:145]
v_mfma_f32_16x16x32_bf16 v[146:149], a[56:59], v[182:185], v[146:149]
v_mfma_f32_16x16x32_bf16 v[150:153], a[224:227], v[182:185], v[150:153]
v_mfma_f32_16x16x32_bf16 v[154:157], a[248:251], v[182:185], v[154:157]
v_mfma_f32_16x16x32_bf16 v[158:161], v[240:243], v[182:185], v[158:161]
v_mfma_f32_16x16x32_bf16 v[162:165], v[182:185], a[80:83], v[162:165]
v_mfma_f32_16x16x32_bf16 v[166:169], v[182:185], a[104:107], v[166:169]
v_mfma_f32_16x16x32_bf16 v[170:173], v[182:185], a[128:131], v[170:173]
ds_read_b128 v[186:189], v210 offset:9216
s_waitcnt lgkmcnt(0)
v_mfma_f32_16x16x32_bf16 v[138:141], a[12:15], v[186:189], v[138:141]
v_mfma_f32_16x16x32_bf16 v[142:145], a[36:39], v[186:189], v[142:145]
v_mfma_f32_16x16x32_bf16 v[146:149], a[60:63], v[186:189], v[146:149]
v_mfma_f32_16x16x32_bf16 v[150:153], a[228:231], v[186:189], v[150:153]
v_mfma_f32_16x16x32_bf16 v[154:157], a[252:255], v[186:189], v[154:157]
v_mfma_f32_16x16x32_bf16 v[158:161], v[244:247], v[186:189], v[158:161]
v_mfma_f32_16x16x32_bf16 v[162:165], v[186:189], a[84:87], v[162:165]
v_mfma_f32_16x16x32_bf16 v[166:169], v[186:189], a[108:111], v[166:169]
v_mfma_f32_16x16x32_bf16 v[170:173], v[186:189], a[132:135], v[170:173]
ds_read_b128 v[182:185], v210 offset:10240
s_waitcnt lgkmcnt(0)
v_mfma_f32_16x16x32_bf16 v[138:141], a[16:19], v[182:185], v[138:141]
v_mfma_f32_16x16x32_bf16 v[142:145], a[40:43], v[182:185], v[142:145]
v_mfma_f32_16x16x32_bf16 v[146:149], a[64:67], v[182:185], v[146:149]
v_mfma_f32_16x16x32_bf16 v[150:153], a[232:235], v[182:185], v[150:153]
v_mfma_f32_16x16x32_bf16 v[154:157], v[224:227], v[182:185], v[154:157]
v_mfma_f32_16x16x32_bf16 v[158:161], v[248:251], v[182:185], v[158:161]
v_mfma_f32_16x16x32_bf16 v[162:165], v[182:185], a[88:91], v[162:165]
v_mfma_f32_16x16x32_bf16 v[166:169], v[182:185], a[112:115], v[166:169]
v_mfma_f32_16x16x32_bf16 v[170:173], v[182:185], a[136:139], v[170:173]
ds_read_b128 v[186:189], v210 offset:11264
s_waitcnt lgkmcnt(0)
v_mfma_f32_16x16x32_bf16 v[138:141], a[20:23], v[186:189], v[138:141]
v_mfma_f32_16x16x32_bf16 v[142:145], a[44:47], v[186:189], v[142:145]
v_mfma_f32_16x16x32_bf16 v[146:149], a[68:71], v[186:189], v[146:149]
v_mfma_f32_16x16x32_bf16 v[150:153], a[236:239], v[186:189], v[150:153]
v_mfma_f32_16x16x32_bf16 v[154:157], v[228:231], v[186:189], v[154:157]
v_mfma_f32_16x16x32_bf16 v[158:161], v[252:255], v[186:189], v[158:161]
v_mfma_f32_16x16x32_bf16 v[162:165], v[186:189], a[92:95], v[162:165]
v_mfma_f32_16x16x32_bf16 v[166:169], v[186:189], a[116:119], v[166:169]
v_mfma_f32_16x16x32_bf16 v[170:173], v[186:189], a[140:143], v[170:173]
v_cvt_pk_bf16_f32 v96, v138, v139
v_cvt_pk_bf16_f32 v97, v140, v141
v_cvt_pk_bf16_f32 v98, v142, v143
v_cvt_pk_bf16_f32 v99, v144, v145
v_cvt_pk_bf16_f32 v100, v146, v147
v_cvt_pk_bf16_f32 v101, v148, v149
v_cvt_pk_bf16_f32 v84, v150, v151
v_cvt_pk_bf16_f32 v85, v152, v153
v_cvt_pk_bf16_f32 v86, v154, v155
v_cvt_pk_bf16_f32 v87, v156, v157
v_cvt_pk_bf16_f32 v88, v158, v159
v_cvt_pk_bf16_f32 v89, v160, v161
v_cvt_pk_bf16_f32 v116, v162, v163
v_cvt_pk_bf16_f32 v117, v164, v165
v_cvt_pk_bf16_f32 v124, v166, v167
v_cvt_pk_bf16_f32 v125, v168, v169
v_cvt_pk_bf16_f32 v132, v170, v171
v_cvt_pk_bf16_f32 v133, v172, v173
ds_read_b128 v[182:185], v210 offset:20480
s_waitcnt lgkmcnt(0)
v_mfma_f32_16x16x32_bf16 v[138:141], a[216:219], v[182:185], 0
v_mfma_f32_16x16x32_bf16 v[142:145], a[240:243], v[182:185], 0
v_mfma_f32_16x16x32_bf16 v[146:149], v[232:235], v[182:185], 0
v_mfma_f32_16x16x32_bf16 v[150:153], a[0:3], v[182:185], 0
v_mfma_f32_16x16x32_bf16 v[154:157], a[24:27], v[182:185], 0
v_mfma_f32_16x16x32_bf16 v[158:161], a[48:51], v[182:185], 0
v_mfma_f32_16x16x32_bf16 v[162:165], a[72:75], v[182:185], 0
v_mfma_f32_16x16x32_bf16 v[166:169], a[96:99], v[182:185], 0
v_mfma_f32_16x16x32_bf16 v[170:173], a[120:123], v[182:185], 0
ds_read_b128 v[186:189], v210 offset:21504
s_waitcnt lgkmcnt(0)
v_mfma_f32_16x16x32_bf16 v[138:141], a[220:223], v[186:189], v[138:141]
v_mfma_f32_16x16x32_bf16 v[142:145], a[244:247], v[186:189], v[142:145]
v_mfma_f32_16x16x32_bf16 v[146:149], v[236:239], v[186:189], v[146:149]
v_mfma_f32_16x16x32_bf16 v[150:153], a[4:7], v[186:189], v[150:153]
v_mfma_f32_16x16x32_bf16 v[154:157], a[28:31], v[186:189], v[154:157]
v_mfma_f32_16x16x32_bf16 v[158:161], a[52:55], v[186:189], v[158:161]
v_mfma_f32_16x16x32_bf16 v[162:165], a[76:79], v[186:189], v[162:165]
v_mfma_f32_16x16x32_bf16 v[166:169], a[100:103], v[186:189], v[166:169]
v_mfma_f32_16x16x32_bf16 v[170:173], a[124:127], v[186:189], v[170:173]
ds_read_b128 v[182:185], v210 offset:22528
s_waitcnt lgkmcnt(0)
v_mfma_f32_16x16x32_bf16 v[138:141], a[224:227], v[182:185], v[138:141]
v_mfma_f32_16x16x32_bf16 v[142:145], a[248:251], v[182:185], v[142:145]
v_mfma_f32_16x16x32_bf16 v[146:149], v[240:243], v[182:185], v[146:149]
v_mfma_f32_16x16x32_bf16 v[150:153], a[8:11], v[182:185], v[150:153]
v_mfma_f32_16x16x32_bf16 v[154:157], a[32:35], v[182:185], v[154:157]
v_mfma_f32_16x16x32_bf16 v[158:161], a[56:59], v[182:185], v[158:161]
v_mfma_f32_16x16x32_bf16 v[162:165], a[80:83], v[182:185], v[162:165]
v_mfma_f32_16x16x32_bf16 v[166:169], a[104:107], v[182:185], v[166:169]
v_mfma_f32_16x16x32_bf16 v[170:173], a[128:131], v[182:185], v[170:173]
ds_read_b128 v[186:189], v210 offset:23552
s_waitcnt lgkmcnt(0)
v_mfma_f32_16x16x32_bf16 v[138:141], a[228:231], v[186:189], v[138:141]
v_mfma_f32_16x16x32_bf16 v[142:145], a[252:255], v[186:189], v[142:145]
v_mfma_f32_16x16x32_bf16 v[146:149], v[244:247], v[186:189], v[146:149]
v_mfma_f32_16x16x32_bf16 v[150:153], a[12:15], v[186:189], v[150:153]
v_mfma_f32_16x16x32_bf16 v[154:157], a[36:39], v[186:189], v[154:157]
v_mfma_f32_16x16x32_bf16 v[158:161], a[60:63], v[186:189], v[158:161]
v_mfma_f32_16x16x32_bf16 v[162:165], a[84:87], v[186:189], v[162:165]
v_mfma_f32_16x16x32_bf16 v[166:169], a[108:111], v[186:189], v[166:169]
v_mfma_f32_16x16x32_bf16 v[170:173], a[132:135], v[186:189], v[170:173]
ds_read_b128 v[182:185], v210 offset:24576
s_waitcnt lgkmcnt(0)
v_mfma_f32_16x16x32_bf16 v[138:141], a[232:235], v[182:185], v[138:141]
v_mfma_f32_16x16x32_bf16 v[142:145], v[224:227], v[182:185], v[142:145]
v_mfma_f32_16x16x32_bf16 v[146:149], v[248:251], v[182:185], v[146:149]
v_mfma_f32_16x16x32_bf16 v[150:153], a[16:19], v[182:185], v[150:153]
v_mfma_f32_16x16x32_bf16 v[154:157], a[40:43], v[182:185], v[154:157]
v_mfma_f32_16x16x32_bf16 v[158:161], a[64:67], v[182:185], v[158:161]
v_mfma_f32_16x16x32_bf16 v[162:165], a[88:91], v[182:185], v[162:165]
v_mfma_f32_16x16x32_bf16 v[166:169], a[112:115], v[182:185], v[166:169]
v_mfma_f32_16x16x32_bf16 v[170:173], a[136:139], v[182:185], v[170:173]
ds_read_b128 v[186:189], v210 offset:25600
s_waitcnt lgkmcnt(0)
v_mfma_f32_16x16x32_bf16 v[138:141], a[236:239], v[186:189], v[138:141]
v_mfma_f32_16x16x32_bf16 v[142:145], v[228:231], v[186:189], v[142:145]
v_mfma_f32_16x16x32_bf16 v[146:149], v[252:255], v[186:189], v[146:149]
v_mfma_f32_16x16x32_bf16 v[150:153], a[20:23], v[186:189], v[150:153]
v_mfma_f32_16x16x32_bf16 v[154:157], a[44:47], v[186:189], v[154:157]
v_mfma_f32_16x16x32_bf16 v[158:161], a[68:71], v[186:189], v[158:161]
v_mfma_f32_16x16x32_bf16 v[162:165], a[92:95], v[186:189], v[162:165]
v_mfma_f32_16x16x32_bf16 v[166:169], a[116:119], v[186:189], v[166:169]
v_mfma_f32_16x16x32_bf16 v[170:173], a[140:143], v[186:189], v[170:173]
s_mov_b32 s30, 65537
s_mov_b32 s31, 65537
v_cvt_pk_bf16_f32 v90, v138, v139
v_cvt_pk_bf16_f32 v91, v140, v141
v_cvt_pk_bf16_f32 v92, v142, v143
v_cvt_pk_bf16_f32 v93, v144, v145
v_cvt_pk_bf16_f32 v94, v146, v147
v_cvt_pk_bf16_f32 v95, v148, v149
s_mov_b64 exec, s[30:31]
ds_write_b128 v215, v[90:93]
s_mov_b64 exec, -1
s_mov_b64 exec, s[30:31]
ds_write_b64 v215, v[94:95] offset:16
s_mov_b64 exec, -1
v_cvt_pk_bf16_f32 v102, v150, v151
v_cvt_pk_bf16_f32 v103, v152, v153
v_cvt_pk_bf16_f32 v104, v154, v155
v_cvt_pk_bf16_f32 v105, v156, v157
v_cvt_pk_bf16_f32 v106, v158, v159
v_cvt_pk_bf16_f32 v107, v160, v161
s_mov_b64 exec, s[30:31]
ds_write_b128 v215, v[102:105] offset:512
s_mov_b64 exec, -1
s_mov_b64 exec, s[30:31]
ds_write_b64 v215, v[106:107] offset:528
s_mov_b64 exec, -1
v_cvt_pk_bf16_f32 v108, v162, v163
v_cvt_pk_bf16_f32 v109, v164, v165
v_cvt_pk_bf16_f32 v110, v166, v167
v_cvt_pk_bf16_f32 v111, v168, v169
v_cvt_pk_bf16_f32 v112, v170, v171
v_cvt_pk_bf16_f32 v113, v172, v173
s_mov_b64 exec, s[30:31]
ds_write_b128 v215, v[108:111] offset:1024
s_mov_b64 exec, -1
s_mov_b64 exec, s[30:31]
ds_write_b64 v215, v[112:113] offset:1040
s_mov_b64 exec, -1
ds_read_b128 v[182:185], v210 offset:12288
s_waitcnt lgkmcnt(0)
v_mfma_f32_16x16x32_bf16 v[138:141], a[0:3], v[182:185], 0
v_mfma_f32_16x16x32_bf16 v[142:145], a[24:27], v[182:185], 0
v_mfma_f32_16x16x32_bf16 v[146:149], a[48:51], v[182:185], 0
ds_read_b128 v[186:189], v210 offset:13312
s_waitcnt lgkmcnt(0)
v_mfma_f32_16x16x32_bf16 v[138:141], a[4:7], v[186:189], v[138:141]
v_mfma_f32_16x16x32_bf16 v[142:145], a[28:31], v[186:189], v[142:145]
v_mfma_f32_16x16x32_bf16 v[146:149], a[52:55], v[186:189], v[146:149]
ds_read_b128 v[182:185], v210 offset:14336
s_waitcnt lgkmcnt(0)
v_mfma_f32_16x16x32_bf16 v[138:141], a[8:11], v[182:185], v[138:141]
v_mfma_f32_16x16x32_bf16 v[142:145], a[32:35], v[182:185], v[142:145]
v_mfma_f32_16x16x32_bf16 v[146:149], a[56:59], v[182:185], v[146:149]
ds_read_b128 v[186:189], v210 offset:15360
s_waitcnt lgkmcnt(0)
v_mfma_f32_16x16x32_bf16 v[138:141], a[12:15], v[186:189], v[138:141]
v_mfma_f32_16x16x32_bf16 v[142:145], a[36:39], v[186:189], v[142:145]
v_mfma_f32_16x16x32_bf16 v[146:149], a[60:63], v[186:189], v[146:149]
ds_read_b128 v[182:185], v210 offset:16384
s_waitcnt lgkmcnt(0)
v_mfma_f32_16x16x32_bf16 v[138:141], a[16:19], v[182:185], v[138:141]
v_mfma_f32_16x16x32_bf16 v[142:145], a[40:43], v[182:185], v[142:145]
v_mfma_f32_16x16x32_bf16 v[146:149], a[64:67], v[182:185], v[146:149]
ds_read_b128 v[186:189], v210 offset:17408
s_waitcnt lgkmcnt(0)
v_mfma_f32_16x16x32_bf16 v[138:141], a[20:23], v[186:189], v[138:141]
v_mfma_f32_16x16x32_bf16 v[142:145], a[44:47], v[186:189], v[142:145]
v_mfma_f32_16x16x32_bf16 v[146:149], a[68:71], v[186:189], v[146:149]
v_cvt_pk_bf16_f32 v102, v138, v139
v_cvt_pk_bf16_f32 v103, v140, v141
s_nop 0
v_cvt_pk_bf16_f32 v104, v142, v143
v_cvt_pk_bf16_f32 v105, v144, v145
s_nop 1
v_cvt_pk_bf16_f32 v106, v146, v147
v_cvt_pk_bf16_f32 v107, v148, v149
ds_read_b128 v[108:111], v215 offset:512
ds_read_b64 v[112:113], v215 offset:528
v_mov_b32 v181, 0
v_mfma_f32_16x16x16_bf16 v[138:141], v[82:83], v[76:77], 0
v_mfma_f32_16x16x16_bf16 v[142:145], v[100:101], v[76:77], 0
s_waitcnt lgkmcnt(0)
v_mfma_f32_16x16x16_bf16 v[150:153], v[112:113], v[76:77], v[206:209]
v_mfma_f32_16x16x16_bf16 v[146:149], v[106:107], v[76:77], 0
v_mfma_f32_16x16x32_bf16 v[138:141], v[78:81], v[72:75], v[138:141]
v_mfma_f32_16x16x32_bf16 v[142:145], v[96:99], v[72:75], v[142:145]
v_mfma_f32_16x16x32_bf16 v[150:153], v[108:111], v[72:75], v[150:153]
v_mfma_f32_16x16x32_bf16 v[146:149], v[102:105], v[72:75], v[146:149]
ds_read_b128 v[72:75], v215
ds_read_b64 v[76:77], v215 offset:16
v_mfma_f32_16x16x16_bf16 v[154:157], v[82:83], v[88:89], 0
v_mfma_f32_16x16x16_bf16 v[158:161], v[100:101], v[88:89], 0
v_mfma_f32_16x16x16_bf16 v[166:169], v[112:113], v[88:89], v[206:209]
v_mfma_f32_16x16x16_bf16 v[162:165], v[106:107], v[88:89], 0
v_mfma_f32_16x16x32_bf16 v[154:157], v[78:81], v[84:87], v[154:157]
v_mfma_f32_16x16x32_bf16 v[158:161], v[96:99], v[84:87], v[158:161]
v_mfma_f32_16x16x32_bf16 v[166:169], v[108:111], v[84:87], v[166:169]
v_mfma_f32_16x16x32_bf16 v[162:165], v[102:105], v[84:87], v[162:165]
ds_read_b128 v[182:185], v210 offset:12288
s_waitcnt lgkmcnt(0)
v_mfma_f32_16x16x32_bf16 v[118:121], v[182:185], a[72:75], 0
v_mfma_f32_16x16x32_bf16 v[126:129], v[182:185], a[96:99], 0
v_mfma_f32_16x16x32_bf16 v[134:137], v[182:185], a[120:123], 0
v_mfma_f32_16x16x32_bf16 v[90:93], a[216:219], v[182:185], 0
v_mfma_f32_16x16x32_bf16 v[170:173], a[240:243], v[182:185], 0
v_mfma_f32_16x16x32_bf16 v[220:223], v[232:235], v[182:185], 0
ds_read_b128 v[186:189], v210 offset:13312
s_waitcnt lgkmcnt(0)
v_mfma_f32_16x16x32_bf16 v[118:121], v[186:189], a[76:79], v[118:121]
v_mfma_f32_16x16x32_bf16 v[126:129], v[186:189], a[100:103], v[126:129]
v_mfma_f32_16x16x32_bf16 v[134:137], v[186:189], a[124:127], v[134:137]
v_mfma_f32_16x16x32_bf16 v[90:93], a[220:223], v[186:189], v[90:93]
v_mfma_f32_16x16x32_bf16 v[170:173], a[244:247], v[186:189], v[170:173]
v_mfma_f32_16x16x32_bf16 v[220:223], v[236:239], v[186:189], v[220:223]
ds_read_b128 v[182:185], v210 offset:14336
s_waitcnt lgkmcnt(0)
v_mfma_f32_16x16x32_bf16 v[118:121], v[182:185], a[80:83], v[118:121]
v_mfma_f32_16x16x32_bf16 v[126:129], v[182:185], a[104:107], v[126:129]
v_mfma_f32_16x16x32_bf16 v[134:137], v[182:185], a[128:131], v[134:137]
v_mfma_f32_16x16x32_bf16 v[90:93], a[224:227], v[182:185], v[90:93]
v_mfma_f32_16x16x32_bf16 v[170:173], a[248:251], v[182:185], v[170:173]
v_mfma_f32_16x16x32_bf16 v[220:223], v[240:243], v[182:185], v[220:223]
ds_read_b128 v[186:189], v210 offset:15360
s_waitcnt lgkmcnt(0)
v_mfma_f32_16x16x32_bf16 v[118:121], v[186:189], a[84:87], v[118:121]
v_mfma_f32_16x16x32_bf16 v[126:129], v[186:189], a[108:111], v[126:129]
v_mfma_f32_16x16x32_bf16 v[134:137], v[186:189], a[132:135], v[134:137]
v_mfma_f32_16x16x32_bf16 v[90:93], a[228:231], v[186:189], v[90:93]
v_mfma_f32_16x16x32_bf16 v[170:173], a[252:255], v[186:189], v[170:173]
v_mfma_f32_16x16x32_bf16 v[220:223], v[244:247], v[186:189], v[220:223]
ds_read_b128 v[182:185], v210 offset:16384
s_waitcnt lgkmcnt(0)
v_mfma_f32_16x16x32_bf16 v[118:121], v[182:185], a[88:91], v[118:121]
v_mfma_f32_16x16x32_bf16 v[126:129], v[182:185], a[112:115], v[126:129]
v_mfma_f32_16x16x32_bf16 v[134:137], v[182:185], a[136:139], v[134:137]
v_mfma_f32_16x16x32_bf16 v[90:93], a[232:235], v[182:185], v[90:93]
v_mfma_f32_16x16x32_bf16 v[170:173], v[224:227], v[182:185], v[170:173]
v_mfma_f32_16x16x32_bf16 v[220:223], v[248:251], v[182:185], v[220:223]
ds_read_b128 v[186:189], v210 offset:17408
s_waitcnt lgkmcnt(0)
v_mfma_f32_16x16x32_bf16 v[118:121], v[186:189], a[92:95], v[118:121]
v_mfma_f32_16x16x32_bf16 v[126:129], v[186:189], a[116:119], v[126:129]
v_mfma_f32_16x16x32_bf16 v[134:137], v[186:189], a[140:143], v[134:137]
v_mfma_f32_16x16x32_bf16 v[90:93], a[236:239], v[186:189], v[90:93]
v_mfma_f32_16x16x32_bf16 v[170:173], v[228:231], v[186:189], v[170:173]
v_mfma_f32_16x16x32_bf16 v[220:223], v[252:255], v[186:189], v[220:223]
v_cvt_pk_bf16_f32 v118, v118, v119
v_cvt_pk_bf16_f32 v119, v120, v121
ds_read_u16 v120, v214 offset:1024
v_mov_b32 v121, 0
v_cvt_pk_bf16_f32 v126, v126, v127
v_cvt_pk_bf16_f32 v127, v128, v129
ds_read_u16 v128, v214 offset:1032
v_mov_b32 v129, 0
v_cvt_pk_bf16_f32 v134, v134, v135
v_cvt_pk_bf16_f32 v135, v136, v137
ds_read_u16 v136, v214 offset:1040
v_mov_b32 v137, 0
v_cvt_pk_bf16_f32 v90, v90, v91
v_cvt_pk_bf16_f32 v91, v92, v93
v_cvt_pk_bf16_f32 v92, v170, v171
v_cvt_pk_bf16_f32 v93, v172, v173
v_cvt_pk_bf16_f32 v94, v220, v221
v_cvt_pk_bf16_f32 v95, v222, v223
v_max3_f32 v151, v138, v139, v140
v_max3_f32 v151, v151, v141, v142
v_max3_f32 v151, v151, v143, v144
v_max3_f32 v151, v151, v145, v146
v_max3_f32 v151, v151, v147, v148
v_max3_f32 v151, v151, v149, v150
v_mov_b32 v152, v151
s_nop 1
v_permlane16_swap_b32 v151, v152
v_max_f32 v151, v151, v152
v_mov_b32 v152, v151
s_nop 1
v_permlane32_swap_b32 v151, v152
v_max_f32 v151, v151, v152
v_sub_f32 v138, v138, v151
v_sub_f32 v139, v139, v151
v_sub_f32 v140, v140, v151
v_sub_f32 v141, v141, v151
v_sub_f32 v142, v142, v151
v_sub_f32 v143, v143, v151
v_sub_f32 v144, v144, v151
v_sub_f32 v145, v145, v151
v_sub_f32 v150, v150, v151
v_sub_f32 v146, v146, v151
v_sub_f32 v147, v147, v151
v_sub_f32 v148, v148, v151
v_sub_f32 v149, v149, v151
v_exp_f32 v138, v138
v_exp_f32 v139, v139
v_exp_f32 v140, v140
v_exp_f32 v141, v141
v_exp_f32 v142, v142
v_exp_f32 v143, v143
v_exp_f32 v144, v144
v_exp_f32 v145, v145
v_exp_f32 v150, v150
v_exp_f32 v146, v146
v_exp_f32 v147, v147
v_exp_f32 v148, v148
v_exp_f32 v149, v149
v_cvt_pk_bf16_f32 v174, v138, v139
v_cvt_pk_bf16_f32 v175, v140, v141
v_cvt_pk_bf16_f32 v176, v142, v143
v_cvt_pk_bf16_f32 v177, v144, v145
v_cvt_pk_bf16_f32 v178, v146, v147
v_cvt_pk_bf16_f32 v179, v148, v149
v_cvt_pk_bf16_f32 v180, v150, 0
v_mfma_f32_16x16x32_bf16 v[150:153], v[190:193], v[174:177], 0
v_mfma_f32_16x16x32_bf16 v[138:141], v[114:117], v[174:177], 0
v_mfma_f32_16x16x32_bf16 v[142:145], v[122:125], v[174:177], 0
v_mfma_f32_16x16x32_bf16 v[146:149], v[130:133], v[174:177], 0
v_mfma_f32_16x16x32_bf16 v[150:153], v[190:193], v[178:181], v[150:153]
s_waitcnt lgkmcnt(2)
v_mfma_f32_16x16x32_bf16 v[138:141], v[118:121], v[178:181], v[138:141]
s_waitcnt lgkmcnt(1)
v_mfma_f32_16x16x32_bf16 v[142:145], v[126:129], v[178:181], v[142:145]
s_waitcnt lgkmcnt(0)
v_mfma_f32_16x16x32_bf16 v[146:149], v[134:137], v[178:181], v[146:149]
v_max3_f32 v167, v154, v155, v156
v_max3_f32 v167, v167, v157, v158
v_max3_f32 v167, v167, v159, v160
v_max3_f32 v167, v167, v161, v162
v_max3_f32 v167, v167, v163, v164
v_max3_f32 v167, v167, v165, v166
v_mov_b32 v168, v167
s_nop 1
v_permlane16_swap_b32 v167, v168
v_max_f32 v167, v167, v168
v_mov_b32 v168, v167
s_nop 1
v_permlane32_swap_b32 v167, v168
v_max_f32 v167, v167, v168
v_sub_f32 v154, v154, v167
v_sub_f32 v155, v155, v167
v_sub_f32 v156, v156, v167
v_sub_f32 v157, v157, v167
v_sub_f32 v158, v158, v167
v_sub_f32 v159, v159, v167
v_sub_f32 v160, v160, v167
v_sub_f32 v161, v161, v167
v_sub_f32 v166, v166, v167
v_sub_f32 v162, v162, v167
v_sub_f32 v163, v163, v167
v_sub_f32 v164, v164, v167
v_sub_f32 v165, v165, v167
v_exp_f32 v154, v154
v_exp_f32 v155, v155
v_exp_f32 v156, v156
v_exp_f32 v157, v157
v_exp_f32 v158, v158
v_exp_f32 v159, v159
v_exp_f32 v160, v160
v_exp_f32 v161, v161
v_exp_f32 v166, v166
v_exp_f32 v162, v162
v_exp_f32 v163, v163
v_exp_f32 v164, v164
v_exp_f32 v165, v165
v_cvt_pk_bf16_f32 v174, v154, v155
v_cvt_pk_bf16_f32 v175, v156, v157
v_cvt_pk_bf16_f32 v176, v158, v159
v_cvt_pk_bf16_f32 v177, v160, v161
v_cvt_pk_bf16_f32 v178, v162, v163
v_cvt_pk_bf16_f32 v179, v164, v165
v_cvt_pk_bf16_f32 v180, v166, 0
v_mfma_f32_16x16x32_bf16 v[166:169], v[190:193], v[174:177], 0
v_mfma_f32_16x16x32_bf16 v[154:157], v[114:117], v[174:177], 0
v_mfma_f32_16x16x32_bf16 v[158:161], v[122:125], v[174:177], 0
v_mfma_f32_16x16x32_bf16 v[162:165], v[130:133], v[174:177], 0
v_mfma_f32_16x16x32_bf16 v[166:169], v[190:193], v[178:181], v[166:169]
v_mfma_f32_16x16x32_bf16 v[154:157], v[118:121], v[178:181], v[154:157]
v_mfma_f32_16x16x32_bf16 v[158:161], v[126:129], v[178:181], v[158:161]
v_mfma_f32_16x16x32_bf16 v[162:165], v[134:137], v[178:181], v[162:165]
v_rcp_f32 v151, v150
s_nop 0
v_mul_f32 v151, s3, v151
v_mul_f32 v138, v138, v151
v_mul_f32 v139, v139, v151
v_cvt_pk_bf16_f32 v138, v138, v139
v_mul_f32 v140, v140, v151
v_mul_f32 v141, v141, v151
v_cvt_pk_bf16_f32 v139, v140, v141
v_mul_f32 v142, v142, v151
v_mul_f32 v143, v143, v151
v_cvt_pk_bf16_f32 v140, v142, v143
v_mul_f32 v144, v144, v151
v_mul_f32 v145, v145, v151
v_cvt_pk_bf16_f32 v141, v144, v145
ds_write_b128 v211, v[138:141] offset:38912
v_mul_f32 v146, v146, v151
v_mul_f32 v147, v147, v151
v_cvt_pk_bf16_f32 v142, v146, v147
v_mul_f32 v148, v148, v151
v_mul_f32 v149, v149, v151
v_cvt_pk_bf16_f32 v143, v148, v149
ds_write_b64 v212, v[142:143] offset:38912
v_mfma_f32_16x16x32_bf16 v[138:141], v[78:81], v[90:93], 0
v_mfma_f32_16x16x32_bf16 v[142:145], v[96:99], v[90:93], 0
v_mfma_f32_16x16x32_bf16 v[150:153], v[108:111], v[90:93], v[206:209]
v_mfma_f32_16x16x32_bf16 v[146:149], v[102:105], v[90:93], 0
v_mfma_f32_16x16x16_bf16 v[138:141], v[82:83], v[94:95], v[138:141]
v_mfma_f32_16x16x16_bf16 v[142:145], v[100:101], v[94:95], v[142:145]
v_mfma_f32_16x16x16_bf16 v[150:153], v[112:113], v[94:95], v[150:153]
v_mfma_f32_16x16x16_bf16 v[146:149], v[106:107], v[94:95], v[146:149]
v_rcp_f32 v167, v166
s_nop 0
v_mul_f32 v167, s3, v167
v_mul_f32 v154, v154, v167
v_mul_f32 v155, v155, v167
v_cvt_pk_bf16_f32 v154, v154, v155
v_mul_f32 v156, v156, v167
v_mul_f32 v157, v157, v167
v_cvt_pk_bf16_f32 v155, v156, v157
v_mul_f32 v158, v158, v167
v_mul_f32 v159, v159, v167
v_cvt_pk_bf16_f32 v156, v158, v159
v_mul_f32 v160, v160, v167
v_mul_f32 v161, v161, v167
v_cvt_pk_bf16_f32 v157, v160, v161
ds_write_b128 v211, v[154:157] offset:45056
v_mul_f32 v162, v162, v167
v_mul_f32 v163, v163, v167
v_cvt_pk_bf16_f32 v158, v162, v163
v_mul_f32 v164, v164, v167
v_mul_f32 v165, v165, v167
v_cvt_pk_bf16_f32 v159, v164, v165
ds_write_b64 v212, v[158:159] offset:45056
v_mfma_f32_16x16x16_bf16 v[154:157], v[76:77], v[82:83], 0
v_mfma_f32_16x16x16_bf16 v[158:161], v[76:77], v[100:101], 0
v_mfma_f32_16x16x16_bf16 v[162:165], v[76:77], v[106:107], 0
v_mfma_f32_16x16x16_bf16 v[166:169], v[76:77], v[112:113], v[206:209]
v_mfma_f32_16x16x32_bf16 v[154:157], v[72:75], v[78:81], v[154:157]
v_mfma_f32_16x16x32_bf16 v[158:161], v[72:75], v[96:99], v[158:161]
v_mfma_f32_16x16x32_bf16 v[162:165], v[72:75], v[102:105], v[162:165]
v_mfma_f32_16x16x32_bf16 v[166:169], v[72:75], v[108:111], v[166:169]
v_mov_b32_dpp v154, v158 quad_perm:[0,1,2,3] row_mask:0x2 bank_mask:0xf
s_nop 1
v_mov_b32_dpp v154, v162 quad_perm:[0,1,2,3] row_mask:0x4 bank_mask:0xf
s_nop 2
v_mov_b32_dpp v154, v167 quad_perm:[0,1,2,3] row_mask:0x8 bank_mask:0xf
v_mov_b32 v155, v154
s_nop 1
v_max_f32_dpp v155, v155, v155 row_ror:8 row_mask:0xf bank_mask:0xf
s_nop 1
v_max_f32_dpp v155, v155, v155 row_ror:4 row_mask:0xf bank_mask:0xf
s_nop 1
v_max_f32_dpp v155, v155, v155 row_ror:2 row_mask:0xf bank_mask:0xf
s_nop 1
v_max_f32_dpp v155, v155, v155 row_ror:1 row_mask:0xf bank_mask:0xf
v_mov_b32 v156, v155
s_nop 1
v_permlane16_swap_b32 v155, v156
v_max_f32 v155, v155, v156
v_mov_b32 v156, v155
s_nop 1
v_permlane32_swap_b32 v155, v156
v_max_f32 v155, v155, v156
v_sub_f32 v154, v154, v155
v_exp_f32 v154, v154
s_nop 0
v_cvt_pk_bf16_f32 v154, v154, 0
ds_write_b16 v214, v154
s_waitcnt lgkmcnt(1)
ds_read_b128 v[84:87], v215
ds_read_b128 v[88:91], v215 offset:16
v_add_u32 v215, 1552, v215
s_barrier
ds_read_b128 v[170:173], v210 offset:38912
s_waitcnt lgkmcnt(0)
v_mfma_f32_16x16x32_bf16 v[0:3], a[144:147], v[170:173], v[0:3]
v_mfma_f32_16x16x32_bf16 v[4:7], a[168:171], v[170:173], v[4:7]
v_mfma_f32_16x16x32_bf16 v[8:11], a[192:195], v[170:173], v[8:11]
ds_read_b128 v[182:185], v210 offset:39936
s_waitcnt lgkmcnt(0)
v_mfma_f32_16x16x32_bf16 v[0:3], a[148:151], v[182:185], v[0:3]
v_mfma_f32_16x16x32_bf16 v[4:7], a[172:175], v[182:185], v[4:7]
v_mfma_f32_16x16x32_bf16 v[8:11], a[196:199], v[182:185], v[8:11]
ds_read_b128 v[186:189], v210 offset:40960
s_waitcnt lgkmcnt(0)
v_mfma_f32_16x16x32_bf16 v[0:3], a[152:155], v[186:189], v[0:3]
v_mfma_f32_16x16x32_bf16 v[4:7], a[176:179], v[186:189], v[4:7]
v_mfma_f32_16x16x32_bf16 v[8:11], a[200:203], v[186:189], v[8:11]
ds_read_b128 v[170:173], v210 offset:41984
s_waitcnt lgkmcnt(0)
v_mfma_f32_16x16x32_bf16 v[0:3], a[156:159], v[170:173], v[0:3]
v_mfma_f32_16x16x32_bf16 v[4:7], a[180:183], v[170:173], v[4:7]
v_mfma_f32_16x16x32_bf16 v[8:11], a[204:207], v[170:173], v[8:11]
ds_read_b128 v[182:185], v210 offset:43008
s_waitcnt lgkmcnt(0)
v_mfma_f32_16x16x32_bf16 v[0:3], a[160:163], v[182:185], v[0:3]
v_mfma_f32_16x16x32_bf16 v[4:7], a[184:187], v[182:185], v[4:7]
v_mfma_f32_16x16x32_bf16 v[8:11], a[208:211], v[182:185], v[8:11]
ds_read_b128 v[186:189], v210 offset:44032
s_waitcnt lgkmcnt(0)
v_mfma_f32_16x16x32_bf16 v[0:3], a[164:167], v[186:189], v[0:3]
v_mfma_f32_16x16x32_bf16 v[4:7], a[188:191], v[186:189], v[4:7]
v_mfma_f32_16x16x32_bf16 v[8:11], a[212:215], v[186:189], v[8:11]
v_cvt_pk_bf16_f32 v72, v0, v1
v_cvt_pk_bf16_f32 v73, v2, v3
buffer_store_dwordx2 v[72:73], v203, s[8:11], s38 offen
v_cvt_pk_bf16_f32 v74, v4, v5
v_cvt_pk_bf16_f32 v75, v6, v7
buffer_store_dwordx2 v[74:75], v203, s[8:11], s38 offen offset:32
s_nop 0
v_cvt_pk_bf16_f32 v76, v8, v9
v_cvt_pk_bf16_f32 v77, v10, v11
buffer_store_dwordx2 v[76:77], v203, s[8:11], s38 offen offset:64
v_max3_f32 v151, v138, v139, v140
v_max3_f32 v151, v151, v141, v142
v_max3_f32 v151, v151, v143, v144
v_max3_f32 v151, v151, v145, v146
v_max3_f32 v151, v151, v147, v148
v_max3_f32 v151, v151, v149, v150
v_mov_b32 v152, v151
s_nop 1
v_permlane16_swap_b32 v151, v152
v_max_f32 v151, v151, v152
v_mov_b32 v152, v151
s_nop 1
v_permlane32_swap_b32 v151, v152
v_max_f32 v151, v151, v152
v_sub_f32 v138, v138, v151
v_sub_f32 v139, v139, v151
v_sub_f32 v140, v140, v151
v_sub_f32 v141, v141, v151
v_sub_f32 v142, v142, v151
v_sub_f32 v143, v143, v151
v_sub_f32 v144, v144, v151
v_sub_f32 v145, v145, v151
v_sub_f32 v150, v150, v151
v_sub_f32 v146, v146, v151
v_sub_f32 v147, v147, v151
v_sub_f32 v148, v148, v151
v_sub_f32 v149, v149, v151
v_exp_f32 v138, v138
v_exp_f32 v139, v139
v_exp_f32 v140, v140
v_exp_f32 v141, v141
v_exp_f32 v142, v142
v_exp_f32 v143, v143
v_exp_f32 v144, v144
v_exp_f32 v145, v145
v_exp_f32 v150, v150
v_exp_f32 v146, v146
v_exp_f32 v147, v147
v_exp_f32 v148, v148
v_exp_f32 v149, v149
v_cvt_pk_bf16_f32 v174, v138, v139
v_cvt_pk_bf16_f32 v175, v140, v141
v_cvt_pk_bf16_f32 v176, v142, v143
v_cvt_pk_bf16_f32 v177, v144, v145
v_cvt_pk_bf16_f32 v178, v146, v147
v_cvt_pk_bf16_f32 v179, v148, v149
v_cvt_pk_bf16_f32 v180, v150, 0
v_mfma_f32_16x16x32_bf16 v[150:153], v[190:193], v[174:177], 0
v_mfma_f32_16x16x32_bf16 v[138:141], v[114:117], v[174:177], 0
v_mfma_f32_16x16x32_bf16 v[142:145], v[122:125], v[174:177], 0
v_mfma_f32_16x16x32_bf16 v[146:149], v[130:133], v[174:177], 0
v_mfma_f32_16x16x32_bf16 v[150:153], v[190:193], v[178:181], v[150:153]
v_mfma_f32_16x16x32_bf16 v[138:141], v[118:121], v[178:181], v[138:141]
v_mfma_f32_16x16x32_bf16 v[142:145], v[126:129], v[178:181], v[142:145]
v_mfma_f32_16x16x32_bf16 v[146:149], v[134:137], v[178:181], v[146:149]
v_mfma_f32_16x16x32_bf16 v[166:169], v[84:87], v[190:193], 0
v_mfma_f32_16x16x32_bf16 v[154:157], v[84:87], v[114:117], 0
v_mfma_f32_16x16x32_bf16 v[158:161], v[84:87], v[122:125], 0
v_mfma_f32_16x16x32_bf16 v[162:165], v[84:87], v[130:133], 0
v_mfma_f32_16x16x32_bf16 v[166:169], v[88:91], v[190:193], v[166:169]
v_mfma_f32_16x16x32_bf16 v[154:157], v[88:91], v[118:121], v[154:157]
v_mfma_f32_16x16x32_bf16 v[158:161], v[88:91], v[126:129], v[158:161]
v_mfma_f32_16x16x32_bf16 v[162:165], v[88:91], v[134:137], v[162:165]
v_rcp_f32 v167, v166
s_nop 1
v_mov_b32_dpp v154, v158 quad_perm:[0,1,2,3] row_mask:0x2 bank_mask:0xf
s_nop 2
v_mov_b32_dpp v154, v162 quad_perm:[0,1,2,3] row_mask:0x4 bank_mask:0xf
v_mul_f32 v167, s3, v167
v_mul_f32 v154, v154, v167
v_cvt_pk_bf16_f32 v154, v154, 0
ds_write_b16 v214, v154
v_add_u32 v214, 1552, v214
ds_read_b128 v[170:173], v210 offset:45056
s_waitcnt lgkmcnt(0)
v_mfma_f32_16x16x32_bf16 v[12:15], a[144:147], v[170:173], v[12:15]
v_mfma_f32_16x16x32_bf16 v[16:19], a[168:171], v[170:173], v[16:19]
v_mfma_f32_16x16x32_bf16 v[20:23], a[192:195], v[170:173], v[20:23]
ds_read_b128 v[182:185], v210 offset:46080
s_waitcnt lgkmcnt(0)
v_mfma_f32_16x16x32_bf16 v[12:15], a[148:151], v[182:185], v[12:15]
v_mfma_f32_16x16x32_bf16 v[16:19], a[172:175], v[182:185], v[16:19]
v_mfma_f32_16x16x32_bf16 v[20:23], a[196:199], v[182:185], v[20:23]
ds_read_b128 v[186:189], v210 offset:47104
s_waitcnt lgkmcnt(0)
v_mfma_f32_16x16x32_bf16 v[12:15], a[152:155], v[186:189], v[12:15]
v_mfma_f32_16x16x32_bf16 v[16:19], a[176:179], v[186:189], v[16:19]
v_mfma_f32_16x16x32_bf16 v[20:23], a[200:203], v[186:189], v[20:23]
ds_read_b128 v[170:173], v210 offset:48128
s_waitcnt lgkmcnt(0)
v_mfma_f32_16x16x32_bf16 v[12:15], a[156:159], v[170:173], v[12:15]
v_mfma_f32_16x16x32_bf16 v[16:19], a[180:183], v[170:173], v[16:19]
v_mfma_f32_16x16x32_bf16 v[20:23], a[204:207], v[170:173], v[20:23]
ds_read_b128 v[182:185], v210 offset:49152
s_waitcnt lgkmcnt(0)
v_mfma_f32_16x16x32_bf16 v[12:15], a[160:163], v[182:185], v[12:15]
v_mfma_f32_16x16x32_bf16 v[16:19], a[184:187], v[182:185], v[16:19]
v_mfma_f32_16x16x32_bf16 v[20:23], a[208:211], v[182:185], v[20:23]
ds_read_b128 v[186:189], v210 offset:50176
s_waitcnt lgkmcnt(0)
v_mfma_f32_16x16x32_bf16 v[12:15], a[164:167], v[186:189], v[12:15]
v_mfma_f32_16x16x32_bf16 v[16:19], a[188:191], v[186:189], v[16:19]
v_mfma_f32_16x16x32_bf16 v[20:23], a[212:215], v[186:189], v[20:23]
v_cvt_pk_bf16_f32 v78, v12, v13
v_cvt_pk_bf16_f32 v79, v14, v15
buffer_store_dwordx2 v[78:79], v204, s[8:11], s38 offen
v_cvt_pk_bf16_f32 v80, v16, v17
v_cvt_pk_bf16_f32 v81, v18, v19
buffer_store_dwordx2 v[80:81], v204, s[8:11], s38 offen offset:32
s_nop 0
v_cvt_pk_bf16_f32 v82, v20, v21
v_cvt_pk_bf16_f32 v83, v22, v23
buffer_store_dwordx2 v[82:83], v204, s[8:11], s38 offen offset:64
v_rcp_f32 v151, v150
s_nop 0
v_mul_f32 v151, s3, v151
v_mul_f32 v138, v138, v151
v_mul_f32 v139, v139, v151
v_cvt_pk_bf16_f32 v138, v138, v139
v_mul_f32 v140, v140, v151
v_mul_f32 v141, v141, v151
v_cvt_pk_bf16_f32 v139, v140, v141
v_mul_f32 v142, v142, v151
v_mul_f32 v143, v143, v151
v_cvt_pk_bf16_f32 v140, v142, v143
v_mul_f32 v144, v144, v151
v_mul_f32 v145, v145, v151
v_cvt_pk_bf16_f32 v141, v144, v145
ds_write_b128 v211, v[138:141] offset:51200
v_mul_f32 v146, v146, v151
v_mul_f32 v147, v147, v151
v_cvt_pk_bf16_f32 v142, v146, v147
v_mul_f32 v148, v148, v151
v_mul_f32 v149, v149, v151
v_cvt_pk_bf16_f32 v143, v148, v149
ds_write_b64 v212, v[142:143] offset:51200
v_cmp_lt_u32 vcc, 1602224128, v218
s_nop 0
s_or_b32 s41, vcc_lo, vcc_hi
v_mov_b32 v69, s41
ds_write_b32 v209, v69
s_waitcnt lgkmcnt(0)
s_barrier
ds_read_b128 v[170:173], v210 offset:51200
s_waitcnt lgkmcnt(0)
v_mfma_f32_16x16x32_bf16 v[24:27], a[144:147], v[170:173], v[24:27]
v_mfma_f32_16x16x32_bf16 v[28:31], a[168:171], v[170:173], v[28:31]
v_mfma_f32_16x16x32_bf16 v[32:35], a[192:195], v[170:173], v[32:35]
ds_read_b128 v[182:185], v210 offset:52224
s_waitcnt lgkmcnt(0)
v_mfma_f32_16x16x32_bf16 v[24:27], a[148:151], v[182:185], v[24:27]
v_mfma_f32_16x16x32_bf16 v[28:31], a[172:175], v[182:185], v[28:31]
v_mfma_f32_16x16x32_bf16 v[32:35], a[196:199], v[182:185], v[32:35]
ds_read_b128 v[186:189], v210 offset:53248
s_waitcnt lgkmcnt(0)
v_mfma_f32_16x16x32_bf16 v[24:27], a[152:155], v[186:189], v[24:27]
v_mfma_f32_16x16x32_bf16 v[28:31], a[176:179], v[186:189], v[28:31]
v_mfma_f32_16x16x32_bf16 v[32:35], a[200:203], v[186:189], v[32:35]
ds_read_b128 v[170:173], v210 offset:54272
s_waitcnt lgkmcnt(0)
v_mfma_f32_16x16x32_bf16 v[24:27], a[156:159], v[170:173], v[24:27]
v_mfma_f32_16x16x32_bf16 v[28:31], a[180:183], v[170:173], v[28:31]
v_mfma_f32_16x16x32_bf16 v[32:35], a[204:207], v[170:173], v[32:35]
ds_read_b128 v[182:185], v210 offset:55296
s_waitcnt lgkmcnt(0)
v_mfma_f32_16x16x32_bf16 v[24:27], a[160:163], v[182:185], v[24:27]
v_mfma_f32_16x16x32_bf16 v[28:31], a[184:187], v[182:185], v[28:31]
v_mfma_f32_16x16x32_bf16 v[32:35], a[208:211], v[182:185], v[32:35]
ds_read_b128 v[186:189], v210 offset:56320
s_waitcnt lgkmcnt(0)
v_mfma_f32_16x16x32_bf16 v[24:27], a[164:167], v[186:189], v[24:27]
v_mfma_f32_16x16x32_bf16 v[28:31], a[188:191], v[186:189], v[28:31]
v_mfma_f32_16x16x32_bf16 v[32:35], a[212:215], v[186:189], v[32:35]
v_cvt_pk_bf16_f32 v116, v24, v25
v_cvt_pk_bf16_f32 v117, v26, v27
buffer_store_dwordx2 v[116:117], v205, s[8:11], s38 offen
v_cvt_pk_bf16_f32 v124, v28, v29
v_cvt_pk_bf16_f32 v125, v30, v31
buffer_store_dwordx2 v[124:125], v205, s[8:11], s38 offen offset:32
s_nop 0
v_cvt_pk_bf16_f32 v132, v32, v33
v_cvt_pk_bf16_f32 v133, v34, v35
buffer_store_dwordx2 v[132:133], v205, s[8:11], s38 offen offset:64
ds_read_b128 v[84:87], v63 offset:24832
ds_read_b128 v[88:91], v63 offset:24960
ds_read_b128 v[92:95], v63 offset:25088
ds_read_b128 v[96:99], v63 offset:25216
ds_read_b64 v[100:101], v63 offset:24848
ds_read_b64 v[102:103], v63 offset:24976
ds_read_b64 v[104:105], v63 offset:25104
ds_read_b64 v[106:107], v63 offset:25232
s_waitcnt lgkmcnt(7)
v_mfma_f32_16x16x32_bf16 v[48:51], a[144:147], v[84:87], v[48:51]
s_waitcnt lgkmcnt(6)
v_mfma_f32_16x16x32_bf16 v[48:51], a[148:151], v[88:91], v[48:51]
s_waitcnt lgkmcnt(5)
v_mfma_f32_16x16x32_bf16 v[48:51], a[152:155], v[92:95], v[48:51]
s_waitcnt lgkmcnt(4)
v_mfma_f32_16x16x32_bf16 v[48:51], a[156:159], v[96:99], v[48:51]
s_waitcnt lgkmcnt(2)
v_mfma_f32_16x16x32_bf16 v[48:51], a[160:163], v[100:103], v[48:51]
s_waitcnt lgkmcnt(0)
v_mfma_f32_16x16x32_bf16 v[48:51], a[164:167], v[104:107], v[48:51]
s_nop 7
v_cvt_pk_bf16_f32 v48, v48, v49
v_cvt_pk_bf16_f32 v49, v50, v51
buffer_store_dwordx2 v[48:49], v66, s[8:11], 0 offen
v_mfma_f32_16x16x32_bf16 v[52:55], a[168:171], v[84:87], v[52:55]
v_mfma_f32_16x16x32_bf16 v[52:55], a[172:175], v[88:91], v[52:55]
v_mfma_f32_16x16x32_bf16 v[52:55], a[176:179], v[92:95], v[52:55]
v_mfma_f32_16x16x32_bf16 v[52:55], a[180:183], v[96:99], v[52:55]
v_mfma_f32_16x16x32_bf16 v[52:55], a[184:187], v[100:103], v[52:55]
v_mfma_f32_16x16x32_bf16 v[52:55], a[188:191], v[104:107], v[52:55]
s_nop 7
v_cvt_pk_bf16_f32 v52, v52, v53
v_cvt_pk_bf16_f32 v53, v54, v55
buffer_store_dwordx2 v[52:53], v66, s[8:11], 0 offen offset:32
v_mfma_f32_16x16x32_bf16 v[56:59], a[192:195], v[84:87], v[56:59]
v_mfma_f32_16x16x32_bf16 v[56:59], a[196:199], v[88:91], v[56:59]
v_mfma_f32_16x16x32_bf16 v[56:59], a[200:203], v[92:95], v[56:59]
v_mfma_f32_16x16x32_bf16 v[56:59], a[204:207], v[96:99], v[56:59]
v_mfma_f32_16x16x32_bf16 v[56:59], a[208:211], v[100:103], v[56:59]
v_mfma_f32_16x16x32_bf16 v[56:59], a[212:215], v[104:107], v[56:59]
s_nop 7
v_cvt_pk_bf16_f32 v56, v56, v57
v_cvt_pk_bf16_f32 v57, v58, v59
buffer_store_dwordx2 v[56:57], v66, s[8:11], 0 offen offset:64
ds_read_b128 v[174:177], v210 offset:18432
s_waitcnt lgkmcnt(0)
v_or3_b32 v174, v174, v175, v176
v_or_b32 v174, v174, v177
s_nop 0
v_readfirstlane_b32 s43, v174
s_endpgm
.p2align 6
.type L_tab,@object
L_tab:
.long 0x0,0x3800,0x5500,0x190,0x320,0x2020,0x5820,0x4b0,0x640,0x2340,0x4040,0x7d0,0x960,0x2660,0x6060,0xaf0
.long 0x1010,0x4810,0x6510,0x11a0,0x1330,0x3030,0x6830,0x14c0,0x1650,0x3350,0x5050,0x17e0,0x1970,0x3670,0x5370,0x1b00
.long 0x190,0x3990,0x5690,0x320,0x4b0,0x21b0,0x59b0,0x640,0x7d0,0x24d0,0x41d0,0x960,0x27f0,0x44f0,0x61f0,0x2980
.long 0x2980,0x4680,0x6380,0x2b10,0x11a0,0x49a0,0x66a0,0x1330,0x14c0,0x31c0,0x69c0,0x1650,0x17e0,0x34e0,0x51e0,0x1970
.long 0x320,0x3b20,0x5820,0x1010,0x640,0x2340,0x5b40,0x1330,0x960,0x2660,0x4360,0x1650,0xc80,0x2980,0x6380,0x1970
.long 0x1330,0x4b30,0x6830,0x2020,0x1650,0x3350,0x6b50,0x2340,0x1970,0x3670,0x5370,0x2660,0x1c90,0x3990,0x5690,0x2980
.long 0x4b0,0x3cb0,0x59b0,0x11a0,0x7d0,0x24d0,0x5cd0,0x14c0,0xaf0,0x27f0,0x44f0,0x17e0,0x2b10,0x4810,0x6510,0x3800
.long 0x2ca0,0x49a0,0x66a0,0x3990,0x14c0,0x4cc0,0x69c0,0x21b0,0x17e0,0x34e0,0x6ce0,0x24d0,0x1b00,0x3800,0x5500,0x27f0
.long 0x2020,0x5820,0x7520,0x1330,0x2340,0x4040,0x7840,0x1650,0x2660,0x4360,0x6060,0x1970,0x2980,0x4680,0x8080,0x1c90
.long 0x3030,0x6830,0x8530,0x2340,0x3350,0x5050,0x8850,0x2660,0x3670,0x5370,0x7070,0x2980,0x3990,0x5690,0x7390,0x2ca0
.long 0x21b0,0x59b0,0x76b0,0x14c0,0x24d0,0x41d0,0x79d0,0x17e0,0x27f0,0x44f0,0x61f0,0x1b00,0x4810,0x6510,0x8210,0x3b20
.long 0x49a0,0x66a0,0x83a0,0x3cb0,0x31c0,0x69c0,0x86c0,0x24d0,0x34e0,0x51e0,0x89e0,0x27f0,0x3800,0x5500,0x7200,0x2b10
.long 0x2340,0x5b40,0x7840,0x21b0,0x2660,0x4360,0x7b60,0x24d0,0x2980,0x4680,0x6380,0x27f0,0x2ca0,0x49a0,0x83a0,0x2b10
.long 0x3350,0x6b50,0x8850,0x31c0,0x3670,0x5370,0x8b70,0x34e0,0x3990,0x5690,0x7390,0x3800,0x3cb0,0x59b0,0x76b0,0x3b20
.long 0x24d0,0x5cd0,0x79d0,0x2340,0x27f0,0x44f0,0x7cf0,0x2660,0x2b10,0x4810,0x6510,0x2980,0x4b30,0x6830,0x8530,0x49a0
.long 0x4cc0,0x69c0,0x86c0,0x4b30,0x34e0,0x6ce0,0x89e0,0x3350,0x3800,0x5500,0x8d00,0x3670,0x3b20,0x5820,0x7520,0x3990
.long 0x3990,0x5690,0x11a0,0x49a0,0x21b0,0x59b0,0x14c0,0x31c0,0x24d0,0x41d0,0x17e0,0x34e0,0x27f0,0x61f0,0x1b00,0x3800
.long 0x49a0,0x66a0,0x21b0,0x59b0,0x31c0,0x69c0,0x24d0,0x41d0,0x34e0,0x51e0,0x27f0,0x44f0,0x3800,0x5500,0x2b10,0x4810
.long 0x3b20,0x5820,0x1330,0x4b30,0x2340,0x5b40,0x1650,0x3350,0x2660,0x4360,0x1970,0x3670,0x4680,0x6380,0x3990,0x5690
.long 0x4810,0x6510,0x3b20,0x5820,0x4b30,0x6830,0x2340,0x5b40,0x3350,0x6b50,0x2660,0x4360,0x3670,0x5370,0x2980,0x4680
.long 0x4810,0x6510,0x11a0,0x49a0,0x3030,0x6830,0x14c0,0x31c0,0x3350,0x5050,0x17e0,0x34e0,0x3670,0x7070,0x1b00,0x3800
.long 0x5820,0x7520,0x21b0,0x59b0,0x4040,0x7840,0x24d0,0x41d0,0x4360,0x6060,0x27f0,0x44f0,0x4680,0x6380,0x2b10,0x4810
.long 0x49a0,0x66a0,0x1330,0x4b30,0x31c0,0x69c0,0x1650,0x3350,0x34e0,0x51e0,0x1970,0x3670,0x5500,0x7200,0x3990,0x5690
.long 0x5690,0x7390,0x3b20,0x5820,0x59b0,0x76b0,0x2340,0x5b40,0x41d0,0x79d0,0x2660,0x4360,0x44f0,0x61f0,0x2980,0x4680
.long 0x4b30,0x6830,0x11b0,0x49b0,0x3350,0x6b50,0x14d0,0x31d0,0x3670,0x5370,0x17f0,0x34f0,0x3990,0x7390,0x1b10,0x3810
.long 0x5b40,0x7840,0x21c0,0x59c0,0x4360,0x7b60,0x24e0,0x41e0,0x4680,0x6380,0x2800,0x4500,0x49a0,0x66a0,0x2b20,0x4820
.long 0x4cc0,0x69c0,0x1340,0x4b40,0x34e0,0x6ce0,0x1660,0x3360,0x3800,0x5500,0x1980,0x3680,0x5820,0x7520,0x39a0,0x56a0
.long 0x59b0,0x76b0,0x3b30,0x5830,0x5cd0,0x79d0,0x2350,0x5b50,0x44f0,0x7cf0,0x2670,0x4370,0x4810,0x6510,0x2990,0x4690
.long 0x59b0,0x76b0,0x11b0,0x49b0,0x41d0,0x79d0,0x14d0,0x31d0,0x44f0,0x61f0,0x17f0,0x34f0,0x4810,0x8210,0x1b10,0x3810
.long 0x69c0,0x86c0,0x21c0,0x59c0,0x51e0,0x89e0,0x24e0,0x41e0,0x5500,0x7200,0x2800,0x4500,0x5820,0x7520,0x2b20,0x4820
.long 0x5b40,0x7840,0x1340,0x4b40,0x4360,0x7b60,0x1660,0x3360,0x4680,0x6380,0x1980,0x3680,0x66a0,0x83a0,0x39a0,0x56a0
.long 0x6830,0x8530,0x3b30,0x5830,0x6b50,0x8850,0x2350,0x5b50,0x5370,0x8b70,0x2670,0x4370,0x5690,0x7390,0x2990,0x4690
.long 0x66a0,0x0,0x90300,0xefd00,0x69c0,0x300,0x5fd00,0xf0000,0x51e0,0x600,0x60000,0xbfa00,0x7200,0x900,0x60300,0x11f700
.long 0x76b0,0x2fe80,0xc0180,0x11fb80,0x79d0,0x30180,0x8fb80,0x11fe80,0x61f0,0x30480,0x8fe80,0xef880,0x6510,0x30780,0x90180,0xefb80
.long 0x6830,0x180,0x90480,0xefe80,0x6b50,0x480,0x5fe80,0xf0180,0x5370,0x780,0x60180,0xbfb80,0x7390,0x60480,0xbfe80,0x11f880
.long 0x7520,0x60600,0xc0000,0x11fa00,0x7840,0x30000,0xc0300,0x11fd00,0x7b60,0x30300,0x8fd00,0x120000,0x6380,0x30600,0x90000,0xefa00
.long 0x66a0,0x8,0x90308,0xefd08,0x69c0,0x308,0x5fd08,0xf0008,0x51e0,0x608,0x60008,0xbfa08,0x7200,0x908,0x60308,0x11f708
.long 0x76b0,0x2fe88,0xc0188,0x11fb88,0x79d0,0x30188,0x8fb88,0x11fe88,0x61f0,0x30488,0x8fe88,0xef888,0x6510,0x30788,0x90188,0xefb88
.long 0x6830,0x188,0x90488,0xefe88,0x6b50,0x488,0x5fe88,0xf0188,0x5370,0x788,0x60188,0xbfb88,0x7390,0x60488,0xbfe88,0x11f888
.long 0x7520,0x60608,0xc0008,0x11fa08,0x7840,0x30008,0xc0308,0x11fd08,0x7b60,0x30308,0x8fd08,0x120008,0x6380,0x30608,0x90008,0xefa08
.long 0x66b0,0x10,0x90310,0xefd10,0x69d0,0x310,0x5fd10,0xf0010,0x51f0,0x610,0x60010,0xbfa10,0x7210,0x910,0x60310,0x11f710
.long 0x76c0,0x2fe90,0xc0190,0x11fb90,0x79e0,0x30190,0x8fb90,0x11fe90,0x6200,0x30490,0x8fe90,0xef890,0x6520,0x30790,0x90190,0xefb90
.long 0x6840,0x190,0x90490,0xefe90,0x6b60,0x490,0x5fe90,0xf0190,0x5380,0x790,0x60190,0xbfb90,0x73a0,0x60490,0xbfe90,0x11f890
.long 0x7530,0x60610,0xc0010,0x11fa10,0x7850,0x30010,0xc0310,0x11fd10,0x7b70,0x30310,0x8fd10,0x120010,0x6390,0x30610,0x90010,0xefa10
.long 0x66b0,0x18,0x90318,0xefd18,0x69d0,0x318,0x5fd18,0xf0018,0x51f0,0x618,0x60018,0xbfa18,0x7210,0x918,0x60318,0x11f718
.long 0x76c0,0x2fe98,0xc0198,0x11fb98,0x79e0,0x30198,0x8fb98,0x11fe98,0x6200,0x30498,0x8fe98,0xef898,0x6520,0x30798,0x90198,0xefb98
.long 0x6840,0x198,0x90498,0xefe98,0x6b60,0x498,0x5fe98,0xf0198,0x5380,0x798,0x60198,0xbfb98,0x73a0,0x60498,0xbfe98,0x11f898
.long 0x7530,0x60618,0xc0018,0x11fa18,0x7850,0x30018,0xc0318,0x11fd18,0x7b70,0x30318,0x8fd18,0x120018,0x6390,0x30618,0x90018,0xefa18
.long 0x0,0x0,0x9100,0xd900,0x0,0xff800000,0x9110,0xd910,0x0,0xff800000,0x9120,0xd920,0x0,0xff800000,0x9130,0xd930
.long 0x0,0xff800000,0x9140,0xd940,0x0,0xff800000,0x9150,0xd950,0x0,0xff800000,0x9160,0xd960,0x0,0xff800000,0x9170,0xd970
.long 0x0,0xff800000,0x9180,0xd980,0x0,0xff800000,0x9190,0xd990,0x0,0xff800000,0x91a0,0xd9a0,0x0,0xff800000,0x91b0,0xd9b0
.long 0x0,0xff800000,0x91c0,0xd9c0,0x0,0xff800000,0x91d0,0xd9d0,0x0,0xff800000,0x91e0,0xd9e0,0x0,0xff800000,0x91f0,0xd9f0
.long 0xff800000,0x0,0x9100,0xdd00,0xff800000,0xff800000,0x9110,0xdd10,0xff800000,0xff800000,0x9120,0xdd20,0xff800000,0xff800000,0x9130,0xdd30
.long 0xff800000,0xff800000,0x9140,0xdd40,0xff800000,0xff800000,0x9150,0xdd50,0xff800000,0xff800000,0x9160,0xdd60,0xff800000,0xff800000,0x9170,0xdd70
.long 0xff800000,0xff800000,0x9180,0xdd80,0xff800000,0xff800000,0x9190,0xdd90,0xff800000,0xff800000,0x91a0,0xdda0,0xff800000,0xff800000,0x91b0,0xddb0
.long 0xff800000,0xff800000,0x91c0,0xddc0,0xff800000,0xff800000,0x91d0,0xddd0,0xff800000,0xff800000,0x91e0,0xdde0,0xff800000,0xff800000,0x91f0,0xddf0
.long 0xff800000,0x0,0x9100,0xda00,0xff800000,0xff800000,0x9110,0xda10,0xff800000,0xff800000,0x9120,0xda20,0xff800000,0xff800000,0x9130,0xda30
.long 0xff800000,0xff800000,0x9140,0xda40,0xff800000,0xff800000,0x9150,0xda50,0xff800000,0xff800000,0x9160,0xda60,0xff800000,0xff800000,0x9170,0xda70
.long 0xff800000,0xff800000,0x9180,0xda80,0xff800000,0xff800000,0x9190,0xda90,0xff800000,0xff800000,0x91a0,0xdaa0,0xff800000,0xff800000,0x91b0,0xdab0
.long 0xff800000,0xff800000,0x91c0,0xdac0,0xff800000,0xff800000,0x91d0,0xdad0,0xff800000,0xff800000,0x91e0,0xdae0,0xff800000,0xff800000,0x91f0,0xdaf0
.long 0xff800000,0x0,0x9100,0xde00,0xff800000,0xff800000,0x9110,0xde10,0xff800000,0xff800000,0x9120,0xde20,0xff800000,0xff800000,0x9130,0xde30
.long 0xff800000,0xff800000,0x9140,0xde40,0xff800000,0xff800000,0x9150,0xde50,0xff800000,0xff800000,0x9160,0xde60,0xff800000,0xff800000,0x9170,0xde70
.long 0xff800000,0xff800000,0x9180,0xde80,0xff800000,0xff800000,0x9190,0xde90,0xff800000,0xff800000,0x91a0,0xdea0,0xff800000,0xff800000,0x91b0,0xdeb0
.long 0xff800000,0xff800000,0x91c0,0xdec0,0xff800000,0xff800000,0x91d0,0xded0,0xff800000,0xff800000,0x91e0,0xdee0,0xff800000,0xff800000,0x91f0,0xdef0
.long 0x9100,0x9100,0xa100,0x0,0x9110,0x9110,0xa110,0x55555555,0x9120,0x9120,0xa120,0xaaaaaaaa,0x9130,0x9130,0xa130,0xffffffff
.long 0x9140,0x9140,0xa140,0x0,0x9150,0x9150,0xa150,0x55555555,0x9160,0x9160,0xa160,0xaaaaaaaa,0x9170,0x9170,0xa170,0xffffffff
.long 0x9180,0x9180,0xa180,0x0,0x9190,0x9190,0xa190,0x55555555,0x91a0,0x91a0,0xa1a0,0xaaaaaaaa,0x91b0,0x91b0,0xa1b0,0xffffffff
.long 0x91c0,0x91c0,0xa1c0,0x0,0x91d0,0x91d0,0xa1d0,0x55555555,0x91e0,0x91e0,0xa1e0,0xaaaaaaaa,0x91f0,0x91f0,0xa1f0,0xffffffff
.long 0x9200,0x9200,0xa200,0x0,0x9210,0x9210,0xa210,0x55555555,0x9220,0x9220,0xa220,0xaaaaaaaa,0x9230,0x9230,0xa230,0xffffffff
.long 0x9240,0x9240,0xa240,0x0,0x9250,0x9250,0xa250,0x55555555,0x9260,0x9260,0xa260,0xaaaaaaaa,0x9270,0x9270,0xa270,0xffffffff
.long 0x9280,0x9280,0xa280,0x0,0x9290,0x9290,0xa290,0x55555555,0x92a0,0x92a0,0xa2a0,0xaaaaaaaa,0x92b0,0x92b0,0xa2b0,0xffffffff
.long 0x92c0,0x92c0,0xa2c0,0x0,0x92d0,0x92d0,0xa2d0,0x55555555,0x92e0,0x92e0,0xa2e0,0xaaaaaaaa,0x92f0,0x92f0,0xa2f0,0xffffffff
.long 0x9300,0x9300,0xa300,0x0,0x9310,0x9310,0xa310,0x55555555,0x9320,0x9320,0xa320,0xaaaaaaaa,0x9330,0x9330,0xa330,0xffffffff
.long 0x9340,0x9340,0xa340,0x0,0x9350,0x9350,0xa350,0x55555555,0x9360,0x9360,0xa360,0xaaaaaaaa,0x9370,0x9370,0xa370,0xffffffff
.long 0x9380,0x9380,0xa380,0x0,0x9390,0x9390,0xa390,0x55555555,0x93a0,0x93a0,0xa3a0,0xaaaaaaaa,0x93b0,0x93b0,0xa3b0,0xffffffff
.long 0x93c0,0x93c0,0xa3c0,0x0,0x93d0,0x93d0,0xa3d0,0x55555555,0x93e0,0x93e0,0xa3e0,0xaaaaaaaa,0x93f0,0x93f0,0xa3f0,0xffffffff
.long 0x9400,0x9400,0xa400,0x0,0x9410,0x9410,0xa410,0x55555555,0x9420,0x9420,0xa420,0xaaaaaaaa,0x9430,0x9430,0xa430,0xffffffff
.long 0x9440,0x9440,0xa440,0x0,0x9450,0x9450,0xa450,0x55555555,0x9460,0x9460,0xa460,0xaaaaaaaa,0x9470,0x9470,0xa470,0xffffffff
.long 0x9480,0x9480,0xa480,0x0,0x9490,0x9490,0xa490,0x55555555,0x94a0,0x94a0,0xa4a0,0xaaaaaaaa,0x94b0,0x94b0,0xa4b0,0xffffffff
.long 0x94c0,0x94c0,0xa4c0,0x0,0x94d0,0x94d0,0xa4d0,0x55555555,0x94e0,0x94e0,0xa4e0,0xaaaaaaaa,0x94f0,0x94f0,0xa4f0,0xffffffff
.long 0x17100,0x17100,0x0,0x23100,0x17102,0x17100,0x0,0x23110,0x17104,0x17100,0x0,0x23120,0x17106,0x17100,0x0,0x23130
.long 0x17120,0x17100,0x0,0x23140,0x17122,0x17100,0x0,0x23150,0x17124,0x17100,0x0,0x23160,0x17126,0x17100,0x0,0x23170
.long 0x17140,0x17100,0x0,0x23300,0x17142,0x17100,0x0,0x23300,0x17144,0x17100,0x0,0x23300,0x17146,0x17100,0x0,0x23300
.long 0x17160,0x17100,0x0,0x23300,0x17162,0x17100,0x0,0x23300,0x17164,0x17100,0x0,0x23300,0x17166,0x17100,0x0,0x23300
.long 0x17108,0x17120,0x0,0x23200,0x1710a,0x17120,0x0,0x23210,0x1710c,0x17120,0x0,0x23220,0x1710e,0x17120,0x0,0x23230
.long 0x17128,0x17120,0x0,0x23240,0x1712a,0x17120,0x0,0x23250,0x1712c,0x17120,0x0,0x23260,0x1712e,0x17120,0x0,0x23270
.long 0x17148,0x17120,0x0,0x23300,0x1714a,0x17120,0x0,0x23300,0x1714c,0x17120,0x0,0x23300,0x1714e,0x17120,0x0,0x23300
.long 0x17168,0x17120,0x0,0x23300,0x1716a,0x17120,0x0,0x23300,0x1716c,0x17120,0x0,0x23300,0x1716e,0x17120,0x0,0x23300
.long 0x17110,0x17140,0x0,0x23300,0x17112,0x17140,0x0,0x23300,0x17114,0x17140,0x0,0x23300,0x17116,0x17140,0x0,0x23300
.long 0x17130,0x17140,0x0,0x23300,0x17132,0x17140,0x0,0x23300,0x17134,0x17140,0x0,0x23300,0x17136,0x17140,0x0,0x23300
.long 0x17150,0x17140,0x0,0x23180,0x17152,0x17140,0x0,0x23190,0x17154,0x17140,0x0,0x231a0,0x17156,0x17140,0x0,0x231b0
.long 0x17170,0x17140,0x0,0x231c0,0x17172,0x17140,0x0,0x231d0,0x17174,0x17140,0x0,0x231e0,0x17176,0x17140,0x0,0x231f0
.long 0x17118,0x17160,0x0,0x23300,0x1711a,0x17160,0x0,0x23300,0x1711c,0x17160,0x0,0x23300,0x1711e,0x17160,0x0,0x23300
.long 0x17138,0x17160,0x0,0x23300,0x1713a,0x17160,0x0,0x23300,0x1713c,0x17160,0x0,0x23300,0x1713e,0x17160,0x0,0x23300
.long 0x17158,0x17160,0x0,0x23280,0x1715a,0x17160,0x0,0x23290,0x1715c,0x17160,0x0,0x232a0,0x1715e,0x17160,0x0,0x232b0
.long 0x17178,0x17160,0x0,0x232c0,0x1717a,0x17160,0x0,0x232d0,0x1717c,0x17160,0x0,0x232e0,0x1717e,0x17160,0x0,0x232f0
.long 0x17100,0xe100,0xe280,0xe700,0x17108,0xee90,0xf010,0xf490,0x17110,0xfc20,0xfda0,0x10220,0x17118,0x109b0,0x10b30,0x10fb0
.long 0x17160,0x11740,0x118c0,0x11d40,0x17168,0x124d0,0x12650,0x12ad0,0x17170,0x13260,0x133e0,0x13860,0x17178,0x13ff0,0x14170,0x145f0
.long 0x171c0,0x14d80,0x14f00,0x15380,0x171c8,0x15b10,0x15c90,0x16110,0x171d0,0x168a0,0x16a20,0x16ea0,0x171d8,0x17630,0x177b0,0x17c30
.long 0x17220,0x183c0,0x18540,0x189c0,0x17228,0x19150,0x192d0,0x19750,0x17230,0x19ee0,0x1a060,0x1a4e0,0x17238,0x1ac70,0x1adf0,0x1b270
.long 0x17280,0xe400,0xe580,0xe700,0x17288,0xf190,0xf310,0xf490,0x17290,0xff20,0x100a0,0x10220,0x17298,0x10cb0,0x10e30,0x10fb0
.long 0x172e0,0x11a40,0x11bc0,0x11d40,0x172e8,0x127d0,0x12950,0x12ad0,0x172f0,0x13560,0x136e0,0x13860,0x172f8,0x142f0,0x14470,0x145f0
.long 0x17340,0x15080,0x15200,0x15380,0x17348,0x15e10,0x15f90,0x16110,0x17350,0x16ba0,0x16d20,0x16ea0,0x17358,0x17930,0x17ab0,0x17c30
.long 0x173a0,0x186c0,0x18840,0x189c0,0x173a8,0x19450,0x195d0,0x19750,0x173b0,0x1a1e0,0x1a360,0x1a4e0,0x173b8,0x1af70,0x1b0f0,0x1b270
.long 0x17400,0xea00,0xe880,0xe710,0x17408,0xf790,0xf610,0xf4a0,0x17410,0x10520,0x103a0,0x10230,0x17418,0x112b0,0x11130,0x10fc0
.long 0x17460,0x12040,0x11ec0,0x11d50,0x17468,0x12dd0,0x12c50,0x12ae0,0x17470,0x13b60,0x139e0,0x13870,0x17478,0x148f0,0x14770,0x14600
.long 0x174c0,0x15680,0x15500,0x15390,0x174c8,0x16410,0x16290,0x16120,0x174d0,0x171a0,0x17020,0x16eb0,0x174d8,0x17f30,0x17db0,0x17c40
.long 0x17520,0x18cc0,0x18b40,0x189d0,0x17528,0x19a50,0x198d0,0x19760,0x17530,0x1a7e0,0x1a660,0x1a4f0,0x17538,0x1b570,0x1b3f0,0x1b280
.long 0x17580,0xed00,0xeb80,0xe710,0x17588,0xfa90,0xf910,0xf4a0,0x17590,0x10820,0x106a0,0x10230,0x17598,0x115b0,0x11430,0x10fc0
.long 0x175e0,0x12340,0x121c0,0x11d50,0x175e8,0x130d0,0x12f50,0x12ae0,0x175f0,0x13e60,0x13ce0,0x13870,0x175f8,0x14bf0,0x14a70,0x14600
.long 0x17640,0x15980,0x15800,0x15390,0x17648,0x16710,0x16590,0x16120,0x17650,0x174a0,0x17320,0x16eb0,0x17658,0x18230,0x180b0,0x17c40
.long 0x176a0,0x18fc0,0x18e40,0x189d0,0x176a8,0x19d50,0x19bd0,0x19760,0x176b0,0x1aae0,0x1a960,0x1a4f0,0x176b8,0x1b870,0x1b6f0,0x1b280
.long 0x17100,0x17500,0x1f050,0x0,0x17710,0x17b10,0x1f360,0x0,0x17d20,0x18120,0x1f670,0x0,0x18330,0x18730,0x1f980,0x0
.long 0x18940,0x18d40,0x1fc90,0x0,0x18f50,0x19350,0x1ffa0,0x0,0x19560,0x19960,0x202b0,0x0,0x19b70,0x19f70,0x205c0,0x0
.long 0x1a180,0x1a580,0x208d0,0x0,0x1a790,0x1ab90,0x20be0,0x0,0x1ada0,0x1b1a0,0x20ef0,0x0,0x1b3b0,0x1b7b0,0x21200,0x0
.long 0x1b9c0,0x1bdc0,0x21510,0x0,0x1bfd0,0x1c3d0,0x21820,0x0,0x1c5e0,0x1c9e0,0x21b30,0x0,0x1cbf0,0x1cff0,0x21e40,0x0
.long 0x17120,0x17508,0x1f060,0x0,0x17730,0x17b18,0x1f370,0x0,0x17d40,0x18128,0x1f680,0x0,0x18350,0x18738,0x1f990,0x0
.long 0x18960,0x18d48,0x1fca0,0x0,0x18f70,0x19358,0x1ffb0,0x0,0x19580,0x19968,0x202c0,0x0,0x19b90,0x19f78,0x205d0,0x0
.long 0x1a1a0,0x1a588,0x208e0,0x0,0x1a7b0,0x1ab98,0x20bf0,0x0,0x1adc0,0x1b1a8,0x20f00,0x0,0x1b3d0,0x1b7b8,0x21210,0x0
.long 0x1b9e0,0x1bdc8,0x21520,0x0,0x1bff0,0x1c3d8,0x21830,0x0,0x1c600,0x1c9e8,0x21b40,0x0,0x1cc10,0x1cff8,0x21e50,0x0
.long 0x17140,0x17510,0x1f070,0x0,0x17750,0x17b20,0x1f380,0x0,0x17d60,0x18130,0x1f690,0x0,0x18370,0x18740,0x1f9a0,0x0
.long 0x18980,0x18d50,0x1fcb0,0x0,0x18f90,0x19360,0x1ffc0,0x0,0x195a0,0x19970,0x202d0,0x0,0x19bb0,0x19f80,0x205e0,0x0
.long 0x1a1c0,0x1a590,0x208f0,0x0,0x1a7d0,0x1aba0,0x20c00,0x0,0x1ade0,0x1b1b0,0x20f10,0x0,0x1b3f0,0x1b7c0,0x21220,0x0
.long 0x1ba00,0x1bdd0,0x21530,0x0,0x1c010,0x1c3e0,0x21840,0x0,0x1c620,0x1c9f0,0x21b50,0x0,0x1cc30,0x1d000,0x21e60,0x0
.long 0x17160,0x17518,0x1f080,0x0,0x17770,0x17b28,0x1f390,0x0,0x17d80,0x18138,0x1f6a0,0x0,0x18390,0x18748,0x1f9b0,0x0
.long 0x189a0,0x18d58,0x1fcc0,0x0,0x18fb0,0x19368,0x1ffd0,0x0,0x195c0,0x19978,0x202e0,0x0,0x19bd0,0x19f88,0x205f0,0x0
.long 0x1a1e0,0x1a598,0x20900,0x0,0x1a7f0,0x1aba8,0x20c10,0x0,0x1ae00,0x1b1b8,0x20f20,0x0,0x1b410,0x1b7c8,0x21230,0x0
.long 0x1ba20,0x1bdd8,0x21540,0x0,0x1c030,0x1c3e8,0x21850,0x0,0x1c640,0x1c9f8,0x21b60,0x0,0x1cc50,0x1d008,0x21e70,0x0
.long 0x26100,0x26160,0x26280,0x0,0x26102,0x26162,0x26282,0x0,0x26104,0x26164,0x26284,0x0,0x26106,0x26166,0x26286,0x0
.long 0x26108,0x26168,0x26288,0x0,0x2610a,0x2616a,0x2628a,0x0,0x2610c,0x2616c,0x2628c,0x0,0x2610e,0x2616e,0x2628e,0x0
.long 0x26110,0x26170,0x26290,0x0,0x26112,0x26172,0x26292,0x0,0x26114,0x26174,0x26294,0x0,0x26116,0x26176,0x26296,0x0
.long 0x26118,0x26178,0x26298,0x0,0x2611a,0x2617a,0x2629a,0x0,0x2611c,0x2617c,0x2629c,0x0,0x2611e,0x2617e,0x2629e,0x0
.long 0x26340,0x262e0,0x26280,0x0,0x26342,0x262e2,0x26282,0x0,0x26344,0x262e4,0x26284,0x0,0x26346,0x262e6,0x26286,0x0
.long 0x26348,0x262e8,0x26288,0x0,0x2634a,0x262ea,0x2628a,0x0,0x2634c,0x262ec,0x2628c,0x0,0x2634e,0x262ee,0x2628e,0x0
.long 0x26350,0x262f0,0x26290,0x0,0x26352,0x262f2,0x26292,0x0,0x26354,0x262f4,0x26294,0x0,0x26356,0x262f6,0x26296,0x0
.long 0x26358,0x262f8,0x26298,0x0,0x2635a,0x262fa,0x2629a,0x0,0x2635c,0x262fc,0x2629c,0x0,0x2635e,0x262fe,0x2629e,0x0
.long 0x26100,0x26160,0x26280,0x0,0x26102,0x26162,0x26282,0x0,0x26104,0x26164,0x26284,0x0,0x26106,0x26166,0x26286,0x0
.long 0x26108,0x26168,0x26288,0x0,0x2610a,0x2616a,0x2628a,0x0,0x2610c,0x2616c,0x2628c,0x0,0x2610e,0x2616e,0x2628e,0x0
.long 0x26110,0x26170,0x26290,0x0,0x26112,0x26172,0x26292,0x0,0x26114,0x26174,0x26294,0x0,0x26116,0x26176,0x26296,0x0
.long 0x26118,0x26178,0x26298,0x0,0x2611a,0x2617a,0x2629a,0x0,0x2611c,0x2617c,0x2629c,0x0,0x2611e,0x2617e,0x2629e,0x0
.long 0x26340,0x262e0,0x26280,0x0,0x26342,0x262e2,0x26282,0x0,0x26344,0x262e4,0x26284,0x0,0x26346,0x262e6,0x26286,0x0
.long 0x26348,0x262e8,0x26288,0x0,0x2634a,0x262ea,0x2628a,0x0,0x2634c,0x262ec,0x2628c,0x0,0x2634e,0x262ee,0x2628e,0x0
.long 0x26350,0x262f0,0x26290,0x0,0x26352,0x262f2,0x26292,0x0,0x26354,0x262f4,0x26294,0x0,0x26356,0x262f6,0x26296,0x0
.long 0x26358,0x262f8,0x26298,0x0,0x2635a,0x262fa,0x2629a,0x0,0x2635c,0x262fc,0x2629c,0x0,0x2635e,0x262fe,0x2629e,0x0
.long 0xffffffff,0x0,0xffff,0x0,0xffffffff,0x0,0xffff,0x0,0xffffffff,0x0,0xffff,0x0,0xffffffff,0x0,0xffff,0x0
.long 0x0,0xffffffff,0xffff,0x0,0x0,0xffffffff,0xffff,0x0,0x0,0xffffffff,0xffff,0x0,0x0,0xffffffff,0xffff,0x0
.long 0x0,0x0,0xffff,0x0,0x0,0x0,0xffff,0x0,0x0,0x0,0xffff,0x0,0x0,0x0,0xffff,0x0
.long 0x0,0x0,0xffff,0x0,0x0,0x0,0xffff,0x0,0x0,0x0,0xffff,0x0,0x0,0x0,0xffff,0x0
.long 0xffffffff,0x0,0x0,0x3f80,0xffffffff,0x0,0x0,0x3f80,0xffffffff,0x0,0x0,0x3f80,0xffffffff,0x0,0x0,0x3f80
.long 0x0,0xffffffff,0x0,0x3f80,0x0,0xffffffff,0x0,0x3f80,0x0,0xffffffff,0x0,0x3f80,0x0,0xffffffff,0x0,0x3f80
.long 0x0,0x0,0x0,0x3f80,0x0,0x0,0x0,0x3f80,0x0,0x0,0x0,0x3f80,0x0,0x0,0x0,0x3f80
.long 0x0,0x0,0x0,0x3f80,0x0,0x0,0x0,0x3f80,0x0,0x0,0x0,0x3f80,0x0,0x0,0x0,0x3f80
.long 0x0,0x0,0xffff,0x0,0x0,0x0,0xffff,0x0,0x0,0x0,0xffff,0x0,0x0,0x0,0xffff,0x0
.long 0x0,0x0,0xffff,0x0,0x0,0x0,0xffff,0x0,0x0,0x0,0xffff,0x0,0x0,0x0,0xffff,0x0
.long 0xffffffff,0x0,0xffff,0x0,0xffffffff,0x0,0xffff,0x0,0xffffffff,0x0,0xffff,0x0,0xffffffff,0x0,0xffff,0x0
.long 0x0,0xffffffff,0xffff,0x0,0x0,0xffffffff,0xffff,0x0,0x0,0xffffffff,0xffff,0x0,0x0,0xffffffff,0xffff,0x0
.long 0x0,0x0,0x0,0x3f80,0x0,0x0,0x0,0x3f80,0x0,0x0,0x0,0x3f80,0x0,0x0,0x0,0x3f80
.long 0x0,0x0,0x0,0x3f80,0x0,0x0,0x0,0x3f80,0x0,0x0,0x0,0x3f80,0x0,0x0,0x0,0x3f80
.long 0xffffffff,0x0,0x0,0x3f80,0xffffffff,0x0,0x0,0x3f80,0xffffffff,0x0,0x0,0x3f80,0xffffffff,0x0,0x0,0x3f80
.long 0x0,0xffffffff,0x0,0x3f80,0x0,0xffffffff,0x0,0x3f80,0x0,0xffffffff,0x0,0x3f80,0x0,0xffffffff,0x0,0x3f80
.long 0xffff,0x0,0x0,0x0,0xffff0000,0x0,0x0,0x0,0x0,0xffff,0x0,0x0,0x0,0xffff0000,0x0,0x0
.long 0x0,0x0,0xffff,0x0,0x0,0x0,0xffff0000,0x0,0x0,0x0,0x0,0xffff,0x0,0x0,0x0,0xffff0000
.long 0x0,0x0,0x0,0x0,0x0,0x0,0x0,0x0,0x0,0x0,0x0,0x0,0x0,0x0,0x0,0x0
.long 0x0,0x0,0x0,0x0,0x0,0x0,0x0,0x0,0x0,0x0,0x0,0x0,0x0,0x0,0x0,0x0
.long 0xffff,0x0,0x0,0x0,0xffff0000,0x0,0x0,0x0,0x0,0xffff,0x0,0x0,0x0,0xffff0000,0x0,0x0
.long 0x0,0x0,0xffff,0x0,0x0,0x0,0xffff0000,0x0,0x0,0x0,0x0,0xffff,0x0,0x0,0x0,0xffff0000
.long 0x0,0x0,0x0,0x0,0x0,0x0,0x0,0x0,0x0,0x0,0x0,0x0,0x0,0x0,0x0,0x0
.long 0x0,0x0,0x0,0x0,0x0,0x0,0x0,0x0,0x0,0x0,0x0,0x0,0x0,0x0,0x0,0x0
.long 0x0,0x0,0x0,0x0,0x0,0x0,0x0,0x0,0x0,0x0,0x0,0x0,0x0,0x0,0x0,0x0
.long 0x0,0x0,0x0,0x0,0x0,0x0,0x0,0x0,0x0,0x0,0x0,0x0,0x0,0x0,0x0,0x0
.long 0xffff,0x0,0x0,0x0,0xffff0000,0x0,0x0,0x0,0x0,0xffff,0x0,0x0,0x0,0xffff0000,0x0,0x0
.long 0x0,0x0,0xffff,0x0,0x0,0x0,0xffff0000,0x0,0x0,0x0,0x0,0xffff,0x0,0x0,0x0,0xffff0000
.long 0x0,0x0,0x0,0x0,0x0,0x0,0x0,0x0,0x0,0x0,0x0,0x0,0x0,0x0,0x0,0x0
.long 0x0,0x0,0x0,0x0,0x0,0x0,0x0,0x0,0x0,0x0,0x0,0x0,0x0,0x0,0x0,0x0
.long 0xffff,0x0,0x0,0x0,0xffff0000,0x0,0x0,0x0,0x0,0xffff,0x0,0x0,0x0,0xffff0000,0x0,0x0
.long 0x0,0x0,0xffff,0x0,0x0,0x0,0xffff0000,0x0,0x0,0x0,0x0,0xffff,0x0,0x0,0x0,0xffff0000
.long 0x0,0x0,0x0,0x0,0x0,0x0,0x0,0x0,0x0,0x0,0x0,0x0,0x0,0x0,0x0,0x0
.long 0x0,0x0,0x0,0x0,0x0,0x0,0x0,0x0,0x0,0x0,0x0,0x0,0x0,0x0,0x0,0x0
.long 0x0,0x0,0x0,0x0,0x0,0x0,0x0,0x0,0x0,0x0,0x0,0x0,0x0,0x0,0x0,0x0
.long 0x0,0x0,0x0,0x0,0x0,0x0,0x0,0x0,0x0,0x0,0x0,0x0,0x0,0x0,0x0,0x0
.long 0x0,0x0,0x0,0x0,0x0,0x0,0x0,0x0,0x0,0x0,0x0,0x0,0x0,0x0,0x0,0x0
.long 0x0,0x0,0x0,0x0,0x0,0x0,0x0,0x0,0x0,0x0,0x0,0x0,0x0,0x0,0x0,0x0
.long 0x0,0x0,0x0,0x0,0x0,0x0,0x0,0x0,0x0,0x0,0x0,0x0,0x0,0x0,0x0,0x0
.long 0x0,0x0,0x0,0x0,0x0,0x0,0x0,0x0,0x0,0x0,0x0,0x0,0x0,0x0,0x0,0x0
.long 0x0,0x0,0x0,0x0,0x0,0x0,0x0,0x0,0x0,0x0,0x0,0x0,0x0,0x0,0x0,0x0
.long 0x0,0x0,0x0,0x0,0x0,0x0,0x0,0x0,0x0,0x0,0x0,0x0,0x0,0x0,0x0,0x0
.long 0x0,0x0,0x0,0x0,0x0,0x0,0x0,0x0,0x0,0x0,0x0,0x0,0x0,0x0,0x0,0x0
.long 0x0,0x0,0x0,0x0,0x0,0x0,0x0,0x0,0x0,0x0,0x0,0x0,0x0,0x0,0x0,0x0
.long 0x0,0x0,0x0,0x0,0x0,0x0,0x0,0x0,0x0,0x0,0x0,0x0,0x0,0x0,0x0,0x0
.long 0x0,0x0,0x0,0x0,0x0,0x0,0x0,0x0,0x0,0x0,0x0,0x0,0x0,0x0,0x0,0x0
.long 0x0,0x0,0x0,0x0,0x0,0x0,0x0,0x0,0x0,0x0,0x0,0x0,0x0,0x0,0x0,0x0
.long 0x0,0x0,0x0,0x0,0x0,0x0,0x0,0x0,0x0,0x0,0x0,0x0,0x0,0x0,0x0,0x0
.size L_tab, 12288
.section .rodata,"a"
.p2align 6
.amdhsa_kernel standalone__window_attn_davit__vision_kernel
  .amdhsa_next_free_vgpr 512
  .amdhsa_next_free_sgpr 102
  .amdhsa_accum_offset 256
  .amdhsa_group_segment_fixed_size 0
  .amdhsa_kernarg_size 56
  .amdhsa_user_sgpr_count 2
  .amdhsa_user_sgpr_kernarg_segment_ptr 1
  .amdhsa_system_sgpr_workgroup_id_x 1
.end_amdhsa_kernel
```

```asm
; @launch grid=(256,1,1) block=(256,1,1) lds=163840
.amdgcn_target "amdgcn-amd-amdhsa--gfx950"
.text
.globl standalone__window_attn_davit__vision_kernel
.p2align 8
.type standalone__window_attn_davit__vision_kernel,@function
standalone__window_attn_davit__vision_kernel:
s_cmp_ge_u32 s2, 256
s_cbranch_scc1 L_end
v_lshrrev_b32 v1, 6, v0
s_mov_b32 s53, s2
s_mov_b32 s47, 0
v_readfirstlane_b32 s32, v1
s_nop 3
L_start:

s_load_dwordx8 s[56:63], s[0:1], 0
s_load_dwordx2 s[64:65], s[0:1], 32
s_load_dwordx2 s[66:67], s[0:1], 48
s_load_dwordx2 s[100:101], s[0:1], 40
s_getpc_b64 s[68:69]
L_pc:
v_mbcnt_lo_u32_b32 v0, -1, 0
v_mbcnt_hi_u32_b32 v0, -1, v0
s_add_u32 s70, s68, L_tab-L_pc
s_addc_u32 s71, s69, 0
s_add_u32 s98, s68, F_tail-L_pc
s_addc_u32 s99, s69, 0
s_and_b32 s41, s53, 8
s_lshl_b32 s41, s41, 11
s_add_u32 s98, s98, s41
s_addc_u32 s99, s99, 0
s_lshl_b32 s45, s32, 10
v_lshl_add_u32 v1, v0, 4, s45
s_add_u32 m0, s45, 143616
s_nop 0
global_load_lds_dwordx4 v1, s[70:71]
v_add_u32 v1, 4096, v1
s_add_u32 m0, s45, 147712
s_nop 0
global_load_lds_dwordx4 v1, s[70:71]
v_add_u32 v1, 4096, v1
s_add_u32 m0, s45, 151808
s_nop 0
global_load_lds_dwordx4 v1, s[70:71]
s_lshr_b32 s42, s53, 3
s_and_b32 s41, s42, 1
s_lshl_b32 s41, s41, 2
s_add_u32 s41, s41, s32
s_lshl_b32 s41, s41, 13
v_lshlrev_b32 v2, 7, v0
v_add_u32 v3, s41, v2
s_cmp_lt_u32 s42, 4
s_cbranch_scc0 L_nopf
global_load_dword v255, v3, s[68:69]
L_nopf:
s_and_b32 s41, s53, 7
s_mul_i32 s43, s41, 640
s_mov_b32 s34, 5329
s_add_u32 s33, s43, s42
s_mov_b32 s35, s33
s_mov_b32 s72, 402653183
s_mul_i32 s54, s32, 96
s_mul_i32 s55, s32, 3072
s_mul_hi_u32 s41, s33, 58835169
s_mul_i32 s28, s41, 73
s_sub_u32 s28, s33, s28
s_mul_i32 s29, s41, 1373568
s_mul_i32 s41, s28, 2688
s_add_u32 s29, s29, s41
s_lshl_b32 s41, s32, 6
v_add_u32 v4, s41, v0
v_mul_u32_u24 v5, 2622, v4
v_lshrrev_b32 v5, 16, v5
v_mul_u32_u24 v6, 25, v5
v_sub_u32 v6, v4, v6
v_mul_u32_u24 v7, 384, v5
v_lshl_add_u32 v7, v6, 4, v7
v_cmp_eq_u32 vcc, 0, v5
v_or_b32 v10, 134217728, v7
s_nop 0
v_cndmask_b32 v7, v7, v10, vcc
v_cmp_eq_u32 vcc, 8, v5
v_or_b32 v10, 536870912, v7
s_nop 0
v_cndmask_b32 v7, v7, v10, vcc
v_cmp_lt_u32 vcc, 8, v5
v_or_b32 v10, 268435456, v7
s_nop 0
v_cndmask_b32 v7, v7, v10, vcc
v_cmp_eq_u32 vcc, 24, v6
v_or_b32 v10, 268435456, v7
s_nop 0
v_cndmask_b32 v7, v7, v10, vcc
v_mov_b32 v208, v7
v_add_u32 v4, 0, v0
v_mul_u32_u24 v5, 171, v4
v_lshrrev_b32 v5, 10, v5
v_mul_u32_u24 v6, 6, v5
v_sub_u32 v6, v4, v6
v_lshlrev_b32 v6, 4, v6
v_mul_u32_u24 v8, 1152, v5
v_add_u32 v72, v8, v6
v_mul_u32_u24 v8, 384, v5
v_add_u32 v136, v8, v6
s_lshl_b32 s96, s42, 13
s_mul_hi_u32 s41, s35, 58835169
s_mul_i32 s42, s41, 73
s_sub_u32 s42, s35, s42
s_mul_i32 s43, s41, 1373568
s_mul_i32 s51, s42, 2688
s_add_u32 s43, s43, s51
s_cmp_lt_u32 s35, s34
s_cselect_b32 s50, s43, 1879048192
s_add_u32 s35, s35, 32
s_cmp_eq_u32 s42, 0
s_cselect_b32 s44, 536870911, s72
s_cmp_eq_u32 s42, 72
s_cselect_b32 s44, 939524095, s44
s_cmp_eq_u32 s41, 0
s_cselect_b32 s52, 1879048192, s50
s_waitcnt lgkmcnt(0)
s_mov_b32 s12, s60
s_mov_b32 s13, s61
s_mov_b32 s14, 221184
s_mov_b32 s15, 131072
s_mov_b32 s16, s62
s_mov_b32 s17, s63
s_mov_b32 s18, 73728
s_mov_b32 s19, 131072
s_cmp_eq_u32 s32, 0
s_cbranch_scc0 L_nopf2
buffer_load_dword v255, v2, s[12:15], s96 offen
L_nopf2:
s_and_b32 s96, s96, 131071
s_cmp_eq_u32 s32, 1
s_cbranch_scc0 L_nopf3
buffer_load_dword v255, v2, s[16:19], s96 offen
L_nopf3:
s_sub_u32 s4, s56, 196608
s_subb_u32 s5, s57, 0
s_mov_b32 s6, 100467072
s_mov_b32 s7, 131072
s_mov_b32 s20, s58
s_mov_b32 s21, s59
s_mov_b32 s22, 3456
s_mov_b32 s23, 131072
s_mul_i32 s96, s32, 864
s_mov_b32 exec_hi, 4194303
s_add_u32 m0, s96, 155904
s_nop 0
buffer_load_dwordx4 v136, s[20:23], s54 offen lds
s_mov_b64 exec, -1
s_mov_b32 s36, s50
v_and_b32 v216, s44, v208
s_add_u32 m0, s45, 0
s_nop 0
buffer_load_dwordx4 v216, s[4:7], s52 offen nt lds
s_add_u32 m0, s45, 4112
s_add_u32 s40, s36, 196224
buffer_load_dwordx4 v216, s[4:7], s40 offen nt lds
s_add_u32 m0, s45, 8224
s_add_u32 s40, s36, 392448
buffer_load_dwordx4 v216, s[4:7], s40 offen nt lds
s_add_u32 m0, s45, 12336
s_add_u32 s40, s36, 588672
buffer_load_dwordx4 v216, s[4:7], s40 offen nt lds
s_add_u32 m0, s45, 16448
s_add_u32 s40, s36, 784896
buffer_load_dwordx4 v216, s[4:7], s40 offen nt lds
s_add_u32 m0, s45, 20560
s_add_u32 s40, s36, 981120
buffer_load_dwordx4 v216, s[4:7], s40 offen nt lds
s_add_u32 m0, s45, 24672
s_add_u32 s40, s36, 1177344
buffer_load_dwordx4 v216, s[4:7], s40 offen nt lds
s_add_u32 m0, s45, 28784
s_add_u32 s40, s36, 1373568
buffer_load_dwordx4 v216, s[4:7], s40 offen nt lds
s_add_u32 m0, s45, 32896
s_add_u32 s40, s36, 1569792
buffer_load_dwordx4 v216, s[4:7], s40 offen nt lds
s_mul_i32 s41, s32, 54
v_add_u32 v4, s41, v0
v_mul_u32_u24 v5, 911, v4
v_lshrrev_b32 v5, 16, v5
v_mul_u32_u24 v6, 72, v5
v_sub_u32 v6, v4, v6
s_mov_b32 s43, 196224
v_mul_lo_u32 v5, v5, s43
v_lshl_add_u32 v82, v6, 4, v5
s_add_u32 s20, s29, 785664
s_add_u32 m0, s96, 57600
s_mov_b32 exec_hi, 4194303
buffer_load_dwordx4 v82, s[4:7], s20 offen nt lds
s_mov_b32 exec_hi, -1
s_add_u32 s28, s28, 32
s_cmp_ge_u32 s28, 73
s_cselect_b32 s21, 73, 0
s_cselect_b32 s22, 1177344, 0
s_sub_u32 s28, s28, s21
s_add_u32 s20, s20, s22
s_add_u32 s20, s20, 86016
s_add_u32 m0, s96, 61072
s_mov_b32 exec_hi, 4194303
buffer_load_dwordx4 v82, s[4:7], s20 offen nt lds
s_mov_b32 exec_hi, -1
s_add_u32 s28, s28, 32
s_cmp_ge_u32 s28, 73
s_cselect_b32 s21, 73, 0
s_cselect_b32 s22, 1177344, 0
s_sub_u32 s28, s28, s21
s_add_u32 s20, s20, s22
s_add_u32 s20, s20, 86016
s_add_u32 m0, s96, 64544
s_mov_b32 exec_hi, 4194303
buffer_load_dwordx4 v82, s[4:7], s20 offen nt lds
s_mov_b32 exec_hi, -1
s_add_u32 s28, s28, 32
s_cmp_ge_u32 s28, 73
s_cselect_b32 s21, 73, 0
s_cselect_b32 s22, 1177344, 0
s_sub_u32 s28, s28, s21
s_add_u32 s20, s20, s22
s_add_u32 s20, s20, 86016
s_add_u32 m0, s96, 68016
s_mov_b32 exec_hi, 4194303
buffer_load_dwordx4 v82, s[4:7], s20 offen nt lds
s_mov_b32 exec_hi, -1
v_add_u32 v4, 64, v0
v_mul_u32_u24 v5, 171, v4
v_lshrrev_b32 v5, 10, v5
v_mul_u32_u24 v6, 6, v5
v_sub_u32 v6, v4, v6
v_lshlrev_b32 v6, 4, v6
v_mul_u32_u24 v8, 1152, v5
v_add_u32 v73, v8, v6
v_mul_u32_u24 v8, 384, v5
v_add_u32 v137, v8, v6
s_mov_b32 s8, s64
s_mov_b32 s9, s65
s_mov_b32 s10, 100270464
s_mov_b32 s11, 131072
s_mov_b32 s24, s66
s_mov_b32 s25, s67
s_mov_b32 s26, 6291456
s_mov_b32 s27, 131072
s_mov_b32 s48, 1001040555
s_mov_b32 s73, 1020061065
s_mov_b32 s49, 944335852
s_mov_b32 s3, 1074544643
v_lshlrev_b32 v11, 4, v0
v_add_u32 v11, 143616, v11
s_waitcnt vmcnt(13)
s_barrier
ds_read_b128 v[194:197], v11
ds_read_b128 v[198:201], v11 offset:1024
ds_read_b128 v[202:205], v11 offset:2048
ds_read_b128 v[206:209], v11 offset:3072
ds_read_b128 v[210:213], v11 offset:4096
ds_read_b128 v[214:217], v11 offset:5120
ds_read_b128 v[110:113], v11 offset:6144
ds_read_b128 v[78:81], v11 offset:7168
ds_read_b128 v[36:39], v11 offset:8192
ds_read_b128 v[40:43], v11 offset:9216
ds_read_b128 v[44:47], v11 offset:10240
s_waitcnt lgkmcnt(7)
v_add_u32 v219, s45, v208
v_mov_b32 v208, v7
v_add_u32 v4, 128, v0
v_mul_u32_u24 v5, 171, v4
v_lshrrev_b32 v5, 10, v5
v_mul_u32_u24 v6, 6, v5
v_sub_u32 v6, v4, v6
v_lshlrev_b32 v6, 4, v6
v_mul_u32_u24 v8, 1152, v5
v_add_u32 v74, v8, v6
v_mul_u32_u24 v8, 384, v5
v_add_u32 v83, v8, v6
s_waitcnt lgkmcnt(2)
v_add_u32 v36, s96, v36
v_add_u32 v37, s96, v37
v_add_u32 v38, s96, v38
ds_read_u16 v48, v36
ds_read_u16 v49, v36 offset:192
ds_read_u16 v50, v37
ds_read_u16 v51, v37 offset:192
ds_read_u16 v52, v38
ds_read_u16 v53, v36 offset:32
ds_read_u16 v54, v36 offset:224
ds_read_u16 v55, v37 offset:32
ds_read_u16 v56, v37 offset:224
ds_read_u16 v57, v38 offset:32
ds_read_u16 v58, v36 offset:64
ds_read_u16 v59, v36 offset:256
ds_read_u16 v60, v37 offset:64
ds_read_u16 v61, v37 offset:256
ds_read_u16 v62, v38 offset:64
v_add_u32 v194, s54, v194
v_add_u32 v195, s54, v195
v_add_u32 v196, s54, v196
v_add_u32 v197, s54, v197
v_add_u32 v198, s54, v198
v_add_u32 v199, s54, v199
v_add_u32 v200, s54, v200
v_add_u32 v201, s54, v201
v_add_u32 v202, s54, v202
v_add_u32 v203, s54, v203
v_add_u32 v204, s54, v204
v_add_u32 v205, s54, v205
v_add_u32 v111, s54, v111
v_add_u32 v112, s54, v112
v_add_u32 v113, s54, v113
v_add_u32 v211, s45, v211
v_add_u32 v110, s55, v110
v_subrev_u32 v128, 94464, v110
v_subrev_u32 v129, 24576, v110
s_lshl_b32 s41, s54, 1
v_add_u32 v121, s41, v80
s_lshr_b32 s41, s32, 1
s_lshl_b32 s41, s41, 10
s_and_b32 s42, s32, 1
s_lshl_b32 s42, s42, 3
s_add_u32 s41, s41, s42
v_add_u32 v212, s41, v212
s_lshl_b32 s41, s32, 2
v_add_u32 v209, s41, v209
s_lshl_b32 s41, s32, 7
v_add_u32 v215, s41, v215
v_add_u32 v214, s41, v214
v_add_u32 v120, s41, v78
s_mul_i32 s41, s32, 4752
v_add_u32 v217, s41, v217
s_waitcnt lgkmcnt(0)
v_and_or_b32 v52, v52, v42, v43
v_lshl_or_b32 v52, v52, 16, v52
v_and_b32 v138, v52, v44
v_and_b32 v139, v52, v45
v_and_b32 v140, v52, v46
v_and_b32 v141, v52, v47
v_and_b32 v142, v48, v40
v_and_b32 v143, v48, v41
v_and_b32 v144, v49, v40
v_and_b32 v145, v49, v41
v_and_b32 v146, v50, v40
v_and_b32 v147, v50, v41
v_and_b32 v148, v51, v40
v_and_b32 v149, v51, v41
v_and_or_b32 v57, v57, v42, v43
v_lshl_or_b32 v57, v57, 16, v57
v_and_b32 v150, v57, v44
v_and_b32 v151, v57, v45
v_and_b32 v152, v57, v46
v_and_b32 v153, v57, v47
v_and_b32 v154, v53, v40
v_and_b32 v155, v53, v41
v_and_b32 v156, v54, v40
v_and_b32 v157, v54, v41
v_and_b32 v158, v55, v40
v_and_b32 v159, v55, v41
v_and_b32 v160, v56, v40
v_and_b32 v161, v56, v41
v_and_or_b32 v62, v62, v42, v43
v_lshl_or_b32 v62, v62, 16, v62
v_and_b32 v162, v62, v44
v_and_b32 v163, v62, v45
v_and_b32 v164, v62, v46
v_and_b32 v165, v62, v47
v_and_b32 v166, v58, v40
v_and_b32 v167, v58, v41
v_and_b32 v168, v59, v40
v_and_b32 v169, v59, v41
v_and_b32 v170, v60, v40
v_and_b32 v171, v60, v41
v_and_b32 v172, v61, v40
v_and_b32 v173, v61, v41
v_mov_b32 v190, 1065369472
v_mov_b32 v191, 1065369472
v_mov_b32 v192, 1065369472
v_mov_b32 v193, 1065369472
v_mov_b32 v218, 0
s_mov_b32 s30, 16712191
s_mov_b32 s31, 4278255360
s_mov_b32 s56, 983055
s_mov_b32 s57, 983055
s_waitcnt vmcnt(4) lgkmcnt(0)
s_barrier

s_cmp_lg_u32 s47, 0
s_cbranch_scc1 L_safe
.p2align 3
s_add_u32 s28, s28, 32
s_cmp_ge_u32 s28, 73
s_cselect_b32 s21, 73, 0
s_cselect_b32 s22, 1177344, 0
s_sub_u32 s28, s28, s21
s_add_u32 s20, s20, s22
s_add_u32 s20, s20, 86016
s_add_u32 m0, s96, 71488
s_mov_b32 exec_hi, 4194303
buffer_load_dwordx4 v82, s[4:7], s20 offen nt lds
s_mov_b32 exec_hi, -1
s_add_u32 s28, s28, 32
s_cmp_ge_u32 s28, 73
s_cselect_b32 s21, 73, 0
s_cselect_b32 s22, 1177344, 0
s_sub_u32 s28, s28, s21
s_add_u32 s20, s20, s22
s_add_u32 s20, s20, 86016
s_add_u32 m0, s96, 74960
s_mov_b32 exec_hi, 4194303
buffer_load_dwordx4 v82, s[4:7], s20 offen nt lds
s_mov_b32 exec_hi, -1
s_add_u32 s28, s28, 32
s_cmp_ge_u32 s28, 73
s_cselect_b32 s21, 73, 0
s_cselect_b32 s22, 1177344, 0
s_sub_u32 s28, s28, s21
s_add_u32 s20, s20, s22
s_add_u32 s20, s20, 86016
s_add_u32 m0, s96, 78432
s_mov_b32 exec_hi, 4194303
buffer_load_dwordx4 v82, s[4:7], s20 offen nt lds
s_mov_b32 exec_hi, -1
s_add_u32 s28, s28, 32
s_cmp_ge_u32 s28, 73
s_cselect_b32 s21, 73, 0
s_cselect_b32 s22, 1177344, 0
s_sub_u32 s28, s28, s21
s_add_u32 s20, s20, s22
s_add_u32 s20, s20, 86016
s_add_u32 m0, s96, 81904
s_mov_b32 exec_hi, 4194303
buffer_load_dwordx4 v82, s[4:7], s20 offen nt lds
s_mov_b32 exec_hi, -1
s_add_u32 s28, s28, 32
s_cmp_ge_u32 s28, 73
s_cselect_b32 s21, 73, 0
s_cselect_b32 s22, 1177344, 0
s_sub_u32 s28, s28, s21
s_add_u32 s20, s20, s22
s_add_u32 s20, s20, 86016
s_add_u32 m0, s96, 85376
s_mov_b32 exec_hi, 4194303
buffer_load_dwordx4 v82, s[4:7], s20 offen nt lds
s_mov_b32 exec_hi, -1
s_add_u32 s28, s28, 32
s_cmp_ge_u32 s28, 73
s_cselect_b32 s21, 73, 0
s_cselect_b32 s22, 1177344, 0
s_sub_u32 s28, s28, s21
s_add_u32 s20, s20, s22
s_add_u32 s20, s20, 86016
s_add_u32 m0, s96, 88848
s_mov_b32 exec_hi, 4194303
buffer_load_dwordx4 v82, s[4:7], s20 offen nt lds
s_mov_b32 exec_hi, -1
s_add_u32 s28, s28, 32
s_cmp_ge_u32 s28, 73
s_cselect_b32 s21, 73, 0
s_cselect_b32 s22, 1177344, 0
s_sub_u32 s28, s28, s21
s_add_u32 s20, s20, s22
s_add_u32 s20, s20, 86016
s_add_u32 m0, s96, 92320
s_mov_b32 exec_hi, 4194303
buffer_load_dwordx4 v82, s[4:7], s20 offen nt lds
s_mov_b32 exec_hi, -1
s_add_u32 s28, s28, 32
s_cmp_ge_u32 s28, 73
s_cselect_b32 s21, 73, 0
s_cselect_b32 s22, 1177344, 0
s_sub_u32 s28, s28, s21
s_add_u32 s20, s20, s22
s_add_u32 s20, s20, 86016
s_add_u32 m0, s96, 95792
s_mov_b32 exec_hi, 4194303
buffer_load_dwordx4 v82, s[4:7], s20 offen nt lds
s_mov_b32 exec_hi, -1
ds_read_b128 v[84:87], v200
ds_read_b128 v[92:95], v201
ds_read_b128 v[100:103], v202
ds_read_b128 v[88:91], v194 offset:16
ds_read_b128 v[96:99], v195 offset:16
s_mul_hi_u32 s41, s35, 58835169
s_mul_i32 s42, s41, 73
s_sub_u32 s42, s35, s42
s_mul_i32 s43, s41, 1373568
s_mul_i32 s51, s42, 2688
s_add_u32 s43, s43, s51
s_cmp_lt_u32 s35, s34
s_cselect_b32 s50, s43, 1879048192
s_add_u32 s35, s35, 32
s_cmp_eq_u32 s42, 0
s_cselect_b32 s44, 536870911, s72
s_cmp_eq_u32 s42, 72
s_cselect_b32 s44, 939524095, s44
s_cmp_eq_u32 s41, 0
s_cselect_b32 s52, 1879048192, s50
v_and_b32 v216, s44, v208
s_mov_b32 s37, s50
s_mul_hi_u32 s41, s35, 58835169
ds_read_b128 v[104:107], v196 offset:16
s_waitcnt lgkmcnt(5)
v_mfma_f32_16x16x32_bf16 v[0:3], v[138:141], v[84:87], 0
s_waitcnt lgkmcnt(4)
ds_read_b128 v[84:87], v194
s_mov_b64 exec, s[30:31]
ds_write_b128 v217, v[138:141]
s_mov_b64 exec, -1
v_mfma_f32_16x16x32_bf16 v[12:15], v[138:141], v[92:95], 0
s_mul_i32 s42, s41, 73
s_mul_i32 s43, s41, 1373568
s_waitcnt lgkmcnt(5)
v_mfma_f32_16x16x32_bf16 v[24:27], v[138:141], v[100:103], 0
s_mov_b32 s38, s36
ds_read_b128 v[92:95], v195
ds_read_b128 v[100:103], v196
s_mov_b64 exec, s[30:31]
ds_write_b128 v217, v[142:145] offset:528
s_mov_b64 exec, -1
s_add_u32 s28, s28, 32
s_cmp_ge_u32 s28, 73
s_cselect_b32 s21, 73, 0
s_cselect_b32 s22, 1177344, 0
s_sub_u32 s28, s28, s21
s_add_u32 s20, s20, s22
s_add_u32 s20, s20, 86016
s_add_u32 m0, s96, 99264
s_mov_b32 exec_hi, 4194303
buffer_load_dwordx4 v82, s[4:7], s20 offen nt lds
s_mov_b32 exec_hi, -1
s_waitcnt lgkmcnt(4)
v_smfmac_f32_16x16x64_bf16 v[0:3], v[142:145], v[84:91], v213
s_mov_b32 s39, s37
ds_read_b128 v[84:87], v197
ds_read_b128 v[88:91], v197 offset:16
s_mov_b64 exec, s[30:31]
ds_write_b128 v217, v[146:149] offset:1056
s_mov_b64 exec, -1
s_waitcnt lgkmcnt(5)
v_smfmac_f32_16x16x64_bf16 v[12:15], v[142:145], v[92:99], v213
s_waitcnt lgkmcnt(4)
v_smfmac_f32_16x16x64_bf16 v[24:27], v[142:145], v[100:107], v213
ds_read_b128 v[92:95], v198
ds_read_b128 v[96:99], v198 offset:16
ds_read_b128 v[100:103], v199
ds_read_b128 v[104:107], v199 offset:16
s_waitcnt lgkmcnt(5)
v_smfmac_f32_16x16x64_bf16 v[0:3], v[146:149], v[84:91], v213
ds_read_b128 v[84:87], v200 offset:32
ds_read_b128 v[88:91], v194 offset:48
s_mov_b64 exec, s[30:31]
ds_write_b128 v217, v[150:153] offset:1584
s_mov_b64 exec, -1
v_add_f32 v118, v0, v1
v_mul_f32 v119, v0, v0
v_add_f32 v118, v118, v2
v_fmac_f32 v119, v1, v1
v_add_f32 v118, v118, v3
v_fmac_f32_e64 v119, v2, v2
v_fmac_f32 v119, v3, v3
s_waitcnt lgkmcnt(5)
v_smfmac_f32_16x16x64_bf16 v[12:15], v[146:149], v[92:99], v213
s_add_u32 s28, s28, 32
s_cmp_ge_u32 s28, 73
s_cselect_b32 s21, 73, 0
s_cselect_b32 s22, 1177344, 0
s_sub_u32 s28, s28, s21
s_add_u32 s20, s20, s22
s_add_u32 s20, s20, 86016
s_add_u32 m0, s96, 102736
s_mov_b32 exec_hi, 4194303
buffer_load_dwordx4 v82, s[4:7], s20 offen nt lds
s_mov_b32 exec_hi, -1
s_waitcnt lgkmcnt(3)
v_smfmac_f32_16x16x64_bf16 v[24:27], v[146:149], v[100:107], v213
s_waitcnt lgkmcnt(2)
ds_read_b128 v[92:95], v201 offset:32
ds_read_b128 v[100:103], v202 offset:32
v_mfma_f32_16x16x32_bf16 v[4:7], v[150:153], v[84:87], 0
ds_read_b128 v[84:87], v194 offset:32
ds_read_b128 v[96:99], v195 offset:48
ds_read_b128 v[104:107], v196 offset:48
v_add_f32 v126, v12, v13
v_mul_f32 v127, v12, v12
v_add_f32 v126, v126, v14
v_fmac_f32 v127, v13, v13
v_add_f32 v126, v126, v15
v_fmac_f32 v127, v14, v14
v_fmac_f32 v127, v15, v15
v_add_f32 v134, v24, v25
v_mul_f32 v135, v24, v24
v_add_f32 v134, v134, v26
v_fmac_f32 v135, v25, v25
v_add_f32 v134, v134, v27
v_fmac_f32_e64 v135, v26, v26
v_fmac_f32 v135, v27, v27
s_waitcnt lgkmcnt(4)
v_mfma_f32_16x16x32_bf16 v[16:19], v[150:153], v[92:95], 0
ds_read_b128 v[92:95], v195 offset:32
s_mov_b64 exec, s[30:31]
ds_write_b128 v217, v[154:157] offset:2112
s_mov_b64 exec, -1
s_waitcnt lgkmcnt(5)
v_mfma_f32_16x16x32_bf16 v[28:31], v[150:153], v[100:103], 0
s_waitcnt lgkmcnt(4)
v_smfmac_f32_16x16x64_bf16 v[4:7], v[154:157], v[84:91], v213
ds_read_b128 v[100:103], v196 offset:32
ds_read_b128 v[84:87], v197 offset:32
ds_read_b128 v[88:91], v197 offset:48
s_mov_b64 exec, s[30:31]
ds_write_b128 v217, v[158:161] offset:2640
s_mov_b64 exec, -1
s_waitcnt lgkmcnt(5)
v_smfmac_f32_16x16x64_bf16 v[16:19], v[154:157], v[92:99], v213
s_add_u32 s28, s28, 32
s_cmp_ge_u32 s28, 73
s_cselect_b32 s21, 73, 0
s_cselect_b32 s22, 1177344, 0
s_sub_u32 s28, s28, s21
s_add_u32 s20, s20, s22
s_add_u32 s20, s20, 86016
s_add_u32 m0, s96, 106208
s_mov_b32 exec_hi, 4194303
buffer_load_dwordx4 v82, s[4:7], s20 offen nt lds
s_mov_b32 exec_hi, -1
s_waitcnt lgkmcnt(3)
v_smfmac_f32_16x16x64_bf16 v[28:31], v[154:157], v[100:107], v213
ds_read_b128 v[92:95], v198 offset:32
ds_read_b128 v[96:99], v198 offset:48
ds_read_b128 v[100:103], v199 offset:32
ds_read_b128 v[104:107], v199 offset:48
s_waitcnt lgkmcnt(5)
v_smfmac_f32_16x16x64_bf16 v[4:7], v[158:161], v[84:91], v213
ds_read_b128 v[84:87], v200 offset:64
ds_read_b128 v[88:91], v194 offset:80
s_mov_b64 exec, s[30:31]
ds_write_b128 v217, v[162:165] offset:3168
s_mov_b64 exec, -1
v_add_f32 v118, v118, v4
v_fmac_f32 v119, v4, v4
v_add_f32 v118, v118, v5
v_fmac_f32 v119, v5, v5
v_add_f32 v118, v118, v6
v_fmac_f32 v119, v6, v6
v_add_f32 v118, v118, v7
v_fmac_f32 v119, v7, v7
s_waitcnt lgkmcnt(5)
v_smfmac_f32_16x16x64_bf16 v[16:19], v[158:161], v[92:99], v213
s_nop 0
ds_read_b128 v[92:95], v201 offset:64
ds_read_b128 v[96:99], v195 offset:80
s_waitcnt lgkmcnt(5)
v_smfmac_f32_16x16x64_bf16 v[28:31], v[158:161], v[100:107], v213
ds_read_b128 v[100:103], v202 offset:64
s_waitcnt lgkmcnt(5)
v_mfma_f32_16x16x32_bf16 v[8:11], v[162:165], v[84:87], 0
ds_read_b128 v[84:87], v194 offset:64
v_add_f32 v126, v126, v16
v_fmac_f32 v127, v16, v16
v_add_f32 v126, v126, v17
v_fmac_f32 v127, v17, v17
v_add_f32 v126, v126, v18
v_fmac_f32 v127, v18, v18
v_add_f32 v126, v126, v19
v_fmac_f32 v127, v19, v19
v_add_f32 v134, v134, v28
v_fmac_f32 v135, v28, v28
v_add_f32 v134, v134, v29
v_fmac_f32 v135, v29, v29
v_add_f32 v134, v134, v30
s_add_u32 s28, s28, 32
s_cmp_ge_u32 s28, 73
s_cselect_b32 s21, 73, 0
s_cselect_b32 s22, 1177344, 0
s_sub_u32 s28, s28, s21
s_add_u32 s20, s20, s22
s_add_u32 s20, s20, 86016
s_add_u32 m0, s96, 109680
s_mov_b32 exec_hi, 4194303
buffer_load_dwordx4 v82, s[4:7], s20 offen nt lds
s_mov_b32 exec_hi, -1
s_waitcnt lgkmcnt(3)
v_mfma_f32_16x16x32_bf16 v[20:23], v[162:165], v[92:95], 0
s_waitcnt lgkmcnt(1)
ds_read_b128 v[92:95], v195 offset:64
ds_read_b128 v[104:107], v196 offset:80
v_mfma_f32_16x16x32_bf16 v[32:35], v[162:165], v[100:103], 0
s_waitcnt lgkmcnt(2)
ds_read_b128 v[100:103], v196 offset:64
v_fmac_f32 v135, v30, v30
v_smfmac_f32_16x16x64_bf16 v[8:11], v[166:169], v[84:91], v213
ds_read_b128 v[84:87], v197 offset:64
ds_read_b128 v[88:91], v197 offset:80
v_add_f32_e64 v134, v134, v31
v_fmac_f32 v135, v31, v31
s_mov_b64 exec, s[30:31]
ds_write_b128 v217, v[166:169] offset:3696
s_mov_b64 exec, -1
s_waitcnt lgkmcnt(5)
v_smfmac_f32_16x16x64_bf16 v[20:23], v[166:169], v[92:99], v213
ds_read_b128 v[92:95], v198 offset:64
ds_read_b128 v[96:99], v198 offset:80
s_mov_b64 exec, s[30:31]
ds_write_b128 v217, v[170:173] offset:4224
s_mov_b64 exec, -1
s_waitcnt lgkmcnt(6)
v_smfmac_f32_16x16x64_bf16 v[32:35], v[166:169], v[100:107], v213
s_waitcnt lgkmcnt(4)
v_smfmac_f32_16x16x64_bf16 v[8:11], v[170:173], v[84:91], v213
ds_read_b128 v[100:103], v199 offset:64
ds_read_b128 v[104:107], v199 offset:80
s_nop 4
v_add_f32 v118, v118, v8
v_fmac_f32_e64 v119, v8, v8
v_add_f32 v118, v118, v9
s_add_u32 s28, s28, 32
s_cmp_ge_u32 s28, 73
s_cselect_b32 s21, 73, 0
s_cselect_b32 s22, 1177344, 0
s_sub_u32 s28, s28, s21
s_add_u32 s20, s20, s22
s_add_u32 s20, s20, 86016
s_add_u32 m0, s96, 113152
s_mov_b32 exec_hi, 4194303
buffer_load_dwordx4 v82, s[4:7], s20 offen nt lds
s_mov_b32 exec_hi, -1
s_waitcnt lgkmcnt(3)
v_smfmac_f32_16x16x64_bf16 v[20:23], v[170:173], v[92:99], v213
v_fmac_f32 v119, v9, v9
v_add_f32 v118, v118, v10
v_fmac_f32 v119, v10, v10
v_add_f32 v118, v118, v11
v_fmac_f32 v119, v11, v11
s_nop 1
v_add_f32 v126, v126, v20
v_fmac_f32 v127, v20, v20
v_add_f32 v126, v126, v21
v_fmac_f32 v127, v21, v21
v_add_f32 v126, v126, v22
s_waitcnt lgkmcnt(0)
v_smfmac_f32_16x16x64_bf16 v[32:35], v[170:173], v[100:107], v213
v_fmac_f32 v127, v22, v22
v_add_f32 v126, v126, v23
v_fmac_f32 v127, v23, v23
v_permlane16_swap_b32 v118, v119
v_add_f32 v118, v118, v119
s_nop 0
v_add_f32 v134, v134, v32
v_fmac_f32 v135, v32, v32
v_add_f32 v134, v134, v33
v_fmac_f32 v135, v33, v33
v_add_f32 v134, v134, v34
v_fmac_f32 v135, v34, v34
v_add_f32 v134, v134, v35
v_fmac_f32 v135, v35, v35
v_permlane16_swap_b32 v126, v127
v_add_f32 v126, v126, v127
v_permlane16_swap_b32 v134, v135
v_add_f32 v134, v134, v135
v_permlane32_swap_b32 v118, v126
v_add_f32 v118, v118, v126
v_mov_b32 v135, v134
ds_write_b32 v209, v118
v_permlane32_swap_b32 v134, v135
v_add_f32 v134, v134, v135
ds_write_b32 v209, v134 offset:512
s_add_u32 s28, s28, 32
s_cmp_ge_u32 s28, 73
s_cselect_b32 s21, 73, 0
s_cselect_b32 s22, 1177344, 0
s_sub_u32 s28, s28, s21
s_add_u32 s20, s20, s22
s_add_u32 s20, s20, 86016
s_add_u32 m0, s96, 116624
s_mov_b32 exec_hi, 4194303
buffer_load_dwordx4 v82, s[4:7], s20 offen nt lds
s_mov_b32 exec_hi, -1
s_waitcnt lgkmcnt(0)
s_barrier
ds_read_b128 v[102:105], v210 offset:18432
ds_read_b128 v[106:109], v210 offset:19456
s_waitcnt lgkmcnt(1)
v_add_f32 v102, v102, v103
v_add_f32 v104, v104, v105
v_add_f32 v102, v102, v104
v_mul_f32 v103, s48, v102
v_mul_f32 v104, s73, v102
s_waitcnt lgkmcnt(0)
v_add_f32 v106, v106, v107
v_add_f32 v108, v108, v109
v_add_f32 v106, v106, v108
v_mul_f32 v106, s73, v106
v_fma_f32 v106, -v103, v104, v106
v_max_f32 v106, 0, v106
v_add_f32 v106, s49, v106
v_rsq_f32 v102, v106
s_nop 0
v_mul_f32_e64 v103, -v103, v102
ds_write_b64 v211, v[102:103]
ds_read_b64 v[118:119], v219
ds_read_b64 v[126:127], v219 offset:256
ds_read_b64 v[134:135], v219 offset:512
s_add_u32 s28, s28, 32
s_cmp_ge_u32 s28, 73
s_cselect_b32 s21, 73, 0
s_cselect_b32 s22, 1177344, 0
s_sub_u32 s28, s28, s21
s_add_u32 s20, s20, s22
s_add_u32 s20, s20, 86016
s_add_u32 m0, s96, 120096
s_mov_b32 exec_hi, 4194303
buffer_load_dwordx4 v82, s[4:7], s20 offen nt lds
s_mov_b32 exec_hi, -1
s_waitcnt lgkmcnt(2)
v_fma_f32 v220, v0, v118, v119
v_fma_f32 v221, v1, v118, v119
v_cvt_pk_bf16_f32 v90, v220, v221
v_fma_f32 v222, v2, v118, v119
v_fma_f32 v223, v3, v118, v119
v_cvt_pk_bf16_f32 v91, v222, v223
v_fma_f32 v220, v4, v118, v119
v_fma_f32 v221, v5, v118, v119
v_cvt_pk_bf16_f32 v92, v220, v221
v_fma_f32 v222, v6, v118, v119
v_fma_f32 v223, v7, v118, v119
v_cvt_pk_bf16_f32 v93, v222, v223
v_fma_f32 v220, v8, v118, v119
v_fma_f32 v221, v9, v118, v119
v_cvt_pk_bf16_f32 v94, v220, v221
v_fma_f32 v222, v10, v118, v119
v_fma_f32 v223, v11, v118, v119
v_cvt_pk_bf16_f32 v95, v222, v223
s_waitcnt lgkmcnt(0)
v_fma_f32 v220, v12, v126, v127
v_fma_f32 v221, v13, v126, v127
v_cvt_pk_bf16_f32 v174, v220, v221
v_fma_f32 v222, v14, v126, v127
v_fma_f32 v223, v15, v126, v127
v_cvt_pk_bf16_f32 v175, v222, v223
v_fma_f32 v220, v16, v126, v127
v_fma_f32 v221, v17, v126, v127
v_cvt_pk_bf16_f32 v176, v220, v221
v_fma_f32 v222, v18, v126, v127
v_fma_f32 v223, v19, v126, v127
v_cvt_pk_bf16_f32 v177, v222, v223
v_fma_f32 v220, v20, v126, v127
v_fma_f32 v221, v21, v126, v127
v_cvt_pk_bf16_f32 v178, v220, v221
v_fma_f32 v222, v22, v126, v127
v_fma_f32 v223, v23, v126, v127
v_cvt_pk_bf16_f32 v179, v222, v223
v_fma_f32 v220, v24, v134, v135
v_fma_f32 v221, v25, v134, v135
v_fma_f32 v222, v26, v134, v135
v_fma_f32 v223, v27, v134, v135
ds_write_b128 v211, v[90:93]
v_cvt_pk_bf16_f32 v90, v220, v221
v_cvt_pk_bf16_f32 v91, v222, v223
v_fma_f32 v220, v28, v134, v135
v_fma_f32 v221, v29, v134, v135
v_cvt_pk_bf16_f32 v92, v220, v221
s_add_u32 s28, s28, 32
s_cmp_ge_u32 s28, 73
s_cselect_b32 s21, 73, 0
s_cselect_b32 s22, 1177344, 0
s_sub_u32 s28, s28, s21
s_add_u32 s20, s20, s22
s_add_u32 s20, s20, 86016
s_add_u32 m0, s96, 123568
s_mov_b32 exec_hi, 4194303
buffer_load_dwordx4 v82, s[4:7], s20 offen nt lds
s_mov_b32 exec_hi, -1
s_add_u32 m0, s55, 131328
s_add_u32 s29, s54, 384
buffer_load_dwordx4 v72, s[12:15], s29 offen lds
s_add_u32 m0, s55, 132352
s_add_u32 s29, s54, 384
buffer_load_dwordx4 v73, s[12:15], s29 offen lds
s_add_u32 m0, s55, 133376
s_add_u32 s29, s54, 384
buffer_load_dwordx4 v74, s[12:15], s29 offen lds
ds_write_b64 v212, v[94:95]
s_add_u32 m0, s55, 0
s_add_u32 s29, s54, 37248
buffer_load_dwordx4 v72, s[12:15], s29 offen lds
ds_write_b128 v211, v[174:177] offset:6144
s_add_u32 m0, s55, 1024
s_add_u32 s29, s54, 37248
buffer_load_dwordx4 v73, s[12:15], s29 offen lds
s_add_u32 m0, s55, 2048
s_add_u32 s29, s54, 37248
buffer_load_dwordx4 v74, s[12:15], s29 offen lds
ds_write_b64 v212, v[178:179] offset:6144
v_fma_f32 v222, v30, v134, v135
v_fma_f32 v223, v31, v134, v135
v_cvt_pk_bf16_f32 v93, v222, v223
v_fma_f32 v220, v32, v134, v135
v_fma_f32 v221, v33, v134, v135
v_cvt_pk_bf16_f32 v94, v220, v221
v_fma_f32 v222, v34, v134, v135
v_fma_f32 v223, v35, v134, v135
v_cvt_pk_bf16_f32 v95, v222, v223
ds_write_b128 v211, v[90:93] offset:12288
s_add_u32 m0, s55, 12288
s_add_u32 s29, s54, 74112
buffer_load_dwordx4 v72, s[12:15], s29 offen lds
ds_write_b64 v212, v[94:95] offset:12288
s_add_u32 m0, s55, 13312
s_add_u32 s29, s54, 74112
buffer_load_dwordx4 v73, s[12:15], s29 offen lds
s_add_u32 m0, s55, 14336
s_add_u32 s29, s54, 74112
buffer_load_dwordx4 v74, s[12:15], s29 offen lds
s_add_u32 m0, s55, 24576
s_add_u32 s29, s54, 110976
buffer_load_dwordx4 v72, s[12:15], s29 offen lds
s_add_u32 m0, s55, 25600
s_add_u32 s29, s54, 110976
buffer_load_dwordx4 v73, s[12:15], s29 offen lds
s_add_u32 m0, s55, 26624
s_add_u32 s29, s54, 110976
buffer_load_dwordx4 v74, s[12:15], s29 offen lds
s_waitcnt vmcnt(3) lgkmcnt(0)
ds_read_b64_tr_b16 a[0:1], v110 offset:36864
ds_read_b64_tr_b16 a[24:25], v110 offset:36896
ds_read_b64_tr_b16 a[48:49], v110 offset:36928
ds_read_b64_tr_b16 a[2:3], v110 offset:38400
ds_read_b64_tr_b16 a[26:27], v110 offset:38432
ds_read_b64_tr_b16 a[50:51], v110 offset:38464
ds_read_b64_tr_b16 a[4:5], v128 offset:1536
ds_read_b64_tr_b16 a[28:29], v128 offset:1568
ds_read_b64_tr_b16 a[52:53], v128 offset:1600
ds_read_b64_tr_b16 a[16:17], v128
ds_read_b64_tr_b16 a[40:41], v128 offset:32
ds_read_b64_tr_b16 a[64:65], v128 offset:64
ds_read_b64_tr_b16 a[6:7], v128 offset:12288
s_barrier
ds_read_b64_tr_b16 a[30:31], v128 offset:12320
ds_read_b64_tr_b16 a[54:55], v128 offset:12352
ds_read_b64_tr_b16 a[18:19], v128 offset:13824
ds_read_b64_tr_b16 a[42:43], v128 offset:13856
ds_read_b64_tr_b16 a[66:67], v128 offset:13888
s_waitcnt vmcnt(1)
ds_read_b64_tr_b16 a[8:9], v128 offset:24576
ds_read_b64_tr_b16 a[32:33], v128 offset:24608
ds_read_b64_tr_b16 a[56:57], v128 offset:24640
s_waitcnt vmcnt(0)
ds_read_b64_tr_b16 a[10:11], v128 offset:26112
ds_read_b64_tr_b16 a[34:35], v128 offset:26144
ds_read_b64_tr_b16 a[58:59], v128 offset:26176
v_mov_b32 v128, v83
ds_read_b128 v[84:87], v113
ds_read_b128 v[92:95], v113 offset:55552
ds_read_b128 v[100:103], v111
ds_read_b128 v[104:107], v111 offset:16
ds_read_b128 v[88:91], v111 offset:55568
ds_read_b128 v[96:99], v112 offset:16
s_waitcnt lgkmcnt(5)
v_mfma_f32_16x16x32_bf16 v[36:39], v[138:141], v[84:87], 0
ds_read_b128 v[84:87], v111 offset:55552
s_waitcnt lgkmcnt(5)
v_mfma_f32_16x16x32_bf16 v[48:51], v[138:141], v[92:95], 0
s_nop 0
ds_read_b128 v[92:95], v112
s_waitcnt lgkmcnt(4)
v_smfmac_f32_16x16x64_bf16 v[36:39], v[142:145], v[100:107], v213
ds_read_b128 v[100:103], v112 offset:55552
ds_read_b128 v[104:107], v112 offset:55568
s_waitcnt lgkmcnt(3)
v_smfmac_f32_16x16x64_bf16 v[48:51], v[142:145], v[84:91], v213
ds_read_b128 v[84:87], v113 offset:32
ds_read_b128 v[88:91], v111 offset:55600
s_waitcnt lgkmcnt(4)
v_smfmac_f32_16x16x64_bf16 v[36:39], v[146:149], v[92:99], v213
ds_read_b128 v[92:95], v113 offset:55584
ds_read_b128 v[96:99], v112 offset:48
s_nop 4
v_add_f32 v118, v36, v37
v_mul_f32 v119, v36, v36
v_add_f32 v118, v118, v38
v_fmac_f32 v119, v37, v37
s_waitcnt lgkmcnt(4)
v_smfmac_f32_16x16x64_bf16 v[48:51], v[146:149], v[100:107], v213
ds_read_b128 v[100:103], v111 offset:32
ds_read_b128 v[104:107], v111 offset:48
v_add_f32 v118, v118, v39
v_fmac_f32 v119, v38, v38
v_fmac_f32 v119, v39, v39
s_waitcnt lgkmcnt(5)
v_mfma_f32_16x16x32_bf16 v[40:43], v[150:153], v[84:87], 0
ds_read_b128 v[84:87], v111 offset:55584
v_add_f32 v126, v48, v49
v_mul_f32 v127, v48, v48
v_add_f32_e64 v126, v126, v50
v_fmac_f32 v127, v49, v49
s_waitcnt lgkmcnt(4)
v_mfma_f32_16x16x32_bf16 v[52:55], v[150:153], v[92:95], 0
ds_read_b128 v[92:95], v112 offset:32
v_add_f32 v126, v126, v51
v_fmac_f32 v127, v50, v50
v_fmac_f32 v127, v51, v51
s_waitcnt lgkmcnt(2)
v_smfmac_f32_16x16x64_bf16 v[40:43], v[154:157], v[100:107], v213
s_nop 0
ds_read_b128 v[100:103], v112 offset:55584
ds_read_b128 v[104:107], v112 offset:55600
s_waitcnt lgkmcnt(3)
v_smfmac_f32_16x16x64_bf16 v[52:55], v[154:157], v[84:91], v213
ds_read_b128 v[84:87], v113 offset:64
ds_read_b128 v[88:91], v111 offset:55632
s_waitcnt lgkmcnt(4)
v_smfmac_f32_16x16x64_bf16 v[40:43], v[158:161], v[92:99], v213
ds_read_b128 v[92:95], v113 offset:55616
ds_read_b128 v[96:99], v112 offset:80
s_nop 4
v_add_f32 v118, v118, v40
v_fmac_f32 v119, v40, v40
v_add_f32 v118, v118, v41
v_fmac_f32 v119, v41, v41
v_add_f32 v118, v118, v42
v_fmac_f32 v119, v42, v42
v_add_f32 v118, v118, v43
v_fmac_f32 v119, v43, v43
s_waitcnt lgkmcnt(4)
v_smfmac_f32_16x16x64_bf16 v[52:55], v[158:161], v[100:107], v213
s_waitcnt lgkmcnt(3)
ds_read_b128 v[100:103], v111 offset:64
ds_read_b128 v[104:107], v111 offset:80
v_mfma_f32_16x16x32_bf16 v[44:47], v[162:165], v[84:87], 0
ds_read_b128 v[84:87], v111 offset:55616
s_waitcnt lgkmcnt(4)
v_mfma_f32_16x16x32_bf16 v[56:59], v[162:165], v[92:95], 0
ds_read_b128 v[92:95], v112 offset:64
v_add_f32 v126, v126, v52
v_fmac_f32 v127, v52, v52
v_add_f32 v126, v126, v53
v_fmac_f32 v127, v53, v53
v_add_f32 v126, v126, v54
v_fmac_f32 v127, v54, v54
v_add_f32 v126, v126, v55
v_fmac_f32 v127, v55, v55
s_waitcnt lgkmcnt(2)
v_smfmac_f32_16x16x64_bf16 v[44:47], v[166:169], v[100:107], v213
ds_read_b128 v[100:103], v112 offset:55616
ds_read_b128 v[104:107], v112 offset:55632
s_waitcnt lgkmcnt(3)
v_smfmac_f32_16x16x64_bf16 v[56:59], v[166:169], v[84:91], v213
s_waitcnt lgkmcnt(2)
v_smfmac_f32_16x16x64_bf16 v[44:47], v[170:173], v[92:99], v213
s_nop 7
v_add_f32 v118, v118, v44
v_fmac_f32 v119, v44, v44
v_add_f32 v118, v118, v45
v_fmac_f32 v119, v45, v45
v_add_f32 v118, v118, v46
v_fmac_f32 v119, v46, v46
v_add_f32 v118, v118, v47
v_fmac_f32 v119, v47, v47
s_waitcnt lgkmcnt(0)
v_smfmac_f32_16x16x64_bf16 v[56:59], v[170:173], v[100:107], v213
s_barrier
s_add_u32 m0, s55, 94464
s_add_u32 s29, s54, 147840
buffer_load_dwordx4 v72, s[12:15], s29 offen lds
s_add_u32 m0, s55, 95488
s_add_u32 s29, s54, 147840
buffer_load_dwordx4 v73, s[12:15], s29 offen lds
s_add_u32 m0, s55, 96512
s_add_u32 s29, s54, 147840
buffer_load_dwordx4 v74, s[12:15], s29 offen lds
s_add_u32 m0, s55, 106752
s_add_u32 s29, s54, 184704
buffer_load_dwordx4 v72, s[12:15], s29 offen lds
s_add_u32 m0, s55, 107776
s_add_u32 s29, s54, 184704
buffer_load_dwordx4 v73, s[12:15], s29 offen lds
s_nop 1
v_add_f32 v126, v126, v56
v_fmac_f32 v127, v56, v56
v_add_f32 v126, v126, v57
v_fmac_f32 v127, v57, v57
s_add_u32 m0, s55, 108800
s_add_u32 s29, s54, 184704
buffer_load_dwordx4 v74, s[12:15], s29 offen lds
v_add_f32 v126, v126, v58
v_fmac_f32 v127, v58, v58
v_add_f32 v126, v126, v59
v_fmac_f32 v127, v59, v59
v_permlane16_swap_b32 v118, v119
v_add_f32 v118, v118, v119
v_permlane16_swap_b32 v126, v127
v_add_f32 v126, v126, v127
s_add_u32 m0, s55, 119040
s_add_u32 s29, s54, 0
buffer_load_dwordx4 v72, s[12:15], s29 offen lds
s_nop 0
v_permlane32_swap_b32 v118, v126
v_add_f32 v118, v118, v126
ds_write_b32 v209, v118
s_add_u32 m0, s55, 120064
s_add_u32 s29, s54, 0
buffer_load_dwordx4 v73, s[12:15], s29 offen lds
s_waitcnt lgkmcnt(0)
s_barrier
ds_read_b128 v[102:105], v210 offset:18432
ds_read_b128 v[106:109], v210 offset:19456
s_add_u32 m0, s55, 121088
s_add_u32 s29, s54, 0
buffer_load_dwordx4 v74, s[12:15], s29 offen lds
s_add_u32 m0, s55, 69888
s_add_u32 s29, s54, 36864
buffer_load_dwordx4 v72, s[12:15], s29 offen lds
s_waitcnt lgkmcnt(0)
v_add_f32 v102, v102, v103
v_add_f32 v104, v104, v105
v_add_f32 v102, v102, v104
v_mul_f32 v103, s48, v102
v_mul_f32 v104, s73, v102
v_add_f32 v106, v106, v107
v_add_f32 v108, v108, v109
v_add_f32 v106, v106, v108
v_mul_f32 v106, s73, v106
v_fma_f32 v106, -v103, v104, v106
s_add_u32 m0, s55, 70912
s_add_u32 s29, s54, 36864
buffer_load_dwordx4 v73, s[12:15], s29 offen lds
v_max_f32 v106, 0, v106
v_add_f32 v106, s49, v106
v_rsq_f32_e64 v102, v106
s_nop 0
v_mul_f32_e64 v103, -v103, v102
ds_write_b64 v211, v[102:103] offset:20480
s_add_u32 m0, s55, 71936
s_add_u32 s29, s54, 36864
buffer_load_dwordx4 v74, s[12:15], s29 offen lds
ds_read_b64 v[118:119], v219 offset:20480
ds_read_b64 v[126:127], v219 offset:20736
s_add_u32 m0, s55, 82176
s_add_u32 s29, s54, 73728
buffer_load_dwordx4 v72, s[12:15], s29 offen lds
s_waitcnt vmcnt(11) lgkmcnt(1)
ds_read_b64_tr_b16 a[20:21], v110
ds_read_b64_tr_b16 a[44:45], v110 offset:32
ds_read_b64_tr_b16 a[68:69], v110 offset:64
v_fma_f32 v220, v36, v118, v119
v_fma_f32 v221, v37, v118, v119
v_cvt_pk_bf16_f32 v90, v220, v221
v_fma_f32 v222, v38, v118, v119
v_fma_f32 v223, v39, v118, v119
v_cvt_pk_bf16_f32 v91, v222, v223
v_fma_f32 v220, v40, v118, v119
v_fma_f32 v221, v41, v118, v119
s_add_u32 m0, s55, 83200
s_add_u32 s29, s54, 73728
buffer_load_dwordx4 v73, s[12:15], s29 offen lds
v_cvt_pk_bf16_f32 v92, v220, v221
v_fma_f32 v222, v42, v118, v119
s_waitcnt vmcnt(11)
ds_read_b64_tr_b16 a[12:13], v110 offset:1536
ds_read_b64_tr_b16 a[36:37], v110 offset:1568
ds_read_b64_tr_b16 a[60:61], v110 offset:1600
v_fma_f32 v223, v43, v118, v119
v_cvt_pk_bf16_f32 v93, v222, v223
v_fma_f32 v220, v44, v118, v119
v_fma_f32 v221, v45, v118, v119
v_cvt_pk_bf16_f32 v94, v220, v221
s_waitcnt lgkmcnt(6)
s_add_u32 m0, s55, 84224
s_add_u32 s29, s54, 73728
buffer_load_dwordx4 v74, s[12:15], s29 offen lds
ds_write_b128 v211, v[90:93] offset:20480
v_fma_f32 v222, v46, v118, v119
v_fma_f32 v223, v47, v118, v119
v_cvt_pk_bf16_f32 v95, v222, v223
v_fma_f32 v220, v48, v126, v127
v_fma_f32 v221, v49, v126, v127
v_cvt_pk_bf16_f32 v174, v220, v221
s_add_u32 m0, s55, 131328
s_add_u32 s29, s54, 110592
buffer_load_dwordx4 v72, s[12:15], s29 offen lds
ds_write_b64 v212, v[94:95] offset:20480
v_fma_f32 v222, v50, v126, v127
v_fma_f32 v223, v51, v126, v127
s_waitcnt vmcnt(11)
ds_read_b64_tr_b16 a[14:15], v110 offset:12288
ds_read_b64_tr_b16 a[38:39], v110 offset:12320
ds_read_b64_tr_b16 a[62:63], v110 offset:12352
v_cvt_pk_bf16_f32 v175, v222, v223
v_fma_f32 v220, v52, v126, v127
s_add_u32 m0, s55, 132352
s_add_u32 s29, s54, 110592
buffer_load_dwordx4 v73, s[12:15], s29 offen lds
v_fma_f32 v221, v53, v126, v127
v_cvt_pk_bf16_f32 v176, v220, v221
s_waitcnt vmcnt(11)
ds_read_b64_tr_b16 a[22:23], v110 offset:13824
ds_read_b64_tr_b16 a[46:47], v110 offset:13856
v_fma_f32 v222, v54, v126, v127
v_fma_f32 v223, v55, v126, v127
v_cvt_pk_bf16_f32 v177, v222, v223
v_fma_f32 v220, v56, v126, v127
v_fma_f32 v221, v57, v126, v127
v_cvt_pk_bf16_f32 v178, v220, v221
s_add_u32 m0, s55, 133376
s_add_u32 s29, s54, 110592
buffer_load_dwordx4 v74, s[12:15], s29 offen lds
v_fma_f32 v222, v58, v126, v127
v_fma_f32 v223, v59, v126, v127
v_cvt_pk_bf16_f32 v179, v222, v223
ds_read_b64_tr_b16 a[70:71], v110 offset:13888
ds_write_b128 v211, v[174:177] offset:26624
s_waitcnt lgkmcnt(9)
s_add_u32 m0, s55, 94464
s_add_u32 s29, s54, 147456
buffer_load_dwordx4 v72, s[12:15], s29 offen lds
s_waitcnt vmcnt(11)
ds_read_b64_tr_b16 a[216:217], v110 offset:24576
ds_read_b64_tr_b16 a[240:241], v110 offset:24608
ds_read_b64_tr_b16 v[232:233], v110 offset:24640
ds_write_b64 v212, v[178:179] offset:26624
ds_read_b128 v[174:177], v217
ds_read_b128 v[178:181], v217 offset:528
ds_read_b128 v[220:223], v210 offset:3072
s_add_u32 m0, s55, 95488
s_add_u32 s29, s54, 147456
buffer_load_dwordx4 v73, s[12:15], s29 offen lds
s_waitcnt vmcnt(11)
ds_read_b64_tr_b16 a[218:219], v110 offset:26112
ds_read_b64_tr_b16 a[242:243], v110 offset:26144
ds_read_b64_tr_b16 v[234:235], v110 offset:26176
s_waitcnt lgkmcnt(6)
s_add_u32 m0, s55, 96512
s_add_u32 s29, s54, 147456
buffer_load_dwordx4 v74, s[12:15], s29 offen lds
s_barrier
ds_read_b128 v[182:185], v210 offset:20480
ds_read_b128 v[186:189], v210 offset:26624
ds_read_b128 v[114:117], v210 offset:21504
ds_read_b128 v[122:125], v210 offset:27648
s_add_u32 m0, s55, 106752
s_add_u32 s29, s54, 184320
buffer_load_dwordx4 v72, s[12:15], s29 offen lds
s_waitcnt vmcnt(11)
ds_read_b64_tr_b16 a[232:233], v129
ds_read_b64_tr_b16 v[224:225], v129 offset:32
ds_read_b64_tr_b16 v[248:249], v129 offset:64
s_waitcnt lgkmcnt(6)
v_mfma_f32_16x16x32_bf16 v[138:141], a[0:3], v[182:185], 0
v_mfma_f32_16x16x32_bf16 v[142:145], a[24:27], v[182:185], 0
s_add_u32 m0, s55, 107776
s_add_u32 s29, s54, 184320
buffer_load_dwordx4 v73, s[12:15], s29 offen lds
v_mfma_f32_16x16x32_bf16 v[146:149], a[48:51], v[182:185], 0
s_waitcnt vmcnt(11) lgkmcnt(4)
ds_read_b64_tr_b16 a[220:221], v129 offset:1536
ds_read_b64_tr_b16 a[244:245], v129 offset:1568
v_mfma_f32_16x16x32_bf16 v[146:149], a[52:55], v[114:117], v[146:149]
ds_read_b64_tr_b16 v[236:237], v129 offset:1600
ds_read_b128 v[182:185], v210 offset:24576
v_mfma_f32_16x16x32_bf16 v[150:153], a[0:3], v[186:189], 0
s_waitcnt lgkmcnt(7)
v_mfma_f32_16x16x32_bf16 v[150:153], a[4:7], v[122:125], v[150:153]
s_add_u32 m0, s55, 108800
s_add_u32 s29, s54, 184320
buffer_load_dwordx4 v74, s[12:15], s29 offen lds
v_mfma_f32_16x16x32_bf16 v[154:157], a[24:27], v[186:189], 0
v_mfma_f32_16x16x32_bf16 v[154:157], a[28:31], v[122:125], v[154:157]
v_mfma_f32_16x16x32_bf16 v[158:161], a[48:51], v[186:189], 0
ds_read_b128 v[186:189], v210 offset:30720
v_mfma_f32_16x16x32_bf16 v[158:161], a[52:55], v[122:125], v[158:161]
s_add_u32 m0, s55, 119040
s_add_u32 s29, s54, 768
buffer_load_dwordx4 v72, s[12:15], s29 offen lds
v_mfma_f32_16x16x32_bf16 v[138:141], a[4:7], v[114:117], v[138:141]
s_waitcnt vmcnt(11) lgkmcnt(1)
ds_read_b64_tr_b16 a[222:223], v129 offset:12288
ds_read_b64_tr_b16 a[246:247], v129 offset:12320
v_mfma_f32_16x16x32_bf16 v[138:141], a[16:19], v[182:185], v[138:141]
ds_read_b64_tr_b16 v[238:239], v129 offset:12352
ds_read_b128 v[122:125], v210 offset:28672
v_mfma_f32_16x16x32_bf16 v[142:145], a[28:31], v[114:117], v[142:145]
ds_read_b128 v[114:117], v210 offset:22528
v_mfma_f32_16x16x32_bf16 v[142:145], a[40:43], v[182:185], v[142:145]
s_nop 0
s_add_u32 m0, s55, 120064
s_add_u32 s29, s54, 768
buffer_load_dwordx4 v73, s[12:15], s29 offen lds
v_mfma_f32_16x16x32_bf16 v[146:149], a[64:67], v[182:185], v[146:149]
s_waitcnt vmcnt(11) lgkmcnt(5)
ds_read_b64_tr_b16 a[234:235], v129 offset:13824
ds_read_b64_tr_b16 v[226:227], v129 offset:13856
v_mfma_f32_16x16x32_bf16 v[150:153], a[16:19], v[186:189], v[150:153]
ds_read_b64_tr_b16 v[250:251], v129 offset:13888
ds_read_b128 v[182:185], v210 offset:23552
v_mfma_f32_16x16x32_bf16 v[154:157], a[40:43], v[186:189], v[154:157]
s_waitcnt lgkmcnt(5)
v_mfma_f32_16x16x32_bf16 v[154:157], a[32:35], v[122:125], v[154:157]
s_add_u32 m0, s55, 121088
s_add_u32 s29, s54, 768
buffer_load_dwordx4 v74, s[12:15], s29 offen lds
v_mfma_f32_16x16x32_bf16 v[158:161], a[64:67], v[186:189], v[158:161]
ds_read_b128 v[186:189], v210 offset:29696
v_mfma_f32_16x16x32_bf16 v[158:161], a[56:59], v[122:125], v[158:161]
s_waitcnt lgkmcnt(5)
v_mfma_f32_16x16x32_bf16 v[138:141], a[8:11], v[114:117], v[138:141]
s_waitcnt lgkmcnt(1)
v_mfma_f32_16x16x32_bf16 v[138:141], a[12:15], v[182:185], v[138:141]
s_add_u32 m0, s55, 69888
s_add_u32 s29, s54, 37632
buffer_load_dwordx4 v72, s[12:15], s29 offen lds
v_mfma_f32_16x16x32_bf16 v[142:145], a[32:35], v[114:117], v[142:145]
s_waitcnt vmcnt(11)
ds_read_b64_tr_b16 a[224:225], v110 offset:36864
ds_read_b64_tr_b16 a[248:249], v110 offset:36896
v_mfma_f32_16x16x32_bf16 v[142:145], a[36:39], v[182:185], v[142:145]
ds_read_b64_tr_b16 v[240:241], v110 offset:36928
v_mfma_f32_16x16x32_bf16 v[146:149], a[56:59], v[114:117], v[146:149]
ds_read_b128 v[114:117], v210 offset:25600
v_mfma_f32_16x16x32_bf16 v[146:149], a[60:63], v[182:185], v[146:149]
s_nop 0
s_add_u32 m0, s55, 70912
s_add_u32 s29, s54, 37632
buffer_load_dwordx4 v73, s[12:15], s29 offen lds
v_mfma_f32_16x16x32_bf16 v[150:153], a[8:11], v[122:125], v[150:153]
s_waitcnt vmcnt(11) lgkmcnt(4)
ds_read_b64_tr_b16 a[226:227], v110 offset:38400
ds_read_b64_tr_b16 a[250:251], v110 offset:38432
v_mfma_f32_16x16x32_bf16 v[150:153], a[12:15], v[186:189], v[150:153]
ds_read_b64_tr_b16 v[242:243], v110 offset:38464
ds_read_b128 v[122:125], v210 offset:31744
v_mfma_f32_16x16x32_bf16 v[154:157], a[36:39], v[186:189], v[154:157]
s_nop 0
ds_read_b128 v[182:185], v210 offset:20480
v_mfma_f32_16x16x32_bf16 v[158:161], a[60:63], v[186:189], v[158:161]
s_waitcnt lgkmcnt(5)
s_add_u32 m0, s55, 71936
s_add_u32 s29, s54, 37632
buffer_load_dwordx4 v74, s[12:15], s29 offen lds
v_mfma_f32_16x16x32_bf16 v[138:141], a[20:23], v[114:117], v[138:141]
ds_read_b128 v[186:189], v210 offset:26624
v_mfma_f32_16x16x32_bf16 v[142:145], a[44:47], v[114:117], v[142:145]
v_mfma_f32_16x16x32_bf16 v[146:149], a[68:71], v[114:117], v[146:149]
ds_read_b128 v[114:117], v210 offset:21504
v_cvt_pk_bf16_f32 v60, v138, v139
v_cvt_pk_bf16_f32 v61, v140, v141
v_cvt_pk_bf16_f32 v62, v142, v143
s_waitcnt lgkmcnt(3)
v_mfma_f32_16x16x32_bf16 v[150:153], a[20:23], v[122:125], v[150:153]
s_add_u32 m0, s55, 82176
s_add_u32 s29, s54, 74496
buffer_load_dwordx4 v72, s[12:15], s29 offen lds
v_mfma_f32_16x16x32_bf16 v[154:157], a[44:47], v[122:125], v[154:157]
s_waitcnt vmcnt(11)
ds_read_b64_tr_b16 a[236:237], v110
ds_read_b64_tr_b16 v[228:229], v110 offset:32
v_mfma_f32_16x16x32_bf16 v[158:161], a[68:71], v[122:125], v[158:161]
s_waitcnt lgkmcnt(4)
ds_read_b64_tr_b16 v[252:253], v110 offset:64
ds_read_b128 v[122:125], v210 offset:27648
v_mfma_f32_16x16x32_bf16 v[162:165], a[216:219], v[182:185], 0
s_waitcnt lgkmcnt(4)
v_cvt_pk_bf16_f32 v63, v144, v145
v_cvt_pk_bf16_f32 v64, v146, v147
v_mfma_f32_16x16x32_bf16 v[162:165], a[220:223], v[114:117], v[162:165]
s_nop 0
s_add_u32 m0, s55, 83200
s_add_u32 s29, s54, 74496
buffer_load_dwordx4 v73, s[12:15], s29 offen lds
v_mfma_f32_16x16x32_bf16 v[166:169], a[240:243], v[182:185], 0
s_waitcnt vmcnt(11)
ds_read_b64_tr_b16 a[228:229], v110 offset:1536
ds_read_b64_tr_b16 a[252:253], v110 offset:1568
v_mfma_f32_16x16x32_bf16 v[166:169], a[244:247], v[114:117], v[166:169]
ds_read_b64_tr_b16 v[244:245], v110 offset:1600
v_cvt_pk_bf16_f32 v65, v148, v149
v_mfma_f32_16x16x32_bf16 v[170:173], v[232:235], v[182:185], 0
ds_read_b128 v[182:185], v210 offset:24576
s_add_u32 m0, s55, 84224
s_add_u32 s29, s54, 74496
buffer_load_dwordx4 v74, s[12:15], s29 offen lds
v_mfma_f32_16x16x32_bf16 v[170:173], v[236:239], v[114:117], v[170:173]
s_nop 0
ds_read_b128 v[114:117], v210 offset:22528
v_cvt_pk_bf16_f32 v66, v150, v151
v_mfma_f32_16x16x32_bf16 v[138:141], a[216:219], v[186:189], 0
s_waitcnt lgkmcnt(5)
v_cvt_pk_bf16_f32 v67, v152, v153
v_cvt_pk_bf16_f32 v68, v154, v155
v_mfma_f32_16x16x32_bf16 v[138:141], a[220:223], v[122:125], v[138:141]
v_cvt_pk_bf16_f32 v69, v156, v157
v_cvt_pk_bf16_f32 v70, v158, v159
v_mfma_f32_16x16x32_bf16 v[142:145], a[240:243], v[186:189], 0
s_nop 0
s_add_u32 m0, s55, 131328
s_add_u32 s29, s54, 111360
buffer_load_dwordx4 v72, s[12:15], s29 offen lds
v_mfma_f32_16x16x32_bf16 v[142:145], a[244:247], v[122:125], v[142:145]
s_waitcnt vmcnt(11)
ds_read_b64_tr_b16 a[230:231], v110 offset:12288
ds_read_b64_tr_b16 a[254:255], v110 offset:12320
v_mfma_f32_16x16x32_bf16 v[146:149], v[232:235], v[186:189], 0
s_nop 0
ds_read_b64_tr_b16 v[246:247], v110 offset:12352
ds_read_b128 v[186:189], v210 offset:30720
v_mfma_f32_16x16x32_bf16 v[146:149], v[236:239], v[122:125], v[146:149]
s_waitcnt lgkmcnt(5)
ds_read_b128 v[122:125], v210 offset:28672
v_cvt_pk_bf16_f32 v71, v160, v161
v_mfma_f32_16x16x32_bf16 v[162:165], a[232:235], v[182:185], v[162:165]
s_waitcnt lgkmcnt(5)
s_add_u32 m0, s55, 132352
s_add_u32 s29, s54, 111360
buffer_load_dwordx4 v73, s[12:15], s29 offen lds
v_mfma_f32_16x16x32_bf16 v[162:165], a[224:227], v[114:117], v[162:165]
s_waitcnt vmcnt(11)
ds_read_b64_tr_b16 a[238:239], v110 offset:13824
ds_read_b64_tr_b16 v[230:231], v110 offset:13856
v_mfma_f32_16x16x32_bf16 v[166:169], v[224:227], v[182:185], v[166:169]
ds_read_b64_tr_b16 v[254:255], v110 offset:13888
v_mfma_f32_16x16x32_bf16 v[166:169], a[248:251], v[114:117], v[166:169]
v_mfma_f32_16x16x32_bf16 v[170:173], v[248:251], v[182:185], v[170:173]
s_nop 0
s_add_u32 m0, s55, 133376
s_add_u32 s29, s54, 111360
buffer_load_dwordx4 v74, s[12:15], s29 offen lds
v_mfma_f32_16x16x32_bf16 v[170:173], v[240:243], v[114:117], v[170:173]
s_waitcnt lgkmcnt(4)
ds_read_b128 v[182:185], v210 offset:23552
ds_read_b128 v[114:117], v210 offset:25600
v_mfma_f32_16x16x32_bf16 v[138:141], a[232:235], v[186:189], v[138:141]
s_waitcnt lgkmcnt(5)
v_mfma_f32_16x16x32_bf16 v[138:141], a[224:227], v[122:125], v[138:141]
v_mfma_f32_16x16x32_bf16 v[142:145], v[224:227], v[186:189], v[142:145]
s_add_u32 m0, s55, 94464
s_add_u32 s29, s54, 148224
buffer_load_dwordx4 v72, s[12:15], s29 offen lds
v_mfma_f32_16x16x32_bf16 v[142:145], a[248:251], v[122:125], v[142:145]
s_waitcnt vmcnt(11)
ds_read_b64_tr_b16 a[72:73], v110 offset:24576
ds_read_b64_tr_b16 a[96:97], v110 offset:24608
v_mfma_f32_16x16x32_bf16 v[146:149], v[248:251], v[186:189], v[146:149]
ds_read_b64_tr_b16 a[120:121], v110 offset:24640
ds_read_b128 v[186:189], v210 offset:29696
v_mfma_f32_16x16x32_bf16 v[146:149], v[240:243], v[122:125], v[146:149]
s_nop 0
ds_read_b128 v[122:125], v210 offset:31744
s_waitcnt lgkmcnt(6)
v_mfma_f32_16x16x32_bf16 v[162:165], a[228:231], v[182:185], v[162:165]
s_waitcnt lgkmcnt(5)
s_add_u32 m0, s55, 95488
s_add_u32 s29, s54, 148224
buffer_load_dwordx4 v73, s[12:15], s29 offen lds
v_mfma_f32_16x16x32_bf16 v[162:165], a[236:239], v[114:117], v[162:165]
s_waitcnt vmcnt(11)
ds_read_b64_tr_b16 a[74:75], v110 offset:26112
ds_read_b64_tr_b16 a[98:99], v110 offset:26144
v_mfma_f32_16x16x32_bf16 v[166:169], a[252:255], v[182:185], v[166:169]
ds_read_b64_tr_b16 a[122:123], v110 offset:26176
v_mfma_f32_16x16x32_bf16 v[166:169], v[228:231], v[114:117], v[166:169]
v_cvt_pk_bf16_f32 v84, v162, v163
v_cvt_pk_bf16_f32 v85, v164, v165
v_mfma_f32_16x16x32_bf16 v[170:173], v[244:247], v[182:185], v[170:173]
s_add_u32 m0, s55, 96512
s_add_u32 s29, s54, 148224
buffer_load_dwordx4 v74, s[12:15], s29 offen lds
v_mfma_f32_16x16x32_bf16 v[170:173], v[252:255], v[114:117], v[170:173]
s_waitcnt lgkmcnt(4)
ds_read_b128 v[182:185], v210 offset:20480
ds_read_b128 v[114:117], v210 offset:21504
v_mfma_f32_16x16x32_bf16 v[138:141], a[228:231], v[186:189], v[138:141]
s_waitcnt lgkmcnt(5)
v_cvt_pk_bf16_f32 v86, v166, v167
v_cvt_pk_bf16_f32 v87, v168, v169
v_mfma_f32_16x16x32_bf16 v[138:141], a[236:239], v[122:125], v[138:141]
v_cvt_pk_bf16_f32 v88, v170, v171
v_cvt_pk_bf16_f32 v89, v172, v173
v_mfma_f32_16x16x32_bf16 v[142:145], a[252:255], v[186:189], v[142:145]
s_nop 0
s_add_u32 m0, s55, 106752
s_add_u32 s29, s54, 185088
buffer_load_dwordx4 v72, s[12:15], s29 offen lds
v_mfma_f32_16x16x32_bf16 v[142:145], v[228:231], v[122:125], v[142:145]
s_waitcnt vmcnt(11)
ds_read_b64_tr_b16 a[88:89], v129
ds_read_b64_tr_b16 a[112:113], v129 offset:32
v_mfma_f32_16x16x32_bf16 v[146:149], v[244:247], v[186:189], v[146:149]
s_nop 0
ds_read_b64_tr_b16 a[136:137], v129 offset:64
ds_read_b128 v[186:189], v210 offset:26624
v_mfma_f32_16x16x32_bf16 v[146:149], v[252:255], v[122:125], v[146:149]
s_waitcnt lgkmcnt(5)
ds_read_b128 v[122:125], v210 offset:27648
v_cvt_pk_bf16_f32 v96, v138, v139
v_mfma_f32_16x16x32_bf16 v[150:153], a[72:75], v[182:185], 0
s_nop 0
s_add_u32 m0, s55, 107776
s_add_u32 s29, s54, 185088
buffer_load_dwordx4 v73, s[12:15], s29 offen lds
v_mfma_f32_16x16x32_bf16 v[154:157], a[96:99], v[182:185], 0
s_waitcnt vmcnt(11)
ds_read_b64_tr_b16 a[76:77], v129 offset:1536
ds_read_b64_tr_b16 a[100:101], v129 offset:1568
v_mfma_f32_16x16x32_bf16 v[158:161], a[120:123], v[182:185], 0
ds_read_b64_tr_b16 a[124:125], v129 offset:1600
ds_read_b128 v[182:185], v210 offset:24576
v_cvt_pk_bf16_f32 v97, v140, v141
v_cvt_pk_bf16_f32 v98, v142, v143
v_cvt_pk_bf16_f32 v99, v144, v145
v_cvt_pk_bf16_f32 v100, v146, v147
v_cvt_pk_bf16_f32 v101, v148, v149
s_waitcnt lgkmcnt(5)
v_mfma_f32_16x16x32_bf16 v[162:165], a[72:75], v[186:189], 0
s_add_u32 m0, s55, 108800
s_add_u32 s29, s54, 185088
buffer_load_dwordx4 v74, s[12:15], s29 offen lds
v_mfma_f32_16x16x32_bf16 v[166:169], a[96:99], v[186:189], 0
v_mfma_f32_16x16x32_bf16 v[170:173], a[120:123], v[186:189], 0
ds_read_b128 v[186:189], v210 offset:30720
s_add_u32 m0, s45, 0
s_nop 0
buffer_load_dwordx4 v216, s[4:7], s52 offen nt lds
s_waitcnt vmcnt(11)
ds_read_b64_tr_b16 a[78:79], v129 offset:12288
ds_read_b64_tr_b16 a[102:103], v129 offset:12320
ds_read_b64_tr_b16 a[126:127], v129 offset:12352
s_add_u32 m0, s45, 4112
s_add_u32 s40, s37, 196224
buffer_load_dwordx4 v216, s[4:7], s40 offen nt lds
s_waitcnt vmcnt(11)
ds_read_b64_tr_b16 a[90:91], v129 offset:13824
ds_read_b64_tr_b16 a[114:115], v129 offset:13856
ds_read_b64_tr_b16 a[138:139], v129 offset:13888
s_waitcnt lgkmcnt(5)
v_mfma_f32_16x16x32_bf16 v[150:153], a[76:79], v[114:117], v[150:153]
s_waitcnt lgkmcnt(4)
v_mfma_f32_16x16x32_bf16 v[154:157], a[100:103], v[114:117], v[154:157]
s_waitcnt lgkmcnt(3)
s_add_u32 m0, s45, 8224
s_add_u32 s40, s37, 392448
buffer_load_dwordx4 v216, s[4:7], s40 offen nt lds
v_mfma_f32_16x16x32_bf16 v[158:161], a[124:127], v[114:117], v[158:161]
ds_read_b128 v[114:117], v210 offset:22528
v_mfma_f32_16x16x32_bf16 v[162:165], a[76:79], v[122:125], v[162:165]
s_waitcnt lgkmcnt(3)
v_mfma_f32_16x16x32_bf16 v[162:165], a[88:91], v[186:189], v[162:165]
s_add_u32 m0, s45, 12336
s_add_u32 s40, s37, 588672
buffer_load_dwordx4 v216, s[4:7], s40 offen nt lds
v_mfma_f32_16x16x32_bf16 v[166:169], a[100:103], v[122:125], v[166:169]
s_waitcnt lgkmcnt(2)
v_mfma_f32_16x16x32_bf16 v[166:169], a[112:115], v[186:189], v[166:169]
s_waitcnt vmcnt(11)
ds_read_b64_tr_b16 a[80:81], v110 offset:36864
v_mfma_f32_16x16x32_bf16 v[170:173], a[124:127], v[122:125], v[170:173]
s_waitcnt lgkmcnt(2)
ds_read_b64_tr_b16 a[104:105], v110 offset:36896
ds_read_b64_tr_b16 a[128:129], v110 offset:36928
v_mfma_f32_16x16x32_bf16 v[170:173], a[136:139], v[186:189], v[170:173]
s_add_u32 m0, s45, 16448
s_add_u32 s40, s37, 784896
buffer_load_dwordx4 v216, s[4:7], s40 offen nt lds
v_mfma_f32_16x16x32_bf16 v[150:153], a[88:91], v[182:185], v[150:153]
s_nop 0
ds_read_b128 v[122:125], v210 offset:28672
ds_read_b128 v[186:189], v210 offset:29696
v_mfma_f32_16x16x32_bf16 v[154:157], a[112:115], v[182:185], v[154:157]
s_waitcnt vmcnt(11)
ds_read_b64_tr_b16 a[82:83], v110 offset:38400
v_mfma_f32_16x16x32_bf16 v[158:161], a[136:139], v[182:185], v[158:161]
s_add_u32 m0, s45, 20560
s_add_u32 s40, s37, 981120
buffer_load_dwordx4 v216, s[4:7], s40 offen nt lds
ds_read_b64_tr_b16 a[106:107], v110 offset:38432
ds_read_b64_tr_b16 a[130:131], v110 offset:38464
ds_read_b128 v[182:185], v210 offset:23552
s_add_u32 m0, s45, 24672
s_add_u32 s40, s37, 1177344
buffer_load_dwordx4 v216, s[4:7], s40 offen nt lds
s_waitcnt lgkmcnt(3)
v_mfma_f32_16x16x32_bf16 v[150:153], a[80:83], v[114:117], v[150:153]
s_waitcnt lgkmcnt(2)
v_mfma_f32_16x16x32_bf16 v[154:157], a[104:107], v[114:117], v[154:157]
s_waitcnt lgkmcnt(1)
v_mfma_f32_16x16x32_bf16 v[158:161], a[128:131], v[114:117], v[158:161]
ds_read_b128 v[114:117], v210 offset:25600
s_add_u32 m0, s45, 28784
s_add_u32 s40, s37, 1373568
buffer_load_dwordx4 v216, s[4:7], s40 offen nt lds
v_mfma_f32_16x16x32_bf16 v[162:165], a[80:83], v[122:125], v[162:165]
s_waitcnt vmcnt(12)
ds_read_b64_tr_b16 a[92:93], v110
ds_read_b64_tr_b16 a[116:117], v110 offset:32
v_mfma_f32_16x16x32_bf16 v[166:169], a[104:107], v[122:125], v[166:169]
ds_read_b64_tr_b16 a[140:141], v110 offset:64
v_mfma_f32_16x16x32_bf16 v[170:173], a[128:131], v[122:125], v[170:173]
ds_read_b128 v[122:125], v210 offset:31744
s_add_u32 m0, s45, 32896
s_add_u32 s40, s37, 1569792
buffer_load_dwordx4 v216, s[4:7], s40 offen nt lds
s_waitcnt vmcnt(12)
ds_read_b64_tr_b16 a[84:85], v110 offset:1536
ds_read_b64_tr_b16 a[108:109], v110 offset:1568
ds_read_b64_tr_b16 a[132:133], v110 offset:1600
s_add_u32 m0, s55, 69888
s_add_u32 s29, s54, 0
buffer_load_dwordx4 v136, s[16:19], s29 offen lds
s_add_u32 m0, s55, 70912
s_add_u32 s29, s54, 0
buffer_load_dwordx4 v137, s[16:19], s29 offen lds
s_waitcnt vmcnt(12)
ds_read_b64_tr_b16 a[86:87], v110 offset:12288
ds_read_b64_tr_b16 a[110:111], v110 offset:12320
ds_read_b64_tr_b16 a[134:135], v110 offset:12352
s_add_u32 m0, s55, 71936
s_add_u32 s29, s54, 0
buffer_load_dwordx4 v128, s[16:19], s29 offen lds
s_waitcnt vmcnt(12)
ds_read_b64_tr_b16 a[94:95], v110 offset:13824
ds_read_b64_tr_b16 a[118:119], v110 offset:13856
ds_read_b64_tr_b16 a[142:143], v110 offset:13888
ds_read_b128 v[110:113], v210 offset:2048
s_waitcnt lgkmcnt(6)
v_mfma_f32_16x16x32_bf16 v[150:153], a[84:87], v[182:185], v[150:153]
s_waitcnt lgkmcnt(5)
v_mfma_f32_16x16x32_bf16 v[154:157], a[108:111], v[182:185], v[154:157]
s_waitcnt lgkmcnt(4)
v_mfma_f32_16x16x32_bf16 v[158:161], a[132:135], v[182:185], v[158:161]
s_add_u32 m0, s55, 82176
s_add_u32 s29, s54, 12288
buffer_load_dwordx4 v136, s[16:19], s29 offen lds
v_mfma_f32_16x16x32_bf16 v[162:165], a[84:87], v[186:189], v[162:165]
ds_read_b128 v[182:185], v210
s_waitcnt lgkmcnt(2)
v_mfma_f32_16x16x32_bf16 v[162:165], a[92:95], v[122:125], v[162:165]
s_barrier
v_mfma_f32_16x16x32_bf16 v[166:169], a[108:111], v[186:189], v[166:169]
s_nop 0
ds_write_b128 v121, v[36:39]
v_mfma_f32_16x16x32_bf16 v[166:169], a[116:119], v[122:125], v[166:169]
s_add_u32 m0, s55, 83200
s_add_u32 s29, s54, 12288
buffer_load_dwordx4 v137, s[16:19], s29 offen lds
v_mfma_f32_16x16x32_bf16 v[170:173], a[132:135], v[186:189], v[170:173]
v_cvt_pk_bf16_f32 v102, v162, v163
v_cvt_pk_bf16_f32 v103, v164, v165
v_mfma_f32_16x16x32_bf16 v[170:173], a[140:143], v[122:125], v[170:173]
v_cvt_pk_bf16_f32 v104, v166, v167
v_cvt_pk_bf16_f32 v105, v168, v169
v_mfma_f32_16x16x32_bf16 v[150:153], a[92:95], v[114:117], v[150:153]
s_add_u32 m0, s55, 84224
s_add_u32 s29, s54, 12288
buffer_load_dwordx4 v128, s[16:19], s29 offen lds
v_mfma_f32_16x16x32_bf16 v[154:157], a[116:119], v[114:117], v[154:157]
v_cvt_pk_bf16_f32 v106, v170, v171
s_nop 1
v_cvt_pk_bf16_f32 v90, v150, v151
v_mfma_f32_16x16x32_bf16 v[158:161], a[140:143], v[114:117], v[158:161]
s_waitcnt lgkmcnt(1)
v_cvt_pk_bf16_f32 v91, v152, v153
v_cvt_pk_bf16_f32 v107, v172, v173
v_mfma_f32_16x16x32_bf16 v[138:141], a[0:3], v[182:185], 0
v_cvt_pk_bf16_f32 v92, v154, v155
v_cvt_pk_bf16_f32 v93, v156, v157
v_mfma_f32_16x16x32_bf16 v[142:145], a[24:27], v[182:185], 0
v_cvt_pk_bf16_f32 v94, v158, v159
v_cvt_pk_bf16_f32 v95, v160, v161
v_mfma_f32_16x16x32_bf16 v[146:149], a[48:51], v[182:185], 0
ds_read_b128 v[186:189], v210 offset:1024
ds_write_b128 v121, v[40:43] offset:64
v_mfma_f32_16x16x32_bf16 v[150:153], a[216:219], v[182:185], 0
v_mfma_f32_16x16x32_bf16 v[154:157], a[240:243], v[182:185], 0
v_mfma_f32_16x16x32_bf16 v[158:161], v[232:235], v[182:185], 0
s_nop 0
ds_write_b128 v121, v[44:47] offset:128
v_mfma_f32_16x16x32_bf16 v[162:165], v[182:185], a[72:75], 0
s_waitcnt lgkmcnt(2)
v_mfma_f32_16x16x32_bf16 v[138:141], a[4:7], v[186:189], v[138:141]
v_mfma_f32_16x16x32_bf16 v[142:145], a[28:31], v[186:189], v[142:145]
ds_write_b128 v120, v[84:87]
v_mfma_f32_16x16x32_bf16 v[146:149], a[52:55], v[186:189], v[146:149]
v_mfma_f32_16x16x32_bf16 v[150:153], a[220:223], v[186:189], v[150:153]
v_mfma_f32_16x16x32_bf16 v[154:157], a[244:247], v[186:189], v[154:157]
ds_write_b64 v120, v[88:89] offset:16
v_mfma_f32_16x16x32_bf16 v[158:161], v[236:239], v[186:189], v[158:161]
v_mfma_f32_16x16x32_bf16 v[162:165], v[186:189], a[76:79], v[162:165]
ds_write_b128 v120, v[60:63] offset:512
v_mfma_f32_16x16x32_bf16 v[166:169], v[182:185], a[96:99], 0
v_mfma_f32_16x16x32_bf16 v[166:169], v[186:189], a[100:103], v[166:169]
v_mfma_f32_16x16x32_bf16 v[170:173], v[182:185], a[120:123], 0
ds_read_b128 v[182:185], v210 offset:4096
ds_write_b64 v120, v[64:65] offset:528
v_mfma_f32_16x16x32_bf16 v[170:173], v[186:189], a[124:127], v[170:173]
v_mfma_f32_16x16x32_bf16 v[138:141], a[8:11], v[110:113], v[138:141]
ds_read_b128 v[186:189], v210 offset:5120
ds_write_b128 v120, v[90:93] offset:1024
v_mfma_f32_16x16x32_bf16 v[138:141], a[12:15], v[220:223], v[138:141]
v_mfma_f32_16x16x32_bf16 v[142:145], a[32:35], v[110:113], v[142:145]
v_mfma_f32_16x16x32_bf16 v[142:145], a[36:39], v[220:223], v[142:145]
ds_write_b64 v120, v[94:95] offset:1040
v_mfma_f32_16x16x32_bf16 v[146:149], a[56:59], v[110:113], v[146:149]
v_mfma_f32_16x16x32_bf16 v[146:149], a[60:63], v[220:223], v[146:149]
s_mov_b64 exec, s[56:57]
ds_write_b128 v121, v[48:51] offset:12544
s_mov_b64 exec, -1
v_mfma_f32_16x16x32_bf16 v[150:153], a[224:227], v[110:113], v[150:153]
v_mfma_f32_16x16x32_bf16 v[150:153], a[228:231], v[220:223], v[150:153]
s_mov_b64 exec, s[56:57]
ds_write_b128 v121, v[52:55] offset:12608
s_mov_b64 exec, -1
v_mfma_f32_16x16x32_bf16 v[154:157], a[248:251], v[110:113], v[154:157]
v_mfma_f32_16x16x32_bf16 v[154:157], a[252:255], v[220:223], v[154:157]
s_mov_b64 exec, s[56:57]
ds_write_b128 v121, v[56:59] offset:12672
s_mov_b64 exec, -1
v_mfma_f32_16x16x32_bf16 v[158:161], v[240:243], v[110:113], v[158:161]
v_mfma_f32_16x16x32_bf16 v[158:161], v[244:247], v[220:223], v[158:161]
s_mov_b64 exec, s[56:57]
ds_write_b128 v120, v[96:99] offset:24832
s_mov_b64 exec, -1
v_mfma_f32_16x16x32_bf16 v[162:165], v[110:113], a[80:83], v[162:165]
v_mfma_f32_16x16x32_bf16 v[162:165], v[220:223], a[84:87], v[162:165]
s_mov_b64 exec, s[56:57]
ds_write_b64 v120, v[100:101] offset:24848
s_mov_b64 exec, -1
v_mfma_f32_16x16x32_bf16 v[166:169], v[110:113], a[104:107], v[166:169]
s_mov_b64 exec, s[56:57]
ds_write_b128 v120, v[66:69] offset:25344
s_mov_b64 exec, -1
v_mfma_f32_16x16x32_bf16 v[166:169], v[220:223], a[108:111], v[166:169]
v_mfma_f32_16x16x32_bf16 v[170:173], v[110:113], a[128:131], v[170:173]
s_nop 0
ds_read_b128 v[110:113], v210 offset:6144
s_mov_b64 exec, s[56:57]
ds_write_b64 v120, v[70:71] offset:25360
s_mov_b64 exec, -1
v_mfma_f32_16x16x32_bf16 v[170:173], v[220:223], a[132:135], v[170:173]
s_waitcnt lgkmcnt(12)
ds_read_b128 v[220:223], v210 offset:7168
s_mov_b64 exec, s[56:57]
ds_write_b128 v120, v[102:105] offset:25856
s_mov_b64 exec, -1
v_mfma_f32_16x16x32_bf16 v[138:141], a[16:19], v[182:185], v[138:141]
s_waitcnt lgkmcnt(12)
v_mfma_f32_16x16x32_bf16 v[138:141], a[20:23], v[186:189], v[138:141]
s_mov_b64 exec, s[56:57]
ds_write_b64 v120, v[106:107] offset:25872
s_mov_b64 exec, -1
v_mfma_f32_16x16x32_bf16 v[142:145], a[40:43], v[182:185], v[142:145]
s_waitcnt vmcnt(3)
ds_read_b64_tr_b16 a[144:145], v129
ds_read_b64_tr_b16 a[168:169], v129 offset:32
v_mfma_f32_16x16x32_bf16 v[142:145], a[44:47], v[186:189], v[142:145]
s_barrier
v_mfma_f32_16x16x32_bf16 v[146:149], a[64:67], v[182:185], v[146:149]
s_nop 0
ds_read_b64_tr_b16 a[192:193], v129 offset:64
ds_read_b64_tr_b16 a[146:147], v129 offset:1536
v_mfma_f32_16x16x32_bf16 v[146:149], a[68:71], v[186:189], v[146:149]
s_nop 0
ds_read_b64_tr_b16 a[170:171], v129 offset:1568
ds_read_b64_tr_b16 a[194:195], v129 offset:1600
v_mfma_f32_16x16x32_bf16 v[150:153], a[232:235], v[182:185], v[150:153]
s_waitcnt vmcnt(0)
ds_read_b64_tr_b16 a[148:149], v129 offset:13824
ds_read_b64_tr_b16 a[172:173], v129 offset:13856
v_mfma_f32_16x16x32_bf16 v[150:153], a[236:239], v[186:189], v[150:153]
ds_read_b64_tr_b16 a[196:197], v129 offset:13888
ds_read_b64_tr_b16 a[160:161], v129 offset:12288
v_mfma_f32_16x16x32_bf16 v[154:157], v[224:227], v[182:185], v[154:157]
ds_read_b64_tr_b16 a[184:185], v129 offset:12320
ds_read_b64_tr_b16 a[208:209], v129 offset:12352
v_mfma_f32_16x16x32_bf16 v[154:157], v[228:231], v[186:189], v[154:157]
ds_read_b128 v[84:87], v200
ds_read_b128 v[92:95], v201
v_mfma_f32_16x16x32_bf16 v[158:161], v[248:251], v[182:185], v[158:161]
ds_read_b128 v[100:103], v202
ds_read_b128 v[88:91], v194 offset:16
v_mfma_f32_16x16x32_bf16 v[158:161], v[252:255], v[186:189], v[158:161]
s_waitcnt lgkmcnt(10)
s_add_u32 m0, s55, 69888
s_add_u32 s29, s54, 24576
buffer_load_dwordx4 v136, s[16:19], s29 offen lds
v_mfma_f32_16x16x32_bf16 v[162:165], v[182:185], a[88:91], v[162:165]
s_add_u32 m0, s55, 70912
s_add_u32 s29, s54, 24576
buffer_load_dwordx4 v137, s[16:19], s29 offen lds
v_mfma_f32_16x16x32_bf16 v[162:165], v[186:189], a[92:95], v[162:165]
s_add_u32 m0, s55, 71936
s_add_u32 s29, s54, 24576
buffer_load_dwordx4 v128, s[16:19], s29 offen lds
ds_read_b128 v[96:99], v195 offset:16
s_waitcnt lgkmcnt(4)
v_mfma_f32_16x16x32_bf16 v[36:39], v[174:177], v[84:87], 0
s_waitcnt lgkmcnt(3)
s_add_u32 m0, s55, 82176
s_add_u32 s29, s54, 36864
buffer_load_dwordx4 v136, s[16:19], s29 offen lds
v_mfma_f32_16x16x32_bf16 v[48:51], v[174:177], v[92:95], 0
s_waitcnt lgkmcnt(2)
s_add_u32 m0, s55, 83200
s_add_u32 s29, s54, 36864
buffer_load_dwordx4 v137, s[16:19], s29 offen lds
v_mfma_f32_16x16x32_bf16 v[60:63], v[174:177], v[100:103], 0
s_add_u32 m0, s55, 84224
s_add_u32 s29, s54, 36864
buffer_load_dwordx4 v128, s[16:19], s29 offen lds
v_mfma_f32_16x16x32_bf16 v[166:169], v[182:185], a[112:115], v[166:169]
ds_read_b128 v[84:87], v194
ds_read_b128 v[92:95], v195
v_mfma_f32_16x16x32_bf16 v[166:169], v[186:189], a[116:119], v[166:169]
ds_read_b128 v[100:103], v196
ds_read_b128 v[104:107], v196 offset:16
v_mfma_f32_16x16x32_bf16 v[170:173], v[182:185], a[136:139], v[170:173]
ds_read_b128 v[174:177], v217 offset:1056
ds_read_b128 v[182:185], v210 offset:8192
v_mfma_f32_16x16x32_bf16 v[170:173], v[186:189], a[140:143], v[170:173]
ds_read_b128 v[186:189], v210 offset:9216
v_cvt_pk_bf16_f32 v78, v138, v139
v_cvt_pk_bf16_f32 v79, v140, v141
v_mfma_f32_16x16x32_bf16 v[138:141], a[0:3], v[110:113], 0
v_cvt_pk_bf16_f32 v80, v142, v143
v_cvt_pk_bf16_f32 v81, v144, v145
v_mfma_f32_16x16x32_bf16 v[138:141], a[4:7], v[220:223], v[138:141]
s_waitcnt lgkmcnt(6)
v_cvt_pk_bf16_f32 v82, v146, v147
v_cvt_pk_bf16_f32 v83, v148, v149
v_smfmac_f32_16x16x64_bf16 v[36:39], v[178:181], v[84:91], v213
s_waitcnt lgkmcnt(5)
ds_read_b128 v[84:87], v197
ds_read_b128 v[88:91], v197 offset:16
v_smfmac_f32_16x16x64_bf16 v[48:51], v[178:181], v[92:99], v213
s_nop 0
ds_read_b128 v[92:95], v198
ds_read_b128 v[96:99], v198 offset:16
v_mfma_f32_16x16x32_bf16 v[142:145], a[24:27], v[110:113], 0
s_waitcnt lgkmcnt(7)
v_cvt_pk_bf16_f32 v72, v150, v151
v_cvt_pk_bf16_f32 v73, v152, v153
v_smfmac_f32_16x16x64_bf16 v[60:63], v[178:181], v[100:107], v213
ds_read_b128 v[100:103], v199
ds_read_b128 v[104:107], v199 offset:16
v_mfma_f32_16x16x32_bf16 v[142:145], a[28:31], v[220:223], v[142:145]
ds_read_b128 v[178:181], v217 offset:1584
v_cvt_pk_bf16_f32 v74, v154, v155
v_mfma_f32_16x16x32_bf16 v[146:149], a[48:51], v[110:113], 0
v_cvt_pk_bf16_f32 v75, v156, v157
v_cvt_pk_bf16_f32 v76, v158, v159
v_mfma_f32_16x16x32_bf16 v[146:149], a[52:55], v[220:223], v[146:149]
s_nop 0
v_cvt_pk_bf16_f32 v77, v160, v161
v_cvt_pk_bf16_f32 v114, v162, v163
v_mfma_f32_16x16x32_bf16 v[150:153], a[216:219], v[110:113], 0
s_waitcnt lgkmcnt(5)
v_cvt_pk_bf16_f32 v115, v164, v165
v_cvt_pk_bf16_f32 v122, v166, v167
v_smfmac_f32_16x16x64_bf16 v[36:39], v[174:177], v[84:91], v213
s_nop 0
ds_read_b128 v[84:87], v200 offset:32
ds_read_b128 v[88:91], v194 offset:48
v_mfma_f32_16x16x32_bf16 v[150:153], a[220:223], v[220:223], v[150:153]
s_waitcnt lgkmcnt(5)
v_cvt_pk_bf16_f32 v123, v168, v169
v_cvt_pk_bf16_f32 v130, v170, v171
v_smfmac_f32_16x16x64_bf16 v[48:51], v[174:177], v[92:99], v213
ds_read_b128 v[92:95], v201 offset:32
ds_read_b128 v[96:99], v195 offset:48
v_mfma_f32_16x16x32_bf16 v[154:157], a[240:243], v[110:113], 0
s_waitcnt lgkmcnt(5)
v_mul_f32 v119, v36, v36
v_add_f32_e64 v118, v36, v37
v_smfmac_f32_16x16x64_bf16 v[60:63], v[174:177], v[100:107], v213
ds_read_b128 v[100:103], v202 offset:32
ds_read_b128 v[174:177], v217 offset:2112
v_mfma_f32_16x16x32_bf16 v[154:157], a[244:247], v[220:223], v[154:157]
ds_read_b128 v[104:107], v196 offset:48
v_mul_f32_e64 v127, v48, v48
v_mfma_f32_16x16x32_bf16 v[158:161], v[232:235], v[110:113], 0
s_waitcnt lgkmcnt(6)
v_mul_f32 v135, v60, v60
v_add_f32_e64 v134, v60, v61
v_mfma_f32_16x16x32_bf16 v[40:43], v[178:181], v[84:87], 0
ds_read_b128 v[84:87], v194 offset:32
v_fmac_f32_e64 v135, v61, v61
v_mfma_f32_16x16x32_bf16 v[158:161], v[236:239], v[220:223], v[158:161]
s_waitcnt lgkmcnt(5)
v_add_f32 v126, v48, v49
v_fmac_f32_e64 v119, v37, v37
v_mfma_f32_16x16x32_bf16 v[52:55], v[178:181], v[92:95], 0
ds_read_b128 v[92:95], v195 offset:32
v_fmac_f32_e64 v127, v49, v49
v_mfma_f32_16x16x32_bf16 v[162:165], v[110:113], a[72:75], 0
s_waitcnt lgkmcnt(4)
v_add_f32 v134, v134, v62
v_fmac_f32_e64 v135, v62, v62
v_mfma_f32_16x16x32_bf16 v[64:67], v[178:181], v[100:103], 0
ds_read_b128 v[100:103], v196 offset:32
ds_read_b128 v[178:181], v217 offset:2640
v_mfma_f32_16x16x32_bf16 v[162:165], v[220:223], a[76:79], v[162:165]
v_add_f32 v118, v118, v38
v_add_f32 v126, v126, v50
v_mfma_f32_16x16x32_bf16 v[166:169], v[110:113], a[96:99], 0
s_waitcnt lgkmcnt(3)
v_fmac_f32 v119, v38, v38
v_fmac_f32_e64 v127, v50, v50
v_smfmac_f32_16x16x64_bf16 v[40:43], v[174:177], v[84:91], v213
ds_read_b128 v[84:87], v197 offset:32
ds_read_b128 v[88:91], v197 offset:48
v_mfma_f32_16x16x32_bf16 v[166:169], v[220:223], a[100:103], v[166:169]
s_waitcnt lgkmcnt(4)
v_add_f32 v134, v134, v63
v_fmac_f32_e64 v135, v63, v63
v_smfmac_f32_16x16x64_bf16 v[52:55], v[174:177], v[92:99], v213
s_waitcnt vmcnt(4)
ds_read_b64_tr_b16 a[150:151], v129
ds_read_b64_tr_b16 a[174:175], v129 offset:32
v_mfma_f32_16x16x32_bf16 v[138:141], a[8:11], v[182:185], v[138:141]
s_waitcnt lgkmcnt(5)
ds_read_b64_tr_b16 a[198:199], v129 offset:64
ds_read_b128 v[92:95], v198 offset:32
v_smfmac_f32_16x16x64_bf16 v[64:67], v[174:177], v[100:107], v213
ds_read_b128 v[96:99], v198 offset:48
ds_read_b128 v[100:103], v199 offset:32
v_mfma_f32_16x16x32_bf16 v[138:141], a[12:15], v[186:189], v[138:141]
s_nop 0
ds_read_b128 v[104:107], v199 offset:48
ds_read_b128 v[174:177], v217 offset:3168
v_mfma_f32_16x16x32_bf16 v[142:145], a[32:35], v[182:185], v[142:145]
s_waitcnt vmcnt(3)
ds_read_b64_tr_b16 a[162:163], v129 offset:1536
ds_read_b64_tr_b16 a[186:187], v129 offset:1568
v_mfma_f32_16x16x32_bf16 v[142:145], a[36:39], v[186:189], v[142:145]
s_waitcnt lgkmcnt(10)
ds_read_b64_tr_b16 a[210:211], v129 offset:1600
v_add_f32 v118, v118, v39
v_smfmac_f32_16x16x64_bf16 v[40:43], v[178:181], v[84:91], v213
ds_read_b128 v[84:87], v200 offset:64
ds_read_b128 v[88:91], v194 offset:80
v_mfma_f32_16x16x32_bf16 v[146:149], a[56:59], v[182:185], v[146:149]
v_add_f32 v126, v126, v51
v_fmac_f32 v119, v39, v39
v_mfma_f32_16x16x32_bf16 v[146:149], a[60:63], v[186:189], v[146:149]
s_waitcnt lgkmcnt(8)
v_fmac_f32 v127, v51, v51
v_add_f32_e64 v118, v118, v40
v_smfmac_f32_16x16x64_bf16 v[52:55], v[178:181], v[92:99], v213
ds_read_b128 v[92:95], v201 offset:64
ds_read_b128 v[96:99], v195 offset:80
v_mfma_f32_16x16x32_bf16 v[150:153], a[224:227], v[182:185], v[150:153]
s_waitcnt lgkmcnt(8)
v_fmac_f32 v119, v40, v40
v_add_f32_e64 v118, v118, v41
v_smfmac_f32_16x16x64_bf16 v[64:67], v[178:181], v[100:107], v213
ds_read_b128 v[100:103], v202 offset:64
ds_read_b128 v[178:181], v217 offset:3696
v_mfma_f32_16x16x32_bf16 v[150:153], a[228:231], v[186:189], v[150:153]
ds_read_b128 v[104:107], v196 offset:80
v_add_f32 v126, v126, v52
v_mfma_f32_16x16x32_bf16 v[154:157], a[248:251], v[182:185], v[154:157]
s_waitcnt lgkmcnt(7)
s_add_u32 m0, s55, 69888
s_add_u32 s29, s54, 49152
buffer_load_dwordx4 v136, s[16:19], s29 offen lds
s_waitcnt lgkmcnt(6)
v_mfma_f32_16x16x32_bf16 v[44:47], v[174:177], v[84:87], 0
s_waitcnt vmcnt(2)
s_add_u32 m0, s55, 70912
s_add_u32 s29, s54, 49152
buffer_load_dwordx4 v137, s[16:19], s29 offen lds
ds_read_b64_tr_b16 a[152:153], v129 offset:12288
s_waitcnt lgkmcnt(5)
v_mfma_f32_16x16x32_bf16 v[56:59], v[174:177], v[92:95], 0
s_nop 0
s_add_u32 m0, s55, 71936
s_add_u32 s29, s54, 49152
buffer_load_dwordx4 v128, s[16:19], s29 offen lds
ds_read_b64_tr_b16 a[176:177], v129 offset:12320
s_waitcnt lgkmcnt(4)
v_mfma_f32_16x16x32_bf16 v[68:71], v[174:177], v[100:103], 0
s_waitcnt vmcnt(3)
ds_read_b64_tr_b16 a[200:201], v129 offset:12352
ds_read_b64_tr_b16 a[154:155], v129 offset:13824
v_mfma_f32_16x16x32_bf16 v[154:157], a[252:255], v[186:189], v[154:157]
ds_read_b64_tr_b16 a[178:179], v129 offset:13856
ds_read_b64_tr_b16 a[202:203], v129 offset:13888
v_mfma_f32_16x16x32_bf16 v[158:161], v[240:243], v[182:185], v[158:161]
ds_read_b128 v[84:87], v194 offset:64
ds_read_b128 v[92:95], v195 offset:64
v_mfma_f32_16x16x32_bf16 v[158:161], v[244:247], v[186:189], v[158:161]
ds_read_b128 v[100:103], v196 offset:64
ds_read_b128 v[174:177], v217 offset:4224
v_mfma_f32_16x16x32_bf16 v[162:165], v[182:185], a[80:83], v[162:165]
v_add_f32 v134, v134, v64
v_fmac_f32 v135, v64, v64
v_mfma_f32_16x16x32_bf16 v[162:165], v[186:189], a[84:87], v[162:165]
v_fmac_f32 v127, v52, v52
v_add_f32 v134, v134, v65
v_mfma_f32_16x16x32_bf16 v[166:169], v[182:185], a[104:107], v[166:169]
v_fmac_f32_e64 v135, v65, v65
v_fmac_f32 v119, v41, v41
v_mfma_f32_16x16x32_bf16 v[166:169], v[186:189], a[108:111], v[166:169]
s_waitcnt lgkmcnt(4)
s_add_u32 m0, s55, 82176
s_add_u32 s29, s54, 61440
buffer_load_dwordx4 v136, s[16:19], s29 offen lds
s_waitcnt lgkmcnt(3)
v_smfmac_f32_16x16x64_bf16 v[44:47], v[178:181], v[84:91], v213
s_waitcnt lgkmcnt(2)
s_add_u32 m0, s55, 83200
s_add_u32 s29, s54, 61440
buffer_load_dwordx4 v137, s[16:19], s29 offen lds
v_smfmac_f32_16x16x64_bf16 v[56:59], v[178:181], v[92:99], v213
s_waitcnt lgkmcnt(1)
s_add_u32 m0, s55, 84224
s_add_u32 s29, s54, 61440
buffer_load_dwordx4 v128, s[16:19], s29 offen lds
v_smfmac_f32_16x16x64_bf16 v[68:71], v[178:181], v[100:107], v213
s_sub_u32 s42, s35, s42
ds_read_b128 v[84:87], v197 offset:64
ds_read_b128 v[88:91], v197 offset:80
ds_read_b128 v[92:95], v198 offset:64
ds_read_b128 v[96:99], v198 offset:80
ds_read_b128 v[100:103], v199 offset:64
v_add_f32 v126, v126, v53
ds_read_b128 v[104:107], v199 offset:80
v_fmac_f32 v127, v53, v53
v_add_f32 v134, v134, v66
v_fmac_f32 v135, v66, v66
v_add_f32 v118, v118, v42
v_fmac_f32 v119, v42, v42
v_add_f32 v126, v126, v54
v_fmac_f32 v127, v54, v54
v_add_f32 v134, v134, v67
v_fmac_f32 v135, v67, v67
v_add_f32 v118, v118, v43
v_fmac_f32 v119, v43, v43
v_add_f32 v126, v126, v55
v_fmac_f32 v127, v55, v55
v_cvt_pk_bf16_f32 v131, v172, v173
v_mfma_f32_16x16x32_bf16 v[170:173], v[110:113], a[120:123], 0
s_mul_i32 s51, s42, 2688
ds_read_b128 v[110:113], v210 offset:10240
s_add_u32 s43, s43, s51
s_cmp_lt_u32 s35, s34
s_waitcnt lgkmcnt(5)
v_smfmac_f32_16x16x64_bf16 v[44:47], v[174:177], v[84:91], v213
s_cselect_b32 s50, s43, 1879048192
s_add_u32 s35, s35, 32
s_cmp_eq_u32 s42, 0
v_mfma_f32_16x16x32_bf16 v[170:173], v[220:223], a[124:127], v[170:173]
s_cselect_b32 s44, 536870911, s72
s_cmp_eq_u32 s42, 72
s_waitcnt lgkmcnt(3)
v_smfmac_f32_16x16x64_bf16 v[56:59], v[174:177], v[92:99], v213
s_cselect_b32 s44, 939524095, s44
s_cmp_eq_u32 s41, 0
v_add_f32 v118, v118, v44
v_mfma_f32_16x16x32_bf16 v[170:173], v[182:185], a[128:131], v[170:173]
s_waitcnt lgkmcnt(1)
v_fmac_f32 v119, v44, v44
v_add_f32 v118, v118, v45
v_smfmac_f32_16x16x64_bf16 v[68:71], v[174:177], v[100:107], v213
s_waitcnt lgkmcnt(0)
ds_read_b128 v[182:185], v210 offset:12288
v_add_f32_e64 v126, v126, v56
v_mfma_f32_16x16x32_bf16 v[170:173], v[186:189], a[132:135], v[170:173]
s_cselect_b32 s52, 1879048192, s50
v_fmac_f32 v127, v56, v56
v_fmac_f32 v119, v45, v45
v_mfma_f32_16x16x32_bf16 v[138:141], a[16:19], v[110:113], v[138:141]
s_add_u32 m0, s45, 0
v_add_f32 v134, v134, v68
v_fmac_f32_e64 v135, v68, v68
v_mfma_f32_16x16x32_bf16 v[142:145], a[40:43], v[110:113], v[142:145]
s_mov_b32 s36, s50
v_add_f32 v134, v134, v69
v_fmac_f32_e64 v135, v69, v69
v_mfma_f32_16x16x32_bf16 v[146:149], a[64:67], v[110:113], v[146:149]
s_mul_hi_u32 s41, s35, 58835169
v_add_f32 v126, v126, v57
v_fmac_f32 v127, v57, v57
v_mfma_f32_16x16x32_bf16 v[150:153], a[232:235], v[110:113], v[150:153]
s_mul_i32 s42, s41, 73
v_add_f32 v134, v134, v70
v_fmac_f32 v135, v70, v70
v_mfma_f32_16x16x32_bf16 v[154:157], v[224:227], v[110:113], v[154:157]
s_mul_i32 s43, s41, 1373568
v_add_f32 v118, v118, v46
v_fmac_f32 v119, v46, v46
v_mfma_f32_16x16x32_bf16 v[158:161], v[248:251], v[110:113], v[158:161]
v_add_f32 v126, v126, v58
v_fmac_f32 v127, v58, v58
v_mfma_f32_16x16x32_bf16 v[162:165], v[110:113], a[88:91], v[162:165]
v_add_f32 v134, v134, v71
v_fmac_f32 v135, v71, v71
v_mfma_f32_16x16x32_bf16 v[166:169], v[110:113], a[112:115], v[166:169]
v_add_f32_e64 v118, v118, v47
v_fmac_f32 v119, v47, v47
v_mfma_f32_16x16x32_bf16 v[170:173], v[110:113], a[136:139], v[170:173]
s_waitcnt vmcnt(4)
ds_read_b64_tr_b16 a[164:165], v129
ds_read_b64_tr_b16 a[188:189], v129 offset:32
ds_read_b64_tr_b16 a[212:213], v129 offset:64
v_add_f32 v126, v126, v59
v_fmac_f32 v127, v59, v59
v_permlane16_swap_b32 v134, v135
v_permlane16_swap_b32 v118, v119
v_permlane16_swap_b32 v126, v127
v_add_f32 v134, v134, v135
v_add_f32 v118, v118, v119
v_add_f32 v126, v126, v127
v_mov_b32_e64 v135, v134
v_and_b32 v216, s44, v208
v_permlane32_swap_b32 v118, v126
v_permlane32_swap_b32 v134, v135
s_waitcnt vmcnt(3)
ds_read_b64_tr_b16 a[156:157], v129 offset:1536
ds_read_b64_tr_b16 a[180:181], v129 offset:1568
ds_read_b64_tr_b16 a[204:205], v129 offset:1600
v_add_f32 v118, v118, v126
v_add_f32 v134, v134, v135
ds_write_b32 v209, v118
ds_write_b32 v209, v134 offset:512
ds_read_b128 v[186:189], v210 offset:13312
ds_read_b64 v[112:113], v215 offset:528
s_waitcnt vmcnt(1)
ds_read_b64_tr_b16 a[158:159], v129 offset:12288
ds_read_b64_tr_b16 a[182:183], v129 offset:12320
ds_read_b64_tr_b16 a[206:207], v129 offset:12352
s_waitcnt vmcnt(0)
ds_read_b64_tr_b16 a[166:167], v129 offset:13824
ds_read_b64_tr_b16 a[190:191], v129 offset:13856
ds_read_b64_tr_b16 a[214:215], v129 offset:13888
s_waitcnt lgkmcnt(0)
s_barrier
ds_read_b128 v[102:105], v210 offset:18432
ds_read_b128 v[106:109], v210 offset:19456
buffer_load_dwordx4 v216, s[4:7], s52 offen nt lds
s_add_u32 m0, s45, 4112
s_add_u32 s40, s36, 196224
buffer_load_dwordx4 v216, s[4:7], s40 offen nt lds
s_add_u32 m0, s45, 8224
s_add_u32 s40, s36, 392448
s_waitcnt lgkmcnt(1)
v_add_f32 v102, v102, v103
v_add_f32 v104, v104, v105
v_add_f32 v102, v102, v104
v_mul_f32 v103, s48, v102
v_mul_f32 v104, s73, v102
s_waitcnt lgkmcnt(0)
v_add_f32 v106, v106, v107
v_add_f32 v108, v108, v109
v_add_f32 v106, v106, v108
v_mul_f32_e64 v106, s73, v106
v_fma_f32 v106, -v103, v104, v106
v_max_f32 v106, 0, v106
v_add_f32 v106, s49, v106
v_rsq_f32 v102, v106
s_nop 0
v_mul_f32_e64 v103, -v103, v102
ds_read_b128 v[106:109], v210 offset:11264
ds_write_b64 v211, v[102:103] offset:20480
ds_read_b64 v[118:119], v219 offset:20480
buffer_load_dwordx4 v216, s[4:7], s40 offen nt lds
ds_read_b64 v[126:127], v219 offset:20736
ds_read_b64 v[134:135], v219 offset:20992
s_add_u32 m0, s45, 12336
s_add_u32 s40, s36, 588672
s_waitcnt lgkmcnt(4)
v_mfma_f32_16x16x32_bf16 v[138:141], a[20:23], v[106:109], v[138:141]
v_mfma_f32_16x16x32_bf16 v[142:145], a[44:47], v[106:109], v[142:145]
v_mfma_f32_16x16x32_bf16 v[146:149], a[68:71], v[106:109], v[146:149]
s_waitcnt lgkmcnt(2)
v_fma_f32 v220, v36, v118, v119
v_fma_f32 v221, v37, v118, v119
v_mfma_f32_16x16x32_bf16 v[150:153], a[236:239], v[106:109], v[150:153]
v_fma_f32 v222, v38, v118, v119
v_fma_f32 v223, v39, v118, v119
v_mfma_f32_16x16x32_bf16 v[154:157], v[228:231], v[106:109], v[154:157]
v_cvt_pk_bf16_f32 v90, v220, v221
v_cvt_pk_bf16_f32 v91, v222, v223
v_mfma_f32_16x16x32_bf16 v[158:161], v[252:255], v[106:109], v[158:161]
buffer_load_dwordx4 v216, s[4:7], s40 offen nt lds
v_mfma_f32_16x16x32_bf16 v[162:165], v[106:109], a[92:95], v[162:165]
s_add_u32 m0, s45, 16448
v_cvt_pk_bf16_f32 v96, v138, v139
v_cvt_pk_bf16_f32 v97, v140, v141
v_mfma_f32_16x16x32_bf16 v[166:169], v[106:109], a[116:119], v[166:169]
s_add_u32 s40, s36, 784896
v_fma_f32 v220, v40, v118, v119
v_fma_f32 v221, v41, v118, v119
v_mfma_f32_16x16x32_bf16 v[170:173], v[106:109], a[140:143], v[170:173]
ds_read_b128 v[108:111], v215 offset:512
v_fma_f32 v222, v42, v118, v119
v_mfma_f32_16x16x32_bf16 v[138:141], a[0:3], v[182:185], 0
v_fma_f32 v223, v43, v118, v119
v_cvt_pk_bf16_f32 v100, v146, v147
v_mfma_f32_16x16x32_bf16 v[138:141], a[4:7], v[186:189], v[138:141]
v_cvt_pk_bf16_f32 v101, v148, v149
v_cvt_pk_bf16_f32 v92, v220, v221
v_mfma_f32_16x16x32_bf16 v[146:149], a[48:51], v[182:185], 0
v_cvt_pk_bf16_f32 v93, v222, v223
v_fma_f32 v220, v44, v118, v119
v_mfma_f32_16x16x32_bf16 v[146:149], a[52:55], v[186:189], v[146:149]
s_waitcnt lgkmcnt(2)
v_fma_f32 v221, v45, v118, v119
v_fma_f32 v222, v46, v118, v119
v_fma_f32 v223, v47, v118, v119
v_cvt_pk_bf16_f32 v94, v220, v221
v_cvt_pk_bf16_f32 v95, v222, v223
v_fma_f32 v220, v48, v126, v127
v_fma_f32 v221, v49, v126, v127
v_fma_f32 v222, v50, v126, v127
v_fma_f32 v223, v51, v126, v127
v_cvt_pk_bf16_f32 v98, v142, v143
v_cvt_pk_bf16_f32 v99, v144, v145
v_mfma_f32_16x16x32_bf16 v[142:145], a[24:27], v[182:185], 0
s_waitcnt lgkmcnt(0)
buffer_load_dwordx4 v216, s[4:7], s40 offen nt lds
v_mfma_f32_16x16x32_bf16 v[142:145], a[28:31], v[186:189], v[142:145]
s_add_u32 m0, s45, 20560
ds_read_b128 v[182:185], v210 offset:15360
ds_read_b128 v[186:189], v210 offset:16384
ds_write_b128 v211, v[90:93] offset:20480
v_cvt_pk_bf16_f32 v174, v220, v221
v_cvt_pk_bf16_f32 v175, v222, v223
v_cvt_pk_bf16_f32 v84, v150, v151
v_cvt_pk_bf16_f32 v85, v152, v153
v_mfma_f32_16x16x16_bf16 v[150:153], v[112:113], v[76:77], v[206:209]
v_cvt_pk_bf16_f32 v132, v170, v171
v_cvt_pk_bf16_f32 v133, v172, v173
v_fma_f32 v220, v52, v126, v127
v_fma_f32 v221, v53, v126, v127
v_fma_f32 v222, v54, v126, v127
v_fma_f32 v223, v55, v126, v127
v_mfma_f32_16x16x32_bf16 v[150:153], v[108:111], v[72:75], v[150:153]
s_add_u32 s40, s36, 981120
ds_read_b128 v[170:173], v210 offset:14336
buffer_load_dwordx4 v216, s[4:7], s40 offen nt lds
v_cvt_pk_bf16_f32 v176, v220, v221
v_cvt_pk_bf16_f32 v177, v222, v223
v_fma_f32 v220, v56, v126, v127
v_fma_f32 v221, v57, v126, v127
v_fma_f32 v222, v58, v126, v127
v_fma_f32 v223, v59, v126, v127
v_cvt_pk_bf16_f32 v178, v220, v221
v_cvt_pk_bf16_f32 v179, v222, v223
v_cvt_pk_bf16_f32 v88, v158, v159
v_cvt_pk_bf16_f32 v89, v160, v161
v_cvt_pk_bf16_f32 v86, v154, v155
v_cvt_pk_bf16_f32 v87, v156, v157
v_mfma_f32_16x16x16_bf16 v[154:157], v[82:83], v[88:89], 0
v_exp_f32 v150, v150
v_cvt_pk_bf16_f32 v124, v166, v167
v_mfma_f32_16x16x16_bf16 v[158:161], v[100:101], v[88:89], 0
v_cvt_pk_bf16_f32 v125, v168, v169
v_fma_f32 v220, v60, v134, v135
v_fma_f32 v221, v61, v134, v135
v_mfma_f32_16x16x16_bf16 v[166:169], v[112:113], v[88:89], v[206:209]
s_waitcnt lgkmcnt(0)
ds_write_b128 v211, v[174:177] offset:26624
v_mfma_f32_16x16x32_bf16 v[138:141], a[8:11], v[170:173], v[138:141]
s_add_u32 m0, s45, 24672
v_fma_f32 v222, v62, v134, v135
v_fma_f32 v223, v63, v134, v135
v_mfma_f32_16x16x32_bf16 v[138:141], a[12:15], v[182:185], v[138:141]
s_add_u32 s40, s36, 1177344
buffer_load_dwordx4 v216, s[4:7], s40 offen nt lds
v_mfma_f32_16x16x32_bf16 v[142:145], a[32:35], v[170:173], v[142:145]
s_add_u32 m0, s45, 28784
ds_write_b64 v212, v[178:179] offset:26624
v_mfma_f32_16x16x32_bf16 v[142:145], a[36:39], v[182:185], v[142:145]
s_add_u32 s40, s36, 1373568
v_cvt_pk_bf16_f32 v116, v162, v163
v_cvt_pk_bf16_f32 v117, v164, v165
v_mfma_f32_16x16x32_bf16 v[146:149], a[56:59], v[170:173], v[146:149]
ds_read_b128 v[174:177], v210 offset:14336
ds_read_b128 v[178:181], v210 offset:15360
v_mfma_f32_16x16x32_bf16 v[146:149], a[60:63], v[182:185], v[146:149]
ds_read_b128 v[182:185], v210 offset:12288
ds_read_b128 v[170:173], v210 offset:17408
v_mfma_f32_16x16x32_bf16 v[138:141], a[16:19], v[186:189], v[138:141]
ds_write_b64 v212, v[94:95] offset:20480
v_mfma_f32_16x16x32_bf16 v[142:145], a[40:43], v[186:189], v[142:145]
buffer_load_dwordx4 v216, s[4:7], s40 offen nt lds
v_mfma_f32_16x16x32_bf16 v[154:157], v[78:81], v[84:87], v[154:157]
s_add_u32 m0, s45, 32896
v_cvt_pk_bf16_f32 v90, v220, v221
v_cvt_pk_bf16_f32 v91, v222, v223
v_mfma_f32_16x16x32_bf16 v[146:149], a[64:67], v[186:189], v[146:149]
s_add_u32 s40, s36, 1569792
ds_read_b128 v[186:189], v210 offset:13312
v_fma_f32 v220, v64, v134, v135
v_mfma_f32_16x16x32_bf16 v[158:161], v[96:99], v[84:87], v[158:161]
s_sub_u32 s42, s35, s42
v_exp_f32 v154, v154
v_mfma_f32_16x16x32_bf16 v[166:169], v[108:111], v[84:87], v[166:169]
s_mul_i32 s51, s42, 2688
v_exp_f32 v155, v155
v_exp_f32 v156, v156
s_waitcnt lgkmcnt(3)
v_mfma_f32_16x16x32_bf16 v[118:121], v[182:185], a[72:75], 0
s_waitcnt lgkmcnt(2)
v_exp_f32 v157, v157
v_mfma_f32_16x16x32_bf16 v[126:129], v[182:185], a[96:99], 0
s_add_u32 s43, s43, s51
v_exp_f32 v158, v158
v_mfma_f32_16x16x32_bf16 v[138:141], a[20:23], v[170:173], v[138:141]
s_cmp_lt_u32 s35, s34
buffer_load_dwordx4 v216, s[4:7], s40 offen nt lds
v_mfma_f32_16x16x32_bf16 v[142:145], a[44:47], v[170:173], v[142:145]
s_waitcnt lgkmcnt(0)
v_exp_f32 v159, v159
v_mfma_f32_16x16x32_bf16 v[118:121], v[186:189], a[76:79], v[118:121]
s_cselect_b32 s50, s43, 1879048192
v_cvt_pk_bf16_f32 v102, v138, v139
v_cvt_pk_bf16_f32 v103, v140, v141
v_fma_f32 v221, v65, v134, v135
v_mfma_f32_16x16x16_bf16 v[138:141], v[82:83], v[76:77], 0
v_cvt_pk_bf16_f32 v104, v142, v143
v_cvt_pk_bf16_f32 v105, v144, v145
v_fma_f32 v222, v66, v134, v135
v_mfma_f32_16x16x16_bf16 v[142:145], v[100:101], v[76:77], 0
v_exp_f32_e64 v160, v160
v_exp_f32 v161, v161
v_mfma_f32_16x16x32_bf16 v[138:141], v[78:81], v[72:75], v[138:141]
s_add_u32 s35, s35, 32
v_exp_f32 v166, v166
v_mfma_f32_16x16x32_bf16 v[142:145], v[96:99], v[72:75], v[142:145]
s_cmp_eq_u32 s42, 0
v_fma_f32 v223, v67, v134, v135
v_cvt_pk_bf16_f32 v92, v220, v221
v_mfma_f32_16x16x32_bf16 v[126:129], v[186:189], a[100:103], v[126:129]
s_cselect_b32 s44, 536870911, s72
v_exp_f32 v138, v138
v_mfma_f32_16x16x32_bf16 v[126:129], v[174:177], a[104:107], v[126:129]
s_cmp_eq_u32 s42, 72
v_exp_f32 v139, v139
v_mfma_f32_16x16x32_bf16 v[126:129], v[178:181], a[108:111], v[126:129]
s_cselect_b32 s44, 939524095, s44
v_exp_f32 v140, v140
v_mfma_f32_16x16x32_bf16 v[146:149], a[68:71], v[170:173], v[146:149]
s_cmp_eq_u32 s41, 0
v_exp_f32_e64 v141, v141
v_mfma_f32_16x16x32_bf16 v[170:173], a[240:243], v[182:185], 0
s_cselect_b32 s52, 1879048192, s50
v_exp_f32 v142, v142
v_mfma_f32_16x16x32_bf16 v[170:173], a[244:247], v[186:189], v[170:173]
s_mov_b32 s37, s50
v_cvt_pk_bf16_f32 v106, v146, v147
v_cvt_pk_bf16_f32 v107, v148, v149
v_mfma_f32_16x16x32_bf16 v[118:121], v[174:177], a[80:83], v[118:121]
s_add_u32 m0, s45, 0
v_exp_f32 v143, v143
v_cvt_pk_bf16_f32 v93, v222, v223
v_mfma_f32_16x16x16_bf16 v[146:149], v[106:107], v[76:77], 0
v_exp_f32 v144, v144
v_fma_f32 v220, v68, v134, v135
v_mfma_f32_16x16x16_bf16 v[162:165], v[106:107], v[88:89], 0
v_exp_f32 v145, v145
v_fma_f32 v221, v69, v134, v135
v_fma_f32 v222, v70, v134, v135
v_mfma_f32_16x16x32_bf16 v[146:149], v[102:105], v[72:75], v[146:149]
ds_write_b128 v211, v[90:93] offset:32768
v_mfma_f32_16x16x32_bf16 v[90:93], a[216:219], v[182:185], 0
v_exp_f32 v146, v146
v_mfma_f32_16x16x32_bf16 v[90:93], a[220:223], v[186:189], v[90:93]
v_exp_f32 v147, v147
v_mfma_f32_16x16x32_bf16 v[90:93], a[224:227], v[174:177], v[90:93]
v_exp_f32 v148, v148
v_mfma_f32_16x16x32_bf16 v[90:93], a[228:231], v[178:181], v[90:93]
v_exp_f32 v149, v149
v_mfma_f32_16x16x32_bf16 v[118:121], v[178:181], a[84:87], v[118:121]
v_fma_f32 v223, v71, v134, v135
v_cvt_pk_bf16_f32 v94, v220, v221
v_mfma_f32_16x16x32_bf16 v[134:137], v[182:185], a[120:123], 0
v_cvt_pk_bf16_f32 v95, v222, v223
v_and_b32_e64 v216, s44, v208
v_mfma_f32_16x16x32_bf16 v[134:137], v[186:189], a[124:127], v[134:137]
ds_write_b64 v212, v[94:95] offset:32768
v_mfma_f32_16x16x32_bf16 v[220:223], v[232:235], v[182:185], 0
v_mfma_f32_16x16x32_bf16 v[220:223], v[236:239], v[186:189], v[220:223]
ds_read_b128 v[182:185], v210 offset:16384
ds_read_b128 v[186:189], v210 offset:17408
v_mfma_f32_16x16x32_bf16 v[134:137], v[174:177], a[128:131], v[134:137]
ds_read_b64 v[76:77], v215 offset:16
ds_read_b128 v[72:75], v215
v_mfma_f32_16x16x32_bf16 v[134:137], v[178:181], a[132:135], v[134:137]
v_mfma_f32_16x16x32_bf16 v[170:173], a[248:251], v[174:177], v[170:173]
v_mfma_f32_16x16x32_bf16 v[170:173], a[252:255], v[178:181], v[170:173]
v_mfma_f32_16x16x32_bf16 v[220:223], v[240:243], v[174:177], v[220:223]
v_cvt_pk_bf16_f32 v174, v138, v139
v_cvt_pk_bf16_f32 v175, v140, v141
v_mfma_f32_16x16x32_bf16 v[220:223], v[244:247], v[178:181], v[220:223]
s_nop 0
v_cvt_pk_bf16_f32 v176, v142, v143
v_cvt_pk_bf16_f32 v177, v144, v145
v_mfma_f32_16x16x32_bf16 v[162:165], v[102:105], v[84:87], v[162:165]
s_waitcnt lgkmcnt(3)
v_cvt_pk_bf16_f32 v180, v150, 0
v_cvt_pk_bf16_f32 v178, v146, v147
v_mfma_f32_16x16x32_bf16 v[118:121], v[182:185], a[88:91], v[118:121]
s_waitcnt lgkmcnt(2)
v_cvt_pk_bf16_f32 v179, v148, v149
v_mov_b32 v181, 0
v_mfma_f32_16x16x32_bf16 v[118:121], v[186:189], a[92:95], v[118:121]
v_exp_f32 v162, v162
v_mfma_f32_16x16x32_bf16 v[126:129], v[182:185], a[112:115], v[126:129]
v_exp_f32 v163, v163
v_mfma_f32_16x16x32_bf16 v[126:129], v[186:189], a[116:119], v[126:129]
v_exp_f32 v164, v164
v_mfma_f32_16x16x32_bf16 v[134:137], v[182:185], a[136:139], v[134:137]
v_exp_f32 v165, v165
v_mfma_f32_16x16x32_bf16 v[134:137], v[186:189], a[140:143], v[134:137]
v_cvt_pk_bf16_f32 v118, v118, v119
v_cvt_pk_bf16_f32 v119, v120, v121
v_mfma_f32_16x16x32_bf16 v[90:93], a[232:235], v[182:185], v[90:93]
ds_read_u16 v120, v214 offset:1024
v_mov_b32_e64 v121, 0
v_mfma_f32_16x16x32_bf16 v[90:93], a[236:239], v[186:189], v[90:93]
v_cvt_pk_bf16_f32 v126, v126, v127
v_cvt_pk_bf16_f32 v127, v128, v129
v_mfma_f32_16x16x32_bf16 v[170:173], v[224:227], v[182:185], v[170:173]
ds_read_u16 v128, v214 offset:1032
v_cvt_pk_bf16_f32 v134, v134, v135
v_mfma_f32_16x16x32_bf16 v[170:173], v[228:231], v[186:189], v[170:173]
v_cvt_pk_bf16_f32 v135, v136, v137
v_mov_b32_e64 v129, 0
v_mfma_f32_16x16x32_bf16 v[220:223], v[248:251], v[182:185], v[220:223]
ds_read_u16 v136, v214 offset:1040
v_mov_b32_e64 v137, 0
v_mfma_f32_16x16x32_bf16 v[220:223], v[252:255], v[186:189], v[220:223]
v_cvt_pk_bf16_f32 v90, v90, v91
v_cvt_pk_bf16_f32 v91, v92, v93
v_mfma_f32_16x16x32_bf16 v[150:153], v[190:193], v[174:177], 0
v_cvt_pk_bf16_f32 v92, v170, v171
v_cvt_pk_bf16_f32 v93, v172, v173
v_mfma_f32_16x16x32_bf16 v[150:153], v[190:193], v[178:181], v[150:153]
v_cvt_pk_bf16_f32 v94, v220, v221
v_cvt_pk_bf16_f32 v95, v222, v223
v_mfma_f32_16x16x32_bf16 v[138:141], v[114:117], v[174:177], 0
s_waitcnt lgkmcnt(2)
v_mfma_f32_16x16x32_bf16 v[138:141], v[118:121], v[178:181], v[138:141]
v_rcp_f32_e64 v151, v150
v_mfma_f32_16x16x32_bf16 v[142:145], v[122:125], v[174:177], 0
s_waitcnt lgkmcnt(1)
v_max3_u32 v218, v218, v150, v151
v_mul_f32_e64 v151, s3, v151
v_mfma_f32_16x16x32_bf16 v[142:145], v[126:129], v[178:181], v[142:145]
v_mul_f32_e64 v138, v138, v151
v_mul_f32 v139, v139, v151
v_mfma_f32_16x16x32_bf16 v[146:149], v[130:133], v[174:177], 0
s_waitcnt lgkmcnt(0)
v_cvt_pk_bf16_f32 v174, v154, v155
v_cvt_pk_bf16_f32 v175, v156, v157
v_mfma_f32_16x16x32_bf16 v[146:149], v[134:137], v[178:181], v[146:149]
v_cvt_pk_bf16_f32 v176, v158, v159
v_cvt_pk_bf16_f32 v177, v160, v161
v_cvt_pk_bf16_f32 v180, v166, 0
v_cvt_pk_bf16_f32 v178, v162, v163
v_mfma_f32_16x16x32_bf16 v[166:169], v[190:193], v[174:177], 0
v_cvt_pk_bf16_f32 v179, v164, v165
v_mul_f32 v140, v140, v151
v_mul_f32 v141, v141, v151
v_mfma_f32_16x16x32_bf16 v[166:169], v[190:193], v[178:181], v[166:169]
v_cvt_pk_bf16_f32 v138, v138, v139
v_mul_f32_e64 v142, v142, v151
v_mfma_f32_16x16x32_bf16 v[154:157], v[114:117], v[174:177], 0
v_mul_f32 v143, v143, v151
v_mul_f32 v144, v144, v151
v_mfma_f32_16x16x32_bf16 v[154:157], v[118:121], v[178:181], v[154:157]
v_mul_f32_e64 v145, v145, v151
v_cvt_pk_bf16_f32 v139, v140, v141
v_mfma_f32_16x16x32_bf16 v[158:161], v[122:125], v[174:177], 0
v_cvt_pk_bf16_f32 v140, v142, v143
v_cvt_pk_bf16_f32 v141, v144, v145
v_mfma_f32_16x16x32_bf16 v[158:161], v[126:129], v[178:181], v[158:161]
ds_write_b128 v211, v[138:141] offset:38912
v_mfma_f32_16x16x32_bf16 v[162:165], v[130:133], v[174:177], 0
v_mul_f32 v146, v146, v151
v_mul_f32 v147, v147, v151
v_mfma_f32_16x16x32_bf16 v[162:165], v[134:137], v[178:181], v[162:165]
v_mul_f32 v148, v148, v151
v_mul_f32 v149, v149, v151
v_cvt_pk_bf16_f32 v142, v146, v147
v_mfma_f32_16x16x16_bf16 v[138:141], v[82:83], v[94:95], 0
v_cvt_pk_bf16_f32 v143, v148, v149
v_rcp_f32_e64 v167, v166
v_mfma_f32_16x16x16_bf16 v[150:153], v[112:113], v[94:95], v[206:209]
v_max3_u32 v218, v218, v166, v167
v_mul_f32 v167, s3, v167
v_mul_f32 v154, v154, v167
v_mfma_f32_16x16x16_bf16 v[146:149], v[106:107], v[94:95], 0
v_mul_f32 v155, v155, v167
v_mul_f32 v156, v156, v167
v_mul_f32_e64 v157, v157, v167
v_cvt_pk_bf16_f32 v154, v154, v155
v_mfma_f32_16x16x32_bf16 v[138:141], v[78:81], v[90:93], v[138:141]
ds_write_b64 v212, v[142:143] offset:38912
v_mfma_f32_16x16x16_bf16 v[142:145], v[100:101], v[94:95], 0
v_mul_f32 v158, v158, v167
v_mul_f32 v159, v159, v167
v_mul_f32 v160, v160, v167
v_mul_f32 v161, v161, v167
v_mfma_f32_16x16x32_bf16 v[150:153], v[108:111], v[90:93], v[150:153]
v_cvt_pk_bf16_f32 v155, v156, v157
v_cvt_pk_bf16_f32 v156, v158, v159
v_mfma_f32_16x16x32_bf16 v[142:145], v[96:99], v[90:93], v[142:145]
v_cvt_pk_bf16_f32 v157, v160, v161
v_mul_f32_e64 v162, v162, v167
v_mfma_f32_16x16x32_bf16 v[146:149], v[102:105], v[90:93], v[146:149]
ds_write_b128 v211, v[154:157] offset:45056
v_mfma_f32_16x16x16_bf16 v[154:157], v[76:77], v[82:83], 0
v_mul_f32 v163, v163, v167
v_mul_f32 v164, v164, v167
v_mul_f32_e64 v165, v165, v167
v_mfma_f32_16x16x16_bf16 v[166:169], v[76:77], v[112:113], v[206:209]
v_cvt_pk_bf16_f32 v158, v162, v163
v_cvt_pk_bf16_f32 v159, v164, v165
v_exp_f32 v138, v138
v_mfma_f32_16x16x16_bf16 v[162:165], v[76:77], v[106:107], 0
v_exp_f32 v139, v139
v_exp_f32 v140, v140
v_mfma_f32_16x16x32_bf16 v[154:157], v[72:75], v[78:81], v[154:157]
ds_write_b64 v212, v[158:159] offset:45056
v_mfma_f32_16x16x16_bf16 v[158:161], v[76:77], v[100:101], 0
v_exp_f32 v141, v141
v_exp_f32 v142, v142
v_mfma_f32_16x16x32_bf16 v[162:165], v[72:75], v[102:105], v[162:165]
v_exp_f32 v143, v143
v_mfma_f32_16x16x32_bf16 v[158:161], v[72:75], v[96:99], v[158:161]
v_exp_f32 v144, v144
v_mfma_f32_16x16x32_bf16 v[166:169], v[72:75], v[108:111], v[166:169]
v_exp_f32 v145, v145
v_exp_f32 v150, v150
v_exp_f32 v146, v146
v_exp_f32 v147, v147
v_exp_f32 v148, v148
v_exp_f32_e64 v149, v149
v_cvt_pk_bf16_f32 v174, v138, v139
v_cvt_pk_bf16_f32 v175, v140, v141
v_cvt_pk_bf16_f32 v176, v142, v143
v_cvt_pk_bf16_f32 v177, v144, v145
v_cvt_pk_bf16_f32 v180, v150, 0
v_cvt_pk_bf16_f32 v178, v146, v147
v_mfma_f32_16x16x32_bf16 v[150:153], v[190:193], v[174:177], 0
s_waitcnt lgkmcnt(0)
v_cvt_pk_bf16_f32 v179, v148, v149
v_mov_b32_dpp v154, v158 quad_perm:[0,1,2,3] row_mask:0x2 bank_mask:0xf
v_mfma_f32_16x16x32_bf16 v[138:141], v[114:117], v[174:177], 0
s_barrier
v_mfma_f32_16x16x32_bf16 v[138:141], v[118:121], v[178:181], v[138:141]
ds_read_b128 v[220:223], v210 offset:38912
ds_read_b128 v[110:113], v210 offset:39936
v_mfma_f32_16x16x32_bf16 v[150:153], v[190:193], v[178:181], v[150:153]
ds_read_b128 v[170:173], v210 offset:40960
ds_read_b128 v[182:185], v210 offset:41984
v_mfma_f32_16x16x32_bf16 v[142:145], v[122:125], v[174:177], 0
v_mov_b32_dpp v154, v162 quad_perm:[0,1,2,3] row_mask:0x4 bank_mask:0xf
v_mfma_f32_16x16x32_bf16 v[142:145], v[126:129], v[178:181], v[142:145]
v_mov_b32_dpp v154, v167 quad_perm:[0,1,2,3] row_mask:0x8 bank_mask:0xf
v_exp_f32 v154, v154
v_mfma_f32_16x16x32_bf16 v[146:149], v[130:133], v[174:177], 0
v_cvt_pk_bf16_f32 v154, v154, 0
v_rcp_f32 v151, v150
v_mfma_f32_16x16x32_bf16 v[146:149], v[134:137], v[178:181], v[146:149]
s_waitcnt lgkmcnt(3)
ds_write_b16 v214, v154
v_mfma_f32_16x16x32_bf16 v[0:3], a[144:147], v[220:223], v[0:3]
s_waitcnt lgkmcnt(3)
ds_read_b128 v[84:87], v215
ds_read_b128 v[88:91], v215 offset:16
v_mfma_f32_16x16x32_bf16 v[0:3], a[148:151], v[110:113], v[0:3]
ds_read_b128 v[186:189], v210 offset:43008
ds_read_b128 v[174:177], v217
v_mfma_f32_16x16x32_bf16 v[4:7], a[168:171], v[220:223], v[4:7]
ds_read_b128 v[178:181], v217 offset:528
v_add_u32 v215, 1552, v215
v_mfma_f32_16x16x32_bf16 v[4:7], a[172:175], v[110:113], v[4:7]
v_mfma_f32_16x16x32_bf16 v[8:11], a[192:195], v[220:223], v[8:11]
ds_read_b128 v[220:223], v210 offset:44032
v_mfma_f32_16x16x32_bf16 v[8:11], a[196:199], v[110:113], v[8:11]
s_nop 0
ds_read_b128 v[110:113], v210 offset:45056
s_waitcnt lgkmcnt(6)
v_mfma_f32_16x16x32_bf16 v[166:169], v[84:87], v[190:193], 0
s_waitcnt lgkmcnt(5)
v_mfma_f32_16x16x32_bf16 v[166:169], v[88:91], v[190:193], v[166:169]
v_mfma_f32_16x16x32_bf16 v[154:157], v[84:87], v[114:117], 0
v_mfma_f32_16x16x32_bf16 v[154:157], v[88:91], v[118:121], v[154:157]
v_rcp_f32 v167, v166
v_mfma_f32_16x16x32_bf16 v[158:161], v[84:87], v[122:125], 0
v_max3_u32 v218, v218, v166, v167
v_max3_u32 v218, v218, v150, v151
v_mfma_f32_16x16x32_bf16 v[158:161], v[88:91], v[126:129], v[158:161]
v_mul_f32 v151, s3, v151
v_mul_f32 v138, v138, v151
v_mfma_f32_16x16x32_bf16 v[162:165], v[84:87], v[130:133], 0
v_mul_f32 v139, v139, v151
v_mul_f32 v140, v140, v151
v_mfma_f32_16x16x32_bf16 v[162:165], v[88:91], v[134:137], v[162:165]
v_mul_f32_e64 v141, v141, v151
v_cvt_pk_bf16_f32 v138, v138, v139
v_mfma_f32_16x16x32_bf16 v[0:3], a[152:155], v[170:173], v[0:3]
v_mul_f32 v142, v142, v151
v_mul_f32 v143, v143, v151
v_mfma_f32_16x16x32_bf16 v[0:3], a[156:159], v[182:185], v[0:3]
s_waitcnt lgkmcnt(4)
v_mul_f32 v144, v144, v151
v_mul_f32_e64 v145, v145, v151
v_mfma_f32_16x16x32_bf16 v[0:3], a[160:163], v[186:189], v[0:3]
v_cvt_pk_bf16_f32 v139, v140, v141
v_cvt_pk_bf16_f32 v140, v142, v143
v_mfma_f32_16x16x32_bf16 v[4:7], a[176:179], v[170:173], v[4:7]
v_cvt_pk_bf16_f32 v141, v144, v145
v_mul_f32_e64 v146, v146, v151
v_mfma_f32_16x16x32_bf16 v[4:7], a[180:183], v[182:185], v[4:7]
ds_write_b128 v211, v[138:141] offset:51200
v_mfma_f32_16x16x32_bf16 v[4:7], a[184:187], v[186:189], v[4:7]
v_mul_f32 v147, v147, v151
v_mul_f32 v148, v148, v151
v_mfma_f32_16x16x32_bf16 v[8:11], a[200:203], v[170:173], v[8:11]
v_mul_f32_e64 v149, v149, v151
v_cvt_pk_bf16_f32 v142, v146, v147
v_mfma_f32_16x16x32_bf16 v[8:11], a[204:207], v[182:185], v[8:11]
s_nop 0
ds_read_b128 v[170:173], v210 offset:46080
ds_read_b128 v[182:185], v210 offset:47104
v_mfma_f32_16x16x32_bf16 v[8:11], a[208:211], v[186:189], v[8:11]
s_waitcnt lgkmcnt(4)
ds_read_b128 v[186:189], v210 offset:48128
v_cvt_pk_bf16_f32 v143, v148, v149
v_mfma_f32_16x16x32_bf16 v[8:11], a[212:215], v[220:223], v[8:11]
ds_write_b64 v212, v[142:143] offset:51200
v_mfma_f32_16x16x32_bf16 v[0:3], a[164:167], v[220:223], v[0:3]
v_mov_b32_dpp v154, v158 quad_perm:[0,1,2,3] row_mask:0x2 bank_mask:0xf
v_mul_f32 v167, s3, v167
v_mfma_f32_16x16x32_bf16 v[4:7], a[188:191], v[220:223], v[4:7]
s_waitcnt lgkmcnt(5)
ds_read_b128 v[220:223], v210 offset:49152
v_mov_b32_dpp v154, v162 quad_perm:[0,1,2,3] row_mask:0x4 bank_mask:0xf
v_mfma_f32_16x16x32_bf16 v[12:15], a[144:147], v[110:113], v[12:15]
s_waitcnt lgkmcnt(4)
v_cvt_pk_bf16_f32 v72, v0, v1
v_cvt_pk_bf16_f32 v73, v2, v3
v_mfma_f32_16x16x32_bf16 v[12:15], a[148:151], v[170:173], v[12:15]
s_waitcnt lgkmcnt(3)
buffer_store_dwordx2 v[72:73], v203, s[8:11], s38 offen
v_cvt_pk_bf16_f32 v74, v4, v5
v_mfma_f32_16x16x32_bf16 v[12:15], a[152:155], v[182:185], v[12:15]
s_waitcnt lgkmcnt(2)
v_cvt_pk_bf16_f32 v75, v6, v7
v_mul_f32 v154, v154, v167
v_mfma_f32_16x16x32_bf16 v[12:15], a[156:159], v[186:189], v[12:15]
v_cvt_pk_bf16_f32 v154, v154, 0
v_cvt_pk_bf16_f32 v76, v8, v9
v_mfma_f32_16x16x32_bf16 v[16:19], a[168:171], v[110:113], v[16:19]
s_nop 0
ds_write_b16 v214, v154
v_mfma_f32_16x16x32_bf16 v[16:19], a[172:175], v[170:173], v[16:19]
s_waitcnt vmcnt(1) lgkmcnt(2)
v_cvt_pk_bf16_f32 v77, v10, v11
v_add_u32 v214, 1552, v214
v_mfma_f32_16x16x32_bf16 v[16:19], a[176:179], v[182:185], v[16:19]
s_barrier
v_mfma_f32_16x16x32_bf16 v[16:19], a[180:183], v[186:189], v[16:19]
s_nop 0
ds_read_b128 v[84:87], v200
ds_read_b128 v[92:95], v201
v_mfma_f32_16x16x32_bf16 v[20:23], a[192:195], v[110:113], v[20:23]
ds_read_b128 v[110:113], v210 offset:50176
ds_read_b128 v[100:103], v202
v_mfma_f32_16x16x32_bf16 v[20:23], a[196:199], v[170:173], v[20:23]
ds_read_b128 v[170:173], v210 offset:51200
ds_read_b128 v[88:91], v194 offset:16
v_mfma_f32_16x16x32_bf16 v[20:23], a[200:203], v[182:185], v[20:23]
ds_read_b128 v[182:185], v210 offset:52224
v_mfma_f32_16x16x32_bf16 v[20:23], a[204:207], v[186:189], v[20:23]
s_nop 0
ds_read_b128 v[186:189], v210 offset:53248
s_waitcnt lgkmcnt(9)
v_mfma_f32_16x16x32_bf16 v[20:23], a[208:211], v[220:223], v[20:23]
ds_read_b128 v[96:99], v195 offset:16
v_mfma_f32_16x16x32_bf16 v[12:15], a[160:163], v[220:223], v[12:15]
ds_read_b128 v[104:107], v196 offset:16
buffer_store_dwordx2 v[74:75], v203, s[8:11], s38 offen offset:32
v_mfma_f32_16x16x32_bf16 v[16:19], a[184:187], v[220:223], v[16:19]
ds_read_b128 v[220:223], v210 offset:54272
s_waitcnt lgkmcnt(8)
v_mfma_f32_16x16x32_bf16 v[16:19], a[188:191], v[110:113], v[16:19]
v_mfma_f32_16x16x32_bf16 v[12:15], a[164:167], v[110:113], v[12:15]
v_mfma_f32_16x16x32_bf16 v[20:23], a[212:215], v[110:113], v[20:23]
s_waitcnt lgkmcnt(6)
ds_read_b128 v[110:113], v210 offset:55296
v_cvt_pk_bf16_f32 v80, v16, v17
v_mfma_f32_16x16x32_bf16 v[24:27], a[144:147], v[170:173], v[24:27]
s_waitcnt lgkmcnt(5)
v_cvt_pk_bf16_f32 v78, v12, v13
v_cvt_pk_bf16_f32 v79, v14, v15
v_mfma_f32_16x16x32_bf16 v[24:27], a[148:151], v[182:185], v[24:27]
s_waitcnt lgkmcnt(4)
v_cvt_pk_bf16_f32 v81, v18, v19
v_cvt_pk_bf16_f32 v82, v20, v21
v_mfma_f32_16x16x32_bf16 v[24:27], a[152:155], v[186:189], v[24:27]
v_cvt_pk_bf16_f32 v83, v22, v23
v_mfma_f32_16x16x32_bf16 v[28:31], a[168:171], v[170:173], v[28:31]
v_mfma_f32_16x16x32_bf16 v[28:31], a[172:175], v[182:185], v[28:31]
s_nop 0
v_mfma_f32_16x16x32_bf16 v[28:31], a[176:179], v[186:189], v[28:31]
s_waitcnt lgkmcnt(1)
v_mfma_f32_16x16x32_bf16 v[28:31], a[180:183], v[220:223], v[28:31]
v_mfma_f32_16x16x32_bf16 v[32:35], a[192:195], v[170:173], v[32:35]
ds_read_b128 v[170:173], v210 offset:56320
v_mfma_f32_16x16x32_bf16 v[32:35], a[196:199], v[182:185], v[32:35]
ds_read_b128 v[182:185], v210 offset:20480
v_mfma_f32_16x16x32_bf16 v[32:35], a[200:203], v[186:189], v[32:35]
ds_read_b128 v[186:189], v210 offset:21504
v_mfma_f32_16x16x32_bf16 v[32:35], a[204:207], v[220:223], v[32:35]
buffer_store_dwordx2 v[76:77], v203, s[8:11], s38 offen offset:64
v_mfma_f32_16x16x32_bf16 v[0:3], v[174:177], v[84:87], 0
ds_read_b128 v[84:87], v194
v_mfma_f32_16x16x32_bf16 v[24:27], a[156:159], v[220:223], v[24:27]
ds_read_b128 v[220:223], v210 offset:23552
s_waitcnt lgkmcnt(5)
v_mfma_f32_16x16x32_bf16 v[24:27], a[160:163], v[110:113], v[24:27]
s_waitcnt lgkmcnt(4)
v_mfma_f32_16x16x32_bf16 v[24:27], a[164:167], v[170:173], v[24:27]
v_mfma_f32_16x16x32_bf16 v[12:15], v[174:177], v[92:95], 0
ds_read_b128 v[92:95], v195
v_mfma_f32_16x16x32_bf16 v[28:31], a[184:187], v[110:113], v[28:31]
v_cvt_pk_bf16_f32 v116, v24, v25
v_cvt_pk_bf16_f32 v117, v26, v27
v_mfma_f32_16x16x32_bf16 v[28:31], a[188:191], v[170:173], v[28:31]
v_mfma_f32_16x16x32_bf16 v[24:27], v[174:177], v[100:103], 0
ds_read_b128 v[100:103], v196
ds_read_b128 v[174:177], v217 offset:1056
v_mfma_f32_16x16x32_bf16 v[32:35], a[208:211], v[110:113], v[32:35]
ds_read_b128 v[110:113], v210 offset:22528
v_cvt_pk_bf16_f32 v124, v28, v29
v_mfma_f32_16x16x32_bf16 v[32:35], a[212:215], v[170:173], v[32:35]
v_cvt_pk_bf16_f32 v125, v30, v31
s_waitcnt lgkmcnt(5)
v_smfmac_f32_16x16x64_bf16 v[0:3], v[178:181], v[84:91], v213
s_waitcnt lgkmcnt(3)
ds_read_b128 v[84:87], v197
ds_read_b128 v[88:91], v197 offset:16
v_smfmac_f32_16x16x64_bf16 v[12:15], v[178:181], v[92:99], v213
ds_read_b128 v[92:95], v198
ds_read_b128 v[96:99], v198 offset:16
v_mfma_f32_16x16x32_bf16 v[138:141], a[0:3], v[182:185], 0
v_cvt_pk_bf16_f32 v132, v32, v33
v_cvt_pk_bf16_f32 v133, v34, v35
v_mfma_f32_16x16x32_bf16 v[138:141], a[4:7], v[186:189], v[138:141]
s_waitcnt lgkmcnt(6)
v_smfmac_f32_16x16x64_bf16 v[24:27], v[178:181], v[100:107], v213
s_nop 0
ds_read_b128 v[100:103], v199
ds_read_b128 v[104:107], v199 offset:16
v_mfma_f32_16x16x32_bf16 v[142:145], a[24:27], v[182:185], 0
ds_read_b128 v[178:181], v217 offset:1584
buffer_store_dwordx2 v[78:79], v204, s[8:11], s38 offen
v_mfma_f32_16x16x32_bf16 v[142:145], a[28:31], v[186:189], v[142:145]
s_waitcnt lgkmcnt(5)
v_smfmac_f32_16x16x64_bf16 v[0:3], v[174:177], v[84:91], v213
ds_read_b128 v[84:87], v200 offset:32
ds_read_b128 v[88:91], v194 offset:48
v_mfma_f32_16x16x32_bf16 v[146:149], a[48:51], v[182:185], 0
s_waitcnt lgkmcnt(5)
v_smfmac_f32_16x16x64_bf16 v[12:15], v[174:177], v[92:99], v213
ds_read_b128 v[92:95], v201 offset:32
ds_read_b128 v[96:99], v195 offset:48
v_mfma_f32_16x16x32_bf16 v[146:149], a[52:55], v[186:189], v[146:149]
s_waitcnt lgkmcnt(5)
v_mul_f32 v119, v0, v0
v_add_f32_e64 v118, v0, v1
v_smfmac_f32_16x16x64_bf16 v[24:27], v[174:177], v[100:107], v213
ds_read_b128 v[100:103], v202 offset:32
ds_read_b128 v[174:177], v217 offset:2112
v_mfma_f32_16x16x32_bf16 v[150:153], a[216:219], v[182:185], 0
ds_read_b128 v[104:107], v196 offset:48
v_mul_f32_e64 v127, v12, v12
v_mfma_f32_16x16x32_bf16 v[150:153], a[220:223], v[186:189], v[150:153]
s_waitcnt lgkmcnt(6)
v_mul_f32 v135, v24, v24
v_add_f32_e64 v134, v24, v25
v_mfma_f32_16x16x32_bf16 v[4:7], v[178:181], v[84:87], 0
ds_read_b128 v[84:87], v194 offset:32
v_fmac_f32_e64 v135, v25, v25
v_mfma_f32_16x16x32_bf16 v[154:157], a[240:243], v[182:185], 0
s_waitcnt lgkmcnt(5)
v_add_f32 v126, v12, v13
v_fmac_f32_e64 v119, v1, v1
v_mfma_f32_16x16x32_bf16 v[16:19], v[178:181], v[92:95], 0
ds_read_b128 v[92:95], v195 offset:32
v_fmac_f32_e64 v127, v13, v13
v_mfma_f32_16x16x32_bf16 v[154:157], a[244:247], v[186:189], v[154:157]
s_waitcnt lgkmcnt(4)
v_add_f32 v134, v134, v26
v_fmac_f32_e64 v135, v26, v26
v_mfma_f32_16x16x32_bf16 v[28:31], v[178:181], v[100:103], 0
ds_read_b128 v[100:103], v196 offset:32
ds_read_b128 v[178:181], v217 offset:2640
v_mfma_f32_16x16x32_bf16 v[158:161], v[232:235], v[182:185], 0
v_add_f32 v118, v118, v2
v_add_f32 v126, v126, v14
v_mfma_f32_16x16x32_bf16 v[158:161], v[236:239], v[186:189], v[158:161]
s_waitcnt lgkmcnt(3)
v_fmac_f32 v119, v2, v2
v_fmac_f32_e64 v127, v14, v14
v_smfmac_f32_16x16x64_bf16 v[4:7], v[174:177], v[84:91], v213
s_nop 0
ds_read_b128 v[84:87], v197 offset:32
ds_read_b128 v[88:91], v197 offset:48
v_mfma_f32_16x16x32_bf16 v[162:165], v[182:185], a[72:75], 0
s_waitcnt lgkmcnt(4)
buffer_store_dwordx2 v[80:81], v204, s[8:11], s38 offen offset:32
v_add_f32 v134, v134, v27
v_smfmac_f32_16x16x64_bf16 v[16:19], v[174:177], v[92:99], v213
s_waitcnt lgkmcnt(3)
ds_read_b128 v[92:95], v198 offset:32
ds_read_b128 v[96:99], v198 offset:48
v_smfmac_f32_16x16x64_bf16 v[28:31], v[174:177], v[100:107], v213
ds_read_b128 v[100:103], v199 offset:32
ds_read_b128 v[104:107], v199 offset:48
v_mfma_f32_16x16x32_bf16 v[162:165], v[186:189], a[76:79], v[162:165]
ds_read_b128 v[174:177], v217 offset:3168
v_fmac_f32_e64 v135, v27, v27
v_mfma_f32_16x16x32_bf16 v[166:169], v[182:185], a[96:99], 0
v_add_f32 v118, v118, v3
v_add_f32 v126, v126, v15
v_mfma_f32_16x16x32_bf16 v[166:169], v[186:189], a[100:103], v[166:169]
s_waitcnt lgkmcnt(5)
v_fmac_f32 v119, v3, v3
v_fmac_f32_e64 v127, v15, v15
v_smfmac_f32_16x16x64_bf16 v[4:7], v[178:181], v[84:91], v213
ds_read_b128 v[84:87], v200 offset:64
ds_read_b128 v[88:91], v194 offset:80
v_mfma_f32_16x16x32_bf16 v[170:173], v[182:185], a[120:123], 0
s_nop 0
ds_read_b128 v[182:185], v210 offset:24576
s_waitcnt lgkmcnt(6)
v_smfmac_f32_16x16x64_bf16 v[16:19], v[178:181], v[92:99], v213
ds_read_b128 v[92:95], v201 offset:64
ds_read_b128 v[96:99], v195 offset:80
v_mfma_f32_16x16x32_bf16 v[170:173], v[186:189], a[124:127], v[170:173]
ds_read_b128 v[186:189], v210 offset:25600
v_add_f32_e64 v118, v118, v4
v_mfma_f32_16x16x32_bf16 v[138:141], a[8:11], v[110:113], v[138:141]
s_waitcnt lgkmcnt(7)
v_fmac_f32 v119, v4, v4
v_add_f32_e64 v126, v126, v16
v_smfmac_f32_16x16x64_bf16 v[28:31], v[178:181], v[100:107], v213
ds_read_b128 v[100:103], v202 offset:64
ds_read_b128 v[178:181], v217 offset:3696
v_mfma_f32_16x16x32_bf16 v[138:141], a[12:15], v[220:223], v[138:141]
s_waitcnt lgkmcnt(7)
ds_read_b128 v[104:107], v196 offset:80
v_fmac_f32 v127, v16, v16
v_mfma_f32_16x16x32_bf16 v[8:11], v[174:177], v[84:87], 0
ds_read_b128 v[84:87], v194 offset:64
v_add_f32_e64 v134, v134, v28
v_mfma_f32_16x16x32_bf16 v[142:145], a[32:35], v[110:113], v[142:145]
buffer_store_dwordx2 v[82:83], v204, s[8:11], s38 offen offset:64
v_fmac_f32 v135, v28, v28
v_mfma_f32_16x16x32_bf16 v[142:145], a[36:39], v[220:223], v[142:145]
s_waitcnt lgkmcnt(6)
v_add_f32 v134, v134, v29
v_fmac_f32 v135, v29, v29
v_mfma_f32_16x16x32_bf16 v[20:23], v[174:177], v[92:95], 0
ds_read_b128 v[92:95], v195 offset:64
v_add_f32_e64 v118, v118, v5
v_mfma_f32_16x16x32_bf16 v[146:149], a[56:59], v[110:113], v[146:149]
v_fmac_f32 v119, v5, v5
v_add_f32 v126, v126, v17
v_mfma_f32_16x16x32_bf16 v[146:149], a[60:63], v[220:223], v[146:149]
s_waitcnt lgkmcnt(4)
v_fmac_f32 v127, v17, v17
v_add_f32_e64 v134, v134, v30
v_mfma_f32_16x16x32_bf16 v[32:35], v[174:177], v[100:103], 0
ds_read_b128 v[100:103], v196 offset:64
ds_read_b128 v[174:177], v217 offset:4224
v_mfma_f32_16x16x32_bf16 v[150:153], a[224:227], v[110:113], v[150:153]
v_fmac_f32 v135, v30, v30
v_add_f32 v118, v118, v6
v_mfma_f32_16x16x32_bf16 v[150:153], a[228:231], v[220:223], v[150:153]
s_waitcnt lgkmcnt(3)
v_fmac_f32 v119, v6, v6
v_add_f32 v126, v126, v18
v_smfmac_f32_16x16x64_bf16 v[8:11], v[178:181], v[84:91], v213
s_waitcnt lgkmcnt(2)
ds_read_b128 v[84:87], v197 offset:64
ds_read_b128 v[88:91], v197 offset:80
v_smfmac_f32_16x16x64_bf16 v[20:23], v[178:181], v[92:99], v213
ds_read_b128 v[92:95], v198 offset:64
ds_read_b128 v[96:99], v198 offset:80
v_mfma_f32_16x16x32_bf16 v[154:157], a[248:251], v[110:113], v[154:157]
v_fmac_f32 v127, v18, v18
v_add_f32 v134, v134, v31
v_mfma_f32_16x16x32_bf16 v[154:157], a[252:255], v[220:223], v[154:157]
s_waitcnt lgkmcnt(5)
v_fmac_f32 v135, v31, v31
v_add_f32_e64 v118, v118, v7
v_smfmac_f32_16x16x64_bf16 v[32:35], v[178:181], v[100:107], v213
ds_read_b128 v[100:103], v199 offset:64
ds_read_b128 v[104:107], v199 offset:80
v_mfma_f32_16x16x32_bf16 v[158:161], v[240:243], v[110:113], v[158:161]
v_fmac_f32 v119, v7, v7
v_add_f32 v126, v126, v19
v_mfma_f32_16x16x32_bf16 v[158:161], v[244:247], v[220:223], v[158:161]
v_fmac_f32 v127, v19, v19
s_waitcnt lgkmcnt(4)
v_smfmac_f32_16x16x64_bf16 v[8:11], v[174:177], v[84:91], v213
v_mfma_f32_16x16x32_bf16 v[162:165], v[110:113], a[80:83], v[162:165]
buffer_store_dwordx2 v[116:117], v205, s[8:11], s38 offen
v_mfma_f32_16x16x32_bf16 v[162:165], v[220:223], a[84:87], v[162:165]
v_add_f32 v118, v118, v8
v_fmac_f32 v119, v8, v8
v_mfma_f32_16x16x32_bf16 v[166:169], v[110:113], a[104:107], v[166:169]
v_add_f32 v118, v118, v9
v_fmac_f32 v119, v9, v9
v_mfma_f32_16x16x32_bf16 v[166:169], v[220:223], a[108:111], v[166:169]
s_waitcnt lgkmcnt(2)
v_add_f32 v118, v118, v10
v_fmac_f32_e64 v119, v10, v10
v_smfmac_f32_16x16x64_bf16 v[20:23], v[174:177], v[92:99], v213
v_add_f32_e64 v118, v118, v11
v_mfma_f32_16x16x32_bf16 v[170:173], v[110:113], a[128:131], v[170:173]
ds_read_b128 v[110:113], v210 offset:26624
v_fmac_f32 v119, v11, v11
v_mfma_f32_16x16x32_bf16 v[170:173], v[220:223], a[132:135], v[170:173]
s_waitcnt lgkmcnt(1)
ds_read_b128 v[220:223], v210 offset:27648
v_add_f32_e64 v126, v126, v20
v_smfmac_f32_16x16x64_bf16 v[32:35], v[174:177], v[100:107], v213
v_fmac_f32_e64 v127, v20, v20
v_mfma_f32_16x16x32_bf16 v[138:141], a[16:19], v[182:185], v[138:141]
v_add_f32 v126, v126, v21
v_fmac_f32 v127, v21, v21
v_mfma_f32_16x16x32_bf16 v[138:141], a[20:23], v[186:189], v[138:141]
v_add_f32 v134, v134, v32
v_fmac_f32 v135, v32, v32
v_mfma_f32_16x16x32_bf16 v[142:145], a[40:43], v[182:185], v[142:145]
v_add_f32 v134, v134, v33
v_fmac_f32 v135, v33, v33
v_mfma_f32_16x16x32_bf16 v[142:145], a[44:47], v[186:189], v[142:145]
v_cvt_pk_bf16_f32 v78, v138, v139
v_cvt_pk_bf16_f32 v79, v140, v141
v_mfma_f32_16x16x32_bf16 v[146:149], a[64:67], v[182:185], v[146:149]
v_add_f32 v134, v134, v34
v_fmac_f32 v135, v34, v34
v_mfma_f32_16x16x32_bf16 v[146:149], a[68:71], v[186:189], v[146:149]
v_cvt_pk_bf16_f32 v80, v142, v143
v_cvt_pk_bf16_f32 v81, v144, v145
v_mfma_f32_16x16x32_bf16 v[150:153], a[232:235], v[182:185], v[150:153]
v_add_f32 v126, v126, v22
v_fmac_f32 v127, v22, v22
v_mfma_f32_16x16x32_bf16 v[150:153], a[236:239], v[186:189], v[150:153]
v_cvt_pk_bf16_f32 v82, v146, v147
v_cvt_pk_bf16_f32 v83, v148, v149
v_mfma_f32_16x16x32_bf16 v[154:157], v[224:227], v[182:185], v[154:157]
buffer_store_dwordx2 v[124:125], v205, s[8:11], s38 offen offset:32
v_add_f32_e64 v134, v134, v35
v_mfma_f32_16x16x32_bf16 v[154:157], v[228:231], v[186:189], v[154:157]
v_cvt_pk_bf16_f32 v72, v150, v151
v_cvt_pk_bf16_f32 v73, v152, v153
v_mfma_f32_16x16x32_bf16 v[158:161], v[248:251], v[182:185], v[158:161]
v_fmac_f32 v135, v35, v35
v_add_f32 v126, v126, v23
v_mfma_f32_16x16x32_bf16 v[158:161], v[252:255], v[186:189], v[158:161]
v_cvt_pk_bf16_f32 v74, v154, v155
v_cvt_pk_bf16_f32 v75, v156, v157
v_mfma_f32_16x16x32_bf16 v[162:165], v[182:185], a[88:91], v[162:165]
v_fmac_f32 v127, v23, v23
v_permlane16_swap_b32 v134, v135
v_mfma_f32_16x16x32_bf16 v[162:165], v[186:189], a[92:95], v[162:165]
v_cvt_pk_bf16_f32 v76, v158, v159
v_cvt_pk_bf16_f32 v77, v160, v161
v_mfma_f32_16x16x32_bf16 v[166:169], v[182:185], a[112:115], v[166:169]
s_nop 0
v_permlane16_swap_b32 v118, v119
v_mfma_f32_16x16x32_bf16 v[166:169], v[186:189], a[116:119], v[166:169]
v_cvt_pk_bf16_f32 v114, v162, v163
v_cvt_pk_bf16_f32 v115, v164, v165
v_mfma_f32_16x16x32_bf16 v[170:173], v[182:185], a[136:139], v[170:173]
ds_read_b128 v[182:185], v210 offset:28672
v_add_f32 v134, v134, v135
v_mfma_f32_16x16x32_bf16 v[170:173], v[186:189], a[140:143], v[170:173]
s_waitcnt lgkmcnt(2)
ds_read_b128 v[186:189], v210 offset:29696
v_cvt_pk_bf16_f32 v122, v166, v167
v_mfma_f32_16x16x32_bf16 v[138:141], a[0:3], v[110:113], 0
s_waitcnt lgkmcnt(2)
v_cvt_pk_bf16_f32 v123, v168, v169
v_add_f32 v118, v118, v119
v_mfma_f32_16x16x32_bf16 v[138:141], a[4:7], v[220:223], v[138:141]
v_cvt_pk_bf16_f32 v130, v170, v171
v_cvt_pk_bf16_f32 v131, v172, v173
v_mfma_f32_16x16x32_bf16 v[142:145], a[24:27], v[110:113], 0
v_permlane16_swap_b32 v126, v127
v_mfma_f32_16x16x32_bf16 v[142:145], a[28:31], v[220:223], v[142:145]
v_mov_b32 v135, v134
v_add_f32_e64 v126, v126, v127
v_mfma_f32_16x16x32_bf16 v[146:149], a[48:51], v[110:113], 0
v_permlane32_swap_b32 v134, v135
v_mfma_f32_16x16x32_bf16 v[146:149], a[52:55], v[220:223], v[146:149]
v_permlane32_swap_b32 v118, v126
v_mfma_f32_16x16x32_bf16 v[150:153], a[216:219], v[110:113], 0
v_add_f32 v134, v134, v135
v_add_f32 v118, v118, v126
v_mfma_f32_16x16x32_bf16 v[150:153], a[220:223], v[220:223], v[150:153]
ds_write_b32 v209, v134 offset:512
v_mfma_f32_16x16x32_bf16 v[154:157], a[240:243], v[110:113], 0
ds_write_b32 v209, v118
v_mfma_f32_16x16x32_bf16 v[154:157], a[244:247], v[220:223], v[154:157]
v_mfma_f32_16x16x32_bf16 v[158:161], v[232:235], v[110:113], 0
v_mfma_f32_16x16x32_bf16 v[158:161], v[236:239], v[220:223], v[158:161]
v_mfma_f32_16x16x32_bf16 v[162:165], v[110:113], a[72:75], 0
v_mfma_f32_16x16x32_bf16 v[162:165], v[220:223], a[76:79], v[162:165]
s_waitcnt lgkmcnt(0)
s_barrier
v_mfma_f32_16x16x32_bf16 v[166:169], v[110:113], a[96:99], 0
ds_read_b128 v[102:105], v210 offset:18432
ds_read_b128 v[106:109], v210 offset:19456
v_mfma_f32_16x16x32_bf16 v[166:169], v[220:223], a[100:103], v[166:169]
v_mfma_f32_16x16x32_bf16 v[170:173], v[110:113], a[120:123], 0
ds_read_b128 v[110:113], v210 offset:30720
v_mfma_f32_16x16x32_bf16 v[170:173], v[220:223], a[124:127], v[170:173]
s_mov_b32 s46, 7
.p2align 6
F_loop:
v_mfma_f32_16x16x32_bf16 v[138:141], a[8:11], v[182:185], v[138:141]
s_waitcnt lgkmcnt(2)
v_add_f32 v102, v102, v103
v_mfma_f32_16x16x32_bf16 v[138:141], a[12:15], v[186:189], v[138:141]
v_add_f32 v104, v104, v105
v_add_f32 v102, v102, v104
v_mfma_f32_16x16x32_bf16 v[142:145], a[32:35], v[182:185], v[142:145]
s_waitcnt lgkmcnt(1)
v_add_f32 v106, v106, v107
v_add_f32_e64 v108, v108, v109
v_mfma_f32_16x16x32_bf16 v[142:145], a[36:39], v[186:189], v[142:145]
buffer_load_dwordx4 v216, s[4:7], s52 offen nt lds
v_mfma_f32_16x16x32_bf16 v[146:149], a[56:59], v[182:185], v[146:149]
v_add_f32 v106, v106, v108
v_mul_f32 v103, s48, v102
v_mfma_f32_16x16x32_bf16 v[146:149], a[60:63], v[186:189], v[146:149]
s_add_u32 m0, s45, 4112
v_mul_f32 v104, s73, v102
v_mul_f32 v106, s73, v106
v_mfma_f32_16x16x32_bf16 v[150:153], a[224:227], v[182:185], v[150:153]
s_add_u32 s40, s37, 196224
v_fma_f32 v106, -v103, v104, v106
v_max_f32_e64 v106, 0, v106
v_mfma_f32_16x16x32_bf16 v[150:153], a[228:231], v[186:189], v[150:153]
v_add_f32 v106, s49, v106
v_rsq_f32 v102, v106
v_mfma_f32_16x16x32_bf16 v[154:157], a[248:251], v[182:185], v[154:157]
ds_read_b128 v[106:109], v210 offset:31744
v_mul_f32_e64 v103, -v103, v102
v_mfma_f32_16x16x32_bf16 v[154:157], a[252:255], v[186:189], v[154:157]
ds_write_b64 v211, v[102:103]
v_mfma_f32_16x16x32_bf16 v[158:161], v[240:243], v[182:185], v[158:161]
buffer_load_dwordx4 v216, s[4:7], s40 offen nt lds
v_mfma_f32_16x16x32_bf16 v[158:161], v[244:247], v[186:189], v[158:161]
s_add_u32 m0, s45, 8224
ds_read_b64 v[118:119], v219
ds_read_b64 v[126:127], v219 offset:256
v_mfma_f32_16x16x32_bf16 v[162:165], v[182:185], a[80:83], v[162:165]
s_add_u32 s40, s37, 392448
ds_read_b64 v[134:135], v219 offset:512
v_mfma_f32_16x16x32_bf16 v[162:165], v[186:189], a[84:87], v[162:165]
v_mfma_f32_16x16x32_bf16 v[166:169], v[182:185], a[104:107], v[166:169]
v_mfma_f32_16x16x32_bf16 v[166:169], v[186:189], a[108:111], v[166:169]
s_nop 0
v_mfma_f32_16x16x32_bf16 v[170:173], v[182:185], a[128:131], v[170:173]
s_waitcnt lgkmcnt(2)
ds_read_b128 v[182:185], v210 offset:32768
v_fma_f32 v220, v0, v118, v119
v_mfma_f32_16x16x32_bf16 v[170:173], v[186:189], a[132:135], v[170:173]
ds_read_b128 v[186:189], v210 offset:33792
v_fma_f32 v221, v1, v118, v119
v_mfma_f32_16x16x32_bf16 v[138:141], a[16:19], v[110:113], v[138:141]
buffer_load_dwordx4 v216, s[4:7], s40 offen nt lds
v_mfma_f32_16x16x32_bf16 v[138:141], a[20:23], v[106:109], v[138:141]
s_add_u32 m0, s45, 12336
v_fma_f32 v222, v2, v118, v119
v_fma_f32 v223, v3, v118, v119
v_mfma_f32_16x16x32_bf16 v[142:145], a[40:43], v[110:113], v[142:145]
s_add_u32 s40, s37, 588672
v_cvt_pk_bf16_f32 v90, v220, v221
v_cvt_pk_bf16_f32 v91, v222, v223
v_mfma_f32_16x16x32_bf16 v[142:145], a[44:47], v[106:109], v[142:145]
v_cvt_pk_bf16_f32 v96, v138, v139
v_cvt_pk_bf16_f32 v97, v140, v141
v_mfma_f32_16x16x32_bf16 v[146:149], a[64:67], v[110:113], v[146:149]
v_fma_f32 v220, v4, v118, v119
v_fma_f32 v221, v5, v118, v119
v_mfma_f32_16x16x32_bf16 v[146:149], a[68:71], v[106:109], v[146:149]
v_fma_f32 v222, v6, v118, v119
v_fma_f32 v223, v7, v118, v119
v_mfma_f32_16x16x32_bf16 v[150:153], a[232:235], v[110:113], v[150:153]
v_cvt_pk_bf16_f32 v92, v220, v221
v_cvt_pk_bf16_f32 v93, v222, v223
v_mfma_f32_16x16x32_bf16 v[150:153], a[236:239], v[106:109], v[150:153]
v_cvt_pk_bf16_f32 v100, v146, v147
v_cvt_pk_bf16_f32 v101, v148, v149
v_mfma_f32_16x16x32_bf16 v[154:157], v[224:227], v[110:113], v[154:157]
buffer_load_dwordx4 v216, s[4:7], s40 offen nt lds
v_mfma_f32_16x16x32_bf16 v[154:157], v[228:231], v[106:109], v[154:157]
s_add_u32 m0, s45, 16448
v_fma_f32 v220, v8, v118, v119
v_fma_f32 v221, v9, v118, v119
v_mfma_f32_16x16x32_bf16 v[158:161], v[248:251], v[110:113], v[158:161]
s_add_u32 s40, s37, 784896
v_fma_f32 v222, v10, v118, v119
v_fma_f32 v223, v11, v118, v119
v_mfma_f32_16x16x32_bf16 v[158:161], v[252:255], v[106:109], v[158:161]
ds_write_b128 v211, v[90:93]
v_mfma_f32_16x16x32_bf16 v[162:165], v[110:113], a[88:91], v[162:165]
s_nop 0
v_cvt_pk_bf16_f32 v94, v220, v221
v_cvt_pk_bf16_f32 v95, v222, v223
v_mfma_f32_16x16x32_bf16 v[162:165], v[106:109], a[92:95], v[162:165]
s_waitcnt lgkmcnt(4)
v_fma_f32 v220, v12, v126, v127
v_fma_f32 v221, v13, v126, v127
v_mfma_f32_16x16x32_bf16 v[166:169], v[110:113], a[112:115], v[166:169]
v_fma_f32 v222, v14, v126, v127
v_fma_f32 v223, v15, v126, v127
v_mfma_f32_16x16x32_bf16 v[166:169], v[106:109], a[116:119], v[166:169]
buffer_store_dwordx2 v[132:133], v205, s[8:11], s38 offen offset:64
v_cvt_pk_bf16_f32 v98, v142, v143
v_mfma_f32_16x16x32_bf16 v[170:173], v[110:113], a[136:139], v[170:173]
ds_read_b64 v[112:113], v215 offset:528
v_cvt_pk_bf16_f32 v99, v144, v145
v_mfma_f32_16x16x32_bf16 v[170:173], v[106:109], a[140:143], v[170:173]
s_waitcnt lgkmcnt(3)
ds_read_b128 v[108:111], v215 offset:512
v_cvt_pk_bf16_f32 v174, v220, v221
v_mfma_f32_16x16x32_bf16 v[138:141], a[0:3], v[182:185], 0
s_waitcnt lgkmcnt(3)
v_cvt_pk_bf16_f32 v175, v222, v223
v_cvt_pk_bf16_f32 v84, v150, v151
v_mfma_f32_16x16x32_bf16 v[138:141], a[4:7], v[186:189], v[138:141]
v_cvt_pk_bf16_f32 v85, v152, v153
v_cvt_pk_bf16_f32 v132, v170, v171
v_mfma_f32_16x16x32_bf16 v[142:145], a[24:27], v[182:185], 0
v_cvt_pk_bf16_f32 v133, v172, v173
v_fma_f32 v220, v16, v126, v127
v_mfma_f32_16x16x32_bf16 v[142:145], a[28:31], v[186:189], v[142:145]
ds_read_b128 v[170:173], v210 offset:34816
v_fma_f32 v221, v17, v126, v127
v_mfma_f32_16x16x32_bf16 v[146:149], a[48:51], v[182:185], 0
s_nop 0
ds_read_b128 v[182:185], v210 offset:35840
v_fma_f32 v222, v18, v126, v127
v_mfma_f32_16x16x32_bf16 v[146:149], a[52:55], v[186:189], v[146:149]
s_waitcnt lgkmcnt(2)
ds_read_b128 v[186:189], v210 offset:36864
v_fma_f32 v223, v19, v126, v127
v_cvt_pk_bf16_f32 v176, v220, v221
v_mfma_f32_16x16x16_bf16 v[150:153], v[112:113], v[76:77], v[206:209]
v_cvt_pk_bf16_f32 v177, v222, v223
v_fma_f32 v220, v20, v126, v127
v_fma_f32 v221, v21, v126, v127
v_fma_f32 v222, v22, v126, v127
v_fma_f32 v223, v23, v126, v127
v_cvt_pk_bf16_f32 v178, v220, v221
v_mfma_f32_16x16x32_bf16 v[150:153], v[108:111], v[72:75], v[150:153]
ds_write_b128 v211, v[174:177] offset:6144
s_waitcnt lgkmcnt(3)
v_mfma_f32_16x16x32_bf16 v[138:141], a[8:11], v[170:173], v[138:141]
s_waitcnt lgkmcnt(2)
v_cvt_pk_bf16_f32 v179, v222, v223
v_cvt_pk_bf16_f32 v88, v158, v159
v_mfma_f32_16x16x32_bf16 v[138:141], a[12:15], v[182:185], v[138:141]
v_cvt_pk_bf16_f32 v89, v160, v161
v_cvt_pk_bf16_f32 v86, v154, v155
v_mfma_f32_16x16x32_bf16 v[142:145], a[32:35], v[170:173], v[142:145]
s_nop 0
ds_write_b64 v212, v[178:179] offset:6144
v_mfma_f32_16x16x32_bf16 v[142:145], a[36:39], v[182:185], v[142:145]
s_waitcnt lgkmcnt(2)
buffer_load_dwordx4 v216, s[4:7], s40 offen nt lds
v_mfma_f32_16x16x32_bf16 v[146:149], a[56:59], v[170:173], v[146:149]
s_add_u32 m0, s45, 20560
ds_read_b128 v[174:177], v210 offset:34816
ds_read_b128 v[178:181], v210 offset:35840
v_mfma_f32_16x16x32_bf16 v[146:149], a[60:63], v[182:185], v[146:149]
s_add_u32 s40, s37, 981120
ds_read_b128 v[182:185], v210 offset:32768
ds_read_b128 v[170:173], v210 offset:37888
v_mfma_f32_16x16x32_bf16 v[138:141], a[16:19], v[186:189], v[138:141]
v_cvt_pk_bf16_f32 v87, v156, v157
v_cvt_pk_bf16_f32 v124, v166, v167
v_cvt_pk_bf16_f32 v125, v168, v169
v_mfma_f32_16x16x16_bf16 v[154:157], v[82:83], v[88:89], 0
v_exp_f32_e64 v150, v150
v_fma_f32 v220, v24, v134, v135
v_mfma_f32_16x16x16_bf16 v[158:161], v[100:101], v[88:89], 0
v_fma_f32 v221, v25, v134, v135
v_fma_f32 v222, v26, v134, v135
v_fma_f32 v223, v27, v134, v135
v_mfma_f32_16x16x16_bf16 v[166:169], v[112:113], v[88:89], v[206:209]
v_cvt_pk_bf16_f32 v116, v162, v163
v_cvt_pk_bf16_f32 v117, v164, v165
v_cvt_pk_bf16_f32 v90, v220, v221
v_cvt_pk_bf16_f32 v91, v222, v223
v_mfma_f32_16x16x32_bf16 v[142:145], a[40:43], v[186:189], v[142:145]
buffer_load_dwordx4 v216, s[4:7], s40 offen nt lds
v_mfma_f32_16x16x32_bf16 v[154:157], v[78:81], v[84:87], v[154:157]
s_waitcnt lgkmcnt(1)
ds_write_b64 v212, v[94:95]
v_mfma_f32_16x16x32_bf16 v[118:121], v[182:185], a[72:75], 0
s_waitcnt lgkmcnt(1)
v_fma_f32 v220, v28, v134, v135
v_fma_f32 v221, v29, v134, v135
v_mfma_f32_16x16x32_bf16 v[126:129], v[182:185], a[96:99], 0
s_add_u32 m0, s45, 24672
v_exp_f32_e64 v154, v154
v_mfma_f32_16x16x32_bf16 v[138:141], a[20:23], v[170:173], v[138:141]
s_add_u32 s40, s37, 1177344
v_exp_f32 v155, v155
v_mfma_f32_16x16x32_bf16 v[142:145], a[44:47], v[170:173], v[142:145]
v_exp_f32 v156, v156
v_mfma_f32_16x16x32_bf16 v[146:149], a[64:67], v[186:189], v[146:149]
ds_read_b128 v[186:189], v210 offset:33792
v_cvt_pk_bf16_f32 v102, v138, v139
v_mfma_f32_16x16x32_bf16 v[146:149], a[68:71], v[170:173], v[146:149]
v_cvt_pk_bf16_f32 v103, v140, v141
v_cvt_pk_bf16_f32 v104, v142, v143
v_cvt_pk_bf16_f32 v105, v144, v145
v_mfma_f32_16x16x16_bf16 v[138:141], v[82:83], v[76:77], 0
v_exp_f32_e64 v157, v157
v_fma_f32 v222, v30, v134, v135
v_mfma_f32_16x16x16_bf16 v[142:145], v[100:101], v[76:77], 0
v_cvt_pk_bf16_f32 v106, v146, v147
v_cvt_pk_bf16_f32 v107, v148, v149
v_fma_f32 v223, v31, v134, v135
v_cvt_pk_bf16_f32 v92, v220, v221
v_mfma_f32_16x16x16_bf16 v[146:149], v[106:107], v[76:77], 0
v_cvt_pk_bf16_f32 v93, v222, v223
v_fma_f32 v220, v32, v134, v135
v_fma_f32 v221, v33, v134, v135
v_fma_f32 v222, v34, v134, v135
v_mfma_f32_16x16x32_bf16 v[138:141], v[78:81], v[72:75], v[138:141]
s_waitcnt lgkmcnt(0)
buffer_load_dwordx4 v216, s[4:7], s40 offen nt lds
v_mfma_f32_16x16x32_bf16 v[142:145], v[96:99], v[72:75], v[142:145]
s_add_u32 m0, s45, 28784
ds_write_b128 v211, v[90:93] offset:12288
v_mfma_f32_16x16x32_bf16 v[146:149], v[102:105], v[72:75], v[146:149]
s_add_u32 s40, s37, 1373568
v_exp_f32 v138, v138
v_mfma_f32_16x16x32_bf16 v[118:121], v[186:189], a[76:79], v[118:121]
v_exp_f32 v139, v139
v_mfma_f32_16x16x32_bf16 v[126:129], v[186:189], a[100:103], v[126:129]
buffer_load_dwordx4 v216, s[4:7], s40 offen nt lds
v_mfma_f32_16x16x32_bf16 v[90:93], a[216:219], v[182:185], 0
s_add_u32 m0, s45, 32896
v_exp_f32 v140, v140
v_mfma_f32_16x16x32_bf16 v[90:93], a[220:223], v[186:189], v[90:93]
s_add_u32 s40, s37, 1569792
v_exp_f32 v141, v141
v_mfma_f32_16x16x32_bf16 v[170:173], a[240:243], v[182:185], 0
v_exp_f32 v142, v142
v_mfma_f32_16x16x32_bf16 v[170:173], a[244:247], v[186:189], v[170:173]
v_exp_f32_e64 v143, v143
v_fma_f32 v223, v35, v134, v135
v_mfma_f32_16x16x16_bf16 v[162:165], v[106:107], v[88:89], 0
v_exp_f32 v144, v144
v_exp_f32 v145, v145
v_mfma_f32_16x16x32_bf16 v[134:137], v[182:185], a[120:123], 0
v_exp_f32 v146, v146
v_mfma_f32_16x16x32_bf16 v[134:137], v[186:189], a[124:127], v[134:137]
buffer_load_dwordx4 v216, s[4:7], s40 offen nt lds
v_mfma_f32_16x16x32_bf16 v[134:137], v[174:177], a[128:131], v[134:137]
v_exp_f32 v147, v147
v_mfma_f32_16x16x32_bf16 v[134:137], v[178:181], a[132:135], v[134:137]
v_exp_f32 v148, v148
v_mfma_f32_16x16x32_bf16 v[158:161], v[96:99], v[84:87], v[158:161]
v_exp_f32 v149, v149
v_mfma_f32_16x16x32_bf16 v[118:121], v[174:177], a[80:83], v[118:121]
v_cvt_pk_bf16_f32 v94, v220, v221
v_cvt_pk_bf16_f32 v95, v222, v223
v_mfma_f32_16x16x32_bf16 v[118:121], v[178:181], a[84:87], v[118:121]
v_exp_f32 v158, v158
v_mfma_f32_16x16x32_bf16 v[220:223], v[232:235], v[182:185], 0
v_exp_f32 v159, v159
v_mfma_f32_16x16x32_bf16 v[220:223], v[236:239], v[186:189], v[220:223]
v_exp_f32 v160, v160
v_mfma_f32_16x16x32_bf16 v[126:129], v[174:177], a[104:107], v[126:129]
v_exp_f32 v161, v161
v_mfma_f32_16x16x32_bf16 v[126:129], v[178:181], a[108:111], v[126:129]
ds_read_b128 v[182:185], v210 offset:36864
ds_read_b128 v[186:189], v210 offset:37888
v_mfma_f32_16x16x32_bf16 v[166:169], v[108:111], v[84:87], v[166:169]
ds_write_b64 v212, v[94:95] offset:12288
v_mfma_f32_16x16x32_bf16 v[90:93], a[224:227], v[174:177], v[90:93]
v_mfma_f32_16x16x32_bf16 v[90:93], a[228:231], v[178:181], v[90:93]
v_exp_f32_e64 v166, v166
v_mfma_f32_16x16x32_bf16 v[170:173], a[248:251], v[174:177], v[170:173]
ds_read_b64 v[76:77], v215 offset:16
ds_read_b128 v[72:75], v215
v_mfma_f32_16x16x32_bf16 v[170:173], a[252:255], v[178:181], v[170:173]
v_mfma_f32_16x16x32_bf16 v[220:223], v[240:243], v[174:177], v[220:223]
v_cvt_pk_bf16_f32 v174, v138, v139
v_cvt_pk_bf16_f32 v175, v140, v141
v_mfma_f32_16x16x32_bf16 v[220:223], v[244:247], v[178:181], v[220:223]
s_nop 0
v_cvt_pk_bf16_f32 v176, v142, v143
v_cvt_pk_bf16_f32 v177, v144, v145
v_mfma_f32_16x16x32_bf16 v[162:165], v[102:105], v[84:87], v[162:165]
s_waitcnt lgkmcnt(4)
v_cvt_pk_bf16_f32 v180, v150, 0
v_cvt_pk_bf16_f32 v178, v146, v147
v_mfma_f32_16x16x32_bf16 v[118:121], v[182:185], a[88:91], v[118:121]
s_waitcnt lgkmcnt(3)
v_cvt_pk_bf16_f32 v179, v148, v149
v_mov_b32 v181, 0
v_mfma_f32_16x16x32_bf16 v[118:121], v[186:189], a[92:95], v[118:121]
v_exp_f32 v162, v162
v_mfma_f32_16x16x32_bf16 v[126:129], v[182:185], a[112:115], v[126:129]
v_exp_f32 v163, v163
v_mfma_f32_16x16x32_bf16 v[126:129], v[186:189], a[116:119], v[126:129]
v_exp_f32 v164, v164
v_mfma_f32_16x16x32_bf16 v[134:137], v[182:185], a[136:139], v[134:137]
v_exp_f32 v165, v165
v_mfma_f32_16x16x32_bf16 v[134:137], v[186:189], a[140:143], v[134:137]
v_cvt_pk_bf16_f32 v118, v118, v119
v_cvt_pk_bf16_f32 v119, v120, v121
v_mfma_f32_16x16x32_bf16 v[90:93], a[232:235], v[182:185], v[90:93]
ds_read_u16 v120, v214 offset:1024
v_mov_b32_e64 v121, 0
v_mfma_f32_16x16x32_bf16 v[90:93], a[236:239], v[186:189], v[90:93]
v_cvt_pk_bf16_f32 v126, v126, v127
v_cvt_pk_bf16_f32 v127, v128, v129
v_mfma_f32_16x16x32_bf16 v[170:173], v[224:227], v[182:185], v[170:173]
ds_read_u16 v128, v214 offset:1032
v_cvt_pk_bf16_f32 v134, v134, v135
v_mfma_f32_16x16x32_bf16 v[170:173], v[228:231], v[186:189], v[170:173]
v_cvt_pk_bf16_f32 v135, v136, v137
v_mov_b32_e64 v129, 0
v_mfma_f32_16x16x32_bf16 v[220:223], v[248:251], v[182:185], v[220:223]
ds_read_u16 v136, v214 offset:1040
v_mov_b32_e64 v137, 0
v_mfma_f32_16x16x32_bf16 v[220:223], v[252:255], v[186:189], v[220:223]
v_cvt_pk_bf16_f32 v90, v90, v91
v_cvt_pk_bf16_f32 v91, v92, v93
v_mfma_f32_16x16x32_bf16 v[150:153], v[190:193], v[174:177], 0
v_cvt_pk_bf16_f32 v92, v170, v171
v_cvt_pk_bf16_f32 v93, v172, v173
v_mfma_f32_16x16x32_bf16 v[150:153], v[190:193], v[178:181], v[150:153]
v_cvt_pk_bf16_f32 v94, v220, v221
v_cvt_pk_bf16_f32 v95, v222, v223
v_mfma_f32_16x16x32_bf16 v[138:141], v[114:117], v[174:177], 0
s_waitcnt lgkmcnt(2)
v_mfma_f32_16x16x32_bf16 v[138:141], v[118:121], v[178:181], v[138:141]
v_rcp_f32_e64 v151, v150
v_mfma_f32_16x16x32_bf16 v[142:145], v[122:125], v[174:177], 0
s_waitcnt lgkmcnt(1)
v_max3_u32 v218, v218, v150, v151
v_mul_f32_e64 v151, s3, v151
v_mfma_f32_16x16x32_bf16 v[142:145], v[126:129], v[178:181], v[142:145]
v_mul_f32_e64 v138, v138, v151
v_mul_f32 v139, v139, v151
v_mfma_f32_16x16x32_bf16 v[146:149], v[130:133], v[174:177], 0
s_waitcnt lgkmcnt(0)
v_cvt_pk_bf16_f32 v174, v154, v155
v_cvt_pk_bf16_f32 v175, v156, v157
v_mfma_f32_16x16x32_bf16 v[146:149], v[134:137], v[178:181], v[146:149]
v_cvt_pk_bf16_f32 v176, v158, v159
v_cvt_pk_bf16_f32 v177, v160, v161
v_cvt_pk_bf16_f32 v180, v166, 0
v_cvt_pk_bf16_f32 v178, v162, v163
v_mfma_f32_16x16x32_bf16 v[166:169], v[190:193], v[174:177], 0
v_cvt_pk_bf16_f32 v179, v164, v165
v_mul_f32 v140, v140, v151
v_mul_f32 v141, v141, v151
v_mfma_f32_16x16x32_bf16 v[166:169], v[190:193], v[178:181], v[166:169]
v_cvt_pk_bf16_f32 v138, v138, v139
v_mul_f32_e64 v142, v142, v151
v_mfma_f32_16x16x32_bf16 v[154:157], v[114:117], v[174:177], 0
v_mul_f32 v143, v143, v151
v_mul_f32 v144, v144, v151
v_mfma_f32_16x16x32_bf16 v[154:157], v[118:121], v[178:181], v[154:157]
v_mul_f32_e64 v145, v145, v151
v_cvt_pk_bf16_f32 v139, v140, v141
v_mfma_f32_16x16x32_bf16 v[158:161], v[122:125], v[174:177], 0
v_cvt_pk_bf16_f32 v140, v142, v143
v_cvt_pk_bf16_f32 v141, v144, v145
v_mfma_f32_16x16x32_bf16 v[158:161], v[126:129], v[178:181], v[158:161]
ds_write_b128 v211, v[138:141] offset:38912
v_mfma_f32_16x16x32_bf16 v[162:165], v[130:133], v[174:177], 0
v_mul_f32 v146, v146, v151
v_mul_f32 v147, v147, v151
v_mfma_f32_16x16x32_bf16 v[162:165], v[134:137], v[178:181], v[162:165]
v_mul_f32 v148, v148, v151
v_mul_f32 v149, v149, v151
v_cvt_pk_bf16_f32 v142, v146, v147
v_mfma_f32_16x16x16_bf16 v[138:141], v[82:83], v[94:95], 0
v_cvt_pk_bf16_f32 v143, v148, v149
v_rcp_f32_e64 v167, v166
v_mfma_f32_16x16x16_bf16 v[150:153], v[112:113], v[94:95], v[206:209]
v_max3_u32 v218, v218, v166, v167
v_mul_f32 v167, s3, v167
v_mul_f32 v154, v154, v167
v_mfma_f32_16x16x16_bf16 v[146:149], v[106:107], v[94:95], 0
v_mul_f32 v155, v155, v167
v_mul_f32 v156, v156, v167
v_mul_f32_e64 v157, v157, v167
v_cvt_pk_bf16_f32 v154, v154, v155
v_mfma_f32_16x16x32_bf16 v[138:141], v[78:81], v[90:93], v[138:141]
ds_write_b64 v212, v[142:143] offset:38912
v_mfma_f32_16x16x16_bf16 v[142:145], v[100:101], v[94:95], 0
v_mul_f32 v158, v158, v167
v_mul_f32 v159, v159, v167
v_mul_f32 v160, v160, v167
v_mul_f32 v161, v161, v167
v_mfma_f32_16x16x32_bf16 v[150:153], v[108:111], v[90:93], v[150:153]
v_cvt_pk_bf16_f32 v155, v156, v157
v_cvt_pk_bf16_f32 v156, v158, v159
v_mfma_f32_16x16x32_bf16 v[142:145], v[96:99], v[90:93], v[142:145]
v_cvt_pk_bf16_f32 v157, v160, v161
v_mul_f32_e64 v162, v162, v167
v_mfma_f32_16x16x32_bf16 v[146:149], v[102:105], v[90:93], v[146:149]
ds_write_b128 v211, v[154:157] offset:45056
v_mfma_f32_16x16x16_bf16 v[154:157], v[76:77], v[82:83], 0
v_mul_f32 v163, v163, v167
v_mul_f32 v164, v164, v167
v_mul_f32_e64 v165, v165, v167
v_mfma_f32_16x16x16_bf16 v[166:169], v[76:77], v[112:113], v[206:209]
v_cvt_pk_bf16_f32 v158, v162, v163
v_cvt_pk_bf16_f32 v159, v164, v165
v_exp_f32 v138, v138
v_mfma_f32_16x16x16_bf16 v[162:165], v[76:77], v[106:107], 0
v_exp_f32 v139, v139
v_exp_f32 v140, v140
v_mfma_f32_16x16x32_bf16 v[154:157], v[72:75], v[78:81], v[154:157]
ds_write_b64 v212, v[158:159] offset:45056
v_mfma_f32_16x16x16_bf16 v[158:161], v[76:77], v[100:101], 0
v_exp_f32 v141, v141
v_exp_f32 v142, v142
v_mfma_f32_16x16x32_bf16 v[162:165], v[72:75], v[102:105], v[162:165]
v_exp_f32 v143, v143
v_mfma_f32_16x16x32_bf16 v[158:161], v[72:75], v[96:99], v[158:161]
v_exp_f32 v144, v144
v_mfma_f32_16x16x32_bf16 v[166:169], v[72:75], v[108:111], v[166:169]
v_exp_f32 v145, v145
v_exp_f32 v150, v150
v_exp_f32 v146, v146
v_exp_f32 v147, v147
v_exp_f32 v148, v148
v_exp_f32_e64 v149, v149
v_cvt_pk_bf16_f32 v174, v138, v139
v_cvt_pk_bf16_f32 v175, v140, v141
v_cvt_pk_bf16_f32 v176, v142, v143
v_cvt_pk_bf16_f32 v177, v144, v145
v_cvt_pk_bf16_f32 v180, v150, 0
v_cvt_pk_bf16_f32 v178, v146, v147
v_mfma_f32_16x16x32_bf16 v[150:153], v[190:193], v[174:177], 0
s_waitcnt lgkmcnt(0)
v_cvt_pk_bf16_f32 v179, v148, v149
v_mov_b32_dpp v154, v158 quad_perm:[0,1,2,3] row_mask:0x2 bank_mask:0xf
v_mfma_f32_16x16x32_bf16 v[138:141], v[114:117], v[174:177], 0
s_barrier
v_mfma_f32_16x16x32_bf16 v[138:141], v[118:121], v[178:181], v[138:141]
ds_read_b128 v[220:223], v210 offset:38912
ds_read_b128 v[110:113], v210 offset:39936
v_mfma_f32_16x16x32_bf16 v[150:153], v[190:193], v[178:181], v[150:153]
ds_read_b128 v[170:173], v210 offset:40960
ds_read_b128 v[182:185], v210 offset:41984
v_mfma_f32_16x16x32_bf16 v[142:145], v[122:125], v[174:177], 0
v_mov_b32_dpp v154, v162 quad_perm:[0,1,2,3] row_mask:0x4 bank_mask:0xf
v_mfma_f32_16x16x32_bf16 v[142:145], v[126:129], v[178:181], v[142:145]
v_mov_b32_dpp v154, v167 quad_perm:[0,1,2,3] row_mask:0x8 bank_mask:0xf
v_exp_f32 v154, v154
v_mfma_f32_16x16x32_bf16 v[146:149], v[130:133], v[174:177], 0
v_cvt_pk_bf16_f32 v154, v154, 0
v_rcp_f32 v151, v150
v_mfma_f32_16x16x32_bf16 v[146:149], v[134:137], v[178:181], v[146:149]
s_waitcnt lgkmcnt(3)
ds_write_b16 v214, v154
v_mfma_f32_16x16x32_bf16 v[36:39], a[144:147], v[220:223], v[36:39]
s_waitcnt lgkmcnt(3)
ds_read_b128 v[84:87], v215
ds_read_b128 v[88:91], v215 offset:16
v_mfma_f32_16x16x32_bf16 v[36:39], a[148:151], v[110:113], v[36:39]
ds_read_b128 v[186:189], v210 offset:43008
ds_read_b128 v[174:177], v217
v_mfma_f32_16x16x32_bf16 v[40:43], a[168:171], v[220:223], v[40:43]
s_mul_hi_u32 s41, s35, 58835169
ds_read_b128 v[178:181], v217 offset:528
s_mul_i32 s42, s41, 73
v_mfma_f32_16x16x32_bf16 v[40:43], a[172:175], v[110:113], v[40:43]
s_sub_u32 s42, s35, s42
s_mul_i32 s43, s41, 1373568
s_mul_i32 s51, s42, 2688
v_mfma_f32_16x16x32_bf16 v[44:47], a[192:195], v[220:223], v[44:47]
ds_read_b128 v[220:223], v210 offset:44032
v_mfma_f32_16x16x32_bf16 v[44:47], a[196:199], v[110:113], v[44:47]
ds_read_b128 v[110:113], v210 offset:45056
s_waitcnt lgkmcnt(6)
v_mfma_f32_16x16x32_bf16 v[166:169], v[84:87], v[190:193], 0
s_add_u32 s43, s43, s51
s_waitcnt lgkmcnt(5)
v_mfma_f32_16x16x32_bf16 v[166:169], v[88:91], v[190:193], v[166:169]
s_cmp_lt_u32 s35, s34
v_mfma_f32_16x16x32_bf16 v[154:157], v[84:87], v[114:117], 0
s_cselect_b32 s50, s43, 1879048192
v_mfma_f32_16x16x32_bf16 v[154:157], v[88:91], v[118:121], v[154:157]
s_add_u32 s35, s35, 32
v_rcp_f32 v167, v166
v_mfma_f32_16x16x32_bf16 v[158:161], v[84:87], v[122:125], 0
s_cmp_eq_u32 s42, 0
v_max3_u32 v218, v218, v166, v167
v_max3_u32 v218, v218, v150, v151
v_mfma_f32_16x16x32_bf16 v[158:161], v[88:91], v[126:129], v[158:161]
s_cselect_b32 s44, 536870911, s72
v_mul_f32 v151, s3, v151
v_mul_f32 v138, v138, v151
v_mfma_f32_16x16x32_bf16 v[162:165], v[84:87], v[130:133], 0
s_waitcnt lgkmcnt(4)
v_mul_f32 v139, v139, v151
v_mul_f32_e64 v140, v140, v151
v_mfma_f32_16x16x32_bf16 v[162:165], v[88:91], v[134:137], v[162:165]
s_cmp_eq_u32 s42, 72
v_mul_f32_e64 v141, v141, v151
v_cvt_pk_bf16_f32 v138, v138, v139
v_mfma_f32_16x16x32_bf16 v[36:39], a[152:155], v[170:173], v[36:39]
s_cselect_b32 s44, 939524095, s44
v_mul_f32 v142, v142, v151
v_mul_f32 v143, v143, v151
v_mfma_f32_16x16x32_bf16 v[36:39], a[156:159], v[182:185], v[36:39]
s_cmp_eq_u32 s41, 0
v_mul_f32 v144, v144, v151
v_mul_f32_e64 v145, v145, v151
v_mfma_f32_16x16x32_bf16 v[36:39], a[160:163], v[186:189], v[36:39]
s_cselect_b32 s52, 1879048192, s50
v_cvt_pk_bf16_f32 v139, v140, v141
v_cvt_pk_bf16_f32 v140, v142, v143
v_mfma_f32_16x16x32_bf16 v[40:43], a[176:179], v[170:173], v[40:43]
s_add_u32 m0, s45, 0
v_cvt_pk_bf16_f32 v141, v144, v145
v_mul_f32 v146, v146, v151
v_mfma_f32_16x16x32_bf16 v[40:43], a[180:183], v[182:185], v[40:43]
s_mov_b32 s38, s36
ds_write_b128 v211, v[138:141] offset:51200
v_mfma_f32_16x16x32_bf16 v[40:43], a[184:187], v[186:189], v[40:43]
s_mov_b32 s36, s50
v_mul_f32 v147, v147, v151
v_mul_f32 v148, v148, v151
v_mfma_f32_16x16x32_bf16 v[44:47], a[200:203], v[170:173], v[44:47]
v_mul_f32_e64 v149, v149, v151
v_cvt_pk_bf16_f32 v142, v146, v147
v_mfma_f32_16x16x32_bf16 v[44:47], a[204:207], v[182:185], v[44:47]
s_nop 0
ds_read_b128 v[170:173], v210 offset:46080
ds_read_b128 v[182:185], v210 offset:47104
v_mfma_f32_16x16x32_bf16 v[44:47], a[208:211], v[186:189], v[44:47]
s_waitcnt lgkmcnt(4)
ds_read_b128 v[186:189], v210 offset:48128
v_cvt_pk_bf16_f32 v143, v148, v149
v_mfma_f32_16x16x32_bf16 v[44:47], a[212:215], v[220:223], v[44:47]
ds_write_b64 v212, v[142:143] offset:51200
v_mfma_f32_16x16x32_bf16 v[36:39], a[164:167], v[220:223], v[36:39]
v_mov_b32_dpp v154, v158 quad_perm:[0,1,2,3] row_mask:0x2 bank_mask:0xf
v_mul_f32 v167, s3, v167
v_mfma_f32_16x16x32_bf16 v[40:43], a[188:191], v[220:223], v[40:43]
s_waitcnt lgkmcnt(5)
ds_read_b128 v[220:223], v210 offset:49152
v_mov_b32_dpp v154, v162 quad_perm:[0,1,2,3] row_mask:0x4 bank_mask:0xf
v_mfma_f32_16x16x32_bf16 v[48:51], a[144:147], v[110:113], v[48:51]
s_waitcnt lgkmcnt(4)
v_cvt_pk_bf16_f32 v72, v36, v37
v_cvt_pk_bf16_f32 v73, v38, v39
v_mfma_f32_16x16x32_bf16 v[48:51], a[148:151], v[170:173], v[48:51]
s_waitcnt lgkmcnt(3)
buffer_store_dwordx2 v[72:73], v203, s[8:11], s39 offen
v_cvt_pk_bf16_f32 v74, v40, v41
v_mfma_f32_16x16x32_bf16 v[48:51], a[152:155], v[182:185], v[48:51]
s_waitcnt lgkmcnt(2)
v_cvt_pk_bf16_f32 v75, v42, v43
v_mul_f32 v154, v154, v167
v_mfma_f32_16x16x32_bf16 v[48:51], a[156:159], v[186:189], v[48:51]
v_cvt_pk_bf16_f32 v154, v154, 0
v_cvt_pk_bf16_f32 v76, v44, v45
v_mfma_f32_16x16x32_bf16 v[52:55], a[168:171], v[110:113], v[52:55]
ds_write_b16 v214, v154
v_mfma_f32_16x16x32_bf16 v[52:55], a[172:175], v[170:173], v[52:55]
v_cvt_pk_bf16_f32 v77, v46, v47
v_and_b32 v216, s44, v208
v_mfma_f32_16x16x32_bf16 v[52:55], a[176:179], v[182:185], v[52:55]
v_add_u32 v215, 1552, v215
v_mfma_f32_16x16x32_bf16 v[52:55], a[180:183], v[186:189], v[52:55]
v_mfma_f32_16x16x32_bf16 v[56:59], a[192:195], v[110:113], v[56:59]
ds_read_b128 v[110:113], v210 offset:50176
v_mfma_f32_16x16x32_bf16 v[56:59], a[196:199], v[170:173], v[56:59]
v_mfma_f32_16x16x32_bf16 v[56:59], a[200:203], v[182:185], v[56:59]
s_waitcnt vmcnt(1) lgkmcnt(2)
v_mfma_f32_16x16x32_bf16 v[56:59], a[204:207], v[186:189], v[56:59]
s_barrier
v_mfma_f32_16x16x32_bf16 v[56:59], a[208:211], v[220:223], v[56:59]
ds_read_b128 v[170:173], v210 offset:51200
ds_read_b128 v[182:185], v210 offset:52224
v_mfma_f32_16x16x32_bf16 v[48:51], a[160:163], v[220:223], v[48:51]
s_waitcnt lgkmcnt(2)
ds_read_b128 v[186:189], v210 offset:53248
ds_read_b128 v[84:87], v200
v_mfma_f32_16x16x32_bf16 v[48:51], a[164:167], v[110:113], v[48:51]
ds_read_b128 v[92:95], v201
ds_read_b128 v[100:103], v202
v_mfma_f32_16x16x32_bf16 v[52:55], a[184:187], v[220:223], v[52:55]
s_nop 0
ds_read_b128 v[220:223], v210 offset:54272
buffer_store_dwordx2 v[74:75], v203, s[8:11], s39 offen offset:32
s_nop 0
v_cvt_pk_bf16_f32 v78, v48, v49
v_mfma_f32_16x16x32_bf16 v[52:55], a[188:191], v[110:113], v[52:55]
ds_read_b128 v[88:91], v194 offset:16
v_cvt_pk_bf16_f32 v79, v50, v51
v_mfma_f32_16x16x32_bf16 v[56:59], a[212:215], v[110:113], v[56:59]
s_nop 0
ds_read_b128 v[110:113], v210 offset:55296
s_waitcnt lgkmcnt(8)
v_mfma_f32_16x16x32_bf16 v[60:63], a[144:147], v[170:173], v[60:63]
s_waitcnt lgkmcnt(7)
ds_read_b128 v[96:99], v195 offset:16
v_cvt_pk_bf16_f32 v80, v52, v53
v_mfma_f32_16x16x32_bf16 v[60:63], a[148:151], v[182:185], v[60:63]
s_waitcnt lgkmcnt(7)
ds_read_b128 v[104:107], v196 offset:16
v_cvt_pk_bf16_f32 v81, v54, v55
v_mfma_f32_16x16x32_bf16 v[60:63], a[152:155], v[186:189], v[60:63]
v_cvt_pk_bf16_f32 v82, v56, v57
v_cvt_pk_bf16_f32 v83, v58, v59
v_mfma_f32_16x16x32_bf16 v[64:67], a[168:171], v[170:173], v[64:67]
v_mfma_f32_16x16x32_bf16 v[64:67], a[172:175], v[182:185], v[64:67]
s_nop 0
v_mfma_f32_16x16x32_bf16 v[64:67], a[176:179], v[186:189], v[64:67]
s_waitcnt lgkmcnt(4)
v_mfma_f32_16x16x32_bf16 v[64:67], a[180:183], v[220:223], v[64:67]
v_mfma_f32_16x16x32_bf16 v[68:71], a[192:195], v[170:173], v[68:71]
ds_read_b128 v[170:173], v210 offset:56320
v_mfma_f32_16x16x32_bf16 v[68:71], a[196:199], v[182:185], v[68:71]
ds_read_b128 v[182:185], v210
v_mfma_f32_16x16x32_bf16 v[68:71], a[200:203], v[186:189], v[68:71]
ds_read_b128 v[186:189], v210 offset:1024
v_mfma_f32_16x16x32_bf16 v[68:71], a[204:207], v[220:223], v[68:71]
buffer_store_dwordx2 v[76:77], v203, s[8:11], s39 offen offset:64
v_mfma_f32_16x16x32_bf16 v[36:39], v[174:177], v[84:87], 0
ds_read_b128 v[84:87], v194
v_mfma_f32_16x16x32_bf16 v[60:63], a[156:159], v[220:223], v[60:63]
ds_read_b128 v[220:223], v210 offset:3072
s_waitcnt lgkmcnt(7)
v_mfma_f32_16x16x32_bf16 v[60:63], a[160:163], v[110:113], v[60:63]
s_waitcnt lgkmcnt(4)
v_mfma_f32_16x16x32_bf16 v[60:63], a[164:167], v[170:173], v[60:63]
v_mfma_f32_16x16x32_bf16 v[48:51], v[174:177], v[92:95], 0
ds_read_b128 v[92:95], v195
v_mfma_f32_16x16x32_bf16 v[64:67], a[184:187], v[110:113], v[64:67]
v_cvt_pk_bf16_f32 v116, v60, v61
v_cvt_pk_bf16_f32 v117, v62, v63
v_mfma_f32_16x16x32_bf16 v[64:67], a[188:191], v[170:173], v[64:67]
v_mfma_f32_16x16x32_bf16 v[60:63], v[174:177], v[100:103], 0
ds_read_b128 v[100:103], v196
ds_read_b128 v[174:177], v217 offset:1056
v_mfma_f32_16x16x32_bf16 v[68:71], a[208:211], v[110:113], v[68:71]
ds_read_b128 v[110:113], v210 offset:2048
v_cvt_pk_bf16_f32 v124, v64, v65
v_mfma_f32_16x16x32_bf16 v[68:71], a[212:215], v[170:173], v[68:71]
v_cvt_pk_bf16_f32 v125, v66, v67
s_waitcnt lgkmcnt(5)
v_smfmac_f32_16x16x64_bf16 v[36:39], v[178:181], v[84:91], v213
s_waitcnt lgkmcnt(3)
ds_read_b128 v[84:87], v197
ds_read_b128 v[88:91], v197 offset:16
v_smfmac_f32_16x16x64_bf16 v[48:51], v[178:181], v[92:99], v213
ds_read_b128 v[92:95], v198
ds_read_b128 v[96:99], v198 offset:16
v_mfma_f32_16x16x32_bf16 v[138:141], a[0:3], v[182:185], 0
v_cvt_pk_bf16_f32 v132, v68, v69
v_cvt_pk_bf16_f32 v133, v70, v71
v_mfma_f32_16x16x32_bf16 v[138:141], a[4:7], v[186:189], v[138:141]
s_waitcnt lgkmcnt(6)
v_smfmac_f32_16x16x64_bf16 v[60:63], v[178:181], v[100:107], v213
s_nop 0
ds_read_b128 v[100:103], v199
ds_read_b128 v[104:107], v199 offset:16
v_mfma_f32_16x16x32_bf16 v[142:145], a[24:27], v[182:185], 0
ds_read_b128 v[178:181], v217 offset:1584
buffer_store_dwordx2 v[78:79], v204, s[8:11], s39 offen
v_mfma_f32_16x16x32_bf16 v[142:145], a[28:31], v[186:189], v[142:145]
s_waitcnt lgkmcnt(5)
v_smfmac_f32_16x16x64_bf16 v[36:39], v[174:177], v[84:91], v213
ds_read_b128 v[84:87], v200 offset:32
ds_read_b128 v[88:91], v194 offset:48
v_mfma_f32_16x16x32_bf16 v[146:149], a[48:51], v[182:185], 0
s_waitcnt lgkmcnt(5)
v_smfmac_f32_16x16x64_bf16 v[48:51], v[174:177], v[92:99], v213
ds_read_b128 v[92:95], v201 offset:32
ds_read_b128 v[96:99], v195 offset:48
v_mfma_f32_16x16x32_bf16 v[146:149], a[52:55], v[186:189], v[146:149]
s_waitcnt lgkmcnt(5)
v_mul_f32 v119, v36, v36
v_add_f32_e64 v118, v36, v37
v_smfmac_f32_16x16x64_bf16 v[60:63], v[174:177], v[100:107], v213
ds_read_b128 v[100:103], v202 offset:32
ds_read_b128 v[174:177], v217 offset:2112
v_mfma_f32_16x16x32_bf16 v[150:153], a[216:219], v[182:185], 0
ds_read_b128 v[104:107], v196 offset:48
v_mul_f32_e64 v127, v48, v48
v_mfma_f32_16x16x32_bf16 v[150:153], a[220:223], v[186:189], v[150:153]
s_waitcnt lgkmcnt(6)
v_mul_f32 v135, v60, v60
v_add_f32_e64 v134, v60, v61
v_mfma_f32_16x16x32_bf16 v[40:43], v[178:181], v[84:87], 0
ds_read_b128 v[84:87], v194 offset:32
v_fmac_f32_e64 v135, v61, v61
v_mfma_f32_16x16x32_bf16 v[154:157], a[240:243], v[182:185], 0
s_waitcnt lgkmcnt(5)
v_add_f32 v126, v48, v49
v_fmac_f32_e64 v119, v37, v37
v_mfma_f32_16x16x32_bf16 v[52:55], v[178:181], v[92:95], 0
ds_read_b128 v[92:95], v195 offset:32
v_fmac_f32_e64 v127, v49, v49
v_mfma_f32_16x16x32_bf16 v[154:157], a[244:247], v[186:189], v[154:157]
s_waitcnt lgkmcnt(4)
v_add_f32 v134, v134, v62
v_fmac_f32_e64 v135, v62, v62
v_mfma_f32_16x16x32_bf16 v[64:67], v[178:181], v[100:103], 0
ds_read_b128 v[100:103], v196 offset:32
ds_read_b128 v[178:181], v217 offset:2640
v_mfma_f32_16x16x32_bf16 v[158:161], v[232:235], v[182:185], 0
v_add_f32 v118, v118, v38
v_add_f32 v126, v126, v50
v_mfma_f32_16x16x32_bf16 v[158:161], v[236:239], v[186:189], v[158:161]
s_waitcnt lgkmcnt(3)
v_fmac_f32 v119, v38, v38
v_fmac_f32_e64 v127, v50, v50
v_smfmac_f32_16x16x64_bf16 v[40:43], v[174:177], v[84:91], v213
s_nop 0
ds_read_b128 v[84:87], v197 offset:32
ds_read_b128 v[88:91], v197 offset:48
v_mfma_f32_16x16x32_bf16 v[162:165], v[182:185], a[72:75], 0
s_waitcnt lgkmcnt(4)
buffer_store_dwordx2 v[80:81], v204, s[8:11], s39 offen offset:32
v_add_f32 v134, v134, v63
v_smfmac_f32_16x16x64_bf16 v[52:55], v[174:177], v[92:99], v213
s_waitcnt lgkmcnt(3)
ds_read_b128 v[92:95], v198 offset:32
ds_read_b128 v[96:99], v198 offset:48
v_smfmac_f32_16x16x64_bf16 v[64:67], v[174:177], v[100:107], v213
ds_read_b128 v[100:103], v199 offset:32
ds_read_b128 v[104:107], v199 offset:48
v_mfma_f32_16x16x32_bf16 v[162:165], v[186:189], a[76:79], v[162:165]
ds_read_b128 v[174:177], v217 offset:3168
v_fmac_f32_e64 v135, v63, v63
v_mfma_f32_16x16x32_bf16 v[166:169], v[182:185], a[96:99], 0
v_add_f32 v118, v118, v39
v_add_f32 v126, v126, v51
v_mfma_f32_16x16x32_bf16 v[166:169], v[186:189], a[100:103], v[166:169]
s_waitcnt lgkmcnt(5)
v_fmac_f32 v119, v39, v39
v_fmac_f32_e64 v127, v51, v51
v_smfmac_f32_16x16x64_bf16 v[40:43], v[178:181], v[84:91], v213
ds_read_b128 v[84:87], v200 offset:64
ds_read_b128 v[88:91], v194 offset:80
v_mfma_f32_16x16x32_bf16 v[170:173], v[182:185], a[120:123], 0
ds_read_b128 v[182:185], v210 offset:4096
v_add_u32 v214, 1552, v214
v_mfma_f32_16x16x32_bf16 v[170:173], v[186:189], a[124:127], v[170:173]
s_waitcnt lgkmcnt(6)
ds_read_b128 v[186:189], v210 offset:5120
v_add_f32 v118, v118, v40
v_smfmac_f32_16x16x64_bf16 v[52:55], v[178:181], v[92:99], v213
ds_read_b128 v[92:95], v201 offset:64
ds_read_b128 v[96:99], v195 offset:80
v_mfma_f32_16x16x32_bf16 v[138:141], a[8:11], v[110:113], v[138:141]
s_waitcnt lgkmcnt(7)
v_fmac_f32 v119, v40, v40
v_add_f32_e64 v118, v118, v41
v_smfmac_f32_16x16x64_bf16 v[64:67], v[178:181], v[100:107], v213
ds_read_b128 v[100:103], v202 offset:64
ds_read_b128 v[178:181], v217 offset:3696
v_mfma_f32_16x16x32_bf16 v[138:141], a[12:15], v[220:223], v[138:141]
s_waitcnt lgkmcnt(7)
ds_read_b128 v[104:107], v196 offset:80
v_add_f32 v126, v126, v52
v_mfma_f32_16x16x32_bf16 v[44:47], v[174:177], v[84:87], 0
ds_read_b128 v[84:87], v194 offset:64
v_add_f32_e64 v134, v134, v64
v_mfma_f32_16x16x32_bf16 v[142:145], a[32:35], v[110:113], v[142:145]
buffer_store_dwordx2 v[82:83], v204, s[8:11], s39 offen offset:64
v_fmac_f32 v135, v64, v64
v_mfma_f32_16x16x32_bf16 v[142:145], a[36:39], v[220:223], v[142:145]
s_waitcnt lgkmcnt(5)
v_fmac_f32 v127, v52, v52
v_add_f32 v134, v134, v65
v_mfma_f32_16x16x32_bf16 v[56:59], v[174:177], v[92:95], 0
ds_read_b128 v[92:95], v195 offset:64
v_fmac_f32_e64 v135, v65, v65
v_mfma_f32_16x16x32_bf16 v[146:149], a[56:59], v[110:113], v[146:149]
v_fmac_f32 v119, v41, v41
v_add_f32 v126, v126, v53
v_mfma_f32_16x16x32_bf16 v[146:149], a[60:63], v[220:223], v[146:149]
s_waitcnt lgkmcnt(4)
v_fmac_f32 v127, v53, v53
v_add_f32_e64 v134, v134, v66
v_mfma_f32_16x16x32_bf16 v[68:71], v[174:177], v[100:103], 0
ds_read_b128 v[100:103], v196 offset:64
ds_read_b128 v[174:177], v217 offset:4224
v_mfma_f32_16x16x32_bf16 v[150:153], a[224:227], v[110:113], v[150:153]
v_fmac_f32 v135, v66, v66
v_add_f32 v118, v118, v42
v_mfma_f32_16x16x32_bf16 v[150:153], a[228:231], v[220:223], v[150:153]
s_waitcnt lgkmcnt(3)
v_fmac_f32 v119, v42, v42
v_add_f32 v126, v126, v54
v_smfmac_f32_16x16x64_bf16 v[44:47], v[178:181], v[84:91], v213
s_waitcnt lgkmcnt(2)
ds_read_b128 v[84:87], v197 offset:64
ds_read_b128 v[88:91], v197 offset:80
v_smfmac_f32_16x16x64_bf16 v[56:59], v[178:181], v[92:99], v213
ds_read_b128 v[92:95], v198 offset:64
ds_read_b128 v[96:99], v198 offset:80
v_mfma_f32_16x16x32_bf16 v[154:157], a[248:251], v[110:113], v[154:157]
v_fmac_f32 v127, v54, v54
v_add_f32 v134, v134, v67
v_mfma_f32_16x16x32_bf16 v[154:157], a[252:255], v[220:223], v[154:157]
s_waitcnt lgkmcnt(5)
v_fmac_f32 v135, v67, v67
v_add_f32_e64 v118, v118, v43
v_smfmac_f32_16x16x64_bf16 v[68:71], v[178:181], v[100:107], v213
ds_read_b128 v[100:103], v199 offset:64
ds_read_b128 v[104:107], v199 offset:80
v_mfma_f32_16x16x32_bf16 v[158:161], v[240:243], v[110:113], v[158:161]
v_fmac_f32 v119, v43, v43
v_add_f32 v126, v126, v55
v_mfma_f32_16x16x32_bf16 v[158:161], v[244:247], v[220:223], v[158:161]
v_fmac_f32 v127, v55, v55
s_waitcnt lgkmcnt(4)
v_smfmac_f32_16x16x64_bf16 v[44:47], v[174:177], v[84:91], v213
v_mfma_f32_16x16x32_bf16 v[162:165], v[110:113], a[80:83], v[162:165]
buffer_store_dwordx2 v[116:117], v205, s[8:11], s39 offen
v_mfma_f32_16x16x32_bf16 v[162:165], v[220:223], a[84:87], v[162:165]
v_add_f32 v118, v118, v44
v_fmac_f32 v119, v44, v44
v_mfma_f32_16x16x32_bf16 v[166:169], v[110:113], a[104:107], v[166:169]
v_add_f32 v118, v118, v45
v_fmac_f32 v119, v45, v45
v_mfma_f32_16x16x32_bf16 v[166:169], v[220:223], a[108:111], v[166:169]
s_waitcnt lgkmcnt(2)
v_add_f32 v118, v118, v46
v_fmac_f32_e64 v119, v46, v46
v_smfmac_f32_16x16x64_bf16 v[56:59], v[174:177], v[92:99], v213
v_add_f32_e64 v118, v118, v47
v_mfma_f32_16x16x32_bf16 v[170:173], v[110:113], a[128:131], v[170:173]
ds_read_b128 v[110:113], v210 offset:6144
v_fmac_f32 v119, v47, v47
v_mfma_f32_16x16x32_bf16 v[170:173], v[220:223], a[132:135], v[170:173]
s_waitcnt lgkmcnt(1)
ds_read_b128 v[220:223], v210 offset:7168
v_add_f32_e64 v126, v126, v56
v_smfmac_f32_16x16x64_bf16 v[68:71], v[174:177], v[100:107], v213
v_fmac_f32_e64 v127, v56, v56
v_mfma_f32_16x16x32_bf16 v[138:141], a[16:19], v[182:185], v[138:141]
v_add_f32 v126, v126, v57
v_fmac_f32 v127, v57, v57
v_mfma_f32_16x16x32_bf16 v[138:141], a[20:23], v[186:189], v[138:141]
v_add_f32 v134, v134, v68
v_fmac_f32 v135, v68, v68
v_mfma_f32_16x16x32_bf16 v[142:145], a[40:43], v[182:185], v[142:145]
v_add_f32 v134, v134, v69
v_fmac_f32 v135, v69, v69
v_mfma_f32_16x16x32_bf16 v[142:145], a[44:47], v[186:189], v[142:145]
v_cvt_pk_bf16_f32 v78, v138, v139
v_cvt_pk_bf16_f32 v79, v140, v141
v_mfma_f32_16x16x32_bf16 v[146:149], a[64:67], v[182:185], v[146:149]
v_add_f32 v134, v134, v70
v_fmac_f32 v135, v70, v70
v_mfma_f32_16x16x32_bf16 v[146:149], a[68:71], v[186:189], v[146:149]
v_cvt_pk_bf16_f32 v80, v142, v143
v_cvt_pk_bf16_f32 v81, v144, v145
v_mfma_f32_16x16x32_bf16 v[150:153], a[232:235], v[182:185], v[150:153]
v_add_f32 v126, v126, v58
v_fmac_f32 v127, v58, v58
v_mfma_f32_16x16x32_bf16 v[150:153], a[236:239], v[186:189], v[150:153]
v_cvt_pk_bf16_f32 v82, v146, v147
v_cvt_pk_bf16_f32 v83, v148, v149
v_mfma_f32_16x16x32_bf16 v[154:157], v[224:227], v[182:185], v[154:157]
v_add_f32 v134, v134, v71
v_fmac_f32 v135, v71, v71
v_mfma_f32_16x16x32_bf16 v[154:157], v[228:231], v[186:189], v[154:157]
v_cvt_pk_bf16_f32 v72, v150, v151
v_cvt_pk_bf16_f32 v73, v152, v153
v_mfma_f32_16x16x32_bf16 v[158:161], v[248:251], v[182:185], v[158:161]
v_add_f32 v126, v126, v59
v_fmac_f32 v127, v59, v59
v_mfma_f32_16x16x32_bf16 v[158:161], v[252:255], v[186:189], v[158:161]
v_cvt_pk_bf16_f32 v74, v154, v155
v_cvt_pk_bf16_f32 v75, v156, v157
v_mfma_f32_16x16x32_bf16 v[162:165], v[182:185], a[88:91], v[162:165]
s_nop 0
v_permlane16_swap_b32 v134, v135
v_mfma_f32_16x16x32_bf16 v[162:165], v[186:189], a[92:95], v[162:165]
v_cvt_pk_bf16_f32 v76, v158, v159
v_cvt_pk_bf16_f32 v77, v160, v161
v_mfma_f32_16x16x32_bf16 v[166:169], v[182:185], a[112:115], v[166:169]
v_permlane16_swap_b32 v118, v119
v_mfma_f32_16x16x32_bf16 v[166:169], v[186:189], a[116:119], v[166:169]
v_permlane16_swap_b32 v126, v127
v_mfma_f32_16x16x32_bf16 v[170:173], v[182:185], a[136:139], v[170:173]
ds_read_b128 v[182:185], v210 offset:8192
v_add_f32 v134, v134, v135
v_mfma_f32_16x16x32_bf16 v[170:173], v[186:189], a[140:143], v[170:173]
s_waitcnt lgkmcnt(2)
ds_read_b128 v[186:189], v210 offset:9216
v_cvt_pk_bf16_f32 v114, v162, v163
v_mfma_f32_16x16x32_bf16 v[138:141], a[0:3], v[110:113], 0
s_waitcnt lgkmcnt(2)
v_cvt_pk_bf16_f32 v115, v164, v165
v_add_f32 v118, v118, v119
v_mfma_f32_16x16x32_bf16 v[138:141], a[4:7], v[220:223], v[138:141]
v_add_f32 v126, v126, v127
v_mov_b32 v135, v134
v_mfma_f32_16x16x32_bf16 v[142:145], a[24:27], v[110:113], 0
v_permlane32_swap_b32 v118, v126
v_mfma_f32_16x16x32_bf16 v[142:145], a[28:31], v[220:223], v[142:145]
v_permlane32_swap_b32 v134, v135
v_mfma_f32_16x16x32_bf16 v[146:149], a[48:51], v[110:113], 0
v_cvt_pk_bf16_f32 v122, v166, v167
v_cvt_pk_bf16_f32 v123, v168, v169
v_mfma_f32_16x16x32_bf16 v[146:149], a[52:55], v[220:223], v[146:149]
v_add_f32 v118, v118, v126
v_add_f32 v134, v134, v135
v_mfma_f32_16x16x32_bf16 v[150:153], a[216:219], v[110:113], 0
ds_write_b32 v209, v118
v_mfma_f32_16x16x32_bf16 v[150:153], a[220:223], v[220:223], v[150:153]
ds_write_b32 v209, v134 offset:512
v_mfma_f32_16x16x32_bf16 v[154:157], a[240:243], v[110:113], 0
v_cvt_pk_bf16_f32 v130, v170, v171
v_cvt_pk_bf16_f32 v131, v172, v173
v_mfma_f32_16x16x32_bf16 v[154:157], a[244:247], v[220:223], v[154:157]
buffer_store_dwordx2 v[124:125], v205, s[8:11], s39 offen offset:32
v_mfma_f32_16x16x32_bf16 v[158:161], v[232:235], v[110:113], 0
v_mfma_f32_16x16x32_bf16 v[158:161], v[236:239], v[220:223], v[158:161]
v_mfma_f32_16x16x32_bf16 v[162:165], v[110:113], a[72:75], 0
s_waitcnt lgkmcnt(0)
s_barrier
v_mfma_f32_16x16x32_bf16 v[162:165], v[220:223], a[76:79], v[162:165]
ds_read_b128 v[102:105], v210 offset:18432
ds_read_b128 v[106:109], v210 offset:19456
v_mfma_f32_16x16x32_bf16 v[166:169], v[110:113], a[96:99], 0
v_mfma_f32_16x16x32_bf16 v[166:169], v[220:223], a[100:103], v[166:169]
v_mfma_f32_16x16x32_bf16 v[170:173], v[110:113], a[120:123], 0
ds_read_b128 v[110:113], v210 offset:10240
v_mfma_f32_16x16x32_bf16 v[170:173], v[220:223], a[124:127], v[170:173]
s_cmp_eq_u32 s46, 1
s_cbranch_scc1 F_pf
F_nopf:
v_mfma_f32_16x16x32_bf16 v[138:141], a[8:11], v[182:185], v[138:141]
s_waitcnt lgkmcnt(2)
v_add_f32 v102, v102, v103
v_mfma_f32_16x16x32_bf16 v[138:141], a[12:15], v[186:189], v[138:141]
v_add_f32 v104, v104, v105
v_add_f32 v102, v102, v104
v_mfma_f32_16x16x32_bf16 v[142:145], a[32:35], v[182:185], v[142:145]
s_waitcnt lgkmcnt(1)
v_add_f32 v106, v106, v107
v_add_f32_e64 v108, v108, v109
v_mfma_f32_16x16x32_bf16 v[142:145], a[36:39], v[186:189], v[142:145]
buffer_load_dwordx4 v216, s[4:7], s52 offen nt lds
v_mfma_f32_16x16x32_bf16 v[146:149], a[56:59], v[182:185], v[146:149]
v_add_f32 v106, v106, v108
v_mul_f32 v103, s48, v102
v_mfma_f32_16x16x32_bf16 v[146:149], a[60:63], v[186:189], v[146:149]
s_add_u32 m0, s45, 4112
v_mul_f32 v104, s73, v102
v_mul_f32 v106, s73, v106
v_mfma_f32_16x16x32_bf16 v[150:153], a[224:227], v[182:185], v[150:153]
s_add_u32 s40, s36, 196224
v_fma_f32 v106, -v103, v104, v106
v_max_f32_e64 v106, 0, v106
v_mfma_f32_16x16x32_bf16 v[150:153], a[228:231], v[186:189], v[150:153]
v_add_f32 v106, s49, v106
v_rsq_f32 v102, v106
v_mfma_f32_16x16x32_bf16 v[154:157], a[248:251], v[182:185], v[154:157]
ds_read_b128 v[106:109], v210 offset:11264
v_mul_f32_e64 v103, -v103, v102
v_mfma_f32_16x16x32_bf16 v[154:157], a[252:255], v[186:189], v[154:157]
ds_write_b64 v211, v[102:103] offset:20480
v_mfma_f32_16x16x32_bf16 v[158:161], v[240:243], v[182:185], v[158:161]
buffer_load_dwordx4 v216, s[4:7], s40 offen nt lds
v_mfma_f32_16x16x32_bf16 v[158:161], v[244:247], v[186:189], v[158:161]
s_add_u32 m0, s45, 8224
ds_read_b64 v[118:119], v219 offset:20480
ds_read_b64 v[126:127], v219 offset:20736
v_mfma_f32_16x16x32_bf16 v[162:165], v[182:185], a[80:83], v[162:165]
s_add_u32 s40, s36, 392448
ds_read_b64 v[134:135], v219 offset:20992
v_mfma_f32_16x16x32_bf16 v[162:165], v[186:189], a[84:87], v[162:165]
v_mfma_f32_16x16x32_bf16 v[166:169], v[182:185], a[104:107], v[166:169]
v_mfma_f32_16x16x32_bf16 v[166:169], v[186:189], a[108:111], v[166:169]
s_nop 0
v_mfma_f32_16x16x32_bf16 v[170:173], v[182:185], a[128:131], v[170:173]
s_waitcnt lgkmcnt(2)
ds_read_b128 v[182:185], v210 offset:12288
v_fma_f32 v220, v36, v118, v119
v_mfma_f32_16x16x32_bf16 v[170:173], v[186:189], a[132:135], v[170:173]
ds_read_b128 v[186:189], v210 offset:13312
v_fma_f32 v221, v37, v118, v119
v_mfma_f32_16x16x32_bf16 v[138:141], a[16:19], v[110:113], v[138:141]
buffer_load_dwordx4 v216, s[4:7], s40 offen nt lds
v_mfma_f32_16x16x32_bf16 v[138:141], a[20:23], v[106:109], v[138:141]
s_add_u32 m0, s45, 12336
v_fma_f32 v222, v38, v118, v119
v_fma_f32 v223, v39, v118, v119
v_mfma_f32_16x16x32_bf16 v[142:145], a[40:43], v[110:113], v[142:145]
s_add_u32 s40, s36, 588672
v_cvt_pk_bf16_f32 v90, v220, v221
v_cvt_pk_bf16_f32 v91, v222, v223
v_mfma_f32_16x16x32_bf16 v[142:145], a[44:47], v[106:109], v[142:145]
v_cvt_pk_bf16_f32 v96, v138, v139
v_cvt_pk_bf16_f32 v97, v140, v141
v_mfma_f32_16x16x32_bf16 v[146:149], a[64:67], v[110:113], v[146:149]
v_fma_f32 v220, v40, v118, v119
v_fma_f32 v221, v41, v118, v119
v_mfma_f32_16x16x32_bf16 v[146:149], a[68:71], v[106:109], v[146:149]
v_fma_f32 v222, v42, v118, v119
v_fma_f32 v223, v43, v118, v119
v_mfma_f32_16x16x32_bf16 v[150:153], a[232:235], v[110:113], v[150:153]
v_cvt_pk_bf16_f32 v92, v220, v221
v_cvt_pk_bf16_f32 v93, v222, v223
v_mfma_f32_16x16x32_bf16 v[150:153], a[236:239], v[106:109], v[150:153]
v_cvt_pk_bf16_f32 v100, v146, v147
v_cvt_pk_bf16_f32 v101, v148, v149
v_mfma_f32_16x16x32_bf16 v[154:157], v[224:227], v[110:113], v[154:157]
buffer_load_dwordx4 v216, s[4:7], s40 offen nt lds
v_mfma_f32_16x16x32_bf16 v[154:157], v[228:231], v[106:109], v[154:157]
s_add_u32 m0, s45, 16448
v_fma_f32 v220, v44, v118, v119
v_fma_f32 v221, v45, v118, v119
v_mfma_f32_16x16x32_bf16 v[158:161], v[248:251], v[110:113], v[158:161]
s_add_u32 s40, s36, 784896
v_fma_f32 v222, v46, v118, v119
v_fma_f32 v223, v47, v118, v119
v_mfma_f32_16x16x32_bf16 v[158:161], v[252:255], v[106:109], v[158:161]
ds_write_b128 v211, v[90:93] offset:20480
v_mfma_f32_16x16x32_bf16 v[162:165], v[110:113], a[88:91], v[162:165]
s_nop 0
v_cvt_pk_bf16_f32 v94, v220, v221
v_cvt_pk_bf16_f32 v95, v222, v223
v_mfma_f32_16x16x32_bf16 v[162:165], v[106:109], a[92:95], v[162:165]
s_waitcnt lgkmcnt(4)
v_fma_f32 v220, v48, v126, v127
v_fma_f32 v221, v49, v126, v127
v_mfma_f32_16x16x32_bf16 v[166:169], v[110:113], a[112:115], v[166:169]
v_fma_f32 v222, v50, v126, v127
v_fma_f32 v223, v51, v126, v127
v_mfma_f32_16x16x32_bf16 v[166:169], v[106:109], a[116:119], v[166:169]
buffer_store_dwordx2 v[132:133], v205, s[8:11], s39 offen offset:64
v_cvt_pk_bf16_f32 v98, v142, v143
v_mfma_f32_16x16x32_bf16 v[170:173], v[110:113], a[136:139], v[170:173]
ds_read_b64 v[112:113], v215 offset:528
v_cvt_pk_bf16_f32 v99, v144, v145
v_mfma_f32_16x16x32_bf16 v[170:173], v[106:109], a[140:143], v[170:173]
s_waitcnt lgkmcnt(3)
ds_read_b128 v[108:111], v215 offset:512
v_cvt_pk_bf16_f32 v174, v220, v221
v_mfma_f32_16x16x32_bf16 v[138:141], a[0:3], v[182:185], 0
s_waitcnt lgkmcnt(3)
v_cvt_pk_bf16_f32 v175, v222, v223
v_cvt_pk_bf16_f32 v84, v150, v151
v_mfma_f32_16x16x32_bf16 v[138:141], a[4:7], v[186:189], v[138:141]
v_cvt_pk_bf16_f32 v85, v152, v153
v_cvt_pk_bf16_f32 v132, v170, v171
v_mfma_f32_16x16x32_bf16 v[142:145], a[24:27], v[182:185], 0
v_cvt_pk_bf16_f32 v133, v172, v173
v_fma_f32 v220, v52, v126, v127
v_mfma_f32_16x16x32_bf16 v[142:145], a[28:31], v[186:189], v[142:145]
ds_read_b128 v[170:173], v210 offset:14336
v_fma_f32 v221, v53, v126, v127
v_mfma_f32_16x16x32_bf16 v[146:149], a[48:51], v[182:185], 0
s_nop 0
ds_read_b128 v[182:185], v210 offset:15360
v_fma_f32 v222, v54, v126, v127
v_mfma_f32_16x16x32_bf16 v[146:149], a[52:55], v[186:189], v[146:149]
s_waitcnt lgkmcnt(2)
ds_read_b128 v[186:189], v210 offset:16384
v_fma_f32 v223, v55, v126, v127
v_cvt_pk_bf16_f32 v176, v220, v221
v_mfma_f32_16x16x16_bf16 v[150:153], v[112:113], v[76:77], v[206:209]
v_cvt_pk_bf16_f32 v177, v222, v223
v_fma_f32 v220, v56, v126, v127
v_fma_f32 v221, v57, v126, v127
v_fma_f32 v222, v58, v126, v127
v_fma_f32 v223, v59, v126, v127
v_cvt_pk_bf16_f32 v178, v220, v221
v_mfma_f32_16x16x32_bf16 v[150:153], v[108:111], v[72:75], v[150:153]
ds_write_b128 v211, v[174:177] offset:26624
s_waitcnt lgkmcnt(3)
v_mfma_f32_16x16x32_bf16 v[138:141], a[8:11], v[170:173], v[138:141]
s_waitcnt lgkmcnt(2)
v_cvt_pk_bf16_f32 v179, v222, v223
v_cvt_pk_bf16_f32 v88, v158, v159
v_mfma_f32_16x16x32_bf16 v[138:141], a[12:15], v[182:185], v[138:141]
v_cvt_pk_bf16_f32 v89, v160, v161
v_cvt_pk_bf16_f32 v86, v154, v155
v_mfma_f32_16x16x32_bf16 v[142:145], a[32:35], v[170:173], v[142:145]
s_nop 0
ds_write_b64 v212, v[178:179] offset:26624
v_mfma_f32_16x16x32_bf16 v[142:145], a[36:39], v[182:185], v[142:145]
s_waitcnt lgkmcnt(2)
buffer_load_dwordx4 v216, s[4:7], s40 offen nt lds
v_mfma_f32_16x16x32_bf16 v[146:149], a[56:59], v[170:173], v[146:149]
s_add_u32 m0, s45, 20560
ds_read_b128 v[174:177], v210 offset:14336
ds_read_b128 v[178:181], v210 offset:15360
v_mfma_f32_16x16x32_bf16 v[146:149], a[60:63], v[182:185], v[146:149]
s_add_u32 s40, s36, 981120
ds_read_b128 v[182:185], v210 offset:12288
ds_read_b128 v[170:173], v210 offset:17408
v_mfma_f32_16x16x32_bf16 v[138:141], a[16:19], v[186:189], v[138:141]
v_cvt_pk_bf16_f32 v87, v156, v157
v_cvt_pk_bf16_f32 v124, v166, v167
v_cvt_pk_bf16_f32 v125, v168, v169
v_mfma_f32_16x16x16_bf16 v[154:157], v[82:83], v[88:89], 0
v_exp_f32_e64 v150, v150
v_fma_f32 v220, v60, v134, v135
v_mfma_f32_16x16x16_bf16 v[158:161], v[100:101], v[88:89], 0
v_fma_f32 v221, v61, v134, v135
v_fma_f32 v222, v62, v134, v135
v_fma_f32 v223, v63, v134, v135
v_mfma_f32_16x16x16_bf16 v[166:169], v[112:113], v[88:89], v[206:209]
v_cvt_pk_bf16_f32 v116, v162, v163
v_cvt_pk_bf16_f32 v117, v164, v165
v_cvt_pk_bf16_f32 v90, v220, v221
v_cvt_pk_bf16_f32 v91, v222, v223
v_mfma_f32_16x16x32_bf16 v[142:145], a[40:43], v[186:189], v[142:145]
buffer_load_dwordx4 v216, s[4:7], s40 offen nt lds
v_mfma_f32_16x16x32_bf16 v[154:157], v[78:81], v[84:87], v[154:157]
s_waitcnt lgkmcnt(1)
ds_write_b64 v212, v[94:95] offset:20480
v_mfma_f32_16x16x32_bf16 v[118:121], v[182:185], a[72:75], 0
s_waitcnt lgkmcnt(1)
v_fma_f32 v220, v64, v134, v135
v_fma_f32 v221, v65, v134, v135
v_mfma_f32_16x16x32_bf16 v[126:129], v[182:185], a[96:99], 0
s_add_u32 m0, s45, 24672
v_exp_f32_e64 v154, v154
v_mfma_f32_16x16x32_bf16 v[138:141], a[20:23], v[170:173], v[138:141]
s_add_u32 s40, s36, 1177344
v_exp_f32 v155, v155
v_mfma_f32_16x16x32_bf16 v[142:145], a[44:47], v[170:173], v[142:145]
v_exp_f32 v156, v156
v_mfma_f32_16x16x32_bf16 v[146:149], a[64:67], v[186:189], v[146:149]
ds_read_b128 v[186:189], v210 offset:13312
v_cvt_pk_bf16_f32 v102, v138, v139
v_mfma_f32_16x16x32_bf16 v[146:149], a[68:71], v[170:173], v[146:149]
v_cvt_pk_bf16_f32 v103, v140, v141
v_cvt_pk_bf16_f32 v104, v142, v143
v_cvt_pk_bf16_f32 v105, v144, v145
v_mfma_f32_16x16x16_bf16 v[138:141], v[82:83], v[76:77], 0
v_exp_f32_e64 v157, v157
v_fma_f32 v222, v66, v134, v135
v_mfma_f32_16x16x16_bf16 v[142:145], v[100:101], v[76:77], 0
v_cvt_pk_bf16_f32 v106, v146, v147
v_cvt_pk_bf16_f32 v107, v148, v149
v_fma_f32 v223, v67, v134, v135
v_cvt_pk_bf16_f32 v92, v220, v221
v_mfma_f32_16x16x16_bf16 v[146:149], v[106:107], v[76:77], 0
v_cvt_pk_bf16_f32 v93, v222, v223
v_fma_f32 v220, v68, v134, v135
v_fma_f32 v221, v69, v134, v135
v_fma_f32 v222, v70, v134, v135
v_mfma_f32_16x16x32_bf16 v[138:141], v[78:81], v[72:75], v[138:141]
s_waitcnt lgkmcnt(0)
buffer_load_dwordx4 v216, s[4:7], s40 offen nt lds
v_mfma_f32_16x16x32_bf16 v[142:145], v[96:99], v[72:75], v[142:145]
s_add_u32 m0, s45, 28784
ds_write_b128 v211, v[90:93] offset:32768
v_mfma_f32_16x16x32_bf16 v[146:149], v[102:105], v[72:75], v[146:149]
s_add_u32 s40, s36, 1373568
v_exp_f32 v138, v138
v_mfma_f32_16x16x32_bf16 v[118:121], v[186:189], a[76:79], v[118:121]
v_exp_f32 v139, v139
v_mfma_f32_16x16x32_bf16 v[126:129], v[186:189], a[100:103], v[126:129]
buffer_load_dwordx4 v216, s[4:7], s40 offen nt lds
v_mfma_f32_16x16x32_bf16 v[90:93], a[216:219], v[182:185], 0
s_add_u32 m0, s45, 32896
v_exp_f32 v140, v140
v_mfma_f32_16x16x32_bf16 v[90:93], a[220:223], v[186:189], v[90:93]
s_add_u32 s40, s36, 1569792
v_exp_f32 v141, v141
v_mfma_f32_16x16x32_bf16 v[170:173], a[240:243], v[182:185], 0
v_exp_f32 v142, v142
v_mfma_f32_16x16x32_bf16 v[170:173], a[244:247], v[186:189], v[170:173]
v_exp_f32_e64 v143, v143
v_fma_f32 v223, v71, v134, v135
v_mfma_f32_16x16x16_bf16 v[162:165], v[106:107], v[88:89], 0
v_exp_f32 v144, v144
v_exp_f32 v145, v145
v_mfma_f32_16x16x32_bf16 v[134:137], v[182:185], a[120:123], 0
v_exp_f32 v146, v146
v_mfma_f32_16x16x32_bf16 v[134:137], v[186:189], a[124:127], v[134:137]
buffer_load_dwordx4 v216, s[4:7], s40 offen nt lds
v_mfma_f32_16x16x32_bf16 v[134:137], v[174:177], a[128:131], v[134:137]
v_exp_f32 v147, v147
v_mfma_f32_16x16x32_bf16 v[134:137], v[178:181], a[132:135], v[134:137]
v_exp_f32 v148, v148
v_mfma_f32_16x16x32_bf16 v[158:161], v[96:99], v[84:87], v[158:161]
v_exp_f32 v149, v149
v_mfma_f32_16x16x32_bf16 v[118:121], v[174:177], a[80:83], v[118:121]
v_cvt_pk_bf16_f32 v94, v220, v221
v_cvt_pk_bf16_f32 v95, v222, v223
v_mfma_f32_16x16x32_bf16 v[118:121], v[178:181], a[84:87], v[118:121]
v_exp_f32 v158, v158
v_mfma_f32_16x16x32_bf16 v[220:223], v[232:235], v[182:185], 0
v_exp_f32 v159, v159
v_mfma_f32_16x16x32_bf16 v[220:223], v[236:239], v[186:189], v[220:223]
v_exp_f32 v160, v160
v_mfma_f32_16x16x32_bf16 v[126:129], v[174:177], a[104:107], v[126:129]
v_exp_f32 v161, v161
v_mfma_f32_16x16x32_bf16 v[126:129], v[178:181], a[108:111], v[126:129]
ds_read_b128 v[182:185], v210 offset:16384
ds_read_b128 v[186:189], v210 offset:17408
v_mfma_f32_16x16x32_bf16 v[166:169], v[108:111], v[84:87], v[166:169]
ds_write_b64 v212, v[94:95] offset:32768
v_mfma_f32_16x16x32_bf16 v[90:93], a[224:227], v[174:177], v[90:93]
v_mfma_f32_16x16x32_bf16 v[90:93], a[228:231], v[178:181], v[90:93]
v_exp_f32_e64 v166, v166
v_mfma_f32_16x16x32_bf16 v[170:173], a[248:251], v[174:177], v[170:173]
ds_read_b64 v[76:77], v215 offset:16
ds_read_b128 v[72:75], v215
v_mfma_f32_16x16x32_bf16 v[170:173], a[252:255], v[178:181], v[170:173]
v_mfma_f32_16x16x32_bf16 v[220:223], v[240:243], v[174:177], v[220:223]
v_cvt_pk_bf16_f32 v174, v138, v139
v_cvt_pk_bf16_f32 v175, v140, v141
v_mfma_f32_16x16x32_bf16 v[220:223], v[244:247], v[178:181], v[220:223]
s_nop 0
v_cvt_pk_bf16_f32 v176, v142, v143
v_cvt_pk_bf16_f32 v177, v144, v145
v_mfma_f32_16x16x32_bf16 v[162:165], v[102:105], v[84:87], v[162:165]
s_waitcnt lgkmcnt(4)
v_cvt_pk_bf16_f32 v180, v150, 0
v_cvt_pk_bf16_f32 v178, v146, v147
v_mfma_f32_16x16x32_bf16 v[118:121], v[182:185], a[88:91], v[118:121]
s_waitcnt lgkmcnt(3)
v_cvt_pk_bf16_f32 v179, v148, v149
v_mov_b32 v181, 0
v_mfma_f32_16x16x32_bf16 v[118:121], v[186:189], a[92:95], v[118:121]
v_exp_f32 v162, v162
v_mfma_f32_16x16x32_bf16 v[126:129], v[182:185], a[112:115], v[126:129]
v_exp_f32 v163, v163
v_mfma_f32_16x16x32_bf16 v[126:129], v[186:189], a[116:119], v[126:129]
v_exp_f32 v164, v164
v_mfma_f32_16x16x32_bf16 v[134:137], v[182:185], a[136:139], v[134:137]
v_exp_f32 v165, v165
v_mfma_f32_16x16x32_bf16 v[134:137], v[186:189], a[140:143], v[134:137]
v_cvt_pk_bf16_f32 v118, v118, v119
v_cvt_pk_bf16_f32 v119, v120, v121
v_mfma_f32_16x16x32_bf16 v[90:93], a[232:235], v[182:185], v[90:93]
ds_read_u16 v120, v214 offset:1024
v_mov_b32_e64 v121, 0
v_mfma_f32_16x16x32_bf16 v[90:93], a[236:239], v[186:189], v[90:93]
v_cvt_pk_bf16_f32 v126, v126, v127
v_cvt_pk_bf16_f32 v127, v128, v129
v_mfma_f32_16x16x32_bf16 v[170:173], v[224:227], v[182:185], v[170:173]
ds_read_u16 v128, v214 offset:1032
v_cvt_pk_bf16_f32 v134, v134, v135
v_mfma_f32_16x16x32_bf16 v[170:173], v[228:231], v[186:189], v[170:173]
v_cvt_pk_bf16_f32 v135, v136, v137
v_mov_b32_e64 v129, 0
v_mfma_f32_16x16x32_bf16 v[220:223], v[248:251], v[182:185], v[220:223]
ds_read_u16 v136, v214 offset:1040
v_mov_b32_e64 v137, 0
v_mfma_f32_16x16x32_bf16 v[220:223], v[252:255], v[186:189], v[220:223]
v_cvt_pk_bf16_f32 v90, v90, v91
v_cvt_pk_bf16_f32 v91, v92, v93
v_mfma_f32_16x16x32_bf16 v[150:153], v[190:193], v[174:177], 0
v_cvt_pk_bf16_f32 v92, v170, v171
v_cvt_pk_bf16_f32 v93, v172, v173
v_mfma_f32_16x16x32_bf16 v[150:153], v[190:193], v[178:181], v[150:153]
v_cvt_pk_bf16_f32 v94, v220, v221
v_cvt_pk_bf16_f32 v95, v222, v223
v_mfma_f32_16x16x32_bf16 v[138:141], v[114:117], v[174:177], 0
s_waitcnt lgkmcnt(2)
v_mfma_f32_16x16x32_bf16 v[138:141], v[118:121], v[178:181], v[138:141]
v_rcp_f32_e64 v151, v150
v_mfma_f32_16x16x32_bf16 v[142:145], v[122:125], v[174:177], 0
s_waitcnt lgkmcnt(1)
v_max3_u32 v218, v218, v150, v151
v_mul_f32_e64 v151, s3, v151
v_mfma_f32_16x16x32_bf16 v[142:145], v[126:129], v[178:181], v[142:145]
v_mul_f32_e64 v138, v138, v151
v_mul_f32 v139, v139, v151
v_mfma_f32_16x16x32_bf16 v[146:149], v[130:133], v[174:177], 0
s_waitcnt lgkmcnt(0)
v_cvt_pk_bf16_f32 v174, v154, v155
v_cvt_pk_bf16_f32 v175, v156, v157
v_mfma_f32_16x16x32_bf16 v[146:149], v[134:137], v[178:181], v[146:149]
v_cvt_pk_bf16_f32 v176, v158, v159
v_cvt_pk_bf16_f32 v177, v160, v161
v_cvt_pk_bf16_f32 v180, v166, 0
v_cvt_pk_bf16_f32 v178, v162, v163
v_mfma_f32_16x16x32_bf16 v[166:169], v[190:193], v[174:177], 0
v_cvt_pk_bf16_f32 v179, v164, v165
v_mul_f32 v140, v140, v151
v_mul_f32 v141, v141, v151
v_mfma_f32_16x16x32_bf16 v[166:169], v[190:193], v[178:181], v[166:169]
v_cvt_pk_bf16_f32 v138, v138, v139
v_mul_f32_e64 v142, v142, v151
v_mfma_f32_16x16x32_bf16 v[154:157], v[114:117], v[174:177], 0
v_mul_f32 v143, v143, v151
v_mul_f32 v144, v144, v151
v_mfma_f32_16x16x32_bf16 v[154:157], v[118:121], v[178:181], v[154:157]
v_mul_f32_e64 v145, v145, v151
v_cvt_pk_bf16_f32 v139, v140, v141
v_mfma_f32_16x16x32_bf16 v[158:161], v[122:125], v[174:177], 0
v_cvt_pk_bf16_f32 v140, v142, v143
v_cvt_pk_bf16_f32 v141, v144, v145
v_mfma_f32_16x16x32_bf16 v[158:161], v[126:129], v[178:181], v[158:161]
ds_write_b128 v211, v[138:141] offset:38912
v_mfma_f32_16x16x32_bf16 v[162:165], v[130:133], v[174:177], 0
v_mul_f32 v146, v146, v151
v_mul_f32 v147, v147, v151
v_mfma_f32_16x16x32_bf16 v[162:165], v[134:137], v[178:181], v[162:165]
v_mul_f32 v148, v148, v151
v_mul_f32 v149, v149, v151
v_cvt_pk_bf16_f32 v142, v146, v147
v_mfma_f32_16x16x16_bf16 v[138:141], v[82:83], v[94:95], 0
v_cvt_pk_bf16_f32 v143, v148, v149
v_rcp_f32_e64 v167, v166
v_mfma_f32_16x16x16_bf16 v[150:153], v[112:113], v[94:95], v[206:209]
v_max3_u32 v218, v218, v166, v167
v_mul_f32 v167, s3, v167
v_mul_f32 v154, v154, v167
v_mfma_f32_16x16x16_bf16 v[146:149], v[106:107], v[94:95], 0
v_mul_f32 v155, v155, v167
v_mul_f32 v156, v156, v167
v_mul_f32_e64 v157, v157, v167
v_cvt_pk_bf16_f32 v154, v154, v155
v_mfma_f32_16x16x32_bf16 v[138:141], v[78:81], v[90:93], v[138:141]
ds_write_b64 v212, v[142:143] offset:38912
v_mfma_f32_16x16x16_bf16 v[142:145], v[100:101], v[94:95], 0
v_mul_f32 v158, v158, v167
v_mul_f32 v159, v159, v167
v_mul_f32 v160, v160, v167
v_mul_f32 v161, v161, v167
v_mfma_f32_16x16x32_bf16 v[150:153], v[108:111], v[90:93], v[150:153]
v_cvt_pk_bf16_f32 v155, v156, v157
v_cvt_pk_bf16_f32 v156, v158, v159
v_mfma_f32_16x16x32_bf16 v[142:145], v[96:99], v[90:93], v[142:145]
v_cvt_pk_bf16_f32 v157, v160, v161
v_mul_f32_e64 v162, v162, v167
v_mfma_f32_16x16x32_bf16 v[146:149], v[102:105], v[90:93], v[146:149]
ds_write_b128 v211, v[154:157] offset:45056
v_mfma_f32_16x16x16_bf16 v[154:157], v[76:77], v[82:83], 0
v_mul_f32 v163, v163, v167
v_mul_f32 v164, v164, v167
v_mul_f32_e64 v165, v165, v167
v_mfma_f32_16x16x16_bf16 v[166:169], v[76:77], v[112:113], v[206:209]
v_cvt_pk_bf16_f32 v158, v162, v163
v_cvt_pk_bf16_f32 v159, v164, v165
v_exp_f32 v138, v138
v_mfma_f32_16x16x16_bf16 v[162:165], v[76:77], v[106:107], 0
v_exp_f32 v139, v139
v_exp_f32 v140, v140
v_mfma_f32_16x16x32_bf16 v[154:157], v[72:75], v[78:81], v[154:157]
ds_write_b64 v212, v[158:159] offset:45056
v_mfma_f32_16x16x16_bf16 v[158:161], v[76:77], v[100:101], 0
v_exp_f32 v141, v141
v_exp_f32 v142, v142
v_mfma_f32_16x16x32_bf16 v[162:165], v[72:75], v[102:105], v[162:165]
v_exp_f32 v143, v143
v_mfma_f32_16x16x32_bf16 v[158:161], v[72:75], v[96:99], v[158:161]
v_exp_f32 v144, v144
v_mfma_f32_16x16x32_bf16 v[166:169], v[72:75], v[108:111], v[166:169]
v_exp_f32 v145, v145
v_exp_f32 v150, v150
v_exp_f32 v146, v146
v_exp_f32 v147, v147
v_exp_f32 v148, v148
v_exp_f32_e64 v149, v149
v_cvt_pk_bf16_f32 v174, v138, v139
v_cvt_pk_bf16_f32 v175, v140, v141
v_cvt_pk_bf16_f32 v176, v142, v143
v_cvt_pk_bf16_f32 v177, v144, v145
v_cvt_pk_bf16_f32 v180, v150, 0
v_cvt_pk_bf16_f32 v178, v146, v147
v_mfma_f32_16x16x32_bf16 v[150:153], v[190:193], v[174:177], 0
s_waitcnt lgkmcnt(0)
v_cvt_pk_bf16_f32 v179, v148, v149
v_mov_b32_dpp v154, v158 quad_perm:[0,1,2,3] row_mask:0x2 bank_mask:0xf
v_mfma_f32_16x16x32_bf16 v[138:141], v[114:117], v[174:177], 0
s_barrier
v_mfma_f32_16x16x32_bf16 v[138:141], v[118:121], v[178:181], v[138:141]
ds_read_b128 v[220:223], v210 offset:38912
ds_read_b128 v[110:113], v210 offset:39936
v_mfma_f32_16x16x32_bf16 v[150:153], v[190:193], v[178:181], v[150:153]
ds_read_b128 v[170:173], v210 offset:40960
ds_read_b128 v[182:185], v210 offset:41984
v_mfma_f32_16x16x32_bf16 v[142:145], v[122:125], v[174:177], 0
v_mov_b32_dpp v154, v162 quad_perm:[0,1,2,3] row_mask:0x4 bank_mask:0xf
v_mfma_f32_16x16x32_bf16 v[142:145], v[126:129], v[178:181], v[142:145]
v_mov_b32_dpp v154, v167 quad_perm:[0,1,2,3] row_mask:0x8 bank_mask:0xf
v_exp_f32 v154, v154
v_mfma_f32_16x16x32_bf16 v[146:149], v[130:133], v[174:177], 0
v_cvt_pk_bf16_f32 v154, v154, 0
v_rcp_f32 v151, v150
v_mfma_f32_16x16x32_bf16 v[146:149], v[134:137], v[178:181], v[146:149]
s_waitcnt lgkmcnt(3)
ds_write_b16 v214, v154
v_mfma_f32_16x16x32_bf16 v[0:3], a[144:147], v[220:223], v[0:3]
s_waitcnt lgkmcnt(3)
ds_read_b128 v[84:87], v215
ds_read_b128 v[88:91], v215 offset:16
v_mfma_f32_16x16x32_bf16 v[0:3], a[148:151], v[110:113], v[0:3]
ds_read_b128 v[186:189], v210 offset:43008
ds_read_b128 v[174:177], v217
v_mfma_f32_16x16x32_bf16 v[4:7], a[168:171], v[220:223], v[4:7]
s_mul_hi_u32 s41, s35, 58835169
ds_read_b128 v[178:181], v217 offset:528
s_mul_i32 s42, s41, 73
v_mfma_f32_16x16x32_bf16 v[4:7], a[172:175], v[110:113], v[4:7]
s_sub_u32 s42, s35, s42
s_mul_i32 s43, s41, 1373568
s_mul_i32 s51, s42, 2688
v_mfma_f32_16x16x32_bf16 v[8:11], a[192:195], v[220:223], v[8:11]
ds_read_b128 v[220:223], v210 offset:44032
v_mfma_f32_16x16x32_bf16 v[8:11], a[196:199], v[110:113], v[8:11]
ds_read_b128 v[110:113], v210 offset:45056
s_waitcnt lgkmcnt(6)
v_mfma_f32_16x16x32_bf16 v[166:169], v[84:87], v[190:193], 0
s_add_u32 s43, s43, s51
s_waitcnt lgkmcnt(5)
v_mfma_f32_16x16x32_bf16 v[166:169], v[88:91], v[190:193], v[166:169]
s_cmp_lt_u32 s35, s34
v_mfma_f32_16x16x32_bf16 v[154:157], v[84:87], v[114:117], 0
s_cselect_b32 s50, s43, 1879048192
v_mfma_f32_16x16x32_bf16 v[154:157], v[88:91], v[118:121], v[154:157]
s_add_u32 s35, s35, 32
v_rcp_f32 v167, v166
v_mfma_f32_16x16x32_bf16 v[158:161], v[84:87], v[122:125], 0
s_cmp_eq_u32 s42, 0
v_max3_u32 v218, v218, v166, v167
v_max3_u32 v218, v218, v150, v151
v_mfma_f32_16x16x32_bf16 v[158:161], v[88:91], v[126:129], v[158:161]
s_cselect_b32 s44, 536870911, s72
v_mul_f32 v151, s3, v151
v_mul_f32 v138, v138, v151
v_mfma_f32_16x16x32_bf16 v[162:165], v[84:87], v[130:133], 0
s_waitcnt lgkmcnt(4)
v_mul_f32 v139, v139, v151
v_mul_f32_e64 v140, v140, v151
v_mfma_f32_16x16x32_bf16 v[162:165], v[88:91], v[134:137], v[162:165]
s_cmp_eq_u32 s42, 72
v_mul_f32_e64 v141, v141, v151
v_cvt_pk_bf16_f32 v138, v138, v139
v_mfma_f32_16x16x32_bf16 v[0:3], a[152:155], v[170:173], v[0:3]
s_cselect_b32 s44, 939524095, s44
v_mul_f32 v142, v142, v151
v_mul_f32 v143, v143, v151
v_mfma_f32_16x16x32_bf16 v[0:3], a[156:159], v[182:185], v[0:3]
s_cmp_eq_u32 s41, 0
v_mul_f32 v144, v144, v151
v_mul_f32_e64 v145, v145, v151
v_mfma_f32_16x16x32_bf16 v[0:3], a[160:163], v[186:189], v[0:3]
s_cselect_b32 s52, 1879048192, s50
v_cvt_pk_bf16_f32 v139, v140, v141
v_cvt_pk_bf16_f32 v140, v142, v143
v_mfma_f32_16x16x32_bf16 v[4:7], a[176:179], v[170:173], v[4:7]
s_add_u32 m0, s45, 0
v_cvt_pk_bf16_f32 v141, v144, v145
v_mul_f32 v146, v146, v151
v_mfma_f32_16x16x32_bf16 v[4:7], a[180:183], v[182:185], v[4:7]
s_mov_b32 s39, s37
ds_write_b128 v211, v[138:141] offset:51200
v_mfma_f32_16x16x32_bf16 v[4:7], a[184:187], v[186:189], v[4:7]
s_mov_b32 s37, s50
v_mul_f32 v147, v147, v151
v_mul_f32 v148, v148, v151
v_mfma_f32_16x16x32_bf16 v[8:11], a[200:203], v[170:173], v[8:11]
v_mul_f32_e64 v149, v149, v151
v_cvt_pk_bf16_f32 v142, v146, v147
v_mfma_f32_16x16x32_bf16 v[8:11], a[204:207], v[182:185], v[8:11]
s_nop 0
ds_read_b128 v[170:173], v210 offset:46080
ds_read_b128 v[182:185], v210 offset:47104
v_mfma_f32_16x16x32_bf16 v[8:11], a[208:211], v[186:189], v[8:11]
s_waitcnt lgkmcnt(4)
ds_read_b128 v[186:189], v210 offset:48128
v_cvt_pk_bf16_f32 v143, v148, v149
v_mfma_f32_16x16x32_bf16 v[8:11], a[212:215], v[220:223], v[8:11]
ds_write_b64 v212, v[142:143] offset:51200
v_mfma_f32_16x16x32_bf16 v[0:3], a[164:167], v[220:223], v[0:3]
v_mov_b32_dpp v154, v158 quad_perm:[0,1,2,3] row_mask:0x2 bank_mask:0xf
v_mul_f32 v167, s3, v167
v_mfma_f32_16x16x32_bf16 v[4:7], a[188:191], v[220:223], v[4:7]
s_waitcnt lgkmcnt(5)
ds_read_b128 v[220:223], v210 offset:49152
v_mov_b32_dpp v154, v162 quad_perm:[0,1,2,3] row_mask:0x4 bank_mask:0xf
v_mfma_f32_16x16x32_bf16 v[12:15], a[144:147], v[110:113], v[12:15]
s_waitcnt lgkmcnt(4)
v_cvt_pk_bf16_f32 v72, v0, v1
v_cvt_pk_bf16_f32 v73, v2, v3
v_mfma_f32_16x16x32_bf16 v[12:15], a[148:151], v[170:173], v[12:15]
s_waitcnt lgkmcnt(3)
buffer_store_dwordx2 v[72:73], v203, s[8:11], s38 offen
v_cvt_pk_bf16_f32 v74, v4, v5
v_mfma_f32_16x16x32_bf16 v[12:15], a[152:155], v[182:185], v[12:15]
s_waitcnt lgkmcnt(2)
v_cvt_pk_bf16_f32 v75, v6, v7
v_mul_f32 v154, v154, v167
v_mfma_f32_16x16x32_bf16 v[12:15], a[156:159], v[186:189], v[12:15]
v_cvt_pk_bf16_f32 v154, v154, 0
v_cvt_pk_bf16_f32 v76, v8, v9
v_mfma_f32_16x16x32_bf16 v[16:19], a[168:171], v[110:113], v[16:19]
ds_write_b16 v214, v154
v_mfma_f32_16x16x32_bf16 v[16:19], a[172:175], v[170:173], v[16:19]
v_cvt_pk_bf16_f32 v77, v10, v11
v_and_b32 v216, s44, v208
v_mfma_f32_16x16x32_bf16 v[16:19], a[176:179], v[182:185], v[16:19]
v_add_u32 v215, 1552, v215
v_mfma_f32_16x16x32_bf16 v[16:19], a[180:183], v[186:189], v[16:19]
v_mfma_f32_16x16x32_bf16 v[20:23], a[192:195], v[110:113], v[20:23]
ds_read_b128 v[110:113], v210 offset:50176
v_mfma_f32_16x16x32_bf16 v[20:23], a[196:199], v[170:173], v[20:23]
v_mfma_f32_16x16x32_bf16 v[20:23], a[200:203], v[182:185], v[20:23]
s_waitcnt vmcnt(1) lgkmcnt(2)
v_mfma_f32_16x16x32_bf16 v[20:23], a[204:207], v[186:189], v[20:23]
s_barrier
v_mfma_f32_16x16x32_bf16 v[20:23], a[208:211], v[220:223], v[20:23]
ds_read_b128 v[170:173], v210 offset:51200
ds_read_b128 v[182:185], v210 offset:52224
v_mfma_f32_16x16x32_bf16 v[12:15], a[160:163], v[220:223], v[12:15]
s_waitcnt lgkmcnt(2)
ds_read_b128 v[186:189], v210 offset:53248
ds_read_b128 v[84:87], v200
v_mfma_f32_16x16x32_bf16 v[12:15], a[164:167], v[110:113], v[12:15]
ds_read_b128 v[92:95], v201
ds_read_b128 v[100:103], v202
v_mfma_f32_16x16x32_bf16 v[16:19], a[184:187], v[220:223], v[16:19]
s_nop 0
ds_read_b128 v[220:223], v210 offset:54272
buffer_store_dwordx2 v[74:75], v203, s[8:11], s38 offen offset:32
s_nop 0
v_cvt_pk_bf16_f32 v78, v12, v13
v_mfma_f32_16x16x32_bf16 v[16:19], a[188:191], v[110:113], v[16:19]
ds_read_b128 v[88:91], v194 offset:16
v_cvt_pk_bf16_f32 v79, v14, v15
v_mfma_f32_16x16x32_bf16 v[20:23], a[212:215], v[110:113], v[20:23]
s_nop 0
ds_read_b128 v[110:113], v210 offset:55296
s_waitcnt lgkmcnt(8)
v_mfma_f32_16x16x32_bf16 v[24:27], a[144:147], v[170:173], v[24:27]
s_waitcnt lgkmcnt(7)
ds_read_b128 v[96:99], v195 offset:16
v_cvt_pk_bf16_f32 v80, v16, v17
v_mfma_f32_16x16x32_bf16 v[24:27], a[148:151], v[182:185], v[24:27]
s_waitcnt lgkmcnt(7)
ds_read_b128 v[104:107], v196 offset:16
v_cvt_pk_bf16_f32 v81, v18, v19
v_mfma_f32_16x16x32_bf16 v[24:27], a[152:155], v[186:189], v[24:27]
v_cvt_pk_bf16_f32 v82, v20, v21
v_cvt_pk_bf16_f32 v83, v22, v23
v_mfma_f32_16x16x32_bf16 v[28:31], a[168:171], v[170:173], v[28:31]
v_mfma_f32_16x16x32_bf16 v[28:31], a[172:175], v[182:185], v[28:31]
s_nop 0
v_mfma_f32_16x16x32_bf16 v[28:31], a[176:179], v[186:189], v[28:31]
s_waitcnt lgkmcnt(4)
v_mfma_f32_16x16x32_bf16 v[28:31], a[180:183], v[220:223], v[28:31]
v_mfma_f32_16x16x32_bf16 v[32:35], a[192:195], v[170:173], v[32:35]
ds_read_b128 v[170:173], v210 offset:56320
v_mfma_f32_16x16x32_bf16 v[32:35], a[196:199], v[182:185], v[32:35]
ds_read_b128 v[182:185], v210 offset:20480
v_mfma_f32_16x16x32_bf16 v[32:35], a[200:203], v[186:189], v[32:35]
ds_read_b128 v[186:189], v210 offset:21504
v_mfma_f32_16x16x32_bf16 v[32:35], a[204:207], v[220:223], v[32:35]
buffer_store_dwordx2 v[76:77], v203, s[8:11], s38 offen offset:64
v_mfma_f32_16x16x32_bf16 v[0:3], v[174:177], v[84:87], 0
ds_read_b128 v[84:87], v194
v_mfma_f32_16x16x32_bf16 v[24:27], a[156:159], v[220:223], v[24:27]
ds_read_b128 v[220:223], v210 offset:23552
s_waitcnt lgkmcnt(7)
v_mfma_f32_16x16x32_bf16 v[24:27], a[160:163], v[110:113], v[24:27]
s_waitcnt lgkmcnt(4)
v_mfma_f32_16x16x32_bf16 v[24:27], a[164:167], v[170:173], v[24:27]
v_mfma_f32_16x16x32_bf16 v[12:15], v[174:177], v[92:95], 0
ds_read_b128 v[92:95], v195
v_mfma_f32_16x16x32_bf16 v[28:31], a[184:187], v[110:113], v[28:31]
v_cvt_pk_bf16_f32 v116, v24, v25
v_cvt_pk_bf16_f32 v117, v26, v27
v_mfma_f32_16x16x32_bf16 v[28:31], a[188:191], v[170:173], v[28:31]
v_mfma_f32_16x16x32_bf16 v[24:27], v[174:177], v[100:103], 0
ds_read_b128 v[100:103], v196
ds_read_b128 v[174:177], v217 offset:1056
v_mfma_f32_16x16x32_bf16 v[32:35], a[208:211], v[110:113], v[32:35]
ds_read_b128 v[110:113], v210 offset:22528
v_cvt_pk_bf16_f32 v124, v28, v29
v_mfma_f32_16x16x32_bf16 v[32:35], a[212:215], v[170:173], v[32:35]
v_cvt_pk_bf16_f32 v125, v30, v31
s_waitcnt lgkmcnt(5)
v_smfmac_f32_16x16x64_bf16 v[0:3], v[178:181], v[84:91], v213
s_waitcnt lgkmcnt(3)
ds_read_b128 v[84:87], v197
ds_read_b128 v[88:91], v197 offset:16
v_smfmac_f32_16x16x64_bf16 v[12:15], v[178:181], v[92:99], v213
ds_read_b128 v[92:95], v198
ds_read_b128 v[96:99], v198 offset:16
v_mfma_f32_16x16x32_bf16 v[138:141], a[0:3], v[182:185], 0
v_cvt_pk_bf16_f32 v132, v32, v33
v_cvt_pk_bf16_f32 v133, v34, v35
v_mfma_f32_16x16x32_bf16 v[138:141], a[4:7], v[186:189], v[138:141]
s_waitcnt lgkmcnt(6)
v_smfmac_f32_16x16x64_bf16 v[24:27], v[178:181], v[100:107], v213
s_nop 0
ds_read_b128 v[100:103], v199
ds_read_b128 v[104:107], v199 offset:16
v_mfma_f32_16x16x32_bf16 v[142:145], a[24:27], v[182:185], 0
ds_read_b128 v[178:181], v217 offset:1584
buffer_store_dwordx2 v[78:79], v204, s[8:11], s38 offen
v_mfma_f32_16x16x32_bf16 v[142:145], a[28:31], v[186:189], v[142:145]
s_waitcnt lgkmcnt(5)
v_smfmac_f32_16x16x64_bf16 v[0:3], v[174:177], v[84:91], v213
ds_read_b128 v[84:87], v200 offset:32
ds_read_b128 v[88:91], v194 offset:48
v_mfma_f32_16x16x32_bf16 v[146:149], a[48:51], v[182:185], 0
s_waitcnt lgkmcnt(5)
v_smfmac_f32_16x16x64_bf16 v[12:15], v[174:177], v[92:99], v213
ds_read_b128 v[92:95], v201 offset:32
ds_read_b128 v[96:99], v195 offset:48
v_mfma_f32_16x16x32_bf16 v[146:149], a[52:55], v[186:189], v[146:149]
s_waitcnt lgkmcnt(5)
v_mul_f32 v119, v0, v0
v_add_f32_e64 v118, v0, v1
v_smfmac_f32_16x16x64_bf16 v[24:27], v[174:177], v[100:107], v213
ds_read_b128 v[100:103], v202 offset:32
ds_read_b128 v[174:177], v217 offset:2112
v_mfma_f32_16x16x32_bf16 v[150:153], a[216:219], v[182:185], 0
ds_read_b128 v[104:107], v196 offset:48
v_mul_f32_e64 v127, v12, v12
v_mfma_f32_16x16x32_bf16 v[150:153], a[220:223], v[186:189], v[150:153]
s_waitcnt lgkmcnt(6)
v_mul_f32 v135, v24, v24
v_add_f32_e64 v134, v24, v25
v_mfma_f32_16x16x32_bf16 v[4:7], v[178:181], v[84:87], 0
ds_read_b128 v[84:87], v194 offset:32
v_fmac_f32_e64 v135, v25, v25
v_mfma_f32_16x16x32_bf16 v[154:157], a[240:243], v[182:185], 0
s_waitcnt lgkmcnt(5)
v_add_f32 v126, v12, v13
v_fmac_f32_e64 v119, v1, v1
v_mfma_f32_16x16x32_bf16 v[16:19], v[178:181], v[92:95], 0
ds_read_b128 v[92:95], v195 offset:32
v_fmac_f32_e64 v127, v13, v13
v_mfma_f32_16x16x32_bf16 v[154:157], a[244:247], v[186:189], v[154:157]
s_waitcnt lgkmcnt(4)
v_add_f32 v134, v134, v26
v_fmac_f32_e64 v135, v26, v26
v_mfma_f32_16x16x32_bf16 v[28:31], v[178:181], v[100:103], 0
ds_read_b128 v[100:103], v196 offset:32
ds_read_b128 v[178:181], v217 offset:2640
v_mfma_f32_16x16x32_bf16 v[158:161], v[232:235], v[182:185], 0
v_add_f32 v118, v118, v2
v_add_f32 v126, v126, v14
v_mfma_f32_16x16x32_bf16 v[158:161], v[236:239], v[186:189], v[158:161]
s_waitcnt lgkmcnt(3)
v_fmac_f32 v119, v2, v2
v_fmac_f32_e64 v127, v14, v14
v_smfmac_f32_16x16x64_bf16 v[4:7], v[174:177], v[84:91], v213
s_nop 0
ds_read_b128 v[84:87], v197 offset:32
ds_read_b128 v[88:91], v197 offset:48
v_mfma_f32_16x16x32_bf16 v[162:165], v[182:185], a[72:75], 0
s_waitcnt lgkmcnt(4)
buffer_store_dwordx2 v[80:81], v204, s[8:11], s38 offen offset:32
v_add_f32 v134, v134, v27
v_smfmac_f32_16x16x64_bf16 v[16:19], v[174:177], v[92:99], v213
s_waitcnt lgkmcnt(3)
ds_read_b128 v[92:95], v198 offset:32
ds_read_b128 v[96:99], v198 offset:48
v_smfmac_f32_16x16x64_bf16 v[28:31], v[174:177], v[100:107], v213
ds_read_b128 v[100:103], v199 offset:32
ds_read_b128 v[104:107], v199 offset:48
v_mfma_f32_16x16x32_bf16 v[162:165], v[186:189], a[76:79], v[162:165]
ds_read_b128 v[174:177], v217 offset:3168
v_fmac_f32_e64 v135, v27, v27
v_mfma_f32_16x16x32_bf16 v[166:169], v[182:185], a[96:99], 0
v_add_f32 v118, v118, v3
v_add_f32 v126, v126, v15
v_mfma_f32_16x16x32_bf16 v[166:169], v[186:189], a[100:103], v[166:169]
s_waitcnt lgkmcnt(5)
v_fmac_f32 v119, v3, v3
v_fmac_f32_e64 v127, v15, v15
v_smfmac_f32_16x16x64_bf16 v[4:7], v[178:181], v[84:91], v213
ds_read_b128 v[84:87], v200 offset:64
ds_read_b128 v[88:91], v194 offset:80
v_mfma_f32_16x16x32_bf16 v[170:173], v[182:185], a[120:123], 0
ds_read_b128 v[182:185], v210 offset:24576
v_add_u32 v214, 1552, v214
v_mfma_f32_16x16x32_bf16 v[170:173], v[186:189], a[124:127], v[170:173]
s_waitcnt lgkmcnt(6)
ds_read_b128 v[186:189], v210 offset:25600
v_add_f32 v118, v118, v4
v_smfmac_f32_16x16x64_bf16 v[16:19], v[178:181], v[92:99], v213
ds_read_b128 v[92:95], v201 offset:64
ds_read_b128 v[96:99], v195 offset:80
v_mfma_f32_16x16x32_bf16 v[138:141], a[8:11], v[110:113], v[138:141]
s_waitcnt lgkmcnt(7)
v_fmac_f32 v119, v4, v4
v_add_f32_e64 v118, v118, v5
v_smfmac_f32_16x16x64_bf16 v[28:31], v[178:181], v[100:107], v213
ds_read_b128 v[100:103], v202 offset:64
ds_read_b128 v[178:181], v217 offset:3696
v_mfma_f32_16x16x32_bf16 v[138:141], a[12:15], v[220:223], v[138:141]
s_waitcnt lgkmcnt(7)
ds_read_b128 v[104:107], v196 offset:80
v_add_f32 v126, v126, v16
v_mfma_f32_16x16x32_bf16 v[8:11], v[174:177], v[84:87], 0
ds_read_b128 v[84:87], v194 offset:64
v_add_f32_e64 v134, v134, v28
v_mfma_f32_16x16x32_bf16 v[142:145], a[32:35], v[110:113], v[142:145]
buffer_store_dwordx2 v[82:83], v204, s[8:11], s38 offen offset:64
v_fmac_f32 v135, v28, v28
v_mfma_f32_16x16x32_bf16 v[142:145], a[36:39], v[220:223], v[142:145]
s_waitcnt lgkmcnt(5)
v_fmac_f32 v127, v16, v16
v_add_f32 v134, v134, v29
v_mfma_f32_16x16x32_bf16 v[20:23], v[174:177], v[92:95], 0
ds_read_b128 v[92:95], v195 offset:64
v_fmac_f32_e64 v135, v29, v29
v_mfma_f32_16x16x32_bf16 v[146:149], a[56:59], v[110:113], v[146:149]
v_fmac_f32 v119, v5, v5
v_add_f32 v126, v126, v17
v_mfma_f32_16x16x32_bf16 v[146:149], a[60:63], v[220:223], v[146:149]
s_waitcnt lgkmcnt(4)
v_fmac_f32 v127, v17, v17
v_add_f32_e64 v134, v134, v30
v_mfma_f32_16x16x32_bf16 v[32:35], v[174:177], v[100:103], 0
ds_read_b128 v[100:103], v196 offset:64
ds_read_b128 v[174:177], v217 offset:4224
v_mfma_f32_16x16x32_bf16 v[150:153], a[224:227], v[110:113], v[150:153]
v_fmac_f32 v135, v30, v30
v_add_f32 v118, v118, v6
v_mfma_f32_16x16x32_bf16 v[150:153], a[228:231], v[220:223], v[150:153]
s_waitcnt lgkmcnt(3)
v_fmac_f32 v119, v6, v6
v_add_f32 v126, v126, v18
v_smfmac_f32_16x16x64_bf16 v[8:11], v[178:181], v[84:91], v213
s_waitcnt lgkmcnt(2)
ds_read_b128 v[84:87], v197 offset:64
ds_read_b128 v[88:91], v197 offset:80
v_smfmac_f32_16x16x64_bf16 v[20:23], v[178:181], v[92:99], v213
ds_read_b128 v[92:95], v198 offset:64
ds_read_b128 v[96:99], v198 offset:80
v_mfma_f32_16x16x32_bf16 v[154:157], a[248:251], v[110:113], v[154:157]
v_fmac_f32 v127, v18, v18
v_add_f32 v134, v134, v31
v_mfma_f32_16x16x32_bf16 v[154:157], a[252:255], v[220:223], v[154:157]
s_waitcnt lgkmcnt(5)
v_fmac_f32 v135, v31, v31
v_add_f32_e64 v118, v118, v7
v_smfmac_f32_16x16x64_bf16 v[32:35], v[178:181], v[100:107], v213
ds_read_b128 v[100:103], v199 offset:64
ds_read_b128 v[104:107], v199 offset:80
v_mfma_f32_16x16x32_bf16 v[158:161], v[240:243], v[110:113], v[158:161]
v_fmac_f32 v119, v7, v7
v_add_f32 v126, v126, v19
v_mfma_f32_16x16x32_bf16 v[158:161], v[244:247], v[220:223], v[158:161]
v_fmac_f32 v127, v19, v19
s_waitcnt lgkmcnt(4)
v_smfmac_f32_16x16x64_bf16 v[8:11], v[174:177], v[84:91], v213
v_mfma_f32_16x16x32_bf16 v[162:165], v[110:113], a[80:83], v[162:165]
buffer_store_dwordx2 v[116:117], v205, s[8:11], s38 offen
v_mfma_f32_16x16x32_bf16 v[162:165], v[220:223], a[84:87], v[162:165]
v_add_f32 v118, v118, v8
v_fmac_f32 v119, v8, v8
v_mfma_f32_16x16x32_bf16 v[166:169], v[110:113], a[104:107], v[166:169]
v_add_f32 v118, v118, v9
v_fmac_f32 v119, v9, v9
v_mfma_f32_16x16x32_bf16 v[166:169], v[220:223], a[108:111], v[166:169]
s_waitcnt lgkmcnt(2)
v_add_f32 v118, v118, v10
v_fmac_f32_e64 v119, v10, v10
v_smfmac_f32_16x16x64_bf16 v[20:23], v[174:177], v[92:99], v213
v_add_f32_e64 v118, v118, v11
v_mfma_f32_16x16x32_bf16 v[170:173], v[110:113], a[128:131], v[170:173]
ds_read_b128 v[110:113], v210 offset:26624
v_fmac_f32 v119, v11, v11
v_mfma_f32_16x16x32_bf16 v[170:173], v[220:223], a[132:135], v[170:173]
s_waitcnt lgkmcnt(1)
ds_read_b128 v[220:223], v210 offset:27648
v_add_f32_e64 v126, v126, v20
v_smfmac_f32_16x16x64_bf16 v[32:35], v[174:177], v[100:107], v213
v_fmac_f32_e64 v127, v20, v20
v_mfma_f32_16x16x32_bf16 v[138:141], a[16:19], v[182:185], v[138:141]
v_add_f32 v126, v126, v21
v_fmac_f32 v127, v21, v21
v_mfma_f32_16x16x32_bf16 v[138:141], a[20:23], v[186:189], v[138:141]
v_add_f32 v134, v134, v32
v_fmac_f32 v135, v32, v32
v_mfma_f32_16x16x32_bf16 v[142:145], a[40:43], v[182:185], v[142:145]
v_add_f32 v134, v134, v33
v_fmac_f32 v135, v33, v33
v_mfma_f32_16x16x32_bf16 v[142:145], a[44:47], v[186:189], v[142:145]
v_cvt_pk_bf16_f32 v78, v138, v139
v_cvt_pk_bf16_f32 v79, v140, v141
v_mfma_f32_16x16x32_bf16 v[146:149], a[64:67], v[182:185], v[146:149]
v_add_f32 v134, v134, v34
v_fmac_f32 v135, v34, v34
v_mfma_f32_16x16x32_bf16 v[146:149], a[68:71], v[186:189], v[146:149]
v_cvt_pk_bf16_f32 v80, v142, v143
v_cvt_pk_bf16_f32 v81, v144, v145
v_mfma_f32_16x16x32_bf16 v[150:153], a[232:235], v[182:185], v[150:153]
v_add_f32 v126, v126, v22
v_fmac_f32 v127, v22, v22
v_mfma_f32_16x16x32_bf16 v[150:153], a[236:239], v[186:189], v[150:153]
v_cvt_pk_bf16_f32 v82, v146, v147
v_cvt_pk_bf16_f32 v83, v148, v149
v_mfma_f32_16x16x32_bf16 v[154:157], v[224:227], v[182:185], v[154:157]
v_add_f32 v134, v134, v35
v_fmac_f32 v135, v35, v35
v_mfma_f32_16x16x32_bf16 v[154:157], v[228:231], v[186:189], v[154:157]
v_cvt_pk_bf16_f32 v72, v150, v151
v_cvt_pk_bf16_f32 v73, v152, v153
v_mfma_f32_16x16x32_bf16 v[158:161], v[248:251], v[182:185], v[158:161]
v_add_f32 v126, v126, v23
v_fmac_f32 v127, v23, v23
v_mfma_f32_16x16x32_bf16 v[158:161], v[252:255], v[186:189], v[158:161]
v_cvt_pk_bf16_f32 v74, v154, v155
v_cvt_pk_bf16_f32 v75, v156, v157
v_mfma_f32_16x16x32_bf16 v[162:165], v[182:185], a[88:91], v[162:165]
s_nop 0
v_permlane16_swap_b32 v134, v135
v_mfma_f32_16x16x32_bf16 v[162:165], v[186:189], a[92:95], v[162:165]
v_cvt_pk_bf16_f32 v76, v158, v159
v_cvt_pk_bf16_f32 v77, v160, v161
v_mfma_f32_16x16x32_bf16 v[166:169], v[182:185], a[112:115], v[166:169]
v_permlane16_swap_b32 v118, v119
v_mfma_f32_16x16x32_bf16 v[166:169], v[186:189], a[116:119], v[166:169]
v_permlane16_swap_b32 v126, v127
v_mfma_f32_16x16x32_bf16 v[170:173], v[182:185], a[136:139], v[170:173]
ds_read_b128 v[182:185], v210 offset:28672
v_add_f32 v134, v134, v135
v_mfma_f32_16x16x32_bf16 v[170:173], v[186:189], a[140:143], v[170:173]
s_waitcnt lgkmcnt(2)
ds_read_b128 v[186:189], v210 offset:29696
v_cvt_pk_bf16_f32 v114, v162, v163
v_mfma_f32_16x16x32_bf16 v[138:141], a[0:3], v[110:113], 0
s_waitcnt lgkmcnt(2)
v_cvt_pk_bf16_f32 v115, v164, v165
v_add_f32 v118, v118, v119
v_mfma_f32_16x16x32_bf16 v[138:141], a[4:7], v[220:223], v[138:141]
v_add_f32 v126, v126, v127
v_mov_b32 v135, v134
v_mfma_f32_16x16x32_bf16 v[142:145], a[24:27], v[110:113], 0
v_permlane32_swap_b32 v118, v126
v_mfma_f32_16x16x32_bf16 v[142:145], a[28:31], v[220:223], v[142:145]
v_permlane32_swap_b32 v134, v135
v_mfma_f32_16x16x32_bf16 v[146:149], a[48:51], v[110:113], 0
v_cvt_pk_bf16_f32 v122, v166, v167
v_cvt_pk_bf16_f32 v123, v168, v169
v_mfma_f32_16x16x32_bf16 v[146:149], a[52:55], v[220:223], v[146:149]
v_add_f32 v118, v118, v126
v_add_f32 v134, v134, v135
v_mfma_f32_16x16x32_bf16 v[150:153], a[216:219], v[110:113], 0
ds_write_b32 v209, v118
v_mfma_f32_16x16x32_bf16 v[150:153], a[220:223], v[220:223], v[150:153]
ds_write_b32 v209, v134 offset:512
v_mfma_f32_16x16x32_bf16 v[154:157], a[240:243], v[110:113], 0
v_cvt_pk_bf16_f32 v130, v170, v171
v_cvt_pk_bf16_f32 v131, v172, v173
v_mfma_f32_16x16x32_bf16 v[154:157], a[244:247], v[220:223], v[154:157]
buffer_store_dwordx2 v[124:125], v205, s[8:11], s38 offen offset:32
v_mfma_f32_16x16x32_bf16 v[158:161], v[232:235], v[110:113], 0
v_mfma_f32_16x16x32_bf16 v[158:161], v[236:239], v[220:223], v[158:161]
v_mfma_f32_16x16x32_bf16 v[162:165], v[110:113], a[72:75], 0
s_waitcnt lgkmcnt(0)
s_barrier
v_mfma_f32_16x16x32_bf16 v[162:165], v[220:223], a[76:79], v[162:165]
ds_read_b128 v[102:105], v210 offset:18432
ds_read_b128 v[106:109], v210 offset:19456
v_mfma_f32_16x16x32_bf16 v[166:169], v[110:113], a[96:99], 0
v_mfma_f32_16x16x32_bf16 v[166:169], v[220:223], a[100:103], v[166:169]
v_mfma_f32_16x16x32_bf16 v[170:173], v[110:113], a[120:123], 0
s_sub_u32 s46, s46, 1
ds_read_b128 v[110:113], v210 offset:30720
v_mfma_f32_16x16x32_bf16 v[170:173], v[220:223], a[124:127], v[170:173]
s_cbranch_scc0 F_loop
F_tail:
v_mfma_f32_16x16x32_bf16 v[138:141], a[8:11], v[182:185], v[138:141]
s_mov_b32 s20, s100
s_waitcnt lgkmcnt(1)
buffer_load_dwordx4 v216, s[4:7], s52 offen nt lds
v_mfma_f32_16x16x32_bf16 v[138:141], a[12:15], v[186:189], v[138:141]
s_add_u32 m0, s45, 4112
v_add_f32 v102, v102, v103
v_add_f32 v106, v106, v107
v_mfma_f32_16x16x32_bf16 v[142:145], a[32:35], v[182:185], v[142:145]
s_add_u32 s40, s37, 196224
v_add_f32 v104, v104, v105
v_add_f32 v108, v108, v109
v_mfma_f32_16x16x32_bf16 v[142:145], a[36:39], v[186:189], v[142:145]
s_mov_b32 s21, s101
v_add_f32 v102, v102, v104
v_add_f32_e64 v106, v106, v108
v_mfma_f32_16x16x32_bf16 v[146:149], a[56:59], v[182:185], v[146:149]
s_mov_b32 s22, 256
buffer_load_dwordx4 v216, s[4:7], s40 offen nt lds
v_mfma_f32_16x16x32_bf16 v[146:149], a[60:63], v[186:189], v[146:149]
s_add_u32 m0, s45, 8224
v_mul_f32 v103, s48, v102
v_mul_f32 v104, s73, v102
v_mfma_f32_16x16x32_bf16 v[150:153], a[224:227], v[182:185], v[150:153]
s_add_u32 s40, s37, 392448
v_mul_f32_e64 v106, s73, v106
v_fma_f32 v106, -v103, v104, v106
v_mfma_f32_16x16x32_bf16 v[150:153], a[228:231], v[186:189], v[150:153]
s_mov_b32 s23, 131072
v_max_f32_e64 v106, 0, v106
v_add_f32 v106, s49, v106
v_mfma_f32_16x16x32_bf16 v[154:157], a[248:251], v[182:185], v[154:157]
s_mov_b32 s30, 1
v_rsq_f32 v102, v106
v_mfma_f32_16x16x32_bf16 v[154:157], a[252:255], v[186:189], v[154:157]
s_mov_b32 s31, 0
ds_read_b128 v[106:109], v210 offset:31744
v_mul_f32_e64 v103, -v103, v102
v_mfma_f32_16x16x32_bf16 v[158:161], v[240:243], v[182:185], v[158:161]
ds_write_b64 v211, v[102:103]
v_mfma_f32_16x16x32_bf16 v[158:161], v[244:247], v[186:189], v[158:161]
v_mfma_f32_16x16x32_bf16 v[162:165], v[182:185], a[80:83], v[162:165]
buffer_load_dwordx4 v216, s[4:7], s40 offen nt lds
v_mfma_f32_16x16x32_bf16 v[162:165], v[186:189], a[84:87], v[162:165]
s_add_u32 m0, s45, 12336
ds_read_b64 v[118:119], v219
ds_read_b64 v[126:127], v219 offset:256
v_mfma_f32_16x16x32_bf16 v[166:169], v[182:185], a[104:107], v[166:169]
s_add_u32 s40, s37, 588672
ds_read_b64 v[134:135], v219 offset:512
v_mfma_f32_16x16x32_bf16 v[166:169], v[186:189], a[108:111], v[166:169]
v_mfma_f32_16x16x32_bf16 v[170:173], v[182:185], a[128:131], v[170:173]
ds_read_b128 v[182:185], v210 offset:32768
v_mfma_f32_16x16x32_bf16 v[170:173], v[186:189], a[132:135], v[170:173]
ds_read_b128 v[186:189], v210 offset:33792
s_waitcnt lgkmcnt(7)
v_mfma_f32_16x16x32_bf16 v[138:141], a[16:19], v[110:113], v[138:141]
s_waitcnt lgkmcnt(4)
v_fma_f32 v220, v0, v118, v119
v_fma_f32 v221, v1, v118, v119
v_mfma_f32_16x16x32_bf16 v[138:141], a[20:23], v[106:109], v[138:141]
v_fma_f32 v222, v2, v118, v119
v_fma_f32 v223, v3, v118, v119
v_mfma_f32_16x16x32_bf16 v[142:145], a[40:43], v[110:113], v[142:145]
buffer_load_dwordx4 v216, s[4:7], s40 offen nt lds
v_mfma_f32_16x16x32_bf16 v[142:145], a[44:47], v[106:109], v[142:145]
s_add_u32 m0, s45, 16448
v_cvt_pk_bf16_f32 v90, v220, v221
v_cvt_pk_bf16_f32 v91, v222, v223
v_mfma_f32_16x16x32_bf16 v[146:149], a[64:67], v[110:113], v[146:149]
s_add_u32 s40, s37, 784896
v_cvt_pk_bf16_f32 v96, v138, v139
v_cvt_pk_bf16_f32 v97, v140, v141
v_mfma_f32_16x16x32_bf16 v[146:149], a[68:71], v[106:109], v[146:149]
v_fma_f32 v220, v4, v118, v119
v_fma_f32 v221, v5, v118, v119
v_mfma_f32_16x16x32_bf16 v[150:153], a[232:235], v[110:113], v[150:153]
v_fma_f32 v222, v6, v118, v119
v_fma_f32 v223, v7, v118, v119
v_mfma_f32_16x16x32_bf16 v[150:153], a[236:239], v[106:109], v[150:153]
v_cvt_pk_bf16_f32 v100, v146, v147
v_cvt_pk_bf16_f32 v101, v148, v149
v_mfma_f32_16x16x32_bf16 v[154:157], v[224:227], v[110:113], v[154:157]
v_cvt_pk_bf16_f32 v92, v220, v221
v_cvt_pk_bf16_f32 v93, v222, v223
v_mfma_f32_16x16x32_bf16 v[154:157], v[228:231], v[106:109], v[154:157]
v_fma_f32 v220, v8, v118, v119
v_fma_f32 v221, v9, v118, v119
v_mfma_f32_16x16x32_bf16 v[158:161], v[248:251], v[110:113], v[158:161]
s_nop 0
buffer_store_dwordx2 v[132:133], v205, s[8:11], s38 offen offset:64
v_fma_f32 v222, v10, v118, v119
v_mfma_f32_16x16x32_bf16 v[158:161], v[252:255], v[106:109], v[158:161]
s_mov_b32 s38, s36
v_fma_f32 v223, v11, v118, v119
v_cvt_pk_bf16_f32 v94, v220, v221
v_mfma_f32_16x16x32_bf16 v[162:165], v[110:113], a[88:91], v[162:165]
s_nop 0
ds_write_b128 v211, v[90:93]
v_mfma_f32_16x16x32_bf16 v[162:165], v[106:109], a[92:95], v[162:165]
s_waitcnt lgkmcnt(4)
v_cvt_pk_bf16_f32 v95, v222, v223
v_fma_f32 v220, v12, v126, v127
v_mfma_f32_16x16x32_bf16 v[166:169], v[110:113], a[112:115], v[166:169]
v_fma_f32 v221, v13, v126, v127
v_fma_f32 v222, v14, v126, v127
v_mfma_f32_16x16x32_bf16 v[166:169], v[106:109], a[116:119], v[166:169]
v_fma_f32 v223, v15, v126, v127
v_cvt_pk_bf16_f32 v98, v142, v143
v_mfma_f32_16x16x32_bf16 v[170:173], v[110:113], a[136:139], v[170:173]
ds_read_b64 v[112:113], v215 offset:528
v_cvt_pk_bf16_f32 v99, v144, v145
v_mfma_f32_16x16x32_bf16 v[170:173], v[106:109], a[140:143], v[170:173]
s_waitcnt lgkmcnt(3)
ds_read_b128 v[108:111], v215 offset:512
v_cvt_pk_bf16_f32 v174, v220, v221
v_mfma_f32_16x16x32_bf16 v[138:141], a[0:3], v[182:185], 0
s_waitcnt lgkmcnt(3)
v_cvt_pk_bf16_f32 v175, v222, v223
v_cvt_pk_bf16_f32 v84, v150, v151
v_mfma_f32_16x16x32_bf16 v[138:141], a[4:7], v[186:189], v[138:141]
v_cvt_pk_bf16_f32 v85, v152, v153
v_cvt_pk_bf16_f32 v132, v170, v171
v_mfma_f32_16x16x32_bf16 v[142:145], a[24:27], v[182:185], 0
v_cvt_pk_bf16_f32 v133, v172, v173
v_fma_f32 v220, v16, v126, v127
v_mfma_f32_16x16x32_bf16 v[142:145], a[28:31], v[186:189], v[142:145]
ds_read_b128 v[170:173], v210 offset:34816
v_fma_f32 v221, v17, v126, v127
v_mfma_f32_16x16x32_bf16 v[146:149], a[48:51], v[182:185], 0
s_nop 0
ds_read_b128 v[182:185], v210 offset:35840
v_fma_f32 v222, v18, v126, v127
v_mfma_f32_16x16x32_bf16 v[146:149], a[52:55], v[186:189], v[146:149]
s_waitcnt lgkmcnt(2)
ds_read_b128 v[186:189], v210 offset:36864
v_fma_f32 v223, v19, v126, v127
v_cvt_pk_bf16_f32 v176, v220, v221
v_mfma_f32_16x16x16_bf16 v[150:153], v[112:113], v[76:77], v[206:209]
v_cvt_pk_bf16_f32 v177, v222, v223
v_fma_f32 v220, v20, v126, v127
v_fma_f32 v221, v21, v126, v127
v_fma_f32 v222, v22, v126, v127
v_fma_f32 v223, v23, v126, v127
v_cvt_pk_bf16_f32 v178, v220, v221
v_mfma_f32_16x16x32_bf16 v[150:153], v[108:111], v[72:75], v[150:153]
buffer_load_dwordx4 v216, s[4:7], s40 offen nt lds
ds_write_b128 v211, v[174:177] offset:6144
s_waitcnt lgkmcnt(3)
v_mfma_f32_16x16x32_bf16 v[138:141], a[8:11], v[170:173], v[138:141]
s_waitcnt lgkmcnt(2)
v_cvt_pk_bf16_f32 v179, v222, v223
v_cvt_pk_bf16_f32 v88, v158, v159
v_mfma_f32_16x16x32_bf16 v[138:141], a[12:15], v[182:185], v[138:141]
s_add_u32 m0, s45, 20560
v_cvt_pk_bf16_f32 v89, v160, v161
v_cvt_pk_bf16_f32 v86, v154, v155
v_mfma_f32_16x16x32_bf16 v[142:145], a[32:35], v[170:173], v[142:145]
s_add_u32 s40, s37, 981120
ds_write_b64 v212, v[178:179] offset:6144
v_mfma_f32_16x16x32_bf16 v[142:145], a[36:39], v[182:185], v[142:145]
v_cvt_pk_bf16_f32 v87, v156, v157
v_cvt_pk_bf16_f32 v124, v166, v167
v_mfma_f32_16x16x32_bf16 v[146:149], a[56:59], v[170:173], v[146:149]
s_nop 0
ds_read_b128 v[174:177], v210 offset:34816
ds_read_b128 v[178:181], v210 offset:35840
v_mfma_f32_16x16x32_bf16 v[146:149], a[60:63], v[182:185], v[146:149]
s_waitcnt lgkmcnt(4)
buffer_load_dwordx4 v216, s[4:7], s40 offen nt lds
v_mfma_f32_16x16x32_bf16 v[138:141], a[16:19], v[186:189], v[138:141]
s_add_u32 m0, s45, 24672
ds_read_b128 v[182:185], v210 offset:32768
ds_read_b128 v[170:173], v210 offset:37888
v_cvt_pk_bf16_f32 v125, v168, v169
v_mfma_f32_16x16x16_bf16 v[154:157], v[82:83], v[88:89], 0
v_exp_f32_e64 v150, v150
v_fma_f32 v220, v24, v134, v135
v_mfma_f32_16x16x16_bf16 v[158:161], v[100:101], v[88:89], 0
v_fma_f32 v221, v25, v134, v135
v_fma_f32 v222, v26, v134, v135
v_fma_f32 v223, v27, v134, v135
v_mfma_f32_16x16x16_bf16 v[166:169], v[112:113], v[88:89], v[206:209]
v_cvt_pk_bf16_f32 v116, v162, v163
v_cvt_pk_bf16_f32 v117, v164, v165
v_cvt_pk_bf16_f32 v90, v220, v221
v_cvt_pk_bf16_f32 v91, v222, v223
v_mfma_f32_16x16x32_bf16 v[142:145], a[40:43], v[186:189], v[142:145]
s_add_u32 s40, s37, 1177344
ds_write_b64 v212, v[94:95]
v_mfma_f32_16x16x32_bf16 v[154:157], v[78:81], v[84:87], v[154:157]
s_waitcnt lgkmcnt(2)
v_fma_f32 v220, v28, v134, v135
v_fma_f32 v221, v29, v134, v135
v_mfma_f32_16x16x32_bf16 v[118:121], v[182:185], a[72:75], 0
s_waitcnt lgkmcnt(1)
buffer_load_dwordx4 v216, s[4:7], s40 offen nt lds
v_mfma_f32_16x16x32_bf16 v[126:129], v[182:185], a[96:99], 0
s_add_u32 m0, s45, 28784
v_exp_f32_e64 v154, v154
v_mfma_f32_16x16x32_bf16 v[138:141], a[20:23], v[170:173], v[138:141]
s_add_u32 s40, s37, 1373568
v_exp_f32 v155, v155
v_mfma_f32_16x16x32_bf16 v[142:145], a[44:47], v[170:173], v[142:145]
v_exp_f32 v156, v156
v_mfma_f32_16x16x32_bf16 v[146:149], a[64:67], v[186:189], v[146:149]
ds_read_b128 v[186:189], v210 offset:33792
v_cvt_pk_bf16_f32 v102, v138, v139
v_mfma_f32_16x16x32_bf16 v[146:149], a[68:71], v[170:173], v[146:149]
v_cvt_pk_bf16_f32 v103, v140, v141
v_cvt_pk_bf16_f32 v104, v142, v143
v_cvt_pk_bf16_f32 v105, v144, v145
v_mfma_f32_16x16x16_bf16 v[138:141], v[82:83], v[76:77], 0
v_exp_f32_e64 v157, v157
v_fma_f32 v222, v30, v134, v135
v_mfma_f32_16x16x16_bf16 v[142:145], v[100:101], v[76:77], 0
v_cvt_pk_bf16_f32 v106, v146, v147
v_cvt_pk_bf16_f32 v107, v148, v149
v_fma_f32 v223, v31, v134, v135
v_cvt_pk_bf16_f32 v92, v220, v221
v_mfma_f32_16x16x16_bf16 v[146:149], v[106:107], v[76:77], 0
v_cvt_pk_bf16_f32 v93, v222, v223
v_fma_f32 v220, v32, v134, v135
v_fma_f32 v221, v33, v134, v135
v_fma_f32 v222, v34, v134, v135
v_mfma_f32_16x16x32_bf16 v[138:141], v[78:81], v[72:75], v[138:141]
s_waitcnt lgkmcnt(0)
buffer_load_dwordx4 v216, s[4:7], s40 offen nt lds
v_mfma_f32_16x16x32_bf16 v[142:145], v[96:99], v[72:75], v[142:145]
s_add_u32 m0, s45, 32896
ds_write_b128 v211, v[90:93] offset:12288
v_mfma_f32_16x16x32_bf16 v[146:149], v[102:105], v[72:75], v[146:149]
s_add_u32 s40, s37, 1569792
v_exp_f32 v138, v138
v_mfma_f32_16x16x32_bf16 v[118:121], v[186:189], a[76:79], v[118:121]
v_exp_f32 v139, v139
v_mfma_f32_16x16x32_bf16 v[126:129], v[186:189], a[100:103], v[126:129]
v_exp_f32 v140, v140
v_mfma_f32_16x16x32_bf16 v[90:93], a[216:219], v[182:185], 0
buffer_load_dwordx4 v216, s[4:7], s40 offen nt lds
v_mfma_f32_16x16x32_bf16 v[90:93], a[220:223], v[186:189], v[90:93]
v_exp_f32 v141, v141
v_mfma_f32_16x16x32_bf16 v[170:173], a[240:243], v[182:185], 0
v_exp_f32 v142, v142
v_mfma_f32_16x16x32_bf16 v[170:173], a[244:247], v[186:189], v[170:173]
v_exp_f32_e64 v143, v143
v_fma_f32 v223, v35, v134, v135
v_mfma_f32_16x16x16_bf16 v[162:165], v[106:107], v[88:89], 0
v_exp_f32 v144, v144
v_exp_f32 v145, v145
v_mfma_f32_16x16x32_bf16 v[134:137], v[182:185], a[120:123], 0
v_exp_f32 v146, v146
v_mfma_f32_16x16x32_bf16 v[134:137], v[186:189], a[124:127], v[134:137]
v_exp_f32 v147, v147
v_mfma_f32_16x16x32_bf16 v[134:137], v[174:177], a[128:131], v[134:137]
v_exp_f32 v148, v148
v_mfma_f32_16x16x32_bf16 v[134:137], v[178:181], a[132:135], v[134:137]
v_exp_f32 v149, v149
v_mfma_f32_16x16x32_bf16 v[158:161], v[96:99], v[84:87], v[158:161]
v_cvt_pk_bf16_f32 v94, v220, v221
v_cvt_pk_bf16_f32 v95, v222, v223
v_mfma_f32_16x16x32_bf16 v[220:223], v[232:235], v[182:185], 0
ds_read_b128 v[182:185], v210 offset:36864
ds_write_b64 v212, v[94:95] offset:12288
v_mfma_f32_16x16x32_bf16 v[220:223], v[236:239], v[186:189], v[220:223]
v_exp_f32 v158, v158
v_mfma_f32_16x16x32_bf16 v[118:121], v[174:177], a[80:83], v[118:121]
v_exp_f32 v159, v159
v_mfma_f32_16x16x32_bf16 v[118:121], v[178:181], a[84:87], v[118:121]
v_exp_f32 v160, v160
v_mfma_f32_16x16x32_bf16 v[126:129], v[174:177], a[104:107], v[126:129]
v_exp_f32 v161, v161
v_mfma_f32_16x16x32_bf16 v[126:129], v[178:181], a[108:111], v[126:129]
ds_read_b128 v[186:189], v210 offset:37888
ds_read_b64 v[76:77], v215 offset:16
v_mfma_f32_16x16x32_bf16 v[166:169], v[108:111], v[84:87], v[166:169]
ds_read_b128 v[72:75], v215
v_mov_b32_e64 v216, 1
v_mfma_f32_16x16x32_bf16 v[90:93], a[224:227], v[174:177], v[90:93]
s_mov_b64 exec, s[30:31]
buffer_atomic_add v216, off, s[20:23], s45 sc0
s_mov_b64 exec, -1
v_mfma_f32_16x16x32_bf16 v[90:93], a[228:231], v[178:181], v[90:93]
v_exp_f32_e64 v166, v166
v_mfma_f32_16x16x32_bf16 v[170:173], a[248:251], v[174:177], v[170:173]
v_mfma_f32_16x16x32_bf16 v[170:173], a[252:255], v[178:181], v[170:173]
v_mfma_f32_16x16x32_bf16 v[220:223], v[240:243], v[174:177], v[220:223]
v_cvt_pk_bf16_f32 v174, v138, v139
v_cvt_pk_bf16_f32 v175, v140, v141
v_mfma_f32_16x16x32_bf16 v[220:223], v[244:247], v[178:181], v[220:223]
s_nop 0
v_cvt_pk_bf16_f32 v176, v142, v143
v_cvt_pk_bf16_f32 v177, v144, v145
v_mfma_f32_16x16x32_bf16 v[162:165], v[102:105], v[84:87], v[162:165]
s_waitcnt lgkmcnt(4)
v_cvt_pk_bf16_f32 v180, v150, 0
v_cvt_pk_bf16_f32 v178, v146, v147
v_mfma_f32_16x16x32_bf16 v[118:121], v[182:185], a[88:91], v[118:121]
s_waitcnt lgkmcnt(2)
v_cvt_pk_bf16_f32 v179, v148, v149
v_mov_b32 v181, 0
v_mfma_f32_16x16x32_bf16 v[118:121], v[186:189], a[92:95], v[118:121]
v_exp_f32 v162, v162
v_mfma_f32_16x16x32_bf16 v[126:129], v[182:185], a[112:115], v[126:129]
v_exp_f32 v163, v163
v_mfma_f32_16x16x32_bf16 v[126:129], v[186:189], a[116:119], v[126:129]
v_exp_f32 v164, v164
v_mfma_f32_16x16x32_bf16 v[134:137], v[182:185], a[136:139], v[134:137]
v_exp_f32 v165, v165
v_mfma_f32_16x16x32_bf16 v[134:137], v[186:189], a[140:143], v[134:137]
v_cvt_pk_bf16_f32 v118, v118, v119
v_cvt_pk_bf16_f32 v119, v120, v121
v_mfma_f32_16x16x32_bf16 v[90:93], a[232:235], v[182:185], v[90:93]
ds_read_u16 v120, v214 offset:1024
v_mov_b32_e64 v121, 0
v_mfma_f32_16x16x32_bf16 v[90:93], a[236:239], v[186:189], v[90:93]
v_cvt_pk_bf16_f32 v126, v126, v127
v_cvt_pk_bf16_f32 v127, v128, v129
v_mfma_f32_16x16x32_bf16 v[170:173], v[224:227], v[182:185], v[170:173]
ds_read_u16 v128, v214 offset:1032
v_cvt_pk_bf16_f32 v134, v134, v135
v_mfma_f32_16x16x32_bf16 v[170:173], v[228:231], v[186:189], v[170:173]
v_cvt_pk_bf16_f32 v135, v136, v137
v_mov_b32_e64 v129, 0
v_mfma_f32_16x16x32_bf16 v[220:223], v[248:251], v[182:185], v[220:223]
ds_read_u16 v136, v214 offset:1040
v_mov_b32_e64 v137, 0
v_mfma_f32_16x16x32_bf16 v[220:223], v[252:255], v[186:189], v[220:223]
v_cvt_pk_bf16_f32 v90, v90, v91
v_cvt_pk_bf16_f32 v91, v92, v93
v_mfma_f32_16x16x32_bf16 v[150:153], v[190:193], v[174:177], 0
v_cvt_pk_bf16_f32 v92, v170, v171
v_cvt_pk_bf16_f32 v93, v172, v173
v_mfma_f32_16x16x32_bf16 v[150:153], v[190:193], v[178:181], v[150:153]
v_cvt_pk_bf16_f32 v94, v220, v221
v_cvt_pk_bf16_f32 v95, v222, v223
v_mfma_f32_16x16x32_bf16 v[138:141], v[114:117], v[174:177], 0
s_waitcnt lgkmcnt(2)
v_mfma_f32_16x16x32_bf16 v[138:141], v[118:121], v[178:181], v[138:141]
v_rcp_f32_e64 v151, v150
v_mfma_f32_16x16x32_bf16 v[142:145], v[122:125], v[174:177], 0
s_waitcnt lgkmcnt(1)
v_max3_u32 v218, v218, v150, v151
v_mul_f32_e64 v151, s3, v151
v_mfma_f32_16x16x32_bf16 v[142:145], v[126:129], v[178:181], v[142:145]
v_mul_f32_e64 v138, v138, v151
v_mul_f32 v139, v139, v151
v_mfma_f32_16x16x32_bf16 v[146:149], v[130:133], v[174:177], 0
s_waitcnt lgkmcnt(0)
v_cvt_pk_bf16_f32 v174, v154, v155
v_cvt_pk_bf16_f32 v175, v156, v157
v_mfma_f32_16x16x32_bf16 v[146:149], v[134:137], v[178:181], v[146:149]
v_cvt_pk_bf16_f32 v176, v158, v159
v_cvt_pk_bf16_f32 v177, v160, v161
v_cvt_pk_bf16_f32 v180, v166, 0
v_cvt_pk_bf16_f32 v178, v162, v163
v_mfma_f32_16x16x32_bf16 v[166:169], v[190:193], v[174:177], 0
v_cvt_pk_bf16_f32 v179, v164, v165
v_mul_f32 v140, v140, v151
v_mul_f32 v141, v141, v151
v_mfma_f32_16x16x32_bf16 v[166:169], v[190:193], v[178:181], v[166:169]
v_cvt_pk_bf16_f32 v138, v138, v139
v_mul_f32_e64 v142, v142, v151
v_mfma_f32_16x16x32_bf16 v[154:157], v[114:117], v[174:177], 0
v_mul_f32 v143, v143, v151
v_mul_f32 v144, v144, v151
v_mfma_f32_16x16x32_bf16 v[154:157], v[118:121], v[178:181], v[154:157]
v_mul_f32_e64 v145, v145, v151
v_cvt_pk_bf16_f32 v139, v140, v141
v_mfma_f32_16x16x32_bf16 v[158:161], v[122:125], v[174:177], 0
v_cvt_pk_bf16_f32 v140, v142, v143
v_cvt_pk_bf16_f32 v141, v144, v145
v_mfma_f32_16x16x32_bf16 v[158:161], v[126:129], v[178:181], v[158:161]
ds_write_b128 v211, v[138:141] offset:38912
v_mfma_f32_16x16x32_bf16 v[162:165], v[130:133], v[174:177], 0
v_mul_f32 v146, v146, v151
v_mul_f32 v147, v147, v151
v_mfma_f32_16x16x32_bf16 v[162:165], v[134:137], v[178:181], v[162:165]
v_mul_f32 v148, v148, v151
v_mul_f32 v149, v149, v151
v_cvt_pk_bf16_f32 v142, v146, v147
v_mfma_f32_16x16x16_bf16 v[138:141], v[82:83], v[94:95], 0
v_cvt_pk_bf16_f32 v143, v148, v149
v_rcp_f32_e64 v167, v166
v_mfma_f32_16x16x16_bf16 v[150:153], v[112:113], v[94:95], v[206:209]
v_max3_u32 v218, v218, v166, v167
v_mul_f32 v167, s3, v167
v_mul_f32 v154, v154, v167
v_mfma_f32_16x16x16_bf16 v[146:149], v[106:107], v[94:95], 0
v_mul_f32 v155, v155, v167
v_mul_f32 v156, v156, v167
v_mul_f32_e64 v157, v157, v167
v_cvt_pk_bf16_f32 v154, v154, v155
v_mfma_f32_16x16x32_bf16 v[138:141], v[78:81], v[90:93], v[138:141]
ds_write_b64 v212, v[142:143] offset:38912
v_mfma_f32_16x16x16_bf16 v[142:145], v[100:101], v[94:95], 0
v_mul_f32 v158, v158, v167
v_mul_f32 v159, v159, v167
v_mul_f32 v160, v160, v167
v_mul_f32 v161, v161, v167
v_mfma_f32_16x16x32_bf16 v[150:153], v[108:111], v[90:93], v[150:153]
v_cvt_pk_bf16_f32 v155, v156, v157
v_cvt_pk_bf16_f32 v156, v158, v159
v_mfma_f32_16x16x32_bf16 v[142:145], v[96:99], v[90:93], v[142:145]
v_cvt_pk_bf16_f32 v157, v160, v161
v_mul_f32_e64 v162, v162, v167
v_mfma_f32_16x16x32_bf16 v[146:149], v[102:105], v[90:93], v[146:149]
ds_write_b128 v211, v[154:157] offset:45056
v_mfma_f32_16x16x16_bf16 v[154:157], v[76:77], v[82:83], 0
v_mul_f32 v163, v163, v167
v_mul_f32 v164, v164, v167
v_mul_f32_e64 v165, v165, v167
v_mfma_f32_16x16x16_bf16 v[166:169], v[76:77], v[112:113], v[206:209]
v_cvt_pk_bf16_f32 v158, v162, v163
v_cvt_pk_bf16_f32 v159, v164, v165
v_exp_f32 v138, v138
v_mfma_f32_16x16x16_bf16 v[162:165], v[76:77], v[106:107], 0
v_exp_f32 v139, v139
v_exp_f32 v140, v140
v_mfma_f32_16x16x32_bf16 v[154:157], v[72:75], v[78:81], v[154:157]
ds_write_b64 v212, v[158:159] offset:45056
v_mfma_f32_16x16x16_bf16 v[158:161], v[76:77], v[100:101], 0
v_exp_f32 v141, v141
v_exp_f32 v142, v142
v_mfma_f32_16x16x32_bf16 v[162:165], v[72:75], v[102:105], v[162:165]
v_exp_f32 v143, v143
v_mfma_f32_16x16x32_bf16 v[158:161], v[72:75], v[96:99], v[158:161]
v_exp_f32 v144, v144
v_mfma_f32_16x16x32_bf16 v[166:169], v[72:75], v[108:111], v[166:169]
v_exp_f32 v145, v145
v_exp_f32 v150, v150
v_exp_f32 v146, v146
v_exp_f32 v147, v147
v_exp_f32 v148, v148
v_exp_f32_e64 v149, v149
v_cvt_pk_bf16_f32 v174, v138, v139
v_cvt_pk_bf16_f32 v175, v140, v141
v_cvt_pk_bf16_f32 v176, v142, v143
v_cvt_pk_bf16_f32 v177, v144, v145
v_cvt_pk_bf16_f32 v180, v150, 0
v_cvt_pk_bf16_f32 v178, v146, v147
v_mfma_f32_16x16x32_bf16 v[150:153], v[190:193], v[174:177], 0
s_waitcnt lgkmcnt(0)
v_cvt_pk_bf16_f32 v179, v148, v149
v_mov_b32_dpp v154, v158 quad_perm:[0,1,2,3] row_mask:0x2 bank_mask:0xf
v_mfma_f32_16x16x32_bf16 v[138:141], v[114:117], v[174:177], 0
s_barrier
v_mfma_f32_16x16x32_bf16 v[138:141], v[118:121], v[178:181], v[138:141]
ds_read_b128 v[220:223], v210 offset:38912
ds_read_b128 v[110:113], v210 offset:39936
v_mfma_f32_16x16x32_bf16 v[150:153], v[190:193], v[178:181], v[150:153]
ds_read_b128 v[170:173], v210 offset:40960
ds_read_b128 v[182:185], v210 offset:41984
v_mfma_f32_16x16x32_bf16 v[142:145], v[122:125], v[174:177], 0
v_mov_b32_dpp v154, v162 quad_perm:[0,1,2,3] row_mask:0x4 bank_mask:0xf
v_mfma_f32_16x16x32_bf16 v[142:145], v[126:129], v[178:181], v[142:145]
v_mov_b32_dpp v154, v167 quad_perm:[0,1,2,3] row_mask:0x8 bank_mask:0xf
v_exp_f32 v154, v154
v_mfma_f32_16x16x32_bf16 v[146:149], v[130:133], v[174:177], 0
v_cvt_pk_bf16_f32 v154, v154, 0
v_rcp_f32 v151, v150
v_mfma_f32_16x16x32_bf16 v[146:149], v[134:137], v[178:181], v[146:149]
s_waitcnt lgkmcnt(3)
ds_write_b16 v214, v154
v_mfma_f32_16x16x32_bf16 v[36:39], a[144:147], v[220:223], v[36:39]
s_waitcnt lgkmcnt(3)
ds_read_b128 v[84:87], v215
ds_read_b128 v[88:91], v215 offset:16
v_mfma_f32_16x16x32_bf16 v[36:39], a[148:151], v[110:113], v[36:39]
ds_read_b128 v[186:189], v210 offset:43008
ds_read_b128 v[174:177], v217
v_mfma_f32_16x16x32_bf16 v[40:43], a[168:171], v[220:223], v[40:43]
ds_read_b128 v[178:181], v217 offset:528
v_add_u32 v215, 1552, v215
v_mfma_f32_16x16x32_bf16 v[40:43], a[172:175], v[110:113], v[40:43]
v_mfma_f32_16x16x32_bf16 v[44:47], a[192:195], v[220:223], v[44:47]
ds_read_b128 v[220:223], v210 offset:44032
v_mfma_f32_16x16x32_bf16 v[44:47], a[196:199], v[110:113], v[44:47]
s_nop 0
ds_read_b128 v[110:113], v210 offset:45056
s_waitcnt lgkmcnt(6)
v_mfma_f32_16x16x32_bf16 v[166:169], v[84:87], v[190:193], 0
s_waitcnt lgkmcnt(5)
v_mfma_f32_16x16x32_bf16 v[166:169], v[88:91], v[190:193], v[166:169]
v_mfma_f32_16x16x32_bf16 v[154:157], v[84:87], v[114:117], 0
v_mfma_f32_16x16x32_bf16 v[154:157], v[88:91], v[118:121], v[154:157]
v_rcp_f32 v167, v166
v_mfma_f32_16x16x32_bf16 v[158:161], v[84:87], v[122:125], 0
v_max3_u32 v218, v218, v166, v167
v_max3_u32 v218, v218, v150, v151
v_mfma_f32_16x16x32_bf16 v[158:161], v[88:91], v[126:129], v[158:161]
v_mul_f32 v151, s3, v151
v_mul_f32 v138, v138, v151
v_mfma_f32_16x16x32_bf16 v[162:165], v[84:87], v[130:133], 0
v_mul_f32 v139, v139, v151
v_mul_f32 v140, v140, v151
v_mfma_f32_16x16x32_bf16 v[162:165], v[88:91], v[134:137], v[162:165]
v_mul_f32_e64 v141, v141, v151
v_cvt_pk_bf16_f32 v138, v138, v139
v_mfma_f32_16x16x32_bf16 v[36:39], a[152:155], v[170:173], v[36:39]
v_mul_f32 v142, v142, v151
v_mul_f32 v143, v143, v151
v_mfma_f32_16x16x32_bf16 v[36:39], a[156:159], v[182:185], v[36:39]
s_waitcnt lgkmcnt(4)
v_mul_f32 v144, v144, v151
v_mul_f32_e64 v145, v145, v151
v_mfma_f32_16x16x32_bf16 v[36:39], a[160:163], v[186:189], v[36:39]
v_cvt_pk_bf16_f32 v139, v140, v141
v_cvt_pk_bf16_f32 v140, v142, v143
v_mfma_f32_16x16x32_bf16 v[40:43], a[176:179], v[170:173], v[40:43]
v_cvt_pk_bf16_f32 v141, v144, v145
v_mul_f32_e64 v146, v146, v151
v_mfma_f32_16x16x32_bf16 v[40:43], a[180:183], v[182:185], v[40:43]
ds_write_b128 v211, v[138:141] offset:51200
v_mfma_f32_16x16x32_bf16 v[40:43], a[184:187], v[186:189], v[40:43]
v_mul_f32 v147, v147, v151
v_mul_f32 v148, v148, v151
v_mfma_f32_16x16x32_bf16 v[44:47], a[200:203], v[170:173], v[44:47]
v_mul_f32_e64 v149, v149, v151
v_cvt_pk_bf16_f32 v142, v146, v147
v_mfma_f32_16x16x32_bf16 v[44:47], a[204:207], v[182:185], v[44:47]
s_nop 0
ds_read_b128 v[170:173], v210 offset:46080
ds_read_b128 v[182:185], v210 offset:47104
v_mfma_f32_16x16x32_bf16 v[44:47], a[208:211], v[186:189], v[44:47]
s_waitcnt lgkmcnt(4)
ds_read_b128 v[186:189], v210 offset:48128
v_cvt_pk_bf16_f32 v143, v148, v149
v_mfma_f32_16x16x32_bf16 v[44:47], a[212:215], v[220:223], v[44:47]
ds_write_b64 v212, v[142:143] offset:51200
v_mfma_f32_16x16x32_bf16 v[36:39], a[164:167], v[220:223], v[36:39]
v_mov_b32_dpp v154, v158 quad_perm:[0,1,2,3] row_mask:0x2 bank_mask:0xf
v_mul_f32 v167, s3, v167
v_mfma_f32_16x16x32_bf16 v[40:43], a[188:191], v[220:223], v[40:43]
s_waitcnt lgkmcnt(5)
ds_read_b128 v[220:223], v210 offset:49152
v_mov_b32_dpp v154, v162 quad_perm:[0,1,2,3] row_mask:0x4 bank_mask:0xf
v_mfma_f32_16x16x32_bf16 v[48:51], a[144:147], v[110:113], v[48:51]
s_waitcnt lgkmcnt(4)
v_cvt_pk_bf16_f32 v72, v36, v37
v_cvt_pk_bf16_f32 v73, v38, v39
v_mfma_f32_16x16x32_bf16 v[48:51], a[148:151], v[170:173], v[48:51]
s_waitcnt lgkmcnt(3)
buffer_store_dwordx2 v[72:73], v203, s[8:11], s39 offen
v_cvt_pk_bf16_f32 v74, v40, v41
v_mfma_f32_16x16x32_bf16 v[48:51], a[152:155], v[182:185], v[48:51]
s_waitcnt lgkmcnt(2)
v_cvt_pk_bf16_f32 v75, v42, v43
v_mul_f32 v154, v154, v167
v_mfma_f32_16x16x32_bf16 v[48:51], a[156:159], v[186:189], v[48:51]
v_cvt_pk_bf16_f32 v154, v154, 0
v_cvt_pk_bf16_f32 v76, v44, v45
v_mfma_f32_16x16x32_bf16 v[52:55], a[168:171], v[110:113], v[52:55]
s_nop 0
ds_write_b16 v214, v154
v_mfma_f32_16x16x32_bf16 v[52:55], a[172:175], v[170:173], v[52:55]
s_waitcnt vmcnt(2) lgkmcnt(2)
v_cvt_pk_bf16_f32 v77, v46, v47
v_add_u32 v214, 1552, v214
v_mfma_f32_16x16x32_bf16 v[52:55], a[176:179], v[182:185], v[52:55]
s_barrier
v_mfma_f32_16x16x32_bf16 v[52:55], a[180:183], v[186:189], v[52:55]
s_nop 0
ds_read_b128 v[84:87], v200
ds_read_b128 v[92:95], v201
v_mfma_f32_16x16x32_bf16 v[56:59], a[192:195], v[110:113], v[56:59]
ds_read_b128 v[110:113], v210 offset:50176
ds_read_b128 v[100:103], v202
v_mfma_f32_16x16x32_bf16 v[56:59], a[196:199], v[170:173], v[56:59]
ds_read_b128 v[170:173], v210 offset:51200
ds_read_b128 v[88:91], v194 offset:16
v_mfma_f32_16x16x32_bf16 v[56:59], a[200:203], v[182:185], v[56:59]
ds_read_b128 v[182:185], v210 offset:52224
v_mfma_f32_16x16x32_bf16 v[56:59], a[204:207], v[186:189], v[56:59]
s_nop 0
ds_read_b128 v[186:189], v210 offset:53248
s_waitcnt lgkmcnt(9)
v_mfma_f32_16x16x32_bf16 v[56:59], a[208:211], v[220:223], v[56:59]
ds_read_b128 v[96:99], v195 offset:16
v_mfma_f32_16x16x32_bf16 v[48:51], a[160:163], v[220:223], v[48:51]
ds_read_b128 v[104:107], v196 offset:16
buffer_store_dwordx2 v[74:75], v203, s[8:11], s39 offen offset:32
v_mfma_f32_16x16x32_bf16 v[52:55], a[184:187], v[220:223], v[52:55]
ds_read_b128 v[220:223], v210 offset:54272
s_waitcnt lgkmcnt(8)
v_mfma_f32_16x16x32_bf16 v[52:55], a[188:191], v[110:113], v[52:55]
v_mfma_f32_16x16x32_bf16 v[48:51], a[164:167], v[110:113], v[48:51]
v_mfma_f32_16x16x32_bf16 v[56:59], a[212:215], v[110:113], v[56:59]
s_waitcnt lgkmcnt(6)
ds_read_b128 v[110:113], v210 offset:55296
v_cvt_pk_bf16_f32 v80, v52, v53
v_mfma_f32_16x16x32_bf16 v[60:63], a[144:147], v[170:173], v[60:63]
s_waitcnt lgkmcnt(5)
v_cvt_pk_bf16_f32 v78, v48, v49
v_cvt_pk_bf16_f32 v79, v50, v51
v_mfma_f32_16x16x32_bf16 v[60:63], a[148:151], v[182:185], v[60:63]
s_waitcnt lgkmcnt(4)
v_cvt_pk_bf16_f32 v81, v54, v55
v_cvt_pk_bf16_f32 v82, v56, v57
v_mfma_f32_16x16x32_bf16 v[60:63], a[152:155], v[186:189], v[60:63]
v_cvt_pk_bf16_f32 v83, v58, v59
v_mfma_f32_16x16x32_bf16 v[64:67], a[168:171], v[170:173], v[64:67]
v_mfma_f32_16x16x32_bf16 v[64:67], a[172:175], v[182:185], v[64:67]
s_nop 0
v_mfma_f32_16x16x32_bf16 v[64:67], a[176:179], v[186:189], v[64:67]
s_waitcnt lgkmcnt(1)
v_mfma_f32_16x16x32_bf16 v[64:67], a[180:183], v[220:223], v[64:67]
v_mfma_f32_16x16x32_bf16 v[68:71], a[192:195], v[170:173], v[68:71]
ds_read_b128 v[170:173], v210 offset:56320
v_mfma_f32_16x16x32_bf16 v[68:71], a[196:199], v[182:185], v[68:71]
ds_read_b128 v[182:185], v210
v_mfma_f32_16x16x32_bf16 v[68:71], a[200:203], v[186:189], v[68:71]
ds_read_b128 v[186:189], v210 offset:1024
v_mfma_f32_16x16x32_bf16 v[68:71], a[204:207], v[220:223], v[68:71]
buffer_store_dwordx2 v[76:77], v203, s[8:11], s39 offen offset:64
v_mfma_f32_16x16x32_bf16 v[36:39], v[174:177], v[84:87], 0
ds_read_b128 v[84:87], v194
v_mfma_f32_16x16x32_bf16 v[60:63], a[156:159], v[220:223], v[60:63]
ds_read_b128 v[220:223], v210 offset:3072
s_waitcnt lgkmcnt(5)
v_mfma_f32_16x16x32_bf16 v[60:63], a[160:163], v[110:113], v[60:63]
s_waitcnt lgkmcnt(4)
v_mfma_f32_16x16x32_bf16 v[60:63], a[164:167], v[170:173], v[60:63]
v_mfma_f32_16x16x32_bf16 v[48:51], v[174:177], v[92:95], 0
ds_read_b128 v[92:95], v195
v_mfma_f32_16x16x32_bf16 v[64:67], a[184:187], v[110:113], v[64:67]
v_cvt_pk_bf16_f32 v116, v60, v61
v_cvt_pk_bf16_f32 v117, v62, v63
v_mfma_f32_16x16x32_bf16 v[64:67], a[188:191], v[170:173], v[64:67]
v_mfma_f32_16x16x32_bf16 v[60:63], v[174:177], v[100:103], 0
ds_read_b128 v[100:103], v196
ds_read_b128 v[174:177], v217 offset:1056
v_mfma_f32_16x16x32_bf16 v[68:71], a[208:211], v[110:113], v[68:71]
ds_read_b128 v[110:113], v210 offset:2048
v_cvt_pk_bf16_f32 v124, v64, v65
v_mfma_f32_16x16x32_bf16 v[68:71], a[212:215], v[170:173], v[68:71]
v_cvt_pk_bf16_f32 v125, v66, v67
s_waitcnt lgkmcnt(5)
v_smfmac_f32_16x16x64_bf16 v[36:39], v[178:181], v[84:91], v213
s_waitcnt lgkmcnt(3)
ds_read_b128 v[84:87], v197
ds_read_b128 v[88:91], v197 offset:16
v_smfmac_f32_16x16x64_bf16 v[48:51], v[178:181], v[92:99], v213
ds_read_b128 v[92:95], v198
ds_read_b128 v[96:99], v198 offset:16
v_mfma_f32_16x16x32_bf16 v[138:141], a[0:3], v[182:185], 0
v_cvt_pk_bf16_f32 v132, v68, v69
v_cvt_pk_bf16_f32 v133, v70, v71
v_mfma_f32_16x16x32_bf16 v[138:141], a[4:7], v[186:189], v[138:141]
s_waitcnt lgkmcnt(6)
v_smfmac_f32_16x16x64_bf16 v[60:63], v[178:181], v[100:107], v213
s_nop 0
ds_read_b128 v[100:103], v199
ds_read_b128 v[104:107], v199 offset:16
v_mfma_f32_16x16x32_bf16 v[142:145], a[24:27], v[182:185], 0
ds_read_b128 v[178:181], v217 offset:1584
buffer_store_dwordx2 v[78:79], v204, s[8:11], s39 offen
v_mfma_f32_16x16x32_bf16 v[142:145], a[28:31], v[186:189], v[142:145]
s_waitcnt lgkmcnt(5)
v_smfmac_f32_16x16x64_bf16 v[36:39], v[174:177], v[84:91], v213
ds_read_b128 v[84:87], v200 offset:32
ds_read_b128 v[88:91], v194 offset:48
v_mfma_f32_16x16x32_bf16 v[146:149], a[48:51], v[182:185], 0
s_waitcnt lgkmcnt(5)
v_smfmac_f32_16x16x64_bf16 v[48:51], v[174:177], v[92:99], v213
ds_read_b128 v[92:95], v201 offset:32
ds_read_b128 v[96:99], v195 offset:48
v_mfma_f32_16x16x32_bf16 v[146:149], a[52:55], v[186:189], v[146:149]
s_waitcnt lgkmcnt(5)
v_mul_f32 v119, v36, v36
v_add_f32_e64 v118, v36, v37
v_smfmac_f32_16x16x64_bf16 v[60:63], v[174:177], v[100:107], v213
ds_read_b128 v[100:103], v202 offset:32
ds_read_b128 v[174:177], v217 offset:2112
v_mfma_f32_16x16x32_bf16 v[150:153], a[216:219], v[182:185], 0
ds_read_b128 v[104:107], v196 offset:48
v_mul_f32_e64 v127, v48, v48
v_mfma_f32_16x16x32_bf16 v[150:153], a[220:223], v[186:189], v[150:153]
s_waitcnt lgkmcnt(6)
v_mul_f32 v135, v60, v60
v_add_f32_e64 v134, v60, v61
v_mfma_f32_16x16x32_bf16 v[40:43], v[178:181], v[84:87], 0
ds_read_b128 v[84:87], v194 offset:32
v_fmac_f32_e64 v135, v61, v61
v_mfma_f32_16x16x32_bf16 v[154:157], a[240:243], v[182:185], 0
s_waitcnt lgkmcnt(5)
v_add_f32 v126, v48, v49
v_fmac_f32_e64 v119, v37, v37
v_mfma_f32_16x16x32_bf16 v[52:55], v[178:181], v[92:95], 0
ds_read_b128 v[92:95], v195 offset:32
v_fmac_f32_e64 v127, v49, v49
v_mfma_f32_16x16x32_bf16 v[154:157], a[244:247], v[186:189], v[154:157]
s_waitcnt lgkmcnt(4)
v_add_f32 v134, v134, v62
v_fmac_f32_e64 v135, v62, v62
v_mfma_f32_16x16x32_bf16 v[64:67], v[178:181], v[100:103], 0
ds_read_b128 v[100:103], v196 offset:32
ds_read_b128 v[178:181], v217 offset:2640
v_mfma_f32_16x16x32_bf16 v[158:161], v[232:235], v[182:185], 0
v_add_f32 v118, v118, v38
v_add_f32 v126, v126, v50
v_mfma_f32_16x16x32_bf16 v[158:161], v[236:239], v[186:189], v[158:161]
s_waitcnt lgkmcnt(3)
v_fmac_f32 v119, v38, v38
v_fmac_f32_e64 v127, v50, v50
v_smfmac_f32_16x16x64_bf16 v[40:43], v[174:177], v[84:91], v213
s_nop 0
ds_read_b128 v[84:87], v197 offset:32
ds_read_b128 v[88:91], v197 offset:48
v_mfma_f32_16x16x32_bf16 v[162:165], v[182:185], a[72:75], 0
s_waitcnt lgkmcnt(4)
buffer_store_dwordx2 v[80:81], v204, s[8:11], s39 offen offset:32
v_add_f32 v134, v134, v63
v_smfmac_f32_16x16x64_bf16 v[52:55], v[174:177], v[92:99], v213
s_waitcnt lgkmcnt(3)
ds_read_b128 v[92:95], v198 offset:32
ds_read_b128 v[96:99], v198 offset:48
v_smfmac_f32_16x16x64_bf16 v[64:67], v[174:177], v[100:107], v213
ds_read_b128 v[100:103], v199 offset:32
ds_read_b128 v[104:107], v199 offset:48
v_mfma_f32_16x16x32_bf16 v[162:165], v[186:189], a[76:79], v[162:165]
ds_read_b128 v[174:177], v217 offset:3168
v_fmac_f32_e64 v135, v63, v63
v_mfma_f32_16x16x32_bf16 v[166:169], v[182:185], a[96:99], 0
v_add_f32 v118, v118, v39
v_add_f32 v126, v126, v51
v_mfma_f32_16x16x32_bf16 v[166:169], v[186:189], a[100:103], v[166:169]
s_waitcnt lgkmcnt(5)
v_fmac_f32 v119, v39, v39
v_fmac_f32_e64 v127, v51, v51
v_smfmac_f32_16x16x64_bf16 v[40:43], v[178:181], v[84:91], v213
ds_read_b128 v[84:87], v200 offset:64
ds_read_b128 v[88:91], v194 offset:80
v_mfma_f32_16x16x32_bf16 v[170:173], v[182:185], a[120:123], 0
ds_read_b128 v[182:185], v210 offset:4096
s_waitcnt lgkmcnt(6)
v_smfmac_f32_16x16x64_bf16 v[52:55], v[178:181], v[92:99], v213
ds_read_b128 v[92:95], v201 offset:64
ds_read_b128 v[96:99], v195 offset:80
v_mfma_f32_16x16x32_bf16 v[170:173], v[186:189], a[124:127], v[170:173]
s_waitcnt vmcnt(5)
ds_read_b128 v[186:189], v210 offset:5120
s_mov_b64 exec, s[30:31]
ds_write_b32 v209, v216 offset:39424
s_mov_b64 exec, -1
s_waitcnt lgkmcnt(8)
v_smfmac_f32_16x16x64_bf16 v[64:67], v[178:181], v[100:107], v213
s_nop 0
ds_read_b128 v[100:103], v202 offset:64
ds_read_b128 v[178:181], v217 offset:3696
v_mfma_f32_16x16x32_bf16 v[138:141], a[8:11], v[110:113], v[138:141]
ds_read_b128 v[104:107], v196 offset:80
v_add_f32_e64 v118, v118, v40
v_mfma_f32_16x16x32_bf16 v[138:141], a[12:15], v[220:223], v[138:141]
s_waitcnt lgkmcnt(9)
v_add_f32 v134, v134, v64
v_fmac_f32_e64 v135, v64, v64
v_mfma_f32_16x16x32_bf16 v[44:47], v[174:177], v[84:87], 0
ds_read_b128 v[84:87], v194 offset:64
buffer_store_dwordx2 v[82:83], v204, s[8:11], s39 offen offset:64
v_fmac_f32_e64 v119, v40, v40
v_mfma_f32_16x16x32_bf16 v[142:145], a[32:35], v[110:113], v[142:145]
v_add_f32 v126, v126, v52
v_fmac_f32 v127, v52, v52
v_mfma_f32_16x16x32_bf16 v[142:145], a[36:39], v[220:223], v[142:145]
s_waitcnt lgkmcnt(7)
v_add_f32 v134, v134, v65
v_fmac_f32_e64 v135, v65, v65
v_mfma_f32_16x16x32_bf16 v[56:59], v[174:177], v[92:95], 0
ds_read_b128 v[92:95], v195 offset:64
v_add_f32_e64 v118, v118, v41
v_mfma_f32_16x16x32_bf16 v[146:149], a[56:59], v[110:113], v[146:149]
v_fmac_f32 v119, v41, v41
v_add_f32 v126, v126, v53
v_mfma_f32_16x16x32_bf16 v[146:149], a[60:63], v[220:223], v[146:149]
s_waitcnt lgkmcnt(4)
v_fmac_f32 v127, v53, v53
v_add_f32_e64 v134, v134, v66
v_mfma_f32_16x16x32_bf16 v[68:71], v[174:177], v[100:103], 0
ds_read_b128 v[100:103], v196 offset:64
ds_read_b128 v[174:177], v217 offset:4224
v_mfma_f32_16x16x32_bf16 v[150:153], a[224:227], v[110:113], v[150:153]
v_fmac_f32 v135, v66, v66
v_add_f32 v118, v118, v42
v_mfma_f32_16x16x32_bf16 v[150:153], a[228:231], v[220:223], v[150:153]
s_waitcnt lgkmcnt(3)
v_fmac_f32 v119, v42, v42
v_add_f32 v126, v126, v54
v_smfmac_f32_16x16x64_bf16 v[44:47], v[178:181], v[84:91], v213
s_waitcnt lgkmcnt(2)
ds_read_b128 v[84:87], v197 offset:64
ds_read_b128 v[88:91], v197 offset:80
v_smfmac_f32_16x16x64_bf16 v[56:59], v[178:181], v[92:99], v213
ds_read_b128 v[92:95], v198 offset:64
ds_read_b128 v[96:99], v198 offset:80
v_mfma_f32_16x16x32_bf16 v[154:157], a[248:251], v[110:113], v[154:157]
v_fmac_f32 v127, v54, v54
v_add_f32 v134, v134, v67
v_mfma_f32_16x16x32_bf16 v[154:157], a[252:255], v[220:223], v[154:157]
s_waitcnt lgkmcnt(5)
v_fmac_f32 v135, v67, v67
v_add_f32_e64 v118, v118, v43
v_smfmac_f32_16x16x64_bf16 v[68:71], v[178:181], v[100:107], v213
ds_read_b128 v[100:103], v199 offset:64
ds_read_b128 v[104:107], v199 offset:80
v_mfma_f32_16x16x32_bf16 v[158:161], v[240:243], v[110:113], v[158:161]
v_fmac_f32 v119, v43, v43
v_add_f32 v126, v126, v55
v_mfma_f32_16x16x32_bf16 v[158:161], v[244:247], v[220:223], v[158:161]
v_fmac_f32 v127, v55, v55
s_waitcnt lgkmcnt(4)
v_smfmac_f32_16x16x64_bf16 v[44:47], v[174:177], v[84:91], v213
buffer_store_dwordx2 v[116:117], v205, s[8:11], s39 offen
v_mfma_f32_16x16x32_bf16 v[162:165], v[110:113], a[80:83], v[162:165]
v_mfma_f32_16x16x32_bf16 v[162:165], v[220:223], a[84:87], v[162:165]
v_add_f32 v118, v118, v44
v_fmac_f32 v119, v44, v44
v_mfma_f32_16x16x32_bf16 v[166:169], v[110:113], a[104:107], v[166:169]
v_add_f32 v118, v118, v45
v_fmac_f32 v119, v45, v45
v_mfma_f32_16x16x32_bf16 v[166:169], v[220:223], a[108:111], v[166:169]
s_waitcnt lgkmcnt(2)
v_add_f32 v118, v118, v46
v_fmac_f32_e64 v119, v46, v46
v_smfmac_f32_16x16x64_bf16 v[56:59], v[174:177], v[92:99], v213
v_add_f32_e64 v118, v118, v47
v_mfma_f32_16x16x32_bf16 v[170:173], v[110:113], a[128:131], v[170:173]
ds_read_b128 v[110:113], v210 offset:6144
v_fmac_f32 v119, v47, v47
v_mfma_f32_16x16x32_bf16 v[170:173], v[220:223], a[132:135], v[170:173]
s_waitcnt lgkmcnt(1)
ds_read_b128 v[220:223], v210 offset:7168
v_add_f32_e64 v126, v126, v56
v_smfmac_f32_16x16x64_bf16 v[68:71], v[174:177], v[100:107], v213
v_fmac_f32_e64 v127, v56, v56
v_mfma_f32_16x16x32_bf16 v[138:141], a[16:19], v[182:185], v[138:141]
v_add_f32 v126, v126, v57
v_fmac_f32 v127, v57, v57
v_mfma_f32_16x16x32_bf16 v[138:141], a[20:23], v[186:189], v[138:141]
v_add_f32 v134, v134, v68
v_fmac_f32 v135, v68, v68
v_mfma_f32_16x16x32_bf16 v[142:145], a[40:43], v[182:185], v[142:145]
v_add_f32 v134, v134, v69
v_fmac_f32 v135, v69, v69
v_mfma_f32_16x16x32_bf16 v[142:145], a[44:47], v[186:189], v[142:145]
v_cvt_pk_bf16_f32 v78, v138, v139
v_cvt_pk_bf16_f32 v79, v140, v141
v_mfma_f32_16x16x32_bf16 v[146:149], a[64:67], v[182:185], v[146:149]
v_add_f32 v134, v134, v70
v_fmac_f32 v135, v70, v70
v_mfma_f32_16x16x32_bf16 v[146:149], a[68:71], v[186:189], v[146:149]
v_cvt_pk_bf16_f32 v80, v142, v143
v_cvt_pk_bf16_f32 v81, v144, v145
v_mfma_f32_16x16x32_bf16 v[150:153], a[232:235], v[182:185], v[150:153]
v_add_f32 v126, v126, v58
v_fmac_f32 v127, v58, v58
v_mfma_f32_16x16x32_bf16 v[150:153], a[236:239], v[186:189], v[150:153]
v_cvt_pk_bf16_f32 v82, v146, v147
v_cvt_pk_bf16_f32 v83, v148, v149
v_mfma_f32_16x16x32_bf16 v[154:157], v[224:227], v[182:185], v[154:157]
buffer_store_dwordx2 v[124:125], v205, s[8:11], s39 offen offset:32
v_add_f32_e64 v134, v134, v71
v_mfma_f32_16x16x32_bf16 v[154:157], v[228:231], v[186:189], v[154:157]
v_cvt_pk_bf16_f32 v72, v150, v151
v_cvt_pk_bf16_f32 v73, v152, v153
v_mfma_f32_16x16x32_bf16 v[158:161], v[248:251], v[182:185], v[158:161]
v_fmac_f32 v135, v71, v71
v_add_f32 v126, v126, v59
v_mfma_f32_16x16x32_bf16 v[158:161], v[252:255], v[186:189], v[158:161]
v_cvt_pk_bf16_f32 v74, v154, v155
v_cvt_pk_bf16_f32 v75, v156, v157
v_mfma_f32_16x16x32_bf16 v[162:165], v[182:185], a[88:91], v[162:165]
v_fmac_f32 v127, v59, v59
v_permlane16_swap_b32 v134, v135
v_mfma_f32_16x16x32_bf16 v[162:165], v[186:189], a[92:95], v[162:165]
v_cvt_pk_bf16_f32 v76, v158, v159
v_cvt_pk_bf16_f32 v77, v160, v161
v_mfma_f32_16x16x32_bf16 v[166:169], v[182:185], a[112:115], v[166:169]
s_nop 0
v_permlane16_swap_b32 v118, v119
v_mfma_f32_16x16x32_bf16 v[166:169], v[186:189], a[116:119], v[166:169]
v_cvt_pk_bf16_f32 v114, v162, v163
v_cvt_pk_bf16_f32 v115, v164, v165
v_mfma_f32_16x16x32_bf16 v[170:173], v[182:185], a[136:139], v[170:173]
ds_read_b128 v[182:185], v210 offset:8192
v_add_f32 v134, v134, v135
v_mfma_f32_16x16x32_bf16 v[170:173], v[186:189], a[140:143], v[170:173]
s_waitcnt lgkmcnt(2)
ds_read_b128 v[186:189], v210 offset:9216
v_cvt_pk_bf16_f32 v122, v166, v167
v_mfma_f32_16x16x32_bf16 v[138:141], a[0:3], v[110:113], 0
s_waitcnt lgkmcnt(2)
v_permlane16_swap_b32 v126, v127
v_mfma_f32_16x16x32_bf16 v[138:141], a[4:7], v[220:223], v[138:141]
v_cvt_pk_bf16_f32 v123, v168, v169
v_add_f32_e64 v118, v118, v119
v_mfma_f32_16x16x32_bf16 v[142:145], a[24:27], v[110:113], 0
v_mov_b32 v135, v134
v_add_f32 v126, v126, v127
v_mfma_f32_16x16x32_bf16 v[142:145], a[28:31], v[220:223], v[142:145]
v_permlane32_swap_b32 v134, v135
v_mfma_f32_16x16x32_bf16 v[146:149], a[48:51], v[110:113], 0
v_permlane32_swap_b32 v118, v126
v_mfma_f32_16x16x32_bf16 v[146:149], a[52:55], v[220:223], v[146:149]
v_cvt_pk_bf16_f32 v130, v170, v171
v_cvt_pk_bf16_f32 v131, v172, v173
v_mfma_f32_16x16x32_bf16 v[150:153], a[216:219], v[110:113], 0
v_add_f32 v134, v134, v135
v_add_f32 v118, v118, v126
v_mfma_f32_16x16x32_bf16 v[150:153], a[220:223], v[220:223], v[150:153]
ds_write_b32 v209, v134 offset:512
v_mfma_f32_16x16x32_bf16 v[154:157], a[240:243], v[110:113], 0
ds_write_b32 v209, v118
v_mfma_f32_16x16x32_bf16 v[154:157], a[244:247], v[220:223], v[154:157]
v_mfma_f32_16x16x32_bf16 v[158:161], v[232:235], v[110:113], 0
v_mfma_f32_16x16x32_bf16 v[158:161], v[236:239], v[220:223], v[158:161]
v_mfma_f32_16x16x32_bf16 v[162:165], v[110:113], a[72:75], 0
v_mfma_f32_16x16x32_bf16 v[162:165], v[220:223], a[76:79], v[162:165]
s_waitcnt lgkmcnt(0)
s_barrier
v_mfma_f32_16x16x32_bf16 v[166:169], v[110:113], a[96:99], 0
ds_read_b32 v216, v210 offset:57856
ds_read_b128 v[102:105], v210 offset:18432
v_mfma_f32_16x16x32_bf16 v[166:169], v[220:223], a[100:103], v[166:169]
ds_read_b128 v[106:109], v210 offset:19456
v_mfma_f32_16x16x32_bf16 v[170:173], v[110:113], a[120:123], 0
s_nop 0
ds_read_b128 v[110:113], v210 offset:10240
v_mfma_f32_16x16x32_bf16 v[170:173], v[220:223], a[124:127], v[170:173]
s_waitcnt lgkmcnt(3)
v_readfirstlane_b32 s97, v216
s_nop 0
s_and_b32 s97, s97, 255
s_add_u32 s97, s97, 5120
s_cmp_lt_u32 s97, s34
s_cbranch_scc0 L_tailb
v_mfma_f32_16x16x32_bf16 v[138:141], a[8:11], v[182:185], v[138:141]
s_mov_b32 s35, s97
s_waitcnt lgkmcnt(2)
v_add_f32 v102, v102, v103
s_waitcnt lgkmcnt(1)
v_add_f32_e64 v106, v106, v107
v_mfma_f32_16x16x32_bf16 v[138:141], a[12:15], v[186:189], v[138:141]
s_mul_hi_u32 s41, s35, 58835169
v_add_f32 v104, v104, v105
v_add_f32 v108, v108, v109
v_mfma_f32_16x16x32_bf16 v[142:145], a[32:35], v[182:185], v[142:145]
s_mul_i32 s42, s41, 73
v_add_f32 v102, v102, v104
v_add_f32 v106, v106, v108
v_mfma_f32_16x16x32_bf16 v[142:145], a[36:39], v[186:189], v[142:145]
s_sub_u32 s42, s35, s42
v_mul_f32 v103, s48, v102
v_mul_f32_e64 v104, s73, v102
v_mfma_f32_16x16x32_bf16 v[146:149], a[56:59], v[182:185], v[146:149]
s_mul_i32 s43, s41, 1373568
v_mul_f32_e64 v106, s73, v106
v_fma_f32 v106, -v103, v104, v106
v_mfma_f32_16x16x32_bf16 v[146:149], a[60:63], v[186:189], v[146:149]
s_mul_i32 s51, s42, 2688
v_max_f32_e64 v106, 0, v106
v_add_f32 v106, s49, v106
v_mfma_f32_16x16x32_bf16 v[150:153], a[224:227], v[182:185], v[150:153]
s_add_u32 s43, s43, s51
v_rsq_f32 v102, v106
v_mfma_f32_16x16x32_bf16 v[150:153], a[228:231], v[186:189], v[150:153]
s_cmp_lt_u32 s35, s34
ds_read_b128 v[106:109], v210 offset:11264
buffer_store_dwordx2 v[132:133], v205, s[8:11], s39 offen offset:64
v_mul_f32_e64 v103, -v103, v102
v_mfma_f32_16x16x32_bf16 v[154:157], a[248:251], v[182:185], v[154:157]
s_cselect_b32 s50, s43, 1879048192
ds_write_b64 v211, v[102:103] offset:20480
v_mfma_f32_16x16x32_bf16 v[154:157], a[252:255], v[186:189], v[154:157]
s_add_u32 s35, s35, 32
s_cmp_eq_u32 s42, 0
s_cselect_b32 s44, 536870911, s72
v_mfma_f32_16x16x32_bf16 v[158:161], v[240:243], v[182:185], v[158:161]
s_cmp_eq_u32 s42, 72
ds_read_b64 v[118:119], v219 offset:20480
ds_read_b64 v[126:127], v219 offset:20736
v_mfma_f32_16x16x32_bf16 v[158:161], v[244:247], v[186:189], v[158:161]
s_cselect_b32 s44, 939524095, s44
v_and_b32_e64 v216, s44, v208
s_cmp_eq_u32 s41, 0
v_mfma_f32_16x16x32_bf16 v[162:165], v[182:185], a[80:83], v[162:165]
s_cselect_b32 s52, 1879048192, s50
ds_read_b64 v[134:135], v219 offset:20992
s_add_u32 m0, s45, 0
v_mfma_f32_16x16x32_bf16 v[162:165], v[186:189], a[84:87], v[162:165]
s_mov_b32 s36, s50
s_mov_b32 s39, s37
s_mul_i32 s41, s32, 192
v_mfma_f32_16x16x32_bf16 v[166:169], v[182:185], a[104:107], v[166:169]
s_mov_b32 s30, 65537
s_mov_b32 s31, 65537
s_mov_b32 s42, 58835169
v_mfma_f32_16x16x32_bf16 v[166:169], v[186:189], a[108:111], v[166:169]
s_waitcnt lgkmcnt(2)
v_fma_f32 v220, v36, v118, v119
v_fma_f32 v221, v37, v118, v119
v_mfma_f32_16x16x32_bf16 v[170:173], v[182:185], a[128:131], v[170:173]
s_nop 0
ds_read_b128 v[182:185], v210 offset:12288
v_fma_f32 v222, v38, v118, v119
v_mfma_f32_16x16x32_bf16 v[170:173], v[186:189], a[132:135], v[170:173]
ds_read_b128 v[186:189], v210 offset:13312
v_fma_f32 v223, v39, v118, v119
v_mfma_f32_16x16x32_bf16 v[138:141], a[16:19], v[110:113], v[138:141]
v_cvt_pk_bf16_f32 v90, v220, v221
v_cvt_pk_bf16_f32 v91, v222, v223
v_mfma_f32_16x16x32_bf16 v[138:141], a[20:23], v[106:109], v[138:141]
buffer_load_dwordx4 v216, s[4:7], s52 offen nt lds
v_mfma_f32_16x16x32_bf16 v[142:145], a[40:43], v[110:113], v[142:145]
s_add_u32 m0, s45, 4112
v_fma_f32 v220, v40, v118, v119
v_fma_f32 v221, v41, v118, v119
v_mfma_f32_16x16x32_bf16 v[142:145], a[44:47], v[106:109], v[142:145]
s_add_u32 s40, s36, 196224
v_cvt_pk_bf16_f32 v96, v138, v139
v_cvt_pk_bf16_f32 v97, v140, v141
v_mfma_f32_16x16x32_bf16 v[146:149], a[64:67], v[110:113], v[146:149]
v_fma_f32 v222, v42, v118, v119
v_fma_f32 v223, v43, v118, v119
v_mfma_f32_16x16x32_bf16 v[146:149], a[68:71], v[106:109], v[146:149]
v_cvt_pk_bf16_f32 v92, v220, v221
v_cvt_pk_bf16_f32 v93, v222, v223
v_mfma_f32_16x16x32_bf16 v[150:153], a[232:235], v[110:113], v[150:153]
v_fma_f32 v220, v44, v118, v119
v_fma_f32 v221, v45, v118, v119
v_mfma_f32_16x16x32_bf16 v[150:153], a[236:239], v[106:109], v[150:153]
v_cvt_pk_bf16_f32 v100, v146, v147
v_cvt_pk_bf16_f32 v101, v148, v149
v_mfma_f32_16x16x32_bf16 v[154:157], v[224:227], v[110:113], v[154:157]
v_fma_f32 v222, v46, v118, v119
v_fma_f32 v223, v47, v118, v119
v_mfma_f32_16x16x32_bf16 v[154:157], v[228:231], v[106:109], v[154:157]
buffer_load_dwordx4 v216, s[4:7], s40 offen nt lds
v_mfma_f32_16x16x32_bf16 v[158:161], v[248:251], v[110:113], v[158:161]
s_add_u32 m0, s45, 8224
ds_write_b128 v211, v[90:93] offset:20480
v_mfma_f32_16x16x32_bf16 v[158:161], v[252:255], v[106:109], v[158:161]
s_add_u32 s40, s36, 392448
v_cvt_pk_bf16_f32 v94, v220, v221
v_cvt_pk_bf16_f32 v95, v222, v223
v_mfma_f32_16x16x32_bf16 v[162:165], v[110:113], a[88:91], v[162:165]
s_waitcnt lgkmcnt(4)
v_fma_f32 v220, v48, v126, v127
v_fma_f32 v221, v49, v126, v127
v_mfma_f32_16x16x32_bf16 v[162:165], v[106:109], a[92:95], v[162:165]
s_nop 0
v_fma_f32 v222, v50, v126, v127
v_fma_f32 v223, v51, v126, v127
v_mfma_f32_16x16x32_bf16 v[166:169], v[110:113], a[112:115], v[166:169]
v_cvt_pk_bf16_f32 v98, v142, v143
v_cvt_pk_bf16_f32 v99, v144, v145
v_mfma_f32_16x16x32_bf16 v[166:169], v[106:109], a[116:119], v[166:169]
s_nop 0
v_cvt_pk_bf16_f32 v174, v220, v221
v_cvt_pk_bf16_f32 v175, v222, v223
v_mfma_f32_16x16x32_bf16 v[170:173], v[110:113], a[136:139], v[170:173]
s_waitcnt lgkmcnt(1)
buffer_load_dwordx4 v216, s[4:7], s40 offen nt lds
v_mfma_f32_16x16x32_bf16 v[170:173], v[106:109], a[140:143], v[170:173]
s_add_u32 m0, s45, 12336
ds_read_b64 v[112:113], v215 offset:528
ds_read_b128 v[108:111], v215 offset:512
v_mfma_f32_16x16x32_bf16 v[138:141], a[0:3], v[182:185], 0
s_add_u32 s40, s36, 588672
v_cvt_pk_bf16_f32 v84, v150, v151
v_cvt_pk_bf16_f32 v85, v152, v153
v_mfma_f32_16x16x32_bf16 v[138:141], a[4:7], v[186:189], v[138:141]
v_cvt_pk_bf16_f32 v132, v170, v171
v_cvt_pk_bf16_f32 v133, v172, v173
v_mfma_f32_16x16x32_bf16 v[142:145], a[24:27], v[182:185], 0
ds_read_b128 v[170:173], v210 offset:14336
v_fma_f32 v220, v52, v126, v127
v_mfma_f32_16x16x32_bf16 v[142:145], a[28:31], v[186:189], v[142:145]
v_fma_f32 v221, v53, v126, v127
v_fma_f32 v222, v54, v126, v127
v_mfma_f32_16x16x32_bf16 v[146:149], a[48:51], v[182:185], 0
s_nop 0
ds_read_b128 v[182:185], v210 offset:15360
v_fma_f32 v223, v55, v126, v127
v_mfma_f32_16x16x32_bf16 v[146:149], a[52:55], v[186:189], v[146:149]
s_waitcnt lgkmcnt(2)
ds_read_b128 v[186:189], v210 offset:16384
v_cvt_pk_bf16_f32 v176, v220, v221
v_cvt_pk_bf16_f32 v177, v222, v223
v_mfma_f32_16x16x16_bf16 v[150:153], v[112:113], v[76:77], v[206:209]
v_fma_f32 v220, v56, v126, v127
v_fma_f32 v221, v57, v126, v127
v_fma_f32 v222, v58, v126, v127
v_fma_f32 v223, v59, v126, v127
v_cvt_pk_bf16_f32 v178, v220, v221
v_cvt_pk_bf16_f32 v179, v222, v223
v_mfma_f32_16x16x32_bf16 v[150:153], v[108:111], v[72:75], v[150:153]
s_waitcnt lgkmcnt(2)
buffer_load_dwordx4 v216, s[4:7], s40 offen nt lds
v_mfma_f32_16x16x32_bf16 v[138:141], a[8:11], v[170:173], v[138:141]
s_add_u32 m0, s45, 16448
ds_write_b128 v211, v[174:177] offset:26624
s_waitcnt lgkmcnt(2)
v_mfma_f32_16x16x32_bf16 v[138:141], a[12:15], v[182:185], v[138:141]
v_cvt_pk_bf16_f32 v88, v158, v159
v_cvt_pk_bf16_f32 v89, v160, v161
v_mfma_f32_16x16x32_bf16 v[142:145], a[32:35], v[170:173], v[142:145]
s_add_u32 s40, s36, 784896
v_cvt_pk_bf16_f32 v86, v154, v155
v_cvt_pk_bf16_f32 v87, v156, v157
v_mfma_f32_16x16x32_bf16 v[142:145], a[36:39], v[182:185], v[142:145]
ds_write_b64 v212, v[178:179] offset:26624
v_mfma_f32_16x16x16_bf16 v[154:157], v[82:83], v[88:89], 0
buffer_load_dwordx4 v216, s[4:7], s40 offen nt lds
v_cvt_pk_bf16_f32 v124, v166, v167
v_mfma_f32_16x16x16_bf16 v[158:161], v[100:101], v[88:89], 0
v_exp_f32 v150, v150
v_cvt_pk_bf16_f32 v125, v168, v169
v_mfma_f32_16x16x16_bf16 v[166:169], v[112:113], v[88:89], v[206:209]
s_waitcnt lgkmcnt(2)
ds_read_b128 v[174:177], v210 offset:14336
ds_read_b128 v[178:181], v210 offset:15360
ds_write_b64 v212, v[94:95] offset:20480
v_mfma_f32_16x16x32_bf16 v[146:149], a[56:59], v[170:173], v[146:149]
s_add_u32 m0, s45, 20560
v_fma_f32 v220, v60, v134, v135
v_fma_f32 v221, v61, v134, v135
v_mfma_f32_16x16x32_bf16 v[146:149], a[60:63], v[182:185], v[146:149]
s_add_u32 s40, s36, 981120
ds_read_b128 v[182:185], v210 offset:12288
ds_read_b128 v[170:173], v210 offset:17408
v_mfma_f32_16x16x32_bf16 v[138:141], a[16:19], v[186:189], v[138:141]
v_fma_f32 v222, v62, v134, v135
v_fma_f32 v223, v63, v134, v135
v_mfma_f32_16x16x32_bf16 v[142:145], a[40:43], v[186:189], v[142:145]
v_cvt_pk_bf16_f32 v116, v162, v163
v_cvt_pk_bf16_f32 v117, v164, v165
v_mfma_f32_16x16x32_bf16 v[154:157], v[78:81], v[84:87], v[154:157]
buffer_load_dwordx4 v216, s[4:7], s40 offen nt lds
v_mfma_f32_16x16x32_bf16 v[146:149], a[64:67], v[186:189], v[146:149]
s_add_u32 m0, s45, 24672
ds_read_b128 v[186:189], v210 offset:13312
v_cvt_pk_bf16_f32 v90, v220, v221
v_mfma_f32_16x16x32_bf16 v[158:161], v[96:99], v[84:87], v[158:161]
s_add_u32 s40, s36, 1177344
v_exp_f32 v154, v154
v_mfma_f32_16x16x32_bf16 v[166:169], v[108:111], v[84:87], v[166:169]
v_exp_f32 v155, v155
v_exp_f32 v156, v156
s_waitcnt lgkmcnt(2)
v_mfma_f32_16x16x32_bf16 v[118:121], v[182:185], a[72:75], 0
v_exp_f32 v157, v157
v_mfma_f32_16x16x32_bf16 v[126:129], v[182:185], a[96:99], 0
s_waitcnt lgkmcnt(1)
v_exp_f32 v158, v158
v_mfma_f32_16x16x32_bf16 v[138:141], a[20:23], v[170:173], v[138:141]
s_waitcnt lgkmcnt(0)
v_exp_f32_e64 v159, v159
v_mfma_f32_16x16x32_bf16 v[118:121], v[186:189], a[76:79], v[118:121]
buffer_load_dwordx4 v216, s[4:7], s40 offen nt lds
v_mfma_f32_16x16x32_bf16 v[126:129], v[186:189], a[100:103], v[126:129]
s_add_u32 m0, s45, 28784
v_cvt_pk_bf16_f32 v102, v138, v139
v_cvt_pk_bf16_f32 v103, v140, v141
v_cvt_pk_bf16_f32 v91, v222, v223
v_mfma_f32_16x16x16_bf16 v[138:141], v[82:83], v[76:77], 0
v_exp_f32 v160, v160
v_exp_f32 v161, v161
v_mfma_f32_16x16x32_bf16 v[142:145], a[44:47], v[170:173], v[142:145]
s_add_u32 s40, s36, 1373568
v_exp_f32_e64 v166, v166
v_mfma_f32_16x16x32_bf16 v[138:141], v[78:81], v[72:75], v[138:141]
v_fma_f32 v220, v64, v134, v135
v_fma_f32 v221, v65, v134, v135
v_mfma_f32_16x16x32_bf16 v[146:149], a[68:71], v[170:173], v[146:149]
v_cvt_pk_bf16_f32 v104, v142, v143
v_cvt_pk_bf16_f32 v105, v144, v145
v_fma_f32 v222, v66, v134, v135
v_mfma_f32_16x16x16_bf16 v[142:145], v[100:101], v[76:77], 0
v_exp_f32 v138, v138
v_exp_f32 v139, v139
v_mfma_f32_16x16x32_bf16 v[170:173], a[240:243], v[182:185], 0
buffer_load_dwordx4 v216, s[4:7], s40 offen nt lds
v_mfma_f32_16x16x32_bf16 v[142:145], v[96:99], v[72:75], v[142:145]
s_add_u32 m0, s45, 32896
v_cvt_pk_bf16_f32 v106, v146, v147
v_cvt_pk_bf16_f32 v107, v148, v149
v_mfma_f32_16x16x32_bf16 v[170:173], a[244:247], v[186:189], v[170:173]
s_add_u32 s40, s36, 1569792
v_exp_f32 v140, v140
v_fma_f32 v223, v67, v134, v135
v_mfma_f32_16x16x16_bf16 v[146:149], v[106:107], v[76:77], 0
v_exp_f32 v141, v141
v_cvt_pk_bf16_f32 v92, v220, v221
v_mfma_f32_16x16x16_bf16 v[162:165], v[106:107], v[88:89], 0
v_exp_f32 v142, v142
v_exp_f32 v143, v143
v_mfma_f32_16x16x32_bf16 v[146:149], v[102:105], v[72:75], v[146:149]
s_add_u32 s41, s41, 127056
v_exp_f32 v144, v144
v_mfma_f32_16x16x32_bf16 v[118:121], v[174:177], a[80:83], v[118:121]
v_exp_f32 v145, v145
v_mfma_f32_16x16x32_bf16 v[118:121], v[178:181], a[84:87], v[118:121]
v_exp_f32 v146, v146
v_mfma_f32_16x16x32_bf16 v[126:129], v[174:177], a[104:107], v[126:129]
buffer_load_dwordx4 v216, s[4:7], s40 offen nt lds
v_mfma_f32_16x16x32_bf16 v[126:129], v[178:181], a[108:111], v[126:129]
v_exp_f32 v147, v147
v_mfma_f32_16x16x32_bf16 v[170:173], a[248:251], v[174:177], v[170:173]
v_exp_f32 v148, v148
v_mfma_f32_16x16x32_bf16 v[170:173], a[252:255], v[178:181], v[170:173]
v_exp_f32 v149, v149
v_mfma_f32_16x16x32_bf16 v[162:165], v[102:105], v[84:87], v[162:165]
v_cvt_pk_bf16_f32 v93, v222, v223
v_fma_f32 v220, v68, v134, v135
v_fma_f32 v221, v69, v134, v135
v_fma_f32 v222, v70, v134, v135
v_fma_f32 v223, v71, v134, v135
v_mfma_f32_16x16x32_bf16 v[134:137], v[182:185], a[120:123], 0
ds_write_b128 v211, v[90:93] offset:32768
v_mfma_f32_16x16x32_bf16 v[134:137], v[186:189], a[124:127], v[134:137]
v_exp_f32 v162, v162
v_mfma_f32_16x16x32_bf16 v[90:93], a[216:219], v[182:185], 0
v_exp_f32 v163, v163
v_mfma_f32_16x16x32_bf16 v[90:93], a[220:223], v[186:189], v[90:93]
v_exp_f32 v164, v164
v_mfma_f32_16x16x32_bf16 v[90:93], a[224:227], v[174:177], v[90:93]
v_exp_f32 v165, v165
v_mfma_f32_16x16x32_bf16 v[90:93], a[228:231], v[178:181], v[90:93]
v_cvt_pk_bf16_f32 v94, v220, v221
v_cvt_pk_bf16_f32 v95, v222, v223
v_mfma_f32_16x16x32_bf16 v[220:223], v[232:235], v[182:185], 0
ds_read_b128 v[182:185], v210 offset:16384
ds_write_b64 v212, v[94:95] offset:32768
v_mfma_f32_16x16x32_bf16 v[220:223], v[236:239], v[186:189], v[220:223]
v_mfma_f32_16x16x32_bf16 v[134:137], v[174:177], a[128:131], v[134:137]
ds_read_b128 v[186:189], v210 offset:17408
ds_read_b64 v[76:77], v215 offset:16
v_mfma_f32_16x16x32_bf16 v[134:137], v[178:181], a[132:135], v[134:137]
ds_read_b128 v[72:75], v215
v_mfma_f32_16x16x32_bf16 v[220:223], v[240:243], v[174:177], v[220:223]
s_nop 0
v_cvt_pk_bf16_f32 v174, v138, v139
v_cvt_pk_bf16_f32 v175, v140, v141
v_mfma_f32_16x16x32_bf16 v[220:223], v[244:247], v[178:181], v[220:223]
s_waitcnt lgkmcnt(4)
v_cvt_pk_bf16_f32 v176, v142, v143
v_cvt_pk_bf16_f32 v177, v144, v145
v_mfma_f32_16x16x32_bf16 v[118:121], v[182:185], a[88:91], v[118:121]
v_cvt_pk_bf16_f32 v180, v150, 0
v_cvt_pk_bf16_f32 v178, v146, v147
v_mfma_f32_16x16x32_bf16 v[126:129], v[182:185], a[112:115], v[126:129]
v_cvt_pk_bf16_f32 v179, v148, v149
v_mov_b32 v181, 0
v_mfma_f32_16x16x32_bf16 v[134:137], v[182:185], a[136:139], v[134:137]
s_waitcnt lgkmcnt(2)
v_mfma_f32_16x16x32_bf16 v[134:137], v[186:189], a[140:143], v[134:137]
v_mfma_f32_16x16x32_bf16 v[118:121], v[186:189], a[92:95], v[118:121]
v_mfma_f32_16x16x32_bf16 v[126:129], v[186:189], a[116:119], v[126:129]
v_cvt_pk_bf16_f32 v134, v134, v135
v_cvt_pk_bf16_f32 v135, v136, v137
v_mfma_f32_16x16x32_bf16 v[90:93], a[232:235], v[182:185], v[90:93]
ds_read_u16 v136, v214 offset:1040
v_cvt_pk_bf16_f32 v118, v118, v119
v_mfma_f32_16x16x32_bf16 v[90:93], a[236:239], v[186:189], v[90:93]
v_cvt_pk_bf16_f32 v119, v120, v121
v_mov_b32_e64 v121, 0
v_mfma_f32_16x16x32_bf16 v[170:173], v[224:227], v[182:185], v[170:173]
ds_read_u16 v120, v214 offset:1024
v_cvt_pk_bf16_f32 v126, v126, v127
v_mfma_f32_16x16x32_bf16 v[170:173], v[228:231], v[186:189], v[170:173]
v_cvt_pk_bf16_f32 v127, v128, v129
v_mov_b32_e64 v129, 0
v_mfma_f32_16x16x32_bf16 v[220:223], v[248:251], v[182:185], v[220:223]
ds_read_u16 v128, v214 offset:1032
v_mov_b32_e64 v137, 0
v_mfma_f32_16x16x32_bf16 v[220:223], v[252:255], v[186:189], v[220:223]
v_cvt_pk_bf16_f32 v90, v90, v91
v_cvt_pk_bf16_f32 v91, v92, v93
v_mfma_f32_16x16x32_bf16 v[150:153], v[190:193], v[174:177], 0
v_cvt_pk_bf16_f32 v92, v170, v171
v_cvt_pk_bf16_f32 v93, v172, v173
v_mfma_f32_16x16x32_bf16 v[150:153], v[190:193], v[178:181], v[150:153]
v_cvt_pk_bf16_f32 v94, v220, v221
v_cvt_pk_bf16_f32 v95, v222, v223
v_mfma_f32_16x16x32_bf16 v[138:141], v[114:117], v[174:177], 0
s_waitcnt lgkmcnt(1)
v_mfma_f32_16x16x32_bf16 v[138:141], v[118:121], v[178:181], v[138:141]
v_rcp_f32_e64 v151, v150
v_mfma_f32_16x16x32_bf16 v[142:145], v[122:125], v[174:177], 0
s_waitcnt lgkmcnt(0)
v_max3_u32 v218, v218, v150, v151
v_mul_f32_e64 v151, s3, v151
v_mfma_f32_16x16x32_bf16 v[142:145], v[126:129], v[178:181], v[142:145]
v_mul_f32 v138, v138, v151
v_mul_f32 v139, v139, v151
v_mfma_f32_16x16x32_bf16 v[146:149], v[130:133], v[174:177], 0
v_cvt_pk_bf16_f32 v174, v154, v155
v_cvt_pk_bf16_f32 v175, v156, v157
v_mfma_f32_16x16x32_bf16 v[146:149], v[134:137], v[178:181], v[146:149]
v_cvt_pk_bf16_f32 v176, v158, v159
v_cvt_pk_bf16_f32 v177, v160, v161
v_cvt_pk_bf16_f32 v180, v166, 0
v_cvt_pk_bf16_f32 v178, v162, v163
v_mfma_f32_16x16x32_bf16 v[166:169], v[190:193], v[174:177], 0
v_cvt_pk_bf16_f32 v179, v164, v165
v_mul_f32 v140, v140, v151
v_mul_f32 v141, v141, v151
v_mfma_f32_16x16x32_bf16 v[166:169], v[190:193], v[178:181], v[166:169]
v_cvt_pk_bf16_f32 v138, v138, v139
v_mul_f32_e64 v142, v142, v151
v_mfma_f32_16x16x32_bf16 v[154:157], v[114:117], v[174:177], 0
v_mul_f32 v143, v143, v151
v_mul_f32 v144, v144, v151
v_mfma_f32_16x16x32_bf16 v[154:157], v[118:121], v[178:181], v[154:157]
v_mul_f32_e64 v145, v145, v151
v_cvt_pk_bf16_f32 v139, v140, v141
v_mfma_f32_16x16x32_bf16 v[158:161], v[122:125], v[174:177], 0
v_cvt_pk_bf16_f32 v140, v142, v143
v_cvt_pk_bf16_f32 v141, v144, v145
v_mfma_f32_16x16x32_bf16 v[158:161], v[126:129], v[178:181], v[158:161]
ds_write_b128 v211, v[138:141] offset:38912
v_mfma_f32_16x16x32_bf16 v[162:165], v[130:133], v[174:177], 0
v_mul_f32 v146, v146, v151
v_mul_f32 v147, v147, v151
v_mfma_f32_16x16x32_bf16 v[162:165], v[134:137], v[178:181], v[162:165]
v_mul_f32 v148, v148, v151
v_mul_f32 v149, v149, v151
v_cvt_pk_bf16_f32 v142, v146, v147
v_mfma_f32_16x16x16_bf16 v[138:141], v[82:83], v[94:95], 0
v_cvt_pk_bf16_f32 v143, v148, v149
v_rcp_f32_e64 v167, v166
v_mfma_f32_16x16x16_bf16 v[150:153], v[112:113], v[94:95], v[206:209]
v_max3_u32 v218, v218, v166, v167
v_mul_f32 v167, s3, v167
v_mul_f32 v154, v154, v167
v_mfma_f32_16x16x16_bf16 v[146:149], v[106:107], v[94:95], 0
v_mul_f32 v155, v155, v167
v_mul_f32 v156, v156, v167
v_mul_f32_e64 v157, v157, v167
v_cvt_pk_bf16_f32 v154, v154, v155
v_mfma_f32_16x16x32_bf16 v[138:141], v[78:81], v[90:93], v[138:141]
ds_write_b64 v212, v[142:143] offset:38912
v_mfma_f32_16x16x16_bf16 v[142:145], v[100:101], v[94:95], 0
v_mul_f32 v158, v158, v167
v_mul_f32 v159, v159, v167
v_mul_f32 v160, v160, v167
v_mul_f32 v161, v161, v167
v_mfma_f32_16x16x32_bf16 v[150:153], v[108:111], v[90:93], v[150:153]
v_cvt_pk_bf16_f32 v155, v156, v157
v_cvt_pk_bf16_f32 v156, v158, v159
v_mfma_f32_16x16x32_bf16 v[142:145], v[96:99], v[90:93], v[142:145]
v_cvt_pk_bf16_f32 v157, v160, v161
v_mul_f32_e64 v162, v162, v167
v_mfma_f32_16x16x32_bf16 v[146:149], v[102:105], v[90:93], v[146:149]
ds_write_b128 v211, v[154:157] offset:45056
v_mfma_f32_16x16x16_bf16 v[154:157], v[76:77], v[82:83], 0
v_mul_f32 v163, v163, v167
v_mul_f32 v164, v164, v167
v_mul_f32_e64 v165, v165, v167
v_mfma_f32_16x16x16_bf16 v[166:169], v[76:77], v[112:113], v[206:209]
v_cvt_pk_bf16_f32 v158, v162, v163
v_cvt_pk_bf16_f32 v159, v164, v165
v_exp_f32 v138, v138
v_mfma_f32_16x16x16_bf16 v[162:165], v[76:77], v[106:107], 0
v_exp_f32 v139, v139
v_exp_f32 v140, v140
v_mfma_f32_16x16x32_bf16 v[154:157], v[72:75], v[78:81], v[154:157]
ds_write_b64 v212, v[158:159] offset:45056
v_mfma_f32_16x16x16_bf16 v[158:161], v[76:77], v[100:101], 0
v_exp_f32 v141, v141
v_exp_f32 v142, v142
v_mfma_f32_16x16x32_bf16 v[162:165], v[72:75], v[102:105], v[162:165]
v_exp_f32 v143, v143
v_mfma_f32_16x16x32_bf16 v[158:161], v[72:75], v[96:99], v[158:161]
v_exp_f32 v144, v144
v_mfma_f32_16x16x32_bf16 v[166:169], v[72:75], v[108:111], v[166:169]
v_exp_f32 v145, v145
v_exp_f32 v150, v150
v_exp_f32 v146, v146
v_exp_f32 v147, v147
v_exp_f32 v148, v148
v_exp_f32_e64 v149, v149
v_cvt_pk_bf16_f32 v174, v138, v139
v_cvt_pk_bf16_f32 v175, v140, v141
v_cvt_pk_bf16_f32 v176, v142, v143
v_cvt_pk_bf16_f32 v177, v144, v145
v_cvt_pk_bf16_f32 v180, v150, 0
v_cvt_pk_bf16_f32 v178, v146, v147
v_mfma_f32_16x16x32_bf16 v[150:153], v[190:193], v[174:177], 0
s_waitcnt lgkmcnt(0)
v_cvt_pk_bf16_f32 v179, v148, v149
v_mov_b32_dpp v154, v158 quad_perm:[0,1,2,3] row_mask:0x2 bank_mask:0xf
v_mfma_f32_16x16x32_bf16 v[138:141], v[114:117], v[174:177], 0
s_barrier
v_mfma_f32_16x16x32_bf16 v[138:141], v[118:121], v[178:181], v[138:141]
ds_read_b128 v[220:223], v210 offset:38912
ds_read_b128 v[110:113], v210 offset:39936
v_mfma_f32_16x16x32_bf16 v[150:153], v[190:193], v[178:181], v[150:153]
ds_read_b128 v[170:173], v210 offset:40960
ds_read_b128 v[182:185], v210 offset:41984
v_mfma_f32_16x16x32_bf16 v[142:145], v[122:125], v[174:177], 0
v_mov_b32_dpp v154, v162 quad_perm:[0,1,2,3] row_mask:0x4 bank_mask:0xf
v_mfma_f32_16x16x32_bf16 v[142:145], v[126:129], v[178:181], v[142:145]
v_mov_b32_dpp v154, v167 quad_perm:[0,1,2,3] row_mask:0x8 bank_mask:0xf
v_exp_f32 v154, v154
v_mfma_f32_16x16x32_bf16 v[146:149], v[130:133], v[174:177], 0
v_cvt_pk_bf16_f32 v154, v154, 0
v_rcp_f32 v151, v150
v_mfma_f32_16x16x32_bf16 v[146:149], v[134:137], v[178:181], v[146:149]
s_waitcnt lgkmcnt(3)
ds_write_b16 v214, v154
v_mfma_f32_16x16x32_bf16 v[0:3], a[144:147], v[220:223], v[0:3]
s_waitcnt lgkmcnt(3)
ds_read_b128 v[84:87], v215
ds_read_b128 v[88:91], v215 offset:16
v_mfma_f32_16x16x32_bf16 v[0:3], a[148:151], v[110:113], v[0:3]
ds_read_b128 v[186:189], v210 offset:43008
ds_read_b128 v[174:177], v217
v_mfma_f32_16x16x32_bf16 v[4:7], a[168:171], v[220:223], v[4:7]
ds_read_b128 v[178:181], v217 offset:528
v_add_u32 v215, 1552, v215
v_mfma_f32_16x16x32_bf16 v[4:7], a[172:175], v[110:113], v[4:7]
v_mfma_f32_16x16x32_bf16 v[8:11], a[192:195], v[220:223], v[8:11]
ds_read_b128 v[220:223], v210 offset:44032
v_mfma_f32_16x16x32_bf16 v[8:11], a[196:199], v[110:113], v[8:11]
s_nop 0
ds_read_b128 v[110:113], v210 offset:45056
s_waitcnt lgkmcnt(6)
v_mfma_f32_16x16x32_bf16 v[166:169], v[84:87], v[190:193], 0
s_waitcnt lgkmcnt(5)
v_mfma_f32_16x16x32_bf16 v[166:169], v[88:91], v[190:193], v[166:169]
v_mfma_f32_16x16x32_bf16 v[154:157], v[84:87], v[114:117], 0
v_mfma_f32_16x16x32_bf16 v[154:157], v[88:91], v[118:121], v[154:157]
v_rcp_f32 v167, v166
v_mfma_f32_16x16x32_bf16 v[158:161], v[84:87], v[122:125], 0
v_max3_u32 v218, v218, v166, v167
v_max3_u32 v218, v218, v150, v151
v_mfma_f32_16x16x32_bf16 v[158:161], v[88:91], v[126:129], v[158:161]
v_mul_f32 v151, s3, v151
v_mul_f32 v138, v138, v151
v_mfma_f32_16x16x32_bf16 v[162:165], v[84:87], v[130:133], 0
v_mul_f32 v139, v139, v151
v_mul_f32 v140, v140, v151
v_mfma_f32_16x16x32_bf16 v[162:165], v[88:91], v[134:137], v[162:165]
v_mul_f32_e64 v141, v141, v151
v_cvt_pk_bf16_f32 v138, v138, v139
v_mfma_f32_16x16x32_bf16 v[0:3], a[152:155], v[170:173], v[0:3]
v_mul_f32 v142, v142, v151
v_mul_f32 v143, v143, v151
v_mfma_f32_16x16x32_bf16 v[0:3], a[156:159], v[182:185], v[0:3]
s_waitcnt lgkmcnt(4)
v_mul_f32 v144, v144, v151
v_mul_f32_e64 v145, v145, v151
v_mfma_f32_16x16x32_bf16 v[0:3], a[160:163], v[186:189], v[0:3]
v_cvt_pk_bf16_f32 v139, v140, v141
v_cvt_pk_bf16_f32 v140, v142, v143
v_mfma_f32_16x16x32_bf16 v[4:7], a[176:179], v[170:173], v[4:7]
v_cvt_pk_bf16_f32 v141, v144, v145
v_mul_f32_e64 v146, v146, v151
v_mfma_f32_16x16x32_bf16 v[4:7], a[180:183], v[182:185], v[4:7]
ds_write_b128 v211, v[138:141] offset:51200
v_mfma_f32_16x16x32_bf16 v[4:7], a[184:187], v[186:189], v[4:7]
v_mul_f32 v147, v147, v151
v_mul_f32 v148, v148, v151
v_mfma_f32_16x16x32_bf16 v[8:11], a[200:203], v[170:173], v[8:11]
v_mul_f32_e64 v149, v149, v151
v_cvt_pk_bf16_f32 v142, v146, v147
v_mfma_f32_16x16x32_bf16 v[8:11], a[204:207], v[182:185], v[8:11]
s_nop 0
ds_read_b128 v[170:173], v210 offset:46080
ds_read_b128 v[182:185], v210 offset:47104
v_mfma_f32_16x16x32_bf16 v[8:11], a[208:211], v[186:189], v[8:11]
s_waitcnt lgkmcnt(4)
ds_read_b128 v[186:189], v210 offset:48128
v_cvt_pk_bf16_f32 v143, v148, v149
v_mfma_f32_16x16x32_bf16 v[8:11], a[212:215], v[220:223], v[8:11]
ds_write_b64 v212, v[142:143] offset:51200
v_mfma_f32_16x16x32_bf16 v[0:3], a[164:167], v[220:223], v[0:3]
v_mov_b32_dpp v154, v158 quad_perm:[0,1,2,3] row_mask:0x2 bank_mask:0xf
v_mul_f32 v167, s3, v167
v_mfma_f32_16x16x32_bf16 v[4:7], a[188:191], v[220:223], v[4:7]
s_waitcnt lgkmcnt(5)
ds_read_b128 v[220:223], v210 offset:49152
v_mov_b32_dpp v154, v162 quad_perm:[0,1,2,3] row_mask:0x4 bank_mask:0xf
v_mfma_f32_16x16x32_bf16 v[12:15], a[144:147], v[110:113], v[12:15]
s_waitcnt lgkmcnt(4)
v_cvt_pk_bf16_f32 v72, v0, v1
v_cvt_pk_bf16_f32 v73, v2, v3
v_mfma_f32_16x16x32_bf16 v[12:15], a[148:151], v[170:173], v[12:15]
s_waitcnt lgkmcnt(3)
buffer_store_dwordx2 v[72:73], v203, s[8:11], s38 offen
v_cvt_pk_bf16_f32 v74, v4, v5
v_mfma_f32_16x16x32_bf16 v[12:15], a[152:155], v[182:185], v[12:15]
s_waitcnt lgkmcnt(2)
v_cvt_pk_bf16_f32 v75, v6, v7
v_mul_f32 v154, v154, v167
v_mfma_f32_16x16x32_bf16 v[12:15], a[156:159], v[186:189], v[12:15]
v_cvt_pk_bf16_f32 v154, v154, 0
v_cvt_pk_bf16_f32 v76, v8, v9
v_mfma_f32_16x16x32_bf16 v[16:19], a[168:171], v[110:113], v[16:19]
ds_write_b16 v214, v154
v_mfma_f32_16x16x32_bf16 v[16:19], a[172:175], v[170:173], v[16:19]
v_cvt_pk_bf16_f32 v77, v10, v11
v_add_u32 v214, 1552, v214
v_mfma_f32_16x16x32_bf16 v[16:19], a[176:179], v[182:185], v[16:19]
v_mfma_f32_16x16x32_bf16 v[16:19], a[180:183], v[186:189], v[16:19]
v_mfma_f32_16x16x32_bf16 v[20:23], a[192:195], v[110:113], v[20:23]
s_nop 0
ds_read_b128 v[110:113], v210 offset:50176
v_mfma_f32_16x16x32_bf16 v[20:23], a[196:199], v[170:173], v[20:23]
s_waitcnt vmcnt(1) lgkmcnt(3)
v_mfma_f32_16x16x32_bf16 v[20:23], a[200:203], v[182:185], v[20:23]
s_barrier
v_mfma_f32_16x16x32_bf16 v[20:23], a[204:207], v[186:189], v[20:23]
s_waitcnt lgkmcnt(2)
ds_read_b128 v[170:173], v210 offset:51200
ds_read_b128 v[182:185], v210 offset:52224
v_mfma_f32_16x16x32_bf16 v[20:23], a[208:211], v[220:223], v[20:23]
s_nop 0
ds_read_b128 v[186:189], v210 offset:53248
ds_read_b128 v[84:87], v200
v_mfma_f32_16x16x32_bf16 v[12:15], a[160:163], v[220:223], v[12:15]
s_waitcnt lgkmcnt(4)
ds_read_b128 v[92:95], v201
ds_read_b128 v[100:103], v202
v_mfma_f32_16x16x32_bf16 v[12:15], a[164:167], v[110:113], v[12:15]
ds_read_b128 v[88:91], v194 offset:16
buffer_store_dwordx2 v[74:75], v203, s[8:11], s38 offen offset:32
v_mfma_f32_16x16x32_bf16 v[16:19], a[184:187], v[220:223], v[16:19]
s_nop 0
ds_read_b128 v[220:223], v210 offset:54272
s_nop 1
v_cvt_pk_bf16_f32 v78, v12, v13
v_mfma_f32_16x16x32_bf16 v[16:19], a[188:191], v[110:113], v[16:19]
ds_read_b128 v[96:99], v195 offset:16
v_cvt_pk_bf16_f32 v79, v14, v15
v_mfma_f32_16x16x32_bf16 v[20:23], a[212:215], v[110:113], v[20:23]
ds_read_b128 v[110:113], v210 offset:55296
s_waitcnt lgkmcnt(9)
v_mfma_f32_16x16x32_bf16 v[24:27], a[144:147], v[170:173], v[24:27]
s_waitcnt lgkmcnt(8)
ds_read_b128 v[104:107], v196 offset:16
v_cvt_pk_bf16_f32 v80, v16, v17
v_mfma_f32_16x16x32_bf16 v[24:27], a[148:151], v[182:185], v[24:27]
s_waitcnt lgkmcnt(8)
v_cvt_pk_bf16_f32 v81, v18, v19
v_cvt_pk_bf16_f32 v82, v20, v21
v_mfma_f32_16x16x32_bf16 v[24:27], a[152:155], v[186:189], v[24:27]
v_cvt_pk_bf16_f32 v83, v22, v23
v_mfma_f32_16x16x32_bf16 v[28:31], a[168:171], v[170:173], v[28:31]
v_mfma_f32_16x16x32_bf16 v[28:31], a[172:175], v[182:185], v[28:31]
v_mfma_f32_16x16x32_bf16 v[28:31], a[176:179], v[186:189], v[28:31]
s_waitcnt lgkmcnt(3)
v_mfma_f32_16x16x32_bf16 v[28:31], a[180:183], v[220:223], v[28:31]
v_mfma_f32_16x16x32_bf16 v[32:35], a[192:195], v[170:173], v[32:35]
ds_read_b128 v[170:173], v210 offset:56320
v_mfma_f32_16x16x32_bf16 v[32:35], a[196:199], v[182:185], v[32:35]
ds_read_b128 v[182:185], v210 offset:20480
v_mfma_f32_16x16x32_bf16 v[32:35], a[200:203], v[186:189], v[32:35]
ds_read_b128 v[186:189], v210 offset:21504
v_mfma_f32_16x16x32_bf16 v[32:35], a[204:207], v[220:223], v[32:35]
buffer_store_dwordx2 v[76:77], v203, s[8:11], s38 offen offset:64
v_mfma_f32_16x16x32_bf16 v[0:3], v[174:177], v[84:87], 0
ds_read_b128 v[84:87], v194
v_mfma_f32_16x16x32_bf16 v[24:27], a[156:159], v[220:223], v[24:27]
ds_read_b128 v[220:223], v210 offset:23552
s_waitcnt lgkmcnt(6)
v_mfma_f32_16x16x32_bf16 v[24:27], a[160:163], v[110:113], v[24:27]
s_waitcnt lgkmcnt(4)
v_mfma_f32_16x16x32_bf16 v[24:27], a[164:167], v[170:173], v[24:27]
v_mfma_f32_16x16x32_bf16 v[12:15], v[174:177], v[92:95], 0
ds_read_b128 v[92:95], v195
v_mfma_f32_16x16x32_bf16 v[28:31], a[184:187], v[110:113], v[28:31]
v_cvt_pk_bf16_f32 v116, v24, v25
v_cvt_pk_bf16_f32 v117, v26, v27
v_mfma_f32_16x16x32_bf16 v[28:31], a[188:191], v[170:173], v[28:31]
v_mfma_f32_16x16x32_bf16 v[24:27], v[174:177], v[100:103], 0
ds_read_b128 v[100:103], v196
ds_read_b128 v[174:177], v217 offset:1056
v_mfma_f32_16x16x32_bf16 v[32:35], a[208:211], v[110:113], v[32:35]
ds_read_b128 v[110:113], v210 offset:22528
v_cvt_pk_bf16_f32 v124, v28, v29
v_mfma_f32_16x16x32_bf16 v[32:35], a[212:215], v[170:173], v[32:35]
v_cvt_pk_bf16_f32 v125, v30, v31
s_waitcnt lgkmcnt(5)
v_smfmac_f32_16x16x64_bf16 v[0:3], v[178:181], v[84:91], v213
s_waitcnt lgkmcnt(3)
ds_read_b128 v[84:87], v197
ds_read_b128 v[88:91], v197 offset:16
v_smfmac_f32_16x16x64_bf16 v[12:15], v[178:181], v[92:99], v213
ds_read_b128 v[92:95], v198
ds_read_b128 v[96:99], v198 offset:16
v_mfma_f32_16x16x32_bf16 v[138:141], a[0:3], v[182:185], 0
v_cvt_pk_bf16_f32 v132, v32, v33
v_cvt_pk_bf16_f32 v133, v34, v35
v_mfma_f32_16x16x32_bf16 v[138:141], a[4:7], v[186:189], v[138:141]
s_waitcnt lgkmcnt(6)
v_smfmac_f32_16x16x64_bf16 v[24:27], v[178:181], v[100:107], v213
s_nop 0
ds_read_b128 v[100:103], v199
ds_read_b128 v[104:107], v199 offset:16
v_mfma_f32_16x16x32_bf16 v[142:145], a[24:27], v[182:185], 0
ds_read_b128 v[178:181], v217 offset:1584
buffer_store_dwordx2 v[78:79], v204, s[8:11], s38 offen
v_mfma_f32_16x16x32_bf16 v[142:145], a[28:31], v[186:189], v[142:145]
s_waitcnt lgkmcnt(5)
v_smfmac_f32_16x16x64_bf16 v[0:3], v[174:177], v[84:91], v213
ds_read_b128 v[84:87], v200 offset:32
ds_read_b128 v[88:91], v194 offset:48
v_mfma_f32_16x16x32_bf16 v[146:149], a[48:51], v[182:185], 0
s_waitcnt lgkmcnt(5)
v_smfmac_f32_16x16x64_bf16 v[12:15], v[174:177], v[92:99], v213
ds_read_b128 v[92:95], v201 offset:32
ds_read_b128 v[96:99], v195 offset:48
v_mfma_f32_16x16x32_bf16 v[146:149], a[52:55], v[186:189], v[146:149]
s_waitcnt lgkmcnt(5)
v_mul_f32 v119, v0, v0
v_add_f32_e64 v118, v0, v1
v_smfmac_f32_16x16x64_bf16 v[24:27], v[174:177], v[100:107], v213
ds_read_b128 v[100:103], v202 offset:32
ds_read_b128 v[174:177], v217 offset:2112
v_mfma_f32_16x16x32_bf16 v[150:153], a[216:219], v[182:185], 0
ds_read_b128 v[104:107], v196 offset:48
v_mul_f32_e64 v127, v12, v12
v_mfma_f32_16x16x32_bf16 v[150:153], a[220:223], v[186:189], v[150:153]
s_waitcnt lgkmcnt(6)
v_mul_f32 v135, v24, v24
v_add_f32_e64 v134, v24, v25
v_mfma_f32_16x16x32_bf16 v[4:7], v[178:181], v[84:87], 0
ds_read_b128 v[84:87], v194 offset:32
v_fmac_f32_e64 v135, v25, v25
v_mfma_f32_16x16x32_bf16 v[154:157], a[240:243], v[182:185], 0
s_waitcnt lgkmcnt(5)
v_add_f32 v126, v12, v13
v_fmac_f32_e64 v119, v1, v1
v_mfma_f32_16x16x32_bf16 v[16:19], v[178:181], v[92:95], 0
ds_read_b128 v[92:95], v195 offset:32
v_fmac_f32_e64 v127, v13, v13
v_mfma_f32_16x16x32_bf16 v[154:157], a[244:247], v[186:189], v[154:157]
s_waitcnt lgkmcnt(4)
v_add_f32 v134, v134, v26
v_fmac_f32_e64 v135, v26, v26
v_mfma_f32_16x16x32_bf16 v[28:31], v[178:181], v[100:103], 0
ds_read_b128 v[100:103], v196 offset:32
ds_read_b128 v[178:181], v217 offset:2640
v_mfma_f32_16x16x32_bf16 v[158:161], v[232:235], v[182:185], 0
v_add_f32 v118, v118, v2
v_add_f32 v126, v126, v14
v_mfma_f32_16x16x32_bf16 v[158:161], v[236:239], v[186:189], v[158:161]
s_waitcnt lgkmcnt(3)
v_fmac_f32 v119, v2, v2
v_fmac_f32_e64 v127, v14, v14
v_smfmac_f32_16x16x64_bf16 v[4:7], v[174:177], v[84:91], v213
s_nop 0
ds_read_b128 v[84:87], v197 offset:32
ds_read_b128 v[88:91], v197 offset:48
v_mfma_f32_16x16x32_bf16 v[162:165], v[182:185], a[72:75], 0
s_waitcnt lgkmcnt(4)
buffer_store_dwordx2 v[80:81], v204, s[8:11], s38 offen offset:32
v_add_f32 v134, v134, v27
v_smfmac_f32_16x16x64_bf16 v[16:19], v[174:177], v[92:99], v213
s_waitcnt lgkmcnt(3)
ds_read_b128 v[92:95], v198 offset:32
ds_read_b128 v[96:99], v198 offset:48
v_smfmac_f32_16x16x64_bf16 v[28:31], v[174:177], v[100:107], v213
ds_read_b128 v[100:103], v199 offset:32
ds_read_b128 v[104:107], v199 offset:48
v_mfma_f32_16x16x32_bf16 v[162:165], v[186:189], a[76:79], v[162:165]
ds_read_b128 v[174:177], v217 offset:3168
v_fmac_f32_e64 v135, v27, v27
v_mfma_f32_16x16x32_bf16 v[166:169], v[182:185], a[96:99], 0
v_add_f32 v118, v118, v3
v_add_f32 v126, v126, v15
v_mfma_f32_16x16x32_bf16 v[166:169], v[186:189], a[100:103], v[166:169]
s_waitcnt lgkmcnt(5)
v_fmac_f32 v119, v3, v3
v_fmac_f32_e64 v127, v15, v15
v_smfmac_f32_16x16x64_bf16 v[4:7], v[178:181], v[84:91], v213
ds_read_b128 v[84:87], v200 offset:64
ds_read_b128 v[88:91], v194 offset:80
v_mfma_f32_16x16x32_bf16 v[170:173], v[182:185], a[120:123], 0
s_nop 0
ds_read_b128 v[182:185], v210 offset:24576
s_waitcnt lgkmcnt(6)
v_smfmac_f32_16x16x64_bf16 v[16:19], v[178:181], v[92:99], v213
ds_read_b128 v[92:95], v201 offset:64
ds_read_b128 v[96:99], v195 offset:80
v_mfma_f32_16x16x32_bf16 v[170:173], v[186:189], a[124:127], v[170:173]
ds_read_b128 v[186:189], v210 offset:25600
v_add_f32_e64 v118, v118, v4
v_mfma_f32_16x16x32_bf16 v[138:141], a[8:11], v[110:113], v[138:141]
s_waitcnt lgkmcnt(7)
v_fmac_f32 v119, v4, v4
v_add_f32_e64 v126, v126, v16
v_smfmac_f32_16x16x64_bf16 v[28:31], v[178:181], v[100:107], v213
ds_read_b128 v[100:103], v202 offset:64
ds_read_b128 v[178:181], v217 offset:3696
v_mfma_f32_16x16x32_bf16 v[138:141], a[12:15], v[220:223], v[138:141]
s_waitcnt lgkmcnt(7)
ds_read_b128 v[104:107], v196 offset:80
v_fmac_f32 v127, v16, v16
v_mfma_f32_16x16x32_bf16 v[8:11], v[174:177], v[84:87], 0
ds_read_b128 v[84:87], v194 offset:64
v_add_f32_e64 v134, v134, v28
v_mfma_f32_16x16x32_bf16 v[142:145], a[32:35], v[110:113], v[142:145]
buffer_store_dwordx2 v[82:83], v204, s[8:11], s38 offen offset:64
v_fmac_f32 v135, v28, v28
v_mfma_f32_16x16x32_bf16 v[142:145], a[36:39], v[220:223], v[142:145]
s_waitcnt lgkmcnt(6)
v_add_f32 v134, v134, v29
v_fmac_f32 v135, v29, v29
v_mfma_f32_16x16x32_bf16 v[20:23], v[174:177], v[92:95], 0
ds_read_b128 v[92:95], v195 offset:64
v_add_f32_e64 v118, v118, v5
v_mfma_f32_16x16x32_bf16 v[146:149], a[56:59], v[110:113], v[146:149]
v_fmac_f32 v119, v5, v5
v_add_f32 v126, v126, v17
v_mfma_f32_16x16x32_bf16 v[146:149], a[60:63], v[220:223], v[146:149]
s_waitcnt lgkmcnt(4)
v_fmac_f32 v127, v17, v17
v_add_f32_e64 v134, v134, v30
v_mfma_f32_16x16x32_bf16 v[32:35], v[174:177], v[100:103], 0
ds_read_b128 v[100:103], v196 offset:64
ds_read_b128 v[174:177], v217 offset:4224
v_mfma_f32_16x16x32_bf16 v[150:153], a[224:227], v[110:113], v[150:153]
v_fmac_f32 v135, v30, v30
v_add_f32 v118, v118, v6
v_mfma_f32_16x16x32_bf16 v[150:153], a[228:231], v[220:223], v[150:153]
s_waitcnt lgkmcnt(3)
v_fmac_f32 v119, v6, v6
v_add_f32 v126, v126, v18
v_smfmac_f32_16x16x64_bf16 v[8:11], v[178:181], v[84:91], v213
s_waitcnt lgkmcnt(2)
ds_read_b128 v[84:87], v197 offset:64
ds_read_b128 v[88:91], v197 offset:80
v_smfmac_f32_16x16x64_bf16 v[20:23], v[178:181], v[92:99], v213
ds_read_b128 v[92:95], v198 offset:64
ds_read_b128 v[96:99], v198 offset:80
v_mfma_f32_16x16x32_bf16 v[154:157], a[248:251], v[110:113], v[154:157]
v_fmac_f32 v127, v18, v18
v_add_f32 v134, v134, v31
v_mfma_f32_16x16x32_bf16 v[154:157], a[252:255], v[220:223], v[154:157]
s_waitcnt lgkmcnt(5)
v_fmac_f32 v135, v31, v31
v_add_f32_e64 v118, v118, v7
v_smfmac_f32_16x16x64_bf16 v[32:35], v[178:181], v[100:107], v213
ds_read_b128 v[100:103], v199 offset:64
ds_read_b128 v[104:107], v199 offset:80
v_mfma_f32_16x16x32_bf16 v[158:161], v[240:243], v[110:113], v[158:161]
v_fmac_f32 v119, v7, v7
v_add_f32 v126, v126, v19
v_mfma_f32_16x16x32_bf16 v[158:161], v[244:247], v[220:223], v[158:161]
v_fmac_f32 v127, v19, v19
s_waitcnt lgkmcnt(4)
v_smfmac_f32_16x16x64_bf16 v[8:11], v[174:177], v[84:91], v213
v_mfma_f32_16x16x32_bf16 v[162:165], v[110:113], a[80:83], v[162:165]
buffer_store_dwordx2 v[116:117], v205, s[8:11], s38 offen
v_mfma_f32_16x16x32_bf16 v[162:165], v[220:223], a[84:87], v[162:165]
v_add_f32 v118, v118, v8
v_fmac_f32 v119, v8, v8
v_mfma_f32_16x16x32_bf16 v[166:169], v[110:113], a[104:107], v[166:169]
v_add_f32 v118, v118, v9
v_fmac_f32 v119, v9, v9
v_mfma_f32_16x16x32_bf16 v[166:169], v[220:223], a[108:111], v[166:169]
s_waitcnt lgkmcnt(2)
v_add_f32 v118, v118, v10
v_fmac_f32_e64 v119, v10, v10
v_smfmac_f32_16x16x64_bf16 v[20:23], v[174:177], v[92:99], v213
v_add_f32_e64 v118, v118, v11
v_mfma_f32_16x16x32_bf16 v[170:173], v[110:113], a[128:131], v[170:173]
ds_read_b128 v[110:113], v210 offset:26624
v_fmac_f32 v119, v11, v11
v_mfma_f32_16x16x32_bf16 v[170:173], v[220:223], a[132:135], v[170:173]
s_waitcnt lgkmcnt(1)
ds_read_b128 v[220:223], v210 offset:27648
v_add_f32_e64 v126, v126, v20
v_smfmac_f32_16x16x64_bf16 v[32:35], v[174:177], v[100:107], v213
v_fmac_f32_e64 v127, v20, v20
v_mfma_f32_16x16x32_bf16 v[138:141], a[16:19], v[182:185], v[138:141]
v_add_f32 v126, v126, v21
v_fmac_f32 v127, v21, v21
v_mfma_f32_16x16x32_bf16 v[138:141], a[20:23], v[186:189], v[138:141]
v_add_f32 v134, v134, v32
v_fmac_f32 v135, v32, v32
v_mfma_f32_16x16x32_bf16 v[142:145], a[40:43], v[182:185], v[142:145]
v_add_f32 v134, v134, v33
v_fmac_f32 v135, v33, v33
v_mfma_f32_16x16x32_bf16 v[142:145], a[44:47], v[186:189], v[142:145]
v_cvt_pk_bf16_f32 v78, v138, v139
v_cvt_pk_bf16_f32 v79, v140, v141
v_mfma_f32_16x16x32_bf16 v[146:149], a[64:67], v[182:185], v[146:149]
v_add_f32 v134, v134, v34
v_fmac_f32 v135, v34, v34
v_mfma_f32_16x16x32_bf16 v[146:149], a[68:71], v[186:189], v[146:149]
v_cvt_pk_bf16_f32 v80, v142, v143
v_cvt_pk_bf16_f32 v81, v144, v145
v_mfma_f32_16x16x32_bf16 v[150:153], a[232:235], v[182:185], v[150:153]
v_add_f32 v126, v126, v22
v_fmac_f32 v127, v22, v22
v_mfma_f32_16x16x32_bf16 v[150:153], a[236:239], v[186:189], v[150:153]
v_cvt_pk_bf16_f32 v82, v146, v147
v_cvt_pk_bf16_f32 v83, v148, v149
v_mfma_f32_16x16x32_bf16 v[154:157], v[224:227], v[182:185], v[154:157]
v_add_f32 v134, v134, v35
v_fmac_f32 v135, v35, v35
v_mfma_f32_16x16x32_bf16 v[154:157], v[228:231], v[186:189], v[154:157]
v_cvt_pk_bf16_f32 v72, v150, v151
v_cvt_pk_bf16_f32 v73, v152, v153
v_mfma_f32_16x16x32_bf16 v[158:161], v[248:251], v[182:185], v[158:161]
v_add_f32 v126, v126, v23
v_fmac_f32 v127, v23, v23
v_mfma_f32_16x16x32_bf16 v[158:161], v[252:255], v[186:189], v[158:161]
v_cvt_pk_bf16_f32 v74, v154, v155
v_cvt_pk_bf16_f32 v75, v156, v157
v_mfma_f32_16x16x32_bf16 v[162:165], v[182:185], a[88:91], v[162:165]
s_nop 0
v_permlane16_swap_b32 v134, v135
v_mfma_f32_16x16x32_bf16 v[162:165], v[186:189], a[92:95], v[162:165]
v_cvt_pk_bf16_f32 v76, v158, v159
v_cvt_pk_bf16_f32 v77, v160, v161
v_mfma_f32_16x16x32_bf16 v[166:169], v[182:185], a[112:115], v[166:169]
v_permlane16_swap_b32 v118, v119
v_mfma_f32_16x16x32_bf16 v[166:169], v[186:189], a[116:119], v[166:169]
v_permlane16_swap_b32 v126, v127
v_mfma_f32_16x16x32_bf16 v[170:173], v[182:185], a[136:139], v[170:173]
ds_read_b128 v[182:185], v210 offset:28672
v_add_f32 v134, v134, v135
v_mfma_f32_16x16x32_bf16 v[170:173], v[186:189], a[140:143], v[170:173]
s_waitcnt lgkmcnt(2)
ds_read_b128 v[186:189], v210 offset:29696
v_cvt_pk_bf16_f32 v114, v162, v163
v_mfma_f32_16x16x32_bf16 v[138:141], a[0:3], v[110:113], 0
s_waitcnt lgkmcnt(2)
v_cvt_pk_bf16_f32 v115, v164, v165
v_add_f32 v118, v118, v119
v_mfma_f32_16x16x32_bf16 v[138:141], a[4:7], v[220:223], v[138:141]
v_add_f32 v126, v126, v127
v_mov_b32 v135, v134
v_mfma_f32_16x16x32_bf16 v[142:145], a[24:27], v[110:113], 0
v_permlane32_swap_b32 v118, v126
v_mfma_f32_16x16x32_bf16 v[142:145], a[28:31], v[220:223], v[142:145]
v_permlane32_swap_b32 v134, v135
v_mfma_f32_16x16x32_bf16 v[146:149], a[48:51], v[110:113], 0
v_cvt_pk_bf16_f32 v122, v166, v167
v_cvt_pk_bf16_f32 v123, v168, v169
v_mfma_f32_16x16x32_bf16 v[146:149], a[52:55], v[220:223], v[146:149]
v_add_f32 v118, v118, v126
v_add_f32 v134, v134, v135
v_mfma_f32_16x16x32_bf16 v[150:153], a[216:219], v[110:113], 0
ds_write_b32 v209, v118
v_mfma_f32_16x16x32_bf16 v[150:153], a[220:223], v[220:223], v[150:153]
ds_write_b32 v209, v134 offset:512
v_mfma_f32_16x16x32_bf16 v[154:157], a[240:243], v[110:113], 0
v_cvt_pk_bf16_f32 v130, v170, v171
v_cvt_pk_bf16_f32 v131, v172, v173
v_mfma_f32_16x16x32_bf16 v[154:157], a[244:247], v[220:223], v[154:157]
buffer_store_dwordx2 v[124:125], v205, s[8:11], s38 offen offset:32
v_mfma_f32_16x16x32_bf16 v[158:161], v[232:235], v[110:113], 0
v_mfma_f32_16x16x32_bf16 v[158:161], v[236:239], v[220:223], v[158:161]
v_mfma_f32_16x16x32_bf16 v[162:165], v[110:113], a[72:75], 0
s_waitcnt lgkmcnt(0)
s_barrier
v_mfma_f32_16x16x32_bf16 v[162:165], v[220:223], a[76:79], v[162:165]
ds_read_b128 v[102:105], v210 offset:18432
ds_read_b128 v[106:109], v210 offset:19456
v_mfma_f32_16x16x32_bf16 v[166:169], v[110:113], a[96:99], 0
v_mfma_f32_16x16x32_bf16 v[166:169], v[220:223], a[100:103], v[166:169]
v_mfma_f32_16x16x32_bf16 v[170:173], v[110:113], a[120:123], 0
ds_read_b128 v[110:113], v210 offset:30720
v_mfma_f32_16x16x32_bf16 v[170:173], v[220:223], a[124:127], v[170:173]
v_mfma_f32_16x16x32_bf16 v[138:141], a[8:11], v[182:185], v[138:141]
s_waitcnt lgkmcnt(2)
v_add_f32 v102, v102, v103
v_mfma_f32_16x16x32_bf16 v[138:141], a[12:15], v[186:189], v[138:141]
v_add_f32 v104, v104, v105
v_add_f32 v102, v102, v104
v_mfma_f32_16x16x32_bf16 v[142:145], a[32:35], v[182:185], v[142:145]
s_waitcnt lgkmcnt(1)
v_add_f32 v106, v106, v107
v_add_f32_e64 v108, v108, v109
v_mfma_f32_16x16x32_bf16 v[142:145], a[36:39], v[186:189], v[142:145]
v_add_f32 v106, v106, v108
v_mul_f32 v103, s48, v102
v_mfma_f32_16x16x32_bf16 v[146:149], a[56:59], v[182:185], v[146:149]
v_mul_f32 v104, s73, v102
v_mul_f32 v106, s73, v106
v_mfma_f32_16x16x32_bf16 v[146:149], a[60:63], v[186:189], v[146:149]
v_fma_f32 v106, -v103, v104, v106
v_max_f32_e64 v106, 0, v106
v_mfma_f32_16x16x32_bf16 v[150:153], a[224:227], v[182:185], v[150:153]
v_add_f32_e64 v106, s49, v106
v_rsq_f32 v102, v106
v_mfma_f32_16x16x32_bf16 v[150:153], a[228:231], v[186:189], v[150:153]
ds_read_b128 v[106:109], v210 offset:31744
buffer_store_dwordx2 v[132:133], v205, s[8:11], s38 offen offset:64
v_mul_f32_e64 v103, -v103, v102
v_mfma_f32_16x16x32_bf16 v[154:157], a[248:251], v[182:185], v[154:157]
s_mov_b32 s38, s36
ds_write_b64 v211, v[102:103]
v_mfma_f32_16x16x32_bf16 v[154:157], a[252:255], v[186:189], v[154:157]
v_mfma_f32_16x16x32_bf16 v[158:161], v[240:243], v[182:185], v[158:161]
ds_read_b64 v[118:119], v219
ds_read_b64 v[126:127], v219 offset:256
v_mfma_f32_16x16x32_bf16 v[158:161], v[244:247], v[186:189], v[158:161]
ds_read_b64 v[134:135], v219 offset:512
v_mfma_f32_16x16x32_bf16 v[162:165], v[182:185], a[80:83], v[162:165]
v_mfma_f32_16x16x32_bf16 v[162:165], v[186:189], a[84:87], v[162:165]
v_mfma_f32_16x16x32_bf16 v[166:169], v[182:185], a[104:107], v[166:169]
s_nop 0
v_mfma_f32_16x16x32_bf16 v[166:169], v[186:189], a[108:111], v[166:169]
s_waitcnt lgkmcnt(2)
v_fma_f32 v220, v0, v118, v119
v_fma_f32 v221, v1, v118, v119
v_mfma_f32_16x16x32_bf16 v[170:173], v[182:185], a[128:131], v[170:173]
ds_read_b128 v[182:185], v210 offset:32768
v_fma_f32 v222, v2, v118, v119
v_mfma_f32_16x16x32_bf16 v[170:173], v[186:189], a[132:135], v[170:173]
ds_read_b128 v[186:189], v210 offset:33792
v_fma_f32 v223, v3, v118, v119
v_mfma_f32_16x16x32_bf16 v[138:141], a[16:19], v[110:113], v[138:141]
v_cvt_pk_bf16_f32 v90, v220, v221
v_cvt_pk_bf16_f32 v91, v222, v223
v_mfma_f32_16x16x32_bf16 v[138:141], a[20:23], v[106:109], v[138:141]
v_fma_f32 v220, v4, v118, v119
v_fma_f32 v221, v5, v118, v119
v_mfma_f32_16x16x32_bf16 v[142:145], a[40:43], v[110:113], v[142:145]
v_fma_f32 v222, v6, v118, v119
v_fma_f32 v223, v7, v118, v119
v_mfma_f32_16x16x32_bf16 v[142:145], a[44:47], v[106:109], v[142:145]
v_cvt_pk_bf16_f32 v96, v138, v139
v_cvt_pk_bf16_f32 v97, v140, v141
v_mfma_f32_16x16x32_bf16 v[146:149], a[64:67], v[110:113], v[146:149]
v_cvt_pk_bf16_f32 v92, v220, v221
v_cvt_pk_bf16_f32 v93, v222, v223
v_mfma_f32_16x16x32_bf16 v[146:149], a[68:71], v[106:109], v[146:149]
v_fma_f32 v220, v8, v118, v119
v_fma_f32 v221, v9, v118, v119
v_mfma_f32_16x16x32_bf16 v[150:153], a[232:235], v[110:113], v[150:153]
v_fma_f32 v222, v10, v118, v119
v_fma_f32 v223, v11, v118, v119
v_mfma_f32_16x16x32_bf16 v[150:153], a[236:239], v[106:109], v[150:153]
v_cvt_pk_bf16_f32 v100, v146, v147
v_cvt_pk_bf16_f32 v101, v148, v149
v_mfma_f32_16x16x32_bf16 v[154:157], v[224:227], v[110:113], v[154:157]
ds_write_b128 v211, v[90:93]
v_mfma_f32_16x16x32_bf16 v[154:157], v[228:231], v[106:109], v[154:157]
s_nop 0
v_cvt_pk_bf16_f32 v94, v220, v221
v_cvt_pk_bf16_f32 v95, v222, v223
v_mfma_f32_16x16x32_bf16 v[158:161], v[248:251], v[110:113], v[158:161]
s_waitcnt lgkmcnt(4)
v_fma_f32 v220, v12, v126, v127
v_fma_f32 v221, v13, v126, v127
v_mfma_f32_16x16x32_bf16 v[158:161], v[252:255], v[106:109], v[158:161]
v_fma_f32 v222, v14, v126, v127
v_fma_f32 v223, v15, v126, v127
v_mfma_f32_16x16x32_bf16 v[162:165], v[110:113], a[88:91], v[162:165]
v_cvt_pk_bf16_f32 v98, v142, v143
v_cvt_pk_bf16_f32 v99, v144, v145
v_mfma_f32_16x16x32_bf16 v[162:165], v[106:109], a[92:95], v[162:165]
v_cvt_pk_bf16_f32 v174, v220, v221
v_cvt_pk_bf16_f32 v175, v222, v223
v_mfma_f32_16x16x32_bf16 v[166:169], v[110:113], a[112:115], v[166:169]
v_cvt_pk_bf16_f32 v84, v150, v151
v_cvt_pk_bf16_f32 v85, v152, v153
v_mfma_f32_16x16x32_bf16 v[166:169], v[106:109], a[116:119], v[166:169]
v_fma_f32 v220, v16, v126, v127
v_fma_f32 v221, v17, v126, v127
v_mfma_f32_16x16x32_bf16 v[170:173], v[110:113], a[136:139], v[170:173]
ds_read_b64 v[112:113], v215 offset:528
v_fma_f32 v222, v18, v126, v127
v_mfma_f32_16x16x32_bf16 v[170:173], v[106:109], a[140:143], v[170:173]
s_waitcnt lgkmcnt(3)
ds_read_b128 v[108:111], v215 offset:512
v_fma_f32 v223, v19, v126, v127
v_mfma_f32_16x16x32_bf16 v[138:141], a[0:3], v[182:185], 0
s_waitcnt lgkmcnt(3)
v_cvt_pk_bf16_f32 v176, v220, v221
v_cvt_pk_bf16_f32 v177, v222, v223
v_mfma_f32_16x16x32_bf16 v[138:141], a[4:7], v[186:189], v[138:141]
ds_write_b128 v211, v[174:177] offset:6144
v_mfma_f32_16x16x32_bf16 v[142:145], a[24:27], v[182:185], 0
v_cvt_pk_bf16_f32 v132, v170, v171
v_cvt_pk_bf16_f32 v133, v172, v173
v_mfma_f32_16x16x32_bf16 v[142:145], a[28:31], v[186:189], v[142:145]
v_fma_f32 v220, v20, v126, v127
v_fma_f32 v221, v21, v126, v127
v_mfma_f32_16x16x32_bf16 v[146:149], a[48:51], v[182:185], 0
s_nop 0
ds_read_b128 v[170:173], v210 offset:34816
ds_read_b128 v[182:185], v210 offset:35840
v_mfma_f32_16x16x32_bf16 v[146:149], a[52:55], v[186:189], v[146:149]
s_waitcnt lgkmcnt(3)
ds_read_b128 v[174:177], v210 offset:34816
ds_read_b128 v[186:189], v210 offset:36864
v_fma_f32 v222, v22, v126, v127
v_mfma_f32_16x16x16_bf16 v[150:153], v[112:113], v[76:77], v[206:209]
v_fma_f32 v223, v23, v126, v127
v_cvt_pk_bf16_f32 v178, v220, v221
v_cvt_pk_bf16_f32 v179, v222, v223
v_cvt_pk_bf16_f32 v88, v158, v159
v_cvt_pk_bf16_f32 v89, v160, v161
v_cvt_pk_bf16_f32 v86, v154, v155
v_mfma_f32_16x16x32_bf16 v[150:153], v[108:111], v[72:75], v[150:153]
ds_write_b64 v212, v[178:179] offset:6144
v_mfma_f32_16x16x16_bf16 v[158:161], v[100:101], v[88:89], 0
v_cvt_pk_bf16_f32 v87, v156, v157
v_cvt_pk_bf16_f32 v124, v166, v167
v_cvt_pk_bf16_f32 v125, v168, v169
v_mfma_f32_16x16x16_bf16 v[154:157], v[82:83], v[88:89], 0
v_exp_f32_e64 v150, v150
v_fma_f32 v220, v24, v134, v135
v_mfma_f32_16x16x16_bf16 v[166:169], v[112:113], v[88:89], v[206:209]
s_waitcnt lgkmcnt(4)
ds_read_b128 v[178:181], v210 offset:35840
ds_write_b64 v212, v[94:95]
v_mfma_f32_16x16x32_bf16 v[138:141], a[8:11], v[170:173], v[138:141]
s_waitcnt lgkmcnt(5)
v_fma_f32 v221, v25, v134, v135
v_fma_f32 v222, v26, v134, v135
v_mfma_f32_16x16x32_bf16 v[138:141], a[12:15], v[182:185], v[138:141]
v_fma_f32 v223, v27, v134, v135
v_cvt_pk_bf16_f32 v116, v162, v163
v_mfma_f32_16x16x32_bf16 v[142:145], a[32:35], v[170:173], v[142:145]
v_cvt_pk_bf16_f32 v117, v164, v165
v_cvt_pk_bf16_f32 v90, v220, v221
v_mfma_f32_16x16x32_bf16 v[142:145], a[36:39], v[182:185], v[142:145]
v_cvt_pk_bf16_f32 v91, v222, v223
v_fma_f32 v220, v28, v134, v135
v_mfma_f32_16x16x32_bf16 v[146:149], a[56:59], v[170:173], v[146:149]
s_nop 0
ds_read_b128 v[170:173], v210 offset:37888
v_fma_f32 v221, v29, v134, v135
v_mfma_f32_16x16x32_bf16 v[146:149], a[60:63], v[182:185], v[146:149]
s_waitcnt lgkmcnt(4)
ds_read_b128 v[182:185], v210 offset:32768
v_fma_f32 v222, v30, v134, v135
v_mfma_f32_16x16x32_bf16 v[138:141], a[16:19], v[186:189], v[138:141]
v_fma_f32 v223, v31, v134, v135
v_cvt_pk_bf16_f32 v92, v220, v221
v_mfma_f32_16x16x32_bf16 v[142:145], a[40:43], v[186:189], v[142:145]
v_cvt_pk_bf16_f32 v93, v222, v223
v_fma_f32 v220, v32, v134, v135
v_mfma_f32_16x16x32_bf16 v[154:157], v[78:81], v[84:87], v[154:157]
ds_write_b128 v211, v[90:93] offset:12288
v_mfma_f32_16x16x32_bf16 v[146:149], a[64:67], v[186:189], v[146:149]
s_waitcnt lgkmcnt(2)
v_exp_f32 v154, v154
v_mfma_f32_16x16x32_bf16 v[138:141], a[20:23], v[170:173], v[138:141]
s_waitcnt lgkmcnt(1)
v_exp_f32 v155, v155
v_mfma_f32_16x16x32_bf16 v[118:121], v[182:185], a[72:75], 0
ds_read_b128 v[186:189], v210 offset:33792
v_fma_f32 v221, v33, v134, v135
v_mfma_f32_16x16x32_bf16 v[126:129], v[182:185], a[96:99], 0
v_cvt_pk_bf16_f32 v102, v138, v139
v_cvt_pk_bf16_f32 v103, v140, v141
v_fma_f32 v222, v34, v134, v135
v_mfma_f32_16x16x16_bf16 v[138:141], v[82:83], v[76:77], 0
v_exp_f32 v156, v156
v_exp_f32 v157, v157
v_mfma_f32_16x16x32_bf16 v[90:93], a[216:219], v[182:185], 0
v_fma_f32 v223, v35, v134, v135
v_cvt_pk_bf16_f32 v94, v220, v221
v_mfma_f32_16x16x32_bf16 v[138:141], v[78:81], v[72:75], v[138:141]
s_nop 0
v_cvt_pk_bf16_f32 v95, v222, v223
v_mfma_f32_16x16x32_bf16 v[134:137], v[182:185], a[120:123], 0
s_waitcnt lgkmcnt(0)
ds_write_b64 v212, v[94:95] offset:12288
v_mfma_f32_16x16x32_bf16 v[134:137], v[186:189], a[124:127], v[134:137]
v_exp_f32 v138, v138
v_mfma_f32_16x16x32_bf16 v[118:121], v[186:189], a[76:79], v[118:121]
v_exp_f32 v139, v139
v_mfma_f32_16x16x32_bf16 v[126:129], v[186:189], a[100:103], v[126:129]
v_exp_f32 v140, v140
v_mfma_f32_16x16x32_bf16 v[142:145], a[44:47], v[170:173], v[142:145]
v_exp_f32 v141, v141
v_mfma_f32_16x16x32_bf16 v[90:93], a[220:223], v[186:189], v[90:93]
v_mfma_f32_16x16x32_bf16 v[220:223], v[232:235], v[182:185], 0
v_cvt_pk_bf16_f32 v104, v142, v143
v_cvt_pk_bf16_f32 v105, v144, v145
v_mfma_f32_16x16x16_bf16 v[142:145], v[100:101], v[76:77], 0
v_mfma_f32_16x16x32_bf16 v[146:149], a[68:71], v[170:173], v[146:149]
v_mfma_f32_16x16x32_bf16 v[142:145], v[96:99], v[72:75], v[142:145]
v_mfma_f32_16x16x32_bf16 v[170:173], a[240:243], v[182:185], 0
v_cvt_pk_bf16_f32 v106, v146, v147
v_cvt_pk_bf16_f32 v107, v148, v149
v_mfma_f32_16x16x32_bf16 v[170:173], a[244:247], v[186:189], v[170:173]
v_exp_f32 v142, v142
v_mfma_f32_16x16x16_bf16 v[146:149], v[106:107], v[76:77], 0
v_exp_f32 v143, v143
v_exp_f32 v144, v144
v_mfma_f32_16x16x16_bf16 v[162:165], v[106:107], v[88:89], 0
v_exp_f32 v145, v145
v_mfma_f32_16x16x32_bf16 v[146:149], v[102:105], v[72:75], v[146:149]
ds_read_b128 v[182:185], v210 offset:36864
ds_read_b64 v[76:77], v215 offset:16
v_mfma_f32_16x16x32_bf16 v[220:223], v[236:239], v[186:189], v[220:223]
ds_read_b128 v[186:189], v210 offset:37888
ds_read_b128 v[72:75], v215
v_mfma_f32_16x16x32_bf16 v[158:161], v[96:99], v[84:87], v[158:161]
v_exp_f32 v146, v146
v_mfma_f32_16x16x32_bf16 v[118:121], v[174:177], a[80:83], v[118:121]
v_exp_f32 v147, v147
v_mfma_f32_16x16x32_bf16 v[118:121], v[178:181], a[84:87], v[118:121]
v_exp_f32 v158, v158
v_mfma_f32_16x16x32_bf16 v[126:129], v[174:177], a[104:107], v[126:129]
v_exp_f32 v159, v159
v_mfma_f32_16x16x32_bf16 v[126:129], v[178:181], a[108:111], v[126:129]
v_exp_f32 v160, v160
v_mfma_f32_16x16x32_bf16 v[134:137], v[174:177], a[128:131], v[134:137]
v_exp_f32 v161, v161
v_mfma_f32_16x16x32_bf16 v[134:137], v[178:181], a[132:135], v[134:137]
v_exp_f32 v148, v148
v_mfma_f32_16x16x32_bf16 v[166:169], v[108:111], v[84:87], v[166:169]
v_exp_f32 v149, v149
v_mfma_f32_16x16x32_bf16 v[90:93], a[224:227], v[174:177], v[90:93]
v_mfma_f32_16x16x32_bf16 v[90:93], a[228:231], v[178:181], v[90:93]
v_exp_f32_e64 v166, v166
v_mfma_f32_16x16x32_bf16 v[170:173], a[248:251], v[174:177], v[170:173]
v_mfma_f32_16x16x32_bf16 v[170:173], a[252:255], v[178:181], v[170:173]
v_mfma_f32_16x16x32_bf16 v[220:223], v[240:243], v[174:177], v[220:223]
v_cvt_pk_bf16_f32 v174, v138, v139
v_cvt_pk_bf16_f32 v175, v140, v141
v_mfma_f32_16x16x32_bf16 v[220:223], v[244:247], v[178:181], v[220:223]
s_nop 0
v_cvt_pk_bf16_f32 v176, v142, v143
v_cvt_pk_bf16_f32 v177, v144, v145
v_mfma_f32_16x16x32_bf16 v[162:165], v[102:105], v[84:87], v[162:165]
s_waitcnt lgkmcnt(3)
v_cvt_pk_bf16_f32 v180, v150, 0
v_cvt_pk_bf16_f32 v178, v146, v147
v_mfma_f32_16x16x32_bf16 v[118:121], v[182:185], a[88:91], v[118:121]
s_waitcnt lgkmcnt(1)
v_cvt_pk_bf16_f32 v179, v148, v149
v_mov_b32 v181, 0
v_mfma_f32_16x16x32_bf16 v[118:121], v[186:189], a[92:95], v[118:121]
v_exp_f32 v162, v162
v_mfma_f32_16x16x32_bf16 v[126:129], v[182:185], a[112:115], v[126:129]
v_exp_f32 v163, v163
v_mfma_f32_16x16x32_bf16 v[126:129], v[186:189], a[116:119], v[126:129]
v_exp_f32 v164, v164
v_mfma_f32_16x16x32_bf16 v[134:137], v[182:185], a[136:139], v[134:137]
v_exp_f32 v165, v165
v_mfma_f32_16x16x32_bf16 v[134:137], v[186:189], a[140:143], v[134:137]
v_cvt_pk_bf16_f32 v118, v118, v119
v_cvt_pk_bf16_f32 v119, v120, v121
v_mfma_f32_16x16x32_bf16 v[90:93], a[232:235], v[182:185], v[90:93]
ds_read_u16 v120, v214 offset:1024
v_mov_b32_e64 v121, 0
v_mfma_f32_16x16x32_bf16 v[90:93], a[236:239], v[186:189], v[90:93]
v_cvt_pk_bf16_f32 v126, v126, v127
v_cvt_pk_bf16_f32 v127, v128, v129
v_mfma_f32_16x16x32_bf16 v[170:173], v[224:227], v[182:185], v[170:173]
ds_read_u16 v128, v214 offset:1032
v_cvt_pk_bf16_f32 v134, v134, v135
v_mfma_f32_16x16x32_bf16 v[170:173], v[228:231], v[186:189], v[170:173]
v_cvt_pk_bf16_f32 v135, v136, v137
v_mov_b32_e64 v129, 0
v_mfma_f32_16x16x32_bf16 v[220:223], v[248:251], v[182:185], v[220:223]
ds_read_u16 v136, v214 offset:1040
v_mov_b32_e64 v137, 0
v_mfma_f32_16x16x32_bf16 v[220:223], v[252:255], v[186:189], v[220:223]
v_cvt_pk_bf16_f32 v90, v90, v91
v_cvt_pk_bf16_f32 v91, v92, v93
v_mfma_f32_16x16x32_bf16 v[150:153], v[190:193], v[174:177], 0
v_cvt_pk_bf16_f32 v92, v170, v171
v_cvt_pk_bf16_f32 v93, v172, v173
v_mfma_f32_16x16x32_bf16 v[150:153], v[190:193], v[178:181], v[150:153]
v_cvt_pk_bf16_f32 v94, v220, v221
v_cvt_pk_bf16_f32 v95, v222, v223
v_mfma_f32_16x16x32_bf16 v[138:141], v[114:117], v[174:177], 0
s_waitcnt lgkmcnt(2)
v_mfma_f32_16x16x32_bf16 v[138:141], v[118:121], v[178:181], v[138:141]
v_rcp_f32_e64 v151, v150
v_mfma_f32_16x16x32_bf16 v[142:145], v[122:125], v[174:177], 0
s_waitcnt lgkmcnt(1)
v_max3_u32 v218, v218, v150, v151
v_mul_f32_e64 v151, s3, v151
v_mfma_f32_16x16x32_bf16 v[142:145], v[126:129], v[178:181], v[142:145]
v_mul_f32_e64 v138, v138, v151
v_mul_f32 v139, v139, v151
v_mfma_f32_16x16x32_bf16 v[146:149], v[130:133], v[174:177], 0
s_waitcnt lgkmcnt(0)
v_cvt_pk_bf16_f32 v174, v154, v155
v_cvt_pk_bf16_f32 v175, v156, v157
v_mfma_f32_16x16x32_bf16 v[146:149], v[134:137], v[178:181], v[146:149]
v_cvt_pk_bf16_f32 v176, v158, v159
v_cvt_pk_bf16_f32 v177, v160, v161
v_cvt_pk_bf16_f32 v180, v166, 0
v_cvt_pk_bf16_f32 v178, v162, v163
v_mfma_f32_16x16x32_bf16 v[166:169], v[190:193], v[174:177], 0
v_cvt_pk_bf16_f32 v179, v164, v165
v_mul_f32 v140, v140, v151
v_mul_f32 v141, v141, v151
v_mfma_f32_16x16x32_bf16 v[166:169], v[190:193], v[178:181], v[166:169]
v_cvt_pk_bf16_f32 v138, v138, v139
v_mul_f32_e64 v142, v142, v151
v_mfma_f32_16x16x32_bf16 v[154:157], v[114:117], v[174:177], 0
v_mul_f32 v143, v143, v151
v_mul_f32 v144, v144, v151
v_mfma_f32_16x16x32_bf16 v[154:157], v[118:121], v[178:181], v[154:157]
v_mul_f32_e64 v145, v145, v151
v_cvt_pk_bf16_f32 v139, v140, v141
v_mfma_f32_16x16x32_bf16 v[158:161], v[122:125], v[174:177], 0
v_cvt_pk_bf16_f32 v140, v142, v143
v_cvt_pk_bf16_f32 v141, v144, v145
v_mfma_f32_16x16x32_bf16 v[158:161], v[126:129], v[178:181], v[158:161]
ds_write_b128 v211, v[138:141] offset:38912
v_mfma_f32_16x16x32_bf16 v[162:165], v[130:133], v[174:177], 0
v_mul_f32 v146, v146, v151
v_mul_f32 v147, v147, v151
v_mfma_f32_16x16x32_bf16 v[162:165], v[134:137], v[178:181], v[162:165]
v_mul_f32 v148, v148, v151
v_mul_f32 v149, v149, v151
v_cvt_pk_bf16_f32 v142, v146, v147
v_mfma_f32_16x16x16_bf16 v[138:141], v[82:83], v[94:95], 0
v_cvt_pk_bf16_f32 v143, v148, v149
v_rcp_f32_e64 v167, v166
v_mfma_f32_16x16x16_bf16 v[150:153], v[112:113], v[94:95], v[206:209]
v_max3_u32 v218, v218, v166, v167
v_mul_f32 v167, s3, v167
v_mul_f32 v154, v154, v167
v_mfma_f32_16x16x16_bf16 v[146:149], v[106:107], v[94:95], 0
v_mul_f32 v155, v155, v167
v_mul_f32 v156, v156, v167
v_mul_f32_e64 v157, v157, v167
v_cvt_pk_bf16_f32 v154, v154, v155
v_mfma_f32_16x16x32_bf16 v[138:141], v[78:81], v[90:93], v[138:141]
ds_write_b64 v212, v[142:143] offset:38912
v_mfma_f32_16x16x16_bf16 v[142:145], v[100:101], v[94:95], 0
v_mul_f32 v158, v158, v167
v_mul_f32 v159, v159, v167
v_mul_f32 v160, v160, v167
v_mul_f32 v161, v161, v167
v_mfma_f32_16x16x32_bf16 v[150:153], v[108:111], v[90:93], v[150:153]
v_cvt_pk_bf16_f32 v155, v156, v157
v_cvt_pk_bf16_f32 v156, v158, v159
v_mfma_f32_16x16x32_bf16 v[142:145], v[96:99], v[90:93], v[142:145]
v_cvt_pk_bf16_f32 v157, v160, v161
v_mul_f32_e64 v162, v162, v167
v_mfma_f32_16x16x32_bf16 v[146:149], v[102:105], v[90:93], v[146:149]
ds_write_b128 v211, v[154:157] offset:45056
v_mfma_f32_16x16x16_bf16 v[154:157], v[76:77], v[82:83], 0
v_mul_f32 v163, v163, v167
v_mul_f32 v164, v164, v167
v_mul_f32_e64 v165, v165, v167
v_mfma_f32_16x16x16_bf16 v[166:169], v[76:77], v[112:113], v[206:209]
v_cvt_pk_bf16_f32 v158, v162, v163
v_cvt_pk_bf16_f32 v159, v164, v165
v_exp_f32 v138, v138
v_mfma_f32_16x16x16_bf16 v[162:165], v[76:77], v[106:107], 0
v_exp_f32 v139, v139
v_exp_f32 v140, v140
v_mfma_f32_16x16x32_bf16 v[154:157], v[72:75], v[78:81], v[154:157]
ds_write_b64 v212, v[158:159] offset:45056
v_mfma_f32_16x16x16_bf16 v[158:161], v[76:77], v[100:101], 0
v_exp_f32 v141, v141
v_exp_f32 v142, v142
v_mfma_f32_16x16x32_bf16 v[162:165], v[72:75], v[102:105], v[162:165]
v_exp_f32 v143, v143
v_mfma_f32_16x16x32_bf16 v[158:161], v[72:75], v[96:99], v[158:161]
v_exp_f32 v144, v144
v_mfma_f32_16x16x32_bf16 v[166:169], v[72:75], v[108:111], v[166:169]
v_exp_f32 v145, v145
v_exp_f32 v150, v150
v_exp_f32 v146, v146
v_exp_f32 v147, v147
v_exp_f32 v148, v148
v_exp_f32_e64 v149, v149
v_cvt_pk_bf16_f32 v174, v138, v139
v_cvt_pk_bf16_f32 v175, v140, v141
v_cvt_pk_bf16_f32 v176, v142, v143
v_cvt_pk_bf16_f32 v177, v144, v145
v_cvt_pk_bf16_f32 v180, v150, 0
v_cvt_pk_bf16_f32 v178, v146, v147
v_mfma_f32_16x16x32_bf16 v[150:153], v[190:193], v[174:177], 0
s_waitcnt lgkmcnt(0)
v_cvt_pk_bf16_f32 v179, v148, v149
v_mov_b32_dpp v154, v158 quad_perm:[0,1,2,3] row_mask:0x2 bank_mask:0xf
v_mfma_f32_16x16x32_bf16 v[138:141], v[114:117], v[174:177], 0
s_barrier
v_mfma_f32_16x16x32_bf16 v[138:141], v[118:121], v[178:181], v[138:141]
ds_read_b128 v[220:223], v210 offset:38912
ds_read_b128 v[110:113], v210 offset:39936
v_mfma_f32_16x16x32_bf16 v[150:153], v[190:193], v[178:181], v[150:153]
ds_read_b128 v[170:173], v210 offset:40960
ds_read_b128 v[182:185], v210 offset:41984
v_mfma_f32_16x16x32_bf16 v[142:145], v[122:125], v[174:177], 0
v_mov_b32_dpp v154, v162 quad_perm:[0,1,2,3] row_mask:0x4 bank_mask:0xf
v_mfma_f32_16x16x32_bf16 v[142:145], v[126:129], v[178:181], v[142:145]
v_mov_b32_dpp v154, v167 quad_perm:[0,1,2,3] row_mask:0x8 bank_mask:0xf
v_exp_f32 v154, v154
v_mfma_f32_16x16x32_bf16 v[146:149], v[130:133], v[174:177], 0
v_cvt_pk_bf16_f32 v154, v154, 0
v_rcp_f32 v151, v150
v_mfma_f32_16x16x32_bf16 v[146:149], v[134:137], v[178:181], v[146:149]
s_waitcnt lgkmcnt(3)
ds_write_b16 v214, v154
v_mfma_f32_16x16x32_bf16 v[36:39], a[144:147], v[220:223], v[36:39]
s_waitcnt lgkmcnt(3)
ds_read_b128 v[84:87], v215
ds_read_b128 v[88:91], v215 offset:16
v_mfma_f32_16x16x32_bf16 v[36:39], a[148:151], v[110:113], v[36:39]
ds_read_b128 v[186:189], v210 offset:43008
ds_read_b128 v[174:177], v217
v_mfma_f32_16x16x32_bf16 v[40:43], a[168:171], v[220:223], v[40:43]
ds_read_b128 v[178:181], v217 offset:528
v_add_u32 v215, 1552, v215
v_mfma_f32_16x16x32_bf16 v[40:43], a[172:175], v[110:113], v[40:43]
v_mfma_f32_16x16x32_bf16 v[44:47], a[192:195], v[220:223], v[44:47]
ds_read_b128 v[220:223], v210 offset:44032
v_mfma_f32_16x16x32_bf16 v[44:47], a[196:199], v[110:113], v[44:47]
s_nop 0
ds_read_b128 v[110:113], v210 offset:45056
s_waitcnt lgkmcnt(6)
v_mfma_f32_16x16x32_bf16 v[166:169], v[84:87], v[190:193], 0
s_waitcnt lgkmcnt(5)
v_mfma_f32_16x16x32_bf16 v[166:169], v[88:91], v[190:193], v[166:169]
v_mfma_f32_16x16x32_bf16 v[154:157], v[84:87], v[114:117], 0
v_mfma_f32_16x16x32_bf16 v[154:157], v[88:91], v[118:121], v[154:157]
v_rcp_f32 v167, v166
v_mfma_f32_16x16x32_bf16 v[158:161], v[84:87], v[122:125], 0
v_max3_u32 v218, v218, v166, v167
v_max3_u32 v218, v218, v150, v151
v_mfma_f32_16x16x32_bf16 v[158:161], v[88:91], v[126:129], v[158:161]
v_mul_f32 v151, s3, v151
v_mul_f32 v138, v138, v151
v_mfma_f32_16x16x32_bf16 v[162:165], v[84:87], v[130:133], 0
v_mul_f32 v139, v139, v151
v_mul_f32 v140, v140, v151
v_mfma_f32_16x16x32_bf16 v[162:165], v[88:91], v[134:137], v[162:165]
v_mul_f32_e64 v141, v141, v151
v_cvt_pk_bf16_f32 v138, v138, v139
v_mfma_f32_16x16x32_bf16 v[36:39], a[152:155], v[170:173], v[36:39]
v_mul_f32 v142, v142, v151
v_mul_f32 v143, v143, v151
v_mfma_f32_16x16x32_bf16 v[36:39], a[156:159], v[182:185], v[36:39]
s_waitcnt lgkmcnt(4)
v_mul_f32 v144, v144, v151
v_mul_f32_e64 v145, v145, v151
v_mfma_f32_16x16x32_bf16 v[36:39], a[160:163], v[186:189], v[36:39]
v_cvt_pk_bf16_f32 v139, v140, v141
v_cvt_pk_bf16_f32 v140, v142, v143
v_mfma_f32_16x16x32_bf16 v[40:43], a[176:179], v[170:173], v[40:43]
v_cvt_pk_bf16_f32 v141, v144, v145
v_mul_f32_e64 v146, v146, v151
v_mfma_f32_16x16x32_bf16 v[40:43], a[180:183], v[182:185], v[40:43]
ds_write_b128 v211, v[138:141] offset:51200
v_mfma_f32_16x16x32_bf16 v[40:43], a[184:187], v[186:189], v[40:43]
v_mul_f32 v147, v147, v151
v_mul_f32 v148, v148, v151
v_mfma_f32_16x16x32_bf16 v[44:47], a[200:203], v[170:173], v[44:47]
v_mul_f32_e64 v149, v149, v151
v_cvt_pk_bf16_f32 v142, v146, v147
v_mfma_f32_16x16x32_bf16 v[44:47], a[204:207], v[182:185], v[44:47]
s_nop 0
ds_read_b128 v[170:173], v210 offset:46080
ds_read_b128 v[182:185], v210 offset:47104
v_mfma_f32_16x16x32_bf16 v[44:47], a[208:211], v[186:189], v[44:47]
s_waitcnt lgkmcnt(4)
ds_read_b128 v[186:189], v210 offset:48128
v_cvt_pk_bf16_f32 v143, v148, v149
v_mfma_f32_16x16x32_bf16 v[44:47], a[212:215], v[220:223], v[44:47]
ds_write_b64 v212, v[142:143] offset:51200
v_mfma_f32_16x16x32_bf16 v[36:39], a[164:167], v[220:223], v[36:39]
v_mov_b32_dpp v154, v158 quad_perm:[0,1,2,3] row_mask:0x2 bank_mask:0xf
v_mul_f32 v167, s3, v167
v_mfma_f32_16x16x32_bf16 v[40:43], a[188:191], v[220:223], v[40:43]
s_waitcnt lgkmcnt(5)
ds_read_b128 v[220:223], v210 offset:49152
v_mov_b32_dpp v154, v162 quad_perm:[0,1,2,3] row_mask:0x4 bank_mask:0xf
v_mfma_f32_16x16x32_bf16 v[48:51], a[144:147], v[110:113], v[48:51]
s_waitcnt lgkmcnt(4)
v_cvt_pk_bf16_f32 v72, v36, v37
v_cvt_pk_bf16_f32 v73, v38, v39
v_mfma_f32_16x16x32_bf16 v[48:51], a[148:151], v[170:173], v[48:51]
s_waitcnt lgkmcnt(3)
buffer_store_dwordx2 v[72:73], v203, s[8:11], s39 offen
v_mul_f32 v154, v154, v167
v_mfma_f32_16x16x32_bf16 v[48:51], a[152:155], v[182:185], v[48:51]
s_waitcnt lgkmcnt(2)
v_cvt_pk_bf16_f32 v154, v154, 0
v_cvt_pk_bf16_f32 v74, v40, v41
v_mfma_f32_16x16x32_bf16 v[48:51], a[156:159], v[186:189], v[48:51]
ds_write_b16 v214, v154
v_mfma_f32_16x16x32_bf16 v[52:55], a[168:171], v[110:113], v[52:55]
s_nop 0
v_cvt_pk_bf16_f32 v75, v42, v43
v_cvt_pk_bf16_f32 v76, v44, v45
v_mfma_f32_16x16x32_bf16 v[52:55], a[172:175], v[170:173], v[52:55]
s_waitcnt lgkmcnt(2)
v_cvt_pk_bf16_f32 v77, v46, v47
v_add_u32 v214, 1552, v214
v_mfma_f32_16x16x32_bf16 v[52:55], a[176:179], v[182:185], v[52:55]
s_barrier
v_mfma_f32_16x16x32_bf16 v[52:55], a[180:183], v[186:189], v[52:55]
v_mfma_f32_16x16x32_bf16 v[56:59], a[192:195], v[110:113], v[56:59]
ds_read_b128 v[110:113], v210 offset:50176
v_mfma_f32_16x16x32_bf16 v[56:59], a[196:199], v[170:173], v[56:59]
ds_read_b128 v[170:173], v210 offset:51200
v_mfma_f32_16x16x32_bf16 v[56:59], a[200:203], v[182:185], v[56:59]
ds_read_b128 v[182:185], v210 offset:52224
v_mfma_f32_16x16x32_bf16 v[56:59], a[204:207], v[186:189], v[56:59]
ds_read_b128 v[186:189], v210 offset:53248
s_waitcnt lgkmcnt(5)
v_mfma_f32_16x16x32_bf16 v[56:59], a[208:211], v[220:223], v[56:59]
v_mfma_f32_16x16x32_bf16 v[48:51], a[160:163], v[220:223], v[48:51]
s_nop 0
buffer_store_dwordx2 v[74:75], v203, s[8:11], s39 offen offset:32
s_waitcnt lgkmcnt(3)
v_mfma_f32_16x16x32_bf16 v[48:51], a[164:167], v[110:113], v[48:51]
v_mfma_f32_16x16x32_bf16 v[52:55], a[184:187], v[220:223], v[52:55]
ds_read_b128 v[220:223], v210 offset:54272
v_mfma_f32_16x16x32_bf16 v[52:55], a[188:191], v[110:113], v[52:55]
v_cvt_pk_bf16_f32 v78, v48, v49
v_cvt_pk_bf16_f32 v79, v50, v51
v_mfma_f32_16x16x32_bf16 v[56:59], a[212:215], v[110:113], v[56:59]
ds_read_b128 v[110:113], v210 offset:55296
s_waitcnt lgkmcnt(4)
v_mfma_f32_16x16x32_bf16 v[60:63], a[144:147], v[170:173], v[60:63]
s_waitcnt lgkmcnt(3)
v_cvt_pk_bf16_f32 v80, v52, v53
v_cvt_pk_bf16_f32 v81, v54, v55
v_mfma_f32_16x16x32_bf16 v[60:63], a[148:151], v[182:185], v[60:63]
s_waitcnt lgkmcnt(2)
v_cvt_pk_bf16_f32 v82, v56, v57
v_cvt_pk_bf16_f32 v83, v58, v59
v_mfma_f32_16x16x32_bf16 v[60:63], a[152:155], v[186:189], v[60:63]
s_waitcnt lgkmcnt(1)
v_mfma_f32_16x16x32_bf16 v[60:63], a[156:159], v[220:223], v[60:63]
v_mfma_f32_16x16x32_bf16 v[64:67], a[168:171], v[170:173], v[64:67]
v_mfma_f32_16x16x32_bf16 v[64:67], a[172:175], v[182:185], v[64:67]
v_mfma_f32_16x16x32_bf16 v[64:67], a[176:179], v[186:189], v[64:67]
v_mfma_f32_16x16x32_bf16 v[64:67], a[180:183], v[220:223], v[64:67]
v_mfma_f32_16x16x32_bf16 v[68:71], a[192:195], v[170:173], v[68:71]
ds_read_b128 v[170:173], v210 offset:56320
v_mfma_f32_16x16x32_bf16 v[68:71], a[196:199], v[182:185], v[68:71]
ds_read_b128 v[182:185], v210
v_mfma_f32_16x16x32_bf16 v[68:71], a[200:203], v[186:189], v[68:71]
ds_read_b128 v[186:189], v210 offset:1024
buffer_store_dwordx2 v[76:77], v203, s[8:11], s39 offen offset:64
v_mfma_f32_16x16x32_bf16 v[68:71], a[204:207], v[220:223], v[68:71]
ds_read_b128 v[220:223], v210 offset:3072
s_waitcnt lgkmcnt(4)
v_mfma_f32_16x16x32_bf16 v[68:71], a[208:211], v[110:113], v[68:71]
v_mfma_f32_16x16x32_bf16 v[60:63], a[160:163], v[110:113], v[60:63]
s_waitcnt lgkmcnt(3)
v_mfma_f32_16x16x32_bf16 v[60:63], a[164:167], v[170:173], v[60:63]
v_mfma_f32_16x16x32_bf16 v[64:67], a[184:187], v[110:113], v[64:67]
ds_read_b128 v[110:113], v210 offset:2048
v_mfma_f32_16x16x32_bf16 v[64:67], a[188:191], v[170:173], v[64:67]
v_cvt_pk_bf16_f32 v116, v60, v61
v_subrev_u32 v60, 37120, v210
v_mfma_f32_16x16x32_bf16 v[68:71], a[212:215], v[170:173], v[68:71]
s_waitcnt lgkmcnt(3)
v_lshrrev_b32 v61, 4, v60
v_cvt_pk_bf16_f32 v117, v62, v63
v_mfma_f32_16x16x32_bf16 v[138:141], a[0:3], v[182:185], 0
s_waitcnt lgkmcnt(2)
v_cvt_pk_bf16_f32 v124, v64, v65
v_and_b32 v61, 15, v61
v_mfma_f32_16x16x32_bf16 v[138:141], a[4:7], v[186:189], v[138:141]
v_cvt_pk_bf16_f32 v133, v70, v71
v_mov_b32_dpp v71, v200 row_newbcast:0 row_mask:0xf bank_mask:0xf
v_mfma_f32_16x16x32_bf16 v[142:145], a[24:27], v[182:185], 0
v_add_u32 v71, 17248, v71
v_cvt_pk_bf16_f32 v132, v68, v69
v_mfma_f32_16x16x32_bf16 v[142:145], a[28:31], v[186:189], v[142:145]
ds_read_b128 v[84:87], v71
v_mov_b32_dpp v69, v194 row_newbcast:0 row_mask:0xf bank_mask:0xf
v_mfma_f32_16x16x32_bf16 v[146:149], a[48:51], v[182:185], 0
v_add_u32 v69, 17248, v69
v_mov_b32_dpp v70, v197 row_newbcast:0 row_mask:0xf bank_mask:0xf
v_mfma_f32_16x16x32_bf16 v[146:149], a[52:55], v[186:189], v[146:149]
ds_read_b128 v[92:95], v69
ds_read_b128 v[96:99], v69 offset:16
v_mfma_f32_16x16x32_bf16 v[150:153], a[216:219], v[182:185], 0
s_nop 0
v_add_u32 v70, 17248, v70
v_lshrrev_b32 v62, 8, v60
v_mfma_f32_16x16x32_bf16 v[150:153], a[220:223], v[186:189], v[150:153]
ds_read_b128 v[100:103], v70
ds_read_b128 v[104:107], v70 offset:16
v_mfma_f32_16x16x32_bf16 v[154:157], a[240:243], v[182:185], 0
s_nop 0
v_mul_u32_u24 v63, 1552, v61
v_mul_u32_u24 v64, 784, v61
v_mfma_f32_16x16x32_bf16 v[154:157], a[244:247], v[186:189], v[154:157]
s_waitcnt lgkmcnt(4)
v_lshl_add_u32 v63, v62, 5, v63
v_lshl_add_u32 v64, v62, 4, v64
v_mfma_f32_16x16x32_bf16 v[48:51], v[174:177], v[84:87], 0
ds_read_b128 v[174:177], v217 offset:1056
ds_read_b128 v[84:87], v71 offset:32
v_mfma_f32_16x16x32_bf16 v[158:161], v[232:235], v[182:185], 0
s_nop 0
v_add_u32 v63, 94464, v63
v_add_u32 v64, s41, v64
v_mfma_f32_16x16x32_bf16 v[158:161], v[236:239], v[186:189], v[158:161]
s_waitcnt lgkmcnt(4)
ds_read_b128 v[36:39], v64
ds_read_b128 v[88:91], v63 offset:128
v_smfmac_f32_16x16x64_bf16 v[48:51], v[178:181], v[92:99], v213
s_add_u32 s41, s33, 0
ds_read_b128 v[178:181], v217 offset:1584
ds_read_b128 v[92:95], v69 offset:32
v_mfma_f32_16x16x32_bf16 v[162:165], v[182:185], a[72:75], 0
ds_read_b128 v[96:99], v69 offset:48
ds_read_b128 v[40:43], v64 offset:64
v_mfma_f32_16x16x32_bf16 v[162:165], v[186:189], a[76:79], v[162:165]
s_nop 0
ds_read_b128 v[44:47], v64 offset:128
buffer_store_dwordx2 v[78:79], v204, s[8:11], s39 offen
v_cvt_pk_bf16_f32 v125, v66, v67
s_waitcnt lgkmcnt(8)
v_smfmac_f32_16x16x64_bf16 v[48:51], v[174:177], v[100:107], v213
ds_read_b128 v[174:177], v217 offset:2112
ds_read_b128 v[100:103], v70 offset:32
v_mfma_f32_16x16x32_bf16 v[166:169], v[182:185], a[96:99], 0
v_lshlrev_b32 v67, 5, v61
v_add_u32 v67, s41, v67
v_mfma_f32_16x16x32_bf16 v[166:169], v[186:189], a[100:103], v[166:169]
s_add_u32 s41, s33, 512
ds_read_b128 v[104:107], v70 offset:48
v_mul_f32 v119, v48, v48
v_mfma_f32_16x16x32_bf16 v[170:173], v[182:185], a[120:123], 0
s_waitcnt lgkmcnt(7)
ds_read_b128 v[182:185], v210 offset:4096
v_add_f32_e64 v118, v48, v49
v_mfma_f32_16x16x32_bf16 v[52:55], v[178:181], v[84:87], 0
ds_read_b128 v[178:181], v217 offset:2640
ds_read_b128 v[84:87], v71 offset:64
v_mfma_f32_16x16x32_bf16 v[170:173], v[186:189], a[124:127], v[170:173]
v_fmac_f32 v119, v49, v49
v_add_f32 v118, v118, v50
v_mfma_f32_16x16x32_bf16 v[138:141], a[8:11], v[110:113], v[138:141]
ds_read_b128 v[186:189], v210 offset:5120
v_fmac_f32_e64 v119, v50, v50
v_mfma_f32_16x16x32_bf16 v[138:141], a[12:15], v[220:223], v[138:141]
v_add_f32_e64 v118, v118, v51
v_fmac_f32 v119, v51, v51
v_mfma_f32_16x16x32_bf16 v[142:145], a[32:35], v[110:113], v[142:145]
s_waitcnt lgkmcnt(6)
v_mul_hi_u32 v68, v67, s42
v_mul_u32_u24 v65, 73, v68
v_smfmac_f32_16x16x64_bf16 v[52:55], v[174:177], v[92:99], v213
s_mov_b32 s42, 1373568
ds_read_b128 v[174:177], v217 offset:3168
ds_read_b128 v[92:95], v69 offset:64
v_mfma_f32_16x16x32_bf16 v[142:145], a[36:39], v[220:223], v[142:145]
ds_read_b128 v[96:99], v69 offset:80
v_mul_lo_u32 v68, v68, s42
v_mfma_f32_16x16x32_bf16 v[146:149], a[56:59], v[110:113], v[146:149]
s_nop 0
buffer_store_dwordx2 v[80:81], v204, s[8:11], s39 offen offset:32
v_sub_u32 v65, v67, v65
v_mfma_f32_16x16x32_bf16 v[146:149], a[60:63], v[220:223], v[146:149]
s_waitcnt lgkmcnt(5)
v_mul_u32_u24 v65, 2688, v65
v_cmp_gt_u32 vcc, s34, v67
v_smfmac_f32_16x16x64_bf16 v[52:55], v[178:181], v[100:107], v213
s_mul_i32 s42, s32, 96
ds_read_b128 v[178:181], v217 offset:3696
ds_read_b128 v[100:103], v70 offset:64
v_mfma_f32_16x16x32_bf16 v[150:153], a[224:227], v[110:113], v[150:153]
ds_read_b128 v[104:107], v70 offset:80
v_add3_u32 v65, v65, v68, s42
v_mfma_f32_16x16x32_bf16 v[150:153], a[228:231], v[220:223], v[150:153]
s_waitcnt lgkmcnt(5)
v_add_f32 v118, v118, v52
v_fmac_f32_e64 v119, v52, v52
v_mfma_f32_16x16x32_bf16 v[56:59], v[174:177], v[84:87], 0
s_mov_b32 s42, 58835169
ds_read_b128 v[174:177], v217 offset:4224
ds_read_b128 v[84:87], v63
v_mfma_f32_16x16x32_bf16 v[154:157], a[248:251], v[110:113], v[154:157]
v_add_f32 v118, v118, v53
v_fmac_f32 v119, v53, v53
v_mfma_f32_16x16x32_bf16 v[154:157], a[252:255], v[220:223], v[154:157]
v_add_f32 v118, v118, v54
v_fmac_f32 v119, v54, v54
v_mfma_f32_16x16x32_bf16 v[158:161], v[240:243], v[110:113], v[158:161]
s_waitcnt lgkmcnt(4)
v_add_f32 v118, v118, v55
v_fmac_f32_e64 v119, v55, v55
v_smfmac_f32_16x16x64_bf16 v[56:59], v[178:181], v[92:99], v213
ds_read_b128 v[92:95], v63 offset:256
ds_read_b128 v[96:99], v63 offset:384
v_mfma_f32_16x16x32_bf16 v[158:161], v[244:247], v[220:223], v[158:161]
ds_read_b128 v[178:181], v210 offset:15360
v_mov_b32 v68, 1879048192
v_mfma_f32_16x16x32_bf16 v[162:165], v[110:113], a[80:83], v[162:165]
s_waitcnt lgkmcnt(4)
v_cndmask_b32 v65, v68, v65, vcc
v_lshlrev_b32 v67, 5, v61
v_smfmac_f32_16x16x64_bf16 v[56:59], v[174:177], v[100:107], v213
s_waitcnt lgkmcnt(3)
ds_read_b64 v[100:101], v63 offset:16
ds_read_b64 v[102:103], v63 offset:144
v_mfma_f32_16x16x32_bf16 v[36:39], a[144:147], v[84:87], v[36:39]
ds_read_b64 v[104:105], v63 offset:272
ds_read_b64 v[106:107], v63 offset:400
v_mfma_f32_16x16x32_bf16 v[36:39], a[148:151], v[88:91], v[36:39]
v_add_f32 v118, v118, v56
v_fmac_f32 v119, v56, v56
v_mfma_f32_16x16x32_bf16 v[40:43], a[168:171], v[84:87], v[40:43]
s_waitcnt lgkmcnt(6)
v_add_f32 v118, v118, v57
v_fmac_f32 v119, v57, v57
v_mfma_f32_16x16x32_bf16 v[36:39], a[152:155], v[92:95], v[36:39]
s_waitcnt lgkmcnt(5)
buffer_store_dwordx2 v[82:83], v204, s[8:11], s39 offen offset:64
v_add_f32 v118, v118, v58
v_mfma_f32_16x16x32_bf16 v[36:39], a[156:159], v[96:99], v[36:39]
s_waitcnt lgkmcnt(2)
v_fmac_f32 v119, v58, v58
v_add_f32 v118, v118, v59
v_mfma_f32_16x16x32_bf16 v[36:39], a[160:163], v[100:103], v[36:39]
s_waitcnt lgkmcnt(0)
v_fmac_f32 v119, v59, v59
v_cmp_gt_u32 vcc, 4, v61
v_mfma_f32_16x16x32_bf16 v[36:39], a[164:167], v[104:107], v[36:39]
v_permlane16_swap_b32 v118, v119
v_mfma_f32_16x16x32_bf16 v[40:43], a[172:175], v[88:91], v[40:43]
v_add_f32 v118, v118, v119
v_mov_b32 v126, v118
v_mfma_f32_16x16x32_bf16 v[40:43], a[176:179], v[92:95], v[40:43]
v_permlane32_swap_b32 v118, v126
v_mfma_f32_16x16x32_bf16 v[40:43], a[180:183], v[96:99], v[40:43]
v_add_f32 v118, v118, v126
v_mov_b32 v68, s97
v_mfma_f32_16x16x32_bf16 v[40:43], a[184:187], v[100:103], v[40:43]
ds_write_b32 v209, v118
v_mfma_f32_16x16x32_bf16 v[40:43], a[188:191], v[104:107], v[40:43]
ds_read_b128 v[174:177], v210 offset:14336
v_add_u32 v67, s41, v67
v_mfma_f32_16x16x32_bf16 v[44:47], a[192:195], v[84:87], v[44:47]
v_cndmask_b32 v67, v68, v67, vcc
v_cmp_gt_u32 vcc, 5, v61
v_mfma_f32_16x16x32_bf16 v[44:47], a[196:199], v[88:91], v[44:47]
s_nop 0
v_mov_b32 v68, 6000
v_cndmask_b32 v67, v68, v67, vcc
v_mfma_f32_16x16x32_bf16 v[44:47], a[200:203], v[92:95], v[44:47]
v_mul_hi_u32 v68, v67, s42
v_mul_u32_u24 v66, 73, v68
v_mfma_f32_16x16x32_bf16 v[44:47], a[204:207], v[96:99], v[44:47]
s_mov_b32 s42, 1373568
v_mul_lo_u32 v68, v68, s42
v_sub_u32 v66, v67, v66
v_mfma_f32_16x16x32_bf16 v[44:47], a[208:211], v[100:103], v[44:47]
s_waitcnt lgkmcnt(1)
v_mul_u32_u24 v66, 2688, v66
v_cmp_gt_u32 vcc, s34, v67
v_mfma_f32_16x16x32_bf16 v[44:47], a[212:215], v[104:107], v[44:47]
s_barrier
v_mfma_f32_16x16x32_bf16 v[162:165], v[220:223], a[84:87], v[162:165]
s_mul_i32 s42, s32, 96
ds_read_b128 v[102:105], v210 offset:18432
ds_read_b128 v[106:109], v210 offset:19456
v_mfma_f32_16x16x32_bf16 v[166:169], v[110:113], a[104:107], v[166:169]
buffer_store_dwordx2 v[116:117], v205, s[8:11], s39 offen
v_add3_u32 v66, v66, v68, s42
v_mfma_f32_16x16x32_bf16 v[166:169], v[220:223], a[108:111], v[166:169]
s_nop 0
v_mov_b32 v68, 1879048192
v_cndmask_b32 v66, v68, v66, vcc
v_mfma_f32_16x16x32_bf16 v[170:173], v[110:113], a[128:131], v[170:173]
ds_read_b128 v[110:113], v210 offset:6144
v_lshl_add_u32 v65, v62, 3, v65
v_mfma_f32_16x16x32_bf16 v[170:173], v[220:223], a[132:135], v[170:173]
ds_read_b128 v[220:223], v210 offset:7168
v_cvt_pk_bf16_f32 v36, v36, v37
v_mfma_f32_16x16x32_bf16 v[138:141], a[16:19], v[182:185], v[138:141]
s_waitcnt lgkmcnt(3)
v_add_f32 v102, v102, v103
v_add_f32_e64 v104, v104, v105
v_mfma_f32_16x16x32_bf16 v[138:141], a[20:23], v[186:189], v[138:141]
s_waitcnt lgkmcnt(2)
v_add_f32 v106, v106, v107
v_add_f32_e64 v108, v108, v109
v_mfma_f32_16x16x32_bf16 v[142:145], a[40:43], v[182:185], v[142:145]
v_add_f32 v102, v102, v104
v_add_f32 v106, v106, v108
v_mfma_f32_16x16x32_bf16 v[142:145], a[44:47], v[186:189], v[142:145]
v_cvt_pk_bf16_f32 v78, v138, v139
v_cvt_pk_bf16_f32 v79, v140, v141
v_mfma_f32_16x16x32_bf16 v[146:149], a[64:67], v[182:185], v[146:149]
v_mul_f32 v103, s48, v102
v_mul_f32 v104, s73, v102
v_mfma_f32_16x16x32_bf16 v[146:149], a[68:71], v[186:189], v[146:149]
v_cvt_pk_bf16_f32 v80, v142, v143
v_cvt_pk_bf16_f32 v81, v144, v145
v_mfma_f32_16x16x32_bf16 v[150:153], a[232:235], v[182:185], v[150:153]
v_mul_f32_e64 v106, s73, v106
v_fma_f32 v106, -v103, v104, v106
v_mfma_f32_16x16x32_bf16 v[150:153], a[236:239], v[186:189], v[150:153]
v_cvt_pk_bf16_f32 v82, v146, v147
v_cvt_pk_bf16_f32 v83, v148, v149
v_mfma_f32_16x16x32_bf16 v[154:157], v[224:227], v[182:185], v[154:157]
v_max_f32 v106, 0, v106
v_add_f32 v106, s49, v106
v_mfma_f32_16x16x32_bf16 v[154:157], v[228:231], v[186:189], v[154:157]
v_cvt_pk_bf16_f32 v72, v150, v151
v_cvt_pk_bf16_f32 v73, v152, v153
v_mfma_f32_16x16x32_bf16 v[158:161], v[248:251], v[182:185], v[158:161]
v_rsq_f32_e64 v102, v106
v_mfma_f32_16x16x32_bf16 v[158:161], v[252:255], v[186:189], v[158:161]
ds_read_b128 v[106:109], v210 offset:11264
v_cvt_pk_bf16_f32 v74, v154, v155
v_mfma_f32_16x16x32_bf16 v[162:165], v[182:185], a[88:91], v[162:165]
v_cvt_pk_bf16_f32 v75, v156, v157
v_mul_f32_e64 v103, -v103, v102
v_mfma_f32_16x16x32_bf16 v[162:165], v[186:189], a[92:95], v[162:165]
ds_write_b64 v211, v[102:103] offset:20480
v_mfma_f32_16x16x32_bf16 v[166:169], v[182:185], a[112:115], v[166:169]
v_cvt_pk_bf16_f32 v76, v158, v159
v_cvt_pk_bf16_f32 v77, v160, v161
v_mfma_f32_16x16x32_bf16 v[166:169], v[186:189], a[116:119], v[166:169]
ds_read_b64 v[118:119], v219 offset:20480
v_cvt_pk_bf16_f32 v114, v162, v163
v_mfma_f32_16x16x32_bf16 v[170:173], v[182:185], a[136:139], v[170:173]
ds_read_b128 v[182:185], v210 offset:8192
v_cvt_pk_bf16_f32 v115, v164, v165
v_mfma_f32_16x16x32_bf16 v[170:173], v[186:189], a[140:143], v[170:173]
s_waitcnt lgkmcnt(5)
ds_read_b128 v[186:189], v210 offset:9216
v_cvt_pk_bf16_f32 v122, v166, v167
v_mfma_f32_16x16x32_bf16 v[138:141], a[0:3], v[110:113], 0
s_waitcnt lgkmcnt(5)
v_cvt_pk_bf16_f32 v123, v168, v169
v_cvt_pk_bf16_f32 v40, v40, v41
v_mfma_f32_16x16x32_bf16 v[138:141], a[4:7], v[220:223], v[138:141]
v_cvt_pk_bf16_f32 v130, v170, v171
v_cvt_pk_bf16_f32 v131, v172, v173
v_mfma_f32_16x16x32_bf16 v[142:145], a[24:27], v[110:113], 0
buffer_store_dwordx2 v[124:125], v205, s[8:11], s39 offen offset:32
v_cvt_pk_bf16_f32 v44, v44, v45
v_mfma_f32_16x16x32_bf16 v[142:145], a[28:31], v[220:223], v[142:145]
v_lshl_add_u32 v66, v62, 3, v66
v_add_u32 v65, 785664, v65
v_mfma_f32_16x16x32_bf16 v[146:149], a[48:51], v[110:113], 0
v_cvt_pk_bf16_f32 v37, v38, v39
v_cvt_pk_bf16_f32 v41, v42, v43
v_mfma_f32_16x16x32_bf16 v[146:149], a[52:55], v[220:223], v[146:149]
v_cvt_pk_bf16_f32 v45, v46, v47
v_add_u32 v66, 785664, v66
v_mfma_f32_16x16x32_bf16 v[150:153], a[216:219], v[110:113], 0
v_mfma_f32_16x16x32_bf16 v[150:153], a[220:223], v[220:223], v[150:153]
v_mfma_f32_16x16x32_bf16 v[154:157], a[240:243], v[110:113], 0
v_mfma_f32_16x16x32_bf16 v[154:157], a[244:247], v[220:223], v[154:157]
v_mfma_f32_16x16x32_bf16 v[158:161], v[232:235], v[110:113], 0
v_mfma_f32_16x16x32_bf16 v[158:161], v[236:239], v[220:223], v[158:161]
v_mfma_f32_16x16x32_bf16 v[162:165], v[110:113], a[72:75], 0
v_mfma_f32_16x16x32_bf16 v[162:165], v[220:223], a[76:79], v[162:165]
v_mfma_f32_16x16x32_bf16 v[166:169], v[110:113], a[96:99], 0
buffer_store_dwordx2 v[132:133], v205, s[8:11], s39 offen offset:64
v_mfma_f32_16x16x32_bf16 v[166:169], v[220:223], a[100:103], v[166:169]
v_mfma_f32_16x16x32_bf16 v[170:173], v[110:113], a[120:123], 0
ds_read_b128 v[110:113], v210 offset:10240
v_mfma_f32_16x16x32_bf16 v[170:173], v[220:223], a[124:127], v[170:173]
s_waitcnt lgkmcnt(2)
v_fma_f32 v220, v48, v118, v119
v_fma_f32 v221, v49, v118, v119
v_mfma_f32_16x16x32_bf16 v[138:141], a[8:11], v[182:185], v[138:141]
s_waitcnt lgkmcnt(1)
v_fma_f32 v222, v50, v118, v119
v_fma_f32 v223, v51, v118, v119
v_mfma_f32_16x16x32_bf16 v[138:141], a[12:15], v[186:189], v[138:141]
v_cvt_pk_bf16_f32 v90, v220, v221
v_cvt_pk_bf16_f32 v91, v222, v223
v_mfma_f32_16x16x32_bf16 v[142:145], a[32:35], v[182:185], v[142:145]
v_fma_f32 v220, v52, v118, v119
v_fma_f32 v221, v53, v118, v119
v_mfma_f32_16x16x32_bf16 v[142:145], a[36:39], v[186:189], v[142:145]
v_fma_f32 v222, v54, v118, v119
v_fma_f32 v223, v55, v118, v119
v_mfma_f32_16x16x32_bf16 v[146:149], a[56:59], v[182:185], v[146:149]
v_cvt_pk_bf16_f32 v92, v220, v221
v_cvt_pk_bf16_f32 v93, v222, v223
v_mfma_f32_16x16x32_bf16 v[146:149], a[60:63], v[186:189], v[146:149]
ds_write_b128 v211, v[90:93] offset:20480
v_mfma_f32_16x16x32_bf16 v[150:153], a[224:227], v[182:185], v[150:153]
v_fma_f32 v220, v56, v118, v119
v_fma_f32 v221, v57, v118, v119
v_mfma_f32_16x16x32_bf16 v[150:153], a[228:231], v[186:189], v[150:153]
v_fma_f32 v222, v58, v118, v119
v_fma_f32 v223, v59, v118, v119
v_mfma_f32_16x16x32_bf16 v[154:157], a[248:251], v[182:185], v[154:157]
v_cvt_pk_bf16_f32 v94, v220, v221
v_cvt_pk_bf16_f32 v95, v222, v223
v_mfma_f32_16x16x32_bf16 v[154:157], a[252:255], v[186:189], v[154:157]
ds_write_b64 v212, v[94:95] offset:20480
v_mfma_f32_16x16x32_bf16 v[158:161], v[240:243], v[182:185], v[158:161]
v_mfma_f32_16x16x32_bf16 v[158:161], v[244:247], v[186:189], v[158:161]
s_mov_b64 exec, s[56:57]
ds_read_b128 v[48:51], v64 offset:12544
s_mov_b64 exec, -1
v_mfma_f32_16x16x32_bf16 v[162:165], v[182:185], a[80:83], v[162:165]
s_mov_b64 exec, s[56:57]
ds_read_b128 v[52:55], v64 offset:12608
s_mov_b64 exec, -1
v_mfma_f32_16x16x32_bf16 v[162:165], v[186:189], a[84:87], v[162:165]
s_mov_b64 exec, s[56:57]
ds_read_b128 v[56:59], v64 offset:12672
s_mov_b64 exec, -1
v_mfma_f32_16x16x32_bf16 v[166:169], v[182:185], a[104:107], v[166:169]
s_waitcnt lgkmcnt(3)
buffer_store_dwordx2 v[36:37], v65, s[8:11], 0 offen
s_barrier
v_mfma_f32_16x16x32_bf16 v[166:169], v[186:189], a[108:111], v[166:169]
v_mfma_f32_16x16x32_bf16 v[170:173], v[182:185], a[128:131], v[170:173]
ds_read_b128 v[182:185], v210 offset:20480
v_mfma_f32_16x16x32_bf16 v[170:173], v[186:189], a[132:135], v[170:173]
ds_read_b128 v[186:189], v210 offset:21504
v_mfma_f32_16x16x32_bf16 v[138:141], a[16:19], v[110:113], v[138:141]
v_mfma_f32_16x16x32_bf16 v[138:141], a[20:23], v[106:109], v[138:141]
v_mfma_f32_16x16x32_bf16 v[142:145], a[40:43], v[110:113], v[142:145]
v_mfma_f32_16x16x32_bf16 v[142:145], a[44:47], v[106:109], v[142:145]
v_cvt_pk_bf16_f32 v96, v138, v139
v_cvt_pk_bf16_f32 v97, v140, v141
v_mfma_f32_16x16x32_bf16 v[146:149], a[64:67], v[110:113], v[146:149]
v_mfma_f32_16x16x32_bf16 v[146:149], a[68:71], v[106:109], v[146:149]
v_cvt_pk_bf16_f32 v98, v142, v143
v_cvt_pk_bf16_f32 v99, v144, v145
v_mfma_f32_16x16x32_bf16 v[150:153], a[232:235], v[110:113], v[150:153]
v_mfma_f32_16x16x32_bf16 v[150:153], a[236:239], v[106:109], v[150:153]
v_cvt_pk_bf16_f32 v100, v146, v147
v_cvt_pk_bf16_f32 v101, v148, v149
v_mfma_f32_16x16x32_bf16 v[154:157], v[224:227], v[110:113], v[154:157]
buffer_store_dwordx2 v[40:41], v65, s[8:11], 0 offen offset:32
v_mfma_f32_16x16x32_bf16 v[154:157], v[228:231], v[106:109], v[154:157]
v_cvt_pk_bf16_f32 v84, v150, v151
v_cvt_pk_bf16_f32 v85, v152, v153
v_mfma_f32_16x16x32_bf16 v[158:161], v[248:251], v[110:113], v[158:161]
v_mfma_f32_16x16x32_bf16 v[158:161], v[252:255], v[106:109], v[158:161]
v_cvt_pk_bf16_f32 v86, v154, v155
v_cvt_pk_bf16_f32 v87, v156, v157
v_mfma_f32_16x16x32_bf16 v[162:165], v[110:113], a[88:91], v[162:165]
v_mfma_f32_16x16x32_bf16 v[162:165], v[106:109], a[92:95], v[162:165]
v_cvt_pk_bf16_f32 v88, v158, v159
v_cvt_pk_bf16_f32 v89, v160, v161
v_mfma_f32_16x16x32_bf16 v[166:169], v[110:113], a[112:115], v[166:169]
v_mfma_f32_16x16x32_bf16 v[166:169], v[106:109], a[116:119], v[166:169]
v_cvt_pk_bf16_f32 v116, v162, v163
v_cvt_pk_bf16_f32 v117, v164, v165
v_mfma_f32_16x16x32_bf16 v[170:173], v[110:113], a[136:139], v[170:173]
s_waitcnt lgkmcnt(1)
v_mfma_f32_16x16x32_bf16 v[138:141], a[216:219], v[182:185], 0
s_nop 0
v_cvt_pk_bf16_f32 v124, v166, v167
v_cvt_pk_bf16_f32 v125, v168, v169
v_mfma_f32_16x16x32_bf16 v[142:145], a[240:243], v[182:185], 0
v_mfma_f32_16x16x32_bf16 v[146:149], v[232:235], v[182:185], 0
v_mfma_f32_16x16x32_bf16 v[150:153], a[0:3], v[182:185], 0
v_mfma_f32_16x16x32_bf16 v[154:157], a[24:27], v[182:185], 0
v_mfma_f32_16x16x32_bf16 v[158:161], a[48:51], v[182:185], 0
v_mfma_f32_16x16x32_bf16 v[162:165], a[72:75], v[182:185], 0
buffer_store_dwordx2 v[44:45], v65, s[8:11], 0 offen offset:64
v_mfma_f32_16x16x32_bf16 v[166:169], a[96:99], v[182:185], 0
s_waitcnt lgkmcnt(0)
v_mfma_f32_16x16x32_bf16 v[166:169], a[100:103], v[186:189], v[166:169]
v_mfma_f32_16x16x32_bf16 v[138:141], a[220:223], v[186:189], v[138:141]
v_mfma_f32_16x16x32_bf16 v[142:145], a[244:247], v[186:189], v[142:145]
v_mfma_f32_16x16x32_bf16 v[146:149], v[236:239], v[186:189], v[146:149]
v_mfma_f32_16x16x32_bf16 v[150:153], a[4:7], v[186:189], v[150:153]
v_mfma_f32_16x16x32_bf16 v[154:157], a[28:31], v[186:189], v[154:157]
v_mfma_f32_16x16x32_bf16 v[158:161], a[52:55], v[186:189], v[158:161]
v_mfma_f32_16x16x32_bf16 v[162:165], a[76:79], v[186:189], v[162:165]
v_mfma_f32_16x16x32_bf16 v[170:173], v[106:109], a[140:143], v[170:173]
s_nop 7
v_cvt_pk_bf16_f32 v132, v170, v171
v_cvt_pk_bf16_f32 v133, v172, v173
v_mfma_f32_16x16x32_bf16 v[170:173], a[120:123], v[182:185], 0
ds_read_b128 v[182:185], v210 offset:22528
v_mfma_f32_16x16x32_bf16 v[170:173], a[124:127], v[186:189], v[170:173]
ds_read_b128 v[186:189], v210 offset:23552
s_waitcnt lgkmcnt(1)
v_mfma_f32_16x16x32_bf16 v[138:141], a[224:227], v[182:185], v[138:141]
v_mfma_f32_16x16x32_bf16 v[142:145], a[248:251], v[182:185], v[142:145]
v_mfma_f32_16x16x32_bf16 v[146:149], v[240:243], v[182:185], v[146:149]
v_mfma_f32_16x16x32_bf16 v[150:153], a[8:11], v[182:185], v[150:153]
v_mfma_f32_16x16x32_bf16 v[154:157], a[32:35], v[182:185], v[154:157]
v_mfma_f32_16x16x32_bf16 v[158:161], a[56:59], v[182:185], v[158:161]
v_mfma_f32_16x16x32_bf16 v[162:165], a[80:83], v[182:185], v[162:165]
v_mfma_f32_16x16x32_bf16 v[166:169], a[104:107], v[182:185], v[166:169]
v_mfma_f32_16x16x32_bf16 v[170:173], a[128:131], v[182:185], v[170:173]
ds_read_b128 v[182:185], v210 offset:24576
s_waitcnt lgkmcnt(1)
v_mfma_f32_16x16x32_bf16 v[138:141], a[228:231], v[186:189], v[138:141]
v_mfma_f32_16x16x32_bf16 v[142:145], a[252:255], v[186:189], v[142:145]
v_mfma_f32_16x16x32_bf16 v[146:149], v[244:247], v[186:189], v[146:149]
v_mfma_f32_16x16x32_bf16 v[150:153], a[12:15], v[186:189], v[150:153]
v_mfma_f32_16x16x32_bf16 v[154:157], a[36:39], v[186:189], v[154:157]
v_mfma_f32_16x16x32_bf16 v[158:161], a[60:63], v[186:189], v[158:161]
v_mfma_f32_16x16x32_bf16 v[162:165], a[84:87], v[186:189], v[162:165]
v_mfma_f32_16x16x32_bf16 v[166:169], a[108:111], v[186:189], v[166:169]
v_mfma_f32_16x16x32_bf16 v[170:173], a[132:135], v[186:189], v[170:173]
ds_read_b128 v[186:189], v210 offset:25600
s_waitcnt lgkmcnt(1)
v_mfma_f32_16x16x32_bf16 v[138:141], a[232:235], v[182:185], v[138:141]
v_mfma_f32_16x16x32_bf16 v[142:145], v[224:227], v[182:185], v[142:145]
v_mfma_f32_16x16x32_bf16 v[146:149], v[248:251], v[182:185], v[146:149]
v_mfma_f32_16x16x32_bf16 v[150:153], a[16:19], v[182:185], v[150:153]
v_mfma_f32_16x16x32_bf16 v[154:157], a[40:43], v[182:185], v[154:157]
v_mfma_f32_16x16x32_bf16 v[158:161], a[64:67], v[182:185], v[158:161]
v_mfma_f32_16x16x32_bf16 v[162:165], a[88:91], v[182:185], v[162:165]
v_mfma_f32_16x16x32_bf16 v[166:169], a[112:115], v[182:185], v[166:169]
v_mfma_f32_16x16x32_bf16 v[170:173], a[136:139], v[182:185], v[170:173]
ds_read_b128 v[182:185], v210 offset:12288
s_waitcnt lgkmcnt(1)
v_mfma_f32_16x16x32_bf16 v[138:141], a[236:239], v[186:189], v[138:141]
v_mfma_f32_16x16x32_bf16 v[142:145], v[228:231], v[186:189], v[142:145]
v_mfma_f32_16x16x32_bf16 v[146:149], v[252:255], v[186:189], v[146:149]
v_cvt_pk_bf16_f32 v90, v138, v139
v_cvt_pk_bf16_f32 v91, v140, v141
v_mfma_f32_16x16x32_bf16 v[150:153], a[20:23], v[186:189], v[150:153]
v_cvt_pk_bf16_f32 v92, v142, v143
v_cvt_pk_bf16_f32 v93, v144, v145
v_mfma_f32_16x16x32_bf16 v[154:157], a[44:47], v[186:189], v[154:157]
s_mov_b64 exec, s[30:31]
ds_write_b128 v215, v[90:93]
s_mov_b64 exec, -1
v_mfma_f32_16x16x32_bf16 v[158:161], a[68:71], v[186:189], v[158:161]
v_cvt_pk_bf16_f32 v94, v146, v147
v_cvt_pk_bf16_f32 v95, v148, v149
v_mfma_f32_16x16x32_bf16 v[162:165], a[92:95], v[186:189], v[162:165]
s_mov_b64 exec, s[30:31]
ds_write_b64 v215, v[94:95] offset:16
s_mov_b64 exec, -1
v_mfma_f32_16x16x32_bf16 v[166:169], a[116:119], v[186:189], v[166:169]
s_nop 0
v_cvt_pk_bf16_f32 v102, v150, v151
v_cvt_pk_bf16_f32 v103, v152, v153
v_mfma_f32_16x16x32_bf16 v[170:173], a[140:143], v[186:189], v[170:173]
s_waitcnt lgkmcnt(2)
ds_read_b128 v[186:189], v210 offset:13312
v_cvt_pk_bf16_f32 v104, v154, v155
v_mfma_f32_16x16x32_bf16 v[138:141], a[0:3], v[182:185], 0
v_cvt_pk_bf16_f32 v105, v156, v157
v_cvt_pk_bf16_f32 v106, v158, v159
v_mfma_f32_16x16x32_bf16 v[142:145], a[24:27], v[182:185], 0
s_mov_b64 exec, s[30:31]
ds_write_b128 v215, v[102:105] offset:512
s_mov_b64 exec, -1
v_mfma_f32_16x16x32_bf16 v[146:149], a[48:51], v[182:185], 0
v_cvt_pk_bf16_f32 v107, v160, v161
v_cvt_pk_bf16_f32 v108, v162, v163
v_cvt_pk_bf16_f32 v109, v164, v165
v_mfma_f32_16x16x16_bf16 v[154:157], v[82:83], v[88:89], 0
v_cvt_pk_bf16_f32 v110, v166, v167
v_cvt_pk_bf16_f32 v111, v168, v169
v_cvt_pk_bf16_f32 v112, v170, v171
v_cvt_pk_bf16_f32 v113, v172, v173
s_waitcnt lgkmcnt(1)
v_mfma_f32_16x16x32_bf16 v[138:141], a[4:7], v[186:189], v[138:141]
s_nop 0
s_mov_b64 exec, s[30:31]
ds_write_b64 v215, v[106:107] offset:528
s_mov_b64 exec, -1
v_mfma_f32_16x16x32_bf16 v[142:145], a[28:31], v[186:189], v[142:145]
s_mov_b64 exec, s[30:31]
ds_write_b128 v215, v[108:111] offset:1024
s_mov_b64 exec, -1
v_mfma_f32_16x16x32_bf16 v[146:149], a[52:55], v[186:189], v[146:149]
v_mfma_f32_16x16x16_bf16 v[158:161], v[100:101], v[88:89], 0
s_mov_b64 exec, s[30:31]
ds_write_b64 v215, v[112:113] offset:1040
s_mov_b64 exec, -1
v_mfma_f32_16x16x32_bf16 v[154:157], v[78:81], v[84:87], v[154:157]
ds_read_b64 v[112:113], v215 offset:528
ds_read_b128 v[170:173], v210 offset:14336
v_mfma_f32_16x16x32_bf16 v[158:161], v[96:99], v[84:87], v[158:161]
ds_read_b128 v[182:185], v210 offset:15360
ds_read_b128 v[108:111], v215 offset:512
ds_read_b128 v[186:189], v210 offset:16384
v_exp_f32 v154, v154
v_exp_f32 v155, v155
v_exp_f32 v156, v156
v_exp_f32 v157, v157
v_exp_f32 v158, v158
v_exp_f32 v159, v159
v_exp_f32_e64 v160, v160
v_exp_f32 v161, v161
s_waitcnt lgkmcnt(4)
v_mfma_f32_16x16x16_bf16 v[150:153], v[112:113], v[76:77], v[206:209]
v_mfma_f32_16x16x16_bf16 v[166:169], v[112:113], v[88:89], v[206:209]
s_waitcnt lgkmcnt(3)
v_mfma_f32_16x16x32_bf16 v[138:141], a[8:11], v[170:173], v[138:141]
s_waitcnt lgkmcnt(2)
v_mfma_f32_16x16x32_bf16 v[138:141], a[12:15], v[182:185], v[138:141]
v_mfma_f32_16x16x32_bf16 v[142:145], a[32:35], v[170:173], v[142:145]
v_mfma_f32_16x16x32_bf16 v[142:145], a[36:39], v[182:185], v[142:145]
s_waitcnt lgkmcnt(1)
v_mfma_f32_16x16x32_bf16 v[150:153], v[108:111], v[72:75], v[150:153]
v_mfma_f32_16x16x32_bf16 v[146:149], a[56:59], v[170:173], v[146:149]
ds_read_b128 v[170:173], v210 offset:17408
v_mfma_f32_16x16x32_bf16 v[146:149], a[60:63], v[182:185], v[146:149]
s_waitcnt lgkmcnt(1)
ds_read_b128 v[182:185], v210 offset:12288
v_exp_f32 v150, v150
v_mfma_f32_16x16x32_bf16 v[138:141], a[16:19], v[186:189], v[138:141]
v_mfma_f32_16x16x32_bf16 v[142:145], a[40:43], v[186:189], v[142:145]
v_mfma_f32_16x16x32_bf16 v[146:149], a[64:67], v[186:189], v[146:149]
ds_read_b128 v[186:189], v210 offset:13312
v_mfma_f32_16x16x32_bf16 v[166:169], v[108:111], v[84:87], v[166:169]
s_waitcnt lgkmcnt(2)
v_mfma_f32_16x16x32_bf16 v[138:141], a[20:23], v[170:173], v[138:141]
s_waitcnt lgkmcnt(1)
v_mfma_f32_16x16x32_bf16 v[118:121], v[182:185], a[72:75], 0
v_exp_f32 v166, v166
v_mfma_f32_16x16x32_bf16 v[126:129], v[182:185], a[96:99], 0
v_cvt_pk_bf16_f32 v102, v138, v139
v_cvt_pk_bf16_f32 v103, v140, v141
v_mfma_f32_16x16x16_bf16 v[138:141], v[82:83], v[76:77], 0
s_waitcnt lgkmcnt(0)
v_mfma_f32_16x16x32_bf16 v[118:121], v[186:189], a[76:79], v[118:121]
v_mfma_f32_16x16x32_bf16 v[138:141], v[78:81], v[72:75], v[138:141]
v_mfma_f32_16x16x32_bf16 v[126:129], v[186:189], a[100:103], v[126:129]
v_mfma_f32_16x16x32_bf16 v[134:137], v[182:185], a[120:123], 0
v_exp_f32 v138, v138
v_mfma_f32_16x16x32_bf16 v[134:137], v[186:189], a[124:127], v[134:137]
v_exp_f32 v139, v139
v_mfma_f32_16x16x32_bf16 v[90:93], a[216:219], v[182:185], 0
v_exp_f32 v140, v140
v_mfma_f32_16x16x32_bf16 v[90:93], a[220:223], v[186:189], v[90:93]
v_exp_f32_e64 v141, v141
v_mfma_f32_16x16x32_bf16 v[142:145], a[44:47], v[170:173], v[142:145]
v_mfma_f32_16x16x32_bf16 v[220:223], v[232:235], v[182:185], 0
v_mfma_f32_16x16x32_bf16 v[220:223], v[236:239], v[186:189], v[220:223]
v_cvt_pk_bf16_f32 v104, v142, v143
v_cvt_pk_bf16_f32 v105, v144, v145
v_mfma_f32_16x16x16_bf16 v[142:145], v[100:101], v[76:77], 0
v_mfma_f32_16x16x32_bf16 v[146:149], a[68:71], v[170:173], v[146:149]
v_mfma_f32_16x16x32_bf16 v[142:145], v[96:99], v[72:75], v[142:145]
v_mfma_f32_16x16x32_bf16 v[170:173], a[240:243], v[182:185], 0
v_cvt_pk_bf16_f32 v106, v146, v147
v_cvt_pk_bf16_f32 v107, v148, v149
v_mfma_f32_16x16x32_bf16 v[170:173], a[244:247], v[186:189], v[170:173]
v_exp_f32 v142, v142
v_mfma_f32_16x16x16_bf16 v[146:149], v[106:107], v[76:77], 0
v_exp_f32 v143, v143
v_exp_f32 v144, v144
v_mfma_f32_16x16x16_bf16 v[162:165], v[106:107], v[88:89], 0
v_exp_f32 v145, v145
v_mfma_f32_16x16x32_bf16 v[146:149], v[102:105], v[72:75], v[146:149]
ds_read_b128 v[182:185], v210 offset:16384
ds_read_b128 v[186:189], v210 offset:17408
v_mfma_f32_16x16x32_bf16 v[118:121], v[174:177], a[80:83], v[118:121]
ds_read_b128 v[72:75], v215
ds_read_b64 v[76:77], v215 offset:16
v_mfma_f32_16x16x32_bf16 v[118:121], v[178:181], a[84:87], v[118:121]
v_exp_f32 v146, v146
v_mfma_f32_16x16x32_bf16 v[126:129], v[174:177], a[104:107], v[126:129]
v_exp_f32 v147, v147
v_mfma_f32_16x16x32_bf16 v[126:129], v[178:181], a[108:111], v[126:129]
v_exp_f32 v148, v148
v_mfma_f32_16x16x32_bf16 v[134:137], v[174:177], a[128:131], v[134:137]
v_exp_f32 v149, v149
v_mfma_f32_16x16x32_bf16 v[134:137], v[178:181], a[132:135], v[134:137]
v_mfma_f32_16x16x32_bf16 v[90:93], a[224:227], v[174:177], v[90:93]
v_mfma_f32_16x16x32_bf16 v[90:93], a[228:231], v[178:181], v[90:93]
v_mfma_f32_16x16x32_bf16 v[170:173], a[248:251], v[174:177], v[170:173]
v_mfma_f32_16x16x32_bf16 v[170:173], a[252:255], v[178:181], v[170:173]
v_mfma_f32_16x16x32_bf16 v[220:223], v[240:243], v[174:177], v[220:223]
v_cvt_pk_bf16_f32 v174, v138, v139
v_cvt_pk_bf16_f32 v175, v140, v141
v_mfma_f32_16x16x32_bf16 v[220:223], v[244:247], v[178:181], v[220:223]
s_nop 0
v_cvt_pk_bf16_f32 v176, v142, v143
v_cvt_pk_bf16_f32 v177, v144, v145
v_mfma_f32_16x16x32_bf16 v[162:165], v[102:105], v[84:87], v[162:165]
s_waitcnt lgkmcnt(3)
v_cvt_pk_bf16_f32 v180, v150, 0
v_cvt_pk_bf16_f32 v178, v146, v147
v_mfma_f32_16x16x32_bf16 v[118:121], v[182:185], a[88:91], v[118:121]
s_waitcnt lgkmcnt(2)
v_cvt_pk_bf16_f32 v179, v148, v149
v_mov_b32 v181, 0
v_mfma_f32_16x16x32_bf16 v[118:121], v[186:189], a[92:95], v[118:121]
v_exp_f32 v162, v162
v_mfma_f32_16x16x32_bf16 v[126:129], v[182:185], a[112:115], v[126:129]
v_exp_f32 v163, v163
v_mfma_f32_16x16x32_bf16 v[126:129], v[186:189], a[116:119], v[126:129]
v_exp_f32 v164, v164
v_mfma_f32_16x16x32_bf16 v[134:137], v[182:185], a[136:139], v[134:137]
v_exp_f32 v165, v165
v_mfma_f32_16x16x32_bf16 v[134:137], v[186:189], a[140:143], v[134:137]
v_cvt_pk_bf16_f32 v118, v118, v119
v_cvt_pk_bf16_f32 v119, v120, v121
v_mfma_f32_16x16x32_bf16 v[90:93], a[232:235], v[182:185], v[90:93]
ds_read_u16 v120, v214 offset:1024
v_mov_b32_e64 v121, 0
v_mfma_f32_16x16x32_bf16 v[90:93], a[236:239], v[186:189], v[90:93]
v_cvt_pk_bf16_f32 v126, v126, v127
v_cvt_pk_bf16_f32 v127, v128, v129
v_mfma_f32_16x16x32_bf16 v[170:173], v[224:227], v[182:185], v[170:173]
ds_read_u16 v128, v214 offset:1032
v_cvt_pk_bf16_f32 v134, v134, v135
v_mfma_f32_16x16x32_bf16 v[170:173], v[228:231], v[186:189], v[170:173]
v_cvt_pk_bf16_f32 v135, v136, v137
v_mov_b32_e64 v129, 0
v_mfma_f32_16x16x32_bf16 v[220:223], v[248:251], v[182:185], v[220:223]
ds_read_u16 v136, v214 offset:1040
v_mov_b32_e64 v137, 0
v_mfma_f32_16x16x32_bf16 v[220:223], v[252:255], v[186:189], v[220:223]
v_cvt_pk_bf16_f32 v90, v90, v91
v_cvt_pk_bf16_f32 v91, v92, v93
v_mfma_f32_16x16x32_bf16 v[150:153], v[190:193], v[174:177], 0
v_cvt_pk_bf16_f32 v92, v170, v171
v_cvt_pk_bf16_f32 v93, v172, v173
v_mfma_f32_16x16x32_bf16 v[150:153], v[190:193], v[178:181], v[150:153]
v_cvt_pk_bf16_f32 v94, v220, v221
v_cvt_pk_bf16_f32 v95, v222, v223
v_mfma_f32_16x16x32_bf16 v[138:141], v[114:117], v[174:177], 0
s_waitcnt lgkmcnt(2)
v_mfma_f32_16x16x32_bf16 v[138:141], v[118:121], v[178:181], v[138:141]
v_rcp_f32_e64 v151, v150
v_mfma_f32_16x16x32_bf16 v[142:145], v[122:125], v[174:177], 0
s_waitcnt lgkmcnt(1)
v_max3_u32 v218, v218, v150, v151
v_mul_f32_e64 v151, s3, v151
v_mfma_f32_16x16x32_bf16 v[142:145], v[126:129], v[178:181], v[142:145]
v_mul_f32_e64 v138, v138, v151
v_mul_f32 v139, v139, v151
v_mfma_f32_16x16x32_bf16 v[146:149], v[130:133], v[174:177], 0
s_waitcnt lgkmcnt(0)
v_cvt_pk_bf16_f32 v174, v154, v155
v_cvt_pk_bf16_f32 v175, v156, v157
v_mfma_f32_16x16x32_bf16 v[146:149], v[134:137], v[178:181], v[146:149]
v_cvt_pk_bf16_f32 v176, v158, v159
v_cvt_pk_bf16_f32 v177, v160, v161
v_cvt_pk_bf16_f32 v180, v166, 0
v_cvt_pk_bf16_f32 v178, v162, v163
v_mfma_f32_16x16x32_bf16 v[166:169], v[190:193], v[174:177], 0
v_cvt_pk_bf16_f32 v179, v164, v165
v_mul_f32 v140, v140, v151
v_mul_f32 v141, v141, v151
v_mfma_f32_16x16x32_bf16 v[166:169], v[190:193], v[178:181], v[166:169]
v_cvt_pk_bf16_f32 v138, v138, v139
v_mul_f32_e64 v142, v142, v151
v_mfma_f32_16x16x32_bf16 v[154:157], v[114:117], v[174:177], 0
v_mul_f32 v143, v143, v151
v_mul_f32 v144, v144, v151
v_mfma_f32_16x16x32_bf16 v[154:157], v[118:121], v[178:181], v[154:157]
v_mul_f32_e64 v145, v145, v151
v_cvt_pk_bf16_f32 v139, v140, v141
v_mfma_f32_16x16x32_bf16 v[158:161], v[122:125], v[174:177], 0
v_cvt_pk_bf16_f32 v140, v142, v143
v_cvt_pk_bf16_f32 v141, v144, v145
v_mfma_f32_16x16x32_bf16 v[158:161], v[126:129], v[178:181], v[158:161]
ds_write_b128 v211, v[138:141] offset:38912
v_mfma_f32_16x16x32_bf16 v[162:165], v[130:133], v[174:177], 0
v_mul_f32 v146, v146, v151
v_mul_f32 v147, v147, v151
v_mfma_f32_16x16x32_bf16 v[162:165], v[134:137], v[178:181], v[162:165]
v_mul_f32 v148, v148, v151
v_mul_f32 v149, v149, v151
v_cvt_pk_bf16_f32 v142, v146, v147
v_mfma_f32_16x16x16_bf16 v[138:141], v[82:83], v[94:95], 0
v_cvt_pk_bf16_f32 v143, v148, v149
v_rcp_f32_e64 v167, v166
v_mfma_f32_16x16x16_bf16 v[150:153], v[112:113], v[94:95], v[206:209]
v_max3_u32 v218, v218, v166, v167
v_mul_f32 v167, s3, v167
v_mul_f32 v154, v154, v167
v_mfma_f32_16x16x16_bf16 v[146:149], v[106:107], v[94:95], 0
v_mul_f32 v155, v155, v167
v_mul_f32 v156, v156, v167
v_mul_f32_e64 v157, v157, v167
v_cvt_pk_bf16_f32 v154, v154, v155
v_mfma_f32_16x16x32_bf16 v[138:141], v[78:81], v[90:93], v[138:141]
ds_write_b64 v212, v[142:143] offset:38912
v_mfma_f32_16x16x16_bf16 v[142:145], v[100:101], v[94:95], 0
v_mul_f32 v158, v158, v167
v_mul_f32 v159, v159, v167
v_mul_f32 v160, v160, v167
v_mul_f32 v161, v161, v167
v_mfma_f32_16x16x32_bf16 v[150:153], v[108:111], v[90:93], v[150:153]
v_cvt_pk_bf16_f32 v155, v156, v157
v_cvt_pk_bf16_f32 v156, v158, v159
v_mfma_f32_16x16x32_bf16 v[142:145], v[96:99], v[90:93], v[142:145]
v_cvt_pk_bf16_f32 v157, v160, v161
v_mul_f32_e64 v162, v162, v167
v_mfma_f32_16x16x32_bf16 v[146:149], v[102:105], v[90:93], v[146:149]
ds_write_b128 v211, v[154:157] offset:45056
v_mfma_f32_16x16x16_bf16 v[154:157], v[76:77], v[82:83], 0
v_mul_f32 v163, v163, v167
v_mul_f32 v164, v164, v167
v_mul_f32_e64 v165, v165, v167
v_mfma_f32_16x16x16_bf16 v[166:169], v[76:77], v[112:113], v[206:209]
v_cvt_pk_bf16_f32 v158, v162, v163
v_cvt_pk_bf16_f32 v159, v164, v165
v_exp_f32 v138, v138
v_mfma_f32_16x16x16_bf16 v[162:165], v[76:77], v[106:107], 0
v_exp_f32 v139, v139
v_exp_f32 v140, v140
v_mfma_f32_16x16x32_bf16 v[154:157], v[72:75], v[78:81], v[154:157]
ds_write_b64 v212, v[158:159] offset:45056
v_mfma_f32_16x16x16_bf16 v[158:161], v[76:77], v[100:101], 0
v_exp_f32 v141, v141
v_exp_f32 v142, v142
v_mfma_f32_16x16x32_bf16 v[162:165], v[72:75], v[102:105], v[162:165]
v_exp_f32 v143, v143
v_mfma_f32_16x16x32_bf16 v[158:161], v[72:75], v[96:99], v[158:161]
v_exp_f32 v144, v144
v_mfma_f32_16x16x32_bf16 v[166:169], v[72:75], v[108:111], v[166:169]
v_exp_f32 v145, v145
v_exp_f32 v150, v150
v_exp_f32 v146, v146
v_exp_f32 v147, v147
v_exp_f32 v148, v148
v_exp_f32_e64 v149, v149
v_cvt_pk_bf16_f32 v174, v138, v139
v_cvt_pk_bf16_f32 v175, v140, v141
v_cvt_pk_bf16_f32 v176, v142, v143
v_cvt_pk_bf16_f32 v177, v144, v145
v_cvt_pk_bf16_f32 v180, v150, 0
v_cvt_pk_bf16_f32 v178, v146, v147
v_mfma_f32_16x16x32_bf16 v[150:153], v[190:193], v[174:177], 0
s_waitcnt lgkmcnt(0)
v_cvt_pk_bf16_f32 v179, v148, v149
v_mov_b32_dpp v154, v158 quad_perm:[0,1,2,3] row_mask:0x2 bank_mask:0xf
v_mfma_f32_16x16x32_bf16 v[138:141], v[114:117], v[174:177], 0
s_barrier
v_mfma_f32_16x16x32_bf16 v[138:141], v[118:121], v[178:181], v[138:141]
ds_read_b128 v[220:223], v210 offset:38912
ds_read_b128 v[110:113], v210 offset:39936
v_mfma_f32_16x16x32_bf16 v[150:153], v[190:193], v[178:181], v[150:153]
ds_read_b128 v[170:173], v210 offset:40960
ds_read_b128 v[182:185], v210 offset:41984
v_mfma_f32_16x16x32_bf16 v[142:145], v[122:125], v[174:177], 0
v_mov_b32_dpp v154, v162 quad_perm:[0,1,2,3] row_mask:0x4 bank_mask:0xf
v_mfma_f32_16x16x32_bf16 v[142:145], v[126:129], v[178:181], v[142:145]
v_mov_b32_dpp v154, v167 quad_perm:[0,1,2,3] row_mask:0x8 bank_mask:0xf
v_exp_f32 v154, v154
v_mfma_f32_16x16x32_bf16 v[146:149], v[130:133], v[174:177], 0
v_cvt_pk_bf16_f32 v154, v154, 0
v_rcp_f32 v151, v150
v_mfma_f32_16x16x32_bf16 v[146:149], v[134:137], v[178:181], v[146:149]
s_waitcnt lgkmcnt(3)
ds_write_b16 v214, v154
v_mfma_f32_16x16x32_bf16 v[0:3], a[144:147], v[220:223], v[0:3]
s_waitcnt lgkmcnt(3)
ds_read_b128 v[84:87], v215
ds_read_b128 v[88:91], v215 offset:16
v_mfma_f32_16x16x32_bf16 v[0:3], a[148:151], v[110:113], v[0:3]
ds_read_b128 v[186:189], v210 offset:43008
v_add_u32 v215, 1552, v215
v_mfma_f32_16x16x32_bf16 v[4:7], a[168:171], v[220:223], v[4:7]
v_mfma_f32_16x16x32_bf16 v[4:7], a[172:175], v[110:113], v[4:7]
v_mfma_f32_16x16x32_bf16 v[8:11], a[192:195], v[220:223], v[8:11]
ds_read_b128 v[220:223], v210 offset:44032
v_mfma_f32_16x16x32_bf16 v[8:11], a[196:199], v[110:113], v[8:11]
s_nop 0
ds_read_b128 v[110:113], v210 offset:45056
s_waitcnt lgkmcnt(4)
v_mfma_f32_16x16x32_bf16 v[166:169], v[84:87], v[190:193], 0
s_waitcnt lgkmcnt(3)
v_mfma_f32_16x16x32_bf16 v[166:169], v[88:91], v[190:193], v[166:169]
v_mfma_f32_16x16x32_bf16 v[154:157], v[84:87], v[114:117], 0
v_mfma_f32_16x16x32_bf16 v[154:157], v[88:91], v[118:121], v[154:157]
v_rcp_f32 v167, v166
v_mfma_f32_16x16x32_bf16 v[158:161], v[84:87], v[122:125], 0
v_max3_u32 v218, v218, v166, v167
v_max3_u32 v218, v218, v150, v151
v_mfma_f32_16x16x32_bf16 v[158:161], v[88:91], v[126:129], v[158:161]
v_mul_f32 v151, s3, v151
v_mul_f32 v138, v138, v151
v_mfma_f32_16x16x32_bf16 v[162:165], v[84:87], v[130:133], 0
v_mul_f32 v139, v139, v151
v_mul_f32 v140, v140, v151
v_mfma_f32_16x16x32_bf16 v[162:165], v[88:91], v[134:137], v[162:165]
v_mul_f32_e64 v141, v141, v151
v_cvt_pk_bf16_f32 v138, v138, v139
v_mfma_f32_16x16x32_bf16 v[0:3], a[152:155], v[170:173], v[0:3]
v_mul_f32 v142, v142, v151
v_mul_f32 v143, v143, v151
v_mfma_f32_16x16x32_bf16 v[0:3], a[156:159], v[182:185], v[0:3]
s_waitcnt lgkmcnt(2)
v_mul_f32 v144, v144, v151
v_mul_f32_e64 v145, v145, v151
v_mfma_f32_16x16x32_bf16 v[0:3], a[160:163], v[186:189], v[0:3]
v_cvt_pk_bf16_f32 v139, v140, v141
v_cvt_pk_bf16_f32 v140, v142, v143
v_mfma_f32_16x16x32_bf16 v[4:7], a[176:179], v[170:173], v[4:7]
v_cvt_pk_bf16_f32 v141, v144, v145
v_mov_b32_dpp v154, v158 quad_perm:[0,1,2,3] row_mask:0x2 bank_mask:0xf
v_mfma_f32_16x16x32_bf16 v[4:7], a[180:183], v[182:185], v[4:7]
ds_write_b128 v211, v[138:141] offset:51200
v_mfma_f32_16x16x32_bf16 v[4:7], a[184:187], v[186:189], v[4:7]
v_cmp_lt_u32 vcc, 1602224128, v218
v_mul_f32_e64 v146, v146, v151
v_mfma_f32_16x16x32_bf16 v[8:11], a[200:203], v[170:173], v[8:11]
s_or_b32 s41, vcc_lo, vcc_hi
v_mul_f32 v147, v147, v151
v_mul_f32_e64 v148, v148, v151
v_mfma_f32_16x16x32_bf16 v[8:11], a[204:207], v[182:185], v[8:11]
ds_read_b128 v[170:173], v210 offset:46080
ds_read_b128 v[182:185], v210 offset:47104
v_mfma_f32_16x16x32_bf16 v[8:11], a[208:211], v[186:189], v[8:11]
s_waitcnt lgkmcnt(4)
ds_read_b128 v[186:189], v210 offset:48128
v_mul_f32 v149, v149, v151
v_mfma_f32_16x16x32_bf16 v[8:11], a[212:215], v[220:223], v[8:11]
v_mul_f32_e64 v167, s3, v167
v_mov_b32_dpp v154, v162 quad_perm:[0,1,2,3] row_mask:0x4 bank_mask:0xf
v_mfma_f32_16x16x32_bf16 v[0:3], a[164:167], v[220:223], v[0:3]
s_nop 0
v_cvt_pk_bf16_f32 v142, v146, v147
v_cvt_pk_bf16_f32 v143, v148, v149
v_mfma_f32_16x16x32_bf16 v[4:7], a[188:191], v[220:223], v[4:7]
s_waitcnt lgkmcnt(4)
v_cvt_pk_bf16_f32 v76, v8, v9
v_cvt_pk_bf16_f32 v77, v10, v11
v_mfma_f32_16x16x32_bf16 v[12:15], a[144:147], v[110:113], v[12:15]
v_cvt_pk_bf16_f32 v72, v0, v1
v_cvt_pk_bf16_f32 v73, v2, v3
v_mfma_f32_16x16x32_bf16 v[16:19], a[168:171], v[110:113], v[16:19]
s_waitcnt lgkmcnt(2)
buffer_store_dwordx2 v[72:73], v203, s[8:11], s38 offen
v_cvt_pk_bf16_f32 v74, v4, v5
v_mfma_f32_16x16x32_bf16 v[16:19], a[172:175], v[170:173], v[16:19]
s_waitcnt lgkmcnt(1)
v_cvt_pk_bf16_f32 v75, v6, v7
v_mul_f32_e64 v154, v154, v167
v_mfma_f32_16x16x32_bf16 v[16:19], a[176:179], v[182:185], v[16:19]
ds_write_b64 v212, v[142:143] offset:51200
v_mfma_f32_16x16x32_bf16 v[12:15], a[148:151], v[170:173], v[12:15]
v_mov_b32 v69, s41
v_cvt_pk_bf16_f32 v154, v154, 0
v_mfma_f32_16x16x32_bf16 v[12:15], a[152:155], v[182:185], v[12:15]
s_waitcnt lgkmcnt(1)
ds_read_b128 v[220:223], v210 offset:49152
ds_write_b32 v209, v69
v_mfma_f32_16x16x32_bf16 v[12:15], a[156:159], v[186:189], v[12:15]
ds_write_b16 v214, v154
v_mfma_f32_16x16x32_bf16 v[20:23], a[192:195], v[110:113], v[20:23]
ds_read_b128 v[110:113], v210 offset:50176
v_add_u32 v214, 1552, v214
v_mfma_f32_16x16x32_bf16 v[20:23], a[196:199], v[170:173], v[20:23]
v_mfma_f32_16x16x32_bf16 v[20:23], a[200:203], v[182:185], v[20:23]
v_mfma_f32_16x16x32_bf16 v[20:23], a[204:207], v[186:189], v[20:23]
s_waitcnt lgkmcnt(3)
v_mfma_f32_16x16x32_bf16 v[20:23], a[208:211], v[220:223], v[20:23]
v_mfma_f32_16x16x32_bf16 v[16:19], a[180:183], v[186:189], v[16:19]
s_waitcnt lgkmcnt(1)
s_barrier
v_mfma_f32_16x16x32_bf16 v[16:19], a[184:187], v[220:223], v[16:19]
s_waitcnt lgkmcnt(0)
buffer_store_dwordx2 v[74:75], v203, s[8:11], s38 offen offset:32
ds_read_b128 v[170:173], v210 offset:51200
v_mfma_f32_16x16x32_bf16 v[16:19], a[188:191], v[110:113], v[16:19]
ds_read_b128 v[182:185], v210 offset:52224
ds_read_b128 v[84:87], v63 offset:24832
v_mfma_f32_16x16x32_bf16 v[12:15], a[160:163], v[220:223], v[12:15]
ds_read_b128 v[88:91], v63 offset:24960
ds_read_b128 v[92:95], v63 offset:25088
v_mfma_f32_16x16x32_bf16 v[12:15], a[164:167], v[110:113], v[12:15]
ds_read_b128 v[96:99], v63 offset:25216
ds_read_b64 v[100:101], v63 offset:24848
v_mfma_f32_16x16x32_bf16 v[20:23], a[212:215], v[110:113], v[20:23]
ds_read_b64 v[102:103], v63 offset:24976
ds_read_b64 v[104:105], v63 offset:25104
v_cvt_pk_bf16_f32 v80, v16, v17
v_cvt_pk_bf16_f32 v78, v12, v13
v_cvt_pk_bf16_f32 v79, v14, v15
v_cvt_pk_bf16_f32 v81, v18, v19
s_waitcnt lgkmcnt(8)
v_mfma_f32_16x16x32_bf16 v[24:27], a[144:147], v[170:173], v[24:27]
ds_read_b64 v[106:107], v63 offset:25232
ds_read_b128 v[186:189], v210 offset:53248
v_mfma_f32_16x16x32_bf16 v[28:31], a[168:171], v[170:173], v[28:31]
s_waitcnt lgkmcnt(9)
ds_read_b128 v[220:223], v210 offset:54272
ds_read_b128 v[110:113], v210 offset:55296
v_mfma_f32_16x16x32_bf16 v[28:31], a[172:175], v[182:185], v[28:31]
v_cvt_pk_bf16_f32 v82, v20, v21
v_cvt_pk_bf16_f32 v83, v22, v23
v_mfma_f32_16x16x32_bf16 v[24:27], a[148:151], v[182:185], v[24:27]
s_nop 0
ds_read_b128 v[174:177], v210 offset:18432
s_waitcnt lgkmcnt(11)
v_mfma_f32_16x16x32_bf16 v[48:51], a[144:147], v[84:87], v[48:51]
s_waitcnt lgkmcnt(10)
v_mfma_f32_16x16x32_bf16 v[48:51], a[148:151], v[88:91], v[48:51]
s_waitcnt lgkmcnt(9)
v_mfma_f32_16x16x32_bf16 v[48:51], a[152:155], v[92:95], v[48:51]
s_waitcnt lgkmcnt(8)
v_mfma_f32_16x16x32_bf16 v[48:51], a[156:159], v[96:99], v[48:51]
s_waitcnt lgkmcnt(6)
v_mfma_f32_16x16x32_bf16 v[48:51], a[160:163], v[100:103], v[48:51]
buffer_store_dwordx2 v[76:77], v203, s[8:11], s38 offen offset:64
s_waitcnt lgkmcnt(4)
v_mfma_f32_16x16x32_bf16 v[48:51], a[164:167], v[104:107], v[48:51]
v_mfma_f32_16x16x32_bf16 v[32:35], a[192:195], v[170:173], v[32:35]
s_waitcnt lgkmcnt(0)
ds_read_b128 v[170:173], v210 offset:56320
v_or3_b32 v174, v174, v175, v176
v_mfma_f32_16x16x32_bf16 v[32:35], a[196:199], v[182:185], v[32:35]
v_cvt_pk_bf16_f32 v48, v48, v49
v_or_b32 v174, v174, v177
v_mfma_f32_16x16x32_bf16 v[24:27], a[152:155], v[186:189], v[24:27]
v_cvt_pk_bf16_f32 v49, v50, v51
v_readfirstlane_b32 s43, v174
v_mfma_f32_16x16x32_bf16 v[24:27], a[156:159], v[220:223], v[24:27]
v_mfma_f32_16x16x32_bf16 v[52:55], a[168:171], v[84:87], v[52:55]
v_mfma_f32_16x16x32_bf16 v[52:55], a[172:175], v[88:91], v[52:55]
v_mfma_f32_16x16x32_bf16 v[52:55], a[176:179], v[92:95], v[52:55]
v_mfma_f32_16x16x32_bf16 v[52:55], a[180:183], v[96:99], v[52:55]
v_mfma_f32_16x16x32_bf16 v[52:55], a[184:187], v[100:103], v[52:55]
v_mfma_f32_16x16x32_bf16 v[52:55], a[188:191], v[104:107], v[52:55]
v_mfma_f32_16x16x32_bf16 v[28:31], a[176:179], v[186:189], v[28:31]
v_mfma_f32_16x16x32_bf16 v[28:31], a[180:183], v[220:223], v[28:31]
v_cvt_pk_bf16_f32 v52, v52, v53
v_cvt_pk_bf16_f32 v53, v54, v55
v_mfma_f32_16x16x32_bf16 v[32:35], a[200:203], v[186:189], v[32:35]
v_mfma_f32_16x16x32_bf16 v[32:35], a[204:207], v[220:223], v[32:35]
v_mfma_f32_16x16x32_bf16 v[56:59], a[192:195], v[84:87], v[56:59]
buffer_store_dwordx2 v[78:79], v204, s[8:11], s38 offen
v_mfma_f32_16x16x32_bf16 v[56:59], a[196:199], v[88:91], v[56:59]
v_mfma_f32_16x16x32_bf16 v[56:59], a[200:203], v[92:95], v[56:59]
v_mfma_f32_16x16x32_bf16 v[56:59], a[204:207], v[96:99], v[56:59]
v_mfma_f32_16x16x32_bf16 v[56:59], a[208:211], v[100:103], v[56:59]
s_nop 0
v_mfma_f32_16x16x32_bf16 v[24:27], a[160:163], v[110:113], v[24:27]
s_waitcnt lgkmcnt(0)
v_mfma_f32_16x16x32_bf16 v[24:27], a[164:167], v[170:173], v[24:27]
v_mfma_f32_16x16x32_bf16 v[28:31], a[184:187], v[110:113], v[28:31]
v_mfma_f32_16x16x32_bf16 v[28:31], a[188:191], v[170:173], v[28:31]
v_cvt_pk_bf16_f32 v116, v24, v25
v_cvt_pk_bf16_f32 v117, v26, v27
v_mfma_f32_16x16x32_bf16 v[56:59], a[212:215], v[104:107], v[56:59]
v_mfma_f32_16x16x32_bf16 v[32:35], a[208:211], v[110:113], v[32:35]
v_cvt_pk_bf16_f32 v124, v28, v29
v_cvt_pk_bf16_f32 v125, v30, v31
v_mfma_f32_16x16x32_bf16 v[32:35], a[212:215], v[170:173], v[32:35]
s_nop 0
v_cvt_pk_bf16_f32 v56, v56, v57
v_cvt_pk_bf16_f32 v57, v58, v59
s_nop 4
v_cvt_pk_bf16_f32 v132, v32, v33
v_cvt_pk_bf16_f32 v133, v34, v35
buffer_store_dwordx2 v[80:81], v204, s[8:11], s38 offen offset:32
buffer_store_dwordx2 v[82:83], v204, s[8:11], s38 offen offset:64
buffer_store_dwordx2 v[116:117], v205, s[8:11], s38 offen
buffer_store_dwordx2 v[124:125], v205, s[8:11], s38 offen offset:32
buffer_store_dwordx2 v[48:49], v66, s[8:11], 0 offen
buffer_store_dwordx2 v[52:53], v66, s[8:11], 0 offen offset:32
buffer_store_dwordx2 v[56:57], v66, s[8:11], 0 offen offset:64
buffer_store_dwordx2 v[132:133], v205, s[8:11], s38 offen offset:64
L_fin:
s_nop 1
s_cmp_lg_u32 s43, 0
s_cbranch_scc1 L_redo
L_end:
s_endpgm
.p2align 3
L_tailb:
v_mfma_f32_16x16x32_bf16 v[138:141], a[8:11], v[182:185], v[138:141]
s_mul_i32 s41, s32, 192
s_waitcnt lgkmcnt(2)
v_add_f32 v102, v102, v103
s_waitcnt lgkmcnt(1)
v_add_f32 v106, v106, v107
v_mfma_f32_16x16x32_bf16 v[138:141], a[12:15], v[186:189], v[138:141]
s_add_u32 s41, s41, 127056
v_add_f32 v104, v104, v105
v_add_f32 v108, v108, v109
v_mfma_f32_16x16x32_bf16 v[142:145], a[32:35], v[182:185], v[142:145]
s_mov_b32 s42, 58835169
v_add_f32 v102, v102, v104
v_add_f32 v106, v106, v108
v_mfma_f32_16x16x32_bf16 v[142:145], a[36:39], v[186:189], v[142:145]
v_mul_f32 v103, s48, v102
v_mul_f32 v104, s73, v102
v_mfma_f32_16x16x32_bf16 v[146:149], a[56:59], v[182:185], v[146:149]
v_mul_f32_e64 v106, s73, v106
v_fma_f32 v106, -v103, v104, v106
v_mfma_f32_16x16x32_bf16 v[146:149], a[60:63], v[186:189], v[146:149]
v_max_f32 v106, 0, v106
v_add_f32 v106, s49, v106
v_mfma_f32_16x16x32_bf16 v[150:153], a[224:227], v[182:185], v[150:153]
v_rsq_f32 v102, v106
v_mfma_f32_16x16x32_bf16 v[150:153], a[228:231], v[186:189], v[150:153]
ds_read_b128 v[106:109], v210 offset:11264
buffer_store_dwordx2 v[132:133], v205, s[8:11], s39 offen offset:64
v_mul_f32_e64 v103, -v103, v102
v_mfma_f32_16x16x32_bf16 v[154:157], a[248:251], v[182:185], v[154:157]
s_mov_b32 s39, s37
ds_write_b64 v211, v[102:103] offset:20480
v_mfma_f32_16x16x32_bf16 v[154:157], a[252:255], v[186:189], v[154:157]
v_mfma_f32_16x16x32_bf16 v[158:161], v[240:243], v[182:185], v[158:161]
ds_read_b64 v[118:119], v219 offset:20480
ds_read_b64 v[126:127], v219 offset:20736
v_mfma_f32_16x16x32_bf16 v[158:161], v[244:247], v[186:189], v[158:161]
ds_read_b64 v[134:135], v219 offset:20992
v_mfma_f32_16x16x32_bf16 v[162:165], v[182:185], a[80:83], v[162:165]
v_mfma_f32_16x16x32_bf16 v[162:165], v[186:189], a[84:87], v[162:165]
v_mfma_f32_16x16x32_bf16 v[166:169], v[182:185], a[104:107], v[166:169]
s_nop 0
v_mfma_f32_16x16x32_bf16 v[166:169], v[186:189], a[108:111], v[166:169]
s_waitcnt lgkmcnt(2)
v_fma_f32 v220, v36, v118, v119
v_fma_f32 v221, v37, v118, v119
v_mfma_f32_16x16x32_bf16 v[170:173], v[182:185], a[128:131], v[170:173]
ds_read_b128 v[182:185], v210 offset:12288
v_fma_f32 v222, v38, v118, v119
v_mfma_f32_16x16x32_bf16 v[170:173], v[186:189], a[132:135], v[170:173]
ds_read_b128 v[186:189], v210 offset:13312
v_fma_f32 v223, v39, v118, v119
v_mfma_f32_16x16x32_bf16 v[138:141], a[16:19], v[110:113], v[138:141]
v_cvt_pk_bf16_f32 v90, v220, v221
v_cvt_pk_bf16_f32 v91, v222, v223
v_mfma_f32_16x16x32_bf16 v[138:141], a[20:23], v[106:109], v[138:141]
v_fma_f32 v220, v40, v118, v119
v_fma_f32 v221, v41, v118, v119
v_mfma_f32_16x16x32_bf16 v[142:145], a[40:43], v[110:113], v[142:145]
v_fma_f32 v222, v42, v118, v119
v_fma_f32 v223, v43, v118, v119
v_mfma_f32_16x16x32_bf16 v[142:145], a[44:47], v[106:109], v[142:145]
v_cvt_pk_bf16_f32 v96, v138, v139
v_cvt_pk_bf16_f32 v97, v140, v141
v_mfma_f32_16x16x32_bf16 v[146:149], a[64:67], v[110:113], v[146:149]
v_cvt_pk_bf16_f32 v92, v220, v221
v_cvt_pk_bf16_f32 v93, v222, v223
v_mfma_f32_16x16x32_bf16 v[146:149], a[68:71], v[106:109], v[146:149]
v_fma_f32 v220, v44, v118, v119
v_fma_f32 v221, v45, v118, v119
v_mfma_f32_16x16x32_bf16 v[150:153], a[232:235], v[110:113], v[150:153]
v_fma_f32 v222, v46, v118, v119
v_fma_f32 v223, v47, v118, v119
v_mfma_f32_16x16x32_bf16 v[150:153], a[236:239], v[106:109], v[150:153]
v_cvt_pk_bf16_f32 v100, v146, v147
v_cvt_pk_bf16_f32 v101, v148, v149
v_mfma_f32_16x16x32_bf16 v[154:157], v[224:227], v[110:113], v[154:157]
ds_write_b128 v211, v[90:93] offset:20480
v_mfma_f32_16x16x32_bf16 v[154:157], v[228:231], v[106:109], v[154:157]
s_nop 0
v_cvt_pk_bf16_f32 v94, v220, v221
v_cvt_pk_bf16_f32 v95, v222, v223
v_mfma_f32_16x16x32_bf16 v[158:161], v[248:251], v[110:113], v[158:161]
s_waitcnt lgkmcnt(4)
v_fma_f32 v220, v48, v126, v127
v_fma_f32 v221, v49, v126, v127
v_mfma_f32_16x16x32_bf16 v[158:161], v[252:255], v[106:109], v[158:161]
v_fma_f32 v222, v50, v126, v127
v_fma_f32 v223, v51, v126, v127
v_mfma_f32_16x16x32_bf16 v[162:165], v[110:113], a[88:91], v[162:165]
v_cvt_pk_bf16_f32 v98, v142, v143
v_cvt_pk_bf16_f32 v99, v144, v145
v_mfma_f32_16x16x32_bf16 v[162:165], v[106:109], a[92:95], v[162:165]
v_cvt_pk_bf16_f32 v174, v220, v221
v_cvt_pk_bf16_f32 v175, v222, v223
v_mfma_f32_16x16x32_bf16 v[166:169], v[110:113], a[112:115], v[166:169]
v_cvt_pk_bf16_f32 v84, v150, v151
v_cvt_pk_bf16_f32 v85, v152, v153
v_mfma_f32_16x16x32_bf16 v[166:169], v[106:109], a[116:119], v[166:169]
v_fma_f32 v220, v52, v126, v127
v_fma_f32 v221, v53, v126, v127
v_mfma_f32_16x16x32_bf16 v[170:173], v[110:113], a[136:139], v[170:173]
ds_read_b64 v[112:113], v215 offset:528
v_fma_f32 v222, v54, v126, v127
v_mfma_f32_16x16x32_bf16 v[170:173], v[106:109], a[140:143], v[170:173]
s_waitcnt lgkmcnt(3)
ds_read_b128 v[108:111], v215 offset:512
v_fma_f32 v223, v55, v126, v127
v_mfma_f32_16x16x32_bf16 v[138:141], a[0:3], v[182:185], 0
s_waitcnt lgkmcnt(3)
v_cvt_pk_bf16_f32 v176, v220, v221
v_cvt_pk_bf16_f32 v177, v222, v223
v_mfma_f32_16x16x32_bf16 v[138:141], a[4:7], v[186:189], v[138:141]
ds_write_b128 v211, v[174:177] offset:26624
v_mfma_f32_16x16x32_bf16 v[142:145], a[24:27], v[182:185], 0
v_cvt_pk_bf16_f32 v132, v170, v171
v_cvt_pk_bf16_f32 v133, v172, v173
v_mfma_f32_16x16x32_bf16 v[142:145], a[28:31], v[186:189], v[142:145]
v_fma_f32 v220, v56, v126, v127
v_fma_f32 v221, v57, v126, v127
v_mfma_f32_16x16x32_bf16 v[146:149], a[48:51], v[182:185], 0
s_nop 0
ds_read_b128 v[170:173], v210 offset:14336
ds_read_b128 v[182:185], v210 offset:15360
v_mfma_f32_16x16x32_bf16 v[146:149], a[52:55], v[186:189], v[146:149]
s_waitcnt lgkmcnt(3)
ds_read_b128 v[174:177], v210 offset:14336
ds_read_b128 v[186:189], v210 offset:16384
v_fma_f32 v222, v58, v126, v127
v_mfma_f32_16x16x16_bf16 v[150:153], v[112:113], v[76:77], v[206:209]
v_fma_f32 v223, v59, v126, v127
v_cvt_pk_bf16_f32 v178, v220, v221
v_cvt_pk_bf16_f32 v179, v222, v223
v_cvt_pk_bf16_f32 v88, v158, v159
v_cvt_pk_bf16_f32 v89, v160, v161
v_cvt_pk_bf16_f32 v86, v154, v155
v_mfma_f32_16x16x32_bf16 v[150:153], v[108:111], v[72:75], v[150:153]
ds_write_b64 v212, v[178:179] offset:26624
v_mfma_f32_16x16x16_bf16 v[158:161], v[100:101], v[88:89], 0
v_cvt_pk_bf16_f32 v87, v156, v157
v_cvt_pk_bf16_f32 v124, v166, v167
v_cvt_pk_bf16_f32 v125, v168, v169
v_mfma_f32_16x16x16_bf16 v[154:157], v[82:83], v[88:89], 0
v_exp_f32_e64 v150, v150
v_fma_f32 v220, v60, v134, v135
v_mfma_f32_16x16x16_bf16 v[166:169], v[112:113], v[88:89], v[206:209]
s_waitcnt lgkmcnt(4)
ds_read_b128 v[178:181], v210 offset:15360
ds_write_b64 v212, v[94:95] offset:20480
v_mfma_f32_16x16x32_bf16 v[138:141], a[8:11], v[170:173], v[138:141]
s_waitcnt lgkmcnt(5)
v_fma_f32 v221, v61, v134, v135
v_fma_f32 v222, v62, v134, v135
v_mfma_f32_16x16x32_bf16 v[138:141], a[12:15], v[182:185], v[138:141]
v_fma_f32 v223, v63, v134, v135
v_cvt_pk_bf16_f32 v116, v162, v163
v_mfma_f32_16x16x32_bf16 v[142:145], a[32:35], v[170:173], v[142:145]
v_cvt_pk_bf16_f32 v117, v164, v165
v_cvt_pk_bf16_f32 v90, v220, v221
v_mfma_f32_16x16x32_bf16 v[142:145], a[36:39], v[182:185], v[142:145]
v_cvt_pk_bf16_f32 v91, v222, v223
v_fma_f32 v220, v64, v134, v135
v_mfma_f32_16x16x32_bf16 v[146:149], a[56:59], v[170:173], v[146:149]
s_nop 0
ds_read_b128 v[170:173], v210 offset:17408
v_fma_f32 v221, v65, v134, v135
v_mfma_f32_16x16x32_bf16 v[146:149], a[60:63], v[182:185], v[146:149]
s_waitcnt lgkmcnt(4)
ds_read_b128 v[182:185], v210 offset:12288
v_fma_f32 v222, v66, v134, v135
v_mfma_f32_16x16x32_bf16 v[138:141], a[16:19], v[186:189], v[138:141]
v_fma_f32 v223, v67, v134, v135
v_cvt_pk_bf16_f32 v92, v220, v221
v_mfma_f32_16x16x32_bf16 v[142:145], a[40:43], v[186:189], v[142:145]
v_cvt_pk_bf16_f32 v93, v222, v223
v_fma_f32 v220, v68, v134, v135
v_mfma_f32_16x16x32_bf16 v[154:157], v[78:81], v[84:87], v[154:157]
ds_write_b128 v211, v[90:93] offset:32768
v_mfma_f32_16x16x32_bf16 v[146:149], a[64:67], v[186:189], v[146:149]
s_waitcnt lgkmcnt(2)
v_exp_f32 v154, v154
v_mfma_f32_16x16x32_bf16 v[138:141], a[20:23], v[170:173], v[138:141]
s_waitcnt lgkmcnt(1)
v_exp_f32 v155, v155
v_mfma_f32_16x16x32_bf16 v[118:121], v[182:185], a[72:75], 0
ds_read_b128 v[186:189], v210 offset:13312
v_fma_f32 v221, v69, v134, v135
v_mfma_f32_16x16x32_bf16 v[126:129], v[182:185], a[96:99], 0
v_cvt_pk_bf16_f32 v102, v138, v139
v_cvt_pk_bf16_f32 v103, v140, v141
v_fma_f32 v222, v70, v134, v135
v_mfma_f32_16x16x16_bf16 v[138:141], v[82:83], v[76:77], 0
v_exp_f32 v156, v156
v_exp_f32 v157, v157
v_mfma_f32_16x16x32_bf16 v[90:93], a[216:219], v[182:185], 0
v_fma_f32 v223, v71, v134, v135
v_cvt_pk_bf16_f32 v94, v220, v221
v_mfma_f32_16x16x32_bf16 v[138:141], v[78:81], v[72:75], v[138:141]
s_nop 0
v_cvt_pk_bf16_f32 v95, v222, v223
v_mfma_f32_16x16x32_bf16 v[134:137], v[182:185], a[120:123], 0
s_waitcnt lgkmcnt(0)
ds_write_b64 v212, v[94:95] offset:32768
v_mfma_f32_16x16x32_bf16 v[134:137], v[186:189], a[124:127], v[134:137]
v_exp_f32 v138, v138
v_mfma_f32_16x16x32_bf16 v[118:121], v[186:189], a[76:79], v[118:121]
v_exp_f32 v139, v139
v_mfma_f32_16x16x32_bf16 v[126:129], v[186:189], a[100:103], v[126:129]
v_exp_f32 v140, v140
v_mfma_f32_16x16x32_bf16 v[142:145], a[44:47], v[170:173], v[142:145]
v_exp_f32 v141, v141
v_mfma_f32_16x16x32_bf16 v[90:93], a[220:223], v[186:189], v[90:93]
v_mfma_f32_16x16x32_bf16 v[220:223], v[232:235], v[182:185], 0
v_cvt_pk_bf16_f32 v104, v142, v143
v_cvt_pk_bf16_f32 v105, v144, v145
v_mfma_f32_16x16x16_bf16 v[142:145], v[100:101], v[76:77], 0
v_mfma_f32_16x16x32_bf16 v[146:149], a[68:71], v[170:173], v[146:149]
v_mfma_f32_16x16x32_bf16 v[142:145], v[96:99], v[72:75], v[142:145]
v_mfma_f32_16x16x32_bf16 v[170:173], a[240:243], v[182:185], 0
v_cvt_pk_bf16_f32 v106, v146, v147
v_cvt_pk_bf16_f32 v107, v148, v149
v_mfma_f32_16x16x32_bf16 v[170:173], a[244:247], v[186:189], v[170:173]
v_exp_f32 v142, v142
v_mfma_f32_16x16x16_bf16 v[146:149], v[106:107], v[76:77], 0
v_exp_f32 v143, v143
v_exp_f32 v144, v144
v_mfma_f32_16x16x16_bf16 v[162:165], v[106:107], v[88:89], 0
v_exp_f32 v145, v145
v_mfma_f32_16x16x32_bf16 v[146:149], v[102:105], v[72:75], v[146:149]
ds_read_b128 v[182:185], v210 offset:16384
ds_read_b64 v[76:77], v215 offset:16
v_mfma_f32_16x16x32_bf16 v[220:223], v[236:239], v[186:189], v[220:223]
ds_read_b128 v[186:189], v210 offset:17408
ds_read_b128 v[72:75], v215
v_mfma_f32_16x16x32_bf16 v[158:161], v[96:99], v[84:87], v[158:161]
v_exp_f32 v146, v146
v_mfma_f32_16x16x32_bf16 v[118:121], v[174:177], a[80:83], v[118:121]
v_exp_f32 v147, v147
v_mfma_f32_16x16x32_bf16 v[118:121], v[178:181], a[84:87], v[118:121]
v_exp_f32 v158, v158
v_mfma_f32_16x16x32_bf16 v[126:129], v[174:177], a[104:107], v[126:129]
v_exp_f32 v159, v159
v_mfma_f32_16x16x32_bf16 v[126:129], v[178:181], a[108:111], v[126:129]
v_exp_f32 v160, v160
v_mfma_f32_16x16x32_bf16 v[134:137], v[174:177], a[128:131], v[134:137]
v_exp_f32 v161, v161
v_mfma_f32_16x16x32_bf16 v[134:137], v[178:181], a[132:135], v[134:137]
v_exp_f32 v148, v148
v_mfma_f32_16x16x32_bf16 v[166:169], v[108:111], v[84:87], v[166:169]
v_exp_f32 v149, v149
v_mfma_f32_16x16x32_bf16 v[90:93], a[224:227], v[174:177], v[90:93]
v_mfma_f32_16x16x32_bf16 v[90:93], a[228:231], v[178:181], v[90:93]
v_exp_f32_e64 v166, v166
v_mfma_f32_16x16x32_bf16 v[170:173], a[248:251], v[174:177], v[170:173]
v_mfma_f32_16x16x32_bf16 v[170:173], a[252:255], v[178:181], v[170:173]
v_mfma_f32_16x16x32_bf16 v[220:223], v[240:243], v[174:177], v[220:223]
v_cvt_pk_bf16_f32 v174, v138, v139
v_cvt_pk_bf16_f32 v175, v140, v141
v_mfma_f32_16x16x32_bf16 v[220:223], v[244:247], v[178:181], v[220:223]
s_nop 0
v_cvt_pk_bf16_f32 v176, v142, v143
v_cvt_pk_bf16_f32 v177, v144, v145
v_mfma_f32_16x16x32_bf16 v[162:165], v[102:105], v[84:87], v[162:165]
s_waitcnt lgkmcnt(3)
v_cvt_pk_bf16_f32 v180, v150, 0
v_cvt_pk_bf16_f32 v178, v146, v147
v_mfma_f32_16x16x32_bf16 v[118:121], v[182:185], a[88:91], v[118:121]
s_waitcnt lgkmcnt(1)
v_cvt_pk_bf16_f32 v179, v148, v149
v_mov_b32 v181, 0
v_mfma_f32_16x16x32_bf16 v[118:121], v[186:189], a[92:95], v[118:121]
v_exp_f32 v162, v162
v_mfma_f32_16x16x32_bf16 v[126:129], v[182:185], a[112:115], v[126:129]
v_exp_f32 v163, v163
v_mfma_f32_16x16x32_bf16 v[126:129], v[186:189], a[116:119], v[126:129]
v_exp_f32 v164, v164
v_mfma_f32_16x16x32_bf16 v[134:137], v[182:185], a[136:139], v[134:137]
v_exp_f32 v165, v165
v_mfma_f32_16x16x32_bf16 v[134:137], v[186:189], a[140:143], v[134:137]
v_cvt_pk_bf16_f32 v118, v118, v119
v_cvt_pk_bf16_f32 v119, v120, v121
v_mfma_f32_16x16x32_bf16 v[90:93], a[232:235], v[182:185], v[90:93]
ds_read_u16 v120, v214 offset:1024
v_mov_b32_e64 v121, 0
v_mfma_f32_16x16x32_bf16 v[90:93], a[236:239], v[186:189], v[90:93]
v_cvt_pk_bf16_f32 v126, v126, v127
v_cvt_pk_bf16_f32 v127, v128, v129
v_mfma_f32_16x16x32_bf16 v[170:173], v[224:227], v[182:185], v[170:173]
ds_read_u16 v128, v214 offset:1032
v_cvt_pk_bf16_f32 v134, v134, v135
v_mfma_f32_16x16x32_bf16 v[170:173], v[228:231], v[186:189], v[170:173]
v_cvt_pk_bf16_f32 v135, v136, v137
v_mov_b32_e64 v129, 0
v_mfma_f32_16x16x32_bf16 v[220:223], v[248:251], v[182:185], v[220:223]
ds_read_u16 v136, v214 offset:1040
v_mov_b32_e64 v137, 0
v_mfma_f32_16x16x32_bf16 v[220:223], v[252:255], v[186:189], v[220:223]
v_cvt_pk_bf16_f32 v90, v90, v91
v_cvt_pk_bf16_f32 v91, v92, v93
v_mfma_f32_16x16x32_bf16 v[150:153], v[190:193], v[174:177], 0
v_cvt_pk_bf16_f32 v92, v170, v171
v_cvt_pk_bf16_f32 v93, v172, v173
v_mfma_f32_16x16x32_bf16 v[150:153], v[190:193], v[178:181], v[150:153]
v_cvt_pk_bf16_f32 v94, v220, v221
v_cvt_pk_bf16_f32 v95, v222, v223
v_mfma_f32_16x16x32_bf16 v[138:141], v[114:117], v[174:177], 0
s_waitcnt lgkmcnt(2)
v_mfma_f32_16x16x32_bf16 v[138:141], v[118:121], v[178:181], v[138:141]
v_rcp_f32_e64 v151, v150
v_mfma_f32_16x16x32_bf16 v[142:145], v[122:125], v[174:177], 0
s_waitcnt lgkmcnt(1)
v_max3_u32 v218, v218, v150, v151
v_mul_f32_e64 v151, s3, v151
v_mfma_f32_16x16x32_bf16 v[142:145], v[126:129], v[178:181], v[142:145]
v_mul_f32_e64 v138, v138, v151
v_mul_f32 v139, v139, v151
v_mfma_f32_16x16x32_bf16 v[146:149], v[130:133], v[174:177], 0
s_waitcnt lgkmcnt(0)
v_cvt_pk_bf16_f32 v174, v154, v155
v_cvt_pk_bf16_f32 v175, v156, v157
v_mfma_f32_16x16x32_bf16 v[146:149], v[134:137], v[178:181], v[146:149]
v_cvt_pk_bf16_f32 v176, v158, v159
v_cvt_pk_bf16_f32 v177, v160, v161
v_cvt_pk_bf16_f32 v180, v166, 0
v_cvt_pk_bf16_f32 v178, v162, v163
v_mfma_f32_16x16x32_bf16 v[166:169], v[190:193], v[174:177], 0
v_cvt_pk_bf16_f32 v179, v164, v165
v_mul_f32 v140, v140, v151
v_mul_f32 v141, v141, v151
v_mfma_f32_16x16x32_bf16 v[166:169], v[190:193], v[178:181], v[166:169]
v_cvt_pk_bf16_f32 v138, v138, v139
v_mul_f32_e64 v142, v142, v151
v_mfma_f32_16x16x32_bf16 v[154:157], v[114:117], v[174:177], 0
v_mul_f32 v143, v143, v151
v_mul_f32 v144, v144, v151
v_mfma_f32_16x16x32_bf16 v[154:157], v[118:121], v[178:181], v[154:157]
v_mul_f32_e64 v145, v145, v151
v_cvt_pk_bf16_f32 v139, v140, v141
v_mfma_f32_16x16x32_bf16 v[158:161], v[122:125], v[174:177], 0
v_cvt_pk_bf16_f32 v140, v142, v143
v_cvt_pk_bf16_f32 v141, v144, v145
v_mfma_f32_16x16x32_bf16 v[158:161], v[126:129], v[178:181], v[158:161]
ds_write_b128 v211, v[138:141] offset:38912
v_mfma_f32_16x16x32_bf16 v[162:165], v[130:133], v[174:177], 0
v_mul_f32 v146, v146, v151
v_mul_f32 v147, v147, v151
v_mfma_f32_16x16x32_bf16 v[162:165], v[134:137], v[178:181], v[162:165]
v_mul_f32 v148, v148, v151
v_mul_f32 v149, v149, v151
v_cvt_pk_bf16_f32 v142, v146, v147
v_mfma_f32_16x16x16_bf16 v[138:141], v[82:83], v[94:95], 0
v_cvt_pk_bf16_f32 v143, v148, v149
v_rcp_f32_e64 v167, v166
v_mfma_f32_16x16x16_bf16 v[150:153], v[112:113], v[94:95], v[206:209]
v_max3_u32 v218, v218, v166, v167
v_mul_f32 v167, s3, v167
v_mul_f32 v154, v154, v167
v_mfma_f32_16x16x16_bf16 v[146:149], v[106:107], v[94:95], 0
v_mul_f32 v155, v155, v167
v_mul_f32 v156, v156, v167
v_mul_f32_e64 v157, v157, v167
v_cvt_pk_bf16_f32 v154, v154, v155
v_mfma_f32_16x16x32_bf16 v[138:141], v[78:81], v[90:93], v[138:141]
ds_write_b64 v212, v[142:143] offset:38912
v_mfma_f32_16x16x16_bf16 v[142:145], v[100:101], v[94:95], 0
v_mul_f32 v158, v158, v167
v_mul_f32 v159, v159, v167
v_mul_f32 v160, v160, v167
v_mul_f32 v161, v161, v167
v_mfma_f32_16x16x32_bf16 v[150:153], v[108:111], v[90:93], v[150:153]
v_cvt_pk_bf16_f32 v155, v156, v157
v_cvt_pk_bf16_f32 v156, v158, v159
v_mfma_f32_16x16x32_bf16 v[142:145], v[96:99], v[90:93], v[142:145]
v_cvt_pk_bf16_f32 v157, v160, v161
v_mul_f32_e64 v162, v162, v167
v_mfma_f32_16x16x32_bf16 v[146:149], v[102:105], v[90:93], v[146:149]
ds_write_b128 v211, v[154:157] offset:45056
v_mfma_f32_16x16x16_bf16 v[154:157], v[76:77], v[82:83], 0
v_mul_f32 v163, v163, v167
v_mul_f32 v164, v164, v167
v_mul_f32_e64 v165, v165, v167
v_mfma_f32_16x16x16_bf16 v[166:169], v[76:77], v[112:113], v[206:209]
v_cvt_pk_bf16_f32 v158, v162, v163
v_cvt_pk_bf16_f32 v159, v164, v165
v_exp_f32 v138, v138
v_mfma_f32_16x16x16_bf16 v[162:165], v[76:77], v[106:107], 0
v_exp_f32 v139, v139
v_exp_f32 v140, v140
v_mfma_f32_16x16x32_bf16 v[154:157], v[72:75], v[78:81], v[154:157]
ds_write_b64 v212, v[158:159] offset:45056
v_mfma_f32_16x16x16_bf16 v[158:161], v[76:77], v[100:101], 0
v_exp_f32 v141, v141
v_exp_f32 v142, v142
v_mfma_f32_16x16x32_bf16 v[162:165], v[72:75], v[102:105], v[162:165]
v_exp_f32 v143, v143
v_mfma_f32_16x16x32_bf16 v[158:161], v[72:75], v[96:99], v[158:161]
v_exp_f32 v144, v144
v_mfma_f32_16x16x32_bf16 v[166:169], v[72:75], v[108:111], v[166:169]
v_exp_f32 v145, v145
v_exp_f32 v150, v150
v_exp_f32 v146, v146
v_exp_f32 v147, v147
v_exp_f32 v148, v148
v_exp_f32_e64 v149, v149
v_cvt_pk_bf16_f32 v174, v138, v139
v_cvt_pk_bf16_f32 v175, v140, v141
v_cvt_pk_bf16_f32 v176, v142, v143
v_cvt_pk_bf16_f32 v177, v144, v145
v_cvt_pk_bf16_f32 v180, v150, 0
v_cvt_pk_bf16_f32 v178, v146, v147
v_mfma_f32_16x16x32_bf16 v[150:153], v[190:193], v[174:177], 0
s_waitcnt lgkmcnt(0)
v_cvt_pk_bf16_f32 v179, v148, v149
v_mov_b32_dpp v154, v158 quad_perm:[0,1,2,3] row_mask:0x2 bank_mask:0xf
v_mfma_f32_16x16x32_bf16 v[138:141], v[114:117], v[174:177], 0
s_barrier
v_mfma_f32_16x16x32_bf16 v[138:141], v[118:121], v[178:181], v[138:141]
ds_read_b128 v[220:223], v210 offset:38912
ds_read_b128 v[110:113], v210 offset:39936
v_mfma_f32_16x16x32_bf16 v[150:153], v[190:193], v[178:181], v[150:153]
ds_read_b128 v[170:173], v210 offset:40960
ds_read_b128 v[182:185], v210 offset:41984
v_mfma_f32_16x16x32_bf16 v[142:145], v[122:125], v[174:177], 0
v_mov_b32_dpp v154, v162 quad_perm:[0,1,2,3] row_mask:0x4 bank_mask:0xf
v_mfma_f32_16x16x32_bf16 v[142:145], v[126:129], v[178:181], v[142:145]
v_mov_b32_dpp v154, v167 quad_perm:[0,1,2,3] row_mask:0x8 bank_mask:0xf
v_exp_f32 v154, v154
v_mfma_f32_16x16x32_bf16 v[146:149], v[130:133], v[174:177], 0
v_cvt_pk_bf16_f32 v154, v154, 0
v_rcp_f32 v151, v150
v_mfma_f32_16x16x32_bf16 v[146:149], v[134:137], v[178:181], v[146:149]
s_waitcnt lgkmcnt(3)
ds_write_b16 v214, v154
v_mfma_f32_16x16x32_bf16 v[0:3], a[144:147], v[220:223], v[0:3]
s_waitcnt lgkmcnt(3)
ds_read_b128 v[84:87], v215
ds_read_b128 v[88:91], v215 offset:16
v_mfma_f32_16x16x32_bf16 v[0:3], a[148:151], v[110:113], v[0:3]
ds_read_b128 v[186:189], v210 offset:43008
ds_read_b128 v[174:177], v210 offset:34816
v_mfma_f32_16x16x32_bf16 v[4:7], a[168:171], v[220:223], v[4:7]
ds_read_b128 v[178:181], v210 offset:35840
v_add_u32 v215, 1552, v215
v_mfma_f32_16x16x32_bf16 v[4:7], a[172:175], v[110:113], v[4:7]
v_mfma_f32_16x16x32_bf16 v[8:11], a[192:195], v[220:223], v[8:11]
ds_read_b128 v[220:223], v210 offset:44032
v_mfma_f32_16x16x32_bf16 v[8:11], a[196:199], v[110:113], v[8:11]
s_nop 0
ds_read_b128 v[110:113], v210 offset:45056
s_waitcnt lgkmcnt(6)
v_mfma_f32_16x16x32_bf16 v[166:169], v[84:87], v[190:193], 0
s_waitcnt lgkmcnt(5)
v_mfma_f32_16x16x32_bf16 v[166:169], v[88:91], v[190:193], v[166:169]
v_mfma_f32_16x16x32_bf16 v[154:157], v[84:87], v[114:117], 0
v_mfma_f32_16x16x32_bf16 v[154:157], v[88:91], v[118:121], v[154:157]
v_rcp_f32 v167, v166
v_mfma_f32_16x16x32_bf16 v[158:161], v[84:87], v[122:125], 0
v_max3_u32 v218, v218, v166, v167
v_max3_u32 v218, v218, v150, v151
v_mfma_f32_16x16x32_bf16 v[158:161], v[88:91], v[126:129], v[158:161]
v_mul_f32 v151, s3, v151
v_mul_f32 v138, v138, v151
v_mfma_f32_16x16x32_bf16 v[162:165], v[84:87], v[130:133], 0
v_mul_f32 v139, v139, v151
v_mul_f32 v140, v140, v151
v_mfma_f32_16x16x32_bf16 v[162:165], v[88:91], v[134:137], v[162:165]
v_mul_f32_e64 v141, v141, v151
v_cvt_pk_bf16_f32 v138, v138, v139
v_mfma_f32_16x16x32_bf16 v[0:3], a[152:155], v[170:173], v[0:3]
v_mul_f32 v142, v142, v151
v_mul_f32 v143, v143, v151
v_mfma_f32_16x16x32_bf16 v[0:3], a[156:159], v[182:185], v[0:3]
s_waitcnt lgkmcnt(4)
v_mul_f32 v144, v144, v151
v_mul_f32_e64 v145, v145, v151
v_mfma_f32_16x16x32_bf16 v[0:3], a[160:163], v[186:189], v[0:3]
v_cvt_pk_bf16_f32 v139, v140, v141
v_cvt_pk_bf16_f32 v140, v142, v143
v_mfma_f32_16x16x32_bf16 v[4:7], a[176:179], v[170:173], v[4:7]
v_cvt_pk_bf16_f32 v141, v144, v145
v_mul_f32_e64 v146, v146, v151
v_mfma_f32_16x16x32_bf16 v[4:7], a[180:183], v[182:185], v[4:7]
ds_write_b128 v211, v[138:141] offset:51200
v_mfma_f32_16x16x32_bf16 v[4:7], a[184:187], v[186:189], v[4:7]
v_mul_f32 v147, v147, v151
v_mul_f32 v148, v148, v151
v_mfma_f32_16x16x32_bf16 v[8:11], a[200:203], v[170:173], v[8:11]
v_mul_f32_e64 v149, v149, v151
v_cvt_pk_bf16_f32 v142, v146, v147
v_mfma_f32_16x16x32_bf16 v[8:11], a[204:207], v[182:185], v[8:11]
s_nop 0
ds_read_b128 v[170:173], v210 offset:46080
ds_read_b128 v[182:185], v210 offset:47104
v_mfma_f32_16x16x32_bf16 v[8:11], a[208:211], v[186:189], v[8:11]
s_waitcnt lgkmcnt(4)
ds_read_b128 v[186:189], v210 offset:48128
v_cvt_pk_bf16_f32 v143, v148, v149
v_mfma_f32_16x16x32_bf16 v[8:11], a[212:215], v[220:223], v[8:11]
ds_write_b64 v212, v[142:143] offset:51200
v_mfma_f32_16x16x32_bf16 v[0:3], a[164:167], v[220:223], v[0:3]
v_mov_b32_dpp v154, v158 quad_perm:[0,1,2,3] row_mask:0x2 bank_mask:0xf
v_mul_f32 v167, s3, v167
v_mfma_f32_16x16x32_bf16 v[4:7], a[188:191], v[220:223], v[4:7]
s_waitcnt lgkmcnt(5)
ds_read_b128 v[220:223], v210 offset:49152
v_mov_b32_dpp v154, v162 quad_perm:[0,1,2,3] row_mask:0x4 bank_mask:0xf
v_mfma_f32_16x16x32_bf16 v[12:15], a[144:147], v[110:113], v[12:15]
s_waitcnt lgkmcnt(4)
v_cvt_pk_bf16_f32 v72, v0, v1
v_cvt_pk_bf16_f32 v73, v2, v3
v_mfma_f32_16x16x32_bf16 v[12:15], a[148:151], v[170:173], v[12:15]
s_waitcnt lgkmcnt(3)
buffer_store_dwordx2 v[72:73], v203, s[8:11], s38 offen
v_mul_f32 v154, v154, v167
v_mfma_f32_16x16x32_bf16 v[12:15], a[152:155], v[182:185], v[12:15]
s_waitcnt lgkmcnt(2)
v_cvt_pk_bf16_f32 v154, v154, 0
v_cvt_pk_bf16_f32 v74, v4, v5
v_mfma_f32_16x16x32_bf16 v[12:15], a[156:159], v[186:189], v[12:15]
ds_write_b16 v214, v154
v_mfma_f32_16x16x32_bf16 v[16:19], a[168:171], v[110:113], v[16:19]
s_nop 0
v_cvt_pk_bf16_f32 v75, v6, v7
v_cvt_pk_bf16_f32 v76, v8, v9
v_mfma_f32_16x16x32_bf16 v[16:19], a[172:175], v[170:173], v[16:19]
s_waitcnt lgkmcnt(2)
v_cvt_pk_bf16_f32 v77, v10, v11
v_add_u32 v214, 1552, v214
v_mfma_f32_16x16x32_bf16 v[16:19], a[176:179], v[182:185], v[16:19]
s_barrier
v_mfma_f32_16x16x32_bf16 v[16:19], a[180:183], v[186:189], v[16:19]
v_mfma_f32_16x16x32_bf16 v[20:23], a[192:195], v[110:113], v[20:23]
ds_read_b128 v[110:113], v210 offset:50176
v_mfma_f32_16x16x32_bf16 v[20:23], a[196:199], v[170:173], v[20:23]
ds_read_b128 v[170:173], v210 offset:51200
v_mfma_f32_16x16x32_bf16 v[20:23], a[200:203], v[182:185], v[20:23]
ds_read_b128 v[182:185], v210 offset:52224
v_mfma_f32_16x16x32_bf16 v[20:23], a[204:207], v[186:189], v[20:23]
ds_read_b128 v[186:189], v210 offset:53248
s_waitcnt lgkmcnt(5)
v_mfma_f32_16x16x32_bf16 v[20:23], a[208:211], v[220:223], v[20:23]
v_mfma_f32_16x16x32_bf16 v[12:15], a[160:163], v[220:223], v[12:15]
s_nop 0
buffer_store_dwordx2 v[74:75], v203, s[8:11], s38 offen offset:32
s_waitcnt lgkmcnt(3)
v_mfma_f32_16x16x32_bf16 v[12:15], a[164:167], v[110:113], v[12:15]
v_mfma_f32_16x16x32_bf16 v[16:19], a[184:187], v[220:223], v[16:19]
ds_read_b128 v[220:223], v210 offset:54272
v_mfma_f32_16x16x32_bf16 v[16:19], a[188:191], v[110:113], v[16:19]
v_cvt_pk_bf16_f32 v78, v12, v13
v_cvt_pk_bf16_f32 v79, v14, v15
v_mfma_f32_16x16x32_bf16 v[20:23], a[212:215], v[110:113], v[20:23]
ds_read_b128 v[110:113], v210 offset:55296
s_waitcnt lgkmcnt(4)
v_mfma_f32_16x16x32_bf16 v[24:27], a[144:147], v[170:173], v[24:27]
s_waitcnt lgkmcnt(3)
v_cvt_pk_bf16_f32 v80, v16, v17
v_cvt_pk_bf16_f32 v81, v18, v19
v_mfma_f32_16x16x32_bf16 v[24:27], a[148:151], v[182:185], v[24:27]
s_waitcnt lgkmcnt(2)
v_cvt_pk_bf16_f32 v82, v20, v21
v_cvt_pk_bf16_f32 v83, v22, v23
v_mfma_f32_16x16x32_bf16 v[24:27], a[152:155], v[186:189], v[24:27]
s_waitcnt lgkmcnt(1)
v_mfma_f32_16x16x32_bf16 v[24:27], a[156:159], v[220:223], v[24:27]
v_mfma_f32_16x16x32_bf16 v[28:31], a[168:171], v[170:173], v[28:31]
v_mfma_f32_16x16x32_bf16 v[28:31], a[172:175], v[182:185], v[28:31]
v_mfma_f32_16x16x32_bf16 v[28:31], a[176:179], v[186:189], v[28:31]
v_mfma_f32_16x16x32_bf16 v[28:31], a[180:183], v[220:223], v[28:31]
v_mfma_f32_16x16x32_bf16 v[32:35], a[192:195], v[170:173], v[32:35]
ds_read_b128 v[170:173], v210 offset:56320
v_mfma_f32_16x16x32_bf16 v[32:35], a[196:199], v[182:185], v[32:35]
ds_read_b128 v[182:185], v210 offset:20480
v_mfma_f32_16x16x32_bf16 v[32:35], a[200:203], v[186:189], v[32:35]
ds_read_b128 v[186:189], v210 offset:21504
buffer_store_dwordx2 v[76:77], v203, s[8:11], s38 offen offset:64
v_mfma_f32_16x16x32_bf16 v[32:35], a[204:207], v[220:223], v[32:35]
s_nop 0
ds_read_b128 v[220:223], v210 offset:23552
s_waitcnt lgkmcnt(4)
v_mfma_f32_16x16x32_bf16 v[32:35], a[208:211], v[110:113], v[32:35]
v_mfma_f32_16x16x32_bf16 v[24:27], a[160:163], v[110:113], v[24:27]
s_waitcnt lgkmcnt(3)
s_barrier
v_mfma_f32_16x16x32_bf16 v[24:27], a[164:167], v[170:173], v[24:27]
v_mfma_f32_16x16x32_bf16 v[28:31], a[184:187], v[110:113], v[28:31]
ds_read_b128 v[110:113], v210 offset:22528
v_mfma_f32_16x16x32_bf16 v[28:31], a[188:191], v[170:173], v[28:31]
v_cvt_pk_bf16_f32 v116, v24, v25
v_subrev_u32 v24, 37120, v210
v_mfma_f32_16x16x32_bf16 v[32:35], a[212:215], v[170:173], v[32:35]
s_waitcnt lgkmcnt(3)
v_lshrrev_b32 v25, 4, v24
v_cvt_pk_bf16_f32 v117, v26, v27
v_mfma_f32_16x16x32_bf16 v[138:141], a[0:3], v[182:185], 0
s_waitcnt lgkmcnt(2)
v_cvt_pk_bf16_f32 v124, v28, v29
v_and_b32 v25, 15, v25
v_mfma_f32_16x16x32_bf16 v[138:141], a[4:7], v[186:189], v[138:141]
s_nop 0
v_lshrrev_b32 v26, 8, v24
v_mul_u32_u24 v27, 1552, v25
v_mfma_f32_16x16x32_bf16 v[142:145], a[24:27], v[182:185], 0
v_mul_u32_u24 v28, 784, v25
v_lshl_add_u32 v27, v26, 5, v27
v_mfma_f32_16x16x32_bf16 v[142:145], a[28:31], v[186:189], v[142:145]
v_lshl_add_u32 v28, v26, 4, v28
v_add_u32 v27, 94464, v27
v_mfma_f32_16x16x32_bf16 v[146:149], a[48:51], v[182:185], 0
ds_read_b128 v[84:87], v27
ds_read_b128 v[88:91], v27 offset:128
v_mfma_f32_16x16x32_bf16 v[146:149], a[52:55], v[186:189], v[146:149]
ds_read_b128 v[92:95], v27 offset:256
ds_read_b128 v[96:99], v27 offset:384
v_mfma_f32_16x16x32_bf16 v[150:153], a[216:219], v[182:185], 0
ds_read_b64 v[100:101], v27 offset:16
ds_read_b64 v[102:103], v27 offset:144
v_mfma_f32_16x16x32_bf16 v[150:153], a[220:223], v[186:189], v[150:153]
ds_read_b64 v[104:105], v27 offset:272
ds_read_b64 v[106:107], v27 offset:400
v_mfma_f32_16x16x32_bf16 v[154:157], a[240:243], v[182:185], 0
v_add_u32 v28, s41, v28
v_cvt_pk_bf16_f32 v125, v30, v31
v_mfma_f32_16x16x32_bf16 v[154:157], a[244:247], v[186:189], v[154:157]
s_add_u32 s41, s33, 0
ds_read_b128 v[0:3], v28
ds_read_b128 v[4:7], v28 offset:64
v_mfma_f32_16x16x32_bf16 v[158:161], v[232:235], v[182:185], 0
ds_read_b128 v[8:11], v28 offset:128
buffer_store_dwordx2 v[78:79], v204, s[8:11], s38 offen
v_cvt_pk_bf16_f32 v132, v32, v33
v_mfma_f32_16x16x32_bf16 v[158:161], v[236:239], v[186:189], v[158:161]
v_cvt_pk_bf16_f32 v133, v34, v35
v_lshlrev_b32 v31, 5, v25
v_mfma_f32_16x16x32_bf16 v[162:165], v[182:185], a[72:75], 0
v_add_u32 v31, s41, v31
v_mul_hi_u32 v32, v31, s42
v_mfma_f32_16x16x32_bf16 v[162:165], v[186:189], a[76:79], v[162:165]
s_mov_b32 s42, 1373568
ds_read_b128 v[12:15], v28 offset:12544
v_mul_u32_u24 v29, 73, v32
v_mfma_f32_16x16x32_bf16 v[166:169], v[182:185], a[96:99], 0
s_add_u32 s41, s33, 512
v_mul_lo_u32 v32, v32, s42
v_sub_u32 v29, v31, v29
v_mfma_f32_16x16x32_bf16 v[166:169], v[186:189], a[100:103], v[166:169]
s_waitcnt lgkmcnt(3)
v_mul_u32_u24 v29, 2688, v29
v_cmp_gt_u32 vcc, s34, v31
v_mfma_f32_16x16x32_bf16 v[0:3], a[144:147], v[84:87], v[0:3]
s_nop 0
v_lshlrev_b32 v31, 5, v25
v_add_u32 v31, s41, v31
v_mfma_f32_16x16x32_bf16 v[0:3], a[148:151], v[88:91], v[0:3]
ds_read_b128 v[16:19], v28 offset:12608
ds_read_b128 v[20:23], v28 offset:12672
v_mfma_f32_16x16x32_bf16 v[0:3], a[152:155], v[92:95], v[0:3]
s_mul_i32 s42, s32, 96
v_add3_u32 v29, v29, v32, s42
v_mov_b32 v32, 1879048192
v_mfma_f32_16x16x32_bf16 v[0:3], a[156:159], v[96:99], v[0:3]
s_mov_b32 s42, 58835169
v_cndmask_b32 v29, v32, v29, vcc
v_cmp_gt_u32 vcc, 4, v25
v_mfma_f32_16x16x32_bf16 v[0:3], a[160:163], v[100:103], v[0:3]
v_mov_b32 v32, 6000
v_cndmask_b32 v31, v32, v31, vcc
v_mfma_f32_16x16x32_bf16 v[0:3], a[164:167], v[104:107], v[0:3]
s_waitcnt lgkmcnt(4)
v_mul_hi_u32 v32, v31, s42
v_mul_u32_u24 v30, 73, v32
v_mfma_f32_16x16x32_bf16 v[4:7], a[168:171], v[84:87], v[4:7]
s_mov_b32 s42, 1373568
v_mul_lo_u32 v32, v32, s42
v_sub_u32 v30, v31, v30
v_mfma_f32_16x16x32_bf16 v[4:7], a[172:175], v[88:91], v[4:7]
s_mul_i32 s42, s32, 96
buffer_store_dwordx2 v[80:81], v204, s[8:11], s38 offen offset:32
v_mul_u32_u24 v30, 2688, v30
v_mfma_f32_16x16x32_bf16 v[4:7], a[176:179], v[92:95], v[4:7]
v_add3_u32 v30, v30, v32, s42
v_cmp_gt_u32 vcc, s34, v31
v_mfma_f32_16x16x32_bf16 v[4:7], a[180:183], v[96:99], v[4:7]
s_nop 0
v_mov_b32 v32, 1879048192
v_cndmask_b32 v30, v32, v30, vcc
v_mfma_f32_16x16x32_bf16 v[4:7], a[184:187], v[100:103], v[4:7]
v_lshl_add_u32 v29, v26, 3, v29
v_cvt_pk_bf16_f32 v0, v0, v1
v_mfma_f32_16x16x32_bf16 v[4:7], a[188:191], v[104:107], v[4:7]
v_lshl_add_u32 v30, v26, 3, v30
v_add_u32 v29, 785664, v29
v_mfma_f32_16x16x32_bf16 v[170:173], v[182:185], a[120:123], 0
ds_read_b128 v[182:185], v210 offset:24576
v_cvt_pk_bf16_f32 v1, v2, v3
v_mfma_f32_16x16x32_bf16 v[170:173], v[186:189], a[124:127], v[170:173]
ds_read_b128 v[186:189], v210 offset:25600
v_cvt_pk_bf16_f32 v4, v4, v5
v_mfma_f32_16x16x32_bf16 v[138:141], a[8:11], v[110:113], v[138:141]
v_add_u32 v30, 785664, v30
v_cvt_pk_bf16_f32 v5, v6, v7
v_mfma_f32_16x16x32_bf16 v[138:141], a[12:15], v[220:223], v[138:141]
v_mfma_f32_16x16x32_bf16 v[142:145], a[32:35], v[110:113], v[142:145]
s_nop 0
v_mfma_f32_16x16x32_bf16 v[142:145], a[36:39], v[220:223], v[142:145]
s_waitcnt lgkmcnt(5)
v_mfma_f32_16x16x32_bf16 v[8:11], a[192:195], v[84:87], v[8:11]
v_mfma_f32_16x16x32_bf16 v[8:11], a[196:199], v[88:91], v[8:11]
v_mfma_f32_16x16x32_bf16 v[8:11], a[200:203], v[92:95], v[8:11]
v_mfma_f32_16x16x32_bf16 v[8:11], a[204:207], v[96:99], v[8:11]
v_mfma_f32_16x16x32_bf16 v[8:11], a[208:211], v[100:103], v[8:11]
v_mfma_f32_16x16x32_bf16 v[8:11], a[212:215], v[104:107], v[8:11]
buffer_store_dwordx2 v[82:83], v204, s[8:11], s38 offen offset:64
ds_read_b128 v[106:109], v210 offset:31744
v_mfma_f32_16x16x32_bf16 v[146:149], a[56:59], v[110:113], v[146:149]
v_mfma_f32_16x16x32_bf16 v[146:149], a[60:63], v[220:223], v[146:149]
v_cvt_pk_bf16_f32 v8, v8, v9
v_cvt_pk_bf16_f32 v9, v10, v11
v_mfma_f32_16x16x32_bf16 v[150:153], a[224:227], v[110:113], v[150:153]
v_mfma_f32_16x16x32_bf16 v[150:153], a[228:231], v[220:223], v[150:153]
v_mfma_f32_16x16x32_bf16 v[154:157], a[248:251], v[110:113], v[154:157]
v_mfma_f32_16x16x32_bf16 v[154:157], a[252:255], v[220:223], v[154:157]
v_mfma_f32_16x16x32_bf16 v[158:161], v[240:243], v[110:113], v[158:161]
v_mfma_f32_16x16x32_bf16 v[158:161], v[244:247], v[220:223], v[158:161]
v_mfma_f32_16x16x32_bf16 v[162:165], v[110:113], a[80:83], v[162:165]
v_mfma_f32_16x16x32_bf16 v[162:165], v[220:223], a[84:87], v[162:165]
v_mfma_f32_16x16x32_bf16 v[166:169], v[110:113], a[104:107], v[166:169]
v_mfma_f32_16x16x32_bf16 v[166:169], v[220:223], a[108:111], v[166:169]
v_mfma_f32_16x16x32_bf16 v[170:173], v[110:113], a[128:131], v[170:173]
ds_read_b128 v[110:113], v210 offset:26624
v_mfma_f32_16x16x32_bf16 v[170:173], v[220:223], a[132:135], v[170:173]
ds_read_b128 v[220:223], v210 offset:27648
s_waitcnt lgkmcnt(4)
v_mfma_f32_16x16x32_bf16 v[138:141], a[16:19], v[182:185], v[138:141]
buffer_store_dwordx2 v[116:117], v205, s[8:11], s38 offen
s_waitcnt lgkmcnt(3)
v_mfma_f32_16x16x32_bf16 v[138:141], a[20:23], v[186:189], v[138:141]
v_mfma_f32_16x16x32_bf16 v[142:145], a[40:43], v[182:185], v[142:145]
v_mfma_f32_16x16x32_bf16 v[142:145], a[44:47], v[186:189], v[142:145]
v_cvt_pk_bf16_f32 v78, v138, v139
v_cvt_pk_bf16_f32 v79, v140, v141
v_mfma_f32_16x16x32_bf16 v[146:149], a[64:67], v[182:185], v[146:149]
v_mfma_f32_16x16x32_bf16 v[146:149], a[68:71], v[186:189], v[146:149]
v_cvt_pk_bf16_f32 v80, v142, v143
v_cvt_pk_bf16_f32 v81, v144, v145
v_mfma_f32_16x16x32_bf16 v[150:153], a[232:235], v[182:185], v[150:153]
v_mfma_f32_16x16x32_bf16 v[150:153], a[236:239], v[186:189], v[150:153]
v_cvt_pk_bf16_f32 v82, v146, v147
v_cvt_pk_bf16_f32 v83, v148, v149
v_mfma_f32_16x16x32_bf16 v[154:157], v[224:227], v[182:185], v[154:157]
v_mfma_f32_16x16x32_bf16 v[154:157], v[228:231], v[186:189], v[154:157]
v_cvt_pk_bf16_f32 v72, v150, v151
v_cvt_pk_bf16_f32 v73, v152, v153
v_mfma_f32_16x16x32_bf16 v[158:161], v[248:251], v[182:185], v[158:161]
v_mfma_f32_16x16x32_bf16 v[158:161], v[252:255], v[186:189], v[158:161]
v_cvt_pk_bf16_f32 v74, v154, v155
v_cvt_pk_bf16_f32 v75, v156, v157
v_mfma_f32_16x16x32_bf16 v[162:165], v[182:185], a[88:91], v[162:165]
v_mfma_f32_16x16x32_bf16 v[162:165], v[186:189], a[92:95], v[162:165]
v_cvt_pk_bf16_f32 v76, v158, v159
v_cvt_pk_bf16_f32 v77, v160, v161
v_mfma_f32_16x16x32_bf16 v[166:169], v[182:185], a[112:115], v[166:169]
v_mfma_f32_16x16x32_bf16 v[166:169], v[186:189], a[116:119], v[166:169]
v_cvt_pk_bf16_f32 v114, v162, v163
v_cvt_pk_bf16_f32 v115, v164, v165
v_mfma_f32_16x16x32_bf16 v[170:173], v[182:185], a[136:139], v[170:173]
ds_read_b128 v[182:185], v210 offset:28672
buffer_store_dwordx2 v[124:125], v205, s[8:11], s38 offen offset:32
s_nop 0
v_cvt_pk_bf16_f32 v122, v166, v167
v_mfma_f32_16x16x32_bf16 v[170:173], v[186:189], a[140:143], v[170:173]
s_waitcnt lgkmcnt(2)
ds_read_b128 v[186:189], v210 offset:29696
v_cvt_pk_bf16_f32 v123, v168, v169
v_mfma_f32_16x16x32_bf16 v[138:141], a[0:3], v[110:113], 0
s_waitcnt lgkmcnt(2)
v_mfma_f32_16x16x32_bf16 v[138:141], a[4:7], v[220:223], v[138:141]
s_nop 0
v_cvt_pk_bf16_f32 v130, v170, v171
v_cvt_pk_bf16_f32 v131, v172, v173
v_mfma_f32_16x16x32_bf16 v[142:145], a[24:27], v[110:113], 0
v_mfma_f32_16x16x32_bf16 v[142:145], a[28:31], v[220:223], v[142:145]
v_mfma_f32_16x16x32_bf16 v[146:149], a[48:51], v[110:113], 0
v_mfma_f32_16x16x32_bf16 v[146:149], a[52:55], v[220:223], v[146:149]
v_mfma_f32_16x16x32_bf16 v[150:153], a[216:219], v[110:113], 0
v_mfma_f32_16x16x32_bf16 v[150:153], a[220:223], v[220:223], v[150:153]
v_mfma_f32_16x16x32_bf16 v[154:157], a[240:243], v[110:113], 0
v_mfma_f32_16x16x32_bf16 v[154:157], a[244:247], v[220:223], v[154:157]
v_mfma_f32_16x16x32_bf16 v[158:161], v[232:235], v[110:113], 0
v_mfma_f32_16x16x32_bf16 v[158:161], v[236:239], v[220:223], v[158:161]
v_mfma_f32_16x16x32_bf16 v[162:165], v[110:113], a[72:75], 0
v_mfma_f32_16x16x32_bf16 v[162:165], v[220:223], a[76:79], v[162:165]
buffer_store_dwordx2 v[132:133], v205, s[8:11], s38 offen offset:64
v_mfma_f32_16x16x32_bf16 v[166:169], v[110:113], a[96:99], 0
v_mfma_f32_16x16x32_bf16 v[166:169], v[220:223], a[100:103], v[166:169]
v_mfma_f32_16x16x32_bf16 v[170:173], v[110:113], a[120:123], 0
ds_read_b128 v[110:113], v210 offset:30720
v_mfma_f32_16x16x32_bf16 v[170:173], v[220:223], a[124:127], v[170:173]
s_waitcnt lgkmcnt(2)
v_mfma_f32_16x16x32_bf16 v[138:141], a[8:11], v[182:185], v[138:141]
s_waitcnt lgkmcnt(1)
v_mfma_f32_16x16x32_bf16 v[138:141], a[12:15], v[186:189], v[138:141]
v_mfma_f32_16x16x32_bf16 v[142:145], a[32:35], v[182:185], v[142:145]
v_mfma_f32_16x16x32_bf16 v[142:145], a[36:39], v[186:189], v[142:145]
v_mfma_f32_16x16x32_bf16 v[146:149], a[56:59], v[182:185], v[146:149]
v_mfma_f32_16x16x32_bf16 v[146:149], a[60:63], v[186:189], v[146:149]
v_mfma_f32_16x16x32_bf16 v[150:153], a[224:227], v[182:185], v[150:153]
v_mfma_f32_16x16x32_bf16 v[150:153], a[228:231], v[186:189], v[150:153]
v_mfma_f32_16x16x32_bf16 v[154:157], a[248:251], v[182:185], v[154:157]
v_mfma_f32_16x16x32_bf16 v[154:157], a[252:255], v[186:189], v[154:157]
v_mfma_f32_16x16x32_bf16 v[158:161], v[240:243], v[182:185], v[158:161]
v_mfma_f32_16x16x32_bf16 v[158:161], v[244:247], v[186:189], v[158:161]
buffer_store_dwordx2 v[0:1], v29, s[8:11], 0 offen
v_mfma_f32_16x16x32_bf16 v[162:165], v[182:185], a[80:83], v[162:165]
v_mfma_f32_16x16x32_bf16 v[162:165], v[186:189], a[84:87], v[162:165]
v_mfma_f32_16x16x32_bf16 v[166:169], v[182:185], a[104:107], v[166:169]
v_mfma_f32_16x16x32_bf16 v[166:169], v[186:189], a[108:111], v[166:169]
v_mfma_f32_16x16x32_bf16 v[170:173], v[182:185], a[128:131], v[170:173]
ds_read_b128 v[182:185], v210 offset:32768
v_mfma_f32_16x16x32_bf16 v[170:173], v[186:189], a[132:135], v[170:173]
s_nop 0
ds_read_b128 v[186:189], v210 offset:33792
s_waitcnt lgkmcnt(2)
v_mfma_f32_16x16x32_bf16 v[138:141], a[16:19], v[110:113], v[138:141]
v_mfma_f32_16x16x32_bf16 v[138:141], a[20:23], v[106:109], v[138:141]
v_mfma_f32_16x16x32_bf16 v[142:145], a[40:43], v[110:113], v[142:145]
v_mfma_f32_16x16x32_bf16 v[142:145], a[44:47], v[106:109], v[142:145]
v_cvt_pk_bf16_f32 v96, v138, v139
v_cvt_pk_bf16_f32 v97, v140, v141
v_mfma_f32_16x16x32_bf16 v[146:149], a[64:67], v[110:113], v[146:149]
v_mfma_f32_16x16x32_bf16 v[146:149], a[68:71], v[106:109], v[146:149]
v_cvt_pk_bf16_f32 v98, v142, v143
v_cvt_pk_bf16_f32 v99, v144, v145
v_mfma_f32_16x16x32_bf16 v[150:153], a[232:235], v[110:113], v[150:153]
v_mfma_f32_16x16x32_bf16 v[150:153], a[236:239], v[106:109], v[150:153]
v_cvt_pk_bf16_f32 v100, v146, v147
v_cvt_pk_bf16_f32 v101, v148, v149
v_mfma_f32_16x16x32_bf16 v[154:157], v[224:227], v[110:113], v[154:157]
v_mfma_f32_16x16x32_bf16 v[154:157], v[228:231], v[106:109], v[154:157]
v_cvt_pk_bf16_f32 v84, v150, v151
v_cvt_pk_bf16_f32 v85, v152, v153
v_mfma_f32_16x16x32_bf16 v[158:161], v[248:251], v[110:113], v[158:161]
buffer_store_dwordx2 v[4:5], v29, s[8:11], 0 offen offset:32
v_mfma_f32_16x16x32_bf16 v[158:161], v[252:255], v[106:109], v[158:161]
v_cvt_pk_bf16_f32 v86, v154, v155
v_cvt_pk_bf16_f32 v87, v156, v157
v_mfma_f32_16x16x32_bf16 v[162:165], v[110:113], a[88:91], v[162:165]
v_mfma_f32_16x16x32_bf16 v[162:165], v[106:109], a[92:95], v[162:165]
v_cvt_pk_bf16_f32 v88, v158, v159
v_cvt_pk_bf16_f32 v89, v160, v161
v_mfma_f32_16x16x32_bf16 v[166:169], v[110:113], a[112:115], v[166:169]
v_mfma_f32_16x16x32_bf16 v[166:169], v[106:109], a[116:119], v[166:169]
v_cvt_pk_bf16_f32 v116, v162, v163
v_cvt_pk_bf16_f32 v117, v164, v165
v_mfma_f32_16x16x32_bf16 v[170:173], v[110:113], a[136:139], v[170:173]
s_nop 0
ds_read_b64 v[112:113], v215 offset:528
v_mfma_f32_16x16x32_bf16 v[170:173], v[106:109], a[140:143], v[170:173]
s_waitcnt lgkmcnt(2)
ds_read_b128 v[108:111], v215 offset:512
v_cvt_pk_bf16_f32 v124, v166, v167
v_mfma_f32_16x16x32_bf16 v[138:141], a[0:3], v[182:185], 0
s_nop 0
v_cvt_pk_bf16_f32 v125, v168, v169
s_waitcnt lgkmcnt(2)
v_mfma_f32_16x16x32_bf16 v[138:141], a[4:7], v[186:189], v[138:141]
v_cvt_pk_bf16_f32 v132, v170, v171
v_cvt_pk_bf16_f32 v133, v172, v173
v_mfma_f32_16x16x32_bf16 v[142:145], a[24:27], v[182:185], 0
ds_read_b128 v[170:173], v210 offset:34816
v_mfma_f32_16x16x32_bf16 v[142:145], a[28:31], v[186:189], v[142:145]
v_mfma_f32_16x16x32_bf16 v[146:149], a[48:51], v[182:185], 0
ds_read_b128 v[182:185], v210 offset:35840
v_mfma_f32_16x16x32_bf16 v[146:149], a[52:55], v[186:189], v[146:149]
ds_read_b128 v[186:189], v210 offset:36864
s_waitcnt lgkmcnt(4)
v_mfma_f32_16x16x16_bf16 v[150:153], v[112:113], v[76:77], v[206:209]
buffer_store_dwordx2 v[8:9], v29, s[8:11], 0 offen offset:64
v_mfma_f32_16x16x16_bf16 v[154:157], v[82:83], v[88:89], 0
v_mfma_f32_16x16x16_bf16 v[158:161], v[100:101], v[88:89], 0
v_mfma_f32_16x16x16_bf16 v[166:169], v[112:113], v[88:89], v[206:209]
s_waitcnt lgkmcnt(2)
v_mfma_f32_16x16x32_bf16 v[138:141], a[8:11], v[170:173], v[138:141]
s_waitcnt lgkmcnt(1)
v_mfma_f32_16x16x32_bf16 v[138:141], a[12:15], v[182:185], v[138:141]
v_mfma_f32_16x16x32_bf16 v[142:145], a[32:35], v[170:173], v[142:145]
v_mfma_f32_16x16x32_bf16 v[142:145], a[36:39], v[182:185], v[142:145]
v_mfma_f32_16x16x32_bf16 v[150:153], v[108:111], v[72:75], v[150:153]
v_mfma_f32_16x16x32_bf16 v[146:149], a[56:59], v[170:173], v[146:149]
ds_read_b128 v[170:173], v210 offset:37888
v_mfma_f32_16x16x32_bf16 v[146:149], a[60:63], v[182:185], v[146:149]
s_waitcnt lgkmcnt(1)
ds_read_b128 v[182:185], v210 offset:32768
v_exp_f32 v150, v150
v_mfma_f32_16x16x32_bf16 v[138:141], a[16:19], v[186:189], v[138:141]
v_mfma_f32_16x16x32_bf16 v[142:145], a[40:43], v[186:189], v[142:145]
v_mfma_f32_16x16x32_bf16 v[154:157], v[78:81], v[84:87], v[154:157]
v_mfma_f32_16x16x32_bf16 v[146:149], a[64:67], v[186:189], v[146:149]
ds_read_b128 v[186:189], v210 offset:33792
s_waitcnt lgkmcnt(2)
v_mfma_f32_16x16x32_bf16 v[138:141], a[20:23], v[170:173], v[138:141]
s_waitcnt lgkmcnt(1)
v_exp_f32 v154, v154
v_mfma_f32_16x16x32_bf16 v[118:121], v[182:185], a[72:75], 0
v_exp_f32 v155, v155
v_mfma_f32_16x16x32_bf16 v[126:129], v[182:185], a[96:99], 0
v_cvt_pk_bf16_f32 v102, v138, v139
v_cvt_pk_bf16_f32 v103, v140, v141
v_mfma_f32_16x16x16_bf16 v[138:141], v[82:83], v[76:77], 0
v_exp_f32 v156, v156
v_exp_f32 v157, v157
v_mfma_f32_16x16x32_bf16 v[134:137], v[182:185], a[120:123], 0
v_mfma_f32_16x16x32_bf16 v[138:141], v[78:81], v[72:75], v[138:141]
s_waitcnt lgkmcnt(0)
v_mfma_f32_16x16x32_bf16 v[118:121], v[186:189], a[76:79], v[118:121]
v_mfma_f32_16x16x32_bf16 v[126:129], v[186:189], a[100:103], v[126:129]
v_exp_f32 v138, v138
v_mfma_f32_16x16x32_bf16 v[134:137], v[186:189], a[124:127], v[134:137]
v_exp_f32 v139, v139
v_mfma_f32_16x16x32_bf16 v[90:93], a[216:219], v[182:185], 0
v_exp_f32 v140, v140
v_mfma_f32_16x16x32_bf16 v[90:93], a[220:223], v[186:189], v[90:93]
v_exp_f32 v141, v141
v_mfma_f32_16x16x32_bf16 v[142:145], a[44:47], v[170:173], v[142:145]
v_mfma_f32_16x16x32_bf16 v[220:223], v[232:235], v[182:185], 0
v_mfma_f32_16x16x32_bf16 v[220:223], v[236:239], v[186:189], v[220:223]
v_cvt_pk_bf16_f32 v104, v142, v143
v_cvt_pk_bf16_f32 v105, v144, v145
v_mfma_f32_16x16x16_bf16 v[142:145], v[100:101], v[76:77], 0
v_mfma_f32_16x16x32_bf16 v[146:149], a[68:71], v[170:173], v[146:149]
v_mfma_f32_16x16x32_bf16 v[142:145], v[96:99], v[72:75], v[142:145]
v_mfma_f32_16x16x32_bf16 v[170:173], a[240:243], v[182:185], 0
v_cvt_pk_bf16_f32 v106, v146, v147
v_cvt_pk_bf16_f32 v107, v148, v149
v_mfma_f32_16x16x32_bf16 v[170:173], a[244:247], v[186:189], v[170:173]
v_exp_f32 v142, v142
v_mfma_f32_16x16x16_bf16 v[146:149], v[106:107], v[76:77], 0
v_exp_f32 v143, v143
v_exp_f32 v144, v144
v_mfma_f32_16x16x16_bf16 v[162:165], v[106:107], v[88:89], 0
v_exp_f32 v145, v145
v_mfma_f32_16x16x32_bf16 v[146:149], v[102:105], v[72:75], v[146:149]
ds_read_b128 v[182:185], v210 offset:36864
ds_read_b128 v[186:189], v210 offset:37888
v_mfma_f32_16x16x32_bf16 v[158:161], v[96:99], v[84:87], v[158:161]
ds_read_b128 v[72:75], v215
ds_read_b64 v[76:77], v215 offset:16
v_mfma_f32_16x16x32_bf16 v[118:121], v[174:177], a[80:83], v[118:121]
v_exp_f32 v146, v146
v_mfma_f32_16x16x32_bf16 v[118:121], v[178:181], a[84:87], v[118:121]
v_exp_f32 v158, v158
v_mfma_f32_16x16x32_bf16 v[126:129], v[174:177], a[104:107], v[126:129]
v_exp_f32 v159, v159
v_mfma_f32_16x16x32_bf16 v[126:129], v[178:181], a[108:111], v[126:129]
v_exp_f32 v160, v160
v_mfma_f32_16x16x32_bf16 v[134:137], v[174:177], a[128:131], v[134:137]
v_exp_f32 v161, v161
v_mfma_f32_16x16x32_bf16 v[134:137], v[178:181], a[132:135], v[134:137]
v_exp_f32 v147, v147
v_mfma_f32_16x16x32_bf16 v[166:169], v[108:111], v[84:87], v[166:169]
v_exp_f32 v148, v148
v_mfma_f32_16x16x32_bf16 v[90:93], a[224:227], v[174:177], v[90:93]
v_exp_f32 v149, v149
v_mfma_f32_16x16x32_bf16 v[90:93], a[228:231], v[178:181], v[90:93]
v_exp_f32_e64 v166, v166
v_mfma_f32_16x16x32_bf16 v[170:173], a[248:251], v[174:177], v[170:173]
v_mfma_f32_16x16x32_bf16 v[170:173], a[252:255], v[178:181], v[170:173]
v_mfma_f32_16x16x32_bf16 v[220:223], v[240:243], v[174:177], v[220:223]
v_cvt_pk_bf16_f32 v174, v138, v139
v_cvt_pk_bf16_f32 v175, v140, v141
v_mfma_f32_16x16x32_bf16 v[220:223], v[244:247], v[178:181], v[220:223]
s_nop 0
v_cvt_pk_bf16_f32 v176, v142, v143
v_cvt_pk_bf16_f32 v177, v144, v145
v_mfma_f32_16x16x32_bf16 v[162:165], v[102:105], v[84:87], v[162:165]
s_waitcnt lgkmcnt(3)
v_cvt_pk_bf16_f32 v180, v150, 0
v_cvt_pk_bf16_f32 v178, v146, v147
v_mfma_f32_16x16x32_bf16 v[118:121], v[182:185], a[88:91], v[118:121]
s_waitcnt lgkmcnt(2)
v_cvt_pk_bf16_f32 v179, v148, v149
v_mov_b32 v181, 0
v_mfma_f32_16x16x32_bf16 v[118:121], v[186:189], a[92:95], v[118:121]
v_exp_f32 v162, v162
v_mfma_f32_16x16x32_bf16 v[126:129], v[182:185], a[112:115], v[126:129]
v_exp_f32 v163, v163
v_mfma_f32_16x16x32_bf16 v[126:129], v[186:189], a[116:119], v[126:129]
v_exp_f32 v164, v164
v_mfma_f32_16x16x32_bf16 v[134:137], v[182:185], a[136:139], v[134:137]
v_exp_f32 v165, v165
v_mfma_f32_16x16x32_bf16 v[134:137], v[186:189], a[140:143], v[134:137]
v_cvt_pk_bf16_f32 v118, v118, v119
v_cvt_pk_bf16_f32 v119, v120, v121
v_mfma_f32_16x16x32_bf16 v[90:93], a[232:235], v[182:185], v[90:93]
ds_read_u16 v120, v214 offset:1024
v_mov_b32_e64 v121, 0
v_mfma_f32_16x16x32_bf16 v[90:93], a[236:239], v[186:189], v[90:93]
v_cvt_pk_bf16_f32 v126, v126, v127
v_cvt_pk_bf16_f32 v127, v128, v129
v_mfma_f32_16x16x32_bf16 v[170:173], v[224:227], v[182:185], v[170:173]
ds_read_u16 v128, v214 offset:1032
v_cvt_pk_bf16_f32 v134, v134, v135
v_mfma_f32_16x16x32_bf16 v[170:173], v[228:231], v[186:189], v[170:173]
v_cvt_pk_bf16_f32 v135, v136, v137
v_mov_b32_e64 v129, 0
v_mfma_f32_16x16x32_bf16 v[220:223], v[248:251], v[182:185], v[220:223]
ds_read_u16 v136, v214 offset:1040
v_mov_b32_e64 v137, 0
v_mfma_f32_16x16x32_bf16 v[220:223], v[252:255], v[186:189], v[220:223]
v_cvt_pk_bf16_f32 v90, v90, v91
v_cvt_pk_bf16_f32 v91, v92, v93
v_mfma_f32_16x16x32_bf16 v[150:153], v[190:193], v[174:177], 0
v_cvt_pk_bf16_f32 v92, v170, v171
v_cvt_pk_bf16_f32 v93, v172, v173
v_mfma_f32_16x16x32_bf16 v[150:153], v[190:193], v[178:181], v[150:153]
v_cvt_pk_bf16_f32 v94, v220, v221
v_cvt_pk_bf16_f32 v95, v222, v223
v_mfma_f32_16x16x32_bf16 v[138:141], v[114:117], v[174:177], 0
s_waitcnt lgkmcnt(2)
v_mfma_f32_16x16x32_bf16 v[138:141], v[118:121], v[178:181], v[138:141]
v_rcp_f32_e64 v151, v150
v_mfma_f32_16x16x32_bf16 v[142:145], v[122:125], v[174:177], 0
s_waitcnt lgkmcnt(1)
v_max3_u32 v218, v218, v150, v151
v_mul_f32_e64 v151, s3, v151
v_mfma_f32_16x16x32_bf16 v[142:145], v[126:129], v[178:181], v[142:145]
v_mul_f32_e64 v138, v138, v151
v_mul_f32 v139, v139, v151
v_mfma_f32_16x16x32_bf16 v[146:149], v[130:133], v[174:177], 0
s_waitcnt lgkmcnt(0)
v_cvt_pk_bf16_f32 v174, v154, v155
v_cvt_pk_bf16_f32 v175, v156, v157
v_mfma_f32_16x16x32_bf16 v[146:149], v[134:137], v[178:181], v[146:149]
v_cvt_pk_bf16_f32 v176, v158, v159
v_cvt_pk_bf16_f32 v177, v160, v161
v_cvt_pk_bf16_f32 v180, v166, 0
v_cvt_pk_bf16_f32 v178, v162, v163
v_mfma_f32_16x16x32_bf16 v[166:169], v[190:193], v[174:177], 0
v_cvt_pk_bf16_f32 v179, v164, v165
v_mul_f32 v140, v140, v151
v_mul_f32 v141, v141, v151
v_mfma_f32_16x16x32_bf16 v[166:169], v[190:193], v[178:181], v[166:169]
v_cvt_pk_bf16_f32 v138, v138, v139
v_mul_f32_e64 v142, v142, v151
v_mfma_f32_16x16x32_bf16 v[154:157], v[114:117], v[174:177], 0
v_mul_f32 v143, v143, v151
v_mul_f32 v144, v144, v151
v_mfma_f32_16x16x32_bf16 v[154:157], v[118:121], v[178:181], v[154:157]
v_mul_f32_e64 v145, v145, v151
v_cvt_pk_bf16_f32 v139, v140, v141
v_mfma_f32_16x16x32_bf16 v[158:161], v[122:125], v[174:177], 0
v_cvt_pk_bf16_f32 v140, v142, v143
v_cvt_pk_bf16_f32 v141, v144, v145
v_mfma_f32_16x16x32_bf16 v[158:161], v[126:129], v[178:181], v[158:161]
ds_write_b128 v211, v[138:141] offset:38912
v_mfma_f32_16x16x32_bf16 v[162:165], v[130:133], v[174:177], 0
v_mul_f32 v146, v146, v151
v_mul_f32 v147, v147, v151
v_mfma_f32_16x16x32_bf16 v[162:165], v[134:137], v[178:181], v[162:165]
v_mul_f32 v148, v148, v151
v_mul_f32 v149, v149, v151
v_cvt_pk_bf16_f32 v142, v146, v147
v_mfma_f32_16x16x16_bf16 v[138:141], v[82:83], v[94:95], 0
v_cvt_pk_bf16_f32 v143, v148, v149
v_rcp_f32_e64 v167, v166
v_mfma_f32_16x16x16_bf16 v[150:153], v[112:113], v[94:95], v[206:209]
v_max3_u32 v218, v218, v166, v167
v_mul_f32 v167, s3, v167
v_mul_f32 v154, v154, v167
v_mfma_f32_16x16x16_bf16 v[146:149], v[106:107], v[94:95], 0
v_mul_f32 v155, v155, v167
v_mul_f32 v156, v156, v167
v_mul_f32_e64 v157, v157, v167
v_cvt_pk_bf16_f32 v154, v154, v155
v_mfma_f32_16x16x32_bf16 v[138:141], v[78:81], v[90:93], v[138:141]
ds_write_b64 v212, v[142:143] offset:38912
v_mfma_f32_16x16x16_bf16 v[142:145], v[100:101], v[94:95], 0
v_mul_f32 v158, v158, v167
v_mul_f32 v159, v159, v167
v_mul_f32 v160, v160, v167
v_mul_f32 v161, v161, v167
v_mfma_f32_16x16x32_bf16 v[150:153], v[108:111], v[90:93], v[150:153]
v_cvt_pk_bf16_f32 v155, v156, v157
v_cvt_pk_bf16_f32 v156, v158, v159
v_mfma_f32_16x16x32_bf16 v[142:145], v[96:99], v[90:93], v[142:145]
v_cvt_pk_bf16_f32 v157, v160, v161
v_mul_f32_e64 v162, v162, v167
v_mfma_f32_16x16x32_bf16 v[146:149], v[102:105], v[90:93], v[146:149]
ds_write_b128 v211, v[154:157] offset:45056
v_mfma_f32_16x16x16_bf16 v[154:157], v[76:77], v[82:83], 0
v_mul_f32 v163, v163, v167
v_mul_f32 v164, v164, v167
v_mul_f32_e64 v165, v165, v167
v_mfma_f32_16x16x16_bf16 v[166:169], v[76:77], v[112:113], v[206:209]
v_cvt_pk_bf16_f32 v158, v162, v163
v_cvt_pk_bf16_f32 v159, v164, v165
v_exp_f32 v138, v138
v_mfma_f32_16x16x16_bf16 v[162:165], v[76:77], v[106:107], 0
v_exp_f32 v139, v139
v_exp_f32 v140, v140
v_mfma_f32_16x16x32_bf16 v[154:157], v[72:75], v[78:81], v[154:157]
ds_write_b64 v212, v[158:159] offset:45056
v_mfma_f32_16x16x16_bf16 v[158:161], v[76:77], v[100:101], 0
v_exp_f32 v141, v141
v_exp_f32 v142, v142
v_mfma_f32_16x16x32_bf16 v[162:165], v[72:75], v[102:105], v[162:165]
v_exp_f32 v143, v143
v_mfma_f32_16x16x32_bf16 v[158:161], v[72:75], v[96:99], v[158:161]
v_exp_f32 v144, v144
v_mfma_f32_16x16x32_bf16 v[166:169], v[72:75], v[108:111], v[166:169]
v_exp_f32 v145, v145
v_exp_f32 v150, v150
v_exp_f32 v146, v146
v_exp_f32 v147, v147
v_exp_f32 v148, v148
v_exp_f32_e64 v149, v149
v_cvt_pk_bf16_f32 v174, v138, v139
v_cvt_pk_bf16_f32 v175, v140, v141
v_cvt_pk_bf16_f32 v176, v142, v143
v_cvt_pk_bf16_f32 v177, v144, v145
v_cvt_pk_bf16_f32 v180, v150, 0
v_cvt_pk_bf16_f32 v178, v146, v147
v_mfma_f32_16x16x32_bf16 v[150:153], v[190:193], v[174:177], 0
s_waitcnt lgkmcnt(0)
v_cvt_pk_bf16_f32 v179, v148, v149
v_mov_b32_dpp v154, v158 quad_perm:[0,1,2,3] row_mask:0x2 bank_mask:0xf
v_mfma_f32_16x16x32_bf16 v[138:141], v[114:117], v[174:177], 0
s_barrier
v_mfma_f32_16x16x32_bf16 v[138:141], v[118:121], v[178:181], v[138:141]
ds_read_b128 v[220:223], v210 offset:38912
ds_read_b128 v[110:113], v210 offset:39936
v_mfma_f32_16x16x32_bf16 v[150:153], v[190:193], v[178:181], v[150:153]
ds_read_b128 v[170:173], v210 offset:40960
ds_read_b128 v[182:185], v210 offset:41984
v_mfma_f32_16x16x32_bf16 v[142:145], v[122:125], v[174:177], 0
v_mov_b32_dpp v154, v162 quad_perm:[0,1,2,3] row_mask:0x4 bank_mask:0xf
v_mfma_f32_16x16x32_bf16 v[142:145], v[126:129], v[178:181], v[142:145]
v_mov_b32_dpp v154, v167 quad_perm:[0,1,2,3] row_mask:0x8 bank_mask:0xf
v_exp_f32 v154, v154
v_mfma_f32_16x16x32_bf16 v[146:149], v[130:133], v[174:177], 0
v_cvt_pk_bf16_f32 v154, v154, 0
v_rcp_f32 v151, v150
v_mfma_f32_16x16x32_bf16 v[146:149], v[134:137], v[178:181], v[146:149]
s_waitcnt lgkmcnt(3)
ds_write_b16 v214, v154
v_mfma_f32_16x16x32_bf16 v[36:39], a[144:147], v[220:223], v[36:39]
s_waitcnt lgkmcnt(3)
ds_read_b128 v[84:87], v215
ds_read_b128 v[88:91], v215 offset:16
v_mfma_f32_16x16x32_bf16 v[36:39], a[148:151], v[110:113], v[36:39]
ds_read_b128 v[186:189], v210 offset:43008
v_add_u32 v215, 1552, v215
v_mfma_f32_16x16x32_bf16 v[40:43], a[168:171], v[220:223], v[40:43]
v_mfma_f32_16x16x32_bf16 v[40:43], a[172:175], v[110:113], v[40:43]
v_mfma_f32_16x16x32_bf16 v[44:47], a[192:195], v[220:223], v[44:47]
ds_read_b128 v[220:223], v210 offset:44032
v_mfma_f32_16x16x32_bf16 v[44:47], a[196:199], v[110:113], v[44:47]
s_nop 0
ds_read_b128 v[110:113], v210 offset:45056
s_waitcnt lgkmcnt(4)
v_mfma_f32_16x16x32_bf16 v[166:169], v[84:87], v[190:193], 0
s_waitcnt lgkmcnt(3)
v_mfma_f32_16x16x32_bf16 v[166:169], v[88:91], v[190:193], v[166:169]
v_mfma_f32_16x16x32_bf16 v[154:157], v[84:87], v[114:117], 0
v_mfma_f32_16x16x32_bf16 v[154:157], v[88:91], v[118:121], v[154:157]
v_rcp_f32 v167, v166
v_mfma_f32_16x16x32_bf16 v[158:161], v[84:87], v[122:125], 0
v_max3_u32 v218, v218, v166, v167
v_max3_u32 v218, v218, v150, v151
v_mfma_f32_16x16x32_bf16 v[158:161], v[88:91], v[126:129], v[158:161]
v_mul_f32 v151, s3, v151
v_mul_f32 v138, v138, v151
v_mfma_f32_16x16x32_bf16 v[162:165], v[84:87], v[130:133], 0
v_mul_f32 v139, v139, v151
v_mul_f32 v140, v140, v151
v_mfma_f32_16x16x32_bf16 v[162:165], v[88:91], v[134:137], v[162:165]
v_mul_f32_e64 v141, v141, v151
v_cvt_pk_bf16_f32 v138, v138, v139
v_mfma_f32_16x16x32_bf16 v[36:39], a[152:155], v[170:173], v[36:39]
v_mul_f32 v142, v142, v151
v_mul_f32 v143, v143, v151
v_mfma_f32_16x16x32_bf16 v[36:39], a[156:159], v[182:185], v[36:39]
s_waitcnt lgkmcnt(2)
v_mul_f32 v144, v144, v151
v_mul_f32_e64 v145, v145, v151
v_mfma_f32_16x16x32_bf16 v[36:39], a[160:163], v[186:189], v[36:39]
v_cvt_pk_bf16_f32 v139, v140, v141
v_cvt_pk_bf16_f32 v140, v142, v143
v_mfma_f32_16x16x32_bf16 v[40:43], a[176:179], v[170:173], v[40:43]
v_cvt_pk_bf16_f32 v141, v144, v145
v_mov_b32_dpp v154, v158 quad_perm:[0,1,2,3] row_mask:0x2 bank_mask:0xf
v_mfma_f32_16x16x32_bf16 v[40:43], a[180:183], v[182:185], v[40:43]
ds_write_b128 v211, v[138:141] offset:51200
v_mfma_f32_16x16x32_bf16 v[40:43], a[184:187], v[186:189], v[40:43]
v_cmp_lt_u32 vcc, 1602224128, v218
v_mul_f32_e64 v146, v146, v151
v_mfma_f32_16x16x32_bf16 v[44:47], a[200:203], v[170:173], v[44:47]
s_or_b32 s41, vcc_lo, vcc_hi
v_mul_f32 v147, v147, v151
v_mul_f32_e64 v148, v148, v151
v_mfma_f32_16x16x32_bf16 v[44:47], a[204:207], v[182:185], v[44:47]
ds_read_b128 v[170:173], v210 offset:46080
ds_read_b128 v[182:185], v210 offset:47104
v_mfma_f32_16x16x32_bf16 v[44:47], a[208:211], v[186:189], v[44:47]
s_waitcnt lgkmcnt(4)
ds_read_b128 v[186:189], v210 offset:48128
v_mul_f32 v149, v149, v151
v_mfma_f32_16x16x32_bf16 v[44:47], a[212:215], v[220:223], v[44:47]
v_mul_f32_e64 v167, s3, v167
v_mov_b32_dpp v154, v162 quad_perm:[0,1,2,3] row_mask:0x4 bank_mask:0xf
v_mfma_f32_16x16x32_bf16 v[36:39], a[164:167], v[220:223], v[36:39]
s_nop 0
v_cvt_pk_bf16_f32 v142, v146, v147
v_cvt_pk_bf16_f32 v143, v148, v149
v_mfma_f32_16x16x32_bf16 v[40:43], a[188:191], v[220:223], v[40:43]
s_waitcnt lgkmcnt(4)
v_cvt_pk_bf16_f32 v76, v44, v45
v_cvt_pk_bf16_f32 v77, v46, v47
v_mfma_f32_16x16x32_bf16 v[48:51], a[144:147], v[110:113], v[48:51]
v_cvt_pk_bf16_f32 v72, v36, v37
v_cvt_pk_bf16_f32 v73, v38, v39
v_mfma_f32_16x16x32_bf16 v[52:55], a[168:171], v[110:113], v[52:55]
s_waitcnt lgkmcnt(2)
buffer_store_dwordx2 v[72:73], v203, s[8:11], s39 offen
v_cvt_pk_bf16_f32 v74, v40, v41
v_mfma_f32_16x16x32_bf16 v[52:55], a[172:175], v[170:173], v[52:55]
s_waitcnt lgkmcnt(1)
v_cvt_pk_bf16_f32 v75, v42, v43
v_mul_f32_e64 v154, v154, v167
v_mfma_f32_16x16x32_bf16 v[52:55], a[176:179], v[182:185], v[52:55]
ds_write_b64 v212, v[142:143] offset:51200
v_mfma_f32_16x16x32_bf16 v[48:51], a[148:151], v[170:173], v[48:51]
v_mov_b32 v33, s41
v_cvt_pk_bf16_f32 v154, v154, 0
v_mfma_f32_16x16x32_bf16 v[48:51], a[152:155], v[182:185], v[48:51]
s_waitcnt lgkmcnt(1)
ds_read_b128 v[220:223], v210 offset:49152
ds_write_b32 v209, v33
v_mfma_f32_16x16x32_bf16 v[48:51], a[156:159], v[186:189], v[48:51]
ds_write_b16 v214, v154
v_mfma_f32_16x16x32_bf16 v[56:59], a[192:195], v[110:113], v[56:59]
ds_read_b128 v[110:113], v210 offset:50176
v_add_u32 v214, 1552, v214
v_mfma_f32_16x16x32_bf16 v[56:59], a[196:199], v[170:173], v[56:59]
v_mfma_f32_16x16x32_bf16 v[56:59], a[200:203], v[182:185], v[56:59]
v_mfma_f32_16x16x32_bf16 v[56:59], a[204:207], v[186:189], v[56:59]
s_waitcnt lgkmcnt(3)
v_mfma_f32_16x16x32_bf16 v[56:59], a[208:211], v[220:223], v[56:59]
v_mfma_f32_16x16x32_bf16 v[52:55], a[180:183], v[186:189], v[52:55]
s_waitcnt lgkmcnt(1)
s_barrier
v_mfma_f32_16x16x32_bf16 v[52:55], a[184:187], v[220:223], v[52:55]
s_waitcnt lgkmcnt(0)
buffer_store_dwordx2 v[74:75], v203, s[8:11], s39 offen offset:32
ds_read_b128 v[170:173], v210 offset:51200
v_mfma_f32_16x16x32_bf16 v[52:55], a[188:191], v[110:113], v[52:55]
ds_read_b128 v[182:185], v210 offset:52224
ds_read_b128 v[84:87], v27 offset:24832
v_mfma_f32_16x16x32_bf16 v[48:51], a[160:163], v[220:223], v[48:51]
ds_read_b128 v[88:91], v27 offset:24960
ds_read_b128 v[92:95], v27 offset:25088
v_mfma_f32_16x16x32_bf16 v[48:51], a[164:167], v[110:113], v[48:51]
ds_read_b128 v[96:99], v27 offset:25216
ds_read_b64 v[100:101], v27 offset:24848
v_mfma_f32_16x16x32_bf16 v[56:59], a[212:215], v[110:113], v[56:59]
ds_read_b64 v[102:103], v27 offset:24976
ds_read_b64 v[104:105], v27 offset:25104
v_cvt_pk_bf16_f32 v80, v52, v53
v_cvt_pk_bf16_f32 v78, v48, v49
v_cvt_pk_bf16_f32 v79, v50, v51
v_cvt_pk_bf16_f32 v81, v54, v55
s_waitcnt lgkmcnt(8)
v_mfma_f32_16x16x32_bf16 v[60:63], a[144:147], v[170:173], v[60:63]
ds_read_b64 v[106:107], v27 offset:25232
ds_read_b128 v[186:189], v210 offset:53248
v_mfma_f32_16x16x32_bf16 v[64:67], a[168:171], v[170:173], v[64:67]
s_waitcnt lgkmcnt(9)
ds_read_b128 v[220:223], v210 offset:54272
ds_read_b128 v[110:113], v210 offset:55296
v_mfma_f32_16x16x32_bf16 v[64:67], a[172:175], v[182:185], v[64:67]
v_cvt_pk_bf16_f32 v82, v56, v57
v_cvt_pk_bf16_f32 v83, v58, v59
v_mfma_f32_16x16x32_bf16 v[60:63], a[148:151], v[182:185], v[60:63]
s_nop 0
ds_read_b128 v[174:177], v210 offset:18432
s_waitcnt lgkmcnt(11)
v_mfma_f32_16x16x32_bf16 v[12:15], a[144:147], v[84:87], v[12:15]
s_waitcnt lgkmcnt(10)
v_mfma_f32_16x16x32_bf16 v[12:15], a[148:151], v[88:91], v[12:15]
s_waitcnt lgkmcnt(9)
v_mfma_f32_16x16x32_bf16 v[12:15], a[152:155], v[92:95], v[12:15]
s_waitcnt lgkmcnt(8)
v_mfma_f32_16x16x32_bf16 v[12:15], a[156:159], v[96:99], v[12:15]
s_waitcnt lgkmcnt(6)
v_mfma_f32_16x16x32_bf16 v[12:15], a[160:163], v[100:103], v[12:15]
buffer_store_dwordx2 v[76:77], v203, s[8:11], s39 offen offset:64
s_waitcnt lgkmcnt(4)
v_mfma_f32_16x16x32_bf16 v[12:15], a[164:167], v[104:107], v[12:15]
v_mfma_f32_16x16x32_bf16 v[68:71], a[192:195], v[170:173], v[68:71]
s_waitcnt lgkmcnt(0)
ds_read_b128 v[170:173], v210 offset:56320
v_or3_b32 v174, v174, v175, v176
v_mfma_f32_16x16x32_bf16 v[68:71], a[196:199], v[182:185], v[68:71]
v_cvt_pk_bf16_f32 v12, v12, v13
v_or_b32 v174, v174, v177
v_mfma_f32_16x16x32_bf16 v[60:63], a[152:155], v[186:189], v[60:63]
v_cvt_pk_bf16_f32 v13, v14, v15
v_readfirstlane_b32 s43, v174
v_mfma_f32_16x16x32_bf16 v[60:63], a[156:159], v[220:223], v[60:63]
v_mfma_f32_16x16x32_bf16 v[16:19], a[168:171], v[84:87], v[16:19]
v_mfma_f32_16x16x32_bf16 v[16:19], a[172:175], v[88:91], v[16:19]
v_mfma_f32_16x16x32_bf16 v[16:19], a[176:179], v[92:95], v[16:19]
v_mfma_f32_16x16x32_bf16 v[16:19], a[180:183], v[96:99], v[16:19]
v_mfma_f32_16x16x32_bf16 v[16:19], a[184:187], v[100:103], v[16:19]
v_mfma_f32_16x16x32_bf16 v[16:19], a[188:191], v[104:107], v[16:19]
v_mfma_f32_16x16x32_bf16 v[64:67], a[176:179], v[186:189], v[64:67]
v_mfma_f32_16x16x32_bf16 v[64:67], a[180:183], v[220:223], v[64:67]
v_cvt_pk_bf16_f32 v16, v16, v17
v_cvt_pk_bf16_f32 v17, v18, v19
v_mfma_f32_16x16x32_bf16 v[68:71], a[200:203], v[186:189], v[68:71]
v_mfma_f32_16x16x32_bf16 v[68:71], a[204:207], v[220:223], v[68:71]
v_mfma_f32_16x16x32_bf16 v[20:23], a[192:195], v[84:87], v[20:23]
buffer_store_dwordx2 v[78:79], v204, s[8:11], s39 offen
v_mfma_f32_16x16x32_bf16 v[20:23], a[196:199], v[88:91], v[20:23]
v_mfma_f32_16x16x32_bf16 v[20:23], a[200:203], v[92:95], v[20:23]
v_mfma_f32_16x16x32_bf16 v[20:23], a[204:207], v[96:99], v[20:23]
v_mfma_f32_16x16x32_bf16 v[20:23], a[208:211], v[100:103], v[20:23]
s_nop 0
v_mfma_f32_16x16x32_bf16 v[60:63], a[160:163], v[110:113], v[60:63]
s_waitcnt lgkmcnt(0)
v_mfma_f32_16x16x32_bf16 v[60:63], a[164:167], v[170:173], v[60:63]
v_mfma_f32_16x16x32_bf16 v[64:67], a[184:187], v[110:113], v[64:67]
v_mfma_f32_16x16x32_bf16 v[64:67], a[188:191], v[170:173], v[64:67]
v_cvt_pk_bf16_f32 v116, v60, v61
v_cvt_pk_bf16_f32 v117, v62, v63
v_mfma_f32_16x16x32_bf16 v[20:23], a[212:215], v[104:107], v[20:23]
v_mfma_f32_16x16x32_bf16 v[68:71], a[208:211], v[110:113], v[68:71]
v_cvt_pk_bf16_f32 v124, v64, v65
v_cvt_pk_bf16_f32 v125, v66, v67
v_mfma_f32_16x16x32_bf16 v[68:71], a[212:215], v[170:173], v[68:71]
s_nop 0
v_cvt_pk_bf16_f32 v20, v20, v21
v_cvt_pk_bf16_f32 v21, v22, v23
s_nop 4
v_cvt_pk_bf16_f32 v132, v68, v69
v_cvt_pk_bf16_f32 v133, v70, v71
buffer_store_dwordx2 v[80:81], v204, s[8:11], s39 offen offset:32
buffer_store_dwordx2 v[82:83], v204, s[8:11], s39 offen offset:64
buffer_store_dwordx2 v[116:117], v205, s[8:11], s39 offen
buffer_store_dwordx2 v[124:125], v205, s[8:11], s39 offen offset:32
buffer_store_dwordx2 v[12:13], v30, s[8:11], 0 offen
buffer_store_dwordx2 v[16:17], v30, s[8:11], 0 offen offset:32
buffer_store_dwordx2 v[20:21], v30, s[8:11], 0 offen offset:64
buffer_store_dwordx2 v[132:133], v205, s[8:11], s39 offen offset:64
s_branch L_fin
F_pf:
v_subrev_u32 v121, 37120, v211
s_mov_b32 s96, m0
s_mov_b32 m0, 3600
v_lshlrev_b32 v121, 3, v121
global_load_lds_dword v121, s[98:99]
s_mov_b32 m0, s96
s_nop 0
s_branch F_nopf
L_redo:
s_mov_b32 s47, 1
s_waitcnt vmcnt(0) lgkmcnt(0)
s_barrier
s_branch L_start
L_safe:
.p2align 3
s_add_u32 s28, s28, 32
s_cmp_ge_u32 s28, 73
s_cselect_b32 s21, 73, 0
s_cselect_b32 s22, 1177344, 0
s_sub_u32 s28, s28, s21
s_add_u32 s20, s20, s22
s_add_u32 s20, s20, 86016
s_add_u32 m0, s96, 71488
s_mov_b32 exec_hi, 4194303
buffer_load_dwordx4 v82, s[4:7], s20 offen nt lds
s_mov_b32 exec_hi, -1
s_add_u32 s28, s28, 32
s_cmp_ge_u32 s28, 73
s_cselect_b32 s21, 73, 0
s_cselect_b32 s22, 1177344, 0
s_sub_u32 s28, s28, s21
s_add_u32 s20, s20, s22
s_add_u32 s20, s20, 86016
s_add_u32 m0, s96, 74960
s_mov_b32 exec_hi, 4194303
buffer_load_dwordx4 v82, s[4:7], s20 offen nt lds
s_mov_b32 exec_hi, -1
s_add_u32 s28, s28, 32
s_cmp_ge_u32 s28, 73
s_cselect_b32 s21, 73, 0
s_cselect_b32 s22, 1177344, 0
s_sub_u32 s28, s28, s21
s_add_u32 s20, s20, s22
s_add_u32 s20, s20, 86016
s_add_u32 m0, s96, 78432
s_mov_b32 exec_hi, 4194303
buffer_load_dwordx4 v82, s[4:7], s20 offen nt lds
s_mov_b32 exec_hi, -1
s_add_u32 s28, s28, 32
s_cmp_ge_u32 s28, 73
s_cselect_b32 s21, 73, 0
s_cselect_b32 s22, 1177344, 0
s_sub_u32 s28, s28, s21
s_add_u32 s20, s20, s22
s_add_u32 s20, s20, 86016
s_add_u32 m0, s96, 81904
s_mov_b32 exec_hi, 4194303
buffer_load_dwordx4 v82, s[4:7], s20 offen nt lds
s_mov_b32 exec_hi, -1
s_add_u32 s28, s28, 32
s_cmp_ge_u32 s28, 73
s_cselect_b32 s21, 73, 0
s_cselect_b32 s22, 1177344, 0
s_sub_u32 s28, s28, s21
s_add_u32 s20, s20, s22
s_add_u32 s20, s20, 86016
s_add_u32 m0, s96, 85376
s_mov_b32 exec_hi, 4194303
buffer_load_dwordx4 v82, s[4:7], s20 offen nt lds
s_mov_b32 exec_hi, -1
s_add_u32 s28, s28, 32
s_cmp_ge_u32 s28, 73
s_cselect_b32 s21, 73, 0
s_cselect_b32 s22, 1177344, 0
s_sub_u32 s28, s28, s21
s_add_u32 s20, s20, s22
s_add_u32 s20, s20, 86016
s_add_u32 m0, s96, 88848
s_mov_b32 exec_hi, 4194303
buffer_load_dwordx4 v82, s[4:7], s20 offen nt lds
s_mov_b32 exec_hi, -1
s_add_u32 s28, s28, 32
s_cmp_ge_u32 s28, 73
s_cselect_b32 s21, 73, 0
s_cselect_b32 s22, 1177344, 0
s_sub_u32 s28, s28, s21
s_add_u32 s20, s20, s22
s_add_u32 s20, s20, 86016
s_add_u32 m0, s96, 92320
s_mov_b32 exec_hi, 4194303
buffer_load_dwordx4 v82, s[4:7], s20 offen nt lds
s_mov_b32 exec_hi, -1
s_add_u32 s28, s28, 32
s_cmp_ge_u32 s28, 73
s_cselect_b32 s21, 73, 0
s_cselect_b32 s22, 1177344, 0
s_sub_u32 s28, s28, s21
s_add_u32 s20, s20, s22
s_add_u32 s20, s20, 86016
s_add_u32 m0, s96, 95792
s_mov_b32 exec_hi, 4194303
buffer_load_dwordx4 v82, s[4:7], s20 offen nt lds
s_mov_b32 exec_hi, -1
s_add_u32 s28, s28, 32
s_cmp_ge_u32 s28, 73
s_cselect_b32 s21, 73, 0
s_cselect_b32 s22, 1177344, 0
s_sub_u32 s28, s28, s21
s_add_u32 s20, s20, s22
s_add_u32 s20, s20, 86016
s_add_u32 m0, s96, 99264
s_mov_b32 exec_hi, 4194303
buffer_load_dwordx4 v82, s[4:7], s20 offen nt lds
s_mov_b32 exec_hi, -1
s_add_u32 s28, s28, 32
s_cmp_ge_u32 s28, 73
s_cselect_b32 s21, 73, 0
s_cselect_b32 s22, 1177344, 0
s_sub_u32 s28, s28, s21
s_add_u32 s20, s20, s22
s_add_u32 s20, s20, 86016
s_add_u32 m0, s96, 102736
s_mov_b32 exec_hi, 4194303
buffer_load_dwordx4 v82, s[4:7], s20 offen nt lds
s_mov_b32 exec_hi, -1
s_add_u32 s28, s28, 32
s_cmp_ge_u32 s28, 73
s_cselect_b32 s21, 73, 0
s_cselect_b32 s22, 1177344, 0
s_sub_u32 s28, s28, s21
s_add_u32 s20, s20, s22
s_add_u32 s20, s20, 86016
s_add_u32 m0, s96, 106208
s_mov_b32 exec_hi, 4194303
buffer_load_dwordx4 v82, s[4:7], s20 offen nt lds
s_mov_b32 exec_hi, -1
s_add_u32 s28, s28, 32
s_cmp_ge_u32 s28, 73
s_cselect_b32 s21, 73, 0
s_cselect_b32 s22, 1177344, 0
s_sub_u32 s28, s28, s21
s_add_u32 s20, s20, s22
s_add_u32 s20, s20, 86016
s_add_u32 m0, s96, 109680
s_mov_b32 exec_hi, 4194303
buffer_load_dwordx4 v82, s[4:7], s20 offen nt lds
s_mov_b32 exec_hi, -1
s_add_u32 s28, s28, 32
s_cmp_ge_u32 s28, 73
s_cselect_b32 s21, 73, 0
s_cselect_b32 s22, 1177344, 0
s_sub_u32 s28, s28, s21
s_add_u32 s20, s20, s22
s_add_u32 s20, s20, 86016
s_add_u32 m0, s96, 113152
s_mov_b32 exec_hi, 4194303
buffer_load_dwordx4 v82, s[4:7], s20 offen nt lds
s_mov_b32 exec_hi, -1
s_add_u32 s28, s28, 32
s_cmp_ge_u32 s28, 73
s_cselect_b32 s21, 73, 0
s_cselect_b32 s22, 1177344, 0
s_sub_u32 s28, s28, s21
s_add_u32 s20, s20, s22
s_add_u32 s20, s20, 86016
s_add_u32 m0, s96, 116624
s_mov_b32 exec_hi, 4194303
buffer_load_dwordx4 v82, s[4:7], s20 offen nt lds
s_mov_b32 exec_hi, -1
s_add_u32 s28, s28, 32
s_cmp_ge_u32 s28, 73
s_cselect_b32 s21, 73, 0
s_cselect_b32 s22, 1177344, 0
s_sub_u32 s28, s28, s21
s_add_u32 s20, s20, s22
s_add_u32 s20, s20, 86016
s_add_u32 m0, s96, 120096
s_mov_b32 exec_hi, 4194303
buffer_load_dwordx4 v82, s[4:7], s20 offen nt lds
s_mov_b32 exec_hi, -1
s_add_u32 s28, s28, 32
s_cmp_ge_u32 s28, 73
s_cselect_b32 s21, 73, 0
s_cselect_b32 s22, 1177344, 0
s_sub_u32 s28, s28, s21
s_add_u32 s20, s20, s22
s_add_u32 s20, s20, 86016
s_add_u32 m0, s96, 123568
s_mov_b32 exec_hi, 4194303
buffer_load_dwordx4 v82, s[4:7], s20 offen nt lds
s_mov_b32 exec_hi, -1
s_add_u32 m0, s55, 131328
s_add_u32 s29, s54, 384
buffer_load_dwordx4 v72, s[12:15], s29 offen lds
s_add_u32 m0, s55, 132352
s_add_u32 s29, s54, 384
buffer_load_dwordx4 v73, s[12:15], s29 offen lds
s_add_u32 m0, s55, 133376
s_add_u32 s29, s54, 384
buffer_load_dwordx4 v74, s[12:15], s29 offen lds
ds_read_b128 v[84:87], v200
s_waitcnt lgkmcnt(0)
v_mfma_f32_16x16x32_bf16 v[0:3], v[138:141], v[84:87], 0
ds_read_b128 v[92:95], v201
s_waitcnt lgkmcnt(0)
v_mfma_f32_16x16x32_bf16 v[12:15], v[138:141], v[92:95], 0
ds_read_b128 v[100:103], v202
s_waitcnt lgkmcnt(0)
v_mfma_f32_16x16x32_bf16 v[24:27], v[138:141], v[100:103], 0
ds_read_b128 v[84:87], v194
ds_read_b128 v[88:91], v194 offset:16
s_waitcnt lgkmcnt(0)
v_smfmac_f32_16x16x64_bf16 v[0:3], v[142:145], v[84:91], v213
ds_read_b128 v[92:95], v195
ds_read_b128 v[96:99], v195 offset:16
s_waitcnt lgkmcnt(0)
v_smfmac_f32_16x16x64_bf16 v[12:15], v[142:145], v[92:99], v213
ds_read_b128 v[100:103], v196
ds_read_b128 v[104:107], v196 offset:16
s_waitcnt lgkmcnt(0)
v_smfmac_f32_16x16x64_bf16 v[24:27], v[142:145], v[100:107], v213
ds_read_b128 v[84:87], v197
ds_read_b128 v[88:91], v197 offset:16
s_waitcnt lgkmcnt(0)
v_smfmac_f32_16x16x64_bf16 v[0:3], v[146:149], v[84:91], v213
ds_read_b128 v[92:95], v198
ds_read_b128 v[96:99], v198 offset:16
s_waitcnt lgkmcnt(0)
v_smfmac_f32_16x16x64_bf16 v[12:15], v[146:149], v[92:99], v213
ds_read_b128 v[100:103], v199
ds_read_b128 v[104:107], v199 offset:16
s_waitcnt lgkmcnt(0)
v_smfmac_f32_16x16x64_bf16 v[24:27], v[146:149], v[100:107], v213
ds_read_b128 v[84:87], v200 offset:32
s_waitcnt lgkmcnt(0)
v_mfma_f32_16x16x32_bf16 v[4:7], v[150:153], v[84:87], 0
ds_read_b128 v[92:95], v201 offset:32
s_waitcnt lgkmcnt(0)
v_mfma_f32_16x16x32_bf16 v[16:19], v[150:153], v[92:95], 0
ds_read_b128 v[100:103], v202 offset:32
s_waitcnt lgkmcnt(0)
v_mfma_f32_16x16x32_bf16 v[28:31], v[150:153], v[100:103], 0
ds_read_b128 v[84:87], v194 offset:32
ds_read_b128 v[88:91], v194 offset:48
s_waitcnt lgkmcnt(0)
v_smfmac_f32_16x16x64_bf16 v[4:7], v[154:157], v[84:91], v213
ds_read_b128 v[92:95], v195 offset:32
ds_read_b128 v[96:99], v195 offset:48
s_waitcnt lgkmcnt(0)
v_smfmac_f32_16x16x64_bf16 v[16:19], v[154:157], v[92:99], v213
ds_read_b128 v[100:103], v196 offset:32
ds_read_b128 v[104:107], v196 offset:48
s_waitcnt lgkmcnt(0)
v_smfmac_f32_16x16x64_bf16 v[28:31], v[154:157], v[100:107], v213
ds_read_b128 v[84:87], v197 offset:32
ds_read_b128 v[88:91], v197 offset:48
s_waitcnt lgkmcnt(0)
v_smfmac_f32_16x16x64_bf16 v[4:7], v[158:161], v[84:91], v213
ds_read_b128 v[92:95], v198 offset:32
ds_read_b128 v[96:99], v198 offset:48
s_waitcnt lgkmcnt(0)
v_smfmac_f32_16x16x64_bf16 v[16:19], v[158:161], v[92:99], v213
ds_read_b128 v[100:103], v199 offset:32
ds_read_b128 v[104:107], v199 offset:48
s_waitcnt lgkmcnt(0)
v_smfmac_f32_16x16x64_bf16 v[28:31], v[158:161], v[100:107], v213
ds_read_b128 v[84:87], v200 offset:64
s_waitcnt lgkmcnt(0)
v_mfma_f32_16x16x32_bf16 v[8:11], v[162:165], v[84:87], 0
ds_read_b128 v[92:95], v201 offset:64
s_waitcnt lgkmcnt(0)
v_mfma_f32_16x16x32_bf16 v[20:23], v[162:165], v[92:95], 0
ds_read_b128 v[100:103], v202 offset:64
s_waitcnt lgkmcnt(0)
v_mfma_f32_16x16x32_bf16 v[32:35], v[162:165], v[100:103], 0
ds_read_b128 v[84:87], v194 offset:64
ds_read_b128 v[88:91], v194 offset:80
s_waitcnt lgkmcnt(0)
v_smfmac_f32_16x16x64_bf16 v[8:11], v[166:169], v[84:91], v213
ds_read_b128 v[92:95], v195 offset:64
ds_read_b128 v[96:99], v195 offset:80
s_waitcnt lgkmcnt(0)
v_smfmac_f32_16x16x64_bf16 v[20:23], v[166:169], v[92:99], v213
ds_read_b128 v[100:103], v196 offset:64
ds_read_b128 v[104:107], v196 offset:80
s_waitcnt lgkmcnt(0)
v_smfmac_f32_16x16x64_bf16 v[32:35], v[166:169], v[100:107], v213
ds_read_b128 v[84:87], v197 offset:64
ds_read_b128 v[88:91], v197 offset:80
s_waitcnt lgkmcnt(0)
v_smfmac_f32_16x16x64_bf16 v[8:11], v[170:173], v[84:91], v213
ds_read_b128 v[92:95], v198 offset:64
ds_read_b128 v[96:99], v198 offset:80
s_waitcnt lgkmcnt(0)
v_smfmac_f32_16x16x64_bf16 v[20:23], v[170:173], v[92:99], v213
ds_read_b128 v[100:103], v199 offset:64
ds_read_b128 v[104:107], v199 offset:80
s_waitcnt lgkmcnt(0)
v_smfmac_f32_16x16x64_bf16 v[32:35], v[170:173], v[100:107], v213
v_add_f32 v118, v0, v1
v_mul_f32 v119, v0, v0
v_add_f32 v118, v118, v2
v_fmac_f32 v119, v1, v1
v_add_f32 v118, v118, v3
v_fmac_f32 v119, v2, v2
v_fmac_f32 v119, v3, v3
v_add_f32 v126, v12, v13
v_mul_f32 v127, v12, v12
v_add_f32 v126, v126, v14
v_fmac_f32 v127, v13, v13
v_add_f32 v126, v126, v15
v_fmac_f32 v127, v14, v14
v_fmac_f32 v127, v15, v15
v_add_f32 v134, v24, v25
v_mul_f32 v135, v24, v24
v_add_f32 v134, v134, v26
v_fmac_f32 v135, v25, v25
v_add_f32 v134, v134, v27
v_fmac_f32 v135, v26, v26
v_fmac_f32 v135, v27, v27
v_add_f32 v118, v118, v4
v_fmac_f32 v119, v4, v4
v_add_f32 v118, v118, v5
v_fmac_f32 v119, v5, v5
v_add_f32 v118, v118, v6
v_fmac_f32 v119, v6, v6
v_add_f32 v118, v118, v7
v_fmac_f32 v119, v7, v7
v_add_f32 v126, v126, v16
v_fmac_f32 v127, v16, v16
v_add_f32 v126, v126, v17
v_fmac_f32 v127, v17, v17
v_add_f32 v126, v126, v18
v_fmac_f32 v127, v18, v18
v_add_f32 v126, v126, v19
v_fmac_f32 v127, v19, v19
v_add_f32 v134, v134, v28
v_fmac_f32 v135, v28, v28
v_add_f32 v134, v134, v29
v_fmac_f32 v135, v29, v29
v_add_f32 v134, v134, v30
v_fmac_f32 v135, v30, v30
v_add_f32 v134, v134, v31
v_fmac_f32 v135, v31, v31
v_add_f32 v118, v118, v8
v_fmac_f32 v119, v8, v8
v_add_f32 v118, v118, v9
v_fmac_f32 v119, v9, v9
v_add_f32 v118, v118, v10
v_fmac_f32 v119, v10, v10
v_add_f32 v118, v118, v11
v_fmac_f32 v119, v11, v11
v_add_f32 v126, v126, v20
v_fmac_f32 v127, v20, v20
v_add_f32 v126, v126, v21
v_fmac_f32 v127, v21, v21
v_add_f32 v126, v126, v22
v_fmac_f32 v127, v22, v22
v_add_f32 v126, v126, v23
v_fmac_f32 v127, v23, v23
v_add_f32 v134, v134, v32
v_fmac_f32 v135, v32, v32
v_add_f32 v134, v134, v33
v_fmac_f32 v135, v33, v33
v_add_f32 v134, v134, v34
v_fmac_f32 v135, v34, v34
v_add_f32 v134, v134, v35
v_fmac_f32 v135, v35, v35
v_permlane16_swap_b32 v118, v119
v_add_f32 v118, v118, v119
v_permlane16_swap_b32 v126, v127
v_add_f32 v126, v126, v127
v_permlane16_swap_b32 v134, v135
v_add_f32 v134, v134, v135
v_permlane32_swap_b32 v118, v126
v_add_f32 v118, v118, v126
ds_write_b32 v209, v118
v_mov_b32 v135, v134
s_nop 1
v_permlane32_swap_b32 v134, v135
v_add_f32 v134, v134, v135
ds_write_b32 v209, v134 offset:512
s_waitcnt lgkmcnt(0)
s_barrier
ds_read_b128 v[102:105], v210 offset:18432
ds_read_b128 v[106:109], v210 offset:19456
s_waitcnt lgkmcnt(1)
v_add_f32 v102, v102, v103
s_waitcnt lgkmcnt(0)
v_add_f32 v106, v106, v107
v_add_f32 v104, v104, v105
v_add_f32 v108, v108, v109
v_add_f32 v102, v102, v104
v_add_f32 v106, v106, v108
v_mul_f32 v103, s48, v102
v_mul_f32 v104, s73, v102
v_mul_f32 v106, s73, v106
v_fma_f32 v106, -v103, v104, v106
v_max_f32 v106, 0, v106
v_add_f32 v106, s49, v106
v_rsq_f32 v102, v106
s_nop 0
v_mul_f32_e64 v103, -v103, v102
ds_write_b64 v211, v[102:103]
ds_read_b64 v[118:119], v219
ds_read_b64 v[126:127], v219 offset:256
ds_read_b64 v[134:135], v219 offset:512
s_waitcnt lgkmcnt(2)
v_fma_f32 v220, v0, v118, v119
v_fma_f32 v221, v1, v118, v119
v_cvt_pk_bf16_f32 v90, v220, v221
v_fma_f32 v222, v2, v118, v119
v_fma_f32 v223, v3, v118, v119
v_cvt_pk_bf16_f32 v91, v222, v223
v_fma_f32 v220, v4, v118, v119
v_fma_f32 v221, v5, v118, v119
v_cvt_pk_bf16_f32 v92, v220, v221
v_fma_f32 v222, v6, v118, v119
v_fma_f32 v223, v7, v118, v119
v_cvt_pk_bf16_f32 v93, v222, v223
ds_write_b128 v211, v[90:93]
v_fma_f32 v220, v8, v118, v119
v_fma_f32 v221, v9, v118, v119
v_cvt_pk_bf16_f32 v94, v220, v221
v_fma_f32 v222, v10, v118, v119
v_fma_f32 v223, v11, v118, v119
v_cvt_pk_bf16_f32 v95, v222, v223
s_waitcnt lgkmcnt(2)
ds_write_b64 v212, v[94:95]
v_fma_f32 v220, v12, v126, v127
v_fma_f32 v221, v13, v126, v127
v_cvt_pk_bf16_f32 v174, v220, v221
v_fma_f32 v222, v14, v126, v127
v_fma_f32 v223, v15, v126, v127
v_cvt_pk_bf16_f32 v175, v222, v223
v_fma_f32 v220, v16, v126, v127
v_fma_f32 v221, v17, v126, v127
v_cvt_pk_bf16_f32 v176, v220, v221
v_fma_f32 v222, v18, v126, v127
v_fma_f32 v223, v19, v126, v127
v_cvt_pk_bf16_f32 v177, v222, v223
ds_write_b128 v211, v[174:177] offset:6144
v_fma_f32 v220, v20, v126, v127
v_fma_f32 v221, v21, v126, v127
v_cvt_pk_bf16_f32 v178, v220, v221
v_fma_f32 v222, v22, v126, v127
v_fma_f32 v223, v23, v126, v127
v_cvt_pk_bf16_f32 v179, v222, v223
s_waitcnt lgkmcnt(3)
ds_write_b64 v212, v[178:179] offset:6144
v_fma_f32 v220, v24, v134, v135
v_fma_f32 v221, v25, v134, v135
v_cvt_pk_bf16_f32 v90, v220, v221
v_fma_f32 v222, v26, v134, v135
v_fma_f32 v223, v27, v134, v135
v_cvt_pk_bf16_f32 v91, v222, v223
v_fma_f32 v220, v28, v134, v135
v_fma_f32 v221, v29, v134, v135
v_cvt_pk_bf16_f32 v92, v220, v221
v_fma_f32 v222, v30, v134, v135
v_fma_f32 v223, v31, v134, v135
v_cvt_pk_bf16_f32 v93, v222, v223
ds_write_b128 v211, v[90:93] offset:12288
v_fma_f32 v220, v32, v134, v135
v_fma_f32 v221, v33, v134, v135
v_cvt_pk_bf16_f32 v94, v220, v221
v_fma_f32 v222, v34, v134, v135
v_fma_f32 v223, v35, v134, v135
v_cvt_pk_bf16_f32 v95, v222, v223
ds_write_b64 v212, v[94:95] offset:12288
s_mov_b64 exec, s[30:31]
ds_write_b128 v217, v[138:141]
s_mov_b64 exec, -1
s_mov_b64 exec, s[30:31]
ds_write_b128 v217, v[142:145] offset:528
s_mov_b64 exec, -1
s_mov_b64 exec, s[30:31]
ds_write_b128 v217, v[146:149] offset:1056
s_mov_b64 exec, -1
s_mov_b64 exec, s[30:31]
ds_write_b128 v217, v[150:153] offset:1584
s_mov_b64 exec, -1
s_mov_b64 exec, s[30:31]
ds_write_b128 v217, v[154:157] offset:2112
s_mov_b64 exec, -1
s_mov_b64 exec, s[30:31]
ds_write_b128 v217, v[158:161] offset:2640
s_mov_b64 exec, -1
s_mov_b64 exec, s[30:31]
ds_write_b128 v217, v[162:165] offset:3168
s_mov_b64 exec, -1
s_mov_b64 exec, s[30:31]
ds_write_b128 v217, v[166:169] offset:3696
s_mov_b64 exec, -1
s_mov_b64 exec, s[30:31]
ds_write_b128 v217, v[170:173] offset:4224
s_mov_b64 exec, -1
s_add_u32 m0, s55, 0
s_add_u32 s29, s54, 37248
buffer_load_dwordx4 v72, s[12:15], s29 offen lds
s_add_u32 m0, s55, 1024
s_add_u32 s29, s54, 37248
buffer_load_dwordx4 v73, s[12:15], s29 offen lds
s_add_u32 m0, s55, 2048
s_add_u32 s29, s54, 37248
buffer_load_dwordx4 v74, s[12:15], s29 offen lds
s_add_u32 m0, s55, 12288
s_add_u32 s29, s54, 74112
buffer_load_dwordx4 v72, s[12:15], s29 offen lds
s_add_u32 m0, s55, 13312
s_add_u32 s29, s54, 74112
buffer_load_dwordx4 v73, s[12:15], s29 offen lds
s_add_u32 m0, s55, 14336
s_add_u32 s29, s54, 74112
buffer_load_dwordx4 v74, s[12:15], s29 offen lds
s_add_u32 m0, s55, 24576
s_add_u32 s29, s54, 110976
buffer_load_dwordx4 v72, s[12:15], s29 offen lds
s_add_u32 m0, s55, 25600
s_add_u32 s29, s54, 110976
buffer_load_dwordx4 v73, s[12:15], s29 offen lds
s_waitcnt vmcnt(11) lgkmcnt(9)
s_add_u32 m0, s55, 26624
s_add_u32 s29, s54, 110976
buffer_load_dwordx4 v74, s[12:15], s29 offen lds
s_barrier
ds_read_b128 v[84:87], v113
s_waitcnt lgkmcnt(0)
v_mfma_f32_16x16x32_bf16 v[36:39], v[138:141], v[84:87], 0
ds_read_b128 v[92:95], v113 offset:55552
s_waitcnt lgkmcnt(0)
v_mfma_f32_16x16x32_bf16 v[48:51], v[138:141], v[92:95], 0
ds_read_b128 v[100:103], v111
ds_read_b128 v[104:107], v111 offset:16
s_waitcnt lgkmcnt(0)
v_smfmac_f32_16x16x64_bf16 v[36:39], v[142:145], v[100:107], v213
ds_read_b128 v[84:87], v111 offset:55552
ds_read_b128 v[88:91], v111 offset:55568
s_waitcnt lgkmcnt(0)
v_smfmac_f32_16x16x64_bf16 v[48:51], v[142:145], v[84:91], v213
ds_read_b128 v[92:95], v112
ds_read_b128 v[96:99], v112 offset:16
s_waitcnt lgkmcnt(0)
v_smfmac_f32_16x16x64_bf16 v[36:39], v[146:149], v[92:99], v213
ds_read_b128 v[100:103], v112 offset:55552
ds_read_b128 v[104:107], v112 offset:55568
s_waitcnt lgkmcnt(0)
v_smfmac_f32_16x16x64_bf16 v[48:51], v[146:149], v[100:107], v213
ds_read_b128 v[84:87], v113 offset:32
s_waitcnt lgkmcnt(0)
v_mfma_f32_16x16x32_bf16 v[40:43], v[150:153], v[84:87], 0
ds_read_b128 v[92:95], v113 offset:55584
s_waitcnt lgkmcnt(0)
v_mfma_f32_16x16x32_bf16 v[52:55], v[150:153], v[92:95], 0
ds_read_b128 v[100:103], v111 offset:32
ds_read_b128 v[104:107], v111 offset:48
s_waitcnt lgkmcnt(0)
v_smfmac_f32_16x16x64_bf16 v[40:43], v[154:157], v[100:107], v213
ds_read_b128 v[84:87], v111 offset:55584
ds_read_b128 v[88:91], v111 offset:55600
s_waitcnt lgkmcnt(0)
v_smfmac_f32_16x16x64_bf16 v[52:55], v[154:157], v[84:91], v213
ds_read_b128 v[92:95], v112 offset:32
ds_read_b128 v[96:99], v112 offset:48
s_waitcnt lgkmcnt(0)
v_smfmac_f32_16x16x64_bf16 v[40:43], v[158:161], v[92:99], v213
ds_read_b128 v[100:103], v112 offset:55584
ds_read_b128 v[104:107], v112 offset:55600
s_waitcnt lgkmcnt(0)
v_smfmac_f32_16x16x64_bf16 v[52:55], v[158:161], v[100:107], v213
ds_read_b128 v[84:87], v113 offset:64
s_waitcnt lgkmcnt(0)
v_mfma_f32_16x16x32_bf16 v[44:47], v[162:165], v[84:87], 0
ds_read_b128 v[92:95], v113 offset:55616
s_waitcnt lgkmcnt(0)
v_mfma_f32_16x16x32_bf16 v[56:59], v[162:165], v[92:95], 0
ds_read_b128 v[100:103], v111 offset:64
ds_read_b128 v[104:107], v111 offset:80
s_waitcnt lgkmcnt(0)
v_smfmac_f32_16x16x64_bf16 v[44:47], v[166:169], v[100:107], v213
ds_read_b128 v[84:87], v111 offset:55616
ds_read_b128 v[88:91], v111 offset:55632
s_waitcnt lgkmcnt(0)
v_smfmac_f32_16x16x64_bf16 v[56:59], v[166:169], v[84:91], v213
ds_read_b128 v[92:95], v112 offset:64
ds_read_b128 v[96:99], v112 offset:80
s_waitcnt lgkmcnt(0)
v_smfmac_f32_16x16x64_bf16 v[44:47], v[170:173], v[92:99], v213
ds_read_b128 v[100:103], v112 offset:55616
ds_read_b128 v[104:107], v112 offset:55632
s_waitcnt lgkmcnt(0)
v_smfmac_f32_16x16x64_bf16 v[56:59], v[170:173], v[100:107], v213
s_barrier
v_add_f32 v118, v36, v37
v_mul_f32 v119, v36, v36
v_add_f32 v118, v118, v38
v_fmac_f32 v119, v37, v37
v_add_f32 v118, v118, v39
v_fmac_f32 v119, v38, v38
v_fmac_f32 v119, v39, v39
v_add_f32 v126, v48, v49
v_mul_f32 v127, v48, v48
v_add_f32 v126, v126, v50
v_fmac_f32 v127, v49, v49
v_add_f32 v126, v126, v51
v_fmac_f32 v127, v50, v50
v_fmac_f32 v127, v51, v51
v_add_f32 v118, v118, v40
v_fmac_f32 v119, v40, v40
v_add_f32 v118, v118, v41
v_fmac_f32 v119, v41, v41
v_add_f32 v118, v118, v42
v_fmac_f32 v119, v42, v42
v_add_f32 v118, v118, v43
v_fmac_f32 v119, v43, v43
v_add_f32 v126, v126, v52
v_fmac_f32 v127, v52, v52
v_add_f32 v126, v126, v53
v_fmac_f32 v127, v53, v53
v_add_f32 v126, v126, v54
v_fmac_f32 v127, v54, v54
v_add_f32 v126, v126, v55
v_fmac_f32 v127, v55, v55
v_add_f32 v118, v118, v44
v_fmac_f32 v119, v44, v44
v_add_f32 v118, v118, v45
v_fmac_f32 v119, v45, v45
v_add_f32 v118, v118, v46
v_fmac_f32 v119, v46, v46
v_add_f32 v118, v118, v47
v_fmac_f32 v119, v47, v47
v_add_f32 v126, v126, v56
v_fmac_f32 v127, v56, v56
v_add_f32 v126, v126, v57
v_fmac_f32 v127, v57, v57
v_add_f32 v126, v126, v58
v_fmac_f32 v127, v58, v58
v_add_f32 v126, v126, v59
v_fmac_f32 v127, v59, v59
v_permlane16_swap_b32 v118, v119
v_add_f32 v118, v118, v119
v_permlane16_swap_b32 v126, v127
v_add_f32 v126, v126, v127
s_nop 1
v_permlane32_swap_b32 v118, v126
v_add_f32 v118, v118, v126
ds_write_b32 v209, v118
s_add_u32 m0, s55, 94464
s_add_u32 s29, s54, 147840
buffer_load_dwordx4 v72, s[12:15], s29 offen lds
s_add_u32 m0, s55, 95488
s_add_u32 s29, s54, 147840
buffer_load_dwordx4 v73, s[12:15], s29 offen lds
s_add_u32 m0, s55, 96512
s_add_u32 s29, s54, 147840
buffer_load_dwordx4 v74, s[12:15], s29 offen lds
s_add_u32 m0, s55, 106752
s_add_u32 s29, s54, 184704
buffer_load_dwordx4 v72, s[12:15], s29 offen lds
s_add_u32 m0, s55, 107776
s_add_u32 s29, s54, 184704
buffer_load_dwordx4 v73, s[12:15], s29 offen lds
s_add_u32 m0, s55, 108800
s_add_u32 s29, s54, 184704
buffer_load_dwordx4 v74, s[12:15], s29 offen lds
s_add_u32 m0, s55, 119040
s_add_u32 s29, s54, 0
buffer_load_dwordx4 v72, s[12:15], s29 offen lds
s_add_u32 m0, s55, 120064
s_add_u32 s29, s54, 0
buffer_load_dwordx4 v73, s[12:15], s29 offen lds
s_add_u32 m0, s55, 121088
s_add_u32 s29, s54, 0
buffer_load_dwordx4 v74, s[12:15], s29 offen lds
s_add_u32 m0, s55, 69888
s_add_u32 s29, s54, 36864
buffer_load_dwordx4 v72, s[12:15], s29 offen lds
s_add_u32 m0, s55, 70912
s_add_u32 s29, s54, 36864
buffer_load_dwordx4 v73, s[12:15], s29 offen lds
s_add_u32 m0, s55, 71936
s_add_u32 s29, s54, 36864
buffer_load_dwordx4 v74, s[12:15], s29 offen lds
s_add_u32 m0, s55, 82176
s_add_u32 s29, s54, 73728
buffer_load_dwordx4 v72, s[12:15], s29 offen lds
s_add_u32 m0, s55, 83200
s_add_u32 s29, s54, 73728
buffer_load_dwordx4 v73, s[12:15], s29 offen lds
s_waitcnt vmcnt(18)
s_add_u32 m0, s55, 84224
s_add_u32 s29, s54, 73728
buffer_load_dwordx4 v74, s[12:15], s29 offen lds
ds_read_b64_tr_b16 a[0:1], v110 offset:36864
ds_read_b64_tr_b16 a[24:25], v110 offset:36896
ds_read_b64_tr_b16 a[48:49], v110 offset:36928
ds_read_b64_tr_b16 a[2:3], v110 offset:38400
ds_read_b64_tr_b16 a[26:27], v110 offset:38432
ds_read_b64_tr_b16 a[50:51], v110 offset:38464
ds_read_b64_tr_b16 a[4:5], v128 offset:1536
ds_read_b64_tr_b16 a[28:29], v128 offset:1568
ds_read_b64_tr_b16 a[52:53], v128 offset:1600
ds_read_b64_tr_b16 a[16:17], v128
ds_read_b64_tr_b16 a[40:41], v128 offset:32
ds_read_b64_tr_b16 a[64:65], v128 offset:64
ds_read_b64_tr_b16 a[6:7], v128 offset:12288
ds_read_b64_tr_b16 a[30:31], v128 offset:12320
ds_read_b64_tr_b16 a[54:55], v128 offset:12352
s_waitcnt vmcnt(18)
ds_read_b64_tr_b16 a[18:19], v128 offset:13824
ds_read_b64_tr_b16 a[42:43], v128 offset:13856
ds_read_b64_tr_b16 a[66:67], v128 offset:13888
s_waitcnt vmcnt(16)
ds_read_b64_tr_b16 a[8:9], v128 offset:24576
ds_read_b64_tr_b16 a[32:33], v128 offset:24608
ds_read_b64_tr_b16 a[56:57], v128 offset:24640
s_waitcnt vmcnt(15)
ds_read_b64_tr_b16 a[10:11], v128 offset:26112
ds_read_b64_tr_b16 a[34:35], v128 offset:26144
ds_read_b64_tr_b16 a[58:59], v128 offset:26176
v_mov_b32 v128, v83
s_waitcnt lgkmcnt(14)
s_add_u32 m0, s55, 131328
s_add_u32 s29, s54, 110592
buffer_load_dwordx4 v72, s[12:15], s29 offen lds
s_add_u32 m0, s55, 132352
s_add_u32 s29, s54, 110592
buffer_load_dwordx4 v73, s[12:15], s29 offen lds
s_add_u32 m0, s55, 133376
s_add_u32 s29, s54, 110592
buffer_load_dwordx4 v74, s[12:15], s29 offen lds
s_barrier
ds_read_b128 v[102:105], v210 offset:18432
ds_read_b128 v[106:109], v210 offset:19456
s_waitcnt lgkmcnt(1)
v_add_f32 v102, v102, v103
s_waitcnt lgkmcnt(0)
v_add_f32 v106, v106, v107
v_add_f32 v104, v104, v105
v_add_f32 v108, v108, v109
v_add_f32 v102, v102, v104
v_add_f32 v106, v106, v108
v_mul_f32 v103, s48, v102
v_mul_f32 v104, s73, v102
v_mul_f32 v106, s73, v106
v_fma_f32 v106, -v103, v104, v106
v_max_f32 v106, 0, v106
v_add_f32 v106, s49, v106
v_rsq_f32 v102, v106
s_nop 0
v_mul_f32_e64 v103, -v103, v102
ds_write_b64 v211, v[102:103] offset:20480
ds_read_b64 v[118:119], v219 offset:20480
ds_read_b64 v[126:127], v219 offset:20736
s_waitcnt lgkmcnt(1)
v_fma_f32 v220, v36, v118, v119
v_fma_f32 v221, v37, v118, v119
v_cvt_pk_bf16_f32 v90, v220, v221
v_fma_f32 v222, v38, v118, v119
v_fma_f32 v223, v39, v118, v119
v_cvt_pk_bf16_f32 v91, v222, v223
v_fma_f32 v220, v40, v118, v119
v_fma_f32 v221, v41, v118, v119
v_cvt_pk_bf16_f32 v92, v220, v221
v_fma_f32 v222, v42, v118, v119
v_fma_f32 v223, v43, v118, v119
v_cvt_pk_bf16_f32 v93, v222, v223
ds_write_b128 v211, v[90:93] offset:20480
v_fma_f32 v220, v44, v118, v119
v_fma_f32 v221, v45, v118, v119
v_cvt_pk_bf16_f32 v94, v220, v221
v_fma_f32 v222, v46, v118, v119
v_fma_f32 v223, v47, v118, v119
v_cvt_pk_bf16_f32 v95, v222, v223
s_waitcnt lgkmcnt(1)
ds_write_b64 v212, v[94:95] offset:20480
v_fma_f32 v220, v48, v126, v127
v_fma_f32 v221, v49, v126, v127
v_cvt_pk_bf16_f32 v174, v220, v221
v_fma_f32 v222, v50, v126, v127
v_fma_f32 v223, v51, v126, v127
v_cvt_pk_bf16_f32 v175, v222, v223
v_fma_f32 v220, v52, v126, v127
v_fma_f32 v221, v53, v126, v127
v_cvt_pk_bf16_f32 v176, v220, v221
v_fma_f32 v222, v54, v126, v127
v_fma_f32 v223, v55, v126, v127
v_cvt_pk_bf16_f32 v177, v222, v223
ds_write_b128 v211, v[174:177] offset:26624
v_fma_f32 v220, v56, v126, v127
v_fma_f32 v221, v57, v126, v127
v_cvt_pk_bf16_f32 v178, v220, v221
v_fma_f32 v222, v58, v126, v127
v_fma_f32 v223, v59, v126, v127
v_cvt_pk_bf16_f32 v179, v222, v223
ds_write_b64 v212, v[178:179] offset:26624
s_waitcnt vmcnt(15) lgkmcnt(0)
s_barrier
ds_read_b64_tr_b16 a[12:13], v110 offset:1536
ds_read_b64_tr_b16 a[36:37], v110 offset:1568
ds_read_b64_tr_b16 a[60:61], v110 offset:1600
ds_read_b64_tr_b16 a[20:21], v110
ds_read_b64_tr_b16 a[44:45], v110 offset:32
ds_read_b64_tr_b16 a[68:69], v110 offset:64
s_waitcnt vmcnt(12) lgkmcnt(0)
s_add_u32 m0, s55, 94464
s_add_u32 s29, s54, 147456
buffer_load_dwordx4 v72, s[12:15], s29 offen lds
s_add_u32 m0, s55, 95488
s_add_u32 s29, s54, 147456
buffer_load_dwordx4 v73, s[12:15], s29 offen lds
s_add_u32 m0, s55, 96512
s_add_u32 s29, s54, 147456
buffer_load_dwordx4 v74, s[12:15], s29 offen lds
ds_read_b64_tr_b16 a[14:15], v110 offset:12288
ds_read_b64_tr_b16 a[38:39], v110 offset:12320
ds_read_b64_tr_b16 a[62:63], v110 offset:12352
ds_read_b64_tr_b16 a[22:23], v110 offset:13824
ds_read_b64_tr_b16 a[46:47], v110 offset:13856
ds_read_b64_tr_b16 a[70:71], v110 offset:13888
s_waitcnt vmcnt(12) lgkmcnt(0)
s_add_u32 m0, s55, 106752
s_add_u32 s29, s54, 184320
buffer_load_dwordx4 v72, s[12:15], s29 offen lds
s_add_u32 m0, s55, 107776
s_add_u32 s29, s54, 184320
buffer_load_dwordx4 v73, s[12:15], s29 offen lds
s_add_u32 m0, s55, 108800
s_add_u32 s29, s54, 184320
buffer_load_dwordx4 v74, s[12:15], s29 offen lds
ds_read_b64_tr_b16 a[216:217], v110 offset:24576
ds_read_b64_tr_b16 a[240:241], v110 offset:24608
ds_read_b64_tr_b16 v[232:233], v110 offset:24640
ds_read_b64_tr_b16 a[218:219], v110 offset:26112
ds_read_b64_tr_b16 a[242:243], v110 offset:26144
ds_read_b64_tr_b16 v[234:235], v110 offset:26176
s_waitcnt vmcnt(12) lgkmcnt(0)
s_add_u32 m0, s55, 119040
s_add_u32 s29, s54, 768
buffer_load_dwordx4 v72, s[12:15], s29 offen lds
s_add_u32 m0, s55, 120064
s_add_u32 s29, s54, 768
buffer_load_dwordx4 v73, s[12:15], s29 offen lds
s_add_u32 m0, s55, 121088
s_add_u32 s29, s54, 768
buffer_load_dwordx4 v74, s[12:15], s29 offen lds
ds_read_b64_tr_b16 a[220:221], v129 offset:1536
ds_read_b64_tr_b16 a[244:245], v129 offset:1568
ds_read_b64_tr_b16 v[236:237], v129 offset:1600
ds_read_b64_tr_b16 a[232:233], v129
ds_read_b64_tr_b16 v[224:225], v129 offset:32
ds_read_b64_tr_b16 v[248:249], v129 offset:64
s_waitcnt lgkmcnt(0)
s_add_u32 m0, s55, 69888
s_add_u32 s29, s54, 37632
buffer_load_dwordx4 v72, s[12:15], s29 offen lds
s_add_u32 m0, s55, 70912
s_add_u32 s29, s54, 37632
buffer_load_dwordx4 v73, s[12:15], s29 offen lds
s_waitcnt vmcnt(14)
s_add_u32 m0, s55, 71936
s_add_u32 s29, s54, 37632
buffer_load_dwordx4 v74, s[12:15], s29 offen lds
ds_read_b64_tr_b16 a[222:223], v129 offset:12288
ds_read_b64_tr_b16 a[246:247], v129 offset:12320
ds_read_b64_tr_b16 v[238:239], v129 offset:12352
ds_read_b64_tr_b16 a[234:235], v129 offset:13824
ds_read_b64_tr_b16 v[226:227], v129 offset:13856
ds_read_b64_tr_b16 v[250:251], v129 offset:13888
s_waitcnt lgkmcnt(0)
s_add_u32 m0, s55, 82176
s_add_u32 s29, s54, 74496
buffer_load_dwordx4 v72, s[12:15], s29 offen lds
s_add_u32 m0, s55, 83200
s_add_u32 s29, s54, 74496
buffer_load_dwordx4 v73, s[12:15], s29 offen lds
s_waitcnt vmcnt(14)
s_add_u32 m0, s55, 84224
s_add_u32 s29, s54, 74496
buffer_load_dwordx4 v74, s[12:15], s29 offen lds
ds_read_b64_tr_b16 a[224:225], v110 offset:36864
ds_read_b64_tr_b16 a[248:249], v110 offset:36896
ds_read_b64_tr_b16 v[240:241], v110 offset:36928
ds_read_b64_tr_b16 a[226:227], v110 offset:38400
ds_read_b64_tr_b16 a[250:251], v110 offset:38432
ds_read_b64_tr_b16 v[242:243], v110 offset:38464
s_waitcnt lgkmcnt(0)
s_add_u32 m0, s55, 131328
s_add_u32 s29, s54, 111360
buffer_load_dwordx4 v72, s[12:15], s29 offen lds
s_add_u32 m0, s55, 132352
s_add_u32 s29, s54, 111360
buffer_load_dwordx4 v73, s[12:15], s29 offen lds
s_waitcnt vmcnt(14)
s_add_u32 m0, s55, 133376
s_add_u32 s29, s54, 111360
buffer_load_dwordx4 v74, s[12:15], s29 offen lds
ds_read_b64_tr_b16 a[228:229], v110 offset:1536
ds_read_b64_tr_b16 a[252:253], v110 offset:1568
ds_read_b64_tr_b16 v[244:245], v110 offset:1600
ds_read_b64_tr_b16 a[236:237], v110
ds_read_b64_tr_b16 v[228:229], v110 offset:32
ds_read_b64_tr_b16 v[252:253], v110 offset:64
s_waitcnt lgkmcnt(0)
s_add_u32 m0, s55, 94464
s_add_u32 s29, s54, 148224
buffer_load_dwordx4 v72, s[12:15], s29 offen lds
s_add_u32 m0, s55, 95488
s_add_u32 s29, s54, 148224
buffer_load_dwordx4 v73, s[12:15], s29 offen lds
s_waitcnt vmcnt(14)
s_add_u32 m0, s55, 96512
s_add_u32 s29, s54, 148224
buffer_load_dwordx4 v74, s[12:15], s29 offen lds
ds_read_b64_tr_b16 a[230:231], v110 offset:12288
ds_read_b64_tr_b16 a[254:255], v110 offset:12320
ds_read_b64_tr_b16 v[246:247], v110 offset:12352
ds_read_b64_tr_b16 a[238:239], v110 offset:13824
ds_read_b64_tr_b16 v[230:231], v110 offset:13856
ds_read_b64_tr_b16 v[254:255], v110 offset:13888
s_waitcnt lgkmcnt(0)
s_add_u32 m0, s55, 106752
s_add_u32 s29, s54, 185088
buffer_load_dwordx4 v72, s[12:15], s29 offen lds
s_add_u32 m0, s55, 107776
s_add_u32 s29, s54, 185088
buffer_load_dwordx4 v73, s[12:15], s29 offen lds
s_add_u32 m0, s55, 108800
s_add_u32 s29, s54, 185088
buffer_load_dwordx4 v74, s[12:15], s29 offen lds
s_mul_hi_u32 s41, s35, 58835169
s_mul_i32 s42, s41, 73
s_sub_u32 s42, s35, s42
s_mul_i32 s43, s41, 1373568
s_mul_i32 s51, s42, 2688
s_add_u32 s43, s43, s51
s_cmp_lt_u32 s35, s34
s_cselect_b32 s50, s43, 1879048192
s_add_u32 s35, s35, 32
s_cmp_eq_u32 s42, 0
s_cselect_b32 s44, 536870911, s72
s_cmp_eq_u32 s42, 72
s_cselect_b32 s44, 939524095, s44
s_cmp_eq_u32 s41, 0
s_cselect_b32 s52, 1879048192, s50
s_mov_b32 s37, s50
v_and_b32 v216, s44, v208
s_add_u32 m0, s45, 0
s_nop 0
buffer_load_dwordx4 v216, s[4:7], s52 offen nt lds
s_add_u32 m0, s45, 4112
s_add_u32 s40, s37, 196224
buffer_load_dwordx4 v216, s[4:7], s40 offen nt lds
s_add_u32 m0, s45, 8224
s_add_u32 s40, s37, 392448
buffer_load_dwordx4 v216, s[4:7], s40 offen nt lds
s_add_u32 m0, s45, 12336
s_add_u32 s40, s37, 588672
buffer_load_dwordx4 v216, s[4:7], s40 offen nt lds
s_add_u32 m0, s45, 16448
s_add_u32 s40, s37, 784896
buffer_load_dwordx4 v216, s[4:7], s40 offen nt lds
s_add_u32 m0, s45, 20560
s_add_u32 s40, s37, 981120
buffer_load_dwordx4 v216, s[4:7], s40 offen nt lds
s_add_u32 m0, s45, 24672
s_add_u32 s40, s37, 1177344
buffer_load_dwordx4 v216, s[4:7], s40 offen nt lds
s_add_u32 m0, s45, 28784
s_add_u32 s40, s37, 1373568
buffer_load_dwordx4 v216, s[4:7], s40 offen nt lds
s_waitcnt vmcnt(20)
s_add_u32 m0, s45, 32896
s_add_u32 s40, s37, 1569792
buffer_load_dwordx4 v216, s[4:7], s40 offen nt lds
ds_read_b64_tr_b16 a[72:73], v110 offset:24576
ds_read_b64_tr_b16 a[96:97], v110 offset:24608
ds_read_b64_tr_b16 a[120:121], v110 offset:24640
ds_read_b64_tr_b16 a[74:75], v110 offset:26112
ds_read_b64_tr_b16 a[98:99], v110 offset:26144
ds_read_b64_tr_b16 a[122:123], v110 offset:26176
ds_read_b64_tr_b16 a[76:77], v129 offset:1536
ds_read_b64_tr_b16 a[100:101], v129 offset:1568
ds_read_b64_tr_b16 a[124:125], v129 offset:1600
ds_read_b64_tr_b16 a[88:89], v129
ds_read_b64_tr_b16 a[112:113], v129 offset:32
ds_read_b64_tr_b16 a[136:137], v129 offset:64
s_waitcnt vmcnt(18) lgkmcnt(0)
s_add_u32 m0, s55, 69888
s_add_u32 s29, s54, 0
buffer_load_dwordx4 v136, s[16:19], s29 offen lds
s_add_u32 m0, s55, 70912
s_add_u32 s29, s54, 0
buffer_load_dwordx4 v137, s[16:19], s29 offen lds
s_add_u32 m0, s55, 71936
s_add_u32 s29, s54, 0
buffer_load_dwordx4 v128, s[16:19], s29 offen lds
ds_read_b64_tr_b16 a[78:79], v129 offset:12288
ds_read_b64_tr_b16 a[102:103], v129 offset:12320
ds_read_b64_tr_b16 a[126:127], v129 offset:12352
ds_read_b64_tr_b16 a[90:91], v129 offset:13824
ds_read_b64_tr_b16 a[114:115], v129 offset:13856
ds_read_b64_tr_b16 a[138:139], v129 offset:13888
s_waitcnt lgkmcnt(0)
s_add_u32 m0, s55, 82176
s_add_u32 s29, s54, 12288
buffer_load_dwordx4 v136, s[16:19], s29 offen lds
s_add_u32 m0, s55, 83200
s_add_u32 s29, s54, 12288
buffer_load_dwordx4 v137, s[16:19], s29 offen lds
s_waitcnt vmcnt(15)
s_add_u32 m0, s55, 84224
s_add_u32 s29, s54, 12288
buffer_load_dwordx4 v128, s[16:19], s29 offen lds
ds_read_b64_tr_b16 a[80:81], v110 offset:36864
ds_read_b64_tr_b16 a[104:105], v110 offset:36896
ds_read_b64_tr_b16 a[128:129], v110 offset:36928
ds_read_b64_tr_b16 a[82:83], v110 offset:38400
ds_read_b64_tr_b16 a[106:107], v110 offset:38432
ds_read_b64_tr_b16 a[130:131], v110 offset:38464
ds_read_b64_tr_b16 a[84:85], v110 offset:1536
ds_read_b64_tr_b16 a[108:109], v110 offset:1568
ds_read_b64_tr_b16 a[132:133], v110 offset:1600
ds_read_b64_tr_b16 a[92:93], v110
ds_read_b64_tr_b16 a[116:117], v110 offset:32
ds_read_b64_tr_b16 a[140:141], v110 offset:64
ds_read_b64_tr_b16 a[86:87], v110 offset:12288
ds_read_b64_tr_b16 a[110:111], v110 offset:12320
ds_read_b64_tr_b16 a[134:135], v110 offset:12352
s_waitcnt vmcnt(15)
ds_read_b64_tr_b16 a[94:95], v110 offset:13824
ds_read_b64_tr_b16 a[118:119], v110 offset:13856
ds_read_b64_tr_b16 a[142:143], v110 offset:13888
s_waitcnt vmcnt(3)
ds_read_b64_tr_b16 a[144:145], v129
ds_read_b64_tr_b16 a[168:169], v129 offset:32
ds_read_b64_tr_b16 a[192:193], v129 offset:64
ds_read_b64_tr_b16 a[146:147], v129 offset:1536
ds_read_b64_tr_b16 a[170:171], v129 offset:1568
ds_read_b64_tr_b16 a[194:195], v129 offset:1600
s_waitcnt vmcnt(0) lgkmcnt(0)
s_add_u32 m0, s55, 69888
s_add_u32 s29, s54, 24576
buffer_load_dwordx4 v136, s[16:19], s29 offen lds
s_add_u32 m0, s55, 70912
s_add_u32 s29, s54, 24576
buffer_load_dwordx4 v137, s[16:19], s29 offen lds
s_add_u32 m0, s55, 71936
s_add_u32 s29, s54, 24576
buffer_load_dwordx4 v128, s[16:19], s29 offen lds
ds_read_b64_tr_b16 a[148:149], v129 offset:13824
ds_read_b64_tr_b16 a[172:173], v129 offset:13856
ds_read_b64_tr_b16 a[196:197], v129 offset:13888
ds_read_b64_tr_b16 a[160:161], v129 offset:12288
ds_read_b64_tr_b16 a[184:185], v129 offset:12320
ds_read_b64_tr_b16 a[208:209], v129 offset:12352
s_waitcnt lgkmcnt(0)
s_add_u32 m0, s55, 82176
s_add_u32 s29, s54, 36864
buffer_load_dwordx4 v136, s[16:19], s29 offen lds
s_add_u32 m0, s55, 83200
s_add_u32 s29, s54, 36864
buffer_load_dwordx4 v137, s[16:19], s29 offen lds
s_add_u32 m0, s55, 84224
s_add_u32 s29, s54, 36864
buffer_load_dwordx4 v128, s[16:19], s29 offen lds
s_waitcnt vmcnt(4)
ds_read_b64_tr_b16 a[150:151], v129
ds_read_b64_tr_b16 a[174:175], v129 offset:32
ds_read_b64_tr_b16 a[198:199], v129 offset:64
s_waitcnt vmcnt(3)
ds_read_b64_tr_b16 a[162:163], v129 offset:1536
ds_read_b64_tr_b16 a[186:187], v129 offset:1568
ds_read_b64_tr_b16 a[210:211], v129 offset:1600
s_waitcnt lgkmcnt(0)
s_add_u32 m0, s55, 69888
s_add_u32 s29, s54, 49152
buffer_load_dwordx4 v136, s[16:19], s29 offen lds
s_add_u32 m0, s55, 70912
s_add_u32 s29, s54, 49152
buffer_load_dwordx4 v137, s[16:19], s29 offen lds
s_add_u32 m0, s55, 71936
s_add_u32 s29, s54, 49152
buffer_load_dwordx4 v128, s[16:19], s29 offen lds
s_waitcnt vmcnt(4)
ds_read_b64_tr_b16 a[152:153], v129 offset:12288
ds_read_b64_tr_b16 a[176:177], v129 offset:12320
ds_read_b64_tr_b16 a[200:201], v129 offset:12352
s_waitcnt vmcnt(3)
ds_read_b64_tr_b16 a[154:155], v129 offset:13824
ds_read_b64_tr_b16 a[178:179], v129 offset:13856
ds_read_b64_tr_b16 a[202:203], v129 offset:13888
s_waitcnt lgkmcnt(0)
s_add_u32 m0, s55, 82176
s_add_u32 s29, s54, 61440
buffer_load_dwordx4 v136, s[16:19], s29 offen lds
s_add_u32 m0, s55, 83200
s_add_u32 s29, s54, 61440
buffer_load_dwordx4 v137, s[16:19], s29 offen lds
s_add_u32 m0, s55, 84224
s_add_u32 s29, s54, 61440
buffer_load_dwordx4 v128, s[16:19], s29 offen lds
s_waitcnt vmcnt(3)
ds_read_b64_tr_b16 a[156:157], v129 offset:1536
ds_read_b64_tr_b16 a[180:181], v129 offset:1568
ds_read_b64_tr_b16 a[204:205], v129 offset:1600
ds_read_b64_tr_b16 a[164:165], v129
ds_read_b64_tr_b16 a[188:189], v129 offset:32
ds_read_b64_tr_b16 a[212:213], v129 offset:64
s_waitcnt vmcnt(1)
ds_read_b64_tr_b16 a[158:159], v129 offset:12288
ds_read_b64_tr_b16 a[182:183], v129 offset:12320
ds_read_b64_tr_b16 a[206:207], v129 offset:12352
s_waitcnt vmcnt(0)
ds_read_b64_tr_b16 a[166:167], v129 offset:13824
ds_read_b64_tr_b16 a[190:191], v129 offset:13856
ds_read_b64_tr_b16 a[214:215], v129 offset:13888
ds_read_b128 v[182:185], v210 offset:20480
s_waitcnt lgkmcnt(0)
v_mfma_f32_16x16x32_bf16 v[138:141], a[0:3], v[182:185], 0
v_mfma_f32_16x16x32_bf16 v[142:145], a[24:27], v[182:185], 0
v_mfma_f32_16x16x32_bf16 v[146:149], a[48:51], v[182:185], 0
ds_read_b128 v[186:189], v210 offset:26624
s_waitcnt lgkmcnt(0)
v_mfma_f32_16x16x32_bf16 v[150:153], a[0:3], v[186:189], 0
v_mfma_f32_16x16x32_bf16 v[154:157], a[24:27], v[186:189], 0
v_mfma_f32_16x16x32_bf16 v[158:161], a[48:51], v[186:189], 0
ds_read_b128 v[114:117], v210 offset:21504
s_waitcnt lgkmcnt(0)
v_mfma_f32_16x16x32_bf16 v[138:141], a[4:7], v[114:117], v[138:141]
v_mfma_f32_16x16x32_bf16 v[142:145], a[28:31], v[114:117], v[142:145]
v_mfma_f32_16x16x32_bf16 v[146:149], a[52:55], v[114:117], v[146:149]
ds_read_b128 v[122:125], v210 offset:27648
s_waitcnt lgkmcnt(0)
v_mfma_f32_16x16x32_bf16 v[150:153], a[4:7], v[122:125], v[150:153]
v_mfma_f32_16x16x32_bf16 v[154:157], a[28:31], v[122:125], v[154:157]
v_mfma_f32_16x16x32_bf16 v[158:161], a[52:55], v[122:125], v[158:161]
ds_read_b128 v[182:185], v210 offset:24576
s_waitcnt lgkmcnt(0)
v_mfma_f32_16x16x32_bf16 v[138:141], a[16:19], v[182:185], v[138:141]
v_mfma_f32_16x16x32_bf16 v[142:145], a[40:43], v[182:185], v[142:145]
v_mfma_f32_16x16x32_bf16 v[146:149], a[64:67], v[182:185], v[146:149]
ds_read_b128 v[186:189], v210 offset:30720
s_waitcnt lgkmcnt(0)
v_mfma_f32_16x16x32_bf16 v[150:153], a[16:19], v[186:189], v[150:153]
v_mfma_f32_16x16x32_bf16 v[154:157], a[40:43], v[186:189], v[154:157]
v_mfma_f32_16x16x32_bf16 v[158:161], a[64:67], v[186:189], v[158:161]
ds_read_b128 v[114:117], v210 offset:22528
s_waitcnt lgkmcnt(0)
v_mfma_f32_16x16x32_bf16 v[138:141], a[8:11], v[114:117], v[138:141]
v_mfma_f32_16x16x32_bf16 v[142:145], a[32:35], v[114:117], v[142:145]
v_mfma_f32_16x16x32_bf16 v[146:149], a[56:59], v[114:117], v[146:149]
ds_read_b128 v[122:125], v210 offset:28672
s_waitcnt lgkmcnt(0)
v_mfma_f32_16x16x32_bf16 v[150:153], a[8:11], v[122:125], v[150:153]
v_mfma_f32_16x16x32_bf16 v[154:157], a[32:35], v[122:125], v[154:157]
v_mfma_f32_16x16x32_bf16 v[158:161], a[56:59], v[122:125], v[158:161]
ds_read_b128 v[182:185], v210 offset:23552
s_waitcnt lgkmcnt(0)
v_mfma_f32_16x16x32_bf16 v[138:141], a[12:15], v[182:185], v[138:141]
v_mfma_f32_16x16x32_bf16 v[142:145], a[36:39], v[182:185], v[142:145]
v_mfma_f32_16x16x32_bf16 v[146:149], a[60:63], v[182:185], v[146:149]
ds_read_b128 v[186:189], v210 offset:29696
s_waitcnt lgkmcnt(0)
v_mfma_f32_16x16x32_bf16 v[150:153], a[12:15], v[186:189], v[150:153]
v_mfma_f32_16x16x32_bf16 v[154:157], a[36:39], v[186:189], v[154:157]
v_mfma_f32_16x16x32_bf16 v[158:161], a[60:63], v[186:189], v[158:161]
ds_read_b128 v[114:117], v210 offset:25600
s_waitcnt lgkmcnt(0)
v_mfma_f32_16x16x32_bf16 v[138:141], a[20:23], v[114:117], v[138:141]
v_mfma_f32_16x16x32_bf16 v[142:145], a[44:47], v[114:117], v[142:145]
v_mfma_f32_16x16x32_bf16 v[146:149], a[68:71], v[114:117], v[146:149]
ds_read_b128 v[122:125], v210 offset:31744
s_waitcnt lgkmcnt(0)
v_mfma_f32_16x16x32_bf16 v[150:153], a[20:23], v[122:125], v[150:153]
v_mfma_f32_16x16x32_bf16 v[154:157], a[44:47], v[122:125], v[154:157]
v_mfma_f32_16x16x32_bf16 v[158:161], a[68:71], v[122:125], v[158:161]
v_cvt_pk_bf16_f32 v60, v138, v139
v_cvt_pk_bf16_f32 v61, v140, v141
v_cvt_pk_bf16_f32 v62, v142, v143
v_cvt_pk_bf16_f32 v63, v144, v145
v_cvt_pk_bf16_f32 v64, v146, v147
v_cvt_pk_bf16_f32 v65, v148, v149
v_cvt_pk_bf16_f32 v66, v150, v151
v_cvt_pk_bf16_f32 v67, v152, v153
v_cvt_pk_bf16_f32 v68, v154, v155
v_cvt_pk_bf16_f32 v69, v156, v157
v_cvt_pk_bf16_f32 v70, v158, v159
v_cvt_pk_bf16_f32 v71, v160, v161
ds_read_b128 v[182:185], v210 offset:20480
s_waitcnt lgkmcnt(0)
v_mfma_f32_16x16x32_bf16 v[162:165], a[216:219], v[182:185], 0
v_mfma_f32_16x16x32_bf16 v[166:169], a[240:243], v[182:185], 0
v_mfma_f32_16x16x32_bf16 v[170:173], v[232:235], v[182:185], 0
ds_read_b128 v[186:189], v210 offset:26624
s_waitcnt lgkmcnt(0)
v_mfma_f32_16x16x32_bf16 v[138:141], a[216:219], v[186:189], 0
v_mfma_f32_16x16x32_bf16 v[142:145], a[240:243], v[186:189], 0
v_mfma_f32_16x16x32_bf16 v[146:149], v[232:235], v[186:189], 0
ds_read_b128 v[114:117], v210 offset:21504
s_waitcnt lgkmcnt(0)
v_mfma_f32_16x16x32_bf16 v[162:165], a[220:223], v[114:117], v[162:165]
v_mfma_f32_16x16x32_bf16 v[166:169], a[244:247], v[114:117], v[166:169]
v_mfma_f32_16x16x32_bf16 v[170:173], v[236:239], v[114:117], v[170:173]
ds_read_b128 v[122:125], v210 offset:27648
s_waitcnt lgkmcnt(0)
v_mfma_f32_16x16x32_bf16 v[138:141], a[220:223], v[122:125], v[138:141]
v_mfma_f32_16x16x32_bf16 v[142:145], a[244:247], v[122:125], v[142:145]
v_mfma_f32_16x16x32_bf16 v[146:149], v[236:239], v[122:125], v[146:149]
ds_read_b128 v[182:185], v210 offset:24576
s_waitcnt lgkmcnt(0)
v_mfma_f32_16x16x32_bf16 v[162:165], a[232:235], v[182:185], v[162:165]
v_mfma_f32_16x16x32_bf16 v[166:169], v[224:227], v[182:185], v[166:169]
v_mfma_f32_16x16x32_bf16 v[170:173], v[248:251], v[182:185], v[170:173]
ds_read_b128 v[186:189], v210 offset:30720
s_waitcnt lgkmcnt(0)
v_mfma_f32_16x16x32_bf16 v[138:141], a[232:235], v[186:189], v[138:141]
v_mfma_f32_16x16x32_bf16 v[142:145], v[224:227], v[186:189], v[142:145]
v_mfma_f32_16x16x32_bf16 v[146:149], v[248:251], v[186:189], v[146:149]
ds_read_b128 v[114:117], v210 offset:22528
s_waitcnt lgkmcnt(0)
v_mfma_f32_16x16x32_bf16 v[162:165], a[224:227], v[114:117], v[162:165]
v_mfma_f32_16x16x32_bf16 v[166:169], a[248:251], v[114:117], v[166:169]
v_mfma_f32_16x16x32_bf16 v[170:173], v[240:243], v[114:117], v[170:173]
ds_read_b128 v[122:125], v210 offset:28672
s_waitcnt lgkmcnt(0)
v_mfma_f32_16x16x32_bf16 v[138:141], a[224:227], v[122:125], v[138:141]
v_mfma_f32_16x16x32_bf16 v[142:145], a[248:251], v[122:125], v[142:145]
v_mfma_f32_16x16x32_bf16 v[146:149], v[240:243], v[122:125], v[146:149]
ds_read_b128 v[182:185], v210 offset:23552
s_waitcnt lgkmcnt(0)
v_mfma_f32_16x16x32_bf16 v[162:165], a[228:231], v[182:185], v[162:165]
v_mfma_f32_16x16x32_bf16 v[166:169], a[252:255], v[182:185], v[166:169]
v_mfma_f32_16x16x32_bf16 v[170:173], v[244:247], v[182:185], v[170:173]
ds_read_b128 v[186:189], v210 offset:29696
s_waitcnt lgkmcnt(0)
v_mfma_f32_16x16x32_bf16 v[138:141], a[228:231], v[186:189], v[138:141]
v_mfma_f32_16x16x32_bf16 v[142:145], a[252:255], v[186:189], v[142:145]
v_mfma_f32_16x16x32_bf16 v[146:149], v[244:247], v[186:189], v[146:149]
ds_read_b128 v[114:117], v210 offset:25600
s_waitcnt lgkmcnt(0)
v_mfma_f32_16x16x32_bf16 v[162:165], a[236:239], v[114:117], v[162:165]
v_mfma_f32_16x16x32_bf16 v[166:169], v[228:231], v[114:117], v[166:169]
v_mfma_f32_16x16x32_bf16 v[170:173], v[252:255], v[114:117], v[170:173]
ds_read_b128 v[122:125], v210 offset:31744
s_waitcnt lgkmcnt(0)
v_mfma_f32_16x16x32_bf16 v[138:141], a[236:239], v[122:125], v[138:141]
v_mfma_f32_16x16x32_bf16 v[142:145], v[228:231], v[122:125], v[142:145]
v_mfma_f32_16x16x32_bf16 v[146:149], v[252:255], v[122:125], v[146:149]
v_cvt_pk_bf16_f32 v84, v162, v163
v_cvt_pk_bf16_f32 v85, v164, v165
v_cvt_pk_bf16_f32 v86, v166, v167
v_cvt_pk_bf16_f32 v87, v168, v169
v_cvt_pk_bf16_f32 v88, v170, v171
v_cvt_pk_bf16_f32 v89, v172, v173
v_cvt_pk_bf16_f32 v96, v138, v139
v_cvt_pk_bf16_f32 v97, v140, v141
v_cvt_pk_bf16_f32 v98, v142, v143
v_cvt_pk_bf16_f32 v99, v144, v145
v_cvt_pk_bf16_f32 v100, v146, v147
v_cvt_pk_bf16_f32 v101, v148, v149
ds_read_b128 v[182:185], v210 offset:20480
s_waitcnt lgkmcnt(0)
v_mfma_f32_16x16x32_bf16 v[150:153], a[72:75], v[182:185], 0
v_mfma_f32_16x16x32_bf16 v[154:157], a[96:99], v[182:185], 0
v_mfma_f32_16x16x32_bf16 v[158:161], a[120:123], v[182:185], 0
ds_read_b128 v[186:189], v210 offset:26624
s_waitcnt lgkmcnt(0)
v_mfma_f32_16x16x32_bf16 v[162:165], a[72:75], v[186:189], 0
v_mfma_f32_16x16x32_bf16 v[166:169], a[96:99], v[186:189], 0
v_mfma_f32_16x16x32_bf16 v[170:173], a[120:123], v[186:189], 0
ds_read_b128 v[114:117], v210 offset:21504
s_waitcnt lgkmcnt(0)
v_mfma_f32_16x16x32_bf16 v[150:153], a[76:79], v[114:117], v[150:153]
v_mfma_f32_16x16x32_bf16 v[154:157], a[100:103], v[114:117], v[154:157]
v_mfma_f32_16x16x32_bf16 v[158:161], a[124:127], v[114:117], v[158:161]
ds_read_b128 v[122:125], v210 offset:27648
s_waitcnt lgkmcnt(0)
v_mfma_f32_16x16x32_bf16 v[162:165], a[76:79], v[122:125], v[162:165]
v_mfma_f32_16x16x32_bf16 v[166:169], a[100:103], v[122:125], v[166:169]
v_mfma_f32_16x16x32_bf16 v[170:173], a[124:127], v[122:125], v[170:173]
ds_read_b128 v[182:185], v210 offset:24576
s_waitcnt lgkmcnt(0)
v_mfma_f32_16x16x32_bf16 v[150:153], a[88:91], v[182:185], v[150:153]
v_mfma_f32_16x16x32_bf16 v[154:157], a[112:115], v[182:185], v[154:157]
v_mfma_f32_16x16x32_bf16 v[158:161], a[136:139], v[182:185], v[158:161]
ds_read_b128 v[186:189], v210 offset:30720
s_waitcnt lgkmcnt(0)
v_mfma_f32_16x16x32_bf16 v[162:165], a[88:91], v[186:189], v[162:165]
v_mfma_f32_16x16x32_bf16 v[166:169], a[112:115], v[186:189], v[166:169]
v_mfma_f32_16x16x32_bf16 v[170:173], a[136:139], v[186:189], v[170:173]
ds_read_b128 v[114:117], v210 offset:22528
s_waitcnt lgkmcnt(0)
v_mfma_f32_16x16x32_bf16 v[150:153], a[80:83], v[114:117], v[150:153]
v_mfma_f32_16x16x32_bf16 v[154:157], a[104:107], v[114:117], v[154:157]
v_mfma_f32_16x16x32_bf16 v[158:161], a[128:131], v[114:117], v[158:161]
ds_read_b128 v[122:125], v210 offset:28672
s_waitcnt lgkmcnt(0)
v_mfma_f32_16x16x32_bf16 v[162:165], a[80:83], v[122:125], v[162:165]
v_mfma_f32_16x16x32_bf16 v[166:169], a[104:107], v[122:125], v[166:169]
v_mfma_f32_16x16x32_bf16 v[170:173], a[128:131], v[122:125], v[170:173]
ds_read_b128 v[182:185], v210 offset:23552
s_waitcnt lgkmcnt(0)
v_mfma_f32_16x16x32_bf16 v[150:153], a[84:87], v[182:185], v[150:153]
v_mfma_f32_16x16x32_bf16 v[154:157], a[108:111], v[182:185], v[154:157]
v_mfma_f32_16x16x32_bf16 v[158:161], a[132:135], v[182:185], v[158:161]
ds_read_b128 v[186:189], v210 offset:29696
s_waitcnt lgkmcnt(0)
v_mfma_f32_16x16x32_bf16 v[162:165], a[84:87], v[186:189], v[162:165]
v_mfma_f32_16x16x32_bf16 v[166:169], a[108:111], v[186:189], v[166:169]
v_mfma_f32_16x16x32_bf16 v[170:173], a[132:135], v[186:189], v[170:173]
ds_read_b128 v[114:117], v210 offset:25600
s_waitcnt lgkmcnt(0)
v_mfma_f32_16x16x32_bf16 v[150:153], a[92:95], v[114:117], v[150:153]
v_mfma_f32_16x16x32_bf16 v[154:157], a[116:119], v[114:117], v[154:157]
v_mfma_f32_16x16x32_bf16 v[158:161], a[140:143], v[114:117], v[158:161]
ds_read_b128 v[122:125], v210 offset:31744
s_waitcnt lgkmcnt(0)
v_mfma_f32_16x16x32_bf16 v[162:165], a[92:95], v[122:125], v[162:165]
v_mfma_f32_16x16x32_bf16 v[166:169], a[116:119], v[122:125], v[166:169]
v_mfma_f32_16x16x32_bf16 v[170:173], a[140:143], v[122:125], v[170:173]
v_cvt_pk_bf16_f32 v90, v150, v151
v_cvt_pk_bf16_f32 v91, v152, v153
v_cvt_pk_bf16_f32 v92, v154, v155
v_cvt_pk_bf16_f32 v93, v156, v157
v_cvt_pk_bf16_f32 v94, v158, v159
v_cvt_pk_bf16_f32 v95, v160, v161
v_cvt_pk_bf16_f32 v102, v162, v163
v_cvt_pk_bf16_f32 v103, v164, v165
v_cvt_pk_bf16_f32 v104, v166, v167
v_cvt_pk_bf16_f32 v105, v168, v169
v_cvt_pk_bf16_f32 v106, v170, v171
v_cvt_pk_bf16_f32 v107, v172, v173
s_barrier
ds_write_b128 v121, v[36:39]
ds_write_b128 v121, v[40:43] offset:64
ds_write_b128 v121, v[44:47] offset:128
ds_write_b128 v120, v[84:87]
ds_write_b64 v120, v[88:89] offset:16
ds_write_b128 v120, v[60:63] offset:512
ds_write_b64 v120, v[64:65] offset:528
ds_write_b128 v120, v[90:93] offset:1024
ds_write_b64 v120, v[94:95] offset:1040
s_mov_b64 exec, s[56:57]
ds_write_b128 v121, v[48:51] offset:12544
s_mov_b64 exec, -1
s_mov_b64 exec, s[56:57]
ds_write_b128 v121, v[52:55] offset:12608
s_mov_b64 exec, -1
s_mov_b64 exec, s[56:57]
ds_write_b128 v121, v[56:59] offset:12672
s_mov_b64 exec, -1
s_mov_b64 exec, s[56:57]
ds_write_b128 v120, v[96:99] offset:24832
s_mov_b64 exec, -1
s_mov_b64 exec, s[56:57]
ds_write_b64 v120, v[100:101] offset:24848
s_mov_b64 exec, -1
s_mov_b64 exec, s[56:57]
ds_write_b128 v120, v[66:69] offset:25344
s_mov_b64 exec, -1
s_mov_b64 exec, s[56:57]
ds_write_b64 v120, v[70:71] offset:25360
s_mov_b64 exec, -1
s_mov_b64 exec, s[56:57]
ds_write_b128 v120, v[102:105] offset:25856
s_mov_b64 exec, -1
s_mov_b64 exec, s[56:57]
ds_write_b64 v120, v[106:107] offset:25872
s_mov_b64 exec, -1
s_nop 0
s_barrier
s_mov_b32 s38, s36
ds_read_b128 v[174:177], v217
ds_read_b128 v[84:87], v200
s_waitcnt lgkmcnt(0)
v_mfma_f32_16x16x32_bf16 v[36:39], v[174:177], v[84:87], 0
ds_read_b128 v[92:95], v201
s_waitcnt lgkmcnt(0)
v_mfma_f32_16x16x32_bf16 v[48:51], v[174:177], v[92:95], 0
ds_read_b128 v[100:103], v202
s_waitcnt lgkmcnt(0)
v_mfma_f32_16x16x32_bf16 v[60:63], v[174:177], v[100:103], 0
ds_read_b128 v[178:181], v217 offset:528
ds_read_b128 v[84:87], v194
ds_read_b128 v[88:91], v194 offset:16
s_waitcnt lgkmcnt(0)
v_smfmac_f32_16x16x64_bf16 v[36:39], v[178:181], v[84:91], v213
ds_read_b128 v[92:95], v195
ds_read_b128 v[96:99], v195 offset:16
s_waitcnt lgkmcnt(0)
v_smfmac_f32_16x16x64_bf16 v[48:51], v[178:181], v[92:99], v213
ds_read_b128 v[100:103], v196
ds_read_b128 v[104:107], v196 offset:16
s_waitcnt lgkmcnt(0)
v_smfmac_f32_16x16x64_bf16 v[60:63], v[178:181], v[100:107], v213
ds_read_b128 v[174:177], v217 offset:1056
ds_read_b128 v[84:87], v197
ds_read_b128 v[88:91], v197 offset:16
s_waitcnt lgkmcnt(0)
v_smfmac_f32_16x16x64_bf16 v[36:39], v[174:177], v[84:91], v213
ds_read_b128 v[92:95], v198
ds_read_b128 v[96:99], v198 offset:16
s_waitcnt lgkmcnt(0)
v_smfmac_f32_16x16x64_bf16 v[48:51], v[174:177], v[92:99], v213
ds_read_b128 v[100:103], v199
ds_read_b128 v[104:107], v199 offset:16
s_waitcnt lgkmcnt(0)
v_smfmac_f32_16x16x64_bf16 v[60:63], v[174:177], v[100:107], v213
ds_read_b128 v[178:181], v217 offset:1584
ds_read_b128 v[84:87], v200 offset:32
s_waitcnt lgkmcnt(0)
v_mfma_f32_16x16x32_bf16 v[40:43], v[178:181], v[84:87], 0
ds_read_b128 v[92:95], v201 offset:32
s_waitcnt lgkmcnt(0)
v_mfma_f32_16x16x32_bf16 v[52:55], v[178:181], v[92:95], 0
ds_read_b128 v[100:103], v202 offset:32
s_waitcnt lgkmcnt(0)
v_mfma_f32_16x16x32_bf16 v[64:67], v[178:181], v[100:103], 0
ds_read_b128 v[174:177], v217 offset:2112
ds_read_b128 v[84:87], v194 offset:32
ds_read_b128 v[88:91], v194 offset:48
s_waitcnt lgkmcnt(0)
v_smfmac_f32_16x16x64_bf16 v[40:43], v[174:177], v[84:91], v213
ds_read_b128 v[92:95], v195 offset:32
ds_read_b128 v[96:99], v195 offset:48
s_waitcnt lgkmcnt(0)
v_smfmac_f32_16x16x64_bf16 v[52:55], v[174:177], v[92:99], v213
ds_read_b128 v[100:103], v196 offset:32
ds_read_b128 v[104:107], v196 offset:48
s_waitcnt lgkmcnt(0)
v_smfmac_f32_16x16x64_bf16 v[64:67], v[174:177], v[100:107], v213
ds_read_b128 v[178:181], v217 offset:2640
ds_read_b128 v[84:87], v197 offset:32
ds_read_b128 v[88:91], v197 offset:48
s_waitcnt lgkmcnt(0)
v_smfmac_f32_16x16x64_bf16 v[40:43], v[178:181], v[84:91], v213
ds_read_b128 v[92:95], v198 offset:32
ds_read_b128 v[96:99], v198 offset:48
s_waitcnt lgkmcnt(0)
v_smfmac_f32_16x16x64_bf16 v[52:55], v[178:181], v[92:99], v213
ds_read_b128 v[100:103], v199 offset:32
ds_read_b128 v[104:107], v199 offset:48
s_waitcnt lgkmcnt(0)
v_smfmac_f32_16x16x64_bf16 v[64:67], v[178:181], v[100:107], v213
ds_read_b128 v[174:177], v217 offset:3168
ds_read_b128 v[84:87], v200 offset:64
s_waitcnt lgkmcnt(0)
v_mfma_f32_16x16x32_bf16 v[44:47], v[174:177], v[84:87], 0
ds_read_b128 v[92:95], v201 offset:64
s_waitcnt lgkmcnt(0)
v_mfma_f32_16x16x32_bf16 v[56:59], v[174:177], v[92:95], 0
ds_read_b128 v[100:103], v202 offset:64
s_waitcnt lgkmcnt(0)
v_mfma_f32_16x16x32_bf16 v[68:71], v[174:177], v[100:103], 0
ds_read_b128 v[178:181], v217 offset:3696
ds_read_b128 v[84:87], v194 offset:64
ds_read_b128 v[88:91], v194 offset:80
s_waitcnt lgkmcnt(0)
v_smfmac_f32_16x16x64_bf16 v[44:47], v[178:181], v[84:91], v213
ds_read_b128 v[92:95], v195 offset:64
ds_read_b128 v[96:99], v195 offset:80
s_waitcnt lgkmcnt(0)
v_smfmac_f32_16x16x64_bf16 v[56:59], v[178:181], v[92:99], v213
ds_read_b128 v[100:103], v196 offset:64
ds_read_b128 v[104:107], v196 offset:80
s_waitcnt lgkmcnt(0)
v_smfmac_f32_16x16x64_bf16 v[68:71], v[178:181], v[100:107], v213
ds_read_b128 v[174:177], v217 offset:4224
ds_read_b128 v[84:87], v197 offset:64
ds_read_b128 v[88:91], v197 offset:80
s_waitcnt lgkmcnt(0)
v_smfmac_f32_16x16x64_bf16 v[44:47], v[174:177], v[84:91], v213
ds_read_b128 v[92:95], v198 offset:64
ds_read_b128 v[96:99], v198 offset:80
s_waitcnt lgkmcnt(0)
v_smfmac_f32_16x16x64_bf16 v[56:59], v[174:177], v[92:99], v213
ds_read_b128 v[100:103], v199 offset:64
ds_read_b128 v[104:107], v199 offset:80
s_waitcnt lgkmcnt(0)
v_smfmac_f32_16x16x64_bf16 v[68:71], v[174:177], v[100:107], v213
v_add_f32 v118, v36, v37
v_mul_f32 v119, v36, v36
v_add_f32 v118, v118, v38
v_fmac_f32 v119, v37, v37
v_add_f32 v118, v118, v39
v_fmac_f32 v119, v38, v38
v_fmac_f32 v119, v39, v39
v_add_f32 v126, v48, v49
v_mul_f32 v127, v48, v48
v_add_f32 v126, v126, v50
v_fmac_f32 v127, v49, v49
v_add_f32 v126, v126, v51
v_fmac_f32 v127, v50, v50
v_fmac_f32 v127, v51, v51
v_add_f32 v134, v60, v61
v_mul_f32 v135, v60, v60
v_add_f32 v134, v134, v62
v_fmac_f32 v135, v61, v61
v_add_f32 v134, v134, v63
v_fmac_f32 v135, v62, v62
v_fmac_f32 v135, v63, v63
v_add_f32 v118, v118, v40
v_fmac_f32 v119, v40, v40
v_add_f32 v118, v118, v41
v_fmac_f32 v119, v41, v41
v_add_f32 v118, v118, v42
v_fmac_f32 v119, v42, v42
v_add_f32 v118, v118, v43
v_fmac_f32 v119, v43, v43
v_add_f32 v126, v126, v52
v_fmac_f32 v127, v52, v52
v_add_f32 v126, v126, v53
v_fmac_f32 v127, v53, v53
v_add_f32 v126, v126, v54
v_fmac_f32 v127, v54, v54
v_add_f32 v126, v126, v55
v_fmac_f32 v127, v55, v55
v_add_f32 v134, v134, v64
v_fmac_f32 v135, v64, v64
v_add_f32 v134, v134, v65
v_fmac_f32 v135, v65, v65
v_add_f32 v134, v134, v66
v_fmac_f32 v135, v66, v66
v_add_f32 v134, v134, v67
v_fmac_f32 v135, v67, v67
v_add_f32 v118, v118, v44
v_fmac_f32 v119, v44, v44
v_add_f32 v118, v118, v45
v_fmac_f32 v119, v45, v45
v_add_f32 v118, v118, v46
v_fmac_f32 v119, v46, v46
v_add_f32 v118, v118, v47
v_fmac_f32 v119, v47, v47
v_add_f32 v126, v126, v56
v_fmac_f32 v127, v56, v56
v_add_f32 v126, v126, v57
v_fmac_f32 v127, v57, v57
v_add_f32 v126, v126, v58
v_fmac_f32 v127, v58, v58
v_add_f32 v126, v126, v59
v_fmac_f32 v127, v59, v59
v_add_f32 v134, v134, v68
v_fmac_f32 v135, v68, v68
v_add_f32 v134, v134, v69
v_fmac_f32 v135, v69, v69
v_add_f32 v134, v134, v70
v_fmac_f32 v135, v70, v70
v_add_f32 v134, v134, v71
v_fmac_f32 v135, v71, v71
v_permlane16_swap_b32 v118, v119
v_add_f32 v118, v118, v119
v_permlane16_swap_b32 v126, v127
v_add_f32 v126, v126, v127
v_permlane16_swap_b32 v134, v135
v_add_f32 v134, v134, v135
v_permlane32_swap_b32 v118, v126
v_add_f32 v118, v118, v126
ds_write_b32 v209, v118
v_mov_b32 v135, v134
s_nop 1
v_permlane32_swap_b32 v134, v135
v_add_f32 v134, v134, v135
ds_write_b32 v209, v134 offset:512
s_waitcnt lgkmcnt(0)
s_barrier
s_mul_hi_u32 s41, s35, 58835169
s_mul_i32 s42, s41, 73
s_sub_u32 s42, s35, s42
s_mul_i32 s43, s41, 1373568
s_mul_i32 s51, s42, 2688
s_add_u32 s43, s43, s51
s_cmp_lt_u32 s35, s34
s_cselect_b32 s50, s43, 1879048192
s_add_u32 s35, s35, 32
s_cmp_eq_u32 s42, 0
s_cselect_b32 s44, 536870911, s72
s_cmp_eq_u32 s42, 72
s_cselect_b32 s44, 939524095, s44
s_cmp_eq_u32 s41, 0
s_cselect_b32 s52, 1879048192, s50
s_mov_b32 s36, s50
v_and_b32 v216, s44, v208
s_add_u32 m0, s45, 0
s_nop 0
buffer_load_dwordx4 v216, s[4:7], s52 offen nt lds
s_add_u32 m0, s45, 4112
s_add_u32 s40, s36, 196224
buffer_load_dwordx4 v216, s[4:7], s40 offen nt lds
s_add_u32 m0, s45, 8224
s_add_u32 s40, s36, 392448
buffer_load_dwordx4 v216, s[4:7], s40 offen nt lds
s_add_u32 m0, s45, 12336
s_add_u32 s40, s36, 588672
buffer_load_dwordx4 v216, s[4:7], s40 offen nt lds
s_add_u32 m0, s45, 16448
s_add_u32 s40, s36, 784896
buffer_load_dwordx4 v216, s[4:7], s40 offen nt lds
s_add_u32 m0, s45, 20560
s_add_u32 s40, s36, 981120
buffer_load_dwordx4 v216, s[4:7], s40 offen nt lds
s_add_u32 m0, s45, 24672
s_add_u32 s40, s36, 1177344
buffer_load_dwordx4 v216, s[4:7], s40 offen nt lds
s_add_u32 m0, s45, 28784
s_add_u32 s40, s36, 1373568
buffer_load_dwordx4 v216, s[4:7], s40 offen nt lds
s_add_u32 m0, s45, 32896
s_add_u32 s40, s36, 1569792
buffer_load_dwordx4 v216, s[4:7], s40 offen nt lds
ds_read_b128 v[182:185], v210
ds_read_b128 v[186:189], v210 offset:1024
s_waitcnt lgkmcnt(1)
v_mfma_f32_16x16x32_bf16 v[138:141], a[0:3], v[182:185], 0
s_waitcnt lgkmcnt(0)
v_mfma_f32_16x16x32_bf16 v[138:141], a[4:7], v[186:189], v[138:141]
v_mfma_f32_16x16x32_bf16 v[142:145], a[24:27], v[182:185], 0
v_mfma_f32_16x16x32_bf16 v[142:145], a[28:31], v[186:189], v[142:145]
v_mfma_f32_16x16x32_bf16 v[146:149], a[48:51], v[182:185], 0
v_mfma_f32_16x16x32_bf16 v[146:149], a[52:55], v[186:189], v[146:149]
v_mfma_f32_16x16x32_bf16 v[150:153], a[216:219], v[182:185], 0
v_mfma_f32_16x16x32_bf16 v[150:153], a[220:223], v[186:189], v[150:153]
v_mfma_f32_16x16x32_bf16 v[154:157], a[240:243], v[182:185], 0
v_mfma_f32_16x16x32_bf16 v[154:157], a[244:247], v[186:189], v[154:157]
v_mfma_f32_16x16x32_bf16 v[158:161], v[232:235], v[182:185], 0
v_mfma_f32_16x16x32_bf16 v[158:161], v[236:239], v[186:189], v[158:161]
v_mfma_f32_16x16x32_bf16 v[162:165], v[182:185], a[72:75], 0
v_mfma_f32_16x16x32_bf16 v[162:165], v[186:189], a[76:79], v[162:165]
v_mfma_f32_16x16x32_bf16 v[166:169], v[182:185], a[96:99], 0
v_mfma_f32_16x16x32_bf16 v[166:169], v[186:189], a[100:103], v[166:169]
v_mfma_f32_16x16x32_bf16 v[170:173], v[182:185], a[120:123], 0
v_mfma_f32_16x16x32_bf16 v[170:173], v[186:189], a[124:127], v[170:173]
ds_read_b128 v[110:113], v210 offset:2048
ds_read_b128 v[220:223], v210 offset:3072
s_waitcnt lgkmcnt(1)
v_mfma_f32_16x16x32_bf16 v[138:141], a[8:11], v[110:113], v[138:141]
s_waitcnt lgkmcnt(0)
v_mfma_f32_16x16x32_bf16 v[138:141], a[12:15], v[220:223], v[138:141]
v_mfma_f32_16x16x32_bf16 v[142:145], a[32:35], v[110:113], v[142:145]
v_mfma_f32_16x16x32_bf16 v[142:145], a[36:39], v[220:223], v[142:145]
v_mfma_f32_16x16x32_bf16 v[146:149], a[56:59], v[110:113], v[146:149]
v_mfma_f32_16x16x32_bf16 v[146:149], a[60:63], v[220:223], v[146:149]
v_mfma_f32_16x16x32_bf16 v[150:153], a[224:227], v[110:113], v[150:153]
v_mfma_f32_16x16x32_bf16 v[150:153], a[228:231], v[220:223], v[150:153]
v_mfma_f32_16x16x32_bf16 v[154:157], a[248:251], v[110:113], v[154:157]
v_mfma_f32_16x16x32_bf16 v[154:157], a[252:255], v[220:223], v[154:157]
v_mfma_f32_16x16x32_bf16 v[158:161], v[240:243], v[110:113], v[158:161]
v_mfma_f32_16x16x32_bf16 v[158:161], v[244:247], v[220:223], v[158:161]
v_mfma_f32_16x16x32_bf16 v[162:165], v[110:113], a[80:83], v[162:165]
v_mfma_f32_16x16x32_bf16 v[162:165], v[220:223], a[84:87], v[162:165]
v_mfma_f32_16x16x32_bf16 v[166:169], v[110:113], a[104:107], v[166:169]
v_mfma_f32_16x16x32_bf16 v[166:169], v[220:223], a[108:111], v[166:169]
v_mfma_f32_16x16x32_bf16 v[170:173], v[110:113], a[128:131], v[170:173]
v_mfma_f32_16x16x32_bf16 v[170:173], v[220:223], a[132:135], v[170:173]
ds_read_b128 v[182:185], v210 offset:4096
ds_read_b128 v[186:189], v210 offset:5120
s_waitcnt lgkmcnt(1)
v_mfma_f32_16x16x32_bf16 v[138:141], a[16:19], v[182:185], v[138:141]
s_waitcnt lgkmcnt(0)
v_mfma_f32_16x16x32_bf16 v[138:141], a[20:23], v[186:189], v[138:141]
v_mfma_f32_16x16x32_bf16 v[142:145], a[40:43], v[182:185], v[142:145]
v_mfma_f32_16x16x32_bf16 v[142:145], a[44:47], v[186:189], v[142:145]
v_mfma_f32_16x16x32_bf16 v[146:149], a[64:67], v[182:185], v[146:149]
v_mfma_f32_16x16x32_bf16 v[146:149], a[68:71], v[186:189], v[146:149]
v_mfma_f32_16x16x32_bf16 v[150:153], a[232:235], v[182:185], v[150:153]
v_mfma_f32_16x16x32_bf16 v[150:153], a[236:239], v[186:189], v[150:153]
v_mfma_f32_16x16x32_bf16 v[154:157], v[224:227], v[182:185], v[154:157]
v_mfma_f32_16x16x32_bf16 v[154:157], v[228:231], v[186:189], v[154:157]
v_mfma_f32_16x16x32_bf16 v[158:161], v[248:251], v[182:185], v[158:161]
v_mfma_f32_16x16x32_bf16 v[158:161], v[252:255], v[186:189], v[158:161]
v_mfma_f32_16x16x32_bf16 v[162:165], v[182:185], a[88:91], v[162:165]
v_mfma_f32_16x16x32_bf16 v[162:165], v[186:189], a[92:95], v[162:165]
v_mfma_f32_16x16x32_bf16 v[166:169], v[182:185], a[112:115], v[166:169]
v_mfma_f32_16x16x32_bf16 v[166:169], v[186:189], a[116:119], v[166:169]
v_mfma_f32_16x16x32_bf16 v[170:173], v[182:185], a[136:139], v[170:173]
v_mfma_f32_16x16x32_bf16 v[170:173], v[186:189], a[140:143], v[170:173]
v_cvt_pk_bf16_f32 v78, v138, v139
v_cvt_pk_bf16_f32 v79, v140, v141
v_cvt_pk_bf16_f32 v80, v142, v143
v_cvt_pk_bf16_f32 v81, v144, v145
v_cvt_pk_bf16_f32 v82, v146, v147
v_cvt_pk_bf16_f32 v83, v148, v149
v_cvt_pk_bf16_f32 v72, v150, v151
v_cvt_pk_bf16_f32 v73, v152, v153
v_cvt_pk_bf16_f32 v74, v154, v155
v_cvt_pk_bf16_f32 v75, v156, v157
v_cvt_pk_bf16_f32 v76, v158, v159
v_cvt_pk_bf16_f32 v77, v160, v161
v_cvt_pk_bf16_f32 v114, v162, v163
v_cvt_pk_bf16_f32 v115, v164, v165
v_cvt_pk_bf16_f32 v122, v166, v167
v_cvt_pk_bf16_f32 v123, v168, v169
v_cvt_pk_bf16_f32 v130, v170, v171
v_cvt_pk_bf16_f32 v131, v172, v173
ds_read_b128 v[110:113], v210 offset:6144
ds_read_b128 v[220:223], v210 offset:7168
s_waitcnt lgkmcnt(1)
v_mfma_f32_16x16x32_bf16 v[138:141], a[0:3], v[110:113], 0
s_waitcnt lgkmcnt(0)
v_mfma_f32_16x16x32_bf16 v[138:141], a[4:7], v[220:223], v[138:141]
v_mfma_f32_16x16x32_bf16 v[142:145], a[24:27], v[110:113], 0
v_mfma_f32_16x16x32_bf16 v[142:145], a[28:31], v[220:223], v[142:145]
v_mfma_f32_16x16x32_bf16 v[146:149], a[48:51], v[110:113], 0
v_mfma_f32_16x16x32_bf16 v[146:149], a[52:55], v[220:223], v[146:149]
v_mfma_f32_16x16x32_bf16 v[150:153], a[216:219], v[110:113], 0
v_mfma_f32_16x16x32_bf16 v[150:153], a[220:223], v[220:223], v[150:153]
v_mfma_f32_16x16x32_bf16 v[154:157], a[240:243], v[110:113], 0
v_mfma_f32_16x16x32_bf16 v[154:157], a[244:247], v[220:223], v[154:157]
v_mfma_f32_16x16x32_bf16 v[158:161], v[232:235], v[110:113], 0
v_mfma_f32_16x16x32_bf16 v[158:161], v[236:239], v[220:223], v[158:161]
v_mfma_f32_16x16x32_bf16 v[162:165], v[110:113], a[72:75], 0
v_mfma_f32_16x16x32_bf16 v[162:165], v[220:223], a[76:79], v[162:165]
v_mfma_f32_16x16x32_bf16 v[166:169], v[110:113], a[96:99], 0
v_mfma_f32_16x16x32_bf16 v[166:169], v[220:223], a[100:103], v[166:169]
v_mfma_f32_16x16x32_bf16 v[170:173], v[110:113], a[120:123], 0
v_mfma_f32_16x16x32_bf16 v[170:173], v[220:223], a[124:127], v[170:173]
ds_read_b128 v[102:105], v210 offset:18432
ds_read_b128 v[106:109], v210 offset:19456
s_waitcnt lgkmcnt(1)
v_add_f32 v102, v102, v103
s_waitcnt lgkmcnt(0)
v_add_f32 v106, v106, v107
v_add_f32 v104, v104, v105
v_add_f32 v108, v108, v109
v_add_f32 v102, v102, v104
v_add_f32 v106, v106, v108
v_mul_f32 v103, s48, v102
v_mul_f32 v104, s73, v102
v_mul_f32 v106, s73, v106
v_fma_f32 v106, -v103, v104, v106
v_max_f32 v106, 0, v106
v_add_f32 v106, s49, v106
v_rsq_f32 v102, v106
s_nop 0
v_mul_f32_e64 v103, -v103, v102
ds_write_b64 v211, v[102:103] offset:20480
ds_read_b64 v[118:119], v219 offset:20480
ds_read_b64 v[126:127], v219 offset:20736
ds_read_b64 v[134:135], v219 offset:20992
s_waitcnt lgkmcnt(2)
v_fma_f32 v220, v36, v118, v119
v_fma_f32 v221, v37, v118, v119
v_cvt_pk_bf16_f32 v90, v220, v221
v_fma_f32 v222, v38, v118, v119
v_fma_f32 v223, v39, v118, v119
v_cvt_pk_bf16_f32 v91, v222, v223
v_fma_f32 v220, v40, v118, v119
v_fma_f32 v221, v41, v118, v119
v_cvt_pk_bf16_f32 v92, v220, v221
v_fma_f32 v222, v42, v118, v119
v_fma_f32 v223, v43, v118, v119
v_cvt_pk_bf16_f32 v93, v222, v223
ds_write_b128 v211, v[90:93] offset:20480
v_fma_f32 v220, v44, v118, v119
v_fma_f32 v221, v45, v118, v119
v_cvt_pk_bf16_f32 v94, v220, v221
v_fma_f32 v222, v46, v118, v119
v_fma_f32 v223, v47, v118, v119
v_cvt_pk_bf16_f32 v95, v222, v223
s_waitcnt lgkmcnt(2)
ds_write_b64 v212, v[94:95] offset:20480
v_fma_f32 v220, v48, v126, v127
v_fma_f32 v221, v49, v126, v127
v_cvt_pk_bf16_f32 v174, v220, v221
v_fma_f32 v222, v50, v126, v127
v_fma_f32 v223, v51, v126, v127
v_cvt_pk_bf16_f32 v175, v222, v223
v_fma_f32 v220, v52, v126, v127
v_fma_f32 v221, v53, v126, v127
v_cvt_pk_bf16_f32 v176, v220, v221
v_fma_f32 v222, v54, v126, v127
v_fma_f32 v223, v55, v126, v127
v_cvt_pk_bf16_f32 v177, v222, v223
ds_write_b128 v211, v[174:177] offset:26624
v_fma_f32 v220, v56, v126, v127
v_fma_f32 v221, v57, v126, v127
v_cvt_pk_bf16_f32 v178, v220, v221
v_fma_f32 v222, v58, v126, v127
v_fma_f32 v223, v59, v126, v127
v_cvt_pk_bf16_f32 v179, v222, v223
s_waitcnt lgkmcnt(3)
ds_write_b64 v212, v[178:179] offset:26624
v_fma_f32 v220, v60, v134, v135
v_fma_f32 v221, v61, v134, v135
v_cvt_pk_bf16_f32 v90, v220, v221
v_fma_f32 v222, v62, v134, v135
v_fma_f32 v223, v63, v134, v135
v_cvt_pk_bf16_f32 v91, v222, v223
v_fma_f32 v220, v64, v134, v135
v_fma_f32 v221, v65, v134, v135
v_cvt_pk_bf16_f32 v92, v220, v221
v_fma_f32 v222, v66, v134, v135
v_fma_f32 v223, v67, v134, v135
v_cvt_pk_bf16_f32 v93, v222, v223
ds_write_b128 v211, v[90:93] offset:32768
v_fma_f32 v220, v68, v134, v135
v_fma_f32 v221, v69, v134, v135
v_cvt_pk_bf16_f32 v94, v220, v221
v_fma_f32 v222, v70, v134, v135
v_fma_f32 v223, v71, v134, v135
v_cvt_pk_bf16_f32 v95, v222, v223
ds_write_b64 v212, v[94:95] offset:32768
ds_read_b128 v[182:185], v210 offset:8192
ds_read_b128 v[186:189], v210 offset:9216
s_waitcnt lgkmcnt(1)
v_mfma_f32_16x16x32_bf16 v[138:141], a[8:11], v[182:185], v[138:141]
s_waitcnt lgkmcnt(0)
v_mfma_f32_16x16x32_bf16 v[138:141], a[12:15], v[186:189], v[138:141]
v_mfma_f32_16x16x32_bf16 v[142:145], a[32:35], v[182:185], v[142:145]
v_mfma_f32_16x16x32_bf16 v[142:145], a[36:39], v[186:189], v[142:145]
v_mfma_f32_16x16x32_bf16 v[146:149], a[56:59], v[182:185], v[146:149]
v_mfma_f32_16x16x32_bf16 v[146:149], a[60:63], v[186:189], v[146:149]
v_mfma_f32_16x16x32_bf16 v[150:153], a[224:227], v[182:185], v[150:153]
v_mfma_f32_16x16x32_bf16 v[150:153], a[228:231], v[186:189], v[150:153]
v_mfma_f32_16x16x32_bf16 v[154:157], a[248:251], v[182:185], v[154:157]
v_mfma_f32_16x16x32_bf16 v[154:157], a[252:255], v[186:189], v[154:157]
v_mfma_f32_16x16x32_bf16 v[158:161], v[240:243], v[182:185], v[158:161]
v_mfma_f32_16x16x32_bf16 v[158:161], v[244:247], v[186:189], v[158:161]
v_mfma_f32_16x16x32_bf16 v[162:165], v[182:185], a[80:83], v[162:165]
v_mfma_f32_16x16x32_bf16 v[162:165], v[186:189], a[84:87], v[162:165]
v_mfma_f32_16x16x32_bf16 v[166:169], v[182:185], a[104:107], v[166:169]
v_mfma_f32_16x16x32_bf16 v[166:169], v[186:189], a[108:111], v[166:169]
v_mfma_f32_16x16x32_bf16 v[170:173], v[182:185], a[128:131], v[170:173]
v_mfma_f32_16x16x32_bf16 v[170:173], v[186:189], a[132:135], v[170:173]
ds_read_b128 v[110:113], v210 offset:10240
ds_read_b128 v[106:109], v210 offset:11264
s_waitcnt lgkmcnt(1)
v_mfma_f32_16x16x32_bf16 v[138:141], a[16:19], v[110:113], v[138:141]
s_waitcnt lgkmcnt(0)
v_mfma_f32_16x16x32_bf16 v[138:141], a[20:23], v[106:109], v[138:141]
v_mfma_f32_16x16x32_bf16 v[142:145], a[40:43], v[110:113], v[142:145]
v_mfma_f32_16x16x32_bf16 v[142:145], a[44:47], v[106:109], v[142:145]
v_mfma_f32_16x16x32_bf16 v[146:149], a[64:67], v[110:113], v[146:149]
v_mfma_f32_16x16x32_bf16 v[146:149], a[68:71], v[106:109], v[146:149]
v_mfma_f32_16x16x32_bf16 v[150:153], a[232:235], v[110:113], v[150:153]
v_mfma_f32_16x16x32_bf16 v[150:153], a[236:239], v[106:109], v[150:153]
v_mfma_f32_16x16x32_bf16 v[154:157], v[224:227], v[110:113], v[154:157]
v_mfma_f32_16x16x32_bf16 v[154:157], v[228:231], v[106:109], v[154:157]
v_mfma_f32_16x16x32_bf16 v[158:161], v[248:251], v[110:113], v[158:161]
v_mfma_f32_16x16x32_bf16 v[158:161], v[252:255], v[106:109], v[158:161]
v_mfma_f32_16x16x32_bf16 v[162:165], v[110:113], a[88:91], v[162:165]
v_mfma_f32_16x16x32_bf16 v[162:165], v[106:109], a[92:95], v[162:165]
v_mfma_f32_16x16x32_bf16 v[166:169], v[110:113], a[112:115], v[166:169]
v_mfma_f32_16x16x32_bf16 v[166:169], v[106:109], a[116:119], v[166:169]
v_mfma_f32_16x16x32_bf16 v[170:173], v[110:113], a[136:139], v[170:173]
v_mfma_f32_16x16x32_bf16 v[170:173], v[106:109], a[140:143], v[170:173]
v_cvt_pk_bf16_f32 v96, v138, v139
v_cvt_pk_bf16_f32 v97, v140, v141
v_cvt_pk_bf16_f32 v98, v142, v143
v_cvt_pk_bf16_f32 v99, v144, v145
v_cvt_pk_bf16_f32 v100, v146, v147
v_cvt_pk_bf16_f32 v101, v148, v149
v_cvt_pk_bf16_f32 v84, v150, v151
v_cvt_pk_bf16_f32 v85, v152, v153
v_cvt_pk_bf16_f32 v86, v154, v155
v_cvt_pk_bf16_f32 v87, v156, v157
v_cvt_pk_bf16_f32 v88, v158, v159
v_cvt_pk_bf16_f32 v89, v160, v161
v_cvt_pk_bf16_f32 v116, v162, v163
v_cvt_pk_bf16_f32 v117, v164, v165
v_cvt_pk_bf16_f32 v124, v166, v167
v_cvt_pk_bf16_f32 v125, v168, v169
v_cvt_pk_bf16_f32 v132, v170, v171
v_cvt_pk_bf16_f32 v133, v172, v173
ds_read_b128 v[182:185], v210 offset:12288
ds_read_b128 v[186:189], v210 offset:13312
s_waitcnt lgkmcnt(1)
v_mfma_f32_16x16x32_bf16 v[138:141], a[0:3], v[182:185], 0
s_waitcnt lgkmcnt(0)
v_mfma_f32_16x16x32_bf16 v[138:141], a[4:7], v[186:189], v[138:141]
v_mfma_f32_16x16x32_bf16 v[142:145], a[24:27], v[182:185], 0
v_mfma_f32_16x16x32_bf16 v[142:145], a[28:31], v[186:189], v[142:145]
v_mfma_f32_16x16x32_bf16 v[146:149], a[48:51], v[182:185], 0
v_mfma_f32_16x16x32_bf16 v[146:149], a[52:55], v[186:189], v[146:149]
ds_read_b128 v[170:173], v210 offset:14336
ds_read_b128 v[182:185], v210 offset:15360
s_waitcnt lgkmcnt(1)
v_mfma_f32_16x16x32_bf16 v[138:141], a[8:11], v[170:173], v[138:141]
s_waitcnt lgkmcnt(0)
v_mfma_f32_16x16x32_bf16 v[138:141], a[12:15], v[182:185], v[138:141]
v_mfma_f32_16x16x32_bf16 v[142:145], a[32:35], v[170:173], v[142:145]
v_mfma_f32_16x16x32_bf16 v[142:145], a[36:39], v[182:185], v[142:145]
v_mfma_f32_16x16x32_bf16 v[146:149], a[56:59], v[170:173], v[146:149]
v_mfma_f32_16x16x32_bf16 v[146:149], a[60:63], v[182:185], v[146:149]
ds_read_b128 v[186:189], v210 offset:16384
ds_read_b128 v[170:173], v210 offset:17408
s_waitcnt lgkmcnt(1)
v_mfma_f32_16x16x32_bf16 v[138:141], a[16:19], v[186:189], v[138:141]
s_waitcnt lgkmcnt(0)
v_mfma_f32_16x16x32_bf16 v[138:141], a[20:23], v[170:173], v[138:141]
v_mfma_f32_16x16x32_bf16 v[142:145], a[40:43], v[186:189], v[142:145]
v_mfma_f32_16x16x32_bf16 v[142:145], a[44:47], v[170:173], v[142:145]
v_mfma_f32_16x16x32_bf16 v[146:149], a[64:67], v[186:189], v[146:149]
v_mfma_f32_16x16x32_bf16 v[146:149], a[68:71], v[170:173], v[146:149]
v_cvt_pk_bf16_f32 v102, v138, v139
v_cvt_pk_bf16_f32 v103, v140, v141
v_cvt_pk_bf16_f32 v104, v142, v143
v_cvt_pk_bf16_f32 v105, v144, v145
s_nop 2
v_cvt_pk_bf16_f32 v106, v146, v147
v_cvt_pk_bf16_f32 v107, v148, v149
ds_read_b128 v[108:111], v215 offset:512
ds_read_b64 v[112:113], v215 offset:528
v_mfma_f32_16x16x16_bf16 v[138:141], v[82:83], v[76:77], 0
v_mfma_f32_16x16x16_bf16 v[142:145], v[100:101], v[76:77], 0
s_waitcnt lgkmcnt(0)
v_mfma_f32_16x16x16_bf16 v[150:153], v[112:113], v[76:77], v[206:209]
v_mfma_f32_16x16x16_bf16 v[146:149], v[106:107], v[76:77], 0
v_mfma_f32_16x16x32_bf16 v[138:141], v[78:81], v[72:75], v[138:141]
v_mfma_f32_16x16x32_bf16 v[142:145], v[96:99], v[72:75], v[142:145]
v_mfma_f32_16x16x32_bf16 v[150:153], v[108:111], v[72:75], v[150:153]
v_mfma_f32_16x16x32_bf16 v[146:149], v[102:105], v[72:75], v[146:149]
ds_read_b128 v[72:75], v215
ds_read_b64 v[76:77], v215 offset:16
v_mfma_f32_16x16x16_bf16 v[154:157], v[82:83], v[88:89], 0
v_mfma_f32_16x16x16_bf16 v[158:161], v[100:101], v[88:89], 0
v_mfma_f32_16x16x16_bf16 v[166:169], v[112:113], v[88:89], v[206:209]
v_mfma_f32_16x16x16_bf16 v[162:165], v[106:107], v[88:89], 0
v_mfma_f32_16x16x32_bf16 v[154:157], v[78:81], v[84:87], v[154:157]
v_mfma_f32_16x16x32_bf16 v[158:161], v[96:99], v[84:87], v[158:161]
v_mfma_f32_16x16x32_bf16 v[166:169], v[108:111], v[84:87], v[166:169]
v_mfma_f32_16x16x32_bf16 v[162:165], v[102:105], v[84:87], v[162:165]
ds_read_b128 v[182:185], v210 offset:12288
ds_read_b128 v[186:189], v210 offset:13312
s_waitcnt lgkmcnt(1)
v_mfma_f32_16x16x32_bf16 v[118:121], v[182:185], a[72:75], 0
s_waitcnt lgkmcnt(0)
v_mfma_f32_16x16x32_bf16 v[118:121], v[186:189], a[76:79], v[118:121]
v_mfma_f32_16x16x32_bf16 v[126:129], v[182:185], a[96:99], 0
v_mfma_f32_16x16x32_bf16 v[126:129], v[186:189], a[100:103], v[126:129]
v_mfma_f32_16x16x32_bf16 v[134:137], v[182:185], a[120:123], 0
v_mfma_f32_16x16x32_bf16 v[134:137], v[186:189], a[124:127], v[134:137]
v_mfma_f32_16x16x32_bf16 v[90:93], a[216:219], v[182:185], 0
v_mfma_f32_16x16x32_bf16 v[90:93], a[220:223], v[186:189], v[90:93]
v_mfma_f32_16x16x32_bf16 v[170:173], a[240:243], v[182:185], 0
v_mfma_f32_16x16x32_bf16 v[170:173], a[244:247], v[186:189], v[170:173]
v_mfma_f32_16x16x32_bf16 v[220:223], v[232:235], v[182:185], 0
v_mfma_f32_16x16x32_bf16 v[220:223], v[236:239], v[186:189], v[220:223]
ds_read_b128 v[174:177], v210 offset:14336
ds_read_b128 v[178:181], v210 offset:15360
s_waitcnt lgkmcnt(1)
v_mfma_f32_16x16x32_bf16 v[118:121], v[174:177], a[80:83], v[118:121]
s_waitcnt lgkmcnt(0)
v_mfma_f32_16x16x32_bf16 v[118:121], v[178:181], a[84:87], v[118:121]
v_mfma_f32_16x16x32_bf16 v[126:129], v[174:177], a[104:107], v[126:129]
v_mfma_f32_16x16x32_bf16 v[126:129], v[178:181], a[108:111], v[126:129]
v_mfma_f32_16x16x32_bf16 v[134:137], v[174:177], a[128:131], v[134:137]
v_mfma_f32_16x16x32_bf16 v[134:137], v[178:181], a[132:135], v[134:137]
v_mfma_f32_16x16x32_bf16 v[90:93], a[224:227], v[174:177], v[90:93]
v_mfma_f32_16x16x32_bf16 v[90:93], a[228:231], v[178:181], v[90:93]
v_mfma_f32_16x16x32_bf16 v[170:173], a[248:251], v[174:177], v[170:173]
v_mfma_f32_16x16x32_bf16 v[170:173], a[252:255], v[178:181], v[170:173]
v_mfma_f32_16x16x32_bf16 v[220:223], v[240:243], v[174:177], v[220:223]
v_mfma_f32_16x16x32_bf16 v[220:223], v[244:247], v[178:181], v[220:223]
ds_read_b128 v[182:185], v210 offset:16384
ds_read_b128 v[186:189], v210 offset:17408
s_waitcnt lgkmcnt(1)
v_mfma_f32_16x16x32_bf16 v[118:121], v[182:185], a[88:91], v[118:121]
s_waitcnt lgkmcnt(0)
v_mfma_f32_16x16x32_bf16 v[118:121], v[186:189], a[92:95], v[118:121]
v_mfma_f32_16x16x32_bf16 v[126:129], v[182:185], a[112:115], v[126:129]
v_mfma_f32_16x16x32_bf16 v[126:129], v[186:189], a[116:119], v[126:129]
v_mfma_f32_16x16x32_bf16 v[134:137], v[182:185], a[136:139], v[134:137]
v_mfma_f32_16x16x32_bf16 v[134:137], v[186:189], a[140:143], v[134:137]
v_mfma_f32_16x16x32_bf16 v[90:93], a[232:235], v[182:185], v[90:93]
v_mfma_f32_16x16x32_bf16 v[90:93], a[236:239], v[186:189], v[90:93]
v_mfma_f32_16x16x32_bf16 v[170:173], v[224:227], v[182:185], v[170:173]
v_mfma_f32_16x16x32_bf16 v[170:173], v[228:231], v[186:189], v[170:173]
v_mfma_f32_16x16x32_bf16 v[220:223], v[248:251], v[182:185], v[220:223]
v_mfma_f32_16x16x32_bf16 v[220:223], v[252:255], v[186:189], v[220:223]
v_mov_b32 v181, 0
v_cvt_pk_bf16_f32 v118, v118, v119
v_cvt_pk_bf16_f32 v119, v120, v121
ds_read_u16 v120, v214 offset:1024
v_mov_b32 v121, 0
v_cvt_pk_bf16_f32 v126, v126, v127
v_cvt_pk_bf16_f32 v127, v128, v129
ds_read_u16 v128, v214 offset:1032
v_mov_b32 v129, 0
v_cvt_pk_bf16_f32 v134, v134, v135
v_cvt_pk_bf16_f32 v135, v136, v137
ds_read_u16 v136, v214 offset:1040
v_mov_b32 v137, 0
v_cvt_pk_bf16_f32 v90, v90, v91
v_cvt_pk_bf16_f32 v91, v92, v93
v_cvt_pk_bf16_f32 v92, v170, v171
v_cvt_pk_bf16_f32 v93, v172, v173
v_cvt_pk_bf16_f32 v94, v220, v221
v_cvt_pk_bf16_f32 v95, v222, v223
v_max3_f32 v151, v138, v139, v140
v_max3_f32 v151, v151, v141, v142
v_max3_f32 v151, v151, v143, v144
v_max3_f32 v151, v151, v145, v146
v_max3_f32 v151, v151, v147, v148
v_max3_f32 v151, v151, v149, v150
v_mov_b32 v152, v151
s_nop 1
v_permlane16_swap_b32 v151, v152
v_max_f32 v151, v151, v152
v_mov_b32 v152, v151
s_nop 1
v_permlane32_swap_b32 v151, v152
v_max_f32 v151, v151, v152
v_sub_f32 v138, v138, v151
v_sub_f32 v139, v139, v151
v_sub_f32 v140, v140, v151
v_sub_f32 v141, v141, v151
v_sub_f32 v142, v142, v151
v_sub_f32 v143, v143, v151
v_sub_f32 v144, v144, v151
v_sub_f32 v145, v145, v151
v_sub_f32 v150, v150, v151
v_sub_f32 v146, v146, v151
v_sub_f32 v147, v147, v151
v_sub_f32 v148, v148, v151
v_sub_f32 v149, v149, v151
v_exp_f32 v138, v138
v_exp_f32 v139, v139
v_exp_f32 v140, v140
v_exp_f32 v141, v141
v_exp_f32 v142, v142
v_exp_f32 v143, v143
v_exp_f32 v144, v144
v_exp_f32 v145, v145
v_exp_f32 v150, v150
v_exp_f32 v146, v146
v_exp_f32 v147, v147
v_exp_f32 v148, v148
v_exp_f32 v149, v149
v_cvt_pk_bf16_f32 v174, v138, v139
v_cvt_pk_bf16_f32 v175, v140, v141
v_cvt_pk_bf16_f32 v176, v142, v143
v_cvt_pk_bf16_f32 v177, v144, v145
v_cvt_pk_bf16_f32 v178, v146, v147
v_cvt_pk_bf16_f32 v179, v148, v149
v_cvt_pk_bf16_f32 v180, v150, 0
v_mfma_f32_16x16x32_bf16 v[150:153], v[190:193], v[174:177], 0
v_mfma_f32_16x16x32_bf16 v[150:153], v[190:193], v[178:181], v[150:153]
v_mfma_f32_16x16x32_bf16 v[138:141], v[114:117], v[174:177], 0
s_waitcnt lgkmcnt(2)
v_mfma_f32_16x16x32_bf16 v[138:141], v[118:121], v[178:181], v[138:141]
v_mfma_f32_16x16x32_bf16 v[142:145], v[122:125], v[174:177], 0
s_waitcnt lgkmcnt(1)
v_mfma_f32_16x16x32_bf16 v[142:145], v[126:129], v[178:181], v[142:145]
v_mfma_f32_16x16x32_bf16 v[146:149], v[130:133], v[174:177], 0
s_waitcnt lgkmcnt(0)
v_mfma_f32_16x16x32_bf16 v[146:149], v[134:137], v[178:181], v[146:149]
v_max3_f32 v167, v154, v155, v156
v_max3_f32 v167, v167, v157, v158
v_max3_f32 v167, v167, v159, v160
v_max3_f32 v167, v167, v161, v162
v_max3_f32 v167, v167, v163, v164
v_max3_f32 v167, v167, v165, v166
v_mov_b32 v168, v167
s_nop 1
v_permlane16_swap_b32 v167, v168
v_max_f32 v167, v167, v168
v_mov_b32 v168, v167
s_nop 1
v_permlane32_swap_b32 v167, v168
v_max_f32 v167, v167, v168
v_sub_f32 v154, v154, v167
v_sub_f32 v155, v155, v167
v_sub_f32 v156, v156, v167
v_sub_f32 v157, v157, v167
v_sub_f32 v158, v158, v167
v_sub_f32 v159, v159, v167
v_sub_f32 v160, v160, v167
v_sub_f32 v161, v161, v167
v_sub_f32 v166, v166, v167
v_sub_f32 v162, v162, v167
v_sub_f32 v163, v163, v167
v_sub_f32 v164, v164, v167
v_sub_f32 v165, v165, v167
v_exp_f32 v154, v154
v_exp_f32 v155, v155
v_exp_f32 v156, v156
v_exp_f32 v157, v157
v_exp_f32 v158, v158
v_exp_f32 v159, v159
v_exp_f32 v160, v160
v_exp_f32 v161, v161
v_exp_f32 v166, v166
v_exp_f32 v162, v162
v_exp_f32 v163, v163
v_exp_f32 v164, v164
v_exp_f32 v165, v165
v_cvt_pk_bf16_f32 v174, v154, v155
v_cvt_pk_bf16_f32 v175, v156, v157
v_cvt_pk_bf16_f32 v176, v158, v159
v_cvt_pk_bf16_f32 v177, v160, v161
v_cvt_pk_bf16_f32 v178, v162, v163
v_cvt_pk_bf16_f32 v179, v164, v165
v_cvt_pk_bf16_f32 v180, v166, 0
v_mfma_f32_16x16x32_bf16 v[166:169], v[190:193], v[174:177], 0
v_mfma_f32_16x16x32_bf16 v[166:169], v[190:193], v[178:181], v[166:169]
v_mfma_f32_16x16x32_bf16 v[154:157], v[114:117], v[174:177], 0
v_mfma_f32_16x16x32_bf16 v[154:157], v[118:121], v[178:181], v[154:157]
v_mfma_f32_16x16x32_bf16 v[158:161], v[122:125], v[174:177], 0
v_mfma_f32_16x16x32_bf16 v[158:161], v[126:129], v[178:181], v[158:161]
v_mfma_f32_16x16x32_bf16 v[162:165], v[130:133], v[174:177], 0
v_mfma_f32_16x16x32_bf16 v[162:165], v[134:137], v[178:181], v[162:165]
v_rcp_f32 v151, v150
s_nop 0
v_mul_f32 v151, s3, v151
v_mul_f32 v138, v138, v151
v_mul_f32 v139, v139, v151
v_cvt_pk_bf16_f32 v138, v138, v139
v_mul_f32 v140, v140, v151
v_mul_f32 v141, v141, v151
v_cvt_pk_bf16_f32 v139, v140, v141
v_mul_f32 v142, v142, v151
v_mul_f32 v143, v143, v151
v_cvt_pk_bf16_f32 v140, v142, v143
v_mul_f32 v144, v144, v151
v_mul_f32 v145, v145, v151
v_cvt_pk_bf16_f32 v141, v144, v145
ds_write_b128 v211, v[138:141] offset:38912
v_mul_f32 v146, v146, v151
v_mul_f32 v147, v147, v151
v_cvt_pk_bf16_f32 v142, v146, v147
v_mul_f32 v148, v148, v151
v_mul_f32 v149, v149, v151
v_cvt_pk_bf16_f32 v143, v148, v149
ds_write_b64 v212, v[142:143] offset:38912
v_mfma_f32_16x16x16_bf16 v[138:141], v[82:83], v[94:95], 0
v_mfma_f32_16x16x16_bf16 v[142:145], v[100:101], v[94:95], 0
v_mfma_f32_16x16x16_bf16 v[150:153], v[112:113], v[94:95], v[206:209]
v_mfma_f32_16x16x16_bf16 v[146:149], v[106:107], v[94:95], 0
v_mfma_f32_16x16x32_bf16 v[138:141], v[78:81], v[90:93], v[138:141]
v_mfma_f32_16x16x32_bf16 v[142:145], v[96:99], v[90:93], v[142:145]
v_mfma_f32_16x16x32_bf16 v[150:153], v[108:111], v[90:93], v[150:153]
v_mfma_f32_16x16x32_bf16 v[146:149], v[102:105], v[90:93], v[146:149]
v_rcp_f32 v167, v166
s_nop 0
v_mul_f32 v167, s3, v167
v_mul_f32 v154, v154, v167
v_mul_f32 v155, v155, v167
v_cvt_pk_bf16_f32 v154, v154, v155
v_mul_f32 v156, v156, v167
v_mul_f32 v157, v157, v167
v_cvt_pk_bf16_f32 v155, v156, v157
v_mul_f32 v158, v158, v167
v_mul_f32 v159, v159, v167
v_cvt_pk_bf16_f32 v156, v158, v159
v_mul_f32 v160, v160, v167
v_mul_f32 v161, v161, v167
v_cvt_pk_bf16_f32 v157, v160, v161
ds_write_b128 v211, v[154:157] offset:45056
v_mul_f32 v162, v162, v167
v_mul_f32 v163, v163, v167
v_cvt_pk_bf16_f32 v158, v162, v163
v_mul_f32 v164, v164, v167
v_mul_f32 v165, v165, v167
v_cvt_pk_bf16_f32 v159, v164, v165
ds_write_b64 v212, v[158:159] offset:45056
v_mfma_f32_16x16x16_bf16 v[154:157], v[76:77], v[82:83], 0
v_mfma_f32_16x16x16_bf16 v[158:161], v[76:77], v[100:101], 0
v_mfma_f32_16x16x16_bf16 v[162:165], v[76:77], v[106:107], 0
v_mfma_f32_16x16x16_bf16 v[166:169], v[76:77], v[112:113], v[206:209]
v_mfma_f32_16x16x32_bf16 v[154:157], v[72:75], v[78:81], v[154:157]
v_mfma_f32_16x16x32_bf16 v[158:161], v[72:75], v[96:99], v[158:161]
v_mfma_f32_16x16x32_bf16 v[162:165], v[72:75], v[102:105], v[162:165]
v_mfma_f32_16x16x32_bf16 v[166:169], v[72:75], v[108:111], v[166:169]
v_mov_b32_dpp v154, v158 quad_perm:[0,1,2,3] row_mask:0x2 bank_mask:0xf
s_nop 1
v_mov_b32_dpp v154, v162 quad_perm:[0,1,2,3] row_mask:0x4 bank_mask:0xf
s_nop 2
v_mov_b32_dpp v154, v167 quad_perm:[0,1,2,3] row_mask:0x8 bank_mask:0xf
v_mov_b32 v155, v154
s_nop 1
v_max_f32_dpp v155, v155, v155 row_ror:8 row_mask:0xf bank_mask:0xf
s_nop 1
v_max_f32_dpp v155, v155, v155 row_ror:4 row_mask:0xf bank_mask:0xf
s_nop 1
v_max_f32_dpp v155, v155, v155 row_ror:2 row_mask:0xf bank_mask:0xf
s_nop 1
v_max_f32_dpp v155, v155, v155 row_ror:1 row_mask:0xf bank_mask:0xf
v_mov_b32 v156, v155
s_nop 1
v_permlane16_swap_b32 v155, v156
v_max_f32 v155, v155, v156
v_mov_b32 v156, v155
s_nop 1
v_permlane32_swap_b32 v155, v156
v_max_f32 v155, v155, v156
v_sub_f32 v154, v154, v155
v_exp_f32 v154, v154
s_nop 0
v_cvt_pk_bf16_f32 v154, v154, 0
ds_write_b16 v214, v154
s_waitcnt lgkmcnt(1)
ds_read_b128 v[84:87], v215
ds_read_b128 v[88:91], v215 offset:16
v_add_u32 v215, 1552, v215
s_barrier
ds_read_b128 v[220:223], v210 offset:38912
ds_read_b128 v[110:113], v210 offset:39936
s_waitcnt lgkmcnt(1)
v_mfma_f32_16x16x32_bf16 v[0:3], a[144:147], v[220:223], v[0:3]
s_waitcnt lgkmcnt(0)
v_mfma_f32_16x16x32_bf16 v[0:3], a[148:151], v[110:113], v[0:3]
v_mfma_f32_16x16x32_bf16 v[4:7], a[168:171], v[220:223], v[4:7]
v_mfma_f32_16x16x32_bf16 v[4:7], a[172:175], v[110:113], v[4:7]
v_mfma_f32_16x16x32_bf16 v[8:11], a[192:195], v[220:223], v[8:11]
v_mfma_f32_16x16x32_bf16 v[8:11], a[196:199], v[110:113], v[8:11]
ds_read_b128 v[170:173], v210 offset:40960
ds_read_b128 v[182:185], v210 offset:41984
s_waitcnt lgkmcnt(1)
v_mfma_f32_16x16x32_bf16 v[0:3], a[152:155], v[170:173], v[0:3]
s_waitcnt lgkmcnt(0)
v_mfma_f32_16x16x32_bf16 v[0:3], a[156:159], v[182:185], v[0:3]
v_mfma_f32_16x16x32_bf16 v[4:7], a[176:179], v[170:173], v[4:7]
v_mfma_f32_16x16x32_bf16 v[4:7], a[180:183], v[182:185], v[4:7]
v_mfma_f32_16x16x32_bf16 v[8:11], a[200:203], v[170:173], v[8:11]
v_mfma_f32_16x16x32_bf16 v[8:11], a[204:207], v[182:185], v[8:11]
ds_read_b128 v[186:189], v210 offset:43008
ds_read_b128 v[220:223], v210 offset:44032
s_waitcnt lgkmcnt(1)
v_mfma_f32_16x16x32_bf16 v[0:3], a[160:163], v[186:189], v[0:3]
s_waitcnt lgkmcnt(0)
v_mfma_f32_16x16x32_bf16 v[0:3], a[164:167], v[220:223], v[0:3]
v_mfma_f32_16x16x32_bf16 v[4:7], a[184:187], v[186:189], v[4:7]
v_mfma_f32_16x16x32_bf16 v[4:7], a[188:191], v[220:223], v[4:7]
v_mfma_f32_16x16x32_bf16 v[8:11], a[208:211], v[186:189], v[8:11]
v_mfma_f32_16x16x32_bf16 v[8:11], a[212:215], v[220:223], v[8:11]
v_cvt_pk_bf16_f32 v72, v0, v1
v_cvt_pk_bf16_f32 v73, v2, v3
buffer_store_dwordx2 v[72:73], v203, s[8:11], s38 offen
v_cvt_pk_bf16_f32 v74, v4, v5
v_cvt_pk_bf16_f32 v75, v6, v7
buffer_store_dwordx2 v[74:75], v203, s[8:11], s38 offen offset:32
s_nop 0
v_cvt_pk_bf16_f32 v76, v8, v9
v_cvt_pk_bf16_f32 v77, v10, v11
buffer_store_dwordx2 v[76:77], v203, s[8:11], s38 offen offset:64
v_max3_f32 v151, v138, v139, v140
v_max3_f32 v151, v151, v141, v142
v_max3_f32 v151, v151, v143, v144
v_max3_f32 v151, v151, v145, v146
v_max3_f32 v151, v151, v147, v148
v_max3_f32 v151, v151, v149, v150
v_mov_b32 v152, v151
s_nop 1
v_permlane16_swap_b32 v151, v152
v_max_f32 v151, v151, v152
v_mov_b32 v152, v151
s_nop 1
v_permlane32_swap_b32 v151, v152
v_max_f32 v151, v151, v152
v_sub_f32 v138, v138, v151
v_sub_f32 v139, v139, v151
v_sub_f32 v140, v140, v151
v_sub_f32 v141, v141, v151
v_sub_f32 v142, v142, v151
v_sub_f32 v143, v143, v151
v_sub_f32 v144, v144, v151
v_sub_f32 v145, v145, v151
v_sub_f32 v150, v150, v151
v_sub_f32 v146, v146, v151
v_sub_f32 v147, v147, v151
v_sub_f32 v148, v148, v151
v_sub_f32 v149, v149, v151
v_exp_f32 v138, v138
v_exp_f32 v139, v139
v_exp_f32 v140, v140
v_exp_f32 v141, v141
v_exp_f32 v142, v142
v_exp_f32 v143, v143
v_exp_f32 v144, v144
v_exp_f32 v145, v145
v_exp_f32 v150, v150
v_exp_f32 v146, v146
v_exp_f32 v147, v147
v_exp_f32 v148, v148
v_exp_f32 v149, v149
v_cvt_pk_bf16_f32 v174, v138, v139
v_cvt_pk_bf16_f32 v175, v140, v141
v_cvt_pk_bf16_f32 v176, v142, v143
v_cvt_pk_bf16_f32 v177, v144, v145
v_cvt_pk_bf16_f32 v178, v146, v147
v_cvt_pk_bf16_f32 v179, v148, v149
v_cvt_pk_bf16_f32 v180, v150, 0
v_mfma_f32_16x16x32_bf16 v[150:153], v[190:193], v[174:177], 0
v_mfma_f32_16x16x32_bf16 v[150:153], v[190:193], v[178:181], v[150:153]
v_mfma_f32_16x16x32_bf16 v[138:141], v[114:117], v[174:177], 0
v_mfma_f32_16x16x32_bf16 v[138:141], v[118:121], v[178:181], v[138:141]
v_mfma_f32_16x16x32_bf16 v[142:145], v[122:125], v[174:177], 0
v_mfma_f32_16x16x32_bf16 v[142:145], v[126:129], v[178:181], v[142:145]
v_mfma_f32_16x16x32_bf16 v[146:149], v[130:133], v[174:177], 0
v_mfma_f32_16x16x32_bf16 v[146:149], v[134:137], v[178:181], v[146:149]
v_mfma_f32_16x16x32_bf16 v[166:169], v[84:87], v[190:193], 0
v_mfma_f32_16x16x32_bf16 v[166:169], v[88:91], v[190:193], v[166:169]
v_mfma_f32_16x16x32_bf16 v[154:157], v[84:87], v[114:117], 0
v_mfma_f32_16x16x32_bf16 v[154:157], v[88:91], v[118:121], v[154:157]
v_mfma_f32_16x16x32_bf16 v[158:161], v[84:87], v[122:125], 0
v_mfma_f32_16x16x32_bf16 v[158:161], v[88:91], v[126:129], v[158:161]
v_mfma_f32_16x16x32_bf16 v[162:165], v[84:87], v[130:133], 0
v_mfma_f32_16x16x32_bf16 v[162:165], v[88:91], v[134:137], v[162:165]
v_rcp_f32 v167, v166
v_mov_b32_dpp v154, v158 quad_perm:[0,1,2,3] row_mask:0x2 bank_mask:0xf
s_nop 3
v_mov_b32_dpp v154, v162 quad_perm:[0,1,2,3] row_mask:0x4 bank_mask:0xf
v_mul_f32 v167, s3, v167
v_mul_f32 v154, v154, v167
v_cvt_pk_bf16_f32 v154, v154, 0
ds_write_b16 v214, v154
v_add_u32 v214, 1552, v214
ds_read_b128 v[110:113], v210 offset:45056
ds_read_b128 v[170:173], v210 offset:46080
s_waitcnt lgkmcnt(1)
v_mfma_f32_16x16x32_bf16 v[12:15], a[144:147], v[110:113], v[12:15]
s_waitcnt lgkmcnt(0)
v_mfma_f32_16x16x32_bf16 v[12:15], a[148:151], v[170:173], v[12:15]
v_mfma_f32_16x16x32_bf16 v[16:19], a[168:171], v[110:113], v[16:19]
v_mfma_f32_16x16x32_bf16 v[16:19], a[172:175], v[170:173], v[16:19]
v_mfma_f32_16x16x32_bf16 v[20:23], a[192:195], v[110:113], v[20:23]
v_mfma_f32_16x16x32_bf16 v[20:23], a[196:199], v[170:173], v[20:23]
ds_read_b128 v[182:185], v210 offset:47104
ds_read_b128 v[186:189], v210 offset:48128
s_waitcnt lgkmcnt(1)
v_mfma_f32_16x16x32_bf16 v[12:15], a[152:155], v[182:185], v[12:15]
s_waitcnt lgkmcnt(0)
v_mfma_f32_16x16x32_bf16 v[12:15], a[156:159], v[186:189], v[12:15]
v_mfma_f32_16x16x32_bf16 v[16:19], a[176:179], v[182:185], v[16:19]
v_mfma_f32_16x16x32_bf16 v[16:19], a[180:183], v[186:189], v[16:19]
v_mfma_f32_16x16x32_bf16 v[20:23], a[200:203], v[182:185], v[20:23]
v_mfma_f32_16x16x32_bf16 v[20:23], a[204:207], v[186:189], v[20:23]
ds_read_b128 v[220:223], v210 offset:49152
ds_read_b128 v[110:113], v210 offset:50176
s_waitcnt lgkmcnt(1)
v_mfma_f32_16x16x32_bf16 v[12:15], a[160:163], v[220:223], v[12:15]
s_waitcnt lgkmcnt(0)
v_mfma_f32_16x16x32_bf16 v[12:15], a[164:167], v[110:113], v[12:15]
v_mfma_f32_16x16x32_bf16 v[16:19], a[184:187], v[220:223], v[16:19]
v_mfma_f32_16x16x32_bf16 v[16:19], a[188:191], v[110:113], v[16:19]
v_mfma_f32_16x16x32_bf16 v[20:23], a[208:211], v[220:223], v[20:23]
v_mfma_f32_16x16x32_bf16 v[20:23], a[212:215], v[110:113], v[20:23]
v_cvt_pk_bf16_f32 v78, v12, v13
v_cvt_pk_bf16_f32 v79, v14, v15
buffer_store_dwordx2 v[78:79], v204, s[8:11], s38 offen
v_cvt_pk_bf16_f32 v80, v16, v17
v_cvt_pk_bf16_f32 v81, v18, v19
buffer_store_dwordx2 v[80:81], v204, s[8:11], s38 offen offset:32
s_nop 0
v_cvt_pk_bf16_f32 v82, v20, v21
v_cvt_pk_bf16_f32 v83, v22, v23
buffer_store_dwordx2 v[82:83], v204, s[8:11], s38 offen offset:64
v_rcp_f32 v151, v150
s_nop 0
v_mul_f32 v151, s3, v151
v_mul_f32 v138, v138, v151
v_mul_f32 v139, v139, v151
v_cvt_pk_bf16_f32 v138, v138, v139
v_mul_f32 v140, v140, v151
v_mul_f32 v141, v141, v151
v_cvt_pk_bf16_f32 v139, v140, v141
v_mul_f32 v142, v142, v151
v_mul_f32 v143, v143, v151
v_cvt_pk_bf16_f32 v140, v142, v143
v_mul_f32 v144, v144, v151
v_mul_f32 v145, v145, v151
v_cvt_pk_bf16_f32 v141, v144, v145
ds_write_b128 v211, v[138:141] offset:51200
v_mul_f32 v146, v146, v151
v_mul_f32 v147, v147, v151
v_cvt_pk_bf16_f32 v142, v146, v147
v_mul_f32 v148, v148, v151
v_mul_f32 v149, v149, v151
v_cvt_pk_bf16_f32 v143, v148, v149
ds_write_b64 v212, v[142:143] offset:51200
s_mov_b32 s46, 7
.p2align 6
G_loop:
s_waitcnt vmcnt(6) lgkmcnt(0)
s_barrier
ds_read_b128 v[170:173], v210 offset:51200
ds_read_b128 v[182:185], v210 offset:52224
s_waitcnt lgkmcnt(1)
v_mfma_f32_16x16x32_bf16 v[24:27], a[144:147], v[170:173], v[24:27]
s_waitcnt lgkmcnt(0)
v_mfma_f32_16x16x32_bf16 v[24:27], a[148:151], v[182:185], v[24:27]
v_mfma_f32_16x16x32_bf16 v[28:31], a[168:171], v[170:173], v[28:31]
v_mfma_f32_16x16x32_bf16 v[28:31], a[172:175], v[182:185], v[28:31]
v_mfma_f32_16x16x32_bf16 v[32:35], a[192:195], v[170:173], v[32:35]
v_mfma_f32_16x16x32_bf16 v[32:35], a[196:199], v[182:185], v[32:35]
ds_read_b128 v[186:189], v210 offset:53248
ds_read_b128 v[220:223], v210 offset:54272
s_waitcnt lgkmcnt(1)
v_mfma_f32_16x16x32_bf16 v[24:27], a[152:155], v[186:189], v[24:27]
s_waitcnt lgkmcnt(0)
v_mfma_f32_16x16x32_bf16 v[24:27], a[156:159], v[220:223], v[24:27]
v_mfma_f32_16x16x32_bf16 v[28:31], a[176:179], v[186:189], v[28:31]
v_mfma_f32_16x16x32_bf16 v[28:31], a[180:183], v[220:223], v[28:31]
v_mfma_f32_16x16x32_bf16 v[32:35], a[200:203], v[186:189], v[32:35]
v_mfma_f32_16x16x32_bf16 v[32:35], a[204:207], v[220:223], v[32:35]
ds_read_b128 v[110:113], v210 offset:55296
ds_read_b128 v[170:173], v210 offset:56320
s_waitcnt lgkmcnt(1)
v_mfma_f32_16x16x32_bf16 v[24:27], a[160:163], v[110:113], v[24:27]
s_waitcnt lgkmcnt(0)
v_mfma_f32_16x16x32_bf16 v[24:27], a[164:167], v[170:173], v[24:27]
v_mfma_f32_16x16x32_bf16 v[28:31], a[184:187], v[110:113], v[28:31]
v_mfma_f32_16x16x32_bf16 v[28:31], a[188:191], v[170:173], v[28:31]
v_mfma_f32_16x16x32_bf16 v[32:35], a[208:211], v[110:113], v[32:35]
v_mfma_f32_16x16x32_bf16 v[32:35], a[212:215], v[170:173], v[32:35]
v_cvt_pk_bf16_f32 v116, v24, v25
v_cvt_pk_bf16_f32 v117, v26, v27
buffer_store_dwordx2 v[116:117], v205, s[8:11], s38 offen
v_cvt_pk_bf16_f32 v124, v28, v29
v_cvt_pk_bf16_f32 v125, v30, v31
buffer_store_dwordx2 v[124:125], v205, s[8:11], s38 offen offset:32
s_nop 0
v_cvt_pk_bf16_f32 v132, v32, v33
v_cvt_pk_bf16_f32 v133, v34, v35
buffer_store_dwordx2 v[132:133], v205, s[8:11], s38 offen offset:64
s_mov_b32 s39, s37
ds_read_b128 v[174:177], v217
ds_read_b128 v[84:87], v200
s_waitcnt lgkmcnt(0)
v_mfma_f32_16x16x32_bf16 v[0:3], v[174:177], v[84:87], 0
ds_read_b128 v[92:95], v201
s_waitcnt lgkmcnt(0)
v_mfma_f32_16x16x32_bf16 v[12:15], v[174:177], v[92:95], 0
ds_read_b128 v[100:103], v202
s_waitcnt lgkmcnt(0)
v_mfma_f32_16x16x32_bf16 v[24:27], v[174:177], v[100:103], 0
ds_read_b128 v[178:181], v217 offset:528
ds_read_b128 v[84:87], v194
ds_read_b128 v[88:91], v194 offset:16
s_waitcnt lgkmcnt(0)
v_smfmac_f32_16x16x64_bf16 v[0:3], v[178:181], v[84:91], v213
ds_read_b128 v[92:95], v195
ds_read_b128 v[96:99], v195 offset:16
s_waitcnt lgkmcnt(0)
v_smfmac_f32_16x16x64_bf16 v[12:15], v[178:181], v[92:99], v213
ds_read_b128 v[100:103], v196
ds_read_b128 v[104:107], v196 offset:16
s_waitcnt lgkmcnt(0)
v_smfmac_f32_16x16x64_bf16 v[24:27], v[178:181], v[100:107], v213
ds_read_b128 v[174:177], v217 offset:1056
ds_read_b128 v[84:87], v197
ds_read_b128 v[88:91], v197 offset:16
s_waitcnt lgkmcnt(0)
v_smfmac_f32_16x16x64_bf16 v[0:3], v[174:177], v[84:91], v213
ds_read_b128 v[92:95], v198
ds_read_b128 v[96:99], v198 offset:16
s_waitcnt lgkmcnt(0)
v_smfmac_f32_16x16x64_bf16 v[12:15], v[174:177], v[92:99], v213
ds_read_b128 v[100:103], v199
ds_read_b128 v[104:107], v199 offset:16
s_waitcnt lgkmcnt(0)
v_smfmac_f32_16x16x64_bf16 v[24:27], v[174:177], v[100:107], v213
ds_read_b128 v[178:181], v217 offset:1584
ds_read_b128 v[84:87], v200 offset:32
s_waitcnt lgkmcnt(0)
v_mfma_f32_16x16x32_bf16 v[4:7], v[178:181], v[84:87], 0
ds_read_b128 v[92:95], v201 offset:32
s_waitcnt lgkmcnt(0)
v_mfma_f32_16x16x32_bf16 v[16:19], v[178:181], v[92:95], 0
ds_read_b128 v[100:103], v202 offset:32
s_waitcnt lgkmcnt(0)
v_mfma_f32_16x16x32_bf16 v[28:31], v[178:181], v[100:103], 0
ds_read_b128 v[174:177], v217 offset:2112
ds_read_b128 v[84:87], v194 offset:32
ds_read_b128 v[88:91], v194 offset:48
s_waitcnt lgkmcnt(0)
v_smfmac_f32_16x16x64_bf16 v[4:7], v[174:177], v[84:91], v213
ds_read_b128 v[92:95], v195 offset:32
ds_read_b128 v[96:99], v195 offset:48
s_waitcnt lgkmcnt(0)
v_smfmac_f32_16x16x64_bf16 v[16:19], v[174:177], v[92:99], v213
ds_read_b128 v[100:103], v196 offset:32
ds_read_b128 v[104:107], v196 offset:48
s_waitcnt lgkmcnt(0)
v_smfmac_f32_16x16x64_bf16 v[28:31], v[174:177], v[100:107], v213
ds_read_b128 v[178:181], v217 offset:2640
ds_read_b128 v[84:87], v197 offset:32
ds_read_b128 v[88:91], v197 offset:48
s_waitcnt lgkmcnt(0)
v_smfmac_f32_16x16x64_bf16 v[4:7], v[178:181], v[84:91], v213
ds_read_b128 v[92:95], v198 offset:32
ds_read_b128 v[96:99], v198 offset:48
s_waitcnt lgkmcnt(0)
v_smfmac_f32_16x16x64_bf16 v[16:19], v[178:181], v[92:99], v213
ds_read_b128 v[100:103], v199 offset:32
ds_read_b128 v[104:107], v199 offset:48
s_waitcnt lgkmcnt(0)
v_smfmac_f32_16x16x64_bf16 v[28:31], v[178:181], v[100:107], v213
ds_read_b128 v[174:177], v217 offset:3168
ds_read_b128 v[84:87], v200 offset:64
s_waitcnt lgkmcnt(0)
v_mfma_f32_16x16x32_bf16 v[8:11], v[174:177], v[84:87], 0
ds_read_b128 v[92:95], v201 offset:64
s_waitcnt lgkmcnt(0)
v_mfma_f32_16x16x32_bf16 v[20:23], v[174:177], v[92:95], 0
ds_read_b128 v[100:103], v202 offset:64
s_waitcnt lgkmcnt(0)
v_mfma_f32_16x16x32_bf16 v[32:35], v[174:177], v[100:103], 0
ds_read_b128 v[178:181], v217 offset:3696
ds_read_b128 v[84:87], v194 offset:64
ds_read_b128 v[88:91], v194 offset:80
s_waitcnt lgkmcnt(0)
v_smfmac_f32_16x16x64_bf16 v[8:11], v[178:181], v[84:91], v213
ds_read_b128 v[92:95], v195 offset:64
ds_read_b128 v[96:99], v195 offset:80
s_waitcnt lgkmcnt(0)
v_smfmac_f32_16x16x64_bf16 v[20:23], v[178:181], v[92:99], v213
ds_read_b128 v[100:103], v196 offset:64
ds_read_b128 v[104:107], v196 offset:80
s_waitcnt lgkmcnt(0)
v_smfmac_f32_16x16x64_bf16 v[32:35], v[178:181], v[100:107], v213
ds_read_b128 v[174:177], v217 offset:4224
ds_read_b128 v[84:87], v197 offset:64
ds_read_b128 v[88:91], v197 offset:80
s_waitcnt lgkmcnt(0)
v_smfmac_f32_16x16x64_bf16 v[8:11], v[174:177], v[84:91], v213
ds_read_b128 v[92:95], v198 offset:64
ds_read_b128 v[96:99], v198 offset:80
s_waitcnt lgkmcnt(0)
v_smfmac_f32_16x16x64_bf16 v[20:23], v[174:177], v[92:99], v213
ds_read_b128 v[100:103], v199 offset:64
ds_read_b128 v[104:107], v199 offset:80
s_waitcnt lgkmcnt(0)
v_smfmac_f32_16x16x64_bf16 v[32:35], v[174:177], v[100:107], v213
v_add_f32 v118, v0, v1
v_mul_f32 v119, v0, v0
v_add_f32 v118, v118, v2
v_fmac_f32 v119, v1, v1
v_add_f32 v118, v118, v3
v_fmac_f32 v119, v2, v2
v_fmac_f32 v119, v3, v3
v_add_f32 v126, v12, v13
v_mul_f32 v127, v12, v12
v_add_f32 v126, v126, v14
v_fmac_f32 v127, v13, v13
v_add_f32 v126, v126, v15
v_fmac_f32 v127, v14, v14
v_fmac_f32 v127, v15, v15
v_add_f32 v134, v24, v25
v_mul_f32 v135, v24, v24
v_add_f32 v134, v134, v26
v_fmac_f32 v135, v25, v25
v_add_f32 v134, v134, v27
v_fmac_f32 v135, v26, v26
v_fmac_f32 v135, v27, v27
v_add_f32 v118, v118, v4
v_fmac_f32 v119, v4, v4
v_add_f32 v118, v118, v5
v_fmac_f32 v119, v5, v5
v_add_f32 v118, v118, v6
v_fmac_f32 v119, v6, v6
v_add_f32 v118, v118, v7
v_fmac_f32 v119, v7, v7
v_add_f32 v126, v126, v16
v_fmac_f32 v127, v16, v16
v_add_f32 v126, v126, v17
v_fmac_f32 v127, v17, v17
v_add_f32 v126, v126, v18
v_fmac_f32 v127, v18, v18
v_add_f32 v126, v126, v19
v_fmac_f32 v127, v19, v19
v_add_f32 v134, v134, v28
v_fmac_f32 v135, v28, v28
v_add_f32 v134, v134, v29
v_fmac_f32 v135, v29, v29
v_add_f32 v134, v134, v30
v_fmac_f32 v135, v30, v30
v_add_f32 v134, v134, v31
v_fmac_f32 v135, v31, v31
v_add_f32 v118, v118, v8
v_fmac_f32 v119, v8, v8
v_add_f32 v118, v118, v9
v_fmac_f32 v119, v9, v9
v_add_f32 v118, v118, v10
v_fmac_f32 v119, v10, v10
v_add_f32 v118, v118, v11
v_fmac_f32 v119, v11, v11
v_add_f32 v126, v126, v20
v_fmac_f32 v127, v20, v20
v_add_f32 v126, v126, v21
v_fmac_f32 v127, v21, v21
v_add_f32 v126, v126, v22
v_fmac_f32 v127, v22, v22
v_add_f32 v126, v126, v23
v_fmac_f32 v127, v23, v23
v_add_f32 v134, v134, v32
v_fmac_f32 v135, v32, v32
v_add_f32 v134, v134, v33
v_fmac_f32 v135, v33, v33
v_add_f32 v134, v134, v34
v_fmac_f32 v135, v34, v34
v_add_f32 v134, v134, v35
v_fmac_f32 v135, v35, v35
v_permlane16_swap_b32 v118, v119
v_add_f32 v118, v118, v119
v_permlane16_swap_b32 v126, v127
v_add_f32 v126, v126, v127
v_permlane16_swap_b32 v134, v135
v_add_f32 v134, v134, v135
v_permlane32_swap_b32 v118, v126
v_add_f32 v118, v118, v126
ds_write_b32 v209, v118
v_mov_b32 v135, v134
s_nop 1
v_permlane32_swap_b32 v134, v135
v_add_f32 v134, v134, v135
ds_write_b32 v209, v134 offset:512
s_waitcnt lgkmcnt(0)
s_barrier
s_mul_hi_u32 s41, s35, 58835169
s_mul_i32 s42, s41, 73
s_sub_u32 s42, s35, s42
s_mul_i32 s43, s41, 1373568
s_mul_i32 s51, s42, 2688
s_add_u32 s43, s43, s51
s_cmp_lt_u32 s35, s34
s_cselect_b32 s50, s43, 1879048192
s_add_u32 s35, s35, 32
s_cmp_eq_u32 s42, 0
s_cselect_b32 s44, 536870911, s72
s_cmp_eq_u32 s42, 72
s_cselect_b32 s44, 939524095, s44
s_cmp_eq_u32 s41, 0
s_cselect_b32 s52, 1879048192, s50
s_mov_b32 s37, s50
v_and_b32 v216, s44, v208
s_add_u32 m0, s45, 0
s_nop 0
buffer_load_dwordx4 v216, s[4:7], s52 offen nt lds
s_add_u32 m0, s45, 4112
s_add_u32 s40, s37, 196224
buffer_load_dwordx4 v216, s[4:7], s40 offen nt lds
s_add_u32 m0, s45, 8224
s_add_u32 s40, s37, 392448
buffer_load_dwordx4 v216, s[4:7], s40 offen nt lds
s_add_u32 m0, s45, 12336
s_add_u32 s40, s37, 588672
buffer_load_dwordx4 v216, s[4:7], s40 offen nt lds
s_add_u32 m0, s45, 16448
s_add_u32 s40, s37, 784896
buffer_load_dwordx4 v216, s[4:7], s40 offen nt lds
s_add_u32 m0, s45, 20560
s_add_u32 s40, s37, 981120
buffer_load_dwordx4 v216, s[4:7], s40 offen nt lds
s_add_u32 m0, s45, 24672
s_add_u32 s40, s37, 1177344
buffer_load_dwordx4 v216, s[4:7], s40 offen nt lds
s_add_u32 m0, s45, 28784
s_add_u32 s40, s37, 1373568
buffer_load_dwordx4 v216, s[4:7], s40 offen nt lds
s_add_u32 m0, s45, 32896
s_add_u32 s40, s37, 1569792
buffer_load_dwordx4 v216, s[4:7], s40 offen nt lds
ds_read_b128 v[182:185], v210 offset:20480
ds_read_b128 v[186:189], v210 offset:21504
s_waitcnt lgkmcnt(1)
v_mfma_f32_16x16x32_bf16 v[138:141], a[0:3], v[182:185], 0
s_waitcnt lgkmcnt(0)
v_mfma_f32_16x16x32_bf16 v[138:141], a[4:7], v[186:189], v[138:141]
v_mfma_f32_16x16x32_bf16 v[142:145], a[24:27], v[182:185], 0
v_mfma_f32_16x16x32_bf16 v[142:145], a[28:31], v[186:189], v[142:145]
v_mfma_f32_16x16x32_bf16 v[146:149], a[48:51], v[182:185], 0
v_mfma_f32_16x16x32_bf16 v[146:149], a[52:55], v[186:189], v[146:149]
v_mfma_f32_16x16x32_bf16 v[150:153], a[216:219], v[182:185], 0
v_mfma_f32_16x16x32_bf16 v[150:153], a[220:223], v[186:189], v[150:153]
v_mfma_f32_16x16x32_bf16 v[154:157], a[240:243], v[182:185], 0
v_mfma_f32_16x16x32_bf16 v[154:157], a[244:247], v[186:189], v[154:157]
v_mfma_f32_16x16x32_bf16 v[158:161], v[232:235], v[182:185], 0
v_mfma_f32_16x16x32_bf16 v[158:161], v[236:239], v[186:189], v[158:161]
v_mfma_f32_16x16x32_bf16 v[162:165], v[182:185], a[72:75], 0
v_mfma_f32_16x16x32_bf16 v[162:165], v[186:189], a[76:79], v[162:165]
v_mfma_f32_16x16x32_bf16 v[166:169], v[182:185], a[96:99], 0
v_mfma_f32_16x16x32_bf16 v[166:169], v[186:189], a[100:103], v[166:169]
v_mfma_f32_16x16x32_bf16 v[170:173], v[182:185], a[120:123], 0
v_mfma_f32_16x16x32_bf16 v[170:173], v[186:189], a[124:127], v[170:173]
ds_read_b128 v[110:113], v210 offset:22528
ds_read_b128 v[220:223], v210 offset:23552
s_waitcnt lgkmcnt(1)
v_mfma_f32_16x16x32_bf16 v[138:141], a[8:11], v[110:113], v[138:141]
s_waitcnt lgkmcnt(0)
v_mfma_f32_16x16x32_bf16 v[138:141], a[12:15], v[220:223], v[138:141]
v_mfma_f32_16x16x32_bf16 v[142:145], a[32:35], v[110:113], v[142:145]
v_mfma_f32_16x16x32_bf16 v[142:145], a[36:39], v[220:223], v[142:145]
v_mfma_f32_16x16x32_bf16 v[146:149], a[56:59], v[110:113], v[146:149]
v_mfma_f32_16x16x32_bf16 v[146:149], a[60:63], v[220:223], v[146:149]
v_mfma_f32_16x16x32_bf16 v[150:153], a[224:227], v[110:113], v[150:153]
v_mfma_f32_16x16x32_bf16 v[150:153], a[228:231], v[220:223], v[150:153]
v_mfma_f32_16x16x32_bf16 v[154:157], a[248:251], v[110:113], v[154:157]
v_mfma_f32_16x16x32_bf16 v[154:157], a[252:255], v[220:223], v[154:157]
v_mfma_f32_16x16x32_bf16 v[158:161], v[240:243], v[110:113], v[158:161]
v_mfma_f32_16x16x32_bf16 v[158:161], v[244:247], v[220:223], v[158:161]
v_mfma_f32_16x16x32_bf16 v[162:165], v[110:113], a[80:83], v[162:165]
v_mfma_f32_16x16x32_bf16 v[162:165], v[220:223], a[84:87], v[162:165]
v_mfma_f32_16x16x32_bf16 v[166:169], v[110:113], a[104:107], v[166:169]
v_mfma_f32_16x16x32_bf16 v[166:169], v[220:223], a[108:111], v[166:169]
v_mfma_f32_16x16x32_bf16 v[170:173], v[110:113], a[128:131], v[170:173]
v_mfma_f32_16x16x32_bf16 v[170:173], v[220:223], a[132:135], v[170:173]
ds_read_b128 v[182:185], v210 offset:24576
ds_read_b128 v[186:189], v210 offset:25600
s_waitcnt lgkmcnt(1)
v_mfma_f32_16x16x32_bf16 v[138:141], a[16:19], v[182:185], v[138:141]
s_waitcnt lgkmcnt(0)
v_mfma_f32_16x16x32_bf16 v[138:141], a[20:23], v[186:189], v[138:141]
v_mfma_f32_16x16x32_bf16 v[142:145], a[40:43], v[182:185], v[142:145]
v_mfma_f32_16x16x32_bf16 v[142:145], a[44:47], v[186:189], v[142:145]
v_mfma_f32_16x16x32_bf16 v[146:149], a[64:67], v[182:185], v[146:149]
v_mfma_f32_16x16x32_bf16 v[146:149], a[68:71], v[186:189], v[146:149]
v_mfma_f32_16x16x32_bf16 v[150:153], a[232:235], v[182:185], v[150:153]
v_mfma_f32_16x16x32_bf16 v[150:153], a[236:239], v[186:189], v[150:153]
v_mfma_f32_16x16x32_bf16 v[154:157], v[224:227], v[182:185], v[154:157]
v_mfma_f32_16x16x32_bf16 v[154:157], v[228:231], v[186:189], v[154:157]
v_mfma_f32_16x16x32_bf16 v[158:161], v[248:251], v[182:185], v[158:161]
v_mfma_f32_16x16x32_bf16 v[158:161], v[252:255], v[186:189], v[158:161]
v_mfma_f32_16x16x32_bf16 v[162:165], v[182:185], a[88:91], v[162:165]
v_mfma_f32_16x16x32_bf16 v[162:165], v[186:189], a[92:95], v[162:165]
v_mfma_f32_16x16x32_bf16 v[166:169], v[182:185], a[112:115], v[166:169]
v_mfma_f32_16x16x32_bf16 v[166:169], v[186:189], a[116:119], v[166:169]
v_mfma_f32_16x16x32_bf16 v[170:173], v[182:185], a[136:139], v[170:173]
v_mfma_f32_16x16x32_bf16 v[170:173], v[186:189], a[140:143], v[170:173]
v_cvt_pk_bf16_f32 v78, v138, v139
v_cvt_pk_bf16_f32 v79, v140, v141
v_cvt_pk_bf16_f32 v80, v142, v143
v_cvt_pk_bf16_f32 v81, v144, v145
v_cvt_pk_bf16_f32 v82, v146, v147
v_cvt_pk_bf16_f32 v83, v148, v149
v_cvt_pk_bf16_f32 v72, v150, v151
v_cvt_pk_bf16_f32 v73, v152, v153
v_cvt_pk_bf16_f32 v74, v154, v155
v_cvt_pk_bf16_f32 v75, v156, v157
v_cvt_pk_bf16_f32 v76, v158, v159
v_cvt_pk_bf16_f32 v77, v160, v161
v_cvt_pk_bf16_f32 v114, v162, v163
v_cvt_pk_bf16_f32 v115, v164, v165
v_cvt_pk_bf16_f32 v122, v166, v167
v_cvt_pk_bf16_f32 v123, v168, v169
v_cvt_pk_bf16_f32 v130, v170, v171
v_cvt_pk_bf16_f32 v131, v172, v173
ds_read_b128 v[110:113], v210 offset:26624
ds_read_b128 v[220:223], v210 offset:27648
s_waitcnt lgkmcnt(1)
v_mfma_f32_16x16x32_bf16 v[138:141], a[0:3], v[110:113], 0
s_waitcnt lgkmcnt(0)
v_mfma_f32_16x16x32_bf16 v[138:141], a[4:7], v[220:223], v[138:141]
v_mfma_f32_16x16x32_bf16 v[142:145], a[24:27], v[110:113], 0
v_mfma_f32_16x16x32_bf16 v[142:145], a[28:31], v[220:223], v[142:145]
v_mfma_f32_16x16x32_bf16 v[146:149], a[48:51], v[110:113], 0
v_mfma_f32_16x16x32_bf16 v[146:149], a[52:55], v[220:223], v[146:149]
v_mfma_f32_16x16x32_bf16 v[150:153], a[216:219], v[110:113], 0
v_mfma_f32_16x16x32_bf16 v[150:153], a[220:223], v[220:223], v[150:153]
v_mfma_f32_16x16x32_bf16 v[154:157], a[240:243], v[110:113], 0
v_mfma_f32_16x16x32_bf16 v[154:157], a[244:247], v[220:223], v[154:157]
v_mfma_f32_16x16x32_bf16 v[158:161], v[232:235], v[110:113], 0
v_mfma_f32_16x16x32_bf16 v[158:161], v[236:239], v[220:223], v[158:161]
v_mfma_f32_16x16x32_bf16 v[162:165], v[110:113], a[72:75], 0
v_mfma_f32_16x16x32_bf16 v[162:165], v[220:223], a[76:79], v[162:165]
v_mfma_f32_16x16x32_bf16 v[166:169], v[110:113], a[96:99], 0
v_mfma_f32_16x16x32_bf16 v[166:169], v[220:223], a[100:103], v[166:169]
v_mfma_f32_16x16x32_bf16 v[170:173], v[110:113], a[120:123], 0
v_mfma_f32_16x16x32_bf16 v[170:173], v[220:223], a[124:127], v[170:173]
ds_read_b128 v[102:105], v210 offset:18432
ds_read_b128 v[106:109], v210 offset:19456
s_waitcnt lgkmcnt(1)
v_add_f32 v102, v102, v103
s_waitcnt lgkmcnt(0)
v_add_f32 v106, v106, v107
v_add_f32 v104, v104, v105
v_add_f32 v108, v108, v109
v_add_f32 v102, v102, v104
v_add_f32 v106, v106, v108
v_mul_f32 v103, s48, v102
v_mul_f32 v104, s73, v102
v_mul_f32 v106, s73, v106
v_fma_f32 v106, -v103, v104, v106
v_max_f32 v106, 0, v106
v_add_f32 v106, s49, v106
v_rsq_f32 v102, v106
s_nop 0
v_mul_f32_e64 v103, -v103, v102
ds_write_b64 v211, v[102:103]
ds_read_b64 v[118:119], v219
ds_read_b64 v[126:127], v219 offset:256
ds_read_b64 v[134:135], v219 offset:512
s_waitcnt lgkmcnt(2)
v_fma_f32 v220, v0, v118, v119
v_fma_f32 v221, v1, v118, v119
v_cvt_pk_bf16_f32 v90, v220, v221
v_fma_f32 v222, v2, v118, v119
v_fma_f32 v223, v3, v118, v119
v_cvt_pk_bf16_f32 v91, v222, v223
v_fma_f32 v220, v4, v118, v119
v_fma_f32 v221, v5, v118, v119
v_cvt_pk_bf16_f32 v92, v220, v221
v_fma_f32 v222, v6, v118, v119
v_fma_f32 v223, v7, v118, v119
v_cvt_pk_bf16_f32 v93, v222, v223
ds_write_b128 v211, v[90:93]
v_fma_f32 v220, v8, v118, v119
v_fma_f32 v221, v9, v118, v119
v_cvt_pk_bf16_f32 v94, v220, v221
v_fma_f32 v222, v10, v118, v119
v_fma_f32 v223, v11, v118, v119
v_cvt_pk_bf16_f32 v95, v222, v223
s_waitcnt lgkmcnt(2)
ds_write_b64 v212, v[94:95]
v_fma_f32 v220, v12, v126, v127
v_fma_f32 v221, v13, v126, v127
v_cvt_pk_bf16_f32 v174, v220, v221
v_fma_f32 v222, v14, v126, v127
v_fma_f32 v223, v15, v126, v127
v_cvt_pk_bf16_f32 v175, v222, v223
v_fma_f32 v220, v16, v126, v127
v_fma_f32 v221, v17, v126, v127
v_cvt_pk_bf16_f32 v176, v220, v221
v_fma_f32 v222, v18, v126, v127
v_fma_f32 v223, v19, v126, v127
v_cvt_pk_bf16_f32 v177, v222, v223
ds_write_b128 v211, v[174:177] offset:6144
v_fma_f32 v220, v20, v126, v127
v_fma_f32 v221, v21, v126, v127
v_cvt_pk_bf16_f32 v178, v220, v221
v_fma_f32 v222, v22, v126, v127
v_fma_f32 v223, v23, v126, v127
v_cvt_pk_bf16_f32 v179, v222, v223
s_waitcnt lgkmcnt(3)
ds_write_b64 v212, v[178:179] offset:6144
v_fma_f32 v220, v24, v134, v135
v_fma_f32 v221, v25, v134, v135
v_cvt_pk_bf16_f32 v90, v220, v221
v_fma_f32 v222, v26, v134, v135
v_fma_f32 v223, v27, v134, v135
v_cvt_pk_bf16_f32 v91, v222, v223
v_fma_f32 v220, v28, v134, v135
v_fma_f32 v221, v29, v134, v135
v_cvt_pk_bf16_f32 v92, v220, v221
v_fma_f32 v222, v30, v134, v135
v_fma_f32 v223, v31, v134, v135
v_cvt_pk_bf16_f32 v93, v222, v223
ds_write_b128 v211, v[90:93] offset:12288
v_fma_f32 v220, v32, v134, v135
v_fma_f32 v221, v33, v134, v135
v_cvt_pk_bf16_f32 v94, v220, v221
v_fma_f32 v222, v34, v134, v135
v_fma_f32 v223, v35, v134, v135
v_cvt_pk_bf16_f32 v95, v222, v223
ds_write_b64 v212, v[94:95] offset:12288
ds_read_b128 v[182:185], v210 offset:28672
ds_read_b128 v[186:189], v210 offset:29696
s_waitcnt lgkmcnt(1)
v_mfma_f32_16x16x32_bf16 v[138:141], a[8:11], v[182:185], v[138:141]
s_waitcnt lgkmcnt(0)
v_mfma_f32_16x16x32_bf16 v[138:141], a[12:15], v[186:189], v[138:141]
v_mfma_f32_16x16x32_bf16 v[142:145], a[32:35], v[182:185], v[142:145]
v_mfma_f32_16x16x32_bf16 v[142:145], a[36:39], v[186:189], v[142:145]
v_mfma_f32_16x16x32_bf16 v[146:149], a[56:59], v[182:185], v[146:149]
v_mfma_f32_16x16x32_bf16 v[146:149], a[60:63], v[186:189], v[146:149]
v_mfma_f32_16x16x32_bf16 v[150:153], a[224:227], v[182:185], v[150:153]
v_mfma_f32_16x16x32_bf16 v[150:153], a[228:231], v[186:189], v[150:153]
v_mfma_f32_16x16x32_bf16 v[154:157], a[248:251], v[182:185], v[154:157]
v_mfma_f32_16x16x32_bf16 v[154:157], a[252:255], v[186:189], v[154:157]
v_mfma_f32_16x16x32_bf16 v[158:161], v[240:243], v[182:185], v[158:161]
v_mfma_f32_16x16x32_bf16 v[158:161], v[244:247], v[186:189], v[158:161]
v_mfma_f32_16x16x32_bf16 v[162:165], v[182:185], a[80:83], v[162:165]
v_mfma_f32_16x16x32_bf16 v[162:165], v[186:189], a[84:87], v[162:165]
v_mfma_f32_16x16x32_bf16 v[166:169], v[182:185], a[104:107], v[166:169]
v_mfma_f32_16x16x32_bf16 v[166:169], v[186:189], a[108:111], v[166:169]
v_mfma_f32_16x16x32_bf16 v[170:173], v[182:185], a[128:131], v[170:173]
v_mfma_f32_16x16x32_bf16 v[170:173], v[186:189], a[132:135], v[170:173]
ds_read_b128 v[110:113], v210 offset:30720
ds_read_b128 v[106:109], v210 offset:31744
s_waitcnt lgkmcnt(1)
v_mfma_f32_16x16x32_bf16 v[138:141], a[16:19], v[110:113], v[138:141]
s_waitcnt lgkmcnt(0)
v_mfma_f32_16x16x32_bf16 v[138:141], a[20:23], v[106:109], v[138:141]
v_mfma_f32_16x16x32_bf16 v[142:145], a[40:43], v[110:113], v[142:145]
v_mfma_f32_16x16x32_bf16 v[142:145], a[44:47], v[106:109], v[142:145]
v_mfma_f32_16x16x32_bf16 v[146:149], a[64:67], v[110:113], v[146:149]
v_mfma_f32_16x16x32_bf16 v[146:149], a[68:71], v[106:109], v[146:149]
v_mfma_f32_16x16x32_bf16 v[150:153], a[232:235], v[110:113], v[150:153]
v_mfma_f32_16x16x32_bf16 v[150:153], a[236:239], v[106:109], v[150:153]
v_mfma_f32_16x16x32_bf16 v[154:157], v[224:227], v[110:113], v[154:157]
v_mfma_f32_16x16x32_bf16 v[154:157], v[228:231], v[106:109], v[154:157]
v_mfma_f32_16x16x32_bf16 v[158:161], v[248:251], v[110:113], v[158:161]
v_mfma_f32_16x16x32_bf16 v[158:161], v[252:255], v[106:109], v[158:161]
v_mfma_f32_16x16x32_bf16 v[162:165], v[110:113], a[88:91], v[162:165]
v_mfma_f32_16x16x32_bf16 v[162:165], v[106:109], a[92:95], v[162:165]
v_mfma_f32_16x16x32_bf16 v[166:169], v[110:113], a[112:115], v[166:169]
v_mfma_f32_16x16x32_bf16 v[166:169], v[106:109], a[116:119], v[166:169]
v_mfma_f32_16x16x32_bf16 v[170:173], v[110:113], a[136:139], v[170:173]
v_mfma_f32_16x16x32_bf16 v[170:173], v[106:109], a[140:143], v[170:173]
v_cvt_pk_bf16_f32 v96, v138, v139
v_cvt_pk_bf16_f32 v97, v140, v141
v_cvt_pk_bf16_f32 v98, v142, v143
v_cvt_pk_bf16_f32 v99, v144, v145
v_cvt_pk_bf16_f32 v100, v146, v147
v_cvt_pk_bf16_f32 v101, v148, v149
v_cvt_pk_bf16_f32 v84, v150, v151
v_cvt_pk_bf16_f32 v85, v152, v153
v_cvt_pk_bf16_f32 v86, v154, v155
v_cvt_pk_bf16_f32 v87, v156, v157
v_cvt_pk_bf16_f32 v88, v158, v159
v_cvt_pk_bf16_f32 v89, v160, v161
v_cvt_pk_bf16_f32 v116, v162, v163
v_cvt_pk_bf16_f32 v117, v164, v165
v_cvt_pk_bf16_f32 v124, v166, v167
v_cvt_pk_bf16_f32 v125, v168, v169
v_cvt_pk_bf16_f32 v132, v170, v171
v_cvt_pk_bf16_f32 v133, v172, v173
ds_read_b128 v[182:185], v210 offset:32768
ds_read_b128 v[186:189], v210 offset:33792
s_waitcnt lgkmcnt(1)
v_mfma_f32_16x16x32_bf16 v[138:141], a[0:3], v[182:185], 0
s_waitcnt lgkmcnt(0)
v_mfma_f32_16x16x32_bf16 v[138:141], a[4:7], v[186:189], v[138:141]
v_mfma_f32_16x16x32_bf16 v[142:145], a[24:27], v[182:185], 0
v_mfma_f32_16x16x32_bf16 v[142:145], a[28:31], v[186:189], v[142:145]
v_mfma_f32_16x16x32_bf16 v[146:149], a[48:51], v[182:185], 0
v_mfma_f32_16x16x32_bf16 v[146:149], a[52:55], v[186:189], v[146:149]
ds_read_b128 v[170:173], v210 offset:34816
ds_read_b128 v[182:185], v210 offset:35840
s_waitcnt lgkmcnt(1)
v_mfma_f32_16x16x32_bf16 v[138:141], a[8:11], v[170:173], v[138:141]
s_waitcnt lgkmcnt(0)
v_mfma_f32_16x16x32_bf16 v[138:141], a[12:15], v[182:185], v[138:141]
v_mfma_f32_16x16x32_bf16 v[142:145], a[32:35], v[170:173], v[142:145]
v_mfma_f32_16x16x32_bf16 v[142:145], a[36:39], v[182:185], v[142:145]
v_mfma_f32_16x16x32_bf16 v[146:149], a[56:59], v[170:173], v[146:149]
v_mfma_f32_16x16x32_bf16 v[146:149], a[60:63], v[182:185], v[146:149]
ds_read_b128 v[186:189], v210 offset:36864
ds_read_b128 v[170:173], v210 offset:37888
s_waitcnt lgkmcnt(1)
v_mfma_f32_16x16x32_bf16 v[138:141], a[16:19], v[186:189], v[138:141]
s_waitcnt lgkmcnt(0)
v_mfma_f32_16x16x32_bf16 v[138:141], a[20:23], v[170:173], v[138:141]
v_mfma_f32_16x16x32_bf16 v[142:145], a[40:43], v[186:189], v[142:145]
v_mfma_f32_16x16x32_bf16 v[142:145], a[44:47], v[170:173], v[142:145]
v_mfma_f32_16x16x32_bf16 v[146:149], a[64:67], v[186:189], v[146:149]
v_mfma_f32_16x16x32_bf16 v[146:149], a[68:71], v[170:173], v[146:149]
v_cvt_pk_bf16_f32 v102, v138, v139
v_cvt_pk_bf16_f32 v103, v140, v141
v_cvt_pk_bf16_f32 v104, v142, v143
v_cvt_pk_bf16_f32 v105, v144, v145
s_nop 2
v_cvt_pk_bf16_f32 v106, v146, v147
v_cvt_pk_bf16_f32 v107, v148, v149
ds_read_b128 v[108:111], v215 offset:512
ds_read_b64 v[112:113], v215 offset:528
v_mfma_f32_16x16x16_bf16 v[138:141], v[82:83], v[76:77], 0
v_mfma_f32_16x16x16_bf16 v[142:145], v[100:101], v[76:77], 0
s_waitcnt lgkmcnt(0)
v_mfma_f32_16x16x16_bf16 v[150:153], v[112:113], v[76:77], v[206:209]
v_mfma_f32_16x16x16_bf16 v[146:149], v[106:107], v[76:77], 0
v_mfma_f32_16x16x32_bf16 v[138:141], v[78:81], v[72:75], v[138:141]
v_mfma_f32_16x16x32_bf16 v[142:145], v[96:99], v[72:75], v[142:145]
v_mfma_f32_16x16x32_bf16 v[150:153], v[108:111], v[72:75], v[150:153]
v_mfma_f32_16x16x32_bf16 v[146:149], v[102:105], v[72:75], v[146:149]
ds_read_b128 v[72:75], v215
ds_read_b64 v[76:77], v215 offset:16
v_mfma_f32_16x16x16_bf16 v[154:157], v[82:83], v[88:89], 0
v_mfma_f32_16x16x16_bf16 v[158:161], v[100:101], v[88:89], 0
v_mfma_f32_16x16x16_bf16 v[166:169], v[112:113], v[88:89], v[206:209]
v_mfma_f32_16x16x16_bf16 v[162:165], v[106:107], v[88:89], 0
v_mfma_f32_16x16x32_bf16 v[154:157], v[78:81], v[84:87], v[154:157]
v_mfma_f32_16x16x32_bf16 v[158:161], v[96:99], v[84:87], v[158:161]
v_mfma_f32_16x16x32_bf16 v[166:169], v[108:111], v[84:87], v[166:169]
v_mfma_f32_16x16x32_bf16 v[162:165], v[102:105], v[84:87], v[162:165]
ds_read_b128 v[182:185], v210 offset:32768
ds_read_b128 v[186:189], v210 offset:33792
s_waitcnt lgkmcnt(1)
v_mfma_f32_16x16x32_bf16 v[118:121], v[182:185], a[72:75], 0
s_waitcnt lgkmcnt(0)
v_mfma_f32_16x16x32_bf16 v[118:121], v[186:189], a[76:79], v[118:121]
v_mfma_f32_16x16x32_bf16 v[126:129], v[182:185], a[96:99], 0
v_mfma_f32_16x16x32_bf16 v[126:129], v[186:189], a[100:103], v[126:129]
v_mfma_f32_16x16x32_bf16 v[134:137], v[182:185], a[120:123], 0
v_mfma_f32_16x16x32_bf16 v[134:137], v[186:189], a[124:127], v[134:137]
v_mfma_f32_16x16x32_bf16 v[90:93], a[216:219], v[182:185], 0
v_mfma_f32_16x16x32_bf16 v[90:93], a[220:223], v[186:189], v[90:93]
v_mfma_f32_16x16x32_bf16 v[170:173], a[240:243], v[182:185], 0
v_mfma_f32_16x16x32_bf16 v[170:173], a[244:247], v[186:189], v[170:173]
v_mfma_f32_16x16x32_bf16 v[220:223], v[232:235], v[182:185], 0
v_mfma_f32_16x16x32_bf16 v[220:223], v[236:239], v[186:189], v[220:223]
ds_read_b128 v[174:177], v210 offset:34816
ds_read_b128 v[178:181], v210 offset:35840
s_waitcnt lgkmcnt(1)
v_mfma_f32_16x16x32_bf16 v[118:121], v[174:177], a[80:83], v[118:121]
s_waitcnt lgkmcnt(0)
v_mfma_f32_16x16x32_bf16 v[118:121], v[178:181], a[84:87], v[118:121]
v_mfma_f32_16x16x32_bf16 v[126:129], v[174:177], a[104:107], v[126:129]
v_mfma_f32_16x16x32_bf16 v[126:129], v[178:181], a[108:111], v[126:129]
v_mfma_f32_16x16x32_bf16 v[134:137], v[174:177], a[128:131], v[134:137]
v_mfma_f32_16x16x32_bf16 v[134:137], v[178:181], a[132:135], v[134:137]
v_mfma_f32_16x16x32_bf16 v[90:93], a[224:227], v[174:177], v[90:93]
v_mfma_f32_16x16x32_bf16 v[90:93], a[228:231], v[178:181], v[90:93]
v_mfma_f32_16x16x32_bf16 v[170:173], a[248:251], v[174:177], v[170:173]
v_mfma_f32_16x16x32_bf16 v[170:173], a[252:255], v[178:181], v[170:173]
v_mfma_f32_16x16x32_bf16 v[220:223], v[240:243], v[174:177], v[220:223]
v_mfma_f32_16x16x32_bf16 v[220:223], v[244:247], v[178:181], v[220:223]
ds_read_b128 v[182:185], v210 offset:36864
ds_read_b128 v[186:189], v210 offset:37888
s_waitcnt lgkmcnt(1)
v_mfma_f32_16x16x32_bf16 v[118:121], v[182:185], a[88:91], v[118:121]
s_waitcnt lgkmcnt(0)
v_mfma_f32_16x16x32_bf16 v[118:121], v[186:189], a[92:95], v[118:121]
v_mfma_f32_16x16x32_bf16 v[126:129], v[182:185], a[112:115], v[126:129]
v_mfma_f32_16x16x32_bf16 v[126:129], v[186:189], a[116:119], v[126:129]
v_mfma_f32_16x16x32_bf16 v[134:137], v[182:185], a[136:139], v[134:137]
v_mfma_f32_16x16x32_bf16 v[134:137], v[186:189], a[140:143], v[134:137]
v_mfma_f32_16x16x32_bf16 v[90:93], a[232:235], v[182:185], v[90:93]
v_mfma_f32_16x16x32_bf16 v[90:93], a[236:239], v[186:189], v[90:93]
v_mfma_f32_16x16x32_bf16 v[170:173], v[224:227], v[182:185], v[170:173]
v_mfma_f32_16x16x32_bf16 v[170:173], v[228:231], v[186:189], v[170:173]
v_mfma_f32_16x16x32_bf16 v[220:223], v[248:251], v[182:185], v[220:223]
v_mfma_f32_16x16x32_bf16 v[220:223], v[252:255], v[186:189], v[220:223]
v_mov_b32 v181, 0
v_cvt_pk_bf16_f32 v118, v118, v119
v_cvt_pk_bf16_f32 v119, v120, v121
ds_read_u16 v120, v214 offset:1024
v_mov_b32 v121, 0
v_cvt_pk_bf16_f32 v126, v126, v127
v_cvt_pk_bf16_f32 v127, v128, v129
ds_read_u16 v128, v214 offset:1032
v_mov_b32 v129, 0
v_cvt_pk_bf16_f32 v134, v134, v135
v_cvt_pk_bf16_f32 v135, v136, v137
ds_read_u16 v136, v214 offset:1040
v_mov_b32 v137, 0
v_cvt_pk_bf16_f32 v90, v90, v91
v_cvt_pk_bf16_f32 v91, v92, v93
v_cvt_pk_bf16_f32 v92, v170, v171
v_cvt_pk_bf16_f32 v93, v172, v173
v_cvt_pk_bf16_f32 v94, v220, v221
v_cvt_pk_bf16_f32 v95, v222, v223
v_max3_f32 v151, v138, v139, v140
v_max3_f32 v151, v151, v141, v142
v_max3_f32 v151, v151, v143, v144
v_max3_f32 v151, v151, v145, v146
v_max3_f32 v151, v151, v147, v148
v_max3_f32 v151, v151, v149, v150
v_mov_b32 v152, v151
s_nop 1
v_permlane16_swap_b32 v151, v152
v_max_f32 v151, v151, v152
v_mov_b32 v152, v151
s_nop 1
v_permlane32_swap_b32 v151, v152
v_max_f32 v151, v151, v152
v_sub_f32 v138, v138, v151
v_sub_f32 v139, v139, v151
v_sub_f32 v140, v140, v151
v_sub_f32 v141, v141, v151
v_sub_f32 v142, v142, v151
v_sub_f32 v143, v143, v151
v_sub_f32 v144, v144, v151
v_sub_f32 v145, v145, v151
v_sub_f32 v150, v150, v151
v_sub_f32 v146, v146, v151
v_sub_f32 v147, v147, v151
v_sub_f32 v148, v148, v151
v_sub_f32 v149, v149, v151
v_exp_f32 v138, v138
v_exp_f32 v139, v139
v_exp_f32 v140, v140
v_exp_f32 v141, v141
v_exp_f32 v142, v142
v_exp_f32 v143, v143
v_exp_f32 v144, v144
v_exp_f32 v145, v145
v_exp_f32 v150, v150
v_exp_f32 v146, v146
v_exp_f32 v147, v147
v_exp_f32 v148, v148
v_exp_f32 v149, v149
v_cvt_pk_bf16_f32 v174, v138, v139
v_cvt_pk_bf16_f32 v175, v140, v141
v_cvt_pk_bf16_f32 v176, v142, v143
v_cvt_pk_bf16_f32 v177, v144, v145
v_cvt_pk_bf16_f32 v178, v146, v147
v_cvt_pk_bf16_f32 v179, v148, v149
v_cvt_pk_bf16_f32 v180, v150, 0
v_mfma_f32_16x16x32_bf16 v[150:153], v[190:193], v[174:177], 0
v_mfma_f32_16x16x32_bf16 v[150:153], v[190:193], v[178:181], v[150:153]
v_mfma_f32_16x16x32_bf16 v[138:141], v[114:117], v[174:177], 0
s_waitcnt lgkmcnt(2)
v_mfma_f32_16x16x32_bf16 v[138:141], v[118:121], v[178:181], v[138:141]
v_mfma_f32_16x16x32_bf16 v[142:145], v[122:125], v[174:177], 0
s_waitcnt lgkmcnt(1)
v_mfma_f32_16x16x32_bf16 v[142:145], v[126:129], v[178:181], v[142:145]
v_mfma_f32_16x16x32_bf16 v[146:149], v[130:133], v[174:177], 0
s_waitcnt lgkmcnt(0)
v_mfma_f32_16x16x32_bf16 v[146:149], v[134:137], v[178:181], v[146:149]
v_max3_f32 v167, v154, v155, v156
v_max3_f32 v167, v167, v157, v158
v_max3_f32 v167, v167, v159, v160
v_max3_f32 v167, v167, v161, v162
v_max3_f32 v167, v167, v163, v164
v_max3_f32 v167, v167, v165, v166
v_mov_b32 v168, v167
s_nop 1
v_permlane16_swap_b32 v167, v168
v_max_f32 v167, v167, v168
v_mov_b32 v168, v167
s_nop 1
v_permlane32_swap_b32 v167, v168
v_max_f32 v167, v167, v168
v_sub_f32 v154, v154, v167
v_sub_f32 v155, v155, v167
v_sub_f32 v156, v156, v167
v_sub_f32 v157, v157, v167
v_sub_f32 v158, v158, v167
v_sub_f32 v159, v159, v167
v_sub_f32 v160, v160, v167
v_sub_f32 v161, v161, v167
v_sub_f32 v166, v166, v167
v_sub_f32 v162, v162, v167
v_sub_f32 v163, v163, v167
v_sub_f32 v164, v164, v167
v_sub_f32 v165, v165, v167
v_exp_f32 v154, v154
v_exp_f32 v155, v155
v_exp_f32 v156, v156
v_exp_f32 v157, v157
v_exp_f32 v158, v158
v_exp_f32 v159, v159
v_exp_f32 v160, v160
v_exp_f32 v161, v161
v_exp_f32 v166, v166
v_exp_f32 v162, v162
v_exp_f32 v163, v163
v_exp_f32 v164, v164
v_exp_f32 v165, v165
v_cvt_pk_bf16_f32 v174, v154, v155
v_cvt_pk_bf16_f32 v175, v156, v157
v_cvt_pk_bf16_f32 v176, v158, v159
v_cvt_pk_bf16_f32 v177, v160, v161
v_cvt_pk_bf16_f32 v178, v162, v163
v_cvt_pk_bf16_f32 v179, v164, v165
v_cvt_pk_bf16_f32 v180, v166, 0
v_mfma_f32_16x16x32_bf16 v[166:169], v[190:193], v[174:177], 0
v_mfma_f32_16x16x32_bf16 v[166:169], v[190:193], v[178:181], v[166:169]
v_mfma_f32_16x16x32_bf16 v[154:157], v[114:117], v[174:177], 0
v_mfma_f32_16x16x32_bf16 v[154:157], v[118:121], v[178:181], v[154:157]
v_mfma_f32_16x16x32_bf16 v[158:161], v[122:125], v[174:177], 0
v_mfma_f32_16x16x32_bf16 v[158:161], v[126:129], v[178:181], v[158:161]
v_mfma_f32_16x16x32_bf16 v[162:165], v[130:133], v[174:177], 0
v_mfma_f32_16x16x32_bf16 v[162:165], v[134:137], v[178:181], v[162:165]
v_rcp_f32 v151, v150
s_nop 0
v_mul_f32 v151, s3, v151
v_mul_f32 v138, v138, v151
v_mul_f32 v139, v139, v151
v_cvt_pk_bf16_f32 v138, v138, v139
v_mul_f32 v140, v140, v151
v_mul_f32 v141, v141, v151
v_cvt_pk_bf16_f32 v139, v140, v141
v_mul_f32 v142, v142, v151
v_mul_f32 v143, v143, v151
v_cvt_pk_bf16_f32 v140, v142, v143
v_mul_f32 v144, v144, v151
v_mul_f32 v145, v145, v151
v_cvt_pk_bf16_f32 v141, v144, v145
ds_write_b128 v211, v[138:141] offset:38912
v_mul_f32 v146, v146, v151
v_mul_f32 v147, v147, v151
v_cvt_pk_bf16_f32 v142, v146, v147
v_mul_f32 v148, v148, v151
v_mul_f32 v149, v149, v151
v_cvt_pk_bf16_f32 v143, v148, v149
ds_write_b64 v212, v[142:143] offset:38912
v_mfma_f32_16x16x16_bf16 v[138:141], v[82:83], v[94:95], 0
v_mfma_f32_16x16x16_bf16 v[142:145], v[100:101], v[94:95], 0
v_mfma_f32_16x16x16_bf16 v[150:153], v[112:113], v[94:95], v[206:209]
v_mfma_f32_16x16x16_bf16 v[146:149], v[106:107], v[94:95], 0
v_mfma_f32_16x16x32_bf16 v[138:141], v[78:81], v[90:93], v[138:141]
v_mfma_f32_16x16x32_bf16 v[142:145], v[96:99], v[90:93], v[142:145]
v_mfma_f32_16x16x32_bf16 v[150:153], v[108:111], v[90:93], v[150:153]
v_mfma_f32_16x16x32_bf16 v[146:149], v[102:105], v[90:93], v[146:149]
v_rcp_f32 v167, v166
s_nop 0
v_mul_f32 v167, s3, v167
v_mul_f32 v154, v154, v167
v_mul_f32 v155, v155, v167
v_cvt_pk_bf16_f32 v154, v154, v155
v_mul_f32 v156, v156, v167
v_mul_f32 v157, v157, v167
v_cvt_pk_bf16_f32 v155, v156, v157
v_mul_f32 v158, v158, v167
v_mul_f32 v159, v159, v167
v_cvt_pk_bf16_f32 v156, v158, v159
v_mul_f32 v160, v160, v167
v_mul_f32 v161, v161, v167
v_cvt_pk_bf16_f32 v157, v160, v161
ds_write_b128 v211, v[154:157] offset:45056
v_mul_f32 v162, v162, v167
v_mul_f32 v163, v163, v167
v_cvt_pk_bf16_f32 v158, v162, v163
v_mul_f32 v164, v164, v167
v_mul_f32 v165, v165, v167
v_cvt_pk_bf16_f32 v159, v164, v165
ds_write_b64 v212, v[158:159] offset:45056
v_mfma_f32_16x16x16_bf16 v[154:157], v[76:77], v[82:83], 0
v_mfma_f32_16x16x16_bf16 v[158:161], v[76:77], v[100:101], 0
v_mfma_f32_16x16x16_bf16 v[162:165], v[76:77], v[106:107], 0
v_mfma_f32_16x16x16_bf16 v[166:169], v[76:77], v[112:113], v[206:209]
v_mfma_f32_16x16x32_bf16 v[154:157], v[72:75], v[78:81], v[154:157]
v_mfma_f32_16x16x32_bf16 v[158:161], v[72:75], v[96:99], v[158:161]
v_mfma_f32_16x16x32_bf16 v[162:165], v[72:75], v[102:105], v[162:165]
v_mfma_f32_16x16x32_bf16 v[166:169], v[72:75], v[108:111], v[166:169]
v_mov_b32_dpp v154, v158 quad_perm:[0,1,2,3] row_mask:0x2 bank_mask:0xf
s_nop 1
v_mov_b32_dpp v154, v162 quad_perm:[0,1,2,3] row_mask:0x4 bank_mask:0xf
s_nop 2
v_mov_b32_dpp v154, v167 quad_perm:[0,1,2,3] row_mask:0x8 bank_mask:0xf
v_mov_b32 v155, v154
s_nop 1
v_max_f32_dpp v155, v155, v155 row_ror:8 row_mask:0xf bank_mask:0xf
s_nop 1
v_max_f32_dpp v155, v155, v155 row_ror:4 row_mask:0xf bank_mask:0xf
s_nop 1
v_max_f32_dpp v155, v155, v155 row_ror:2 row_mask:0xf bank_mask:0xf
s_nop 1
v_max_f32_dpp v155, v155, v155 row_ror:1 row_mask:0xf bank_mask:0xf
v_mov_b32 v156, v155
s_nop 1
v_permlane16_swap_b32 v155, v156
v_max_f32 v155, v155, v156
v_mov_b32 v156, v155
s_nop 1
v_permlane32_swap_b32 v155, v156
v_max_f32 v155, v155, v156
v_sub_f32 v154, v154, v155
v_exp_f32 v154, v154
s_nop 0
v_cvt_pk_bf16_f32 v154, v154, 0
ds_write_b16 v214, v154
s_waitcnt lgkmcnt(1)
ds_read_b128 v[84:87], v215
ds_read_b128 v[88:91], v215 offset:16
v_add_u32 v215, 1552, v215
s_barrier
ds_read_b128 v[220:223], v210 offset:38912
ds_read_b128 v[110:113], v210 offset:39936
s_waitcnt lgkmcnt(1)
v_mfma_f32_16x16x32_bf16 v[36:39], a[144:147], v[220:223], v[36:39]
s_waitcnt lgkmcnt(0)
v_mfma_f32_16x16x32_bf16 v[36:39], a[148:151], v[110:113], v[36:39]
v_mfma_f32_16x16x32_bf16 v[40:43], a[168:171], v[220:223], v[40:43]
v_mfma_f32_16x16x32_bf16 v[40:43], a[172:175], v[110:113], v[40:43]
v_mfma_f32_16x16x32_bf16 v[44:47], a[192:195], v[220:223], v[44:47]
v_mfma_f32_16x16x32_bf16 v[44:47], a[196:199], v[110:113], v[44:47]
ds_read_b128 v[170:173], v210 offset:40960
ds_read_b128 v[182:185], v210 offset:41984
s_waitcnt lgkmcnt(1)
v_mfma_f32_16x16x32_bf16 v[36:39], a[152:155], v[170:173], v[36:39]
s_waitcnt lgkmcnt(0)
v_mfma_f32_16x16x32_bf16 v[36:39], a[156:159], v[182:185], v[36:39]
v_mfma_f32_16x16x32_bf16 v[40:43], a[176:179], v[170:173], v[40:43]
v_mfma_f32_16x16x32_bf16 v[40:43], a[180:183], v[182:185], v[40:43]
v_mfma_f32_16x16x32_bf16 v[44:47], a[200:203], v[170:173], v[44:47]
v_mfma_f32_16x16x32_bf16 v[44:47], a[204:207], v[182:185], v[44:47]
ds_read_b128 v[186:189], v210 offset:43008
ds_read_b128 v[220:223], v210 offset:44032
s_waitcnt lgkmcnt(1)
v_mfma_f32_16x16x32_bf16 v[36:39], a[160:163], v[186:189], v[36:39]
s_waitcnt lgkmcnt(0)
v_mfma_f32_16x16x32_bf16 v[36:39], a[164:167], v[220:223], v[36:39]
v_mfma_f32_16x16x32_bf16 v[40:43], a[184:187], v[186:189], v[40:43]
v_mfma_f32_16x16x32_bf16 v[40:43], a[188:191], v[220:223], v[40:43]
v_mfma_f32_16x16x32_bf16 v[44:47], a[208:211], v[186:189], v[44:47]
v_mfma_f32_16x16x32_bf16 v[44:47], a[212:215], v[220:223], v[44:47]
v_cvt_pk_bf16_f32 v72, v36, v37
v_cvt_pk_bf16_f32 v73, v38, v39
buffer_store_dwordx2 v[72:73], v203, s[8:11], s39 offen
v_cvt_pk_bf16_f32 v74, v40, v41
v_cvt_pk_bf16_f32 v75, v42, v43
buffer_store_dwordx2 v[74:75], v203, s[8:11], s39 offen offset:32
s_nop 0
v_cvt_pk_bf16_f32 v76, v44, v45
v_cvt_pk_bf16_f32 v77, v46, v47
buffer_store_dwordx2 v[76:77], v203, s[8:11], s39 offen offset:64
v_max3_f32 v151, v138, v139, v140
v_max3_f32 v151, v151, v141, v142
v_max3_f32 v151, v151, v143, v144
v_max3_f32 v151, v151, v145, v146
v_max3_f32 v151, v151, v147, v148
v_max3_f32 v151, v151, v149, v150
v_mov_b32 v152, v151
s_nop 1
v_permlane16_swap_b32 v151, v152
v_max_f32 v151, v151, v152
v_mov_b32 v152, v151
s_nop 1
v_permlane32_swap_b32 v151, v152
v_max_f32 v151, v151, v152
v_sub_f32 v138, v138, v151
v_sub_f32 v139, v139, v151
v_sub_f32 v140, v140, v151
v_sub_f32 v141, v141, v151
v_sub_f32 v142, v142, v151
v_sub_f32 v143, v143, v151
v_sub_f32 v144, v144, v151
v_sub_f32 v145, v145, v151
v_sub_f32 v150, v150, v151
v_sub_f32 v146, v146, v151
v_sub_f32 v147, v147, v151
v_sub_f32 v148, v148, v151
v_sub_f32 v149, v149, v151
v_exp_f32 v138, v138
v_exp_f32 v139, v139
v_exp_f32 v140, v140
v_exp_f32 v141, v141
v_exp_f32 v142, v142
v_exp_f32 v143, v143
v_exp_f32 v144, v144
v_exp_f32 v145, v145
v_exp_f32 v150, v150
v_exp_f32 v146, v146
v_exp_f32 v147, v147
v_exp_f32 v148, v148
v_exp_f32 v149, v149
v_cvt_pk_bf16_f32 v174, v138, v139
v_cvt_pk_bf16_f32 v175, v140, v141
v_cvt_pk_bf16_f32 v176, v142, v143
v_cvt_pk_bf16_f32 v177, v144, v145
v_cvt_pk_bf16_f32 v178, v146, v147
v_cvt_pk_bf16_f32 v179, v148, v149
v_cvt_pk_bf16_f32 v180, v150, 0
v_mfma_f32_16x16x32_bf16 v[150:153], v[190:193], v[174:177], 0
v_mfma_f32_16x16x32_bf16 v[150:153], v[190:193], v[178:181], v[150:153]
v_mfma_f32_16x16x32_bf16 v[138:141], v[114:117], v[174:177], 0
v_mfma_f32_16x16x32_bf16 v[138:141], v[118:121], v[178:181], v[138:141]
v_mfma_f32_16x16x32_bf16 v[142:145], v[122:125], v[174:177], 0
v_mfma_f32_16x16x32_bf16 v[142:145], v[126:129], v[178:181], v[142:145]
v_mfma_f32_16x16x32_bf16 v[146:149], v[130:133], v[174:177], 0
v_mfma_f32_16x16x32_bf16 v[146:149], v[134:137], v[178:181], v[146:149]
v_mfma_f32_16x16x32_bf16 v[166:169], v[84:87], v[190:193], 0
v_mfma_f32_16x16x32_bf16 v[166:169], v[88:91], v[190:193], v[166:169]
v_mfma_f32_16x16x32_bf16 v[154:157], v[84:87], v[114:117], 0
v_mfma_f32_16x16x32_bf16 v[154:157], v[88:91], v[118:121], v[154:157]
v_mfma_f32_16x16x32_bf16 v[158:161], v[84:87], v[122:125], 0
v_mfma_f32_16x16x32_bf16 v[158:161], v[88:91], v[126:129], v[158:161]
v_mfma_f32_16x16x32_bf16 v[162:165], v[84:87], v[130:133], 0
v_mfma_f32_16x16x32_bf16 v[162:165], v[88:91], v[134:137], v[162:165]
v_rcp_f32 v167, v166
v_mov_b32_dpp v154, v158 quad_perm:[0,1,2,3] row_mask:0x2 bank_mask:0xf
s_nop 3
v_mov_b32_dpp v154, v162 quad_perm:[0,1,2,3] row_mask:0x4 bank_mask:0xf
v_mul_f32 v167, s3, v167
v_mul_f32 v154, v154, v167
v_cvt_pk_bf16_f32 v154, v154, 0
ds_write_b16 v214, v154
v_add_u32 v214, 1552, v214
ds_read_b128 v[110:113], v210 offset:45056
ds_read_b128 v[170:173], v210 offset:46080
s_waitcnt lgkmcnt(1)
v_mfma_f32_16x16x32_bf16 v[48:51], a[144:147], v[110:113], v[48:51]
s_waitcnt lgkmcnt(0)
v_mfma_f32_16x16x32_bf16 v[48:51], a[148:151], v[170:173], v[48:51]
v_mfma_f32_16x16x32_bf16 v[52:55], a[168:171], v[110:113], v[52:55]
v_mfma_f32_16x16x32_bf16 v[52:55], a[172:175], v[170:173], v[52:55]
v_mfma_f32_16x16x32_bf16 v[56:59], a[192:195], v[110:113], v[56:59]
v_mfma_f32_16x16x32_bf16 v[56:59], a[196:199], v[170:173], v[56:59]
ds_read_b128 v[182:185], v210 offset:47104
ds_read_b128 v[186:189], v210 offset:48128
s_waitcnt lgkmcnt(1)
v_mfma_f32_16x16x32_bf16 v[48:51], a[152:155], v[182:185], v[48:51]
s_waitcnt lgkmcnt(0)
v_mfma_f32_16x16x32_bf16 v[48:51], a[156:159], v[186:189], v[48:51]
v_mfma_f32_16x16x32_bf16 v[52:55], a[176:179], v[182:185], v[52:55]
v_mfma_f32_16x16x32_bf16 v[52:55], a[180:183], v[186:189], v[52:55]
v_mfma_f32_16x16x32_bf16 v[56:59], a[200:203], v[182:185], v[56:59]
v_mfma_f32_16x16x32_bf16 v[56:59], a[204:207], v[186:189], v[56:59]
ds_read_b128 v[220:223], v210 offset:49152
ds_read_b128 v[110:113], v210 offset:50176
s_waitcnt lgkmcnt(1)
v_mfma_f32_16x16x32_bf16 v[48:51], a[160:163], v[220:223], v[48:51]
s_waitcnt lgkmcnt(0)
v_mfma_f32_16x16x32_bf16 v[48:51], a[164:167], v[110:113], v[48:51]
v_mfma_f32_16x16x32_bf16 v[52:55], a[184:187], v[220:223], v[52:55]
v_mfma_f32_16x16x32_bf16 v[52:55], a[188:191], v[110:113], v[52:55]
v_mfma_f32_16x16x32_bf16 v[56:59], a[208:211], v[220:223], v[56:59]
v_mfma_f32_16x16x32_bf16 v[56:59], a[212:215], v[110:113], v[56:59]
v_cvt_pk_bf16_f32 v78, v48, v49
v_cvt_pk_bf16_f32 v79, v50, v51
buffer_store_dwordx2 v[78:79], v204, s[8:11], s39 offen
v_cvt_pk_bf16_f32 v80, v52, v53
v_cvt_pk_bf16_f32 v81, v54, v55
buffer_store_dwordx2 v[80:81], v204, s[8:11], s39 offen offset:32
s_nop 0
v_cvt_pk_bf16_f32 v82, v56, v57
v_cvt_pk_bf16_f32 v83, v58, v59
buffer_store_dwordx2 v[82:83], v204, s[8:11], s39 offen offset:64
v_rcp_f32 v151, v150
s_nop 0
v_mul_f32 v151, s3, v151
v_mul_f32 v138, v138, v151
v_mul_f32 v139, v139, v151
v_cvt_pk_bf16_f32 v138, v138, v139
v_mul_f32 v140, v140, v151
v_mul_f32 v141, v141, v151
v_cvt_pk_bf16_f32 v139, v140, v141
v_mul_f32 v142, v142, v151
v_mul_f32 v143, v143, v151
v_cvt_pk_bf16_f32 v140, v142, v143
v_mul_f32 v144, v144, v151
v_mul_f32 v145, v145, v151
v_cvt_pk_bf16_f32 v141, v144, v145
ds_write_b128 v211, v[138:141] offset:51200
v_mul_f32 v146, v146, v151
v_mul_f32 v147, v147, v151
v_cvt_pk_bf16_f32 v142, v146, v147
v_mul_f32 v148, v148, v151
v_mul_f32 v149, v149, v151
v_cvt_pk_bf16_f32 v143, v148, v149
ds_write_b64 v212, v[142:143] offset:51200
s_waitcnt vmcnt(6) lgkmcnt(0)
s_barrier
ds_read_b128 v[170:173], v210 offset:51200
ds_read_b128 v[182:185], v210 offset:52224
s_waitcnt lgkmcnt(1)
v_mfma_f32_16x16x32_bf16 v[60:63], a[144:147], v[170:173], v[60:63]
s_waitcnt lgkmcnt(0)
v_mfma_f32_16x16x32_bf16 v[60:63], a[148:151], v[182:185], v[60:63]
v_mfma_f32_16x16x32_bf16 v[64:67], a[168:171], v[170:173], v[64:67]
v_mfma_f32_16x16x32_bf16 v[64:67], a[172:175], v[182:185], v[64:67]
v_mfma_f32_16x16x32_bf16 v[68:71], a[192:195], v[170:173], v[68:71]
v_mfma_f32_16x16x32_bf16 v[68:71], a[196:199], v[182:185], v[68:71]
ds_read_b128 v[186:189], v210 offset:53248
ds_read_b128 v[220:223], v210 offset:54272
s_waitcnt lgkmcnt(1)
v_mfma_f32_16x16x32_bf16 v[60:63], a[152:155], v[186:189], v[60:63]
s_waitcnt lgkmcnt(0)
v_mfma_f32_16x16x32_bf16 v[60:63], a[156:159], v[220:223], v[60:63]
v_mfma_f32_16x16x32_bf16 v[64:67], a[176:179], v[186:189], v[64:67]
v_mfma_f32_16x16x32_bf16 v[64:67], a[180:183], v[220:223], v[64:67]
v_mfma_f32_16x16x32_bf16 v[68:71], a[200:203], v[186:189], v[68:71]
v_mfma_f32_16x16x32_bf16 v[68:71], a[204:207], v[220:223], v[68:71]
ds_read_b128 v[110:113], v210 offset:55296
ds_read_b128 v[170:173], v210 offset:56320
s_waitcnt lgkmcnt(1)
v_mfma_f32_16x16x32_bf16 v[60:63], a[160:163], v[110:113], v[60:63]
s_waitcnt lgkmcnt(0)
v_mfma_f32_16x16x32_bf16 v[60:63], a[164:167], v[170:173], v[60:63]
v_mfma_f32_16x16x32_bf16 v[64:67], a[184:187], v[110:113], v[64:67]
v_mfma_f32_16x16x32_bf16 v[64:67], a[188:191], v[170:173], v[64:67]
v_mfma_f32_16x16x32_bf16 v[68:71], a[208:211], v[110:113], v[68:71]
v_mfma_f32_16x16x32_bf16 v[68:71], a[212:215], v[170:173], v[68:71]
v_cvt_pk_bf16_f32 v116, v60, v61
v_cvt_pk_bf16_f32 v117, v62, v63
buffer_store_dwordx2 v[116:117], v205, s[8:11], s39 offen
v_cvt_pk_bf16_f32 v124, v64, v65
v_cvt_pk_bf16_f32 v125, v66, v67
buffer_store_dwordx2 v[124:125], v205, s[8:11], s39 offen offset:32
s_nop 0
v_cvt_pk_bf16_f32 v132, v68, v69
v_cvt_pk_bf16_f32 v133, v70, v71
buffer_store_dwordx2 v[132:133], v205, s[8:11], s39 offen offset:64
s_mov_b32 s38, s36
ds_read_b128 v[174:177], v217
ds_read_b128 v[84:87], v200
s_waitcnt lgkmcnt(0)
v_mfma_f32_16x16x32_bf16 v[36:39], v[174:177], v[84:87], 0
ds_read_b128 v[92:95], v201
s_waitcnt lgkmcnt(0)
v_mfma_f32_16x16x32_bf16 v[48:51], v[174:177], v[92:95], 0
ds_read_b128 v[100:103], v202
s_waitcnt lgkmcnt(0)
v_mfma_f32_16x16x32_bf16 v[60:63], v[174:177], v[100:103], 0
ds_read_b128 v[178:181], v217 offset:528
ds_read_b128 v[84:87], v194
ds_read_b128 v[88:91], v194 offset:16
s_waitcnt lgkmcnt(0)
v_smfmac_f32_16x16x64_bf16 v[36:39], v[178:181], v[84:91], v213
ds_read_b128 v[92:95], v195
ds_read_b128 v[96:99], v195 offset:16
s_waitcnt lgkmcnt(0)
v_smfmac_f32_16x16x64_bf16 v[48:51], v[178:181], v[92:99], v213
ds_read_b128 v[100:103], v196
ds_read_b128 v[104:107], v196 offset:16
s_waitcnt lgkmcnt(0)
v_smfmac_f32_16x16x64_bf16 v[60:63], v[178:181], v[100:107], v213
ds_read_b128 v[174:177], v217 offset:1056
ds_read_b128 v[84:87], v197
ds_read_b128 v[88:91], v197 offset:16
s_waitcnt lgkmcnt(0)
v_smfmac_f32_16x16x64_bf16 v[36:39], v[174:177], v[84:91], v213
ds_read_b128 v[92:95], v198
ds_read_b128 v[96:99], v198 offset:16
s_waitcnt lgkmcnt(0)
v_smfmac_f32_16x16x64_bf16 v[48:51], v[174:177], v[92:99], v213
ds_read_b128 v[100:103], v199
ds_read_b128 v[104:107], v199 offset:16
s_waitcnt lgkmcnt(0)
v_smfmac_f32_16x16x64_bf16 v[60:63], v[174:177], v[100:107], v213
ds_read_b128 v[178:181], v217 offset:1584
ds_read_b128 v[84:87], v200 offset:32
s_waitcnt lgkmcnt(0)
v_mfma_f32_16x16x32_bf16 v[40:43], v[178:181], v[84:87], 0
ds_read_b128 v[92:95], v201 offset:32
s_waitcnt lgkmcnt(0)
v_mfma_f32_16x16x32_bf16 v[52:55], v[178:181], v[92:95], 0
ds_read_b128 v[100:103], v202 offset:32
s_waitcnt lgkmcnt(0)
v_mfma_f32_16x16x32_bf16 v[64:67], v[178:181], v[100:103], 0
ds_read_b128 v[174:177], v217 offset:2112
ds_read_b128 v[84:87], v194 offset:32
ds_read_b128 v[88:91], v194 offset:48
s_waitcnt lgkmcnt(0)
v_smfmac_f32_16x16x64_bf16 v[40:43], v[174:177], v[84:91], v213
ds_read_b128 v[92:95], v195 offset:32
ds_read_b128 v[96:99], v195 offset:48
s_waitcnt lgkmcnt(0)
v_smfmac_f32_16x16x64_bf16 v[52:55], v[174:177], v[92:99], v213
ds_read_b128 v[100:103], v196 offset:32
ds_read_b128 v[104:107], v196 offset:48
s_waitcnt lgkmcnt(0)
v_smfmac_f32_16x16x64_bf16 v[64:67], v[174:177], v[100:107], v213
ds_read_b128 v[178:181], v217 offset:2640
ds_read_b128 v[84:87], v197 offset:32
ds_read_b128 v[88:91], v197 offset:48
s_waitcnt lgkmcnt(0)
v_smfmac_f32_16x16x64_bf16 v[40:43], v[178:181], v[84:91], v213
ds_read_b128 v[92:95], v198 offset:32
ds_read_b128 v[96:99], v198 offset:48
s_waitcnt lgkmcnt(0)
v_smfmac_f32_16x16x64_bf16 v[52:55], v[178:181], v[92:99], v213
ds_read_b128 v[100:103], v199 offset:32
ds_read_b128 v[104:107], v199 offset:48
s_waitcnt lgkmcnt(0)
v_smfmac_f32_16x16x64_bf16 v[64:67], v[178:181], v[100:107], v213
ds_read_b128 v[174:177], v217 offset:3168
ds_read_b128 v[84:87], v200 offset:64
s_waitcnt lgkmcnt(0)
v_mfma_f32_16x16x32_bf16 v[44:47], v[174:177], v[84:87], 0
ds_read_b128 v[92:95], v201 offset:64
s_waitcnt lgkmcnt(0)
v_mfma_f32_16x16x32_bf16 v[56:59], v[174:177], v[92:95], 0
ds_read_b128 v[100:103], v202 offset:64
s_waitcnt lgkmcnt(0)
v_mfma_f32_16x16x32_bf16 v[68:71], v[174:177], v[100:103], 0
ds_read_b128 v[178:181], v217 offset:3696
ds_read_b128 v[84:87], v194 offset:64
ds_read_b128 v[88:91], v194 offset:80
s_waitcnt lgkmcnt(0)
v_smfmac_f32_16x16x64_bf16 v[44:47], v[178:181], v[84:91], v213
ds_read_b128 v[92:95], v195 offset:64
ds_read_b128 v[96:99], v195 offset:80
s_waitcnt lgkmcnt(0)
v_smfmac_f32_16x16x64_bf16 v[56:59], v[178:181], v[92:99], v213
ds_read_b128 v[100:103], v196 offset:64
ds_read_b128 v[104:107], v196 offset:80
s_waitcnt lgkmcnt(0)
v_smfmac_f32_16x16x64_bf16 v[68:71], v[178:181], v[100:107], v213
ds_read_b128 v[174:177], v217 offset:4224
ds_read_b128 v[84:87], v197 offset:64
ds_read_b128 v[88:91], v197 offset:80
s_waitcnt lgkmcnt(0)
v_smfmac_f32_16x16x64_bf16 v[44:47], v[174:177], v[84:91], v213
ds_read_b128 v[92:95], v198 offset:64
ds_read_b128 v[96:99], v198 offset:80
s_waitcnt lgkmcnt(0)
v_smfmac_f32_16x16x64_bf16 v[56:59], v[174:177], v[92:99], v213
ds_read_b128 v[100:103], v199 offset:64
ds_read_b128 v[104:107], v199 offset:80
s_waitcnt lgkmcnt(0)
v_smfmac_f32_16x16x64_bf16 v[68:71], v[174:177], v[100:107], v213
v_add_f32 v118, v36, v37
v_mul_f32 v119, v36, v36
v_add_f32 v118, v118, v38
v_fmac_f32 v119, v37, v37
v_add_f32 v118, v118, v39
v_fmac_f32 v119, v38, v38
v_fmac_f32 v119, v39, v39
v_add_f32 v126, v48, v49
v_mul_f32 v127, v48, v48
v_add_f32 v126, v126, v50
v_fmac_f32 v127, v49, v49
v_add_f32 v126, v126, v51
v_fmac_f32 v127, v50, v50
v_fmac_f32 v127, v51, v51
v_add_f32 v134, v60, v61
v_mul_f32 v135, v60, v60
v_add_f32 v134, v134, v62
v_fmac_f32 v135, v61, v61
v_add_f32 v134, v134, v63
v_fmac_f32 v135, v62, v62
v_fmac_f32 v135, v63, v63
v_add_f32 v118, v118, v40
v_fmac_f32 v119, v40, v40
v_add_f32 v118, v118, v41
v_fmac_f32 v119, v41, v41
v_add_f32 v118, v118, v42
v_fmac_f32 v119, v42, v42
v_add_f32 v118, v118, v43
v_fmac_f32 v119, v43, v43
v_add_f32 v126, v126, v52
v_fmac_f32 v127, v52, v52
v_add_f32 v126, v126, v53
v_fmac_f32 v127, v53, v53
v_add_f32 v126, v126, v54
v_fmac_f32 v127, v54, v54
v_add_f32 v126, v126, v55
v_fmac_f32 v127, v55, v55
v_add_f32 v134, v134, v64
v_fmac_f32 v135, v64, v64
v_add_f32 v134, v134, v65
v_fmac_f32 v135, v65, v65
v_add_f32 v134, v134, v66
v_fmac_f32 v135, v66, v66
v_add_f32 v134, v134, v67
v_fmac_f32 v135, v67, v67
v_add_f32 v118, v118, v44
v_fmac_f32 v119, v44, v44
v_add_f32 v118, v118, v45
v_fmac_f32 v119, v45, v45
v_add_f32 v118, v118, v46
v_fmac_f32 v119, v46, v46
v_add_f32 v118, v118, v47
v_fmac_f32 v119, v47, v47
v_add_f32 v126, v126, v56
v_fmac_f32 v127, v56, v56
v_add_f32 v126, v126, v57
v_fmac_f32 v127, v57, v57
v_add_f32 v126, v126, v58
v_fmac_f32 v127, v58, v58
v_add_f32 v126, v126, v59
v_fmac_f32 v127, v59, v59
v_add_f32 v134, v134, v68
v_fmac_f32 v135, v68, v68
v_add_f32 v134, v134, v69
v_fmac_f32 v135, v69, v69
v_add_f32 v134, v134, v70
v_fmac_f32 v135, v70, v70
v_add_f32 v134, v134, v71
v_fmac_f32 v135, v71, v71
v_permlane16_swap_b32 v118, v119
v_add_f32 v118, v118, v119
v_permlane16_swap_b32 v126, v127
v_add_f32 v126, v126, v127
v_permlane16_swap_b32 v134, v135
v_add_f32 v134, v134, v135
v_permlane32_swap_b32 v118, v126
v_add_f32 v118, v118, v126
ds_write_b32 v209, v118
v_mov_b32 v135, v134
s_nop 1
v_permlane32_swap_b32 v134, v135
v_add_f32 v134, v134, v135
ds_write_b32 v209, v134 offset:512
s_waitcnt lgkmcnt(0)
s_barrier
s_mul_hi_u32 s41, s35, 58835169
s_mul_i32 s42, s41, 73
s_sub_u32 s42, s35, s42
s_mul_i32 s43, s41, 1373568
s_mul_i32 s51, s42, 2688
s_add_u32 s43, s43, s51
s_cmp_lt_u32 s35, s34
s_cselect_b32 s50, s43, 1879048192
s_add_u32 s35, s35, 32
s_cmp_eq_u32 s42, 0
s_cselect_b32 s44, 536870911, s72
s_cmp_eq_u32 s42, 72
s_cselect_b32 s44, 939524095, s44
s_cmp_eq_u32 s41, 0
s_cselect_b32 s52, 1879048192, s50
s_mov_b32 s36, s50
v_and_b32 v216, s44, v208
s_add_u32 m0, s45, 0
s_nop 0
buffer_load_dwordx4 v216, s[4:7], s52 offen nt lds
s_add_u32 m0, s45, 4112
s_add_u32 s40, s36, 196224
buffer_load_dwordx4 v216, s[4:7], s40 offen nt lds
s_add_u32 m0, s45, 8224
s_add_u32 s40, s36, 392448
buffer_load_dwordx4 v216, s[4:7], s40 offen nt lds
s_add_u32 m0, s45, 12336
s_add_u32 s40, s36, 588672
buffer_load_dwordx4 v216, s[4:7], s40 offen nt lds
s_add_u32 m0, s45, 16448
s_add_u32 s40, s36, 784896
buffer_load_dwordx4 v216, s[4:7], s40 offen nt lds
s_add_u32 m0, s45, 20560
s_add_u32 s40, s36, 981120
buffer_load_dwordx4 v216, s[4:7], s40 offen nt lds
s_add_u32 m0, s45, 24672
s_add_u32 s40, s36, 1177344
buffer_load_dwordx4 v216, s[4:7], s40 offen nt lds
s_add_u32 m0, s45, 28784
s_add_u32 s40, s36, 1373568
buffer_load_dwordx4 v216, s[4:7], s40 offen nt lds
s_add_u32 m0, s45, 32896
s_add_u32 s40, s36, 1569792
buffer_load_dwordx4 v216, s[4:7], s40 offen nt lds
ds_read_b128 v[182:185], v210
ds_read_b128 v[186:189], v210 offset:1024
s_waitcnt lgkmcnt(1)
v_mfma_f32_16x16x32_bf16 v[138:141], a[0:3], v[182:185], 0
s_waitcnt lgkmcnt(0)
v_mfma_f32_16x16x32_bf16 v[138:141], a[4:7], v[186:189], v[138:141]
v_mfma_f32_16x16x32_bf16 v[142:145], a[24:27], v[182:185], 0
v_mfma_f32_16x16x32_bf16 v[142:145], a[28:31], v[186:189], v[142:145]
v_mfma_f32_16x16x32_bf16 v[146:149], a[48:51], v[182:185], 0
v_mfma_f32_16x16x32_bf16 v[146:149], a[52:55], v[186:189], v[146:149]
v_mfma_f32_16x16x32_bf16 v[150:153], a[216:219], v[182:185], 0
v_mfma_f32_16x16x32_bf16 v[150:153], a[220:223], v[186:189], v[150:153]
v_mfma_f32_16x16x32_bf16 v[154:157], a[240:243], v[182:185], 0
v_mfma_f32_16x16x32_bf16 v[154:157], a[244:247], v[186:189], v[154:157]
v_mfma_f32_16x16x32_bf16 v[158:161], v[232:235], v[182:185], 0
v_mfma_f32_16x16x32_bf16 v[158:161], v[236:239], v[186:189], v[158:161]
v_mfma_f32_16x16x32_bf16 v[162:165], v[182:185], a[72:75], 0
v_mfma_f32_16x16x32_bf16 v[162:165], v[186:189], a[76:79], v[162:165]
v_mfma_f32_16x16x32_bf16 v[166:169], v[182:185], a[96:99], 0
v_mfma_f32_16x16x32_bf16 v[166:169], v[186:189], a[100:103], v[166:169]
v_mfma_f32_16x16x32_bf16 v[170:173], v[182:185], a[120:123], 0
v_mfma_f32_16x16x32_bf16 v[170:173], v[186:189], a[124:127], v[170:173]
ds_read_b128 v[110:113], v210 offset:2048
ds_read_b128 v[220:223], v210 offset:3072
s_waitcnt lgkmcnt(1)
v_mfma_f32_16x16x32_bf16 v[138:141], a[8:11], v[110:113], v[138:141]
s_waitcnt lgkmcnt(0)
v_mfma_f32_16x16x32_bf16 v[138:141], a[12:15], v[220:223], v[138:141]
v_mfma_f32_16x16x32_bf16 v[142:145], a[32:35], v[110:113], v[142:145]
v_mfma_f32_16x16x32_bf16 v[142:145], a[36:39], v[220:223], v[142:145]
v_mfma_f32_16x16x32_bf16 v[146:149], a[56:59], v[110:113], v[146:149]
v_mfma_f32_16x16x32_bf16 v[146:149], a[60:63], v[220:223], v[146:149]
v_mfma_f32_16x16x32_bf16 v[150:153], a[224:227], v[110:113], v[150:153]
v_mfma_f32_16x16x32_bf16 v[150:153], a[228:231], v[220:223], v[150:153]
v_mfma_f32_16x16x32_bf16 v[154:157], a[248:251], v[110:113], v[154:157]
v_mfma_f32_16x16x32_bf16 v[154:157], a[252:255], v[220:223], v[154:157]
v_mfma_f32_16x16x32_bf16 v[158:161], v[240:243], v[110:113], v[158:161]
v_mfma_f32_16x16x32_bf16 v[158:161], v[244:247], v[220:223], v[158:161]
v_mfma_f32_16x16x32_bf16 v[162:165], v[110:113], a[80:83], v[162:165]
v_mfma_f32_16x16x32_bf16 v[162:165], v[220:223], a[84:87], v[162:165]
v_mfma_f32_16x16x32_bf16 v[166:169], v[110:113], a[104:107], v[166:169]
v_mfma_f32_16x16x32_bf16 v[166:169], v[220:223], a[108:111], v[166:169]
v_mfma_f32_16x16x32_bf16 v[170:173], v[110:113], a[128:131], v[170:173]
v_mfma_f32_16x16x32_bf16 v[170:173], v[220:223], a[132:135], v[170:173]
ds_read_b128 v[182:185], v210 offset:4096
ds_read_b128 v[186:189], v210 offset:5120
s_waitcnt lgkmcnt(1)
v_mfma_f32_16x16x32_bf16 v[138:141], a[16:19], v[182:185], v[138:141]
s_waitcnt lgkmcnt(0)
v_mfma_f32_16x16x32_bf16 v[138:141], a[20:23], v[186:189], v[138:141]
v_mfma_f32_16x16x32_bf16 v[142:145], a[40:43], v[182:185], v[142:145]
v_mfma_f32_16x16x32_bf16 v[142:145], a[44:47], v[186:189], v[142:145]
v_mfma_f32_16x16x32_bf16 v[146:149], a[64:67], v[182:185], v[146:149]
v_mfma_f32_16x16x32_bf16 v[146:149], a[68:71], v[186:189], v[146:149]
v_mfma_f32_16x16x32_bf16 v[150:153], a[232:235], v[182:185], v[150:153]
v_mfma_f32_16x16x32_bf16 v[150:153], a[236:239], v[186:189], v[150:153]
v_mfma_f32_16x16x32_bf16 v[154:157], v[224:227], v[182:185], v[154:157]
v_mfma_f32_16x16x32_bf16 v[154:157], v[228:231], v[186:189], v[154:157]
v_mfma_f32_16x16x32_bf16 v[158:161], v[248:251], v[182:185], v[158:161]
v_mfma_f32_16x16x32_bf16 v[158:161], v[252:255], v[186:189], v[158:161]
v_mfma_f32_16x16x32_bf16 v[162:165], v[182:185], a[88:91], v[162:165]
v_mfma_f32_16x16x32_bf16 v[162:165], v[186:189], a[92:95], v[162:165]
v_mfma_f32_16x16x32_bf16 v[166:169], v[182:185], a[112:115], v[166:169]
v_mfma_f32_16x16x32_bf16 v[166:169], v[186:189], a[116:119], v[166:169]
v_mfma_f32_16x16x32_bf16 v[170:173], v[182:185], a[136:139], v[170:173]
v_mfma_f32_16x16x32_bf16 v[170:173], v[186:189], a[140:143], v[170:173]
v_cvt_pk_bf16_f32 v78, v138, v139
v_cvt_pk_bf16_f32 v79, v140, v141
v_cvt_pk_bf16_f32 v80, v142, v143
v_cvt_pk_bf16_f32 v81, v144, v145
v_cvt_pk_bf16_f32 v82, v146, v147
v_cvt_pk_bf16_f32 v83, v148, v149
v_cvt_pk_bf16_f32 v72, v150, v151
v_cvt_pk_bf16_f32 v73, v152, v153
v_cvt_pk_bf16_f32 v74, v154, v155
v_cvt_pk_bf16_f32 v75, v156, v157
v_cvt_pk_bf16_f32 v76, v158, v159
v_cvt_pk_bf16_f32 v77, v160, v161
v_cvt_pk_bf16_f32 v114, v162, v163
v_cvt_pk_bf16_f32 v115, v164, v165
v_cvt_pk_bf16_f32 v122, v166, v167
v_cvt_pk_bf16_f32 v123, v168, v169
v_cvt_pk_bf16_f32 v130, v170, v171
v_cvt_pk_bf16_f32 v131, v172, v173
ds_read_b128 v[110:113], v210 offset:6144
ds_read_b128 v[220:223], v210 offset:7168
s_waitcnt lgkmcnt(1)
v_mfma_f32_16x16x32_bf16 v[138:141], a[0:3], v[110:113], 0
s_waitcnt lgkmcnt(0)
v_mfma_f32_16x16x32_bf16 v[138:141], a[4:7], v[220:223], v[138:141]
v_mfma_f32_16x16x32_bf16 v[142:145], a[24:27], v[110:113], 0
v_mfma_f32_16x16x32_bf16 v[142:145], a[28:31], v[220:223], v[142:145]
v_mfma_f32_16x16x32_bf16 v[146:149], a[48:51], v[110:113], 0
v_mfma_f32_16x16x32_bf16 v[146:149], a[52:55], v[220:223], v[146:149]
v_mfma_f32_16x16x32_bf16 v[150:153], a[216:219], v[110:113], 0
v_mfma_f32_16x16x32_bf16 v[150:153], a[220:223], v[220:223], v[150:153]
v_mfma_f32_16x16x32_bf16 v[154:157], a[240:243], v[110:113], 0
v_mfma_f32_16x16x32_bf16 v[154:157], a[244:247], v[220:223], v[154:157]
v_mfma_f32_16x16x32_bf16 v[158:161], v[232:235], v[110:113], 0
v_mfma_f32_16x16x32_bf16 v[158:161], v[236:239], v[220:223], v[158:161]
v_mfma_f32_16x16x32_bf16 v[162:165], v[110:113], a[72:75], 0
v_mfma_f32_16x16x32_bf16 v[162:165], v[220:223], a[76:79], v[162:165]
v_mfma_f32_16x16x32_bf16 v[166:169], v[110:113], a[96:99], 0
v_mfma_f32_16x16x32_bf16 v[166:169], v[220:223], a[100:103], v[166:169]
v_mfma_f32_16x16x32_bf16 v[170:173], v[110:113], a[120:123], 0
v_mfma_f32_16x16x32_bf16 v[170:173], v[220:223], a[124:127], v[170:173]
ds_read_b128 v[102:105], v210 offset:18432
ds_read_b128 v[106:109], v210 offset:19456
s_waitcnt lgkmcnt(1)
v_add_f32 v102, v102, v103
s_waitcnt lgkmcnt(0)
v_add_f32 v106, v106, v107
v_add_f32 v104, v104, v105
v_add_f32 v108, v108, v109
v_add_f32 v102, v102, v104
v_add_f32 v106, v106, v108
v_mul_f32 v103, s48, v102
v_mul_f32 v104, s73, v102
v_mul_f32 v106, s73, v106
v_fma_f32 v106, -v103, v104, v106
v_max_f32 v106, 0, v106
v_add_f32 v106, s49, v106
v_rsq_f32 v102, v106
s_nop 0
v_mul_f32_e64 v103, -v103, v102
ds_write_b64 v211, v[102:103] offset:20480
ds_read_b64 v[118:119], v219 offset:20480
ds_read_b64 v[126:127], v219 offset:20736
ds_read_b64 v[134:135], v219 offset:20992
s_waitcnt lgkmcnt(2)
v_fma_f32 v220, v36, v118, v119
v_fma_f32 v221, v37, v118, v119
v_cvt_pk_bf16_f32 v90, v220, v221
v_fma_f32 v222, v38, v118, v119
v_fma_f32 v223, v39, v118, v119
v_cvt_pk_bf16_f32 v91, v222, v223
v_fma_f32 v220, v40, v118, v119
v_fma_f32 v221, v41, v118, v119
v_cvt_pk_bf16_f32 v92, v220, v221
v_fma_f32 v222, v42, v118, v119
v_fma_f32 v223, v43, v118, v119
v_cvt_pk_bf16_f32 v93, v222, v223
ds_write_b128 v211, v[90:93] offset:20480
v_fma_f32 v220, v44, v118, v119
v_fma_f32 v221, v45, v118, v119
v_cvt_pk_bf16_f32 v94, v220, v221
v_fma_f32 v222, v46, v118, v119
v_fma_f32 v223, v47, v118, v119
v_cvt_pk_bf16_f32 v95, v222, v223
s_waitcnt lgkmcnt(2)
ds_write_b64 v212, v[94:95] offset:20480
v_fma_f32 v220, v48, v126, v127
v_fma_f32 v221, v49, v126, v127
v_cvt_pk_bf16_f32 v174, v220, v221
v_fma_f32 v222, v50, v126, v127
v_fma_f32 v223, v51, v126, v127
v_cvt_pk_bf16_f32 v175, v222, v223
v_fma_f32 v220, v52, v126, v127
v_fma_f32 v221, v53, v126, v127
v_cvt_pk_bf16_f32 v176, v220, v221
v_fma_f32 v222, v54, v126, v127
v_fma_f32 v223, v55, v126, v127
v_cvt_pk_bf16_f32 v177, v222, v223
ds_write_b128 v211, v[174:177] offset:26624
v_fma_f32 v220, v56, v126, v127
v_fma_f32 v221, v57, v126, v127
v_cvt_pk_bf16_f32 v178, v220, v221
v_fma_f32 v222, v58, v126, v127
v_fma_f32 v223, v59, v126, v127
v_cvt_pk_bf16_f32 v179, v222, v223
s_waitcnt lgkmcnt(3)
ds_write_b64 v212, v[178:179] offset:26624
v_fma_f32 v220, v60, v134, v135
v_fma_f32 v221, v61, v134, v135
v_cvt_pk_bf16_f32 v90, v220, v221
v_fma_f32 v222, v62, v134, v135
v_fma_f32 v223, v63, v134, v135
v_cvt_pk_bf16_f32 v91, v222, v223
v_fma_f32 v220, v64, v134, v135
v_fma_f32 v221, v65, v134, v135
v_cvt_pk_bf16_f32 v92, v220, v221
v_fma_f32 v222, v66, v134, v135
v_fma_f32 v223, v67, v134, v135
v_cvt_pk_bf16_f32 v93, v222, v223
ds_write_b128 v211, v[90:93] offset:32768
v_fma_f32 v220, v68, v134, v135
v_fma_f32 v221, v69, v134, v135
v_cvt_pk_bf16_f32 v94, v220, v221
v_fma_f32 v222, v70, v134, v135
v_fma_f32 v223, v71, v134, v135
v_cvt_pk_bf16_f32 v95, v222, v223
ds_write_b64 v212, v[94:95] offset:32768
ds_read_b128 v[182:185], v210 offset:8192
ds_read_b128 v[186:189], v210 offset:9216
s_waitcnt lgkmcnt(1)
v_mfma_f32_16x16x32_bf16 v[138:141], a[8:11], v[182:185], v[138:141]
s_waitcnt lgkmcnt(0)
v_mfma_f32_16x16x32_bf16 v[138:141], a[12:15], v[186:189], v[138:141]
v_mfma_f32_16x16x32_bf16 v[142:145], a[32:35], v[182:185], v[142:145]
v_mfma_f32_16x16x32_bf16 v[142:145], a[36:39], v[186:189], v[142:145]
v_mfma_f32_16x16x32_bf16 v[146:149], a[56:59], v[182:185], v[146:149]
v_mfma_f32_16x16x32_bf16 v[146:149], a[60:63], v[186:189], v[146:149]
v_mfma_f32_16x16x32_bf16 v[150:153], a[224:227], v[182:185], v[150:153]
v_mfma_f32_16x16x32_bf16 v[150:153], a[228:231], v[186:189], v[150:153]
v_mfma_f32_16x16x32_bf16 v[154:157], a[248:251], v[182:185], v[154:157]
v_mfma_f32_16x16x32_bf16 v[154:157], a[252:255], v[186:189], v[154:157]
v_mfma_f32_16x16x32_bf16 v[158:161], v[240:243], v[182:185], v[158:161]
v_mfma_f32_16x16x32_bf16 v[158:161], v[244:247], v[186:189], v[158:161]
v_mfma_f32_16x16x32_bf16 v[162:165], v[182:185], a[80:83], v[162:165]
v_mfma_f32_16x16x32_bf16 v[162:165], v[186:189], a[84:87], v[162:165]
v_mfma_f32_16x16x32_bf16 v[166:169], v[182:185], a[104:107], v[166:169]
v_mfma_f32_16x16x32_bf16 v[166:169], v[186:189], a[108:111], v[166:169]
v_mfma_f32_16x16x32_bf16 v[170:173], v[182:185], a[128:131], v[170:173]
v_mfma_f32_16x16x32_bf16 v[170:173], v[186:189], a[132:135], v[170:173]
ds_read_b128 v[110:113], v210 offset:10240
ds_read_b128 v[106:109], v210 offset:11264
s_waitcnt lgkmcnt(1)
v_mfma_f32_16x16x32_bf16 v[138:141], a[16:19], v[110:113], v[138:141]
s_waitcnt lgkmcnt(0)
v_mfma_f32_16x16x32_bf16 v[138:141], a[20:23], v[106:109], v[138:141]
v_mfma_f32_16x16x32_bf16 v[142:145], a[40:43], v[110:113], v[142:145]
v_mfma_f32_16x16x32_bf16 v[142:145], a[44:47], v[106:109], v[142:145]
v_mfma_f32_16x16x32_bf16 v[146:149], a[64:67], v[110:113], v[146:149]
v_mfma_f32_16x16x32_bf16 v[146:149], a[68:71], v[106:109], v[146:149]
v_mfma_f32_16x16x32_bf16 v[150:153], a[232:235], v[110:113], v[150:153]
v_mfma_f32_16x16x32_bf16 v[150:153], a[236:239], v[106:109], v[150:153]
v_mfma_f32_16x16x32_bf16 v[154:157], v[224:227], v[110:113], v[154:157]
v_mfma_f32_16x16x32_bf16 v[154:157], v[228:231], v[106:109], v[154:157]
v_mfma_f32_16x16x32_bf16 v[158:161], v[248:251], v[110:113], v[158:161]
v_mfma_f32_16x16x32_bf16 v[158:161], v[252:255], v[106:109], v[158:161]
v_mfma_f32_16x16x32_bf16 v[162:165], v[110:113], a[88:91], v[162:165]
v_mfma_f32_16x16x32_bf16 v[162:165], v[106:109], a[92:95], v[162:165]
v_mfma_f32_16x16x32_bf16 v[166:169], v[110:113], a[112:115], v[166:169]
v_mfma_f32_16x16x32_bf16 v[166:169], v[106:109], a[116:119], v[166:169]
v_mfma_f32_16x16x32_bf16 v[170:173], v[110:113], a[136:139], v[170:173]
v_mfma_f32_16x16x32_bf16 v[170:173], v[106:109], a[140:143], v[170:173]
v_cvt_pk_bf16_f32 v96, v138, v139
v_cvt_pk_bf16_f32 v97, v140, v141
v_cvt_pk_bf16_f32 v98, v142, v143
v_cvt_pk_bf16_f32 v99, v144, v145
v_cvt_pk_bf16_f32 v100, v146, v147
v_cvt_pk_bf16_f32 v101, v148, v149
v_cvt_pk_bf16_f32 v84, v150, v151
v_cvt_pk_bf16_f32 v85, v152, v153
v_cvt_pk_bf16_f32 v86, v154, v155
v_cvt_pk_bf16_f32 v87, v156, v157
v_cvt_pk_bf16_f32 v88, v158, v159
v_cvt_pk_bf16_f32 v89, v160, v161
v_cvt_pk_bf16_f32 v116, v162, v163
v_cvt_pk_bf16_f32 v117, v164, v165
v_cvt_pk_bf16_f32 v124, v166, v167
v_cvt_pk_bf16_f32 v125, v168, v169
v_cvt_pk_bf16_f32 v132, v170, v171
v_cvt_pk_bf16_f32 v133, v172, v173
ds_read_b128 v[182:185], v210 offset:12288
ds_read_b128 v[186:189], v210 offset:13312
s_waitcnt lgkmcnt(1)
v_mfma_f32_16x16x32_bf16 v[138:141], a[0:3], v[182:185], 0
s_waitcnt lgkmcnt(0)
v_mfma_f32_16x16x32_bf16 v[138:141], a[4:7], v[186:189], v[138:141]
v_mfma_f32_16x16x32_bf16 v[142:145], a[24:27], v[182:185], 0
v_mfma_f32_16x16x32_bf16 v[142:145], a[28:31], v[186:189], v[142:145]
v_mfma_f32_16x16x32_bf16 v[146:149], a[48:51], v[182:185], 0
v_mfma_f32_16x16x32_bf16 v[146:149], a[52:55], v[186:189], v[146:149]
ds_read_b128 v[170:173], v210 offset:14336
ds_read_b128 v[182:185], v210 offset:15360
s_waitcnt lgkmcnt(1)
v_mfma_f32_16x16x32_bf16 v[138:141], a[8:11], v[170:173], v[138:141]
s_waitcnt lgkmcnt(0)
v_mfma_f32_16x16x32_bf16 v[138:141], a[12:15], v[182:185], v[138:141]
v_mfma_f32_16x16x32_bf16 v[142:145], a[32:35], v[170:173], v[142:145]
v_mfma_f32_16x16x32_bf16 v[142:145], a[36:39], v[182:185], v[142:145]
v_mfma_f32_16x16x32_bf16 v[146:149], a[56:59], v[170:173], v[146:149]
v_mfma_f32_16x16x32_bf16 v[146:149], a[60:63], v[182:185], v[146:149]
ds_read_b128 v[186:189], v210 offset:16384
ds_read_b128 v[170:173], v210 offset:17408
s_waitcnt lgkmcnt(1)
v_mfma_f32_16x16x32_bf16 v[138:141], a[16:19], v[186:189], v[138:141]
s_waitcnt lgkmcnt(0)
v_mfma_f32_16x16x32_bf16 v[138:141], a[20:23], v[170:173], v[138:141]
v_mfma_f32_16x16x32_bf16 v[142:145], a[40:43], v[186:189], v[142:145]
v_mfma_f32_16x16x32_bf16 v[142:145], a[44:47], v[170:173], v[142:145]
v_mfma_f32_16x16x32_bf16 v[146:149], a[64:67], v[186:189], v[146:149]
v_mfma_f32_16x16x32_bf16 v[146:149], a[68:71], v[170:173], v[146:149]
v_cvt_pk_bf16_f32 v102, v138, v139
v_cvt_pk_bf16_f32 v103, v140, v141
v_cvt_pk_bf16_f32 v104, v142, v143
v_cvt_pk_bf16_f32 v105, v144, v145
s_nop 2
v_cvt_pk_bf16_f32 v106, v146, v147
v_cvt_pk_bf16_f32 v107, v148, v149
ds_read_b128 v[108:111], v215 offset:512
ds_read_b64 v[112:113], v215 offset:528
v_mfma_f32_16x16x16_bf16 v[138:141], v[82:83], v[76:77], 0
v_mfma_f32_16x16x16_bf16 v[142:145], v[100:101], v[76:77], 0
s_waitcnt lgkmcnt(0)
v_mfma_f32_16x16x16_bf16 v[150:153], v[112:113], v[76:77], v[206:209]
v_mfma_f32_16x16x16_bf16 v[146:149], v[106:107], v[76:77], 0
v_mfma_f32_16x16x32_bf16 v[138:141], v[78:81], v[72:75], v[138:141]
v_mfma_f32_16x16x32_bf16 v[142:145], v[96:99], v[72:75], v[142:145]
v_mfma_f32_16x16x32_bf16 v[150:153], v[108:111], v[72:75], v[150:153]
v_mfma_f32_16x16x32_bf16 v[146:149], v[102:105], v[72:75], v[146:149]
ds_read_b128 v[72:75], v215
ds_read_b64 v[76:77], v215 offset:16
v_mfma_f32_16x16x16_bf16 v[154:157], v[82:83], v[88:89], 0
v_mfma_f32_16x16x16_bf16 v[158:161], v[100:101], v[88:89], 0
v_mfma_f32_16x16x16_bf16 v[166:169], v[112:113], v[88:89], v[206:209]
v_mfma_f32_16x16x16_bf16 v[162:165], v[106:107], v[88:89], 0
v_mfma_f32_16x16x32_bf16 v[154:157], v[78:81], v[84:87], v[154:157]
v_mfma_f32_16x16x32_bf16 v[158:161], v[96:99], v[84:87], v[158:161]
v_mfma_f32_16x16x32_bf16 v[166:169], v[108:111], v[84:87], v[166:169]
v_mfma_f32_16x16x32_bf16 v[162:165], v[102:105], v[84:87], v[162:165]
ds_read_b128 v[182:185], v210 offset:12288
ds_read_b128 v[186:189], v210 offset:13312
s_waitcnt lgkmcnt(1)
v_mfma_f32_16x16x32_bf16 v[118:121], v[182:185], a[72:75], 0
s_waitcnt lgkmcnt(0)
v_mfma_f32_16x16x32_bf16 v[118:121], v[186:189], a[76:79], v[118:121]
v_mfma_f32_16x16x32_bf16 v[126:129], v[182:185], a[96:99], 0
v_mfma_f32_16x16x32_bf16 v[126:129], v[186:189], a[100:103], v[126:129]
v_mfma_f32_16x16x32_bf16 v[134:137], v[182:185], a[120:123], 0
v_mfma_f32_16x16x32_bf16 v[134:137], v[186:189], a[124:127], v[134:137]
v_mfma_f32_16x16x32_bf16 v[90:93], a[216:219], v[182:185], 0
v_mfma_f32_16x16x32_bf16 v[90:93], a[220:223], v[186:189], v[90:93]
v_mfma_f32_16x16x32_bf16 v[170:173], a[240:243], v[182:185], 0
v_mfma_f32_16x16x32_bf16 v[170:173], a[244:247], v[186:189], v[170:173]
v_mfma_f32_16x16x32_bf16 v[220:223], v[232:235], v[182:185], 0
v_mfma_f32_16x16x32_bf16 v[220:223], v[236:239], v[186:189], v[220:223]
ds_read_b128 v[174:177], v210 offset:14336
ds_read_b128 v[178:181], v210 offset:15360
s_waitcnt lgkmcnt(1)
v_mfma_f32_16x16x32_bf16 v[118:121], v[174:177], a[80:83], v[118:121]
s_waitcnt lgkmcnt(0)
v_mfma_f32_16x16x32_bf16 v[118:121], v[178:181], a[84:87], v[118:121]
v_mfma_f32_16x16x32_bf16 v[126:129], v[174:177], a[104:107], v[126:129]
v_mfma_f32_16x16x32_bf16 v[126:129], v[178:181], a[108:111], v[126:129]
v_mfma_f32_16x16x32_bf16 v[134:137], v[174:177], a[128:131], v[134:137]
v_mfma_f32_16x16x32_bf16 v[134:137], v[178:181], a[132:135], v[134:137]
v_mfma_f32_16x16x32_bf16 v[90:93], a[224:227], v[174:177], v[90:93]
v_mfma_f32_16x16x32_bf16 v[90:93], a[228:231], v[178:181], v[90:93]
v_mfma_f32_16x16x32_bf16 v[170:173], a[248:251], v[174:177], v[170:173]
v_mfma_f32_16x16x32_bf16 v[170:173], a[252:255], v[178:181], v[170:173]
v_mfma_f32_16x16x32_bf16 v[220:223], v[240:243], v[174:177], v[220:223]
v_mfma_f32_16x16x32_bf16 v[220:223], v[244:247], v[178:181], v[220:223]
ds_read_b128 v[182:185], v210 offset:16384
ds_read_b128 v[186:189], v210 offset:17408
s_waitcnt lgkmcnt(1)
v_mfma_f32_16x16x32_bf16 v[118:121], v[182:185], a[88:91], v[118:121]
s_waitcnt lgkmcnt(0)
v_mfma_f32_16x16x32_bf16 v[118:121], v[186:189], a[92:95], v[118:121]
v_mfma_f32_16x16x32_bf16 v[126:129], v[182:185], a[112:115], v[126:129]
v_mfma_f32_16x16x32_bf16 v[126:129], v[186:189], a[116:119], v[126:129]
v_mfma_f32_16x16x32_bf16 v[134:137], v[182:185], a[136:139], v[134:137]
v_mfma_f32_16x16x32_bf16 v[134:137], v[186:189], a[140:143], v[134:137]
v_mfma_f32_16x16x32_bf16 v[90:93], a[232:235], v[182:185], v[90:93]
v_mfma_f32_16x16x32_bf16 v[90:93], a[236:239], v[186:189], v[90:93]
v_mfma_f32_16x16x32_bf16 v[170:173], v[224:227], v[182:185], v[170:173]
v_mfma_f32_16x16x32_bf16 v[170:173], v[228:231], v[186:189], v[170:173]
v_mfma_f32_16x16x32_bf16 v[220:223], v[248:251], v[182:185], v[220:223]
v_mfma_f32_16x16x32_bf16 v[220:223], v[252:255], v[186:189], v[220:223]
v_mov_b32 v181, 0
v_cvt_pk_bf16_f32 v118, v118, v119
v_cvt_pk_bf16_f32 v119, v120, v121
ds_read_u16 v120, v214 offset:1024
v_mov_b32 v121, 0
v_cvt_pk_bf16_f32 v126, v126, v127
v_cvt_pk_bf16_f32 v127, v128, v129
ds_read_u16 v128, v214 offset:1032
v_mov_b32 v129, 0
v_cvt_pk_bf16_f32 v134, v134, v135
v_cvt_pk_bf16_f32 v135, v136, v137
ds_read_u16 v136, v214 offset:1040
v_mov_b32 v137, 0
v_cvt_pk_bf16_f32 v90, v90, v91
v_cvt_pk_bf16_f32 v91, v92, v93
v_cvt_pk_bf16_f32 v92, v170, v171
v_cvt_pk_bf16_f32 v93, v172, v173
v_cvt_pk_bf16_f32 v94, v220, v221
v_cvt_pk_bf16_f32 v95, v222, v223
v_max3_f32 v151, v138, v139, v140
v_max3_f32 v151, v151, v141, v142
v_max3_f32 v151, v151, v143, v144
v_max3_f32 v151, v151, v145, v146
v_max3_f32 v151, v151, v147, v148
v_max3_f32 v151, v151, v149, v150
v_mov_b32 v152, v151
s_nop 1
v_permlane16_swap_b32 v151, v152
v_max_f32 v151, v151, v152
v_mov_b32 v152, v151
s_nop 1
v_permlane32_swap_b32 v151, v152
v_max_f32 v151, v151, v152
v_sub_f32 v138, v138, v151
v_sub_f32 v139, v139, v151
v_sub_f32 v140, v140, v151
v_sub_f32 v141, v141, v151
v_sub_f32 v142, v142, v151
v_sub_f32 v143, v143, v151
v_sub_f32 v144, v144, v151
v_sub_f32 v145, v145, v151
v_sub_f32 v150, v150, v151
v_sub_f32 v146, v146, v151
v_sub_f32 v147, v147, v151
v_sub_f32 v148, v148, v151
v_sub_f32 v149, v149, v151
v_exp_f32 v138, v138
v_exp_f32 v139, v139
v_exp_f32 v140, v140
v_exp_f32 v141, v141
v_exp_f32 v142, v142
v_exp_f32 v143, v143
v_exp_f32 v144, v144
v_exp_f32 v145, v145
v_exp_f32 v150, v150
v_exp_f32 v146, v146
v_exp_f32 v147, v147
v_exp_f32 v148, v148
v_exp_f32 v149, v149
v_cvt_pk_bf16_f32 v174, v138, v139
v_cvt_pk_bf16_f32 v175, v140, v141
v_cvt_pk_bf16_f32 v176, v142, v143
v_cvt_pk_bf16_f32 v177, v144, v145
v_cvt_pk_bf16_f32 v178, v146, v147
v_cvt_pk_bf16_f32 v179, v148, v149
v_cvt_pk_bf16_f32 v180, v150, 0
v_mfma_f32_16x16x32_bf16 v[150:153], v[190:193], v[174:177], 0
v_mfma_f32_16x16x32_bf16 v[150:153], v[190:193], v[178:181], v[150:153]
v_mfma_f32_16x16x32_bf16 v[138:141], v[114:117], v[174:177], 0
s_waitcnt lgkmcnt(2)
v_mfma_f32_16x16x32_bf16 v[138:141], v[118:121], v[178:181], v[138:141]
v_mfma_f32_16x16x32_bf16 v[142:145], v[122:125], v[174:177], 0
s_waitcnt lgkmcnt(1)
v_mfma_f32_16x16x32_bf16 v[142:145], v[126:129], v[178:181], v[142:145]
v_mfma_f32_16x16x32_bf16 v[146:149], v[130:133], v[174:177], 0
s_waitcnt lgkmcnt(0)
v_mfma_f32_16x16x32_bf16 v[146:149], v[134:137], v[178:181], v[146:149]
v_max3_f32 v167, v154, v155, v156
v_max3_f32 v167, v167, v157, v158
v_max3_f32 v167, v167, v159, v160
v_max3_f32 v167, v167, v161, v162
v_max3_f32 v167, v167, v163, v164
v_max3_f32 v167, v167, v165, v166
v_mov_b32 v168, v167
s_nop 1
v_permlane16_swap_b32 v167, v168
v_max_f32 v167, v167, v168
v_mov_b32 v168, v167
s_nop 1
v_permlane32_swap_b32 v167, v168
v_max_f32 v167, v167, v168
v_sub_f32 v154, v154, v167
v_sub_f32 v155, v155, v167
v_sub_f32 v156, v156, v167
v_sub_f32 v157, v157, v167
v_sub_f32 v158, v158, v167
v_sub_f32 v159, v159, v167
v_sub_f32 v160, v160, v167
v_sub_f32 v161, v161, v167
v_sub_f32 v166, v166, v167
v_sub_f32 v162, v162, v167
v_sub_f32 v163, v163, v167
v_sub_f32 v164, v164, v167
v_sub_f32 v165, v165, v167
v_exp_f32 v154, v154
v_exp_f32 v155, v155
v_exp_f32 v156, v156
v_exp_f32 v157, v157
v_exp_f32 v158, v158
v_exp_f32 v159, v159
v_exp_f32 v160, v160
v_exp_f32 v161, v161
v_exp_f32 v166, v166
v_exp_f32 v162, v162
v_exp_f32 v163, v163
v_exp_f32 v164, v164
v_exp_f32 v165, v165
v_cvt_pk_bf16_f32 v174, v154, v155
v_cvt_pk_bf16_f32 v175, v156, v157
v_cvt_pk_bf16_f32 v176, v158, v159
v_cvt_pk_bf16_f32 v177, v160, v161
v_cvt_pk_bf16_f32 v178, v162, v163
v_cvt_pk_bf16_f32 v179, v164, v165
v_cvt_pk_bf16_f32 v180, v166, 0
v_mfma_f32_16x16x32_bf16 v[166:169], v[190:193], v[174:177], 0
v_mfma_f32_16x16x32_bf16 v[166:169], v[190:193], v[178:181], v[166:169]
v_mfma_f32_16x16x32_bf16 v[154:157], v[114:117], v[174:177], 0
v_mfma_f32_16x16x32_bf16 v[154:157], v[118:121], v[178:181], v[154:157]
v_mfma_f32_16x16x32_bf16 v[158:161], v[122:125], v[174:177], 0
v_mfma_f32_16x16x32_bf16 v[158:161], v[126:129], v[178:181], v[158:161]
v_mfma_f32_16x16x32_bf16 v[162:165], v[130:133], v[174:177], 0
v_mfma_f32_16x16x32_bf16 v[162:165], v[134:137], v[178:181], v[162:165]
v_rcp_f32 v151, v150
s_nop 0
v_mul_f32 v151, s3, v151
v_mul_f32 v138, v138, v151
v_mul_f32 v139, v139, v151
v_cvt_pk_bf16_f32 v138, v138, v139
v_mul_f32 v140, v140, v151
v_mul_f32 v141, v141, v151
v_cvt_pk_bf16_f32 v139, v140, v141
v_mul_f32 v142, v142, v151
v_mul_f32 v143, v143, v151
v_cvt_pk_bf16_f32 v140, v142, v143
v_mul_f32 v144, v144, v151
v_mul_f32 v145, v145, v151
v_cvt_pk_bf16_f32 v141, v144, v145
ds_write_b128 v211, v[138:141] offset:38912
v_mul_f32 v146, v146, v151
v_mul_f32 v147, v147, v151
v_cvt_pk_bf16_f32 v142, v146, v147
v_mul_f32 v148, v148, v151
v_mul_f32 v149, v149, v151
v_cvt_pk_bf16_f32 v143, v148, v149
ds_write_b64 v212, v[142:143] offset:38912
v_mfma_f32_16x16x16_bf16 v[138:141], v[82:83], v[94:95], 0
v_mfma_f32_16x16x16_bf16 v[142:145], v[100:101], v[94:95], 0
v_mfma_f32_16x16x16_bf16 v[150:153], v[112:113], v[94:95], v[206:209]
v_mfma_f32_16x16x16_bf16 v[146:149], v[106:107], v[94:95], 0
v_mfma_f32_16x16x32_bf16 v[138:141], v[78:81], v[90:93], v[138:141]
v_mfma_f32_16x16x32_bf16 v[142:145], v[96:99], v[90:93], v[142:145]
v_mfma_f32_16x16x32_bf16 v[150:153], v[108:111], v[90:93], v[150:153]
v_mfma_f32_16x16x32_bf16 v[146:149], v[102:105], v[90:93], v[146:149]
v_rcp_f32 v167, v166
s_nop 0
v_mul_f32 v167, s3, v167
v_mul_f32 v154, v154, v167
v_mul_f32 v155, v155, v167
v_cvt_pk_bf16_f32 v154, v154, v155
v_mul_f32 v156, v156, v167
v_mul_f32 v157, v157, v167
v_cvt_pk_bf16_f32 v155, v156, v157
v_mul_f32 v158, v158, v167
v_mul_f32 v159, v159, v167
v_cvt_pk_bf16_f32 v156, v158, v159
v_mul_f32 v160, v160, v167
v_mul_f32 v161, v161, v167
v_cvt_pk_bf16_f32 v157, v160, v161
ds_write_b128 v211, v[154:157] offset:45056
v_mul_f32 v162, v162, v167
v_mul_f32 v163, v163, v167
v_cvt_pk_bf16_f32 v158, v162, v163
v_mul_f32 v164, v164, v167
v_mul_f32 v165, v165, v167
v_cvt_pk_bf16_f32 v159, v164, v165
ds_write_b64 v212, v[158:159] offset:45056
v_mfma_f32_16x16x16_bf16 v[154:157], v[76:77], v[82:83], 0
v_mfma_f32_16x16x16_bf16 v[158:161], v[76:77], v[100:101], 0
v_mfma_f32_16x16x16_bf16 v[162:165], v[76:77], v[106:107], 0
v_mfma_f32_16x16x16_bf16 v[166:169], v[76:77], v[112:113], v[206:209]
v_mfma_f32_16x16x32_bf16 v[154:157], v[72:75], v[78:81], v[154:157]
v_mfma_f32_16x16x32_bf16 v[158:161], v[72:75], v[96:99], v[158:161]
v_mfma_f32_16x16x32_bf16 v[162:165], v[72:75], v[102:105], v[162:165]
v_mfma_f32_16x16x32_bf16 v[166:169], v[72:75], v[108:111], v[166:169]
v_mov_b32_dpp v154, v158 quad_perm:[0,1,2,3] row_mask:0x2 bank_mask:0xf
s_nop 1
v_mov_b32_dpp v154, v162 quad_perm:[0,1,2,3] row_mask:0x4 bank_mask:0xf
s_nop 2
v_mov_b32_dpp v154, v167 quad_perm:[0,1,2,3] row_mask:0x8 bank_mask:0xf
v_mov_b32 v155, v154
s_nop 1
v_max_f32_dpp v155, v155, v155 row_ror:8 row_mask:0xf bank_mask:0xf
s_nop 1
v_max_f32_dpp v155, v155, v155 row_ror:4 row_mask:0xf bank_mask:0xf
s_nop 1
v_max_f32_dpp v155, v155, v155 row_ror:2 row_mask:0xf bank_mask:0xf
s_nop 1
v_max_f32_dpp v155, v155, v155 row_ror:1 row_mask:0xf bank_mask:0xf
v_mov_b32 v156, v155
s_nop 1
v_permlane16_swap_b32 v155, v156
v_max_f32 v155, v155, v156
v_mov_b32 v156, v155
s_nop 1
v_permlane32_swap_b32 v155, v156
v_max_f32 v155, v155, v156
v_sub_f32 v154, v154, v155
v_exp_f32 v154, v154
s_nop 0
v_cvt_pk_bf16_f32 v154, v154, 0
ds_write_b16 v214, v154
s_waitcnt lgkmcnt(1)
ds_read_b128 v[84:87], v215
ds_read_b128 v[88:91], v215 offset:16
v_add_u32 v215, 1552, v215
s_barrier
ds_read_b128 v[220:223], v210 offset:38912
ds_read_b128 v[110:113], v210 offset:39936
s_waitcnt lgkmcnt(1)
v_mfma_f32_16x16x32_bf16 v[0:3], a[144:147], v[220:223], v[0:3]
s_waitcnt lgkmcnt(0)
v_mfma_f32_16x16x32_bf16 v[0:3], a[148:151], v[110:113], v[0:3]
v_mfma_f32_16x16x32_bf16 v[4:7], a[168:171], v[220:223], v[4:7]
v_mfma_f32_16x16x32_bf16 v[4:7], a[172:175], v[110:113], v[4:7]
v_mfma_f32_16x16x32_bf16 v[8:11], a[192:195], v[220:223], v[8:11]
v_mfma_f32_16x16x32_bf16 v[8:11], a[196:199], v[110:113], v[8:11]
ds_read_b128 v[170:173], v210 offset:40960
ds_read_b128 v[182:185], v210 offset:41984
s_waitcnt lgkmcnt(1)
v_mfma_f32_16x16x32_bf16 v[0:3], a[152:155], v[170:173], v[0:3]
s_waitcnt lgkmcnt(0)
v_mfma_f32_16x16x32_bf16 v[0:3], a[156:159], v[182:185], v[0:3]
v_mfma_f32_16x16x32_bf16 v[4:7], a[176:179], v[170:173], v[4:7]
v_mfma_f32_16x16x32_bf16 v[4:7], a[180:183], v[182:185], v[4:7]
v_mfma_f32_16x16x32_bf16 v[8:11], a[200:203], v[170:173], v[8:11]
v_mfma_f32_16x16x32_bf16 v[8:11], a[204:207], v[182:185], v[8:11]
ds_read_b128 v[186:189], v210 offset:43008
ds_read_b128 v[220:223], v210 offset:44032
s_waitcnt lgkmcnt(1)
v_mfma_f32_16x16x32_bf16 v[0:3], a[160:163], v[186:189], v[0:3]
s_waitcnt lgkmcnt(0)
v_mfma_f32_16x16x32_bf16 v[0:3], a[164:167], v[220:223], v[0:3]
v_mfma_f32_16x16x32_bf16 v[4:7], a[184:187], v[186:189], v[4:7]
v_mfma_f32_16x16x32_bf16 v[4:7], a[188:191], v[220:223], v[4:7]
v_mfma_f32_16x16x32_bf16 v[8:11], a[208:211], v[186:189], v[8:11]
v_mfma_f32_16x16x32_bf16 v[8:11], a[212:215], v[220:223], v[8:11]
v_cvt_pk_bf16_f32 v72, v0, v1
v_cvt_pk_bf16_f32 v73, v2, v3
buffer_store_dwordx2 v[72:73], v203, s[8:11], s38 offen
v_cvt_pk_bf16_f32 v74, v4, v5
v_cvt_pk_bf16_f32 v75, v6, v7
buffer_store_dwordx2 v[74:75], v203, s[8:11], s38 offen offset:32
s_nop 0
v_cvt_pk_bf16_f32 v76, v8, v9
v_cvt_pk_bf16_f32 v77, v10, v11
buffer_store_dwordx2 v[76:77], v203, s[8:11], s38 offen offset:64
v_max3_f32 v151, v138, v139, v140
v_max3_f32 v151, v151, v141, v142
v_max3_f32 v151, v151, v143, v144
v_max3_f32 v151, v151, v145, v146
v_max3_f32 v151, v151, v147, v148
v_max3_f32 v151, v151, v149, v150
v_mov_b32 v152, v151
s_nop 1
v_permlane16_swap_b32 v151, v152
v_max_f32 v151, v151, v152
v_mov_b32 v152, v151
s_nop 1
v_permlane32_swap_b32 v151, v152
v_max_f32 v151, v151, v152
v_sub_f32 v138, v138, v151
v_sub_f32 v139, v139, v151
v_sub_f32 v140, v140, v151
v_sub_f32 v141, v141, v151
v_sub_f32 v142, v142, v151
v_sub_f32 v143, v143, v151
v_sub_f32 v144, v144, v151
v_sub_f32 v145, v145, v151
v_sub_f32 v150, v150, v151
v_sub_f32 v146, v146, v151
v_sub_f32 v147, v147, v151
v_sub_f32 v148, v148, v151
v_sub_f32 v149, v149, v151
v_exp_f32 v138, v138
v_exp_f32 v139, v139
v_exp_f32 v140, v140
v_exp_f32 v141, v141
v_exp_f32 v142, v142
v_exp_f32 v143, v143
v_exp_f32 v144, v144
v_exp_f32 v145, v145
v_exp_f32 v150, v150
v_exp_f32 v146, v146
v_exp_f32 v147, v147
v_exp_f32 v148, v148
v_exp_f32 v149, v149
v_cvt_pk_bf16_f32 v174, v138, v139
v_cvt_pk_bf16_f32 v175, v140, v141
v_cvt_pk_bf16_f32 v176, v142, v143
v_cvt_pk_bf16_f32 v177, v144, v145
v_cvt_pk_bf16_f32 v178, v146, v147
v_cvt_pk_bf16_f32 v179, v148, v149
v_cvt_pk_bf16_f32 v180, v150, 0
v_mfma_f32_16x16x32_bf16 v[150:153], v[190:193], v[174:177], 0
v_mfma_f32_16x16x32_bf16 v[150:153], v[190:193], v[178:181], v[150:153]
v_mfma_f32_16x16x32_bf16 v[138:141], v[114:117], v[174:177], 0
v_mfma_f32_16x16x32_bf16 v[138:141], v[118:121], v[178:181], v[138:141]
v_mfma_f32_16x16x32_bf16 v[142:145], v[122:125], v[174:177], 0
v_mfma_f32_16x16x32_bf16 v[142:145], v[126:129], v[178:181], v[142:145]
v_mfma_f32_16x16x32_bf16 v[146:149], v[130:133], v[174:177], 0
v_mfma_f32_16x16x32_bf16 v[146:149], v[134:137], v[178:181], v[146:149]
v_mfma_f32_16x16x32_bf16 v[166:169], v[84:87], v[190:193], 0
v_mfma_f32_16x16x32_bf16 v[166:169], v[88:91], v[190:193], v[166:169]
v_mfma_f32_16x16x32_bf16 v[154:157], v[84:87], v[114:117], 0
v_mfma_f32_16x16x32_bf16 v[154:157], v[88:91], v[118:121], v[154:157]
v_mfma_f32_16x16x32_bf16 v[158:161], v[84:87], v[122:125], 0
v_mfma_f32_16x16x32_bf16 v[158:161], v[88:91], v[126:129], v[158:161]
v_mfma_f32_16x16x32_bf16 v[162:165], v[84:87], v[130:133], 0
v_mfma_f32_16x16x32_bf16 v[162:165], v[88:91], v[134:137], v[162:165]
v_rcp_f32 v167, v166
v_mov_b32_dpp v154, v158 quad_perm:[0,1,2,3] row_mask:0x2 bank_mask:0xf
s_nop 3
v_mov_b32_dpp v154, v162 quad_perm:[0,1,2,3] row_mask:0x4 bank_mask:0xf
v_mul_f32 v167, s3, v167
v_mul_f32 v154, v154, v167
v_cvt_pk_bf16_f32 v154, v154, 0
ds_write_b16 v214, v154
v_add_u32 v214, 1552, v214
ds_read_b128 v[110:113], v210 offset:45056
ds_read_b128 v[170:173], v210 offset:46080
s_waitcnt lgkmcnt(1)
v_mfma_f32_16x16x32_bf16 v[12:15], a[144:147], v[110:113], v[12:15]
s_waitcnt lgkmcnt(0)
v_mfma_f32_16x16x32_bf16 v[12:15], a[148:151], v[170:173], v[12:15]
v_mfma_f32_16x16x32_bf16 v[16:19], a[168:171], v[110:113], v[16:19]
v_mfma_f32_16x16x32_bf16 v[16:19], a[172:175], v[170:173], v[16:19]
v_mfma_f32_16x16x32_bf16 v[20:23], a[192:195], v[110:113], v[20:23]
v_mfma_f32_16x16x32_bf16 v[20:23], a[196:199], v[170:173], v[20:23]
ds_read_b128 v[182:185], v210 offset:47104
ds_read_b128 v[186:189], v210 offset:48128
s_waitcnt lgkmcnt(1)
v_mfma_f32_16x16x32_bf16 v[12:15], a[152:155], v[182:185], v[12:15]
s_waitcnt lgkmcnt(0)
v_mfma_f32_16x16x32_bf16 v[12:15], a[156:159], v[186:189], v[12:15]
v_mfma_f32_16x16x32_bf16 v[16:19], a[176:179], v[182:185], v[16:19]
v_mfma_f32_16x16x32_bf16 v[16:19], a[180:183], v[186:189], v[16:19]
v_mfma_f32_16x16x32_bf16 v[20:23], a[200:203], v[182:185], v[20:23]
v_mfma_f32_16x16x32_bf16 v[20:23], a[204:207], v[186:189], v[20:23]
ds_read_b128 v[220:223], v210 offset:49152
ds_read_b128 v[110:113], v210 offset:50176
s_waitcnt lgkmcnt(1)
v_mfma_f32_16x16x32_bf16 v[12:15], a[160:163], v[220:223], v[12:15]
s_waitcnt lgkmcnt(0)
v_mfma_f32_16x16x32_bf16 v[12:15], a[164:167], v[110:113], v[12:15]
v_mfma_f32_16x16x32_bf16 v[16:19], a[184:187], v[220:223], v[16:19]
v_mfma_f32_16x16x32_bf16 v[16:19], a[188:191], v[110:113], v[16:19]
v_mfma_f32_16x16x32_bf16 v[20:23], a[208:211], v[220:223], v[20:23]
v_mfma_f32_16x16x32_bf16 v[20:23], a[212:215], v[110:113], v[20:23]
s_sub_u32 s46, s46, 1
v_cvt_pk_bf16_f32 v78, v12, v13
v_cvt_pk_bf16_f32 v79, v14, v15
buffer_store_dwordx2 v[78:79], v204, s[8:11], s38 offen
v_cvt_pk_bf16_f32 v80, v16, v17
v_cvt_pk_bf16_f32 v81, v18, v19
buffer_store_dwordx2 v[80:81], v204, s[8:11], s38 offen offset:32
s_nop 0
v_cvt_pk_bf16_f32 v82, v20, v21
v_cvt_pk_bf16_f32 v83, v22, v23
buffer_store_dwordx2 v[82:83], v204, s[8:11], s38 offen offset:64
v_rcp_f32 v151, v150
s_nop 0
v_mul_f32 v151, s3, v151
v_mul_f32 v138, v138, v151
v_mul_f32 v139, v139, v151
v_cvt_pk_bf16_f32 v138, v138, v139
v_mul_f32 v140, v140, v151
v_mul_f32 v141, v141, v151
v_cvt_pk_bf16_f32 v139, v140, v141
v_mul_f32 v142, v142, v151
v_mul_f32 v143, v143, v151
v_cvt_pk_bf16_f32 v140, v142, v143
v_mul_f32 v144, v144, v151
v_mul_f32 v145, v145, v151
v_cvt_pk_bf16_f32 v141, v144, v145
ds_write_b128 v211, v[138:141] offset:51200
v_mul_f32 v146, v146, v151
v_mul_f32 v147, v147, v151
v_cvt_pk_bf16_f32 v142, v146, v147
v_mul_f32 v148, v148, v151
v_mul_f32 v149, v149, v151
v_cvt_pk_bf16_f32 v143, v148, v149
ds_write_b64 v212, v[142:143] offset:51200
s_cbranch_scc0 G_loop
G_tail:
s_waitcnt vmcnt(6) lgkmcnt(0)
s_barrier
ds_read_b128 v[170:173], v210 offset:51200
ds_read_b128 v[182:185], v210 offset:52224
s_waitcnt lgkmcnt(1)
v_mfma_f32_16x16x32_bf16 v[24:27], a[144:147], v[170:173], v[24:27]
s_waitcnt lgkmcnt(0)
v_mfma_f32_16x16x32_bf16 v[24:27], a[148:151], v[182:185], v[24:27]
v_mfma_f32_16x16x32_bf16 v[28:31], a[168:171], v[170:173], v[28:31]
v_mfma_f32_16x16x32_bf16 v[28:31], a[172:175], v[182:185], v[28:31]
v_mfma_f32_16x16x32_bf16 v[32:35], a[192:195], v[170:173], v[32:35]
v_mfma_f32_16x16x32_bf16 v[32:35], a[196:199], v[182:185], v[32:35]
ds_read_b128 v[186:189], v210 offset:53248
ds_read_b128 v[220:223], v210 offset:54272
s_waitcnt lgkmcnt(1)
v_mfma_f32_16x16x32_bf16 v[24:27], a[152:155], v[186:189], v[24:27]
s_waitcnt lgkmcnt(0)
v_mfma_f32_16x16x32_bf16 v[24:27], a[156:159], v[220:223], v[24:27]
v_mfma_f32_16x16x32_bf16 v[28:31], a[176:179], v[186:189], v[28:31]
v_mfma_f32_16x16x32_bf16 v[28:31], a[180:183], v[220:223], v[28:31]
v_mfma_f32_16x16x32_bf16 v[32:35], a[200:203], v[186:189], v[32:35]
v_mfma_f32_16x16x32_bf16 v[32:35], a[204:207], v[220:223], v[32:35]
ds_read_b128 v[110:113], v210 offset:55296
ds_read_b128 v[170:173], v210 offset:56320
s_waitcnt lgkmcnt(1)
v_mfma_f32_16x16x32_bf16 v[24:27], a[160:163], v[110:113], v[24:27]
s_waitcnt lgkmcnt(0)
v_mfma_f32_16x16x32_bf16 v[24:27], a[164:167], v[170:173], v[24:27]
v_mfma_f32_16x16x32_bf16 v[28:31], a[184:187], v[110:113], v[28:31]
v_mfma_f32_16x16x32_bf16 v[28:31], a[188:191], v[170:173], v[28:31]
v_mfma_f32_16x16x32_bf16 v[32:35], a[208:211], v[110:113], v[32:35]
v_mfma_f32_16x16x32_bf16 v[32:35], a[212:215], v[170:173], v[32:35]
v_cvt_pk_bf16_f32 v116, v24, v25
v_cvt_pk_bf16_f32 v117, v26, v27
buffer_store_dwordx2 v[116:117], v205, s[8:11], s38 offen
v_cvt_pk_bf16_f32 v124, v28, v29
v_cvt_pk_bf16_f32 v125, v30, v31
buffer_store_dwordx2 v[124:125], v205, s[8:11], s38 offen offset:32
s_nop 0
v_cvt_pk_bf16_f32 v132, v32, v33
v_cvt_pk_bf16_f32 v133, v34, v35
buffer_store_dwordx2 v[132:133], v205, s[8:11], s38 offen offset:64
s_mov_b32 s39, s37
ds_read_b128 v[174:177], v217
ds_read_b128 v[84:87], v200
s_waitcnt lgkmcnt(0)
v_mfma_f32_16x16x32_bf16 v[0:3], v[174:177], v[84:87], 0
ds_read_b128 v[92:95], v201
s_waitcnt lgkmcnt(0)
v_mfma_f32_16x16x32_bf16 v[12:15], v[174:177], v[92:95], 0
ds_read_b128 v[100:103], v202
s_waitcnt lgkmcnt(0)
v_mfma_f32_16x16x32_bf16 v[24:27], v[174:177], v[100:103], 0
ds_read_b128 v[178:181], v217 offset:528
ds_read_b128 v[84:87], v194
ds_read_b128 v[88:91], v194 offset:16
s_waitcnt lgkmcnt(0)
v_smfmac_f32_16x16x64_bf16 v[0:3], v[178:181], v[84:91], v213
ds_read_b128 v[92:95], v195
ds_read_b128 v[96:99], v195 offset:16
s_waitcnt lgkmcnt(0)
v_smfmac_f32_16x16x64_bf16 v[12:15], v[178:181], v[92:99], v213
ds_read_b128 v[100:103], v196
ds_read_b128 v[104:107], v196 offset:16
s_waitcnt lgkmcnt(0)
v_smfmac_f32_16x16x64_bf16 v[24:27], v[178:181], v[100:107], v213
ds_read_b128 v[174:177], v217 offset:1056
ds_read_b128 v[84:87], v197
ds_read_b128 v[88:91], v197 offset:16
s_waitcnt lgkmcnt(0)
v_smfmac_f32_16x16x64_bf16 v[0:3], v[174:177], v[84:91], v213
ds_read_b128 v[92:95], v198
ds_read_b128 v[96:99], v198 offset:16
s_waitcnt lgkmcnt(0)
v_smfmac_f32_16x16x64_bf16 v[12:15], v[174:177], v[92:99], v213
ds_read_b128 v[100:103], v199
ds_read_b128 v[104:107], v199 offset:16
s_waitcnt lgkmcnt(0)
v_smfmac_f32_16x16x64_bf16 v[24:27], v[174:177], v[100:107], v213
ds_read_b128 v[178:181], v217 offset:1584
ds_read_b128 v[84:87], v200 offset:32
s_waitcnt lgkmcnt(0)
v_mfma_f32_16x16x32_bf16 v[4:7], v[178:181], v[84:87], 0
ds_read_b128 v[92:95], v201 offset:32
s_waitcnt lgkmcnt(0)
v_mfma_f32_16x16x32_bf16 v[16:19], v[178:181], v[92:95], 0
ds_read_b128 v[100:103], v202 offset:32
s_waitcnt lgkmcnt(0)
v_mfma_f32_16x16x32_bf16 v[28:31], v[178:181], v[100:103], 0
ds_read_b128 v[174:177], v217 offset:2112
ds_read_b128 v[84:87], v194 offset:32
ds_read_b128 v[88:91], v194 offset:48
s_waitcnt lgkmcnt(0)
v_smfmac_f32_16x16x64_bf16 v[4:7], v[174:177], v[84:91], v213
ds_read_b128 v[92:95], v195 offset:32
ds_read_b128 v[96:99], v195 offset:48
s_waitcnt lgkmcnt(0)
v_smfmac_f32_16x16x64_bf16 v[16:19], v[174:177], v[92:99], v213
ds_read_b128 v[100:103], v196 offset:32
ds_read_b128 v[104:107], v196 offset:48
s_waitcnt lgkmcnt(0)
v_smfmac_f32_16x16x64_bf16 v[28:31], v[174:177], v[100:107], v213
ds_read_b128 v[178:181], v217 offset:2640
ds_read_b128 v[84:87], v197 offset:32
ds_read_b128 v[88:91], v197 offset:48
s_waitcnt lgkmcnt(0)
v_smfmac_f32_16x16x64_bf16 v[4:7], v[178:181], v[84:91], v213
ds_read_b128 v[92:95], v198 offset:32
ds_read_b128 v[96:99], v198 offset:48
s_waitcnt lgkmcnt(0)
v_smfmac_f32_16x16x64_bf16 v[16:19], v[178:181], v[92:99], v213
ds_read_b128 v[100:103], v199 offset:32
ds_read_b128 v[104:107], v199 offset:48
s_waitcnt lgkmcnt(0)
v_smfmac_f32_16x16x64_bf16 v[28:31], v[178:181], v[100:107], v213
ds_read_b128 v[174:177], v217 offset:3168
ds_read_b128 v[84:87], v200 offset:64
s_waitcnt lgkmcnt(0)
v_mfma_f32_16x16x32_bf16 v[8:11], v[174:177], v[84:87], 0
ds_read_b128 v[92:95], v201 offset:64
s_waitcnt lgkmcnt(0)
v_mfma_f32_16x16x32_bf16 v[20:23], v[174:177], v[92:95], 0
ds_read_b128 v[100:103], v202 offset:64
s_waitcnt lgkmcnt(0)
v_mfma_f32_16x16x32_bf16 v[32:35], v[174:177], v[100:103], 0
ds_read_b128 v[178:181], v217 offset:3696
ds_read_b128 v[84:87], v194 offset:64
ds_read_b128 v[88:91], v194 offset:80
s_waitcnt lgkmcnt(0)
v_smfmac_f32_16x16x64_bf16 v[8:11], v[178:181], v[84:91], v213
ds_read_b128 v[92:95], v195 offset:64
ds_read_b128 v[96:99], v195 offset:80
s_waitcnt lgkmcnt(0)
v_smfmac_f32_16x16x64_bf16 v[20:23], v[178:181], v[92:99], v213
ds_read_b128 v[100:103], v196 offset:64
ds_read_b128 v[104:107], v196 offset:80
s_waitcnt lgkmcnt(0)
v_smfmac_f32_16x16x64_bf16 v[32:35], v[178:181], v[100:107], v213
ds_read_b128 v[174:177], v217 offset:4224
ds_read_b128 v[84:87], v197 offset:64
ds_read_b128 v[88:91], v197 offset:80
s_waitcnt lgkmcnt(0)
v_smfmac_f32_16x16x64_bf16 v[8:11], v[174:177], v[84:91], v213
ds_read_b128 v[92:95], v198 offset:64
ds_read_b128 v[96:99], v198 offset:80
s_waitcnt lgkmcnt(0)
v_smfmac_f32_16x16x64_bf16 v[20:23], v[174:177], v[92:99], v213
ds_read_b128 v[100:103], v199 offset:64
ds_read_b128 v[104:107], v199 offset:80
s_waitcnt lgkmcnt(0)
v_smfmac_f32_16x16x64_bf16 v[32:35], v[174:177], v[100:107], v213
v_add_f32 v118, v0, v1
v_mul_f32 v119, v0, v0
v_add_f32 v118, v118, v2
v_fmac_f32 v119, v1, v1
v_add_f32 v118, v118, v3
v_fmac_f32 v119, v2, v2
v_fmac_f32 v119, v3, v3
v_add_f32 v126, v12, v13
v_mul_f32 v127, v12, v12
v_add_f32 v126, v126, v14
v_fmac_f32 v127, v13, v13
v_add_f32 v126, v126, v15
v_fmac_f32 v127, v14, v14
v_fmac_f32 v127, v15, v15
v_add_f32 v134, v24, v25
v_mul_f32 v135, v24, v24
v_add_f32 v134, v134, v26
v_fmac_f32 v135, v25, v25
v_add_f32 v134, v134, v27
v_fmac_f32 v135, v26, v26
v_fmac_f32 v135, v27, v27
v_add_f32 v118, v118, v4
v_fmac_f32 v119, v4, v4
v_add_f32 v118, v118, v5
v_fmac_f32 v119, v5, v5
v_add_f32 v118, v118, v6
v_fmac_f32 v119, v6, v6
v_add_f32 v118, v118, v7
v_fmac_f32 v119, v7, v7
v_add_f32 v126, v126, v16
v_fmac_f32 v127, v16, v16
v_add_f32 v126, v126, v17
v_fmac_f32 v127, v17, v17
v_add_f32 v126, v126, v18
v_fmac_f32 v127, v18, v18
v_add_f32 v126, v126, v19
v_fmac_f32 v127, v19, v19
v_add_f32 v134, v134, v28
v_fmac_f32 v135, v28, v28
v_add_f32 v134, v134, v29
v_fmac_f32 v135, v29, v29
v_add_f32 v134, v134, v30
v_fmac_f32 v135, v30, v30
v_add_f32 v134, v134, v31
v_fmac_f32 v135, v31, v31
v_add_f32 v118, v118, v8
v_fmac_f32 v119, v8, v8
v_add_f32 v118, v118, v9
v_fmac_f32 v119, v9, v9
v_add_f32 v118, v118, v10
v_fmac_f32 v119, v10, v10
v_add_f32 v118, v118, v11
v_fmac_f32 v119, v11, v11
v_add_f32 v126, v126, v20
v_fmac_f32 v127, v20, v20
v_add_f32 v126, v126, v21
v_fmac_f32 v127, v21, v21
v_add_f32 v126, v126, v22
v_fmac_f32 v127, v22, v22
v_add_f32 v126, v126, v23
v_fmac_f32 v127, v23, v23
v_add_f32 v134, v134, v32
v_fmac_f32 v135, v32, v32
v_add_f32 v134, v134, v33
v_fmac_f32 v135, v33, v33
v_add_f32 v134, v134, v34
v_fmac_f32 v135, v34, v34
v_add_f32 v134, v134, v35
v_fmac_f32 v135, v35, v35
v_permlane16_swap_b32 v118, v119
v_add_f32 v118, v118, v119
v_permlane16_swap_b32 v126, v127
v_add_f32 v126, v126, v127
v_permlane16_swap_b32 v134, v135
v_add_f32 v134, v134, v135
v_permlane32_swap_b32 v118, v126
v_add_f32 v118, v118, v126
ds_write_b32 v209, v118
v_mov_b32 v135, v134
s_nop 1
v_permlane32_swap_b32 v134, v135
v_add_f32 v134, v134, v135
ds_write_b32 v209, v134 offset:512
s_waitcnt lgkmcnt(0)
s_barrier
s_mul_hi_u32 s41, s35, 58835169
s_mul_i32 s42, s41, 73
s_sub_u32 s42, s35, s42
s_mul_i32 s43, s41, 1373568
s_mul_i32 s51, s42, 2688
s_add_u32 s43, s43, s51
s_cmp_lt_u32 s35, s34
s_cselect_b32 s50, s43, 1879048192
s_add_u32 s35, s35, 32
s_cmp_eq_u32 s42, 0
s_cselect_b32 s44, 536870911, s72
s_cmp_eq_u32 s42, 72
s_cselect_b32 s44, 939524095, s44
s_cmp_eq_u32 s41, 0
s_cselect_b32 s52, 1879048192, s50
s_mov_b32 s37, s50
v_and_b32 v216, s44, v208
s_add_u32 m0, s45, 0
s_nop 0
buffer_load_dwordx4 v216, s[4:7], s52 offen nt lds
s_add_u32 m0, s45, 4112
s_add_u32 s40, s37, 196224
buffer_load_dwordx4 v216, s[4:7], s40 offen nt lds
s_add_u32 m0, s45, 8224
s_add_u32 s40, s37, 392448
buffer_load_dwordx4 v216, s[4:7], s40 offen nt lds
s_add_u32 m0, s45, 12336
s_add_u32 s40, s37, 588672
buffer_load_dwordx4 v216, s[4:7], s40 offen nt lds
s_add_u32 m0, s45, 16448
s_add_u32 s40, s37, 784896
buffer_load_dwordx4 v216, s[4:7], s40 offen nt lds
s_add_u32 m0, s45, 20560
s_add_u32 s40, s37, 981120
buffer_load_dwordx4 v216, s[4:7], s40 offen nt lds
s_add_u32 m0, s45, 24672
s_add_u32 s40, s37, 1177344
buffer_load_dwordx4 v216, s[4:7], s40 offen nt lds
s_add_u32 m0, s45, 28784
s_add_u32 s40, s37, 1373568
buffer_load_dwordx4 v216, s[4:7], s40 offen nt lds
s_add_u32 m0, s45, 32896
s_add_u32 s40, s37, 1569792
buffer_load_dwordx4 v216, s[4:7], s40 offen nt lds
ds_read_b128 v[182:185], v210 offset:20480
ds_read_b128 v[186:189], v210 offset:21504
s_waitcnt lgkmcnt(1)
v_mfma_f32_16x16x32_bf16 v[138:141], a[0:3], v[182:185], 0
s_waitcnt lgkmcnt(0)
v_mfma_f32_16x16x32_bf16 v[138:141], a[4:7], v[186:189], v[138:141]
v_mfma_f32_16x16x32_bf16 v[142:145], a[24:27], v[182:185], 0
v_mfma_f32_16x16x32_bf16 v[142:145], a[28:31], v[186:189], v[142:145]
v_mfma_f32_16x16x32_bf16 v[146:149], a[48:51], v[182:185], 0
v_mfma_f32_16x16x32_bf16 v[146:149], a[52:55], v[186:189], v[146:149]
v_mfma_f32_16x16x32_bf16 v[150:153], a[216:219], v[182:185], 0
v_mfma_f32_16x16x32_bf16 v[150:153], a[220:223], v[186:189], v[150:153]
v_mfma_f32_16x16x32_bf16 v[154:157], a[240:243], v[182:185], 0
v_mfma_f32_16x16x32_bf16 v[154:157], a[244:247], v[186:189], v[154:157]
v_mfma_f32_16x16x32_bf16 v[158:161], v[232:235], v[182:185], 0
v_mfma_f32_16x16x32_bf16 v[158:161], v[236:239], v[186:189], v[158:161]
v_mfma_f32_16x16x32_bf16 v[162:165], v[182:185], a[72:75], 0
v_mfma_f32_16x16x32_bf16 v[162:165], v[186:189], a[76:79], v[162:165]
v_mfma_f32_16x16x32_bf16 v[166:169], v[182:185], a[96:99], 0
v_mfma_f32_16x16x32_bf16 v[166:169], v[186:189], a[100:103], v[166:169]
v_mfma_f32_16x16x32_bf16 v[170:173], v[182:185], a[120:123], 0
v_mfma_f32_16x16x32_bf16 v[170:173], v[186:189], a[124:127], v[170:173]
ds_read_b128 v[110:113], v210 offset:22528
ds_read_b128 v[220:223], v210 offset:23552
s_waitcnt lgkmcnt(1)
v_mfma_f32_16x16x32_bf16 v[138:141], a[8:11], v[110:113], v[138:141]
s_waitcnt lgkmcnt(0)
v_mfma_f32_16x16x32_bf16 v[138:141], a[12:15], v[220:223], v[138:141]
v_mfma_f32_16x16x32_bf16 v[142:145], a[32:35], v[110:113], v[142:145]
v_mfma_f32_16x16x32_bf16 v[142:145], a[36:39], v[220:223], v[142:145]
v_mfma_f32_16x16x32_bf16 v[146:149], a[56:59], v[110:113], v[146:149]
v_mfma_f32_16x16x32_bf16 v[146:149], a[60:63], v[220:223], v[146:149]
v_mfma_f32_16x16x32_bf16 v[150:153], a[224:227], v[110:113], v[150:153]
v_mfma_f32_16x16x32_bf16 v[150:153], a[228:231], v[220:223], v[150:153]
v_mfma_f32_16x16x32_bf16 v[154:157], a[248:251], v[110:113], v[154:157]
v_mfma_f32_16x16x32_bf16 v[154:157], a[252:255], v[220:223], v[154:157]
v_mfma_f32_16x16x32_bf16 v[158:161], v[240:243], v[110:113], v[158:161]
v_mfma_f32_16x16x32_bf16 v[158:161], v[244:247], v[220:223], v[158:161]
v_mfma_f32_16x16x32_bf16 v[162:165], v[110:113], a[80:83], v[162:165]
v_mfma_f32_16x16x32_bf16 v[162:165], v[220:223], a[84:87], v[162:165]
v_mfma_f32_16x16x32_bf16 v[166:169], v[110:113], a[104:107], v[166:169]
v_mfma_f32_16x16x32_bf16 v[166:169], v[220:223], a[108:111], v[166:169]
v_mfma_f32_16x16x32_bf16 v[170:173], v[110:113], a[128:131], v[170:173]
v_mfma_f32_16x16x32_bf16 v[170:173], v[220:223], a[132:135], v[170:173]
ds_read_b128 v[182:185], v210 offset:24576
ds_read_b128 v[186:189], v210 offset:25600
s_waitcnt lgkmcnt(1)
v_mfma_f32_16x16x32_bf16 v[138:141], a[16:19], v[182:185], v[138:141]
s_waitcnt lgkmcnt(0)
v_mfma_f32_16x16x32_bf16 v[138:141], a[20:23], v[186:189], v[138:141]
v_mfma_f32_16x16x32_bf16 v[142:145], a[40:43], v[182:185], v[142:145]
v_mfma_f32_16x16x32_bf16 v[142:145], a[44:47], v[186:189], v[142:145]
v_mfma_f32_16x16x32_bf16 v[146:149], a[64:67], v[182:185], v[146:149]
v_mfma_f32_16x16x32_bf16 v[146:149], a[68:71], v[186:189], v[146:149]
v_mfma_f32_16x16x32_bf16 v[150:153], a[232:235], v[182:185], v[150:153]
v_mfma_f32_16x16x32_bf16 v[150:153], a[236:239], v[186:189], v[150:153]
v_mfma_f32_16x16x32_bf16 v[154:157], v[224:227], v[182:185], v[154:157]
v_mfma_f32_16x16x32_bf16 v[154:157], v[228:231], v[186:189], v[154:157]
v_mfma_f32_16x16x32_bf16 v[158:161], v[248:251], v[182:185], v[158:161]
v_mfma_f32_16x16x32_bf16 v[158:161], v[252:255], v[186:189], v[158:161]
v_mfma_f32_16x16x32_bf16 v[162:165], v[182:185], a[88:91], v[162:165]
v_mfma_f32_16x16x32_bf16 v[162:165], v[186:189], a[92:95], v[162:165]
v_mfma_f32_16x16x32_bf16 v[166:169], v[182:185], a[112:115], v[166:169]
v_mfma_f32_16x16x32_bf16 v[166:169], v[186:189], a[116:119], v[166:169]
v_mfma_f32_16x16x32_bf16 v[170:173], v[182:185], a[136:139], v[170:173]
v_mfma_f32_16x16x32_bf16 v[170:173], v[186:189], a[140:143], v[170:173]
v_cvt_pk_bf16_f32 v78, v138, v139
v_cvt_pk_bf16_f32 v79, v140, v141
v_cvt_pk_bf16_f32 v80, v142, v143
v_cvt_pk_bf16_f32 v81, v144, v145
v_cvt_pk_bf16_f32 v82, v146, v147
v_cvt_pk_bf16_f32 v83, v148, v149
v_cvt_pk_bf16_f32 v72, v150, v151
v_cvt_pk_bf16_f32 v73, v152, v153
v_cvt_pk_bf16_f32 v74, v154, v155
v_cvt_pk_bf16_f32 v75, v156, v157
v_cvt_pk_bf16_f32 v76, v158, v159
v_cvt_pk_bf16_f32 v77, v160, v161
v_cvt_pk_bf16_f32 v114, v162, v163
v_cvt_pk_bf16_f32 v115, v164, v165
v_cvt_pk_bf16_f32 v122, v166, v167
v_cvt_pk_bf16_f32 v123, v168, v169
v_cvt_pk_bf16_f32 v130, v170, v171
v_cvt_pk_bf16_f32 v131, v172, v173
ds_read_b128 v[110:113], v210 offset:26624
ds_read_b128 v[220:223], v210 offset:27648
s_waitcnt lgkmcnt(1)
v_mfma_f32_16x16x32_bf16 v[138:141], a[0:3], v[110:113], 0
s_waitcnt lgkmcnt(0)
v_mfma_f32_16x16x32_bf16 v[138:141], a[4:7], v[220:223], v[138:141]
v_mfma_f32_16x16x32_bf16 v[142:145], a[24:27], v[110:113], 0
v_mfma_f32_16x16x32_bf16 v[142:145], a[28:31], v[220:223], v[142:145]
v_mfma_f32_16x16x32_bf16 v[146:149], a[48:51], v[110:113], 0
v_mfma_f32_16x16x32_bf16 v[146:149], a[52:55], v[220:223], v[146:149]
v_mfma_f32_16x16x32_bf16 v[150:153], a[216:219], v[110:113], 0
v_mfma_f32_16x16x32_bf16 v[150:153], a[220:223], v[220:223], v[150:153]
v_mfma_f32_16x16x32_bf16 v[154:157], a[240:243], v[110:113], 0
v_mfma_f32_16x16x32_bf16 v[154:157], a[244:247], v[220:223], v[154:157]
v_mfma_f32_16x16x32_bf16 v[158:161], v[232:235], v[110:113], 0
v_mfma_f32_16x16x32_bf16 v[158:161], v[236:239], v[220:223], v[158:161]
v_mfma_f32_16x16x32_bf16 v[162:165], v[110:113], a[72:75], 0
v_mfma_f32_16x16x32_bf16 v[162:165], v[220:223], a[76:79], v[162:165]
v_mfma_f32_16x16x32_bf16 v[166:169], v[110:113], a[96:99], 0
v_mfma_f32_16x16x32_bf16 v[166:169], v[220:223], a[100:103], v[166:169]
v_mfma_f32_16x16x32_bf16 v[170:173], v[110:113], a[120:123], 0
v_mfma_f32_16x16x32_bf16 v[170:173], v[220:223], a[124:127], v[170:173]
ds_read_b128 v[102:105], v210 offset:18432
ds_read_b128 v[106:109], v210 offset:19456
s_waitcnt lgkmcnt(1)
v_add_f32 v102, v102, v103
s_waitcnt lgkmcnt(0)
v_add_f32 v106, v106, v107
v_add_f32 v104, v104, v105
v_add_f32 v108, v108, v109
v_add_f32 v102, v102, v104
v_add_f32 v106, v106, v108
v_mul_f32 v103, s48, v102
v_mul_f32 v104, s73, v102
v_mul_f32 v106, s73, v106
v_fma_f32 v106, -v103, v104, v106
v_max_f32 v106, 0, v106
v_add_f32 v106, s49, v106
v_rsq_f32 v102, v106
s_nop 0
v_mul_f32_e64 v103, -v103, v102
ds_write_b64 v211, v[102:103]
ds_read_b64 v[118:119], v219
ds_read_b64 v[126:127], v219 offset:256
ds_read_b64 v[134:135], v219 offset:512
s_waitcnt lgkmcnt(2)
v_fma_f32 v220, v0, v118, v119
v_fma_f32 v221, v1, v118, v119
v_cvt_pk_bf16_f32 v90, v220, v221
v_fma_f32 v222, v2, v118, v119
v_fma_f32 v223, v3, v118, v119
v_cvt_pk_bf16_f32 v91, v222, v223
v_fma_f32 v220, v4, v118, v119
v_fma_f32 v221, v5, v118, v119
v_cvt_pk_bf16_f32 v92, v220, v221
v_fma_f32 v222, v6, v118, v119
v_fma_f32 v223, v7, v118, v119
v_cvt_pk_bf16_f32 v93, v222, v223
ds_write_b128 v211, v[90:93]
v_fma_f32 v220, v8, v118, v119
v_fma_f32 v221, v9, v118, v119
v_cvt_pk_bf16_f32 v94, v220, v221
v_fma_f32 v222, v10, v118, v119
v_fma_f32 v223, v11, v118, v119
v_cvt_pk_bf16_f32 v95, v222, v223
s_waitcnt lgkmcnt(2)
ds_write_b64 v212, v[94:95]
v_fma_f32 v220, v12, v126, v127
v_fma_f32 v221, v13, v126, v127
v_cvt_pk_bf16_f32 v174, v220, v221
v_fma_f32 v222, v14, v126, v127
v_fma_f32 v223, v15, v126, v127
v_cvt_pk_bf16_f32 v175, v222, v223
v_fma_f32 v220, v16, v126, v127
v_fma_f32 v221, v17, v126, v127
v_cvt_pk_bf16_f32 v176, v220, v221
v_fma_f32 v222, v18, v126, v127
v_fma_f32 v223, v19, v126, v127
v_cvt_pk_bf16_f32 v177, v222, v223
ds_write_b128 v211, v[174:177] offset:6144
v_fma_f32 v220, v20, v126, v127
v_fma_f32 v221, v21, v126, v127
v_cvt_pk_bf16_f32 v178, v220, v221
v_fma_f32 v222, v22, v126, v127
v_fma_f32 v223, v23, v126, v127
v_cvt_pk_bf16_f32 v179, v222, v223
s_waitcnt lgkmcnt(3)
ds_write_b64 v212, v[178:179] offset:6144
v_fma_f32 v220, v24, v134, v135
v_fma_f32 v221, v25, v134, v135
v_cvt_pk_bf16_f32 v90, v220, v221
v_fma_f32 v222, v26, v134, v135
v_fma_f32 v223, v27, v134, v135
v_cvt_pk_bf16_f32 v91, v222, v223
v_fma_f32 v220, v28, v134, v135
v_fma_f32 v221, v29, v134, v135
v_cvt_pk_bf16_f32 v92, v220, v221
v_fma_f32 v222, v30, v134, v135
v_fma_f32 v223, v31, v134, v135
v_cvt_pk_bf16_f32 v93, v222, v223
ds_write_b128 v211, v[90:93] offset:12288
v_fma_f32 v220, v32, v134, v135
v_fma_f32 v221, v33, v134, v135
v_cvt_pk_bf16_f32 v94, v220, v221
v_fma_f32 v222, v34, v134, v135
v_fma_f32 v223, v35, v134, v135
v_cvt_pk_bf16_f32 v95, v222, v223
ds_write_b64 v212, v[94:95] offset:12288
ds_read_b128 v[182:185], v210 offset:28672
ds_read_b128 v[186:189], v210 offset:29696
s_waitcnt lgkmcnt(1)
v_mfma_f32_16x16x32_bf16 v[138:141], a[8:11], v[182:185], v[138:141]
s_waitcnt lgkmcnt(0)
v_mfma_f32_16x16x32_bf16 v[138:141], a[12:15], v[186:189], v[138:141]
v_mfma_f32_16x16x32_bf16 v[142:145], a[32:35], v[182:185], v[142:145]
v_mfma_f32_16x16x32_bf16 v[142:145], a[36:39], v[186:189], v[142:145]
v_mfma_f32_16x16x32_bf16 v[146:149], a[56:59], v[182:185], v[146:149]
v_mfma_f32_16x16x32_bf16 v[146:149], a[60:63], v[186:189], v[146:149]
v_mfma_f32_16x16x32_bf16 v[150:153], a[224:227], v[182:185], v[150:153]
v_mfma_f32_16x16x32_bf16 v[150:153], a[228:231], v[186:189], v[150:153]
v_mfma_f32_16x16x32_bf16 v[154:157], a[248:251], v[182:185], v[154:157]
v_mfma_f32_16x16x32_bf16 v[154:157], a[252:255], v[186:189], v[154:157]
v_mfma_f32_16x16x32_bf16 v[158:161], v[240:243], v[182:185], v[158:161]
v_mfma_f32_16x16x32_bf16 v[158:161], v[244:247], v[186:189], v[158:161]
v_mfma_f32_16x16x32_bf16 v[162:165], v[182:185], a[80:83], v[162:165]
v_mfma_f32_16x16x32_bf16 v[162:165], v[186:189], a[84:87], v[162:165]
v_mfma_f32_16x16x32_bf16 v[166:169], v[182:185], a[104:107], v[166:169]
v_mfma_f32_16x16x32_bf16 v[166:169], v[186:189], a[108:111], v[166:169]
v_mfma_f32_16x16x32_bf16 v[170:173], v[182:185], a[128:131], v[170:173]
v_mfma_f32_16x16x32_bf16 v[170:173], v[186:189], a[132:135], v[170:173]
ds_read_b128 v[110:113], v210 offset:30720
ds_read_b128 v[106:109], v210 offset:31744
s_waitcnt lgkmcnt(1)
v_mfma_f32_16x16x32_bf16 v[138:141], a[16:19], v[110:113], v[138:141]
s_waitcnt lgkmcnt(0)
v_mfma_f32_16x16x32_bf16 v[138:141], a[20:23], v[106:109], v[138:141]
v_mfma_f32_16x16x32_bf16 v[142:145], a[40:43], v[110:113], v[142:145]
v_mfma_f32_16x16x32_bf16 v[142:145], a[44:47], v[106:109], v[142:145]
v_mfma_f32_16x16x32_bf16 v[146:149], a[64:67], v[110:113], v[146:149]
v_mfma_f32_16x16x32_bf16 v[146:149], a[68:71], v[106:109], v[146:149]
v_mfma_f32_16x16x32_bf16 v[150:153], a[232:235], v[110:113], v[150:153]
v_mfma_f32_16x16x32_bf16 v[150:153], a[236:239], v[106:109], v[150:153]
v_mfma_f32_16x16x32_bf16 v[154:157], v[224:227], v[110:113], v[154:157]
v_mfma_f32_16x16x32_bf16 v[154:157], v[228:231], v[106:109], v[154:157]
v_mfma_f32_16x16x32_bf16 v[158:161], v[248:251], v[110:113], v[158:161]
v_mfma_f32_16x16x32_bf16 v[158:161], v[252:255], v[106:109], v[158:161]
v_mfma_f32_16x16x32_bf16 v[162:165], v[110:113], a[88:91], v[162:165]
v_mfma_f32_16x16x32_bf16 v[162:165], v[106:109], a[92:95], v[162:165]
v_mfma_f32_16x16x32_bf16 v[166:169], v[110:113], a[112:115], v[166:169]
v_mfma_f32_16x16x32_bf16 v[166:169], v[106:109], a[116:119], v[166:169]
v_mfma_f32_16x16x32_bf16 v[170:173], v[110:113], a[136:139], v[170:173]
v_mfma_f32_16x16x32_bf16 v[170:173], v[106:109], a[140:143], v[170:173]
v_cvt_pk_bf16_f32 v96, v138, v139
v_cvt_pk_bf16_f32 v97, v140, v141
v_cvt_pk_bf16_f32 v98, v142, v143
v_cvt_pk_bf16_f32 v99, v144, v145
v_cvt_pk_bf16_f32 v100, v146, v147
v_cvt_pk_bf16_f32 v101, v148, v149
v_cvt_pk_bf16_f32 v84, v150, v151
v_cvt_pk_bf16_f32 v85, v152, v153
v_cvt_pk_bf16_f32 v86, v154, v155
v_cvt_pk_bf16_f32 v87, v156, v157
v_cvt_pk_bf16_f32 v88, v158, v159
v_cvt_pk_bf16_f32 v89, v160, v161
v_cvt_pk_bf16_f32 v116, v162, v163
v_cvt_pk_bf16_f32 v117, v164, v165
v_cvt_pk_bf16_f32 v124, v166, v167
v_cvt_pk_bf16_f32 v125, v168, v169
v_cvt_pk_bf16_f32 v132, v170, v171
v_cvt_pk_bf16_f32 v133, v172, v173
ds_read_b128 v[182:185], v210 offset:32768
ds_read_b128 v[186:189], v210 offset:33792
s_waitcnt lgkmcnt(1)
v_mfma_f32_16x16x32_bf16 v[138:141], a[0:3], v[182:185], 0
s_waitcnt lgkmcnt(0)
v_mfma_f32_16x16x32_bf16 v[138:141], a[4:7], v[186:189], v[138:141]
v_mfma_f32_16x16x32_bf16 v[142:145], a[24:27], v[182:185], 0
v_mfma_f32_16x16x32_bf16 v[142:145], a[28:31], v[186:189], v[142:145]
v_mfma_f32_16x16x32_bf16 v[146:149], a[48:51], v[182:185], 0
v_mfma_f32_16x16x32_bf16 v[146:149], a[52:55], v[186:189], v[146:149]
ds_read_b128 v[170:173], v210 offset:34816
ds_read_b128 v[182:185], v210 offset:35840
s_waitcnt lgkmcnt(1)
v_mfma_f32_16x16x32_bf16 v[138:141], a[8:11], v[170:173], v[138:141]
s_waitcnt lgkmcnt(0)
v_mfma_f32_16x16x32_bf16 v[138:141], a[12:15], v[182:185], v[138:141]
v_mfma_f32_16x16x32_bf16 v[142:145], a[32:35], v[170:173], v[142:145]
v_mfma_f32_16x16x32_bf16 v[142:145], a[36:39], v[182:185], v[142:145]
v_mfma_f32_16x16x32_bf16 v[146:149], a[56:59], v[170:173], v[146:149]
v_mfma_f32_16x16x32_bf16 v[146:149], a[60:63], v[182:185], v[146:149]
ds_read_b128 v[186:189], v210 offset:36864
ds_read_b128 v[170:173], v210 offset:37888
s_waitcnt lgkmcnt(1)
v_mfma_f32_16x16x32_bf16 v[138:141], a[16:19], v[186:189], v[138:141]
s_waitcnt lgkmcnt(0)
v_mfma_f32_16x16x32_bf16 v[138:141], a[20:23], v[170:173], v[138:141]
v_mfma_f32_16x16x32_bf16 v[142:145], a[40:43], v[186:189], v[142:145]
v_mfma_f32_16x16x32_bf16 v[142:145], a[44:47], v[170:173], v[142:145]
v_mfma_f32_16x16x32_bf16 v[146:149], a[64:67], v[186:189], v[146:149]
v_mfma_f32_16x16x32_bf16 v[146:149], a[68:71], v[170:173], v[146:149]
v_cvt_pk_bf16_f32 v102, v138, v139
v_cvt_pk_bf16_f32 v103, v140, v141
v_cvt_pk_bf16_f32 v104, v142, v143
v_cvt_pk_bf16_f32 v105, v144, v145
s_nop 2
v_cvt_pk_bf16_f32 v106, v146, v147
v_cvt_pk_bf16_f32 v107, v148, v149
ds_read_b128 v[108:111], v215 offset:512
ds_read_b64 v[112:113], v215 offset:528
v_mfma_f32_16x16x16_bf16 v[138:141], v[82:83], v[76:77], 0
v_mfma_f32_16x16x16_bf16 v[142:145], v[100:101], v[76:77], 0
s_waitcnt lgkmcnt(0)
v_mfma_f32_16x16x16_bf16 v[150:153], v[112:113], v[76:77], v[206:209]
v_mfma_f32_16x16x16_bf16 v[146:149], v[106:107], v[76:77], 0
v_mfma_f32_16x16x32_bf16 v[138:141], v[78:81], v[72:75], v[138:141]
v_mfma_f32_16x16x32_bf16 v[142:145], v[96:99], v[72:75], v[142:145]
v_mfma_f32_16x16x32_bf16 v[150:153], v[108:111], v[72:75], v[150:153]
v_mfma_f32_16x16x32_bf16 v[146:149], v[102:105], v[72:75], v[146:149]
ds_read_b128 v[72:75], v215
ds_read_b64 v[76:77], v215 offset:16
v_mfma_f32_16x16x16_bf16 v[154:157], v[82:83], v[88:89], 0
v_mfma_f32_16x16x16_bf16 v[158:161], v[100:101], v[88:89], 0
v_mfma_f32_16x16x16_bf16 v[166:169], v[112:113], v[88:89], v[206:209]
v_mfma_f32_16x16x16_bf16 v[162:165], v[106:107], v[88:89], 0
v_mfma_f32_16x16x32_bf16 v[154:157], v[78:81], v[84:87], v[154:157]
v_mfma_f32_16x16x32_bf16 v[158:161], v[96:99], v[84:87], v[158:161]
v_mfma_f32_16x16x32_bf16 v[166:169], v[108:111], v[84:87], v[166:169]
v_mfma_f32_16x16x32_bf16 v[162:165], v[102:105], v[84:87], v[162:165]
ds_read_b128 v[182:185], v210 offset:32768
ds_read_b128 v[186:189], v210 offset:33792
s_waitcnt lgkmcnt(1)
v_mfma_f32_16x16x32_bf16 v[118:121], v[182:185], a[72:75], 0
s_waitcnt lgkmcnt(0)
v_mfma_f32_16x16x32_bf16 v[118:121], v[186:189], a[76:79], v[118:121]
v_mfma_f32_16x16x32_bf16 v[126:129], v[182:185], a[96:99], 0
v_mfma_f32_16x16x32_bf16 v[126:129], v[186:189], a[100:103], v[126:129]
v_mfma_f32_16x16x32_bf16 v[134:137], v[182:185], a[120:123], 0
v_mfma_f32_16x16x32_bf16 v[134:137], v[186:189], a[124:127], v[134:137]
v_mfma_f32_16x16x32_bf16 v[90:93], a[216:219], v[182:185], 0
v_mfma_f32_16x16x32_bf16 v[90:93], a[220:223], v[186:189], v[90:93]
v_mfma_f32_16x16x32_bf16 v[170:173], a[240:243], v[182:185], 0
v_mfma_f32_16x16x32_bf16 v[170:173], a[244:247], v[186:189], v[170:173]
v_mfma_f32_16x16x32_bf16 v[220:223], v[232:235], v[182:185], 0
v_mfma_f32_16x16x32_bf16 v[220:223], v[236:239], v[186:189], v[220:223]
ds_read_b128 v[174:177], v210 offset:34816
ds_read_b128 v[178:181], v210 offset:35840
s_waitcnt lgkmcnt(1)
v_mfma_f32_16x16x32_bf16 v[118:121], v[174:177], a[80:83], v[118:121]
s_waitcnt lgkmcnt(0)
v_mfma_f32_16x16x32_bf16 v[118:121], v[178:181], a[84:87], v[118:121]
v_mfma_f32_16x16x32_bf16 v[126:129], v[174:177], a[104:107], v[126:129]
v_mfma_f32_16x16x32_bf16 v[126:129], v[178:181], a[108:111], v[126:129]
v_mfma_f32_16x16x32_bf16 v[134:137], v[174:177], a[128:131], v[134:137]
v_mfma_f32_16x16x32_bf16 v[134:137], v[178:181], a[132:135], v[134:137]
v_mfma_f32_16x16x32_bf16 v[90:93], a[224:227], v[174:177], v[90:93]
v_mfma_f32_16x16x32_bf16 v[90:93], a[228:231], v[178:181], v[90:93]
v_mfma_f32_16x16x32_bf16 v[170:173], a[248:251], v[174:177], v[170:173]
v_mfma_f32_16x16x32_bf16 v[170:173], a[252:255], v[178:181], v[170:173]
v_mfma_f32_16x16x32_bf16 v[220:223], v[240:243], v[174:177], v[220:223]
v_mfma_f32_16x16x32_bf16 v[220:223], v[244:247], v[178:181], v[220:223]
ds_read_b128 v[182:185], v210 offset:36864
ds_read_b128 v[186:189], v210 offset:37888
s_waitcnt lgkmcnt(1)
v_mfma_f32_16x16x32_bf16 v[118:121], v[182:185], a[88:91], v[118:121]
s_waitcnt lgkmcnt(0)
v_mfma_f32_16x16x32_bf16 v[118:121], v[186:189], a[92:95], v[118:121]
v_mfma_f32_16x16x32_bf16 v[126:129], v[182:185], a[112:115], v[126:129]
v_mfma_f32_16x16x32_bf16 v[126:129], v[186:189], a[116:119], v[126:129]
v_mfma_f32_16x16x32_bf16 v[134:137], v[182:185], a[136:139], v[134:137]
v_mfma_f32_16x16x32_bf16 v[134:137], v[186:189], a[140:143], v[134:137]
v_mfma_f32_16x16x32_bf16 v[90:93], a[232:235], v[182:185], v[90:93]
v_mfma_f32_16x16x32_bf16 v[90:93], a[236:239], v[186:189], v[90:93]
v_mfma_f32_16x16x32_bf16 v[170:173], v[224:227], v[182:185], v[170:173]
v_mfma_f32_16x16x32_bf16 v[170:173], v[228:231], v[186:189], v[170:173]
v_mfma_f32_16x16x32_bf16 v[220:223], v[248:251], v[182:185], v[220:223]
v_mfma_f32_16x16x32_bf16 v[220:223], v[252:255], v[186:189], v[220:223]
v_mov_b32 v181, 0
v_cvt_pk_bf16_f32 v118, v118, v119
v_cvt_pk_bf16_f32 v119, v120, v121
ds_read_u16 v120, v214 offset:1024
v_mov_b32 v121, 0
v_cvt_pk_bf16_f32 v126, v126, v127
v_cvt_pk_bf16_f32 v127, v128, v129
ds_read_u16 v128, v214 offset:1032
v_mov_b32 v129, 0
v_cvt_pk_bf16_f32 v134, v134, v135
v_cvt_pk_bf16_f32 v135, v136, v137
ds_read_u16 v136, v214 offset:1040
v_mov_b32 v137, 0
v_cvt_pk_bf16_f32 v90, v90, v91
v_cvt_pk_bf16_f32 v91, v92, v93
v_cvt_pk_bf16_f32 v92, v170, v171
v_cvt_pk_bf16_f32 v93, v172, v173
v_cvt_pk_bf16_f32 v94, v220, v221
v_cvt_pk_bf16_f32 v95, v222, v223
v_max3_f32 v151, v138, v139, v140
v_max3_f32 v151, v151, v141, v142
v_max3_f32 v151, v151, v143, v144
v_max3_f32 v151, v151, v145, v146
v_max3_f32 v151, v151, v147, v148
v_max3_f32 v151, v151, v149, v150
v_mov_b32 v152, v151
s_nop 1
v_permlane16_swap_b32 v151, v152
v_max_f32 v151, v151, v152
v_mov_b32 v152, v151
s_nop 1
v_permlane32_swap_b32 v151, v152
v_max_f32 v151, v151, v152
v_sub_f32 v138, v138, v151
v_sub_f32 v139, v139, v151
v_sub_f32 v140, v140, v151
v_sub_f32 v141, v141, v151
v_sub_f32 v142, v142, v151
v_sub_f32 v143, v143, v151
v_sub_f32 v144, v144, v151
v_sub_f32 v145, v145, v151
v_sub_f32 v150, v150, v151
v_sub_f32 v146, v146, v151
v_sub_f32 v147, v147, v151
v_sub_f32 v148, v148, v151
v_sub_f32 v149, v149, v151
v_exp_f32 v138, v138
v_exp_f32 v139, v139
v_exp_f32 v140, v140
v_exp_f32 v141, v141
v_exp_f32 v142, v142
v_exp_f32 v143, v143
v_exp_f32 v144, v144
v_exp_f32 v145, v145
v_exp_f32 v150, v150
v_exp_f32 v146, v146
v_exp_f32 v147, v147
v_exp_f32 v148, v148
v_exp_f32 v149, v149
v_cvt_pk_bf16_f32 v174, v138, v139
v_cvt_pk_bf16_f32 v175, v140, v141
v_cvt_pk_bf16_f32 v176, v142, v143
v_cvt_pk_bf16_f32 v177, v144, v145
v_cvt_pk_bf16_f32 v178, v146, v147
v_cvt_pk_bf16_f32 v179, v148, v149
v_cvt_pk_bf16_f32 v180, v150, 0
v_mfma_f32_16x16x32_bf16 v[150:153], v[190:193], v[174:177], 0
v_mfma_f32_16x16x32_bf16 v[150:153], v[190:193], v[178:181], v[150:153]
v_mfma_f32_16x16x32_bf16 v[138:141], v[114:117], v[174:177], 0
s_waitcnt lgkmcnt(2)
v_mfma_f32_16x16x32_bf16 v[138:141], v[118:121], v[178:181], v[138:141]
v_mfma_f32_16x16x32_bf16 v[142:145], v[122:125], v[174:177], 0
s_waitcnt lgkmcnt(1)
v_mfma_f32_16x16x32_bf16 v[142:145], v[126:129], v[178:181], v[142:145]
v_mfma_f32_16x16x32_bf16 v[146:149], v[130:133], v[174:177], 0
s_waitcnt lgkmcnt(0)
v_mfma_f32_16x16x32_bf16 v[146:149], v[134:137], v[178:181], v[146:149]
v_max3_f32 v167, v154, v155, v156
v_max3_f32 v167, v167, v157, v158
v_max3_f32 v167, v167, v159, v160
v_max3_f32 v167, v167, v161, v162
v_max3_f32 v167, v167, v163, v164
v_max3_f32 v167, v167, v165, v166
v_mov_b32 v168, v167
s_nop 1
v_permlane16_swap_b32 v167, v168
v_max_f32 v167, v167, v168
v_mov_b32 v168, v167
s_nop 1
v_permlane32_swap_b32 v167, v168
v_max_f32 v167, v167, v168
v_sub_f32 v154, v154, v167
v_sub_f32 v155, v155, v167
v_sub_f32 v156, v156, v167
v_sub_f32 v157, v157, v167
v_sub_f32 v158, v158, v167
v_sub_f32 v159, v159, v167
v_sub_f32 v160, v160, v167
v_sub_f32 v161, v161, v167
v_sub_f32 v166, v166, v167
v_sub_f32 v162, v162, v167
v_sub_f32 v163, v163, v167
v_sub_f32 v164, v164, v167
v_sub_f32 v165, v165, v167
v_exp_f32 v154, v154
v_exp_f32 v155, v155
v_exp_f32 v156, v156
v_exp_f32 v157, v157
v_exp_f32 v158, v158
v_exp_f32 v159, v159
v_exp_f32 v160, v160
v_exp_f32 v161, v161
v_exp_f32 v166, v166
v_exp_f32 v162, v162
v_exp_f32 v163, v163
v_exp_f32 v164, v164
v_exp_f32 v165, v165
v_cvt_pk_bf16_f32 v174, v154, v155
v_cvt_pk_bf16_f32 v175, v156, v157
v_cvt_pk_bf16_f32 v176, v158, v159
v_cvt_pk_bf16_f32 v177, v160, v161
v_cvt_pk_bf16_f32 v178, v162, v163
v_cvt_pk_bf16_f32 v179, v164, v165
v_cvt_pk_bf16_f32 v180, v166, 0
v_mfma_f32_16x16x32_bf16 v[166:169], v[190:193], v[174:177], 0
v_mfma_f32_16x16x32_bf16 v[166:169], v[190:193], v[178:181], v[166:169]
v_mfma_f32_16x16x32_bf16 v[154:157], v[114:117], v[174:177], 0
v_mfma_f32_16x16x32_bf16 v[154:157], v[118:121], v[178:181], v[154:157]
v_mfma_f32_16x16x32_bf16 v[158:161], v[122:125], v[174:177], 0
v_mfma_f32_16x16x32_bf16 v[158:161], v[126:129], v[178:181], v[158:161]
v_mfma_f32_16x16x32_bf16 v[162:165], v[130:133], v[174:177], 0
v_mfma_f32_16x16x32_bf16 v[162:165], v[134:137], v[178:181], v[162:165]
v_rcp_f32 v151, v150
s_nop 0
v_mul_f32 v151, s3, v151
v_mul_f32 v138, v138, v151
v_mul_f32 v139, v139, v151
v_cvt_pk_bf16_f32 v138, v138, v139
v_mul_f32 v140, v140, v151
v_mul_f32 v141, v141, v151
v_cvt_pk_bf16_f32 v139, v140, v141
v_mul_f32 v142, v142, v151
v_mul_f32 v143, v143, v151
v_cvt_pk_bf16_f32 v140, v142, v143
v_mul_f32 v144, v144, v151
v_mul_f32 v145, v145, v151
v_cvt_pk_bf16_f32 v141, v144, v145
ds_write_b128 v211, v[138:141] offset:38912
v_mul_f32 v146, v146, v151
v_mul_f32 v147, v147, v151
v_cvt_pk_bf16_f32 v142, v146, v147
v_mul_f32 v148, v148, v151
v_mul_f32 v149, v149, v151
v_cvt_pk_bf16_f32 v143, v148, v149
ds_write_b64 v212, v[142:143] offset:38912
v_mfma_f32_16x16x16_bf16 v[138:141], v[82:83], v[94:95], 0
v_mfma_f32_16x16x16_bf16 v[142:145], v[100:101], v[94:95], 0
v_mfma_f32_16x16x16_bf16 v[150:153], v[112:113], v[94:95], v[206:209]
v_mfma_f32_16x16x16_bf16 v[146:149], v[106:107], v[94:95], 0
v_mfma_f32_16x16x32_bf16 v[138:141], v[78:81], v[90:93], v[138:141]
v_mfma_f32_16x16x32_bf16 v[142:145], v[96:99], v[90:93], v[142:145]
v_mfma_f32_16x16x32_bf16 v[150:153], v[108:111], v[90:93], v[150:153]
v_mfma_f32_16x16x32_bf16 v[146:149], v[102:105], v[90:93], v[146:149]
v_rcp_f32 v167, v166
s_nop 0
v_mul_f32 v167, s3, v167
v_mul_f32 v154, v154, v167
v_mul_f32 v155, v155, v167
v_cvt_pk_bf16_f32 v154, v154, v155
v_mul_f32 v156, v156, v167
v_mul_f32 v157, v157, v167
v_cvt_pk_bf16_f32 v155, v156, v157
v_mul_f32 v158, v158, v167
v_mul_f32 v159, v159, v167
v_cvt_pk_bf16_f32 v156, v158, v159
v_mul_f32 v160, v160, v167
v_mul_f32 v161, v161, v167
v_cvt_pk_bf16_f32 v157, v160, v161
ds_write_b128 v211, v[154:157] offset:45056
v_mul_f32 v162, v162, v167
v_mul_f32 v163, v163, v167
v_cvt_pk_bf16_f32 v158, v162, v163
v_mul_f32 v164, v164, v167
v_mul_f32 v165, v165, v167
v_cvt_pk_bf16_f32 v159, v164, v165
ds_write_b64 v212, v[158:159] offset:45056
v_mfma_f32_16x16x16_bf16 v[154:157], v[76:77], v[82:83], 0
v_mfma_f32_16x16x16_bf16 v[158:161], v[76:77], v[100:101], 0
v_mfma_f32_16x16x16_bf16 v[162:165], v[76:77], v[106:107], 0
v_mfma_f32_16x16x16_bf16 v[166:169], v[76:77], v[112:113], v[206:209]
v_mfma_f32_16x16x32_bf16 v[154:157], v[72:75], v[78:81], v[154:157]
v_mfma_f32_16x16x32_bf16 v[158:161], v[72:75], v[96:99], v[158:161]
v_mfma_f32_16x16x32_bf16 v[162:165], v[72:75], v[102:105], v[162:165]
v_mfma_f32_16x16x32_bf16 v[166:169], v[72:75], v[108:111], v[166:169]
v_mov_b32_dpp v154, v158 quad_perm:[0,1,2,3] row_mask:0x2 bank_mask:0xf
s_nop 1
v_mov_b32_dpp v154, v162 quad_perm:[0,1,2,3] row_mask:0x4 bank_mask:0xf
s_nop 2
v_mov_b32_dpp v154, v167 quad_perm:[0,1,2,3] row_mask:0x8 bank_mask:0xf
v_mov_b32 v155, v154
s_nop 1
v_max_f32_dpp v155, v155, v155 row_ror:8 row_mask:0xf bank_mask:0xf
s_nop 1
v_max_f32_dpp v155, v155, v155 row_ror:4 row_mask:0xf bank_mask:0xf
s_nop 1
v_max_f32_dpp v155, v155, v155 row_ror:2 row_mask:0xf bank_mask:0xf
s_nop 1
v_max_f32_dpp v155, v155, v155 row_ror:1 row_mask:0xf bank_mask:0xf
v_mov_b32 v156, v155
s_nop 1
v_permlane16_swap_b32 v155, v156
v_max_f32 v155, v155, v156
v_mov_b32 v156, v155
s_nop 1
v_permlane32_swap_b32 v155, v156
v_max_f32 v155, v155, v156
v_sub_f32 v154, v154, v155
v_exp_f32 v154, v154
s_nop 0
v_cvt_pk_bf16_f32 v154, v154, 0
ds_write_b16 v214, v154
s_waitcnt lgkmcnt(1)
ds_read_b128 v[84:87], v215
ds_read_b128 v[88:91], v215 offset:16
v_add_u32 v215, 1552, v215
s_barrier
ds_read_b128 v[220:223], v210 offset:38912
ds_read_b128 v[110:113], v210 offset:39936
s_waitcnt lgkmcnt(1)
v_mfma_f32_16x16x32_bf16 v[36:39], a[144:147], v[220:223], v[36:39]
s_waitcnt lgkmcnt(0)
v_mfma_f32_16x16x32_bf16 v[36:39], a[148:151], v[110:113], v[36:39]
v_mfma_f32_16x16x32_bf16 v[40:43], a[168:171], v[220:223], v[40:43]
v_mfma_f32_16x16x32_bf16 v[40:43], a[172:175], v[110:113], v[40:43]
v_mfma_f32_16x16x32_bf16 v[44:47], a[192:195], v[220:223], v[44:47]
v_mfma_f32_16x16x32_bf16 v[44:47], a[196:199], v[110:113], v[44:47]
ds_read_b128 v[170:173], v210 offset:40960
ds_read_b128 v[182:185], v210 offset:41984
s_waitcnt lgkmcnt(1)
v_mfma_f32_16x16x32_bf16 v[36:39], a[152:155], v[170:173], v[36:39]
s_waitcnt lgkmcnt(0)
v_mfma_f32_16x16x32_bf16 v[36:39], a[156:159], v[182:185], v[36:39]
v_mfma_f32_16x16x32_bf16 v[40:43], a[176:179], v[170:173], v[40:43]
v_mfma_f32_16x16x32_bf16 v[40:43], a[180:183], v[182:185], v[40:43]
v_mfma_f32_16x16x32_bf16 v[44:47], a[200:203], v[170:173], v[44:47]
v_mfma_f32_16x16x32_bf16 v[44:47], a[204:207], v[182:185], v[44:47]
ds_read_b128 v[186:189], v210 offset:43008
ds_read_b128 v[220:223], v210 offset:44032
s_waitcnt lgkmcnt(1)
v_mfma_f32_16x16x32_bf16 v[36:39], a[160:163], v[186:189], v[36:39]
s_waitcnt lgkmcnt(0)
v_mfma_f32_16x16x32_bf16 v[36:39], a[164:167], v[220:223], v[36:39]
v_mfma_f32_16x16x32_bf16 v[40:43], a[184:187], v[186:189], v[40:43]
v_mfma_f32_16x16x32_bf16 v[40:43], a[188:191], v[220:223], v[40:43]
v_mfma_f32_16x16x32_bf16 v[44:47], a[208:211], v[186:189], v[44:47]
v_mfma_f32_16x16x32_bf16 v[44:47], a[212:215], v[220:223], v[44:47]
v_cvt_pk_bf16_f32 v72, v36, v37
v_cvt_pk_bf16_f32 v73, v38, v39
buffer_store_dwordx2 v[72:73], v203, s[8:11], s39 offen
v_cvt_pk_bf16_f32 v74, v40, v41
v_cvt_pk_bf16_f32 v75, v42, v43
buffer_store_dwordx2 v[74:75], v203, s[8:11], s39 offen offset:32
s_nop 0
v_cvt_pk_bf16_f32 v76, v44, v45
v_cvt_pk_bf16_f32 v77, v46, v47
buffer_store_dwordx2 v[76:77], v203, s[8:11], s39 offen offset:64
v_max3_f32 v151, v138, v139, v140
v_max3_f32 v151, v151, v141, v142
v_max3_f32 v151, v151, v143, v144
v_max3_f32 v151, v151, v145, v146
v_max3_f32 v151, v151, v147, v148
v_max3_f32 v151, v151, v149, v150
v_mov_b32 v152, v151
s_nop 1
v_permlane16_swap_b32 v151, v152
v_max_f32 v151, v151, v152
v_mov_b32 v152, v151
s_nop 1
v_permlane32_swap_b32 v151, v152
v_max_f32 v151, v151, v152
v_sub_f32 v138, v138, v151
v_sub_f32 v139, v139, v151
v_sub_f32 v140, v140, v151
v_sub_f32 v141, v141, v151
v_sub_f32 v142, v142, v151
v_sub_f32 v143, v143, v151
v_sub_f32 v144, v144, v151
v_sub_f32 v145, v145, v151
v_sub_f32 v150, v150, v151
v_sub_f32 v146, v146, v151
v_sub_f32 v147, v147, v151
v_sub_f32 v148, v148, v151
v_sub_f32 v149, v149, v151
v_exp_f32 v138, v138
v_exp_f32 v139, v139
v_exp_f32 v140, v140
v_exp_f32 v141, v141
v_exp_f32 v142, v142
v_exp_f32 v143, v143
v_exp_f32 v144, v144
v_exp_f32 v145, v145
v_exp_f32 v150, v150
v_exp_f32 v146, v146
v_exp_f32 v147, v147
v_exp_f32 v148, v148
v_exp_f32 v149, v149
v_cvt_pk_bf16_f32 v174, v138, v139
v_cvt_pk_bf16_f32 v175, v140, v141
v_cvt_pk_bf16_f32 v176, v142, v143
v_cvt_pk_bf16_f32 v177, v144, v145
v_cvt_pk_bf16_f32 v178, v146, v147
v_cvt_pk_bf16_f32 v179, v148, v149
v_cvt_pk_bf16_f32 v180, v150, 0
v_mfma_f32_16x16x32_bf16 v[150:153], v[190:193], v[174:177], 0
v_mfma_f32_16x16x32_bf16 v[150:153], v[190:193], v[178:181], v[150:153]
v_mfma_f32_16x16x32_bf16 v[138:141], v[114:117], v[174:177], 0
v_mfma_f32_16x16x32_bf16 v[138:141], v[118:121], v[178:181], v[138:141]
v_mfma_f32_16x16x32_bf16 v[142:145], v[122:125], v[174:177], 0
v_mfma_f32_16x16x32_bf16 v[142:145], v[126:129], v[178:181], v[142:145]
v_mfma_f32_16x16x32_bf16 v[146:149], v[130:133], v[174:177], 0
v_mfma_f32_16x16x32_bf16 v[146:149], v[134:137], v[178:181], v[146:149]
v_mfma_f32_16x16x32_bf16 v[166:169], v[84:87], v[190:193], 0
v_mfma_f32_16x16x32_bf16 v[166:169], v[88:91], v[190:193], v[166:169]
v_mfma_f32_16x16x32_bf16 v[154:157], v[84:87], v[114:117], 0
v_mfma_f32_16x16x32_bf16 v[154:157], v[88:91], v[118:121], v[154:157]
v_mfma_f32_16x16x32_bf16 v[158:161], v[84:87], v[122:125], 0
v_mfma_f32_16x16x32_bf16 v[158:161], v[88:91], v[126:129], v[158:161]
v_mfma_f32_16x16x32_bf16 v[162:165], v[84:87], v[130:133], 0
v_mfma_f32_16x16x32_bf16 v[162:165], v[88:91], v[134:137], v[162:165]
v_rcp_f32 v167, v166
v_mov_b32_dpp v154, v158 quad_perm:[0,1,2,3] row_mask:0x2 bank_mask:0xf
s_nop 3
v_mov_b32_dpp v154, v162 quad_perm:[0,1,2,3] row_mask:0x4 bank_mask:0xf
v_mul_f32 v167, s3, v167
v_mul_f32 v154, v154, v167
v_cvt_pk_bf16_f32 v154, v154, 0
ds_write_b16 v214, v154
v_add_u32 v214, 1552, v214
ds_read_b128 v[110:113], v210 offset:45056
ds_read_b128 v[170:173], v210 offset:46080
s_waitcnt lgkmcnt(1)
v_mfma_f32_16x16x32_bf16 v[48:51], a[144:147], v[110:113], v[48:51]
s_waitcnt lgkmcnt(0)
v_mfma_f32_16x16x32_bf16 v[48:51], a[148:151], v[170:173], v[48:51]
v_mfma_f32_16x16x32_bf16 v[52:55], a[168:171], v[110:113], v[52:55]
v_mfma_f32_16x16x32_bf16 v[52:55], a[172:175], v[170:173], v[52:55]
v_mfma_f32_16x16x32_bf16 v[56:59], a[192:195], v[110:113], v[56:59]
v_mfma_f32_16x16x32_bf16 v[56:59], a[196:199], v[170:173], v[56:59]
ds_read_b128 v[182:185], v210 offset:47104
ds_read_b128 v[186:189], v210 offset:48128
s_waitcnt lgkmcnt(1)
v_mfma_f32_16x16x32_bf16 v[48:51], a[152:155], v[182:185], v[48:51]
s_waitcnt lgkmcnt(0)
v_mfma_f32_16x16x32_bf16 v[48:51], a[156:159], v[186:189], v[48:51]
v_mfma_f32_16x16x32_bf16 v[52:55], a[176:179], v[182:185], v[52:55]
v_mfma_f32_16x16x32_bf16 v[52:55], a[180:183], v[186:189], v[52:55]
v_mfma_f32_16x16x32_bf16 v[56:59], a[200:203], v[182:185], v[56:59]
v_mfma_f32_16x16x32_bf16 v[56:59], a[204:207], v[186:189], v[56:59]
ds_read_b128 v[220:223], v210 offset:49152
ds_read_b128 v[110:113], v210 offset:50176
s_waitcnt lgkmcnt(1)
v_mfma_f32_16x16x32_bf16 v[48:51], a[160:163], v[220:223], v[48:51]
s_waitcnt lgkmcnt(0)
v_mfma_f32_16x16x32_bf16 v[48:51], a[164:167], v[110:113], v[48:51]
v_mfma_f32_16x16x32_bf16 v[52:55], a[184:187], v[220:223], v[52:55]
v_mfma_f32_16x16x32_bf16 v[52:55], a[188:191], v[110:113], v[52:55]
v_mfma_f32_16x16x32_bf16 v[56:59], a[208:211], v[220:223], v[56:59]
v_mfma_f32_16x16x32_bf16 v[56:59], a[212:215], v[110:113], v[56:59]
v_cvt_pk_bf16_f32 v78, v48, v49
v_cvt_pk_bf16_f32 v79, v50, v51
buffer_store_dwordx2 v[78:79], v204, s[8:11], s39 offen
v_cvt_pk_bf16_f32 v80, v52, v53
v_cvt_pk_bf16_f32 v81, v54, v55
buffer_store_dwordx2 v[80:81], v204, s[8:11], s39 offen offset:32
s_nop 0
v_cvt_pk_bf16_f32 v82, v56, v57
v_cvt_pk_bf16_f32 v83, v58, v59
buffer_store_dwordx2 v[82:83], v204, s[8:11], s39 offen offset:64
v_rcp_f32 v151, v150
s_nop 0
v_mul_f32 v151, s3, v151
v_mul_f32 v138, v138, v151
v_mul_f32 v139, v139, v151
v_cvt_pk_bf16_f32 v138, v138, v139
v_mul_f32 v140, v140, v151
v_mul_f32 v141, v141, v151
v_cvt_pk_bf16_f32 v139, v140, v141
v_mul_f32 v142, v142, v151
v_mul_f32 v143, v143, v151
v_cvt_pk_bf16_f32 v140, v142, v143
v_mul_f32 v144, v144, v151
v_mul_f32 v145, v145, v151
v_cvt_pk_bf16_f32 v141, v144, v145
ds_write_b128 v211, v[138:141] offset:51200
v_mul_f32 v146, v146, v151
v_mul_f32 v147, v147, v151
v_cvt_pk_bf16_f32 v142, v146, v147
v_mul_f32 v148, v148, v151
v_mul_f32 v149, v149, v151
v_cvt_pk_bf16_f32 v143, v148, v149
ds_write_b64 v212, v[142:143] offset:51200
s_waitcnt vmcnt(6) lgkmcnt(0)
s_barrier
ds_read_b128 v[170:173], v210 offset:51200
ds_read_b128 v[182:185], v210 offset:52224
s_waitcnt lgkmcnt(1)
v_mfma_f32_16x16x32_bf16 v[60:63], a[144:147], v[170:173], v[60:63]
s_waitcnt lgkmcnt(0)
v_mfma_f32_16x16x32_bf16 v[60:63], a[148:151], v[182:185], v[60:63]
v_mfma_f32_16x16x32_bf16 v[64:67], a[168:171], v[170:173], v[64:67]
v_mfma_f32_16x16x32_bf16 v[64:67], a[172:175], v[182:185], v[64:67]
v_mfma_f32_16x16x32_bf16 v[68:71], a[192:195], v[170:173], v[68:71]
v_mfma_f32_16x16x32_bf16 v[68:71], a[196:199], v[182:185], v[68:71]
ds_read_b128 v[186:189], v210 offset:53248
ds_read_b128 v[220:223], v210 offset:54272
s_waitcnt lgkmcnt(1)
v_mfma_f32_16x16x32_bf16 v[60:63], a[152:155], v[186:189], v[60:63]
s_waitcnt lgkmcnt(0)
v_mfma_f32_16x16x32_bf16 v[60:63], a[156:159], v[220:223], v[60:63]
v_mfma_f32_16x16x32_bf16 v[64:67], a[176:179], v[186:189], v[64:67]
v_mfma_f32_16x16x32_bf16 v[64:67], a[180:183], v[220:223], v[64:67]
v_mfma_f32_16x16x32_bf16 v[68:71], a[200:203], v[186:189], v[68:71]
v_mfma_f32_16x16x32_bf16 v[68:71], a[204:207], v[220:223], v[68:71]
ds_read_b128 v[110:113], v210 offset:55296
ds_read_b128 v[170:173], v210 offset:56320
s_waitcnt lgkmcnt(1)
v_mfma_f32_16x16x32_bf16 v[60:63], a[160:163], v[110:113], v[60:63]
s_waitcnt lgkmcnt(0)
v_mfma_f32_16x16x32_bf16 v[60:63], a[164:167], v[170:173], v[60:63]
v_mfma_f32_16x16x32_bf16 v[64:67], a[184:187], v[110:113], v[64:67]
v_mfma_f32_16x16x32_bf16 v[64:67], a[188:191], v[170:173], v[64:67]
v_mfma_f32_16x16x32_bf16 v[68:71], a[208:211], v[110:113], v[68:71]
v_mfma_f32_16x16x32_bf16 v[68:71], a[212:215], v[170:173], v[68:71]
v_cvt_pk_bf16_f32 v116, v60, v61
v_cvt_pk_bf16_f32 v117, v62, v63
buffer_store_dwordx2 v[116:117], v205, s[8:11], s39 offen
v_cvt_pk_bf16_f32 v124, v64, v65
v_cvt_pk_bf16_f32 v125, v66, v67
buffer_store_dwordx2 v[124:125], v205, s[8:11], s39 offen offset:32
s_nop 0
v_cvt_pk_bf16_f32 v132, v68, v69
v_cvt_pk_bf16_f32 v133, v70, v71
buffer_store_dwordx2 v[132:133], v205, s[8:11], s39 offen offset:64
s_mov_b32 s38, s36
ds_read_b128 v[174:177], v217
ds_read_b128 v[84:87], v200
s_waitcnt lgkmcnt(0)
v_mfma_f32_16x16x32_bf16 v[36:39], v[174:177], v[84:87], 0
ds_read_b128 v[92:95], v201
s_waitcnt lgkmcnt(0)
v_mfma_f32_16x16x32_bf16 v[48:51], v[174:177], v[92:95], 0
ds_read_b128 v[100:103], v202
s_waitcnt lgkmcnt(0)
v_mfma_f32_16x16x32_bf16 v[60:63], v[174:177], v[100:103], 0
ds_read_b128 v[178:181], v217 offset:528
ds_read_b128 v[84:87], v194
ds_read_b128 v[88:91], v194 offset:16
s_waitcnt lgkmcnt(0)
v_smfmac_f32_16x16x64_bf16 v[36:39], v[178:181], v[84:91], v213
ds_read_b128 v[92:95], v195
ds_read_b128 v[96:99], v195 offset:16
s_waitcnt lgkmcnt(0)
v_smfmac_f32_16x16x64_bf16 v[48:51], v[178:181], v[92:99], v213
ds_read_b128 v[100:103], v196
ds_read_b128 v[104:107], v196 offset:16
s_waitcnt lgkmcnt(0)
v_smfmac_f32_16x16x64_bf16 v[60:63], v[178:181], v[100:107], v213
ds_read_b128 v[174:177], v217 offset:1056
ds_read_b128 v[84:87], v197
ds_read_b128 v[88:91], v197 offset:16
s_waitcnt lgkmcnt(0)
v_smfmac_f32_16x16x64_bf16 v[36:39], v[174:177], v[84:91], v213
ds_read_b128 v[92:95], v198
ds_read_b128 v[96:99], v198 offset:16
s_waitcnt lgkmcnt(0)
v_smfmac_f32_16x16x64_bf16 v[48:51], v[174:177], v[92:99], v213
ds_read_b128 v[100:103], v199
ds_read_b128 v[104:107], v199 offset:16
s_waitcnt lgkmcnt(0)
v_smfmac_f32_16x16x64_bf16 v[60:63], v[174:177], v[100:107], v213
ds_read_b128 v[178:181], v217 offset:1584
ds_read_b128 v[84:87], v200 offset:32
s_waitcnt lgkmcnt(0)
v_mfma_f32_16x16x32_bf16 v[40:43], v[178:181], v[84:87], 0
ds_read_b128 v[92:95], v201 offset:32
s_waitcnt lgkmcnt(0)
v_mfma_f32_16x16x32_bf16 v[52:55], v[178:181], v[92:95], 0
ds_read_b128 v[100:103], v202 offset:32
s_waitcnt lgkmcnt(0)
v_mfma_f32_16x16x32_bf16 v[64:67], v[178:181], v[100:103], 0
ds_read_b128 v[174:177], v217 offset:2112
ds_read_b128 v[84:87], v194 offset:32
ds_read_b128 v[88:91], v194 offset:48
s_waitcnt lgkmcnt(0)
v_smfmac_f32_16x16x64_bf16 v[40:43], v[174:177], v[84:91], v213
ds_read_b128 v[92:95], v195 offset:32
ds_read_b128 v[96:99], v195 offset:48
s_waitcnt lgkmcnt(0)
v_smfmac_f32_16x16x64_bf16 v[52:55], v[174:177], v[92:99], v213
ds_read_b128 v[100:103], v196 offset:32
ds_read_b128 v[104:107], v196 offset:48
s_waitcnt lgkmcnt(0)
v_smfmac_f32_16x16x64_bf16 v[64:67], v[174:177], v[100:107], v213
ds_read_b128 v[178:181], v217 offset:2640
ds_read_b128 v[84:87], v197 offset:32
ds_read_b128 v[88:91], v197 offset:48
s_waitcnt lgkmcnt(0)
v_smfmac_f32_16x16x64_bf16 v[40:43], v[178:181], v[84:91], v213
ds_read_b128 v[92:95], v198 offset:32
ds_read_b128 v[96:99], v198 offset:48
s_waitcnt lgkmcnt(0)
v_smfmac_f32_16x16x64_bf16 v[52:55], v[178:181], v[92:99], v213
ds_read_b128 v[100:103], v199 offset:32
ds_read_b128 v[104:107], v199 offset:48
s_waitcnt lgkmcnt(0)
v_smfmac_f32_16x16x64_bf16 v[64:67], v[178:181], v[100:107], v213
ds_read_b128 v[174:177], v217 offset:3168
ds_read_b128 v[84:87], v200 offset:64
s_waitcnt lgkmcnt(0)
v_mfma_f32_16x16x32_bf16 v[44:47], v[174:177], v[84:87], 0
ds_read_b128 v[92:95], v201 offset:64
s_waitcnt lgkmcnt(0)
v_mfma_f32_16x16x32_bf16 v[56:59], v[174:177], v[92:95], 0
ds_read_b128 v[100:103], v202 offset:64
s_waitcnt lgkmcnt(0)
v_mfma_f32_16x16x32_bf16 v[68:71], v[174:177], v[100:103], 0
ds_read_b128 v[178:181], v217 offset:3696
ds_read_b128 v[84:87], v194 offset:64
ds_read_b128 v[88:91], v194 offset:80
s_waitcnt lgkmcnt(0)
v_smfmac_f32_16x16x64_bf16 v[44:47], v[178:181], v[84:91], v213
ds_read_b128 v[92:95], v195 offset:64
ds_read_b128 v[96:99], v195 offset:80
s_waitcnt lgkmcnt(0)
v_smfmac_f32_16x16x64_bf16 v[56:59], v[178:181], v[92:99], v213
ds_read_b128 v[100:103], v196 offset:64
ds_read_b128 v[104:107], v196 offset:80
s_waitcnt lgkmcnt(0)
v_smfmac_f32_16x16x64_bf16 v[68:71], v[178:181], v[100:107], v213
ds_read_b128 v[174:177], v217 offset:4224
ds_read_b128 v[84:87], v197 offset:64
ds_read_b128 v[88:91], v197 offset:80
s_waitcnt lgkmcnt(0)
v_smfmac_f32_16x16x64_bf16 v[44:47], v[174:177], v[84:91], v213
ds_read_b128 v[92:95], v198 offset:64
ds_read_b128 v[96:99], v198 offset:80
s_waitcnt lgkmcnt(0)
v_smfmac_f32_16x16x64_bf16 v[56:59], v[174:177], v[92:99], v213
ds_read_b128 v[100:103], v199 offset:64
ds_read_b128 v[104:107], v199 offset:80
s_waitcnt lgkmcnt(0)
v_smfmac_f32_16x16x64_bf16 v[68:71], v[174:177], v[100:107], v213
v_add_f32 v118, v36, v37
v_mul_f32 v119, v36, v36
v_add_f32 v118, v118, v38
v_fmac_f32 v119, v37, v37
v_add_f32 v118, v118, v39
v_fmac_f32 v119, v38, v38
v_fmac_f32 v119, v39, v39
v_add_f32 v126, v48, v49
v_mul_f32 v127, v48, v48
v_add_f32 v126, v126, v50
v_fmac_f32 v127, v49, v49
v_add_f32 v126, v126, v51
v_fmac_f32 v127, v50, v50
v_fmac_f32 v127, v51, v51
v_add_f32 v134, v60, v61
v_mul_f32 v135, v60, v60
v_add_f32 v134, v134, v62
v_fmac_f32 v135, v61, v61
v_add_f32 v134, v134, v63
v_fmac_f32 v135, v62, v62
v_fmac_f32 v135, v63, v63
v_add_f32 v118, v118, v40
v_fmac_f32 v119, v40, v40
v_add_f32 v118, v118, v41
v_fmac_f32 v119, v41, v41
v_add_f32 v118, v118, v42
v_fmac_f32 v119, v42, v42
v_add_f32 v118, v118, v43
v_fmac_f32 v119, v43, v43
v_add_f32 v126, v126, v52
v_fmac_f32 v127, v52, v52
v_add_f32 v126, v126, v53
v_fmac_f32 v127, v53, v53
v_add_f32 v126, v126, v54
v_fmac_f32 v127, v54, v54
v_add_f32 v126, v126, v55
v_fmac_f32 v127, v55, v55
v_add_f32 v134, v134, v64
v_fmac_f32 v135, v64, v64
v_add_f32 v134, v134, v65
v_fmac_f32 v135, v65, v65
v_add_f32 v134, v134, v66
v_fmac_f32 v135, v66, v66
v_add_f32 v134, v134, v67
v_fmac_f32 v135, v67, v67
v_add_f32 v118, v118, v44
v_fmac_f32 v119, v44, v44
v_add_f32 v118, v118, v45
v_fmac_f32 v119, v45, v45
v_add_f32 v118, v118, v46
v_fmac_f32 v119, v46, v46
v_add_f32 v118, v118, v47
v_fmac_f32 v119, v47, v47
v_add_f32 v126, v126, v56
v_fmac_f32 v127, v56, v56
v_add_f32 v126, v126, v57
v_fmac_f32 v127, v57, v57
v_add_f32 v126, v126, v58
v_fmac_f32 v127, v58, v58
v_add_f32 v126, v126, v59
v_fmac_f32 v127, v59, v59
v_add_f32 v134, v134, v68
v_fmac_f32 v135, v68, v68
v_add_f32 v134, v134, v69
v_fmac_f32 v135, v69, v69
v_add_f32 v134, v134, v70
v_fmac_f32 v135, v70, v70
v_add_f32 v134, v134, v71
v_fmac_f32 v135, v71, v71
v_permlane16_swap_b32 v118, v119
v_add_f32 v118, v118, v119
v_permlane16_swap_b32 v126, v127
v_add_f32 v126, v126, v127
v_permlane16_swap_b32 v134, v135
v_add_f32 v134, v134, v135
v_permlane32_swap_b32 v118, v126
v_add_f32 v118, v118, v126
ds_write_b32 v209, v118
v_mov_b32 v135, v134
s_nop 1
v_permlane32_swap_b32 v134, v135
v_add_f32 v134, v134, v135
ds_write_b32 v209, v134 offset:512
s_waitcnt lgkmcnt(0)
s_barrier
s_mov_b32 s35, s97
s_mul_hi_u32 s41, s35, 58835169
s_mul_i32 s42, s41, 73
s_sub_u32 s42, s35, s42
s_mul_i32 s43, s41, 1373568
s_mul_i32 s51, s42, 2688
s_add_u32 s43, s43, s51
s_cmp_lt_u32 s35, s34
s_cselect_b32 s50, s43, 1879048192
s_add_u32 s35, s35, 32
s_cmp_eq_u32 s42, 0
s_cselect_b32 s44, 536870911, s72
s_cmp_eq_u32 s42, 72
s_cselect_b32 s44, 939524095, s44
s_cmp_eq_u32 s41, 0
s_cselect_b32 s52, 1879048192, s50
s_mov_b32 s36, s50
v_and_b32 v216, s44, v208
s_add_u32 m0, s45, 0
s_nop 0
buffer_load_dwordx4 v216, s[4:7], s52 offen nt lds
s_add_u32 m0, s45, 4112
s_add_u32 s40, s36, 196224
buffer_load_dwordx4 v216, s[4:7], s40 offen nt lds
s_add_u32 m0, s45, 8224
s_add_u32 s40, s36, 392448
buffer_load_dwordx4 v216, s[4:7], s40 offen nt lds
s_add_u32 m0, s45, 12336
s_add_u32 s40, s36, 588672
buffer_load_dwordx4 v216, s[4:7], s40 offen nt lds
s_add_u32 m0, s45, 16448
s_add_u32 s40, s36, 784896
buffer_load_dwordx4 v216, s[4:7], s40 offen nt lds
s_add_u32 m0, s45, 20560
s_add_u32 s40, s36, 981120
buffer_load_dwordx4 v216, s[4:7], s40 offen nt lds
s_add_u32 m0, s45, 24672
s_add_u32 s40, s36, 1177344
buffer_load_dwordx4 v216, s[4:7], s40 offen nt lds
s_add_u32 m0, s45, 28784
s_add_u32 s40, s36, 1373568
buffer_load_dwordx4 v216, s[4:7], s40 offen nt lds
s_add_u32 m0, s45, 32896
s_add_u32 s40, s36, 1569792
buffer_load_dwordx4 v216, s[4:7], s40 offen nt lds
ds_read_b128 v[182:185], v210
ds_read_b128 v[186:189], v210 offset:1024
s_waitcnt lgkmcnt(1)
v_mfma_f32_16x16x32_bf16 v[138:141], a[0:3], v[182:185], 0
s_waitcnt lgkmcnt(0)
v_mfma_f32_16x16x32_bf16 v[138:141], a[4:7], v[186:189], v[138:141]
v_mfma_f32_16x16x32_bf16 v[142:145], a[24:27], v[182:185], 0
v_mfma_f32_16x16x32_bf16 v[142:145], a[28:31], v[186:189], v[142:145]
v_mfma_f32_16x16x32_bf16 v[146:149], a[48:51], v[182:185], 0
v_mfma_f32_16x16x32_bf16 v[146:149], a[52:55], v[186:189], v[146:149]
v_mfma_f32_16x16x32_bf16 v[150:153], a[216:219], v[182:185], 0
v_mfma_f32_16x16x32_bf16 v[150:153], a[220:223], v[186:189], v[150:153]
v_mfma_f32_16x16x32_bf16 v[154:157], a[240:243], v[182:185], 0
v_mfma_f32_16x16x32_bf16 v[154:157], a[244:247], v[186:189], v[154:157]
v_mfma_f32_16x16x32_bf16 v[158:161], v[232:235], v[182:185], 0
v_mfma_f32_16x16x32_bf16 v[158:161], v[236:239], v[186:189], v[158:161]
v_mfma_f32_16x16x32_bf16 v[162:165], v[182:185], a[72:75], 0
v_mfma_f32_16x16x32_bf16 v[162:165], v[186:189], a[76:79], v[162:165]
v_mfma_f32_16x16x32_bf16 v[166:169], v[182:185], a[96:99], 0
v_mfma_f32_16x16x32_bf16 v[166:169], v[186:189], a[100:103], v[166:169]
v_mfma_f32_16x16x32_bf16 v[170:173], v[182:185], a[120:123], 0
v_mfma_f32_16x16x32_bf16 v[170:173], v[186:189], a[124:127], v[170:173]
ds_read_b128 v[110:113], v210 offset:2048
ds_read_b128 v[220:223], v210 offset:3072
s_waitcnt lgkmcnt(1)
v_mfma_f32_16x16x32_bf16 v[138:141], a[8:11], v[110:113], v[138:141]
s_waitcnt lgkmcnt(0)
v_mfma_f32_16x16x32_bf16 v[138:141], a[12:15], v[220:223], v[138:141]
v_mfma_f32_16x16x32_bf16 v[142:145], a[32:35], v[110:113], v[142:145]
v_mfma_f32_16x16x32_bf16 v[142:145], a[36:39], v[220:223], v[142:145]
v_mfma_f32_16x16x32_bf16 v[146:149], a[56:59], v[110:113], v[146:149]
v_mfma_f32_16x16x32_bf16 v[146:149], a[60:63], v[220:223], v[146:149]
v_mfma_f32_16x16x32_bf16 v[150:153], a[224:227], v[110:113], v[150:153]
v_mfma_f32_16x16x32_bf16 v[150:153], a[228:231], v[220:223], v[150:153]
v_mfma_f32_16x16x32_bf16 v[154:157], a[248:251], v[110:113], v[154:157]
v_mfma_f32_16x16x32_bf16 v[154:157], a[252:255], v[220:223], v[154:157]
v_mfma_f32_16x16x32_bf16 v[158:161], v[240:243], v[110:113], v[158:161]
v_mfma_f32_16x16x32_bf16 v[158:161], v[244:247], v[220:223], v[158:161]
v_mfma_f32_16x16x32_bf16 v[162:165], v[110:113], a[80:83], v[162:165]
v_mfma_f32_16x16x32_bf16 v[162:165], v[220:223], a[84:87], v[162:165]
v_mfma_f32_16x16x32_bf16 v[166:169], v[110:113], a[104:107], v[166:169]
v_mfma_f32_16x16x32_bf16 v[166:169], v[220:223], a[108:111], v[166:169]
v_mfma_f32_16x16x32_bf16 v[170:173], v[110:113], a[128:131], v[170:173]
v_mfma_f32_16x16x32_bf16 v[170:173], v[220:223], a[132:135], v[170:173]
ds_read_b128 v[182:185], v210 offset:4096
ds_read_b128 v[186:189], v210 offset:5120
s_waitcnt lgkmcnt(1)
v_mfma_f32_16x16x32_bf16 v[138:141], a[16:19], v[182:185], v[138:141]
s_waitcnt lgkmcnt(0)
v_mfma_f32_16x16x32_bf16 v[138:141], a[20:23], v[186:189], v[138:141]
v_mfma_f32_16x16x32_bf16 v[142:145], a[40:43], v[182:185], v[142:145]
v_mfma_f32_16x16x32_bf16 v[142:145], a[44:47], v[186:189], v[142:145]
v_mfma_f32_16x16x32_bf16 v[146:149], a[64:67], v[182:185], v[146:149]
v_mfma_f32_16x16x32_bf16 v[146:149], a[68:71], v[186:189], v[146:149]
v_mfma_f32_16x16x32_bf16 v[150:153], a[232:235], v[182:185], v[150:153]
v_mfma_f32_16x16x32_bf16 v[150:153], a[236:239], v[186:189], v[150:153]
v_mfma_f32_16x16x32_bf16 v[154:157], v[224:227], v[182:185], v[154:157]
v_mfma_f32_16x16x32_bf16 v[154:157], v[228:231], v[186:189], v[154:157]
v_mfma_f32_16x16x32_bf16 v[158:161], v[248:251], v[182:185], v[158:161]
v_mfma_f32_16x16x32_bf16 v[158:161], v[252:255], v[186:189], v[158:161]
v_mfma_f32_16x16x32_bf16 v[162:165], v[182:185], a[88:91], v[162:165]
v_mfma_f32_16x16x32_bf16 v[162:165], v[186:189], a[92:95], v[162:165]
v_mfma_f32_16x16x32_bf16 v[166:169], v[182:185], a[112:115], v[166:169]
v_mfma_f32_16x16x32_bf16 v[166:169], v[186:189], a[116:119], v[166:169]
v_mfma_f32_16x16x32_bf16 v[170:173], v[182:185], a[136:139], v[170:173]
v_mfma_f32_16x16x32_bf16 v[170:173], v[186:189], a[140:143], v[170:173]
v_cvt_pk_bf16_f32 v78, v138, v139
v_cvt_pk_bf16_f32 v79, v140, v141
v_cvt_pk_bf16_f32 v80, v142, v143
v_cvt_pk_bf16_f32 v81, v144, v145
v_cvt_pk_bf16_f32 v82, v146, v147
v_cvt_pk_bf16_f32 v83, v148, v149
v_cvt_pk_bf16_f32 v72, v150, v151
v_cvt_pk_bf16_f32 v73, v152, v153
v_cvt_pk_bf16_f32 v74, v154, v155
v_cvt_pk_bf16_f32 v75, v156, v157
v_cvt_pk_bf16_f32 v76, v158, v159
v_cvt_pk_bf16_f32 v77, v160, v161
v_cvt_pk_bf16_f32 v114, v162, v163
v_cvt_pk_bf16_f32 v115, v164, v165
v_cvt_pk_bf16_f32 v122, v166, v167
v_cvt_pk_bf16_f32 v123, v168, v169
v_cvt_pk_bf16_f32 v130, v170, v171
v_cvt_pk_bf16_f32 v131, v172, v173
ds_read_b128 v[110:113], v210 offset:6144
ds_read_b128 v[220:223], v210 offset:7168
s_waitcnt lgkmcnt(1)
v_mfma_f32_16x16x32_bf16 v[138:141], a[0:3], v[110:113], 0
s_waitcnt lgkmcnt(0)
v_mfma_f32_16x16x32_bf16 v[138:141], a[4:7], v[220:223], v[138:141]
v_mfma_f32_16x16x32_bf16 v[142:145], a[24:27], v[110:113], 0
v_mfma_f32_16x16x32_bf16 v[142:145], a[28:31], v[220:223], v[142:145]
v_mfma_f32_16x16x32_bf16 v[146:149], a[48:51], v[110:113], 0
v_mfma_f32_16x16x32_bf16 v[146:149], a[52:55], v[220:223], v[146:149]
v_mfma_f32_16x16x32_bf16 v[150:153], a[216:219], v[110:113], 0
v_mfma_f32_16x16x32_bf16 v[150:153], a[220:223], v[220:223], v[150:153]
v_mfma_f32_16x16x32_bf16 v[154:157], a[240:243], v[110:113], 0
v_mfma_f32_16x16x32_bf16 v[154:157], a[244:247], v[220:223], v[154:157]
v_mfma_f32_16x16x32_bf16 v[158:161], v[232:235], v[110:113], 0
v_mfma_f32_16x16x32_bf16 v[158:161], v[236:239], v[220:223], v[158:161]
v_mfma_f32_16x16x32_bf16 v[162:165], v[110:113], a[72:75], 0
v_mfma_f32_16x16x32_bf16 v[162:165], v[220:223], a[76:79], v[162:165]
v_mfma_f32_16x16x32_bf16 v[166:169], v[110:113], a[96:99], 0
v_mfma_f32_16x16x32_bf16 v[166:169], v[220:223], a[100:103], v[166:169]
v_mfma_f32_16x16x32_bf16 v[170:173], v[110:113], a[120:123], 0
v_mfma_f32_16x16x32_bf16 v[170:173], v[220:223], a[124:127], v[170:173]
ds_read_b128 v[102:105], v210 offset:18432
ds_read_b128 v[106:109], v210 offset:19456
s_waitcnt lgkmcnt(1)
v_add_f32 v102, v102, v103
s_waitcnt lgkmcnt(0)
v_add_f32 v106, v106, v107
v_add_f32 v104, v104, v105
v_add_f32 v108, v108, v109
v_add_f32 v102, v102, v104
v_add_f32 v106, v106, v108
v_mul_f32 v103, s48, v102
v_mul_f32 v104, s73, v102
v_mul_f32 v106, s73, v106
v_fma_f32 v106, -v103, v104, v106
v_max_f32 v106, 0, v106
v_add_f32 v106, s49, v106
v_rsq_f32 v102, v106
s_nop 0
v_mul_f32_e64 v103, -v103, v102
ds_write_b64 v211, v[102:103] offset:20480
ds_read_b64 v[118:119], v219 offset:20480
ds_read_b64 v[126:127], v219 offset:20736
ds_read_b64 v[134:135], v219 offset:20992
s_waitcnt lgkmcnt(2)
v_fma_f32 v220, v36, v118, v119
v_fma_f32 v221, v37, v118, v119
v_cvt_pk_bf16_f32 v90, v220, v221
v_fma_f32 v222, v38, v118, v119
v_fma_f32 v223, v39, v118, v119
v_cvt_pk_bf16_f32 v91, v222, v223
v_fma_f32 v220, v40, v118, v119
v_fma_f32 v221, v41, v118, v119
v_cvt_pk_bf16_f32 v92, v220, v221
v_fma_f32 v222, v42, v118, v119
v_fma_f32 v223, v43, v118, v119
v_cvt_pk_bf16_f32 v93, v222, v223
ds_write_b128 v211, v[90:93] offset:20480
v_fma_f32 v220, v44, v118, v119
v_fma_f32 v221, v45, v118, v119
v_cvt_pk_bf16_f32 v94, v220, v221
v_fma_f32 v222, v46, v118, v119
v_fma_f32 v223, v47, v118, v119
v_cvt_pk_bf16_f32 v95, v222, v223
s_waitcnt lgkmcnt(2)
ds_write_b64 v212, v[94:95] offset:20480
v_fma_f32 v220, v48, v126, v127
v_fma_f32 v221, v49, v126, v127
v_cvt_pk_bf16_f32 v174, v220, v221
v_fma_f32 v222, v50, v126, v127
v_fma_f32 v223, v51, v126, v127
v_cvt_pk_bf16_f32 v175, v222, v223
v_fma_f32 v220, v52, v126, v127
v_fma_f32 v221, v53, v126, v127
v_cvt_pk_bf16_f32 v176, v220, v221
v_fma_f32 v222, v54, v126, v127
v_fma_f32 v223, v55, v126, v127
v_cvt_pk_bf16_f32 v177, v222, v223
ds_write_b128 v211, v[174:177] offset:26624
v_fma_f32 v220, v56, v126, v127
v_fma_f32 v221, v57, v126, v127
v_cvt_pk_bf16_f32 v178, v220, v221
v_fma_f32 v222, v58, v126, v127
v_fma_f32 v223, v59, v126, v127
v_cvt_pk_bf16_f32 v179, v222, v223
s_waitcnt lgkmcnt(3)
ds_write_b64 v212, v[178:179] offset:26624
v_fma_f32 v220, v60, v134, v135
v_fma_f32 v221, v61, v134, v135
v_cvt_pk_bf16_f32 v90, v220, v221
v_fma_f32 v222, v62, v134, v135
v_fma_f32 v223, v63, v134, v135
v_cvt_pk_bf16_f32 v91, v222, v223
v_fma_f32 v220, v64, v134, v135
v_fma_f32 v221, v65, v134, v135
v_cvt_pk_bf16_f32 v92, v220, v221
v_fma_f32 v222, v66, v134, v135
v_fma_f32 v223, v67, v134, v135
v_cvt_pk_bf16_f32 v93, v222, v223
ds_write_b128 v211, v[90:93] offset:32768
v_fma_f32 v220, v68, v134, v135
v_fma_f32 v221, v69, v134, v135
v_cvt_pk_bf16_f32 v94, v220, v221
v_fma_f32 v222, v70, v134, v135
v_fma_f32 v223, v71, v134, v135
v_cvt_pk_bf16_f32 v95, v222, v223
ds_write_b64 v212, v[94:95] offset:32768
ds_read_b128 v[182:185], v210 offset:8192
ds_read_b128 v[186:189], v210 offset:9216
s_waitcnt lgkmcnt(1)
v_mfma_f32_16x16x32_bf16 v[138:141], a[8:11], v[182:185], v[138:141]
s_waitcnt lgkmcnt(0)
v_mfma_f32_16x16x32_bf16 v[138:141], a[12:15], v[186:189], v[138:141]
v_mfma_f32_16x16x32_bf16 v[142:145], a[32:35], v[182:185], v[142:145]
v_mfma_f32_16x16x32_bf16 v[142:145], a[36:39], v[186:189], v[142:145]
v_mfma_f32_16x16x32_bf16 v[146:149], a[56:59], v[182:185], v[146:149]
v_mfma_f32_16x16x32_bf16 v[146:149], a[60:63], v[186:189], v[146:149]
v_mfma_f32_16x16x32_bf16 v[150:153], a[224:227], v[182:185], v[150:153]
v_mfma_f32_16x16x32_bf16 v[150:153], a[228:231], v[186:189], v[150:153]
v_mfma_f32_16x16x32_bf16 v[154:157], a[248:251], v[182:185], v[154:157]
v_mfma_f32_16x16x32_bf16 v[154:157], a[252:255], v[186:189], v[154:157]
v_mfma_f32_16x16x32_bf16 v[158:161], v[240:243], v[182:185], v[158:161]
v_mfma_f32_16x16x32_bf16 v[158:161], v[244:247], v[186:189], v[158:161]
v_mfma_f32_16x16x32_bf16 v[162:165], v[182:185], a[80:83], v[162:165]
v_mfma_f32_16x16x32_bf16 v[162:165], v[186:189], a[84:87], v[162:165]
v_mfma_f32_16x16x32_bf16 v[166:169], v[182:185], a[104:107], v[166:169]
v_mfma_f32_16x16x32_bf16 v[166:169], v[186:189], a[108:111], v[166:169]
v_mfma_f32_16x16x32_bf16 v[170:173], v[182:185], a[128:131], v[170:173]
v_mfma_f32_16x16x32_bf16 v[170:173], v[186:189], a[132:135], v[170:173]
ds_read_b128 v[110:113], v210 offset:10240
ds_read_b128 v[106:109], v210 offset:11264
s_waitcnt lgkmcnt(1)
v_mfma_f32_16x16x32_bf16 v[138:141], a[16:19], v[110:113], v[138:141]
s_waitcnt lgkmcnt(0)
v_mfma_f32_16x16x32_bf16 v[138:141], a[20:23], v[106:109], v[138:141]
v_mfma_f32_16x16x32_bf16 v[142:145], a[40:43], v[110:113], v[142:145]
v_mfma_f32_16x16x32_bf16 v[142:145], a[44:47], v[106:109], v[142:145]
v_mfma_f32_16x16x32_bf16 v[146:149], a[64:67], v[110:113], v[146:149]
v_mfma_f32_16x16x32_bf16 v[146:149], a[68:71], v[106:109], v[146:149]
v_mfma_f32_16x16x32_bf16 v[150:153], a[232:235], v[110:113], v[150:153]
v_mfma_f32_16x16x32_bf16 v[150:153], a[236:239], v[106:109], v[150:153]
v_mfma_f32_16x16x32_bf16 v[154:157], v[224:227], v[110:113], v[154:157]
v_mfma_f32_16x16x32_bf16 v[154:157], v[228:231], v[106:109], v[154:157]
v_mfma_f32_16x16x32_bf16 v[158:161], v[248:251], v[110:113], v[158:161]
v_mfma_f32_16x16x32_bf16 v[158:161], v[252:255], v[106:109], v[158:161]
v_mfma_f32_16x16x32_bf16 v[162:165], v[110:113], a[88:91], v[162:165]
v_mfma_f32_16x16x32_bf16 v[162:165], v[106:109], a[92:95], v[162:165]
v_mfma_f32_16x16x32_bf16 v[166:169], v[110:113], a[112:115], v[166:169]
v_mfma_f32_16x16x32_bf16 v[166:169], v[106:109], a[116:119], v[166:169]
v_mfma_f32_16x16x32_bf16 v[170:173], v[110:113], a[136:139], v[170:173]
v_mfma_f32_16x16x32_bf16 v[170:173], v[106:109], a[140:143], v[170:173]
v_cvt_pk_bf16_f32 v96, v138, v139
v_cvt_pk_bf16_f32 v97, v140, v141
v_cvt_pk_bf16_f32 v98, v142, v143
v_cvt_pk_bf16_f32 v99, v144, v145
v_cvt_pk_bf16_f32 v100, v146, v147
v_cvt_pk_bf16_f32 v101, v148, v149
v_cvt_pk_bf16_f32 v84, v150, v151
v_cvt_pk_bf16_f32 v85, v152, v153
v_cvt_pk_bf16_f32 v86, v154, v155
v_cvt_pk_bf16_f32 v87, v156, v157
v_cvt_pk_bf16_f32 v88, v158, v159
v_cvt_pk_bf16_f32 v89, v160, v161
v_cvt_pk_bf16_f32 v116, v162, v163
v_cvt_pk_bf16_f32 v117, v164, v165
v_cvt_pk_bf16_f32 v124, v166, v167
v_cvt_pk_bf16_f32 v125, v168, v169
v_cvt_pk_bf16_f32 v132, v170, v171
v_cvt_pk_bf16_f32 v133, v172, v173
ds_read_b128 v[182:185], v210 offset:12288
ds_read_b128 v[186:189], v210 offset:13312
s_waitcnt lgkmcnt(1)
v_mfma_f32_16x16x32_bf16 v[138:141], a[0:3], v[182:185], 0
s_waitcnt lgkmcnt(0)
v_mfma_f32_16x16x32_bf16 v[138:141], a[4:7], v[186:189], v[138:141]
v_mfma_f32_16x16x32_bf16 v[142:145], a[24:27], v[182:185], 0
v_mfma_f32_16x16x32_bf16 v[142:145], a[28:31], v[186:189], v[142:145]
v_mfma_f32_16x16x32_bf16 v[146:149], a[48:51], v[182:185], 0
v_mfma_f32_16x16x32_bf16 v[146:149], a[52:55], v[186:189], v[146:149]
ds_read_b128 v[170:173], v210 offset:14336
ds_read_b128 v[182:185], v210 offset:15360
s_waitcnt lgkmcnt(1)
v_mfma_f32_16x16x32_bf16 v[138:141], a[8:11], v[170:173], v[138:141]
s_waitcnt lgkmcnt(0)
v_mfma_f32_16x16x32_bf16 v[138:141], a[12:15], v[182:185], v[138:141]
v_mfma_f32_16x16x32_bf16 v[142:145], a[32:35], v[170:173], v[142:145]
v_mfma_f32_16x16x32_bf16 v[142:145], a[36:39], v[182:185], v[142:145]
v_mfma_f32_16x16x32_bf16 v[146:149], a[56:59], v[170:173], v[146:149]
v_mfma_f32_16x16x32_bf16 v[146:149], a[60:63], v[182:185], v[146:149]
ds_read_b128 v[186:189], v210 offset:16384
ds_read_b128 v[170:173], v210 offset:17408
s_waitcnt lgkmcnt(1)
v_mfma_f32_16x16x32_bf16 v[138:141], a[16:19], v[186:189], v[138:141]
s_waitcnt lgkmcnt(0)
v_mfma_f32_16x16x32_bf16 v[138:141], a[20:23], v[170:173], v[138:141]
v_mfma_f32_16x16x32_bf16 v[142:145], a[40:43], v[186:189], v[142:145]
v_mfma_f32_16x16x32_bf16 v[142:145], a[44:47], v[170:173], v[142:145]
v_mfma_f32_16x16x32_bf16 v[146:149], a[64:67], v[186:189], v[146:149]
v_mfma_f32_16x16x32_bf16 v[146:149], a[68:71], v[170:173], v[146:149]
v_cvt_pk_bf16_f32 v102, v138, v139
v_cvt_pk_bf16_f32 v103, v140, v141
v_cvt_pk_bf16_f32 v104, v142, v143
v_cvt_pk_bf16_f32 v105, v144, v145
s_nop 2
v_cvt_pk_bf16_f32 v106, v146, v147
v_cvt_pk_bf16_f32 v107, v148, v149
ds_read_b128 v[108:111], v215 offset:512
ds_read_b64 v[112:113], v215 offset:528
v_mfma_f32_16x16x16_bf16 v[138:141], v[82:83], v[76:77], 0
v_mfma_f32_16x16x16_bf16 v[142:145], v[100:101], v[76:77], 0
s_waitcnt lgkmcnt(0)
v_mfma_f32_16x16x16_bf16 v[150:153], v[112:113], v[76:77], v[206:209]
v_mfma_f32_16x16x16_bf16 v[146:149], v[106:107], v[76:77], 0
v_mfma_f32_16x16x32_bf16 v[138:141], v[78:81], v[72:75], v[138:141]
v_mfma_f32_16x16x32_bf16 v[142:145], v[96:99], v[72:75], v[142:145]
v_mfma_f32_16x16x32_bf16 v[150:153], v[108:111], v[72:75], v[150:153]
v_mfma_f32_16x16x32_bf16 v[146:149], v[102:105], v[72:75], v[146:149]
ds_read_b128 v[72:75], v215
ds_read_b64 v[76:77], v215 offset:16
v_mfma_f32_16x16x16_bf16 v[154:157], v[82:83], v[88:89], 0
v_mfma_f32_16x16x16_bf16 v[158:161], v[100:101], v[88:89], 0
v_mfma_f32_16x16x16_bf16 v[166:169], v[112:113], v[88:89], v[206:209]
v_mfma_f32_16x16x16_bf16 v[162:165], v[106:107], v[88:89], 0
v_mfma_f32_16x16x32_bf16 v[154:157], v[78:81], v[84:87], v[154:157]
v_mfma_f32_16x16x32_bf16 v[158:161], v[96:99], v[84:87], v[158:161]
v_mfma_f32_16x16x32_bf16 v[166:169], v[108:111], v[84:87], v[166:169]
v_mfma_f32_16x16x32_bf16 v[162:165], v[102:105], v[84:87], v[162:165]
ds_read_b128 v[182:185], v210 offset:12288
ds_read_b128 v[186:189], v210 offset:13312
s_waitcnt lgkmcnt(1)
v_mfma_f32_16x16x32_bf16 v[118:121], v[182:185], a[72:75], 0
s_waitcnt lgkmcnt(0)
v_mfma_f32_16x16x32_bf16 v[118:121], v[186:189], a[76:79], v[118:121]
v_mfma_f32_16x16x32_bf16 v[126:129], v[182:185], a[96:99], 0
v_mfma_f32_16x16x32_bf16 v[126:129], v[186:189], a[100:103], v[126:129]
v_mfma_f32_16x16x32_bf16 v[134:137], v[182:185], a[120:123], 0
v_mfma_f32_16x16x32_bf16 v[134:137], v[186:189], a[124:127], v[134:137]
v_mfma_f32_16x16x32_bf16 v[90:93], a[216:219], v[182:185], 0
v_mfma_f32_16x16x32_bf16 v[90:93], a[220:223], v[186:189], v[90:93]
v_mfma_f32_16x16x32_bf16 v[170:173], a[240:243], v[182:185], 0
v_mfma_f32_16x16x32_bf16 v[170:173], a[244:247], v[186:189], v[170:173]
v_mfma_f32_16x16x32_bf16 v[220:223], v[232:235], v[182:185], 0
v_mfma_f32_16x16x32_bf16 v[220:223], v[236:239], v[186:189], v[220:223]
ds_read_b128 v[174:177], v210 offset:14336
ds_read_b128 v[178:181], v210 offset:15360
s_waitcnt lgkmcnt(1)
v_mfma_f32_16x16x32_bf16 v[118:121], v[174:177], a[80:83], v[118:121]
s_waitcnt lgkmcnt(0)
v_mfma_f32_16x16x32_bf16 v[118:121], v[178:181], a[84:87], v[118:121]
v_mfma_f32_16x16x32_bf16 v[126:129], v[174:177], a[104:107], v[126:129]
v_mfma_f32_16x16x32_bf16 v[126:129], v[178:181], a[108:111], v[126:129]
v_mfma_f32_16x16x32_bf16 v[134:137], v[174:177], a[128:131], v[134:137]
v_mfma_f32_16x16x32_bf16 v[134:137], v[178:181], a[132:135], v[134:137]
v_mfma_f32_16x16x32_bf16 v[90:93], a[224:227], v[174:177], v[90:93]
v_mfma_f32_16x16x32_bf16 v[90:93], a[228:231], v[178:181], v[90:93]
v_mfma_f32_16x16x32_bf16 v[170:173], a[248:251], v[174:177], v[170:173]
v_mfma_f32_16x16x32_bf16 v[170:173], a[252:255], v[178:181], v[170:173]
v_mfma_f32_16x16x32_bf16 v[220:223], v[240:243], v[174:177], v[220:223]
v_mfma_f32_16x16x32_bf16 v[220:223], v[244:247], v[178:181], v[220:223]
ds_read_b128 v[182:185], v210 offset:16384
ds_read_b128 v[186:189], v210 offset:17408
s_waitcnt lgkmcnt(1)
v_mfma_f32_16x16x32_bf16 v[118:121], v[182:185], a[88:91], v[118:121]
s_waitcnt lgkmcnt(0)
v_mfma_f32_16x16x32_bf16 v[118:121], v[186:189], a[92:95], v[118:121]
v_mfma_f32_16x16x32_bf16 v[126:129], v[182:185], a[112:115], v[126:129]
v_mfma_f32_16x16x32_bf16 v[126:129], v[186:189], a[116:119], v[126:129]
v_mfma_f32_16x16x32_bf16 v[134:137], v[182:185], a[136:139], v[134:137]
v_mfma_f32_16x16x32_bf16 v[134:137], v[186:189], a[140:143], v[134:137]
v_mfma_f32_16x16x32_bf16 v[90:93], a[232:235], v[182:185], v[90:93]
v_mfma_f32_16x16x32_bf16 v[90:93], a[236:239], v[186:189], v[90:93]
v_mfma_f32_16x16x32_bf16 v[170:173], v[224:227], v[182:185], v[170:173]
v_mfma_f32_16x16x32_bf16 v[170:173], v[228:231], v[186:189], v[170:173]
v_mfma_f32_16x16x32_bf16 v[220:223], v[248:251], v[182:185], v[220:223]
v_mfma_f32_16x16x32_bf16 v[220:223], v[252:255], v[186:189], v[220:223]
v_mov_b32 v181, 0
v_cvt_pk_bf16_f32 v118, v118, v119
v_cvt_pk_bf16_f32 v119, v120, v121
ds_read_u16 v120, v214 offset:1024
v_mov_b32 v121, 0
v_cvt_pk_bf16_f32 v126, v126, v127
v_cvt_pk_bf16_f32 v127, v128, v129
ds_read_u16 v128, v214 offset:1032
v_mov_b32 v129, 0
v_cvt_pk_bf16_f32 v134, v134, v135
v_cvt_pk_bf16_f32 v135, v136, v137
ds_read_u16 v136, v214 offset:1040
v_mov_b32 v137, 0
v_cvt_pk_bf16_f32 v90, v90, v91
v_cvt_pk_bf16_f32 v91, v92, v93
v_cvt_pk_bf16_f32 v92, v170, v171
v_cvt_pk_bf16_f32 v93, v172, v173
v_cvt_pk_bf16_f32 v94, v220, v221
v_cvt_pk_bf16_f32 v95, v222, v223
v_max3_f32 v151, v138, v139, v140
v_max3_f32 v151, v151, v141, v142
v_max3_f32 v151, v151, v143, v144
v_max3_f32 v151, v151, v145, v146
v_max3_f32 v151, v151, v147, v148
v_max3_f32 v151, v151, v149, v150
v_mov_b32 v152, v151
s_nop 1
v_permlane16_swap_b32 v151, v152
v_max_f32 v151, v151, v152
v_mov_b32 v152, v151
s_nop 1
v_permlane32_swap_b32 v151, v152
v_max_f32 v151, v151, v152
v_sub_f32 v138, v138, v151
v_sub_f32 v139, v139, v151
v_sub_f32 v140, v140, v151
v_sub_f32 v141, v141, v151
v_sub_f32 v142, v142, v151
v_sub_f32 v143, v143, v151
v_sub_f32 v144, v144, v151
v_sub_f32 v145, v145, v151
v_sub_f32 v150, v150, v151
v_sub_f32 v146, v146, v151
v_sub_f32 v147, v147, v151
v_sub_f32 v148, v148, v151
v_sub_f32 v149, v149, v151
v_exp_f32 v138, v138
v_exp_f32 v139, v139
v_exp_f32 v140, v140
v_exp_f32 v141, v141
v_exp_f32 v142, v142
v_exp_f32 v143, v143
v_exp_f32 v144, v144
v_exp_f32 v145, v145
v_exp_f32 v150, v150
v_exp_f32 v146, v146
v_exp_f32 v147, v147
v_exp_f32 v148, v148
v_exp_f32 v149, v149
v_cvt_pk_bf16_f32 v174, v138, v139
v_cvt_pk_bf16_f32 v175, v140, v141
v_cvt_pk_bf16_f32 v176, v142, v143
v_cvt_pk_bf16_f32 v177, v144, v145
v_cvt_pk_bf16_f32 v178, v146, v147
v_cvt_pk_bf16_f32 v179, v148, v149
v_cvt_pk_bf16_f32 v180, v150, 0
v_mfma_f32_16x16x32_bf16 v[150:153], v[190:193], v[174:177], 0
v_mfma_f32_16x16x32_bf16 v[150:153], v[190:193], v[178:181], v[150:153]
v_mfma_f32_16x16x32_bf16 v[138:141], v[114:117], v[174:177], 0
s_waitcnt lgkmcnt(2)
v_mfma_f32_16x16x32_bf16 v[138:141], v[118:121], v[178:181], v[138:141]
v_mfma_f32_16x16x32_bf16 v[142:145], v[122:125], v[174:177], 0
s_waitcnt lgkmcnt(1)
v_mfma_f32_16x16x32_bf16 v[142:145], v[126:129], v[178:181], v[142:145]
v_mfma_f32_16x16x32_bf16 v[146:149], v[130:133], v[174:177], 0
s_waitcnt lgkmcnt(0)
v_mfma_f32_16x16x32_bf16 v[146:149], v[134:137], v[178:181], v[146:149]
v_max3_f32 v167, v154, v155, v156
v_max3_f32 v167, v167, v157, v158
v_max3_f32 v167, v167, v159, v160
v_max3_f32 v167, v167, v161, v162
v_max3_f32 v167, v167, v163, v164
v_max3_f32 v167, v167, v165, v166
v_mov_b32 v168, v167
s_nop 1
v_permlane16_swap_b32 v167, v168
v_max_f32 v167, v167, v168
v_mov_b32 v168, v167
s_nop 1
v_permlane32_swap_b32 v167, v168
v_max_f32 v167, v167, v168
v_sub_f32 v154, v154, v167
v_sub_f32 v155, v155, v167
v_sub_f32 v156, v156, v167
v_sub_f32 v157, v157, v167
v_sub_f32 v158, v158, v167
v_sub_f32 v159, v159, v167
v_sub_f32 v160, v160, v167
v_sub_f32 v161, v161, v167
v_sub_f32 v166, v166, v167
v_sub_f32 v162, v162, v167
v_sub_f32 v163, v163, v167
v_sub_f32 v164, v164, v167
v_sub_f32 v165, v165, v167
v_exp_f32 v154, v154
v_exp_f32 v155, v155
v_exp_f32 v156, v156
v_exp_f32 v157, v157
v_exp_f32 v158, v158
v_exp_f32 v159, v159
v_exp_f32 v160, v160
v_exp_f32 v161, v161
v_exp_f32 v166, v166
v_exp_f32 v162, v162
v_exp_f32 v163, v163
v_exp_f32 v164, v164
v_exp_f32 v165, v165
v_cvt_pk_bf16_f32 v174, v154, v155
v_cvt_pk_bf16_f32 v175, v156, v157
v_cvt_pk_bf16_f32 v176, v158, v159
v_cvt_pk_bf16_f32 v177, v160, v161
v_cvt_pk_bf16_f32 v178, v162, v163
v_cvt_pk_bf16_f32 v179, v164, v165
v_cvt_pk_bf16_f32 v180, v166, 0
v_mfma_f32_16x16x32_bf16 v[166:169], v[190:193], v[174:177], 0
v_mfma_f32_16x16x32_bf16 v[166:169], v[190:193], v[178:181], v[166:169]
v_mfma_f32_16x16x32_bf16 v[154:157], v[114:117], v[174:177], 0
v_mfma_f32_16x16x32_bf16 v[154:157], v[118:121], v[178:181], v[154:157]
v_mfma_f32_16x16x32_bf16 v[158:161], v[122:125], v[174:177], 0
v_mfma_f32_16x16x32_bf16 v[158:161], v[126:129], v[178:181], v[158:161]
v_mfma_f32_16x16x32_bf16 v[162:165], v[130:133], v[174:177], 0
v_mfma_f32_16x16x32_bf16 v[162:165], v[134:137], v[178:181], v[162:165]
v_rcp_f32 v151, v150
s_nop 0
v_mul_f32 v151, s3, v151
v_mul_f32 v138, v138, v151
v_mul_f32 v139, v139, v151
v_cvt_pk_bf16_f32 v138, v138, v139
v_mul_f32 v140, v140, v151
v_mul_f32 v141, v141, v151
v_cvt_pk_bf16_f32 v139, v140, v141
v_mul_f32 v142, v142, v151
v_mul_f32 v143, v143, v151
v_cvt_pk_bf16_f32 v140, v142, v143
v_mul_f32 v144, v144, v151
v_mul_f32 v145, v145, v151
v_cvt_pk_bf16_f32 v141, v144, v145
ds_write_b128 v211, v[138:141] offset:38912
v_mul_f32 v146, v146, v151
v_mul_f32 v147, v147, v151
v_cvt_pk_bf16_f32 v142, v146, v147
v_mul_f32 v148, v148, v151
v_mul_f32 v149, v149, v151
v_cvt_pk_bf16_f32 v143, v148, v149
ds_write_b64 v212, v[142:143] offset:38912
v_mfma_f32_16x16x16_bf16 v[138:141], v[82:83], v[94:95], 0
v_mfma_f32_16x16x16_bf16 v[142:145], v[100:101], v[94:95], 0
v_mfma_f32_16x16x16_bf16 v[150:153], v[112:113], v[94:95], v[206:209]
v_mfma_f32_16x16x16_bf16 v[146:149], v[106:107], v[94:95], 0
v_mfma_f32_16x16x32_bf16 v[138:141], v[78:81], v[90:93], v[138:141]
v_mfma_f32_16x16x32_bf16 v[142:145], v[96:99], v[90:93], v[142:145]
v_mfma_f32_16x16x32_bf16 v[150:153], v[108:111], v[90:93], v[150:153]
v_mfma_f32_16x16x32_bf16 v[146:149], v[102:105], v[90:93], v[146:149]
v_rcp_f32 v167, v166
s_nop 0
v_mul_f32 v167, s3, v167
v_mul_f32 v154, v154, v167
v_mul_f32 v155, v155, v167
v_cvt_pk_bf16_f32 v154, v154, v155
v_mul_f32 v156, v156, v167
v_mul_f32 v157, v157, v167
v_cvt_pk_bf16_f32 v155, v156, v157
v_mul_f32 v158, v158, v167
v_mul_f32 v159, v159, v167
v_cvt_pk_bf16_f32 v156, v158, v159
v_mul_f32 v160, v160, v167
v_mul_f32 v161, v161, v167
v_cvt_pk_bf16_f32 v157, v160, v161
ds_write_b128 v211, v[154:157] offset:45056
v_mul_f32 v162, v162, v167
v_mul_f32 v163, v163, v167
v_cvt_pk_bf16_f32 v158, v162, v163
v_mul_f32 v164, v164, v167
v_mul_f32 v165, v165, v167
v_cvt_pk_bf16_f32 v159, v164, v165
ds_write_b64 v212, v[158:159] offset:45056
v_mfma_f32_16x16x16_bf16 v[154:157], v[76:77], v[82:83], 0
v_mfma_f32_16x16x16_bf16 v[158:161], v[76:77], v[100:101], 0
v_mfma_f32_16x16x16_bf16 v[162:165], v[76:77], v[106:107], 0
v_mfma_f32_16x16x16_bf16 v[166:169], v[76:77], v[112:113], v[206:209]
v_mfma_f32_16x16x32_bf16 v[154:157], v[72:75], v[78:81], v[154:157]
v_mfma_f32_16x16x32_bf16 v[158:161], v[72:75], v[96:99], v[158:161]
v_mfma_f32_16x16x32_bf16 v[162:165], v[72:75], v[102:105], v[162:165]
v_mfma_f32_16x16x32_bf16 v[166:169], v[72:75], v[108:111], v[166:169]
v_mov_b32_dpp v154, v158 quad_perm:[0,1,2,3] row_mask:0x2 bank_mask:0xf
s_nop 1
v_mov_b32_dpp v154, v162 quad_perm:[0,1,2,3] row_mask:0x4 bank_mask:0xf
s_nop 2
v_mov_b32_dpp v154, v167 quad_perm:[0,1,2,3] row_mask:0x8 bank_mask:0xf
v_mov_b32 v155, v154
s_nop 1
v_max_f32_dpp v155, v155, v155 row_ror:8 row_mask:0xf bank_mask:0xf
s_nop 1
v_max_f32_dpp v155, v155, v155 row_ror:4 row_mask:0xf bank_mask:0xf
s_nop 1
v_max_f32_dpp v155, v155, v155 row_ror:2 row_mask:0xf bank_mask:0xf
s_nop 1
v_max_f32_dpp v155, v155, v155 row_ror:1 row_mask:0xf bank_mask:0xf
v_mov_b32 v156, v155
s_nop 1
v_permlane16_swap_b32 v155, v156
v_max_f32 v155, v155, v156
v_mov_b32 v156, v155
s_nop 1
v_permlane32_swap_b32 v155, v156
v_max_f32 v155, v155, v156
v_sub_f32 v154, v154, v155
v_exp_f32 v154, v154
s_nop 0
v_cvt_pk_bf16_f32 v154, v154, 0
ds_write_b16 v214, v154
s_waitcnt lgkmcnt(1)
ds_read_b128 v[84:87], v215
ds_read_b128 v[88:91], v215 offset:16
v_add_u32 v215, 1552, v215
s_barrier
ds_read_b128 v[220:223], v210 offset:38912
ds_read_b128 v[110:113], v210 offset:39936
s_waitcnt lgkmcnt(1)
v_mfma_f32_16x16x32_bf16 v[0:3], a[144:147], v[220:223], v[0:3]
s_waitcnt lgkmcnt(0)
v_mfma_f32_16x16x32_bf16 v[0:3], a[148:151], v[110:113], v[0:3]
v_mfma_f32_16x16x32_bf16 v[4:7], a[168:171], v[220:223], v[4:7]
v_mfma_f32_16x16x32_bf16 v[4:7], a[172:175], v[110:113], v[4:7]
v_mfma_f32_16x16x32_bf16 v[8:11], a[192:195], v[220:223], v[8:11]
v_mfma_f32_16x16x32_bf16 v[8:11], a[196:199], v[110:113], v[8:11]
ds_read_b128 v[170:173], v210 offset:40960
ds_read_b128 v[182:185], v210 offset:41984
s_waitcnt lgkmcnt(1)
v_mfma_f32_16x16x32_bf16 v[0:3], a[152:155], v[170:173], v[0:3]
s_waitcnt lgkmcnt(0)
v_mfma_f32_16x16x32_bf16 v[0:3], a[156:159], v[182:185], v[0:3]
v_mfma_f32_16x16x32_bf16 v[4:7], a[176:179], v[170:173], v[4:7]
v_mfma_f32_16x16x32_bf16 v[4:7], a[180:183], v[182:185], v[4:7]
v_mfma_f32_16x16x32_bf16 v[8:11], a[200:203], v[170:173], v[8:11]
v_mfma_f32_16x16x32_bf16 v[8:11], a[204:207], v[182:185], v[8:11]
ds_read_b128 v[186:189], v210 offset:43008
ds_read_b128 v[220:223], v210 offset:44032
s_waitcnt lgkmcnt(1)
v_mfma_f32_16x16x32_bf16 v[0:3], a[160:163], v[186:189], v[0:3]
s_waitcnt lgkmcnt(0)
v_mfma_f32_16x16x32_bf16 v[0:3], a[164:167], v[220:223], v[0:3]
v_mfma_f32_16x16x32_bf16 v[4:7], a[184:187], v[186:189], v[4:7]
v_mfma_f32_16x16x32_bf16 v[4:7], a[188:191], v[220:223], v[4:7]
v_mfma_f32_16x16x32_bf16 v[8:11], a[208:211], v[186:189], v[8:11]
v_mfma_f32_16x16x32_bf16 v[8:11], a[212:215], v[220:223], v[8:11]
v_cvt_pk_bf16_f32 v72, v0, v1
v_cvt_pk_bf16_f32 v73, v2, v3
buffer_store_dwordx2 v[72:73], v203, s[8:11], s38 offen
v_cvt_pk_bf16_f32 v74, v4, v5
v_cvt_pk_bf16_f32 v75, v6, v7
buffer_store_dwordx2 v[74:75], v203, s[8:11], s38 offen offset:32
s_nop 0
v_cvt_pk_bf16_f32 v76, v8, v9
v_cvt_pk_bf16_f32 v77, v10, v11
buffer_store_dwordx2 v[76:77], v203, s[8:11], s38 offen offset:64
v_max3_f32 v151, v138, v139, v140
v_max3_f32 v151, v151, v141, v142
v_max3_f32 v151, v151, v143, v144
v_max3_f32 v151, v151, v145, v146
v_max3_f32 v151, v151, v147, v148
v_max3_f32 v151, v151, v149, v150
v_mov_b32 v152, v151
s_nop 1
v_permlane16_swap_b32 v151, v152
v_max_f32 v151, v151, v152
v_mov_b32 v152, v151
s_nop 1
v_permlane32_swap_b32 v151, v152
v_max_f32 v151, v151, v152
v_sub_f32 v138, v138, v151
v_sub_f32 v139, v139, v151
v_sub_f32 v140, v140, v151
v_sub_f32 v141, v141, v151
v_sub_f32 v142, v142, v151
v_sub_f32 v143, v143, v151
v_sub_f32 v144, v144, v151
v_sub_f32 v145, v145, v151
v_sub_f32 v150, v150, v151
v_sub_f32 v146, v146, v151
v_sub_f32 v147, v147, v151
v_sub_f32 v148, v148, v151
v_sub_f32 v149, v149, v151
v_exp_f32 v138, v138
v_exp_f32 v139, v139
v_exp_f32 v140, v140
v_exp_f32 v141, v141
v_exp_f32 v142, v142
v_exp_f32 v143, v143
v_exp_f32 v144, v144
v_exp_f32 v145, v145
v_exp_f32 v150, v150
v_exp_f32 v146, v146
v_exp_f32 v147, v147
v_exp_f32 v148, v148
v_exp_f32 v149, v149
v_cvt_pk_bf16_f32 v174, v138, v139
v_cvt_pk_bf16_f32 v175, v140, v141
v_cvt_pk_bf16_f32 v176, v142, v143
v_cvt_pk_bf16_f32 v177, v144, v145
v_cvt_pk_bf16_f32 v178, v146, v147
v_cvt_pk_bf16_f32 v179, v148, v149
v_cvt_pk_bf16_f32 v180, v150, 0
v_mfma_f32_16x16x32_bf16 v[150:153], v[190:193], v[174:177], 0
v_mfma_f32_16x16x32_bf16 v[150:153], v[190:193], v[178:181], v[150:153]
v_mfma_f32_16x16x32_bf16 v[138:141], v[114:117], v[174:177], 0
v_mfma_f32_16x16x32_bf16 v[138:141], v[118:121], v[178:181], v[138:141]
v_mfma_f32_16x16x32_bf16 v[142:145], v[122:125], v[174:177], 0
v_mfma_f32_16x16x32_bf16 v[142:145], v[126:129], v[178:181], v[142:145]
v_mfma_f32_16x16x32_bf16 v[146:149], v[130:133], v[174:177], 0
v_mfma_f32_16x16x32_bf16 v[146:149], v[134:137], v[178:181], v[146:149]
v_mfma_f32_16x16x32_bf16 v[166:169], v[84:87], v[190:193], 0
v_mfma_f32_16x16x32_bf16 v[166:169], v[88:91], v[190:193], v[166:169]
v_mfma_f32_16x16x32_bf16 v[154:157], v[84:87], v[114:117], 0
v_mfma_f32_16x16x32_bf16 v[154:157], v[88:91], v[118:121], v[154:157]
v_mfma_f32_16x16x32_bf16 v[158:161], v[84:87], v[122:125], 0
v_mfma_f32_16x16x32_bf16 v[158:161], v[88:91], v[126:129], v[158:161]
v_mfma_f32_16x16x32_bf16 v[162:165], v[84:87], v[130:133], 0
v_mfma_f32_16x16x32_bf16 v[162:165], v[88:91], v[134:137], v[162:165]
v_rcp_f32 v167, v166
v_mov_b32_dpp v154, v158 quad_perm:[0,1,2,3] row_mask:0x2 bank_mask:0xf
s_nop 3
v_mov_b32_dpp v154, v162 quad_perm:[0,1,2,3] row_mask:0x4 bank_mask:0xf
v_mul_f32 v167, s3, v167
v_mul_f32 v154, v154, v167
v_cvt_pk_bf16_f32 v154, v154, 0
ds_write_b16 v214, v154
v_add_u32 v214, 1552, v214
ds_read_b128 v[110:113], v210 offset:45056
ds_read_b128 v[170:173], v210 offset:46080
s_waitcnt lgkmcnt(1)
v_mfma_f32_16x16x32_bf16 v[12:15], a[144:147], v[110:113], v[12:15]
s_waitcnt lgkmcnt(0)
v_mfma_f32_16x16x32_bf16 v[12:15], a[148:151], v[170:173], v[12:15]
v_mfma_f32_16x16x32_bf16 v[16:19], a[168:171], v[110:113], v[16:19]
v_mfma_f32_16x16x32_bf16 v[16:19], a[172:175], v[170:173], v[16:19]
v_mfma_f32_16x16x32_bf16 v[20:23], a[192:195], v[110:113], v[20:23]
v_mfma_f32_16x16x32_bf16 v[20:23], a[196:199], v[170:173], v[20:23]
ds_read_b128 v[182:185], v210 offset:47104
ds_read_b128 v[186:189], v210 offset:48128
s_waitcnt lgkmcnt(1)
v_mfma_f32_16x16x32_bf16 v[12:15], a[152:155], v[182:185], v[12:15]
s_waitcnt lgkmcnt(0)
v_mfma_f32_16x16x32_bf16 v[12:15], a[156:159], v[186:189], v[12:15]
v_mfma_f32_16x16x32_bf16 v[16:19], a[176:179], v[182:185], v[16:19]
v_mfma_f32_16x16x32_bf16 v[16:19], a[180:183], v[186:189], v[16:19]
v_mfma_f32_16x16x32_bf16 v[20:23], a[200:203], v[182:185], v[20:23]
v_mfma_f32_16x16x32_bf16 v[20:23], a[204:207], v[186:189], v[20:23]
ds_read_b128 v[220:223], v210 offset:49152
ds_read_b128 v[110:113], v210 offset:50176
s_waitcnt lgkmcnt(1)
v_mfma_f32_16x16x32_bf16 v[12:15], a[160:163], v[220:223], v[12:15]
s_waitcnt lgkmcnt(0)
v_mfma_f32_16x16x32_bf16 v[12:15], a[164:167], v[110:113], v[12:15]
v_mfma_f32_16x16x32_bf16 v[16:19], a[184:187], v[220:223], v[16:19]
v_mfma_f32_16x16x32_bf16 v[16:19], a[188:191], v[110:113], v[16:19]
v_mfma_f32_16x16x32_bf16 v[20:23], a[208:211], v[220:223], v[20:23]
v_mfma_f32_16x16x32_bf16 v[20:23], a[212:215], v[110:113], v[20:23]
v_cvt_pk_bf16_f32 v78, v12, v13
v_cvt_pk_bf16_f32 v79, v14, v15
buffer_store_dwordx2 v[78:79], v204, s[8:11], s38 offen
v_cvt_pk_bf16_f32 v80, v16, v17
v_cvt_pk_bf16_f32 v81, v18, v19
buffer_store_dwordx2 v[80:81], v204, s[8:11], s38 offen offset:32
s_nop 0
v_cvt_pk_bf16_f32 v82, v20, v21
v_cvt_pk_bf16_f32 v83, v22, v23
buffer_store_dwordx2 v[82:83], v204, s[8:11], s38 offen offset:64
v_rcp_f32 v151, v150
s_nop 0
v_mul_f32 v151, s3, v151
v_mul_f32 v138, v138, v151
v_mul_f32 v139, v139, v151
v_cvt_pk_bf16_f32 v138, v138, v139
v_mul_f32 v140, v140, v151
v_mul_f32 v141, v141, v151
v_cvt_pk_bf16_f32 v139, v140, v141
v_mul_f32 v142, v142, v151
v_mul_f32 v143, v143, v151
v_cvt_pk_bf16_f32 v140, v142, v143
v_mul_f32 v144, v144, v151
v_mul_f32 v145, v145, v151
v_cvt_pk_bf16_f32 v141, v144, v145
ds_write_b128 v211, v[138:141] offset:51200
v_mul_f32 v146, v146, v151
v_mul_f32 v147, v147, v151
v_cvt_pk_bf16_f32 v142, v146, v147
v_mul_f32 v148, v148, v151
v_mul_f32 v149, v149, v151
v_cvt_pk_bf16_f32 v143, v148, v149
ds_write_b64 v212, v[142:143] offset:51200
s_waitcnt vmcnt(6) lgkmcnt(0)
s_barrier
ds_read_b128 v[170:173], v210 offset:51200
ds_read_b128 v[182:185], v210 offset:52224
s_waitcnt lgkmcnt(1)
v_mfma_f32_16x16x32_bf16 v[24:27], a[144:147], v[170:173], v[24:27]
s_waitcnt lgkmcnt(0)
v_mfma_f32_16x16x32_bf16 v[24:27], a[148:151], v[182:185], v[24:27]
v_mfma_f32_16x16x32_bf16 v[28:31], a[168:171], v[170:173], v[28:31]
v_mfma_f32_16x16x32_bf16 v[28:31], a[172:175], v[182:185], v[28:31]
v_mfma_f32_16x16x32_bf16 v[32:35], a[192:195], v[170:173], v[32:35]
v_mfma_f32_16x16x32_bf16 v[32:35], a[196:199], v[182:185], v[32:35]
ds_read_b128 v[186:189], v210 offset:53248
ds_read_b128 v[220:223], v210 offset:54272
s_waitcnt lgkmcnt(1)
v_mfma_f32_16x16x32_bf16 v[24:27], a[152:155], v[186:189], v[24:27]
s_waitcnt lgkmcnt(0)
v_mfma_f32_16x16x32_bf16 v[24:27], a[156:159], v[220:223], v[24:27]
v_mfma_f32_16x16x32_bf16 v[28:31], a[176:179], v[186:189], v[28:31]
v_mfma_f32_16x16x32_bf16 v[28:31], a[180:183], v[220:223], v[28:31]
v_mfma_f32_16x16x32_bf16 v[32:35], a[200:203], v[186:189], v[32:35]
v_mfma_f32_16x16x32_bf16 v[32:35], a[204:207], v[220:223], v[32:35]
ds_read_b128 v[110:113], v210 offset:55296
ds_read_b128 v[170:173], v210 offset:56320
s_waitcnt lgkmcnt(1)
v_mfma_f32_16x16x32_bf16 v[24:27], a[160:163], v[110:113], v[24:27]
s_waitcnt lgkmcnt(0)
v_mfma_f32_16x16x32_bf16 v[24:27], a[164:167], v[170:173], v[24:27]
v_mfma_f32_16x16x32_bf16 v[28:31], a[184:187], v[110:113], v[28:31]
v_mfma_f32_16x16x32_bf16 v[28:31], a[188:191], v[170:173], v[28:31]
v_mfma_f32_16x16x32_bf16 v[32:35], a[208:211], v[110:113], v[32:35]
v_mfma_f32_16x16x32_bf16 v[32:35], a[212:215], v[170:173], v[32:35]
v_cvt_pk_bf16_f32 v116, v24, v25
v_cvt_pk_bf16_f32 v117, v26, v27
buffer_store_dwordx2 v[116:117], v205, s[8:11], s38 offen
v_cvt_pk_bf16_f32 v124, v28, v29
v_cvt_pk_bf16_f32 v125, v30, v31
buffer_store_dwordx2 v[124:125], v205, s[8:11], s38 offen offset:32
s_nop 0
v_cvt_pk_bf16_f32 v132, v32, v33
v_cvt_pk_bf16_f32 v133, v34, v35
buffer_store_dwordx2 v[132:133], v205, s[8:11], s38 offen offset:64
s_mov_b32 s39, s37
ds_read_b128 v[174:177], v217
ds_read_b128 v[84:87], v200
s_waitcnt lgkmcnt(0)
v_mfma_f32_16x16x32_bf16 v[0:3], v[174:177], v[84:87], 0
ds_read_b128 v[92:95], v201
s_waitcnt lgkmcnt(0)
v_mfma_f32_16x16x32_bf16 v[12:15], v[174:177], v[92:95], 0
ds_read_b128 v[100:103], v202
s_waitcnt lgkmcnt(0)
v_mfma_f32_16x16x32_bf16 v[24:27], v[174:177], v[100:103], 0
ds_read_b128 v[178:181], v217 offset:528
ds_read_b128 v[84:87], v194
ds_read_b128 v[88:91], v194 offset:16
s_waitcnt lgkmcnt(0)
v_smfmac_f32_16x16x64_bf16 v[0:3], v[178:181], v[84:91], v213
ds_read_b128 v[92:95], v195
ds_read_b128 v[96:99], v195 offset:16
s_waitcnt lgkmcnt(0)
v_smfmac_f32_16x16x64_bf16 v[12:15], v[178:181], v[92:99], v213
ds_read_b128 v[100:103], v196
ds_read_b128 v[104:107], v196 offset:16
s_waitcnt lgkmcnt(0)
v_smfmac_f32_16x16x64_bf16 v[24:27], v[178:181], v[100:107], v213
ds_read_b128 v[174:177], v217 offset:1056
ds_read_b128 v[84:87], v197
ds_read_b128 v[88:91], v197 offset:16
s_waitcnt lgkmcnt(0)
v_smfmac_f32_16x16x64_bf16 v[0:3], v[174:177], v[84:91], v213
ds_read_b128 v[92:95], v198
ds_read_b128 v[96:99], v198 offset:16
s_waitcnt lgkmcnt(0)
v_smfmac_f32_16x16x64_bf16 v[12:15], v[174:177], v[92:99], v213
ds_read_b128 v[100:103], v199
ds_read_b128 v[104:107], v199 offset:16
s_waitcnt lgkmcnt(0)
v_smfmac_f32_16x16x64_bf16 v[24:27], v[174:177], v[100:107], v213
ds_read_b128 v[178:181], v217 offset:1584
ds_read_b128 v[84:87], v200 offset:32
s_waitcnt lgkmcnt(0)
v_mfma_f32_16x16x32_bf16 v[4:7], v[178:181], v[84:87], 0
ds_read_b128 v[92:95], v201 offset:32
s_waitcnt lgkmcnt(0)
v_mfma_f32_16x16x32_bf16 v[16:19], v[178:181], v[92:95], 0
ds_read_b128 v[100:103], v202 offset:32
s_waitcnt lgkmcnt(0)
v_mfma_f32_16x16x32_bf16 v[28:31], v[178:181], v[100:103], 0
ds_read_b128 v[174:177], v217 offset:2112
ds_read_b128 v[84:87], v194 offset:32
ds_read_b128 v[88:91], v194 offset:48
s_waitcnt lgkmcnt(0)
v_smfmac_f32_16x16x64_bf16 v[4:7], v[174:177], v[84:91], v213
ds_read_b128 v[92:95], v195 offset:32
ds_read_b128 v[96:99], v195 offset:48
s_waitcnt lgkmcnt(0)
v_smfmac_f32_16x16x64_bf16 v[16:19], v[174:177], v[92:99], v213
ds_read_b128 v[100:103], v196 offset:32
ds_read_b128 v[104:107], v196 offset:48
s_waitcnt lgkmcnt(0)
v_smfmac_f32_16x16x64_bf16 v[28:31], v[174:177], v[100:107], v213
ds_read_b128 v[178:181], v217 offset:2640
ds_read_b128 v[84:87], v197 offset:32
ds_read_b128 v[88:91], v197 offset:48
s_waitcnt lgkmcnt(0)
v_smfmac_f32_16x16x64_bf16 v[4:7], v[178:181], v[84:91], v213
ds_read_b128 v[92:95], v198 offset:32
ds_read_b128 v[96:99], v198 offset:48
s_waitcnt lgkmcnt(0)
v_smfmac_f32_16x16x64_bf16 v[16:19], v[178:181], v[92:99], v213
ds_read_b128 v[100:103], v199 offset:32
ds_read_b128 v[104:107], v199 offset:48
s_waitcnt lgkmcnt(0)
v_smfmac_f32_16x16x64_bf16 v[28:31], v[178:181], v[100:107], v213
ds_read_b128 v[174:177], v217 offset:3168
ds_read_b128 v[84:87], v200 offset:64
s_waitcnt lgkmcnt(0)
v_mfma_f32_16x16x32_bf16 v[8:11], v[174:177], v[84:87], 0
ds_read_b128 v[92:95], v201 offset:64
s_waitcnt lgkmcnt(0)
v_mfma_f32_16x16x32_bf16 v[20:23], v[174:177], v[92:95], 0
ds_read_b128 v[100:103], v202 offset:64
s_waitcnt lgkmcnt(0)
v_mfma_f32_16x16x32_bf16 v[32:35], v[174:177], v[100:103], 0
ds_read_b128 v[178:181], v217 offset:3696
ds_read_b128 v[84:87], v194 offset:64
ds_read_b128 v[88:91], v194 offset:80
s_waitcnt lgkmcnt(0)
v_smfmac_f32_16x16x64_bf16 v[8:11], v[178:181], v[84:91], v213
ds_read_b128 v[92:95], v195 offset:64
ds_read_b128 v[96:99], v195 offset:80
s_waitcnt lgkmcnt(0)
v_smfmac_f32_16x16x64_bf16 v[20:23], v[178:181], v[92:99], v213
ds_read_b128 v[100:103], v196 offset:64
ds_read_b128 v[104:107], v196 offset:80
s_waitcnt lgkmcnt(0)
v_smfmac_f32_16x16x64_bf16 v[32:35], v[178:181], v[100:107], v213
ds_read_b128 v[174:177], v217 offset:4224
ds_read_b128 v[84:87], v197 offset:64
ds_read_b128 v[88:91], v197 offset:80
s_waitcnt lgkmcnt(0)
v_smfmac_f32_16x16x64_bf16 v[8:11], v[174:177], v[84:91], v213
ds_read_b128 v[92:95], v198 offset:64
ds_read_b128 v[96:99], v198 offset:80
s_waitcnt lgkmcnt(0)
v_smfmac_f32_16x16x64_bf16 v[20:23], v[174:177], v[92:99], v213
ds_read_b128 v[100:103], v199 offset:64
ds_read_b128 v[104:107], v199 offset:80
s_waitcnt lgkmcnt(0)
v_smfmac_f32_16x16x64_bf16 v[32:35], v[174:177], v[100:107], v213
v_add_f32 v118, v0, v1
v_mul_f32 v119, v0, v0
v_add_f32 v118, v118, v2
v_fmac_f32 v119, v1, v1
v_add_f32 v118, v118, v3
v_fmac_f32 v119, v2, v2
v_fmac_f32 v119, v3, v3
v_add_f32 v126, v12, v13
v_mul_f32 v127, v12, v12
v_add_f32 v126, v126, v14
v_fmac_f32 v127, v13, v13
v_add_f32 v126, v126, v15
v_fmac_f32 v127, v14, v14
v_fmac_f32 v127, v15, v15
v_add_f32 v134, v24, v25
v_mul_f32 v135, v24, v24
v_add_f32 v134, v134, v26
v_fmac_f32 v135, v25, v25
v_add_f32 v134, v134, v27
v_fmac_f32 v135, v26, v26
v_fmac_f32 v135, v27, v27
v_add_f32 v118, v118, v4
v_fmac_f32 v119, v4, v4
v_add_f32 v118, v118, v5
v_fmac_f32 v119, v5, v5
v_add_f32 v118, v118, v6
v_fmac_f32 v119, v6, v6
v_add_f32 v118, v118, v7
v_fmac_f32 v119, v7, v7
v_add_f32 v126, v126, v16
v_fmac_f32 v127, v16, v16
v_add_f32 v126, v126, v17
v_fmac_f32 v127, v17, v17
v_add_f32 v126, v126, v18
v_fmac_f32 v127, v18, v18
v_add_f32 v126, v126, v19
v_fmac_f32 v127, v19, v19
v_add_f32 v134, v134, v28
v_fmac_f32 v135, v28, v28
v_add_f32 v134, v134, v29
v_fmac_f32 v135, v29, v29
v_add_f32 v134, v134, v30
v_fmac_f32 v135, v30, v30
v_add_f32 v134, v134, v31
v_fmac_f32 v135, v31, v31
v_add_f32 v118, v118, v8
v_fmac_f32 v119, v8, v8
v_add_f32 v118, v118, v9
v_fmac_f32 v119, v9, v9
v_add_f32 v118, v118, v10
v_fmac_f32 v119, v10, v10
v_add_f32 v118, v118, v11
v_fmac_f32 v119, v11, v11
v_add_f32 v126, v126, v20
v_fmac_f32 v127, v20, v20
v_add_f32 v126, v126, v21
v_fmac_f32 v127, v21, v21
v_add_f32 v126, v126, v22
v_fmac_f32 v127, v22, v22
v_add_f32 v126, v126, v23
v_fmac_f32 v127, v23, v23
v_add_f32 v134, v134, v32
v_fmac_f32 v135, v32, v32
v_add_f32 v134, v134, v33
v_fmac_f32 v135, v33, v33
v_add_f32 v134, v134, v34
v_fmac_f32 v135, v34, v34
v_add_f32 v134, v134, v35
v_fmac_f32 v135, v35, v35
v_permlane16_swap_b32 v118, v119
v_add_f32 v118, v118, v119
v_permlane16_swap_b32 v126, v127
v_add_f32 v126, v126, v127
v_permlane16_swap_b32 v134, v135
v_add_f32 v134, v134, v135
v_permlane32_swap_b32 v118, v126
v_add_f32 v118, v118, v126
ds_write_b32 v209, v118
v_mov_b32 v135, v134
s_nop 1
v_permlane32_swap_b32 v134, v135
v_add_f32 v134, v134, v135
ds_write_b32 v209, v134 offset:512
s_waitcnt lgkmcnt(0)
s_barrier
ds_read_b128 v[182:185], v210 offset:20480
ds_read_b128 v[186:189], v210 offset:21504
s_waitcnt lgkmcnt(1)
v_mfma_f32_16x16x32_bf16 v[138:141], a[0:3], v[182:185], 0
s_waitcnt lgkmcnt(0)
v_mfma_f32_16x16x32_bf16 v[138:141], a[4:7], v[186:189], v[138:141]
v_mfma_f32_16x16x32_bf16 v[142:145], a[24:27], v[182:185], 0
v_mfma_f32_16x16x32_bf16 v[142:145], a[28:31], v[186:189], v[142:145]
v_mfma_f32_16x16x32_bf16 v[146:149], a[48:51], v[182:185], 0
v_mfma_f32_16x16x32_bf16 v[146:149], a[52:55], v[186:189], v[146:149]
v_mfma_f32_16x16x32_bf16 v[150:153], a[216:219], v[182:185], 0
v_mfma_f32_16x16x32_bf16 v[150:153], a[220:223], v[186:189], v[150:153]
v_mfma_f32_16x16x32_bf16 v[154:157], a[240:243], v[182:185], 0
v_mfma_f32_16x16x32_bf16 v[154:157], a[244:247], v[186:189], v[154:157]
v_mfma_f32_16x16x32_bf16 v[158:161], v[232:235], v[182:185], 0
v_mfma_f32_16x16x32_bf16 v[158:161], v[236:239], v[186:189], v[158:161]
v_mfma_f32_16x16x32_bf16 v[162:165], v[182:185], a[72:75], 0
v_mfma_f32_16x16x32_bf16 v[162:165], v[186:189], a[76:79], v[162:165]
v_mfma_f32_16x16x32_bf16 v[166:169], v[182:185], a[96:99], 0
v_mfma_f32_16x16x32_bf16 v[166:169], v[186:189], a[100:103], v[166:169]
v_mfma_f32_16x16x32_bf16 v[170:173], v[182:185], a[120:123], 0
v_mfma_f32_16x16x32_bf16 v[170:173], v[186:189], a[124:127], v[170:173]
ds_read_b128 v[110:113], v210 offset:22528
ds_read_b128 v[220:223], v210 offset:23552
s_waitcnt lgkmcnt(1)
v_mfma_f32_16x16x32_bf16 v[138:141], a[8:11], v[110:113], v[138:141]
s_waitcnt lgkmcnt(0)
v_mfma_f32_16x16x32_bf16 v[138:141], a[12:15], v[220:223], v[138:141]
v_mfma_f32_16x16x32_bf16 v[142:145], a[32:35], v[110:113], v[142:145]
v_mfma_f32_16x16x32_bf16 v[142:145], a[36:39], v[220:223], v[142:145]
v_mfma_f32_16x16x32_bf16 v[146:149], a[56:59], v[110:113], v[146:149]
v_mfma_f32_16x16x32_bf16 v[146:149], a[60:63], v[220:223], v[146:149]
v_mfma_f32_16x16x32_bf16 v[150:153], a[224:227], v[110:113], v[150:153]
v_mfma_f32_16x16x32_bf16 v[150:153], a[228:231], v[220:223], v[150:153]
v_mfma_f32_16x16x32_bf16 v[154:157], a[248:251], v[110:113], v[154:157]
v_mfma_f32_16x16x32_bf16 v[154:157], a[252:255], v[220:223], v[154:157]
v_mfma_f32_16x16x32_bf16 v[158:161], v[240:243], v[110:113], v[158:161]
v_mfma_f32_16x16x32_bf16 v[158:161], v[244:247], v[220:223], v[158:161]
v_mfma_f32_16x16x32_bf16 v[162:165], v[110:113], a[80:83], v[162:165]
v_mfma_f32_16x16x32_bf16 v[162:165], v[220:223], a[84:87], v[162:165]
v_mfma_f32_16x16x32_bf16 v[166:169], v[110:113], a[104:107], v[166:169]
v_mfma_f32_16x16x32_bf16 v[166:169], v[220:223], a[108:111], v[166:169]
v_mfma_f32_16x16x32_bf16 v[170:173], v[110:113], a[128:131], v[170:173]
v_mfma_f32_16x16x32_bf16 v[170:173], v[220:223], a[132:135], v[170:173]
ds_read_b128 v[182:185], v210 offset:24576
ds_read_b128 v[186:189], v210 offset:25600
s_waitcnt lgkmcnt(1)
v_mfma_f32_16x16x32_bf16 v[138:141], a[16:19], v[182:185], v[138:141]
s_waitcnt lgkmcnt(0)
v_mfma_f32_16x16x32_bf16 v[138:141], a[20:23], v[186:189], v[138:141]
v_mfma_f32_16x16x32_bf16 v[142:145], a[40:43], v[182:185], v[142:145]
v_mfma_f32_16x16x32_bf16 v[142:145], a[44:47], v[186:189], v[142:145]
v_mfma_f32_16x16x32_bf16 v[146:149], a[64:67], v[182:185], v[146:149]
v_mfma_f32_16x16x32_bf16 v[146:149], a[68:71], v[186:189], v[146:149]
v_mfma_f32_16x16x32_bf16 v[150:153], a[232:235], v[182:185], v[150:153]
v_mfma_f32_16x16x32_bf16 v[150:153], a[236:239], v[186:189], v[150:153]
v_mfma_f32_16x16x32_bf16 v[154:157], v[224:227], v[182:185], v[154:157]
v_mfma_f32_16x16x32_bf16 v[154:157], v[228:231], v[186:189], v[154:157]
v_mfma_f32_16x16x32_bf16 v[158:161], v[248:251], v[182:185], v[158:161]
v_mfma_f32_16x16x32_bf16 v[158:161], v[252:255], v[186:189], v[158:161]
v_mfma_f32_16x16x32_bf16 v[162:165], v[182:185], a[88:91], v[162:165]
v_mfma_f32_16x16x32_bf16 v[162:165], v[186:189], a[92:95], v[162:165]
v_mfma_f32_16x16x32_bf16 v[166:169], v[182:185], a[112:115], v[166:169]
v_mfma_f32_16x16x32_bf16 v[166:169], v[186:189], a[116:119], v[166:169]
v_mfma_f32_16x16x32_bf16 v[170:173], v[182:185], a[136:139], v[170:173]
v_mfma_f32_16x16x32_bf16 v[170:173], v[186:189], a[140:143], v[170:173]
v_cvt_pk_bf16_f32 v78, v138, v139
v_cvt_pk_bf16_f32 v79, v140, v141
v_cvt_pk_bf16_f32 v80, v142, v143
v_cvt_pk_bf16_f32 v81, v144, v145
v_cvt_pk_bf16_f32 v82, v146, v147
v_cvt_pk_bf16_f32 v83, v148, v149
v_cvt_pk_bf16_f32 v72, v150, v151
v_cvt_pk_bf16_f32 v73, v152, v153
v_cvt_pk_bf16_f32 v74, v154, v155
v_cvt_pk_bf16_f32 v75, v156, v157
v_cvt_pk_bf16_f32 v76, v158, v159
v_cvt_pk_bf16_f32 v77, v160, v161
v_cvt_pk_bf16_f32 v114, v162, v163
v_cvt_pk_bf16_f32 v115, v164, v165
v_cvt_pk_bf16_f32 v122, v166, v167
v_cvt_pk_bf16_f32 v123, v168, v169
v_cvt_pk_bf16_f32 v130, v170, v171
v_cvt_pk_bf16_f32 v131, v172, v173
ds_read_b128 v[110:113], v210 offset:26624
ds_read_b128 v[220:223], v210 offset:27648
s_waitcnt lgkmcnt(1)
v_mfma_f32_16x16x32_bf16 v[138:141], a[0:3], v[110:113], 0
s_waitcnt lgkmcnt(0)
v_mfma_f32_16x16x32_bf16 v[138:141], a[4:7], v[220:223], v[138:141]
v_mfma_f32_16x16x32_bf16 v[142:145], a[24:27], v[110:113], 0
v_mfma_f32_16x16x32_bf16 v[142:145], a[28:31], v[220:223], v[142:145]
v_mfma_f32_16x16x32_bf16 v[146:149], a[48:51], v[110:113], 0
v_mfma_f32_16x16x32_bf16 v[146:149], a[52:55], v[220:223], v[146:149]
v_mfma_f32_16x16x32_bf16 v[150:153], a[216:219], v[110:113], 0
v_mfma_f32_16x16x32_bf16 v[150:153], a[220:223], v[220:223], v[150:153]
v_mfma_f32_16x16x32_bf16 v[154:157], a[240:243], v[110:113], 0
v_mfma_f32_16x16x32_bf16 v[154:157], a[244:247], v[220:223], v[154:157]
v_mfma_f32_16x16x32_bf16 v[158:161], v[232:235], v[110:113], 0
v_mfma_f32_16x16x32_bf16 v[158:161], v[236:239], v[220:223], v[158:161]
v_mfma_f32_16x16x32_bf16 v[162:165], v[110:113], a[72:75], 0
v_mfma_f32_16x16x32_bf16 v[162:165], v[220:223], a[76:79], v[162:165]
v_mfma_f32_16x16x32_bf16 v[166:169], v[110:113], a[96:99], 0
v_mfma_f32_16x16x32_bf16 v[166:169], v[220:223], a[100:103], v[166:169]
v_mfma_f32_16x16x32_bf16 v[170:173], v[110:113], a[120:123], 0
v_mfma_f32_16x16x32_bf16 v[170:173], v[220:223], a[124:127], v[170:173]
ds_read_b128 v[102:105], v210 offset:18432
ds_read_b128 v[106:109], v210 offset:19456
s_waitcnt lgkmcnt(1)
v_add_f32 v102, v102, v103
s_waitcnt lgkmcnt(0)
v_add_f32 v106, v106, v107
v_add_f32 v104, v104, v105
v_add_f32 v108, v108, v109
v_add_f32 v102, v102, v104
v_add_f32 v106, v106, v108
v_mul_f32 v103, s48, v102
v_mul_f32 v104, s73, v102
v_mul_f32 v106, s73, v106
v_fma_f32 v106, -v103, v104, v106
v_max_f32 v106, 0, v106
v_add_f32 v106, s49, v106
v_rsq_f32 v102, v106
s_nop 0
v_mul_f32_e64 v103, -v103, v102
ds_write_b64 v211, v[102:103]
ds_read_b64 v[118:119], v219
ds_read_b64 v[126:127], v219 offset:256
ds_read_b64 v[134:135], v219 offset:512
s_waitcnt lgkmcnt(2)
v_fma_f32 v220, v0, v118, v119
v_fma_f32 v221, v1, v118, v119
v_cvt_pk_bf16_f32 v90, v220, v221
v_fma_f32 v222, v2, v118, v119
v_fma_f32 v223, v3, v118, v119
v_cvt_pk_bf16_f32 v91, v222, v223
v_fma_f32 v220, v4, v118, v119
v_fma_f32 v221, v5, v118, v119
v_cvt_pk_bf16_f32 v92, v220, v221
v_fma_f32 v222, v6, v118, v119
v_fma_f32 v223, v7, v118, v119
v_cvt_pk_bf16_f32 v93, v222, v223
ds_write_b128 v211, v[90:93]
v_fma_f32 v220, v8, v118, v119
v_fma_f32 v221, v9, v118, v119
v_cvt_pk_bf16_f32 v94, v220, v221
v_fma_f32 v222, v10, v118, v119
v_fma_f32 v223, v11, v118, v119
v_cvt_pk_bf16_f32 v95, v222, v223
s_waitcnt lgkmcnt(2)
ds_write_b64 v212, v[94:95]
v_fma_f32 v220, v12, v126, v127
v_fma_f32 v221, v13, v126, v127
v_cvt_pk_bf16_f32 v174, v220, v221
v_fma_f32 v222, v14, v126, v127
v_fma_f32 v223, v15, v126, v127
v_cvt_pk_bf16_f32 v175, v222, v223
v_fma_f32 v220, v16, v126, v127
v_fma_f32 v221, v17, v126, v127
v_cvt_pk_bf16_f32 v176, v220, v221
v_fma_f32 v222, v18, v126, v127
v_fma_f32 v223, v19, v126, v127
v_cvt_pk_bf16_f32 v177, v222, v223
ds_write_b128 v211, v[174:177] offset:6144
v_fma_f32 v220, v20, v126, v127
v_fma_f32 v221, v21, v126, v127
v_cvt_pk_bf16_f32 v178, v220, v221
v_fma_f32 v222, v22, v126, v127
v_fma_f32 v223, v23, v126, v127
v_cvt_pk_bf16_f32 v179, v222, v223
s_waitcnt lgkmcnt(3)
ds_write_b64 v212, v[178:179] offset:6144
v_fma_f32 v220, v24, v134, v135
v_fma_f32 v221, v25, v134, v135
v_cvt_pk_bf16_f32 v90, v220, v221
v_fma_f32 v222, v26, v134, v135
v_fma_f32 v223, v27, v134, v135
v_cvt_pk_bf16_f32 v91, v222, v223
v_fma_f32 v220, v28, v134, v135
v_fma_f32 v221, v29, v134, v135
v_cvt_pk_bf16_f32 v92, v220, v221
v_fma_f32 v222, v30, v134, v135
v_fma_f32 v223, v31, v134, v135
v_cvt_pk_bf16_f32 v93, v222, v223
ds_write_b128 v211, v[90:93] offset:12288
v_fma_f32 v220, v32, v134, v135
v_fma_f32 v221, v33, v134, v135
v_cvt_pk_bf16_f32 v94, v220, v221
v_fma_f32 v222, v34, v134, v135
v_fma_f32 v223, v35, v134, v135
v_cvt_pk_bf16_f32 v95, v222, v223
ds_write_b64 v212, v[94:95] offset:12288
ds_read_b128 v[182:185], v210 offset:28672
ds_read_b128 v[186:189], v210 offset:29696
s_waitcnt lgkmcnt(1)
v_mfma_f32_16x16x32_bf16 v[138:141], a[8:11], v[182:185], v[138:141]
s_waitcnt lgkmcnt(0)
v_mfma_f32_16x16x32_bf16 v[138:141], a[12:15], v[186:189], v[138:141]
v_mfma_f32_16x16x32_bf16 v[142:145], a[32:35], v[182:185], v[142:145]
v_mfma_f32_16x16x32_bf16 v[142:145], a[36:39], v[186:189], v[142:145]
v_mfma_f32_16x16x32_bf16 v[146:149], a[56:59], v[182:185], v[146:149]
v_mfma_f32_16x16x32_bf16 v[146:149], a[60:63], v[186:189], v[146:149]
v_mfma_f32_16x16x32_bf16 v[150:153], a[224:227], v[182:185], v[150:153]
v_mfma_f32_16x16x32_bf16 v[150:153], a[228:231], v[186:189], v[150:153]
v_mfma_f32_16x16x32_bf16 v[154:157], a[248:251], v[182:185], v[154:157]
v_mfma_f32_16x16x32_bf16 v[154:157], a[252:255], v[186:189], v[154:157]
v_mfma_f32_16x16x32_bf16 v[158:161], v[240:243], v[182:185], v[158:161]
v_mfma_f32_16x16x32_bf16 v[158:161], v[244:247], v[186:189], v[158:161]
v_mfma_f32_16x16x32_bf16 v[162:165], v[182:185], a[80:83], v[162:165]
v_mfma_f32_16x16x32_bf16 v[162:165], v[186:189], a[84:87], v[162:165]
v_mfma_f32_16x16x32_bf16 v[166:169], v[182:185], a[104:107], v[166:169]
v_mfma_f32_16x16x32_bf16 v[166:169], v[186:189], a[108:111], v[166:169]
v_mfma_f32_16x16x32_bf16 v[170:173], v[182:185], a[128:131], v[170:173]
v_mfma_f32_16x16x32_bf16 v[170:173], v[186:189], a[132:135], v[170:173]
ds_read_b128 v[110:113], v210 offset:30720
ds_read_b128 v[106:109], v210 offset:31744
s_waitcnt lgkmcnt(1)
v_mfma_f32_16x16x32_bf16 v[138:141], a[16:19], v[110:113], v[138:141]
s_waitcnt lgkmcnt(0)
v_mfma_f32_16x16x32_bf16 v[138:141], a[20:23], v[106:109], v[138:141]
v_mfma_f32_16x16x32_bf16 v[142:145], a[40:43], v[110:113], v[142:145]
v_mfma_f32_16x16x32_bf16 v[142:145], a[44:47], v[106:109], v[142:145]
v_mfma_f32_16x16x32_bf16 v[146:149], a[64:67], v[110:113], v[146:149]
v_mfma_f32_16x16x32_bf16 v[146:149], a[68:71], v[106:109], v[146:149]
v_mfma_f32_16x16x32_bf16 v[150:153], a[232:235], v[110:113], v[150:153]
v_mfma_f32_16x16x32_bf16 v[150:153], a[236:239], v[106:109], v[150:153]
v_mfma_f32_16x16x32_bf16 v[154:157], v[224:227], v[110:113], v[154:157]
v_mfma_f32_16x16x32_bf16 v[154:157], v[228:231], v[106:109], v[154:157]
v_mfma_f32_16x16x32_bf16 v[158:161], v[248:251], v[110:113], v[158:161]
v_mfma_f32_16x16x32_bf16 v[158:161], v[252:255], v[106:109], v[158:161]
v_mfma_f32_16x16x32_bf16 v[162:165], v[110:113], a[88:91], v[162:165]
v_mfma_f32_16x16x32_bf16 v[162:165], v[106:109], a[92:95], v[162:165]
v_mfma_f32_16x16x32_bf16 v[166:169], v[110:113], a[112:115], v[166:169]
v_mfma_f32_16x16x32_bf16 v[166:169], v[106:109], a[116:119], v[166:169]
v_mfma_f32_16x16x32_bf16 v[170:173], v[110:113], a[136:139], v[170:173]
v_mfma_f32_16x16x32_bf16 v[170:173], v[106:109], a[140:143], v[170:173]
v_cvt_pk_bf16_f32 v96, v138, v139
v_cvt_pk_bf16_f32 v97, v140, v141
v_cvt_pk_bf16_f32 v98, v142, v143
v_cvt_pk_bf16_f32 v99, v144, v145
v_cvt_pk_bf16_f32 v100, v146, v147
v_cvt_pk_bf16_f32 v101, v148, v149
v_cvt_pk_bf16_f32 v84, v150, v151
v_cvt_pk_bf16_f32 v85, v152, v153
v_cvt_pk_bf16_f32 v86, v154, v155
v_cvt_pk_bf16_f32 v87, v156, v157
v_cvt_pk_bf16_f32 v88, v158, v159
v_cvt_pk_bf16_f32 v89, v160, v161
v_cvt_pk_bf16_f32 v116, v162, v163
v_cvt_pk_bf16_f32 v117, v164, v165
v_cvt_pk_bf16_f32 v124, v166, v167
v_cvt_pk_bf16_f32 v125, v168, v169
v_cvt_pk_bf16_f32 v132, v170, v171
v_cvt_pk_bf16_f32 v133, v172, v173
ds_read_b128 v[182:185], v210 offset:32768
ds_read_b128 v[186:189], v210 offset:33792
s_waitcnt lgkmcnt(1)
v_mfma_f32_16x16x32_bf16 v[138:141], a[0:3], v[182:185], 0
s_waitcnt lgkmcnt(0)
v_mfma_f32_16x16x32_bf16 v[138:141], a[4:7], v[186:189], v[138:141]
v_mfma_f32_16x16x32_bf16 v[142:145], a[24:27], v[182:185], 0
v_mfma_f32_16x16x32_bf16 v[142:145], a[28:31], v[186:189], v[142:145]
v_mfma_f32_16x16x32_bf16 v[146:149], a[48:51], v[182:185], 0
v_mfma_f32_16x16x32_bf16 v[146:149], a[52:55], v[186:189], v[146:149]
ds_read_b128 v[170:173], v210 offset:34816
ds_read_b128 v[182:185], v210 offset:35840
s_waitcnt lgkmcnt(1)
v_mfma_f32_16x16x32_bf16 v[138:141], a[8:11], v[170:173], v[138:141]
s_waitcnt lgkmcnt(0)
v_mfma_f32_16x16x32_bf16 v[138:141], a[12:15], v[182:185], v[138:141]
v_mfma_f32_16x16x32_bf16 v[142:145], a[32:35], v[170:173], v[142:145]
v_mfma_f32_16x16x32_bf16 v[142:145], a[36:39], v[182:185], v[142:145]
v_mfma_f32_16x16x32_bf16 v[146:149], a[56:59], v[170:173], v[146:149]
v_mfma_f32_16x16x32_bf16 v[146:149], a[60:63], v[182:185], v[146:149]
ds_read_b128 v[186:189], v210 offset:36864
ds_read_b128 v[170:173], v210 offset:37888
s_waitcnt lgkmcnt(1)
v_mfma_f32_16x16x32_bf16 v[138:141], a[16:19], v[186:189], v[138:141]
s_waitcnt lgkmcnt(0)
v_mfma_f32_16x16x32_bf16 v[138:141], a[20:23], v[170:173], v[138:141]
v_mfma_f32_16x16x32_bf16 v[142:145], a[40:43], v[186:189], v[142:145]
v_mfma_f32_16x16x32_bf16 v[142:145], a[44:47], v[170:173], v[142:145]
v_mfma_f32_16x16x32_bf16 v[146:149], a[64:67], v[186:189], v[146:149]
v_mfma_f32_16x16x32_bf16 v[146:149], a[68:71], v[170:173], v[146:149]
v_cvt_pk_bf16_f32 v102, v138, v139
v_cvt_pk_bf16_f32 v103, v140, v141
v_cvt_pk_bf16_f32 v104, v142, v143
v_cvt_pk_bf16_f32 v105, v144, v145
s_nop 2
v_cvt_pk_bf16_f32 v106, v146, v147
v_cvt_pk_bf16_f32 v107, v148, v149
ds_read_b128 v[108:111], v215 offset:512
ds_read_b64 v[112:113], v215 offset:528
v_mfma_f32_16x16x16_bf16 v[138:141], v[82:83], v[76:77], 0
v_mfma_f32_16x16x16_bf16 v[142:145], v[100:101], v[76:77], 0
s_waitcnt lgkmcnt(0)
v_mfma_f32_16x16x16_bf16 v[150:153], v[112:113], v[76:77], v[206:209]
v_mfma_f32_16x16x16_bf16 v[146:149], v[106:107], v[76:77], 0
v_mfma_f32_16x16x32_bf16 v[138:141], v[78:81], v[72:75], v[138:141]
v_mfma_f32_16x16x32_bf16 v[142:145], v[96:99], v[72:75], v[142:145]
v_mfma_f32_16x16x32_bf16 v[150:153], v[108:111], v[72:75], v[150:153]
v_mfma_f32_16x16x32_bf16 v[146:149], v[102:105], v[72:75], v[146:149]
ds_read_b128 v[72:75], v215
ds_read_b64 v[76:77], v215 offset:16
v_mfma_f32_16x16x16_bf16 v[154:157], v[82:83], v[88:89], 0
v_mfma_f32_16x16x16_bf16 v[158:161], v[100:101], v[88:89], 0
v_mfma_f32_16x16x16_bf16 v[166:169], v[112:113], v[88:89], v[206:209]
v_mfma_f32_16x16x16_bf16 v[162:165], v[106:107], v[88:89], 0
v_mfma_f32_16x16x32_bf16 v[154:157], v[78:81], v[84:87], v[154:157]
v_mfma_f32_16x16x32_bf16 v[158:161], v[96:99], v[84:87], v[158:161]
v_mfma_f32_16x16x32_bf16 v[166:169], v[108:111], v[84:87], v[166:169]
v_mfma_f32_16x16x32_bf16 v[162:165], v[102:105], v[84:87], v[162:165]
ds_read_b128 v[182:185], v210 offset:32768
ds_read_b128 v[186:189], v210 offset:33792
s_waitcnt lgkmcnt(1)
v_mfma_f32_16x16x32_bf16 v[118:121], v[182:185], a[72:75], 0
s_waitcnt lgkmcnt(0)
v_mfma_f32_16x16x32_bf16 v[118:121], v[186:189], a[76:79], v[118:121]
v_mfma_f32_16x16x32_bf16 v[126:129], v[182:185], a[96:99], 0
v_mfma_f32_16x16x32_bf16 v[126:129], v[186:189], a[100:103], v[126:129]
v_mfma_f32_16x16x32_bf16 v[134:137], v[182:185], a[120:123], 0
v_mfma_f32_16x16x32_bf16 v[134:137], v[186:189], a[124:127], v[134:137]
v_mfma_f32_16x16x32_bf16 v[90:93], a[216:219], v[182:185], 0
v_mfma_f32_16x16x32_bf16 v[90:93], a[220:223], v[186:189], v[90:93]
v_mfma_f32_16x16x32_bf16 v[170:173], a[240:243], v[182:185], 0
v_mfma_f32_16x16x32_bf16 v[170:173], a[244:247], v[186:189], v[170:173]
v_mfma_f32_16x16x32_bf16 v[220:223], v[232:235], v[182:185], 0
v_mfma_f32_16x16x32_bf16 v[220:223], v[236:239], v[186:189], v[220:223]
ds_read_b128 v[174:177], v210 offset:34816
ds_read_b128 v[178:181], v210 offset:35840
s_waitcnt lgkmcnt(1)
v_mfma_f32_16x16x32_bf16 v[118:121], v[174:177], a[80:83], v[118:121]
s_waitcnt lgkmcnt(0)
v_mfma_f32_16x16x32_bf16 v[118:121], v[178:181], a[84:87], v[118:121]
v_mfma_f32_16x16x32_bf16 v[126:129], v[174:177], a[104:107], v[126:129]
v_mfma_f32_16x16x32_bf16 v[126:129], v[178:181], a[108:111], v[126:129]
v_mfma_f32_16x16x32_bf16 v[134:137], v[174:177], a[128:131], v[134:137]
v_mfma_f32_16x16x32_bf16 v[134:137], v[178:181], a[132:135], v[134:137]
v_mfma_f32_16x16x32_bf16 v[90:93], a[224:227], v[174:177], v[90:93]
v_mfma_f32_16x16x32_bf16 v[90:93], a[228:231], v[178:181], v[90:93]
v_mfma_f32_16x16x32_bf16 v[170:173], a[248:251], v[174:177], v[170:173]
v_mfma_f32_16x16x32_bf16 v[170:173], a[252:255], v[178:181], v[170:173]
v_mfma_f32_16x16x32_bf16 v[220:223], v[240:243], v[174:177], v[220:223]
v_mfma_f32_16x16x32_bf16 v[220:223], v[244:247], v[178:181], v[220:223]
ds_read_b128 v[182:185], v210 offset:36864
ds_read_b128 v[186:189], v210 offset:37888
s_waitcnt lgkmcnt(1)
v_mfma_f32_16x16x32_bf16 v[118:121], v[182:185], a[88:91], v[118:121]
s_waitcnt lgkmcnt(0)
v_mfma_f32_16x16x32_bf16 v[118:121], v[186:189], a[92:95], v[118:121]
v_mfma_f32_16x16x32_bf16 v[126:129], v[182:185], a[112:115], v[126:129]
v_mfma_f32_16x16x32_bf16 v[126:129], v[186:189], a[116:119], v[126:129]
v_mfma_f32_16x16x32_bf16 v[134:137], v[182:185], a[136:139], v[134:137]
v_mfma_f32_16x16x32_bf16 v[134:137], v[186:189], a[140:143], v[134:137]
v_mfma_f32_16x16x32_bf16 v[90:93], a[232:235], v[182:185], v[90:93]
v_mfma_f32_16x16x32_bf16 v[90:93], a[236:239], v[186:189], v[90:93]
v_mfma_f32_16x16x32_bf16 v[170:173], v[224:227], v[182:185], v[170:173]
v_mfma_f32_16x16x32_bf16 v[170:173], v[228:231], v[186:189], v[170:173]
v_mfma_f32_16x16x32_bf16 v[220:223], v[248:251], v[182:185], v[220:223]
v_mfma_f32_16x16x32_bf16 v[220:223], v[252:255], v[186:189], v[220:223]
v_mov_b32 v181, 0
v_cvt_pk_bf16_f32 v118, v118, v119
v_cvt_pk_bf16_f32 v119, v120, v121
ds_read_u16 v120, v214 offset:1024
v_mov_b32 v121, 0
v_cvt_pk_bf16_f32 v126, v126, v127
v_cvt_pk_bf16_f32 v127, v128, v129
ds_read_u16 v128, v214 offset:1032
v_mov_b32 v129, 0
v_cvt_pk_bf16_f32 v134, v134, v135
v_cvt_pk_bf16_f32 v135, v136, v137
ds_read_u16 v136, v214 offset:1040
v_mov_b32 v137, 0
v_cvt_pk_bf16_f32 v90, v90, v91
v_cvt_pk_bf16_f32 v91, v92, v93
v_cvt_pk_bf16_f32 v92, v170, v171
v_cvt_pk_bf16_f32 v93, v172, v173
v_cvt_pk_bf16_f32 v94, v220, v221
v_cvt_pk_bf16_f32 v95, v222, v223
v_max3_f32 v151, v138, v139, v140
v_max3_f32 v151, v151, v141, v142
v_max3_f32 v151, v151, v143, v144
v_max3_f32 v151, v151, v145, v146
v_max3_f32 v151, v151, v147, v148
v_max3_f32 v151, v151, v149, v150
v_mov_b32 v152, v151
s_nop 1
v_permlane16_swap_b32 v151, v152
v_max_f32 v151, v151, v152
v_mov_b32 v152, v151
s_nop 1
v_permlane32_swap_b32 v151, v152
v_max_f32 v151, v151, v152
v_sub_f32 v138, v138, v151
v_sub_f32 v139, v139, v151
v_sub_f32 v140, v140, v151
v_sub_f32 v141, v141, v151
v_sub_f32 v142, v142, v151
v_sub_f32 v143, v143, v151
v_sub_f32 v144, v144, v151
v_sub_f32 v145, v145, v151
v_sub_f32 v150, v150, v151
v_sub_f32 v146, v146, v151
v_sub_f32 v147, v147, v151
v_sub_f32 v148, v148, v151
v_sub_f32 v149, v149, v151
v_exp_f32 v138, v138
v_exp_f32 v139, v139
v_exp_f32 v140, v140
v_exp_f32 v141, v141
v_exp_f32 v142, v142
v_exp_f32 v143, v143
v_exp_f32 v144, v144
v_exp_f32 v145, v145
v_exp_f32 v150, v150
v_exp_f32 v146, v146
v_exp_f32 v147, v147
v_exp_f32 v148, v148
v_exp_f32 v149, v149
v_cvt_pk_bf16_f32 v174, v138, v139
v_cvt_pk_bf16_f32 v175, v140, v141
v_cvt_pk_bf16_f32 v176, v142, v143
v_cvt_pk_bf16_f32 v177, v144, v145
v_cvt_pk_bf16_f32 v178, v146, v147
v_cvt_pk_bf16_f32 v179, v148, v149
v_cvt_pk_bf16_f32 v180, v150, 0
v_mfma_f32_16x16x32_bf16 v[150:153], v[190:193], v[174:177], 0
v_mfma_f32_16x16x32_bf16 v[150:153], v[190:193], v[178:181], v[150:153]
v_mfma_f32_16x16x32_bf16 v[138:141], v[114:117], v[174:177], 0
s_waitcnt lgkmcnt(2)
v_mfma_f32_16x16x32_bf16 v[138:141], v[118:121], v[178:181], v[138:141]
v_mfma_f32_16x16x32_bf16 v[142:145], v[122:125], v[174:177], 0
s_waitcnt lgkmcnt(1)
v_mfma_f32_16x16x32_bf16 v[142:145], v[126:129], v[178:181], v[142:145]
v_mfma_f32_16x16x32_bf16 v[146:149], v[130:133], v[174:177], 0
s_waitcnt lgkmcnt(0)
v_mfma_f32_16x16x32_bf16 v[146:149], v[134:137], v[178:181], v[146:149]
v_max3_f32 v167, v154, v155, v156
v_max3_f32 v167, v167, v157, v158
v_max3_f32 v167, v167, v159, v160
v_max3_f32 v167, v167, v161, v162
v_max3_f32 v167, v167, v163, v164
v_max3_f32 v167, v167, v165, v166
v_mov_b32 v168, v167
s_nop 1
v_permlane16_swap_b32 v167, v168
v_max_f32 v167, v167, v168
v_mov_b32 v168, v167
s_nop 1
v_permlane32_swap_b32 v167, v168
v_max_f32 v167, v167, v168
v_sub_f32 v154, v154, v167
v_sub_f32 v155, v155, v167
v_sub_f32 v156, v156, v167
v_sub_f32 v157, v157, v167
v_sub_f32 v158, v158, v167
v_sub_f32 v159, v159, v167
v_sub_f32 v160, v160, v167
v_sub_f32 v161, v161, v167
v_sub_f32 v166, v166, v167
v_sub_f32 v162, v162, v167
v_sub_f32 v163, v163, v167
v_sub_f32 v164, v164, v167
v_sub_f32 v165, v165, v167
v_exp_f32 v154, v154
v_exp_f32 v155, v155
v_exp_f32 v156, v156
v_exp_f32 v157, v157
v_exp_f32 v158, v158
v_exp_f32 v159, v159
v_exp_f32 v160, v160
v_exp_f32 v161, v161
v_exp_f32 v166, v166
v_exp_f32 v162, v162
v_exp_f32 v163, v163
v_exp_f32 v164, v164
v_exp_f32 v165, v165
v_cvt_pk_bf16_f32 v174, v154, v155
v_cvt_pk_bf16_f32 v175, v156, v157
v_cvt_pk_bf16_f32 v176, v158, v159
v_cvt_pk_bf16_f32 v177, v160, v161
v_cvt_pk_bf16_f32 v178, v162, v163
v_cvt_pk_bf16_f32 v179, v164, v165
v_cvt_pk_bf16_f32 v180, v166, 0
v_mfma_f32_16x16x32_bf16 v[166:169], v[190:193], v[174:177], 0
v_mfma_f32_16x16x32_bf16 v[166:169], v[190:193], v[178:181], v[166:169]
v_mfma_f32_16x16x32_bf16 v[154:157], v[114:117], v[174:177], 0
v_mfma_f32_16x16x32_bf16 v[154:157], v[118:121], v[178:181], v[154:157]
v_mfma_f32_16x16x32_bf16 v[158:161], v[122:125], v[174:177], 0
v_mfma_f32_16x16x32_bf16 v[158:161], v[126:129], v[178:181], v[158:161]
v_mfma_f32_16x16x32_bf16 v[162:165], v[130:133], v[174:177], 0
v_mfma_f32_16x16x32_bf16 v[162:165], v[134:137], v[178:181], v[162:165]
v_rcp_f32 v151, v150
s_nop 0
v_mul_f32 v151, s3, v151
v_mul_f32 v138, v138, v151
v_mul_f32 v139, v139, v151
v_cvt_pk_bf16_f32 v138, v138, v139
v_mul_f32 v140, v140, v151
v_mul_f32 v141, v141, v151
v_cvt_pk_bf16_f32 v139, v140, v141
v_mul_f32 v142, v142, v151
v_mul_f32 v143, v143, v151
v_cvt_pk_bf16_f32 v140, v142, v143
v_mul_f32 v144, v144, v151
v_mul_f32 v145, v145, v151
v_cvt_pk_bf16_f32 v141, v144, v145
ds_write_b128 v211, v[138:141] offset:38912
v_mul_f32 v146, v146, v151
v_mul_f32 v147, v147, v151
v_cvt_pk_bf16_f32 v142, v146, v147
v_mul_f32 v148, v148, v151
v_mul_f32 v149, v149, v151
v_cvt_pk_bf16_f32 v143, v148, v149
ds_write_b64 v212, v[142:143] offset:38912
v_mfma_f32_16x16x16_bf16 v[138:141], v[82:83], v[94:95], 0
v_mfma_f32_16x16x16_bf16 v[142:145], v[100:101], v[94:95], 0
v_mfma_f32_16x16x16_bf16 v[150:153], v[112:113], v[94:95], v[206:209]
v_mfma_f32_16x16x16_bf16 v[146:149], v[106:107], v[94:95], 0
v_mfma_f32_16x16x32_bf16 v[138:141], v[78:81], v[90:93], v[138:141]
v_mfma_f32_16x16x32_bf16 v[142:145], v[96:99], v[90:93], v[142:145]
v_mfma_f32_16x16x32_bf16 v[150:153], v[108:111], v[90:93], v[150:153]
v_mfma_f32_16x16x32_bf16 v[146:149], v[102:105], v[90:93], v[146:149]
v_rcp_f32 v167, v166
s_nop 0
v_mul_f32 v167, s3, v167
v_mul_f32 v154, v154, v167
v_mul_f32 v155, v155, v167
v_cvt_pk_bf16_f32 v154, v154, v155
v_mul_f32 v156, v156, v167
v_mul_f32 v157, v157, v167
v_cvt_pk_bf16_f32 v155, v156, v157
v_mul_f32 v158, v158, v167
v_mul_f32 v159, v159, v167
v_cvt_pk_bf16_f32 v156, v158, v159
v_mul_f32 v160, v160, v167
v_mul_f32 v161, v161, v167
v_cvt_pk_bf16_f32 v157, v160, v161
ds_write_b128 v211, v[154:157] offset:45056
v_mul_f32 v162, v162, v167
v_mul_f32 v163, v163, v167
v_cvt_pk_bf16_f32 v158, v162, v163
v_mul_f32 v164, v164, v167
v_mul_f32 v165, v165, v167
v_cvt_pk_bf16_f32 v159, v164, v165
ds_write_b64 v212, v[158:159] offset:45056
v_mfma_f32_16x16x16_bf16 v[154:157], v[76:77], v[82:83], 0
v_mfma_f32_16x16x16_bf16 v[158:161], v[76:77], v[100:101], 0
v_mfma_f32_16x16x16_bf16 v[162:165], v[76:77], v[106:107], 0
v_mfma_f32_16x16x16_bf16 v[166:169], v[76:77], v[112:113], v[206:209]
v_mfma_f32_16x16x32_bf16 v[154:157], v[72:75], v[78:81], v[154:157]
v_mfma_f32_16x16x32_bf16 v[158:161], v[72:75], v[96:99], v[158:161]
v_mfma_f32_16x16x32_bf16 v[162:165], v[72:75], v[102:105], v[162:165]
v_mfma_f32_16x16x32_bf16 v[166:169], v[72:75], v[108:111], v[166:169]
v_mov_b32_dpp v154, v158 quad_perm:[0,1,2,3] row_mask:0x2 bank_mask:0xf
s_nop 1
v_mov_b32_dpp v154, v162 quad_perm:[0,1,2,3] row_mask:0x4 bank_mask:0xf
s_nop 2
v_mov_b32_dpp v154, v167 quad_perm:[0,1,2,3] row_mask:0x8 bank_mask:0xf
v_mov_b32 v155, v154
s_nop 1
v_max_f32_dpp v155, v155, v155 row_ror:8 row_mask:0xf bank_mask:0xf
s_nop 1
v_max_f32_dpp v155, v155, v155 row_ror:4 row_mask:0xf bank_mask:0xf
s_nop 1
v_max_f32_dpp v155, v155, v155 row_ror:2 row_mask:0xf bank_mask:0xf
s_nop 1
v_max_f32_dpp v155, v155, v155 row_ror:1 row_mask:0xf bank_mask:0xf
v_mov_b32 v156, v155
s_nop 1
v_permlane16_swap_b32 v155, v156
v_max_f32 v155, v155, v156
v_mov_b32 v156, v155
s_nop 1
v_permlane32_swap_b32 v155, v156
v_max_f32 v155, v155, v156
v_sub_f32 v154, v154, v155
v_exp_f32 v154, v154
s_nop 0
v_cvt_pk_bf16_f32 v154, v154, 0
ds_write_b16 v214, v154
s_waitcnt lgkmcnt(1)
ds_read_b128 v[84:87], v215
ds_read_b128 v[88:91], v215 offset:16
v_add_u32 v215, 1552, v215
s_barrier
ds_read_b128 v[220:223], v210 offset:38912
ds_read_b128 v[110:113], v210 offset:39936
s_waitcnt lgkmcnt(1)
v_mfma_f32_16x16x32_bf16 v[36:39], a[144:147], v[220:223], v[36:39]
s_waitcnt lgkmcnt(0)
v_mfma_f32_16x16x32_bf16 v[36:39], a[148:151], v[110:113], v[36:39]
v_mfma_f32_16x16x32_bf16 v[40:43], a[168:171], v[220:223], v[40:43]
v_mfma_f32_16x16x32_bf16 v[40:43], a[172:175], v[110:113], v[40:43]
v_mfma_f32_16x16x32_bf16 v[44:47], a[192:195], v[220:223], v[44:47]
v_mfma_f32_16x16x32_bf16 v[44:47], a[196:199], v[110:113], v[44:47]
ds_read_b128 v[170:173], v210 offset:40960
ds_read_b128 v[182:185], v210 offset:41984
s_waitcnt lgkmcnt(1)
v_mfma_f32_16x16x32_bf16 v[36:39], a[152:155], v[170:173], v[36:39]
s_waitcnt lgkmcnt(0)
v_mfma_f32_16x16x32_bf16 v[36:39], a[156:159], v[182:185], v[36:39]
v_mfma_f32_16x16x32_bf16 v[40:43], a[176:179], v[170:173], v[40:43]
v_mfma_f32_16x16x32_bf16 v[40:43], a[180:183], v[182:185], v[40:43]
v_mfma_f32_16x16x32_bf16 v[44:47], a[200:203], v[170:173], v[44:47]
v_mfma_f32_16x16x32_bf16 v[44:47], a[204:207], v[182:185], v[44:47]
ds_read_b128 v[186:189], v210 offset:43008
ds_read_b128 v[220:223], v210 offset:44032
s_waitcnt lgkmcnt(1)
v_mfma_f32_16x16x32_bf16 v[36:39], a[160:163], v[186:189], v[36:39]
s_waitcnt lgkmcnt(0)
v_mfma_f32_16x16x32_bf16 v[36:39], a[164:167], v[220:223], v[36:39]
v_mfma_f32_16x16x32_bf16 v[40:43], a[184:187], v[186:189], v[40:43]
v_mfma_f32_16x16x32_bf16 v[40:43], a[188:191], v[220:223], v[40:43]
v_mfma_f32_16x16x32_bf16 v[44:47], a[208:211], v[186:189], v[44:47]
v_mfma_f32_16x16x32_bf16 v[44:47], a[212:215], v[220:223], v[44:47]
v_cvt_pk_bf16_f32 v72, v36, v37
v_cvt_pk_bf16_f32 v73, v38, v39
buffer_store_dwordx2 v[72:73], v203, s[8:11], s39 offen
v_cvt_pk_bf16_f32 v74, v40, v41
v_cvt_pk_bf16_f32 v75, v42, v43
buffer_store_dwordx2 v[74:75], v203, s[8:11], s39 offen offset:32
s_nop 0
v_cvt_pk_bf16_f32 v76, v44, v45
v_cvt_pk_bf16_f32 v77, v46, v47
buffer_store_dwordx2 v[76:77], v203, s[8:11], s39 offen offset:64
v_max3_f32 v151, v138, v139, v140
v_max3_f32 v151, v151, v141, v142
v_max3_f32 v151, v151, v143, v144
v_max3_f32 v151, v151, v145, v146
v_max3_f32 v151, v151, v147, v148
v_max3_f32 v151, v151, v149, v150
v_mov_b32 v152, v151
s_nop 1
v_permlane16_swap_b32 v151, v152
v_max_f32 v151, v151, v152
v_mov_b32 v152, v151
s_nop 1
v_permlane32_swap_b32 v151, v152
v_max_f32 v151, v151, v152
v_sub_f32 v138, v138, v151
v_sub_f32 v139, v139, v151
v_sub_f32 v140, v140, v151
v_sub_f32 v141, v141, v151
v_sub_f32 v142, v142, v151
v_sub_f32 v143, v143, v151
v_sub_f32 v144, v144, v151
v_sub_f32 v145, v145, v151
v_sub_f32 v150, v150, v151
v_sub_f32 v146, v146, v151
v_sub_f32 v147, v147, v151
v_sub_f32 v148, v148, v151
v_sub_f32 v149, v149, v151
v_exp_f32 v138, v138
v_exp_f32 v139, v139
v_exp_f32 v140, v140
v_exp_f32 v141, v141
v_exp_f32 v142, v142
v_exp_f32 v143, v143
v_exp_f32 v144, v144
v_exp_f32 v145, v145
v_exp_f32 v150, v150
v_exp_f32 v146, v146
v_exp_f32 v147, v147
v_exp_f32 v148, v148
v_exp_f32 v149, v149
v_cvt_pk_bf16_f32 v174, v138, v139
v_cvt_pk_bf16_f32 v175, v140, v141
v_cvt_pk_bf16_f32 v176, v142, v143
v_cvt_pk_bf16_f32 v177, v144, v145
v_cvt_pk_bf16_f32 v178, v146, v147
v_cvt_pk_bf16_f32 v179, v148, v149
v_cvt_pk_bf16_f32 v180, v150, 0
v_mfma_f32_16x16x32_bf16 v[150:153], v[190:193], v[174:177], 0
v_mfma_f32_16x16x32_bf16 v[150:153], v[190:193], v[178:181], v[150:153]
v_mfma_f32_16x16x32_bf16 v[138:141], v[114:117], v[174:177], 0
v_mfma_f32_16x16x32_bf16 v[138:141], v[118:121], v[178:181], v[138:141]
v_mfma_f32_16x16x32_bf16 v[142:145], v[122:125], v[174:177], 0
v_mfma_f32_16x16x32_bf16 v[142:145], v[126:129], v[178:181], v[142:145]
v_mfma_f32_16x16x32_bf16 v[146:149], v[130:133], v[174:177], 0
v_mfma_f32_16x16x32_bf16 v[146:149], v[134:137], v[178:181], v[146:149]
v_mfma_f32_16x16x32_bf16 v[166:169], v[84:87], v[190:193], 0
v_mfma_f32_16x16x32_bf16 v[166:169], v[88:91], v[190:193], v[166:169]
v_mfma_f32_16x16x32_bf16 v[154:157], v[84:87], v[114:117], 0
v_mfma_f32_16x16x32_bf16 v[154:157], v[88:91], v[118:121], v[154:157]
v_mfma_f32_16x16x32_bf16 v[158:161], v[84:87], v[122:125], 0
v_mfma_f32_16x16x32_bf16 v[158:161], v[88:91], v[126:129], v[158:161]
v_mfma_f32_16x16x32_bf16 v[162:165], v[84:87], v[130:133], 0
v_mfma_f32_16x16x32_bf16 v[162:165], v[88:91], v[134:137], v[162:165]
v_rcp_f32 v167, v166
v_mov_b32_dpp v154, v158 quad_perm:[0,1,2,3] row_mask:0x2 bank_mask:0xf
s_nop 3
v_mov_b32_dpp v154, v162 quad_perm:[0,1,2,3] row_mask:0x4 bank_mask:0xf
v_mul_f32 v167, s3, v167
v_mul_f32 v154, v154, v167
v_cvt_pk_bf16_f32 v154, v154, 0
ds_write_b16 v214, v154
v_add_u32 v214, 1552, v214
ds_read_b128 v[110:113], v210 offset:45056
ds_read_b128 v[170:173], v210 offset:46080
s_waitcnt lgkmcnt(1)
v_mfma_f32_16x16x32_bf16 v[48:51], a[144:147], v[110:113], v[48:51]
s_waitcnt lgkmcnt(0)
v_mfma_f32_16x16x32_bf16 v[48:51], a[148:151], v[170:173], v[48:51]
v_mfma_f32_16x16x32_bf16 v[52:55], a[168:171], v[110:113], v[52:55]
v_mfma_f32_16x16x32_bf16 v[52:55], a[172:175], v[170:173], v[52:55]
v_mfma_f32_16x16x32_bf16 v[56:59], a[192:195], v[110:113], v[56:59]
v_mfma_f32_16x16x32_bf16 v[56:59], a[196:199], v[170:173], v[56:59]
ds_read_b128 v[182:185], v210 offset:47104
ds_read_b128 v[186:189], v210 offset:48128
s_waitcnt lgkmcnt(1)
v_mfma_f32_16x16x32_bf16 v[48:51], a[152:155], v[182:185], v[48:51]
s_waitcnt lgkmcnt(0)
v_mfma_f32_16x16x32_bf16 v[48:51], a[156:159], v[186:189], v[48:51]
v_mfma_f32_16x16x32_bf16 v[52:55], a[176:179], v[182:185], v[52:55]
v_mfma_f32_16x16x32_bf16 v[52:55], a[180:183], v[186:189], v[52:55]
v_mfma_f32_16x16x32_bf16 v[56:59], a[200:203], v[182:185], v[56:59]
v_mfma_f32_16x16x32_bf16 v[56:59], a[204:207], v[186:189], v[56:59]
ds_read_b128 v[220:223], v210 offset:49152
ds_read_b128 v[110:113], v210 offset:50176
s_waitcnt lgkmcnt(1)
v_mfma_f32_16x16x32_bf16 v[48:51], a[160:163], v[220:223], v[48:51]
s_waitcnt lgkmcnt(0)
v_mfma_f32_16x16x32_bf16 v[48:51], a[164:167], v[110:113], v[48:51]
v_mfma_f32_16x16x32_bf16 v[52:55], a[184:187], v[220:223], v[52:55]
v_mfma_f32_16x16x32_bf16 v[52:55], a[188:191], v[110:113], v[52:55]
v_mfma_f32_16x16x32_bf16 v[56:59], a[208:211], v[220:223], v[56:59]
v_mfma_f32_16x16x32_bf16 v[56:59], a[212:215], v[110:113], v[56:59]
v_cvt_pk_bf16_f32 v78, v48, v49
v_cvt_pk_bf16_f32 v79, v50, v51
buffer_store_dwordx2 v[78:79], v204, s[8:11], s39 offen
v_cvt_pk_bf16_f32 v80, v52, v53
v_cvt_pk_bf16_f32 v81, v54, v55
buffer_store_dwordx2 v[80:81], v204, s[8:11], s39 offen offset:32
s_nop 0
v_cvt_pk_bf16_f32 v82, v56, v57
v_cvt_pk_bf16_f32 v83, v58, v59
buffer_store_dwordx2 v[82:83], v204, s[8:11], s39 offen offset:64
v_rcp_f32 v151, v150
s_nop 0
v_mul_f32 v151, s3, v151
v_mul_f32 v138, v138, v151
v_mul_f32 v139, v139, v151
v_cvt_pk_bf16_f32 v138, v138, v139
v_mul_f32 v140, v140, v151
v_mul_f32 v141, v141, v151
v_cvt_pk_bf16_f32 v139, v140, v141
v_mul_f32 v142, v142, v151
v_mul_f32 v143, v143, v151
v_cvt_pk_bf16_f32 v140, v142, v143
v_mul_f32 v144, v144, v151
v_mul_f32 v145, v145, v151
v_cvt_pk_bf16_f32 v141, v144, v145
ds_write_b128 v211, v[138:141] offset:51200
v_mul_f32 v146, v146, v151
v_mul_f32 v147, v147, v151
v_cvt_pk_bf16_f32 v142, v146, v147
v_mul_f32 v148, v148, v151
v_mul_f32 v149, v149, v151
v_cvt_pk_bf16_f32 v143, v148, v149
ds_write_b64 v212, v[142:143] offset:51200
s_waitcnt lgkmcnt(0)
s_barrier
ds_read_b128 v[170:173], v210 offset:51200
ds_read_b128 v[182:185], v210 offset:52224
s_waitcnt lgkmcnt(1)
v_mfma_f32_16x16x32_bf16 v[60:63], a[144:147], v[170:173], v[60:63]
s_waitcnt lgkmcnt(0)
v_mfma_f32_16x16x32_bf16 v[60:63], a[148:151], v[182:185], v[60:63]
v_mfma_f32_16x16x32_bf16 v[64:67], a[168:171], v[170:173], v[64:67]
v_mfma_f32_16x16x32_bf16 v[64:67], a[172:175], v[182:185], v[64:67]
v_mfma_f32_16x16x32_bf16 v[68:71], a[192:195], v[170:173], v[68:71]
v_mfma_f32_16x16x32_bf16 v[68:71], a[196:199], v[182:185], v[68:71]
ds_read_b128 v[186:189], v210 offset:53248
ds_read_b128 v[220:223], v210 offset:54272
s_waitcnt lgkmcnt(1)
v_mfma_f32_16x16x32_bf16 v[60:63], a[152:155], v[186:189], v[60:63]
s_waitcnt lgkmcnt(0)
v_mfma_f32_16x16x32_bf16 v[60:63], a[156:159], v[220:223], v[60:63]
v_mfma_f32_16x16x32_bf16 v[64:67], a[176:179], v[186:189], v[64:67]
v_mfma_f32_16x16x32_bf16 v[64:67], a[180:183], v[220:223], v[64:67]
v_mfma_f32_16x16x32_bf16 v[68:71], a[200:203], v[186:189], v[68:71]
v_mfma_f32_16x16x32_bf16 v[68:71], a[204:207], v[220:223], v[68:71]
ds_read_b128 v[110:113], v210 offset:55296
ds_read_b128 v[170:173], v210 offset:56320
s_waitcnt lgkmcnt(1)
v_mfma_f32_16x16x32_bf16 v[60:63], a[160:163], v[110:113], v[60:63]
s_waitcnt lgkmcnt(0)
v_mfma_f32_16x16x32_bf16 v[60:63], a[164:167], v[170:173], v[60:63]
v_mfma_f32_16x16x32_bf16 v[64:67], a[184:187], v[110:113], v[64:67]
v_mfma_f32_16x16x32_bf16 v[64:67], a[188:191], v[170:173], v[64:67]
v_mfma_f32_16x16x32_bf16 v[68:71], a[208:211], v[110:113], v[68:71]
v_mfma_f32_16x16x32_bf16 v[68:71], a[212:215], v[170:173], v[68:71]
v_cvt_pk_bf16_f32 v116, v60, v61
v_cvt_pk_bf16_f32 v117, v62, v63
buffer_store_dwordx2 v[116:117], v205, s[8:11], s39 offen
v_cvt_pk_bf16_f32 v124, v64, v65
v_cvt_pk_bf16_f32 v125, v66, v67
buffer_store_dwordx2 v[124:125], v205, s[8:11], s39 offen offset:32
s_nop 0
v_cvt_pk_bf16_f32 v132, v68, v69
v_cvt_pk_bf16_f32 v133, v70, v71
buffer_store_dwordx2 v[132:133], v205, s[8:11], s39 offen offset:64
v_subrev_u32 v60, 37120, v210
v_lshrrev_b32 v61, 4, v60
v_and_b32 v61, 15, v61
v_lshrrev_b32 v62, 8, v60
v_mul_u32_u24 v63, 1552, v61
v_lshl_add_u32 v63, v62, 5, v63
v_add_u32 v63, 94464, v63
v_mul_u32_u24 v64, 784, v61
v_lshl_add_u32 v64, v62, 4, v64
s_mul_i32 s41, s32, 192
s_add_u32 s41, s41, 127056
v_add_u32 v64, s41, v64
ds_read_b128 v[36:39], v64
ds_read_b128 v[40:43], v64 offset:64
ds_read_b128 v[44:47], v64 offset:128
v_lshlrev_b32 v67, 5, v61
s_add_u32 s41, s33, 0
v_add_u32 v67, s41, v67
s_mov_b32 s42, 58835169
v_mul_hi_u32 v68, v67, s42
v_mul_u32_u24 v65, 73, v68
v_sub_u32 v65, v67, v65
v_mul_u32_u24 v65, 2688, v65
s_mov_b32 s42, 1373568
v_mul_lo_u32 v68, v68, s42
s_mul_i32 s42, s32, 96
v_add3_u32 v65, v65, v68, s42
v_cmp_gt_u32 vcc, s34, v67
v_mov_b32 v68, 1879048192
s_nop 0
v_cndmask_b32 v65, v68, v65, vcc
v_lshl_add_u32 v65, v62, 3, v65
v_add_u32 v65, 785664, v65
v_lshlrev_b32 v67, 5, v61
s_add_u32 s41, s33, 512
v_add_u32 v67, s41, v67
v_mov_b32 v68, s97
v_cmp_gt_u32 vcc, 4, v61
s_nop 1
v_cndmask_b32 v67, v68, v67, vcc
v_mov_b32 v68, 6000
v_cmp_gt_u32 vcc, 5, v61
s_nop 1
v_cndmask_b32 v67, v68, v67, vcc
s_mov_b32 s42, 58835169
v_mul_hi_u32 v68, v67, s42
v_mul_u32_u24 v66, 73, v68
v_sub_u32 v66, v67, v66
v_mul_u32_u24 v66, 2688, v66
s_mov_b32 s42, 1373568
v_mul_lo_u32 v68, v68, s42
s_mul_i32 s42, s32, 96
v_add3_u32 v66, v66, v68, s42
v_cmp_gt_u32 vcc, s34, v67
v_mov_b32 v68, 1879048192
s_nop 0
v_cndmask_b32 v66, v68, v66, vcc
v_lshl_add_u32 v66, v62, 3, v66
v_add_u32 v66, 785664, v66
v_mov_b32_dpp v69, v194 row_newbcast:0 row_mask:0xf bank_mask:0xf
v_add_u32 v69, 17248, v69
v_mov_b32_dpp v70, v197 row_newbcast:0 row_mask:0xf bank_mask:0xf
v_add_u32 v70, 17248, v70
v_mov_b32_dpp v71, v200 row_newbcast:0 row_mask:0xf bank_mask:0xf
v_add_u32 v71, 17248, v71
ds_read_b128 v[174:177], v217
ds_read_b128 v[84:87], v71
s_waitcnt lgkmcnt(0)
v_mfma_f32_16x16x32_bf16 v[48:51], v[174:177], v[84:87], 0
ds_read_b128 v[178:181], v217 offset:528
ds_read_b128 v[92:95], v69
ds_read_b128 v[96:99], v69 offset:16
s_waitcnt lgkmcnt(0)
s_nop 0
v_smfmac_f32_16x16x64_bf16 v[48:51], v[178:181], v[92:99], v213
ds_read_b128 v[174:177], v217 offset:1056
ds_read_b128 v[100:103], v70
ds_read_b128 v[104:107], v70 offset:16
s_waitcnt lgkmcnt(0)
v_smfmac_f32_16x16x64_bf16 v[48:51], v[174:177], v[100:107], v213
ds_read_b128 v[178:181], v217 offset:1584
ds_read_b128 v[84:87], v71 offset:32
s_waitcnt lgkmcnt(0)
v_mfma_f32_16x16x32_bf16 v[52:55], v[178:181], v[84:87], 0
ds_read_b128 v[174:177], v217 offset:2112
ds_read_b128 v[92:95], v69 offset:32
ds_read_b128 v[96:99], v69 offset:48
s_waitcnt lgkmcnt(0)
s_nop 0
v_smfmac_f32_16x16x64_bf16 v[52:55], v[174:177], v[92:99], v213
ds_read_b128 v[178:181], v217 offset:2640
ds_read_b128 v[100:103], v70 offset:32
ds_read_b128 v[104:107], v70 offset:48
s_waitcnt lgkmcnt(0)
v_smfmac_f32_16x16x64_bf16 v[52:55], v[178:181], v[100:107], v213
ds_read_b128 v[174:177], v217 offset:3168
ds_read_b128 v[84:87], v71 offset:64
s_waitcnt lgkmcnt(0)
v_mfma_f32_16x16x32_bf16 v[56:59], v[174:177], v[84:87], 0
ds_read_b128 v[178:181], v217 offset:3696
ds_read_b128 v[92:95], v69 offset:64
ds_read_b128 v[96:99], v69 offset:80
s_waitcnt lgkmcnt(0)
s_nop 0
v_smfmac_f32_16x16x64_bf16 v[56:59], v[178:181], v[92:99], v213
ds_read_b128 v[174:177], v217 offset:4224
ds_read_b128 v[100:103], v70 offset:64
ds_read_b128 v[104:107], v70 offset:80
s_waitcnt lgkmcnt(0)
v_smfmac_f32_16x16x64_bf16 v[56:59], v[174:177], v[100:107], v213
v_add_f32 v118, v48, v49
v_mul_f32 v119, v48, v48
v_add_f32 v118, v118, v50
v_fmac_f32 v119, v49, v49
v_add_f32 v118, v118, v51
v_fmac_f32 v119, v50, v50
v_fmac_f32 v119, v51, v51
v_add_f32 v118, v118, v52
v_fmac_f32 v119, v52, v52
v_add_f32 v118, v118, v53
v_fmac_f32 v119, v53, v53
v_add_f32 v118, v118, v54
v_fmac_f32 v119, v54, v54
v_add_f32 v118, v118, v55
v_fmac_f32 v119, v55, v55
v_add_f32 v118, v118, v56
v_fmac_f32 v119, v56, v56
v_add_f32 v118, v118, v57
v_fmac_f32 v119, v57, v57
v_add_f32 v118, v118, v58
v_fmac_f32 v119, v58, v58
v_add_f32 v118, v118, v59
v_fmac_f32 v119, v59, v59
s_nop 1
v_permlane16_swap_b32 v118, v119
v_add_f32 v118, v118, v119
v_mov_b32 v126, v118
s_nop 1
v_permlane32_swap_b32 v118, v126
v_add_f32 v118, v118, v126
ds_write_b32 v209, v118
s_mov_b32 s38, s36
s_waitcnt lgkmcnt(0)
s_barrier
ds_read_b128 v[84:87], v63
ds_read_b128 v[88:91], v63 offset:128
ds_read_b128 v[92:95], v63 offset:256
ds_read_b128 v[96:99], v63 offset:384
ds_read_b64 v[100:101], v63 offset:16
ds_read_b64 v[102:103], v63 offset:144
ds_read_b64 v[104:105], v63 offset:272
ds_read_b64 v[106:107], v63 offset:400
s_waitcnt lgkmcnt(7)
v_mfma_f32_16x16x32_bf16 v[36:39], a[144:147], v[84:87], v[36:39]
s_waitcnt lgkmcnt(6)
v_mfma_f32_16x16x32_bf16 v[36:39], a[148:151], v[88:91], v[36:39]
s_waitcnt lgkmcnt(5)
v_mfma_f32_16x16x32_bf16 v[36:39], a[152:155], v[92:95], v[36:39]
s_waitcnt lgkmcnt(4)
v_mfma_f32_16x16x32_bf16 v[36:39], a[156:159], v[96:99], v[36:39]
s_waitcnt lgkmcnt(2)
v_mfma_f32_16x16x32_bf16 v[36:39], a[160:163], v[100:103], v[36:39]
s_waitcnt lgkmcnt(0)
v_mfma_f32_16x16x32_bf16 v[36:39], a[164:167], v[104:107], v[36:39]
s_nop 7
v_cvt_pk_bf16_f32 v36, v36, v37
v_cvt_pk_bf16_f32 v37, v38, v39
buffer_store_dwordx2 v[36:37], v65, s[8:11], 0 offen
v_mfma_f32_16x16x32_bf16 v[40:43], a[168:171], v[84:87], v[40:43]
v_mfma_f32_16x16x32_bf16 v[40:43], a[172:175], v[88:91], v[40:43]
v_mfma_f32_16x16x32_bf16 v[40:43], a[176:179], v[92:95], v[40:43]
v_mfma_f32_16x16x32_bf16 v[40:43], a[180:183], v[96:99], v[40:43]
v_mfma_f32_16x16x32_bf16 v[40:43], a[184:187], v[100:103], v[40:43]
v_mfma_f32_16x16x32_bf16 v[40:43], a[188:191], v[104:107], v[40:43]
s_nop 7
v_cvt_pk_bf16_f32 v40, v40, v41
v_cvt_pk_bf16_f32 v41, v42, v43
buffer_store_dwordx2 v[40:41], v65, s[8:11], 0 offen offset:32
v_mfma_f32_16x16x32_bf16 v[44:47], a[192:195], v[84:87], v[44:47]
v_mfma_f32_16x16x32_bf16 v[44:47], a[196:199], v[88:91], v[44:47]
v_mfma_f32_16x16x32_bf16 v[44:47], a[200:203], v[92:95], v[44:47]
v_mfma_f32_16x16x32_bf16 v[44:47], a[204:207], v[96:99], v[44:47]
v_mfma_f32_16x16x32_bf16 v[44:47], a[208:211], v[100:103], v[44:47]
v_mfma_f32_16x16x32_bf16 v[44:47], a[212:215], v[104:107], v[44:47]
s_nop 7
v_cvt_pk_bf16_f32 v44, v44, v45
v_cvt_pk_bf16_f32 v45, v46, v47
buffer_store_dwordx2 v[44:45], v65, s[8:11], 0 offen offset:64
ds_read_b128 v[182:185], v210
ds_read_b128 v[186:189], v210 offset:1024
s_waitcnt lgkmcnt(1)
v_mfma_f32_16x16x32_bf16 v[138:141], a[0:3], v[182:185], 0
s_waitcnt lgkmcnt(0)
v_mfma_f32_16x16x32_bf16 v[138:141], a[4:7], v[186:189], v[138:141]
v_mfma_f32_16x16x32_bf16 v[142:145], a[24:27], v[182:185], 0
v_mfma_f32_16x16x32_bf16 v[142:145], a[28:31], v[186:189], v[142:145]
v_mfma_f32_16x16x32_bf16 v[146:149], a[48:51], v[182:185], 0
v_mfma_f32_16x16x32_bf16 v[146:149], a[52:55], v[186:189], v[146:149]
v_mfma_f32_16x16x32_bf16 v[150:153], a[216:219], v[182:185], 0
v_mfma_f32_16x16x32_bf16 v[150:153], a[220:223], v[186:189], v[150:153]
v_mfma_f32_16x16x32_bf16 v[154:157], a[240:243], v[182:185], 0
v_mfma_f32_16x16x32_bf16 v[154:157], a[244:247], v[186:189], v[154:157]
v_mfma_f32_16x16x32_bf16 v[158:161], v[232:235], v[182:185], 0
v_mfma_f32_16x16x32_bf16 v[158:161], v[236:239], v[186:189], v[158:161]
v_mfma_f32_16x16x32_bf16 v[162:165], v[182:185], a[72:75], 0
v_mfma_f32_16x16x32_bf16 v[162:165], v[186:189], a[76:79], v[162:165]
v_mfma_f32_16x16x32_bf16 v[166:169], v[182:185], a[96:99], 0
v_mfma_f32_16x16x32_bf16 v[166:169], v[186:189], a[100:103], v[166:169]
v_mfma_f32_16x16x32_bf16 v[170:173], v[182:185], a[120:123], 0
v_mfma_f32_16x16x32_bf16 v[170:173], v[186:189], a[124:127], v[170:173]
ds_read_b128 v[110:113], v210 offset:2048
ds_read_b128 v[220:223], v210 offset:3072
s_waitcnt lgkmcnt(1)
v_mfma_f32_16x16x32_bf16 v[138:141], a[8:11], v[110:113], v[138:141]
s_waitcnt lgkmcnt(0)
v_mfma_f32_16x16x32_bf16 v[138:141], a[12:15], v[220:223], v[138:141]
v_mfma_f32_16x16x32_bf16 v[142:145], a[32:35], v[110:113], v[142:145]
v_mfma_f32_16x16x32_bf16 v[142:145], a[36:39], v[220:223], v[142:145]
v_mfma_f32_16x16x32_bf16 v[146:149], a[56:59], v[110:113], v[146:149]
v_mfma_f32_16x16x32_bf16 v[146:149], a[60:63], v[220:223], v[146:149]
v_mfma_f32_16x16x32_bf16 v[150:153], a[224:227], v[110:113], v[150:153]
v_mfma_f32_16x16x32_bf16 v[150:153], a[228:231], v[220:223], v[150:153]
v_mfma_f32_16x16x32_bf16 v[154:157], a[248:251], v[110:113], v[154:157]
v_mfma_f32_16x16x32_bf16 v[154:157], a[252:255], v[220:223], v[154:157]
v_mfma_f32_16x16x32_bf16 v[158:161], v[240:243], v[110:113], v[158:161]
v_mfma_f32_16x16x32_bf16 v[158:161], v[244:247], v[220:223], v[158:161]
v_mfma_f32_16x16x32_bf16 v[162:165], v[110:113], a[80:83], v[162:165]
v_mfma_f32_16x16x32_bf16 v[162:165], v[220:223], a[84:87], v[162:165]
v_mfma_f32_16x16x32_bf16 v[166:169], v[110:113], a[104:107], v[166:169]
v_mfma_f32_16x16x32_bf16 v[166:169], v[220:223], a[108:111], v[166:169]
v_mfma_f32_16x16x32_bf16 v[170:173], v[110:113], a[128:131], v[170:173]
v_mfma_f32_16x16x32_bf16 v[170:173], v[220:223], a[132:135], v[170:173]
ds_read_b128 v[182:185], v210 offset:4096
ds_read_b128 v[186:189], v210 offset:5120
s_waitcnt lgkmcnt(1)
v_mfma_f32_16x16x32_bf16 v[138:141], a[16:19], v[182:185], v[138:141]
s_waitcnt lgkmcnt(0)
v_mfma_f32_16x16x32_bf16 v[138:141], a[20:23], v[186:189], v[138:141]
v_mfma_f32_16x16x32_bf16 v[142:145], a[40:43], v[182:185], v[142:145]
v_mfma_f32_16x16x32_bf16 v[142:145], a[44:47], v[186:189], v[142:145]
v_mfma_f32_16x16x32_bf16 v[146:149], a[64:67], v[182:185], v[146:149]
v_mfma_f32_16x16x32_bf16 v[146:149], a[68:71], v[186:189], v[146:149]
v_mfma_f32_16x16x32_bf16 v[150:153], a[232:235], v[182:185], v[150:153]
v_mfma_f32_16x16x32_bf16 v[150:153], a[236:239], v[186:189], v[150:153]
v_mfma_f32_16x16x32_bf16 v[154:157], v[224:227], v[182:185], v[154:157]
v_mfma_f32_16x16x32_bf16 v[154:157], v[228:231], v[186:189], v[154:157]
v_mfma_f32_16x16x32_bf16 v[158:161], v[248:251], v[182:185], v[158:161]
v_mfma_f32_16x16x32_bf16 v[158:161], v[252:255], v[186:189], v[158:161]
v_mfma_f32_16x16x32_bf16 v[162:165], v[182:185], a[88:91], v[162:165]
v_mfma_f32_16x16x32_bf16 v[162:165], v[186:189], a[92:95], v[162:165]
v_mfma_f32_16x16x32_bf16 v[166:169], v[182:185], a[112:115], v[166:169]
v_mfma_f32_16x16x32_bf16 v[166:169], v[186:189], a[116:119], v[166:169]
v_mfma_f32_16x16x32_bf16 v[170:173], v[182:185], a[136:139], v[170:173]
v_mfma_f32_16x16x32_bf16 v[170:173], v[186:189], a[140:143], v[170:173]
v_cvt_pk_bf16_f32 v78, v138, v139
v_cvt_pk_bf16_f32 v79, v140, v141
v_cvt_pk_bf16_f32 v80, v142, v143
v_cvt_pk_bf16_f32 v81, v144, v145
v_cvt_pk_bf16_f32 v82, v146, v147
v_cvt_pk_bf16_f32 v83, v148, v149
v_cvt_pk_bf16_f32 v72, v150, v151
v_cvt_pk_bf16_f32 v73, v152, v153
v_cvt_pk_bf16_f32 v74, v154, v155
v_cvt_pk_bf16_f32 v75, v156, v157
v_cvt_pk_bf16_f32 v76, v158, v159
v_cvt_pk_bf16_f32 v77, v160, v161
v_cvt_pk_bf16_f32 v114, v162, v163
v_cvt_pk_bf16_f32 v115, v164, v165
v_cvt_pk_bf16_f32 v122, v166, v167
v_cvt_pk_bf16_f32 v123, v168, v169
v_cvt_pk_bf16_f32 v130, v170, v171
v_cvt_pk_bf16_f32 v131, v172, v173
ds_read_b128 v[110:113], v210 offset:6144
ds_read_b128 v[220:223], v210 offset:7168
s_waitcnt lgkmcnt(1)
v_mfma_f32_16x16x32_bf16 v[138:141], a[0:3], v[110:113], 0
s_waitcnt lgkmcnt(0)
v_mfma_f32_16x16x32_bf16 v[138:141], a[4:7], v[220:223], v[138:141]
v_mfma_f32_16x16x32_bf16 v[142:145], a[24:27], v[110:113], 0
v_mfma_f32_16x16x32_bf16 v[142:145], a[28:31], v[220:223], v[142:145]
v_mfma_f32_16x16x32_bf16 v[146:149], a[48:51], v[110:113], 0
v_mfma_f32_16x16x32_bf16 v[146:149], a[52:55], v[220:223], v[146:149]
v_mfma_f32_16x16x32_bf16 v[150:153], a[216:219], v[110:113], 0
v_mfma_f32_16x16x32_bf16 v[150:153], a[220:223], v[220:223], v[150:153]
v_mfma_f32_16x16x32_bf16 v[154:157], a[240:243], v[110:113], 0
v_mfma_f32_16x16x32_bf16 v[154:157], a[244:247], v[220:223], v[154:157]
v_mfma_f32_16x16x32_bf16 v[158:161], v[232:235], v[110:113], 0
v_mfma_f32_16x16x32_bf16 v[158:161], v[236:239], v[220:223], v[158:161]
v_mfma_f32_16x16x32_bf16 v[162:165], v[110:113], a[72:75], 0
v_mfma_f32_16x16x32_bf16 v[162:165], v[220:223], a[76:79], v[162:165]
v_mfma_f32_16x16x32_bf16 v[166:169], v[110:113], a[96:99], 0
v_mfma_f32_16x16x32_bf16 v[166:169], v[220:223], a[100:103], v[166:169]
v_mfma_f32_16x16x32_bf16 v[170:173], v[110:113], a[120:123], 0
v_mfma_f32_16x16x32_bf16 v[170:173], v[220:223], a[124:127], v[170:173]
ds_read_b128 v[102:105], v210 offset:18432
ds_read_b128 v[106:109], v210 offset:19456
s_waitcnt lgkmcnt(1)
v_add_f32 v102, v102, v103
s_waitcnt lgkmcnt(0)
v_add_f32 v106, v106, v107
v_add_f32 v104, v104, v105
v_add_f32 v108, v108, v109
v_add_f32 v102, v102, v104
v_add_f32 v106, v106, v108
v_mul_f32 v103, s48, v102
v_mul_f32 v104, s73, v102
v_mul_f32 v106, s73, v106
v_fma_f32 v106, -v103, v104, v106
v_max_f32 v106, 0, v106
v_add_f32 v106, s49, v106
v_rsq_f32 v102, v106
s_nop 0
v_mul_f32_e64 v103, -v103, v102
ds_write_b64 v211, v[102:103] offset:20480
ds_read_b64 v[118:119], v219 offset:20480
s_waitcnt lgkmcnt(0)
v_fma_f32 v220, v48, v118, v119
v_fma_f32 v221, v49, v118, v119
v_cvt_pk_bf16_f32 v90, v220, v221
v_fma_f32 v222, v50, v118, v119
v_fma_f32 v223, v51, v118, v119
v_cvt_pk_bf16_f32 v91, v222, v223
v_fma_f32 v220, v52, v118, v119
v_fma_f32 v221, v53, v118, v119
v_cvt_pk_bf16_f32 v92, v220, v221
v_fma_f32 v222, v54, v118, v119
v_fma_f32 v223, v55, v118, v119
v_cvt_pk_bf16_f32 v93, v222, v223
ds_write_b128 v211, v[90:93] offset:20480
v_fma_f32 v220, v56, v118, v119
v_fma_f32 v221, v57, v118, v119
v_cvt_pk_bf16_f32 v94, v220, v221
v_fma_f32 v222, v58, v118, v119
v_fma_f32 v223, v59, v118, v119
v_cvt_pk_bf16_f32 v95, v222, v223
ds_write_b64 v212, v[94:95] offset:20480
s_mov_b64 exec, s[56:57]
ds_read_b128 v[48:51], v64 offset:12544
s_mov_b64 exec, -1
s_mov_b64 exec, s[56:57]
ds_read_b128 v[52:55], v64 offset:12608
s_mov_b64 exec, -1
s_mov_b64 exec, s[56:57]
ds_read_b128 v[56:59], v64 offset:12672
s_mov_b64 exec, -1
s_waitcnt lgkmcnt(3)
s_barrier
ds_read_b128 v[182:185], v210 offset:8192
ds_read_b128 v[186:189], v210 offset:9216
s_waitcnt lgkmcnt(1)
v_mfma_f32_16x16x32_bf16 v[138:141], a[8:11], v[182:185], v[138:141]
s_waitcnt lgkmcnt(0)
v_mfma_f32_16x16x32_bf16 v[138:141], a[12:15], v[186:189], v[138:141]
v_mfma_f32_16x16x32_bf16 v[142:145], a[32:35], v[182:185], v[142:145]
v_mfma_f32_16x16x32_bf16 v[142:145], a[36:39], v[186:189], v[142:145]
v_mfma_f32_16x16x32_bf16 v[146:149], a[56:59], v[182:185], v[146:149]
v_mfma_f32_16x16x32_bf16 v[146:149], a[60:63], v[186:189], v[146:149]
v_mfma_f32_16x16x32_bf16 v[150:153], a[224:227], v[182:185], v[150:153]
v_mfma_f32_16x16x32_bf16 v[150:153], a[228:231], v[186:189], v[150:153]
v_mfma_f32_16x16x32_bf16 v[154:157], a[248:251], v[182:185], v[154:157]
v_mfma_f32_16x16x32_bf16 v[154:157], a[252:255], v[186:189], v[154:157]
v_mfma_f32_16x16x32_bf16 v[158:161], v[240:243], v[182:185], v[158:161]
v_mfma_f32_16x16x32_bf16 v[158:161], v[244:247], v[186:189], v[158:161]
v_mfma_f32_16x16x32_bf16 v[162:165], v[182:185], a[80:83], v[162:165]
v_mfma_f32_16x16x32_bf16 v[162:165], v[186:189], a[84:87], v[162:165]
v_mfma_f32_16x16x32_bf16 v[166:169], v[182:185], a[104:107], v[166:169]
v_mfma_f32_16x16x32_bf16 v[166:169], v[186:189], a[108:111], v[166:169]
v_mfma_f32_16x16x32_bf16 v[170:173], v[182:185], a[128:131], v[170:173]
v_mfma_f32_16x16x32_bf16 v[170:173], v[186:189], a[132:135], v[170:173]
ds_read_b128 v[110:113], v210 offset:10240
ds_read_b128 v[106:109], v210 offset:11264
s_waitcnt lgkmcnt(1)
v_mfma_f32_16x16x32_bf16 v[138:141], a[16:19], v[110:113], v[138:141]
s_waitcnt lgkmcnt(0)
v_mfma_f32_16x16x32_bf16 v[138:141], a[20:23], v[106:109], v[138:141]
v_mfma_f32_16x16x32_bf16 v[142:145], a[40:43], v[110:113], v[142:145]
v_mfma_f32_16x16x32_bf16 v[142:145], a[44:47], v[106:109], v[142:145]
v_mfma_f32_16x16x32_bf16 v[146:149], a[64:67], v[110:113], v[146:149]
v_mfma_f32_16x16x32_bf16 v[146:149], a[68:71], v[106:109], v[146:149]
v_mfma_f32_16x16x32_bf16 v[150:153], a[232:235], v[110:113], v[150:153]
v_mfma_f32_16x16x32_bf16 v[150:153], a[236:239], v[106:109], v[150:153]
v_mfma_f32_16x16x32_bf16 v[154:157], v[224:227], v[110:113], v[154:157]
v_mfma_f32_16x16x32_bf16 v[154:157], v[228:231], v[106:109], v[154:157]
v_mfma_f32_16x16x32_bf16 v[158:161], v[248:251], v[110:113], v[158:161]
v_mfma_f32_16x16x32_bf16 v[158:161], v[252:255], v[106:109], v[158:161]
v_mfma_f32_16x16x32_bf16 v[162:165], v[110:113], a[88:91], v[162:165]
v_mfma_f32_16x16x32_bf16 v[162:165], v[106:109], a[92:95], v[162:165]
v_mfma_f32_16x16x32_bf16 v[166:169], v[110:113], a[112:115], v[166:169]
v_mfma_f32_16x16x32_bf16 v[166:169], v[106:109], a[116:119], v[166:169]
v_mfma_f32_16x16x32_bf16 v[170:173], v[110:113], a[136:139], v[170:173]
v_mfma_f32_16x16x32_bf16 v[170:173], v[106:109], a[140:143], v[170:173]
v_cvt_pk_bf16_f32 v96, v138, v139
v_cvt_pk_bf16_f32 v97, v140, v141
v_cvt_pk_bf16_f32 v98, v142, v143
v_cvt_pk_bf16_f32 v99, v144, v145
v_cvt_pk_bf16_f32 v100, v146, v147
v_cvt_pk_bf16_f32 v101, v148, v149
v_cvt_pk_bf16_f32 v84, v150, v151
v_cvt_pk_bf16_f32 v85, v152, v153
v_cvt_pk_bf16_f32 v86, v154, v155
v_cvt_pk_bf16_f32 v87, v156, v157
v_cvt_pk_bf16_f32 v88, v158, v159
v_cvt_pk_bf16_f32 v89, v160, v161
v_cvt_pk_bf16_f32 v116, v162, v163
v_cvt_pk_bf16_f32 v117, v164, v165
v_cvt_pk_bf16_f32 v124, v166, v167
v_cvt_pk_bf16_f32 v125, v168, v169
v_cvt_pk_bf16_f32 v132, v170, v171
v_cvt_pk_bf16_f32 v133, v172, v173
ds_read_b128 v[182:185], v210 offset:20480
s_waitcnt lgkmcnt(0)
v_mfma_f32_16x16x32_bf16 v[138:141], a[216:219], v[182:185], 0
v_mfma_f32_16x16x32_bf16 v[142:145], a[240:243], v[182:185], 0
v_mfma_f32_16x16x32_bf16 v[146:149], v[232:235], v[182:185], 0
v_mfma_f32_16x16x32_bf16 v[150:153], a[0:3], v[182:185], 0
v_mfma_f32_16x16x32_bf16 v[154:157], a[24:27], v[182:185], 0
v_mfma_f32_16x16x32_bf16 v[158:161], a[48:51], v[182:185], 0
v_mfma_f32_16x16x32_bf16 v[162:165], a[72:75], v[182:185], 0
v_mfma_f32_16x16x32_bf16 v[166:169], a[96:99], v[182:185], 0
v_mfma_f32_16x16x32_bf16 v[170:173], a[120:123], v[182:185], 0
ds_read_b128 v[186:189], v210 offset:21504
s_waitcnt lgkmcnt(0)
v_mfma_f32_16x16x32_bf16 v[138:141], a[220:223], v[186:189], v[138:141]
v_mfma_f32_16x16x32_bf16 v[142:145], a[244:247], v[186:189], v[142:145]
v_mfma_f32_16x16x32_bf16 v[146:149], v[236:239], v[186:189], v[146:149]
v_mfma_f32_16x16x32_bf16 v[150:153], a[4:7], v[186:189], v[150:153]
v_mfma_f32_16x16x32_bf16 v[154:157], a[28:31], v[186:189], v[154:157]
v_mfma_f32_16x16x32_bf16 v[158:161], a[52:55], v[186:189], v[158:161]
v_mfma_f32_16x16x32_bf16 v[162:165], a[76:79], v[186:189], v[162:165]
v_mfma_f32_16x16x32_bf16 v[166:169], a[100:103], v[186:189], v[166:169]
v_mfma_f32_16x16x32_bf16 v[170:173], a[124:127], v[186:189], v[170:173]
ds_read_b128 v[182:185], v210 offset:22528
s_waitcnt lgkmcnt(0)
v_mfma_f32_16x16x32_bf16 v[138:141], a[224:227], v[182:185], v[138:141]
v_mfma_f32_16x16x32_bf16 v[142:145], a[248:251], v[182:185], v[142:145]
v_mfma_f32_16x16x32_bf16 v[146:149], v[240:243], v[182:185], v[146:149]
v_mfma_f32_16x16x32_bf16 v[150:153], a[8:11], v[182:185], v[150:153]
v_mfma_f32_16x16x32_bf16 v[154:157], a[32:35], v[182:185], v[154:157]
v_mfma_f32_16x16x32_bf16 v[158:161], a[56:59], v[182:185], v[158:161]
v_mfma_f32_16x16x32_bf16 v[162:165], a[80:83], v[182:185], v[162:165]
v_mfma_f32_16x16x32_bf16 v[166:169], a[104:107], v[182:185], v[166:169]
v_mfma_f32_16x16x32_bf16 v[170:173], a[128:131], v[182:185], v[170:173]
ds_read_b128 v[186:189], v210 offset:23552
s_waitcnt lgkmcnt(0)
v_mfma_f32_16x16x32_bf16 v[138:141], a[228:231], v[186:189], v[138:141]
v_mfma_f32_16x16x32_bf16 v[142:145], a[252:255], v[186:189], v[142:145]
v_mfma_f32_16x16x32_bf16 v[146:149], v[244:247], v[186:189], v[146:149]
v_mfma_f32_16x16x32_bf16 v[150:153], a[12:15], v[186:189], v[150:153]
v_mfma_f32_16x16x32_bf16 v[154:157], a[36:39], v[186:189], v[154:157]
v_mfma_f32_16x16x32_bf16 v[158:161], a[60:63], v[186:189], v[158:161]
v_mfma_f32_16x16x32_bf16 v[162:165], a[84:87], v[186:189], v[162:165]
v_mfma_f32_16x16x32_bf16 v[166:169], a[108:111], v[186:189], v[166:169]
v_mfma_f32_16x16x32_bf16 v[170:173], a[132:135], v[186:189], v[170:173]
ds_read_b128 v[182:185], v210 offset:24576
s_waitcnt lgkmcnt(0)
v_mfma_f32_16x16x32_bf16 v[138:141], a[232:235], v[182:185], v[138:141]
v_mfma_f32_16x16x32_bf16 v[142:145], v[224:227], v[182:185], v[142:145]
v_mfma_f32_16x16x32_bf16 v[146:149], v[248:251], v[182:185], v[146:149]
v_mfma_f32_16x16x32_bf16 v[150:153], a[16:19], v[182:185], v[150:153]
v_mfma_f32_16x16x32_bf16 v[154:157], a[40:43], v[182:185], v[154:157]
v_mfma_f32_16x16x32_bf16 v[158:161], a[64:67], v[182:185], v[158:161]
v_mfma_f32_16x16x32_bf16 v[162:165], a[88:91], v[182:185], v[162:165]
v_mfma_f32_16x16x32_bf16 v[166:169], a[112:115], v[182:185], v[166:169]
v_mfma_f32_16x16x32_bf16 v[170:173], a[136:139], v[182:185], v[170:173]
ds_read_b128 v[186:189], v210 offset:25600
s_waitcnt lgkmcnt(0)
v_mfma_f32_16x16x32_bf16 v[138:141], a[236:239], v[186:189], v[138:141]
v_mfma_f32_16x16x32_bf16 v[142:145], v[228:231], v[186:189], v[142:145]
v_mfma_f32_16x16x32_bf16 v[146:149], v[252:255], v[186:189], v[146:149]
v_mfma_f32_16x16x32_bf16 v[150:153], a[20:23], v[186:189], v[150:153]
v_mfma_f32_16x16x32_bf16 v[154:157], a[44:47], v[186:189], v[154:157]
v_mfma_f32_16x16x32_bf16 v[158:161], a[68:71], v[186:189], v[158:161]
v_mfma_f32_16x16x32_bf16 v[162:165], a[92:95], v[186:189], v[162:165]
v_mfma_f32_16x16x32_bf16 v[166:169], a[116:119], v[186:189], v[166:169]
v_mfma_f32_16x16x32_bf16 v[170:173], a[140:143], v[186:189], v[170:173]
s_mov_b32 s30, 65537
s_mov_b32 s31, 65537
v_cvt_pk_bf16_f32 v90, v138, v139
v_cvt_pk_bf16_f32 v91, v140, v141
v_cvt_pk_bf16_f32 v92, v142, v143
v_cvt_pk_bf16_f32 v93, v144, v145
v_cvt_pk_bf16_f32 v94, v146, v147
v_cvt_pk_bf16_f32 v95, v148, v149
s_mov_b64 exec, s[30:31]
ds_write_b128 v215, v[90:93]
s_mov_b64 exec, -1
s_mov_b64 exec, s[30:31]
ds_write_b64 v215, v[94:95] offset:16
s_mov_b64 exec, -1
v_cvt_pk_bf16_f32 v102, v150, v151
v_cvt_pk_bf16_f32 v103, v152, v153
v_cvt_pk_bf16_f32 v104, v154, v155
v_cvt_pk_bf16_f32 v105, v156, v157
v_cvt_pk_bf16_f32 v106, v158, v159
v_cvt_pk_bf16_f32 v107, v160, v161
s_mov_b64 exec, s[30:31]
ds_write_b128 v215, v[102:105] offset:512
s_mov_b64 exec, -1
s_mov_b64 exec, s[30:31]
ds_write_b64 v215, v[106:107] offset:528
s_mov_b64 exec, -1
v_cvt_pk_bf16_f32 v108, v162, v163
v_cvt_pk_bf16_f32 v109, v164, v165
v_cvt_pk_bf16_f32 v110, v166, v167
v_cvt_pk_bf16_f32 v111, v168, v169
v_cvt_pk_bf16_f32 v112, v170, v171
v_cvt_pk_bf16_f32 v113, v172, v173
s_mov_b64 exec, s[30:31]
ds_write_b128 v215, v[108:111] offset:1024
s_mov_b64 exec, -1
s_mov_b64 exec, s[30:31]
ds_write_b64 v215, v[112:113] offset:1040
s_mov_b64 exec, -1
ds_read_b128 v[182:185], v210 offset:12288
ds_read_b128 v[186:189], v210 offset:13312
s_waitcnt lgkmcnt(1)
v_mfma_f32_16x16x32_bf16 v[138:141], a[0:3], v[182:185], 0
s_waitcnt lgkmcnt(0)
v_mfma_f32_16x16x32_bf16 v[138:141], a[4:7], v[186:189], v[138:141]
v_mfma_f32_16x16x32_bf16 v[142:145], a[24:27], v[182:185], 0
v_mfma_f32_16x16x32_bf16 v[142:145], a[28:31], v[186:189], v[142:145]
v_mfma_f32_16x16x32_bf16 v[146:149], a[48:51], v[182:185], 0
v_mfma_f32_16x16x32_bf16 v[146:149], a[52:55], v[186:189], v[146:149]
ds_read_b128 v[170:173], v210 offset:14336
ds_read_b128 v[182:185], v210 offset:15360
s_waitcnt lgkmcnt(1)
v_mfma_f32_16x16x32_bf16 v[138:141], a[8:11], v[170:173], v[138:141]
s_waitcnt lgkmcnt(0)
v_mfma_f32_16x16x32_bf16 v[138:141], a[12:15], v[182:185], v[138:141]
v_mfma_f32_16x16x32_bf16 v[142:145], a[32:35], v[170:173], v[142:145]
v_mfma_f32_16x16x32_bf16 v[142:145], a[36:39], v[182:185], v[142:145]
v_mfma_f32_16x16x32_bf16 v[146:149], a[56:59], v[170:173], v[146:149]
v_mfma_f32_16x16x32_bf16 v[146:149], a[60:63], v[182:185], v[146:149]
ds_read_b128 v[186:189], v210 offset:16384
ds_read_b128 v[170:173], v210 offset:17408
s_waitcnt lgkmcnt(1)
v_mfma_f32_16x16x32_bf16 v[138:141], a[16:19], v[186:189], v[138:141]
s_waitcnt lgkmcnt(0)
v_mfma_f32_16x16x32_bf16 v[138:141], a[20:23], v[170:173], v[138:141]
v_mfma_f32_16x16x32_bf16 v[142:145], a[40:43], v[186:189], v[142:145]
v_mfma_f32_16x16x32_bf16 v[142:145], a[44:47], v[170:173], v[142:145]
v_mfma_f32_16x16x32_bf16 v[146:149], a[64:67], v[186:189], v[146:149]
v_mfma_f32_16x16x32_bf16 v[146:149], a[68:71], v[170:173], v[146:149]
v_cvt_pk_bf16_f32 v102, v138, v139
v_cvt_pk_bf16_f32 v103, v140, v141
v_cvt_pk_bf16_f32 v104, v142, v143
v_cvt_pk_bf16_f32 v105, v144, v145
s_nop 2
v_cvt_pk_bf16_f32 v106, v146, v147
v_cvt_pk_bf16_f32 v107, v148, v149
ds_read_b128 v[108:111], v215 offset:512
ds_read_b64 v[112:113], v215 offset:528
v_mfma_f32_16x16x16_bf16 v[138:141], v[82:83], v[76:77], 0
v_mfma_f32_16x16x16_bf16 v[142:145], v[100:101], v[76:77], 0
s_waitcnt lgkmcnt(0)
v_mfma_f32_16x16x16_bf16 v[150:153], v[112:113], v[76:77], v[206:209]
v_mfma_f32_16x16x16_bf16 v[146:149], v[106:107], v[76:77], 0
v_mfma_f32_16x16x32_bf16 v[138:141], v[78:81], v[72:75], v[138:141]
v_mfma_f32_16x16x32_bf16 v[142:145], v[96:99], v[72:75], v[142:145]
v_mfma_f32_16x16x32_bf16 v[150:153], v[108:111], v[72:75], v[150:153]
v_mfma_f32_16x16x32_bf16 v[146:149], v[102:105], v[72:75], v[146:149]
ds_read_b128 v[72:75], v215
ds_read_b64 v[76:77], v215 offset:16
v_mfma_f32_16x16x16_bf16 v[154:157], v[82:83], v[88:89], 0
v_mfma_f32_16x16x16_bf16 v[158:161], v[100:101], v[88:89], 0
v_mfma_f32_16x16x16_bf16 v[166:169], v[112:113], v[88:89], v[206:209]
v_mfma_f32_16x16x16_bf16 v[162:165], v[106:107], v[88:89], 0
v_mfma_f32_16x16x32_bf16 v[154:157], v[78:81], v[84:87], v[154:157]
v_mfma_f32_16x16x32_bf16 v[158:161], v[96:99], v[84:87], v[158:161]
v_mfma_f32_16x16x32_bf16 v[166:169], v[108:111], v[84:87], v[166:169]
v_mfma_f32_16x16x32_bf16 v[162:165], v[102:105], v[84:87], v[162:165]
ds_read_b128 v[182:185], v210 offset:12288
ds_read_b128 v[186:189], v210 offset:13312
s_waitcnt lgkmcnt(1)
v_mfma_f32_16x16x32_bf16 v[118:121], v[182:185], a[72:75], 0
s_waitcnt lgkmcnt(0)
v_mfma_f32_16x16x32_bf16 v[118:121], v[186:189], a[76:79], v[118:121]
v_mfma_f32_16x16x32_bf16 v[126:129], v[182:185], a[96:99], 0
v_mfma_f32_16x16x32_bf16 v[126:129], v[186:189], a[100:103], v[126:129]
v_mfma_f32_16x16x32_bf16 v[134:137], v[182:185], a[120:123], 0
v_mfma_f32_16x16x32_bf16 v[134:137], v[186:189], a[124:127], v[134:137]
v_mfma_f32_16x16x32_bf16 v[90:93], a[216:219], v[182:185], 0
v_mfma_f32_16x16x32_bf16 v[90:93], a[220:223], v[186:189], v[90:93]
v_mfma_f32_16x16x32_bf16 v[170:173], a[240:243], v[182:185], 0
v_mfma_f32_16x16x32_bf16 v[170:173], a[244:247], v[186:189], v[170:173]
v_mfma_f32_16x16x32_bf16 v[220:223], v[232:235], v[182:185], 0
v_mfma_f32_16x16x32_bf16 v[220:223], v[236:239], v[186:189], v[220:223]
ds_read_b128 v[174:177], v210 offset:14336
ds_read_b128 v[178:181], v210 offset:15360
s_waitcnt lgkmcnt(1)
v_mfma_f32_16x16x32_bf16 v[118:121], v[174:177], a[80:83], v[118:121]
s_waitcnt lgkmcnt(0)
v_mfma_f32_16x16x32_bf16 v[118:121], v[178:181], a[84:87], v[118:121]
v_mfma_f32_16x16x32_bf16 v[126:129], v[174:177], a[104:107], v[126:129]
v_mfma_f32_16x16x32_bf16 v[126:129], v[178:181], a[108:111], v[126:129]
v_mfma_f32_16x16x32_bf16 v[134:137], v[174:177], a[128:131], v[134:137]
v_mfma_f32_16x16x32_bf16 v[134:137], v[178:181], a[132:135], v[134:137]
v_mfma_f32_16x16x32_bf16 v[90:93], a[224:227], v[174:177], v[90:93]
v_mfma_f32_16x16x32_bf16 v[90:93], a[228:231], v[178:181], v[90:93]
v_mfma_f32_16x16x32_bf16 v[170:173], a[248:251], v[174:177], v[170:173]
v_mfma_f32_16x16x32_bf16 v[170:173], a[252:255], v[178:181], v[170:173]
v_mfma_f32_16x16x32_bf16 v[220:223], v[240:243], v[174:177], v[220:223]
v_mfma_f32_16x16x32_bf16 v[220:223], v[244:247], v[178:181], v[220:223]
ds_read_b128 v[182:185], v210 offset:16384
ds_read_b128 v[186:189], v210 offset:17408
s_waitcnt lgkmcnt(1)
v_mfma_f32_16x16x32_bf16 v[118:121], v[182:185], a[88:91], v[118:121]
s_waitcnt lgkmcnt(0)
v_mfma_f32_16x16x32_bf16 v[118:121], v[186:189], a[92:95], v[118:121]
v_mfma_f32_16x16x32_bf16 v[126:129], v[182:185], a[112:115], v[126:129]
v_mfma_f32_16x16x32_bf16 v[126:129], v[186:189], a[116:119], v[126:129]
v_mfma_f32_16x16x32_bf16 v[134:137], v[182:185], a[136:139], v[134:137]
v_mfma_f32_16x16x32_bf16 v[134:137], v[186:189], a[140:143], v[134:137]
v_mfma_f32_16x16x32_bf16 v[90:93], a[232:235], v[182:185], v[90:93]
v_mfma_f32_16x16x32_bf16 v[90:93], a[236:239], v[186:189], v[90:93]
v_mfma_f32_16x16x32_bf16 v[170:173], v[224:227], v[182:185], v[170:173]
v_mfma_f32_16x16x32_bf16 v[170:173], v[228:231], v[186:189], v[170:173]
v_mfma_f32_16x16x32_bf16 v[220:223], v[248:251], v[182:185], v[220:223]
v_mfma_f32_16x16x32_bf16 v[220:223], v[252:255], v[186:189], v[220:223]
v_mov_b32 v181, 0
v_cvt_pk_bf16_f32 v118, v118, v119
v_cvt_pk_bf16_f32 v119, v120, v121
ds_read_u16 v120, v214 offset:1024
v_mov_b32 v121, 0
v_cvt_pk_bf16_f32 v126, v126, v127
v_cvt_pk_bf16_f32 v127, v128, v129
ds_read_u16 v128, v214 offset:1032
v_mov_b32 v129, 0
v_cvt_pk_bf16_f32 v134, v134, v135
v_cvt_pk_bf16_f32 v135, v136, v137
ds_read_u16 v136, v214 offset:1040
v_mov_b32 v137, 0
v_cvt_pk_bf16_f32 v90, v90, v91
v_cvt_pk_bf16_f32 v91, v92, v93
v_cvt_pk_bf16_f32 v92, v170, v171
v_cvt_pk_bf16_f32 v93, v172, v173
v_cvt_pk_bf16_f32 v94, v220, v221
v_cvt_pk_bf16_f32 v95, v222, v223
v_max3_f32 v151, v138, v139, v140
v_max3_f32 v151, v151, v141, v142
v_max3_f32 v151, v151, v143, v144
v_max3_f32 v151, v151, v145, v146
v_max3_f32 v151, v151, v147, v148
v_max3_f32 v151, v151, v149, v150
v_mov_b32 v152, v151
s_nop 1
v_permlane16_swap_b32 v151, v152
v_max_f32 v151, v151, v152
v_mov_b32 v152, v151
s_nop 1
v_permlane32_swap_b32 v151, v152
v_max_f32 v151, v151, v152
v_sub_f32 v138, v138, v151
v_sub_f32 v139, v139, v151
v_sub_f32 v140, v140, v151
v_sub_f32 v141, v141, v151
v_sub_f32 v142, v142, v151
v_sub_f32 v143, v143, v151
v_sub_f32 v144, v144, v151
v_sub_f32 v145, v145, v151
v_sub_f32 v150, v150, v151
v_sub_f32 v146, v146, v151
v_sub_f32 v147, v147, v151
v_sub_f32 v148, v148, v151
v_sub_f32 v149, v149, v151
v_exp_f32 v138, v138
v_exp_f32 v139, v139
v_exp_f32 v140, v140
v_exp_f32 v141, v141
v_exp_f32 v142, v142
v_exp_f32 v143, v143
v_exp_f32 v144, v144
v_exp_f32 v145, v145
v_exp_f32 v150, v150
v_exp_f32 v146, v146
v_exp_f32 v147, v147
v_exp_f32 v148, v148
v_exp_f32 v149, v149
v_cvt_pk_bf16_f32 v174, v138, v139
v_cvt_pk_bf16_f32 v175, v140, v141
v_cvt_pk_bf16_f32 v176, v142, v143
v_cvt_pk_bf16_f32 v177, v144, v145
v_cvt_pk_bf16_f32 v178, v146, v147
v_cvt_pk_bf16_f32 v179, v148, v149
v_cvt_pk_bf16_f32 v180, v150, 0
v_mfma_f32_16x16x32_bf16 v[150:153], v[190:193], v[174:177], 0
v_mfma_f32_16x16x32_bf16 v[150:153], v[190:193], v[178:181], v[150:153]
v_mfma_f32_16x16x32_bf16 v[138:141], v[114:117], v[174:177], 0
s_waitcnt lgkmcnt(2)
v_mfma_f32_16x16x32_bf16 v[138:141], v[118:121], v[178:181], v[138:141]
v_mfma_f32_16x16x32_bf16 v[142:145], v[122:125], v[174:177], 0
s_waitcnt lgkmcnt(1)
v_mfma_f32_16x16x32_bf16 v[142:145], v[126:129], v[178:181], v[142:145]
v_mfma_f32_16x16x32_bf16 v[146:149], v[130:133], v[174:177], 0
s_waitcnt lgkmcnt(0)
v_mfma_f32_16x16x32_bf16 v[146:149], v[134:137], v[178:181], v[146:149]
v_max3_f32 v167, v154, v155, v156
v_max3_f32 v167, v167, v157, v158
v_max3_f32 v167, v167, v159, v160
v_max3_f32 v167, v167, v161, v162
v_max3_f32 v167, v167, v163, v164
v_max3_f32 v167, v167, v165, v166
v_mov_b32 v168, v167
s_nop 1
v_permlane16_swap_b32 v167, v168
v_max_f32 v167, v167, v168
v_mov_b32 v168, v167
s_nop 1
v_permlane32_swap_b32 v167, v168
v_max_f32 v167, v167, v168
v_sub_f32 v154, v154, v167
v_sub_f32 v155, v155, v167
v_sub_f32 v156, v156, v167
v_sub_f32 v157, v157, v167
v_sub_f32 v158, v158, v167
v_sub_f32 v159, v159, v167
v_sub_f32 v160, v160, v167
v_sub_f32 v161, v161, v167
v_sub_f32 v166, v166, v167
v_sub_f32 v162, v162, v167
v_sub_f32 v163, v163, v167
v_sub_f32 v164, v164, v167
v_sub_f32 v165, v165, v167
v_exp_f32 v154, v154
v_exp_f32 v155, v155
v_exp_f32 v156, v156
v_exp_f32 v157, v157
v_exp_f32 v158, v158
v_exp_f32 v159, v159
v_exp_f32 v160, v160
v_exp_f32 v161, v161
v_exp_f32 v166, v166
v_exp_f32 v162, v162
v_exp_f32 v163, v163
v_exp_f32 v164, v164
v_exp_f32 v165, v165
v_cvt_pk_bf16_f32 v174, v154, v155
v_cvt_pk_bf16_f32 v175, v156, v157
v_cvt_pk_bf16_f32 v176, v158, v159
v_cvt_pk_bf16_f32 v177, v160, v161
v_cvt_pk_bf16_f32 v178, v162, v163
v_cvt_pk_bf16_f32 v179, v164, v165
v_cvt_pk_bf16_f32 v180, v166, 0
v_mfma_f32_16x16x32_bf16 v[166:169], v[190:193], v[174:177], 0
v_mfma_f32_16x16x32_bf16 v[166:169], v[190:193], v[178:181], v[166:169]
v_mfma_f32_16x16x32_bf16 v[154:157], v[114:117], v[174:177], 0
v_mfma_f32_16x16x32_bf16 v[154:157], v[118:121], v[178:181], v[154:157]
v_mfma_f32_16x16x32_bf16 v[158:161], v[122:125], v[174:177], 0
v_mfma_f32_16x16x32_bf16 v[158:161], v[126:129], v[178:181], v[158:161]
v_mfma_f32_16x16x32_bf16 v[162:165], v[130:133], v[174:177], 0
v_mfma_f32_16x16x32_bf16 v[162:165], v[134:137], v[178:181], v[162:165]
v_rcp_f32 v151, v150
s_nop 0
v_mul_f32 v151, s3, v151
v_mul_f32 v138, v138, v151
v_mul_f32 v139, v139, v151
v_cvt_pk_bf16_f32 v138, v138, v139
v_mul_f32 v140, v140, v151
v_mul_f32 v141, v141, v151
v_cvt_pk_bf16_f32 v139, v140, v141
v_mul_f32 v142, v142, v151
v_mul_f32 v143, v143, v151
v_cvt_pk_bf16_f32 v140, v142, v143
v_mul_f32 v144, v144, v151
v_mul_f32 v145, v145, v151
v_cvt_pk_bf16_f32 v141, v144, v145
ds_write_b128 v211, v[138:141] offset:38912
v_mul_f32 v146, v146, v151
v_mul_f32 v147, v147, v151
v_cvt_pk_bf16_f32 v142, v146, v147
v_mul_f32 v148, v148, v151
v_mul_f32 v149, v149, v151
v_cvt_pk_bf16_f32 v143, v148, v149
ds_write_b64 v212, v[142:143] offset:38912
v_mfma_f32_16x16x16_bf16 v[138:141], v[82:83], v[94:95], 0
v_mfma_f32_16x16x16_bf16 v[142:145], v[100:101], v[94:95], 0
v_mfma_f32_16x16x16_bf16 v[150:153], v[112:113], v[94:95], v[206:209]
v_mfma_f32_16x16x16_bf16 v[146:149], v[106:107], v[94:95], 0
v_mfma_f32_16x16x32_bf16 v[138:141], v[78:81], v[90:93], v[138:141]
v_mfma_f32_16x16x32_bf16 v[142:145], v[96:99], v[90:93], v[142:145]
v_mfma_f32_16x16x32_bf16 v[150:153], v[108:111], v[90:93], v[150:153]
v_mfma_f32_16x16x32_bf16 v[146:149], v[102:105], v[90:93], v[146:149]
v_rcp_f32 v167, v166
s_nop 0
v_mul_f32 v167, s3, v167
v_mul_f32 v154, v154, v167
v_mul_f32 v155, v155, v167
v_cvt_pk_bf16_f32 v154, v154, v155
v_mul_f32 v156, v156, v167
v_mul_f32 v157, v157, v167
v_cvt_pk_bf16_f32 v155, v156, v157
v_mul_f32 v158, v158, v167
v_mul_f32 v159, v159, v167
v_cvt_pk_bf16_f32 v156, v158, v159
v_mul_f32 v160, v160, v167
v_mul_f32 v161, v161, v167
v_cvt_pk_bf16_f32 v157, v160, v161
ds_write_b128 v211, v[154:157] offset:45056
v_mul_f32 v162, v162, v167
v_mul_f32 v163, v163, v167
v_cvt_pk_bf16_f32 v158, v162, v163
v_mul_f32 v164, v164, v167
v_mul_f32 v165, v165, v167
v_cvt_pk_bf16_f32 v159, v164, v165
ds_write_b64 v212, v[158:159] offset:45056
v_mfma_f32_16x16x16_bf16 v[154:157], v[76:77], v[82:83], 0
v_mfma_f32_16x16x16_bf16 v[158:161], v[76:77], v[100:101], 0
v_mfma_f32_16x16x16_bf16 v[162:165], v[76:77], v[106:107], 0
v_mfma_f32_16x16x16_bf16 v[166:169], v[76:77], v[112:113], v[206:209]
v_mfma_f32_16x16x32_bf16 v[154:157], v[72:75], v[78:81], v[154:157]
v_mfma_f32_16x16x32_bf16 v[158:161], v[72:75], v[96:99], v[158:161]
v_mfma_f32_16x16x32_bf16 v[162:165], v[72:75], v[102:105], v[162:165]
v_mfma_f32_16x16x32_bf16 v[166:169], v[72:75], v[108:111], v[166:169]
v_mov_b32_dpp v154, v158 quad_perm:[0,1,2,3] row_mask:0x2 bank_mask:0xf
s_nop 1
v_mov_b32_dpp v154, v162 quad_perm:[0,1,2,3] row_mask:0x4 bank_mask:0xf
s_nop 2
v_mov_b32_dpp v154, v167 quad_perm:[0,1,2,3] row_mask:0x8 bank_mask:0xf
v_mov_b32 v155, v154
s_nop 1
v_max_f32_dpp v155, v155, v155 row_ror:8 row_mask:0xf bank_mask:0xf
s_nop 1
v_max_f32_dpp v155, v155, v155 row_ror:4 row_mask:0xf bank_mask:0xf
s_nop 1
v_max_f32_dpp v155, v155, v155 row_ror:2 row_mask:0xf bank_mask:0xf
s_nop 1
v_max_f32_dpp v155, v155, v155 row_ror:1 row_mask:0xf bank_mask:0xf
v_mov_b32 v156, v155
s_nop 1
v_permlane16_swap_b32 v155, v156
v_max_f32 v155, v155, v156
v_mov_b32 v156, v155
s_nop 1
v_permlane32_swap_b32 v155, v156
v_max_f32 v155, v155, v156
v_sub_f32 v154, v154, v155
v_exp_f32 v154, v154
s_nop 0
v_cvt_pk_bf16_f32 v154, v154, 0
ds_write_b16 v214, v154
s_waitcnt lgkmcnt(1)
ds_read_b128 v[84:87], v215
ds_read_b128 v[88:91], v215 offset:16
v_add_u32 v215, 1552, v215
s_barrier
ds_read_b128 v[220:223], v210 offset:38912
ds_read_b128 v[110:113], v210 offset:39936
s_waitcnt lgkmcnt(1)
v_mfma_f32_16x16x32_bf16 v[0:3], a[144:147], v[220:223], v[0:3]
s_waitcnt lgkmcnt(0)
v_mfma_f32_16x16x32_bf16 v[0:3], a[148:151], v[110:113], v[0:3]
v_mfma_f32_16x16x32_bf16 v[4:7], a[168:171], v[220:223], v[4:7]
v_mfma_f32_16x16x32_bf16 v[4:7], a[172:175], v[110:113], v[4:7]
v_mfma_f32_16x16x32_bf16 v[8:11], a[192:195], v[220:223], v[8:11]
v_mfma_f32_16x16x32_bf16 v[8:11], a[196:199], v[110:113], v[8:11]
ds_read_b128 v[170:173], v210 offset:40960
ds_read_b128 v[182:185], v210 offset:41984
s_waitcnt lgkmcnt(1)
v_mfma_f32_16x16x32_bf16 v[0:3], a[152:155], v[170:173], v[0:3]
s_waitcnt lgkmcnt(0)
v_mfma_f32_16x16x32_bf16 v[0:3], a[156:159], v[182:185], v[0:3]
v_mfma_f32_16x16x32_bf16 v[4:7], a[176:179], v[170:173], v[4:7]
v_mfma_f32_16x16x32_bf16 v[4:7], a[180:183], v[182:185], v[4:7]
v_mfma_f32_16x16x32_bf16 v[8:11], a[200:203], v[170:173], v[8:11]
v_mfma_f32_16x16x32_bf16 v[8:11], a[204:207], v[182:185], v[8:11]
ds_read_b128 v[186:189], v210 offset:43008
ds_read_b128 v[220:223], v210 offset:44032
s_waitcnt lgkmcnt(1)
v_mfma_f32_16x16x32_bf16 v[0:3], a[160:163], v[186:189], v[0:3]
s_waitcnt lgkmcnt(0)
v_mfma_f32_16x16x32_bf16 v[0:3], a[164:167], v[220:223], v[0:3]
v_mfma_f32_16x16x32_bf16 v[4:7], a[184:187], v[186:189], v[4:7]
v_mfma_f32_16x16x32_bf16 v[4:7], a[188:191], v[220:223], v[4:7]
v_mfma_f32_16x16x32_bf16 v[8:11], a[208:211], v[186:189], v[8:11]
v_mfma_f32_16x16x32_bf16 v[8:11], a[212:215], v[220:223], v[8:11]
v_cvt_pk_bf16_f32 v72, v0, v1
v_cvt_pk_bf16_f32 v73, v2, v3
buffer_store_dwordx2 v[72:73], v203, s[8:11], s38 offen
v_cvt_pk_bf16_f32 v74, v4, v5
v_cvt_pk_bf16_f32 v75, v6, v7
buffer_store_dwordx2 v[74:75], v203, s[8:11], s38 offen offset:32
s_nop 0
v_cvt_pk_bf16_f32 v76, v8, v9
v_cvt_pk_bf16_f32 v77, v10, v11
buffer_store_dwordx2 v[76:77], v203, s[8:11], s38 offen offset:64
v_max3_f32 v151, v138, v139, v140
v_max3_f32 v151, v151, v141, v142
v_max3_f32 v151, v151, v143, v144
v_max3_f32 v151, v151, v145, v146
v_max3_f32 v151, v151, v147, v148
v_max3_f32 v151, v151, v149, v150
v_mov_b32 v152, v151
s_nop 1
v_permlane16_swap_b32 v151, v152
v_max_f32 v151, v151, v152
v_mov_b32 v152, v151
s_nop 1
v_permlane32_swap_b32 v151, v152
v_max_f32 v151, v151, v152
v_sub_f32 v138, v138, v151
v_sub_f32 v139, v139, v151
v_sub_f32 v140, v140, v151
v_sub_f32 v141, v141, v151
v_sub_f32 v142, v142, v151
v_sub_f32 v143, v143, v151
v_sub_f32 v144, v144, v151
v_sub_f32 v145, v145, v151
v_sub_f32 v150, v150, v151
v_sub_f32 v146, v146, v151
v_sub_f32 v147, v147, v151
v_sub_f32 v148, v148, v151
v_sub_f32 v149, v149, v151
v_exp_f32 v138, v138
v_exp_f32 v139, v139
v_exp_f32 v140, v140
v_exp_f32 v141, v141
v_exp_f32 v142, v142
v_exp_f32 v143, v143
v_exp_f32 v144, v144
v_exp_f32 v145, v145
v_exp_f32 v150, v150
v_exp_f32 v146, v146
v_exp_f32 v147, v147
v_exp_f32 v148, v148
v_exp_f32 v149, v149
v_cvt_pk_bf16_f32 v174, v138, v139
v_cvt_pk_bf16_f32 v175, v140, v141
v_cvt_pk_bf16_f32 v176, v142, v143
v_cvt_pk_bf16_f32 v177, v144, v145
v_cvt_pk_bf16_f32 v178, v146, v147
v_cvt_pk_bf16_f32 v179, v148, v149
v_cvt_pk_bf16_f32 v180, v150, 0
v_mfma_f32_16x16x32_bf16 v[150:153], v[190:193], v[174:177], 0
v_mfma_f32_16x16x32_bf16 v[150:153], v[190:193], v[178:181], v[150:153]
v_mfma_f32_16x16x32_bf16 v[138:141], v[114:117], v[174:177], 0
v_mfma_f32_16x16x32_bf16 v[138:141], v[118:121], v[178:181], v[138:141]
v_mfma_f32_16x16x32_bf16 v[142:145], v[122:125], v[174:177], 0
v_mfma_f32_16x16x32_bf16 v[142:145], v[126:129], v[178:181], v[142:145]
v_mfma_f32_16x16x32_bf16 v[146:149], v[130:133], v[174:177], 0
v_mfma_f32_16x16x32_bf16 v[146:149], v[134:137], v[178:181], v[146:149]
v_mfma_f32_16x16x32_bf16 v[166:169], v[84:87], v[190:193], 0
v_mfma_f32_16x16x32_bf16 v[166:169], v[88:91], v[190:193], v[166:169]
v_mfma_f32_16x16x32_bf16 v[154:157], v[84:87], v[114:117], 0
v_mfma_f32_16x16x32_bf16 v[154:157], v[88:91], v[118:121], v[154:157]
v_mfma_f32_16x16x32_bf16 v[158:161], v[84:87], v[122:125], 0
v_mfma_f32_16x16x32_bf16 v[158:161], v[88:91], v[126:129], v[158:161]
v_mfma_f32_16x16x32_bf16 v[162:165], v[84:87], v[130:133], 0
v_mfma_f32_16x16x32_bf16 v[162:165], v[88:91], v[134:137], v[162:165]
v_rcp_f32 v167, v166
v_mov_b32_dpp v154, v158 quad_perm:[0,1,2,3] row_mask:0x2 bank_mask:0xf
s_nop 3
v_mov_b32_dpp v154, v162 quad_perm:[0,1,2,3] row_mask:0x4 bank_mask:0xf
v_mul_f32 v167, s3, v167
v_mul_f32 v154, v154, v167
v_cvt_pk_bf16_f32 v154, v154, 0
ds_write_b16 v214, v154
v_add_u32 v214, 1552, v214
ds_read_b128 v[110:113], v210 offset:45056
ds_read_b128 v[170:173], v210 offset:46080
s_waitcnt lgkmcnt(1)
v_mfma_f32_16x16x32_bf16 v[12:15], a[144:147], v[110:113], v[12:15]
s_waitcnt lgkmcnt(0)
v_mfma_f32_16x16x32_bf16 v[12:15], a[148:151], v[170:173], v[12:15]
v_mfma_f32_16x16x32_bf16 v[16:19], a[168:171], v[110:113], v[16:19]
v_mfma_f32_16x16x32_bf16 v[16:19], a[172:175], v[170:173], v[16:19]
v_mfma_f32_16x16x32_bf16 v[20:23], a[192:195], v[110:113], v[20:23]
v_mfma_f32_16x16x32_bf16 v[20:23], a[196:199], v[170:173], v[20:23]
ds_read_b128 v[182:185], v210 offset:47104
ds_read_b128 v[186:189], v210 offset:48128
s_waitcnt lgkmcnt(1)
v_mfma_f32_16x16x32_bf16 v[12:15], a[152:155], v[182:185], v[12:15]
s_waitcnt lgkmcnt(0)
v_mfma_f32_16x16x32_bf16 v[12:15], a[156:159], v[186:189], v[12:15]
v_mfma_f32_16x16x32_bf16 v[16:19], a[176:179], v[182:185], v[16:19]
v_mfma_f32_16x16x32_bf16 v[16:19], a[180:183], v[186:189], v[16:19]
v_mfma_f32_16x16x32_bf16 v[20:23], a[200:203], v[182:185], v[20:23]
v_mfma_f32_16x16x32_bf16 v[20:23], a[204:207], v[186:189], v[20:23]
ds_read_b128 v[220:223], v210 offset:49152
ds_read_b128 v[110:113], v210 offset:50176
s_waitcnt lgkmcnt(1)
v_mfma_f32_16x16x32_bf16 v[12:15], a[160:163], v[220:223], v[12:15]
s_waitcnt lgkmcnt(0)
v_mfma_f32_16x16x32_bf16 v[12:15], a[164:167], v[110:113], v[12:15]
v_mfma_f32_16x16x32_bf16 v[16:19], a[184:187], v[220:223], v[16:19]
v_mfma_f32_16x16x32_bf16 v[16:19], a[188:191], v[110:113], v[16:19]
v_mfma_f32_16x16x32_bf16 v[20:23], a[208:211], v[220:223], v[20:23]
v_mfma_f32_16x16x32_bf16 v[20:23], a[212:215], v[110:113], v[20:23]
v_cvt_pk_bf16_f32 v78, v12, v13
v_cvt_pk_bf16_f32 v79, v14, v15
buffer_store_dwordx2 v[78:79], v204, s[8:11], s38 offen
v_cvt_pk_bf16_f32 v80, v16, v17
v_cvt_pk_bf16_f32 v81, v18, v19
buffer_store_dwordx2 v[80:81], v204, s[8:11], s38 offen offset:32
s_nop 0
v_cvt_pk_bf16_f32 v82, v20, v21
v_cvt_pk_bf16_f32 v83, v22, v23
buffer_store_dwordx2 v[82:83], v204, s[8:11], s38 offen offset:64
v_rcp_f32 v151, v150
s_nop 0
v_mul_f32 v151, s3, v151
v_mul_f32 v138, v138, v151
v_mul_f32 v139, v139, v151
v_cvt_pk_bf16_f32 v138, v138, v139
v_mul_f32 v140, v140, v151
v_mul_f32 v141, v141, v151
v_cvt_pk_bf16_f32 v139, v140, v141
v_mul_f32 v142, v142, v151
v_mul_f32 v143, v143, v151
v_cvt_pk_bf16_f32 v140, v142, v143
v_mul_f32 v144, v144, v151
v_mul_f32 v145, v145, v151
v_cvt_pk_bf16_f32 v141, v144, v145
ds_write_b128 v211, v[138:141] offset:51200
v_mul_f32 v146, v146, v151
v_mul_f32 v147, v147, v151
v_cvt_pk_bf16_f32 v142, v146, v147
v_mul_f32 v148, v148, v151
v_mul_f32 v149, v149, v151
v_cvt_pk_bf16_f32 v143, v148, v149
ds_write_b64 v212, v[142:143] offset:51200
v_cmp_lt_u32 vcc, 1602224128, v218
s_nop 0
s_or_b32 s41, vcc_lo, vcc_hi
v_mov_b32 v69, s41
ds_write_b32 v209, v69
s_waitcnt lgkmcnt(0)
s_barrier
ds_read_b128 v[170:173], v210 offset:51200
ds_read_b128 v[182:185], v210 offset:52224
s_waitcnt lgkmcnt(1)
v_mfma_f32_16x16x32_bf16 v[24:27], a[144:147], v[170:173], v[24:27]
s_waitcnt lgkmcnt(0)
v_mfma_f32_16x16x32_bf16 v[24:27], a[148:151], v[182:185], v[24:27]
v_mfma_f32_16x16x32_bf16 v[28:31], a[168:171], v[170:173], v[28:31]
v_mfma_f32_16x16x32_bf16 v[28:31], a[172:175], v[182:185], v[28:31]
v_mfma_f32_16x16x32_bf16 v[32:35], a[192:195], v[170:173], v[32:35]
v_mfma_f32_16x16x32_bf16 v[32:35], a[196:199], v[182:185], v[32:35]
ds_read_b128 v[186:189], v210 offset:53248
ds_read_b128 v[220:223], v210 offset:54272
s_waitcnt lgkmcnt(1)
v_mfma_f32_16x16x32_bf16 v[24:27], a[152:155], v[186:189], v[24:27]
s_waitcnt lgkmcnt(0)
v_mfma_f32_16x16x32_bf16 v[24:27], a[156:159], v[220:223], v[24:27]
v_mfma_f32_16x16x32_bf16 v[28:31], a[176:179], v[186:189], v[28:31]
v_mfma_f32_16x16x32_bf16 v[28:31], a[180:183], v[220:223], v[28:31]
v_mfma_f32_16x16x32_bf16 v[32:35], a[200:203], v[186:189], v[32:35]
v_mfma_f32_16x16x32_bf16 v[32:35], a[204:207], v[220:223], v[32:35]
ds_read_b128 v[110:113], v210 offset:55296
ds_read_b128 v[170:173], v210 offset:56320
s_waitcnt lgkmcnt(1)
v_mfma_f32_16x16x32_bf16 v[24:27], a[160:163], v[110:113], v[24:27]
s_waitcnt lgkmcnt(0)
v_mfma_f32_16x16x32_bf16 v[24:27], a[164:167], v[170:173], v[24:27]
v_mfma_f32_16x16x32_bf16 v[28:31], a[184:187], v[110:113], v[28:31]
v_mfma_f32_16x16x32_bf16 v[28:31], a[188:191], v[170:173], v[28:31]
v_mfma_f32_16x16x32_bf16 v[32:35], a[208:211], v[110:113], v[32:35]
v_mfma_f32_16x16x32_bf16 v[32:35], a[212:215], v[170:173], v[32:35]
v_cvt_pk_bf16_f32 v116, v24, v25
v_cvt_pk_bf16_f32 v117, v26, v27
buffer_store_dwordx2 v[116:117], v205, s[8:11], s38 offen
v_cvt_pk_bf16_f32 v124, v28, v29
v_cvt_pk_bf16_f32 v125, v30, v31
buffer_store_dwordx2 v[124:125], v205, s[8:11], s38 offen offset:32
s_nop 0
v_cvt_pk_bf16_f32 v132, v32, v33
v_cvt_pk_bf16_f32 v133, v34, v35
buffer_store_dwordx2 v[132:133], v205, s[8:11], s38 offen offset:64
ds_read_b128 v[84:87], v63 offset:24832
ds_read_b128 v[88:91], v63 offset:24960
ds_read_b128 v[92:95], v63 offset:25088
ds_read_b128 v[96:99], v63 offset:25216
ds_read_b64 v[100:101], v63 offset:24848
ds_read_b64 v[102:103], v63 offset:24976
ds_read_b64 v[104:105], v63 offset:25104
ds_read_b64 v[106:107], v63 offset:25232
s_waitcnt lgkmcnt(7)
v_mfma_f32_16x16x32_bf16 v[48:51], a[144:147], v[84:87], v[48:51]
s_waitcnt lgkmcnt(6)
v_mfma_f32_16x16x32_bf16 v[48:51], a[148:151], v[88:91], v[48:51]
s_waitcnt lgkmcnt(5)
v_mfma_f32_16x16x32_bf16 v[48:51], a[152:155], v[92:95], v[48:51]
s_waitcnt lgkmcnt(4)
v_mfma_f32_16x16x32_bf16 v[48:51], a[156:159], v[96:99], v[48:51]
s_waitcnt lgkmcnt(2)
v_mfma_f32_16x16x32_bf16 v[48:51], a[160:163], v[100:103], v[48:51]
s_waitcnt lgkmcnt(0)
v_mfma_f32_16x16x32_bf16 v[48:51], a[164:167], v[104:107], v[48:51]
s_nop 7
v_cvt_pk_bf16_f32 v48, v48, v49
v_cvt_pk_bf16_f32 v49, v50, v51
buffer_store_dwordx2 v[48:49], v66, s[8:11], 0 offen
v_mfma_f32_16x16x32_bf16 v[52:55], a[168:171], v[84:87], v[52:55]
v_mfma_f32_16x16x32_bf16 v[52:55], a[172:175], v[88:91], v[52:55]
v_mfma_f32_16x16x32_bf16 v[52:55], a[176:179], v[92:95], v[52:55]
v_mfma_f32_16x16x32_bf16 v[52:55], a[180:183], v[96:99], v[52:55]
v_mfma_f32_16x16x32_bf16 v[52:55], a[184:187], v[100:103], v[52:55]
v_mfma_f32_16x16x32_bf16 v[52:55], a[188:191], v[104:107], v[52:55]
s_nop 7
v_cvt_pk_bf16_f32 v52, v52, v53
v_cvt_pk_bf16_f32 v53, v54, v55
buffer_store_dwordx2 v[52:53], v66, s[8:11], 0 offen offset:32
v_mfma_f32_16x16x32_bf16 v[56:59], a[192:195], v[84:87], v[56:59]
v_mfma_f32_16x16x32_bf16 v[56:59], a[196:199], v[88:91], v[56:59]
v_mfma_f32_16x16x32_bf16 v[56:59], a[200:203], v[92:95], v[56:59]
v_mfma_f32_16x16x32_bf16 v[56:59], a[204:207], v[96:99], v[56:59]
v_mfma_f32_16x16x32_bf16 v[56:59], a[208:211], v[100:103], v[56:59]
v_mfma_f32_16x16x32_bf16 v[56:59], a[212:215], v[104:107], v[56:59]
s_nop 7
v_cvt_pk_bf16_f32 v56, v56, v57
v_cvt_pk_bf16_f32 v57, v58, v59
buffer_store_dwordx2 v[56:57], v66, s[8:11], 0 offen offset:64
ds_read_b128 v[174:177], v210 offset:18432
s_waitcnt lgkmcnt(0)
v_or3_b32 v174, v174, v175, v176
v_or_b32 v174, v174, v177
s_nop 0
v_readfirstlane_b32 s43, v174
s_endpgm
.p2align 6
.type L_tab,@object
L_tab:
.long 0x0,0x3800,0x5500,0x190,0x320,0x2020,0x5820,0x4b0,0x640,0x2340,0x4040,0x7d0,0x960,0x2660,0x6060,0xaf0
.long 0x1010,0x4810,0x6510,0x11a0,0x1330,0x3030,0x6830,0x14c0,0x1650,0x3350,0x5050,0x17e0,0x1970,0x3670,0x5370,0x1b00
.long 0x190,0x3990,0x5690,0x320,0x4b0,0x21b0,0x59b0,0x640,0x7d0,0x24d0,0x41d0,0x960,0x27f0,0x44f0,0x61f0,0x2980
.long 0x2980,0x4680,0x6380,0x2b10,0x11a0,0x49a0,0x66a0,0x1330,0x14c0,0x31c0,0x69c0,0x1650,0x17e0,0x34e0,0x51e0,0x1970
.long 0x320,0x3b20,0x5820,0x1010,0x640,0x2340,0x5b40,0x1330,0x960,0x2660,0x4360,0x1650,0xc80,0x2980,0x6380,0x1970
.long 0x1330,0x4b30,0x6830,0x2020,0x1650,0x3350,0x6b50,0x2340,0x1970,0x3670,0x5370,0x2660,0x1c90,0x3990,0x5690,0x2980
.long 0x4b0,0x3cb0,0x59b0,0x11a0,0x7d0,0x24d0,0x5cd0,0x14c0,0xaf0,0x27f0,0x44f0,0x17e0,0x2b10,0x4810,0x6510,0x3800
.long 0x2ca0,0x49a0,0x66a0,0x3990,0x14c0,0x4cc0,0x69c0,0x21b0,0x17e0,0x34e0,0x6ce0,0x24d0,0x1b00,0x3800,0x5500,0x27f0
.long 0x2020,0x5820,0x7520,0x1330,0x2340,0x4040,0x7840,0x1650,0x2660,0x4360,0x6060,0x1970,0x2980,0x4680,0x8080,0x1c90
.long 0x3030,0x6830,0x8530,0x2340,0x3350,0x5050,0x8850,0x2660,0x3670,0x5370,0x7070,0x2980,0x3990,0x5690,0x7390,0x2ca0
.long 0x21b0,0x59b0,0x76b0,0x14c0,0x24d0,0x41d0,0x79d0,0x17e0,0x27f0,0x44f0,0x61f0,0x1b00,0x4810,0x6510,0x8210,0x3b20
.long 0x49a0,0x66a0,0x83a0,0x3cb0,0x31c0,0x69c0,0x86c0,0x24d0,0x34e0,0x51e0,0x89e0,0x27f0,0x3800,0x5500,0x7200,0x2b10
.long 0x2340,0x5b40,0x7840,0x21b0,0x2660,0x4360,0x7b60,0x24d0,0x2980,0x4680,0x6380,0x27f0,0x2ca0,0x49a0,0x83a0,0x2b10
.long 0x3350,0x6b50,0x8850,0x31c0,0x3670,0x5370,0x8b70,0x34e0,0x3990,0x5690,0x7390,0x3800,0x3cb0,0x59b0,0x76b0,0x3b20
.long 0x24d0,0x5cd0,0x79d0,0x2340,0x27f0,0x44f0,0x7cf0,0x2660,0x2b10,0x4810,0x6510,0x2980,0x4b30,0x6830,0x8530,0x49a0
.long 0x4cc0,0x69c0,0x86c0,0x4b30,0x34e0,0x6ce0,0x89e0,0x3350,0x3800,0x5500,0x8d00,0x3670,0x3b20,0x5820,0x7520,0x3990
.long 0x3990,0x5690,0x11a0,0x49a0,0x21b0,0x59b0,0x14c0,0x31c0,0x24d0,0x41d0,0x17e0,0x34e0,0x27f0,0x61f0,0x1b00,0x3800
.long 0x49a0,0x66a0,0x21b0,0x59b0,0x31c0,0x69c0,0x24d0,0x41d0,0x34e0,0x51e0,0x27f0,0x44f0,0x3800,0x5500,0x2b10,0x4810
.long 0x3b20,0x5820,0x1330,0x4b30,0x2340,0x5b40,0x1650,0x3350,0x2660,0x4360,0x1970,0x3670,0x4680,0x6380,0x3990,0x5690
.long 0x4810,0x6510,0x3b20,0x5820,0x4b30,0x6830,0x2340,0x5b40,0x3350,0x6b50,0x2660,0x4360,0x3670,0x5370,0x2980,0x4680
.long 0x4810,0x6510,0x11a0,0x49a0,0x3030,0x6830,0x14c0,0x31c0,0x3350,0x5050,0x17e0,0x34e0,0x3670,0x7070,0x1b00,0x3800
.long 0x5820,0x7520,0x21b0,0x59b0,0x4040,0x7840,0x24d0,0x41d0,0x4360,0x6060,0x27f0,0x44f0,0x4680,0x6380,0x2b10,0x4810
.long 0x49a0,0x66a0,0x1330,0x4b30,0x31c0,0x69c0,0x1650,0x3350,0x34e0,0x51e0,0x1970,0x3670,0x5500,0x7200,0x3990,0x5690
.long 0x5690,0x7390,0x3b20,0x5820,0x59b0,0x76b0,0x2340,0x5b40,0x41d0,0x79d0,0x2660,0x4360,0x44f0,0x61f0,0x2980,0x4680
.long 0x4b30,0x6830,0x11b0,0x49b0,0x3350,0x6b50,0x14d0,0x31d0,0x3670,0x5370,0x17f0,0x34f0,0x3990,0x7390,0x1b10,0x3810
.long 0x5b40,0x7840,0x21c0,0x59c0,0x4360,0x7b60,0x24e0,0x41e0,0x4680,0x6380,0x2800,0x4500,0x49a0,0x66a0,0x2b20,0x4820
.long 0x4cc0,0x69c0,0x1340,0x4b40,0x34e0,0x6ce0,0x1660,0x3360,0x3800,0x5500,0x1980,0x3680,0x5820,0x7520,0x39a0,0x56a0
.long 0x59b0,0x76b0,0x3b30,0x5830,0x5cd0,0x79d0,0x2350,0x5b50,0x44f0,0x7cf0,0x2670,0x4370,0x4810,0x6510,0x2990,0x4690
.long 0x59b0,0x76b0,0x11b0,0x49b0,0x41d0,0x79d0,0x14d0,0x31d0,0x44f0,0x61f0,0x17f0,0x34f0,0x4810,0x8210,0x1b10,0x3810
.long 0x69c0,0x86c0,0x21c0,0x59c0,0x51e0,0x89e0,0x24e0,0x41e0,0x5500,0x7200,0x2800,0x4500,0x5820,0x7520,0x2b20,0x4820
.long 0x5b40,0x7840,0x1340,0x4b40,0x4360,0x7b60,0x1660,0x3360,0x4680,0x6380,0x1980,0x3680,0x66a0,0x83a0,0x39a0,0x56a0
.long 0x6830,0x8530,0x3b30,0x5830,0x6b50,0x8850,0x2350,0x5b50,0x5370,0x8b70,0x2670,0x4370,0x5690,0x7390,0x2990,0x4690
.long 0x66a0,0x0,0x90300,0xefd00,0x69c0,0x300,0x5fd00,0xf0000,0x51e0,0x600,0x60000,0xbfa00,0x7200,0x900,0x60300,0x11f700
.long 0x76b0,0x2fe80,0xc0180,0x11fb80,0x79d0,0x30180,0x8fb80,0x11fe80,0x61f0,0x30480,0x8fe80,0xef880,0x6510,0x30780,0x90180,0xefb80
.long 0x6830,0x180,0x90480,0xefe80,0x6b50,0x480,0x5fe80,0xf0180,0x5370,0x780,0x60180,0xbfb80,0x7390,0x60480,0xbfe80,0x11f880
.long 0x7520,0x60600,0xc0000,0x11fa00,0x7840,0x30000,0xc0300,0x11fd00,0x7b60,0x30300,0x8fd00,0x120000,0x6380,0x30600,0x90000,0xefa00
.long 0x66a0,0x8,0x90308,0xefd08,0x69c0,0x308,0x5fd08,0xf0008,0x51e0,0x608,0x60008,0xbfa08,0x7200,0x908,0x60308,0x11f708
.long 0x76b0,0x2fe88,0xc0188,0x11fb88,0x79d0,0x30188,0x8fb88,0x11fe88,0x61f0,0x30488,0x8fe88,0xef888,0x6510,0x30788,0x90188,0xefb88
.long 0x6830,0x188,0x90488,0xefe88,0x6b50,0x488,0x5fe88,0xf0188,0x5370,0x788,0x60188,0xbfb88,0x7390,0x60488,0xbfe88,0x11f888
.long 0x7520,0x60608,0xc0008,0x11fa08,0x7840,0x30008,0xc0308,0x11fd08,0x7b60,0x30308,0x8fd08,0x120008,0x6380,0x30608,0x90008,0xefa08
.long 0x66b0,0x10,0x90310,0xefd10,0x69d0,0x310,0x5fd10,0xf0010,0x51f0,0x610,0x60010,0xbfa10,0x7210,0x910,0x60310,0x11f710
.long 0x76c0,0x2fe90,0xc0190,0x11fb90,0x79e0,0x30190,0x8fb90,0x11fe90,0x6200,0x30490,0x8fe90,0xef890,0x6520,0x30790,0x90190,0xefb90
.long 0x6840,0x190,0x90490,0xefe90,0x6b60,0x490,0x5fe90,0xf0190,0x5380,0x790,0x60190,0xbfb90,0x73a0,0x60490,0xbfe90,0x11f890
.long 0x7530,0x60610,0xc0010,0x11fa10,0x7850,0x30010,0xc0310,0x11fd10,0x7b70,0x30310,0x8fd10,0x120010,0x6390,0x30610,0x90010,0xefa10
.long 0x66b0,0x18,0x90318,0xefd18,0x69d0,0x318,0x5fd18,0xf0018,0x51f0,0x618,0x60018,0xbfa18,0x7210,0x918,0x60318,0x11f718
.long 0x76c0,0x2fe98,0xc0198,0x11fb98,0x79e0,0x30198,0x8fb98,0x11fe98,0x6200,0x30498,0x8fe98,0xef898,0x6520,0x30798,0x90198,0xefb98
.long 0x6840,0x198,0x90498,0xefe98,0x6b60,0x498,0x5fe98,0xf0198,0x5380,0x798,0x60198,0xbfb98,0x73a0,0x60498,0xbfe98,0x11f898
.long 0x7530,0x60618,0xc0018,0x11fa18,0x7850,0x30018,0xc0318,0x11fd18,0x7b70,0x30318,0x8fd18,0x120018,0x6390,0x30618,0x90018,0xefa18
.long 0x0,0x0,0x9100,0xd900,0x0,0xff800000,0x9110,0xd910,0x0,0xff800000,0x9120,0xd920,0x0,0xff800000,0x9130,0xd930
.long 0x0,0xff800000,0x9140,0xd940,0x0,0xff800000,0x9150,0xd950,0x0,0xff800000,0x9160,0xd960,0x0,0xff800000,0x9170,0xd970
.long 0x0,0xff800000,0x9180,0xd980,0x0,0xff800000,0x9190,0xd990,0x0,0xff800000,0x91a0,0xd9a0,0x0,0xff800000,0x91b0,0xd9b0
.long 0x0,0xff800000,0x91c0,0xd9c0,0x0,0xff800000,0x91d0,0xd9d0,0x0,0xff800000,0x91e0,0xd9e0,0x0,0xff800000,0x91f0,0xd9f0
.long 0xff800000,0x0,0x9100,0xdd00,0xff800000,0xff800000,0x9110,0xdd10,0xff800000,0xff800000,0x9120,0xdd20,0xff800000,0xff800000,0x9130,0xdd30
.long 0xff800000,0xff800000,0x9140,0xdd40,0xff800000,0xff800000,0x9150,0xdd50,0xff800000,0xff800000,0x9160,0xdd60,0xff800000,0xff800000,0x9170,0xdd70
.long 0xff800000,0xff800000,0x9180,0xdd80,0xff800000,0xff800000,0x9190,0xdd90,0xff800000,0xff800000,0x91a0,0xdda0,0xff800000,0xff800000,0x91b0,0xddb0
.long 0xff800000,0xff800000,0x91c0,0xddc0,0xff800000,0xff800000,0x91d0,0xddd0,0xff800000,0xff800000,0x91e0,0xdde0,0xff800000,0xff800000,0x91f0,0xddf0
.long 0xff800000,0x0,0x9100,0xda00,0xff800000,0xff800000,0x9110,0xda10,0xff800000,0xff800000,0x9120,0xda20,0xff800000,0xff800000,0x9130,0xda30
.long 0xff800000,0xff800000,0x9140,0xda40,0xff800000,0xff800000,0x9150,0xda50,0xff800000,0xff800000,0x9160,0xda60,0xff800000,0xff800000,0x9170,0xda70
.long 0xff800000,0xff800000,0x9180,0xda80,0xff800000,0xff800000,0x9190,0xda90,0xff800000,0xff800000,0x91a0,0xdaa0,0xff800000,0xff800000,0x91b0,0xdab0
.long 0xff800000,0xff800000,0x91c0,0xdac0,0xff800000,0xff800000,0x91d0,0xdad0,0xff800000,0xff800000,0x91e0,0xdae0,0xff800000,0xff800000,0x91f0,0xdaf0
.long 0xff800000,0x0,0x9100,0xde00,0xff800000,0xff800000,0x9110,0xde10,0xff800000,0xff800000,0x9120,0xde20,0xff800000,0xff800000,0x9130,0xde30
.long 0xff800000,0xff800000,0x9140,0xde40,0xff800000,0xff800000,0x9150,0xde50,0xff800000,0xff800000,0x9160,0xde60,0xff800000,0xff800000,0x9170,0xde70
.long 0xff800000,0xff800000,0x9180,0xde80,0xff800000,0xff800000,0x9190,0xde90,0xff800000,0xff800000,0x91a0,0xdea0,0xff800000,0xff800000,0x91b0,0xdeb0
.long 0xff800000,0xff800000,0x91c0,0xdec0,0xff800000,0xff800000,0x91d0,0xded0,0xff800000,0xff800000,0x91e0,0xdee0,0xff800000,0xff800000,0x91f0,0xdef0
.long 0x9100,0x9100,0xa100,0x0,0x9110,0x9110,0xa110,0x55555555,0x9120,0x9120,0xa120,0xaaaaaaaa,0x9130,0x9130,0xa130,0xffffffff
.long 0x9140,0x9140,0xa140,0x0,0x9150,0x9150,0xa150,0x55555555,0x9160,0x9160,0xa160,0xaaaaaaaa,0x9170,0x9170,0xa170,0xffffffff
.long 0x9180,0x9180,0xa180,0x0,0x9190,0x9190,0xa190,0x55555555,0x91a0,0x91a0,0xa1a0,0xaaaaaaaa,0x91b0,0x91b0,0xa1b0,0xffffffff
.long 0x91c0,0x91c0,0xa1c0,0x0,0x91d0,0x91d0,0xa1d0,0x55555555,0x91e0,0x91e0,0xa1e0,0xaaaaaaaa,0x91f0,0x91f0,0xa1f0,0xffffffff
.long 0x9200,0x9200,0xa200,0x0,0x9210,0x9210,0xa210,0x55555555,0x9220,0x9220,0xa220,0xaaaaaaaa,0x9230,0x9230,0xa230,0xffffffff
.long 0x9240,0x9240,0xa240,0x0,0x9250,0x9250,0xa250,0x55555555,0x9260,0x9260,0xa260,0xaaaaaaaa,0x9270,0x9270,0xa270,0xffffffff
.long 0x9280,0x9280,0xa280,0x0,0x9290,0x9290,0xa290,0x55555555,0x92a0,0x92a0,0xa2a0,0xaaaaaaaa,0x92b0,0x92b0,0xa2b0,0xffffffff
.long 0x92c0,0x92c0,0xa2c0,0x0,0x92d0,0x92d0,0xa2d0,0x55555555,0x92e0,0x92e0,0xa2e0,0xaaaaaaaa,0x92f0,0x92f0,0xa2f0,0xffffffff
.long 0x9300,0x9300,0xa300,0x0,0x9310,0x9310,0xa310,0x55555555,0x9320,0x9320,0xa320,0xaaaaaaaa,0x9330,0x9330,0xa330,0xffffffff
.long 0x9340,0x9340,0xa340,0x0,0x9350,0x9350,0xa350,0x55555555,0x9360,0x9360,0xa360,0xaaaaaaaa,0x9370,0x9370,0xa370,0xffffffff
.long 0x9380,0x9380,0xa380,0x0,0x9390,0x9390,0xa390,0x55555555,0x93a0,0x93a0,0xa3a0,0xaaaaaaaa,0x93b0,0x93b0,0xa3b0,0xffffffff
.long 0x93c0,0x93c0,0xa3c0,0x0,0x93d0,0x93d0,0xa3d0,0x55555555,0x93e0,0x93e0,0xa3e0,0xaaaaaaaa,0x93f0,0x93f0,0xa3f0,0xffffffff
.long 0x9400,0x9400,0xa400,0x0,0x9410,0x9410,0xa410,0x55555555,0x9420,0x9420,0xa420,0xaaaaaaaa,0x9430,0x9430,0xa430,0xffffffff
.long 0x9440,0x9440,0xa440,0x0,0x9450,0x9450,0xa450,0x55555555,0x9460,0x9460,0xa460,0xaaaaaaaa,0x9470,0x9470,0xa470,0xffffffff
.long 0x9480,0x9480,0xa480,0x0,0x9490,0x9490,0xa490,0x55555555,0x94a0,0x94a0,0xa4a0,0xaaaaaaaa,0x94b0,0x94b0,0xa4b0,0xffffffff
.long 0x94c0,0x94c0,0xa4c0,0x0,0x94d0,0x94d0,0xa4d0,0x55555555,0x94e0,0x94e0,0xa4e0,0xaaaaaaaa,0x94f0,0x94f0,0xa4f0,0xffffffff
.long 0x17100,0x17100,0x0,0x23100,0x17102,0x17100,0x0,0x23110,0x17104,0x17100,0x0,0x23120,0x17106,0x17100,0x0,0x23130
.long 0x17120,0x17100,0x0,0x23140,0x17122,0x17100,0x0,0x23150,0x17124,0x17100,0x0,0x23160,0x17126,0x17100,0x0,0x23170
.long 0x17140,0x17100,0x0,0x23300,0x17142,0x17100,0x0,0x23300,0x17144,0x17100,0x0,0x23300,0x17146,0x17100,0x0,0x23300
.long 0x17160,0x17100,0x0,0x23300,0x17162,0x17100,0x0,0x23300,0x17164,0x17100,0x0,0x23300,0x17166,0x17100,0x0,0x23300
.long 0x17108,0x17120,0x0,0x23200,0x1710a,0x17120,0x0,0x23210,0x1710c,0x17120,0x0,0x23220,0x1710e,0x17120,0x0,0x23230
.long 0x17128,0x17120,0x0,0x23240,0x1712a,0x17120,0x0,0x23250,0x1712c,0x17120,0x0,0x23260,0x1712e,0x17120,0x0,0x23270
.long 0x17148,0x17120,0x0,0x23300,0x1714a,0x17120,0x0,0x23300,0x1714c,0x17120,0x0,0x23300,0x1714e,0x17120,0x0,0x23300
.long 0x17168,0x17120,0x0,0x23300,0x1716a,0x17120,0x0,0x23300,0x1716c,0x17120,0x0,0x23300,0x1716e,0x17120,0x0,0x23300
.long 0x17110,0x17140,0x0,0x23300,0x17112,0x17140,0x0,0x23300,0x17114,0x17140,0x0,0x23300,0x17116,0x17140,0x0,0x23300
.long 0x17130,0x17140,0x0,0x23300,0x17132,0x17140,0x0,0x23300,0x17134,0x17140,0x0,0x23300,0x17136,0x17140,0x0,0x23300
.long 0x17150,0x17140,0x0,0x23180,0x17152,0x17140,0x0,0x23190,0x17154,0x17140,0x0,0x231a0,0x17156,0x17140,0x0,0x231b0
.long 0x17170,0x17140,0x0,0x231c0,0x17172,0x17140,0x0,0x231d0,0x17174,0x17140,0x0,0x231e0,0x17176,0x17140,0x0,0x231f0
.long 0x17118,0x17160,0x0,0x23300,0x1711a,0x17160,0x0,0x23300,0x1711c,0x17160,0x0,0x23300,0x1711e,0x17160,0x0,0x23300
.long 0x17138,0x17160,0x0,0x23300,0x1713a,0x17160,0x0,0x23300,0x1713c,0x17160,0x0,0x23300,0x1713e,0x17160,0x0,0x23300
.long 0x17158,0x17160,0x0,0x23280,0x1715a,0x17160,0x0,0x23290,0x1715c,0x17160,0x0,0x232a0,0x1715e,0x17160,0x0,0x232b0
.long 0x17178,0x17160,0x0,0x232c0,0x1717a,0x17160,0x0,0x232d0,0x1717c,0x17160,0x0,0x232e0,0x1717e,0x17160,0x0,0x232f0
.long 0x17100,0xe100,0xe280,0xe700,0x17108,0xee90,0xf010,0xf490,0x17110,0xfc20,0xfda0,0x10220,0x17118,0x109b0,0x10b30,0x10fb0
.long 0x17160,0x11740,0x118c0,0x11d40,0x17168,0x124d0,0x12650,0x12ad0,0x17170,0x13260,0x133e0,0x13860,0x17178,0x13ff0,0x14170,0x145f0
.long 0x171c0,0x14d80,0x14f00,0x15380,0x171c8,0x15b10,0x15c90,0x16110,0x171d0,0x168a0,0x16a20,0x16ea0,0x171d8,0x17630,0x177b0,0x17c30
.long 0x17220,0x183c0,0x18540,0x189c0,0x17228,0x19150,0x192d0,0x19750,0x17230,0x19ee0,0x1a060,0x1a4e0,0x17238,0x1ac70,0x1adf0,0x1b270
.long 0x17280,0xe400,0xe580,0xe700,0x17288,0xf190,0xf310,0xf490,0x17290,0xff20,0x100a0,0x10220,0x17298,0x10cb0,0x10e30,0x10fb0
.long 0x172e0,0x11a40,0x11bc0,0x11d40,0x172e8,0x127d0,0x12950,0x12ad0,0x172f0,0x13560,0x136e0,0x13860,0x172f8,0x142f0,0x14470,0x145f0
.long 0x17340,0x15080,0x15200,0x15380,0x17348,0x15e10,0x15f90,0x16110,0x17350,0x16ba0,0x16d20,0x16ea0,0x17358,0x17930,0x17ab0,0x17c30
.long 0x173a0,0x186c0,0x18840,0x189c0,0x173a8,0x19450,0x195d0,0x19750,0x173b0,0x1a1e0,0x1a360,0x1a4e0,0x173b8,0x1af70,0x1b0f0,0x1b270
.long 0x17400,0xea00,0xe880,0xe710,0x17408,0xf790,0xf610,0xf4a0,0x17410,0x10520,0x103a0,0x10230,0x17418,0x112b0,0x11130,0x10fc0
.long 0x17460,0x12040,0x11ec0,0x11d50,0x17468,0x12dd0,0x12c50,0x12ae0,0x17470,0x13b60,0x139e0,0x13870,0x17478,0x148f0,0x14770,0x14600
.long 0x174c0,0x15680,0x15500,0x15390,0x174c8,0x16410,0x16290,0x16120,0x174d0,0x171a0,0x17020,0x16eb0,0x174d8,0x17f30,0x17db0,0x17c40
.long 0x17520,0x18cc0,0x18b40,0x189d0,0x17528,0x19a50,0x198d0,0x19760,0x17530,0x1a7e0,0x1a660,0x1a4f0,0x17538,0x1b570,0x1b3f0,0x1b280
.long 0x17580,0xed00,0xeb80,0xe710,0x17588,0xfa90,0xf910,0xf4a0,0x17590,0x10820,0x106a0,0x10230,0x17598,0x115b0,0x11430,0x10fc0
.long 0x175e0,0x12340,0x121c0,0x11d50,0x175e8,0x130d0,0x12f50,0x12ae0,0x175f0,0x13e60,0x13ce0,0x13870,0x175f8,0x14bf0,0x14a70,0x14600
.long 0x17640,0x15980,0x15800,0x15390,0x17648,0x16710,0x16590,0x16120,0x17650,0x174a0,0x17320,0x16eb0,0x17658,0x18230,0x180b0,0x17c40
.long 0x176a0,0x18fc0,0x18e40,0x189d0,0x176a8,0x19d50,0x19bd0,0x19760,0x176b0,0x1aae0,0x1a960,0x1a4f0,0x176b8,0x1b870,0x1b6f0,0x1b280
.long 0x17100,0x17500,0x1f050,0x0,0x17710,0x17b10,0x1f360,0x0,0x17d20,0x18120,0x1f670,0x0,0x18330,0x18730,0x1f980,0x0
.long 0x18940,0x18d40,0x1fc90,0x0,0x18f50,0x19350,0x1ffa0,0x0,0x19560,0x19960,0x202b0,0x0,0x19b70,0x19f70,0x205c0,0x0
.long 0x1a180,0x1a580,0x208d0,0x0,0x1a790,0x1ab90,0x20be0,0x0,0x1ada0,0x1b1a0,0x20ef0,0x0,0x1b3b0,0x1b7b0,0x21200,0x0
.long 0x1b9c0,0x1bdc0,0x21510,0x0,0x1bfd0,0x1c3d0,0x21820,0x0,0x1c5e0,0x1c9e0,0x21b30,0x0,0x1cbf0,0x1cff0,0x21e40,0x0
.long 0x17120,0x17508,0x1f060,0x0,0x17730,0x17b18,0x1f370,0x0,0x17d40,0x18128,0x1f680,0x0,0x18350,0x18738,0x1f990,0x0
.long 0x18960,0x18d48,0x1fca0,0x0,0x18f70,0x19358,0x1ffb0,0x0,0x19580,0x19968,0x202c0,0x0,0x19b90,0x19f78,0x205d0,0x0
.long 0x1a1a0,0x1a588,0x208e0,0x0,0x1a7b0,0x1ab98,0x20bf0,0x0,0x1adc0,0x1b1a8,0x20f00,0x0,0x1b3d0,0x1b7b8,0x21210,0x0
.long 0x1b9e0,0x1bdc8,0x21520,0x0,0x1bff0,0x1c3d8,0x21830,0x0,0x1c600,0x1c9e8,0x21b40,0x0,0x1cc10,0x1cff8,0x21e50,0x0
.long 0x17140,0x17510,0x1f070,0x0,0x17750,0x17b20,0x1f380,0x0,0x17d60,0x18130,0x1f690,0x0,0x18370,0x18740,0x1f9a0,0x0
.long 0x18980,0x18d50,0x1fcb0,0x0,0x18f90,0x19360,0x1ffc0,0x0,0x195a0,0x19970,0x202d0,0x0,0x19bb0,0x19f80,0x205e0,0x0
.long 0x1a1c0,0x1a590,0x208f0,0x0,0x1a7d0,0x1aba0,0x20c00,0x0,0x1ade0,0x1b1b0,0x20f10,0x0,0x1b3f0,0x1b7c0,0x21220,0x0
.long 0x1ba00,0x1bdd0,0x21530,0x0,0x1c010,0x1c3e0,0x21840,0x0,0x1c620,0x1c9f0,0x21b50,0x0,0x1cc30,0x1d000,0x21e60,0x0
.long 0x17160,0x17518,0x1f080,0x0,0x17770,0x17b28,0x1f390,0x0,0x17d80,0x18138,0x1f6a0,0x0,0x18390,0x18748,0x1f9b0,0x0
.long 0x189a0,0x18d58,0x1fcc0,0x0,0x18fb0,0x19368,0x1ffd0,0x0,0x195c0,0x19978,0x202e0,0x0,0x19bd0,0x19f88,0x205f0,0x0
.long 0x1a1e0,0x1a598,0x20900,0x0,0x1a7f0,0x1aba8,0x20c10,0x0,0x1ae00,0x1b1b8,0x20f20,0x0,0x1b410,0x1b7c8,0x21230,0x0
.long 0x1ba20,0x1bdd8,0x21540,0x0,0x1c030,0x1c3e8,0x21850,0x0,0x1c640,0x1c9f8,0x21b60,0x0,0x1cc50,0x1d008,0x21e70,0x0
.long 0x26100,0x26160,0x26280,0x0,0x26102,0x26162,0x26282,0x0,0x26104,0x26164,0x26284,0x0,0x26106,0x26166,0x26286,0x0
.long 0x26108,0x26168,0x26288,0x0,0x2610a,0x2616a,0x2628a,0x0,0x2610c,0x2616c,0x2628c,0x0,0x2610e,0x2616e,0x2628e,0x0
.long 0x26110,0x26170,0x26290,0x0,0x26112,0x26172,0x26292,0x0,0x26114,0x26174,0x26294,0x0,0x26116,0x26176,0x26296,0x0
.long 0x26118,0x26178,0x26298,0x0,0x2611a,0x2617a,0x2629a,0x0,0x2611c,0x2617c,0x2629c,0x0,0x2611e,0x2617e,0x2629e,0x0
.long 0x26340,0x262e0,0x26280,0x0,0x26342,0x262e2,0x26282,0x0,0x26344,0x262e4,0x26284,0x0,0x26346,0x262e6,0x26286,0x0
.long 0x26348,0x262e8,0x26288,0x0,0x2634a,0x262ea,0x2628a,0x0,0x2634c,0x262ec,0x2628c,0x0,0x2634e,0x262ee,0x2628e,0x0
.long 0x26350,0x262f0,0x26290,0x0,0x26352,0x262f2,0x26292,0x0,0x26354,0x262f4,0x26294,0x0,0x26356,0x262f6,0x26296,0x0
.long 0x26358,0x262f8,0x26298,0x0,0x2635a,0x262fa,0x2629a,0x0,0x2635c,0x262fc,0x2629c,0x0,0x2635e,0x262fe,0x2629e,0x0
.long 0x26100,0x26160,0x26280,0x0,0x26102,0x26162,0x26282,0x0,0x26104,0x26164,0x26284,0x0,0x26106,0x26166,0x26286,0x0
.long 0x26108,0x26168,0x26288,0x0,0x2610a,0x2616a,0x2628a,0x0,0x2610c,0x2616c,0x2628c,0x0,0x2610e,0x2616e,0x2628e,0x0
.long 0x26110,0x26170,0x26290,0x0,0x26112,0x26172,0x26292,0x0,0x26114,0x26174,0x26294,0x0,0x26116,0x26176,0x26296,0x0
.long 0x26118,0x26178,0x26298,0x0,0x2611a,0x2617a,0x2629a,0x0,0x2611c,0x2617c,0x2629c,0x0,0x2611e,0x2617e,0x2629e,0x0
.long 0x26340,0x262e0,0x26280,0x0,0x26342,0x262e2,0x26282,0x0,0x26344,0x262e4,0x26284,0x0,0x26346,0x262e6,0x26286,0x0
.long 0x26348,0x262e8,0x26288,0x0,0x2634a,0x262ea,0x2628a,0x0,0x2634c,0x262ec,0x2628c,0x0,0x2634e,0x262ee,0x2628e,0x0
.long 0x26350,0x262f0,0x26290,0x0,0x26352,0x262f2,0x26292,0x0,0x26354,0x262f4,0x26294,0x0,0x26356,0x262f6,0x26296,0x0
.long 0x26358,0x262f8,0x26298,0x0,0x2635a,0x262fa,0x2629a,0x0,0x2635c,0x262fc,0x2629c,0x0,0x2635e,0x262fe,0x2629e,0x0
.long 0xffffffff,0x0,0xffff,0x0,0xffffffff,0x0,0xffff,0x0,0xffffffff,0x0,0xffff,0x0,0xffffffff,0x0,0xffff,0x0
.long 0x0,0xffffffff,0xffff,0x0,0x0,0xffffffff,0xffff,0x0,0x0,0xffffffff,0xffff,0x0,0x0,0xffffffff,0xffff,0x0
.long 0x0,0x0,0xffff,0x0,0x0,0x0,0xffff,0x0,0x0,0x0,0xffff,0x0,0x0,0x0,0xffff,0x0
.long 0x0,0x0,0xffff,0x0,0x0,0x0,0xffff,0x0,0x0,0x0,0xffff,0x0,0x0,0x0,0xffff,0x0
.long 0xffffffff,0x0,0x0,0x3f80,0xffffffff,0x0,0x0,0x3f80,0xffffffff,0x0,0x0,0x3f80,0xffffffff,0x0,0x0,0x3f80
.long 0x0,0xffffffff,0x0,0x3f80,0x0,0xffffffff,0x0,0x3f80,0x0,0xffffffff,0x0,0x3f80,0x0,0xffffffff,0x0,0x3f80
.long 0x0,0x0,0x0,0x3f80,0x0,0x0,0x0,0x3f80,0x0,0x0,0x0,0x3f80,0x0,0x0,0x0,0x3f80
.long 0x0,0x0,0x0,0x3f80,0x0,0x0,0x0,0x3f80,0x0,0x0,0x0,0x3f80,0x0,0x0,0x0,0x3f80
.long 0x0,0x0,0xffff,0x0,0x0,0x0,0xffff,0x0,0x0,0x0,0xffff,0x0,0x0,0x0,0xffff,0x0
.long 0x0,0x0,0xffff,0x0,0x0,0x0,0xffff,0x0,0x0,0x0,0xffff,0x0,0x0,0x0,0xffff,0x0
.long 0xffffffff,0x0,0xffff,0x0,0xffffffff,0x0,0xffff,0x0,0xffffffff,0x0,0xffff,0x0,0xffffffff,0x0,0xffff,0x0
.long 0x0,0xffffffff,0xffff,0x0,0x0,0xffffffff,0xffff,0x0,0x0,0xffffffff,0xffff,0x0,0x0,0xffffffff,0xffff,0x0
.long 0x0,0x0,0x0,0x3f80,0x0,0x0,0x0,0x3f80,0x0,0x0,0x0,0x3f80,0x0,0x0,0x0,0x3f80
.long 0x0,0x0,0x0,0x3f80,0x0,0x0,0x0,0x3f80,0x0,0x0,0x0,0x3f80,0x0,0x0,0x0,0x3f80
.long 0xffffffff,0x0,0x0,0x3f80,0xffffffff,0x0,0x0,0x3f80,0xffffffff,0x0,0x0,0x3f80,0xffffffff,0x0,0x0,0x3f80
.long 0x0,0xffffffff,0x0,0x3f80,0x0,0xffffffff,0x0,0x3f80,0x0,0xffffffff,0x0,0x3f80,0x0,0xffffffff,0x0,0x3f80
.long 0xffff,0x0,0x0,0x0,0xffff0000,0x0,0x0,0x0,0x0,0xffff,0x0,0x0,0x0,0xffff0000,0x0,0x0
.long 0x0,0x0,0xffff,0x0,0x0,0x0,0xffff0000,0x0,0x0,0x0,0x0,0xffff,0x0,0x0,0x0,0xffff0000
.long 0x0,0x0,0x0,0x0,0x0,0x0,0x0,0x0,0x0,0x0,0x0,0x0,0x0,0x0,0x0,0x0
.long 0x0,0x0,0x0,0x0,0x0,0x0,0x0,0x0,0x0,0x0,0x0,0x0,0x0,0x0,0x0,0x0
.long 0xffff,0x0,0x0,0x0,0xffff0000,0x0,0x0,0x0,0x0,0xffff,0x0,0x0,0x0,0xffff0000,0x0,0x0
.long 0x0,0x0,0xffff,0x0,0x0,0x0,0xffff0000,0x0,0x0,0x0,0x0,0xffff,0x0,0x0,0x0,0xffff0000
.long 0x0,0x0,0x0,0x0,0x0,0x0,0x0,0x0,0x0,0x0,0x0,0x0,0x0,0x0,0x0,0x0
.long 0x0,0x0,0x0,0x0,0x0,0x0,0x0,0x0,0x0,0x0,0x0,0x0,0x0,0x0,0x0,0x0
.long 0x0,0x0,0x0,0x0,0x0,0x0,0x0,0x0,0x0,0x0,0x0,0x0,0x0,0x0,0x0,0x0
.long 0x0,0x0,0x0,0x0,0x0,0x0,0x0,0x0,0x0,0x0,0x0,0x0,0x0,0x0,0x0,0x0
.long 0xffff,0x0,0x0,0x0,0xffff0000,0x0,0x0,0x0,0x0,0xffff,0x0,0x0,0x0,0xffff0000,0x0,0x0
.long 0x0,0x0,0xffff,0x0,0x0,0x0,0xffff0000,0x0,0x0,0x0,0x0,0xffff,0x0,0x0,0x0,0xffff0000
.long 0x0,0x0,0x0,0x0,0x0,0x0,0x0,0x0,0x0,0x0,0x0,0x0,0x0,0x0,0x0,0x0
.long 0x0,0x0,0x0,0x0,0x0,0x0,0x0,0x0,0x0,0x0,0x0,0x0,0x0,0x0,0x0,0x0
.long 0xffff,0x0,0x0,0x0,0xffff0000,0x0,0x0,0x0,0x0,0xffff,0x0,0x0,0x0,0xffff0000,0x0,0x0
.long 0x0,0x0,0xffff,0x0,0x0,0x0,0xffff0000,0x0,0x0,0x0,0x0,0xffff,0x0,0x0,0x0,0xffff0000
.long 0x0,0x0,0x0,0x0,0x0,0x0,0x0,0x0,0x0,0x0,0x0,0x0,0x0,0x0,0x0,0x0
.long 0x0,0x0,0x0,0x0,0x0,0x0,0x0,0x0,0x0,0x0,0x0,0x0,0x0,0x0,0x0,0x0
.long 0x0,0x0,0x0,0x0,0x0,0x0,0x0,0x0,0x0,0x0,0x0,0x0,0x0,0x0,0x0,0x0
.long 0x0,0x0,0x0,0x0,0x0,0x0,0x0,0x0,0x0,0x0,0x0,0x0,0x0,0x0,0x0,0x0
.long 0x0,0x0,0x0,0x0,0x0,0x0,0x0,0x0,0x0,0x0,0x0,0x0,0x0,0x0,0x0,0x0
.long 0x0,0x0,0x0,0x0,0x0,0x0,0x0,0x0,0x0,0x0,0x0,0x0,0x0,0x0,0x0,0x0
.long 0x0,0x0,0x0,0x0,0x0,0x0,0x0,0x0,0x0,0x0,0x0,0x0,0x0,0x0,0x0,0x0
.long 0x0,0x0,0x0,0x0,0x0,0x0,0x0,0x0,0x0,0x0,0x0,0x0,0x0,0x0,0x0,0x0
.long 0x0,0x0,0x0,0x0,0x0,0x0,0x0,0x0,0x0,0x0,0x0,0x0,0x0,0x0,0x0,0x0
.long 0x0,0x0,0x0,0x0,0x0,0x0,0x0,0x0,0x0,0x0,0x0,0x0,0x0,0x0,0x0,0x0
.long 0x0,0x0,0x0,0x0,0x0,0x0,0x0,0x0,0x0,0x0,0x0,0x0,0x0,0x0,0x0,0x0
.long 0x0,0x0,0x0,0x0,0x0,0x0,0x0,0x0,0x0,0x0,0x0,0x0,0x0,0x0,0x0,0x0
.long 0x0,0x0,0x0,0x0,0x0,0x0,0x0,0x0,0x0,0x0,0x0,0x0,0x0,0x0,0x0,0x0
.long 0x0,0x0,0x0,0x0,0x0,0x0,0x0,0x0,0x0,0x0,0x0,0x0,0x0,0x0,0x0,0x0
.long 0x0,0x0,0x0,0x0,0x0,0x0,0x0,0x0,0x0,0x0,0x0,0x0,0x0,0x0,0x0,0x0
.long 0x0,0x0,0x0,0x0,0x0,0x0,0x0,0x0,0x0,0x0,0x0,0x0,0x0,0x0,0x0,0x0
.size L_tab, 12288
.section .rodata,"a"
.p2align 6
.amdhsa_kernel standalone__window_attn_davit__vision_kernel
  .amdhsa_next_free_vgpr 512
  .amdhsa_next_free_sgpr 102
  .amdhsa_accum_offset 256
  .amdhsa_group_segment_fixed_size 0
  .amdhsa_kernarg_size 56
  .amdhsa_user_sgpr_count 2
  .amdhsa_user_sgpr_kernarg_segment_ptr 1
  .amdhsa_system_sgpr_workgroup_id_x 1
.end_amdhsa_kernel
```

```asm
; @launch grid=(256,1,1) block=(256,1,1) lds=163840
.amdgcn_target "amdgcn-amd-amdhsa--gfx950"
.text
.globl standalone__window_attn_davit__vision_kernel
.p2align 8
.type standalone__window_attn_davit__vision_kernel,@function
standalone__window_attn_davit__vision_kernel:
s_cmp_ge_u32 s2, 256
s_cbranch_scc1 L_end
v_lshrrev_b32 v1, 6, v0
s_mov_b32 s53, s2
s_mov_b32 s47, 0
v_readfirstlane_b32 s32, v1
s_nop 3
L_start:

s_load_dwordx8 s[56:63], s[0:1], 0
s_load_dwordx2 s[64:65], s[0:1], 32
s_load_dwordx2 s[66:67], s[0:1], 48
s_load_dwordx2 s[100:101], s[0:1], 40
s_getpc_b64 s[68:69]
L_pc:
v_mbcnt_lo_u32_b32 v0, -1, 0
v_mbcnt_hi_u32_b32 v0, -1, v0
s_add_u32 s70, s68, L_tab-L_pc
s_addc_u32 s71, s69, 0
s_add_u32 s98, s68, F_tail-L_pc
s_addc_u32 s99, s69, 0
s_and_b32 s41, s53, 8
s_lshl_b32 s41, s41, 11
s_add_u32 s98, s98, s41
s_addc_u32 s99, s99, 0
s_lshl_b32 s45, s32, 10
v_lshl_add_u32 v1, v0, 4, s45
s_add_u32 m0, s45, 143616
s_nop 0
global_load_lds_dwordx4 v1, s[70:71]
v_add_u32 v1, 4096, v1
s_add_u32 m0, s45, 147712
s_nop 0
global_load_lds_dwordx4 v1, s[70:71]
v_add_u32 v1, 4096, v1
s_add_u32 m0, s45, 151808
s_nop 0
global_load_lds_dwordx4 v1, s[70:71]
s_lshr_b32 s42, s53, 3
s_and_b32 s41, s42, 1
s_lshl_b32 s41, s41, 2
s_add_u32 s41, s41, s32
s_lshl_b32 s41, s41, 13
v_lshlrev_b32 v2, 7, v0
v_add_u32 v3, s41, v2
s_cmp_lt_u32 s42, 4
s_cbranch_scc0 L_nopf
global_load_dword v255, v3, s[68:69]
L_nopf:
s_and_b32 s41, s53, 7
s_mul_i32 s43, s41, 640
s_mov_b32 s34, 5329
s_add_u32 s33, s43, s42
s_mov_b32 s35, s33
s_mov_b32 s72, 402653183
s_mul_i32 s54, s32, 96
s_mul_i32 s55, s32, 3072
s_mul_hi_u32 s41, s33, 58835169
s_mul_i32 s28, s41, 73
s_sub_u32 s28, s33, s28
s_mul_i32 s29, s41, 1373568
s_mul_i32 s41, s28, 2688
s_add_u32 s29, s29, s41
s_lshl_b32 s41, s32, 6
v_add_u32 v4, s41, v0
v_mul_u32_u24 v5, 2622, v4
v_lshrrev_b32 v5, 16, v5
v_mul_u32_u24 v6, 25, v5
v_sub_u32 v6, v4, v6
v_mul_u32_u24 v7, 384, v5
v_lshl_add_u32 v7, v6, 4, v7
v_cmp_eq_u32 vcc, 0, v5
v_or_b32 v10, 134217728, v7
s_nop 0
v_cndmask_b32 v7, v7, v10, vcc
v_cmp_eq_u32 vcc, 8, v5
v_or_b32 v10, 536870912, v7
s_nop 0
v_cndmask_b32 v7, v7, v10, vcc
v_cmp_lt_u32 vcc, 8, v5
v_or_b32 v10, 268435456, v7
s_nop 0
v_cndmask_b32 v7, v7, v10, vcc
v_cmp_eq_u32 vcc, 24, v6
v_or_b32 v10, 268435456, v7
s_nop 0
v_cndmask_b32 v7, v7, v10, vcc
v_mov_b32 v208, v7
v_add_u32 v4, 0, v0
v_mul_u32_u24 v5, 171, v4
v_lshrrev_b32 v5, 10, v5
v_mul_u32_u24 v6, 6, v5
v_sub_u32 v6, v4, v6
v_lshlrev_b32 v6, 4, v6
v_mul_u32_u24 v8, 1152, v5
v_add_u32 v72, v8, v6
v_mul_u32_u24 v8, 384, v5
v_add_u32 v136, v8, v6
s_lshl_b32 s96, s42, 13
s_mul_hi_u32 s41, s35, 58835169
s_mul_i32 s42, s41, 73
s_sub_u32 s42, s35, s42
s_mul_i32 s43, s41, 1373568
s_mul_i32 s51, s42, 2688
s_add_u32 s50, s43, s51
s_add_u32 s35, s35, 32
s_min_u32 s41, s41, 1
s_sub_u32 s41, 1, s41
s_lshl_b32 s41, s41, 30
s_add_u32 s52, s50, s41
s_min_u32 s43, s42, 1
s_lshl_b32 s43, s43, 27
s_sub_u32 s43, 536870911, s43
s_add_u32 s51, s42, 56
s_and_b32 s51, s51, 128
s_lshl_b32 s51, s51, 22
s_or_b32 s44, s43, s51
s_waitcnt lgkmcnt(0)
s_mov_b32 s12, s60
s_mov_b32 s13, s61
s_mov_b32 s14, 221184
s_mov_b32 s15, 131072
s_mov_b32 s16, s62
s_mov_b32 s17, s63
s_mov_b32 s18, 73728
s_mov_b32 s19, 131072
s_cmp_eq_u32 s32, 0
s_cbranch_scc0 L_nopf2
buffer_load_dword v255, v2, s[12:15], s96 offen
L_nopf2:
s_and_b32 s96, s96, 131071
s_cmp_eq_u32 s32, 1
s_cbranch_scc0 L_nopf3
buffer_load_dword v255, v2, s[16:19], s96 offen
L_nopf3:
s_sub_u32 s4, s56, 196608
s_subb_u32 s5, s57, 0
s_mov_b32 s6, 100467072
s_mov_b32 s7, 131072
s_mov_b32 s20, s58
s_mov_b32 s21, s59
s_mov_b32 s22, 3456
s_mov_b32 s23, 131072
s_mul_i32 s96, s32, 864
s_mov_b32 exec_hi, 4194303
s_add_u32 m0, s96, 155904
s_nop 0
buffer_load_dwordx4 v136, s[20:23], s54 offen lds
s_mov_b64 exec, -1
s_mov_b32 s36, s50
v_and_b32 v216, s44, v208
s_add_u32 m0, s45, 0
s_nop 0
buffer_load_dwordx4 v216, s[4:7], s52 offen nt lds
s_add_u32 m0, s45, 4112
s_add_u32 s40, s36, 196224
buffer_load_dwordx4 v216, s[4:7], s40 offen nt lds
s_add_u32 m0, s45, 8224
s_add_u32 s40, s36, 392448
buffer_load_dwordx4 v216, s[4:7], s40 offen nt lds
s_add_u32 m0, s45, 12336
s_add_u32 s40, s36, 588672
buffer_load_dwordx4 v216, s[4:7], s40 offen nt lds
s_add_u32 m0, s45, 16448
s_add_u32 s40, s36, 784896
buffer_load_dwordx4 v216, s[4:7], s40 offen nt lds
s_add_u32 m0, s45, 20560
s_add_u32 s40, s36, 981120
buffer_load_dwordx4 v216, s[4:7], s40 offen nt lds
s_add_u32 m0, s45, 24672
s_add_u32 s40, s36, 1177344
buffer_load_dwordx4 v216, s[4:7], s40 offen nt lds
s_add_u32 m0, s45, 28784
s_add_u32 s40, s36, 1373568
buffer_load_dwordx4 v216, s[4:7], s40 offen nt lds
s_add_u32 m0, s45, 32896
s_add_u32 s40, s36, 1569792
buffer_load_dwordx4 v216, s[4:7], s40 offen nt lds
s_mul_i32 s41, s32, 54
v_add_u32 v4, s41, v0
v_mul_u32_u24 v5, 911, v4
v_lshrrev_b32 v5, 16, v5
v_mul_u32_u24 v6, 72, v5
v_sub_u32 v6, v4, v6
s_mov_b32 s43, 196224
v_mul_lo_u32 v5, v5, s43
v_lshl_add_u32 v82, v6, 4, v5
s_add_u32 s20, s29, 785664
s_add_u32 m0, s96, 57600
s_mov_b32 exec_hi, 4194303
buffer_load_dwordx4 v82, s[4:7], s20 offen nt lds
s_mov_b32 exec_hi, -1
s_add_u32 s28, s28, 32
s_cmp_ge_u32 s28, 73
s_cselect_b32 s21, 73, 0
s_cselect_b32 s22, 1177344, 0
s_sub_u32 s28, s28, s21
s_add_u32 s20, s20, s22
s_add_u32 s20, s20, 86016
s_add_u32 m0, s96, 61072
s_mov_b32 exec_hi, 4194303
buffer_load_dwordx4 v82, s[4:7], s20 offen nt lds
s_mov_b32 exec_hi, -1
s_add_u32 s28, s28, 32
s_cmp_ge_u32 s28, 73
s_cselect_b32 s21, 73, 0
s_cselect_b32 s22, 1177344, 0
s_sub_u32 s28, s28, s21
s_add_u32 s20, s20, s22
s_add_u32 s20, s20, 86016
s_add_u32 m0, s96, 64544
s_mov_b32 exec_hi, 4194303
buffer_load_dwordx4 v82, s[4:7], s20 offen nt lds
s_mov_b32 exec_hi, -1
s_add_u32 s28, s28, 32
s_cmp_ge_u32 s28, 73
s_cselect_b32 s21, 73, 0
s_cselect_b32 s22, 1177344, 0
s_sub_u32 s28, s28, s21
s_add_u32 s20, s20, s22
s_add_u32 s20, s20, 86016
s_add_u32 m0, s96, 68016
s_mov_b32 exec_hi, 4194303
buffer_load_dwordx4 v82, s[4:7], s20 offen nt lds
s_mov_b32 exec_hi, -1
v_add_u32 v4, 64, v0
v_mul_u32_u24 v5, 171, v4
v_lshrrev_b32 v5, 10, v5
v_mul_u32_u24 v6, 6, v5
v_sub_u32 v6, v4, v6
v_lshlrev_b32 v6, 4, v6
v_mul_u32_u24 v8, 1152, v5
v_add_u32 v73, v8, v6
v_mul_u32_u24 v8, 384, v5
v_add_u32 v137, v8, v6
s_sub_u32 s8, s64, 262144
s_subb_u32 s9, s65, 0
s_mov_b32 s10, 100532608
s_mov_b32 s11, 131072
s_mov_b32 s24, s66
s_mov_b32 s25, s67
s_mov_b32 s26, 6356992
s_mov_b32 s27, 131072
s_lshl_b32 s41, s32, 6
s_add_u32 s58, s70, s41
s_addc_u32 s59, s71, 0
s_load_dwordx8 s[60:67], s[58:59], 11264
s_load_dwordx4 s[68:71], s[58:59], 11296
s_mov_b32 s48, 1001040555
s_mov_b32 s73, 1020061065
s_mov_b32 s49, 944335852
s_mov_b32 s3, 1074544643
v_lshlrev_b32 v11, 4, v0
v_add_u32 v11, 143616, v11
s_waitcnt vmcnt(13) lgkmcnt(0)
s_mul_i32 s58, s53, 24576
s_mul_i32 s41, s32, 6144
s_add_u32 s58, s58, s41
s_add_u32 s59, s58, 3072
s_barrier
ds_read_b128 v[194:197], v11
ds_read_b128 v[198:201], v11 offset:1024
ds_read_b128 v[202:205], v11 offset:2048
ds_read_b128 v[206:209], v11 offset:3072
ds_read_b128 v[210:213], v11 offset:4096
ds_read_b128 v[214:217], v11 offset:5120
ds_read_b128 v[110:113], v11 offset:6144
ds_read_b128 v[78:81], v11 offset:7168
ds_read_b128 v[36:39], v11 offset:8192
ds_read_b128 v[40:43], v11 offset:9216
s_waitcnt lgkmcnt(6)
ds_read_b128 v[44:47], v11 offset:10240
v_add_u32 v219, s45, v208
v_mov_b32 v208, v7
v_add_u32 v4, 128, v0
v_mul_u32_u24 v5, 171, v4
v_lshrrev_b32 v5, 10, v5
v_mul_u32_u24 v6, 6, v5
v_sub_u32 v6, v4, v6
v_lshlrev_b32 v6, 4, v6
v_mul_u32_u24 v8, 1152, v5
v_add_u32 v74, v8, v6
v_mul_u32_u24 v8, 384, v5
v_add_u32 v83, v8, v6
s_waitcnt lgkmcnt(2)
v_add_u32 v36, s96, v36
v_add_u32 v37, s96, v37
v_add_u32 v38, s96, v38
ds_read_u16 v48, v36
ds_read_u16 v49, v36 offset:192
ds_read_u16 v50, v37
ds_read_u16 v51, v37 offset:192
ds_read_u16 v52, v38
ds_read_u16 v53, v36 offset:32
ds_read_u16 v54, v36 offset:224
ds_read_u16 v55, v37 offset:32
ds_read_u16 v56, v37 offset:224
ds_read_u16 v57, v38 offset:32
ds_read_u16 v58, v36 offset:64
ds_read_u16 v59, v36 offset:256
ds_read_u16 v60, v37 offset:64
ds_read_u16 v61, v37 offset:256
s_waitcnt lgkmcnt(9)
ds_read_u16 v62, v38 offset:64
v_add_u32 v194, s54, v194
v_add_u32 v195, s54, v195
v_add_u32 v196, s54, v196
v_add_u32 v197, s54, v197
v_add_u32 v198, s54, v198
v_add_u32 v199, s54, v199
v_add_u32 v200, s54, v200
v_add_u32 v201, s54, v201
v_add_u32 v202, s54, v202
v_add_u32 v203, s54, v203
v_add_u32 v205, s54, v205
v_add_u32 v111, s54, v111
v_add_u32 v112, s54, v112
v_add_u32 v113, s54, v113
v_add_u32 v211, s45, v211
v_add_u32 v110, s55, v110
v_subrev_u32 v128, 94464, v110
v_subrev_u32 v129, 24576, v110
v_add_u32 v121, s54, v79
s_mul_i32 s41, s32, 1568
v_add_u32 v204, s41, v204
s_lshr_b32 s41, s32, 1
s_lshl_b32 s41, s41, 10
s_and_b32 s42, s32, 1
s_lshl_b32 s42, s42, 3
s_add_u32 s41, s41, s42
v_add_u32 v212, s41, v212
s_lshl_b32 s41, s32, 2
v_add_u32 v209, s41, v209
s_lshl_b32 s41, s32, 7
v_add_u32 v215, s41, v215
v_add_u32 v214, s41, v214
v_add_u32 v120, s41, v78
s_mul_i32 s41, s32, 4752
v_add_u32 v217, s41, v217
v_and_or_b32 v52, v52, v42, v43
v_lshl_or_b32 v52, v52, 16, v52
v_and_b32 v138, v52, v44
v_and_b32 v139, v52, v45
v_and_b32 v140, v52, v46
v_and_b32 v141, v52, v47
v_and_b32 v142, v48, v40
v_and_b32 v143, v48, v41
v_and_b32 v144, v49, v40
v_and_b32 v145, v49, v41
v_and_b32 v146, v50, v40
v_and_b32 v147, v50, v41
v_and_b32 v148, v51, v40
v_and_b32 v149, v51, v41
s_waitcnt lgkmcnt(0)
v_and_or_b32 v57, v57, v42, v43
v_lshl_or_b32 v57, v57, 16, v57
v_and_b32 v150, v57, v44
v_and_b32 v151, v57, v45
v_and_b32 v152, v57, v46
v_and_b32 v153, v57, v47
v_and_b32 v154, v53, v40
v_and_b32 v155, v53, v41
v_and_b32 v156, v54, v40
v_and_b32 v157, v54, v41
v_and_b32 v158, v55, v40
v_and_b32 v159, v55, v41
v_and_b32 v160, v56, v40
v_and_b32 v161, v56, v41
v_and_or_b32 v62, v62, v42, v43
v_lshl_or_b32 v62, v62, 16, v62
v_and_b32 v162, v62, v44
v_and_b32 v163, v62, v45
v_and_b32 v164, v62, v46
v_and_b32 v165, v62, v47
v_and_b32 v166, v58, v40
v_and_b32 v167, v58, v41
v_and_b32 v168, v59, v40
v_and_b32 v169, v59, v41
v_and_b32 v170, v60, v40
v_and_b32 v171, v60, v41
v_and_b32 v172, v61, v40
v_and_b32 v173, v61, v41
v_mov_b32 v190, 1065369472
v_mov_b32 v191, 1065369472
v_mov_b32 v192, 1065369472
v_mov_b32 v193, 1065369472
v_mov_b32 v218, 0
s_mov_b32 s30, 16712191
s_mov_b32 s31, 4278255360
s_mov_b32 s56, 983055
s_mov_b32 s57, 983055
s_waitcnt vmcnt(4) lgkmcnt(0)
s_barrier

s_cmp_lg_u32 s47, 0
s_cbranch_scc1 L_safe
.p2align 3
s_add_u32 s28, s28, 32
s_cmp_ge_u32 s28, 73
s_cselect_b32 s21, 73, 0
s_cselect_b32 s22, 1177344, 0
s_sub_u32 s28, s28, s21
s_add_u32 s20, s20, s22
s_add_u32 s20, s20, 86016
s_add_u32 m0, s96, 71488
s_mov_b32 exec_hi, 4194303
buffer_load_dwordx4 v82, s[4:7], s20 offen nt lds
s_mov_b32 exec_hi, -1
s_add_u32 s28, s28, 32
s_cmp_ge_u32 s28, 73
s_cselect_b32 s21, 73, 0
s_cselect_b32 s22, 1177344, 0
s_sub_u32 s28, s28, s21
s_add_u32 s20, s20, s22
s_add_u32 s20, s20, 86016
s_add_u32 m0, s96, 74960
s_mov_b32 exec_hi, 4194303
buffer_load_dwordx4 v82, s[4:7], s20 offen nt lds
s_mov_b32 exec_hi, -1
s_mul_hi_u32 s41, s35, 58835169
s_mul_i32 s42, s41, 73
s_sub_u32 s42, s35, s42
s_mul_i32 s43, s41, 1373568
s_mul_i32 s51, s42, 2688
s_add_u32 s50, s43, s51
s_add_u32 s35, s35, 32
s_min_u32 s41, s41, 1
s_sub_u32 s41, 1, s41
s_lshl_b32 s41, s41, 30
s_add_u32 s52, s50, s41
s_min_u32 s43, s42, 1
s_lshl_b32 s43, s43, 27
s_sub_u32 s43, 536870911, s43
s_add_u32 s51, s42, 56
s_and_b32 s51, s51, 128
s_lshl_b32 s51, s51, 22
s_or_b32 s44, s43, s51
s_add_u32 s28, s28, 32
s_cmp_ge_u32 s28, 73
s_cselect_b32 s21, 73, 0
s_cselect_b32 s22, 1177344, 0
s_sub_u32 s28, s28, s21
s_add_u32 s20, s20, s22
s_add_u32 s20, s20, 86016
s_add_u32 m0, s96, 78432
s_mov_b32 exec_hi, 4194303
buffer_load_dwordx4 v82, s[4:7], s20 offen nt lds
s_mov_b32 exec_hi, -1
v_and_b32_e64 v216, s44, v208
s_mov_b32 s37, s50
s_mul_hi_u32 s41, s35, 58835169
s_add_u32 s28, s28, 32
s_cmp_ge_u32 s28, 73
s_cselect_b32 s21, 73, 0
s_cselect_b32 s22, 1177344, 0
s_sub_u32 s28, s28, s21
s_add_u32 s20, s20, s22
s_add_u32 s20, s20, 86016
s_add_u32 m0, s96, 81904
s_mov_b32 exec_hi, 4194303
buffer_load_dwordx4 v82, s[4:7], s20 offen nt lds
s_mov_b32 exec_hi, -1
s_add_u32 s28, s28, 32
s_cmp_ge_u32 s28, 73
s_cselect_b32 s21, 73, 0
s_cselect_b32 s22, 1177344, 0
s_sub_u32 s28, s28, s21
s_add_u32 s20, s20, s22
s_add_u32 s20, s20, 86016
s_add_u32 m0, s96, 85376
s_mov_b32 exec_hi, 4194303
buffer_load_dwordx4 v82, s[4:7], s20 offen nt lds
s_mov_b32 exec_hi, -1
s_mul_i32 s42, s41, 73
s_sub_u32 s42, s35, s42
s_mul_i32 s43, s41, 1373568
s_add_u32 s28, s28, 32
s_cmp_ge_u32 s28, 73
s_cselect_b32 s21, 73, 0
s_cselect_b32 s22, 1177344, 0
s_sub_u32 s28, s28, s21
s_add_u32 s20, s20, s22
s_add_u32 s20, s20, 86016
s_add_u32 m0, s96, 88848
s_mov_b32 exec_hi, 4194303
buffer_load_dwordx4 v82, s[4:7], s20 offen nt lds
s_mov_b32 exec_hi, -1
s_mul_i32 s51, s42, 2688
s_add_u32 s50, s43, s51
s_min_u32 s43, s42, 1
s_add_u32 s28, s28, 32
s_cmp_ge_u32 s28, 73
s_cselect_b32 s21, 73, 0
s_cselect_b32 s22, 1177344, 0
s_sub_u32 s28, s28, s21
s_add_u32 s20, s20, s22
s_add_u32 s20, s20, 86016
s_add_u32 m0, s96, 92320
s_mov_b32 exec_hi, 4194303
buffer_load_dwordx4 v82, s[4:7], s20 offen nt lds
s_mov_b32 exec_hi, -1
s_add_u32 s51, s42, 56
s_min_u32 s41, s41, 1
s_lshl_b32 s43, s43, 27
s_add_u32 s28, s28, 32
s_cmp_ge_u32 s28, 73
s_cselect_b32 s21, 73, 0
s_cselect_b32 s22, 1177344, 0
s_sub_u32 s28, s28, s21
s_add_u32 s20, s20, s22
s_add_u32 s20, s20, 86016
s_add_u32 m0, s96, 95792
s_mov_b32 exec_hi, 4194303
buffer_load_dwordx4 v82, s[4:7], s20 offen nt lds
s_mov_b32 exec_hi, -1
s_and_b32 s51, s51, 128
s_sub_u32 s41, 1, s41
s_sub_u32 s43, 536870911, s43
ds_read_b128 v[84:87], v200
s_lshl_b32 s51, s51, 22
s_lshl_b32 s41, s41, 30
s_or_b32 s44, s43, s51
ds_read_b128 v[92:95], v201
s_mov_b32 s38, s36
s_mov_b32 s36, s50
s_add_u32 s35, s35, 32
ds_read_b128 v[100:103], v202
s_mov_b32 s39, s37
s_add_u32 s28, s28, 32
s_cmp_ge_u32 s28, 73
s_cselect_b32 s21, 73, 0
s_cselect_b32 s22, 1177344, 0
s_sub_u32 s28, s28, s21
s_add_u32 s20, s20, s22
s_add_u32 s20, s20, 86016
s_add_u32 m0, s96, 99264
s_mov_b32 exec_hi, 4194303
buffer_load_dwordx4 v82, s[4:7], s20 offen nt lds
s_mov_b32 exec_hi, -1
s_waitcnt lgkmcnt(2)
v_mfma_f32_16x16x32_bf16 v[0:3], v[138:141], v[84:87], 0
s_waitcnt lgkmcnt(1)
ds_read_b128 v[84:87], v194
ds_read_b128 v[88:91], v194 offset:16
v_mfma_f32_16x16x32_bf16 v[12:15], v[138:141], v[92:95], 0
s_waitcnt lgkmcnt(2)
ds_read_b128 v[92:95], v195
ds_read_b128 v[96:99], v195 offset:16
v_mfma_f32_16x16x32_bf16 v[24:27], v[138:141], v[100:103], 0
ds_read_b128 v[100:103], v196
ds_read_b128 v[104:107], v196 offset:16
s_mov_b64 exec, s[30:31]
ds_write_b128 v217, v[138:141]
s_mov_b64 exec, -1
s_waitcnt lgkmcnt(5)
v_smfmac_f32_16x16x64_bf16 v[0:3], v[142:145], v[84:91], v213
ds_read_b128 v[84:87], v197
ds_read_b128 v[88:91], v197 offset:16
s_waitcnt lgkmcnt(5)
v_smfmac_f32_16x16x64_bf16 v[12:15], v[142:145], v[92:99], v213
ds_read_b128 v[92:95], v198
ds_read_b128 v[96:99], v198 offset:16
s_waitcnt lgkmcnt(5)
v_smfmac_f32_16x16x64_bf16 v[24:27], v[142:145], v[100:107], v213
ds_read_b128 v[100:103], v199
ds_read_b128 v[104:107], v199 offset:16
s_mov_b64 exec, s[30:31]
ds_write_b128 v217, v[142:145] offset:528
s_mov_b64 exec, -1
s_add_u32 s28, s28, 32
s_cmp_ge_u32 s28, 73
s_cselect_b32 s21, 73, 0
s_cselect_b32 s22, 1177344, 0
s_sub_u32 s28, s28, s21
s_add_u32 s20, s20, s22
s_add_u32 s20, s20, 86016
s_add_u32 m0, s96, 102736
s_mov_b32 exec_hi, 4194303
buffer_load_dwordx4 v82, s[4:7], s20 offen nt lds
s_mov_b32 exec_hi, -1
s_waitcnt lgkmcnt(5)
v_smfmac_f32_16x16x64_bf16 v[0:3], v[146:149], v[84:91], v213
s_waitcnt lgkmcnt(3)
ds_read_b128 v[84:87], v200 offset:32
ds_read_b128 v[88:91], v194 offset:48
v_smfmac_f32_16x16x64_bf16 v[12:15], v[146:149], v[92:99], v213
s_waitcnt lgkmcnt(3)
ds_read_b128 v[92:95], v201 offset:32
ds_read_b128 v[96:99], v195 offset:48
v_smfmac_f32_16x16x64_bf16 v[24:27], v[146:149], v[100:107], v213
ds_read_b128 v[100:103], v202 offset:32
ds_read_b128 v[104:107], v196 offset:48
v_add_f32 v118, v0, v1
v_mul_f32 v119, v0, v0
v_add_f32 v118, v118, v2
v_fmac_f32 v119, v1, v1
v_add_f32 v118, v118, v3
v_fmac_f32 v119, v2, v2
v_fmac_f32 v119, v3, v3
v_add_f32 v126, v12, v13
v_mul_f32 v127, v12, v12
v_add_f32 v126, v126, v14
v_fmac_f32 v127, v13, v13
v_add_f32 v126, v126, v15
v_fmac_f32_e64 v127, v14, v14
v_fmac_f32 v127, v15, v15
s_waitcnt lgkmcnt(5)
v_mfma_f32_16x16x32_bf16 v[4:7], v[150:153], v[84:87], 0
ds_read_b128 v[84:87], v194 offset:32
v_add_f32 v134, v24, v25
v_mul_f32 v135, v24, v24
v_add_f32_e64 v134, v134, v26
v_fmac_f32 v135, v25, v25
s_waitcnt lgkmcnt(4)
v_mfma_f32_16x16x32_bf16 v[16:19], v[150:153], v[92:95], 0
ds_read_b128 v[92:95], v195 offset:32
v_add_f32 v134, v134, v27
v_fmac_f32 v135, v26, v26
v_fmac_f32 v135, v27, v27
s_waitcnt lgkmcnt(3)
v_mfma_f32_16x16x32_bf16 v[28:31], v[150:153], v[100:103], 0
s_nop 0
ds_read_b128 v[100:103], v196 offset:32
s_mov_b64 exec, s[30:31]
ds_write_b128 v217, v[146:149] offset:1056
s_mov_b64 exec, -1
s_waitcnt lgkmcnt(3)
v_smfmac_f32_16x16x64_bf16 v[4:7], v[154:157], v[84:91], v213
s_add_u32 s28, s28, 32
s_cmp_ge_u32 s28, 73
s_cselect_b32 s21, 73, 0
s_cselect_b32 s22, 1177344, 0
s_sub_u32 s28, s28, s21
s_add_u32 s20, s20, s22
s_add_u32 s20, s20, 86016
s_add_u32 m0, s96, 106208
s_mov_b32 exec_hi, 4194303
buffer_load_dwordx4 v82, s[4:7], s20 offen nt lds
s_mov_b32 exec_hi, -1
s_waitcnt lgkmcnt(2)
v_smfmac_f32_16x16x64_bf16 v[16:19], v[154:157], v[92:99], v213
s_waitcnt lgkmcnt(1)
ds_read_b128 v[84:87], v197 offset:32
ds_read_b128 v[88:91], v197 offset:48
v_smfmac_f32_16x16x64_bf16 v[28:31], v[154:157], v[100:107], v213
ds_read_b128 v[92:95], v198 offset:32
ds_read_b128 v[96:99], v198 offset:48
ds_read_b128 v[100:103], v199 offset:32
ds_read_b128 v[104:107], v199 offset:48
s_mov_b64 exec, s[30:31]
ds_write_b128 v217, v[150:153] offset:1584
s_mov_b64 exec, -1
s_waitcnt lgkmcnt(5)
v_smfmac_f32_16x16x64_bf16 v[4:7], v[158:161], v[84:91], v213
ds_read_b128 v[84:87], v200 offset:64
ds_read_b128 v[88:91], v194 offset:80
s_waitcnt lgkmcnt(5)
v_smfmac_f32_16x16x64_bf16 v[16:19], v[158:161], v[92:99], v213
ds_read_b128 v[92:95], v201 offset:64
ds_read_b128 v[96:99], v195 offset:80
v_add_f32 v118, v118, v4
v_fmac_f32 v119, v4, v4
v_add_f32 v118, v118, v5
v_fmac_f32 v119, v5, v5
v_add_f32_e64 v118, v118, v6
v_fmac_f32 v119, v6, v6
s_waitcnt lgkmcnt(5)
v_smfmac_f32_16x16x64_bf16 v[28:31], v[158:161], v[100:107], v213
ds_read_b128 v[100:103], v202 offset:64
ds_read_b128 v[104:107], v196 offset:80
v_add_f32_e64 v118, v118, v7
s_add_u32 s28, s28, 32
s_cmp_ge_u32 s28, 73
s_cselect_b32 s21, 73, 0
s_cselect_b32 s22, 1177344, 0
s_sub_u32 s28, s28, s21
s_add_u32 s20, s20, s22
s_add_u32 s20, s20, 86016
s_add_u32 m0, s96, 109680
s_mov_b32 exec_hi, 4194303
buffer_load_dwordx4 v82, s[4:7], s20 offen nt lds
s_mov_b32 exec_hi, -1
s_waitcnt lgkmcnt(5)
v_mfma_f32_16x16x32_bf16 v[8:11], v[162:165], v[84:87], 0
s_waitcnt lgkmcnt(3)
ds_read_b128 v[84:87], v194 offset:64
v_fmac_f32_e64 v119, v7, v7
v_mfma_f32_16x16x32_bf16 v[20:23], v[162:165], v[92:95], 0
ds_read_b128 v[92:95], v195 offset:64
v_add_f32 v126, v126, v16
v_fmac_f32 v127, v16, v16
v_add_f32 v126, v126, v17
v_fmac_f32 v127, v17, v17
v_add_f32 v126, v126, v18
s_waitcnt lgkmcnt(3)
v_mfma_f32_16x16x32_bf16 v[32:35], v[162:165], v[100:103], 0
ds_read_b128 v[100:103], v196 offset:64
v_fmac_f32 v127, v18, v18
v_add_f32 v126, v126, v19
v_fmac_f32 v127, v19, v19
v_add_f32 v134, v134, v28
v_fmac_f32 v135, v28, v28
v_add_f32 v134, v134, v29
v_fmac_f32 v135, v29, v29
v_add_f32 v134, v134, v30
v_fmac_f32 v135, v30, v30
v_add_f32 v134, v134, v31
s_waitcnt lgkmcnt(2)
v_smfmac_f32_16x16x64_bf16 v[8:11], v[166:169], v[84:91], v213
s_waitcnt lgkmcnt(1)
ds_read_b128 v[84:87], v197 offset:64
ds_read_b128 v[88:91], v197 offset:80
v_smfmac_f32_16x16x64_bf16 v[20:23], v[166:169], v[92:99], v213
ds_read_b128 v[92:95], v198 offset:64
ds_read_b128 v[96:99], v198 offset:80
v_fmac_f32 v135, v31, v31
s_waitcnt lgkmcnt(4)
v_smfmac_f32_16x16x64_bf16 v[32:35], v[166:169], v[100:107], v213
s_nop 0
ds_read_b128 v[100:103], v199 offset:64
ds_read_b128 v[104:107], v199 offset:80
s_mov_b64 exec, s[30:31]
ds_write_b128 v217, v[154:157] offset:2112
s_mov_b64 exec, -1
s_waitcnt lgkmcnt(5)
v_smfmac_f32_16x16x64_bf16 v[8:11], v[170:173], v[84:91], v213
s_add_u32 s28, s28, 32
s_cmp_ge_u32 s28, 73
s_cselect_b32 s21, 73, 0
s_cselect_b32 s22, 1177344, 0
s_sub_u32 s28, s28, s21
s_add_u32 s20, s20, s22
s_add_u32 s20, s20, 86016
s_add_u32 m0, s96, 113152
s_mov_b32 exec_hi, 4194303
buffer_load_dwordx4 v82, s[4:7], s20 offen nt lds
s_mov_b32 exec_hi, -1
s_waitcnt lgkmcnt(3)
v_smfmac_f32_16x16x64_bf16 v[20:23], v[170:173], v[92:99], v213
s_waitcnt lgkmcnt(1)
s_mov_b64 exec, s[30:31]
ds_write_b128 v217, v[158:161] offset:2640
s_mov_b64 exec, -1
v_smfmac_f32_16x16x64_bf16 v[32:35], v[170:173], v[100:107], v213
v_add_f32 v118, v118, v8
v_fmac_f32 v119, v8, v8
v_add_f32 v118, v118, v9
v_fmac_f32 v119, v9, v9
v_add_f32 v118, v118, v10
v_fmac_f32 v119, v10, v10
v_add_f32 v118, v118, v11
v_fmac_f32 v119, v11, v11
v_add_f32 v126, v126, v20
v_fmac_f32 v127, v20, v20
v_add_f32 v126, v126, v21
v_fmac_f32 v127, v21, v21
v_add_f32 v126, v126, v22
v_fmac_f32 v127, v22, v22
v_add_f32 v126, v126, v23
v_fmac_f32 v127, v23, v23
v_add_f32 v134, v134, v32
v_fmac_f32 v135, v32, v32
v_add_f32 v134, v134, v33
v_fmac_f32 v135, v33, v33
v_add_f32 v134, v134, v34
v_fmac_f32 v135, v34, v34
v_add_f32 v134, v134, v35
v_fmac_f32 v135, v35, v35
v_permlane16_swap_b32 v118, v119
v_add_f32 v118, v118, v119
v_permlane16_swap_b32 v126, v127
v_add_f32 v126, v126, v127
v_permlane16_swap_b32 v134, v135
v_add_f32 v134, v134, v135
v_permlane32_swap_b32 v118, v126
v_add_f32 v118, v118, v126
v_mov_b32 v135, v134
ds_write_b32 v209, v118
v_permlane32_swap_b32 v134, v135
s_add_u32 s28, s28, 32
s_cmp_ge_u32 s28, 73
s_cselect_b32 s21, 73, 0
s_cselect_b32 s22, 1177344, 0
s_sub_u32 s28, s28, s21
s_add_u32 s20, s20, s22
s_add_u32 s20, s20, 86016
s_add_u32 m0, s96, 116624
s_mov_b32 exec_hi, 4194303
buffer_load_dwordx4 v82, s[4:7], s20 offen nt lds
s_mov_b32 exec_hi, -1
v_add_f32 v134, v134, v135
ds_write_b32 v209, v134 offset:512
s_mov_b64 exec, s[30:31]
ds_write_b128 v217, v[162:165] offset:3168
s_mov_b64 exec, -1
s_mov_b64 exec, s[30:31]
ds_write_b128 v217, v[166:169] offset:3696
s_mov_b64 exec, -1
s_waitcnt lgkmcnt(2)
s_barrier
ds_read_b128 v[102:105], v210 offset:18432
ds_read_b128 v[106:109], v210 offset:19456
s_mov_b64 exec, s[30:31]
ds_write_b128 v217, v[170:173] offset:4224
s_mov_b64 exec, -1
s_waitcnt lgkmcnt(2)
v_add_f32 v102, v102, v103
v_add_f32 v104, v104, v105
s_waitcnt lgkmcnt(1)
s_add_u32 s28, s28, 32
s_cmp_ge_u32 s28, 73
s_cselect_b32 s21, 73, 0
s_cselect_b32 s22, 1177344, 0
s_sub_u32 s28, s28, s21
s_add_u32 s20, s20, s22
s_add_u32 s20, s20, 86016
s_add_u32 m0, s96, 120096
s_mov_b32 exec_hi, 4194303
buffer_load_dwordx4 v82, s[4:7], s20 offen nt lds
s_mov_b32 exec_hi, -1
v_add_f32 v102, v102, v104
v_mul_f32 v103, s48, v102
v_mul_f32 v104, s73, v102
v_add_f32 v106, v106, v107
v_add_f32 v108, v108, v109
v_add_f32 v106, v106, v108
v_mul_f32 v106, s73, v106
v_fma_f32 v106, -v103, v104, v106
v_max_f32 v106, 0, v106
v_add_f32 v106, s49, v106
v_rsq_f32 v102, v106
s_nop 0
v_mul_f32_e64 v103, -v103, v102
ds_write_b64 v211, v[102:103]
ds_read_b64 v[118:119], v219
ds_read_b64 v[126:127], v219 offset:256
ds_read_b64 v[134:135], v219 offset:512
s_waitcnt lgkmcnt(2)
v_fma_f32 v220, v0, v118, v119
v_fma_f32 v221, v1, v118, v119
v_cvt_pk_bf16_f32 v90, v220, v221
v_fma_f32 v222, v2, v118, v119
v_fma_f32 v223, v3, v118, v119
v_cvt_pk_bf16_f32 v91, v222, v223
v_fma_f32 v220, v4, v118, v119
v_fma_f32 v221, v5, v118, v119
v_cvt_pk_bf16_f32 v92, v220, v221
v_fma_f32 v222, v6, v118, v119
v_fma_f32 v223, v7, v118, v119
v_cvt_pk_bf16_f32 v93, v222, v223
v_fma_f32 v220, v8, v118, v119
v_fma_f32 v221, v9, v118, v119
s_add_u32 s28, s28, 32
s_cmp_ge_u32 s28, 73
s_cselect_b32 s21, 73, 0
s_cselect_b32 s22, 1177344, 0
s_sub_u32 s28, s28, s21
s_add_u32 s20, s20, s22
s_add_u32 s20, s20, 86016
s_add_u32 m0, s96, 123568
s_mov_b32 exec_hi, 4194303
buffer_load_dwordx4 v82, s[4:7], s20 offen nt lds
s_mov_b32 exec_hi, -1
s_add_u32 m0, s55, 131328
s_add_u32 s29, s54, 384
buffer_load_dwordx4 v72, s[12:15], s29 offen lds
v_cvt_pk_bf16_f32 v94, v220, v221
s_waitcnt lgkmcnt(1)
s_add_u32 m0, s55, 132352
s_add_u32 s29, s54, 384
buffer_load_dwordx4 v73, s[12:15], s29 offen lds
s_add_u32 m0, s55, 133376
s_add_u32 s29, s54, 384
buffer_load_dwordx4 v74, s[12:15], s29 offen lds
v_fma_f32 v222, v10, v118, v119
v_fma_f32 v223, v11, v118, v119
v_cvt_pk_bf16_f32 v95, v222, v223
v_fma_f32 v220, v12, v126, v127
v_fma_f32 v221, v13, v126, v127
v_cvt_pk_bf16_f32 v174, v220, v221
v_fma_f32 v222, v14, v126, v127
v_fma_f32 v223, v15, v126, v127
v_cvt_pk_bf16_f32 v175, v222, v223
v_fma_f32 v220, v16, v126, v127
v_fma_f32 v221, v17, v126, v127
v_cvt_pk_bf16_f32 v176, v220, v221
v_fma_f32 v222, v18, v126, v127
v_fma_f32 v223, v19, v126, v127
v_cvt_pk_bf16_f32 v177, v222, v223
ds_write_b128 v211, v[90:93]
s_add_u32 m0, s55, 0
s_add_u32 s29, s54, 37248
buffer_load_dwordx4 v72, s[12:15], s29 offen lds
v_fma_f32 v220, v20, v126, v127
v_fma_f32 v221, v21, v126, v127
v_cvt_pk_bf16_f32 v178, v220, v221
v_fma_f32 v222, v22, v126, v127
v_fma_f32 v223, v23, v126, v127
v_cvt_pk_bf16_f32 v179, v222, v223
s_waitcnt lgkmcnt(1)
ds_write_b64 v212, v[94:95]
s_add_u32 m0, s55, 1024
s_add_u32 s29, s54, 37248
buffer_load_dwordx4 v73, s[12:15], s29 offen lds
v_fma_f32 v220, v24, v134, v135
v_fma_f32 v221, v25, v134, v135
v_cvt_pk_bf16_f32 v90, v220, v221
v_fma_f32 v222, v26, v134, v135
v_fma_f32 v223, v27, v134, v135
v_cvt_pk_bf16_f32 v91, v222, v223
v_fma_f32 v220, v28, v134, v135
v_fma_f32 v221, v29, v134, v135
v_cvt_pk_bf16_f32 v92, v220, v221
v_fma_f32 v222, v30, v134, v135
v_fma_f32 v223, v31, v134, v135
v_cvt_pk_bf16_f32 v93, v222, v223
ds_write_b128 v211, v[174:177] offset:6144
s_add_u32 m0, s55, 2048
s_add_u32 s29, s54, 37248
buffer_load_dwordx4 v74, s[12:15], s29 offen lds
v_fma_f32 v220, v32, v134, v135
v_fma_f32 v221, v33, v134, v135
v_cvt_pk_bf16_f32 v94, v220, v221
v_fma_f32 v222, v34, v134, v135
v_fma_f32 v223, v35, v134, v135
v_cvt_pk_bf16_f32 v95, v222, v223
s_add_u32 s28, s38, s60
ds_write_b64 v212, v[178:179] offset:6144
s_add_u32 m0, s55, 12288
s_add_u32 s29, s54, 74112
buffer_load_dwordx4 v72, s[12:15], s29 offen lds
ds_write_b128 v211, v[90:93] offset:12288
s_add_u32 m0, s55, 13312
s_add_u32 s29, s54, 74112
buffer_load_dwordx4 v73, s[12:15], s29 offen lds
ds_write_b64 v212, v[94:95] offset:12288
s_add_u32 m0, s55, 14336
s_add_u32 s29, s54, 74112
buffer_load_dwordx4 v74, s[12:15], s29 offen lds
s_add_u32 m0, s55, 24576
s_add_u32 s29, s54, 110976
buffer_load_dwordx4 v72, s[12:15], s29 offen lds
s_add_u32 m0, s55, 25600
s_add_u32 s29, s54, 110976
buffer_load_dwordx4 v73, s[12:15], s29 offen lds
s_add_u32 m0, s55, 26624
s_add_u32 s29, s54, 110976
buffer_load_dwordx4 v74, s[12:15], s29 offen lds
s_waitcnt vmcnt(10) lgkmcnt(0)
ds_read_b64_tr_b16 a[0:1], v110 offset:36864
s_barrier
ds_read_b128 v[84:87], v113
ds_read_b128 v[92:95], v113 offset:55552
ds_read_b128 v[100:103], v111
ds_read_b128 v[104:107], v111 offset:16
ds_read_b128 v[88:91], v111 offset:55568
ds_read_b128 v[96:99], v112 offset:16
s_waitcnt lgkmcnt(5)
v_mfma_f32_16x16x32_bf16 v[36:39], v[138:141], v[84:87], 0
s_nop 0
ds_read_b128 v[84:87], v111 offset:55552
ds_read_b64_tr_b16 a[24:25], v110 offset:36896
s_waitcnt lgkmcnt(6)
v_mfma_f32_16x16x32_bf16 v[48:51], v[138:141], v[92:95], 0
ds_read_b128 v[92:95], v112
ds_read_b64_tr_b16 a[48:49], v110 offset:36928
s_waitcnt lgkmcnt(6)
v_smfmac_f32_16x16x64_bf16 v[36:39], v[142:145], v[100:107], v213
ds_read_b128 v[100:103], v112 offset:55552
ds_read_b128 v[104:107], v112 offset:55568
s_waitcnt vmcnt(9)
ds_read_b64_tr_b16 a[2:3], v110 offset:38400
ds_read_b64_tr_b16 a[26:27], v110 offset:38432
s_waitcnt lgkmcnt(7)
v_smfmac_f32_16x16x64_bf16 v[48:51], v[142:145], v[84:91], v213
ds_read_b128 v[84:87], v113 offset:32
ds_read_b128 v[88:91], v111 offset:55600
s_waitcnt lgkmcnt(7)
v_smfmac_f32_16x16x64_bf16 v[36:39], v[146:149], v[92:99], v213
ds_read_b128 v[92:95], v113 offset:55584
ds_read_b128 v[96:99], v112 offset:48
ds_read_b64_tr_b16 a[50:51], v110 offset:38464
s_nop 3
v_add_f32 v118, v36, v37
v_mul_f32 v119, v36, v36
v_add_f32 v118, v118, v38
v_fmac_f32 v119, v37, v37
s_waitcnt lgkmcnt(7)
v_smfmac_f32_16x16x64_bf16 v[48:51], v[146:149], v[100:107], v213
ds_read_b128 v[100:103], v111 offset:32
ds_read_b128 v[104:107], v111 offset:48
v_add_f32 v118, v118, v39
v_fmac_f32 v119, v38, v38
v_fmac_f32 v119, v39, v39
s_waitcnt lgkmcnt(6)
v_mfma_f32_16x16x32_bf16 v[40:43], v[150:153], v[84:87], 0
ds_read_b128 v[84:87], v111 offset:55584
v_add_f32 v126, v48, v49
v_mul_f32 v127, v48, v48
v_add_f32_e64 v126, v126, v50
v_fmac_f32 v127, v49, v49
s_waitcnt lgkmcnt(5)
v_mfma_f32_16x16x32_bf16 v[52:55], v[150:153], v[92:95], 0
ds_read_b128 v[92:95], v112 offset:32
v_add_f32 v126, v126, v51
v_fmac_f32 v127, v50, v50
v_fmac_f32 v127, v51, v51
s_waitcnt vmcnt(6)
ds_read_b64_tr_b16 a[4:5], v128 offset:1536
ds_read_b64_tr_b16 a[28:29], v128 offset:1568
s_waitcnt lgkmcnt(4)
v_smfmac_f32_16x16x64_bf16 v[40:43], v[154:157], v[100:107], v213
ds_read_b128 v[100:103], v112 offset:55584
ds_read_b128 v[104:107], v112 offset:55600
s_waitcnt lgkmcnt(5)
v_smfmac_f32_16x16x64_bf16 v[52:55], v[154:157], v[84:91], v213
ds_read_b128 v[84:87], v113 offset:64
ds_read_b128 v[88:91], v111 offset:55632
s_waitcnt lgkmcnt(6)
v_smfmac_f32_16x16x64_bf16 v[40:43], v[158:161], v[92:99], v213
ds_read_b128 v[92:95], v113 offset:55616
ds_read_b128 v[96:99], v112 offset:80
ds_read_b64_tr_b16 a[52:53], v128 offset:1600
s_nop 3
v_add_f32 v118, v118, v40
v_fmac_f32 v119, v40, v40
v_add_f32 v118, v118, v41
v_fmac_f32 v119, v41, v41
v_add_f32 v118, v118, v42
v_fmac_f32 v119, v42, v42
v_add_f32 v118, v118, v43
v_fmac_f32 v119, v43, v43
s_waitcnt lgkmcnt(5)
v_smfmac_f32_16x16x64_bf16 v[52:55], v[158:161], v[100:107], v213
s_waitcnt lgkmcnt(4)
ds_read_b128 v[100:103], v111 offset:64
ds_read_b128 v[104:107], v111 offset:80
v_mfma_f32_16x16x32_bf16 v[44:47], v[162:165], v[84:87], 0
s_nop 0
ds_read_b128 v[84:87], v111 offset:55616
ds_read_b64_tr_b16 a[16:17], v128
s_waitcnt lgkmcnt(6)
v_mfma_f32_16x16x32_bf16 v[56:59], v[162:165], v[92:95], 0
ds_read_b128 v[92:95], v112 offset:64
v_add_f32 v126, v126, v52
v_fmac_f32 v127, v52, v52
v_add_f32 v126, v126, v53
v_fmac_f32 v127, v53, v53
v_add_f32 v126, v126, v54
v_fmac_f32 v127, v54, v54
v_add_f32_e64 v126, v126, v55
v_fmac_f32 v127, v55, v55
ds_read_b64_tr_b16 a[40:41], v128 offset:32
ds_read_b64_tr_b16 a[64:65], v128 offset:64
s_waitcnt lgkmcnt(5)
v_smfmac_f32_16x16x64_bf16 v[44:47], v[166:169], v[100:107], v213
ds_read_b128 v[100:103], v112 offset:55616
ds_read_b128 v[104:107], v112 offset:55632
s_waitcnt lgkmcnt(6)
v_smfmac_f32_16x16x64_bf16 v[56:59], v[166:169], v[84:91], v213
s_waitcnt vmcnt(4)
ds_read_b64_tr_b16 a[6:7], v128 offset:12288
ds_read_b64_tr_b16 a[30:31], v128 offset:12320
s_waitcnt lgkmcnt(6)
v_smfmac_f32_16x16x64_bf16 v[44:47], v[170:173], v[92:99], v213
s_waitcnt vmcnt(3)
ds_read_b64_tr_b16 a[54:55], v128 offset:12352
ds_read_b64_tr_b16 a[18:19], v128 offset:13824
ds_read_b64_tr_b16 a[42:43], v128 offset:13856
s_nop 3
v_add_f32 v118, v118, v44
v_fmac_f32 v119, v44, v44
v_add_f32 v118, v118, v45
v_fmac_f32 v119, v45, v45
v_add_f32 v118, v118, v46
v_fmac_f32 v119, v46, v46
v_add_f32 v118, v118, v47
v_fmac_f32 v119, v47, v47
s_waitcnt lgkmcnt(5)
v_smfmac_f32_16x16x64_bf16 v[56:59], v[170:173], v[100:107], v213
s_barrier
v_permlane16_swap_b32 v118, v119
v_add_f32 v118, v118, v119
s_nop 3
v_add_f32 v126, v126, v56
v_fmac_f32 v127, v56, v56
v_add_f32 v126, v126, v57
v_fmac_f32 v127, v57, v57
v_add_f32 v126, v126, v58
v_fmac_f32 v127, v58, v58
v_add_f32 v126, v126, v59
v_fmac_f32 v127, v59, v59
s_nop 1
v_permlane16_swap_b32 v126, v127
v_add_f32 v126, v126, v127
s_nop 1
v_permlane32_swap_b32 v118, v126
v_add_f32 v118, v118, v126
ds_write_b32 v209, v118
s_add_u32 m0, s55, 94464
s_add_u32 s29, s54, 147840
buffer_load_dwordx4 v72, s[12:15], s29 offen lds
s_add_u32 m0, s55, 95488
s_add_u32 s29, s54, 147840
buffer_load_dwordx4 v73, s[12:15], s29 offen lds
s_add_u32 m0, s55, 96512
s_add_u32 s29, s54, 147840
buffer_load_dwordx4 v74, s[12:15], s29 offen lds
s_waitcnt lgkmcnt(0)
s_barrier
ds_read_b128 v[102:105], v210 offset:18432
ds_read_b128 v[106:109], v210 offset:19456
s_add_u32 m0, s55, 106752
s_add_u32 s29, s54, 184704
buffer_load_dwordx4 v72, s[12:15], s29 offen lds
s_add_u32 m0, s55, 107776
s_add_u32 s29, s54, 184704
buffer_load_dwordx4 v73, s[12:15], s29 offen lds
s_waitcnt lgkmcnt(1)
v_add_f32 v102, v102, v103
v_add_f32 v104, v104, v105
v_add_f32 v102, v102, v104
v_mul_f32 v103, s48, v102
v_mul_f32 v104, s73, v102
s_waitcnt lgkmcnt(0)
v_add_f32 v106, v106, v107
v_add_f32 v108, v108, v109
v_add_f32 v106, v106, v108
v_mul_f32_e64 v106, s73, v106
v_fma_f32 v106, -v103, v104, v106
v_max_f32 v106, 0, v106
v_add_f32 v106, s49, v106
v_rsq_f32_e64 v102, v106
s_nop 0
v_mul_f32_e64 v103, -v103, v102
ds_write_b64 v211, v[102:103] offset:20480
s_add_u32 m0, s55, 108800
s_add_u32 s29, s54, 184704
buffer_load_dwordx4 v74, s[12:15], s29 offen lds
ds_read_b64 v[118:119], v219 offset:20480
ds_read_b64 v[126:127], v219 offset:20736
s_add_u32 m0, s55, 119040
s_add_u32 s29, s54, 0
buffer_load_dwordx4 v72, s[12:15], s29 offen lds
s_add_u32 m0, s55, 120064
s_add_u32 s29, s54, 0
buffer_load_dwordx4 v73, s[12:15], s29 offen lds
s_waitcnt lgkmcnt(1)
v_fma_f32 v220, v36, v118, v119
v_fma_f32 v221, v37, v118, v119
v_cvt_pk_bf16_f32 v90, v220, v221
v_fma_f32 v222, v38, v118, v119
v_fma_f32 v223, v39, v118, v119
v_cvt_pk_bf16_f32 v91, v222, v223
v_fma_f32 v220, v40, v118, v119
v_fma_f32 v221, v41, v118, v119
v_cvt_pk_bf16_f32 v92, v220, v221
v_fma_f32 v222, v42, v118, v119
v_fma_f32 v223, v43, v118, v119
v_cvt_pk_bf16_f32 v93, v222, v223
v_fma_f32 v220, v44, v118, v119
v_fma_f32 v221, v45, v118, v119
v_cvt_pk_bf16_f32 v94, v220, v221
v_fma_f32 v222, v46, v118, v119
v_fma_f32 v223, v47, v118, v119
v_cvt_pk_bf16_f32 v95, v222, v223
s_waitcnt lgkmcnt(0)
v_fma_f32 v220, v48, v126, v127
v_fma_f32 v221, v49, v126, v127
v_cvt_pk_bf16_f32 v174, v220, v221
v_fma_f32 v222, v50, v126, v127
v_fma_f32 v223, v51, v126, v127
v_cvt_pk_bf16_f32 v175, v222, v223
v_fma_f32 v220, v52, v126, v127
v_fma_f32 v221, v53, v126, v127
v_cvt_pk_bf16_f32 v176, v220, v221
v_fma_f32 v222, v54, v126, v127
v_fma_f32 v223, v55, v126, v127
v_cvt_pk_bf16_f32 v177, v222, v223
ds_write_b128 v211, v[90:93] offset:20480
v_fma_f32 v220, v56, v126, v127
v_fma_f32 v221, v57, v126, v127
v_cvt_pk_bf16_f32 v178, v220, v221
v_fma_f32 v222, v58, v126, v127
v_fma_f32 v223, v59, v126, v127
v_cvt_pk_bf16_f32 v179, v222, v223
ds_write_b64 v212, v[94:95] offset:20480
s_add_u32 m0, s55, 121088
s_add_u32 s29, s54, 0
buffer_load_dwordx4 v74, s[12:15], s29 offen lds
ds_write_b128 v211, v[174:177] offset:26624
s_add_u32 m0, s55, 69888
s_add_u32 s29, s54, 36864
buffer_load_dwordx4 v72, s[12:15], s29 offen lds
ds_write_b64 v212, v[178:179] offset:26624
s_add_u32 m0, s55, 70912
s_add_u32 s29, s54, 36864
buffer_load_dwordx4 v73, s[12:15], s29 offen lds
s_add_u32 m0, s55, 71936
s_add_u32 s29, s54, 36864
buffer_load_dwordx4 v74, s[12:15], s29 offen lds
s_add_u32 m0, s55, 82176
s_add_u32 s29, s54, 73728
buffer_load_dwordx4 v72, s[12:15], s29 offen lds
s_add_u32 m0, s55, 83200
s_add_u32 s29, s54, 73728
buffer_load_dwordx4 v73, s[12:15], s29 offen lds
s_add_u32 m0, s55, 84224
s_add_u32 s29, s54, 73728
buffer_load_dwordx4 v74, s[12:15], s29 offen lds
ds_read_b64_tr_b16 a[66:67], v128 offset:13888
s_waitcnt vmcnt(16)
ds_read_b64_tr_b16 a[8:9], v128 offset:24576
ds_read_b64_tr_b16 a[32:33], v128 offset:24608
ds_read_b64_tr_b16 a[56:57], v128 offset:24640
s_waitcnt vmcnt(15)
ds_read_b64_tr_b16 a[10:11], v128 offset:26112
ds_read_b64_tr_b16 a[34:35], v128 offset:26144
ds_read_b64_tr_b16 a[58:59], v128 offset:26176
v_mov_b32 v128, v83
s_add_u32 m0, s55, 131328
s_add_u32 s29, s54, 110592
buffer_load_dwordx4 v72, s[12:15], s29 offen lds
s_add_u32 m0, s55, 132352
s_add_u32 s29, s54, 110592
buffer_load_dwordx4 v73, s[12:15], s29 offen lds
s_add_u32 m0, s55, 133376
s_add_u32 s29, s54, 110592
buffer_load_dwordx4 v74, s[12:15], s29 offen lds
s_waitcnt vmcnt(15) lgkmcnt(0)
s_barrier
ds_read_b64_tr_b16 a[12:13], v110 offset:1536
ds_read_b64_tr_b16 a[36:37], v110 offset:1568
ds_read_b64_tr_b16 a[60:61], v110 offset:1600
ds_read_b64_tr_b16 a[20:21], v110
ds_read_b64_tr_b16 a[44:45], v110 offset:32
ds_read_b64_tr_b16 a[68:69], v110 offset:64
s_waitcnt vmcnt(13)
ds_read_b64_tr_b16 a[14:15], v110 offset:12288
ds_read_b64_tr_b16 a[38:39], v110 offset:12320
ds_read_b64_tr_b16 a[62:63], v110 offset:12352
s_waitcnt vmcnt(12)
ds_read_b64_tr_b16 a[22:23], v110 offset:13824
s_waitcnt lgkmcnt(4)
s_add_u32 m0, s55, 94464
s_add_u32 s29, s54, 147456
buffer_load_dwordx4 v72, s[12:15], s29 offen lds
s_add_u32 m0, s55, 95488
s_add_u32 s29, s54, 147456
buffer_load_dwordx4 v73, s[12:15], s29 offen lds
s_add_u32 m0, s55, 96512
s_add_u32 s29, s54, 147456
buffer_load_dwordx4 v74, s[12:15], s29 offen lds
ds_read_b64_tr_b16 a[46:47], v110 offset:13856
ds_read_b64_tr_b16 a[70:71], v110 offset:13888
s_waitcnt vmcnt(13)
ds_read_b64_tr_b16 a[216:217], v110 offset:24576
ds_read_b64_tr_b16 a[240:241], v110 offset:24608
ds_read_b64_tr_b16 v[232:233], v110 offset:24640
s_waitcnt vmcnt(12)
ds_read_b64_tr_b16 a[218:219], v110 offset:26112
s_waitcnt lgkmcnt(4)
s_add_u32 m0, s55, 106752
s_add_u32 s29, s54, 184320
buffer_load_dwordx4 v72, s[12:15], s29 offen lds
s_add_u32 m0, s55, 107776
s_add_u32 s29, s54, 184320
buffer_load_dwordx4 v73, s[12:15], s29 offen lds
s_add_u32 m0, s55, 108800
s_add_u32 s29, s54, 184320
buffer_load_dwordx4 v74, s[12:15], s29 offen lds
ds_read_b64_tr_b16 a[242:243], v110 offset:26144
ds_read_b64_tr_b16 v[234:235], v110 offset:26176
s_waitcnt vmcnt(12)
ds_read_b64_tr_b16 a[220:221], v129 offset:1536
ds_read_b64_tr_b16 a[244:245], v129 offset:1568
ds_read_b64_tr_b16 v[236:237], v129 offset:1600
ds_read_b64_tr_b16 a[232:233], v129
s_waitcnt lgkmcnt(4)
s_add_u32 m0, s55, 119040
s_add_u32 s29, s54, 768
buffer_load_dwordx4 v72, s[12:15], s29 offen lds
s_add_u32 m0, s55, 120064
s_add_u32 s29, s54, 768
buffer_load_dwordx4 v73, s[12:15], s29 offen lds
ds_read_b64_tr_b16 v[224:225], v129 offset:32
ds_read_b64_tr_b16 v[248:249], v129 offset:64
s_add_u32 m0, s55, 121088
s_add_u32 s29, s54, 768
buffer_load_dwordx4 v74, s[12:15], s29 offen lds
s_waitcnt vmcnt(13)
ds_read_b64_tr_b16 a[222:223], v129 offset:12288
ds_read_b64_tr_b16 a[246:247], v129 offset:12320
ds_read_b64_tr_b16 v[238:239], v129 offset:12352
s_waitcnt lgkmcnt(3)
s_add_u32 m0, s55, 69888
s_add_u32 s29, s54, 37632
buffer_load_dwordx4 v72, s[12:15], s29 offen lds
s_waitcnt vmcnt(13)
ds_read_b64_tr_b16 a[234:235], v129 offset:13824
ds_read_b64_tr_b16 v[226:227], v129 offset:13856
ds_read_b64_tr_b16 v[250:251], v129 offset:13888
s_add_u32 m0, s55, 70912
s_add_u32 s29, s54, 37632
buffer_load_dwordx4 v73, s[12:15], s29 offen lds
s_waitcnt vmcnt(12)
ds_read_b64_tr_b16 a[224:225], v110 offset:36864
ds_read_b64_tr_b16 a[248:249], v110 offset:36896
ds_read_b64_tr_b16 v[240:241], v110 offset:36928
s_add_u32 m0, s55, 71936
s_add_u32 s29, s54, 37632
buffer_load_dwordx4 v74, s[12:15], s29 offen lds
s_waitcnt vmcnt(12)
ds_read_b64_tr_b16 a[226:227], v110 offset:38400
ds_read_b64_tr_b16 a[250:251], v110 offset:38432
s_waitcnt lgkmcnt(5)
s_add_u32 m0, s55, 82176
s_add_u32 s29, s54, 74496
buffer_load_dwordx4 v72, s[12:15], s29 offen lds
ds_read_b64_tr_b16 v[242:243], v110 offset:38464
s_waitcnt vmcnt(11)
ds_read_b64_tr_b16 a[236:237], v110
ds_read_b64_tr_b16 v[228:229], v110 offset:32
s_add_u32 m0, s55, 83200
s_add_u32 s29, s54, 74496
buffer_load_dwordx4 v73, s[12:15], s29 offen lds
s_waitcnt vmcnt(11)
ds_read_b64_tr_b16 a[228:229], v110 offset:1536
ds_read_b64_tr_b16 a[252:253], v110 offset:1568
ds_read_b64_tr_b16 v[244:245], v110 offset:1600
s_add_u32 m0, s55, 84224
s_add_u32 s29, s54, 74496
buffer_load_dwordx4 v74, s[12:15], s29 offen lds
ds_read_b64_tr_b16 v[252:253], v110 offset:64
ds_read_b128 v[182:185], v210 offset:20480
ds_read_b128 v[186:189], v210 offset:26624
s_waitcnt lgkmcnt(8)
s_add_u32 m0, s55, 131328
s_add_u32 s29, s54, 111360
buffer_load_dwordx4 v72, s[12:15], s29 offen lds
s_waitcnt vmcnt(11)
ds_read_b64_tr_b16 a[230:231], v110 offset:12288
ds_read_b64_tr_b16 a[254:255], v110 offset:12320
s_waitcnt lgkmcnt(3)
v_mfma_f32_16x16x32_bf16 v[138:141], a[0:3], v[182:185], 0
s_add_u32 m0, s55, 132352
s_add_u32 s29, s54, 111360
buffer_load_dwordx4 v73, s[12:15], s29 offen lds
v_mfma_f32_16x16x32_bf16 v[142:145], a[24:27], v[182:185], 0
s_waitcnt vmcnt(11)
ds_read_b64_tr_b16 v[246:247], v110 offset:12352
ds_read_b64_tr_b16 a[238:239], v110 offset:13824
v_mfma_f32_16x16x32_bf16 v[146:149], a[48:51], v[182:185], 0
s_waitcnt lgkmcnt(4)
ds_read_b64_tr_b16 v[230:231], v110 offset:13856
ds_read_b64_tr_b16 v[254:255], v110 offset:13888
v_mfma_f32_16x16x32_bf16 v[150:153], a[0:3], v[186:189], 0
ds_read_b128 v[114:117], v210 offset:21504
ds_read_b128 v[122:125], v210 offset:27648
v_mfma_f32_16x16x32_bf16 v[154:157], a[24:27], v[186:189], 0
s_add_u32 m0, s55, 133376
s_add_u32 s29, s54, 111360
buffer_load_dwordx4 v74, s[12:15], s29 offen lds
v_mfma_f32_16x16x32_bf16 v[158:161], a[48:51], v[186:189], 0
s_nop 0
ds_read_b128 v[182:185], v210 offset:24576
ds_read_b128 v[186:189], v210 offset:30720
ds_read_b128 v[174:177], v217
ds_read_b128 v[178:181], v217 offset:528
s_waitcnt lgkmcnt(5)
v_mfma_f32_16x16x32_bf16 v[138:141], a[4:7], v[114:117], v[138:141]
s_add_u32 m0, s55, 94464
s_add_u32 s29, s54, 148224
buffer_load_dwordx4 v72, s[12:15], s29 offen lds
v_mfma_f32_16x16x32_bf16 v[142:145], a[28:31], v[114:117], v[142:145]
s_waitcnt vmcnt(11)
ds_read_b64_tr_b16 a[72:73], v110 offset:24576
ds_read_b64_tr_b16 a[96:97], v110 offset:24608
v_mfma_f32_16x16x32_bf16 v[146:149], a[52:55], v[114:117], v[146:149]
s_waitcnt lgkmcnt(5)
ds_read_b64_tr_b16 a[120:121], v110 offset:24640
ds_read_b128 v[114:117], v210 offset:22528
v_mfma_f32_16x16x32_bf16 v[146:149], a[64:67], v[182:185], v[146:149]
ds_read_b128 v[220:223], v210 offset:3072
v_mfma_f32_16x16x32_bf16 v[150:153], a[4:7], v[122:125], v[150:153]
s_waitcnt lgkmcnt(7)
s_add_u32 m0, s55, 95488
s_add_u32 s29, s54, 148224
buffer_load_dwordx4 v73, s[12:15], s29 offen lds
v_mfma_f32_16x16x32_bf16 v[150:153], a[16:19], v[186:189], v[150:153]
s_waitcnt vmcnt(11)
ds_read_b64_tr_b16 a[74:75], v110 offset:26112
ds_read_b64_tr_b16 a[98:99], v110 offset:26144
v_mfma_f32_16x16x32_bf16 v[154:157], a[28:31], v[122:125], v[154:157]
ds_read_b64_tr_b16 a[122:123], v110 offset:26176
v_mfma_f32_16x16x32_bf16 v[154:157], a[40:43], v[186:189], v[154:157]
v_mfma_f32_16x16x32_bf16 v[158:161], a[52:55], v[122:125], v[158:161]
s_add_u32 m0, s55, 96512
s_add_u32 s29, s54, 148224
buffer_load_dwordx4 v74, s[12:15], s29 offen lds
v_mfma_f32_16x16x32_bf16 v[158:161], a[64:67], v[186:189], v[158:161]
ds_read_b128 v[122:125], v210 offset:28672
ds_read_b128 v[186:189], v210 offset:29696
v_mfma_f32_16x16x32_bf16 v[138:141], a[16:19], v[182:185], v[138:141]
s_waitcnt lgkmcnt(6)
v_mfma_f32_16x16x32_bf16 v[138:141], a[8:11], v[114:117], v[138:141]
v_mfma_f32_16x16x32_bf16 v[142:145], a[40:43], v[182:185], v[142:145]
s_add_u32 m0, s55, 106752
s_add_u32 s29, s54, 185088
buffer_load_dwordx4 v72, s[12:15], s29 offen lds
v_mfma_f32_16x16x32_bf16 v[142:145], a[32:35], v[114:117], v[142:145]
s_waitcnt vmcnt(11)
ds_read_b64_tr_b16 a[88:89], v129
ds_read_b64_tr_b16 a[112:113], v129 offset:32
v_mfma_f32_16x16x32_bf16 v[146:149], a[56:59], v[114:117], v[146:149]
s_waitcnt lgkmcnt(3)
ds_read_b64_tr_b16 a[136:137], v129 offset:64
ds_read_b128 v[182:185], v210 offset:23552
v_mfma_f32_16x16x32_bf16 v[150:153], a[8:11], v[122:125], v[150:153]
ds_read_b128 v[114:117], v210 offset:25600
s_waitcnt lgkmcnt(5)
v_mfma_f32_16x16x32_bf16 v[150:153], a[12:15], v[186:189], v[150:153]
s_nop 0
s_add_u32 m0, s55, 107776
s_add_u32 s29, s54, 185088
buffer_load_dwordx4 v73, s[12:15], s29 offen lds
v_mfma_f32_16x16x32_bf16 v[154:157], a[32:35], v[122:125], v[154:157]
s_waitcnt vmcnt(11)
ds_read_b64_tr_b16 a[76:77], v129 offset:1536
ds_read_b64_tr_b16 a[100:101], v129 offset:1568
v_mfma_f32_16x16x32_bf16 v[154:157], a[36:39], v[186:189], v[154:157]
ds_read_b64_tr_b16 a[124:125], v129 offset:1600
v_mfma_f32_16x16x32_bf16 v[158:161], a[56:59], v[122:125], v[158:161]
ds_read_b128 v[122:125], v210 offset:31744
v_mfma_f32_16x16x32_bf16 v[158:161], a[60:63], v[186:189], v[158:161]
s_waitcnt lgkmcnt(5)
s_add_u32 m0, s55, 108800
s_add_u32 s29, s54, 185088
buffer_load_dwordx4 v74, s[12:15], s29 offen lds
v_mfma_f32_16x16x32_bf16 v[138:141], a[12:15], v[182:185], v[138:141]
ds_read_b128 v[186:189], v210 offset:26624
s_waitcnt lgkmcnt(5)
v_mfma_f32_16x16x32_bf16 v[138:141], a[20:23], v[114:117], v[138:141]
v_mfma_f32_16x16x32_bf16 v[142:145], a[36:39], v[182:185], v[142:145]
v_mfma_f32_16x16x32_bf16 v[142:145], a[44:47], v[114:117], v[142:145]
s_add_u32 m0, s45, 0
s_nop 0
buffer_load_dwordx4 v216, s[4:7], s52 offen nt lds
v_mfma_f32_16x16x32_bf16 v[146:149], a[60:63], v[182:185], v[146:149]
s_waitcnt vmcnt(11) lgkmcnt(1)
ds_read_b64_tr_b16 a[78:79], v129 offset:12288
ds_read_b64_tr_b16 a[102:103], v129 offset:12320
v_mfma_f32_16x16x32_bf16 v[146:149], a[68:71], v[114:117], v[146:149]
s_add_u32 s52, s50, s41
ds_read_b64_tr_b16 a[126:127], v129 offset:12352
ds_read_b128 v[182:185], v210 offset:20480
v_mfma_f32_16x16x32_bf16 v[150:153], a[20:23], v[122:125], v[150:153]
s_mul_hi_u32 s41, s35, 58835169
ds_read_b128 v[114:117], v210 offset:21504
s_add_u32 m0, s45, 4112
s_add_u32 s40, s37, 196224
buffer_load_dwordx4 v216, s[4:7], s40 offen nt lds
v_mfma_f32_16x16x32_bf16 v[154:157], a[44:47], v[122:125], v[154:157]
s_mul_i32 s42, s41, 73
v_cvt_pk_bf16_f32 v60, v138, v139
v_cvt_pk_bf16_f32 v61, v140, v141
v_mfma_f32_16x16x32_bf16 v[158:161], a[68:71], v[122:125], v[158:161]
s_waitcnt vmcnt(11) lgkmcnt(5)
ds_read_b64_tr_b16 a[90:91], v129 offset:13824
ds_read_b64_tr_b16 a[114:115], v129 offset:13856
v_mfma_f32_16x16x32_bf16 v[138:141], a[216:219], v[186:189], 0
s_sub_u32 s42, s35, s42
ds_read_b64_tr_b16 a[138:139], v129 offset:13888
ds_read_b128 v[122:125], v210 offset:27648
v_cvt_pk_bf16_f32 v62, v142, v143
s_waitcnt lgkmcnt(5)
s_add_u32 m0, s45, 8224
s_add_u32 s40, s37, 392448
buffer_load_dwordx4 v216, s[4:7], s40 offen nt lds
v_mfma_f32_16x16x32_bf16 v[162:165], a[216:219], v[182:185], 0
s_waitcnt lgkmcnt(4)
v_cvt_pk_bf16_f32 v63, v144, v145
v_cvt_pk_bf16_f32 v64, v146, v147
v_mfma_f32_16x16x32_bf16 v[162:165], a[220:223], v[114:117], v[162:165]
s_mul_i32 s43, s41, 1373568
v_cvt_pk_bf16_f32 v65, v148, v149
v_cvt_pk_bf16_f32 v66, v150, v151
v_mfma_f32_16x16x32_bf16 v[166:169], a[240:243], v[182:185], 0
s_mul_i32 s51, s42, 2688
s_add_u32 m0, s45, 12336
s_add_u32 s40, s37, 588672
buffer_load_dwordx4 v216, s[4:7], s40 offen nt lds
v_mfma_f32_16x16x32_bf16 v[166:169], a[244:247], v[114:117], v[166:169]
v_cvt_pk_bf16_f32 v67, v152, v153
v_cvt_pk_bf16_f32 v68, v154, v155
v_mfma_f32_16x16x32_bf16 v[170:173], v[232:235], v[182:185], 0
s_waitcnt vmcnt(11)
ds_read_b64_tr_b16 a[80:81], v110 offset:36864
ds_read_b64_tr_b16 a[104:105], v110 offset:36896
v_mfma_f32_16x16x32_bf16 v[170:173], v[236:239], v[114:117], v[170:173]
s_add_u32 s50, s43, s51
s_waitcnt lgkmcnt(2)
s_add_u32 m0, s45, 16448
s_add_u32 s40, s37, 784896
buffer_load_dwordx4 v216, s[4:7], s40 offen nt lds
v_mfma_f32_16x16x32_bf16 v[142:145], a[240:243], v[186:189], 0
s_min_u32 s43, s42, 1
ds_read_b64_tr_b16 a[128:129], v110 offset:36928
ds_read_b128 v[182:185], v210 offset:24576
v_mfma_f32_16x16x32_bf16 v[142:145], a[244:247], v[122:125], v[142:145]
s_add_u32 s51, s42, 56
ds_read_b128 v[114:117], v210 offset:22528
v_cvt_pk_bf16_f32 v69, v156, v157
v_mfma_f32_16x16x32_bf16 v[146:149], v[232:235], v[186:189], 0
s_waitcnt vmcnt(11)
ds_read_b64_tr_b16 a[82:83], v110 offset:38400
ds_read_b64_tr_b16 a[106:107], v110 offset:38432
v_mfma_f32_16x16x32_bf16 v[146:149], v[236:239], v[122:125], v[146:149]
s_min_u32 s41, s41, 1
s_add_u32 m0, s45, 20560
s_add_u32 s40, s37, 981120
buffer_load_dwordx4 v216, s[4:7], s40 offen nt lds
v_mfma_f32_16x16x32_bf16 v[138:141], a[220:223], v[122:125], v[138:141]
s_lshl_b32 s43, s43, 27
ds_read_b64_tr_b16 a[130:131], v110 offset:38464
ds_read_b128 v[186:189], v210 offset:30720
v_cvt_pk_bf16_f32 v70, v158, v159
v_cvt_pk_bf16_f32 v71, v160, v161
s_and_b32 s51, s51, 128
s_sub_u32 s41, 1, s41
ds_read_b128 v[122:125], v210 offset:28672
s_sub_u32 s43, 536870911, s43
s_waitcnt lgkmcnt(6)
v_mfma_f32_16x16x32_bf16 v[162:165], a[232:235], v[182:185], v[162:165]
s_waitcnt lgkmcnt(5)
s_add_u32 m0, s45, 24672
s_add_u32 s40, s37, 1177344
buffer_load_dwordx4 v216, s[4:7], s40 offen nt lds
v_mfma_f32_16x16x32_bf16 v[162:165], a[224:227], v[114:117], v[162:165]
s_lshl_b32 s51, s51, 22
s_lshl_b32 s41, s41, 30
v_mfma_f32_16x16x32_bf16 v[166:169], v[224:227], v[182:185], v[166:169]
s_nop 0
v_mfma_f32_16x16x32_bf16 v[166:169], a[248:251], v[114:117], v[166:169]
s_add_u32 m0, s45, 28784
s_add_u32 s40, s37, 1373568
buffer_load_dwordx4 v216, s[4:7], s40 offen nt lds
v_mfma_f32_16x16x32_bf16 v[170:173], v[248:251], v[182:185], v[170:173]
s_waitcnt vmcnt(12)
ds_read_b64_tr_b16 a[92:93], v110
ds_read_b64_tr_b16 a[116:117], v110 offset:32
v_mfma_f32_16x16x32_bf16 v[170:173], v[240:243], v[114:117], v[170:173]
s_waitcnt lgkmcnt(3)
ds_read_b64_tr_b16 a[140:141], v110 offset:64
ds_read_b128 v[182:185], v210 offset:23552
v_mfma_f32_16x16x32_bf16 v[138:141], a[232:235], v[186:189], v[138:141]
s_waitcnt lgkmcnt(4)
ds_read_b128 v[114:117], v210 offset:25600
s_add_u32 m0, s45, 32896
s_add_u32 s40, s37, 1569792
buffer_load_dwordx4 v216, s[4:7], s40 offen nt lds
v_mfma_f32_16x16x32_bf16 v[138:141], a[224:227], v[122:125], v[138:141]
s_waitcnt vmcnt(12)
ds_read_b64_tr_b16 a[84:85], v110 offset:1536
ds_read_b64_tr_b16 a[108:109], v110 offset:1568
v_mfma_f32_16x16x32_bf16 v[142:145], v[224:227], v[186:189], v[142:145]
s_add_u32 s40, s36, 196224
ds_read_b64_tr_b16 a[132:133], v110 offset:1600
v_and_b32_e64 v216, s44, v208
v_mfma_f32_16x16x32_bf16 v[142:145], a[248:251], v[122:125], v[142:145]
s_or_b32 s44, s43, s51
s_mov_b32 s37, s50
v_mfma_f32_16x16x32_bf16 v[146:149], v[248:251], v[186:189], v[146:149]
s_add_u32 m0, s55, 69888
s_add_u32 s29, s54, 0
buffer_load_dwordx4 v136, s[16:19], s29 offen lds
v_mfma_f32_16x16x32_bf16 v[146:149], v[240:243], v[122:125], v[146:149]
s_waitcnt lgkmcnt(4)
ds_read_b128 v[186:189], v210 offset:29696
ds_read_b128 v[122:125], v210 offset:31744
v_mfma_f32_16x16x32_bf16 v[162:165], a[228:231], v[182:185], v[162:165]
s_waitcnt lgkmcnt(5)
v_mfma_f32_16x16x32_bf16 v[162:165], a[236:239], v[114:117], v[162:165]
s_nop 0
v_mfma_f32_16x16x32_bf16 v[166:169], a[252:255], v[182:185], v[166:169]
s_add_u32 m0, s55, 70912
s_add_u32 s29, s54, 0
buffer_load_dwordx4 v137, s[16:19], s29 offen lds
v_mfma_f32_16x16x32_bf16 v[166:169], v[228:231], v[114:117], v[166:169]
s_waitcnt vmcnt(12)
ds_read_b64_tr_b16 a[86:87], v110 offset:12288
ds_read_b64_tr_b16 a[110:111], v110 offset:12320
v_mfma_f32_16x16x32_bf16 v[170:173], v[244:247], v[182:185], v[170:173]
ds_read_b64_tr_b16 a[134:135], v110 offset:12352
ds_read_b128 v[182:185], v210 offset:20480
v_mfma_f32_16x16x32_bf16 v[170:173], v[252:255], v[114:117], v[170:173]
s_waitcnt lgkmcnt(5)
ds_read_b128 v[114:117], v210 offset:21504
v_cvt_pk_bf16_f32 v84, v162, v163
v_mfma_f32_16x16x32_bf16 v[138:141], a[228:231], v[186:189], v[138:141]
s_waitcnt lgkmcnt(5)
s_add_u32 m0, s55, 71936
s_add_u32 s29, s54, 0
buffer_load_dwordx4 v128, s[16:19], s29 offen lds
v_mfma_f32_16x16x32_bf16 v[138:141], a[236:239], v[122:125], v[138:141]
s_waitcnt vmcnt(12)
ds_read_b64_tr_b16 a[94:95], v110 offset:13824
ds_read_b64_tr_b16 a[118:119], v110 offset:13856
v_mfma_f32_16x16x32_bf16 v[142:145], a[252:255], v[186:189], v[142:145]
ds_read_b64_tr_b16 a[142:143], v110 offset:13888
v_cvt_pk_bf16_f32 v85, v164, v165
v_mfma_f32_16x16x32_bf16 v[142:145], v[228:231], v[122:125], v[142:145]
v_cvt_pk_bf16_f32 v86, v166, v167
v_cvt_pk_bf16_f32 v87, v168, v169
v_mfma_f32_16x16x32_bf16 v[146:149], v[244:247], v[186:189], v[146:149]
s_nop 0
s_add_u32 m0, s55, 82176
s_add_u32 s29, s54, 12288
buffer_load_dwordx4 v136, s[16:19], s29 offen lds
v_mfma_f32_16x16x32_bf16 v[146:149], v[252:255], v[122:125], v[146:149]
s_waitcnt lgkmcnt(4)
ds_read_b128 v[186:189], v210 offset:26624
ds_read_b128 v[122:125], v210 offset:27648
v_mfma_f32_16x16x32_bf16 v[150:153], a[72:75], v[182:185], 0
s_waitcnt lgkmcnt(5)
v_cvt_pk_bf16_f32 v88, v170, v171
v_cvt_pk_bf16_f32 v89, v172, v173
v_mfma_f32_16x16x32_bf16 v[150:153], a[76:79], v[114:117], v[150:153]
s_waitcnt lgkmcnt(2)
v_cvt_pk_bf16_f32 v96, v138, v139
v_cvt_pk_bf16_f32 v97, v140, v141
v_mfma_f32_16x16x32_bf16 v[154:157], a[96:99], v[182:185], 0
s_barrier
v_mfma_f32_16x16x32_bf16 v[154:157], a[100:103], v[114:117], v[154:157]
s_nop 0
s_add_u32 m0, s55, 83200
s_add_u32 s29, s54, 12288
buffer_load_dwordx4 v137, s[16:19], s29 offen lds
v_mfma_f32_16x16x32_bf16 v[158:161], a[120:123], v[182:185], 0
ds_read_b128 v[182:185], v210 offset:24576
v_cvt_pk_bf16_f32 v98, v142, v143
v_mfma_f32_16x16x32_bf16 v[158:161], a[124:127], v[114:117], v[158:161]
s_waitcnt lgkmcnt(2)
ds_read_b128 v[114:117], v210 offset:22528
s_add_u32 m0, s55, 84224
s_add_u32 s29, s54, 12288
buffer_load_dwordx4 v128, s[16:19], s29 offen lds
v_mfma_f32_16x16x32_bf16 v[162:165], a[72:75], v[186:189], 0
s_waitcnt lgkmcnt(2)
v_cvt_pk_bf16_f32 v99, v144, v145
v_cvt_pk_bf16_f32 v100, v146, v147
v_mfma_f32_16x16x32_bf16 v[162:165], a[76:79], v[122:125], v[162:165]
v_cvt_pk_bf16_f32 v101, v148, v149
v_mfma_f32_16x16x32_bf16 v[166:169], a[96:99], v[186:189], 0
ds_read_b128 v[110:113], v210 offset:2048
v_mfma_f32_16x16x32_bf16 v[166:169], a[100:103], v[122:125], v[166:169]
ds_write_b128 v120, v[84:87]
v_mfma_f32_16x16x32_bf16 v[170:173], a[120:123], v[186:189], 0
v_mfma_f32_16x16x32_bf16 v[170:173], a[124:127], v[122:125], v[170:173]
s_waitcnt lgkmcnt(3)
v_mfma_f32_16x16x32_bf16 v[150:153], a[88:91], v[182:185], v[150:153]
s_waitcnt lgkmcnt(2)
ds_read_b128 v[186:189], v210 offset:30720
ds_read_b128 v[122:125], v210 offset:28672
v_mfma_f32_16x16x32_bf16 v[150:153], a[80:83], v[114:117], v[150:153]
ds_write_b64 v120, v[88:89] offset:16
v_mfma_f32_16x16x32_bf16 v[154:157], a[112:115], v[182:185], v[154:157]
v_mfma_f32_16x16x32_bf16 v[154:157], a[104:107], v[114:117], v[154:157]
ds_write_b128 v120, v[60:63] offset:512
v_mfma_f32_16x16x32_bf16 v[158:161], a[136:139], v[182:185], v[158:161]
v_mfma_f32_16x16x32_bf16 v[158:161], a[128:131], v[114:117], v[158:161]
s_waitcnt lgkmcnt(3)
v_mfma_f32_16x16x32_bf16 v[162:165], a[88:91], v[186:189], v[162:165]
s_waitcnt lgkmcnt(2)
ds_read_b128 v[182:185], v210 offset:23552
ds_read_b128 v[114:117], v210 offset:25600
v_mfma_f32_16x16x32_bf16 v[162:165], a[80:83], v[122:125], v[162:165]
ds_write_b64 v120, v[64:65] offset:528
v_mfma_f32_16x16x32_bf16 v[166:169], a[112:115], v[186:189], v[166:169]
buffer_store_dwordx4 v[36:39], v210, s[24:27], s58 offen sc1
s_mov_b64 exec, s[56:57]
ds_write_b128 v120, v[96:99] offset:22784
s_mov_b64 exec, -1
v_mfma_f32_16x16x32_bf16 v[166:169], a[104:107], v[122:125], v[166:169]
v_mfma_f32_16x16x32_bf16 v[170:173], a[136:139], v[186:189], v[170:173]
ds_read_b128 v[186:189], v210 offset:29696
v_mfma_f32_16x16x32_bf16 v[170:173], a[128:131], v[122:125], v[170:173]
ds_read_b128 v[122:125], v210 offset:31744
s_waitcnt lgkmcnt(5)
v_mfma_f32_16x16x32_bf16 v[150:153], a[84:87], v[182:185], v[150:153]
s_waitcnt lgkmcnt(4)
buffer_store_dwordx4 v[40:43], v210, s[24:27], s58 offen offset:1024 sc1
s_mov_b64 exec, s[56:57]
ds_write_b64 v120, v[100:101] offset:22800
s_mov_b64 exec, -1
v_mfma_f32_16x16x32_bf16 v[150:153], a[92:95], v[114:117], v[150:153]
buffer_store_dwordx4 v[44:47], v210, s[24:27], s58 offen offset:2048 sc1
s_mov_b64 exec, s[56:57]
ds_write_b128 v120, v[66:69] offset:23296
s_mov_b64 exec, -1
v_mfma_f32_16x16x32_bf16 v[154:157], a[108:111], v[182:185], v[154:157]
v_cvt_pk_bf16_f32 v90, v150, v151
v_cvt_pk_bf16_f32 v91, v152, v153
v_mfma_f32_16x16x32_bf16 v[154:157], a[116:119], v[114:117], v[154:157]
ds_write_b64 v121, v[90:91]
v_mfma_f32_16x16x32_bf16 v[158:161], a[132:135], v[182:185], v[158:161]
s_nop 0
buffer_store_dwordx4 v[48:51], v210, s[24:27], s59 offen sc1
s_nop 0
v_cvt_pk_bf16_f32 v92, v154, v155
v_cvt_pk_bf16_f32 v93, v156, v157
v_mfma_f32_16x16x32_bf16 v[158:161], a[140:143], v[114:117], v[158:161]
ds_read_b128 v[182:185], v210
s_waitcnt lgkmcnt(5)
v_mfma_f32_16x16x32_bf16 v[162:165], a[84:87], v[186:189], v[162:165]
s_waitcnt lgkmcnt(4)
ds_write_b64 v121, v[92:93] offset:32
v_mfma_f32_16x16x32_bf16 v[162:165], a[92:95], v[122:125], v[162:165]
v_cvt_pk_bf16_f32 v94, v158, v159
v_cvt_pk_bf16_f32 v95, v160, v161
v_mfma_f32_16x16x32_bf16 v[166:169], a[108:111], v[186:189], v[166:169]
ds_write_b64 v121, v[94:95] offset:64
v_mfma_f32_16x16x32_bf16 v[166:169], a[116:119], v[122:125], v[166:169]
v_cvt_pk_bf16_f32 v102, v162, v163
v_cvt_pk_bf16_f32 v103, v164, v165
v_mfma_f32_16x16x32_bf16 v[170:173], a[132:135], v[186:189], v[170:173]
s_nop 0
ds_read_b128 v[186:189], v210 offset:1024
v_mfma_f32_16x16x32_bf16 v[170:173], a[140:143], v[122:125], v[170:173]
s_waitcnt lgkmcnt(3)
v_cvt_pk_bf16_f32 v104, v166, v167
v_cvt_pk_bf16_f32 v105, v168, v169
v_mfma_f32_16x16x32_bf16 v[138:141], a[0:3], v[182:185], 0
s_nop 0
buffer_store_dwordx4 v[52:55], v210, s[24:27], s59 offen offset:1024 sc1
buffer_store_dwordx4 v[56:59], v210, s[24:27], s59 offen offset:2048 sc1
s_nop 0
v_cvt_pk_bf16_f32 v106, v170, v171
v_cvt_pk_bf16_f32 v107, v172, v173
v_mfma_f32_16x16x32_bf16 v[142:145], a[24:27], v[182:185], 0
s_nop 0
s_mov_b64 exec, s[56:57]
ds_write_b64 v121, v[102:103] offset:22784
s_mov_b64 exec, -1
v_mfma_f32_16x16x32_bf16 v[146:149], a[48:51], v[182:185], 0
s_waitcnt lgkmcnt(1)
s_mov_b64 exec, s[56:57]
ds_write_b64 v121, v[104:105] offset:22816
s_mov_b64 exec, -1
v_mfma_f32_16x16x32_bf16 v[146:149], a[52:55], v[186:189], v[146:149]
s_mov_b64 exec, s[56:57]
ds_write_b64 v121, v[106:107] offset:22848
s_mov_b64 exec, -1
v_mfma_f32_16x16x32_bf16 v[138:141], a[4:7], v[186:189], v[138:141]
s_mov_b64 exec, s[56:57]
ds_write_b64 v120, v[70:71] offset:23312
s_mov_b64 exec, -1
v_mfma_f32_16x16x32_bf16 v[142:145], a[28:31], v[186:189], v[142:145]
s_nop 0
v_mfma_f32_16x16x32_bf16 v[150:153], a[216:219], v[182:185], 0
v_mfma_f32_16x16x32_bf16 v[150:153], a[220:223], v[186:189], v[150:153]
v_mfma_f32_16x16x32_bf16 v[154:157], a[240:243], v[182:185], 0
v_mfma_f32_16x16x32_bf16 v[154:157], a[244:247], v[186:189], v[154:157]
v_mfma_f32_16x16x32_bf16 v[158:161], v[232:235], v[182:185], 0
v_mfma_f32_16x16x32_bf16 v[158:161], v[236:239], v[186:189], v[158:161]
v_mfma_f32_16x16x32_bf16 v[162:165], v[182:185], a[72:75], 0
s_waitcnt vmcnt(10)
ds_read_b64_tr_b16 a[144:145], v129
v_mfma_f32_16x16x32_bf16 v[162:165], v[186:189], a[76:79], v[162:165]
s_barrier
v_mfma_f32_16x16x32_bf16 v[166:169], v[182:185], a[96:99], 0
s_nop 0
ds_read_b64_tr_b16 a[168:169], v129 offset:32
ds_read_b64_tr_b16 a[192:193], v129 offset:64
v_mfma_f32_16x16x32_bf16 v[166:169], v[186:189], a[100:103], v[166:169]
s_waitcnt vmcnt(9)
ds_read_b64_tr_b16 a[146:147], v129 offset:1536
ds_read_b64_tr_b16 a[170:171], v129 offset:1568
v_mfma_f32_16x16x32_bf16 v[170:173], v[182:185], a[120:123], 0
s_waitcnt vmcnt(6)
ds_read_b64_tr_b16 a[194:195], v129 offset:1600
ds_read_b64_tr_b16 a[148:149], v129 offset:13824
v_mfma_f32_16x16x32_bf16 v[170:173], v[186:189], a[124:127], v[170:173]
ds_read_b64_tr_b16 a[172:173], v129 offset:13856
ds_read_b64_tr_b16 a[196:197], v129 offset:13888
v_mfma_f32_16x16x32_bf16 v[138:141], a[8:11], v[110:113], v[138:141]
ds_read_b64_tr_b16 a[160:161], v129 offset:12288
ds_read_b64_tr_b16 a[184:185], v129 offset:12320
v_mfma_f32_16x16x32_bf16 v[138:141], a[12:15], v[220:223], v[138:141]
ds_read_b64_tr_b16 a[208:209], v129 offset:12352
ds_read_b128 v[84:87], v200
v_mfma_f32_16x16x32_bf16 v[142:145], a[32:35], v[110:113], v[142:145]
ds_read_b128 v[92:95], v201
ds_read_b128 v[100:103], v202
v_mfma_f32_16x16x32_bf16 v[142:145], a[36:39], v[220:223], v[142:145]
s_waitcnt lgkmcnt(9)
s_add_u32 m0, s55, 69888
s_add_u32 s29, s54, 24576
buffer_load_dwordx4 v136, s[16:19], s29 offen lds
v_mfma_f32_16x16x32_bf16 v[146:149], a[56:59], v[110:113], v[146:149]
s_add_u32 m0, s55, 70912
s_add_u32 s29, s54, 24576
buffer_load_dwordx4 v137, s[16:19], s29 offen lds
v_mfma_f32_16x16x32_bf16 v[146:149], a[60:63], v[220:223], v[146:149]
s_add_u32 m0, s55, 71936
s_add_u32 s29, s54, 24576
buffer_load_dwordx4 v128, s[16:19], s29 offen lds
v_mfma_f32_16x16x32_bf16 v[150:153], a[224:227], v[110:113], v[150:153]
s_waitcnt lgkmcnt(2)
s_add_u32 m0, s55, 82176
s_add_u32 s29, s54, 36864
buffer_load_dwordx4 v136, s[16:19], s29 offen lds
v_mfma_f32_16x16x32_bf16 v[36:39], v[174:177], v[84:87], 0
s_waitcnt lgkmcnt(1)
s_add_u32 m0, s55, 83200
s_add_u32 s29, s54, 36864
buffer_load_dwordx4 v137, s[16:19], s29 offen lds
v_mfma_f32_16x16x32_bf16 v[48:51], v[174:177], v[92:95], 0
s_waitcnt lgkmcnt(0)
s_add_u32 m0, s55, 84224
s_add_u32 s29, s54, 36864
buffer_load_dwordx4 v128, s[16:19], s29 offen lds
v_mfma_f32_16x16x32_bf16 v[60:63], v[174:177], v[100:103], 0
ds_read_b128 v[84:87], v194
ds_read_b128 v[92:95], v195
v_mfma_f32_16x16x32_bf16 v[150:153], a[228:231], v[220:223], v[150:153]
ds_read_b128 v[100:103], v196
ds_read_b128 v[88:91], v194 offset:16
v_mfma_f32_16x16x32_bf16 v[154:157], a[248:251], v[110:113], v[154:157]
ds_read_b128 v[96:99], v195 offset:16
ds_read_b128 v[104:107], v196 offset:16
v_mfma_f32_16x16x32_bf16 v[154:157], a[252:255], v[220:223], v[154:157]
ds_read_b128 v[174:177], v217 offset:1056
v_mfma_f32_16x16x32_bf16 v[158:161], v[240:243], v[110:113], v[158:161]
ds_read_b128 v[182:185], v210 offset:4096
v_mfma_f32_16x16x32_bf16 v[158:161], v[244:247], v[220:223], v[158:161]
ds_read_b128 v[186:189], v210 offset:5120
v_mfma_f32_16x16x32_bf16 v[162:165], v[110:113], a[80:83], v[162:165]
v_mfma_f32_16x16x32_bf16 v[162:165], v[220:223], a[84:87], v[162:165]
s_nop 0
v_mfma_f32_16x16x32_bf16 v[166:169], v[110:113], a[104:107], v[166:169]
s_waitcnt lgkmcnt(5)
v_smfmac_f32_16x16x64_bf16 v[36:39], v[178:181], v[84:91], v213
ds_read_b128 v[84:87], v197
ds_read_b128 v[88:91], v197 offset:16
v_mfma_f32_16x16x32_bf16 v[166:169], v[220:223], a[108:111], v[166:169]
s_waitcnt lgkmcnt(6)
v_smfmac_f32_16x16x64_bf16 v[48:51], v[178:181], v[92:99], v213
s_waitcnt lgkmcnt(5)
ds_read_b128 v[92:95], v198
ds_read_b128 v[96:99], v198 offset:16
v_smfmac_f32_16x16x64_bf16 v[60:63], v[178:181], v[100:107], v213
ds_read_b128 v[100:103], v199
ds_read_b128 v[104:107], v199 offset:16
v_mfma_f32_16x16x32_bf16 v[170:173], v[110:113], a[128:131], v[170:173]
ds_read_b128 v[178:181], v217 offset:1584
ds_read_b128 v[110:113], v210 offset:6144
v_mfma_f32_16x16x32_bf16 v[170:173], v[220:223], a[132:135], v[170:173]
ds_read_b128 v[220:223], v210 offset:7168
s_waitcnt lgkmcnt(10)
v_mfma_f32_16x16x32_bf16 v[138:141], a[16:19], v[182:185], v[138:141]
s_waitcnt lgkmcnt(7)
v_smfmac_f32_16x16x64_bf16 v[36:39], v[174:177], v[84:91], v213
ds_read_b128 v[84:87], v200 offset:32
ds_read_b128 v[88:91], v194 offset:48
v_mfma_f32_16x16x32_bf16 v[138:141], a[20:23], v[186:189], v[138:141]
s_waitcnt lgkmcnt(7)
v_smfmac_f32_16x16x64_bf16 v[48:51], v[174:177], v[92:99], v213
s_nop 0
ds_read_b128 v[92:95], v201 offset:32
ds_read_b128 v[96:99], v195 offset:48
v_mfma_f32_16x16x32_bf16 v[142:145], a[40:43], v[182:185], v[142:145]
v_mul_f32 v119, v36, v36
v_add_f32 v118, v36, v37
v_mfma_f32_16x16x32_bf16 v[142:145], a[44:47], v[186:189], v[142:145]
s_waitcnt lgkmcnt(7)
v_mul_f32 v127, v48, v48
v_add_f32_e64 v126, v48, v49
v_smfmac_f32_16x16x64_bf16 v[60:63], v[174:177], v[100:107], v213
ds_read_b128 v[100:103], v202 offset:32
ds_read_b128 v[174:177], v217 offset:2112
v_mfma_f32_16x16x32_bf16 v[146:149], a[64:67], v[182:185], v[146:149]
ds_read_b128 v[104:107], v196 offset:48
v_fmac_f32_e64 v119, v37, v37
v_mfma_f32_16x16x32_bf16 v[146:149], a[68:71], v[186:189], v[146:149]
v_mul_f32 v135, v60, v60
v_add_f32 v134, v60, v61
v_mfma_f32_16x16x32_bf16 v[150:153], a[232:235], v[182:185], v[150:153]
s_waitcnt lgkmcnt(6)
v_fmac_f32 v135, v61, v61
v_fmac_f32_e64 v127, v49, v49
v_mfma_f32_16x16x32_bf16 v[40:43], v[178:181], v[84:87], 0
ds_read_b128 v[84:87], v194 offset:32
v_add_f32_e64 v134, v134, v62
v_mfma_f32_16x16x32_bf16 v[150:153], a[236:239], v[186:189], v[150:153]
s_waitcnt lgkmcnt(5)
v_fmac_f32 v135, v62, v62
v_cvt_pk_bf16_f32 v78, v138, v139
v_mfma_f32_16x16x32_bf16 v[52:55], v[178:181], v[92:95], 0
ds_read_b128 v[92:95], v195 offset:32
v_cvt_pk_bf16_f32 v79, v140, v141
v_mfma_f32_16x16x32_bf16 v[154:157], v[224:227], v[182:185], v[154:157]
s_waitcnt lgkmcnt(4)
v_add_f32 v118, v118, v38
v_add_f32_e64 v126, v126, v50
v_mfma_f32_16x16x32_bf16 v[64:67], v[178:181], v[100:103], 0
ds_read_b128 v[100:103], v196 offset:32
ds_read_b128 v[178:181], v217 offset:2640
v_mfma_f32_16x16x32_bf16 v[154:157], v[228:231], v[186:189], v[154:157]
v_fmac_f32_e64 v119, v38, v38
v_fmac_f32 v127, v50, v50
v_mfma_f32_16x16x32_bf16 v[158:161], v[248:251], v[182:185], v[158:161]
s_waitcnt vmcnt(4) lgkmcnt(3)
ds_read_b64_tr_b16 a[150:151], v129
ds_read_b64_tr_b16 a[174:175], v129 offset:32
v_smfmac_f32_16x16x64_bf16 v[40:43], v[174:177], v[84:91], v213
ds_read_b64_tr_b16 a[198:199], v129 offset:64
ds_read_b128 v[84:87], v197 offset:32
v_mfma_f32_16x16x32_bf16 v[158:161], v[252:255], v[186:189], v[158:161]
s_waitcnt lgkmcnt(6)
ds_read_b128 v[88:91], v197 offset:48
v_add_f32 v134, v134, v63
v_smfmac_f32_16x16x64_bf16 v[52:55], v[174:177], v[92:99], v213
s_nop 0
ds_read_b128 v[92:95], v198 offset:32
ds_read_b128 v[96:99], v198 offset:48
v_mfma_f32_16x16x32_bf16 v[162:165], v[182:185], a[88:91], v[162:165]
s_waitcnt vmcnt(3) lgkmcnt(8)
ds_read_b64_tr_b16 a[162:163], v129 offset:1536
ds_read_b64_tr_b16 a[186:187], v129 offset:1568
v_smfmac_f32_16x16x64_bf16 v[64:67], v[174:177], v[100:107], v213
ds_read_b64_tr_b16 a[210:211], v129 offset:1600
ds_read_b128 v[100:103], v199 offset:32
v_mfma_f32_16x16x32_bf16 v[162:165], v[186:189], a[92:95], v[162:165]
ds_read_b128 v[104:107], v199 offset:48
ds_read_b128 v[174:177], v217 offset:3168
v_mfma_f32_16x16x32_bf16 v[166:169], v[182:185], a[112:115], v[166:169]
v_fmac_f32 v135, v63, v63
v_add_f32 v118, v118, v39
v_mfma_f32_16x16x32_bf16 v[166:169], v[186:189], a[116:119], v[166:169]
s_waitcnt lgkmcnt(8)
v_add_f32 v126, v126, v51
v_fmac_f32_e64 v119, v39, v39
v_smfmac_f32_16x16x64_bf16 v[40:43], v[178:181], v[84:91], v213
ds_read_b128 v[84:87], v200 offset:64
ds_read_b128 v[88:91], v194 offset:80
v_mfma_f32_16x16x32_bf16 v[170:173], v[182:185], a[136:139], v[170:173]
s_waitcnt lgkmcnt(8)
ds_read_b128 v[182:185], v210 offset:8192
v_fmac_f32 v127, v51, v51
v_smfmac_f32_16x16x64_bf16 v[52:55], v[178:181], v[92:99], v213
ds_read_b128 v[92:95], v201 offset:64
ds_read_b128 v[96:99], v195 offset:80
v_mfma_f32_16x16x32_bf16 v[170:173], v[186:189], a[140:143], v[170:173]
s_waitcnt lgkmcnt(8)
s_add_u32 m0, s55, 69888
s_add_u32 s29, s54, 49152
buffer_load_dwordx4 v136, s[16:19], s29 offen lds
v_mfma_f32_16x16x32_bf16 v[138:141], a[0:3], v[110:113], 0
s_waitcnt lgkmcnt(6)
s_add_u32 m0, s55, 70912
s_add_u32 s29, s54, 49152
buffer_load_dwordx4 v137, s[16:19], s29 offen lds
v_smfmac_f32_16x16x64_bf16 v[64:67], v[178:181], v[100:107], v213
s_add_u32 m0, s55, 71936
s_add_u32 s29, s54, 49152
buffer_load_dwordx4 v128, s[16:19], s29 offen lds
s_waitcnt lgkmcnt(4)
v_mfma_f32_16x16x32_bf16 v[44:47], v[174:177], v[84:87], 0
s_waitcnt vmcnt(4)
ds_read_b64_tr_b16 a[152:153], v129 offset:12288
ds_read_b64_tr_b16 a[176:177], v129 offset:12320
v_mfma_f32_16x16x32_bf16 v[138:141], a[4:7], v[220:223], v[138:141]
s_waitcnt vmcnt(3) lgkmcnt(4)
ds_read_b64_tr_b16 a[200:201], v129 offset:12352
ds_read_b64_tr_b16 a[154:155], v129 offset:13824
v_mfma_f32_16x16x32_bf16 v[138:141], a[8:11], v[182:185], v[138:141]
s_waitcnt lgkmcnt(5)
ds_read_b64_tr_b16 a[178:179], v129 offset:13856
ds_read_b64_tr_b16 a[202:203], v129 offset:13888
v_mfma_f32_16x16x32_bf16 v[56:59], v[174:177], v[92:95], 0
ds_read_b128 v[100:103], v202 offset:64
ds_read_b128 v[178:181], v217 offset:3696
v_add_f32 v134, v134, v64
ds_read_b128 v[84:87], v194 offset:64
ds_read_b128 v[92:95], v195 offset:64
v_fmac_f32 v135, v64, v64
ds_read_b128 v[104:107], v196 offset:80
ds_read_b128 v[186:189], v210 offset:9216
v_add_f32 v118, v118, v40
v_fmac_f32 v119, v40, v40
v_add_f32 v126, v126, v52
v_fmac_f32 v127, v52, v52
v_add_f32 v134, v134, v65
v_fmac_f32 v135, v65, v65
s_waitcnt lgkmcnt(6)
s_add_u32 m0, s55, 82176
s_add_u32 s29, s54, 61440
buffer_load_dwordx4 v136, s[16:19], s29 offen lds
s_waitcnt lgkmcnt(5)
v_mfma_f32_16x16x32_bf16 v[68:71], v[174:177], v[100:103], 0
s_add_u32 m0, s55, 83200
s_add_u32 s29, s54, 61440
buffer_load_dwordx4 v137, s[16:19], s29 offen lds
s_add_u32 m0, s55, 84224
s_add_u32 s29, s54, 61440
buffer_load_dwordx4 v128, s[16:19], s29 offen lds
s_waitcnt lgkmcnt(3)
v_smfmac_f32_16x16x64_bf16 v[44:47], v[178:181], v[84:91], v213
s_waitcnt lgkmcnt(2)
ds_read_b128 v[100:103], v196 offset:64
ds_read_b128 v[174:177], v217 offset:4224
v_smfmac_f32_16x16x64_bf16 v[56:59], v[178:181], v[92:99], v213
s_waitcnt lgkmcnt(2)
ds_read_b128 v[84:87], v197 offset:64
ds_read_b128 v[88:91], v197 offset:80
v_mfma_f32_16x16x32_bf16 v[138:141], a[12:15], v[186:189], v[138:141]
s_add_u32 m0, s45, 0
ds_read_b128 v[92:95], v198 offset:64
ds_read_b128 v[96:99], v198 offset:80
v_add_f32 v118, v118, v41
v_fmac_f32 v119, v41, v41
v_add_f32 v126, v126, v53
v_fmac_f32 v127, v53, v53
v_add_f32 v134, v134, v66
v_fmac_f32 v135, v66, v66
v_add_f32 v118, v118, v42
v_fmac_f32 v119, v42, v42
v_add_f32 v126, v126, v54
v_fmac_f32 v127, v54, v54
v_add_f32 v134, v134, v67
v_fmac_f32 v135, v67, v67
v_add_f32 v118, v118, v43
v_fmac_f32 v119, v43, v43
s_waitcnt lgkmcnt(5)
v_smfmac_f32_16x16x64_bf16 v[68:71], v[178:181], v[100:107], v213
s_add_u32 s29, s38, s61
ds_read_b128 v[100:103], v199 offset:64
ds_read_b128 v[104:107], v199 offset:80
v_add_f32 v126, v126, v55
v_fmac_f32 v127, v55, v55
v_cvt_pk_bf16_f32 v80, v142, v143
v_cvt_pk_bf16_f32 v81, v144, v145
v_mfma_f32_16x16x32_bf16 v[142:145], a[24:27], v[110:113], 0
s_waitcnt lgkmcnt(4)
v_cvt_pk_bf16_f32 v82, v146, v147
v_cvt_pk_bf16_f32 v83, v148, v149
v_smfmac_f32_16x16x64_bf16 v[44:47], v[174:177], v[84:91], v213
v_cvt_pk_bf16_f32 v72, v150, v151
v_mfma_f32_16x16x32_bf16 v[142:145], a[28:31], v[220:223], v[142:145]
s_waitcnt lgkmcnt(2)
v_cvt_pk_bf16_f32 v73, v152, v153
v_cvt_pk_bf16_f32 v74, v154, v155
v_smfmac_f32_16x16x64_bf16 v[56:59], v[174:177], v[92:99], v213
v_add_f32_e64 v118, v118, v44
v_mfma_f32_16x16x32_bf16 v[146:149], a[48:51], v[110:113], 0
v_fmac_f32 v119, v44, v44
v_add_f32 v118, v118, v45
v_mfma_f32_16x16x32_bf16 v[146:149], a[52:55], v[220:223], v[146:149]
s_waitcnt lgkmcnt(0)
v_add_f32 v126, v126, v56
v_fmac_f32_e64 v127, v56, v56
v_smfmac_f32_16x16x64_bf16 v[68:71], v[174:177], v[100:107], v213
v_fmac_f32_e64 v119, v45, v45
v_mfma_f32_16x16x32_bf16 v[150:153], a[216:219], v[110:113], 0
v_add_f32 v126, v126, v57
v_fmac_f32 v127, v57, v57
v_mfma_f32_16x16x32_bf16 v[150:153], a[220:223], v[220:223], v[150:153]
v_add_f32 v134, v134, v68
v_fmac_f32 v135, v68, v68
v_mfma_f32_16x16x32_bf16 v[150:153], a[224:227], v[182:185], v[150:153]
v_add_f32 v134, v134, v69
v_fmac_f32 v135, v69, v69
v_mfma_f32_16x16x32_bf16 v[150:153], a[228:231], v[186:189], v[150:153]
v_add_f32 v134, v134, v70
v_fmac_f32 v135, v70, v70
v_mfma_f32_16x16x32_bf16 v[142:145], a[32:35], v[182:185], v[142:145]
v_add_f32 v118, v118, v46
v_fmac_f32 v119, v46, v46
v_mfma_f32_16x16x32_bf16 v[142:145], a[36:39], v[186:189], v[142:145]
v_add_f32 v126, v126, v58
v_fmac_f32 v127, v58, v58
v_mfma_f32_16x16x32_bf16 v[146:149], a[56:59], v[182:185], v[146:149]
v_add_f32_e64 v134, v134, v71
v_fmac_f32 v135, v71, v71
v_mfma_f32_16x16x32_bf16 v[146:149], a[60:63], v[186:189], v[146:149]
s_waitcnt vmcnt(4)
ds_read_b64_tr_b16 a[164:165], v129
ds_read_b64_tr_b16 a[188:189], v129 offset:32
v_add_f32 v118, v118, v47
ds_read_b64_tr_b16 a[212:213], v129 offset:64
v_fmac_f32 v119, v47, v47
v_add_f32_e64 v126, v126, v59
v_fmac_f32 v127, v59, v59
v_permlane16_swap_b32 v134, v135
v_permlane16_swap_b32 v118, v119
v_permlane16_swap_b32 v126, v127
v_add_f32 v134, v134, v135
s_waitcnt vmcnt(3)
ds_read_b64_tr_b16 a[156:157], v129 offset:1536
ds_read_b64_tr_b16 a[180:181], v129 offset:1568
v_add_f32 v118, v118, v119
ds_read_b64_tr_b16 a[204:205], v129 offset:1600
v_add_f32 v126, v126, v127
v_mov_b32_e64 v135, v134
v_cvt_pk_bf16_f32 v75, v156, v157
v_mfma_f32_16x16x32_bf16 v[154:157], a[240:243], v[110:113], 0
v_permlane32_swap_b32 v118, v126
v_mfma_f32_16x16x32_bf16 v[154:157], a[244:247], v[220:223], v[154:157]
v_permlane32_swap_b32 v134, v135
v_mfma_f32_16x16x32_bf16 v[154:157], a[248:251], v[182:185], v[154:157]
v_add_f32 v118, v118, v126
v_add_f32 v134, v134, v135
v_mfma_f32_16x16x32_bf16 v[154:157], a[252:255], v[186:189], v[154:157]
ds_write_b32 v209, v118
v_cvt_pk_bf16_f32 v76, v158, v159
v_cvt_pk_bf16_f32 v77, v160, v161
v_mfma_f32_16x16x32_bf16 v[158:161], v[232:235], v[110:113], 0
s_nop 0
ds_write_b32 v209, v134 offset:512
v_mfma_f32_16x16x32_bf16 v[158:161], v[236:239], v[220:223], v[158:161]
s_waitcnt vmcnt(1)
ds_read_b64_tr_b16 a[158:159], v129 offset:12288
ds_read_b64_tr_b16 a[182:183], v129 offset:12320
v_mfma_f32_16x16x32_bf16 v[158:161], v[240:243], v[182:185], v[158:161]
ds_read_b64_tr_b16 a[206:207], v129 offset:12352
v_cvt_pk_bf16_f32 v114, v162, v163
v_mfma_f32_16x16x32_bf16 v[158:161], v[244:247], v[186:189], v[158:161]
v_cvt_pk_bf16_f32 v115, v164, v165
v_cvt_pk_bf16_f32 v122, v166, v167
v_mfma_f32_16x16x32_bf16 v[162:165], v[110:113], a[72:75], 0
v_cvt_pk_bf16_f32 v123, v168, v169
v_cvt_pk_bf16_f32 v130, v170, v171
v_mfma_f32_16x16x32_bf16 v[162:165], v[220:223], a[76:79], v[162:165]
s_nop 0
v_cvt_pk_bf16_f32 v131, v172, v173
v_mfma_f32_16x16x32_bf16 v[166:169], v[110:113], a[96:99], 0
s_waitcnt vmcnt(0)
ds_read_b64_tr_b16 a[166:167], v129 offset:13824
ds_read_b64_tr_b16 a[190:191], v129 offset:13856
v_mfma_f32_16x16x32_bf16 v[166:169], v[220:223], a[100:103], v[166:169]
ds_read_b64_tr_b16 a[214:215], v129 offset:13888
v_mfma_f32_16x16x32_bf16 v[170:173], v[110:113], a[120:123], 0
ds_read_b128 v[110:113], v210 offset:10240
v_mfma_f32_16x16x32_bf16 v[170:173], v[220:223], a[124:127], v[170:173]
v_mfma_f32_16x16x32_bf16 v[170:173], v[182:185], a[128:131], v[170:173]
v_mfma_f32_16x16x32_bf16 v[170:173], v[186:189], a[132:135], v[170:173]
v_mfma_f32_16x16x32_bf16 v[162:165], v[182:185], a[80:83], v[162:165]
s_waitcnt lgkmcnt(1)
s_barrier
v_mfma_f32_16x16x32_bf16 v[162:165], v[186:189], a[84:87], v[162:165]
s_nop 0
ds_read_b128 v[102:105], v210 offset:18432
ds_read_b128 v[106:109], v210 offset:19456
v_mfma_f32_16x16x32_bf16 v[166:169], v[182:185], a[104:107], v[166:169]
s_waitcnt lgkmcnt(2)
buffer_load_dwordx4 v216, s[4:7], s52 offen nt lds
v_mfma_f32_16x16x32_bf16 v[166:169], v[186:189], a[108:111], v[166:169]
s_add_u32 m0, s45, 4112
ds_read_b128 v[182:185], v210 offset:12288
ds_read_b128 v[186:189], v210 offset:13312
v_mfma_f32_16x16x32_bf16 v[138:141], a[16:19], v[110:113], v[138:141]
s_add_u32 s52, s50, s41
v_mfma_f32_16x16x32_bf16 v[142:145], a[40:43], v[110:113], v[142:145]
v_mfma_f32_16x16x32_bf16 v[146:149], a[64:67], v[110:113], v[146:149]
s_waitcnt lgkmcnt(3)
v_add_f32_e64 v102, v102, v103
v_mfma_f32_16x16x32_bf16 v[150:153], a[232:235], v[110:113], v[150:153]
v_add_f32 v104, v104, v105
v_add_f32 v102, v102, v104
v_mfma_f32_16x16x32_bf16 v[154:157], v[224:227], v[110:113], v[154:157]
s_waitcnt lgkmcnt(2)
v_add_f32 v106, v106, v107
v_add_f32_e64 v108, v108, v109
v_mfma_f32_16x16x32_bf16 v[158:161], v[248:251], v[110:113], v[158:161]
buffer_load_dwordx4 v216, s[4:7], s40 offen nt lds
v_mfma_f32_16x16x32_bf16 v[162:165], v[110:113], a[88:91], v[162:165]
s_add_u32 m0, s45, 8224
v_add_f32 v106, v106, v108
v_mul_f32 v103, s48, v102
v_mfma_f32_16x16x32_bf16 v[166:169], v[110:113], a[112:115], v[166:169]
s_add_u32 s40, s36, 392448
v_mul_f32 v104, s73, v102
v_mul_f32 v106, s73, v106
v_mfma_f32_16x16x32_bf16 v[170:173], v[110:113], a[136:139], v[170:173]
v_fma_f32 v106, -v103, v104, v106
v_max_f32 v106, 0, v106
v_add_f32 v106, s49, v106
v_rsq_f32_e64 v102, v106
ds_read_b128 v[106:109], v210 offset:11264
ds_read_b64 v[112:113], v215 offset:528
v_mul_f32_e64 v103, -v103, v102
ds_write_b64 v211, v[102:103] offset:20480
buffer_load_dwordx4 v216, s[4:7], s40 offen nt lds
s_add_u32 m0, s45, 12336
s_add_u32 s40, s36, 588672
ds_read_b64 v[118:119], v219 offset:20480
ds_read_b64 v[126:127], v219 offset:20736
s_waitcnt lgkmcnt(4)
v_mfma_f32_16x16x32_bf16 v[138:141], a[20:23], v[106:109], v[138:141]
s_nop 0
ds_read_b64 v[134:135], v219 offset:20992
v_mfma_f32_16x16x32_bf16 v[142:145], a[44:47], v[106:109], v[142:145]
v_mfma_f32_16x16x32_bf16 v[146:149], a[68:71], v[106:109], v[146:149]
v_cvt_pk_bf16_f32 v96, v138, v139
v_cvt_pk_bf16_f32 v97, v140, v141
v_mfma_f32_16x16x32_bf16 v[150:153], a[236:239], v[106:109], v[150:153]
v_cvt_pk_bf16_f32 v98, v142, v143
v_cvt_pk_bf16_f32 v99, v144, v145
v_mfma_f32_16x16x32_bf16 v[154:157], v[228:231], v[106:109], v[154:157]
buffer_load_dwordx4 v216, s[4:7], s40 offen nt lds
v_mfma_f32_16x16x32_bf16 v[158:161], v[252:255], v[106:109], v[158:161]
s_add_u32 m0, s45, 16448
v_cvt_pk_bf16_f32 v84, v150, v151
v_cvt_pk_bf16_f32 v85, v152, v153
v_mfma_f32_16x16x32_bf16 v[162:165], v[106:109], a[92:95], v[162:165]
s_add_u32 s40, s36, 784896
v_cvt_pk_bf16_f32 v100, v146, v147
v_cvt_pk_bf16_f32 v101, v148, v149
v_mfma_f32_16x16x32_bf16 v[166:169], v[106:109], a[116:119], v[166:169]
v_cvt_pk_bf16_f32 v88, v158, v159
v_cvt_pk_bf16_f32 v89, v160, v161
v_mfma_f32_16x16x32_bf16 v[170:173], v[106:109], a[140:143], v[170:173]
s_nop 0
ds_read_b128 v[108:111], v215 offset:512
v_cvt_pk_bf16_f32 v86, v154, v155
v_mfma_f32_16x16x32_bf16 v[138:141], a[0:3], v[182:185], 0
s_waitcnt lgkmcnt(3)
v_cvt_pk_bf16_f32 v87, v156, v157
v_fma_f32 v220, v36, v118, v119
v_mfma_f32_16x16x32_bf16 v[138:141], a[4:7], v[186:189], v[138:141]
v_cvt_pk_bf16_f32 v132, v170, v171
v_cvt_pk_bf16_f32 v133, v172, v173
v_mfma_f32_16x16x32_bf16 v[142:145], a[24:27], v[182:185], 0
buffer_load_dwordx4 v216, s[4:7], s40 offen nt lds
v_mfma_f32_16x16x32_bf16 v[142:145], a[28:31], v[186:189], v[142:145]
s_add_u32 m0, s45, 20560
ds_read_b128 v[170:173], v210 offset:14336
v_fma_f32 v221, v37, v118, v119
v_mfma_f32_16x16x32_bf16 v[146:149], a[48:51], v[182:185], 0
s_add_u32 s40, s36, 981120
ds_read_b128 v[182:185], v210 offset:15360
v_fma_f32 v222, v38, v118, v119
v_mfma_f32_16x16x32_bf16 v[146:149], a[52:55], v[186:189], v[146:149]
s_waitcnt lgkmcnt(2)
ds_read_b128 v[186:189], v210 offset:16384
v_fma_f32 v223, v39, v118, v119
v_mfma_f32_16x16x32_bf16 v[150:153], v[108:111], v[72:75], v[206:209]
s_nop 0
v_cvt_pk_bf16_f32 v90, v220, v221
v_cvt_pk_bf16_f32 v91, v222, v223
v_fma_f32 v220, v40, v118, v119
v_mfma_f32_16x16x16_bf16 v[154:157], v[82:83], v[88:89], 0
v_fma_f32 v221, v41, v118, v119
v_fma_f32 v222, v42, v118, v119
v_fma_f32 v223, v43, v118, v119
v_mfma_f32_16x16x16_bf16 v[158:161], v[100:101], v[88:89], 0
v_cvt_pk_bf16_f32 v92, v220, v221
v_cvt_pk_bf16_f32 v93, v222, v223
v_fma_f32 v220, v44, v118, v119
s_waitcnt lgkmcnt(2)
v_mfma_f32_16x16x32_bf16 v[138:141], a[8:11], v[170:173], v[138:141]
s_waitcnt lgkmcnt(1)
buffer_load_dwordx4 v216, s[4:7], s40 offen nt lds
v_mfma_f32_16x16x32_bf16 v[138:141], a[12:15], v[182:185], v[138:141]
ds_write_b128 v211, v[90:93] offset:20480
v_mfma_f32_16x16x32_bf16 v[142:145], a[32:35], v[170:173], v[142:145]
s_add_u32 m0, s45, 24672
v_fma_f32 v221, v45, v118, v119
v_fma_f32 v222, v46, v118, v119
v_mfma_f32_16x16x32_bf16 v[142:145], a[36:39], v[182:185], v[142:145]
s_add_u32 s40, s36, 1177344
v_fma_f32 v223, v47, v118, v119
v_cvt_pk_bf16_f32 v94, v220, v221
v_mfma_f32_16x16x32_bf16 v[146:149], a[56:59], v[170:173], v[146:149]
ds_read_b128 v[170:173], v210 offset:17408
v_cvt_pk_bf16_f32 v95, v222, v223
v_mfma_f32_16x16x32_bf16 v[146:149], a[60:63], v[182:185], v[146:149]
s_nop 0
ds_read_b128 v[182:185], v210 offset:12288
v_fma_f32 v220, v48, v126, v127
v_mfma_f32_16x16x32_bf16 v[154:157], v[78:81], v[84:87], v[154:157]
s_waitcnt lgkmcnt(3)
ds_write_b64 v212, v[94:95] offset:20480
v_mfma_f32_16x16x16_bf16 v[150:153], v[112:113], v[76:77], v[150:153]
buffer_load_dwordx4 v216, s[4:7], s40 offen nt lds
v_fma_f32 v221, v49, v126, v127
v_fma_f32 v222, v50, v126, v127
v_mfma_f32_16x16x32_bf16 v[158:161], v[96:99], v[84:87], v[158:161]
s_add_u32 m0, s45, 28784
v_fma_f32 v223, v51, v126, v127
v_cvt_pk_bf16_f32 v174, v220, v221
v_mfma_f32_16x16x32_bf16 v[138:141], a[16:19], v[186:189], v[138:141]
s_waitcnt lgkmcnt(2)
v_cvt_pk_bf16_f32 v175, v222, v223
v_fma_f32 v220, v52, v126, v127
v_mfma_f32_16x16x32_bf16 v[138:141], a[20:23], v[170:173], v[138:141]
s_waitcnt lgkmcnt(1)
v_fma_f32 v221, v53, v126, v127
v_fma_f32 v222, v54, v126, v127
v_mfma_f32_16x16x32_bf16 v[118:121], v[182:185], a[72:75], 0
s_add_u32 s40, s36, 1373568
v_fma_f32 v223, v55, v126, v127
v_cvt_pk_bf16_f32 v176, v220, v221
v_mfma_f32_16x16x32_bf16 v[142:145], a[40:43], v[186:189], v[142:145]
v_cvt_pk_bf16_f32 v102, v138, v139
v_cvt_pk_bf16_f32 v103, v140, v141
v_mfma_f32_16x16x32_bf16 v[138:141], v[78:81], v[72:75], 0
v_cvt_pk_bf16_f32 v177, v222, v223
v_fma_f32 v220, v56, v126, v127
v_mfma_f32_16x16x32_bf16 v[142:145], a[44:47], v[170:173], v[142:145]
ds_write_b128 v211, v[174:177] offset:26624
v_mfma_f32_16x16x16_bf16 v[138:141], v[82:83], v[76:77], v[138:141]
buffer_load_dwordx4 v216, s[4:7], s40 offen nt lds
v_cvt_pk_bf16_f32 v104, v142, v143
v_cvt_pk_bf16_f32 v105, v144, v145
v_mfma_f32_16x16x32_bf16 v[142:145], v[96:99], v[72:75], 0
s_add_u32 m0, s45, 32896
v_fma_f32 v221, v57, v126, v127
v_fma_f32 v222, v58, v126, v127
v_mfma_f32_16x16x32_bf16 v[146:149], a[64:67], v[186:189], v[146:149]
s_add_u32 s40, s36, 1569792
ds_read_b128 v[186:189], v210 offset:13312
ds_read_b128 v[174:177], v210 offset:14336
v_mfma_f32_16x16x16_bf16 v[142:145], v[100:101], v[76:77], v[142:145]
v_fma_f32 v223, v59, v126, v127
v_cvt_pk_bf16_f32 v124, v166, v167
v_cvt_pk_bf16_f32 v125, v168, v169
v_mfma_f32_16x16x16_bf16 v[166:169], v[112:113], v[88:89], v[206:209]
v_cvt_pk_bf16_f32 v178, v220, v221
v_cvt_pk_bf16_f32 v179, v222, v223
v_fma_f32 v220, v60, v134, v135
v_fma_f32 v221, v61, v134, v135
v_mfma_f32_16x16x32_bf16 v[126:129], v[182:185], a[96:99], 0
ds_write_b64 v212, v[178:179] offset:26624
v_mfma_f32_16x16x32_bf16 v[166:169], v[108:111], v[84:87], v[166:169]
s_nop 0
buffer_load_dwordx4 v216, s[4:7], s40 offen nt lds
v_mfma_f32_16x16x32_bf16 v[146:149], a[68:71], v[170:173], v[146:149]
s_waitcnt lgkmcnt(2)
ds_read_b128 v[178:181], v210 offset:15360
v_fma_f32 v222, v62, v134, v135
v_mfma_f32_16x16x32_bf16 v[118:121], v[186:189], a[76:79], v[118:121]
s_nop 0
v_fma_f32 v223, v63, v134, v135
v_cvt_pk_bf16_f32 v90, v220, v221
v_mfma_f32_16x16x32_bf16 v[126:129], v[186:189], a[100:103], v[126:129]
s_add_u32 m0, s45, 0
v_cvt_pk_bf16_f32 v106, v146, v147
v_cvt_pk_bf16_f32 v107, v148, v149
v_mfma_f32_16x16x32_bf16 v[146:149], v[102:105], v[72:75], 0
s_add_u32 s40, s37, 196224
v_cvt_pk_bf16_f32 v91, v222, v223
v_fma_f32 v220, v64, v134, v135
v_mfma_f32_16x16x32_bf16 v[170:173], a[240:243], v[182:185], 0
v_fma_f32 v221, v65, v134, v135
v_fma_f32 v222, v66, v134, v135
v_mfma_f32_16x16x32_bf16 v[170:173], a[244:247], v[186:189], v[170:173]
s_waitcnt lgkmcnt(2)
v_fma_f32 v223, v67, v134, v135
v_cvt_pk_bf16_f32 v92, v220, v221
v_mfma_f32_16x16x32_bf16 v[118:121], v[174:177], a[80:83], v[118:121]
s_waitcnt lgkmcnt(0)
v_cvt_pk_bf16_f32 v93, v222, v223
v_fma_f32 v220, v68, v134, v135
v_mfma_f32_16x16x32_bf16 v[118:121], v[178:181], a[84:87], v[118:121]
ds_write_b128 v211, v[90:93] offset:32768
v_mfma_f32_16x16x32_bf16 v[90:93], a[216:219], v[182:185], 0
v_fma_f32 v221, v69, v134, v135
v_fma_f32 v222, v70, v134, v135
v_mfma_f32_16x16x32_bf16 v[90:93], a[220:223], v[186:189], v[90:93]
v_fma_f32 v223, v71, v134, v135
v_cvt_pk_bf16_f32 v116, v162, v163
v_mfma_f32_16x16x32_bf16 v[134:137], v[182:185], a[120:123], 0
v_cvt_pk_bf16_f32 v117, v164, v165
v_cvt_pk_bf16_f32 v94, v220, v221
v_mfma_f32_16x16x32_bf16 v[134:137], v[186:189], a[124:127], v[134:137]
v_exp_f32 v138, v138
v_mfma_f32_16x16x16_bf16 v[162:165], v[106:107], v[88:89], 0
v_exp_f32 v139, v139
v_cvt_pk_bf16_f32 v95, v222, v223
v_mfma_f32_16x16x16_bf16 v[146:149], v[106:107], v[76:77], v[146:149]
v_exp_f32 v140, v140
v_exp_f32 v141, v141
v_mfma_f32_16x16x32_bf16 v[220:223], v[232:235], v[182:185], 0
ds_read_b128 v[182:185], v210 offset:16384
ds_read_b64 v[76:77], v215 offset:16
v_mfma_f32_16x16x32_bf16 v[220:223], v[236:239], v[186:189], v[220:223]
ds_read_b128 v[186:189], v210 offset:17408
ds_read_b128 v[72:75], v215
v_mfma_f32_16x16x32_bf16 v[126:129], v[174:177], a[104:107], v[126:129]
v_exp_f32 v142, v142
v_mfma_f32_16x16x32_bf16 v[126:129], v[178:181], a[108:111], v[126:129]
v_exp_f32 v143, v143
v_mfma_f32_16x16x32_bf16 v[134:137], v[174:177], a[128:131], v[134:137]
v_exp_f32 v144, v144
v_mfma_f32_16x16x32_bf16 v[134:137], v[178:181], a[132:135], v[134:137]
v_exp_f32 v145, v145
v_mfma_f32_16x16x32_bf16 v[90:93], a[224:227], v[174:177], v[90:93]
v_exp_f32 v154, v154
v_mfma_f32_16x16x32_bf16 v[90:93], a[228:231], v[178:181], v[90:93]
v_exp_f32 v155, v155
v_mfma_f32_16x16x32_bf16 v[170:173], a[248:251], v[174:177], v[170:173]
v_exp_f32 v156, v156
v_mfma_f32_16x16x32_bf16 v[170:173], a[252:255], v[178:181], v[170:173]
v_exp_f32 v157, v157
v_mfma_f32_16x16x32_bf16 v[220:223], v[240:243], v[174:177], v[220:223]
v_exp_f32 v158, v158
v_mfma_f32_16x16x32_bf16 v[220:223], v[244:247], v[178:181], v[220:223]
v_exp_f32 v159, v159
v_mfma_f32_16x16x32_bf16 v[162:165], v[102:105], v[84:87], v[162:165]
s_waitcnt lgkmcnt(3)
v_exp_f32 v160, v160
v_mfma_f32_16x16x32_bf16 v[118:121], v[182:185], a[88:91], v[118:121]
s_waitcnt lgkmcnt(1)
v_exp_f32 v161, v161
v_mfma_f32_16x16x32_bf16 v[118:121], v[186:189], a[92:95], v[118:121]
v_exp_f32_e64 v150, v150
v_mfma_f32_16x16x32_bf16 v[126:129], v[182:185], a[112:115], v[126:129]
v_cvt_pk_bf16_f32 v174, v138, v139
v_cvt_pk_bf16_f32 v175, v140, v141
v_mfma_f32_16x16x32_bf16 v[126:129], v[186:189], a[116:119], v[126:129]
v_cvt_pk_bf16_f32 v176, v142, v143
v_cvt_pk_bf16_f32 v177, v144, v145
v_mfma_f32_16x16x32_bf16 v[134:137], v[182:185], a[136:139], v[134:137]
v_exp_f32 v166, v166
v_mfma_f32_16x16x32_bf16 v[134:137], v[186:189], a[140:143], v[134:137]
v_cvt_pk_bf16_f32 v180, v150, 0
v_mov_b32 v181, 0
v_mfma_f32_16x16x32_bf16 v[90:93], a[232:235], v[182:185], v[90:93]
v_exp_f32 v146, v146
v_mfma_f32_16x16x32_bf16 v[90:93], a[236:239], v[186:189], v[90:93]
v_exp_f32 v147, v147
v_mfma_f32_16x16x32_bf16 v[170:173], v[224:227], v[182:185], v[170:173]
v_exp_f32 v148, v148
v_mfma_f32_16x16x32_bf16 v[170:173], v[228:231], v[186:189], v[170:173]
v_exp_f32 v149, v149
v_mfma_f32_16x16x32_bf16 v[220:223], v[248:251], v[182:185], v[220:223]
v_exp_f32 v162, v162
v_mfma_f32_16x16x32_bf16 v[220:223], v[252:255], v[186:189], v[220:223]
v_exp_f32 v163, v163
v_mfma_f32_16x16x32_bf16 v[150:153], v[190:193], v[174:177], 0
v_exp_f32 v164, v164
v_mfma_f32_16x16x32_bf16 v[138:141], v[114:117], v[174:177], 0
v_exp_f32 v165, v165
v_mfma_f32_16x16x32_bf16 v[142:145], v[122:125], v[174:177], 0
v_cvt_pk_bf16_f32 v178, v146, v147
v_cvt_pk_bf16_f32 v179, v148, v149
v_mfma_f32_16x16x32_bf16 v[146:149], v[130:133], v[174:177], 0
v_cvt_pk_bf16_f32 v174, v154, v155
v_cvt_pk_bf16_f32 v175, v156, v157
v_mfma_f32_16x16x32_bf16 v[150:153], v[190:193], v[178:181], v[150:153]
v_cvt_pk_bf16_f32 v176, v158, v159
v_cvt_pk_bf16_f32 v177, v160, v161
v_cvt_pk_bf16_f32 v118, v118, v119
v_cvt_pk_bf16_f32 v119, v120, v121
v_mfma_f32_16x16x32_bf16 v[154:157], v[114:117], v[174:177], 0
ds_read_u16 v120, v205
v_mov_b32_e64 v121, 0
v_mfma_f32_16x16x32_bf16 v[158:161], v[122:125], v[174:177], 0
ds_write_b64 v212, v[94:95] offset:32768
v_cvt_pk_bf16_f32 v126, v126, v127
v_cvt_pk_bf16_f32 v127, v128, v129
ds_read_u16 v128, v205 offset:32
v_mov_b32_e64 v129, 0
v_cvt_pk_bf16_f32 v134, v134, v135
v_cvt_pk_bf16_f32 v135, v136, v137
v_rcp_f32 v151, v150
s_nop 0
v_mul_f32 v152, s3, v151
s_waitcnt lgkmcnt(2)
ds_read_u16 v136, v205 offset:64
v_cvt_pk_bf16_f32 v90, v90, v91
v_mfma_f32_16x16x32_bf16 v[138:141], v[118:121], v[178:181], v[138:141]
v_cvt_pk_bf16_f32 v91, v92, v93
v_cvt_pk_bf16_f32 v92, v170, v171
v_cvt_pk_bf16_f32 v93, v172, v173
v_mov_b32_e64 v137, 0
v_max3_u32 v218, v218, v150, v151
v_cvt_pk_bf16_f32 v94, v220, v221
v_cvt_pk_bf16_f32 v95, v222, v223
v_mul_f32 v138, v138, v152
s_waitcnt lgkmcnt(1)
v_mfma_f32_16x16x32_bf16 v[142:145], v[126:129], v[178:181], v[142:145]
v_mul_f32 v139, v139, v152
v_mul_f32 v140, v140, v152
v_mul_f32_e64 v141, v141, v152
v_cvt_pk_bf16_f32 v138, v138, v139
v_cvt_pk_bf16_f32 v139, v140, v141
v_and_b32 v216, s44, v208
s_waitcnt lgkmcnt(0)
v_mfma_f32_16x16x32_bf16 v[146:149], v[134:137], v[178:181], v[146:149]
v_cvt_pk_bf16_f32 v180, v166, 0
v_cvt_pk_bf16_f32 v178, v162, v163
v_mfma_f32_16x16x32_bf16 v[166:169], v[190:193], v[174:177], 0
v_cvt_pk_bf16_f32 v179, v164, v165
v_mul_f32 v142, v142, v152
s_nop 0
v_mfma_f32_16x16x32_bf16 v[166:169], v[190:193], v[178:181], v[166:169]
v_mul_f32 v143, v143, v152
v_mul_f32 v144, v144, v152
v_mfma_f32_16x16x32_bf16 v[154:157], v[118:121], v[178:181], v[154:157]
v_mul_f32_e64 v145, v145, v152
v_cvt_pk_bf16_f32 v140, v142, v143
v_mfma_f32_16x16x32_bf16 v[158:161], v[126:129], v[178:181], v[158:161]
v_rcp_f32 v167, v166
v_mfma_f32_16x16x32_bf16 v[162:165], v[130:133], v[174:177], 0
v_mul_f32 v168, s3, v167
v_mul_f32_e64 v154, v154, v168
v_mfma_f32_16x16x32_bf16 v[162:165], v[134:137], v[178:181], v[162:165]
v_mul_f32 v155, v155, v168
v_mul_f32 v156, v156, v168
v_mul_f32_e64 v157, v157, v168
v_cvt_pk_bf16_f32 v154, v154, v155
v_mul_f32 v158, v158, v168
v_mul_f32 v159, v159, v168
v_mul_f32 v160, v160, v168
v_mul_f32 v161, v161, v168
v_cvt_pk_bf16_f32 v155, v156, v157
v_cvt_pk_bf16_f32 v141, v144, v145
v_cvt_pk_bf16_f32 v156, v158, v159
v_cvt_pk_bf16_f32 v157, v160, v161
v_mul_f32 v146, v146, v152
v_mul_f32 v147, v147, v152
v_mul_f32 v148, v148, v152
v_mul_f32 v149, v149, v152
v_mfma_f32_16x16x32_bf16 v[150:153], v[108:111], v[90:93], v[206:209]
ds_write_b128 v211, v[138:141] offset:38912
v_mfma_f32_16x16x32_bf16 v[138:141], v[78:81], v[90:93], 0
v_mul_f32 v162, v162, v168
v_mul_f32 v163, v163, v168
v_mul_f32_e64 v164, v164, v168
v_mfma_f32_16x16x16_bf16 v[150:153], v[112:113], v[94:95], v[150:153]
v_mul_f32_e64 v165, v165, v168
v_cvt_pk_bf16_f32 v142, v146, v147
v_cvt_pk_bf16_f32 v143, v148, v149
v_mfma_f32_16x16x16_bf16 v[138:141], v[82:83], v[94:95], v[138:141]
v_cvt_pk_bf16_f32 v158, v162, v163
v_cvt_pk_bf16_f32 v159, v164, v165
v_max3_u32 v218, v218, v166, v167
v_mfma_f32_16x16x32_bf16 v[146:149], v[102:105], v[90:93], 0
ds_write_b128 v211, v[154:157] offset:45056
v_mfma_f32_16x16x16_bf16 v[146:149], v[106:107], v[94:95], v[146:149]
v_exp_f32_e64 v138, v138
v_add_u32 v205, 1424, v205
v_mfma_f32_16x16x16_bf16 v[154:157], v[76:77], v[82:83], 0
v_exp_f32 v139, v139
s_nop 0
v_cvt_pk_bf16_f32 v174, v138, v139
v_mfma_f32_16x16x16_bf16 v[162:165], v[76:77], v[106:107], 0
v_exp_f32 v140, v140
v_exp_f32 v141, v141
v_mfma_f32_16x16x16_bf16 v[166:169], v[76:77], v[112:113], v[206:209]
ds_write_b64 v212, v[142:143] offset:38912
v_mfma_f32_16x16x32_bf16 v[142:145], v[96:99], v[90:93], 0
v_exp_f32_e64 v150, v150
v_mfma_f32_16x16x32_bf16 v[154:157], v[72:75], v[78:81], v[154:157]
ds_write_b64 v212, v[158:159] offset:45056
v_mfma_f32_16x16x16_bf16 v[142:145], v[100:101], v[94:95], v[142:145]
v_cvt_pk_bf16_f32 v175, v140, v141
v_cvt_pk_bf16_f32 v180, v150, 0
v_exp_f32 v146, v146
v_mfma_f32_16x16x16_bf16 v[158:161], v[76:77], v[100:101], 0
v_exp_f32 v147, v147
v_exp_f32 v148, v148
v_mfma_f32_16x16x32_bf16 v[162:165], v[72:75], v[102:105], v[162:165]
v_exp_f32 v142, v142
v_mfma_f32_16x16x32_bf16 v[158:161], v[72:75], v[96:99], v[158:161]
v_exp_f32 v143, v143
v_mfma_f32_16x16x32_bf16 v[166:169], v[72:75], v[108:111], v[166:169]
v_exp_f32 v144, v144
v_exp_f32_e64 v145, v145
v_cvt_pk_bf16_f32 v176, v142, v143
v_cvt_pk_bf16_f32 v177, v144, v145
v_exp_f32 v149, v149
v_mfma_f32_16x16x32_bf16 v[150:153], v[190:193], v[174:177], 0
s_waitcnt lgkmcnt(0)
v_cvt_pk_bf16_f32 v178, v146, v147
v_cvt_pk_bf16_f32 v179, v148, v149
v_mfma_f32_16x16x32_bf16 v[138:141], v[114:117], v[174:177], 0
s_barrier
v_mfma_f32_16x16x32_bf16 v[138:141], v[118:121], v[178:181], v[138:141]
s_nop 0
ds_read_b128 v[220:223], v210 offset:38912
ds_read_b128 v[110:113], v210 offset:39936
v_mfma_f32_16x16x32_bf16 v[150:153], v[190:193], v[178:181], v[150:153]
ds_read_b128 v[170:173], v210 offset:40960
ds_read_b128 v[182:185], v210 offset:41984
v_mfma_f32_16x16x32_bf16 v[142:145], v[122:125], v[174:177], 0
ds_read_b128 v[186:189], v210 offset:43008
v_mov_b32_dpp v154, v158 quad_perm:[0,1,2,3] row_mask:0x2 bank_mask:0xf
v_mfma_f32_16x16x32_bf16 v[142:145], v[126:129], v[178:181], v[142:145]
v_rcp_f32 v151, v150
v_mfma_f32_16x16x32_bf16 v[146:149], v[130:133], v[174:177], 0
ds_read_b128 v[174:177], v217
v_mul_f32 v152, s3, v151
v_mfma_f32_16x16x32_bf16 v[146:149], v[134:137], v[178:181], v[146:149]
v_mul_f32 v138, v138, v152
v_mul_f32 v139, v139, v152
v_mov_b32_dpp v154, v162 quad_perm:[0,1,2,3] row_mask:0x4 bank_mask:0xf
v_mul_f32 v140, v140, v152
s_waitcnt lgkmcnt(5)
v_mfma_f32_16x16x32_bf16 v[0:3], a[144:147], v[220:223], v[0:3]
s_waitcnt lgkmcnt(4)
v_mul_f32 v141, v141, v152
v_cvt_pk_bf16_f32 v138, v138, v139
v_mfma_f32_16x16x32_bf16 v[0:3], a[148:151], v[110:113], v[0:3]
s_waitcnt lgkmcnt(3)
v_mul_f32 v142, v142, v152
v_mul_f32_e64 v143, v143, v152
v_mfma_f32_16x16x32_bf16 v[0:3], a[152:155], v[170:173], v[0:3]
v_mul_f32 v144, v144, v152
v_mul_f32 v145, v145, v152
v_mfma_f32_16x16x32_bf16 v[4:7], a[168:171], v[220:223], v[4:7]
v_cvt_pk_bf16_f32 v139, v140, v141
v_cvt_pk_bf16_f32 v140, v142, v143
v_mfma_f32_16x16x32_bf16 v[4:7], a[172:175], v[110:113], v[4:7]
s_nop 0
v_cvt_pk_bf16_f32 v141, v144, v145
v_mov_b32_dpp v154, v167 quad_perm:[0,1,2,3] row_mask:0x8 bank_mask:0xf
v_mfma_f32_16x16x32_bf16 v[4:7], a[176:179], v[170:173], v[4:7]
s_waitcnt lgkmcnt(2)
ds_write_b128 v211, v[138:141] offset:51200
v_mfma_f32_16x16x32_bf16 v[4:7], a[180:183], v[182:185], v[4:7]
v_exp_f32 v154, v154
v_mfma_f32_16x16x32_bf16 v[8:11], a[192:195], v[220:223], v[8:11]
v_cvt_pk_bf16_f32 v154, v154, 0
v_mul_f32 v146, v146, v152
v_mfma_f32_16x16x32_bf16 v[8:11], a[196:199], v[110:113], v[8:11]
ds_read_b128 v[220:223], v210 offset:44032
ds_read_b128 v[110:113], v210 offset:45056
v_mfma_f32_16x16x32_bf16 v[8:11], a[200:203], v[170:173], v[8:11]
ds_read_b128 v[170:173], v210 offset:46080
ds_read_b128 v[178:181], v217 offset:528
v_mfma_f32_16x16x32_bf16 v[8:11], a[204:207], v[182:185], v[8:11]
s_nop 0
ds_write_b16 v214, v154
v_mfma_f32_16x16x32_bf16 v[0:3], a[156:159], v[182:185], v[0:3]
s_waitcnt lgkmcnt(7)
ds_read_b128 v[182:185], v210 offset:47104
ds_read_b128 v[84:87], v215
v_mfma_f32_16x16x32_bf16 v[0:3], a[160:163], v[186:189], v[0:3]
ds_read_b128 v[88:91], v215 offset:16
v_mul_f32_e64 v147, v147, v152
v_mfma_f32_16x16x32_bf16 v[4:7], a[184:187], v[186:189], v[4:7]
v_mul_f32_e64 v148, v148, v152
v_mul_f32 v149, v149, v152
v_mfma_f32_16x16x32_bf16 v[8:11], a[208:211], v[186:189], v[8:11]
s_waitcnt lgkmcnt(7)
ds_read_b128 v[186:189], v210 offset:48128
v_cvt_pk_bf16_f32 v142, v146, v147
v_mfma_f32_16x16x32_bf16 v[8:11], a[212:215], v[220:223], v[8:11]
v_cvt_pk_bf16_f32 v143, v148, v149
v_max3_u32 v218, v218, v150, v151
v_mfma_f32_16x16x32_bf16 v[0:3], a[164:167], v[220:223], v[0:3]
s_nop 0
ds_write_b64 v212, v[142:143] offset:51200
v_mfma_f32_16x16x32_bf16 v[4:7], a[188:191], v[220:223], v[4:7]
s_waitcnt lgkmcnt(8)
v_cvt_pk_bf16_f32 v8, v8, v9
v_cvt_pk_bf16_f32 v9, v10, v11
v_mfma_f32_16x16x32_bf16 v[12:15], a[144:147], v[110:113], v[12:15]
s_waitcnt lgkmcnt(7)
ds_read_b128 v[220:223], v210 offset:49152
v_cvt_pk_bf16_f32 v0, v0, v1
v_mfma_f32_16x16x32_bf16 v[12:15], a[148:151], v[170:173], v[12:15]
s_waitcnt lgkmcnt(5)
ds_write_b64 v203, v[8:9] offset:64
v_mfma_f32_16x16x32_bf16 v[12:15], a[152:155], v[182:185], v[12:15]
v_cvt_pk_bf16_f32 v4, v4, v5
v_cvt_pk_bf16_f32 v1, v2, v3
v_mfma_f32_16x16x32_bf16 v[16:19], a[168:171], v[110:113], v[16:19]
ds_write_b64 v203, v[0:1]
v_mfma_f32_16x16x32_bf16 v[16:19], a[172:175], v[170:173], v[16:19]
v_cvt_pk_bf16_f32 v5, v6, v7
v_add_u32 v215, 1424, v215
v_mfma_f32_16x16x32_bf16 v[16:19], a[176:179], v[182:185], v[16:19]
s_waitcnt lgkmcnt(4)
ds_write_b64 v203, v[4:5] offset:32
v_mfma_f32_16x16x32_bf16 v[16:19], a[180:183], v[186:189], v[16:19]
v_mfma_f32_16x16x32_bf16 v[20:23], a[192:195], v[110:113], v[20:23]
ds_read_b128 v[110:113], v210 offset:50176
v_mfma_f32_16x16x32_bf16 v[20:23], a[196:199], v[170:173], v[20:23]
v_mfma_f32_16x16x32_bf16 v[20:23], a[200:203], v[182:185], v[20:23]
v_mfma_f32_16x16x32_bf16 v[20:23], a[204:207], v[186:189], v[20:23]
v_mfma_f32_16x16x32_bf16 v[12:15], a[156:159], v[186:189], v[12:15]
s_waitcnt vmcnt(0) lgkmcnt(1)
s_barrier
v_mfma_f32_16x16x32_bf16 v[12:15], a[160:163], v[220:223], v[12:15]
s_waitcnt lgkmcnt(0)
ds_read_b128 v[92:95], v201
ds_read_b128 v[170:173], v210 offset:51200
v_mfma_f32_16x16x32_bf16 v[12:15], a[164:167], v[110:113], v[12:15]
ds_read_b128 v[100:103], v202
ds_read_b128 v[182:185], v210 offset:52224
v_mfma_f32_16x16x32_bf16 v[16:19], a[184:187], v[220:223], v[16:19]
ds_read_b128 v[186:189], v210 offset:53248
ds_read_b128 v[96:99], v195 offset:16
v_mfma_f32_16x16x32_bf16 v[16:19], a[188:191], v[110:113], v[16:19]
ds_read_b128 v[104:107], v196 offset:16
v_cvt_pk_bf16_f32 v12, v12, v13
v_mfma_f32_16x16x32_bf16 v[20:23], a[208:211], v[220:223], v[20:23]
ds_read_b128 v[220:223], v210 offset:54272
v_cvt_pk_bf16_f32 v13, v14, v15
v_mfma_f32_16x16x32_bf16 v[20:23], a[212:215], v[110:113], v[20:23]
ds_write_b64 v203, v[12:13] offset:6272
v_mfma_f32_16x16x32_bf16 v[166:169], v[84:87], v[190:193], 0
v_cvt_pk_bf16_f32 v16, v16, v17
v_cvt_pk_bf16_f32 v17, v18, v19
v_mfma_f32_16x16x32_bf16 v[166:169], v[88:91], v[190:193], v[166:169]
ds_read_b128 v[110:113], v210 offset:55296
v_cvt_pk_bf16_f32 v20, v20, v21
v_mfma_f32_16x16x32_bf16 v[154:157], v[84:87], v[114:117], 0
ds_write_b64 v203, v[16:17] offset:6304
v_mfma_f32_16x16x32_bf16 v[154:157], v[88:91], v[118:121], v[154:157]
v_rcp_f32 v167, v166
v_mfma_f32_16x16x32_bf16 v[158:161], v[84:87], v[122:125], 0
v_mul_f32 v168, s3, v167
v_max3_u32 v218, v218, v166, v167
v_mfma_f32_16x16x32_bf16 v[158:161], v[88:91], v[126:129], v[158:161]
v_cvt_pk_bf16_f32 v21, v22, v23
v_mfma_f32_16x16x32_bf16 v[162:165], v[84:87], v[130:133], 0
ds_read_b128 v[84:87], v200
ds_read_b64 v[120:121], v204
v_mfma_f32_16x16x32_bf16 v[162:165], v[88:91], v[134:137], v[162:165]
s_waitcnt lgkmcnt(12)
ds_read_b128 v[88:91], v194 offset:16
v_mov_b32_dpp v154, v158 quad_perm:[0,1,2,3] row_mask:0x2 bank_mask:0xf
v_mfma_f32_16x16x32_bf16 v[12:15], v[174:177], v[92:95], 0
s_waitcnt lgkmcnt(12)
ds_read_b128 v[92:95], v195
ds_read_b64 v[128:129], v204 offset:392
v_mfma_f32_16x16x32_bf16 v[24:27], a[144:147], v[170:173], v[24:27]
s_waitcnt lgkmcnt(12)
ds_write_b64 v203, v[20:21] offset:6336
v_mfma_f32_16x16x32_bf16 v[24:27], a[148:151], v[182:185], v[24:27]
s_waitcnt lgkmcnt(12)
v_mov_b32_dpp v154, v162 quad_perm:[0,1,2,3] row_mask:0x4 bank_mask:0xf
v_mul_f32_e64 v154, v154, v168
v_mfma_f32_16x16x32_bf16 v[24:27], a[152:155], v[186:189], v[24:27]
s_nop 0
v_cvt_pk_bf16_f32 v154, v154, 0
s_waitcnt lgkmcnt(5)
v_mfma_f32_16x16x32_bf16 v[0:3], v[174:177], v[84:87], 0
ds_read_b128 v[84:87], v194
ds_read_b64 v[136:137], v204 offset:784
v_mfma_f32_16x16x32_bf16 v[28:31], a[168:171], v[170:173], v[28:31]
ds_write_b16 v214, v154
v_mfma_f32_16x16x32_bf16 v[28:31], a[172:175], v[182:185], v[28:31]
s_waitcnt lgkmcnt(7)
buffer_store_dwordx2 v[120:121], v204, s[8:11], s28 offen sc1
ds_read_b64 v[120:121], v204 offset:1176
v_mfma_f32_16x16x32_bf16 v[28:31], a[176:179], v[186:189], v[28:31]
s_add_u32 s28, s38, s62
v_add_u32 v214, 1424, v214
v_mfma_f32_16x16x32_bf16 v[32:35], a[192:195], v[170:173], v[32:35]
ds_read_b128 v[170:173], v210 offset:56320
v_mfma_f32_16x16x32_bf16 v[32:35], a[196:199], v[182:185], v[32:35]
ds_read_b128 v[182:185], v210 offset:20480
v_mfma_f32_16x16x32_bf16 v[32:35], a[200:203], v[186:189], v[32:35]
s_nop 0
ds_read_b128 v[186:189], v210 offset:21504
s_waitcnt lgkmcnt(6)
v_smfmac_f32_16x16x64_bf16 v[0:3], v[178:181], v[84:91], v213
ds_read_b128 v[84:87], v197
ds_read_b128 v[88:91], v197 offset:16
v_mfma_f32_16x16x32_bf16 v[24:27], a[156:159], v[220:223], v[24:27]
buffer_store_dwordx2 v[128:129], v204, s[8:11], s29 offen sc1
s_add_u32 s29, s38, s63
v_mfma_f32_16x16x32_bf16 v[24:27], a[160:163], v[110:113], v[24:27]
s_waitcnt lgkmcnt(4)
v_mfma_f32_16x16x32_bf16 v[24:27], a[164:167], v[170:173], v[24:27]
v_smfmac_f32_16x16x64_bf16 v[12:15], v[178:181], v[92:99], v213
ds_read_b128 v[92:95], v198
ds_read_b128 v[96:99], v198 offset:16
v_mfma_f32_16x16x32_bf16 v[28:31], a[180:183], v[220:223], v[28:31]
v_cvt_pk_bf16_f32 v24, v24, v25
v_cvt_pk_bf16_f32 v25, v26, v27
v_mfma_f32_16x16x32_bf16 v[28:31], a[184:187], v[110:113], v[28:31]
ds_write_b64 v203, v[24:25] offset:12544
v_mfma_f32_16x16x32_bf16 v[24:27], v[174:177], v[100:103], 0
s_nop 0
buffer_store_dwordx2 v[136:137], v204, s[8:11], s28 offen sc1
ds_read_b128 v[100:103], v196
v_mfma_f32_16x16x32_bf16 v[32:35], a[204:207], v[220:223], v[32:35]
s_add_u32 s28, s38, s64
ds_read_b128 v[174:177], v217 offset:1056
ds_read_b128 v[220:223], v210 offset:23552
v_mfma_f32_16x16x32_bf16 v[32:35], a[208:211], v[110:113], v[32:35]
ds_read_b128 v[110:113], v210 offset:22528
v_mfma_f32_16x16x32_bf16 v[32:35], a[212:215], v[170:173], v[32:35]
s_nop 0
buffer_store_dwordx2 v[120:121], v204, s[8:11], s29 offen sc1
s_add_u32 s29, s38, s65
v_mfma_f32_16x16x32_bf16 v[28:31], a[188:191], v[170:173], v[28:31]
s_waitcnt lgkmcnt(10)
v_mfma_f32_16x16x32_bf16 v[138:141], a[0:3], v[182:185], 0
s_waitcnt lgkmcnt(9)
v_cvt_pk_bf16_f32 v32, v32, v33
v_cvt_pk_bf16_f32 v33, v34, v35
v_mfma_f32_16x16x32_bf16 v[138:141], a[4:7], v[186:189], v[138:141]
s_waitcnt lgkmcnt(3)
v_cvt_pk_bf16_f32 v28, v28, v29
v_cvt_pk_bf16_f32 v29, v30, v31
v_smfmac_f32_16x16x64_bf16 v[24:27], v[178:181], v[100:107], v213
s_waitcnt lgkmcnt(2)
ds_read_b128 v[100:103], v199
ds_read_b128 v[104:107], v199 offset:16
v_smfmac_f32_16x16x64_bf16 v[0:3], v[174:177], v[84:91], v213
ds_read_b128 v[84:87], v200 offset:32
ds_read_b128 v[178:181], v217 offset:1584
v_smfmac_f32_16x16x64_bf16 v[12:15], v[174:177], v[92:99], v213
ds_read_b128 v[92:95], v201 offset:32
ds_read_b128 v[88:91], v194 offset:48
v_mfma_f32_16x16x32_bf16 v[142:145], a[24:27], v[182:185], 0
ds_read_b128 v[96:99], v195 offset:48
v_mul_f32_e64 v119, v0, v0
v_mfma_f32_16x16x32_bf16 v[142:145], a[28:31], v[186:189], v[142:145]
ds_write_b64 v203, v[28:29] offset:12576
v_mfma_f32_16x16x32_bf16 v[146:149], a[48:51], v[182:185], 0
v_mul_f32_e64 v127, v12, v12
v_add_f32 v118, v0, v1
v_mfma_f32_16x16x32_bf16 v[146:149], a[52:55], v[186:189], v[146:149]
s_waitcnt lgkmcnt(6)
ds_write_b64 v203, v[32:33] offset:12608
v_smfmac_f32_16x16x64_bf16 v[24:27], v[174:177], v[100:107], v213
v_add_f32 v126, v12, v13
v_mfma_f32_16x16x32_bf16 v[150:153], a[216:219], v[182:185], 0
ds_read_b128 v[100:103], v202 offset:32
ds_read_b128 v[174:177], v217 offset:2112
v_mfma_f32_16x16x32_bf16 v[150:153], a[220:223], v[186:189], v[150:153]
s_waitcnt lgkmcnt(7)
ds_read_b128 v[104:107], v196 offset:48
v_mul_f32 v135, v24, v24
v_mfma_f32_16x16x32_bf16 v[4:7], v[178:181], v[84:87], 0
s_waitcnt lgkmcnt(7)
ds_read_b128 v[84:87], v194 offset:32
v_add_f32_e64 v134, v24, v25
v_mfma_f32_16x16x32_bf16 v[16:19], v[178:181], v[92:95], 0
ds_read_b128 v[92:95], v195 offset:32
v_fmac_f32_e64 v135, v25, v25
v_mfma_f32_16x16x32_bf16 v[154:157], a[240:243], v[182:185], 0
v_fmac_f32 v119, v1, v1
v_fmac_f32 v127, v13, v13
v_mfma_f32_16x16x32_bf16 v[154:157], a[244:247], v[186:189], v[154:157]
v_add_f32 v134, v134, v26
v_fmac_f32 v135, v26, v26
v_mfma_f32_16x16x32_bf16 v[158:161], v[232:235], v[182:185], 0
v_add_f32 v118, v118, v2
v_add_f32 v126, v126, v14
v_mfma_f32_16x16x32_bf16 v[158:161], v[236:239], v[186:189], v[158:161]
v_fmac_f32 v119, v2, v2
v_fmac_f32 v127, v14, v14
v_mfma_f32_16x16x32_bf16 v[162:165], v[182:185], a[72:75], 0
s_waitcnt lgkmcnt(4)
v_add_f32 v134, v134, v27
v_fmac_f32_e64 v135, v27, v27
v_mfma_f32_16x16x32_bf16 v[28:31], v[178:181], v[100:103], 0
ds_read_b128 v[100:103], v196 offset:32
ds_read_b128 v[178:181], v217 offset:2640
v_mfma_f32_16x16x32_bf16 v[162:165], v[186:189], a[76:79], v[162:165]
v_add_f32 v118, v118, v3
v_add_f32 v126, v126, v15
v_mfma_f32_16x16x32_bf16 v[166:169], v[182:185], a[96:99], 0
s_waitcnt lgkmcnt(3)
v_fmac_f32 v119, v3, v3
v_fmac_f32 v127, v15, v15
v_smfmac_f32_16x16x64_bf16 v[4:7], v[174:177], v[84:91], v213
s_waitcnt lgkmcnt(2)
ds_read_b128 v[84:87], v197 offset:32
ds_read_b128 v[88:91], v197 offset:48
v_smfmac_f32_16x16x64_bf16 v[16:19], v[174:177], v[92:99], v213
ds_read_b128 v[92:95], v198 offset:32
ds_read_b128 v[96:99], v198 offset:48
v_mfma_f32_16x16x32_bf16 v[166:169], v[186:189], a[100:103], v[166:169]
s_waitcnt lgkmcnt(5)
v_smfmac_f32_16x16x64_bf16 v[28:31], v[174:177], v[100:107], v213
s_nop 0
ds_read_b128 v[100:103], v199 offset:32
ds_read_b128 v[104:107], v199 offset:48
v_mfma_f32_16x16x32_bf16 v[170:173], v[182:185], a[120:123], 0
ds_read_b128 v[174:177], v217 offset:3168
ds_read_b128 v[182:185], v210 offset:24576
v_mfma_f32_16x16x32_bf16 v[170:173], v[186:189], a[124:127], v[170:173]
ds_read_b128 v[186:189], v210 offset:25600
v_mfma_f32_16x16x32_bf16 v[138:141], a[8:11], v[110:113], v[138:141]
s_nop 0
v_mfma_f32_16x16x32_bf16 v[138:141], a[12:15], v[220:223], v[138:141]
s_waitcnt lgkmcnt(7)
v_smfmac_f32_16x16x64_bf16 v[4:7], v[178:181], v[84:91], v213
ds_read_b128 v[84:87], v200 offset:64
ds_read_b128 v[88:91], v194 offset:80
v_mfma_f32_16x16x32_bf16 v[142:145], a[32:35], v[110:113], v[142:145]
v_mfma_f32_16x16x32_bf16 v[142:145], a[36:39], v[220:223], v[142:145]
s_waitcnt lgkmcnt(7)
v_add_f32 v118, v118, v4
v_fmac_f32 v119, v4, v4
v_smfmac_f32_16x16x64_bf16 v[16:19], v[178:181], v[92:99], v213
s_waitcnt lgkmcnt(5)
ds_read_b128 v[92:95], v201 offset:64
ds_read_b128 v[96:99], v195 offset:80
v_smfmac_f32_16x16x64_bf16 v[28:31], v[178:181], v[100:107], v213
ds_read_b128 v[100:103], v202 offset:64
ds_read_b128 v[178:181], v217 offset:3696
v_mfma_f32_16x16x32_bf16 v[146:149], a[56:59], v[110:113], v[146:149]
ds_read_b128 v[104:107], v196 offset:80
v_add_f32_e64 v126, v126, v16
v_mfma_f32_16x16x32_bf16 v[146:149], a[60:63], v[220:223], v[146:149]
v_add_f32 v134, v134, v28
v_fmac_f32 v135, v28, v28
v_mfma_f32_16x16x32_bf16 v[150:153], a[224:227], v[110:113], v[150:153]
v_fmac_f32 v127, v16, v16
v_add_f32 v134, v134, v29
v_mfma_f32_16x16x32_bf16 v[150:153], a[228:231], v[220:223], v[150:153]
s_waitcnt lgkmcnt(6)
v_fmac_f32 v135, v29, v29
v_add_f32 v118, v118, v5
v_mfma_f32_16x16x32_bf16 v[8:11], v[174:177], v[84:87], 0
s_waitcnt lgkmcnt(4)
ds_read_b128 v[84:87], v194 offset:64
v_fmac_f32_e64 v119, v5, v5
v_mfma_f32_16x16x32_bf16 v[20:23], v[174:177], v[92:95], 0
ds_read_b128 v[92:95], v195 offset:64
v_add_f32_e64 v126, v126, v17
v_mfma_f32_16x16x32_bf16 v[154:157], a[248:251], v[110:113], v[154:157]
v_fmac_f32 v127, v17, v17
v_add_f32 v134, v134, v30
v_mfma_f32_16x16x32_bf16 v[154:157], a[252:255], v[220:223], v[154:157]
s_waitcnt lgkmcnt(4)
v_fmac_f32 v135, v30, v30
v_add_f32_e64 v118, v118, v6
v_mfma_f32_16x16x32_bf16 v[32:35], v[174:177], v[100:103], 0
ds_read_b128 v[100:103], v196 offset:64
ds_read_b128 v[174:177], v217 offset:4224
v_mfma_f32_16x16x32_bf16 v[158:161], v[240:243], v[110:113], v[158:161]
v_fmac_f32 v119, v6, v6
v_add_f32 v126, v126, v18
v_mfma_f32_16x16x32_bf16 v[158:161], v[244:247], v[220:223], v[158:161]
s_waitcnt lgkmcnt(3)
v_fmac_f32 v127, v18, v18
v_add_f32 v134, v134, v31
v_smfmac_f32_16x16x64_bf16 v[8:11], v[178:181], v[84:91], v213
s_waitcnt lgkmcnt(2)
ds_read_b128 v[84:87], v197 offset:64
ds_read_b128 v[88:91], v197 offset:80
v_smfmac_f32_16x16x64_bf16 v[20:23], v[178:181], v[92:99], v213
ds_read_b128 v[92:95], v198 offset:64
ds_read_b128 v[96:99], v198 offset:80
v_mfma_f32_16x16x32_bf16 v[162:165], v[110:113], a[80:83], v[162:165]
v_fmac_f32 v135, v31, v31
v_add_f32 v118, v118, v7
v_mfma_f32_16x16x32_bf16 v[162:165], v[220:223], a[84:87], v[162:165]
s_waitcnt lgkmcnt(5)
v_fmac_f32 v119, v7, v7
v_add_f32_e64 v126, v126, v19
v_smfmac_f32_16x16x64_bf16 v[32:35], v[178:181], v[100:107], v213
ds_read_b128 v[100:103], v199 offset:64
ds_read_b128 v[104:107], v199 offset:80
v_mfma_f32_16x16x32_bf16 v[166:169], v[110:113], a[104:107], v[166:169]
v_fmac_f32 v127, v19, v19
v_mfma_f32_16x16x32_bf16 v[166:169], v[220:223], a[108:111], v[166:169]
s_waitcnt lgkmcnt(4)
v_smfmac_f32_16x16x64_bf16 v[8:11], v[174:177], v[84:91], v213
v_mfma_f32_16x16x32_bf16 v[170:173], v[110:113], a[128:131], v[170:173]
ds_read_b128 v[110:113], v210 offset:26624
v_mfma_f32_16x16x32_bf16 v[170:173], v[220:223], a[132:135], v[170:173]
s_waitcnt lgkmcnt(3)
ds_read_b128 v[220:223], v210 offset:27648
v_add_f32 v118, v118, v8
v_smfmac_f32_16x16x64_bf16 v[20:23], v[174:177], v[92:99], v213
s_waitcnt lgkmcnt(2)
v_fmac_f32 v119, v8, v8
v_smfmac_f32_16x16x64_bf16 v[32:35], v[174:177], v[100:107], v213
v_add_f32_e64 v118, v118, v9
v_mfma_f32_16x16x32_bf16 v[138:141], a[16:19], v[182:185], v[138:141]
v_add_f32 v126, v126, v20
v_fmac_f32 v127, v20, v20
v_mfma_f32_16x16x32_bf16 v[138:141], a[20:23], v[186:189], v[138:141]
v_add_f32 v134, v134, v32
v_fmac_f32 v135, v32, v32
v_mfma_f32_16x16x32_bf16 v[142:145], a[40:43], v[182:185], v[142:145]
v_add_f32 v134, v134, v33
v_fmac_f32 v135, v33, v33
v_mfma_f32_16x16x32_bf16 v[142:145], a[44:47], v[186:189], v[142:145]
v_cvt_pk_bf16_f32 v78, v138, v139
v_cvt_pk_bf16_f32 v79, v140, v141
v_mfma_f32_16x16x32_bf16 v[146:149], a[64:67], v[182:185], v[146:149]
v_fmac_f32 v119, v9, v9
v_add_f32 v126, v126, v21
v_mfma_f32_16x16x32_bf16 v[146:149], a[68:71], v[186:189], v[146:149]
v_cvt_pk_bf16_f32 v80, v142, v143
v_cvt_pk_bf16_f32 v81, v144, v145
v_mfma_f32_16x16x32_bf16 v[150:153], a[232:235], v[182:185], v[150:153]
v_fmac_f32 v127, v21, v21
v_add_f32 v134, v134, v34
v_mfma_f32_16x16x32_bf16 v[150:153], a[236:239], v[186:189], v[150:153]
v_cvt_pk_bf16_f32 v82, v146, v147
v_cvt_pk_bf16_f32 v83, v148, v149
v_mfma_f32_16x16x32_bf16 v[154:157], v[224:227], v[182:185], v[154:157]
v_fmac_f32 v135, v34, v34
v_add_f32 v118, v118, v10
v_mfma_f32_16x16x32_bf16 v[154:157], v[228:231], v[186:189], v[154:157]
v_cvt_pk_bf16_f32 v72, v150, v151
v_cvt_pk_bf16_f32 v73, v152, v153
v_mfma_f32_16x16x32_bf16 v[158:161], v[248:251], v[182:185], v[158:161]
v_fmac_f32 v119, v10, v10
v_add_f32 v126, v126, v22
v_mfma_f32_16x16x32_bf16 v[158:161], v[252:255], v[186:189], v[158:161]
v_cvt_pk_bf16_f32 v74, v154, v155
v_cvt_pk_bf16_f32 v75, v156, v157
v_mfma_f32_16x16x32_bf16 v[162:165], v[182:185], a[88:91], v[162:165]
v_fmac_f32 v127, v22, v22
v_add_f32 v134, v134, v35
v_mfma_f32_16x16x32_bf16 v[162:165], v[186:189], a[92:95], v[162:165]
v_fmac_f32 v135, v35, v35
v_add_f32 v118, v118, v11
v_mfma_f32_16x16x32_bf16 v[166:169], v[182:185], a[112:115], v[166:169]
v_fmac_f32 v119, v11, v11
v_add_f32 v126, v126, v23
v_mfma_f32_16x16x32_bf16 v[166:169], v[186:189], a[116:119], v[166:169]
v_fmac_f32_e64 v127, v23, v23
v_cvt_pk_bf16_f32 v76, v158, v159
v_mfma_f32_16x16x32_bf16 v[170:173], v[182:185], a[136:139], v[170:173]
s_nop 0
ds_read_b128 v[182:185], v210 offset:28672
v_cvt_pk_bf16_f32 v77, v160, v161
v_mfma_f32_16x16x32_bf16 v[170:173], v[186:189], a[140:143], v[170:173]
s_waitcnt lgkmcnt(2)
ds_read_b128 v[186:189], v210 offset:29696
v_cvt_pk_bf16_f32 v114, v162, v163
v_mfma_f32_16x16x32_bf16 v[138:141], a[0:3], v[110:113], 0
s_waitcnt lgkmcnt(2)
v_permlane16_swap_b32 v134, v135
v_mfma_f32_16x16x32_bf16 v[138:141], a[4:7], v[220:223], v[138:141]
v_permlane16_swap_b32 v118, v119
v_mfma_f32_16x16x32_bf16 v[142:145], a[24:27], v[110:113], 0
v_permlane16_swap_b32 v126, v127
v_mfma_f32_16x16x32_bf16 v[142:145], a[28:31], v[220:223], v[142:145]
v_add_f32 v134, v134, v135
v_add_f32 v118, v118, v119
v_mfma_f32_16x16x32_bf16 v[146:149], a[48:51], v[110:113], 0
v_add_f32 v126, v126, v127
v_mov_b32 v135, v134
v_mfma_f32_16x16x32_bf16 v[146:149], a[52:55], v[220:223], v[146:149]
v_permlane32_swap_b32 v118, v126
v_mfma_f32_16x16x32_bf16 v[150:153], a[216:219], v[110:113], 0
v_permlane32_swap_b32 v134, v135
v_mfma_f32_16x16x32_bf16 v[150:153], a[220:223], v[220:223], v[150:153]
v_cvt_pk_bf16_f32 v115, v164, v165
v_add_f32_e64 v118, v118, v126
v_mfma_f32_16x16x32_bf16 v[154:157], a[240:243], v[110:113], 0
ds_write_b32 v209, v118
v_mfma_f32_16x16x32_bf16 v[154:157], a[244:247], v[220:223], v[154:157]
v_add_f32_e64 v134, v134, v135
v_cvt_pk_bf16_f32 v122, v166, v167
v_mfma_f32_16x16x32_bf16 v[158:161], v[232:235], v[110:113], 0
ds_write_b32 v209, v134 offset:512
v_mfma_f32_16x16x32_bf16 v[158:161], v[236:239], v[220:223], v[158:161]
v_cvt_pk_bf16_f32 v123, v168, v169
v_cvt_pk_bf16_f32 v130, v170, v171
v_mfma_f32_16x16x32_bf16 v[162:165], v[110:113], a[72:75], 0
v_cvt_pk_bf16_f32 v131, v172, v173
v_mfma_f32_16x16x32_bf16 v[162:165], v[220:223], a[76:79], v[162:165]
v_mfma_f32_16x16x32_bf16 v[166:169], v[110:113], a[96:99], 0
v_mfma_f32_16x16x32_bf16 v[166:169], v[220:223], a[100:103], v[166:169]
s_waitcnt lgkmcnt(0)
v_mfma_f32_16x16x32_bf16 v[170:173], v[110:113], a[120:123], 0
s_barrier
v_mfma_f32_16x16x32_bf16 v[170:173], v[220:223], a[124:127], v[170:173]
ds_read_b128 v[102:105], v210 offset:18432
ds_read_b128 v[110:113], v210 offset:30720
v_mfma_f32_16x16x32_bf16 v[146:149], a[56:59], v[182:185], v[146:149]
buffer_load_dwordx4 v216, s[4:7], s52 offen nt lds
v_mfma_f32_16x16x32_bf16 v[146:149], a[60:63], v[186:189], v[146:149]
s_add_u32 m0, s45, 4112
ds_read_b64 v[128:129], v204 offset:6272
ds_read_b64 v[136:137], v204 offset:6664
ds_read_b64 v[120:121], v204 offset:7056
ds_read_b128 v[106:109], v210 offset:19456
s_waitcnt lgkmcnt(5)
v_add_f32 v102, v102, v103
s_waitcnt lgkmcnt(0)
s_nop 6
s_mov_b32 s46, 7
.p2align 6
F_loop:
v_add_f32_e64 v104, v104, v105
v_mfma_f32_16x16x32_bf16 v[138:141], a[8:11], v[182:185], v[138:141]
s_waitcnt lgkmcnt(4)
v_add_f32 v102, v102, v104
v_add_f32 v106, v106, v107
v_mfma_f32_16x16x32_bf16 v[138:141], a[12:15], v[186:189], v[138:141]
s_waitcnt lgkmcnt(3)
buffer_store_dwordx2 v[128:129], v204, s[8:11], s28 offen sc1
v_mul_f32 v104, s73, v102
v_add_f32 v108, v108, v109
v_mfma_f32_16x16x32_bf16 v[142:145], a[32:35], v[182:185], v[142:145]
buffer_load_dwordx4 v216, s[4:7], s40 offen nt lds
v_mfma_f32_16x16x32_bf16 v[142:145], a[36:39], v[186:189], v[142:145]
v_add_f32 v106, v106, v108
v_mul_f32 v103, s48, v102
v_mfma_f32_16x16x32_bf16 v[150:153], a[224:227], v[182:185], v[150:153]
v_mul_f32_e64 v106, s73, v106
v_fma_f32 v106, -v103, v104, v106
v_mfma_f32_16x16x32_bf16 v[150:153], a[228:231], v[186:189], v[150:153]
s_add_u32 s28, s38, s66
v_max_f32 v106, 0, v106
v_add_f32_e64 v106, s49, v106
v_mfma_f32_16x16x32_bf16 v[154:157], a[248:251], v[182:185], v[154:157]
s_waitcnt lgkmcnt(2)
v_rsq_f32 v102, v106
v_mfma_f32_16x16x32_bf16 v[154:157], a[252:255], v[186:189], v[154:157]
s_add_u32 m0, s45, 8224
ds_read_b128 v[106:109], v210 offset:31744
v_mul_f32_e64 v103, -v103, v102
v_mfma_f32_16x16x32_bf16 v[158:161], v[240:243], v[182:185], v[158:161]
s_add_u32 s40, s37, 392448
buffer_store_dwordx2 v[136:137], v204, s[8:11], s29 offen sc1
ds_write_b64 v211, v[102:103]
v_mfma_f32_16x16x32_bf16 v[158:161], v[244:247], v[186:189], v[158:161]
buffer_load_dwordx4 v216, s[4:7], s40 offen nt lds
v_mfma_f32_16x16x32_bf16 v[166:169], v[182:185], a[104:107], v[166:169]
ds_read_b64 v[118:119], v219
ds_read_b64 v[136:137], v204 offset:12544
v_mfma_f32_16x16x32_bf16 v[166:169], v[186:189], a[108:111], v[166:169]
s_nop 0
ds_read_b64 v[134:135], v219 offset:512
s_add_u32 s29, s38, s67
v_mfma_f32_16x16x32_bf16 v[162:165], v[182:185], a[80:83], v[162:165]
ds_read_b64 v[128:129], v204 offset:7448
v_mfma_f32_16x16x32_bf16 v[162:165], v[186:189], a[84:87], v[162:165]
s_add_u32 s40, s37, 588672
s_add_u32 m0, s45, 12336
v_mfma_f32_16x16x32_bf16 v[170:173], v[182:185], a[128:131], v[170:173]
s_nop 0
ds_read_b128 v[182:185], v210 offset:32768
ds_read_b64 v[126:127], v219 offset:256
v_mfma_f32_16x16x32_bf16 v[170:173], v[186:189], a[132:135], v[170:173]
s_waitcnt lgkmcnt(5)
buffer_store_dwordx2 v[120:121], v204, s[8:11], s28 offen sc1
v_fma_f32 v223, v3, v118, v119
v_fma_f32 v221, v1, v118, v119
v_mfma_f32_16x16x32_bf16 v[138:141], a[16:19], v[110:113], v[138:141]
buffer_load_dwordx4 v216, s[4:7], s40 offen nt lds
v_mfma_f32_16x16x32_bf16 v[138:141], a[20:23], v[106:109], v[138:141]
s_add_u32 s40, s37, 784896
v_fma_f32 v220, v0, v118, v119
v_fma_f32 v222, v2, v118, v119
v_mfma_f32_16x16x32_bf16 v[142:145], a[40:43], v[110:113], v[142:145]
v_cvt_pk_bf16_f32 v91, v222, v223
v_fma_f32 v222, v6, v118, v119
v_mfma_f32_16x16x32_bf16 v[142:145], a[44:47], v[106:109], v[142:145]
s_nop 0
v_fma_f32 v223, v7, v118, v119
v_cvt_pk_bf16_f32 v96, v138, v139
v_mfma_f32_16x16x32_bf16 v[146:149], a[64:67], v[110:113], v[146:149]
s_add_u32 s28, s38, s68
v_cvt_pk_bf16_f32 v90, v220, v221
v_fma_f32 v220, v4, v118, v119
v_mfma_f32_16x16x32_bf16 v[146:149], a[68:71], v[106:109], v[146:149]
s_add_u32 m0, s45, 16448
v_cvt_pk_bf16_f32 v93, v222, v223
v_fma_f32 v221, v5, v118, v119
v_mfma_f32_16x16x32_bf16 v[150:153], a[232:235], v[110:113], v[150:153]
s_waitcnt lgkmcnt(2)
buffer_store_dwordx2 v[128:129], v204, s[8:11], s29 offen sc1
v_fma_f32 v222, v10, v118, v119
v_fma_f32 v223, v11, v118, v119
v_mfma_f32_16x16x32_bf16 v[150:153], a[236:239], v[106:109], v[150:153]
s_nop 0
v_cvt_pk_bf16_f32 v92, v220, v221
v_cvt_pk_bf16_f32 v97, v140, v141
v_mfma_f32_16x16x32_bf16 v[154:157], v[224:227], v[110:113], v[154:157]
buffer_load_dwordx4 v216, s[4:7], s40 offen nt lds
v_mfma_f32_16x16x32_bf16 v[154:157], v[228:231], v[106:109], v[154:157]
s_nop 0
ds_read_b128 v[186:189], v210 offset:33792
v_cvt_pk_bf16_f32 v95, v222, v223
v_mfma_f32_16x16x32_bf16 v[158:161], v[248:251], v[110:113], v[158:161]
s_waitcnt lgkmcnt(1)
v_cvt_pk_bf16_f32 v84, v150, v151
v_fma_f32 v223, v15, v126, v127
v_cvt_pk_bf16_f32 v101, v148, v149
v_mfma_f32_16x16x32_bf16 v[158:161], v[252:255], v[106:109], v[158:161]
s_add_u32 m0, s45, 20560
v_cvt_pk_bf16_f32 v99, v144, v145
v_fma_f32 v222, v14, v126, v127
v_mfma_f32_16x16x32_bf16 v[162:165], v[110:113], a[88:91], v[162:165]
v_cvt_pk_bf16_f32 v175, v222, v223
v_fma_f32 v223, v19, v126, v127
v_mfma_f32_16x16x32_bf16 v[162:165], v[106:109], a[92:95], v[162:165]
v_fma_f32 v221, v9, v118, v119
v_cvt_pk_bf16_f32 v98, v142, v143
v_mfma_f32_16x16x32_bf16 v[166:169], v[110:113], a[112:115], v[166:169]
v_cvt_pk_bf16_f32 v87, v156, v157
v_cvt_pk_bf16_f32 v100, v146, v147
v_mfma_f32_16x16x32_bf16 v[166:169], v[106:109], a[116:119], v[166:169]
s_add_u32 s40, s37, 981120
buffer_load_dwordx4 v216, s[4:7], s40 offen nt lds
v_mfma_f32_16x16x32_bf16 v[170:173], v[110:113], a[136:139], v[170:173]
v_fma_f32 v220, v8, v118, v119
v_cvt_pk_bf16_f32 v94, v220, v221
v_mfma_f32_16x16x32_bf16 v[170:173], v[106:109], a[140:143], v[170:173]
s_waitcnt lgkmcnt(0)
ds_write_b128 v211, v[90:93]
v_mfma_f32_16x16x32_bf16 v[138:141], a[0:3], v[182:185], 0
s_add_u32 s29, s38, s69
v_cvt_pk_bf16_f32 v133, v172, v173
v_cvt_pk_bf16_f32 v125, v168, v169
v_mfma_f32_16x16x32_bf16 v[138:141], a[4:7], v[186:189], v[138:141]
s_add_u32 s40, s37, 1177344
v_cvt_pk_bf16_f32 v89, v160, v161
v_cvt_pk_bf16_f32 v86, v154, v155
v_mfma_f32_16x16x32_bf16 v[142:145], a[24:27], v[182:185], 0
v_cvt_pk_bf16_f32 v132, v170, v171
v_fma_f32 v220, v12, v126, v127
v_mfma_f32_16x16x32_bf16 v[142:145], a[28:31], v[186:189], v[142:145]
ds_read_b128 v[170:173], v210 offset:34816
v_cvt_pk_bf16_f32 v88, v158, v159
v_mfma_f32_16x16x32_bf16 v[146:149], a[48:51], v[182:185], 0
s_add_u32 m0, s45, 24672
ds_read_b128 v[182:185], v210 offset:35840
v_fma_f32 v221, v13, v126, v127
v_mfma_f32_16x16x32_bf16 v[146:149], a[52:55], v[186:189], v[146:149]
buffer_store_dwordx2 v[136:137], v204, s[8:11], s28 offen sc1
buffer_load_dwordx4 v216, s[4:7], s40 offen nt lds
v_mfma_f32_16x16x16_bf16 v[154:157], v[82:83], v[88:89], 0
ds_read_b128 v[186:189], v210 offset:36864
v_cvt_pk_bf16_f32 v85, v152, v153
v_fma_f32 v222, v18, v126, v127
v_mfma_f32_16x16x16_bf16 v[158:161], v[100:101], v[88:89], 0
v_cvt_pk_bf16_f32 v177, v222, v223
v_fma_f32 v223, v23, v126, v127
v_cvt_pk_bf16_f32 v174, v220, v221
v_fma_f32 v222, v22, v126, v127
v_mfma_f32_16x16x32_bf16 v[154:157], v[78:81], v[84:87], v[154:157]
s_waitcnt lgkmcnt(2)
ds_read_b128 v[108:111], v215 offset:512
v_fma_f32 v221, v17, v126, v127
v_mfma_f32_16x16x32_bf16 v[138:141], a[8:11], v[170:173], v[138:141]
s_waitcnt lgkmcnt(2)
ds_read_b64 v[120:121], v204 offset:12936
v_fma_f32 v220, v16, v126, v127
v_mfma_f32_16x16x32_bf16 v[138:141], a[12:15], v[182:185], v[138:141]
ds_read_b64 v[112:113], v215 offset:528
v_cvt_pk_bf16_f32 v176, v220, v221
v_mfma_f32_16x16x32_bf16 v[142:145], a[32:35], v[170:173], v[142:145]
s_nop 0
v_fma_f32 v220, v20, v126, v127
v_fma_f32 v221, v21, v126, v127
v_mfma_f32_16x16x32_bf16 v[142:145], a[36:39], v[182:185], v[142:145]
s_waitcnt lgkmcnt(3)
ds_read_b64 v[136:137], v204 offset:13720
v_cvt_pk_bf16_f32 v179, v222, v223
v_mfma_f32_16x16x32_bf16 v[146:149], a[56:59], v[170:173], v[146:149]
s_add_u32 s40, s37, 1373568
ds_read_b128 v[170:173], v210 offset:37888
ds_read_b64 v[128:129], v204 offset:13328
v_mfma_f32_16x16x32_bf16 v[146:149], a[60:63], v[182:185], v[146:149]
s_add_u32 m0, s45, 28784
v_cvt_pk_bf16_f32 v178, v220, v221
v_cvt_pk_bf16_f32 v124, v166, v167
v_mfma_f32_16x16x32_bf16 v[146:149], a[64:67], v[186:189], v[146:149]
s_waitcnt lgkmcnt(3)
ds_write_b64 v212, v[94:95]
v_mfma_f32_16x16x16_bf16 v[166:169], v[112:113], v[88:89], v[206:209]
buffer_store_dwordx2 v[120:121], v204, s[8:11], s29 offen sc1
v_fma_f32 v221, v25, v134, v135
v_exp_f32 v154, v154
v_mfma_f32_16x16x32_bf16 v[142:145], a[40:43], v[186:189], v[142:145]
s_add_u32 s29, s38, s71
buffer_load_dwordx4 v216, s[4:7], s40 offen nt lds
v_mfma_f32_16x16x32_bf16 v[138:141], a[16:19], v[186:189], v[138:141]
s_waitcnt lgkmcnt(2)
ds_read_b128 v[186:189], v210 offset:33792
ds_read_b128 v[182:185], v210 offset:32768
v_mfma_f32_16x16x32_bf16 v[138:141], a[20:23], v[170:173], v[138:141]
ds_write_b128 v211, v[174:177] offset:6144
v_mfma_f32_16x16x32_bf16 v[142:145], a[44:47], v[170:173], v[142:145]
v_cvt_pk_bf16_f32 v102, v138, v139
v_fma_f32 v222, v26, v134, v135
v_cvt_pk_bf16_f32 v103, v140, v141
v_mfma_f32_16x16x32_bf16 v[150:153], v[108:111], v[72:75], v[206:209]
s_add_u32 s28, s38, s70
v_fma_f32 v220, v24, v134, v135
v_cvt_pk_bf16_f32 v90, v220, v221
v_mfma_f32_16x16x32_bf16 v[138:141], v[78:81], v[72:75], 0
s_waitcnt lgkmcnt(4)
ds_write_b64 v212, v[178:179] offset:6144
v_mfma_f32_16x16x16_bf16 v[150:153], v[112:113], v[76:77], v[150:153]
buffer_store_dwordx2 v[128:129], v204, s[8:11], s28 offen sc1
v_fma_f32 v223, v27, v134, v135
v_cvt_pk_bf16_f32 v91, v222, v223
v_mfma_f32_16x16x16_bf16 v[138:141], v[82:83], v[76:77], v[138:141]
v_fma_f32 v220, v28, v134, v135
v_fma_f32 v221, v29, v134, v135
v_cvt_pk_bf16_f32 v92, v220, v221
v_cvt_pk_bf16_f32 v104, v142, v143
v_mfma_f32_16x16x32_bf16 v[166:169], v[108:111], v[84:87], v[166:169]
v_fma_f32 v221, v33, v134, v135
v_fma_f32 v220, v32, v134, v135
v_mfma_f32_16x16x32_bf16 v[146:149], a[68:71], v[170:173], v[146:149]
s_nop 0
v_fma_f32 v223, v31, v134, v135
v_fma_f32 v222, v30, v134, v135
v_mfma_f32_16x16x32_bf16 v[158:161], v[96:99], v[84:87], v[158:161]
s_waitcnt lgkmcnt(2)
v_cvt_pk_bf16_f32 v93, v222, v223
v_fma_f32 v222, v34, v134, v135
v_mfma_f32_16x16x32_bf16 v[126:129], v[182:185], a[96:99], 0
ds_read_b128 v[174:177], v210 offset:34816
ds_read_b128 v[178:181], v210 offset:35840
v_mfma_f32_16x16x32_bf16 v[118:121], v[182:185], a[72:75], 0
v_cvt_pk_bf16_f32 v105, v144, v145
v_cvt_pk_bf16_f32 v106, v146, v147
v_mfma_f32_16x16x32_bf16 v[170:173], a[240:243], v[182:185], 0
v_cvt_pk_bf16_f32 v107, v148, v149
v_fma_f32 v223, v35, v134, v135
v_mfma_f32_16x16x32_bf16 v[170:173], a[244:247], v[186:189], v[170:173]
s_add_u32 m0, s45, 32896
ds_write_b128 v211, v[90:93] offset:12288
v_mfma_f32_16x16x32_bf16 v[146:149], v[102:105], v[72:75], 0
s_add_u32 s40, s37, 1569792
v_exp_f32 v157, v157
v_mfma_f32_16x16x32_bf16 v[142:145], v[96:99], v[72:75], 0
buffer_store_dwordx2 v[136:137], v204, s[8:11], s29 offen sc1
v_exp_f32 v160, v160
v_mfma_f32_16x16x32_bf16 v[90:93], a[216:219], v[182:185], 0
v_exp_f32 v138, v138
v_mfma_f32_16x16x32_bf16 v[90:93], a[220:223], v[186:189], v[90:93]
s_waitcnt lgkmcnt(2)
v_exp_f32 v140, v140
v_mfma_f32_16x16x32_bf16 v[134:137], v[182:185], a[120:123], 0
s_add_u32 s35, s35, 32
v_exp_f32_e64 v166, v166
v_mfma_f32_16x16x32_bf16 v[134:137], v[186:189], a[124:127], v[134:137]
s_mul_hi_u32 s41, s35, 58835169
buffer_load_dwordx4 v216, s[4:7], s40 offen nt lds
v_mfma_f32_16x16x32_bf16 v[134:137], v[174:177], a[128:131], v[134:137]
s_waitcnt lgkmcnt(1)
v_exp_f32 v141, v141
v_mfma_f32_16x16x32_bf16 v[134:137], v[178:181], a[132:135], v[134:137]
v_exp_f32_e64 v139, v139
v_mfma_f32_16x16x32_bf16 v[118:121], v[186:189], a[76:79], v[118:121]
v_cvt_pk_bf16_f32 v94, v220, v221
v_cvt_pk_bf16_f32 v95, v222, v223
v_mfma_f32_16x16x32_bf16 v[118:121], v[174:177], a[80:83], v[118:121]
ds_read_b128 v[72:75], v215
v_exp_f32 v155, v155
v_mfma_f32_16x16x16_bf16 v[146:149], v[106:107], v[76:77], v[146:149]
v_cvt_pk_bf16_f32 v117, v164, v165
v_exp_f32 v158, v158
v_mfma_f32_16x16x16_bf16 v[142:145], v[100:101], v[76:77], v[142:145]
v_cvt_pk_bf16_f32 v116, v162, v163
v_exp_f32 v159, v159
v_mfma_f32_16x16x16_bf16 v[162:165], v[106:107], v[88:89], 0
v_exp_f32 v147, v147
v_exp_f32 v150, v150
v_mfma_f32_16x16x32_bf16 v[126:129], v[186:189], a[100:103], v[126:129]
v_exp_f32 v143, v143
v_mfma_f32_16x16x32_bf16 v[126:129], v[174:177], a[104:107], v[126:129]
v_exp_f32 v149, v149
v_mfma_f32_16x16x32_bf16 v[126:129], v[178:181], a[108:111], v[126:129]
ds_write_b64 v212, v[94:95] offset:12288
v_mfma_f32_16x16x32_bf16 v[220:223], v[232:235], v[182:185], 0
s_mov_b32 s38, s36
v_exp_f32_e64 v142, v142
v_mfma_f32_16x16x32_bf16 v[220:223], v[236:239], v[186:189], v[220:223]
ds_read_b128 v[182:185], v210 offset:36864
ds_read_b128 v[186:189], v210 offset:37888
v_mfma_f32_16x16x32_bf16 v[220:223], v[240:243], v[174:177], v[220:223]
v_exp_f32 v144, v144
v_mfma_f32_16x16x32_bf16 v[220:223], v[244:247], v[178:181], v[220:223]
v_exp_f32 v146, v146
v_mfma_f32_16x16x32_bf16 v[162:165], v[102:105], v[84:87], v[162:165]
v_exp_f32 v145, v145
v_mfma_f32_16x16x32_bf16 v[170:173], a[248:251], v[174:177], v[170:173]
v_exp_f32 v156, v156
v_mfma_f32_16x16x32_bf16 v[170:173], a[252:255], v[178:181], v[170:173]
v_exp_f32 v163, v163
v_mfma_f32_16x16x32_bf16 v[90:93], a[224:227], v[174:177], v[90:93]
v_exp_f32 v165, v165
v_mfma_f32_16x16x32_bf16 v[90:93], a[228:231], v[178:181], v[90:93]
s_waitcnt lgkmcnt(1)
v_exp_f32 v161, v161
v_mfma_f32_16x16x32_bf16 v[118:121], v[178:181], a[84:87], v[118:121]
s_mul_i32 s42, s41, 73
v_cvt_pk_bf16_f32 v174, v138, v139
v_cvt_pk_bf16_f32 v175, v140, v141
v_mfma_f32_16x16x32_bf16 v[118:121], v[182:185], a[88:91], v[118:121]
s_waitcnt lgkmcnt(0)
v_exp_f32_e64 v164, v164
v_mfma_f32_16x16x32_bf16 v[118:121], v[186:189], a[92:95], v[118:121]
s_add_u32 s29, s39, s61
ds_read_b64 v[76:77], v215 offset:16
v_cvt_pk_bf16_f32 v178, v146, v147
v_mfma_f32_16x16x32_bf16 v[126:129], v[182:185], a[112:115], v[126:129]
v_exp_f32_e64 v148, v148
v_mfma_f32_16x16x32_bf16 v[126:129], v[186:189], a[116:119], v[126:129]
v_cvt_pk_bf16_f32 v118, v118, v119
v_cvt_pk_bf16_f32 v176, v142, v143
v_mfma_f32_16x16x32_bf16 v[134:137], v[182:185], a[136:139], v[134:137]
s_nop 0
v_cvt_pk_bf16_f32 v180, v150, 0
v_cvt_pk_bf16_f32 v177, v144, v145
v_mfma_f32_16x16x32_bf16 v[134:137], v[186:189], a[140:143], v[134:137]
s_sub_u32 s42, s35, s42
v_cvt_pk_bf16_f32 v126, v126, v127
v_cvt_pk_bf16_f32 v119, v120, v121
v_mfma_f32_16x16x32_bf16 v[90:93], a[232:235], v[182:185], v[90:93]
ds_read_u16 v120, v205
v_mov_b32_e64 v121, 0
v_mfma_f32_16x16x32_bf16 v[90:93], a[236:239], v[186:189], v[90:93]
v_exp_f32_e64 v162, v162
v_mfma_f32_16x16x32_bf16 v[220:223], v[248:251], v[182:185], v[220:223]
v_cvt_pk_bf16_f32 v179, v148, v149
v_cvt_pk_bf16_f32 v127, v128, v129
v_mfma_f32_16x16x32_bf16 v[220:223], v[252:255], v[186:189], v[220:223]
ds_read_u16 v128, v205 offset:32
v_mov_b32_e64 v181, 0
v_mfma_f32_16x16x32_bf16 v[150:153], v[190:193], v[174:177], 0
v_cvt_pk_bf16_f32 v134, v134, v135
v_cvt_pk_bf16_f32 v135, v136, v137
v_mov_b32 v129, 0
v_mfma_f32_16x16x32_bf16 v[150:153], v[190:193], v[178:181], v[150:153]
s_waitcnt lgkmcnt(1)
ds_read_u16 v136, v205 offset:64
v_cvt_pk_bf16_f32 v95, v222, v223
v_mfma_f32_16x16x32_bf16 v[138:141], v[114:117], v[174:177], 0
s_mul_i32 s43, s41, 1373568
v_cvt_pk_bf16_f32 v90, v90, v91
v_mov_b32_e64 v137, 0
v_mfma_f32_16x16x32_bf16 v[138:141], v[118:121], v[178:181], v[138:141]
v_rcp_f32 v151, v150
v_mfma_f32_16x16x32_bf16 v[142:145], v[122:125], v[174:177], 0
s_waitcnt lgkmcnt(1)
v_mul_f32_e64 v152, s3, v151
v_cvt_pk_bf16_f32 v91, v92, v93
v_mfma_f32_16x16x32_bf16 v[142:145], v[126:129], v[178:181], v[142:145]
v_mul_f32 v140, v140, v152
v_mul_f32 v138, v138, v152
v_mfma_f32_16x16x32_bf16 v[146:149], v[130:133], v[174:177], 0
s_waitcnt lgkmcnt(0)
v_mul_f32 v139, v139, v152
v_cvt_pk_bf16_f32 v175, v156, v157
v_mfma_f32_16x16x32_bf16 v[146:149], v[134:137], v[178:181], v[146:149]
s_min_u32 s41, s41, 1
v_cvt_pk_bf16_f32 v176, v158, v159
v_cvt_pk_bf16_f32 v180, v166, 0
v_mul_f32 v145, v145, v152
v_mul_f32 v142, v142, v152
v_mul_f32 v141, v141, v152
v_mfma_f32_16x16x32_bf16 v[170:173], v[224:227], v[182:185], v[170:173]
s_mul_i32 s51, s42, 2688
v_cvt_pk_bf16_f32 v174, v154, v155
v_cvt_pk_bf16_f32 v179, v164, v165
v_mul_f32_e64 v147, v147, v152
v_mfma_f32_16x16x32_bf16 v[170:173], v[228:231], v[186:189], v[170:173]
v_cvt_pk_bf16_f32 v94, v220, v221
v_cvt_pk_bf16_f32 v177, v160, v161
v_cvt_pk_bf16_f32 v138, v138, v139
v_cvt_pk_bf16_f32 v178, v162, v163
v_mfma_f32_16x16x32_bf16 v[166:169], v[190:193], v[174:177], 0
v_cvt_pk_bf16_f32 v139, v140, v141
v_mul_f32_e64 v143, v143, v152
v_mfma_f32_16x16x32_bf16 v[166:169], v[190:193], v[178:181], v[166:169]
v_mul_f32 v149, v149, v152
v_mul_f32 v144, v144, v152
v_mfma_f32_16x16x32_bf16 v[154:157], v[114:117], v[174:177], 0
v_cvt_pk_bf16_f32 v93, v172, v173
v_mul_f32_e64 v146, v146, v152
v_mfma_f32_16x16x32_bf16 v[154:157], v[118:121], v[178:181], v[154:157]
v_cvt_pk_bf16_f32 v141, v144, v145
v_cvt_pk_bf16_f32 v140, v142, v143
v_max3_u32 v218, v218, v150, v151
v_mfma_f32_16x16x32_bf16 v[158:161], v[122:125], v[174:177], 0
v_rcp_f32 v167, v166
v_mfma_f32_16x16x32_bf16 v[158:161], v[126:129], v[178:181], v[158:161]
ds_write_b128 v211, v[138:141] offset:38912
v_mul_f32 v168, s3, v167
v_mul_f32_e64 v148, v148, v152
v_cvt_pk_bf16_f32 v92, v170, v171
v_mfma_f32_16x16x32_bf16 v[162:165], v[130:133], v[174:177], 0
s_sub_u32 s41, 1, s41
v_cvt_pk_bf16_f32 v142, v146, v147
v_mul_f32 v155, v155, v168
v_cvt_pk_bf16_f32 v143, v148, v149
v_mfma_f32_16x16x32_bf16 v[162:165], v[134:137], v[178:181], v[162:165]
v_mul_f32 v154, v154, v168
v_mul_f32 v157, v157, v168
v_mul_f32_e64 v159, v159, v168
v_mfma_f32_16x16x32_bf16 v[150:153], v[108:111], v[90:93], v[206:209]
v_mul_f32 v161, v161, v168
v_mul_f32 v156, v156, v168
v_mfma_f32_16x16x32_bf16 v[138:141], v[78:81], v[90:93], 0
ds_write_b64 v212, v[142:143] offset:38912
v_mfma_f32_16x16x16_bf16 v[150:153], v[112:113], v[94:95], v[150:153]
v_cvt_pk_bf16_f32 v154, v154, v155
v_mul_f32_e64 v158, v158, v168
v_cvt_pk_bf16_f32 v155, v156, v157
v_mfma_f32_16x16x16_bf16 v[138:141], v[82:83], v[94:95], v[138:141]
v_mul_f32 v160, v160, v168
v_mul_f32 v162, v162, v168
v_cvt_pk_bf16_f32 v157, v160, v161
v_cvt_pk_bf16_f32 v156, v158, v159
v_mfma_f32_16x16x32_bf16 v[142:145], v[96:99], v[90:93], 0
ds_write_b128 v211, v[154:157] offset:45056
v_mfma_f32_16x16x16_bf16 v[142:145], v[100:101], v[94:95], v[142:145]
v_mul_f32 v163, v163, v168
v_mul_f32 v164, v164, v168
v_mul_f32_e64 v165, v165, v168
v_cvt_pk_bf16_f32 v159, v164, v165
v_cvt_pk_bf16_f32 v158, v162, v163
v_mfma_f32_16x16x32_bf16 v[146:149], v[102:105], v[90:93], 0
ds_write_b64 v212, v[158:159] offset:45056
v_mfma_f32_16x16x16_bf16 v[154:157], v[76:77], v[82:83], 0
v_exp_f32_e64 v141, v141
v_max3_u32 v218, v218, v166, v167
v_mfma_f32_16x16x16_bf16 v[146:149], v[106:107], v[94:95], v[146:149]
v_exp_f32 v143, v143
v_exp_f32 v144, v144
v_mfma_f32_16x16x16_bf16 v[158:161], v[76:77], v[100:101], 0
v_exp_f32 v145, v145
v_exp_f32 v140, v140
v_mfma_f32_16x16x16_bf16 v[166:169], v[76:77], v[112:113], v[206:209]
v_cvt_pk_bf16_f32 v175, v140, v141
v_exp_f32 v138, v138
v_mfma_f32_16x16x16_bf16 v[162:165], v[76:77], v[106:107], 0
v_exp_f32 v139, v139
v_exp_f32 v142, v142
v_mfma_f32_16x16x32_bf16 v[154:157], v[72:75], v[78:81], v[154:157]
s_waitcnt lgkmcnt(0)
v_cvt_pk_bf16_f32 v177, v144, v145
v_cvt_pk_bf16_f32 v174, v138, v139
v_mfma_f32_16x16x32_bf16 v[158:161], v[72:75], v[96:99], v[158:161]
s_barrier
ds_read_b128 v[220:223], v210 offset:38912
v_mfma_f32_16x16x32_bf16 v[166:169], v[72:75], v[108:111], v[166:169]
s_nop 0
ds_read_b128 v[110:113], v210 offset:39936
v_cvt_pk_bf16_f32 v176, v142, v143
v_mfma_f32_16x16x32_bf16 v[162:165], v[72:75], v[102:105], v[162:165]
v_exp_f32 v150, v150
v_mfma_f32_16x16x32_bf16 v[142:145], v[122:125], v[174:177], 0
v_cvt_pk_bf16_f32 v180, v150, 0
v_mfma_f32_16x16x32_bf16 v[138:141], v[114:117], v[174:177], 0
v_exp_f32 v149, v149
v_mfma_f32_16x16x32_bf16 v[150:153], v[190:193], v[174:177], 0
ds_read_b128 v[170:173], v210 offset:40960
s_waitcnt lgkmcnt(2)
v_mfma_f32_16x16x32_bf16 v[40:43], a[168:171], v[220:223], v[40:43]
v_mov_b32_dpp v154, v158 quad_perm:[0,1,2,3] row_mask:0x2 bank_mask:0xf
s_waitcnt lgkmcnt(1)
v_mfma_f32_16x16x32_bf16 v[40:43], a[172:175], v[110:113], v[40:43]
v_exp_f32 v147, v147
v_mfma_f32_16x16x32_bf16 v[44:47], a[192:195], v[220:223], v[44:47]
s_add_u32 s28, s39, s60
v_exp_f32 v146, v146
v_mfma_f32_16x16x32_bf16 v[44:47], a[196:199], v[110:113], v[44:47]
v_exp_f32 v148, v148
v_mfma_f32_16x16x32_bf16 v[36:39], a[144:147], v[220:223], v[36:39]
v_cvt_pk_bf16_f32 v179, v148, v149
v_cvt_pk_bf16_f32 v178, v146, v147
v_mfma_f32_16x16x32_bf16 v[36:39], a[148:151], v[110:113], v[36:39]
ds_read_b128 v[182:185], v210 offset:41984
ds_read_b128 v[110:113], v210 offset:45056
v_mfma_f32_16x16x32_bf16 v[150:153], v[190:193], v[178:181], v[150:153]
v_mov_b32_dpp v154, v162 quad_perm:[0,1,2,3] row_mask:0x4 bank_mask:0xf
v_mfma_f32_16x16x32_bf16 v[138:141], v[118:121], v[178:181], v[138:141]
ds_read_b128 v[220:223], v210 offset:44032
ds_read_b128 v[186:189], v210 offset:43008
v_mfma_f32_16x16x32_bf16 v[142:145], v[126:129], v[178:181], v[142:145]
v_rcp_f32 v151, v150
v_mfma_f32_16x16x32_bf16 v[146:149], v[130:133], v[174:177], 0
v_mul_f32 v152, s3, v151
v_mov_b32_dpp v154, v167 quad_perm:[0,1,2,3] row_mask:0x8 bank_mask:0xf
v_mfma_f32_16x16x32_bf16 v[146:149], v[134:137], v[178:181], v[146:149]
s_waitcnt lgkmcnt(4)
v_mul_f32 v139, v139, v152
v_mul_f32_e64 v140, v140, v152
v_mfma_f32_16x16x32_bf16 v[36:39], a[152:155], v[170:173], v[36:39]
s_waitcnt lgkmcnt(3)
v_mul_f32 v138, v138, v152
v_cvt_pk_bf16_f32 v138, v138, v139
v_mfma_f32_16x16x32_bf16 v[36:39], a[156:159], v[182:185], v[36:39]
v_mul_f32 v141, v141, v152
v_mul_f32 v142, v142, v152
v_mfma_f32_16x16x32_bf16 v[40:43], a[176:179], v[170:173], v[40:43]
v_exp_f32 v154, v154
v_mfma_f32_16x16x32_bf16 v[40:43], a[180:183], v[182:185], v[40:43]
v_mul_f32 v143, v143, v152
v_cvt_pk_bf16_f32 v154, v154, 0
v_mfma_f32_16x16x32_bf16 v[44:47], a[200:203], v[170:173], v[44:47]
v_cvt_pk_bf16_f32 v139, v140, v141
v_mul_f32 v145, v145, v152
v_mfma_f32_16x16x32_bf16 v[44:47], a[204:207], v[182:185], v[44:47]
s_waitcnt lgkmcnt(0)
v_cvt_pk_bf16_f32 v140, v142, v143
v_mul_f32_e64 v144, v144, v152
v_mfma_f32_16x16x32_bf16 v[44:47], a[208:211], v[186:189], v[44:47]
ds_read_b128 v[170:173], v210 offset:46080
v_cvt_pk_bf16_f32 v141, v144, v145
v_mfma_f32_16x16x32_bf16 v[44:47], a[212:215], v[220:223], v[44:47]
ds_write_b128 v211, v[138:141] offset:51200
v_mfma_f32_16x16x32_bf16 v[36:39], a[160:163], v[186:189], v[36:39]
v_mul_f32 v148, v148, v152
v_mul_f32 v149, v149, v152
v_mfma_f32_16x16x32_bf16 v[36:39], a[164:167], v[220:223], v[36:39]
v_cvt_pk_bf16_f32 v44, v44, v45
v_mfma_f32_16x16x32_bf16 v[40:43], a[184:187], v[186:189], v[40:43]
s_nop 0
ds_write_b16 v214, v154
v_mfma_f32_16x16x32_bf16 v[40:43], a[188:191], v[220:223], v[40:43]
s_add_u32 s50, s43, s51
ds_read_b128 v[182:185], v210 offset:47104
v_cvt_pk_bf16_f32 v45, v46, v47
v_mfma_f32_16x16x32_bf16 v[48:51], a[144:147], v[110:113], v[48:51]
s_waitcnt lgkmcnt(3)
ds_read_b128 v[186:189], v210 offset:48128
ds_read_b128 v[220:223], v210 offset:49152
v_mfma_f32_16x16x32_bf16 v[48:51], a[148:151], v[170:173], v[48:51]
s_lshl_b32 s41, s41, 30
ds_read_b128 v[88:91], v215 offset:16
v_cvt_pk_bf16_f32 v36, v36, v37
v_mfma_f32_16x16x32_bf16 v[52:55], a[168:171], v[110:113], v[52:55]
v_cvt_pk_bf16_f32 v37, v38, v39
v_mul_f32_e64 v147, v147, v152
v_mfma_f32_16x16x32_bf16 v[52:55], a[172:175], v[170:173], v[52:55]
ds_write_b64 v203, v[44:45] offset:64
v_mfma_f32_16x16x32_bf16 v[56:59], a[192:195], v[110:113], v[56:59]
v_mul_f32 v146, v146, v152
v_cvt_pk_bf16_f32 v40, v40, v41
v_mfma_f32_16x16x32_bf16 v[56:59], a[196:199], v[170:173], v[56:59]
s_waitcnt lgkmcnt(4)
ds_read_b128 v[110:113], v210 offset:50176
v_cvt_pk_bf16_f32 v41, v42, v43
v_mfma_f32_16x16x32_bf16 v[56:59], a[200:203], v[182:185], v[56:59]
s_waitcnt lgkmcnt(4)
ds_write_b64 v203, v[36:37]
v_mfma_f32_16x16x32_bf16 v[56:59], a[204:207], v[186:189], v[56:59]
v_cvt_pk_bf16_f32 v143, v148, v149
v_mfma_f32_16x16x32_bf16 v[48:51], a[152:155], v[182:185], v[48:51]
ds_read_b128 v[84:87], v215
v_mfma_f32_16x16x32_bf16 v[48:51], a[156:159], v[186:189], v[48:51]
s_waitcnt lgkmcnt(5)
ds_write_b64 v203, v[40:41] offset:32
v_mfma_f32_16x16x32_bf16 v[48:51], a[160:163], v[220:223], v[48:51]
s_nop 0
v_cvt_pk_bf16_f32 v142, v146, v147
s_waitcnt lgkmcnt(3)
v_mfma_f32_16x16x32_bf16 v[48:51], a[164:167], v[110:113], v[48:51]
ds_write_b64 v212, v[142:143] offset:51200
v_mfma_f32_16x16x32_bf16 v[56:59], a[208:211], v[220:223], v[56:59]
v_mfma_f32_16x16x32_bf16 v[56:59], a[212:215], v[110:113], v[56:59]
v_cvt_pk_bf16_f32 v48, v48, v49
v_mfma_f32_16x16x32_bf16 v[52:55], a[176:179], v[182:185], v[52:55]
v_cvt_pk_bf16_f32 v49, v50, v51
v_add_u32 v205, 1424, v205
v_mfma_f32_16x16x32_bf16 v[52:55], a[180:183], v[186:189], v[52:55]
s_nop 0
ds_write_b64 v203, v[48:49] offset:6272
v_mfma_f32_16x16x32_bf16 v[52:55], a[184:187], v[220:223], v[52:55]
s_add_u32 s52, s50, s41
s_min_u32 s43, s42, 1
s_waitcnt vmcnt(0) lgkmcnt(1)
v_mfma_f32_16x16x32_bf16 v[52:55], a[188:191], v[110:113], v[52:55]
s_barrier
v_mfma_f32_16x16x32_bf16 v[158:161], v[84:87], v[122:125], 0
s_nop 0
ds_read_b128 v[178:181], v217 offset:528
v_mfma_f32_16x16x32_bf16 v[158:161], v[88:91], v[126:129], v[158:161]
ds_read_b128 v[170:173], v210 offset:51200
ds_read_b128 v[182:185], v210 offset:52224
v_mfma_f32_16x16x32_bf16 v[154:157], v[84:87], v[114:117], 0
s_nop 0
ds_read_b128 v[220:223], v210 offset:54272
v_mfma_f32_16x16x32_bf16 v[154:157], v[88:91], v[118:121], v[154:157]
s_mov_b32 s36, s50
ds_read_b128 v[186:189], v210 offset:53248
ds_read_b128 v[110:113], v210 offset:55296
v_mfma_f32_16x16x32_bf16 v[162:165], v[84:87], v[130:133], 0
ds_read_b64 v[120:121], v204
v_mfma_f32_16x16x32_bf16 v[162:165], v[88:91], v[134:137], v[162:165]
v_mov_b32_dpp v154, v158 quad_perm:[0,1,2,3] row_mask:0x2 bank_mask:0xf
v_max3_u32 v218, v218, v150, v151
v_mfma_f32_16x16x32_bf16 v[166:169], v[84:87], v[190:193], 0
s_nop 0
ds_read_b128 v[84:87], v200
v_add_u32 v215, 1424, v215
v_mfma_f32_16x16x32_bf16 v[166:169], v[88:91], v[190:193], v[166:169]
s_waitcnt lgkmcnt(6)
ds_read_b128 v[92:95], v201
ds_read_b128 v[174:177], v217
v_mfma_f32_16x16x32_bf16 v[60:63], a[144:147], v[170:173], v[60:63]
s_lshl_b32 s43, s43, 27
v_cvt_pk_bf16_f32 v52, v52, v53
s_waitcnt lgkmcnt(7)
v_mfma_f32_16x16x32_bf16 v[60:63], a[148:151], v[182:185], v[60:63]
v_mfma_f32_16x16x32_bf16 v[64:67], a[168:171], v[170:173], v[64:67]
ds_read_b128 v[100:103], v202
ds_read_b128 v[96:99], v195 offset:16
v_mfma_f32_16x16x32_bf16 v[64:67], a[172:175], v[182:185], v[64:67]
v_mfma_f32_16x16x32_bf16 v[68:71], a[192:195], v[170:173], v[68:71]
s_add_u32 s51, s42, 56
v_rcp_f32 v167, v166
v_mfma_f32_16x16x32_bf16 v[68:71], a[196:199], v[182:185], v[68:71]
s_waitcnt lgkmcnt(7)
ds_read_b128 v[170:173], v210 offset:56320
v_cvt_pk_bf16_f32 v56, v56, v57
v_mfma_f32_16x16x32_bf16 v[68:71], a[200:203], v[186:189], v[68:71]
s_waitcnt lgkmcnt(3)
v_cvt_pk_bf16_f32 v57, v58, v59
v_cvt_pk_bf16_f32 v53, v54, v55
v_mfma_f32_16x16x32_bf16 v[48:51], v[174:177], v[92:95], 0
ds_read_b128 v[92:95], v195
ds_read_b128 v[182:185], v210
v_mfma_f32_16x16x32_bf16 v[36:39], v[174:177], v[84:87], 0
s_sub_u32 s43, 536870911, s43
ds_write_b64 v203, v[52:53] offset:6304
v_mfma_f32_16x16x32_bf16 v[60:63], a[152:155], v[186:189], v[60:63]
v_mfma_f32_16x16x32_bf16 v[60:63], a[156:159], v[220:223], v[60:63]
ds_read_b128 v[104:107], v196 offset:16
v_mul_f32 v168, s3, v167
v_mfma_f32_16x16x32_bf16 v[60:63], a[160:163], v[110:113], v[60:63]
s_waitcnt lgkmcnt(4)
ds_read_b128 v[84:87], v194
ds_read_b128 v[88:91], v194 offset:16
v_mfma_f32_16x16x32_bf16 v[60:63], a[164:167], v[170:173], v[60:63]
ds_write_b64 v203, v[56:57] offset:6336
v_mfma_f32_16x16x32_bf16 v[64:67], a[176:179], v[186:189], v[64:67]
buffer_store_dwordx2 v[120:121], v204, s[8:11], s28 offen sc1
s_and_b32 s51, s51, 128
ds_read_b128 v[186:189], v210 offset:1024
v_mfma_f32_16x16x32_bf16 v[64:67], a[180:183], v[220:223], v[64:67]
v_cvt_pk_bf16_f32 v60, v60, v61
v_cvt_pk_bf16_f32 v61, v62, v63
v_mfma_f32_16x16x32_bf16 v[64:67], a[184:187], v[110:113], v[64:67]
ds_write_b64 v203, v[60:61] offset:12544
v_mfma_f32_16x16x32_bf16 v[64:67], a[188:191], v[170:173], v[64:67]
v_max3_u32 v218, v218, v166, v167
v_mfma_f32_16x16x32_bf16 v[60:63], v[174:177], v[100:103], 0
s_waitcnt lgkmcnt(8)
ds_read_b128 v[100:103], v196
v_mov_b32_dpp v154, v162 quad_perm:[0,1,2,3] row_mask:0x4 bank_mask:0xf
v_smfmac_f32_16x16x64_bf16 v[48:51], v[178:181], v[92:99], v213
s_waitcnt lgkmcnt(4)
ds_read_b128 v[92:95], v198
ds_read_b64 v[128:129], v204 offset:392
v_smfmac_f32_16x16x64_bf16 v[36:39], v[178:181], v[84:91], v213
ds_read_b128 v[174:177], v217 offset:1056
ds_read_b128 v[84:87], v197
v_mfma_f32_16x16x32_bf16 v[68:71], a[204:207], v[220:223], v[68:71]
ds_read_b128 v[88:91], v197 offset:16
v_cvt_pk_bf16_f32 v64, v64, v65
v_mfma_f32_16x16x32_bf16 v[68:71], a[208:211], v[110:113], v[68:71]
ds_read_b128 v[96:99], v198 offset:16
v_mfma_f32_16x16x32_bf16 v[68:71], a[212:215], v[170:173], v[68:71]
s_nop 0
v_cvt_pk_bf16_f32 v65, v66, v67
s_waitcnt lgkmcnt(6)
v_smfmac_f32_16x16x64_bf16 v[60:63], v[178:181], v[100:107], v213
ds_read_b128 v[100:103], v199
v_mul_f32 v154, v154, v168
v_mfma_f32_16x16x32_bf16 v[162:165], v[182:185], a[72:75], 0
s_waitcnt lgkmcnt(5)
buffer_store_dwordx2 v[128:129], v204, s[8:11], s29 offen sc1
v_cvt_pk_bf16_f32 v154, v154, 0
v_cvt_pk_bf16_f32 v68, v68, v69
v_mfma_f32_16x16x32_bf16 v[162:165], v[186:189], a[76:79], v[162:165]
ds_read_b128 v[104:107], v199 offset:16
ds_read_b128 v[220:223], v210 offset:3072
v_mfma_f32_16x16x32_bf16 v[166:169], v[182:185], a[96:99], 0
ds_write_b64 v203, v[64:65] offset:12576
v_mfma_f32_16x16x32_bf16 v[166:169], v[186:189], a[100:103], v[166:169]
s_nop 0
v_mfma_f32_16x16x32_bf16 v[170:173], v[182:185], a[120:123], 0
s_waitcnt lgkmcnt(5)
ds_write_b16 v214, v154
v_smfmac_f32_16x16x64_bf16 v[36:39], v[174:177], v[84:91], v213
ds_read_b128 v[178:181], v217 offset:1584
s_waitcnt lgkmcnt(6)
v_smfmac_f32_16x16x64_bf16 v[48:51], v[174:177], v[92:99], v213
s_waitcnt lgkmcnt(4)
ds_read_b128 v[92:95], v201 offset:32
ds_read_b128 v[84:87], v200 offset:32
v_smfmac_f32_16x16x64_bf16 v[60:63], v[174:177], v[100:107], v213
ds_read_b128 v[100:103], v202 offset:32
ds_read_b128 v[104:107], v196 offset:48
v_mfma_f32_16x16x32_bf16 v[138:141], a[0:3], v[182:185], 0
v_mul_f32 v119, v36, v36
v_fmac_f32 v119, v37, v37
v_mfma_f32_16x16x32_bf16 v[138:141], a[4:7], v[186:189], v[138:141]
ds_read_b128 v[96:99], v195 offset:48
ds_read_b128 v[110:113], v210 offset:2048
v_mfma_f32_16x16x32_bf16 v[142:145], a[24:27], v[182:185], 0
v_mul_f32 v127, v48, v48
v_add_f32 v118, v36, v37
v_mfma_f32_16x16x32_bf16 v[142:145], a[28:31], v[186:189], v[142:145]
ds_read_b128 v[88:91], v194 offset:48
v_add_f32_e64 v126, v48, v49
v_mfma_f32_16x16x32_bf16 v[146:149], a[48:51], v[182:185], 0
v_fmac_f32_e64 v119, v38, v38
v_add_f32 v118, v118, v38
v_mfma_f32_16x16x32_bf16 v[146:149], a[52:55], v[186:189], v[146:149]
s_waitcnt lgkmcnt(5)
ds_read_b128 v[174:177], v217 offset:2112
v_fmac_f32_e64 v119, v39, v39
v_mfma_f32_16x16x32_bf16 v[40:43], v[178:181], v[84:87], 0
s_lshl_b32 s51, s51, 22
ds_read_b128 v[84:87], v194 offset:32
s_waitcnt lgkmcnt(6)
v_mfma_f32_16x16x32_bf16 v[64:67], v[178:181], v[100:103], 0
v_mul_f32 v135, v60, v60
v_fmac_f32 v127, v49, v49
v_mfma_f32_16x16x32_bf16 v[52:55], v[178:181], v[92:95], 0
ds_read_b128 v[92:95], v195 offset:32
v_fmac_f32_e64 v127, v50, v50
v_mfma_f32_16x16x32_bf16 v[158:161], v[232:235], v[182:185], 0
ds_read_b128 v[100:103], v196 offset:32
ds_read_b128 v[178:181], v217 offset:2640
v_mfma_f32_16x16x32_bf16 v[158:161], v[236:239], v[186:189], v[158:161]
v_cvt_pk_bf16_f32 v69, v70, v71
v_add_u32 v214, 1424, v214
v_mfma_f32_16x16x32_bf16 v[154:157], a[240:243], v[182:185], 0
s_or_b32 s44, s43, s51
ds_write_b64 v203, v[68:69] offset:12608
v_mfma_f32_16x16x32_bf16 v[154:157], a[244:247], v[186:189], v[154:157]
s_waitcnt lgkmcnt(4)
v_and_b32 v216, s44, v208
v_add_f32 v126, v126, v50
v_smfmac_f32_16x16x64_bf16 v[40:43], v[174:177], v[84:91], v213
s_waitcnt lgkmcnt(3)
ds_read_b128 v[88:91], v197 offset:48
v_add_f32 v134, v60, v61
v_smfmac_f32_16x16x64_bf16 v[52:55], v[174:177], v[92:99], v213
s_waitcnt lgkmcnt(3)
ds_read_b128 v[84:87], v197 offset:32
v_add_f32 v134, v134, v62
v_smfmac_f32_16x16x64_bf16 v[64:67], v[174:177], v[100:107], v213
ds_read_b128 v[92:95], v198 offset:32
v_fmac_f32_e64 v135, v61, v61
v_mfma_f32_16x16x32_bf16 v[150:153], a[216:219], v[182:185], 0
ds_read_b128 v[96:99], v198 offset:48
ds_read_b128 v[104:107], v199 offset:48
v_mfma_f32_16x16x32_bf16 v[150:153], a[220:223], v[186:189], v[150:153]
ds_read_b128 v[100:103], v199 offset:32
v_fmac_f32_e64 v135, v62, v62
v_mfma_f32_16x16x32_bf16 v[150:153], a[224:227], v[110:113], v[150:153]
v_add_f32 v126, v126, v51
v_fmac_f32 v135, v63, v63
v_mfma_f32_16x16x32_bf16 v[150:153], a[228:231], v[220:223], v[150:153]
v_add_f32 v118, v118, v39
s_waitcnt lgkmcnt(4)
v_smfmac_f32_16x16x64_bf16 v[40:43], v[178:181], v[84:91], v213
ds_read_b128 v[84:87], v200 offset:64
ds_read_b128 v[182:185], v210 offset:4096
v_mfma_f32_16x16x32_bf16 v[170:173], v[186:189], a[124:127], v[170:173]
s_add_u32 s29, s39, s63
ds_read_b128 v[174:177], v217 offset:3168
s_waitcnt lgkmcnt(5)
v_smfmac_f32_16x16x64_bf16 v[52:55], v[178:181], v[92:99], v213
ds_read_b128 v[92:95], v201 offset:64
v_add_f32_e64 v118, v118, v40
v_mfma_f32_16x16x32_bf16 v[162:165], v[110:113], a[80:83], v[162:165]
v_fmac_f32 v119, v40, v40
s_waitcnt lgkmcnt(4)
v_smfmac_f32_16x16x64_bf16 v[64:67], v[178:181], v[100:107], v213
ds_read_b128 v[100:103], v202 offset:64
v_fmac_f32_e64 v119, v41, v41
v_mfma_f32_16x16x32_bf16 v[158:161], v[240:243], v[110:113], v[158:161]
ds_read_b128 v[88:91], v194 offset:80
ds_read_b128 v[178:181], v217 offset:3696
v_mfma_f32_16x16x32_bf16 v[158:161], v[244:247], v[220:223], v[158:161]
s_add_u32 s28, s39, s62
v_add_f32 v118, v118, v41
v_add_f32_e64 v134, v134, v63
v_mfma_f32_16x16x32_bf16 v[138:141], a[8:11], v[110:113], v[138:141]
ds_read_b64 v[136:137], v204 offset:784
v_fmac_f32 v135, v64, v64
v_mfma_f32_16x16x32_bf16 v[138:141], a[12:15], v[220:223], v[138:141]
s_waitcnt lgkmcnt(5)
ds_read_b64 v[120:121], v204 offset:1176
ds_read_b128 v[96:99], v195 offset:80
v_mfma_f32_16x16x32_bf16 v[44:47], v[174:177], v[84:87], 0
s_waitcnt lgkmcnt(6)
ds_read_b128 v[84:87], v194 offset:64
v_fmac_f32 v127, v51, v51
v_mfma_f32_16x16x32_bf16 v[56:59], v[174:177], v[92:95], 0
s_nop 0
ds_read_b128 v[92:95], v195 offset:64
s_waitcnt lgkmcnt(7)
v_mfma_f32_16x16x32_bf16 v[68:71], v[174:177], v[100:103], 0
v_add_f32 v134, v134, v64
v_fmac_f32 v127, v52, v52
v_mfma_f32_16x16x32_bf16 v[146:149], a[56:59], v[110:113], v[146:149]
ds_read_b128 v[104:107], v196 offset:80
v_add_f32_e64 v118, v118, v42
v_mfma_f32_16x16x32_bf16 v[146:149], a[60:63], v[220:223], v[146:149]
ds_read_b128 v[100:103], v196 offset:64
v_add_f32_e64 v126, v126, v52
v_mfma_f32_16x16x32_bf16 v[142:145], a[32:35], v[110:113], v[142:145]
ds_read_b128 v[174:177], v217 offset:4224
v_fmac_f32_e64 v119, v42, v42
v_mfma_f32_16x16x32_bf16 v[142:145], a[36:39], v[220:223], v[142:145]
s_waitcnt lgkmcnt(4)
v_add_f32 v118, v118, v43
v_fmac_f32 v127, v53, v53
v_smfmac_f32_16x16x64_bf16 v[44:47], v[178:181], v[84:91], v213
s_waitcnt lgkmcnt(3)
ds_read_b128 v[88:91], v197 offset:80
ds_read_b128 v[84:87], v197 offset:64
v_smfmac_f32_16x16x64_bf16 v[56:59], v[178:181], v[92:99], v213
s_add_u32 m0, s45, 0
ds_read_b128 v[96:99], v198 offset:80
v_add_f32 v126, v126, v53
v_mfma_f32_16x16x32_bf16 v[170:173], v[110:113], a[128:131], v[170:173]
ds_read_b128 v[92:95], v198 offset:64
v_fmac_f32_e64 v135, v65, v65
v_mfma_f32_16x16x32_bf16 v[170:173], v[220:223], a[132:135], v[170:173]
s_waitcnt lgkmcnt(5)
v_add_f32 v134, v134, v65
v_fmac_f32_e64 v135, v66, v66
v_smfmac_f32_16x16x64_bf16 v[68:71], v[178:181], v[100:107], v213
ds_read_b128 v[104:107], v199 offset:80
ds_read_b128 v[100:103], v199 offset:64
v_mfma_f32_16x16x32_bf16 v[154:157], a[248:251], v[110:113], v[154:157]
buffer_store_dwordx2 v[136:137], v204, s[8:11], s28 offen sc1
v_fmac_f32 v135, v67, v67
v_add_f32 v126, v126, v54
v_mfma_f32_16x16x32_bf16 v[154:157], a[252:255], v[220:223], v[154:157]
s_waitcnt lgkmcnt(4)
v_add_f32 v126, v126, v55
v_add_f32_e64 v134, v134, v66
v_smfmac_f32_16x16x64_bf16 v[44:47], v[174:177], v[84:91], v213
ds_read_b128 v[186:189], v210 offset:5120
v_fmac_f32_e64 v127, v54, v54
v_mfma_f32_16x16x32_bf16 v[166:169], v[110:113], a[104:107], v[166:169]
s_waitcnt lgkmcnt(3)
v_add_f32 v134, v134, v67
v_fmac_f32_e64 v127, v55, v55
v_smfmac_f32_16x16x64_bf16 v[56:59], v[174:177], v[92:99], v213
buffer_store_dwordx2 v[120:121], v204, s[8:11], s29 offen sc1
v_add_f32 v118, v118, v44
v_fmac_f32 v119, v43, v43
v_mfma_f32_16x16x32_bf16 v[166:169], v[220:223], a[108:111], v[166:169]
s_waitcnt lgkmcnt(1)
v_add_f32 v118, v118, v45
v_fmac_f32_e64 v119, v44, v44
v_smfmac_f32_16x16x64_bf16 v[68:71], v[174:177], v[100:107], v213
ds_read_b128 v[110:113], v210 offset:6144
v_fmac_f32_e64 v119, v45, v45
v_mfma_f32_16x16x32_bf16 v[162:165], v[220:223], a[84:87], v[162:165]
v_add_f32 v126, v126, v56
v_add_f32 v126, v126, v57
v_mfma_f32_16x16x32_bf16 v[138:141], a[16:19], v[182:185], v[138:141]
s_waitcnt lgkmcnt(1)
v_fmac_f32 v135, v68, v68
v_fmac_f32_e64 v135, v69, v69
v_mfma_f32_16x16x32_bf16 v[138:141], a[20:23], v[186:189], v[138:141]
v_add_f32 v126, v126, v58
v_add_f32 v118, v118, v46
v_mfma_f32_16x16x32_bf16 v[142:145], a[40:43], v[182:185], v[142:145]
s_add_u32 s40, s36, 196224
v_add_f32 v134, v134, v68
v_fmac_f32 v127, v56, v56
v_mfma_f32_16x16x32_bf16 v[142:145], a[44:47], v[186:189], v[142:145]
v_fmac_f32 v119, v46, v46
v_fmac_f32 v135, v70, v70
v_mfma_f32_16x16x32_bf16 v[146:149], a[64:67], v[182:185], v[146:149]
s_add_u32 s28, s39, s64
v_add_f32 v134, v134, v69
v_fmac_f32_e64 v127, v57, v57
v_mfma_f32_16x16x32_bf16 v[146:149], a[68:71], v[186:189], v[146:149]
v_fmac_f32 v127, v58, v58
v_add_f32 v126, v126, v59
v_mfma_f32_16x16x32_bf16 v[150:153], a[232:235], v[182:185], v[150:153]
v_cvt_pk_bf16_f32 v80, v142, v143
v_fmac_f32_e64 v135, v71, v71
v_mfma_f32_16x16x32_bf16 v[150:153], a[236:239], v[186:189], v[150:153]
v_add_f32 v134, v134, v70
v_fmac_f32 v119, v47, v47
v_mfma_f32_16x16x32_bf16 v[154:157], v[224:227], v[182:185], v[154:157]
v_add_f32_e64 v118, v118, v47
v_cvt_pk_bf16_f32 v83, v148, v149
v_mfma_f32_16x16x32_bf16 v[154:157], v[228:231], v[186:189], v[154:157]
v_add_f32_e64 v134, v134, v71
v_cvt_pk_bf16_f32 v78, v138, v139
v_mfma_f32_16x16x32_bf16 v[158:161], v[248:251], v[182:185], v[158:161]
ds_read_b128 v[220:223], v210 offset:7168
v_cvt_pk_bf16_f32 v82, v146, v147
v_mfma_f32_16x16x32_bf16 v[158:161], v[252:255], v[186:189], v[158:161]
v_fmac_f32_e64 v127, v59, v59
v_cvt_pk_bf16_f32 v75, v156, v157
v_mfma_f32_16x16x32_bf16 v[162:165], v[182:185], a[88:91], v[162:165]
v_cvt_pk_bf16_f32 v79, v140, v141
v_cvt_pk_bf16_f32 v72, v150, v151
v_mfma_f32_16x16x32_bf16 v[162:165], v[186:189], a[92:95], v[162:165]
v_permlane16_swap_b32 v134, v135
v_mfma_f32_16x16x32_bf16 v[166:169], v[182:185], a[112:115], v[166:169]
v_permlane16_swap_b32 v126, v127
v_mfma_f32_16x16x32_bf16 v[166:169], v[186:189], a[116:119], v[166:169]
v_permlane16_swap_b32 v118, v119
v_mfma_f32_16x16x32_bf16 v[170:173], v[182:185], a[136:139], v[170:173]
ds_read_b128 v[182:185], v210 offset:8192
v_cvt_pk_bf16_f32 v81, v144, v145
v_mfma_f32_16x16x32_bf16 v[170:173], v[186:189], a[140:143], v[170:173]
s_waitcnt lgkmcnt(2)
ds_read_b128 v[186:189], v210 offset:9216
v_add_f32_e64 v118, v118, v119
v_mfma_f32_16x16x32_bf16 v[138:141], a[0:3], v[110:113], 0
s_waitcnt lgkmcnt(2)
v_add_f32 v126, v126, v127
v_add_f32_e64 v134, v134, v135
v_mfma_f32_16x16x32_bf16 v[138:141], a[4:7], v[220:223], v[138:141]
v_permlane32_swap_b32 v118, v126
v_mfma_f32_16x16x32_bf16 v[142:145], a[24:27], v[110:113], 0
v_add_f32 v118, v118, v126
v_mov_b32_e64 v135, v134
v_mfma_f32_16x16x32_bf16 v[142:145], a[28:31], v[220:223], v[142:145]
ds_write_b32 v209, v118
v_mfma_f32_16x16x32_bf16 v[146:149], a[48:51], v[110:113], 0
v_permlane32_swap_b32 v134, v135
v_mfma_f32_16x16x32_bf16 v[146:149], a[52:55], v[220:223], v[146:149]
s_waitcnt lgkmcnt(2)
v_cvt_pk_bf16_f32 v73, v152, v153
v_add_f32 v134, v134, v135
v_mfma_f32_16x16x32_bf16 v[146:149], a[56:59], v[182:185], v[146:149]
s_waitcnt lgkmcnt(1)
ds_write_b32 v209, v134 offset:512
v_mfma_f32_16x16x32_bf16 v[146:149], a[60:63], v[186:189], v[146:149]
v_cvt_pk_bf16_f32 v74, v154, v155
v_cvt_pk_bf16_f32 v122, v166, v167
v_mfma_f32_16x16x32_bf16 v[150:153], a[216:219], v[110:113], 0
v_cvt_pk_bf16_f32 v77, v160, v161
v_cvt_pk_bf16_f32 v123, v168, v169
v_mfma_f32_16x16x32_bf16 v[150:153], a[220:223], v[220:223], v[150:153]
v_cvt_pk_bf16_f32 v114, v162, v163
v_cvt_pk_bf16_f32 v76, v158, v159
v_mfma_f32_16x16x32_bf16 v[154:157], a[240:243], v[110:113], 0
v_cvt_pk_bf16_f32 v130, v170, v171
v_mfma_f32_16x16x32_bf16 v[154:157], a[244:247], v[220:223], v[154:157]
s_waitcnt lgkmcnt(0)
v_mfma_f32_16x16x32_bf16 v[158:161], v[232:235], v[110:113], 0
s_barrier
v_mfma_f32_16x16x32_bf16 v[158:161], v[236:239], v[220:223], v[158:161]
ds_read_b128 v[102:105], v210 offset:18432
ds_read_b128 v[106:109], v210 offset:19456
v_mfma_f32_16x16x32_bf16 v[166:169], v[110:113], a[96:99], 0
v_cvt_pk_bf16_f32 v131, v172, v173
v_cvt_pk_bf16_f32 v115, v164, v165
v_mfma_f32_16x16x32_bf16 v[166:169], v[220:223], a[100:103], v[166:169]
buffer_load_dwordx4 v216, s[4:7], s52 offen nt lds
v_mfma_f32_16x16x32_bf16 v[162:165], v[110:113], a[72:75], 0
s_nop 0
ds_read_b64 v[128:129], v204 offset:6272
v_mfma_f32_16x16x32_bf16 v[162:165], v[220:223], a[76:79], v[162:165]
s_add_u32 m0, s45, 4112
ds_read_b64 v[136:137], v204 offset:6664
v_mfma_f32_16x16x32_bf16 v[170:173], v[110:113], a[120:123], 0
s_add_u32 s29, s39, s65
ds_read_b64 v[120:121], v204 offset:7056
ds_read_b128 v[110:113], v210 offset:10240
v_mfma_f32_16x16x32_bf16 v[170:173], v[220:223], a[124:127], v[170:173]
s_waitcnt lgkmcnt(5)
v_add_f32 v102, v102, v103
s_cmp_eq_u32 s46, 1
s_cbranch_scc1 F_pf
F_nopf:
v_add_f32_e64 v104, v104, v105
v_mfma_f32_16x16x32_bf16 v[138:141], a[8:11], v[182:185], v[138:141]
s_waitcnt lgkmcnt(4)
v_add_f32 v102, v102, v104
v_add_f32 v106, v106, v107
v_mfma_f32_16x16x32_bf16 v[138:141], a[12:15], v[186:189], v[138:141]
s_waitcnt lgkmcnt(3)
buffer_store_dwordx2 v[128:129], v204, s[8:11], s28 offen sc1
v_mul_f32 v104, s73, v102
v_add_f32 v108, v108, v109
v_mfma_f32_16x16x32_bf16 v[142:145], a[32:35], v[182:185], v[142:145]
buffer_load_dwordx4 v216, s[4:7], s40 offen nt lds
v_mfma_f32_16x16x32_bf16 v[142:145], a[36:39], v[186:189], v[142:145]
v_add_f32 v106, v106, v108
v_mul_f32 v103, s48, v102
v_mfma_f32_16x16x32_bf16 v[150:153], a[224:227], v[182:185], v[150:153]
v_mul_f32_e64 v106, s73, v106
v_fma_f32 v106, -v103, v104, v106
v_mfma_f32_16x16x32_bf16 v[150:153], a[228:231], v[186:189], v[150:153]
s_add_u32 s28, s39, s66
v_max_f32 v106, 0, v106
v_add_f32_e64 v106, s49, v106
v_mfma_f32_16x16x32_bf16 v[154:157], a[248:251], v[182:185], v[154:157]
s_waitcnt lgkmcnt(2)
v_rsq_f32 v102, v106
v_mfma_f32_16x16x32_bf16 v[154:157], a[252:255], v[186:189], v[154:157]
s_add_u32 m0, s45, 8224
ds_read_b128 v[106:109], v210 offset:11264
v_mul_f32_e64 v103, -v103, v102
v_mfma_f32_16x16x32_bf16 v[158:161], v[240:243], v[182:185], v[158:161]
s_add_u32 s40, s36, 392448
buffer_store_dwordx2 v[136:137], v204, s[8:11], s29 offen sc1
ds_write_b64 v211, v[102:103] offset:20480
v_mfma_f32_16x16x32_bf16 v[158:161], v[244:247], v[186:189], v[158:161]
buffer_load_dwordx4 v216, s[4:7], s40 offen nt lds
v_mfma_f32_16x16x32_bf16 v[166:169], v[182:185], a[104:107], v[166:169]
ds_read_b64 v[118:119], v219 offset:20480
ds_read_b64 v[136:137], v204 offset:12544
v_mfma_f32_16x16x32_bf16 v[166:169], v[186:189], a[108:111], v[166:169]
s_nop 0
ds_read_b64 v[134:135], v219 offset:20992
s_add_u32 s29, s39, s67
v_mfma_f32_16x16x32_bf16 v[162:165], v[182:185], a[80:83], v[162:165]
ds_read_b64 v[128:129], v204 offset:7448
v_mfma_f32_16x16x32_bf16 v[162:165], v[186:189], a[84:87], v[162:165]
s_add_u32 s40, s36, 588672
s_add_u32 m0, s45, 12336
v_mfma_f32_16x16x32_bf16 v[170:173], v[182:185], a[128:131], v[170:173]
s_nop 0
ds_read_b128 v[182:185], v210 offset:12288
ds_read_b64 v[126:127], v219 offset:20736
v_mfma_f32_16x16x32_bf16 v[170:173], v[186:189], a[132:135], v[170:173]
s_waitcnt lgkmcnt(5)
buffer_store_dwordx2 v[120:121], v204, s[8:11], s28 offen sc1
v_fma_f32 v223, v39, v118, v119
v_fma_f32 v221, v37, v118, v119
v_mfma_f32_16x16x32_bf16 v[138:141], a[16:19], v[110:113], v[138:141]
buffer_load_dwordx4 v216, s[4:7], s40 offen nt lds
v_mfma_f32_16x16x32_bf16 v[138:141], a[20:23], v[106:109], v[138:141]
s_add_u32 s40, s36, 784896
v_fma_f32 v220, v36, v118, v119
v_fma_f32 v222, v38, v118, v119
v_mfma_f32_16x16x32_bf16 v[142:145], a[40:43], v[110:113], v[142:145]
v_cvt_pk_bf16_f32 v91, v222, v223
v_fma_f32 v222, v42, v118, v119
v_mfma_f32_16x16x32_bf16 v[142:145], a[44:47], v[106:109], v[142:145]
s_nop 0
v_fma_f32 v223, v43, v118, v119
v_cvt_pk_bf16_f32 v96, v138, v139
v_mfma_f32_16x16x32_bf16 v[146:149], a[64:67], v[110:113], v[146:149]
s_add_u32 s28, s39, s68
v_cvt_pk_bf16_f32 v90, v220, v221
v_fma_f32 v220, v40, v118, v119
v_mfma_f32_16x16x32_bf16 v[146:149], a[68:71], v[106:109], v[146:149]
s_add_u32 m0, s45, 16448
v_cvt_pk_bf16_f32 v93, v222, v223
v_fma_f32 v221, v41, v118, v119
v_mfma_f32_16x16x32_bf16 v[150:153], a[232:235], v[110:113], v[150:153]
s_waitcnt lgkmcnt(2)
buffer_store_dwordx2 v[128:129], v204, s[8:11], s29 offen sc1
v_fma_f32 v222, v46, v118, v119
v_fma_f32 v223, v47, v118, v119
v_mfma_f32_16x16x32_bf16 v[150:153], a[236:239], v[106:109], v[150:153]
s_nop 0
v_cvt_pk_bf16_f32 v92, v220, v221
v_cvt_pk_bf16_f32 v97, v140, v141
v_mfma_f32_16x16x32_bf16 v[154:157], v[224:227], v[110:113], v[154:157]
buffer_load_dwordx4 v216, s[4:7], s40 offen nt lds
v_mfma_f32_16x16x32_bf16 v[154:157], v[228:231], v[106:109], v[154:157]
s_nop 0
ds_read_b128 v[186:189], v210 offset:13312
v_cvt_pk_bf16_f32 v95, v222, v223
v_mfma_f32_16x16x32_bf16 v[158:161], v[248:251], v[110:113], v[158:161]
s_waitcnt lgkmcnt(1)
v_cvt_pk_bf16_f32 v84, v150, v151
v_fma_f32 v223, v51, v126, v127
v_cvt_pk_bf16_f32 v101, v148, v149
v_mfma_f32_16x16x32_bf16 v[158:161], v[252:255], v[106:109], v[158:161]
s_add_u32 m0, s45, 20560
v_cvt_pk_bf16_f32 v99, v144, v145
v_fma_f32 v222, v50, v126, v127
v_mfma_f32_16x16x32_bf16 v[162:165], v[110:113], a[88:91], v[162:165]
v_cvt_pk_bf16_f32 v175, v222, v223
v_fma_f32 v223, v55, v126, v127
v_mfma_f32_16x16x32_bf16 v[162:165], v[106:109], a[92:95], v[162:165]
v_fma_f32 v221, v45, v118, v119
v_cvt_pk_bf16_f32 v98, v142, v143
v_mfma_f32_16x16x32_bf16 v[166:169], v[110:113], a[112:115], v[166:169]
v_cvt_pk_bf16_f32 v87, v156, v157
v_cvt_pk_bf16_f32 v100, v146, v147
v_mfma_f32_16x16x32_bf16 v[166:169], v[106:109], a[116:119], v[166:169]
s_add_u32 s40, s36, 981120
buffer_load_dwordx4 v216, s[4:7], s40 offen nt lds
v_mfma_f32_16x16x32_bf16 v[170:173], v[110:113], a[136:139], v[170:173]
v_fma_f32 v220, v44, v118, v119
v_cvt_pk_bf16_f32 v94, v220, v221
v_mfma_f32_16x16x32_bf16 v[170:173], v[106:109], a[140:143], v[170:173]
s_waitcnt lgkmcnt(0)
ds_write_b128 v211, v[90:93] offset:20480
v_mfma_f32_16x16x32_bf16 v[138:141], a[0:3], v[182:185], 0
s_add_u32 s29, s39, s69
v_cvt_pk_bf16_f32 v133, v172, v173
v_cvt_pk_bf16_f32 v125, v168, v169
v_mfma_f32_16x16x32_bf16 v[138:141], a[4:7], v[186:189], v[138:141]
s_add_u32 s40, s36, 1177344
v_cvt_pk_bf16_f32 v89, v160, v161
v_cvt_pk_bf16_f32 v86, v154, v155
v_mfma_f32_16x16x32_bf16 v[142:145], a[24:27], v[182:185], 0
v_cvt_pk_bf16_f32 v132, v170, v171
v_fma_f32 v220, v48, v126, v127
v_mfma_f32_16x16x32_bf16 v[142:145], a[28:31], v[186:189], v[142:145]
ds_read_b128 v[170:173], v210 offset:14336
v_cvt_pk_bf16_f32 v88, v158, v159
v_mfma_f32_16x16x32_bf16 v[146:149], a[48:51], v[182:185], 0
s_add_u32 m0, s45, 24672
ds_read_b128 v[182:185], v210 offset:15360
v_fma_f32 v221, v49, v126, v127
v_mfma_f32_16x16x32_bf16 v[146:149], a[52:55], v[186:189], v[146:149]
buffer_store_dwordx2 v[136:137], v204, s[8:11], s28 offen sc1
buffer_load_dwordx4 v216, s[4:7], s40 offen nt lds
v_mfma_f32_16x16x16_bf16 v[154:157], v[82:83], v[88:89], 0
ds_read_b128 v[186:189], v210 offset:16384
v_cvt_pk_bf16_f32 v85, v152, v153
v_fma_f32 v222, v54, v126, v127
v_mfma_f32_16x16x16_bf16 v[158:161], v[100:101], v[88:89], 0
v_cvt_pk_bf16_f32 v177, v222, v223
v_fma_f32 v223, v59, v126, v127
v_cvt_pk_bf16_f32 v174, v220, v221
v_fma_f32 v222, v58, v126, v127
v_mfma_f32_16x16x32_bf16 v[154:157], v[78:81], v[84:87], v[154:157]
s_waitcnt lgkmcnt(2)
ds_read_b128 v[108:111], v215 offset:512
v_fma_f32 v221, v53, v126, v127
v_mfma_f32_16x16x32_bf16 v[138:141], a[8:11], v[170:173], v[138:141]
s_waitcnt lgkmcnt(2)
ds_read_b64 v[120:121], v204 offset:12936
v_fma_f32 v220, v52, v126, v127
v_mfma_f32_16x16x32_bf16 v[138:141], a[12:15], v[182:185], v[138:141]
ds_read_b64 v[112:113], v215 offset:528
v_cvt_pk_bf16_f32 v176, v220, v221
v_mfma_f32_16x16x32_bf16 v[142:145], a[32:35], v[170:173], v[142:145]
s_nop 0
v_fma_f32 v220, v56, v126, v127
v_fma_f32 v221, v57, v126, v127
v_mfma_f32_16x16x32_bf16 v[142:145], a[36:39], v[182:185], v[142:145]
s_waitcnt lgkmcnt(3)
ds_read_b64 v[136:137], v204 offset:13720
v_cvt_pk_bf16_f32 v179, v222, v223
v_mfma_f32_16x16x32_bf16 v[146:149], a[56:59], v[170:173], v[146:149]
s_add_u32 s40, s36, 1373568
ds_read_b128 v[170:173], v210 offset:17408
ds_read_b64 v[128:129], v204 offset:13328
v_mfma_f32_16x16x32_bf16 v[146:149], a[60:63], v[182:185], v[146:149]
s_add_u32 m0, s45, 28784
v_cvt_pk_bf16_f32 v178, v220, v221
v_cvt_pk_bf16_f32 v124, v166, v167
v_mfma_f32_16x16x32_bf16 v[146:149], a[64:67], v[186:189], v[146:149]
s_waitcnt lgkmcnt(3)
ds_write_b64 v212, v[94:95] offset:20480
v_mfma_f32_16x16x16_bf16 v[166:169], v[112:113], v[88:89], v[206:209]
buffer_store_dwordx2 v[120:121], v204, s[8:11], s29 offen sc1
v_fma_f32 v221, v61, v134, v135
v_exp_f32 v154, v154
v_mfma_f32_16x16x32_bf16 v[142:145], a[40:43], v[186:189], v[142:145]
s_add_u32 s29, s39, s71
buffer_load_dwordx4 v216, s[4:7], s40 offen nt lds
v_mfma_f32_16x16x32_bf16 v[138:141], a[16:19], v[186:189], v[138:141]
s_waitcnt lgkmcnt(2)
ds_read_b128 v[186:189], v210 offset:13312
ds_read_b128 v[182:185], v210 offset:12288
v_mfma_f32_16x16x32_bf16 v[138:141], a[20:23], v[170:173], v[138:141]
ds_write_b128 v211, v[174:177] offset:26624
v_mfma_f32_16x16x32_bf16 v[142:145], a[44:47], v[170:173], v[142:145]
v_cvt_pk_bf16_f32 v102, v138, v139
v_fma_f32 v222, v62, v134, v135
v_cvt_pk_bf16_f32 v103, v140, v141
v_mfma_f32_16x16x32_bf16 v[150:153], v[108:111], v[72:75], v[206:209]
s_add_u32 s28, s39, s70
v_fma_f32 v220, v60, v134, v135
v_cvt_pk_bf16_f32 v90, v220, v221
v_mfma_f32_16x16x32_bf16 v[138:141], v[78:81], v[72:75], 0
s_waitcnt lgkmcnt(4)
ds_write_b64 v212, v[178:179] offset:26624
v_mfma_f32_16x16x16_bf16 v[150:153], v[112:113], v[76:77], v[150:153]
buffer_store_dwordx2 v[128:129], v204, s[8:11], s28 offen sc1
v_fma_f32 v223, v63, v134, v135
v_cvt_pk_bf16_f32 v91, v222, v223
v_mfma_f32_16x16x16_bf16 v[138:141], v[82:83], v[76:77], v[138:141]
v_fma_f32 v220, v64, v134, v135
v_fma_f32 v221, v65, v134, v135
v_cvt_pk_bf16_f32 v92, v220, v221
v_cvt_pk_bf16_f32 v104, v142, v143
v_mfma_f32_16x16x32_bf16 v[166:169], v[108:111], v[84:87], v[166:169]
v_fma_f32 v221, v69, v134, v135
v_fma_f32 v220, v68, v134, v135
v_mfma_f32_16x16x32_bf16 v[146:149], a[68:71], v[170:173], v[146:149]
s_nop 0
v_fma_f32 v223, v67, v134, v135
v_fma_f32 v222, v66, v134, v135
v_mfma_f32_16x16x32_bf16 v[158:161], v[96:99], v[84:87], v[158:161]
s_waitcnt lgkmcnt(2)
v_cvt_pk_bf16_f32 v93, v222, v223
v_fma_f32 v222, v70, v134, v135
v_mfma_f32_16x16x32_bf16 v[126:129], v[182:185], a[96:99], 0
ds_read_b128 v[174:177], v210 offset:14336
ds_read_b128 v[178:181], v210 offset:15360
v_mfma_f32_16x16x32_bf16 v[118:121], v[182:185], a[72:75], 0
v_cvt_pk_bf16_f32 v105, v144, v145
v_cvt_pk_bf16_f32 v106, v146, v147
v_mfma_f32_16x16x32_bf16 v[170:173], a[240:243], v[182:185], 0
v_cvt_pk_bf16_f32 v107, v148, v149
v_fma_f32 v223, v71, v134, v135
v_mfma_f32_16x16x32_bf16 v[170:173], a[244:247], v[186:189], v[170:173]
s_add_u32 m0, s45, 32896
ds_write_b128 v211, v[90:93] offset:32768
v_mfma_f32_16x16x32_bf16 v[146:149], v[102:105], v[72:75], 0
s_add_u32 s40, s36, 1569792
v_exp_f32 v157, v157
v_mfma_f32_16x16x32_bf16 v[142:145], v[96:99], v[72:75], 0
buffer_store_dwordx2 v[136:137], v204, s[8:11], s29 offen sc1
v_exp_f32 v160, v160
v_mfma_f32_16x16x32_bf16 v[90:93], a[216:219], v[182:185], 0
v_exp_f32 v138, v138
v_mfma_f32_16x16x32_bf16 v[90:93], a[220:223], v[186:189], v[90:93]
s_waitcnt lgkmcnt(2)
v_exp_f32 v140, v140
v_mfma_f32_16x16x32_bf16 v[134:137], v[182:185], a[120:123], 0
s_add_u32 s35, s35, 32
v_exp_f32_e64 v166, v166
v_mfma_f32_16x16x32_bf16 v[134:137], v[186:189], a[124:127], v[134:137]
s_mul_hi_u32 s41, s35, 58835169
buffer_load_dwordx4 v216, s[4:7], s40 offen nt lds
v_mfma_f32_16x16x32_bf16 v[134:137], v[174:177], a[128:131], v[134:137]
s_waitcnt lgkmcnt(1)
v_exp_f32 v141, v141
v_mfma_f32_16x16x32_bf16 v[134:137], v[178:181], a[132:135], v[134:137]
v_exp_f32_e64 v139, v139
v_mfma_f32_16x16x32_bf16 v[118:121], v[186:189], a[76:79], v[118:121]
v_cvt_pk_bf16_f32 v94, v220, v221
v_cvt_pk_bf16_f32 v95, v222, v223
v_mfma_f32_16x16x32_bf16 v[118:121], v[174:177], a[80:83], v[118:121]
ds_read_b128 v[72:75], v215
v_exp_f32 v155, v155
v_mfma_f32_16x16x16_bf16 v[146:149], v[106:107], v[76:77], v[146:149]
v_cvt_pk_bf16_f32 v117, v164, v165
v_exp_f32 v158, v158
v_mfma_f32_16x16x16_bf16 v[142:145], v[100:101], v[76:77], v[142:145]
v_cvt_pk_bf16_f32 v116, v162, v163
v_exp_f32 v159, v159
v_mfma_f32_16x16x16_bf16 v[162:165], v[106:107], v[88:89], 0
v_exp_f32 v147, v147
v_exp_f32 v150, v150
v_mfma_f32_16x16x32_bf16 v[126:129], v[186:189], a[100:103], v[126:129]
v_exp_f32 v143, v143
v_mfma_f32_16x16x32_bf16 v[126:129], v[174:177], a[104:107], v[126:129]
v_exp_f32 v149, v149
v_mfma_f32_16x16x32_bf16 v[126:129], v[178:181], a[108:111], v[126:129]
ds_write_b64 v212, v[94:95] offset:32768
v_mfma_f32_16x16x32_bf16 v[220:223], v[232:235], v[182:185], 0
s_mov_b32 s39, s37
v_exp_f32_e64 v142, v142
v_mfma_f32_16x16x32_bf16 v[220:223], v[236:239], v[186:189], v[220:223]
ds_read_b128 v[182:185], v210 offset:16384
ds_read_b128 v[186:189], v210 offset:17408
v_mfma_f32_16x16x32_bf16 v[220:223], v[240:243], v[174:177], v[220:223]
v_exp_f32 v144, v144
v_mfma_f32_16x16x32_bf16 v[220:223], v[244:247], v[178:181], v[220:223]
v_exp_f32 v146, v146
v_mfma_f32_16x16x32_bf16 v[162:165], v[102:105], v[84:87], v[162:165]
v_exp_f32 v145, v145
v_mfma_f32_16x16x32_bf16 v[170:173], a[248:251], v[174:177], v[170:173]
v_exp_f32 v156, v156
v_mfma_f32_16x16x32_bf16 v[170:173], a[252:255], v[178:181], v[170:173]
v_exp_f32 v163, v163
v_mfma_f32_16x16x32_bf16 v[90:93], a[224:227], v[174:177], v[90:93]
v_exp_f32 v165, v165
v_mfma_f32_16x16x32_bf16 v[90:93], a[228:231], v[178:181], v[90:93]
s_waitcnt lgkmcnt(1)
v_exp_f32 v161, v161
v_mfma_f32_16x16x32_bf16 v[118:121], v[178:181], a[84:87], v[118:121]
s_mul_i32 s42, s41, 73
v_cvt_pk_bf16_f32 v174, v138, v139
v_cvt_pk_bf16_f32 v175, v140, v141
v_mfma_f32_16x16x32_bf16 v[118:121], v[182:185], a[88:91], v[118:121]
s_waitcnt lgkmcnt(0)
v_exp_f32_e64 v164, v164
v_mfma_f32_16x16x32_bf16 v[118:121], v[186:189], a[92:95], v[118:121]
s_add_u32 s29, s38, s61
ds_read_b64 v[76:77], v215 offset:16
v_cvt_pk_bf16_f32 v178, v146, v147
v_mfma_f32_16x16x32_bf16 v[126:129], v[182:185], a[112:115], v[126:129]
v_exp_f32_e64 v148, v148
v_mfma_f32_16x16x32_bf16 v[126:129], v[186:189], a[116:119], v[126:129]
v_cvt_pk_bf16_f32 v118, v118, v119
v_cvt_pk_bf16_f32 v176, v142, v143
v_mfma_f32_16x16x32_bf16 v[134:137], v[182:185], a[136:139], v[134:137]
s_nop 0
v_cvt_pk_bf16_f32 v180, v150, 0
v_cvt_pk_bf16_f32 v177, v144, v145
v_mfma_f32_16x16x32_bf16 v[134:137], v[186:189], a[140:143], v[134:137]
s_sub_u32 s42, s35, s42
v_cvt_pk_bf16_f32 v126, v126, v127
v_cvt_pk_bf16_f32 v119, v120, v121
v_mfma_f32_16x16x32_bf16 v[90:93], a[232:235], v[182:185], v[90:93]
ds_read_u16 v120, v205
v_mov_b32_e64 v121, 0
v_mfma_f32_16x16x32_bf16 v[90:93], a[236:239], v[186:189], v[90:93]
v_exp_f32_e64 v162, v162
v_mfma_f32_16x16x32_bf16 v[220:223], v[248:251], v[182:185], v[220:223]
v_cvt_pk_bf16_f32 v179, v148, v149
v_cvt_pk_bf16_f32 v127, v128, v129
v_mfma_f32_16x16x32_bf16 v[220:223], v[252:255], v[186:189], v[220:223]
ds_read_u16 v128, v205 offset:32
v_mov_b32_e64 v181, 0
v_mfma_f32_16x16x32_bf16 v[150:153], v[190:193], v[174:177], 0
v_cvt_pk_bf16_f32 v134, v134, v135
v_cvt_pk_bf16_f32 v135, v136, v137
v_mov_b32 v129, 0
v_mfma_f32_16x16x32_bf16 v[150:153], v[190:193], v[178:181], v[150:153]
s_waitcnt lgkmcnt(1)
ds_read_u16 v136, v205 offset:64
v_cvt_pk_bf16_f32 v95, v222, v223
v_mfma_f32_16x16x32_bf16 v[138:141], v[114:117], v[174:177], 0
s_mul_i32 s43, s41, 1373568
v_cvt_pk_bf16_f32 v90, v90, v91
v_mov_b32_e64 v137, 0
v_mfma_f32_16x16x32_bf16 v[138:141], v[118:121], v[178:181], v[138:141]
v_rcp_f32 v151, v150
v_mfma_f32_16x16x32_bf16 v[142:145], v[122:125], v[174:177], 0
s_waitcnt lgkmcnt(1)
v_mul_f32_e64 v152, s3, v151
v_cvt_pk_bf16_f32 v91, v92, v93
v_mfma_f32_16x16x32_bf16 v[142:145], v[126:129], v[178:181], v[142:145]
v_mul_f32 v140, v140, v152
v_mul_f32 v138, v138, v152
v_mfma_f32_16x16x32_bf16 v[146:149], v[130:133], v[174:177], 0
s_waitcnt lgkmcnt(0)
v_mul_f32 v139, v139, v152
v_cvt_pk_bf16_f32 v175, v156, v157
v_mfma_f32_16x16x32_bf16 v[146:149], v[134:137], v[178:181], v[146:149]
s_min_u32 s41, s41, 1
v_cvt_pk_bf16_f32 v176, v158, v159
v_cvt_pk_bf16_f32 v180, v166, 0
v_mul_f32 v145, v145, v152
v_mul_f32 v142, v142, v152
v_mul_f32 v141, v141, v152
v_mfma_f32_16x16x32_bf16 v[170:173], v[224:227], v[182:185], v[170:173]
s_mul_i32 s51, s42, 2688
v_cvt_pk_bf16_f32 v174, v154, v155
v_cvt_pk_bf16_f32 v179, v164, v165
v_mul_f32_e64 v147, v147, v152
v_mfma_f32_16x16x32_bf16 v[170:173], v[228:231], v[186:189], v[170:173]
v_cvt_pk_bf16_f32 v94, v220, v221
v_cvt_pk_bf16_f32 v177, v160, v161
v_cvt_pk_bf16_f32 v138, v138, v139
v_cvt_pk_bf16_f32 v178, v162, v163
v_mfma_f32_16x16x32_bf16 v[166:169], v[190:193], v[174:177], 0
v_cvt_pk_bf16_f32 v139, v140, v141
v_mul_f32_e64 v143, v143, v152
v_mfma_f32_16x16x32_bf16 v[166:169], v[190:193], v[178:181], v[166:169]
v_mul_f32 v149, v149, v152
v_mul_f32 v144, v144, v152
v_mfma_f32_16x16x32_bf16 v[154:157], v[114:117], v[174:177], 0
v_cvt_pk_bf16_f32 v93, v172, v173
v_mul_f32_e64 v146, v146, v152
v_mfma_f32_16x16x32_bf16 v[154:157], v[118:121], v[178:181], v[154:157]
v_cvt_pk_bf16_f32 v141, v144, v145
v_cvt_pk_bf16_f32 v140, v142, v143
v_max3_u32 v218, v218, v150, v151
v_mfma_f32_16x16x32_bf16 v[158:161], v[122:125], v[174:177], 0
v_rcp_f32 v167, v166
v_mfma_f32_16x16x32_bf16 v[158:161], v[126:129], v[178:181], v[158:161]
ds_write_b128 v211, v[138:141] offset:38912
v_mul_f32 v168, s3, v167
v_mul_f32_e64 v148, v148, v152
v_cvt_pk_bf16_f32 v92, v170, v171
v_mfma_f32_16x16x32_bf16 v[162:165], v[130:133], v[174:177], 0
s_sub_u32 s41, 1, s41
v_cvt_pk_bf16_f32 v142, v146, v147
v_mul_f32 v155, v155, v168
v_cvt_pk_bf16_f32 v143, v148, v149
v_mfma_f32_16x16x32_bf16 v[162:165], v[134:137], v[178:181], v[162:165]
v_mul_f32 v154, v154, v168
v_mul_f32 v157, v157, v168
v_mul_f32_e64 v159, v159, v168
v_mfma_f32_16x16x32_bf16 v[150:153], v[108:111], v[90:93], v[206:209]
v_mul_f32 v161, v161, v168
v_mul_f32 v156, v156, v168
v_mfma_f32_16x16x32_bf16 v[138:141], v[78:81], v[90:93], 0
ds_write_b64 v212, v[142:143] offset:38912
v_mfma_f32_16x16x16_bf16 v[150:153], v[112:113], v[94:95], v[150:153]
v_cvt_pk_bf16_f32 v154, v154, v155
v_mul_f32_e64 v158, v158, v168
v_cvt_pk_bf16_f32 v155, v156, v157
v_mfma_f32_16x16x16_bf16 v[138:141], v[82:83], v[94:95], v[138:141]
v_mul_f32 v160, v160, v168
v_mul_f32 v162, v162, v168
v_cvt_pk_bf16_f32 v157, v160, v161
v_cvt_pk_bf16_f32 v156, v158, v159
v_mfma_f32_16x16x32_bf16 v[142:145], v[96:99], v[90:93], 0
ds_write_b128 v211, v[154:157] offset:45056
v_mfma_f32_16x16x16_bf16 v[142:145], v[100:101], v[94:95], v[142:145]
v_mul_f32 v163, v163, v168
v_mul_f32 v164, v164, v168
v_mul_f32_e64 v165, v165, v168
v_cvt_pk_bf16_f32 v159, v164, v165
v_cvt_pk_bf16_f32 v158, v162, v163
v_mfma_f32_16x16x32_bf16 v[146:149], v[102:105], v[90:93], 0
ds_write_b64 v212, v[158:159] offset:45056
v_mfma_f32_16x16x16_bf16 v[154:157], v[76:77], v[82:83], 0
v_exp_f32_e64 v141, v141
v_max3_u32 v218, v218, v166, v167
v_mfma_f32_16x16x16_bf16 v[146:149], v[106:107], v[94:95], v[146:149]
v_exp_f32 v143, v143
v_exp_f32 v144, v144
v_mfma_f32_16x16x16_bf16 v[158:161], v[76:77], v[100:101], 0
v_exp_f32 v145, v145
v_exp_f32 v140, v140
v_mfma_f32_16x16x16_bf16 v[166:169], v[76:77], v[112:113], v[206:209]
v_cvt_pk_bf16_f32 v175, v140, v141
v_exp_f32 v138, v138
v_mfma_f32_16x16x16_bf16 v[162:165], v[76:77], v[106:107], 0
v_exp_f32 v139, v139
v_exp_f32 v142, v142
v_mfma_f32_16x16x32_bf16 v[154:157], v[72:75], v[78:81], v[154:157]
s_waitcnt lgkmcnt(0)
v_cvt_pk_bf16_f32 v177, v144, v145
v_cvt_pk_bf16_f32 v174, v138, v139
v_mfma_f32_16x16x32_bf16 v[158:161], v[72:75], v[96:99], v[158:161]
s_barrier
ds_read_b128 v[220:223], v210 offset:38912
v_mfma_f32_16x16x32_bf16 v[166:169], v[72:75], v[108:111], v[166:169]
s_nop 0
ds_read_b128 v[110:113], v210 offset:39936
v_cvt_pk_bf16_f32 v176, v142, v143
v_mfma_f32_16x16x32_bf16 v[162:165], v[72:75], v[102:105], v[162:165]
v_exp_f32 v150, v150
v_mfma_f32_16x16x32_bf16 v[142:145], v[122:125], v[174:177], 0
v_cvt_pk_bf16_f32 v180, v150, 0
v_mfma_f32_16x16x32_bf16 v[138:141], v[114:117], v[174:177], 0
v_exp_f32 v149, v149
v_mfma_f32_16x16x32_bf16 v[150:153], v[190:193], v[174:177], 0
ds_read_b128 v[170:173], v210 offset:40960
s_waitcnt lgkmcnt(2)
v_mfma_f32_16x16x32_bf16 v[4:7], a[168:171], v[220:223], v[4:7]
v_mov_b32_dpp v154, v158 quad_perm:[0,1,2,3] row_mask:0x2 bank_mask:0xf
s_waitcnt lgkmcnt(1)
v_mfma_f32_16x16x32_bf16 v[4:7], a[172:175], v[110:113], v[4:7]
v_exp_f32 v147, v147
v_mfma_f32_16x16x32_bf16 v[8:11], a[192:195], v[220:223], v[8:11]
s_add_u32 s28, s38, s60
v_exp_f32 v146, v146
v_mfma_f32_16x16x32_bf16 v[8:11], a[196:199], v[110:113], v[8:11]
v_exp_f32 v148, v148
v_mfma_f32_16x16x32_bf16 v[0:3], a[144:147], v[220:223], v[0:3]
v_cvt_pk_bf16_f32 v179, v148, v149
v_cvt_pk_bf16_f32 v178, v146, v147
v_mfma_f32_16x16x32_bf16 v[0:3], a[148:151], v[110:113], v[0:3]
ds_read_b128 v[182:185], v210 offset:41984
ds_read_b128 v[110:113], v210 offset:45056
v_mfma_f32_16x16x32_bf16 v[150:153], v[190:193], v[178:181], v[150:153]
v_mov_b32_dpp v154, v162 quad_perm:[0,1,2,3] row_mask:0x4 bank_mask:0xf
v_mfma_f32_16x16x32_bf16 v[138:141], v[118:121], v[178:181], v[138:141]
ds_read_b128 v[220:223], v210 offset:44032
ds_read_b128 v[186:189], v210 offset:43008
v_mfma_f32_16x16x32_bf16 v[142:145], v[126:129], v[178:181], v[142:145]
v_rcp_f32 v151, v150
v_mfma_f32_16x16x32_bf16 v[146:149], v[130:133], v[174:177], 0
v_mul_f32 v152, s3, v151
v_mov_b32_dpp v154, v167 quad_perm:[0,1,2,3] row_mask:0x8 bank_mask:0xf
v_mfma_f32_16x16x32_bf16 v[146:149], v[134:137], v[178:181], v[146:149]
s_waitcnt lgkmcnt(4)
v_mul_f32 v139, v139, v152
v_mul_f32_e64 v140, v140, v152
v_mfma_f32_16x16x32_bf16 v[0:3], a[152:155], v[170:173], v[0:3]
s_waitcnt lgkmcnt(3)
v_mul_f32 v138, v138, v152
v_cvt_pk_bf16_f32 v138, v138, v139
v_mfma_f32_16x16x32_bf16 v[0:3], a[156:159], v[182:185], v[0:3]
v_mul_f32 v141, v141, v152
v_mul_f32 v142, v142, v152
v_mfma_f32_16x16x32_bf16 v[4:7], a[176:179], v[170:173], v[4:7]
v_exp_f32 v154, v154
v_mfma_f32_16x16x32_bf16 v[4:7], a[180:183], v[182:185], v[4:7]
v_mul_f32 v143, v143, v152
v_cvt_pk_bf16_f32 v154, v154, 0
v_mfma_f32_16x16x32_bf16 v[8:11], a[200:203], v[170:173], v[8:11]
v_cvt_pk_bf16_f32 v139, v140, v141
v_mul_f32 v145, v145, v152
v_mfma_f32_16x16x32_bf16 v[8:11], a[204:207], v[182:185], v[8:11]
s_waitcnt lgkmcnt(0)
v_cvt_pk_bf16_f32 v140, v142, v143
v_mul_f32_e64 v144, v144, v152
v_mfma_f32_16x16x32_bf16 v[8:11], a[208:211], v[186:189], v[8:11]
ds_read_b128 v[170:173], v210 offset:46080
v_cvt_pk_bf16_f32 v141, v144, v145
v_mfma_f32_16x16x32_bf16 v[8:11], a[212:215], v[220:223], v[8:11]
ds_write_b128 v211, v[138:141] offset:51200
v_mfma_f32_16x16x32_bf16 v[0:3], a[160:163], v[186:189], v[0:3]
v_mul_f32 v148, v148, v152
v_mul_f32 v149, v149, v152
v_mfma_f32_16x16x32_bf16 v[0:3], a[164:167], v[220:223], v[0:3]
v_cvt_pk_bf16_f32 v8, v8, v9
v_mfma_f32_16x16x32_bf16 v[4:7], a[184:187], v[186:189], v[4:7]
s_nop 0
ds_write_b16 v214, v154
v_mfma_f32_16x16x32_bf16 v[4:7], a[188:191], v[220:223], v[4:7]
s_add_u32 s50, s43, s51
ds_read_b128 v[182:185], v210 offset:47104
v_cvt_pk_bf16_f32 v9, v10, v11
v_mfma_f32_16x16x32_bf16 v[12:15], a[144:147], v[110:113], v[12:15]
s_waitcnt lgkmcnt(3)
ds_read_b128 v[186:189], v210 offset:48128
ds_read_b128 v[220:223], v210 offset:49152
v_mfma_f32_16x16x32_bf16 v[12:15], a[148:151], v[170:173], v[12:15]
s_lshl_b32 s41, s41, 30
ds_read_b128 v[88:91], v215 offset:16
v_cvt_pk_bf16_f32 v0, v0, v1
v_mfma_f32_16x16x32_bf16 v[16:19], a[168:171], v[110:113], v[16:19]
v_cvt_pk_bf16_f32 v1, v2, v3
v_mul_f32_e64 v147, v147, v152
v_mfma_f32_16x16x32_bf16 v[16:19], a[172:175], v[170:173], v[16:19]
ds_write_b64 v203, v[8:9] offset:64
v_mfma_f32_16x16x32_bf16 v[20:23], a[192:195], v[110:113], v[20:23]
v_mul_f32 v146, v146, v152
v_cvt_pk_bf16_f32 v4, v4, v5
v_mfma_f32_16x16x32_bf16 v[20:23], a[196:199], v[170:173], v[20:23]
s_waitcnt lgkmcnt(4)
ds_read_b128 v[110:113], v210 offset:50176
v_cvt_pk_bf16_f32 v5, v6, v7
v_mfma_f32_16x16x32_bf16 v[20:23], a[200:203], v[182:185], v[20:23]
s_waitcnt lgkmcnt(4)
ds_write_b64 v203, v[0:1]
v_mfma_f32_16x16x32_bf16 v[20:23], a[204:207], v[186:189], v[20:23]
v_cvt_pk_bf16_f32 v143, v148, v149
v_mfma_f32_16x16x32_bf16 v[12:15], a[152:155], v[182:185], v[12:15]
ds_read_b128 v[84:87], v215
v_mfma_f32_16x16x32_bf16 v[12:15], a[156:159], v[186:189], v[12:15]
s_waitcnt lgkmcnt(5)
ds_write_b64 v203, v[4:5] offset:32
v_mfma_f32_16x16x32_bf16 v[12:15], a[160:163], v[220:223], v[12:15]
s_nop 0
v_cvt_pk_bf16_f32 v142, v146, v147
s_waitcnt lgkmcnt(3)
v_mfma_f32_16x16x32_bf16 v[12:15], a[164:167], v[110:113], v[12:15]
ds_write_b64 v212, v[142:143] offset:51200
v_mfma_f32_16x16x32_bf16 v[20:23], a[208:211], v[220:223], v[20:23]
v_mfma_f32_16x16x32_bf16 v[20:23], a[212:215], v[110:113], v[20:23]
v_cvt_pk_bf16_f32 v12, v12, v13
v_mfma_f32_16x16x32_bf16 v[16:19], a[176:179], v[182:185], v[16:19]
v_cvt_pk_bf16_f32 v13, v14, v15
v_add_u32 v205, 1424, v205
v_mfma_f32_16x16x32_bf16 v[16:19], a[180:183], v[186:189], v[16:19]
s_nop 0
ds_write_b64 v203, v[12:13] offset:6272
v_mfma_f32_16x16x32_bf16 v[16:19], a[184:187], v[220:223], v[16:19]
s_add_u32 s52, s50, s41
s_min_u32 s43, s42, 1
s_waitcnt vmcnt(0) lgkmcnt(1)
v_mfma_f32_16x16x32_bf16 v[16:19], a[188:191], v[110:113], v[16:19]
s_barrier
v_mfma_f32_16x16x32_bf16 v[158:161], v[84:87], v[122:125], 0
s_nop 0
ds_read_b128 v[178:181], v217 offset:528
v_mfma_f32_16x16x32_bf16 v[158:161], v[88:91], v[126:129], v[158:161]
ds_read_b128 v[170:173], v210 offset:51200
ds_read_b128 v[182:185], v210 offset:52224
v_mfma_f32_16x16x32_bf16 v[154:157], v[84:87], v[114:117], 0
s_nop 0
ds_read_b128 v[220:223], v210 offset:54272
v_mfma_f32_16x16x32_bf16 v[154:157], v[88:91], v[118:121], v[154:157]
s_mov_b32 s37, s50
ds_read_b128 v[186:189], v210 offset:53248
ds_read_b128 v[110:113], v210 offset:55296
v_mfma_f32_16x16x32_bf16 v[162:165], v[84:87], v[130:133], 0
ds_read_b64 v[120:121], v204
v_mfma_f32_16x16x32_bf16 v[162:165], v[88:91], v[134:137], v[162:165]
v_mov_b32_dpp v154, v158 quad_perm:[0,1,2,3] row_mask:0x2 bank_mask:0xf
v_max3_u32 v218, v218, v150, v151
v_mfma_f32_16x16x32_bf16 v[166:169], v[84:87], v[190:193], 0
s_nop 0
ds_read_b128 v[84:87], v200
v_add_u32 v215, 1424, v215
v_mfma_f32_16x16x32_bf16 v[166:169], v[88:91], v[190:193], v[166:169]
s_waitcnt lgkmcnt(6)
ds_read_b128 v[92:95], v201
ds_read_b128 v[174:177], v217
v_mfma_f32_16x16x32_bf16 v[24:27], a[144:147], v[170:173], v[24:27]
s_lshl_b32 s43, s43, 27
v_cvt_pk_bf16_f32 v16, v16, v17
s_waitcnt lgkmcnt(7)
v_mfma_f32_16x16x32_bf16 v[24:27], a[148:151], v[182:185], v[24:27]
v_mfma_f32_16x16x32_bf16 v[28:31], a[168:171], v[170:173], v[28:31]
ds_read_b128 v[100:103], v202
ds_read_b128 v[96:99], v195 offset:16
v_mfma_f32_16x16x32_bf16 v[28:31], a[172:175], v[182:185], v[28:31]
v_mfma_f32_16x16x32_bf16 v[32:35], a[192:195], v[170:173], v[32:35]
s_add_u32 s51, s42, 56
v_rcp_f32 v167, v166
v_mfma_f32_16x16x32_bf16 v[32:35], a[196:199], v[182:185], v[32:35]
s_waitcnt lgkmcnt(7)
ds_read_b128 v[170:173], v210 offset:56320
v_cvt_pk_bf16_f32 v20, v20, v21
v_mfma_f32_16x16x32_bf16 v[32:35], a[200:203], v[186:189], v[32:35]
s_waitcnt lgkmcnt(3)
v_cvt_pk_bf16_f32 v21, v22, v23
v_cvt_pk_bf16_f32 v17, v18, v19
v_mfma_f32_16x16x32_bf16 v[12:15], v[174:177], v[92:95], 0
ds_read_b128 v[92:95], v195
ds_read_b128 v[182:185], v210 offset:20480
v_mfma_f32_16x16x32_bf16 v[0:3], v[174:177], v[84:87], 0
s_sub_u32 s43, 536870911, s43
ds_write_b64 v203, v[16:17] offset:6304
v_mfma_f32_16x16x32_bf16 v[24:27], a[152:155], v[186:189], v[24:27]
v_mfma_f32_16x16x32_bf16 v[24:27], a[156:159], v[220:223], v[24:27]
ds_read_b128 v[104:107], v196 offset:16
v_mul_f32 v168, s3, v167
v_mfma_f32_16x16x32_bf16 v[24:27], a[160:163], v[110:113], v[24:27]
s_waitcnt lgkmcnt(4)
ds_read_b128 v[84:87], v194
ds_read_b128 v[88:91], v194 offset:16
v_mfma_f32_16x16x32_bf16 v[24:27], a[164:167], v[170:173], v[24:27]
ds_write_b64 v203, v[20:21] offset:6336
v_mfma_f32_16x16x32_bf16 v[28:31], a[176:179], v[186:189], v[28:31]
buffer_store_dwordx2 v[120:121], v204, s[8:11], s28 offen sc1
s_and_b32 s51, s51, 128
ds_read_b128 v[186:189], v210 offset:21504
v_mfma_f32_16x16x32_bf16 v[28:31], a[180:183], v[220:223], v[28:31]
v_cvt_pk_bf16_f32 v24, v24, v25
v_cvt_pk_bf16_f32 v25, v26, v27
v_mfma_f32_16x16x32_bf16 v[28:31], a[184:187], v[110:113], v[28:31]
ds_write_b64 v203, v[24:25] offset:12544
v_mfma_f32_16x16x32_bf16 v[28:31], a[188:191], v[170:173], v[28:31]
v_max3_u32 v218, v218, v166, v167
v_mfma_f32_16x16x32_bf16 v[24:27], v[174:177], v[100:103], 0
s_waitcnt lgkmcnt(8)
ds_read_b128 v[100:103], v196
v_mov_b32_dpp v154, v162 quad_perm:[0,1,2,3] row_mask:0x4 bank_mask:0xf
v_smfmac_f32_16x16x64_bf16 v[12:15], v[178:181], v[92:99], v213
s_waitcnt lgkmcnt(4)
ds_read_b128 v[92:95], v198
ds_read_b64 v[128:129], v204 offset:392
v_smfmac_f32_16x16x64_bf16 v[0:3], v[178:181], v[84:91], v213
ds_read_b128 v[174:177], v217 offset:1056
ds_read_b128 v[84:87], v197
v_mfma_f32_16x16x32_bf16 v[32:35], a[204:207], v[220:223], v[32:35]
ds_read_b128 v[88:91], v197 offset:16
v_cvt_pk_bf16_f32 v28, v28, v29
v_mfma_f32_16x16x32_bf16 v[32:35], a[208:211], v[110:113], v[32:35]
ds_read_b128 v[96:99], v198 offset:16
v_mfma_f32_16x16x32_bf16 v[32:35], a[212:215], v[170:173], v[32:35]
s_nop 0
v_cvt_pk_bf16_f32 v29, v30, v31
s_waitcnt lgkmcnt(6)
v_smfmac_f32_16x16x64_bf16 v[24:27], v[178:181], v[100:107], v213
ds_read_b128 v[100:103], v199
v_mul_f32 v154, v154, v168
v_mfma_f32_16x16x32_bf16 v[162:165], v[182:185], a[72:75], 0
s_waitcnt lgkmcnt(5)
buffer_store_dwordx2 v[128:129], v204, s[8:11], s29 offen sc1
v_cvt_pk_bf16_f32 v154, v154, 0
v_cvt_pk_bf16_f32 v32, v32, v33
v_mfma_f32_16x16x32_bf16 v[162:165], v[186:189], a[76:79], v[162:165]
ds_read_b128 v[104:107], v199 offset:16
ds_read_b128 v[220:223], v210 offset:23552
v_mfma_f32_16x16x32_bf16 v[166:169], v[182:185], a[96:99], 0
ds_write_b64 v203, v[28:29] offset:12576
v_mfma_f32_16x16x32_bf16 v[166:169], v[186:189], a[100:103], v[166:169]
s_nop 0
v_mfma_f32_16x16x32_bf16 v[170:173], v[182:185], a[120:123], 0
s_waitcnt lgkmcnt(5)
ds_write_b16 v214, v154
v_smfmac_f32_16x16x64_bf16 v[0:3], v[174:177], v[84:91], v213
ds_read_b128 v[178:181], v217 offset:1584
s_waitcnt lgkmcnt(6)
v_smfmac_f32_16x16x64_bf16 v[12:15], v[174:177], v[92:99], v213
s_waitcnt lgkmcnt(4)
ds_read_b128 v[92:95], v201 offset:32
ds_read_b128 v[84:87], v200 offset:32
v_smfmac_f32_16x16x64_bf16 v[24:27], v[174:177], v[100:107], v213
ds_read_b128 v[100:103], v202 offset:32
ds_read_b128 v[104:107], v196 offset:48
v_mfma_f32_16x16x32_bf16 v[138:141], a[0:3], v[182:185], 0
v_mul_f32 v119, v0, v0
v_fmac_f32 v119, v1, v1
v_mfma_f32_16x16x32_bf16 v[138:141], a[4:7], v[186:189], v[138:141]
ds_read_b128 v[96:99], v195 offset:48
ds_read_b128 v[110:113], v210 offset:22528
v_mfma_f32_16x16x32_bf16 v[142:145], a[24:27], v[182:185], 0
v_mul_f32 v127, v12, v12
v_add_f32 v118, v0, v1
v_mfma_f32_16x16x32_bf16 v[142:145], a[28:31], v[186:189], v[142:145]
ds_read_b128 v[88:91], v194 offset:48
v_add_f32_e64 v126, v12, v13
v_mfma_f32_16x16x32_bf16 v[146:149], a[48:51], v[182:185], 0
v_fmac_f32_e64 v119, v2, v2
v_add_f32 v118, v118, v2
v_mfma_f32_16x16x32_bf16 v[146:149], a[52:55], v[186:189], v[146:149]
s_waitcnt lgkmcnt(5)
ds_read_b128 v[174:177], v217 offset:2112
v_fmac_f32_e64 v119, v3, v3
v_mfma_f32_16x16x32_bf16 v[4:7], v[178:181], v[84:87], 0
s_lshl_b32 s51, s51, 22
ds_read_b128 v[84:87], v194 offset:32
s_waitcnt lgkmcnt(6)
v_mfma_f32_16x16x32_bf16 v[28:31], v[178:181], v[100:103], 0
v_mul_f32 v135, v24, v24
v_fmac_f32 v127, v13, v13
v_mfma_f32_16x16x32_bf16 v[16:19], v[178:181], v[92:95], 0
ds_read_b128 v[92:95], v195 offset:32
v_fmac_f32_e64 v127, v14, v14
v_mfma_f32_16x16x32_bf16 v[158:161], v[232:235], v[182:185], 0
ds_read_b128 v[100:103], v196 offset:32
ds_read_b128 v[178:181], v217 offset:2640
v_mfma_f32_16x16x32_bf16 v[158:161], v[236:239], v[186:189], v[158:161]
v_cvt_pk_bf16_f32 v33, v34, v35
v_add_u32 v214, 1424, v214
v_mfma_f32_16x16x32_bf16 v[154:157], a[240:243], v[182:185], 0
s_or_b32 s44, s43, s51
ds_write_b64 v203, v[32:33] offset:12608
v_mfma_f32_16x16x32_bf16 v[154:157], a[244:247], v[186:189], v[154:157]
s_waitcnt lgkmcnt(4)
v_and_b32 v216, s44, v208
v_add_f32 v126, v126, v14
v_smfmac_f32_16x16x64_bf16 v[4:7], v[174:177], v[84:91], v213
s_waitcnt lgkmcnt(3)
ds_read_b128 v[88:91], v197 offset:48
v_add_f32 v134, v24, v25
v_smfmac_f32_16x16x64_bf16 v[16:19], v[174:177], v[92:99], v213
s_waitcnt lgkmcnt(3)
ds_read_b128 v[84:87], v197 offset:32
v_add_f32 v134, v134, v26
v_smfmac_f32_16x16x64_bf16 v[28:31], v[174:177], v[100:107], v213
ds_read_b128 v[92:95], v198 offset:32
v_fmac_f32_e64 v135, v25, v25
v_mfma_f32_16x16x32_bf16 v[150:153], a[216:219], v[182:185], 0
ds_read_b128 v[96:99], v198 offset:48
ds_read_b128 v[104:107], v199 offset:48
v_mfma_f32_16x16x32_bf16 v[150:153], a[220:223], v[186:189], v[150:153]
ds_read_b128 v[100:103], v199 offset:32
v_fmac_f32_e64 v135, v26, v26
v_mfma_f32_16x16x32_bf16 v[150:153], a[224:227], v[110:113], v[150:153]
v_add_f32 v126, v126, v15
v_fmac_f32 v135, v27, v27
v_mfma_f32_16x16x32_bf16 v[150:153], a[228:231], v[220:223], v[150:153]
v_add_f32 v118, v118, v3
s_waitcnt lgkmcnt(4)
v_smfmac_f32_16x16x64_bf16 v[4:7], v[178:181], v[84:91], v213
ds_read_b128 v[84:87], v200 offset:64
ds_read_b128 v[182:185], v210 offset:24576
v_mfma_f32_16x16x32_bf16 v[170:173], v[186:189], a[124:127], v[170:173]
s_add_u32 s29, s38, s63
ds_read_b128 v[174:177], v217 offset:3168
s_waitcnt lgkmcnt(5)
v_smfmac_f32_16x16x64_bf16 v[16:19], v[178:181], v[92:99], v213
ds_read_b128 v[92:95], v201 offset:64
v_add_f32_e64 v118, v118, v4
v_mfma_f32_16x16x32_bf16 v[162:165], v[110:113], a[80:83], v[162:165]
v_fmac_f32 v119, v4, v4
s_waitcnt lgkmcnt(4)
v_smfmac_f32_16x16x64_bf16 v[28:31], v[178:181], v[100:107], v213
ds_read_b128 v[100:103], v202 offset:64
v_fmac_f32_e64 v119, v5, v5
v_mfma_f32_16x16x32_bf16 v[158:161], v[240:243], v[110:113], v[158:161]
ds_read_b128 v[88:91], v194 offset:80
ds_read_b128 v[178:181], v217 offset:3696
v_mfma_f32_16x16x32_bf16 v[158:161], v[244:247], v[220:223], v[158:161]
s_add_u32 s28, s38, s62
v_add_f32 v118, v118, v5
v_add_f32_e64 v134, v134, v27
v_mfma_f32_16x16x32_bf16 v[138:141], a[8:11], v[110:113], v[138:141]
ds_read_b64 v[136:137], v204 offset:784
v_fmac_f32 v135, v28, v28
v_mfma_f32_16x16x32_bf16 v[138:141], a[12:15], v[220:223], v[138:141]
s_waitcnt lgkmcnt(5)
ds_read_b64 v[120:121], v204 offset:1176
ds_read_b128 v[96:99], v195 offset:80
v_mfma_f32_16x16x32_bf16 v[8:11], v[174:177], v[84:87], 0
s_waitcnt lgkmcnt(6)
ds_read_b128 v[84:87], v194 offset:64
v_fmac_f32 v127, v15, v15
v_mfma_f32_16x16x32_bf16 v[20:23], v[174:177], v[92:95], 0
s_nop 0
ds_read_b128 v[92:95], v195 offset:64
s_waitcnt lgkmcnt(7)
v_mfma_f32_16x16x32_bf16 v[32:35], v[174:177], v[100:103], 0
v_add_f32 v134, v134, v28
v_fmac_f32 v127, v16, v16
v_mfma_f32_16x16x32_bf16 v[146:149], a[56:59], v[110:113], v[146:149]
ds_read_b128 v[104:107], v196 offset:80
v_add_f32_e64 v118, v118, v6
v_mfma_f32_16x16x32_bf16 v[146:149], a[60:63], v[220:223], v[146:149]
ds_read_b128 v[100:103], v196 offset:64
v_add_f32_e64 v126, v126, v16
v_mfma_f32_16x16x32_bf16 v[142:145], a[32:35], v[110:113], v[142:145]
ds_read_b128 v[174:177], v217 offset:4224
v_fmac_f32_e64 v119, v6, v6
v_mfma_f32_16x16x32_bf16 v[142:145], a[36:39], v[220:223], v[142:145]
s_waitcnt lgkmcnt(4)
v_add_f32 v118, v118, v7
v_fmac_f32 v127, v17, v17
v_smfmac_f32_16x16x64_bf16 v[8:11], v[178:181], v[84:91], v213
s_waitcnt lgkmcnt(3)
ds_read_b128 v[88:91], v197 offset:80
ds_read_b128 v[84:87], v197 offset:64
v_smfmac_f32_16x16x64_bf16 v[20:23], v[178:181], v[92:99], v213
s_add_u32 m0, s45, 0
ds_read_b128 v[96:99], v198 offset:80
v_add_f32 v126, v126, v17
v_mfma_f32_16x16x32_bf16 v[170:173], v[110:113], a[128:131], v[170:173]
ds_read_b128 v[92:95], v198 offset:64
v_fmac_f32_e64 v135, v29, v29
v_mfma_f32_16x16x32_bf16 v[170:173], v[220:223], a[132:135], v[170:173]
s_waitcnt lgkmcnt(5)
v_add_f32 v134, v134, v29
v_fmac_f32_e64 v135, v30, v30
v_smfmac_f32_16x16x64_bf16 v[32:35], v[178:181], v[100:107], v213
ds_read_b128 v[104:107], v199 offset:80
ds_read_b128 v[100:103], v199 offset:64
v_mfma_f32_16x16x32_bf16 v[154:157], a[248:251], v[110:113], v[154:157]
buffer_store_dwordx2 v[136:137], v204, s[8:11], s28 offen sc1
v_fmac_f32 v135, v31, v31
v_add_f32 v126, v126, v18
v_mfma_f32_16x16x32_bf16 v[154:157], a[252:255], v[220:223], v[154:157]
s_waitcnt lgkmcnt(4)
v_add_f32 v126, v126, v19
v_add_f32_e64 v134, v134, v30
v_smfmac_f32_16x16x64_bf16 v[8:11], v[174:177], v[84:91], v213
ds_read_b128 v[186:189], v210 offset:25600
v_fmac_f32_e64 v127, v18, v18
v_mfma_f32_16x16x32_bf16 v[166:169], v[110:113], a[104:107], v[166:169]
s_waitcnt lgkmcnt(3)
v_add_f32 v134, v134, v31
v_fmac_f32_e64 v127, v19, v19
v_smfmac_f32_16x16x64_bf16 v[20:23], v[174:177], v[92:99], v213
buffer_store_dwordx2 v[120:121], v204, s[8:11], s29 offen sc1
v_add_f32 v118, v118, v8
v_fmac_f32 v119, v7, v7
v_mfma_f32_16x16x32_bf16 v[166:169], v[220:223], a[108:111], v[166:169]
s_waitcnt lgkmcnt(1)
v_add_f32 v118, v118, v9
v_fmac_f32_e64 v119, v8, v8
v_smfmac_f32_16x16x64_bf16 v[32:35], v[174:177], v[100:107], v213
ds_read_b128 v[110:113], v210 offset:26624
v_fmac_f32_e64 v119, v9, v9
v_mfma_f32_16x16x32_bf16 v[162:165], v[220:223], a[84:87], v[162:165]
v_add_f32 v126, v126, v20
v_add_f32 v126, v126, v21
v_mfma_f32_16x16x32_bf16 v[138:141], a[16:19], v[182:185], v[138:141]
s_waitcnt lgkmcnt(1)
v_fmac_f32 v135, v32, v32
v_fmac_f32_e64 v135, v33, v33
v_mfma_f32_16x16x32_bf16 v[138:141], a[20:23], v[186:189], v[138:141]
v_add_f32 v126, v126, v22
v_add_f32 v118, v118, v10
v_mfma_f32_16x16x32_bf16 v[142:145], a[40:43], v[182:185], v[142:145]
s_add_u32 s40, s37, 196224
v_add_f32 v134, v134, v32
v_fmac_f32 v127, v20, v20
v_mfma_f32_16x16x32_bf16 v[142:145], a[44:47], v[186:189], v[142:145]
v_fmac_f32 v119, v10, v10
v_fmac_f32 v135, v34, v34
v_mfma_f32_16x16x32_bf16 v[146:149], a[64:67], v[182:185], v[146:149]
s_add_u32 s28, s38, s64
v_add_f32 v134, v134, v33
v_fmac_f32_e64 v127, v21, v21
v_mfma_f32_16x16x32_bf16 v[146:149], a[68:71], v[186:189], v[146:149]
v_fmac_f32 v127, v22, v22
v_add_f32 v126, v126, v23
v_mfma_f32_16x16x32_bf16 v[150:153], a[232:235], v[182:185], v[150:153]
v_cvt_pk_bf16_f32 v80, v142, v143
v_fmac_f32_e64 v135, v35, v35
v_mfma_f32_16x16x32_bf16 v[150:153], a[236:239], v[186:189], v[150:153]
v_add_f32 v134, v134, v34
v_fmac_f32 v119, v11, v11
v_mfma_f32_16x16x32_bf16 v[154:157], v[224:227], v[182:185], v[154:157]
v_add_f32_e64 v118, v118, v11
v_cvt_pk_bf16_f32 v83, v148, v149
v_mfma_f32_16x16x32_bf16 v[154:157], v[228:231], v[186:189], v[154:157]
v_add_f32_e64 v134, v134, v35
v_cvt_pk_bf16_f32 v78, v138, v139
v_mfma_f32_16x16x32_bf16 v[158:161], v[248:251], v[182:185], v[158:161]
ds_read_b128 v[220:223], v210 offset:27648
v_cvt_pk_bf16_f32 v82, v146, v147
v_mfma_f32_16x16x32_bf16 v[158:161], v[252:255], v[186:189], v[158:161]
v_fmac_f32_e64 v127, v23, v23
v_cvt_pk_bf16_f32 v75, v156, v157
v_mfma_f32_16x16x32_bf16 v[162:165], v[182:185], a[88:91], v[162:165]
v_cvt_pk_bf16_f32 v79, v140, v141
v_cvt_pk_bf16_f32 v72, v150, v151
v_mfma_f32_16x16x32_bf16 v[162:165], v[186:189], a[92:95], v[162:165]
v_permlane16_swap_b32 v134, v135
v_mfma_f32_16x16x32_bf16 v[166:169], v[182:185], a[112:115], v[166:169]
v_permlane16_swap_b32 v126, v127
v_mfma_f32_16x16x32_bf16 v[166:169], v[186:189], a[116:119], v[166:169]
v_permlane16_swap_b32 v118, v119
v_mfma_f32_16x16x32_bf16 v[170:173], v[182:185], a[136:139], v[170:173]
ds_read_b128 v[182:185], v210 offset:28672
v_cvt_pk_bf16_f32 v81, v144, v145
v_mfma_f32_16x16x32_bf16 v[170:173], v[186:189], a[140:143], v[170:173]
s_waitcnt lgkmcnt(2)
ds_read_b128 v[186:189], v210 offset:29696
v_add_f32_e64 v118, v118, v119
v_mfma_f32_16x16x32_bf16 v[138:141], a[0:3], v[110:113], 0
s_waitcnt lgkmcnt(2)
v_add_f32 v126, v126, v127
v_add_f32_e64 v134, v134, v135
v_mfma_f32_16x16x32_bf16 v[138:141], a[4:7], v[220:223], v[138:141]
v_permlane32_swap_b32 v118, v126
v_mfma_f32_16x16x32_bf16 v[142:145], a[24:27], v[110:113], 0
v_add_f32 v118, v118, v126
v_mov_b32_e64 v135, v134
v_mfma_f32_16x16x32_bf16 v[142:145], a[28:31], v[220:223], v[142:145]
ds_write_b32 v209, v118
v_mfma_f32_16x16x32_bf16 v[146:149], a[48:51], v[110:113], 0
v_permlane32_swap_b32 v134, v135
v_mfma_f32_16x16x32_bf16 v[146:149], a[52:55], v[220:223], v[146:149]
s_waitcnt lgkmcnt(2)
v_cvt_pk_bf16_f32 v73, v152, v153
v_add_f32 v134, v134, v135
v_mfma_f32_16x16x32_bf16 v[146:149], a[56:59], v[182:185], v[146:149]
s_waitcnt lgkmcnt(1)
ds_write_b32 v209, v134 offset:512
v_mfma_f32_16x16x32_bf16 v[146:149], a[60:63], v[186:189], v[146:149]
v_cvt_pk_bf16_f32 v74, v154, v155
v_cvt_pk_bf16_f32 v122, v166, v167
v_mfma_f32_16x16x32_bf16 v[150:153], a[216:219], v[110:113], 0
v_cvt_pk_bf16_f32 v77, v160, v161
v_cvt_pk_bf16_f32 v123, v168, v169
v_mfma_f32_16x16x32_bf16 v[150:153], a[220:223], v[220:223], v[150:153]
v_cvt_pk_bf16_f32 v114, v162, v163
v_cvt_pk_bf16_f32 v76, v158, v159
v_mfma_f32_16x16x32_bf16 v[154:157], a[240:243], v[110:113], 0
v_cvt_pk_bf16_f32 v130, v170, v171
v_mfma_f32_16x16x32_bf16 v[154:157], a[244:247], v[220:223], v[154:157]
s_waitcnt lgkmcnt(0)
v_mfma_f32_16x16x32_bf16 v[158:161], v[232:235], v[110:113], 0
s_barrier
v_mfma_f32_16x16x32_bf16 v[158:161], v[236:239], v[220:223], v[158:161]
ds_read_b128 v[102:105], v210 offset:18432
ds_read_b128 v[106:109], v210 offset:19456
v_mfma_f32_16x16x32_bf16 v[166:169], v[110:113], a[96:99], 0
v_cvt_pk_bf16_f32 v131, v172, v173
v_cvt_pk_bf16_f32 v115, v164, v165
v_mfma_f32_16x16x32_bf16 v[166:169], v[220:223], a[100:103], v[166:169]
buffer_load_dwordx4 v216, s[4:7], s52 offen nt lds
v_mfma_f32_16x16x32_bf16 v[162:165], v[110:113], a[72:75], 0
s_nop 0
ds_read_b64 v[128:129], v204 offset:6272
v_mfma_f32_16x16x32_bf16 v[162:165], v[220:223], a[76:79], v[162:165]
s_add_u32 m0, s45, 4112
ds_read_b64 v[136:137], v204 offset:6664
v_mfma_f32_16x16x32_bf16 v[170:173], v[110:113], a[120:123], 0
s_add_u32 s29, s38, s65
ds_read_b64 v[120:121], v204 offset:7056
ds_read_b128 v[110:113], v210 offset:30720
v_mfma_f32_16x16x32_bf16 v[170:173], v[220:223], a[124:127], v[170:173]
s_waitcnt lgkmcnt(5)
v_add_f32 v102, v102, v103
s_sub_u32 s46, s46, 1
s_cbranch_scc0 F_loop
F_tail:
s_mov_b32 s31, 0
s_mov_b32 s30, 1
s_mov_b32 s23, 131072
s_mov_b32 s22, 256
s_mov_b32 s21, s101
s_mov_b32 s20, s100
v_add_f32_e64 v104, v104, v105
v_mfma_f32_16x16x32_bf16 v[138:141], a[8:11], v[182:185], v[138:141]
s_waitcnt lgkmcnt(4)
v_add_f32 v102, v102, v104
v_add_f32 v106, v106, v107
v_mfma_f32_16x16x32_bf16 v[138:141], a[12:15], v[186:189], v[138:141]
s_waitcnt lgkmcnt(3)
buffer_store_dwordx2 v[128:129], v204, s[8:11], s28 offen sc1
v_mul_f32 v104, s73, v102
v_add_f32 v108, v108, v109
v_mfma_f32_16x16x32_bf16 v[142:145], a[32:35], v[182:185], v[142:145]
buffer_load_dwordx4 v216, s[4:7], s40 offen nt lds
v_mfma_f32_16x16x32_bf16 v[142:145], a[36:39], v[186:189], v[142:145]
v_add_f32 v106, v106, v108
v_mul_f32 v103, s48, v102
v_mfma_f32_16x16x32_bf16 v[150:153], a[224:227], v[182:185], v[150:153]
v_mul_f32_e64 v106, s73, v106
v_fma_f32 v106, -v103, v104, v106
v_mfma_f32_16x16x32_bf16 v[150:153], a[228:231], v[186:189], v[150:153]
s_add_u32 s28, s38, s66
v_max_f32 v106, 0, v106
v_add_f32_e64 v106, s49, v106
v_mfma_f32_16x16x32_bf16 v[154:157], a[248:251], v[182:185], v[154:157]
s_waitcnt lgkmcnt(2)
v_rsq_f32 v102, v106
v_mfma_f32_16x16x32_bf16 v[154:157], a[252:255], v[186:189], v[154:157]
s_add_u32 m0, s45, 8224
ds_read_b128 v[106:109], v210 offset:31744
v_mul_f32_e64 v103, -v103, v102
v_mfma_f32_16x16x32_bf16 v[158:161], v[240:243], v[182:185], v[158:161]
s_add_u32 s40, s37, 392448
buffer_store_dwordx2 v[136:137], v204, s[8:11], s29 offen sc1
ds_write_b64 v211, v[102:103]
v_mfma_f32_16x16x32_bf16 v[158:161], v[244:247], v[186:189], v[158:161]
buffer_load_dwordx4 v216, s[4:7], s40 offen nt lds
v_mfma_f32_16x16x32_bf16 v[166:169], v[182:185], a[104:107], v[166:169]
ds_read_b64 v[118:119], v219
ds_read_b64 v[136:137], v204 offset:12544
v_mfma_f32_16x16x32_bf16 v[166:169], v[186:189], a[108:111], v[166:169]
s_nop 0
ds_read_b64 v[134:135], v219 offset:512
s_add_u32 s29, s38, s67
v_mfma_f32_16x16x32_bf16 v[162:165], v[182:185], a[80:83], v[162:165]
ds_read_b64 v[128:129], v204 offset:7448
v_mfma_f32_16x16x32_bf16 v[162:165], v[186:189], a[84:87], v[162:165]
s_add_u32 s40, s37, 588672
s_add_u32 m0, s45, 12336
v_mfma_f32_16x16x32_bf16 v[170:173], v[182:185], a[128:131], v[170:173]
s_nop 0
ds_read_b128 v[182:185], v210 offset:32768
ds_read_b64 v[126:127], v219 offset:256
v_mfma_f32_16x16x32_bf16 v[170:173], v[186:189], a[132:135], v[170:173]
s_waitcnt lgkmcnt(5)
buffer_store_dwordx2 v[120:121], v204, s[8:11], s28 offen sc1
v_fma_f32 v223, v3, v118, v119
v_fma_f32 v221, v1, v118, v119
v_mfma_f32_16x16x32_bf16 v[138:141], a[16:19], v[110:113], v[138:141]
buffer_load_dwordx4 v216, s[4:7], s40 offen nt lds
v_mfma_f32_16x16x32_bf16 v[138:141], a[20:23], v[106:109], v[138:141]
s_add_u32 s40, s37, 784896
v_fma_f32 v220, v0, v118, v119
v_fma_f32 v222, v2, v118, v119
v_mfma_f32_16x16x32_bf16 v[142:145], a[40:43], v[110:113], v[142:145]
v_cvt_pk_bf16_f32 v91, v222, v223
v_fma_f32 v222, v6, v118, v119
v_mfma_f32_16x16x32_bf16 v[142:145], a[44:47], v[106:109], v[142:145]
s_nop 0
v_fma_f32 v223, v7, v118, v119
v_cvt_pk_bf16_f32 v96, v138, v139
v_mfma_f32_16x16x32_bf16 v[146:149], a[64:67], v[110:113], v[146:149]
s_add_u32 s28, s38, s68
v_cvt_pk_bf16_f32 v90, v220, v221
v_fma_f32 v220, v4, v118, v119
v_mfma_f32_16x16x32_bf16 v[146:149], a[68:71], v[106:109], v[146:149]
s_add_u32 m0, s45, 16448
v_cvt_pk_bf16_f32 v93, v222, v223
v_fma_f32 v221, v5, v118, v119
v_mfma_f32_16x16x32_bf16 v[150:153], a[232:235], v[110:113], v[150:153]
s_waitcnt lgkmcnt(2)
buffer_store_dwordx2 v[128:129], v204, s[8:11], s29 offen sc1
v_fma_f32 v222, v10, v118, v119
v_fma_f32 v223, v11, v118, v119
v_mfma_f32_16x16x32_bf16 v[150:153], a[236:239], v[106:109], v[150:153]
s_nop 0
v_cvt_pk_bf16_f32 v92, v220, v221
v_cvt_pk_bf16_f32 v97, v140, v141
v_mfma_f32_16x16x32_bf16 v[154:157], v[224:227], v[110:113], v[154:157]
buffer_load_dwordx4 v216, s[4:7], s40 offen nt lds
v_mfma_f32_16x16x32_bf16 v[154:157], v[228:231], v[106:109], v[154:157]
s_nop 0
ds_read_b128 v[186:189], v210 offset:33792
v_cvt_pk_bf16_f32 v95, v222, v223
v_mfma_f32_16x16x32_bf16 v[158:161], v[248:251], v[110:113], v[158:161]
s_waitcnt lgkmcnt(1)
v_cvt_pk_bf16_f32 v84, v150, v151
v_fma_f32 v223, v15, v126, v127
v_cvt_pk_bf16_f32 v101, v148, v149
v_mfma_f32_16x16x32_bf16 v[158:161], v[252:255], v[106:109], v[158:161]
s_add_u32 m0, s45, 20560
v_cvt_pk_bf16_f32 v99, v144, v145
v_fma_f32 v222, v14, v126, v127
v_mfma_f32_16x16x32_bf16 v[162:165], v[110:113], a[88:91], v[162:165]
v_cvt_pk_bf16_f32 v175, v222, v223
v_fma_f32 v223, v19, v126, v127
v_mfma_f32_16x16x32_bf16 v[162:165], v[106:109], a[92:95], v[162:165]
v_fma_f32 v221, v9, v118, v119
v_cvt_pk_bf16_f32 v98, v142, v143
v_mfma_f32_16x16x32_bf16 v[166:169], v[110:113], a[112:115], v[166:169]
v_cvt_pk_bf16_f32 v87, v156, v157
v_cvt_pk_bf16_f32 v100, v146, v147
v_mfma_f32_16x16x32_bf16 v[166:169], v[106:109], a[116:119], v[166:169]
s_add_u32 s40, s37, 981120
buffer_load_dwordx4 v216, s[4:7], s40 offen nt lds
v_mfma_f32_16x16x32_bf16 v[170:173], v[110:113], a[136:139], v[170:173]
v_fma_f32 v220, v8, v118, v119
v_cvt_pk_bf16_f32 v94, v220, v221
v_mfma_f32_16x16x32_bf16 v[170:173], v[106:109], a[140:143], v[170:173]
s_waitcnt lgkmcnt(0)
ds_write_b128 v211, v[90:93]
v_mfma_f32_16x16x32_bf16 v[138:141], a[0:3], v[182:185], 0
s_add_u32 s29, s38, s69
v_cvt_pk_bf16_f32 v133, v172, v173
v_cvt_pk_bf16_f32 v125, v168, v169
v_mfma_f32_16x16x32_bf16 v[138:141], a[4:7], v[186:189], v[138:141]
s_add_u32 s40, s37, 1177344
v_cvt_pk_bf16_f32 v89, v160, v161
v_cvt_pk_bf16_f32 v86, v154, v155
v_mfma_f32_16x16x32_bf16 v[142:145], a[24:27], v[182:185], 0
v_cvt_pk_bf16_f32 v132, v170, v171
v_fma_f32 v220, v12, v126, v127
v_mfma_f32_16x16x32_bf16 v[142:145], a[28:31], v[186:189], v[142:145]
ds_read_b128 v[170:173], v210 offset:34816
v_cvt_pk_bf16_f32 v88, v158, v159
v_mfma_f32_16x16x32_bf16 v[146:149], a[48:51], v[182:185], 0
s_add_u32 m0, s45, 24672
ds_read_b128 v[182:185], v210 offset:35840
v_fma_f32 v221, v13, v126, v127
v_mfma_f32_16x16x32_bf16 v[146:149], a[52:55], v[186:189], v[146:149]
buffer_store_dwordx2 v[136:137], v204, s[8:11], s28 offen sc1
buffer_load_dwordx4 v216, s[4:7], s40 offen nt lds
v_mfma_f32_16x16x16_bf16 v[154:157], v[82:83], v[88:89], 0
ds_read_b128 v[186:189], v210 offset:36864
v_cvt_pk_bf16_f32 v85, v152, v153
v_fma_f32 v222, v18, v126, v127
v_mfma_f32_16x16x16_bf16 v[158:161], v[100:101], v[88:89], 0
v_cvt_pk_bf16_f32 v177, v222, v223
v_fma_f32 v223, v23, v126, v127
v_cvt_pk_bf16_f32 v174, v220, v221
v_fma_f32 v222, v22, v126, v127
v_mfma_f32_16x16x32_bf16 v[154:157], v[78:81], v[84:87], v[154:157]
s_waitcnt lgkmcnt(2)
ds_read_b128 v[108:111], v215 offset:512
v_fma_f32 v221, v17, v126, v127
v_mfma_f32_16x16x32_bf16 v[138:141], a[8:11], v[170:173], v[138:141]
s_waitcnt lgkmcnt(2)
ds_read_b64 v[120:121], v204 offset:12936
v_fma_f32 v220, v16, v126, v127
v_mfma_f32_16x16x32_bf16 v[138:141], a[12:15], v[182:185], v[138:141]
ds_read_b64 v[112:113], v215 offset:528
v_cvt_pk_bf16_f32 v176, v220, v221
v_mfma_f32_16x16x32_bf16 v[142:145], a[32:35], v[170:173], v[142:145]
s_nop 0
v_fma_f32 v220, v20, v126, v127
v_fma_f32 v221, v21, v126, v127
v_mfma_f32_16x16x32_bf16 v[142:145], a[36:39], v[182:185], v[142:145]
s_waitcnt lgkmcnt(3)
ds_read_b64 v[136:137], v204 offset:13720
v_cvt_pk_bf16_f32 v179, v222, v223
v_mfma_f32_16x16x32_bf16 v[146:149], a[56:59], v[170:173], v[146:149]
s_add_u32 s40, s37, 1373568
ds_read_b128 v[170:173], v210 offset:37888
ds_read_b64 v[128:129], v204 offset:13328
v_mfma_f32_16x16x32_bf16 v[146:149], a[60:63], v[182:185], v[146:149]
s_add_u32 m0, s45, 28784
v_cvt_pk_bf16_f32 v178, v220, v221
v_cvt_pk_bf16_f32 v124, v166, v167
v_mfma_f32_16x16x32_bf16 v[146:149], a[64:67], v[186:189], v[146:149]
s_waitcnt lgkmcnt(3)
ds_write_b64 v212, v[94:95]
v_mfma_f32_16x16x16_bf16 v[166:169], v[112:113], v[88:89], v[206:209]
buffer_store_dwordx2 v[120:121], v204, s[8:11], s29 offen sc1
v_fma_f32 v221, v25, v134, v135
v_exp_f32 v154, v154
v_mfma_f32_16x16x32_bf16 v[142:145], a[40:43], v[186:189], v[142:145]
s_add_u32 s29, s38, s71
buffer_load_dwordx4 v216, s[4:7], s40 offen nt lds
v_mfma_f32_16x16x32_bf16 v[138:141], a[16:19], v[186:189], v[138:141]
s_waitcnt lgkmcnt(2)
ds_read_b128 v[186:189], v210 offset:33792
ds_read_b128 v[182:185], v210 offset:32768
v_mfma_f32_16x16x32_bf16 v[138:141], a[20:23], v[170:173], v[138:141]
ds_write_b128 v211, v[174:177] offset:6144
v_mfma_f32_16x16x32_bf16 v[142:145], a[44:47], v[170:173], v[142:145]
v_cvt_pk_bf16_f32 v102, v138, v139
v_fma_f32 v222, v26, v134, v135
v_cvt_pk_bf16_f32 v103, v140, v141
v_mfma_f32_16x16x32_bf16 v[150:153], v[108:111], v[72:75], v[206:209]
s_add_u32 s28, s38, s70
v_fma_f32 v220, v24, v134, v135
v_cvt_pk_bf16_f32 v90, v220, v221
v_mfma_f32_16x16x32_bf16 v[138:141], v[78:81], v[72:75], 0
s_waitcnt lgkmcnt(4)
ds_write_b64 v212, v[178:179] offset:6144
v_mfma_f32_16x16x16_bf16 v[150:153], v[112:113], v[76:77], v[150:153]
buffer_store_dwordx2 v[128:129], v204, s[8:11], s28 offen sc1
v_fma_f32 v223, v27, v134, v135
v_cvt_pk_bf16_f32 v91, v222, v223
v_mfma_f32_16x16x16_bf16 v[138:141], v[82:83], v[76:77], v[138:141]
v_fma_f32 v220, v28, v134, v135
v_fma_f32 v221, v29, v134, v135
v_cvt_pk_bf16_f32 v92, v220, v221
v_cvt_pk_bf16_f32 v104, v142, v143
v_mfma_f32_16x16x32_bf16 v[166:169], v[108:111], v[84:87], v[166:169]
v_fma_f32 v221, v33, v134, v135
v_fma_f32 v220, v32, v134, v135
v_mfma_f32_16x16x32_bf16 v[146:149], a[68:71], v[170:173], v[146:149]
s_nop 0
v_fma_f32 v223, v31, v134, v135
v_fma_f32 v222, v30, v134, v135
v_mfma_f32_16x16x32_bf16 v[158:161], v[96:99], v[84:87], v[158:161]
s_waitcnt lgkmcnt(2)
v_cvt_pk_bf16_f32 v93, v222, v223
v_fma_f32 v222, v34, v134, v135
v_mfma_f32_16x16x32_bf16 v[126:129], v[182:185], a[96:99], 0
ds_read_b128 v[174:177], v210 offset:34816
ds_read_b128 v[178:181], v210 offset:35840
v_mfma_f32_16x16x32_bf16 v[118:121], v[182:185], a[72:75], 0
v_cvt_pk_bf16_f32 v105, v144, v145
v_cvt_pk_bf16_f32 v106, v146, v147
v_mfma_f32_16x16x32_bf16 v[170:173], a[240:243], v[182:185], 0
v_cvt_pk_bf16_f32 v107, v148, v149
v_fma_f32 v223, v35, v134, v135
v_mfma_f32_16x16x32_bf16 v[170:173], a[244:247], v[186:189], v[170:173]
s_add_u32 m0, s45, 32896
ds_write_b128 v211, v[90:93] offset:12288
v_mfma_f32_16x16x32_bf16 v[146:149], v[102:105], v[72:75], 0
s_add_u32 s40, s37, 1569792
v_exp_f32 v157, v157
v_mfma_f32_16x16x32_bf16 v[142:145], v[96:99], v[72:75], 0
buffer_store_dwordx2 v[136:137], v204, s[8:11], s29 offen sc1
v_exp_f32 v160, v160
v_mfma_f32_16x16x32_bf16 v[90:93], a[216:219], v[182:185], 0
v_exp_f32 v138, v138
v_mfma_f32_16x16x32_bf16 v[90:93], a[220:223], v[186:189], v[90:93]
v_exp_f32 v140, v140
v_mfma_f32_16x16x32_bf16 v[134:137], v[182:185], a[120:123], 0
s_add_u32 s35, s35, 32
v_exp_f32 v166, v166
v_mfma_f32_16x16x32_bf16 v[134:137], v[186:189], a[124:127], v[134:137]
buffer_load_dwordx4 v216, s[4:7], s40 offen nt lds
v_mov_b32 v216, 1
s_waitcnt lgkmcnt(2)
s_mov_b64 exec, s[30:31]
buffer_atomic_add v216, off, s[20:23], s45 sc0
s_mov_b64 exec, -1
v_mfma_f32_16x16x32_bf16 v[134:137], v[174:177], a[128:131], v[134:137]
s_waitcnt lgkmcnt(1)
v_exp_f32 v141, v141
v_mfma_f32_16x16x32_bf16 v[134:137], v[178:181], a[132:135], v[134:137]
v_exp_f32_e64 v139, v139
v_mfma_f32_16x16x32_bf16 v[118:121], v[186:189], a[76:79], v[118:121]
v_cvt_pk_bf16_f32 v94, v220, v221
v_cvt_pk_bf16_f32 v95, v222, v223
v_mfma_f32_16x16x32_bf16 v[118:121], v[174:177], a[80:83], v[118:121]
ds_read_b128 v[72:75], v215
v_exp_f32 v155, v155
v_mfma_f32_16x16x16_bf16 v[146:149], v[106:107], v[76:77], v[146:149]
v_cvt_pk_bf16_f32 v117, v164, v165
v_exp_f32 v158, v158
v_mfma_f32_16x16x16_bf16 v[142:145], v[100:101], v[76:77], v[142:145]
v_cvt_pk_bf16_f32 v116, v162, v163
v_exp_f32 v159, v159
v_mfma_f32_16x16x16_bf16 v[162:165], v[106:107], v[88:89], 0
v_exp_f32 v147, v147
v_exp_f32 v150, v150
v_mfma_f32_16x16x32_bf16 v[126:129], v[186:189], a[100:103], v[126:129]
v_exp_f32 v143, v143
v_mfma_f32_16x16x32_bf16 v[126:129], v[174:177], a[104:107], v[126:129]
v_exp_f32 v149, v149
v_mfma_f32_16x16x32_bf16 v[126:129], v[178:181], a[108:111], v[126:129]
ds_write_b64 v212, v[94:95] offset:12288
v_mfma_f32_16x16x32_bf16 v[220:223], v[232:235], v[182:185], 0
s_mov_b32 s38, s36
v_exp_f32_e64 v142, v142
v_mfma_f32_16x16x32_bf16 v[220:223], v[236:239], v[186:189], v[220:223]
ds_read_b128 v[182:185], v210 offset:36864
ds_read_b128 v[186:189], v210 offset:37888
v_mfma_f32_16x16x32_bf16 v[220:223], v[240:243], v[174:177], v[220:223]
v_exp_f32 v144, v144
v_mfma_f32_16x16x32_bf16 v[220:223], v[244:247], v[178:181], v[220:223]
v_exp_f32 v146, v146
v_mfma_f32_16x16x32_bf16 v[162:165], v[102:105], v[84:87], v[162:165]
v_exp_f32 v145, v145
v_mfma_f32_16x16x32_bf16 v[170:173], a[248:251], v[174:177], v[170:173]
v_exp_f32 v156, v156
v_mfma_f32_16x16x32_bf16 v[170:173], a[252:255], v[178:181], v[170:173]
v_exp_f32 v163, v163
v_mfma_f32_16x16x32_bf16 v[90:93], a[224:227], v[174:177], v[90:93]
v_exp_f32 v165, v165
v_mfma_f32_16x16x32_bf16 v[90:93], a[228:231], v[178:181], v[90:93]
v_exp_f32 v161, v161
v_mfma_f32_16x16x32_bf16 v[118:121], v[178:181], a[84:87], v[118:121]
s_waitcnt lgkmcnt(1)
v_cvt_pk_bf16_f32 v174, v138, v139
v_cvt_pk_bf16_f32 v175, v140, v141
v_mfma_f32_16x16x32_bf16 v[118:121], v[182:185], a[88:91], v[118:121]
s_waitcnt lgkmcnt(0)
v_exp_f32_e64 v164, v164
v_mfma_f32_16x16x32_bf16 v[118:121], v[186:189], a[92:95], v[118:121]
s_add_u32 s29, s39, s61
ds_read_b64 v[76:77], v215 offset:16
v_cvt_pk_bf16_f32 v178, v146, v147
v_mfma_f32_16x16x32_bf16 v[126:129], v[182:185], a[112:115], v[126:129]
v_exp_f32_e64 v148, v148
v_mfma_f32_16x16x32_bf16 v[126:129], v[186:189], a[116:119], v[126:129]
v_cvt_pk_bf16_f32 v118, v118, v119
v_cvt_pk_bf16_f32 v176, v142, v143
v_mfma_f32_16x16x32_bf16 v[134:137], v[182:185], a[136:139], v[134:137]
v_cvt_pk_bf16_f32 v180, v150, 0
v_cvt_pk_bf16_f32 v177, v144, v145
v_mfma_f32_16x16x32_bf16 v[134:137], v[186:189], a[140:143], v[134:137]
v_cvt_pk_bf16_f32 v126, v126, v127
v_cvt_pk_bf16_f32 v119, v120, v121
v_mfma_f32_16x16x32_bf16 v[90:93], a[232:235], v[182:185], v[90:93]
ds_read_u16 v120, v205
v_mov_b32_e64 v121, 0
v_mfma_f32_16x16x32_bf16 v[90:93], a[236:239], v[186:189], v[90:93]
v_exp_f32_e64 v162, v162
v_mfma_f32_16x16x32_bf16 v[220:223], v[248:251], v[182:185], v[220:223]
v_cvt_pk_bf16_f32 v179, v148, v149
v_cvt_pk_bf16_f32 v127, v128, v129
v_mfma_f32_16x16x32_bf16 v[220:223], v[252:255], v[186:189], v[220:223]
ds_read_u16 v128, v205 offset:32
v_mov_b32_e64 v181, 0
v_mfma_f32_16x16x32_bf16 v[150:153], v[190:193], v[174:177], 0
v_cvt_pk_bf16_f32 v134, v134, v135
v_cvt_pk_bf16_f32 v135, v136, v137
v_mov_b32_e64 v129, 0
v_mfma_f32_16x16x32_bf16 v[150:153], v[190:193], v[178:181], v[150:153]
ds_read_u16 v136, v205 offset:64
v_cvt_pk_bf16_f32 v95, v222, v223
v_mfma_f32_16x16x32_bf16 v[138:141], v[114:117], v[174:177], 0
s_waitcnt lgkmcnt(2)
v_cvt_pk_bf16_f32 v90, v90, v91
v_mov_b32 v137, 0
v_mfma_f32_16x16x32_bf16 v[138:141], v[118:121], v[178:181], v[138:141]
v_rcp_f32 v151, v150
v_mfma_f32_16x16x32_bf16 v[142:145], v[122:125], v[174:177], 0
s_waitcnt lgkmcnt(1)
v_mul_f32_e64 v152, s3, v151
v_cvt_pk_bf16_f32 v91, v92, v93
v_mfma_f32_16x16x32_bf16 v[142:145], v[126:129], v[178:181], v[142:145]
v_mul_f32 v140, v140, v152
v_mul_f32 v138, v138, v152
v_mfma_f32_16x16x32_bf16 v[146:149], v[130:133], v[174:177], 0
s_waitcnt lgkmcnt(0)
v_mul_f32 v139, v139, v152
v_cvt_pk_bf16_f32 v175, v156, v157
v_mfma_f32_16x16x32_bf16 v[146:149], v[134:137], v[178:181], v[146:149]
v_cvt_pk_bf16_f32 v176, v158, v159
v_cvt_pk_bf16_f32 v180, v166, 0
v_mul_f32 v145, v145, v152
v_mul_f32 v142, v142, v152
v_mul_f32_e64 v141, v141, v152
v_mfma_f32_16x16x32_bf16 v[170:173], v[224:227], v[182:185], v[170:173]
v_cvt_pk_bf16_f32 v174, v154, v155
v_cvt_pk_bf16_f32 v179, v164, v165
v_mul_f32_e64 v147, v147, v152
v_mfma_f32_16x16x32_bf16 v[170:173], v[228:231], v[186:189], v[170:173]
v_cvt_pk_bf16_f32 v94, v220, v221
v_cvt_pk_bf16_f32 v177, v160, v161
v_cvt_pk_bf16_f32 v138, v138, v139
v_cvt_pk_bf16_f32 v178, v162, v163
v_mfma_f32_16x16x32_bf16 v[166:169], v[190:193], v[174:177], 0
v_cvt_pk_bf16_f32 v139, v140, v141
v_mul_f32_e64 v143, v143, v152
v_mfma_f32_16x16x32_bf16 v[166:169], v[190:193], v[178:181], v[166:169]
v_mul_f32 v149, v149, v152
v_mul_f32 v144, v144, v152
v_mfma_f32_16x16x32_bf16 v[154:157], v[114:117], v[174:177], 0
v_cvt_pk_bf16_f32 v93, v172, v173
v_mul_f32_e64 v146, v146, v152
v_mfma_f32_16x16x32_bf16 v[154:157], v[118:121], v[178:181], v[154:157]
v_cvt_pk_bf16_f32 v141, v144, v145
v_cvt_pk_bf16_f32 v140, v142, v143
v_max3_u32 v218, v218, v150, v151
v_mfma_f32_16x16x32_bf16 v[158:161], v[122:125], v[174:177], 0
v_rcp_f32 v167, v166
v_mfma_f32_16x16x32_bf16 v[158:161], v[126:129], v[178:181], v[158:161]
ds_write_b128 v211, v[138:141] offset:38912
v_mul_f32 v168, s3, v167
v_mul_f32_e64 v148, v148, v152
v_cvt_pk_bf16_f32 v92, v170, v171
v_mfma_f32_16x16x32_bf16 v[162:165], v[130:133], v[174:177], 0
v_cvt_pk_bf16_f32 v142, v146, v147
v_mul_f32_e64 v155, v155, v168
v_cvt_pk_bf16_f32 v143, v148, v149
v_mfma_f32_16x16x32_bf16 v[162:165], v[134:137], v[178:181], v[162:165]
v_mul_f32 v154, v154, v168
v_mul_f32 v157, v157, v168
v_mul_f32_e64 v159, v159, v168
v_mfma_f32_16x16x32_bf16 v[150:153], v[108:111], v[90:93], v[206:209]
v_mul_f32 v161, v161, v168
v_mul_f32 v156, v156, v168
v_mfma_f32_16x16x32_bf16 v[138:141], v[78:81], v[90:93], 0
ds_write_b64 v212, v[142:143] offset:38912
v_mfma_f32_16x16x16_bf16 v[150:153], v[112:113], v[94:95], v[150:153]
v_cvt_pk_bf16_f32 v154, v154, v155
v_mul_f32_e64 v158, v158, v168
v_cvt_pk_bf16_f32 v155, v156, v157
v_mfma_f32_16x16x16_bf16 v[138:141], v[82:83], v[94:95], v[138:141]
v_mul_f32 v160, v160, v168
v_mul_f32 v162, v162, v168
v_cvt_pk_bf16_f32 v157, v160, v161
v_cvt_pk_bf16_f32 v156, v158, v159
v_mfma_f32_16x16x32_bf16 v[142:145], v[96:99], v[90:93], 0
ds_write_b128 v211, v[154:157] offset:45056
v_mfma_f32_16x16x16_bf16 v[142:145], v[100:101], v[94:95], v[142:145]
v_mul_f32 v163, v163, v168
v_mul_f32 v164, v164, v168
v_mul_f32_e64 v165, v165, v168
v_cvt_pk_bf16_f32 v159, v164, v165
v_cvt_pk_bf16_f32 v158, v162, v163
v_mfma_f32_16x16x32_bf16 v[146:149], v[102:105], v[90:93], 0
ds_write_b64 v212, v[158:159] offset:45056
v_mfma_f32_16x16x16_bf16 v[154:157], v[76:77], v[82:83], 0
v_exp_f32_e64 v141, v141
v_max3_u32 v218, v218, v166, v167
v_mfma_f32_16x16x16_bf16 v[146:149], v[106:107], v[94:95], v[146:149]
v_exp_f32 v143, v143
v_exp_f32 v144, v144
v_mfma_f32_16x16x16_bf16 v[158:161], v[76:77], v[100:101], 0
v_exp_f32 v145, v145
v_exp_f32 v140, v140
v_mfma_f32_16x16x16_bf16 v[166:169], v[76:77], v[112:113], v[206:209]
v_cvt_pk_bf16_f32 v175, v140, v141
v_exp_f32 v138, v138
v_mfma_f32_16x16x16_bf16 v[162:165], v[76:77], v[106:107], 0
v_exp_f32 v139, v139
v_exp_f32 v142, v142
v_mfma_f32_16x16x32_bf16 v[154:157], v[72:75], v[78:81], v[154:157]
s_waitcnt lgkmcnt(0)
v_cvt_pk_bf16_f32 v177, v144, v145
v_cvt_pk_bf16_f32 v174, v138, v139
v_mfma_f32_16x16x32_bf16 v[158:161], v[72:75], v[96:99], v[158:161]
s_barrier
ds_read_b128 v[220:223], v210 offset:38912
v_mfma_f32_16x16x32_bf16 v[166:169], v[72:75], v[108:111], v[166:169]
s_nop 0
ds_read_b128 v[110:113], v210 offset:39936
v_cvt_pk_bf16_f32 v176, v142, v143
v_mfma_f32_16x16x32_bf16 v[162:165], v[72:75], v[102:105], v[162:165]
v_exp_f32 v150, v150
v_mfma_f32_16x16x32_bf16 v[142:145], v[122:125], v[174:177], 0
v_cvt_pk_bf16_f32 v180, v150, 0
v_mfma_f32_16x16x32_bf16 v[138:141], v[114:117], v[174:177], 0
v_exp_f32 v149, v149
v_mfma_f32_16x16x32_bf16 v[150:153], v[190:193], v[174:177], 0
ds_read_b128 v[170:173], v210 offset:40960
s_waitcnt lgkmcnt(2)
v_mfma_f32_16x16x32_bf16 v[40:43], a[168:171], v[220:223], v[40:43]
v_mov_b32_dpp v154, v158 quad_perm:[0,1,2,3] row_mask:0x2 bank_mask:0xf
s_waitcnt lgkmcnt(1)
v_mfma_f32_16x16x32_bf16 v[40:43], a[172:175], v[110:113], v[40:43]
v_exp_f32 v147, v147
v_mfma_f32_16x16x32_bf16 v[44:47], a[192:195], v[220:223], v[44:47]
s_add_u32 s28, s39, s60
v_exp_f32 v146, v146
v_mfma_f32_16x16x32_bf16 v[44:47], a[196:199], v[110:113], v[44:47]
v_exp_f32 v148, v148
v_mfma_f32_16x16x32_bf16 v[36:39], a[144:147], v[220:223], v[36:39]
v_cvt_pk_bf16_f32 v179, v148, v149
v_cvt_pk_bf16_f32 v178, v146, v147
v_mfma_f32_16x16x32_bf16 v[36:39], a[148:151], v[110:113], v[36:39]
ds_read_b128 v[182:185], v210 offset:41984
ds_read_b128 v[110:113], v210 offset:45056
v_mfma_f32_16x16x32_bf16 v[150:153], v[190:193], v[178:181], v[150:153]
v_mov_b32_dpp v154, v162 quad_perm:[0,1,2,3] row_mask:0x4 bank_mask:0xf
v_mfma_f32_16x16x32_bf16 v[138:141], v[118:121], v[178:181], v[138:141]
ds_read_b128 v[220:223], v210 offset:44032
ds_read_b128 v[186:189], v210 offset:43008
v_mfma_f32_16x16x32_bf16 v[142:145], v[126:129], v[178:181], v[142:145]
v_rcp_f32 v151, v150
v_mfma_f32_16x16x32_bf16 v[146:149], v[130:133], v[174:177], 0
v_mul_f32 v152, s3, v151
v_mov_b32_dpp v154, v167 quad_perm:[0,1,2,3] row_mask:0x8 bank_mask:0xf
v_mfma_f32_16x16x32_bf16 v[146:149], v[134:137], v[178:181], v[146:149]
s_waitcnt lgkmcnt(4)
v_mul_f32 v139, v139, v152
v_mul_f32_e64 v140, v140, v152
v_mfma_f32_16x16x32_bf16 v[36:39], a[152:155], v[170:173], v[36:39]
s_waitcnt lgkmcnt(3)
v_mul_f32 v138, v138, v152
v_cvt_pk_bf16_f32 v138, v138, v139
v_mfma_f32_16x16x32_bf16 v[36:39], a[156:159], v[182:185], v[36:39]
v_mul_f32 v141, v141, v152
v_mul_f32 v142, v142, v152
v_mfma_f32_16x16x32_bf16 v[40:43], a[176:179], v[170:173], v[40:43]
v_exp_f32 v154, v154
v_mfma_f32_16x16x32_bf16 v[40:43], a[180:183], v[182:185], v[40:43]
v_mul_f32 v143, v143, v152
v_cvt_pk_bf16_f32 v154, v154, 0
v_mfma_f32_16x16x32_bf16 v[44:47], a[200:203], v[170:173], v[44:47]
v_cvt_pk_bf16_f32 v139, v140, v141
v_mul_f32 v145, v145, v152
v_mfma_f32_16x16x32_bf16 v[44:47], a[204:207], v[182:185], v[44:47]
s_waitcnt lgkmcnt(0)
v_cvt_pk_bf16_f32 v140, v142, v143
v_mul_f32_e64 v144, v144, v152
v_mfma_f32_16x16x32_bf16 v[44:47], a[208:211], v[186:189], v[44:47]
ds_read_b128 v[170:173], v210 offset:46080
v_cvt_pk_bf16_f32 v141, v144, v145
v_mfma_f32_16x16x32_bf16 v[44:47], a[212:215], v[220:223], v[44:47]
ds_write_b128 v211, v[138:141] offset:51200
v_mfma_f32_16x16x32_bf16 v[36:39], a[160:163], v[186:189], v[36:39]
v_mul_f32 v148, v148, v152
v_mul_f32 v149, v149, v152
v_mfma_f32_16x16x32_bf16 v[36:39], a[164:167], v[220:223], v[36:39]
v_cvt_pk_bf16_f32 v44, v44, v45
v_mfma_f32_16x16x32_bf16 v[40:43], a[184:187], v[186:189], v[40:43]
ds_write_b16 v214, v154
v_mfma_f32_16x16x32_bf16 v[40:43], a[188:191], v[220:223], v[40:43]
s_nop 0
ds_read_b128 v[182:185], v210 offset:47104
v_cvt_pk_bf16_f32 v45, v46, v47
v_mfma_f32_16x16x32_bf16 v[48:51], a[144:147], v[110:113], v[48:51]
s_waitcnt lgkmcnt(3)
ds_read_b128 v[186:189], v210 offset:48128
ds_read_b128 v[220:223], v210 offset:49152
v_mfma_f32_16x16x32_bf16 v[48:51], a[148:151], v[170:173], v[48:51]
ds_read_b128 v[88:91], v215 offset:16
v_cvt_pk_bf16_f32 v36, v36, v37
v_mfma_f32_16x16x32_bf16 v[52:55], a[168:171], v[110:113], v[52:55]
v_cvt_pk_bf16_f32 v37, v38, v39
v_mul_f32_e64 v147, v147, v152
v_mfma_f32_16x16x32_bf16 v[52:55], a[172:175], v[170:173], v[52:55]
ds_write_b64 v203, v[44:45] offset:64
v_mfma_f32_16x16x32_bf16 v[56:59], a[192:195], v[110:113], v[56:59]
v_mul_f32 v146, v146, v152
v_cvt_pk_bf16_f32 v40, v40, v41
v_mfma_f32_16x16x32_bf16 v[56:59], a[196:199], v[170:173], v[56:59]
s_waitcnt lgkmcnt(4)
ds_read_b128 v[110:113], v210 offset:50176
v_cvt_pk_bf16_f32 v41, v42, v43
v_mfma_f32_16x16x32_bf16 v[56:59], a[200:203], v[182:185], v[56:59]
s_waitcnt lgkmcnt(4)
ds_write_b64 v203, v[36:37]
v_mfma_f32_16x16x32_bf16 v[56:59], a[204:207], v[186:189], v[56:59]
v_cvt_pk_bf16_f32 v143, v148, v149
v_mfma_f32_16x16x32_bf16 v[48:51], a[152:155], v[182:185], v[48:51]
ds_read_b128 v[84:87], v215
v_mfma_f32_16x16x32_bf16 v[48:51], a[156:159], v[186:189], v[48:51]
s_waitcnt lgkmcnt(5)
ds_write_b64 v203, v[40:41] offset:32
v_mfma_f32_16x16x32_bf16 v[48:51], a[160:163], v[220:223], v[48:51]
s_nop 0
v_cvt_pk_bf16_f32 v142, v146, v147
s_waitcnt lgkmcnt(3)
v_mfma_f32_16x16x32_bf16 v[48:51], a[164:167], v[110:113], v[48:51]
ds_write_b64 v212, v[142:143] offset:51200
v_mfma_f32_16x16x32_bf16 v[56:59], a[208:211], v[220:223], v[56:59]
v_mfma_f32_16x16x32_bf16 v[56:59], a[212:215], v[110:113], v[56:59]
v_cvt_pk_bf16_f32 v48, v48, v49
v_mfma_f32_16x16x32_bf16 v[52:55], a[176:179], v[182:185], v[52:55]
v_cvt_pk_bf16_f32 v49, v50, v51
v_add_u32 v205, 1424, v205
v_mfma_f32_16x16x32_bf16 v[52:55], a[180:183], v[186:189], v[52:55]
ds_write_b64 v203, v[48:49] offset:6272
v_mfma_f32_16x16x32_bf16 v[52:55], a[184:187], v[220:223], v[52:55]
s_waitcnt vmcnt(1) lgkmcnt(1)
v_mfma_f32_16x16x32_bf16 v[52:55], a[188:191], v[110:113], v[52:55]
s_barrier
v_mfma_f32_16x16x32_bf16 v[158:161], v[84:87], v[122:125], 0
ds_read_b128 v[178:181], v217 offset:528
v_mfma_f32_16x16x32_bf16 v[158:161], v[88:91], v[126:129], v[158:161]
ds_read_b128 v[170:173], v210 offset:51200
ds_read_b128 v[182:185], v210 offset:52224
v_mfma_f32_16x16x32_bf16 v[154:157], v[84:87], v[114:117], 0
ds_read_b128 v[220:223], v210 offset:54272
v_mfma_f32_16x16x32_bf16 v[154:157], v[88:91], v[118:121], v[154:157]
ds_read_b128 v[186:189], v210 offset:53248
ds_read_b128 v[110:113], v210 offset:55296
v_mfma_f32_16x16x32_bf16 v[162:165], v[84:87], v[130:133], 0
ds_read_b64 v[120:121], v204
v_mfma_f32_16x16x32_bf16 v[162:165], v[88:91], v[134:137], v[162:165]
v_mov_b32_dpp v154, v158 quad_perm:[0,1,2,3] row_mask:0x2 bank_mask:0xf
v_max3_u32 v218, v218, v150, v151
v_mfma_f32_16x16x32_bf16 v[166:169], v[84:87], v[190:193], 0
s_nop 0
ds_read_b128 v[84:87], v200
v_add_u32 v215, 1424, v215
v_mfma_f32_16x16x32_bf16 v[166:169], v[88:91], v[190:193], v[166:169]
s_waitcnt lgkmcnt(6)
ds_read_b128 v[92:95], v201
ds_read_b128 v[174:177], v217
v_mfma_f32_16x16x32_bf16 v[60:63], a[144:147], v[170:173], v[60:63]
s_nop 0
v_cvt_pk_bf16_f32 v52, v52, v53
s_waitcnt lgkmcnt(7)
v_mfma_f32_16x16x32_bf16 v[60:63], a[148:151], v[182:185], v[60:63]
v_mfma_f32_16x16x32_bf16 v[64:67], a[168:171], v[170:173], v[64:67]
ds_read_b128 v[100:103], v202
ds_read_b128 v[96:99], v195 offset:16
v_mfma_f32_16x16x32_bf16 v[64:67], a[172:175], v[182:185], v[64:67]
v_mfma_f32_16x16x32_bf16 v[68:71], a[192:195], v[170:173], v[68:71]
v_rcp_f32_e64 v167, v166
v_mfma_f32_16x16x32_bf16 v[68:71], a[196:199], v[182:185], v[68:71]
s_waitcnt lgkmcnt(7)
ds_read_b128 v[170:173], v210 offset:56320
v_cvt_pk_bf16_f32 v56, v56, v57
v_mfma_f32_16x16x32_bf16 v[68:71], a[200:203], v[186:189], v[68:71]
s_waitcnt lgkmcnt(3)
v_cvt_pk_bf16_f32 v57, v58, v59
v_cvt_pk_bf16_f32 v53, v54, v55
v_mfma_f32_16x16x32_bf16 v[48:51], v[174:177], v[92:95], 0
ds_read_b128 v[92:95], v195
ds_read_b128 v[182:185], v210
v_mfma_f32_16x16x32_bf16 v[36:39], v[174:177], v[84:87], 0
ds_write_b64 v203, v[52:53] offset:6304
v_mfma_f32_16x16x32_bf16 v[60:63], a[152:155], v[186:189], v[60:63]
v_mfma_f32_16x16x32_bf16 v[60:63], a[156:159], v[220:223], v[60:63]
ds_read_b128 v[104:107], v196 offset:16
v_mul_f32 v168, s3, v167
v_mfma_f32_16x16x32_bf16 v[60:63], a[160:163], v[110:113], v[60:63]
s_waitcnt lgkmcnt(4)
ds_read_b128 v[84:87], v194
ds_read_b128 v[88:91], v194 offset:16
v_mfma_f32_16x16x32_bf16 v[60:63], a[164:167], v[170:173], v[60:63]
ds_write_b64 v203, v[56:57] offset:6336
v_mfma_f32_16x16x32_bf16 v[64:67], a[176:179], v[186:189], v[64:67]
buffer_store_dwordx2 v[120:121], v204, s[8:11], s28 offen sc1
ds_read_b128 v[186:189], v210 offset:1024
v_mfma_f32_16x16x32_bf16 v[64:67], a[180:183], v[220:223], v[64:67]
v_cvt_pk_bf16_f32 v60, v60, v61
v_cvt_pk_bf16_f32 v61, v62, v63
v_mfma_f32_16x16x32_bf16 v[64:67], a[184:187], v[110:113], v[64:67]
ds_write_b64 v203, v[60:61] offset:12544
v_mfma_f32_16x16x32_bf16 v[64:67], a[188:191], v[170:173], v[64:67]
v_max3_u32 v218, v218, v166, v167
v_mfma_f32_16x16x32_bf16 v[60:63], v[174:177], v[100:103], 0
s_waitcnt lgkmcnt(8)
ds_read_b128 v[100:103], v196
v_mov_b32_dpp v154, v162 quad_perm:[0,1,2,3] row_mask:0x4 bank_mask:0xf
v_smfmac_f32_16x16x64_bf16 v[48:51], v[178:181], v[92:99], v213
s_waitcnt lgkmcnt(4)
ds_read_b128 v[92:95], v198
ds_read_b64 v[128:129], v204 offset:392
v_smfmac_f32_16x16x64_bf16 v[36:39], v[178:181], v[84:91], v213
ds_read_b128 v[174:177], v217 offset:1056
ds_read_b128 v[84:87], v197
v_mfma_f32_16x16x32_bf16 v[68:71], a[204:207], v[220:223], v[68:71]
ds_read_b128 v[88:91], v197 offset:16
v_cvt_pk_bf16_f32 v64, v64, v65
v_mfma_f32_16x16x32_bf16 v[68:71], a[208:211], v[110:113], v[68:71]
ds_read_b128 v[96:99], v198 offset:16
v_mfma_f32_16x16x32_bf16 v[68:71], a[212:215], v[170:173], v[68:71]
s_nop 0
v_cvt_pk_bf16_f32 v65, v66, v67
s_waitcnt lgkmcnt(6)
v_smfmac_f32_16x16x64_bf16 v[60:63], v[178:181], v[100:107], v213
ds_read_b128 v[100:103], v199
v_mul_f32 v154, v154, v168
v_mfma_f32_16x16x32_bf16 v[162:165], v[182:185], a[72:75], 0
s_waitcnt lgkmcnt(5)
buffer_store_dwordx2 v[128:129], v204, s[8:11], s29 offen sc1
v_cvt_pk_bf16_f32 v154, v154, 0
v_cvt_pk_bf16_f32 v68, v68, v69
v_mfma_f32_16x16x32_bf16 v[162:165], v[186:189], a[76:79], v[162:165]
ds_read_b128 v[104:107], v199 offset:16
ds_read_b128 v[220:223], v210 offset:3072
v_mfma_f32_16x16x32_bf16 v[166:169], v[182:185], a[96:99], 0
ds_write_b64 v203, v[64:65] offset:12576
v_mfma_f32_16x16x32_bf16 v[166:169], v[186:189], a[100:103], v[166:169]
s_nop 0
v_mfma_f32_16x16x32_bf16 v[170:173], v[182:185], a[120:123], 0
s_waitcnt lgkmcnt(5)
ds_write_b16 v214, v154
v_smfmac_f32_16x16x64_bf16 v[36:39], v[174:177], v[84:91], v213
ds_read_b128 v[178:181], v217 offset:1584
s_waitcnt lgkmcnt(6)
v_smfmac_f32_16x16x64_bf16 v[48:51], v[174:177], v[92:99], v213
s_waitcnt lgkmcnt(4)
ds_read_b128 v[92:95], v201 offset:32
ds_read_b128 v[84:87], v200 offset:32
v_smfmac_f32_16x16x64_bf16 v[60:63], v[174:177], v[100:107], v213
ds_read_b128 v[100:103], v202 offset:32
ds_read_b128 v[104:107], v196 offset:48
v_mfma_f32_16x16x32_bf16 v[138:141], a[0:3], v[182:185], 0
v_mul_f32 v119, v36, v36
v_fmac_f32 v119, v37, v37
v_mfma_f32_16x16x32_bf16 v[138:141], a[4:7], v[186:189], v[138:141]
ds_read_b128 v[96:99], v195 offset:48
ds_read_b128 v[110:113], v210 offset:2048
v_mfma_f32_16x16x32_bf16 v[142:145], a[24:27], v[182:185], 0
v_mul_f32 v127, v48, v48
v_add_f32 v118, v36, v37
v_mfma_f32_16x16x32_bf16 v[142:145], a[28:31], v[186:189], v[142:145]
ds_read_b128 v[88:91], v194 offset:48
v_add_f32_e64 v126, v48, v49
v_mfma_f32_16x16x32_bf16 v[146:149], a[48:51], v[182:185], 0
v_fmac_f32_e64 v119, v38, v38
v_add_f32 v118, v118, v38
v_mfma_f32_16x16x32_bf16 v[146:149], a[52:55], v[186:189], v[146:149]
s_waitcnt lgkmcnt(5)
ds_read_b128 v[174:177], v217 offset:2112
v_fmac_f32_e64 v119, v39, v39
v_mfma_f32_16x16x32_bf16 v[40:43], v[178:181], v[84:87], 0
s_nop 0
ds_read_b128 v[84:87], v194 offset:32
s_waitcnt lgkmcnt(6)
v_mfma_f32_16x16x32_bf16 v[64:67], v[178:181], v[100:103], 0
v_mul_f32 v135, v60, v60
v_fmac_f32 v127, v49, v49
v_mfma_f32_16x16x32_bf16 v[52:55], v[178:181], v[92:95], 0
ds_read_b128 v[92:95], v195 offset:32
v_fmac_f32_e64 v127, v50, v50
v_mfma_f32_16x16x32_bf16 v[158:161], v[232:235], v[182:185], 0
ds_read_b128 v[100:103], v196 offset:32
ds_read_b128 v[178:181], v217 offset:2640
v_mfma_f32_16x16x32_bf16 v[158:161], v[236:239], v[186:189], v[158:161]
v_cvt_pk_bf16_f32 v69, v70, v71
v_add_u32 v214, 1424, v214
v_mfma_f32_16x16x32_bf16 v[154:157], a[240:243], v[182:185], 0
ds_write_b64 v203, v[68:69] offset:12608
v_mfma_f32_16x16x32_bf16 v[154:157], a[244:247], v[186:189], v[154:157]
v_add_f32_e64 v126, v126, v50
s_waitcnt lgkmcnt(4)
v_smfmac_f32_16x16x64_bf16 v[40:43], v[174:177], v[84:91], v213
s_waitcnt lgkmcnt(3)
ds_read_b128 v[88:91], v197 offset:48
v_add_f32 v134, v60, v61
v_smfmac_f32_16x16x64_bf16 v[52:55], v[174:177], v[92:99], v213
s_waitcnt lgkmcnt(3)
ds_read_b128 v[84:87], v197 offset:32
v_add_f32_e64 v134, v134, v62
v_smfmac_f32_16x16x64_bf16 v[64:67], v[174:177], v[100:107], v213
ds_read_b128 v[92:95], v198 offset:32
v_fmac_f32_e64 v135, v61, v61
v_mfma_f32_16x16x32_bf16 v[150:153], a[216:219], v[182:185], 0
ds_read_b128 v[96:99], v198 offset:48
ds_read_b128 v[104:107], v199 offset:48
v_mfma_f32_16x16x32_bf16 v[150:153], a[220:223], v[186:189], v[150:153]
ds_read_b128 v[100:103], v199 offset:32
v_fmac_f32_e64 v135, v62, v62
v_mfma_f32_16x16x32_bf16 v[150:153], a[224:227], v[110:113], v[150:153]
v_add_f32 v126, v126, v51
v_fmac_f32 v135, v63, v63
v_mfma_f32_16x16x32_bf16 v[150:153], a[228:231], v[220:223], v[150:153]
v_add_f32 v118, v118, v39
s_waitcnt lgkmcnt(4)
v_smfmac_f32_16x16x64_bf16 v[40:43], v[178:181], v[84:91], v213
ds_read_b128 v[84:87], v200 offset:64
ds_read_b128 v[182:185], v210 offset:4096
v_mfma_f32_16x16x32_bf16 v[170:173], v[186:189], a[124:127], v[170:173]
s_add_u32 s29, s39, s63
ds_read_b128 v[174:177], v217 offset:3168
s_waitcnt lgkmcnt(5)
v_smfmac_f32_16x16x64_bf16 v[52:55], v[178:181], v[92:99], v213
ds_read_b128 v[92:95], v201 offset:64
v_add_f32_e64 v118, v118, v40
v_mfma_f32_16x16x32_bf16 v[162:165], v[110:113], a[80:83], v[162:165]
v_fmac_f32 v119, v40, v40
s_waitcnt lgkmcnt(4)
v_smfmac_f32_16x16x64_bf16 v[64:67], v[178:181], v[100:107], v213
ds_read_b128 v[100:103], v202 offset:64
v_fmac_f32_e64 v119, v41, v41
v_mfma_f32_16x16x32_bf16 v[158:161], v[240:243], v[110:113], v[158:161]
ds_read_b128 v[88:91], v194 offset:80
ds_read_b128 v[178:181], v217 offset:3696
v_mfma_f32_16x16x32_bf16 v[158:161], v[244:247], v[220:223], v[158:161]
s_add_u32 s28, s39, s62
v_add_f32 v118, v118, v41
v_add_f32_e64 v134, v134, v63
v_mfma_f32_16x16x32_bf16 v[138:141], a[8:11], v[110:113], v[138:141]
ds_read_b64 v[136:137], v204 offset:784
v_fmac_f32 v135, v64, v64
v_mfma_f32_16x16x32_bf16 v[138:141], a[12:15], v[220:223], v[138:141]
s_waitcnt lgkmcnt(5)
ds_read_b64 v[120:121], v204 offset:1176
ds_read_b128 v[96:99], v195 offset:80
v_mfma_f32_16x16x32_bf16 v[44:47], v[174:177], v[84:87], 0
s_waitcnt lgkmcnt(6)
ds_read_b128 v[84:87], v194 offset:64
v_fmac_f32 v127, v51, v51
v_mfma_f32_16x16x32_bf16 v[56:59], v[174:177], v[92:95], 0
s_nop 0
ds_read_b128 v[92:95], v195 offset:64
s_waitcnt lgkmcnt(7)
v_mfma_f32_16x16x32_bf16 v[68:71], v[174:177], v[100:103], 0
v_add_f32 v134, v134, v64
v_fmac_f32 v127, v52, v52
v_mfma_f32_16x16x32_bf16 v[146:149], a[56:59], v[110:113], v[146:149]
ds_read_b128 v[104:107], v196 offset:80
v_add_f32_e64 v118, v118, v42
v_mfma_f32_16x16x32_bf16 v[146:149], a[60:63], v[220:223], v[146:149]
ds_read_b128 v[100:103], v196 offset:64
v_add_f32_e64 v126, v126, v52
v_mfma_f32_16x16x32_bf16 v[142:145], a[32:35], v[110:113], v[142:145]
ds_read_b128 v[174:177], v217 offset:4224
v_fmac_f32_e64 v119, v42, v42
v_mfma_f32_16x16x32_bf16 v[142:145], a[36:39], v[220:223], v[142:145]
s_waitcnt lgkmcnt(4)
v_add_f32 v118, v118, v43
v_fmac_f32 v127, v53, v53
v_smfmac_f32_16x16x64_bf16 v[44:47], v[178:181], v[84:91], v213
s_waitcnt lgkmcnt(3)
ds_read_b128 v[88:91], v197 offset:80
ds_read_b128 v[84:87], v197 offset:64
v_smfmac_f32_16x16x64_bf16 v[56:59], v[178:181], v[92:99], v213
ds_read_b128 v[96:99], v198 offset:80
v_add_f32_e64 v126, v126, v53
v_mfma_f32_16x16x32_bf16 v[170:173], v[110:113], a[128:131], v[170:173]
ds_read_b128 v[92:95], v198 offset:64
v_fmac_f32_e64 v135, v65, v65
v_mfma_f32_16x16x32_bf16 v[170:173], v[220:223], a[132:135], v[170:173]
s_waitcnt lgkmcnt(5)
v_add_f32 v134, v134, v65
v_fmac_f32_e64 v135, v66, v66
v_smfmac_f32_16x16x64_bf16 v[68:71], v[178:181], v[100:107], v213
ds_read_b128 v[104:107], v199 offset:80
ds_read_b128 v[100:103], v199 offset:64
v_mfma_f32_16x16x32_bf16 v[154:157], a[248:251], v[110:113], v[154:157]
buffer_store_dwordx2 v[136:137], v204, s[8:11], s28 offen sc1
v_fmac_f32 v135, v67, v67
v_add_f32 v126, v126, v54
v_mfma_f32_16x16x32_bf16 v[154:157], a[252:255], v[220:223], v[154:157]
s_waitcnt lgkmcnt(4)
v_add_f32 v126, v126, v55
v_add_f32_e64 v134, v134, v66
v_smfmac_f32_16x16x64_bf16 v[44:47], v[174:177], v[84:91], v213
ds_read_b128 v[186:189], v210 offset:5120
v_fmac_f32_e64 v127, v54, v54
v_mfma_f32_16x16x32_bf16 v[166:169], v[110:113], a[104:107], v[166:169]
s_waitcnt lgkmcnt(3)
v_add_f32 v134, v134, v67
v_fmac_f32_e64 v127, v55, v55
v_smfmac_f32_16x16x64_bf16 v[56:59], v[174:177], v[92:99], v213
buffer_store_dwordx2 v[120:121], v204, s[8:11], s29 offen sc1
v_add_f32 v118, v118, v44
v_fmac_f32 v119, v43, v43
v_mfma_f32_16x16x32_bf16 v[166:169], v[220:223], a[108:111], v[166:169]
s_waitcnt lgkmcnt(1)
v_add_f32 v118, v118, v45
v_fmac_f32_e64 v119, v44, v44
v_smfmac_f32_16x16x64_bf16 v[68:71], v[174:177], v[100:107], v213
ds_read_b128 v[110:113], v210 offset:6144
v_fmac_f32_e64 v119, v45, v45
v_mfma_f32_16x16x32_bf16 v[162:165], v[220:223], a[84:87], v[162:165]
v_add_f32 v126, v126, v56
v_add_f32 v126, v126, v57
v_mfma_f32_16x16x32_bf16 v[138:141], a[16:19], v[182:185], v[138:141]
s_waitcnt lgkmcnt(1)
v_fmac_f32 v135, v68, v68
v_fmac_f32_e64 v135, v69, v69
v_mfma_f32_16x16x32_bf16 v[138:141], a[20:23], v[186:189], v[138:141]
v_add_f32 v126, v126, v58
v_add_f32 v118, v118, v46
v_mfma_f32_16x16x32_bf16 v[142:145], a[40:43], v[182:185], v[142:145]
v_add_f32 v134, v134, v68
v_fmac_f32 v127, v56, v56
v_mfma_f32_16x16x32_bf16 v[142:145], a[44:47], v[186:189], v[142:145]
v_fmac_f32 v119, v46, v46
v_fmac_f32 v135, v70, v70
v_mfma_f32_16x16x32_bf16 v[146:149], a[64:67], v[182:185], v[146:149]
s_add_u32 s28, s39, s64
v_add_f32 v134, v134, v69
v_fmac_f32_e64 v127, v57, v57
v_mfma_f32_16x16x32_bf16 v[146:149], a[68:71], v[186:189], v[146:149]
v_fmac_f32 v127, v58, v58
v_add_f32 v126, v126, v59
v_mfma_f32_16x16x32_bf16 v[150:153], a[232:235], v[182:185], v[150:153]
v_cvt_pk_bf16_f32 v80, v142, v143
v_fmac_f32 v135, v71, v71
s_waitcnt vmcnt(4)
s_mov_b64 exec, s[30:31]
ds_write_b32 v209, v216 offset:39424
s_mov_b64 exec, -1
v_mfma_f32_16x16x32_bf16 v[150:153], a[236:239], v[186:189], v[150:153]
v_add_f32 v134, v134, v70
v_fmac_f32 v119, v47, v47
v_mfma_f32_16x16x32_bf16 v[154:157], v[224:227], v[182:185], v[154:157]
v_add_f32_e64 v118, v118, v47
v_cvt_pk_bf16_f32 v83, v148, v149
v_mfma_f32_16x16x32_bf16 v[154:157], v[228:231], v[186:189], v[154:157]
v_add_f32_e64 v134, v134, v71
v_cvt_pk_bf16_f32 v78, v138, v139
v_mfma_f32_16x16x32_bf16 v[158:161], v[248:251], v[182:185], v[158:161]
ds_read_b128 v[220:223], v210 offset:7168
v_cvt_pk_bf16_f32 v82, v146, v147
v_mfma_f32_16x16x32_bf16 v[158:161], v[252:255], v[186:189], v[158:161]
v_fmac_f32_e64 v127, v59, v59
v_cvt_pk_bf16_f32 v75, v156, v157
v_mfma_f32_16x16x32_bf16 v[162:165], v[182:185], a[88:91], v[162:165]
v_cvt_pk_bf16_f32 v79, v140, v141
v_cvt_pk_bf16_f32 v72, v150, v151
v_mfma_f32_16x16x32_bf16 v[162:165], v[186:189], a[92:95], v[162:165]
v_permlane16_swap_b32 v134, v135
v_mfma_f32_16x16x32_bf16 v[166:169], v[182:185], a[112:115], v[166:169]
v_permlane16_swap_b32 v126, v127
v_mfma_f32_16x16x32_bf16 v[166:169], v[186:189], a[116:119], v[166:169]
v_permlane16_swap_b32 v118, v119
v_mfma_f32_16x16x32_bf16 v[170:173], v[182:185], a[136:139], v[170:173]
ds_read_b128 v[182:185], v210 offset:8192
v_cvt_pk_bf16_f32 v81, v144, v145
v_mfma_f32_16x16x32_bf16 v[170:173], v[186:189], a[140:143], v[170:173]
s_waitcnt lgkmcnt(3)
ds_read_b128 v[186:189], v210 offset:9216
v_add_f32_e64 v118, v118, v119
v_mfma_f32_16x16x32_bf16 v[138:141], a[0:3], v[110:113], 0
s_waitcnt lgkmcnt(2)
v_add_f32 v126, v126, v127
v_add_f32_e64 v134, v134, v135
v_mfma_f32_16x16x32_bf16 v[138:141], a[4:7], v[220:223], v[138:141]
v_permlane32_swap_b32 v118, v126
v_mfma_f32_16x16x32_bf16 v[142:145], a[24:27], v[110:113], 0
v_add_f32 v118, v118, v126
v_mov_b32_e64 v135, v134
v_mfma_f32_16x16x32_bf16 v[142:145], a[28:31], v[220:223], v[142:145]
ds_write_b32 v209, v118
v_mfma_f32_16x16x32_bf16 v[146:149], a[48:51], v[110:113], 0
v_permlane32_swap_b32 v134, v135
v_mfma_f32_16x16x32_bf16 v[146:149], a[52:55], v[220:223], v[146:149]
s_waitcnt lgkmcnt(2)
v_cvt_pk_bf16_f32 v73, v152, v153
v_add_f32 v134, v134, v135
v_mfma_f32_16x16x32_bf16 v[146:149], a[56:59], v[182:185], v[146:149]
s_waitcnt lgkmcnt(1)
ds_write_b32 v209, v134 offset:512
v_mfma_f32_16x16x32_bf16 v[146:149], a[60:63], v[186:189], v[146:149]
v_cvt_pk_bf16_f32 v74, v154, v155
v_cvt_pk_bf16_f32 v122, v166, v167
v_mfma_f32_16x16x32_bf16 v[150:153], a[216:219], v[110:113], 0
v_cvt_pk_bf16_f32 v77, v160, v161
v_cvt_pk_bf16_f32 v123, v168, v169
v_mfma_f32_16x16x32_bf16 v[150:153], a[220:223], v[220:223], v[150:153]
v_cvt_pk_bf16_f32 v114, v162, v163
v_cvt_pk_bf16_f32 v76, v158, v159
v_mfma_f32_16x16x32_bf16 v[154:157], a[240:243], v[110:113], 0
v_cvt_pk_bf16_f32 v130, v170, v171
v_mfma_f32_16x16x32_bf16 v[154:157], a[244:247], v[220:223], v[154:157]
s_waitcnt lgkmcnt(0)
v_mfma_f32_16x16x32_bf16 v[158:161], v[232:235], v[110:113], 0
s_barrier
v_mfma_f32_16x16x32_bf16 v[158:161], v[236:239], v[220:223], v[158:161]
ds_read_b128 v[102:105], v210 offset:18432
ds_read_b128 v[106:109], v210 offset:19456
v_mfma_f32_16x16x32_bf16 v[166:169], v[110:113], a[96:99], 0
v_cvt_pk_bf16_f32 v131, v172, v173
v_cvt_pk_bf16_f32 v115, v164, v165
v_mfma_f32_16x16x32_bf16 v[166:169], v[220:223], a[100:103], v[166:169]
v_mfma_f32_16x16x32_bf16 v[162:165], v[110:113], a[72:75], 0
ds_read_b64 v[128:129], v204 offset:6272
v_mfma_f32_16x16x32_bf16 v[162:165], v[220:223], a[76:79], v[162:165]
s_nop 0
ds_read_b64 v[136:137], v204 offset:6664
v_mfma_f32_16x16x32_bf16 v[170:173], v[110:113], a[120:123], 0
s_add_u32 s29, s39, s65
ds_read_b64 v[120:121], v204 offset:7056
ds_read_b128 v[110:113], v210 offset:10240
v_mfma_f32_16x16x32_bf16 v[170:173], v[220:223], a[124:127], v[170:173]
s_waitcnt lgkmcnt(5)
v_add_f32_e64 v102, v102, v103
ds_read_b32 v216, v210 offset:57856
s_waitcnt lgkmcnt(0)
v_readfirstlane_b32 s97, v216
s_nop 0
s_and_b32 s97, s97, 255
s_add_u32 s97, s97, 5120
s_cmp_lt_u32 s97, s34
s_cbranch_scc0 L_tailb
s_mov_b32 s35, s97
s_mul_hi_u32 s41, s35, 58835169
s_mul_i32 s42, s41, 73
s_sub_u32 s42, s35, s42
s_mul_i32 s43, s41, 1373568
s_mul_i32 s51, s42, 2688
s_add_u32 s50, s43, s51
s_min_u32 s41, s41, 1
s_sub_u32 s41, 1, s41
s_lshl_b32 s41, s41, 30
s_add_u32 s52, s50, s41
s_min_u32 s43, s42, 1
s_lshl_b32 s43, s43, 27
s_sub_u32 s43, 536870911, s43
s_add_u32 s51, s42, 56
s_and_b32 s51, s51, 128
s_lshl_b32 s51, s51, 22
s_or_b32 s44, s43, s51
s_mov_b32 s36, s50
v_and_b32 v216, s44, v208
s_add_u32 m0, s45, 0
s_nop 0
buffer_load_dwordx4 v216, s[4:7], s52 offen nt lds
s_add_u32 m0, s45, 4112
s_add_u32 s40, s36, 196224
v_add_f32_e64 v104, v104, v105
v_mfma_f32_16x16x32_bf16 v[138:141], a[8:11], v[182:185], v[138:141]
v_add_f32 v102, v102, v104
v_add_f32 v106, v106, v107
v_mfma_f32_16x16x32_bf16 v[138:141], a[12:15], v[186:189], v[138:141]
buffer_store_dwordx2 v[128:129], v204, s[8:11], s28 offen sc1
v_mul_f32 v104, s73, v102
v_add_f32 v108, v108, v109
v_mfma_f32_16x16x32_bf16 v[142:145], a[32:35], v[182:185], v[142:145]
buffer_load_dwordx4 v216, s[4:7], s40 offen nt lds
v_mfma_f32_16x16x32_bf16 v[142:145], a[36:39], v[186:189], v[142:145]
v_add_f32 v106, v106, v108
v_mul_f32 v103, s48, v102
v_mfma_f32_16x16x32_bf16 v[150:153], a[224:227], v[182:185], v[150:153]
v_mul_f32_e64 v106, s73, v106
v_fma_f32 v106, -v103, v104, v106
v_mfma_f32_16x16x32_bf16 v[150:153], a[228:231], v[186:189], v[150:153]
s_add_u32 s28, s39, s66
v_max_f32 v106, 0, v106
v_add_f32_e64 v106, s49, v106
v_mfma_f32_16x16x32_bf16 v[154:157], a[248:251], v[182:185], v[154:157]
v_rsq_f32_e64 v102, v106
v_mfma_f32_16x16x32_bf16 v[154:157], a[252:255], v[186:189], v[154:157]
s_add_u32 m0, s45, 8224
ds_read_b128 v[106:109], v210 offset:11264
v_mul_f32_e64 v103, -v103, v102
v_mfma_f32_16x16x32_bf16 v[158:161], v[240:243], v[182:185], v[158:161]
s_add_u32 s40, s36, 392448
buffer_store_dwordx2 v[136:137], v204, s[8:11], s29 offen sc1
ds_write_b64 v211, v[102:103] offset:20480
v_mfma_f32_16x16x32_bf16 v[158:161], v[244:247], v[186:189], v[158:161]
buffer_load_dwordx4 v216, s[4:7], s40 offen nt lds
v_mfma_f32_16x16x32_bf16 v[166:169], v[182:185], a[104:107], v[166:169]
ds_read_b64 v[118:119], v219 offset:20480
ds_read_b64 v[136:137], v204 offset:12544
v_mfma_f32_16x16x32_bf16 v[166:169], v[186:189], a[108:111], v[166:169]
s_nop 0
ds_read_b64 v[134:135], v219 offset:20992
s_add_u32 s29, s39, s67
v_mfma_f32_16x16x32_bf16 v[162:165], v[182:185], a[80:83], v[162:165]
ds_read_b64 v[128:129], v204 offset:7448
v_mfma_f32_16x16x32_bf16 v[162:165], v[186:189], a[84:87], v[162:165]
s_add_u32 s40, s36, 588672
s_add_u32 m0, s45, 12336
v_mfma_f32_16x16x32_bf16 v[170:173], v[182:185], a[128:131], v[170:173]
s_nop 0
ds_read_b128 v[182:185], v210 offset:12288
ds_read_b64 v[126:127], v219 offset:20736
v_mfma_f32_16x16x32_bf16 v[170:173], v[186:189], a[132:135], v[170:173]
s_waitcnt lgkmcnt(5)
buffer_store_dwordx2 v[120:121], v204, s[8:11], s28 offen sc1
v_fma_f32 v223, v39, v118, v119
v_fma_f32 v221, v37, v118, v119
v_mfma_f32_16x16x32_bf16 v[138:141], a[16:19], v[110:113], v[138:141]
buffer_load_dwordx4 v216, s[4:7], s40 offen nt lds
v_mfma_f32_16x16x32_bf16 v[138:141], a[20:23], v[106:109], v[138:141]
s_add_u32 s40, s36, 784896
v_fma_f32 v220, v36, v118, v119
v_fma_f32 v222, v38, v118, v119
v_mfma_f32_16x16x32_bf16 v[142:145], a[40:43], v[110:113], v[142:145]
v_cvt_pk_bf16_f32 v91, v222, v223
v_fma_f32 v222, v42, v118, v119
v_mfma_f32_16x16x32_bf16 v[142:145], a[44:47], v[106:109], v[142:145]
s_nop 0
v_fma_f32 v223, v43, v118, v119
v_cvt_pk_bf16_f32 v96, v138, v139
v_mfma_f32_16x16x32_bf16 v[146:149], a[64:67], v[110:113], v[146:149]
s_add_u32 s28, s39, s68
v_cvt_pk_bf16_f32 v90, v220, v221
v_fma_f32 v220, v40, v118, v119
v_mfma_f32_16x16x32_bf16 v[146:149], a[68:71], v[106:109], v[146:149]
s_add_u32 m0, s45, 16448
v_cvt_pk_bf16_f32 v93, v222, v223
v_fma_f32 v221, v41, v118, v119
v_mfma_f32_16x16x32_bf16 v[150:153], a[232:235], v[110:113], v[150:153]
s_waitcnt lgkmcnt(2)
buffer_store_dwordx2 v[128:129], v204, s[8:11], s29 offen sc1
v_fma_f32 v222, v46, v118, v119
v_fma_f32 v223, v47, v118, v119
v_mfma_f32_16x16x32_bf16 v[150:153], a[236:239], v[106:109], v[150:153]
s_nop 0
v_cvt_pk_bf16_f32 v92, v220, v221
v_cvt_pk_bf16_f32 v97, v140, v141
v_mfma_f32_16x16x32_bf16 v[154:157], v[224:227], v[110:113], v[154:157]
buffer_load_dwordx4 v216, s[4:7], s40 offen nt lds
v_mfma_f32_16x16x32_bf16 v[154:157], v[228:231], v[106:109], v[154:157]
s_nop 0
ds_read_b128 v[186:189], v210 offset:13312
v_cvt_pk_bf16_f32 v95, v222, v223
v_mfma_f32_16x16x32_bf16 v[158:161], v[248:251], v[110:113], v[158:161]
s_waitcnt lgkmcnt(1)
v_cvt_pk_bf16_f32 v84, v150, v151
v_fma_f32 v223, v51, v126, v127
v_cvt_pk_bf16_f32 v101, v148, v149
v_mfma_f32_16x16x32_bf16 v[158:161], v[252:255], v[106:109], v[158:161]
s_add_u32 m0, s45, 20560
v_cvt_pk_bf16_f32 v99, v144, v145
v_fma_f32 v222, v50, v126, v127
v_mfma_f32_16x16x32_bf16 v[162:165], v[110:113], a[88:91], v[162:165]
v_cvt_pk_bf16_f32 v175, v222, v223
v_fma_f32 v223, v55, v126, v127
v_mfma_f32_16x16x32_bf16 v[162:165], v[106:109], a[92:95], v[162:165]
v_fma_f32 v221, v45, v118, v119
v_cvt_pk_bf16_f32 v98, v142, v143
v_mfma_f32_16x16x32_bf16 v[166:169], v[110:113], a[112:115], v[166:169]
v_cvt_pk_bf16_f32 v87, v156, v157
v_cvt_pk_bf16_f32 v100, v146, v147
v_mfma_f32_16x16x32_bf16 v[166:169], v[106:109], a[116:119], v[166:169]
s_add_u32 s40, s36, 981120
buffer_load_dwordx4 v216, s[4:7], s40 offen nt lds
v_mfma_f32_16x16x32_bf16 v[170:173], v[110:113], a[136:139], v[170:173]
v_fma_f32 v220, v44, v118, v119
v_cvt_pk_bf16_f32 v94, v220, v221
v_mfma_f32_16x16x32_bf16 v[170:173], v[106:109], a[140:143], v[170:173]
s_waitcnt lgkmcnt(0)
ds_write_b128 v211, v[90:93] offset:20480
v_mfma_f32_16x16x32_bf16 v[138:141], a[0:3], v[182:185], 0
s_add_u32 s29, s39, s69
v_cvt_pk_bf16_f32 v133, v172, v173
v_cvt_pk_bf16_f32 v125, v168, v169
v_mfma_f32_16x16x32_bf16 v[138:141], a[4:7], v[186:189], v[138:141]
s_add_u32 s40, s36, 1177344
v_cvt_pk_bf16_f32 v89, v160, v161
v_cvt_pk_bf16_f32 v86, v154, v155
v_mfma_f32_16x16x32_bf16 v[142:145], a[24:27], v[182:185], 0
v_cvt_pk_bf16_f32 v132, v170, v171
v_fma_f32 v220, v48, v126, v127
v_mfma_f32_16x16x32_bf16 v[142:145], a[28:31], v[186:189], v[142:145]
ds_read_b128 v[170:173], v210 offset:14336
v_cvt_pk_bf16_f32 v88, v158, v159
v_mfma_f32_16x16x32_bf16 v[146:149], a[48:51], v[182:185], 0
s_add_u32 m0, s45, 24672
ds_read_b128 v[182:185], v210 offset:15360
v_fma_f32 v221, v49, v126, v127
v_mfma_f32_16x16x32_bf16 v[146:149], a[52:55], v[186:189], v[146:149]
buffer_store_dwordx2 v[136:137], v204, s[8:11], s28 offen sc1
buffer_load_dwordx4 v216, s[4:7], s40 offen nt lds
v_mfma_f32_16x16x16_bf16 v[154:157], v[82:83], v[88:89], 0
ds_read_b128 v[186:189], v210 offset:16384
v_cvt_pk_bf16_f32 v85, v152, v153
v_fma_f32 v222, v54, v126, v127
v_mfma_f32_16x16x16_bf16 v[158:161], v[100:101], v[88:89], 0
v_cvt_pk_bf16_f32 v177, v222, v223
v_fma_f32 v223, v59, v126, v127
v_cvt_pk_bf16_f32 v174, v220, v221
v_fma_f32 v222, v58, v126, v127
v_mfma_f32_16x16x32_bf16 v[154:157], v[78:81], v[84:87], v[154:157]
s_waitcnt lgkmcnt(2)
ds_read_b128 v[108:111], v215 offset:512
v_fma_f32 v221, v53, v126, v127
v_mfma_f32_16x16x32_bf16 v[138:141], a[8:11], v[170:173], v[138:141]
s_waitcnt lgkmcnt(2)
ds_read_b64 v[120:121], v204 offset:12936
v_fma_f32 v220, v52, v126, v127
v_mfma_f32_16x16x32_bf16 v[138:141], a[12:15], v[182:185], v[138:141]
ds_read_b64 v[112:113], v215 offset:528
v_cvt_pk_bf16_f32 v176, v220, v221
v_mfma_f32_16x16x32_bf16 v[142:145], a[32:35], v[170:173], v[142:145]
s_nop 0
v_fma_f32 v220, v56, v126, v127
v_fma_f32 v221, v57, v126, v127
v_mfma_f32_16x16x32_bf16 v[142:145], a[36:39], v[182:185], v[142:145]
s_waitcnt lgkmcnt(3)
ds_read_b64 v[136:137], v204 offset:13720
v_cvt_pk_bf16_f32 v179, v222, v223
v_mfma_f32_16x16x32_bf16 v[146:149], a[56:59], v[170:173], v[146:149]
s_add_u32 s40, s36, 1373568
ds_read_b128 v[170:173], v210 offset:17408
ds_read_b64 v[128:129], v204 offset:13328
v_mfma_f32_16x16x32_bf16 v[146:149], a[60:63], v[182:185], v[146:149]
s_add_u32 m0, s45, 28784
v_cvt_pk_bf16_f32 v178, v220, v221
v_cvt_pk_bf16_f32 v124, v166, v167
v_mfma_f32_16x16x32_bf16 v[146:149], a[64:67], v[186:189], v[146:149]
s_waitcnt lgkmcnt(3)
ds_write_b64 v212, v[94:95] offset:20480
v_mfma_f32_16x16x16_bf16 v[166:169], v[112:113], v[88:89], v[206:209]
buffer_store_dwordx2 v[120:121], v204, s[8:11], s29 offen sc1
v_fma_f32 v221, v61, v134, v135
v_exp_f32 v154, v154
v_mfma_f32_16x16x32_bf16 v[142:145], a[40:43], v[186:189], v[142:145]
s_add_u32 s29, s39, s71
buffer_load_dwordx4 v216, s[4:7], s40 offen nt lds
v_mfma_f32_16x16x32_bf16 v[138:141], a[16:19], v[186:189], v[138:141]
s_waitcnt lgkmcnt(2)
ds_read_b128 v[186:189], v210 offset:13312
ds_read_b128 v[182:185], v210 offset:12288
v_mfma_f32_16x16x32_bf16 v[138:141], a[20:23], v[170:173], v[138:141]
ds_write_b128 v211, v[174:177] offset:26624
v_mfma_f32_16x16x32_bf16 v[142:145], a[44:47], v[170:173], v[142:145]
v_cvt_pk_bf16_f32 v102, v138, v139
v_fma_f32 v222, v62, v134, v135
v_cvt_pk_bf16_f32 v103, v140, v141
v_mfma_f32_16x16x32_bf16 v[150:153], v[108:111], v[72:75], v[206:209]
s_add_u32 s28, s39, s70
v_fma_f32 v220, v60, v134, v135
v_cvt_pk_bf16_f32 v90, v220, v221
v_mfma_f32_16x16x32_bf16 v[138:141], v[78:81], v[72:75], 0
s_waitcnt lgkmcnt(4)
ds_write_b64 v212, v[178:179] offset:26624
v_mfma_f32_16x16x16_bf16 v[150:153], v[112:113], v[76:77], v[150:153]
buffer_store_dwordx2 v[128:129], v204, s[8:11], s28 offen sc1
v_fma_f32 v223, v63, v134, v135
v_cvt_pk_bf16_f32 v91, v222, v223
v_mfma_f32_16x16x16_bf16 v[138:141], v[82:83], v[76:77], v[138:141]
v_fma_f32 v220, v64, v134, v135
v_fma_f32 v221, v65, v134, v135
v_cvt_pk_bf16_f32 v92, v220, v221
v_cvt_pk_bf16_f32 v104, v142, v143
v_mfma_f32_16x16x32_bf16 v[166:169], v[108:111], v[84:87], v[166:169]
v_fma_f32 v221, v69, v134, v135
v_fma_f32 v220, v68, v134, v135
v_mfma_f32_16x16x32_bf16 v[146:149], a[68:71], v[170:173], v[146:149]
s_nop 0
v_fma_f32 v223, v67, v134, v135
v_fma_f32 v222, v66, v134, v135
v_mfma_f32_16x16x32_bf16 v[158:161], v[96:99], v[84:87], v[158:161]
s_waitcnt lgkmcnt(2)
v_cvt_pk_bf16_f32 v93, v222, v223
v_fma_f32 v222, v70, v134, v135
v_mfma_f32_16x16x32_bf16 v[126:129], v[182:185], a[96:99], 0
ds_read_b128 v[174:177], v210 offset:14336
ds_read_b128 v[178:181], v210 offset:15360
v_mfma_f32_16x16x32_bf16 v[118:121], v[182:185], a[72:75], 0
v_cvt_pk_bf16_f32 v105, v144, v145
v_cvt_pk_bf16_f32 v106, v146, v147
v_mfma_f32_16x16x32_bf16 v[170:173], a[240:243], v[182:185], 0
v_cvt_pk_bf16_f32 v107, v148, v149
v_fma_f32 v223, v71, v134, v135
v_mfma_f32_16x16x32_bf16 v[170:173], a[244:247], v[186:189], v[170:173]
s_add_u32 m0, s45, 32896
ds_write_b128 v211, v[90:93] offset:32768
v_mfma_f32_16x16x32_bf16 v[146:149], v[102:105], v[72:75], 0
s_add_u32 s40, s36, 1569792
v_exp_f32 v157, v157
v_mfma_f32_16x16x32_bf16 v[142:145], v[96:99], v[72:75], 0
buffer_store_dwordx2 v[136:137], v204, s[8:11], s29 offen sc1
v_exp_f32 v160, v160
v_mfma_f32_16x16x32_bf16 v[90:93], a[216:219], v[182:185], 0
v_exp_f32_e64 v138, v138
v_mfma_f32_16x16x32_bf16 v[90:93], a[220:223], v[186:189], v[90:93]
v_exp_f32 v140, v140
v_mfma_f32_16x16x32_bf16 v[134:137], v[182:185], a[120:123], 0
s_add_u32 s35, s35, 32
v_exp_f32 v166, v166
v_mfma_f32_16x16x32_bf16 v[134:137], v[186:189], a[124:127], v[134:137]
s_waitcnt lgkmcnt(2)
buffer_load_dwordx4 v216, s[4:7], s40 offen nt lds
v_mfma_f32_16x16x32_bf16 v[134:137], v[174:177], a[128:131], v[134:137]
s_waitcnt lgkmcnt(1)
v_exp_f32 v141, v141
v_mfma_f32_16x16x32_bf16 v[134:137], v[178:181], a[132:135], v[134:137]
v_exp_f32_e64 v139, v139
v_mfma_f32_16x16x32_bf16 v[118:121], v[186:189], a[76:79], v[118:121]
v_cvt_pk_bf16_f32 v94, v220, v221
v_cvt_pk_bf16_f32 v95, v222, v223
v_mfma_f32_16x16x32_bf16 v[118:121], v[174:177], a[80:83], v[118:121]
ds_read_b128 v[72:75], v215
v_exp_f32 v155, v155
v_mfma_f32_16x16x16_bf16 v[146:149], v[106:107], v[76:77], v[146:149]
v_cvt_pk_bf16_f32 v117, v164, v165
v_exp_f32 v158, v158
v_mfma_f32_16x16x16_bf16 v[142:145], v[100:101], v[76:77], v[142:145]
v_cvt_pk_bf16_f32 v116, v162, v163
v_exp_f32 v159, v159
v_mfma_f32_16x16x16_bf16 v[162:165], v[106:107], v[88:89], 0
v_exp_f32 v147, v147
v_exp_f32 v150, v150
v_mfma_f32_16x16x32_bf16 v[126:129], v[186:189], a[100:103], v[126:129]
v_exp_f32 v143, v143
v_mfma_f32_16x16x32_bf16 v[126:129], v[174:177], a[104:107], v[126:129]
v_exp_f32 v149, v149
v_mfma_f32_16x16x32_bf16 v[126:129], v[178:181], a[108:111], v[126:129]
ds_write_b64 v212, v[94:95] offset:32768
v_mfma_f32_16x16x32_bf16 v[220:223], v[232:235], v[182:185], 0
s_mov_b32 s39, s37
v_exp_f32_e64 v142, v142
v_mfma_f32_16x16x32_bf16 v[220:223], v[236:239], v[186:189], v[220:223]
ds_read_b128 v[182:185], v210 offset:16384
ds_read_b128 v[186:189], v210 offset:17408
v_mfma_f32_16x16x32_bf16 v[220:223], v[240:243], v[174:177], v[220:223]
v_exp_f32 v144, v144
v_mfma_f32_16x16x32_bf16 v[220:223], v[244:247], v[178:181], v[220:223]
v_exp_f32 v146, v146
v_mfma_f32_16x16x32_bf16 v[162:165], v[102:105], v[84:87], v[162:165]
v_exp_f32 v145, v145
v_mfma_f32_16x16x32_bf16 v[170:173], a[248:251], v[174:177], v[170:173]
v_exp_f32 v156, v156
v_mfma_f32_16x16x32_bf16 v[170:173], a[252:255], v[178:181], v[170:173]
v_exp_f32 v163, v163
v_mfma_f32_16x16x32_bf16 v[90:93], a[224:227], v[174:177], v[90:93]
v_exp_f32 v165, v165
v_mfma_f32_16x16x32_bf16 v[90:93], a[228:231], v[178:181], v[90:93]
v_exp_f32 v161, v161
v_mfma_f32_16x16x32_bf16 v[118:121], v[178:181], a[84:87], v[118:121]
s_waitcnt lgkmcnt(1)
v_cvt_pk_bf16_f32 v174, v138, v139
v_cvt_pk_bf16_f32 v175, v140, v141
v_mfma_f32_16x16x32_bf16 v[118:121], v[182:185], a[88:91], v[118:121]
s_waitcnt lgkmcnt(0)
v_exp_f32_e64 v164, v164
v_mfma_f32_16x16x32_bf16 v[118:121], v[186:189], a[92:95], v[118:121]
s_add_u32 s29, s38, s61
ds_read_b64 v[76:77], v215 offset:16
v_cvt_pk_bf16_f32 v178, v146, v147
v_mfma_f32_16x16x32_bf16 v[126:129], v[182:185], a[112:115], v[126:129]
v_exp_f32_e64 v148, v148
v_mfma_f32_16x16x32_bf16 v[126:129], v[186:189], a[116:119], v[126:129]
v_cvt_pk_bf16_f32 v118, v118, v119
v_cvt_pk_bf16_f32 v176, v142, v143
v_mfma_f32_16x16x32_bf16 v[134:137], v[182:185], a[136:139], v[134:137]
v_cvt_pk_bf16_f32 v180, v150, 0
v_cvt_pk_bf16_f32 v177, v144, v145
v_mfma_f32_16x16x32_bf16 v[134:137], v[186:189], a[140:143], v[134:137]
v_cvt_pk_bf16_f32 v126, v126, v127
v_cvt_pk_bf16_f32 v119, v120, v121
v_mfma_f32_16x16x32_bf16 v[90:93], a[232:235], v[182:185], v[90:93]
ds_read_u16 v120, v205
v_mov_b32_e64 v121, 0
v_mfma_f32_16x16x32_bf16 v[90:93], a[236:239], v[186:189], v[90:93]
v_exp_f32_e64 v162, v162
v_mfma_f32_16x16x32_bf16 v[220:223], v[248:251], v[182:185], v[220:223]
v_cvt_pk_bf16_f32 v179, v148, v149
v_cvt_pk_bf16_f32 v127, v128, v129
v_mfma_f32_16x16x32_bf16 v[220:223], v[252:255], v[186:189], v[220:223]
ds_read_u16 v128, v205 offset:32
v_mov_b32_e64 v181, 0
v_mfma_f32_16x16x32_bf16 v[150:153], v[190:193], v[174:177], 0
v_cvt_pk_bf16_f32 v134, v134, v135
v_cvt_pk_bf16_f32 v135, v136, v137
v_mov_b32_e64 v129, 0
v_mfma_f32_16x16x32_bf16 v[150:153], v[190:193], v[178:181], v[150:153]
ds_read_u16 v136, v205 offset:64
v_cvt_pk_bf16_f32 v95, v222, v223
v_mfma_f32_16x16x32_bf16 v[138:141], v[114:117], v[174:177], 0
s_waitcnt lgkmcnt(2)
v_cvt_pk_bf16_f32 v90, v90, v91
v_mov_b32 v137, 0
v_mfma_f32_16x16x32_bf16 v[138:141], v[118:121], v[178:181], v[138:141]
v_rcp_f32 v151, v150
v_mfma_f32_16x16x32_bf16 v[142:145], v[122:125], v[174:177], 0
s_waitcnt lgkmcnt(1)
v_mul_f32_e64 v152, s3, v151
v_cvt_pk_bf16_f32 v91, v92, v93
v_mfma_f32_16x16x32_bf16 v[142:145], v[126:129], v[178:181], v[142:145]
v_mul_f32 v140, v140, v152
v_mul_f32 v138, v138, v152
v_mfma_f32_16x16x32_bf16 v[146:149], v[130:133], v[174:177], 0
s_waitcnt lgkmcnt(0)
v_mul_f32 v139, v139, v152
v_cvt_pk_bf16_f32 v175, v156, v157
v_mfma_f32_16x16x32_bf16 v[146:149], v[134:137], v[178:181], v[146:149]
v_cvt_pk_bf16_f32 v176, v158, v159
v_cvt_pk_bf16_f32 v180, v166, 0
v_mul_f32 v145, v145, v152
v_mul_f32 v142, v142, v152
v_mul_f32_e64 v141, v141, v152
v_mfma_f32_16x16x32_bf16 v[170:173], v[224:227], v[182:185], v[170:173]
v_cvt_pk_bf16_f32 v174, v154, v155
v_cvt_pk_bf16_f32 v179, v164, v165
v_mul_f32_e64 v147, v147, v152
v_mfma_f32_16x16x32_bf16 v[170:173], v[228:231], v[186:189], v[170:173]
v_cvt_pk_bf16_f32 v94, v220, v221
v_cvt_pk_bf16_f32 v177, v160, v161
v_cvt_pk_bf16_f32 v138, v138, v139
v_cvt_pk_bf16_f32 v178, v162, v163
v_mfma_f32_16x16x32_bf16 v[166:169], v[190:193], v[174:177], 0
v_cvt_pk_bf16_f32 v139, v140, v141
v_mul_f32_e64 v143, v143, v152
v_mfma_f32_16x16x32_bf16 v[166:169], v[190:193], v[178:181], v[166:169]
v_mul_f32 v149, v149, v152
v_mul_f32 v144, v144, v152
v_mfma_f32_16x16x32_bf16 v[154:157], v[114:117], v[174:177], 0
v_cvt_pk_bf16_f32 v93, v172, v173
v_mul_f32_e64 v146, v146, v152
v_mfma_f32_16x16x32_bf16 v[154:157], v[118:121], v[178:181], v[154:157]
v_cvt_pk_bf16_f32 v141, v144, v145
v_cvt_pk_bf16_f32 v140, v142, v143
v_max3_u32 v218, v218, v150, v151
v_mfma_f32_16x16x32_bf16 v[158:161], v[122:125], v[174:177], 0
v_rcp_f32 v167, v166
v_mfma_f32_16x16x32_bf16 v[158:161], v[126:129], v[178:181], v[158:161]
ds_write_b128 v211, v[138:141] offset:38912
v_mul_f32 v168, s3, v167
v_mul_f32_e64 v148, v148, v152
v_cvt_pk_bf16_f32 v92, v170, v171
v_mfma_f32_16x16x32_bf16 v[162:165], v[130:133], v[174:177], 0
v_cvt_pk_bf16_f32 v142, v146, v147
v_mul_f32_e64 v155, v155, v168
v_cvt_pk_bf16_f32 v143, v148, v149
v_mfma_f32_16x16x32_bf16 v[162:165], v[134:137], v[178:181], v[162:165]
v_mul_f32 v154, v154, v168
v_mul_f32 v157, v157, v168
v_mul_f32_e64 v159, v159, v168
v_mfma_f32_16x16x32_bf16 v[150:153], v[108:111], v[90:93], v[206:209]
v_mul_f32 v161, v161, v168
v_mul_f32 v156, v156, v168
v_mfma_f32_16x16x32_bf16 v[138:141], v[78:81], v[90:93], 0
ds_write_b64 v212, v[142:143] offset:38912
v_mfma_f32_16x16x16_bf16 v[150:153], v[112:113], v[94:95], v[150:153]
v_cvt_pk_bf16_f32 v154, v154, v155
v_mul_f32_e64 v158, v158, v168
v_cvt_pk_bf16_f32 v155, v156, v157
v_mfma_f32_16x16x16_bf16 v[138:141], v[82:83], v[94:95], v[138:141]
v_mul_f32 v160, v160, v168
v_mul_f32 v162, v162, v168
v_cvt_pk_bf16_f32 v157, v160, v161
v_cvt_pk_bf16_f32 v156, v158, v159
v_mfma_f32_16x16x32_bf16 v[142:145], v[96:99], v[90:93], 0
ds_write_b128 v211, v[154:157] offset:45056
v_mfma_f32_16x16x16_bf16 v[142:145], v[100:101], v[94:95], v[142:145]
v_mul_f32 v163, v163, v168
v_mul_f32 v164, v164, v168
v_mul_f32_e64 v165, v165, v168
v_cvt_pk_bf16_f32 v159, v164, v165
v_cvt_pk_bf16_f32 v158, v162, v163
v_mfma_f32_16x16x32_bf16 v[146:149], v[102:105], v[90:93], 0
ds_write_b64 v212, v[158:159] offset:45056
v_mfma_f32_16x16x16_bf16 v[154:157], v[76:77], v[82:83], 0
v_exp_f32_e64 v141, v141
v_max3_u32 v218, v218, v166, v167
v_mfma_f32_16x16x16_bf16 v[146:149], v[106:107], v[94:95], v[146:149]
v_exp_f32 v143, v143
v_exp_f32 v144, v144
v_mfma_f32_16x16x16_bf16 v[158:161], v[76:77], v[100:101], 0
v_exp_f32 v145, v145
v_exp_f32 v140, v140
v_mfma_f32_16x16x16_bf16 v[166:169], v[76:77], v[112:113], v[206:209]
v_cvt_pk_bf16_f32 v175, v140, v141
v_exp_f32 v138, v138
v_mfma_f32_16x16x16_bf16 v[162:165], v[76:77], v[106:107], 0
v_exp_f32 v139, v139
v_exp_f32 v142, v142
v_mfma_f32_16x16x32_bf16 v[154:157], v[72:75], v[78:81], v[154:157]
s_waitcnt lgkmcnt(0)
v_cvt_pk_bf16_f32 v177, v144, v145
v_cvt_pk_bf16_f32 v174, v138, v139
v_mfma_f32_16x16x32_bf16 v[158:161], v[72:75], v[96:99], v[158:161]
s_barrier
ds_read_b128 v[220:223], v210 offset:38912
v_mfma_f32_16x16x32_bf16 v[166:169], v[72:75], v[108:111], v[166:169]
s_nop 0
ds_read_b128 v[110:113], v210 offset:39936
v_cvt_pk_bf16_f32 v176, v142, v143
v_mfma_f32_16x16x32_bf16 v[162:165], v[72:75], v[102:105], v[162:165]
v_exp_f32 v150, v150
v_mfma_f32_16x16x32_bf16 v[142:145], v[122:125], v[174:177], 0
v_cvt_pk_bf16_f32 v180, v150, 0
v_mfma_f32_16x16x32_bf16 v[138:141], v[114:117], v[174:177], 0
v_exp_f32 v149, v149
v_mfma_f32_16x16x32_bf16 v[150:153], v[190:193], v[174:177], 0
ds_read_b128 v[170:173], v210 offset:40960
s_waitcnt lgkmcnt(2)
v_mfma_f32_16x16x32_bf16 v[4:7], a[168:171], v[220:223], v[4:7]
v_mov_b32_dpp v154, v158 quad_perm:[0,1,2,3] row_mask:0x2 bank_mask:0xf
s_waitcnt lgkmcnt(1)
v_mfma_f32_16x16x32_bf16 v[4:7], a[172:175], v[110:113], v[4:7]
v_exp_f32 v147, v147
v_mfma_f32_16x16x32_bf16 v[8:11], a[192:195], v[220:223], v[8:11]
s_add_u32 s28, s38, s60
v_exp_f32 v146, v146
v_mfma_f32_16x16x32_bf16 v[8:11], a[196:199], v[110:113], v[8:11]
v_exp_f32 v148, v148
v_mfma_f32_16x16x32_bf16 v[0:3], a[144:147], v[220:223], v[0:3]
v_cvt_pk_bf16_f32 v179, v148, v149
v_cvt_pk_bf16_f32 v178, v146, v147
v_mfma_f32_16x16x32_bf16 v[0:3], a[148:151], v[110:113], v[0:3]
ds_read_b128 v[182:185], v210 offset:41984
ds_read_b128 v[110:113], v210 offset:45056
v_mfma_f32_16x16x32_bf16 v[150:153], v[190:193], v[178:181], v[150:153]
v_mov_b32_dpp v154, v162 quad_perm:[0,1,2,3] row_mask:0x4 bank_mask:0xf
v_mfma_f32_16x16x32_bf16 v[138:141], v[118:121], v[178:181], v[138:141]
ds_read_b128 v[220:223], v210 offset:44032
ds_read_b128 v[186:189], v210 offset:43008
v_mfma_f32_16x16x32_bf16 v[142:145], v[126:129], v[178:181], v[142:145]
v_rcp_f32 v151, v150
v_mfma_f32_16x16x32_bf16 v[146:149], v[130:133], v[174:177], 0
v_mul_f32 v152, s3, v151
v_mov_b32_dpp v154, v167 quad_perm:[0,1,2,3] row_mask:0x8 bank_mask:0xf
v_mfma_f32_16x16x32_bf16 v[146:149], v[134:137], v[178:181], v[146:149]
s_waitcnt lgkmcnt(4)
v_mul_f32 v139, v139, v152
v_mul_f32_e64 v140, v140, v152
v_mfma_f32_16x16x32_bf16 v[0:3], a[152:155], v[170:173], v[0:3]
s_waitcnt lgkmcnt(3)
v_mul_f32 v138, v138, v152
v_cvt_pk_bf16_f32 v138, v138, v139
v_mfma_f32_16x16x32_bf16 v[0:3], a[156:159], v[182:185], v[0:3]
v_mul_f32 v141, v141, v152
v_mul_f32 v142, v142, v152
v_mfma_f32_16x16x32_bf16 v[4:7], a[176:179], v[170:173], v[4:7]
v_exp_f32 v154, v154
v_mfma_f32_16x16x32_bf16 v[4:7], a[180:183], v[182:185], v[4:7]
v_mul_f32 v143, v143, v152
v_cvt_pk_bf16_f32 v154, v154, 0
v_mfma_f32_16x16x32_bf16 v[8:11], a[200:203], v[170:173], v[8:11]
v_cvt_pk_bf16_f32 v139, v140, v141
v_mul_f32 v145, v145, v152
v_mfma_f32_16x16x32_bf16 v[8:11], a[204:207], v[182:185], v[8:11]
s_waitcnt lgkmcnt(0)
v_cvt_pk_bf16_f32 v140, v142, v143
v_mul_f32_e64 v144, v144, v152
v_mfma_f32_16x16x32_bf16 v[8:11], a[208:211], v[186:189], v[8:11]
ds_read_b128 v[170:173], v210 offset:46080
v_cvt_pk_bf16_f32 v141, v144, v145
v_mfma_f32_16x16x32_bf16 v[8:11], a[212:215], v[220:223], v[8:11]
ds_write_b128 v211, v[138:141] offset:51200
v_mfma_f32_16x16x32_bf16 v[0:3], a[160:163], v[186:189], v[0:3]
v_mul_f32 v148, v148, v152
v_mul_f32 v149, v149, v152
v_mfma_f32_16x16x32_bf16 v[0:3], a[164:167], v[220:223], v[0:3]
v_cvt_pk_bf16_f32 v8, v8, v9
v_mfma_f32_16x16x32_bf16 v[4:7], a[184:187], v[186:189], v[4:7]
ds_write_b16 v214, v154
v_mfma_f32_16x16x32_bf16 v[4:7], a[188:191], v[220:223], v[4:7]
s_nop 0
ds_read_b128 v[182:185], v210 offset:47104
v_cvt_pk_bf16_f32 v9, v10, v11
v_mfma_f32_16x16x32_bf16 v[12:15], a[144:147], v[110:113], v[12:15]
s_waitcnt lgkmcnt(3)
ds_read_b128 v[186:189], v210 offset:48128
ds_read_b128 v[220:223], v210 offset:49152
v_mfma_f32_16x16x32_bf16 v[12:15], a[148:151], v[170:173], v[12:15]
ds_read_b128 v[88:91], v215 offset:16
v_cvt_pk_bf16_f32 v0, v0, v1
v_mfma_f32_16x16x32_bf16 v[16:19], a[168:171], v[110:113], v[16:19]
v_cvt_pk_bf16_f32 v1, v2, v3
v_mul_f32_e64 v147, v147, v152
v_mfma_f32_16x16x32_bf16 v[16:19], a[172:175], v[170:173], v[16:19]
ds_write_b64 v203, v[8:9] offset:64
v_mfma_f32_16x16x32_bf16 v[20:23], a[192:195], v[110:113], v[20:23]
v_mul_f32 v146, v146, v152
v_cvt_pk_bf16_f32 v4, v4, v5
v_mfma_f32_16x16x32_bf16 v[20:23], a[196:199], v[170:173], v[20:23]
s_waitcnt lgkmcnt(4)
ds_read_b128 v[110:113], v210 offset:50176
v_cvt_pk_bf16_f32 v5, v6, v7
v_mfma_f32_16x16x32_bf16 v[20:23], a[200:203], v[182:185], v[20:23]
s_waitcnt lgkmcnt(4)
ds_write_b64 v203, v[0:1]
v_mfma_f32_16x16x32_bf16 v[20:23], a[204:207], v[186:189], v[20:23]
v_cvt_pk_bf16_f32 v143, v148, v149
v_mfma_f32_16x16x32_bf16 v[12:15], a[152:155], v[182:185], v[12:15]
ds_read_b128 v[84:87], v215
v_mfma_f32_16x16x32_bf16 v[12:15], a[156:159], v[186:189], v[12:15]
s_waitcnt lgkmcnt(5)
ds_write_b64 v203, v[4:5] offset:32
v_mfma_f32_16x16x32_bf16 v[12:15], a[160:163], v[220:223], v[12:15]
s_nop 0
v_cvt_pk_bf16_f32 v142, v146, v147
s_waitcnt lgkmcnt(3)
v_mfma_f32_16x16x32_bf16 v[12:15], a[164:167], v[110:113], v[12:15]
ds_write_b64 v212, v[142:143] offset:51200
v_mfma_f32_16x16x32_bf16 v[20:23], a[208:211], v[220:223], v[20:23]
v_mfma_f32_16x16x32_bf16 v[20:23], a[212:215], v[110:113], v[20:23]
v_cvt_pk_bf16_f32 v12, v12, v13
v_mfma_f32_16x16x32_bf16 v[16:19], a[176:179], v[182:185], v[16:19]
v_cvt_pk_bf16_f32 v13, v14, v15
v_add_u32 v205, 1424, v205
v_mfma_f32_16x16x32_bf16 v[16:19], a[180:183], v[186:189], v[16:19]
ds_write_b64 v203, v[12:13] offset:6272
v_mfma_f32_16x16x32_bf16 v[16:19], a[184:187], v[220:223], v[16:19]
s_waitcnt vmcnt(0) lgkmcnt(1)
v_mfma_f32_16x16x32_bf16 v[16:19], a[188:191], v[110:113], v[16:19]
s_barrier
v_mfma_f32_16x16x32_bf16 v[158:161], v[84:87], v[122:125], 0
ds_read_b128 v[178:181], v217 offset:528
v_mfma_f32_16x16x32_bf16 v[158:161], v[88:91], v[126:129], v[158:161]
ds_read_b128 v[170:173], v210 offset:51200
ds_read_b128 v[182:185], v210 offset:52224
v_mfma_f32_16x16x32_bf16 v[154:157], v[84:87], v[114:117], 0
ds_read_b128 v[220:223], v210 offset:54272
v_mfma_f32_16x16x32_bf16 v[154:157], v[88:91], v[118:121], v[154:157]
ds_read_b128 v[186:189], v210 offset:53248
ds_read_b128 v[110:113], v210 offset:55296
v_mfma_f32_16x16x32_bf16 v[162:165], v[84:87], v[130:133], 0
ds_read_b64 v[120:121], v204
v_mfma_f32_16x16x32_bf16 v[162:165], v[88:91], v[134:137], v[162:165]
v_mov_b32_dpp v154, v158 quad_perm:[0,1,2,3] row_mask:0x2 bank_mask:0xf
v_max3_u32 v218, v218, v150, v151
v_mfma_f32_16x16x32_bf16 v[166:169], v[84:87], v[190:193], 0
s_nop 0
ds_read_b128 v[84:87], v200
v_add_u32 v215, 1424, v215
v_mfma_f32_16x16x32_bf16 v[166:169], v[88:91], v[190:193], v[166:169]
s_waitcnt lgkmcnt(6)
ds_read_b128 v[92:95], v201
ds_read_b128 v[174:177], v217
v_mfma_f32_16x16x32_bf16 v[24:27], a[144:147], v[170:173], v[24:27]
s_nop 0
v_cvt_pk_bf16_f32 v16, v16, v17
s_waitcnt lgkmcnt(7)
v_mfma_f32_16x16x32_bf16 v[24:27], a[148:151], v[182:185], v[24:27]
v_mfma_f32_16x16x32_bf16 v[28:31], a[168:171], v[170:173], v[28:31]
ds_read_b128 v[100:103], v202
ds_read_b128 v[96:99], v195 offset:16
v_mfma_f32_16x16x32_bf16 v[28:31], a[172:175], v[182:185], v[28:31]
v_mfma_f32_16x16x32_bf16 v[32:35], a[192:195], v[170:173], v[32:35]
v_rcp_f32_e64 v167, v166
v_mfma_f32_16x16x32_bf16 v[32:35], a[196:199], v[182:185], v[32:35]
s_waitcnt lgkmcnt(7)
ds_read_b128 v[170:173], v210 offset:56320
v_cvt_pk_bf16_f32 v20, v20, v21
v_mfma_f32_16x16x32_bf16 v[32:35], a[200:203], v[186:189], v[32:35]
s_waitcnt lgkmcnt(3)
v_cvt_pk_bf16_f32 v21, v22, v23
v_cvt_pk_bf16_f32 v17, v18, v19
v_mfma_f32_16x16x32_bf16 v[12:15], v[174:177], v[92:95], 0
ds_read_b128 v[92:95], v195
ds_read_b128 v[182:185], v210 offset:20480
v_mfma_f32_16x16x32_bf16 v[0:3], v[174:177], v[84:87], 0
ds_write_b64 v203, v[16:17] offset:6304
v_mfma_f32_16x16x32_bf16 v[24:27], a[152:155], v[186:189], v[24:27]
v_mfma_f32_16x16x32_bf16 v[24:27], a[156:159], v[220:223], v[24:27]
ds_read_b128 v[104:107], v196 offset:16
v_mul_f32 v168, s3, v167
v_mfma_f32_16x16x32_bf16 v[24:27], a[160:163], v[110:113], v[24:27]
s_waitcnt lgkmcnt(4)
ds_read_b128 v[84:87], v194
ds_read_b128 v[88:91], v194 offset:16
v_mfma_f32_16x16x32_bf16 v[24:27], a[164:167], v[170:173], v[24:27]
ds_write_b64 v203, v[20:21] offset:6336
v_mfma_f32_16x16x32_bf16 v[28:31], a[176:179], v[186:189], v[28:31]
buffer_store_dwordx2 v[120:121], v204, s[8:11], s28 offen sc1
ds_read_b128 v[186:189], v210 offset:21504
v_mfma_f32_16x16x32_bf16 v[28:31], a[180:183], v[220:223], v[28:31]
v_cvt_pk_bf16_f32 v24, v24, v25
v_cvt_pk_bf16_f32 v25, v26, v27
v_mfma_f32_16x16x32_bf16 v[28:31], a[184:187], v[110:113], v[28:31]
ds_write_b64 v203, v[24:25] offset:12544
v_mfma_f32_16x16x32_bf16 v[28:31], a[188:191], v[170:173], v[28:31]
v_max3_u32 v218, v218, v166, v167
v_mfma_f32_16x16x32_bf16 v[24:27], v[174:177], v[100:103], 0
s_waitcnt lgkmcnt(8)
ds_read_b128 v[100:103], v196
v_mov_b32_dpp v154, v162 quad_perm:[0,1,2,3] row_mask:0x4 bank_mask:0xf
v_smfmac_f32_16x16x64_bf16 v[12:15], v[178:181], v[92:99], v213
s_waitcnt lgkmcnt(4)
ds_read_b128 v[92:95], v198
ds_read_b64 v[128:129], v204 offset:392
v_smfmac_f32_16x16x64_bf16 v[0:3], v[178:181], v[84:91], v213
ds_read_b128 v[174:177], v217 offset:1056
ds_read_b128 v[84:87], v197
v_mfma_f32_16x16x32_bf16 v[32:35], a[204:207], v[220:223], v[32:35]
ds_read_b128 v[88:91], v197 offset:16
v_cvt_pk_bf16_f32 v28, v28, v29
v_mfma_f32_16x16x32_bf16 v[32:35], a[208:211], v[110:113], v[32:35]
ds_read_b128 v[96:99], v198 offset:16
v_mfma_f32_16x16x32_bf16 v[32:35], a[212:215], v[170:173], v[32:35]
s_nop 0
v_cvt_pk_bf16_f32 v29, v30, v31
s_waitcnt lgkmcnt(6)
v_smfmac_f32_16x16x64_bf16 v[24:27], v[178:181], v[100:107], v213
ds_read_b128 v[100:103], v199
v_mul_f32 v154, v154, v168
v_mfma_f32_16x16x32_bf16 v[162:165], v[182:185], a[72:75], 0
s_waitcnt lgkmcnt(5)
buffer_store_dwordx2 v[128:129], v204, s[8:11], s29 offen sc1
v_cvt_pk_bf16_f32 v154, v154, 0
v_cvt_pk_bf16_f32 v32, v32, v33
v_mfma_f32_16x16x32_bf16 v[162:165], v[186:189], a[76:79], v[162:165]
ds_read_b128 v[104:107], v199 offset:16
ds_read_b128 v[220:223], v210 offset:23552
v_mfma_f32_16x16x32_bf16 v[166:169], v[182:185], a[96:99], 0
ds_write_b64 v203, v[28:29] offset:12576
v_mfma_f32_16x16x32_bf16 v[166:169], v[186:189], a[100:103], v[166:169]
s_nop 0
v_mfma_f32_16x16x32_bf16 v[170:173], v[182:185], a[120:123], 0
s_waitcnt lgkmcnt(5)
ds_write_b16 v214, v154
v_smfmac_f32_16x16x64_bf16 v[0:3], v[174:177], v[84:91], v213
ds_read_b128 v[178:181], v217 offset:1584
s_waitcnt lgkmcnt(6)
v_smfmac_f32_16x16x64_bf16 v[12:15], v[174:177], v[92:99], v213
s_waitcnt lgkmcnt(4)
ds_read_b128 v[92:95], v201 offset:32
ds_read_b128 v[84:87], v200 offset:32
v_smfmac_f32_16x16x64_bf16 v[24:27], v[174:177], v[100:107], v213
ds_read_b128 v[100:103], v202 offset:32
ds_read_b128 v[104:107], v196 offset:48
v_mfma_f32_16x16x32_bf16 v[138:141], a[0:3], v[182:185], 0
v_mul_f32 v119, v0, v0
v_fmac_f32 v119, v1, v1
v_mfma_f32_16x16x32_bf16 v[138:141], a[4:7], v[186:189], v[138:141]
ds_read_b128 v[96:99], v195 offset:48
ds_read_b128 v[110:113], v210 offset:22528
v_mfma_f32_16x16x32_bf16 v[142:145], a[24:27], v[182:185], 0
v_mul_f32 v127, v12, v12
v_add_f32 v118, v0, v1
v_mfma_f32_16x16x32_bf16 v[142:145], a[28:31], v[186:189], v[142:145]
ds_read_b128 v[88:91], v194 offset:48
v_add_f32_e64 v126, v12, v13
v_mfma_f32_16x16x32_bf16 v[146:149], a[48:51], v[182:185], 0
v_fmac_f32_e64 v119, v2, v2
v_add_f32 v118, v118, v2
v_mfma_f32_16x16x32_bf16 v[146:149], a[52:55], v[186:189], v[146:149]
s_waitcnt lgkmcnt(5)
ds_read_b128 v[174:177], v217 offset:2112
v_fmac_f32_e64 v119, v3, v3
v_mfma_f32_16x16x32_bf16 v[4:7], v[178:181], v[84:87], 0
s_nop 0
ds_read_b128 v[84:87], v194 offset:32
s_waitcnt lgkmcnt(6)
v_mfma_f32_16x16x32_bf16 v[28:31], v[178:181], v[100:103], 0
v_mul_f32 v135, v24, v24
v_fmac_f32 v127, v13, v13
v_mfma_f32_16x16x32_bf16 v[16:19], v[178:181], v[92:95], 0
ds_read_b128 v[92:95], v195 offset:32
v_fmac_f32_e64 v127, v14, v14
v_mfma_f32_16x16x32_bf16 v[158:161], v[232:235], v[182:185], 0
ds_read_b128 v[100:103], v196 offset:32
ds_read_b128 v[178:181], v217 offset:2640
v_mfma_f32_16x16x32_bf16 v[158:161], v[236:239], v[186:189], v[158:161]
v_cvt_pk_bf16_f32 v33, v34, v35
v_add_u32 v214, 1424, v214
v_mfma_f32_16x16x32_bf16 v[154:157], a[240:243], v[182:185], 0
ds_write_b64 v203, v[32:33] offset:12608
v_mfma_f32_16x16x32_bf16 v[154:157], a[244:247], v[186:189], v[154:157]
v_add_f32_e64 v126, v126, v14
s_waitcnt lgkmcnt(4)
v_smfmac_f32_16x16x64_bf16 v[4:7], v[174:177], v[84:91], v213
s_waitcnt lgkmcnt(3)
ds_read_b128 v[88:91], v197 offset:48
v_add_f32 v134, v24, v25
v_smfmac_f32_16x16x64_bf16 v[16:19], v[174:177], v[92:99], v213
s_waitcnt lgkmcnt(3)
ds_read_b128 v[84:87], v197 offset:32
v_add_f32_e64 v134, v134, v26
v_smfmac_f32_16x16x64_bf16 v[28:31], v[174:177], v[100:107], v213
ds_read_b128 v[92:95], v198 offset:32
v_fmac_f32_e64 v135, v25, v25
v_mfma_f32_16x16x32_bf16 v[150:153], a[216:219], v[182:185], 0
ds_read_b128 v[96:99], v198 offset:48
ds_read_b128 v[104:107], v199 offset:48
v_mfma_f32_16x16x32_bf16 v[150:153], a[220:223], v[186:189], v[150:153]
ds_read_b128 v[100:103], v199 offset:32
v_fmac_f32_e64 v135, v26, v26
v_mfma_f32_16x16x32_bf16 v[150:153], a[224:227], v[110:113], v[150:153]
v_add_f32 v126, v126, v15
v_fmac_f32 v135, v27, v27
v_mfma_f32_16x16x32_bf16 v[150:153], a[228:231], v[220:223], v[150:153]
v_add_f32 v118, v118, v3
s_waitcnt lgkmcnt(4)
v_smfmac_f32_16x16x64_bf16 v[4:7], v[178:181], v[84:91], v213
ds_read_b128 v[84:87], v200 offset:64
ds_read_b128 v[182:185], v210 offset:24576
v_mfma_f32_16x16x32_bf16 v[170:173], v[186:189], a[124:127], v[170:173]
s_add_u32 s29, s38, s63
ds_read_b128 v[174:177], v217 offset:3168
s_waitcnt lgkmcnt(5)
v_smfmac_f32_16x16x64_bf16 v[16:19], v[178:181], v[92:99], v213
ds_read_b128 v[92:95], v201 offset:64
v_add_f32_e64 v118, v118, v4
v_mfma_f32_16x16x32_bf16 v[162:165], v[110:113], a[80:83], v[162:165]
v_fmac_f32 v119, v4, v4
s_waitcnt lgkmcnt(4)
v_smfmac_f32_16x16x64_bf16 v[28:31], v[178:181], v[100:107], v213
ds_read_b128 v[100:103], v202 offset:64
v_fmac_f32_e64 v119, v5, v5
v_mfma_f32_16x16x32_bf16 v[158:161], v[240:243], v[110:113], v[158:161]
ds_read_b128 v[88:91], v194 offset:80
ds_read_b128 v[178:181], v217 offset:3696
v_mfma_f32_16x16x32_bf16 v[158:161], v[244:247], v[220:223], v[158:161]
s_add_u32 s28, s38, s62
v_add_f32 v118, v118, v5
v_add_f32_e64 v134, v134, v27
v_mfma_f32_16x16x32_bf16 v[138:141], a[8:11], v[110:113], v[138:141]
ds_read_b64 v[136:137], v204 offset:784
v_fmac_f32 v135, v28, v28
v_mfma_f32_16x16x32_bf16 v[138:141], a[12:15], v[220:223], v[138:141]
s_waitcnt lgkmcnt(5)
ds_read_b64 v[120:121], v204 offset:1176
ds_read_b128 v[96:99], v195 offset:80
v_mfma_f32_16x16x32_bf16 v[8:11], v[174:177], v[84:87], 0
s_waitcnt lgkmcnt(6)
ds_read_b128 v[84:87], v194 offset:64
v_fmac_f32 v127, v15, v15
v_mfma_f32_16x16x32_bf16 v[20:23], v[174:177], v[92:95], 0
s_nop 0
ds_read_b128 v[92:95], v195 offset:64
s_waitcnt lgkmcnt(7)
v_mfma_f32_16x16x32_bf16 v[32:35], v[174:177], v[100:103], 0
v_add_f32 v134, v134, v28
v_fmac_f32 v127, v16, v16
v_mfma_f32_16x16x32_bf16 v[146:149], a[56:59], v[110:113], v[146:149]
ds_read_b128 v[104:107], v196 offset:80
v_add_f32_e64 v118, v118, v6
v_mfma_f32_16x16x32_bf16 v[146:149], a[60:63], v[220:223], v[146:149]
ds_read_b128 v[100:103], v196 offset:64
v_add_f32_e64 v126, v126, v16
v_mfma_f32_16x16x32_bf16 v[142:145], a[32:35], v[110:113], v[142:145]
ds_read_b128 v[174:177], v217 offset:4224
v_fmac_f32_e64 v119, v6, v6
v_mfma_f32_16x16x32_bf16 v[142:145], a[36:39], v[220:223], v[142:145]
s_waitcnt lgkmcnt(4)
v_add_f32 v118, v118, v7
v_fmac_f32 v127, v17, v17
v_smfmac_f32_16x16x64_bf16 v[8:11], v[178:181], v[84:91], v213
s_waitcnt lgkmcnt(3)
ds_read_b128 v[88:91], v197 offset:80
ds_read_b128 v[84:87], v197 offset:64
v_smfmac_f32_16x16x64_bf16 v[20:23], v[178:181], v[92:99], v213
ds_read_b128 v[96:99], v198 offset:80
v_add_f32_e64 v126, v126, v17
v_mfma_f32_16x16x32_bf16 v[170:173], v[110:113], a[128:131], v[170:173]
ds_read_b128 v[92:95], v198 offset:64
v_fmac_f32_e64 v135, v29, v29
v_mfma_f32_16x16x32_bf16 v[170:173], v[220:223], a[132:135], v[170:173]
s_waitcnt lgkmcnt(5)
v_add_f32 v134, v134, v29
v_fmac_f32_e64 v135, v30, v30
v_smfmac_f32_16x16x64_bf16 v[32:35], v[178:181], v[100:107], v213
ds_read_b128 v[104:107], v199 offset:80
ds_read_b128 v[100:103], v199 offset:64
v_mfma_f32_16x16x32_bf16 v[154:157], a[248:251], v[110:113], v[154:157]
buffer_store_dwordx2 v[136:137], v204, s[8:11], s28 offen sc1
v_fmac_f32 v135, v31, v31
v_add_f32 v126, v126, v18
v_mfma_f32_16x16x32_bf16 v[154:157], a[252:255], v[220:223], v[154:157]
s_waitcnt lgkmcnt(4)
v_add_f32 v126, v126, v19
v_add_f32_e64 v134, v134, v30
v_smfmac_f32_16x16x64_bf16 v[8:11], v[174:177], v[84:91], v213
ds_read_b128 v[186:189], v210 offset:25600
v_fmac_f32_e64 v127, v18, v18
v_mfma_f32_16x16x32_bf16 v[166:169], v[110:113], a[104:107], v[166:169]
s_waitcnt lgkmcnt(3)
v_add_f32 v134, v134, v31
v_fmac_f32_e64 v127, v19, v19
v_smfmac_f32_16x16x64_bf16 v[20:23], v[174:177], v[92:99], v213
buffer_store_dwordx2 v[120:121], v204, s[8:11], s29 offen sc1
v_add_f32 v118, v118, v8
v_fmac_f32 v119, v7, v7
v_mfma_f32_16x16x32_bf16 v[166:169], v[220:223], a[108:111], v[166:169]
s_waitcnt lgkmcnt(1)
v_add_f32 v118, v118, v9
v_fmac_f32_e64 v119, v8, v8
v_smfmac_f32_16x16x64_bf16 v[32:35], v[174:177], v[100:107], v213
ds_read_b128 v[110:113], v210 offset:26624
v_fmac_f32_e64 v119, v9, v9
v_mfma_f32_16x16x32_bf16 v[162:165], v[220:223], a[84:87], v[162:165]
v_add_f32 v126, v126, v20
v_add_f32 v126, v126, v21
v_mfma_f32_16x16x32_bf16 v[138:141], a[16:19], v[182:185], v[138:141]
s_waitcnt lgkmcnt(1)
v_fmac_f32 v135, v32, v32
v_fmac_f32_e64 v135, v33, v33
v_mfma_f32_16x16x32_bf16 v[138:141], a[20:23], v[186:189], v[138:141]
v_add_f32 v126, v126, v22
v_add_f32 v118, v118, v10
v_mfma_f32_16x16x32_bf16 v[142:145], a[40:43], v[182:185], v[142:145]
v_add_f32 v134, v134, v32
v_fmac_f32 v127, v20, v20
v_mfma_f32_16x16x32_bf16 v[142:145], a[44:47], v[186:189], v[142:145]
v_fmac_f32 v119, v10, v10
v_fmac_f32 v135, v34, v34
v_mfma_f32_16x16x32_bf16 v[146:149], a[64:67], v[182:185], v[146:149]
s_add_u32 s28, s38, s64
v_add_f32 v134, v134, v33
v_fmac_f32_e64 v127, v21, v21
v_mfma_f32_16x16x32_bf16 v[146:149], a[68:71], v[186:189], v[146:149]
v_fmac_f32 v127, v22, v22
v_add_f32 v126, v126, v23
v_mfma_f32_16x16x32_bf16 v[150:153], a[232:235], v[182:185], v[150:153]
v_cvt_pk_bf16_f32 v80, v142, v143
v_fmac_f32_e64 v135, v35, v35
v_mfma_f32_16x16x32_bf16 v[150:153], a[236:239], v[186:189], v[150:153]
v_add_f32 v134, v134, v34
v_fmac_f32 v119, v11, v11
v_mfma_f32_16x16x32_bf16 v[154:157], v[224:227], v[182:185], v[154:157]
v_add_f32_e64 v118, v118, v11
v_cvt_pk_bf16_f32 v83, v148, v149
v_mfma_f32_16x16x32_bf16 v[154:157], v[228:231], v[186:189], v[154:157]
v_add_f32_e64 v134, v134, v35
v_cvt_pk_bf16_f32 v78, v138, v139
v_mfma_f32_16x16x32_bf16 v[158:161], v[248:251], v[182:185], v[158:161]
ds_read_b128 v[220:223], v210 offset:27648
v_cvt_pk_bf16_f32 v82, v146, v147
v_mfma_f32_16x16x32_bf16 v[158:161], v[252:255], v[186:189], v[158:161]
v_fmac_f32_e64 v127, v23, v23
v_cvt_pk_bf16_f32 v75, v156, v157
v_mfma_f32_16x16x32_bf16 v[162:165], v[182:185], a[88:91], v[162:165]
v_cvt_pk_bf16_f32 v79, v140, v141
v_cvt_pk_bf16_f32 v72, v150, v151
v_mfma_f32_16x16x32_bf16 v[162:165], v[186:189], a[92:95], v[162:165]
v_permlane16_swap_b32 v134, v135
v_mfma_f32_16x16x32_bf16 v[166:169], v[182:185], a[112:115], v[166:169]
v_permlane16_swap_b32 v126, v127
v_mfma_f32_16x16x32_bf16 v[166:169], v[186:189], a[116:119], v[166:169]
v_permlane16_swap_b32 v118, v119
v_mfma_f32_16x16x32_bf16 v[170:173], v[182:185], a[136:139], v[170:173]
ds_read_b128 v[182:185], v210 offset:28672
v_cvt_pk_bf16_f32 v81, v144, v145
v_mfma_f32_16x16x32_bf16 v[170:173], v[186:189], a[140:143], v[170:173]
s_waitcnt lgkmcnt(2)
ds_read_b128 v[186:189], v210 offset:29696
v_add_f32_e64 v118, v118, v119
v_mfma_f32_16x16x32_bf16 v[138:141], a[0:3], v[110:113], 0
s_waitcnt lgkmcnt(2)
v_add_f32 v126, v126, v127
v_add_f32_e64 v134, v134, v135
v_mfma_f32_16x16x32_bf16 v[138:141], a[4:7], v[220:223], v[138:141]
v_permlane32_swap_b32 v118, v126
v_mfma_f32_16x16x32_bf16 v[142:145], a[24:27], v[110:113], 0
v_add_f32 v118, v118, v126
v_mov_b32_e64 v135, v134
v_mfma_f32_16x16x32_bf16 v[142:145], a[28:31], v[220:223], v[142:145]
ds_write_b32 v209, v118
v_mfma_f32_16x16x32_bf16 v[146:149], a[48:51], v[110:113], 0
v_permlane32_swap_b32 v134, v135
v_mfma_f32_16x16x32_bf16 v[146:149], a[52:55], v[220:223], v[146:149]
s_waitcnt lgkmcnt(2)
v_cvt_pk_bf16_f32 v73, v152, v153
v_add_f32 v134, v134, v135
v_mfma_f32_16x16x32_bf16 v[146:149], a[56:59], v[182:185], v[146:149]
s_waitcnt lgkmcnt(1)
ds_write_b32 v209, v134 offset:512
v_mfma_f32_16x16x32_bf16 v[146:149], a[60:63], v[186:189], v[146:149]
v_cvt_pk_bf16_f32 v74, v154, v155
v_cvt_pk_bf16_f32 v122, v166, v167
v_mfma_f32_16x16x32_bf16 v[150:153], a[216:219], v[110:113], 0
v_cvt_pk_bf16_f32 v77, v160, v161
v_cvt_pk_bf16_f32 v123, v168, v169
v_mfma_f32_16x16x32_bf16 v[150:153], a[220:223], v[220:223], v[150:153]
v_cvt_pk_bf16_f32 v114, v162, v163
v_cvt_pk_bf16_f32 v76, v158, v159
v_mfma_f32_16x16x32_bf16 v[154:157], a[240:243], v[110:113], 0
v_cvt_pk_bf16_f32 v130, v170, v171
v_mfma_f32_16x16x32_bf16 v[154:157], a[244:247], v[220:223], v[154:157]
s_waitcnt lgkmcnt(0)
v_mfma_f32_16x16x32_bf16 v[158:161], v[232:235], v[110:113], 0
s_barrier
v_mfma_f32_16x16x32_bf16 v[158:161], v[236:239], v[220:223], v[158:161]
ds_read_b128 v[102:105], v210 offset:18432
ds_read_b128 v[106:109], v210 offset:19456
v_mfma_f32_16x16x32_bf16 v[166:169], v[110:113], a[96:99], 0
v_cvt_pk_bf16_f32 v131, v172, v173
v_cvt_pk_bf16_f32 v115, v164, v165
v_mfma_f32_16x16x32_bf16 v[166:169], v[220:223], a[100:103], v[166:169]
v_mfma_f32_16x16x32_bf16 v[162:165], v[110:113], a[72:75], 0
ds_read_b64 v[128:129], v204 offset:6272
v_mfma_f32_16x16x32_bf16 v[162:165], v[220:223], a[76:79], v[162:165]
s_nop 0
ds_read_b64 v[136:137], v204 offset:6664
v_mfma_f32_16x16x32_bf16 v[170:173], v[110:113], a[120:123], 0
s_add_u32 s29, s38, s65
ds_read_b64 v[120:121], v204 offset:7056
ds_read_b128 v[110:113], v210 offset:30720
v_mfma_f32_16x16x32_bf16 v[170:173], v[220:223], a[124:127], v[170:173]
s_waitcnt lgkmcnt(5)
v_add_f32 v102, v102, v103
v_mfma_f32_16x16x32_bf16 v[138:141], a[8:11], v[182:185], v[138:141]
s_mov_b32 s30, 65537
s_waitcnt lgkmcnt(3)
buffer_store_dwordx2 v[128:129], v204, s[8:11], s28 offen sc1
v_add_f32 v106, v106, v107
v_mfma_f32_16x16x32_bf16 v[138:141], a[12:15], v[186:189], v[138:141]
s_add_u32 s28, s38, s66
v_add_f32 v104, v104, v105
v_add_f32_e64 v108, v108, v109
v_mfma_f32_16x16x32_bf16 v[142:145], a[32:35], v[182:185], v[142:145]
s_mov_b32 s31, 65537
ds_read_b64 v[128:129], v204 offset:7448
v_add_f32_e64 v102, v102, v104
v_mfma_f32_16x16x32_bf16 v[142:145], a[36:39], v[186:189], v[142:145]
s_add_u32 s41, s33, 0
v_add_f32 v106, v106, v108
v_mul_f32_e64 v103, s48, v102
v_mfma_f32_16x16x32_bf16 v[150:153], a[224:227], v[182:185], v[150:153]
s_mov_b32 s42, 58835169
v_mul_f32 v104, s73, v102
v_mul_f32 v106, s73, v106
v_mfma_f32_16x16x32_bf16 v[150:153], a[228:231], v[186:189], v[150:153]
v_fma_f32 v106, -v103, v104, v106
v_max_f32_e64 v106, 0, v106
v_mfma_f32_16x16x32_bf16 v[154:157], a[248:251], v[182:185], v[154:157]
v_add_f32 v106, s49, v106
v_mfma_f32_16x16x32_bf16 v[154:157], a[252:255], v[186:189], v[154:157]
v_rsq_f32 v102, v106
v_mfma_f32_16x16x32_bf16 v[158:161], v[240:243], v[182:185], v[158:161]
ds_read_b128 v[106:109], v210 offset:31744
v_mul_f32_e64 v103, -v103, v102
v_mfma_f32_16x16x32_bf16 v[158:161], v[244:247], v[186:189], v[158:161]
ds_write_b64 v211, v[102:103]
v_mfma_f32_16x16x32_bf16 v[162:165], v[182:185], a[80:83], v[162:165]
s_waitcnt lgkmcnt(5)
buffer_store_dwordx2 v[136:137], v204, s[8:11], s29 offen sc1
ds_read_b64 v[136:137], v204 offset:12544
v_mfma_f32_16x16x32_bf16 v[162:165], v[186:189], a[84:87], v[162:165]
s_add_u32 s29, s38, s67
ds_read_b64 v[118:119], v219
ds_read_b64 v[126:127], v219 offset:256
v_mfma_f32_16x16x32_bf16 v[166:169], v[182:185], a[104:107], v[166:169]
ds_read_b64 v[134:135], v219 offset:512
v_mfma_f32_16x16x32_bf16 v[166:169], v[186:189], a[108:111], v[166:169]
s_waitcnt lgkmcnt(8)
buffer_store_dwordx2 v[120:121], v204, s[8:11], s28 offen sc1
ds_read_b64 v[120:121], v204 offset:12936
v_mfma_f32_16x16x32_bf16 v[170:173], v[182:185], a[128:131], v[170:173]
s_add_u32 s28, s38, s68
ds_read_b128 v[182:185], v210 offset:32768
v_mfma_f32_16x16x32_bf16 v[170:173], v[186:189], a[132:135], v[170:173]
s_nop 0
ds_read_b128 v[186:189], v210 offset:33792
s_waitcnt lgkmcnt(10)
v_mfma_f32_16x16x32_bf16 v[138:141], a[16:19], v[110:113], v[138:141]
s_waitcnt lgkmcnt(5)
buffer_store_dwordx2 v[128:129], v204, s[8:11], s29 offen sc1
ds_read_b64 v[128:129], v204 offset:13328
v_mfma_f32_16x16x32_bf16 v[138:141], a[20:23], v[106:109], v[138:141]
s_add_u32 s29, s38, s69
v_fma_f32 v220, v0, v118, v119
v_fma_f32 v221, v1, v118, v119
v_mfma_f32_16x16x32_bf16 v[142:145], a[40:43], v[110:113], v[142:145]
v_fma_f32 v222, v2, v118, v119
v_fma_f32 v223, v3, v118, v119
v_mfma_f32_16x16x32_bf16 v[142:145], a[44:47], v[106:109], v[142:145]
s_nop 0
buffer_store_dwordx2 v[136:137], v204, s[8:11], s28 offen sc1
ds_read_b64 v[136:137], v204 offset:13720
v_mfma_f32_16x16x32_bf16 v[146:149], a[64:67], v[110:113], v[146:149]
s_add_u32 s28, s38, s70
v_cvt_pk_bf16_f32 v96, v138, v139
v_cvt_pk_bf16_f32 v97, v140, v141
v_mfma_f32_16x16x32_bf16 v[146:149], a[68:71], v[106:109], v[146:149]
s_nop 0
v_cvt_pk_bf16_f32 v98, v142, v143
v_cvt_pk_bf16_f32 v99, v144, v145
v_mfma_f32_16x16x32_bf16 v[150:153], a[232:235], v[110:113], v[150:153]
s_waitcnt lgkmcnt(4)
buffer_store_dwordx2 v[120:121], v204, s[8:11], s29 offen sc1
v_cvt_pk_bf16_f32 v90, v220, v221
v_mfma_f32_16x16x32_bf16 v[150:153], a[236:239], v[106:109], v[150:153]
s_add_u32 s29, s38, s71
v_cvt_pk_bf16_f32 v100, v146, v147
v_cvt_pk_bf16_f32 v101, v148, v149
v_mfma_f32_16x16x32_bf16 v[154:157], v[224:227], v[110:113], v[154:157]
s_mov_b32 s38, s36
v_cvt_pk_bf16_f32 v91, v222, v223
v_fma_f32 v220, v4, v118, v119
v_mfma_f32_16x16x32_bf16 v[154:157], v[228:231], v[106:109], v[154:157]
s_waitcnt lgkmcnt(1)
buffer_store_dwordx2 v[128:129], v204, s[8:11], s28 offen sc1
v_cvt_pk_bf16_f32 v84, v150, v151
v_mfma_f32_16x16x32_bf16 v[158:161], v[248:251], v[110:113], v[158:161]
s_add_u32 s28, s39, s60
v_cvt_pk_bf16_f32 v85, v152, v153
v_fma_f32 v221, v5, v118, v119
v_mfma_f32_16x16x32_bf16 v[158:161], v[252:255], v[106:109], v[158:161]
v_cvt_pk_bf16_f32 v86, v154, v155
v_cvt_pk_bf16_f32 v87, v156, v157
v_mfma_f32_16x16x32_bf16 v[162:165], v[110:113], a[88:91], v[162:165]
s_waitcnt lgkmcnt(0)
buffer_store_dwordx2 v[136:137], v204, s[8:11], s29 offen sc1
v_fma_f32 v222, v6, v118, v119
v_mfma_f32_16x16x32_bf16 v[162:165], v[106:109], a[92:95], v[162:165]
s_add_u32 s29, s39, s61
v_cvt_pk_bf16_f32 v88, v158, v159
v_cvt_pk_bf16_f32 v89, v160, v161
v_mfma_f32_16x16x32_bf16 v[166:169], v[110:113], a[112:115], v[166:169]
v_fma_f32 v223, v7, v118, v119
v_cvt_pk_bf16_f32 v92, v220, v221
v_mfma_f32_16x16x32_bf16 v[166:169], v[106:109], a[116:119], v[166:169]
v_cvt_pk_bf16_f32 v93, v222, v223
v_fma_f32 v220, v8, v118, v119
v_mfma_f32_16x16x32_bf16 v[170:173], v[110:113], a[136:139], v[170:173]
ds_read_b64 v[112:113], v215 offset:528
v_fma_f32 v221, v9, v118, v119
v_mfma_f32_16x16x32_bf16 v[170:173], v[106:109], a[140:143], v[170:173]
ds_read_b128 v[108:111], v215 offset:512
v_fma_f32 v222, v10, v118, v119
v_mfma_f32_16x16x32_bf16 v[138:141], a[0:3], v[182:185], 0
ds_write_b128 v211, v[90:93]
v_mfma_f32_16x16x32_bf16 v[138:141], a[4:7], v[186:189], v[138:141]
v_cvt_pk_bf16_f32 v132, v170, v171
v_cvt_pk_bf16_f32 v133, v172, v173
v_mfma_f32_16x16x32_bf16 v[142:145], a[24:27], v[182:185], 0
v_fma_f32 v223, v11, v118, v119
v_cvt_pk_bf16_f32 v94, v220, v221
v_mfma_f32_16x16x32_bf16 v[142:145], a[28:31], v[186:189], v[142:145]
ds_read_b128 v[170:173], v210 offset:34816
v_cvt_pk_bf16_f32 v95, v222, v223
v_mfma_f32_16x16x32_bf16 v[146:149], a[48:51], v[182:185], 0
s_nop 0
ds_read_b128 v[182:185], v210 offset:35840
v_fma_f32 v220, v12, v126, v127
v_mfma_f32_16x16x32_bf16 v[146:149], a[52:55], v[186:189], v[146:149]
s_waitcnt lgkmcnt(3)
ds_read_b128 v[186:189], v210 offset:36864
v_fma_f32 v221, v13, v126, v127
v_mfma_f32_16x16x32_bf16 v[150:153], v[108:111], v[72:75], v[206:209]
ds_write_b64 v212, v[94:95]
v_mfma_f32_16x16x16_bf16 v[154:157], v[82:83], v[88:89], 0
v_fma_f32 v222, v14, v126, v127
v_fma_f32 v223, v15, v126, v127
v_cvt_pk_bf16_f32 v174, v220, v221
v_mfma_f32_16x16x16_bf16 v[158:161], v[100:101], v[88:89], 0
v_cvt_pk_bf16_f32 v175, v222, v223
v_fma_f32 v220, v16, v126, v127
v_fma_f32 v221, v17, v126, v127
s_waitcnt lgkmcnt(3)
v_mfma_f32_16x16x32_bf16 v[138:141], a[8:11], v[170:173], v[138:141]
s_waitcnt lgkmcnt(2)
v_fma_f32 v222, v18, v126, v127
v_fma_f32 v223, v19, v126, v127
v_mfma_f32_16x16x32_bf16 v[138:141], a[12:15], v[182:185], v[138:141]
v_cvt_pk_bf16_f32 v176, v220, v221
v_cvt_pk_bf16_f32 v177, v222, v223
v_mfma_f32_16x16x32_bf16 v[142:145], a[32:35], v[170:173], v[142:145]
ds_write_b128 v211, v[174:177] offset:6144
v_mfma_f32_16x16x32_bf16 v[142:145], a[36:39], v[182:185], v[142:145]
v_fma_f32 v220, v20, v126, v127
v_fma_f32 v221, v21, v126, v127
v_mfma_f32_16x16x32_bf16 v[146:149], a[56:59], v[170:173], v[146:149]
v_fma_f32 v222, v22, v126, v127
v_fma_f32 v223, v23, v126, v127
v_mfma_f32_16x16x32_bf16 v[146:149], a[60:63], v[182:185], v[146:149]
ds_read_b128 v[182:185], v210 offset:32768
ds_read_b128 v[170:173], v210 offset:37888
v_mfma_f32_16x16x32_bf16 v[154:157], v[78:81], v[84:87], v[154:157]
ds_read_b128 v[174:177], v210 offset:34816
v_cvt_pk_bf16_f32 v124, v166, v167
v_mfma_f32_16x16x32_bf16 v[158:161], v[96:99], v[84:87], v[158:161]
s_nop 0
v_cvt_pk_bf16_f32 v125, v168, v169
v_cvt_pk_bf16_f32 v178, v220, v221
s_waitcnt lgkmcnt(5)
v_mfma_f32_16x16x16_bf16 v[166:169], v[112:113], v[88:89], v[206:209]
v_cvt_pk_bf16_f32 v179, v222, v223
v_fma_f32 v220, v24, v134, v135
v_fma_f32 v221, v25, v134, v135
v_mfma_f32_16x16x16_bf16 v[150:153], v[112:113], v[76:77], v[150:153]
v_fma_f32 v222, v26, v134, v135
v_fma_f32 v223, v27, v134, v135
v_cvt_pk_bf16_f32 v90, v220, v221
v_cvt_pk_bf16_f32 v91, v222, v223
v_mfma_f32_16x16x32_bf16 v[138:141], a[16:19], v[186:189], v[138:141]
s_waitcnt lgkmcnt(2)
ds_write_b64 v212, v[178:179] offset:6144
v_mfma_f32_16x16x32_bf16 v[118:121], v[182:185], a[72:75], 0
v_fma_f32 v220, v28, v134, v135
v_fma_f32 v221, v29, v134, v135
v_mfma_f32_16x16x32_bf16 v[126:129], v[182:185], a[96:99], 0
s_waitcnt lgkmcnt(2)
ds_read_b128 v[178:181], v210 offset:35840
v_fma_f32 v222, v30, v134, v135
v_mfma_f32_16x16x32_bf16 v[138:141], a[20:23], v[170:173], v[138:141]
v_fma_f32 v223, v31, v134, v135
v_cvt_pk_bf16_f32 v92, v220, v221
v_mfma_f32_16x16x32_bf16 v[166:169], v[108:111], v[84:87], v[166:169]
v_cvt_pk_bf16_f32 v93, v222, v223
v_fma_f32 v220, v32, v134, v135
v_mfma_f32_16x16x32_bf16 v[142:145], a[40:43], v[186:189], v[142:145]
v_cvt_pk_bf16_f32 v102, v138, v139
v_cvt_pk_bf16_f32 v103, v140, v141
v_mfma_f32_16x16x32_bf16 v[138:141], v[78:81], v[72:75], 0
ds_write_b128 v211, v[90:93] offset:12288
v_mfma_f32_16x16x16_bf16 v[138:141], v[82:83], v[76:77], v[138:141]
v_fma_f32 v221, v33, v134, v135
v_fma_f32 v222, v34, v134, v135
v_fma_f32 v223, v35, v134, v135
v_cvt_pk_bf16_f32 v116, v162, v163
v_mfma_f32_16x16x32_bf16 v[134:137], v[182:185], a[120:123], 0
v_cvt_pk_bf16_f32 v117, v164, v165
v_cvt_pk_bf16_f32 v94, v220, v221
v_mfma_f32_16x16x32_bf16 v[90:93], a[216:219], v[182:185], 0
v_exp_f32 v138, v138
v_mfma_f32_16x16x32_bf16 v[142:145], a[44:47], v[170:173], v[142:145]
v_exp_f32 v139, v139
v_mfma_f32_16x16x32_bf16 v[146:149], a[64:67], v[186:189], v[146:149]
ds_read_b128 v[186:189], v210 offset:33792
v_cvt_pk_bf16_f32 v95, v222, v223
v_mfma_f32_16x16x32_bf16 v[220:223], v[232:235], v[182:185], 0
v_cvt_pk_bf16_f32 v104, v142, v143
v_cvt_pk_bf16_f32 v105, v144, v145
v_mfma_f32_16x16x32_bf16 v[142:145], v[96:99], v[72:75], 0
v_exp_f32 v140, v140
v_mfma_f32_16x16x32_bf16 v[146:149], a[68:71], v[170:173], v[146:149]
v_exp_f32 v141, v141
v_mfma_f32_16x16x32_bf16 v[170:173], a[240:243], v[182:185], 0
ds_read_b128 v[182:185], v210 offset:36864
v_exp_f32_e64 v154, v154
v_mfma_f32_16x16x16_bf16 v[142:145], v[100:101], v[76:77], v[142:145]
v_cvt_pk_bf16_f32 v106, v146, v147
v_cvt_pk_bf16_f32 v107, v148, v149
v_exp_f32 v155, v155
v_mfma_f32_16x16x32_bf16 v[146:149], v[102:105], v[72:75], 0
s_waitcnt lgkmcnt(1)
v_exp_f32 v156, v156
v_mfma_f32_16x16x32_bf16 v[118:121], v[186:189], a[76:79], v[118:121]
v_exp_f32 v142, v142
v_mfma_f32_16x16x32_bf16 v[126:129], v[186:189], a[100:103], v[126:129]
v_exp_f32 v143, v143
v_mfma_f32_16x16x32_bf16 v[134:137], v[186:189], a[124:127], v[134:137]
v_exp_f32 v144, v144
v_mfma_f32_16x16x32_bf16 v[90:93], a[220:223], v[186:189], v[90:93]
v_exp_f32 v145, v145
v_mfma_f32_16x16x32_bf16 v[170:173], a[244:247], v[186:189], v[170:173]
v_exp_f32 v157, v157
v_mfma_f32_16x16x32_bf16 v[220:223], v[236:239], v[186:189], v[220:223]
ds_read_b128 v[186:189], v210 offset:37888
ds_read_b128 v[72:75], v215
v_mfma_f32_16x16x32_bf16 v[118:121], v[174:177], a[80:83], v[118:121]
v_exp_f32 v158, v158
v_mfma_f32_16x16x32_bf16 v[118:121], v[178:181], a[84:87], v[118:121]
v_exp_f32 v159, v159
v_mfma_f32_16x16x32_bf16 v[126:129], v[174:177], a[104:107], v[126:129]
v_exp_f32 v160, v160
v_mfma_f32_16x16x32_bf16 v[126:129], v[178:181], a[108:111], v[126:129]
v_exp_f32 v161, v161
v_mfma_f32_16x16x16_bf16 v[162:165], v[106:107], v[88:89], 0
v_exp_f32 v150, v150
v_exp_f32 v166, v166
v_mfma_f32_16x16x32_bf16 v[134:137], v[174:177], a[128:131], v[134:137]
ds_write_b64 v212, v[94:95] offset:12288
v_mfma_f32_16x16x32_bf16 v[134:137], v[178:181], a[132:135], v[134:137]
v_mfma_f32_16x16x32_bf16 v[90:93], a[224:227], v[174:177], v[90:93]
v_mfma_f32_16x16x32_bf16 v[90:93], a[228:231], v[178:181], v[90:93]
v_mfma_f32_16x16x32_bf16 v[170:173], a[248:251], v[174:177], v[170:173]
v_mfma_f32_16x16x32_bf16 v[170:173], a[252:255], v[178:181], v[170:173]
v_mfma_f32_16x16x32_bf16 v[220:223], v[240:243], v[174:177], v[220:223]
v_cvt_pk_bf16_f32 v174, v138, v139
v_cvt_pk_bf16_f32 v175, v140, v141
v_mfma_f32_16x16x32_bf16 v[220:223], v[244:247], v[178:181], v[220:223]
v_cvt_pk_bf16_f32 v176, v142, v143
v_cvt_pk_bf16_f32 v177, v144, v145
v_mfma_f32_16x16x32_bf16 v[162:165], v[102:105], v[84:87], v[162:165]
s_waitcnt lgkmcnt(3)
v_cvt_pk_bf16_f32 v180, v150, 0
v_mov_b32 v181, 0
v_mfma_f32_16x16x32_bf16 v[118:121], v[182:185], a[88:91], v[118:121]
s_waitcnt lgkmcnt(2)
v_mfma_f32_16x16x16_bf16 v[146:149], v[106:107], v[76:77], v[146:149]
v_exp_f32 v162, v162
v_exp_f32 v163, v163
v_mfma_f32_16x16x32_bf16 v[118:121], v[186:189], a[92:95], v[118:121]
v_exp_f32 v164, v164
v_mfma_f32_16x16x32_bf16 v[126:129], v[182:185], a[112:115], v[126:129]
v_exp_f32 v146, v146
v_mfma_f32_16x16x32_bf16 v[126:129], v[186:189], a[116:119], v[126:129]
v_exp_f32 v147, v147
v_mfma_f32_16x16x32_bf16 v[134:137], v[182:185], a[136:139], v[134:137]
v_exp_f32 v148, v148
v_mfma_f32_16x16x32_bf16 v[134:137], v[186:189], a[140:143], v[134:137]
v_exp_f32 v149, v149
v_mfma_f32_16x16x32_bf16 v[90:93], a[232:235], v[182:185], v[90:93]
v_exp_f32_e64 v165, v165
v_mfma_f32_16x16x32_bf16 v[90:93], a[236:239], v[186:189], v[90:93]
v_cvt_pk_bf16_f32 v178, v146, v147
v_cvt_pk_bf16_f32 v179, v148, v149
v_mfma_f32_16x16x32_bf16 v[170:173], v[224:227], v[182:185], v[170:173]
v_cvt_pk_bf16_f32 v118, v118, v119
v_cvt_pk_bf16_f32 v119, v120, v121
v_mfma_f32_16x16x32_bf16 v[170:173], v[228:231], v[186:189], v[170:173]
ds_read_u16 v120, v205
v_mov_b32_e64 v121, 0
v_mfma_f32_16x16x32_bf16 v[220:223], v[248:251], v[182:185], v[220:223]
v_cvt_pk_bf16_f32 v126, v126, v127
v_cvt_pk_bf16_f32 v127, v128, v129
v_mfma_f32_16x16x32_bf16 v[220:223], v[252:255], v[186:189], v[220:223]
ds_read_u16 v128, v205 offset:32
v_mov_b32_e64 v129, 0
v_mfma_f32_16x16x32_bf16 v[150:153], v[190:193], v[174:177], 0
v_cvt_pk_bf16_f32 v134, v134, v135
v_cvt_pk_bf16_f32 v135, v136, v137
v_mfma_f32_16x16x32_bf16 v[150:153], v[190:193], v[178:181], v[150:153]
s_nop 0
ds_read_u16 v136, v205 offset:64
v_cvt_pk_bf16_f32 v90, v90, v91
v_mfma_f32_16x16x32_bf16 v[138:141], v[114:117], v[174:177], 0
s_waitcnt lgkmcnt(2)
v_cvt_pk_bf16_f32 v91, v92, v93
v_cvt_pk_bf16_f32 v92, v170, v171
v_mfma_f32_16x16x32_bf16 v[138:141], v[118:121], v[178:181], v[138:141]
v_rcp_f32 v151, v150
v_mfma_f32_16x16x32_bf16 v[142:145], v[122:125], v[174:177], 0
s_waitcnt lgkmcnt(1)
v_mul_f32_e64 v152, s3, v151
v_cvt_pk_bf16_f32 v93, v172, v173
v_mfma_f32_16x16x32_bf16 v[142:145], v[126:129], v[178:181], v[142:145]
v_mul_f32 v138, v138, v152
v_mul_f32 v139, v139, v152
v_mfma_f32_16x16x32_bf16 v[146:149], v[130:133], v[174:177], 0
v_cvt_pk_bf16_f32 v174, v154, v155
v_cvt_pk_bf16_f32 v175, v156, v157
v_cvt_pk_bf16_f32 v176, v158, v159
v_cvt_pk_bf16_f32 v177, v160, v161
v_mul_f32 v140, v140, v152
v_mul_f32 v141, v141, v152
v_mfma_f32_16x16x32_bf16 v[154:157], v[114:117], v[174:177], 0
v_cvt_pk_bf16_f32 v138, v138, v139
v_mul_f32_e64 v142, v142, v152
v_mfma_f32_16x16x32_bf16 v[158:161], v[122:125], v[174:177], 0
s_waitcnt lgkmcnt(0)
v_mul_f32 v143, v143, v152
v_mul_f32 v144, v144, v152
v_mul_f32 v145, v145, v152
v_cvt_pk_bf16_f32 v139, v140, v141
v_cvt_pk_bf16_f32 v140, v142, v143
v_cvt_pk_bf16_f32 v141, v144, v145
v_mov_b32_e64 v137, 0
v_max3_u32 v218, v218, v150, v151
v_cvt_pk_bf16_f32 v94, v220, v221
v_mfma_f32_16x16x32_bf16 v[146:149], v[134:137], v[178:181], v[146:149]
v_cvt_pk_bf16_f32 v180, v166, 0
v_cvt_pk_bf16_f32 v178, v162, v163
v_mfma_f32_16x16x32_bf16 v[166:169], v[190:193], v[174:177], 0
s_nop 0
v_cvt_pk_bf16_f32 v179, v164, v165
v_cvt_pk_bf16_f32 v95, v222, v223
s_nop 0
v_mfma_f32_16x16x32_bf16 v[166:169], v[190:193], v[178:181], v[166:169]
ds_write_b128 v211, v[138:141] offset:38912
v_mfma_f32_16x16x32_bf16 v[154:157], v[118:121], v[178:181], v[154:157]
v_rcp_f32 v167, v166
v_mfma_f32_16x16x32_bf16 v[158:161], v[126:129], v[178:181], v[158:161]
v_mul_f32 v168, s3, v167
v_mul_f32_e64 v146, v146, v152
v_mfma_f32_16x16x32_bf16 v[162:165], v[130:133], v[174:177], 0
v_mul_f32 v154, v154, v168
v_mul_f32 v155, v155, v168
v_mfma_f32_16x16x32_bf16 v[162:165], v[134:137], v[178:181], v[162:165]
v_mul_f32 v156, v156, v168
v_mul_f32 v157, v157, v168
v_mfma_f32_16x16x32_bf16 v[138:141], v[78:81], v[90:93], 0
v_cvt_pk_bf16_f32 v154, v154, v155
v_mul_f32 v158, v158, v168
v_mul_f32 v159, v159, v168
v_mul_f32 v160, v160, v168
v_mul_f32 v161, v161, v168
v_mfma_f32_16x16x16_bf16 v[138:141], v[82:83], v[94:95], v[138:141]
v_cvt_pk_bf16_f32 v155, v156, v157
v_cvt_pk_bf16_f32 v156, v158, v159
v_cvt_pk_bf16_f32 v157, v160, v161
v_mul_f32 v147, v147, v152
v_mul_f32 v148, v148, v152
v_mul_f32_e64 v149, v149, v152
v_mfma_f32_16x16x32_bf16 v[150:153], v[108:111], v[90:93], v[206:209]
ds_write_b128 v211, v[154:157] offset:45056
v_mfma_f32_16x16x16_bf16 v[150:153], v[112:113], v[94:95], v[150:153]
v_mul_f32 v162, v162, v168
v_mul_f32 v163, v163, v168
v_mul_f32 v164, v164, v168
v_mul_f32 v165, v165, v168
v_cvt_pk_bf16_f32 v142, v146, v147
v_cvt_pk_bf16_f32 v143, v148, v149
v_mfma_f32_16x16x32_bf16 v[146:149], v[102:105], v[90:93], 0
ds_write_b64 v212, v[142:143] offset:38912
v_mfma_f32_16x16x32_bf16 v[142:145], v[96:99], v[90:93], 0
v_cvt_pk_bf16_f32 v158, v162, v163
v_cvt_pk_bf16_f32 v159, v164, v165
v_exp_f32_e64 v138, v138
v_mfma_f32_16x16x16_bf16 v[146:149], v[106:107], v[94:95], v[146:149]
v_exp_f32 v139, v139
s_nop 0
v_cvt_pk_bf16_f32 v174, v138, v139
v_mfma_f32_16x16x16_bf16 v[142:145], v[100:101], v[94:95], v[142:145]
ds_write_b64 v212, v[158:159] offset:45056
v_exp_f32 v140, v140
v_exp_f32 v141, v141
s_nop 1
v_exp_f32 v142, v142
v_exp_f32 v143, v143
v_exp_f32 v144, v144
v_exp_f32 v145, v145
v_exp_f32 v150, v150
v_cvt_pk_bf16_f32 v175, v140, v141
v_cvt_pk_bf16_f32 v176, v142, v143
v_cvt_pk_bf16_f32 v177, v144, v145
v_cvt_pk_bf16_f32 v180, v150, 0
v_max3_u32 v218, v218, v166, v167
v_mfma_f32_16x16x32_bf16 v[150:153], v[190:193], v[174:177], 0
s_waitcnt lgkmcnt(0)
v_exp_f32 v146, v146
v_mfma_f32_16x16x32_bf16 v[138:141], v[114:117], v[174:177], 0
s_barrier
v_mfma_f32_16x16x32_bf16 v[142:145], v[122:125], v[174:177], 0
ds_read_b128 v[220:223], v210 offset:38912
ds_read_b128 v[170:173], v210 offset:40960
v_exp_f32 v147, v147
v_exp_f32 v148, v148
v_exp_f32 v149, v149
v_cvt_pk_bf16_f32 v178, v146, v147
v_cvt_pk_bf16_f32 v179, v148, v149
v_mfma_f32_16x16x32_bf16 v[146:149], v[130:133], v[174:177], 0
ds_read_b128 v[182:185], v210 offset:41984
ds_read_b128 v[186:189], v210 offset:43008
v_mfma_f32_16x16x32_bf16 v[150:153], v[190:193], v[178:181], v[150:153]
ds_read_b128 v[174:177], v217
ds_read_b64 v[76:77], v215 offset:16
v_mfma_f32_16x16x32_bf16 v[138:141], v[118:121], v[178:181], v[138:141]
v_add_u32 v205, 1424, v205
v_mfma_f32_16x16x32_bf16 v[142:145], v[126:129], v[178:181], v[142:145]
s_waitcnt lgkmcnt(5)
v_rcp_f32 v151, v150
v_mfma_f32_16x16x32_bf16 v[36:39], a[144:147], v[220:223], v[36:39]
v_mul_f32 v152, s3, v151
v_mul_f32 v138, v138, v152
v_mfma_f32_16x16x32_bf16 v[40:43], a[168:171], v[220:223], v[40:43]
v_mul_f32 v139, v139, v152
v_mul_f32 v140, v140, v152
v_mfma_f32_16x16x32_bf16 v[44:47], a[192:195], v[220:223], v[44:47]
ds_read_b128 v[220:223], v210 offset:44032
v_mul_f32_e64 v141, v141, v152
v_mfma_f32_16x16x32_bf16 v[146:149], v[134:137], v[178:181], v[146:149]
ds_read_b128 v[178:181], v217 offset:528
v_cvt_pk_bf16_f32 v138, v138, v139
v_mul_f32 v142, v142, v152
v_mul_f32 v143, v143, v152
v_mul_f32_e64 v144, v144, v152
v_mul_f32 v145, v145, v152
s_waitcnt lgkmcnt(2)
v_mfma_f32_16x16x16_bf16 v[154:157], v[76:77], v[82:83], 0
v_cvt_pk_bf16_f32 v139, v140, v141
v_cvt_pk_bf16_f32 v140, v142, v143
v_cvt_pk_bf16_f32 v141, v144, v145
v_mfma_f32_16x16x16_bf16 v[158:161], v[76:77], v[100:101], 0
v_mul_f32 v146, v146, v152
v_mul_f32 v147, v147, v152
v_mul_f32_e64 v148, v148, v152
v_mfma_f32_16x16x16_bf16 v[162:165], v[76:77], v[106:107], 0
v_mul_f32_e64 v149, v149, v152
v_cvt_pk_bf16_f32 v142, v146, v147
v_cvt_pk_bf16_f32 v143, v148, v149
v_mfma_f32_16x16x16_bf16 v[166:169], v[76:77], v[112:113], v[206:209]
ds_write_b128 v211, v[138:141] offset:51200
v_mfma_f32_16x16x32_bf16 v[154:157], v[72:75], v[78:81], v[154:157]
v_max3_u32 v218, v218, v150, v151
v_mfma_f32_16x16x32_bf16 v[158:161], v[72:75], v[96:99], v[158:161]
v_mfma_f32_16x16x32_bf16 v[162:165], v[72:75], v[102:105], v[162:165]
ds_write_b64 v212, v[142:143] offset:51200
v_mfma_f32_16x16x32_bf16 v[166:169], v[72:75], v[108:111], v[166:169]
ds_read_b128 v[110:113], v210 offset:39936
v_mov_b32_dpp v154, v158 quad_perm:[0,1,2,3] row_mask:0x2 bank_mask:0xf
s_nop 1
v_mov_b32_dpp v154, v162 quad_perm:[0,1,2,3] row_mask:0x4 bank_mask:0xf
s_nop 1
v_mov_b32_dpp v154, v167 quad_perm:[0,1,2,3] row_mask:0x8 bank_mask:0xf
v_exp_f32 v154, v154
s_nop 0
v_cvt_pk_bf16_f32 v154, v154, 0
ds_write_b16 v214, v154
ds_read_b128 v[84:87], v215
s_waitcnt lgkmcnt(2)
v_mfma_f32_16x16x32_bf16 v[36:39], a[148:151], v[110:113], v[36:39]
s_nop 0
ds_read_b128 v[88:91], v215 offset:16
v_add_u32 v215, 1424, v215
v_mfma_f32_16x16x32_bf16 v[36:39], a[152:155], v[170:173], v[36:39]
v_mfma_f32_16x16x32_bf16 v[36:39], a[156:159], v[182:185], v[36:39]
v_mfma_f32_16x16x32_bf16 v[40:43], a[172:175], v[110:113], v[40:43]
v_mfma_f32_16x16x32_bf16 v[40:43], a[176:179], v[170:173], v[40:43]
v_mfma_f32_16x16x32_bf16 v[40:43], a[180:183], v[182:185], v[40:43]
v_mfma_f32_16x16x32_bf16 v[44:47], a[196:199], v[110:113], v[44:47]
ds_read_b128 v[110:113], v210 offset:45056
v_mfma_f32_16x16x32_bf16 v[44:47], a[200:203], v[170:173], v[44:47]
ds_read_b128 v[170:173], v210 offset:46080
v_mfma_f32_16x16x32_bf16 v[44:47], a[204:207], v[182:185], v[44:47]
ds_read_b128 v[182:185], v210 offset:47104
v_mfma_f32_16x16x32_bf16 v[44:47], a[208:211], v[186:189], v[44:47]
v_mfma_f32_16x16x32_bf16 v[44:47], a[212:215], v[220:223], v[44:47]
v_mfma_f32_16x16x32_bf16 v[36:39], a[160:163], v[186:189], v[36:39]
v_mfma_f32_16x16x32_bf16 v[36:39], a[164:167], v[220:223], v[36:39]
v_cvt_pk_bf16_f32 v44, v44, v45
v_cvt_pk_bf16_f32 v45, v46, v47
v_mfma_f32_16x16x32_bf16 v[40:43], a[184:187], v[186:189], v[40:43]
s_nop 0
ds_read_b128 v[186:189], v210 offset:48128
v_mfma_f32_16x16x32_bf16 v[40:43], a[188:191], v[220:223], v[40:43]
s_waitcnt lgkmcnt(3)
ds_read_b128 v[220:223], v210 offset:49152
v_cvt_pk_bf16_f32 v36, v36, v37
v_mfma_f32_16x16x32_bf16 v[48:51], a[144:147], v[110:113], v[48:51]
s_waitcnt lgkmcnt(3)
ds_write_b64 v203, v[44:45] offset:64
v_mfma_f32_16x16x32_bf16 v[48:51], a[148:151], v[170:173], v[48:51]
s_waitcnt lgkmcnt(3)
buffer_load_dwordx4 v[44:47], v210, s[24:27], s58 offen offset:2048
v_mfma_f32_16x16x32_bf16 v[48:51], a[152:155], v[182:185], v[48:51]
v_cvt_pk_bf16_f32 v40, v40, v41
v_cvt_pk_bf16_f32 v37, v38, v39
v_mfma_f32_16x16x32_bf16 v[52:55], a[168:171], v[110:113], v[52:55]
ds_write_b64 v203, v[36:37]
v_mfma_f32_16x16x32_bf16 v[52:55], a[172:175], v[170:173], v[52:55]
buffer_load_dwordx4 v[36:39], v210, s[24:27], s58 offen
v_mfma_f32_16x16x32_bf16 v[52:55], a[176:179], v[182:185], v[52:55]
s_nop 0
v_cvt_pk_bf16_f32 v41, v42, v43
s_waitcnt lgkmcnt(3)
v_mfma_f32_16x16x32_bf16 v[52:55], a[180:183], v[186:189], v[52:55]
ds_write_b64 v203, v[40:41] offset:32
v_mfma_f32_16x16x32_bf16 v[56:59], a[192:195], v[110:113], v[56:59]
buffer_load_dwordx4 v[40:43], v210, s[24:27], s58 offen offset:1024
v_mfma_f32_16x16x32_bf16 v[56:59], a[196:199], v[170:173], v[56:59]
ds_read_b128 v[110:113], v210 offset:50176
v_mfma_f32_16x16x32_bf16 v[56:59], a[200:203], v[182:185], v[56:59]
v_mfma_f32_16x16x32_bf16 v[56:59], a[204:207], v[186:189], v[56:59]
v_mfma_f32_16x16x32_bf16 v[48:51], a[156:159], v[186:189], v[48:51]
s_waitcnt lgkmcnt(4)
v_mfma_f32_16x16x32_bf16 v[48:51], a[160:163], v[220:223], v[48:51]
s_waitcnt lgkmcnt(1)
s_barrier
v_mfma_f32_16x16x32_bf16 v[52:55], a[184:187], v[220:223], v[52:55]
s_waitcnt lgkmcnt(0)
ds_read_b128 v[170:173], v210 offset:51200
ds_read_b128 v[182:185], v210 offset:52224
v_mfma_f32_16x16x32_bf16 v[52:55], a[188:191], v[110:113], v[52:55]
ds_read_b128 v[186:189], v210 offset:53248
v_mfma_f32_16x16x32_bf16 v[48:51], a[164:167], v[110:113], v[48:51]
v_mfma_f32_16x16x32_bf16 v[56:59], a[208:211], v[220:223], v[56:59]
ds_read_b128 v[220:223], v210 offset:54272
v_cvt_pk_bf16_f32 v52, v52, v53
v_mfma_f32_16x16x32_bf16 v[56:59], a[212:215], v[110:113], v[56:59]
ds_read_b128 v[110:113], v210 offset:55296
v_cvt_pk_bf16_f32 v48, v48, v49
v_mfma_f32_16x16x32_bf16 v[166:169], v[84:87], v[190:193], 0
v_cvt_pk_bf16_f32 v49, v50, v51
v_cvt_pk_bf16_f32 v53, v54, v55
v_mfma_f32_16x16x32_bf16 v[166:169], v[88:91], v[190:193], v[166:169]
ds_write_b64 v203, v[48:49] offset:6272
v_mfma_f32_16x16x32_bf16 v[154:157], v[84:87], v[114:117], 0
v_cvt_pk_bf16_f32 v56, v56, v57
v_cvt_pk_bf16_f32 v57, v58, v59
v_mfma_f32_16x16x32_bf16 v[154:157], v[88:91], v[118:121], v[154:157]
ds_write_b64 v203, v[52:53] offset:6304
v_mfma_f32_16x16x32_bf16 v[158:161], v[84:87], v[122:125], 0
v_rcp_f32 v167, v166
v_mfma_f32_16x16x32_bf16 v[158:161], v[88:91], v[126:129], v[158:161]
ds_write_b64 v203, v[56:57] offset:6336
v_mfma_f32_16x16x32_bf16 v[162:165], v[84:87], v[130:133], 0
v_mul_f32 v168, s3, v167
v_max3_u32 v218, v218, v166, v167
v_mfma_f32_16x16x32_bf16 v[162:165], v[88:91], v[134:137], v[162:165]
v_mov_b32_dpp v154, v158 quad_perm:[0,1,2,3] row_mask:0x2 bank_mask:0xf
s_waitcnt lgkmcnt(7)
v_mfma_f32_16x16x32_bf16 v[60:63], a[144:147], v[170:173], v[60:63]
s_waitcnt lgkmcnt(6)
ds_read_b64 v[120:121], v204
ds_read_b64 v[128:129], v204 offset:392
v_mfma_f32_16x16x32_bf16 v[60:63], a[148:151], v[182:185], v[60:63]
s_waitcnt lgkmcnt(7)
v_mov_b32_dpp v154, v162 quad_perm:[0,1,2,3] row_mask:0x4 bank_mask:0xf
v_mul_f32 v154, v154, v168
v_mfma_f32_16x16x32_bf16 v[60:63], a[152:155], v[186:189], v[60:63]
v_cvt_pk_bf16_f32 v154, v154, 0
v_mfma_f32_16x16x32_bf16 v[64:67], a[168:171], v[170:173], v[64:67]
ds_write_b16 v214, v154
v_mfma_f32_16x16x32_bf16 v[64:67], a[172:175], v[182:185], v[64:67]
ds_read_b64 v[136:137], v204 offset:784
v_add_u32 v214, 1424, v214
v_mfma_f32_16x16x32_bf16 v[64:67], a[176:179], v[186:189], v[64:67]
s_waitcnt lgkmcnt(3)
buffer_store_dwordx2 v[120:121], v204, s[8:11], s28 offen sc1
ds_read_b64 v[120:121], v204 offset:1176
v_mfma_f32_16x16x32_bf16 v[68:71], a[192:195], v[170:173], v[68:71]
s_add_u32 s28, s39, s62
ds_read_b128 v[170:173], v210 offset:56320
v_mfma_f32_16x16x32_bf16 v[68:71], a[196:199], v[182:185], v[68:71]
ds_read_b128 v[182:185], v210
v_mfma_f32_16x16x32_bf16 v[68:71], a[200:203], v[186:189], v[68:71]
ds_read_b128 v[186:189], v210 offset:1024
v_mfma_f32_16x16x32_bf16 v[68:71], a[204:207], v[220:223], v[68:71]
s_waitcnt lgkmcnt(6)
buffer_store_dwordx2 v[128:129], v204, s[8:11], s29 offen sc1
s_add_u32 s29, s39, s63
v_mfma_f32_16x16x32_bf16 v[60:63], a[156:159], v[220:223], v[60:63]
v_mfma_f32_16x16x32_bf16 v[60:63], a[160:163], v[110:113], v[60:63]
s_waitcnt lgkmcnt(2)
v_mfma_f32_16x16x32_bf16 v[60:63], a[164:167], v[170:173], v[60:63]
buffer_store_dwordx2 v[136:137], v204, s[8:11], s28 offen sc1
s_add_u32 s28, s39, s64
v_mfma_f32_16x16x32_bf16 v[64:67], a[180:183], v[220:223], v[64:67]
ds_read_b128 v[220:223], v210 offset:3072
v_mfma_f32_16x16x32_bf16 v[64:67], a[184:187], v[110:113], v[64:67]
v_cvt_pk_bf16_f32 v60, v60, v61
v_cvt_pk_bf16_f32 v61, v62, v63
v_mfma_f32_16x16x32_bf16 v[64:67], a[188:191], v[170:173], v[64:67]
ds_write_b64 v203, v[60:61] offset:12544
v_mfma_f32_16x16x32_bf16 v[68:71], a[208:211], v[110:113], v[68:71]
v_subrev_u32 v60, 37120, v210
v_lshrrev_b32 v61, 4, v60
v_mfma_f32_16x16x32_bf16 v[68:71], a[212:215], v[170:173], v[68:71]
s_waitcnt lgkmcnt(3)
ds_read_b128 v[110:113], v210 offset:2048
v_and_b32_e64 v61, 15, v61
v_mfma_f32_16x16x32_bf16 v[138:141], a[0:3], v[182:185], 0
s_waitcnt lgkmcnt(3)
v_lshrrev_b32 v62, 8, v60
v_mul_u32_u24 v63, 1424, v61
v_mfma_f32_16x16x32_bf16 v[138:141], a[4:7], v[186:189], v[138:141]
v_cvt_pk_bf16_f32 v68, v68, v69
v_cvt_pk_bf16_f32 v69, v70, v71
v_mfma_f32_16x16x32_bf16 v[142:145], a[24:27], v[182:185], 0
ds_write_b64 v203, v[68:69] offset:12608
v_mfma_f32_16x16x32_bf16 v[142:145], a[28:31], v[186:189], v[142:145]
v_mov_b32_dpp v71, v200 row_newbcast:0 row_mask:0xf bank_mask:0xf
v_add_u32 v71, 17248, v71
v_mfma_f32_16x16x32_bf16 v[146:149], a[48:51], v[182:185], 0
ds_read_b128 v[84:87], v71
v_mov_b32_dpp v69, v194 row_newbcast:0 row_mask:0xf bank_mask:0xf
v_mfma_f32_16x16x32_bf16 v[146:149], a[52:55], v[186:189], v[146:149]
v_add_u32 v69, 17248, v69
v_mov_b32_dpp v70, v197 row_newbcast:0 row_mask:0xf bank_mask:0xf
v_mfma_f32_16x16x32_bf16 v[150:153], a[216:219], v[182:185], 0
ds_read_b128 v[92:95], v69
ds_read_b128 v[96:99], v69 offset:16
v_mfma_f32_16x16x32_bf16 v[150:153], a[220:223], v[186:189], v[150:153]
v_add_u32 v70, 17248, v70
v_lshl_add_u32 v63, v62, 5, v63
v_mfma_f32_16x16x32_bf16 v[154:157], a[240:243], v[182:185], 0
ds_read_b128 v[100:103], v70
ds_read_b128 v[104:107], v70 offset:16
v_mfma_f32_16x16x32_bf16 v[154:157], a[244:247], v[186:189], v[154:157]
s_nop 0
v_add_u32 v63, 94464, v63
v_cvt_pk_bf16_f32 v64, v64, v65
v_mfma_f32_16x16x32_bf16 v[158:161], v[232:235], v[182:185], 0
s_waitcnt lgkmcnt(4)
ds_read_b128 v[88:91], v63 offset:128
v_cvt_pk_bf16_f32 v65, v66, v67
v_mfma_f32_16x16x32_bf16 v[48:51], v[174:177], v[84:87], 0
ds_read_b128 v[174:177], v217 offset:1056
ds_read_b128 v[84:87], v71 offset:32
v_mfma_f32_16x16x32_bf16 v[158:161], v[236:239], v[186:189], v[158:161]
ds_write_b64 v203, v[64:65] offset:12576
s_waitcnt lgkmcnt(6)
v_smfmac_f32_16x16x64_bf16 v[48:51], v[178:181], v[92:99], v213
buffer_store_dwordx2 v[120:121], v204, s[8:11], s29 offen sc1
ds_read_b128 v[178:181], v217 offset:1584
v_mfma_f32_16x16x32_bf16 v[162:165], v[182:185], a[72:75], 0
s_add_u32 s29, s39, s65
ds_read_b128 v[92:95], v69 offset:32
ds_read_b128 v[96:99], v69 offset:48
v_mfma_f32_16x16x32_bf16 v[162:165], v[186:189], a[76:79], v[162:165]
s_nop 0
v_lshl_add_u32 v64, v62, 3, v205
v_lshlrev_b32 v67, 5, v61
v_mfma_f32_16x16x32_bf16 v[166:169], v[182:185], a[96:99], 0
s_waitcnt lgkmcnt(5)
v_add_u32 v67, s41, v67
v_mul_hi_u32 v68, v67, s42
v_smfmac_f32_16x16x64_bf16 v[48:51], v[174:177], v[100:107], v213
s_mov_b32 s42, 1373568
ds_read_b128 v[174:177], v217 offset:2112
ds_read_b128 v[100:103], v70 offset:32
v_mfma_f32_16x16x32_bf16 v[166:169], v[186:189], a[100:103], v[166:169]
s_add_u32 s41, s33, 512
ds_read_b128 v[104:107], v70 offset:48
v_mul_u32_u24 v65, 73, v68
v_mfma_f32_16x16x32_bf16 v[170:173], v[182:185], a[120:123], 0
ds_read_b128 v[182:185], v210 offset:4096
v_mul_f32 v119, v48, v48
v_mfma_f32_16x16x32_bf16 v[170:173], v[186:189], a[124:127], v[170:173]
s_waitcnt lgkmcnt(6)
ds_read_b128 v[186:189], v210 offset:5120
v_add_f32_e64 v118, v48, v49
v_mfma_f32_16x16x32_bf16 v[52:55], v[178:181], v[84:87], 0
ds_read_b128 v[178:181], v217 offset:2640
ds_read_b128 v[84:87], v71 offset:64
v_mfma_f32_16x16x32_bf16 v[138:141], a[8:11], v[110:113], v[138:141]
v_fmac_f32 v119, v49, v49
v_add_f32 v118, v118, v50
v_mfma_f32_16x16x32_bf16 v[138:141], a[12:15], v[220:223], v[138:141]
s_waitcnt lgkmcnt(6)
v_fmac_f32 v119, v50, v50
v_add_f32_e64 v118, v118, v51
v_smfmac_f32_16x16x64_bf16 v[52:55], v[174:177], v[92:99], v213
ds_read_b128 v[174:177], v217 offset:3168
ds_read_b128 v[92:95], v69 offset:64
v_mfma_f32_16x16x32_bf16 v[142:145], a[32:35], v[110:113], v[142:145]
ds_read_b128 v[96:99], v69 offset:80
v_fmac_f32 v119, v51, v51
v_mfma_f32_16x16x32_bf16 v[142:145], a[36:39], v[220:223], v[142:145]
v_mul_lo_u32 v68, v68, s42
v_sub_u32 v65, v67, v65
v_mfma_f32_16x16x32_bf16 v[146:149], a[56:59], v[110:113], v[146:149]
s_mul_i32 s42, s32, 96
v_cmp_gt_u32 vcc, s34, v67
v_mul_u32_u24 v65, 2688, v65
v_mfma_f32_16x16x32_bf16 v[146:149], a[60:63], v[220:223], v[146:149]
s_waitcnt lgkmcnt(4)
v_add3_u32 v65, v65, v68, s42
v_mov_b32 v68, 1879048192
v_smfmac_f32_16x16x64_bf16 v[52:55], v[178:181], v[100:107], v213
s_mov_b32 s42, 58835169
ds_read_b128 v[178:181], v217 offset:3696
ds_read_b128 v[100:103], v70 offset:64
v_mfma_f32_16x16x32_bf16 v[150:153], a[224:227], v[110:113], v[150:153]
s_waitcnt lgkmcnt(4)
ds_read_b128 v[104:107], v70 offset:80
v_cndmask_b32 v65, v68, v65, vcc
v_mfma_f32_16x16x32_bf16 v[56:59], v[174:177], v[84:87], 0
ds_read_b128 v[174:177], v217 offset:4224
ds_read_b128 v[84:87], v63
v_mfma_f32_16x16x32_bf16 v[150:153], a[228:231], v[220:223], v[150:153]
v_add_f32 v118, v118, v52
v_fmac_f32 v119, v52, v52
v_mfma_f32_16x16x32_bf16 v[154:157], a[248:251], v[110:113], v[154:157]
v_add_f32 v118, v118, v53
v_fmac_f32 v119, v53, v53
v_mfma_f32_16x16x32_bf16 v[154:157], a[252:255], v[220:223], v[154:157]
v_add_f32 v118, v118, v54
v_fmac_f32 v119, v54, v54
v_mfma_f32_16x16x32_bf16 v[158:161], v[240:243], v[110:113], v[158:161]
s_waitcnt lgkmcnt(4)
v_add_f32 v118, v118, v55
v_fmac_f32_e64 v119, v55, v55
v_smfmac_f32_16x16x64_bf16 v[56:59], v[178:181], v[92:99], v213
ds_read_b128 v[92:95], v63 offset:256
ds_read_b128 v[96:99], v63 offset:384
v_mfma_f32_16x16x32_bf16 v[158:161], v[244:247], v[220:223], v[158:161]
ds_read_b128 v[178:181], v210 offset:15360
v_cmp_gt_u32 vcc, 4, v61
v_mfma_f32_16x16x32_bf16 v[162:165], v[110:113], a[80:83], v[162:165]
s_waitcnt lgkmcnt(4)
v_lshlrev_b32 v67, 5, v61
v_mov_b32 v68, s97
v_smfmac_f32_16x16x64_bf16 v[56:59], v[174:177], v[100:107], v213
ds_read_b64 v[100:101], v63 offset:16
ds_read_b64 v[102:103], v63 offset:144
v_mfma_f32_16x16x32_bf16 v[162:165], v[220:223], a[84:87], v[162:165]
ds_read_b64 v[104:105], v63 offset:272
ds_read_b64 v[106:107], v63 offset:400
v_mfma_f32_16x16x32_bf16 v[166:169], v[110:113], a[104:107], v[166:169]
v_add_f32 v118, v118, v56
v_fmac_f32 v119, v56, v56
v_mfma_f32_16x16x32_bf16 v[166:169], v[220:223], a[108:111], v[166:169]
v_add_f32 v118, v118, v57
v_fmac_f32 v119, v57, v57
v_mfma_f32_16x16x32_bf16 v[170:173], v[110:113], a[128:131], v[170:173]
ds_read_b128 v[110:113], v210 offset:6144
v_add_f32_e64 v118, v118, v58
v_mfma_f32_16x16x32_bf16 v[170:173], v[220:223], a[132:135], v[170:173]
ds_read_b128 v[220:223], v210 offset:7168
v_fmac_f32_e64 v119, v58, v58
v_mfma_f32_16x16x32_bf16 v[138:141], a[16:19], v[182:185], v[138:141]
v_add_f32 v118, v118, v59
v_fmac_f32 v119, v59, v59
v_mfma_f32_16x16x32_bf16 v[138:141], a[20:23], v[186:189], v[138:141]
v_permlane16_swap_b32 v118, v119
v_mfma_f32_16x16x32_bf16 v[142:145], a[40:43], v[182:185], v[142:145]
v_add_f32 v118, v118, v119
v_mov_b32_e64 v126, v118
v_mfma_f32_16x16x32_bf16 v[142:145], a[44:47], v[186:189], v[142:145]
v_cvt_pk_bf16_f32 v78, v138, v139
v_cvt_pk_bf16_f32 v79, v140, v141
v_mfma_f32_16x16x32_bf16 v[146:149], a[64:67], v[182:185], v[146:149]
s_nop 0
v_permlane32_swap_b32 v118, v126
v_mfma_f32_16x16x32_bf16 v[146:149], a[68:71], v[186:189], v[146:149]
v_cvt_pk_bf16_f32 v80, v142, v143
v_cvt_pk_bf16_f32 v81, v144, v145
v_mfma_f32_16x16x32_bf16 v[150:153], a[232:235], v[182:185], v[150:153]
v_add_f32 v118, v118, v126
v_add_u32 v67, s41, v67
v_mfma_f32_16x16x32_bf16 v[150:153], a[236:239], v[186:189], v[150:153]
ds_write_b32 v209, v118
v_mfma_f32_16x16x32_bf16 v[154:157], v[224:227], v[182:185], v[154:157]
v_cvt_pk_bf16_f32 v82, v146, v147
v_cvt_pk_bf16_f32 v83, v148, v149
v_mfma_f32_16x16x32_bf16 v[154:157], v[228:231], v[186:189], v[154:157]
v_cvt_pk_bf16_f32 v72, v150, v151
v_cvt_pk_bf16_f32 v73, v152, v153
v_mfma_f32_16x16x32_bf16 v[158:161], v[248:251], v[182:185], v[158:161]
s_nop 0
ds_read_b128 v[174:177], v210 offset:14336
v_cndmask_b32 v67, v68, v67, vcc
v_mfma_f32_16x16x32_bf16 v[158:161], v[252:255], v[186:189], v[158:161]
v_cvt_pk_bf16_f32 v74, v154, v155
v_cvt_pk_bf16_f32 v75, v156, v157
v_mfma_f32_16x16x32_bf16 v[162:165], v[182:185], a[88:91], v[162:165]
v_cmp_gt_u32 vcc, 5, v61
v_mov_b32 v68, 6000
v_mfma_f32_16x16x32_bf16 v[162:165], v[186:189], a[92:95], v[162:165]
s_waitcnt lgkmcnt(1)
v_cvt_pk_bf16_f32 v76, v158, v159
v_cvt_pk_bf16_f32 v77, v160, v161
v_mfma_f32_16x16x32_bf16 v[166:169], v[182:185], a[112:115], v[166:169]
s_barrier
v_mfma_f32_16x16x32_bf16 v[166:169], v[186:189], a[116:119], v[166:169]
s_nop 0
v_cvt_pk_bf16_f32 v114, v162, v163
v_cvt_pk_bf16_f32 v115, v164, v165
v_mfma_f32_16x16x32_bf16 v[170:173], v[182:185], a[136:139], v[170:173]
ds_read_b128 v[182:185], v210 offset:8192
ds_read_b64 v[128:129], v204 offset:6272
v_mfma_f32_16x16x32_bf16 v[170:173], v[186:189], a[140:143], v[170:173]
ds_read_b128 v[186:189], v210 offset:9216
v_cvt_pk_bf16_f32 v122, v166, v167
v_mfma_f32_16x16x32_bf16 v[138:141], a[0:3], v[110:113], 0
s_nop 0
v_cvt_pk_bf16_f32 v123, v168, v169
v_cndmask_b32 v67, v68, v67, vcc
v_mfma_f32_16x16x32_bf16 v[138:141], a[4:7], v[220:223], v[138:141]
v_cvt_pk_bf16_f32 v130, v170, v171
v_cvt_pk_bf16_f32 v131, v172, v173
v_mfma_f32_16x16x32_bf16 v[142:145], a[24:27], v[110:113], 0
ds_read_b64 v[136:137], v204 offset:6664
ds_read_b64 v[120:121], v204 offset:7056
v_mfma_f32_16x16x32_bf16 v[142:145], a[28:31], v[220:223], v[142:145]
v_mul_hi_u32 v68, v67, s42
v_mul_u32_u24 v66, 73, v68
v_mfma_f32_16x16x32_bf16 v[146:149], a[48:51], v[110:113], 0
s_waitcnt vmcnt(5) lgkmcnt(3)
buffer_store_dwordx2 v[128:129], v204, s[8:11], s28 offen sc1
ds_read_b64 v[128:129], v204 offset:7448
v_mfma_f32_16x16x32_bf16 v[146:149], a[52:55], v[220:223], v[146:149]
s_add_u32 s28, s39, s66
v_sub_u32 v66, v67, v66
v_cmp_gt_u32 vcc, s34, v67
v_mfma_f32_16x16x32_bf16 v[36:39], a[144:147], v[84:87], v[36:39]
s_mov_b32 s42, 1373568
v_mul_lo_u32 v68, v68, s42
v_mul_u32_u24 v66, 2688, v66
v_mfma_f32_16x16x32_bf16 v[36:39], a[148:151], v[88:91], v[36:39]
s_waitcnt lgkmcnt(2)
buffer_store_dwordx2 v[136:137], v204, s[8:11], s29 offen sc1
ds_read_b64 v[136:137], v204 offset:12544
v_mfma_f32_16x16x32_bf16 v[36:39], a[152:155], v[92:95], v[36:39]
s_add_u32 s29, s39, s67
v_lshl_add_u32 v65, v62, 3, v65
v_add_u32 v65, 1047808, v65
v_mfma_f32_16x16x32_bf16 v[36:39], a[156:159], v[96:99], v[36:39]
s_mul_i32 s42, s32, 96
v_add3_u32 v66, v66, v68, s42
v_mov_b32 v68, 1879048192
v_mfma_f32_16x16x32_bf16 v[36:39], a[160:163], v[100:103], v[36:39]
s_waitcnt lgkmcnt(2)
buffer_store_dwordx2 v[120:121], v204, s[8:11], s28 offen sc1
ds_read_b64 v[120:121], v204 offset:12936
v_mfma_f32_16x16x32_bf16 v[36:39], a[164:167], v[104:107], v[36:39]
s_add_u32 s28, s39, s68
v_cndmask_b32 v66, v68, v66, vcc
v_lshl_add_u32 v66, v62, 3, v66
v_mfma_f32_16x16x32_bf16 v[150:153], a[216:219], v[110:113], 0
s_nop 0
v_add_u32 v66, 1047808, v66
v_mfma_f32_16x16x32_bf16 v[150:153], a[220:223], v[220:223], v[150:153]
s_waitcnt vmcnt(7) lgkmcnt(2)
buffer_store_dwordx2 v[128:129], v204, s[8:11], s29 offen sc1
ds_read_b64 v[128:129], v204 offset:13328
v_mfma_f32_16x16x32_bf16 v[40:43], a[168:171], v[84:87], v[40:43]
s_add_u32 s29, s39, s69
v_cvt_pk_bf16_f32 v36, v36, v37
v_cvt_pk_bf16_f32 v37, v38, v39
v_mfma_f32_16x16x32_bf16 v[40:43], a[172:175], v[88:91], v[40:43]
buffer_store_dwordx2 v[36:37], v65, s[8:11], 0 offen
v_mfma_f32_16x16x32_bf16 v[40:43], a[176:179], v[92:95], v[40:43]
v_mfma_f32_16x16x32_bf16 v[40:43], a[180:183], v[96:99], v[40:43]
v_mfma_f32_16x16x32_bf16 v[40:43], a[184:187], v[100:103], v[40:43]
v_mfma_f32_16x16x32_bf16 v[40:43], a[188:191], v[104:107], v[40:43]
v_mfma_f32_16x16x32_bf16 v[154:157], a[240:243], v[110:113], 0
v_mfma_f32_16x16x32_bf16 v[154:157], a[244:247], v[220:223], v[154:157]
v_cvt_pk_bf16_f32 v40, v40, v41
v_cvt_pk_bf16_f32 v41, v42, v43
v_mfma_f32_16x16x32_bf16 v[158:161], v[232:235], v[110:113], 0
v_mfma_f32_16x16x32_bf16 v[158:161], v[236:239], v[220:223], v[158:161]
v_mfma_f32_16x16x32_bf16 v[44:47], a[192:195], v[84:87], v[44:47]
v_mfma_f32_16x16x32_bf16 v[44:47], a[196:199], v[88:91], v[44:47]
v_mfma_f32_16x16x32_bf16 v[44:47], a[200:203], v[92:95], v[44:47]
v_mfma_f32_16x16x32_bf16 v[44:47], a[204:207], v[96:99], v[44:47]
v_mfma_f32_16x16x32_bf16 v[44:47], a[208:211], v[100:103], v[44:47]
buffer_store_dwordx2 v[40:41], v65, s[8:11], 0 offen offset:32
v_mfma_f32_16x16x32_bf16 v[44:47], a[212:215], v[104:107], v[44:47]
ds_read_b128 v[102:105], v210 offset:18432
ds_read_b128 v[106:109], v210 offset:19456
v_mfma_f32_16x16x32_bf16 v[162:165], v[110:113], a[72:75], 0
v_mfma_f32_16x16x32_bf16 v[162:165], v[220:223], a[76:79], v[162:165]
v_cvt_pk_bf16_f32 v44, v44, v45
v_cvt_pk_bf16_f32 v45, v46, v47
v_mfma_f32_16x16x32_bf16 v[166:169], v[110:113], a[96:99], 0
v_mfma_f32_16x16x32_bf16 v[166:169], v[220:223], a[100:103], v[166:169]
v_mfma_f32_16x16x32_bf16 v[170:173], v[110:113], a[120:123], 0
ds_read_b128 v[110:113], v210 offset:10240
v_mfma_f32_16x16x32_bf16 v[170:173], v[220:223], a[124:127], v[170:173]
s_waitcnt lgkmcnt(2)
v_add_f32 v102, v102, v103
v_add_f32_e64 v104, v104, v105
v_mfma_f32_16x16x32_bf16 v[138:141], a[8:11], v[182:185], v[138:141]
s_waitcnt lgkmcnt(1)
v_add_f32 v106, v106, v107
v_add_f32_e64 v108, v108, v109
v_mfma_f32_16x16x32_bf16 v[138:141], a[12:15], v[186:189], v[138:141]
v_add_f32 v102, v102, v104
v_add_f32 v106, v106, v108
v_mfma_f32_16x16x32_bf16 v[142:145], a[32:35], v[182:185], v[142:145]
v_mul_f32 v103, s48, v102
v_mul_f32 v104, s73, v102
v_mfma_f32_16x16x32_bf16 v[142:145], a[36:39], v[186:189], v[142:145]
v_mul_f32_e64 v106, s73, v106
v_fma_f32 v106, -v103, v104, v106
v_mfma_f32_16x16x32_bf16 v[146:149], a[56:59], v[182:185], v[146:149]
v_max_f32 v106, 0, v106
v_add_f32 v106, s49, v106
v_mfma_f32_16x16x32_bf16 v[146:149], a[60:63], v[186:189], v[146:149]
v_rsq_f32_e64 v102, v106
v_mfma_f32_16x16x32_bf16 v[150:153], a[224:227], v[182:185], v[150:153]
ds_read_b128 v[106:109], v210 offset:11264
v_mul_f32_e64 v103, -v103, v102
v_mfma_f32_16x16x32_bf16 v[150:153], a[228:231], v[186:189], v[150:153]
ds_write_b64 v211, v[102:103] offset:20480
v_mfma_f32_16x16x32_bf16 v[154:157], a[248:251], v[182:185], v[154:157]
buffer_store_dwordx2 v[44:45], v65, s[8:11], 0 offen offset:64
ds_read_b64 v[118:119], v219 offset:20480
v_mfma_f32_16x16x32_bf16 v[154:157], a[252:255], v[186:189], v[154:157]
v_mfma_f32_16x16x32_bf16 v[158:161], v[240:243], v[182:185], v[158:161]
v_mfma_f32_16x16x32_bf16 v[158:161], v[244:247], v[186:189], v[158:161]
v_mfma_f32_16x16x32_bf16 v[162:165], v[182:185], a[80:83], v[162:165]
s_nop 0
v_mfma_f32_16x16x32_bf16 v[162:165], v[186:189], a[84:87], v[162:165]
s_waitcnt lgkmcnt(0)
v_fma_f32 v220, v48, v118, v119
v_fma_f32 v221, v49, v118, v119
v_mfma_f32_16x16x32_bf16 v[166:169], v[182:185], a[104:107], v[166:169]
v_fma_f32 v222, v50, v118, v119
v_fma_f32 v223, v51, v118, v119
v_mfma_f32_16x16x32_bf16 v[166:169], v[186:189], a[108:111], v[166:169]
v_cvt_pk_bf16_f32 v90, v220, v221
v_cvt_pk_bf16_f32 v91, v222, v223
v_mfma_f32_16x16x32_bf16 v[170:173], v[182:185], a[128:131], v[170:173]
v_fma_f32 v220, v52, v118, v119
v_fma_f32 v221, v53, v118, v119
v_mfma_f32_16x16x32_bf16 v[170:173], v[186:189], a[132:135], v[170:173]
v_fma_f32 v222, v54, v118, v119
v_fma_f32 v223, v55, v118, v119
v_mfma_f32_16x16x32_bf16 v[138:141], a[16:19], v[110:113], v[138:141]
v_cvt_pk_bf16_f32 v92, v220, v221
v_cvt_pk_bf16_f32 v93, v222, v223
v_mfma_f32_16x16x32_bf16 v[138:141], a[20:23], v[106:109], v[138:141]
ds_write_b128 v211, v[90:93] offset:20480
v_mfma_f32_16x16x32_bf16 v[142:145], a[40:43], v[110:113], v[142:145]
v_fma_f32 v220, v56, v118, v119
v_fma_f32 v221, v57, v118, v119
v_mfma_f32_16x16x32_bf16 v[142:145], a[44:47], v[106:109], v[142:145]
v_fma_f32 v222, v58, v118, v119
v_fma_f32 v223, v59, v118, v119
v_mfma_f32_16x16x32_bf16 v[146:149], a[64:67], v[110:113], v[146:149]
v_cvt_pk_bf16_f32 v94, v220, v221
v_cvt_pk_bf16_f32 v95, v222, v223
v_mfma_f32_16x16x32_bf16 v[146:149], a[68:71], v[106:109], v[146:149]
ds_write_b64 v212, v[94:95] offset:20480
v_mfma_f32_16x16x32_bf16 v[150:153], a[232:235], v[110:113], v[150:153]
v_cvt_pk_bf16_f32 v96, v138, v139
v_cvt_pk_bf16_f32 v97, v140, v141
v_mfma_f32_16x16x32_bf16 v[150:153], a[236:239], v[106:109], v[150:153]
v_cvt_pk_bf16_f32 v98, v142, v143
v_cvt_pk_bf16_f32 v99, v144, v145
v_mfma_f32_16x16x32_bf16 v[154:157], v[224:227], v[110:113], v[154:157]
v_cvt_pk_bf16_f32 v100, v146, v147
v_cvt_pk_bf16_f32 v101, v148, v149
v_mfma_f32_16x16x32_bf16 v[154:157], v[228:231], v[106:109], v[154:157]
v_cvt_pk_bf16_f32 v84, v150, v151
v_cvt_pk_bf16_f32 v85, v152, v153
v_mfma_f32_16x16x32_bf16 v[158:161], v[248:251], v[110:113], v[158:161]
s_nop 0
buffer_store_dwordx2 v[136:137], v204, s[8:11], s28 offen sc1
ds_read_b64 v[136:137], v204 offset:13720
v_mfma_f32_16x16x32_bf16 v[158:161], v[252:255], v[106:109], v[158:161]
s_waitcnt lgkmcnt(1)
v_cvt_pk_bf16_f32 v86, v154, v155
v_cvt_pk_bf16_f32 v87, v156, v157
v_mfma_f32_16x16x32_bf16 v[162:165], v[110:113], a[88:91], v[162:165]
s_barrier
v_mfma_f32_16x16x32_bf16 v[162:165], v[106:109], a[92:95], v[162:165]
s_add_u32 s28, s39, s70
ds_read_b128 v[182:185], v210 offset:20480
ds_read_b128 v[186:189], v210 offset:21504
v_mfma_f32_16x16x32_bf16 v[166:169], v[110:113], a[112:115], v[166:169]
v_cvt_pk_bf16_f32 v88, v158, v159
v_cvt_pk_bf16_f32 v89, v160, v161
v_mfma_f32_16x16x32_bf16 v[166:169], v[106:109], a[116:119], v[166:169]
v_cvt_pk_bf16_f32 v116, v162, v163
v_cvt_pk_bf16_f32 v117, v164, v165
v_mfma_f32_16x16x32_bf16 v[170:173], v[110:113], a[136:139], v[170:173]
s_nop 0
buffer_store_dwordx2 v[120:121], v204, s[8:11], s29 offen sc1
s_add_u32 s29, s39, s71
v_mfma_f32_16x16x32_bf16 v[170:173], v[106:109], a[140:143], v[170:173]
v_cvt_pk_bf16_f32 v124, v166, v167
v_cvt_pk_bf16_f32 v125, v168, v169
s_waitcnt lgkmcnt(1)
v_mfma_f32_16x16x32_bf16 v[138:141], a[216:219], v[182:185], 0
buffer_store_dwordx2 v[128:129], v204, s[8:11], s28 offen sc1
s_nop 0
v_cvt_pk_bf16_f32 v132, v170, v171
v_mfma_f32_16x16x32_bf16 v[142:145], a[240:243], v[182:185], 0
v_cvt_pk_bf16_f32 v133, v172, v173
s_add_u32 s28, s38, s60
v_mfma_f32_16x16x32_bf16 v[146:149], v[232:235], v[182:185], 0
s_mov_b64 exec, s[56:57]
buffer_load_dwordx4 v[48:51], v210, s[24:27], s59 offen
s_mov_b64 exec, -1
v_mfma_f32_16x16x32_bf16 v[150:153], a[0:3], v[182:185], 0
s_mov_b64 exec, s[56:57]
buffer_load_dwordx4 v[52:55], v210, s[24:27], s59 offen offset:1024
s_mov_b64 exec, -1
v_mfma_f32_16x16x32_bf16 v[154:157], a[24:27], v[182:185], 0
s_mov_b64 exec, s[56:57]
buffer_load_dwordx4 v[56:59], v210, s[24:27], s59 offen offset:2048
s_mov_b64 exec, -1
v_mfma_f32_16x16x32_bf16 v[158:161], a[48:51], v[182:185], 0
v_mfma_f32_16x16x32_bf16 v[162:165], a[72:75], v[182:185], 0
v_mfma_f32_16x16x32_bf16 v[166:169], a[96:99], v[182:185], 0
v_mfma_f32_16x16x32_bf16 v[170:173], a[120:123], v[182:185], 0
ds_read_b128 v[182:185], v210 offset:22528
s_waitcnt lgkmcnt(1)
v_mfma_f32_16x16x32_bf16 v[138:141], a[220:223], v[186:189], v[138:141]
v_mfma_f32_16x16x32_bf16 v[142:145], a[244:247], v[186:189], v[142:145]
v_mfma_f32_16x16x32_bf16 v[146:149], v[236:239], v[186:189], v[146:149]
v_mfma_f32_16x16x32_bf16 v[150:153], a[4:7], v[186:189], v[150:153]
v_mfma_f32_16x16x32_bf16 v[154:157], a[28:31], v[186:189], v[154:157]
v_mfma_f32_16x16x32_bf16 v[158:161], a[52:55], v[186:189], v[158:161]
buffer_store_dwordx2 v[136:137], v204, s[8:11], s29 offen sc1
s_add_u32 s29, s38, s61
v_mfma_f32_16x16x32_bf16 v[162:165], a[76:79], v[186:189], v[162:165]
v_mfma_f32_16x16x32_bf16 v[166:169], a[100:103], v[186:189], v[166:169]
v_mfma_f32_16x16x32_bf16 v[170:173], a[124:127], v[186:189], v[170:173]
ds_read_b128 v[186:189], v210 offset:23552
s_waitcnt lgkmcnt(1)
v_mfma_f32_16x16x32_bf16 v[138:141], a[224:227], v[182:185], v[138:141]
v_mfma_f32_16x16x32_bf16 v[142:145], a[248:251], v[182:185], v[142:145]
v_mfma_f32_16x16x32_bf16 v[146:149], v[240:243], v[182:185], v[146:149]
v_mfma_f32_16x16x32_bf16 v[150:153], a[8:11], v[182:185], v[150:153]
v_mfma_f32_16x16x32_bf16 v[154:157], a[32:35], v[182:185], v[154:157]
v_mfma_f32_16x16x32_bf16 v[158:161], a[56:59], v[182:185], v[158:161]
v_mfma_f32_16x16x32_bf16 v[162:165], a[80:83], v[182:185], v[162:165]
v_mfma_f32_16x16x32_bf16 v[166:169], a[104:107], v[182:185], v[166:169]
v_mfma_f32_16x16x32_bf16 v[170:173], a[128:131], v[182:185], v[170:173]
ds_read_b128 v[182:185], v210 offset:24576
s_waitcnt lgkmcnt(1)
v_mfma_f32_16x16x32_bf16 v[138:141], a[228:231], v[186:189], v[138:141]
v_mfma_f32_16x16x32_bf16 v[142:145], a[252:255], v[186:189], v[142:145]
v_mfma_f32_16x16x32_bf16 v[146:149], v[244:247], v[186:189], v[146:149]
v_mfma_f32_16x16x32_bf16 v[150:153], a[12:15], v[186:189], v[150:153]
v_mfma_f32_16x16x32_bf16 v[154:157], a[36:39], v[186:189], v[154:157]
v_mfma_f32_16x16x32_bf16 v[158:161], a[60:63], v[186:189], v[158:161]
v_mfma_f32_16x16x32_bf16 v[162:165], a[84:87], v[186:189], v[162:165]
v_mfma_f32_16x16x32_bf16 v[166:169], a[108:111], v[186:189], v[166:169]
v_mfma_f32_16x16x32_bf16 v[170:173], a[132:135], v[186:189], v[170:173]
ds_read_b128 v[186:189], v210 offset:25600
s_waitcnt lgkmcnt(1)
v_mfma_f32_16x16x32_bf16 v[138:141], a[232:235], v[182:185], v[138:141]
v_mfma_f32_16x16x32_bf16 v[142:145], v[224:227], v[182:185], v[142:145]
v_mfma_f32_16x16x32_bf16 v[146:149], v[248:251], v[182:185], v[146:149]
v_mfma_f32_16x16x32_bf16 v[150:153], a[16:19], v[182:185], v[150:153]
v_mfma_f32_16x16x32_bf16 v[154:157], a[40:43], v[182:185], v[154:157]
v_mfma_f32_16x16x32_bf16 v[158:161], a[64:67], v[182:185], v[158:161]
v_mfma_f32_16x16x32_bf16 v[162:165], a[88:91], v[182:185], v[162:165]
v_mfma_f32_16x16x32_bf16 v[166:169], a[112:115], v[182:185], v[166:169]
v_mfma_f32_16x16x32_bf16 v[170:173], a[136:139], v[182:185], v[170:173]
s_nop 0
ds_read_b128 v[182:185], v210 offset:12288
s_waitcnt lgkmcnt(1)
v_mfma_f32_16x16x32_bf16 v[138:141], a[236:239], v[186:189], v[138:141]
v_mfma_f32_16x16x32_bf16 v[142:145], v[228:231], v[186:189], v[142:145]
v_mfma_f32_16x16x32_bf16 v[146:149], v[252:255], v[186:189], v[146:149]
v_cvt_pk_bf16_f32 v90, v138, v139
v_cvt_pk_bf16_f32 v91, v140, v141
v_mfma_f32_16x16x32_bf16 v[150:153], a[20:23], v[186:189], v[150:153]
v_cvt_pk_bf16_f32 v92, v142, v143
v_cvt_pk_bf16_f32 v93, v144, v145
v_mfma_f32_16x16x32_bf16 v[154:157], a[44:47], v[186:189], v[154:157]
s_mov_b64 exec, s[30:31]
ds_write_b128 v215, v[90:93]
s_mov_b64 exec, -1
v_mfma_f32_16x16x32_bf16 v[158:161], a[68:71], v[186:189], v[158:161]
v_cvt_pk_bf16_f32 v94, v146, v147
v_cvt_pk_bf16_f32 v95, v148, v149
v_mfma_f32_16x16x32_bf16 v[162:165], a[92:95], v[186:189], v[162:165]
s_mov_b64 exec, s[30:31]
ds_write_b64 v215, v[94:95] offset:16
s_mov_b64 exec, -1
v_mfma_f32_16x16x32_bf16 v[166:169], a[116:119], v[186:189], v[166:169]
s_nop 0
v_cvt_pk_bf16_f32 v102, v150, v151
v_cvt_pk_bf16_f32 v103, v152, v153
v_mfma_f32_16x16x32_bf16 v[170:173], a[140:143], v[186:189], v[170:173]
s_waitcnt lgkmcnt(2)
v_cvt_pk_bf16_f32 v104, v154, v155
v_cvt_pk_bf16_f32 v105, v156, v157
v_mfma_f32_16x16x32_bf16 v[138:141], a[0:3], v[182:185], 0
s_mov_b64 exec, s[30:31]
ds_write_b128 v215, v[102:105] offset:512
s_mov_b64 exec, -1
v_mfma_f32_16x16x32_bf16 v[142:145], a[24:27], v[182:185], 0
v_cvt_pk_bf16_f32 v106, v158, v159
v_cvt_pk_bf16_f32 v107, v160, v161
v_mfma_f32_16x16x32_bf16 v[146:149], a[48:51], v[182:185], 0
ds_read_b128 v[186:189], v210 offset:13312
s_mov_b64 exec, s[30:31]
ds_write_b64 v215, v[106:107] offset:528
s_mov_b64 exec, -1
v_mfma_f32_16x16x16_bf16 v[154:157], v[82:83], v[88:89], 0
v_cvt_pk_bf16_f32 v108, v162, v163
v_cvt_pk_bf16_f32 v109, v164, v165
v_cvt_pk_bf16_f32 v110, v166, v167
v_mfma_f32_16x16x16_bf16 v[158:161], v[100:101], v[88:89], 0
v_cvt_pk_bf16_f32 v111, v168, v169
v_cvt_pk_bf16_f32 v112, v170, v171
v_cvt_pk_bf16_f32 v113, v172, v173
v_mfma_f32_16x16x32_bf16 v[154:157], v[78:81], v[84:87], v[154:157]
s_nop 0
s_mov_b64 exec, s[30:31]
ds_write_b64 v64, v[108:109]
s_mov_b64 exec, -1
v_mfma_f32_16x16x32_bf16 v[158:161], v[96:99], v[84:87], v[158:161]
s_waitcnt lgkmcnt(2)
s_mov_b64 exec, s[30:31]
ds_write_b64 v64, v[110:111] offset:32
s_mov_b64 exec, -1
v_mfma_f32_16x16x32_bf16 v[138:141], a[4:7], v[186:189], v[138:141]
s_mov_b64 exec, s[30:31]
ds_write_b64 v64, v[112:113] offset:64
s_mov_b64 exec, -1
v_mfma_f32_16x16x32_bf16 v[142:145], a[28:31], v[186:189], v[142:145]
ds_read_b128 v[182:185], v210 offset:15360
ds_read_b128 v[108:111], v215 offset:512
v_mfma_f32_16x16x32_bf16 v[146:149], a[52:55], v[186:189], v[146:149]
ds_read_b128 v[186:189], v210 offset:16384
ds_read_b128 v[170:173], v210 offset:14336
v_exp_f32 v154, v154
ds_read_b64 v[112:113], v215 offset:528
v_exp_f32 v155, v155
v_exp_f32 v156, v156
v_exp_f32 v157, v157
v_exp_f32 v158, v158
v_exp_f32 v159, v159
v_exp_f32_e64 v160, v160
v_exp_f32 v161, v161
s_waitcnt lgkmcnt(3)
v_mfma_f32_16x16x32_bf16 v[150:153], v[108:111], v[72:75], v[206:209]
s_waitcnt lgkmcnt(1)
v_mfma_f32_16x16x32_bf16 v[138:141], a[8:11], v[170:173], v[138:141]
v_mfma_f32_16x16x32_bf16 v[138:141], a[12:15], v[182:185], v[138:141]
v_mfma_f32_16x16x32_bf16 v[142:145], a[32:35], v[170:173], v[142:145]
v_mfma_f32_16x16x32_bf16 v[142:145], a[36:39], v[182:185], v[142:145]
v_mfma_f32_16x16x32_bf16 v[146:149], a[56:59], v[170:173], v[146:149]
ds_read_b128 v[170:173], v210 offset:17408
s_waitcnt lgkmcnt(1)
v_mfma_f32_16x16x16_bf16 v[166:169], v[112:113], v[88:89], v[206:209]
v_mfma_f32_16x16x16_bf16 v[150:153], v[112:113], v[76:77], v[150:153]
v_mfma_f32_16x16x32_bf16 v[146:149], a[60:63], v[182:185], v[146:149]
ds_read_b128 v[182:185], v210 offset:12288
v_mfma_f32_16x16x32_bf16 v[138:141], a[16:19], v[186:189], v[138:141]
v_exp_f32 v150, v150
v_mfma_f32_16x16x32_bf16 v[166:169], v[108:111], v[84:87], v[166:169]
s_waitcnt lgkmcnt(1)
v_mfma_f32_16x16x32_bf16 v[138:141], a[20:23], v[170:173], v[138:141]
v_mfma_f32_16x16x32_bf16 v[142:145], a[40:43], v[186:189], v[142:145]
v_exp_f32 v166, v166
v_mfma_f32_16x16x32_bf16 v[142:145], a[44:47], v[170:173], v[142:145]
v_cvt_pk_bf16_f32 v102, v138, v139
v_cvt_pk_bf16_f32 v103, v140, v141
v_mfma_f32_16x16x32_bf16 v[138:141], v[78:81], v[72:75], 0
s_waitcnt lgkmcnt(0)
v_mfma_f32_16x16x32_bf16 v[118:121], v[182:185], a[72:75], 0
v_cvt_pk_bf16_f32 v104, v142, v143
v_cvt_pk_bf16_f32 v105, v144, v145
v_mfma_f32_16x16x32_bf16 v[142:145], v[96:99], v[72:75], 0
v_mfma_f32_16x16x32_bf16 v[126:129], v[182:185], a[96:99], 0
v_mfma_f32_16x16x32_bf16 v[134:137], v[182:185], a[120:123], 0
v_mfma_f32_16x16x32_bf16 v[90:93], a[216:219], v[182:185], 0
v_mfma_f32_16x16x16_bf16 v[138:141], v[82:83], v[76:77], v[138:141]
v_mfma_f32_16x16x16_bf16 v[142:145], v[100:101], v[76:77], v[142:145]
v_mfma_f32_16x16x32_bf16 v[220:223], v[232:235], v[182:185], 0
v_exp_f32 v138, v138
v_mfma_f32_16x16x32_bf16 v[146:149], a[64:67], v[186:189], v[146:149]
ds_read_b128 v[186:189], v210 offset:13312
v_mfma_f32_16x16x32_bf16 v[146:149], a[68:71], v[170:173], v[146:149]
v_exp_f32 v139, v139
v_mfma_f32_16x16x32_bf16 v[170:173], a[240:243], v[182:185], 0
ds_read_b128 v[182:185], v210 offset:16384
v_exp_f32_e64 v140, v140
v_cvt_pk_bf16_f32 v106, v146, v147
v_cvt_pk_bf16_f32 v107, v148, v149
v_mfma_f32_16x16x32_bf16 v[146:149], v[102:105], v[72:75], 0
v_exp_f32 v141, v141
v_mfma_f32_16x16x16_bf16 v[162:165], v[106:107], v[88:89], 0
v_exp_f32 v142, v142
s_waitcnt lgkmcnt(1)
v_mfma_f32_16x16x32_bf16 v[118:121], v[186:189], a[76:79], v[118:121]
v_exp_f32 v143, v143
v_mfma_f32_16x16x32_bf16 v[126:129], v[186:189], a[100:103], v[126:129]
v_exp_f32 v144, v144
v_mfma_f32_16x16x32_bf16 v[134:137], v[186:189], a[124:127], v[134:137]
v_exp_f32 v145, v145
v_mfma_f32_16x16x32_bf16 v[90:93], a[220:223], v[186:189], v[90:93]
ds_read_b128 v[72:75], v215
v_mfma_f32_16x16x32_bf16 v[170:173], a[244:247], v[186:189], v[170:173]
v_mfma_f32_16x16x32_bf16 v[220:223], v[236:239], v[186:189], v[220:223]
ds_read_b128 v[186:189], v210 offset:17408
v_mfma_f32_16x16x32_bf16 v[118:121], v[174:177], a[80:83], v[118:121]
v_mfma_f32_16x16x32_bf16 v[118:121], v[178:181], a[84:87], v[118:121]
v_mfma_f32_16x16x32_bf16 v[126:129], v[174:177], a[104:107], v[126:129]
v_mfma_f32_16x16x32_bf16 v[126:129], v[178:181], a[108:111], v[126:129]
v_mfma_f32_16x16x32_bf16 v[134:137], v[174:177], a[128:131], v[134:137]
v_mfma_f32_16x16x32_bf16 v[134:137], v[178:181], a[132:135], v[134:137]
v_mfma_f32_16x16x32_bf16 v[90:93], a[224:227], v[174:177], v[90:93]
v_mfma_f32_16x16x32_bf16 v[90:93], a[228:231], v[178:181], v[90:93]
v_mfma_f32_16x16x32_bf16 v[170:173], a[248:251], v[174:177], v[170:173]
v_mfma_f32_16x16x32_bf16 v[170:173], a[252:255], v[178:181], v[170:173]
v_mfma_f32_16x16x32_bf16 v[220:223], v[240:243], v[174:177], v[220:223]
v_cvt_pk_bf16_f32 v174, v138, v139
v_cvt_pk_bf16_f32 v175, v140, v141
v_mfma_f32_16x16x32_bf16 v[220:223], v[244:247], v[178:181], v[220:223]
v_cvt_pk_bf16_f32 v176, v142, v143
v_cvt_pk_bf16_f32 v177, v144, v145
v_mfma_f32_16x16x32_bf16 v[162:165], v[102:105], v[84:87], v[162:165]
s_waitcnt lgkmcnt(2)
v_cvt_pk_bf16_f32 v180, v150, 0
v_mov_b32 v181, 0
v_mfma_f32_16x16x32_bf16 v[118:121], v[182:185], a[88:91], v[118:121]
s_waitcnt lgkmcnt(0)
v_mfma_f32_16x16x16_bf16 v[146:149], v[106:107], v[76:77], v[146:149]
v_exp_f32 v162, v162
v_exp_f32 v163, v163
v_mfma_f32_16x16x32_bf16 v[118:121], v[186:189], a[92:95], v[118:121]
v_exp_f32 v164, v164
v_mfma_f32_16x16x32_bf16 v[126:129], v[182:185], a[112:115], v[126:129]
v_exp_f32 v146, v146
v_mfma_f32_16x16x32_bf16 v[126:129], v[186:189], a[116:119], v[126:129]
v_exp_f32 v147, v147
v_mfma_f32_16x16x32_bf16 v[134:137], v[182:185], a[136:139], v[134:137]
v_exp_f32 v148, v148
v_mfma_f32_16x16x32_bf16 v[134:137], v[186:189], a[140:143], v[134:137]
v_exp_f32 v149, v149
v_mfma_f32_16x16x32_bf16 v[90:93], a[232:235], v[182:185], v[90:93]
v_exp_f32_e64 v165, v165
v_mfma_f32_16x16x32_bf16 v[90:93], a[236:239], v[186:189], v[90:93]
v_cvt_pk_bf16_f32 v178, v146, v147
v_cvt_pk_bf16_f32 v179, v148, v149
v_mfma_f32_16x16x32_bf16 v[170:173], v[224:227], v[182:185], v[170:173]
v_cvt_pk_bf16_f32 v118, v118, v119
v_cvt_pk_bf16_f32 v119, v120, v121
v_mfma_f32_16x16x32_bf16 v[170:173], v[228:231], v[186:189], v[170:173]
ds_read_u16 v120, v205
v_mov_b32_e64 v121, 0
v_mfma_f32_16x16x32_bf16 v[220:223], v[248:251], v[182:185], v[220:223]
v_cvt_pk_bf16_f32 v126, v126, v127
v_cvt_pk_bf16_f32 v127, v128, v129
v_mfma_f32_16x16x32_bf16 v[220:223], v[252:255], v[186:189], v[220:223]
ds_read_u16 v128, v205 offset:32
v_mov_b32_e64 v129, 0
v_mfma_f32_16x16x32_bf16 v[150:153], v[190:193], v[174:177], 0
v_cvt_pk_bf16_f32 v134, v134, v135
v_cvt_pk_bf16_f32 v135, v136, v137
v_mfma_f32_16x16x32_bf16 v[150:153], v[190:193], v[178:181], v[150:153]
s_nop 0
ds_read_u16 v136, v205 offset:64
v_cvt_pk_bf16_f32 v90, v90, v91
v_mfma_f32_16x16x32_bf16 v[138:141], v[114:117], v[174:177], 0
s_waitcnt lgkmcnt(2)
v_cvt_pk_bf16_f32 v91, v92, v93
v_cvt_pk_bf16_f32 v92, v170, v171
v_mfma_f32_16x16x32_bf16 v[138:141], v[118:121], v[178:181], v[138:141]
v_rcp_f32 v151, v150
v_mfma_f32_16x16x32_bf16 v[142:145], v[122:125], v[174:177], 0
s_waitcnt lgkmcnt(1)
v_mul_f32_e64 v152, s3, v151
v_cvt_pk_bf16_f32 v93, v172, v173
v_mfma_f32_16x16x32_bf16 v[142:145], v[126:129], v[178:181], v[142:145]
v_mul_f32 v138, v138, v152
v_mul_f32 v139, v139, v152
v_mfma_f32_16x16x32_bf16 v[146:149], v[130:133], v[174:177], 0
v_cvt_pk_bf16_f32 v174, v154, v155
v_cvt_pk_bf16_f32 v175, v156, v157
v_cvt_pk_bf16_f32 v176, v158, v159
v_cvt_pk_bf16_f32 v177, v160, v161
v_mul_f32 v140, v140, v152
v_mul_f32 v141, v141, v152
v_mfma_f32_16x16x32_bf16 v[154:157], v[114:117], v[174:177], 0
v_cvt_pk_bf16_f32 v138, v138, v139
v_mul_f32_e64 v142, v142, v152
v_mfma_f32_16x16x32_bf16 v[158:161], v[122:125], v[174:177], 0
s_waitcnt lgkmcnt(0)
v_mul_f32 v143, v143, v152
v_mul_f32 v144, v144, v152
v_mul_f32 v145, v145, v152
v_cvt_pk_bf16_f32 v139, v140, v141
v_cvt_pk_bf16_f32 v140, v142, v143
v_cvt_pk_bf16_f32 v141, v144, v145
v_mov_b32_e64 v137, 0
v_max3_u32 v218, v218, v150, v151
v_cvt_pk_bf16_f32 v94, v220, v221
v_mfma_f32_16x16x32_bf16 v[146:149], v[134:137], v[178:181], v[146:149]
v_cvt_pk_bf16_f32 v180, v166, 0
v_cvt_pk_bf16_f32 v178, v162, v163
v_mfma_f32_16x16x32_bf16 v[166:169], v[190:193], v[174:177], 0
s_nop 0
v_cvt_pk_bf16_f32 v179, v164, v165
v_cvt_pk_bf16_f32 v95, v222, v223
s_nop 0
v_mfma_f32_16x16x32_bf16 v[166:169], v[190:193], v[178:181], v[166:169]
ds_write_b128 v211, v[138:141] offset:38912
v_mfma_f32_16x16x32_bf16 v[154:157], v[118:121], v[178:181], v[154:157]
v_rcp_f32 v167, v166
v_mfma_f32_16x16x32_bf16 v[158:161], v[126:129], v[178:181], v[158:161]
v_mul_f32 v168, s3, v167
v_mul_f32_e64 v146, v146, v152
v_mfma_f32_16x16x32_bf16 v[162:165], v[130:133], v[174:177], 0
v_mul_f32 v154, v154, v168
v_mul_f32 v155, v155, v168
v_mfma_f32_16x16x32_bf16 v[162:165], v[134:137], v[178:181], v[162:165]
v_mul_f32 v156, v156, v168
v_mul_f32 v157, v157, v168
v_mfma_f32_16x16x32_bf16 v[138:141], v[78:81], v[90:93], 0
v_cvt_pk_bf16_f32 v154, v154, v155
v_mul_f32 v158, v158, v168
v_mul_f32 v159, v159, v168
v_mul_f32 v160, v160, v168
v_mul_f32 v161, v161, v168
v_mfma_f32_16x16x16_bf16 v[138:141], v[82:83], v[94:95], v[138:141]
v_cvt_pk_bf16_f32 v155, v156, v157
v_cvt_pk_bf16_f32 v156, v158, v159
v_cvt_pk_bf16_f32 v157, v160, v161
v_mul_f32 v147, v147, v152
v_mul_f32 v148, v148, v152
v_mul_f32_e64 v149, v149, v152
v_mfma_f32_16x16x32_bf16 v[150:153], v[108:111], v[90:93], v[206:209]
ds_write_b128 v211, v[154:157] offset:45056
v_mfma_f32_16x16x16_bf16 v[150:153], v[112:113], v[94:95], v[150:153]
v_mul_f32 v162, v162, v168
v_mul_f32 v163, v163, v168
v_mul_f32 v164, v164, v168
v_mul_f32 v165, v165, v168
v_cvt_pk_bf16_f32 v142, v146, v147
v_cvt_pk_bf16_f32 v143, v148, v149
v_mfma_f32_16x16x32_bf16 v[146:149], v[102:105], v[90:93], 0
ds_write_b64 v212, v[142:143] offset:38912
v_mfma_f32_16x16x32_bf16 v[142:145], v[96:99], v[90:93], 0
v_cvt_pk_bf16_f32 v158, v162, v163
v_cvt_pk_bf16_f32 v159, v164, v165
v_exp_f32_e64 v138, v138
v_mfma_f32_16x16x16_bf16 v[146:149], v[106:107], v[94:95], v[146:149]
v_exp_f32 v139, v139
s_nop 0
v_cvt_pk_bf16_f32 v174, v138, v139
v_mfma_f32_16x16x16_bf16 v[142:145], v[100:101], v[94:95], v[142:145]
ds_write_b64 v212, v[158:159] offset:45056
v_exp_f32 v140, v140
v_exp_f32 v141, v141
s_nop 1
v_exp_f32 v142, v142
v_exp_f32 v143, v143
v_exp_f32 v144, v144
v_exp_f32 v145, v145
v_exp_f32 v150, v150
v_cvt_pk_bf16_f32 v175, v140, v141
v_cvt_pk_bf16_f32 v176, v142, v143
v_cvt_pk_bf16_f32 v177, v144, v145
v_cvt_pk_bf16_f32 v180, v150, 0
v_max3_u32 v218, v218, v166, v167
v_mfma_f32_16x16x32_bf16 v[150:153], v[190:193], v[174:177], 0
s_waitcnt lgkmcnt(0)
v_exp_f32 v146, v146
v_mfma_f32_16x16x32_bf16 v[138:141], v[114:117], v[174:177], 0
s_barrier
v_mfma_f32_16x16x32_bf16 v[142:145], v[122:125], v[174:177], 0
ds_read_b128 v[220:223], v210 offset:38912
ds_read_b128 v[170:173], v210 offset:40960
v_exp_f32 v147, v147
v_exp_f32 v148, v148
v_exp_f32 v149, v149
v_cvt_pk_bf16_f32 v178, v146, v147
v_cvt_pk_bf16_f32 v179, v148, v149
v_mfma_f32_16x16x32_bf16 v[146:149], v[130:133], v[174:177], 0
ds_read_b128 v[182:185], v210 offset:41984
ds_read_b128 v[186:189], v210 offset:43008
v_mfma_f32_16x16x32_bf16 v[150:153], v[190:193], v[178:181], v[150:153]
ds_read_b64 v[76:77], v215 offset:16
v_add_u32 v205, 1424, v205
v_mfma_f32_16x16x32_bf16 v[138:141], v[118:121], v[178:181], v[138:141]
v_mfma_f32_16x16x32_bf16 v[142:145], v[126:129], v[178:181], v[142:145]
s_waitcnt lgkmcnt(4)
v_rcp_f32 v151, v150
v_mfma_f32_16x16x32_bf16 v[0:3], a[144:147], v[220:223], v[0:3]
v_mul_f32 v152, s3, v151
v_mul_f32 v138, v138, v152
v_mfma_f32_16x16x32_bf16 v[4:7], a[168:171], v[220:223], v[4:7]
v_mul_f32 v139, v139, v152
v_mul_f32 v140, v140, v152
v_mfma_f32_16x16x32_bf16 v[8:11], a[192:195], v[220:223], v[8:11]
ds_read_b128 v[220:223], v210 offset:44032
v_mul_f32 v141, v141, v152
v_mfma_f32_16x16x32_bf16 v[146:149], v[134:137], v[178:181], v[146:149]
s_waitcnt lgkmcnt(1)
v_cvt_pk_bf16_f32 v138, v138, v139
v_mul_f32 v142, v142, v152
v_mul_f32 v143, v143, v152
v_mfma_f32_16x16x16_bf16 v[154:157], v[76:77], v[82:83], 0
v_mul_f32 v144, v144, v152
v_mul_f32 v145, v145, v152
v_cvt_pk_bf16_f32 v139, v140, v141
v_mfma_f32_16x16x16_bf16 v[158:161], v[76:77], v[100:101], 0
v_cvt_pk_bf16_f32 v140, v142, v143
v_cvt_pk_bf16_f32 v141, v144, v145
v_max3_u32 v218, v218, v150, v151
v_mfma_f32_16x16x16_bf16 v[162:165], v[76:77], v[106:107], 0
v_mul_f32 v146, v146, v152
v_mul_f32 v147, v147, v152
v_mul_f32_e64 v148, v148, v152
v_mfma_f32_16x16x16_bf16 v[166:169], v[76:77], v[112:113], v[206:209]
v_mul_f32_e64 v149, v149, v152
v_cvt_pk_bf16_f32 v142, v146, v147
v_cvt_pk_bf16_f32 v143, v148, v149
v_mfma_f32_16x16x32_bf16 v[154:157], v[72:75], v[78:81], v[154:157]
ds_write_b128 v211, v[138:141] offset:51200
v_mfma_f32_16x16x32_bf16 v[158:161], v[72:75], v[96:99], v[158:161]
v_mfma_f32_16x16x32_bf16 v[162:165], v[72:75], v[102:105], v[162:165]
v_mfma_f32_16x16x32_bf16 v[166:169], v[72:75], v[108:111], v[166:169]
ds_read_b128 v[110:113], v210 offset:39936
ds_write_b64 v212, v[142:143] offset:51200
v_mov_b32_dpp v154, v158 quad_perm:[0,1,2,3] row_mask:0x2 bank_mask:0xf
s_nop 1
v_mov_b32_dpp v154, v162 quad_perm:[0,1,2,3] row_mask:0x4 bank_mask:0xf
s_nop 1
v_mov_b32_dpp v154, v167 quad_perm:[0,1,2,3] row_mask:0x8 bank_mask:0xf
v_exp_f32 v154, v154
s_nop 0
v_cvt_pk_bf16_f32 v154, v154, 0
ds_write_b16 v214, v154
ds_read_b128 v[84:87], v215
s_waitcnt lgkmcnt(3)
v_mfma_f32_16x16x32_bf16 v[0:3], a[148:151], v[110:113], v[0:3]
s_nop 0
ds_read_b128 v[88:91], v215 offset:16
v_add_u32 v215, 1424, v215
v_mfma_f32_16x16x32_bf16 v[0:3], a[152:155], v[170:173], v[0:3]
v_mfma_f32_16x16x32_bf16 v[0:3], a[156:159], v[182:185], v[0:3]
v_mfma_f32_16x16x32_bf16 v[4:7], a[172:175], v[110:113], v[4:7]
v_mfma_f32_16x16x32_bf16 v[4:7], a[176:179], v[170:173], v[4:7]
v_mfma_f32_16x16x32_bf16 v[4:7], a[180:183], v[182:185], v[4:7]
v_mfma_f32_16x16x32_bf16 v[8:11], a[196:199], v[110:113], v[8:11]
ds_read_b128 v[110:113], v210 offset:45056
v_mfma_f32_16x16x32_bf16 v[8:11], a[200:203], v[170:173], v[8:11]
ds_read_b128 v[170:173], v210 offset:46080
v_mfma_f32_16x16x32_bf16 v[8:11], a[204:207], v[182:185], v[8:11]
ds_read_b128 v[182:185], v210 offset:47104
v_mfma_f32_16x16x32_bf16 v[8:11], a[208:211], v[186:189], v[8:11]
v_mfma_f32_16x16x32_bf16 v[8:11], a[212:215], v[220:223], v[8:11]
v_mfma_f32_16x16x32_bf16 v[0:3], a[160:163], v[186:189], v[0:3]
v_mfma_f32_16x16x32_bf16 v[0:3], a[164:167], v[220:223], v[0:3]
v_cvt_pk_bf16_f32 v8, v8, v9
v_cvt_pk_bf16_f32 v9, v10, v11
v_mfma_f32_16x16x32_bf16 v[4:7], a[184:187], v[186:189], v[4:7]
s_nop 0
ds_read_b128 v[186:189], v210 offset:48128
v_mfma_f32_16x16x32_bf16 v[4:7], a[188:191], v[220:223], v[4:7]
s_waitcnt lgkmcnt(3)
ds_read_b128 v[220:223], v210 offset:49152
v_cvt_pk_bf16_f32 v0, v0, v1
v_mfma_f32_16x16x32_bf16 v[12:15], a[144:147], v[110:113], v[12:15]
s_waitcnt lgkmcnt(3)
ds_write_b64 v203, v[8:9] offset:64
v_mfma_f32_16x16x32_bf16 v[12:15], a[148:151], v[170:173], v[12:15]
s_waitcnt lgkmcnt(3)
v_cvt_pk_bf16_f32 v4, v4, v5
v_cvt_pk_bf16_f32 v1, v2, v3
v_mfma_f32_16x16x32_bf16 v[12:15], a[152:155], v[182:185], v[12:15]
ds_write_b64 v203, v[0:1]
v_mfma_f32_16x16x32_bf16 v[16:19], a[168:171], v[110:113], v[16:19]
v_cvt_pk_bf16_f32 v5, v6, v7
v_mfma_f32_16x16x32_bf16 v[16:19], a[172:175], v[170:173], v[16:19]
s_nop 0
ds_write_b64 v203, v[4:5] offset:32
v_mfma_f32_16x16x32_bf16 v[16:19], a[176:179], v[182:185], v[16:19]
s_waitcnt lgkmcnt(4)
v_mfma_f32_16x16x32_bf16 v[16:19], a[180:183], v[186:189], v[16:19]
v_mfma_f32_16x16x32_bf16 v[20:23], a[192:195], v[110:113], v[20:23]
ds_read_b128 v[110:113], v210 offset:50176
v_mfma_f32_16x16x32_bf16 v[20:23], a[196:199], v[170:173], v[20:23]
v_mfma_f32_16x16x32_bf16 v[20:23], a[200:203], v[182:185], v[20:23]
v_mfma_f32_16x16x32_bf16 v[20:23], a[204:207], v[186:189], v[20:23]
v_mfma_f32_16x16x32_bf16 v[12:15], a[156:159], v[186:189], v[12:15]
s_waitcnt lgkmcnt(4)
v_mfma_f32_16x16x32_bf16 v[12:15], a[160:163], v[220:223], v[12:15]
s_waitcnt lgkmcnt(0)
v_mfma_f32_16x16x32_bf16 v[12:15], a[164:167], v[110:113], v[12:15]
v_mfma_f32_16x16x32_bf16 v[16:19], a[184:187], v[220:223], v[16:19]
v_mfma_f32_16x16x32_bf16 v[16:19], a[188:191], v[110:113], v[16:19]
v_cvt_pk_bf16_f32 v12, v12, v13
v_cvt_pk_bf16_f32 v13, v14, v15
v_mfma_f32_16x16x32_bf16 v[20:23], a[208:211], v[220:223], v[20:23]
ds_write_b64 v203, v[12:13] offset:6272
v_mfma_f32_16x16x32_bf16 v[20:23], a[212:215], v[110:113], v[20:23]
v_cvt_pk_bf16_f32 v16, v16, v17
v_cvt_pk_bf16_f32 v17, v18, v19
v_mfma_f32_16x16x32_bf16 v[166:169], v[84:87], v[190:193], 0
ds_write_b64 v203, v[16:17] offset:6304
v_mfma_f32_16x16x32_bf16 v[166:169], v[88:91], v[190:193], v[166:169]
v_cvt_pk_bf16_f32 v20, v20, v21
v_cvt_pk_bf16_f32 v21, v22, v23
v_mfma_f32_16x16x32_bf16 v[154:157], v[84:87], v[114:117], 0
ds_write_b64 v203, v[20:21] offset:6336
v_mfma_f32_16x16x32_bf16 v[154:157], v[88:91], v[118:121], v[154:157]
v_rcp_f32_e64 v167, v166
v_mfma_f32_16x16x32_bf16 v[158:161], v[84:87], v[122:125], 0
v_max3_u32 v218, v218, v166, v167
v_cmp_lt_u32 vcc, 1602224128, v218
v_mfma_f32_16x16x32_bf16 v[158:161], v[88:91], v[126:129], v[158:161]
s_or_b32 s41, vcc_lo, vcc_hi
v_mul_f32 v168, s3, v167
v_mov_b32_e64 v69, s41
v_mfma_f32_16x16x32_bf16 v[162:165], v[84:87], v[130:133], 0
ds_write_b32 v209, v69
v_mfma_f32_16x16x32_bf16 v[162:165], v[88:91], v[134:137], v[162:165]
v_mov_b32_dpp v154, v158 quad_perm:[0,1,2,3] row_mask:0x2 bank_mask:0xf
s_nop 5
v_mov_b32_dpp v154, v162 quad_perm:[0,1,2,3] row_mask:0x4 bank_mask:0xf
v_mul_f32 v154, v154, v168
v_cvt_pk_bf16_f32 v154, v154, 0
ds_write_b16 v214, v154
v_add_u32 v214, 1424, v214
s_waitcnt lgkmcnt(0)
s_barrier
ds_read_b128 v[170:173], v210 offset:51200
ds_read_b128 v[182:185], v210 offset:52224
ds_read_b128 v[84:87], v63 offset:22784
ds_read_b128 v[88:91], v63 offset:22912
ds_read_b128 v[92:95], v63 offset:23040
ds_read_b128 v[96:99], v63 offset:23168
s_waitcnt lgkmcnt(5)
v_mfma_f32_16x16x32_bf16 v[24:27], a[144:147], v[170:173], v[24:27]
ds_read_b64 v[100:101], v63 offset:22800
ds_read_b64 v[102:103], v63 offset:22928
v_mfma_f32_16x16x32_bf16 v[28:31], a[168:171], v[170:173], v[28:31]
s_waitcnt lgkmcnt(6)
ds_read_b64 v[104:105], v63 offset:23056
ds_read_b64 v[106:107], v63 offset:23184
v_mfma_f32_16x16x32_bf16 v[28:31], a[172:175], v[182:185], v[28:31]
ds_read_b128 v[186:189], v210 offset:53248
ds_read_b64 v[120:121], v204
v_mfma_f32_16x16x32_bf16 v[24:27], a[148:151], v[182:185], v[24:27]
s_waitcnt vmcnt(3) lgkmcnt(9)
ds_read_b128 v[220:223], v210 offset:54272
ds_read_b128 v[110:113], v210 offset:55296
v_mfma_f32_16x16x32_bf16 v[48:51], a[144:147], v[84:87], v[48:51]
s_waitcnt lgkmcnt(10)
ds_read_b64 v[128:129], v204 offset:392
ds_read_b64 v[136:137], v204 offset:784
v_mfma_f32_16x16x32_bf16 v[48:51], a[148:151], v[88:91], v[48:51]
ds_read_b128 v[174:177], v210 offset:18432
s_waitcnt lgkmcnt(12)
v_mfma_f32_16x16x32_bf16 v[48:51], a[152:155], v[92:95], v[48:51]
s_waitcnt lgkmcnt(11)
v_mfma_f32_16x16x32_bf16 v[48:51], a[156:159], v[96:99], v[48:51]
s_waitcnt lgkmcnt(9)
v_mfma_f32_16x16x32_bf16 v[48:51], a[160:163], v[100:103], v[48:51]
s_waitcnt lgkmcnt(5)
buffer_store_dwordx2 v[120:121], v204, s[8:11], s28 offen sc1
ds_read_b64 v[120:121], v204 offset:1176
v_mfma_f32_16x16x32_bf16 v[48:51], a[164:167], v[104:107], v[48:51]
s_add_u32 s28, s38, s62
v_mfma_f32_16x16x32_bf16 v[32:35], a[192:195], v[170:173], v[32:35]
ds_read_b128 v[170:173], v210 offset:56320
v_mfma_f32_16x16x32_bf16 v[32:35], a[196:199], v[182:185], v[32:35]
s_waitcnt lgkmcnt(4)
buffer_store_dwordx2 v[128:129], v204, s[8:11], s29 offen sc1
v_cvt_pk_bf16_f32 v48, v48, v49
v_mfma_f32_16x16x32_bf16 v[24:27], a[152:155], v[186:189], v[24:27]
s_waitcnt vmcnt(4) lgkmcnt(2)
v_or3_b32 v174, v174, v175, v176
v_or_b32 v174, v174, v177
v_mfma_f32_16x16x32_bf16 v[24:27], a[156:159], v[220:223], v[24:27]
s_add_u32 s29, s38, s63
v_cvt_pk_bf16_f32 v49, v50, v51
v_readfirstlane_b32 s43, v174
v_mfma_f32_16x16x32_bf16 v[52:55], a[168:171], v[84:87], v[52:55]
s_nop 0
buffer_store_dwordx2 v[136:137], v204, s[8:11], s28 offen sc1
s_add_u32 s28, s38, s64
v_mfma_f32_16x16x32_bf16 v[52:55], a[172:175], v[88:91], v[52:55]
buffer_store_dwordx2 v[48:49], v66, s[8:11], 0 offen
v_mfma_f32_16x16x32_bf16 v[52:55], a[176:179], v[92:95], v[52:55]
v_mfma_f32_16x16x32_bf16 v[52:55], a[180:183], v[96:99], v[52:55]
v_mfma_f32_16x16x32_bf16 v[52:55], a[184:187], v[100:103], v[52:55]
v_mfma_f32_16x16x32_bf16 v[52:55], a[188:191], v[104:107], v[52:55]
v_mfma_f32_16x16x32_bf16 v[28:31], a[176:179], v[186:189], v[28:31]
v_mfma_f32_16x16x32_bf16 v[28:31], a[180:183], v[220:223], v[28:31]
v_cvt_pk_bf16_f32 v52, v52, v53
v_cvt_pk_bf16_f32 v53, v54, v55
v_mfma_f32_16x16x32_bf16 v[32:35], a[200:203], v[186:189], v[32:35]
buffer_store_dwordx2 v[52:53], v66, s[8:11], 0 offen offset:32
v_mfma_f32_16x16x32_bf16 v[32:35], a[204:207], v[220:223], v[32:35]
s_waitcnt vmcnt(6)
v_mfma_f32_16x16x32_bf16 v[56:59], a[192:195], v[84:87], v[56:59]
v_mfma_f32_16x16x32_bf16 v[56:59], a[196:199], v[88:91], v[56:59]
v_mfma_f32_16x16x32_bf16 v[56:59], a[200:203], v[92:95], v[56:59]
v_mfma_f32_16x16x32_bf16 v[56:59], a[204:207], v[96:99], v[56:59]
v_mfma_f32_16x16x32_bf16 v[56:59], a[208:211], v[100:103], v[56:59]
s_waitcnt lgkmcnt(1)
buffer_store_dwordx2 v[120:121], v204, s[8:11], s29 offen sc1
s_add_u32 s29, s38, s65
v_mfma_f32_16x16x32_bf16 v[56:59], a[212:215], v[104:107], v[56:59]
v_mfma_f32_16x16x32_bf16 v[24:27], a[160:163], v[110:113], v[24:27]
s_waitcnt lgkmcnt(0)
v_mfma_f32_16x16x32_bf16 v[24:27], a[164:167], v[170:173], v[24:27]
v_cvt_pk_bf16_f32 v56, v56, v57
v_cvt_pk_bf16_f32 v57, v58, v59
v_mfma_f32_16x16x32_bf16 v[28:31], a[184:187], v[110:113], v[28:31]
buffer_store_dwordx2 v[56:57], v66, s[8:11], 0 offen offset:64
v_mfma_f32_16x16x32_bf16 v[28:31], a[188:191], v[170:173], v[28:31]
v_cvt_pk_bf16_f32 v24, v24, v25
v_cvt_pk_bf16_f32 v25, v26, v27
v_mfma_f32_16x16x32_bf16 v[32:35], a[208:211], v[110:113], v[32:35]
ds_write_b64 v203, v[24:25] offset:12544
v_mfma_f32_16x16x32_bf16 v[32:35], a[212:215], v[170:173], v[32:35]
s_nop 0
v_cvt_pk_bf16_f32 v28, v28, v29
v_cvt_pk_bf16_f32 v29, v30, v31
ds_write_b64 v203, v[28:29] offset:12576
s_nop 3
v_cvt_pk_bf16_f32 v32, v32, v33
v_cvt_pk_bf16_f32 v33, v34, v35
ds_write_b64 v203, v[32:33] offset:12608
s_waitcnt lgkmcnt(0)
s_barrier
ds_read_b64 v[128:129], v204 offset:6272
ds_read_b64 v[136:137], v204 offset:6664
ds_read_b64 v[120:121], v204 offset:7056
s_waitcnt lgkmcnt(2)
buffer_store_dwordx2 v[128:129], v204, s[8:11], s28 offen sc1
s_add_u32 s28, s38, s66
ds_read_b64 v[128:129], v204 offset:7448
s_waitcnt lgkmcnt(2)
buffer_store_dwordx2 v[136:137], v204, s[8:11], s29 offen sc1
s_add_u32 s29, s38, s67
ds_read_b64 v[136:137], v204 offset:12544
s_waitcnt lgkmcnt(2)
buffer_store_dwordx2 v[120:121], v204, s[8:11], s28 offen sc1
s_add_u32 s28, s38, s68
ds_read_b64 v[120:121], v204 offset:12936
s_waitcnt lgkmcnt(2)
buffer_store_dwordx2 v[128:129], v204, s[8:11], s29 offen sc1
s_add_u32 s29, s38, s69
ds_read_b64 v[128:129], v204 offset:13328
s_waitcnt lgkmcnt(2)
buffer_store_dwordx2 v[136:137], v204, s[8:11], s28 offen sc1
s_add_u32 s28, s38, s70
ds_read_b64 v[136:137], v204 offset:13720
s_waitcnt lgkmcnt(2)
buffer_store_dwordx2 v[120:121], v204, s[8:11], s29 offen sc1
s_add_u32 s29, s38, s71
s_waitcnt lgkmcnt(1)
buffer_store_dwordx2 v[128:129], v204, s[8:11], s28 offen sc1
s_waitcnt lgkmcnt(0)
buffer_store_dwordx2 v[136:137], v204, s[8:11], s29 offen sc1
L_fin:
s_nop 1
s_cmp_lg_u32 s43, 0
s_cbranch_scc1 L_redo
L_end:
s_endpgm
.p2align 3
L_tailb:
v_mfma_f32_16x16x32_bf16 v[138:141], a[8:11], v[182:185], v[138:141]
s_add_u32 s41, s33, 0
buffer_store_dwordx2 v[128:129], v204, s[8:11], s28 offen sc1
v_add_f32 v106, v106, v107
v_mfma_f32_16x16x32_bf16 v[138:141], a[12:15], v[186:189], v[138:141]
s_add_u32 s28, s39, s66
v_add_f32 v104, v104, v105
v_add_f32_e64 v108, v108, v109
v_mfma_f32_16x16x32_bf16 v[142:145], a[32:35], v[182:185], v[142:145]
s_mov_b32 s42, 58835169
ds_read_b64 v[128:129], v204 offset:7448
v_add_f32_e64 v102, v102, v104
v_mfma_f32_16x16x32_bf16 v[142:145], a[36:39], v[186:189], v[142:145]
v_add_f32 v106, v106, v108
v_mul_f32 v103, s48, v102
v_mfma_f32_16x16x32_bf16 v[150:153], a[224:227], v[182:185], v[150:153]
v_mul_f32 v104, s73, v102
v_mul_f32 v106, s73, v106
v_mfma_f32_16x16x32_bf16 v[150:153], a[228:231], v[186:189], v[150:153]
v_fma_f32 v106, -v103, v104, v106
v_max_f32_e64 v106, 0, v106
v_mfma_f32_16x16x32_bf16 v[154:157], a[248:251], v[182:185], v[154:157]
v_add_f32 v106, s49, v106
v_mfma_f32_16x16x32_bf16 v[154:157], a[252:255], v[186:189], v[154:157]
v_rsq_f32 v102, v106
v_mfma_f32_16x16x32_bf16 v[158:161], v[240:243], v[182:185], v[158:161]
ds_read_b128 v[106:109], v210 offset:11264
v_mul_f32_e64 v103, -v103, v102
v_mfma_f32_16x16x32_bf16 v[158:161], v[244:247], v[186:189], v[158:161]
ds_write_b64 v211, v[102:103] offset:20480
v_mfma_f32_16x16x32_bf16 v[162:165], v[182:185], a[80:83], v[162:165]
s_nop 0
buffer_store_dwordx2 v[136:137], v204, s[8:11], s29 offen sc1
ds_read_b64 v[136:137], v204 offset:12544
v_mfma_f32_16x16x32_bf16 v[162:165], v[186:189], a[84:87], v[162:165]
s_add_u32 s29, s39, s67
ds_read_b64 v[118:119], v219 offset:20480
ds_read_b64 v[126:127], v219 offset:20736
v_mfma_f32_16x16x32_bf16 v[166:169], v[182:185], a[104:107], v[166:169]
ds_read_b64 v[134:135], v219 offset:20992
v_mfma_f32_16x16x32_bf16 v[166:169], v[186:189], a[108:111], v[166:169]
s_nop 0
buffer_store_dwordx2 v[120:121], v204, s[8:11], s28 offen sc1
ds_read_b64 v[120:121], v204 offset:12936
v_mfma_f32_16x16x32_bf16 v[170:173], v[182:185], a[128:131], v[170:173]
s_add_u32 s28, s39, s68
ds_read_b128 v[182:185], v210 offset:12288
v_mfma_f32_16x16x32_bf16 v[170:173], v[186:189], a[132:135], v[170:173]
ds_read_b128 v[186:189], v210 offset:13312
v_mfma_f32_16x16x32_bf16 v[138:141], a[16:19], v[110:113], v[138:141]
s_waitcnt lgkmcnt(5)
buffer_store_dwordx2 v[128:129], v204, s[8:11], s29 offen sc1
ds_read_b64 v[128:129], v204 offset:13328
v_mfma_f32_16x16x32_bf16 v[138:141], a[20:23], v[106:109], v[138:141]
s_add_u32 s29, s39, s69
v_fma_f32 v220, v36, v118, v119
v_fma_f32 v221, v37, v118, v119
v_mfma_f32_16x16x32_bf16 v[142:145], a[40:43], v[110:113], v[142:145]
v_fma_f32 v222, v38, v118, v119
v_fma_f32 v223, v39, v118, v119
v_mfma_f32_16x16x32_bf16 v[142:145], a[44:47], v[106:109], v[142:145]
s_nop 0
buffer_store_dwordx2 v[136:137], v204, s[8:11], s28 offen sc1
ds_read_b64 v[136:137], v204 offset:13720
v_mfma_f32_16x16x32_bf16 v[146:149], a[64:67], v[110:113], v[146:149]
s_add_u32 s28, s39, s70
v_cvt_pk_bf16_f32 v96, v138, v139
v_cvt_pk_bf16_f32 v97, v140, v141
v_mfma_f32_16x16x32_bf16 v[146:149], a[68:71], v[106:109], v[146:149]
s_nop 0
v_cvt_pk_bf16_f32 v98, v142, v143
v_cvt_pk_bf16_f32 v99, v144, v145
v_mfma_f32_16x16x32_bf16 v[150:153], a[232:235], v[110:113], v[150:153]
s_waitcnt lgkmcnt(4)
buffer_store_dwordx2 v[120:121], v204, s[8:11], s29 offen sc1
v_cvt_pk_bf16_f32 v90, v220, v221
v_mfma_f32_16x16x32_bf16 v[150:153], a[236:239], v[106:109], v[150:153]
s_add_u32 s29, s39, s71
v_cvt_pk_bf16_f32 v100, v146, v147
v_cvt_pk_bf16_f32 v101, v148, v149
v_mfma_f32_16x16x32_bf16 v[154:157], v[224:227], v[110:113], v[154:157]
s_mov_b32 s39, s37
v_cvt_pk_bf16_f32 v91, v222, v223
v_fma_f32 v220, v40, v118, v119
v_mfma_f32_16x16x32_bf16 v[154:157], v[228:231], v[106:109], v[154:157]
s_waitcnt lgkmcnt(1)
buffer_store_dwordx2 v[128:129], v204, s[8:11], s28 offen sc1
v_cvt_pk_bf16_f32 v84, v150, v151
v_mfma_f32_16x16x32_bf16 v[158:161], v[248:251], v[110:113], v[158:161]
s_add_u32 s28, s38, s60
v_cvt_pk_bf16_f32 v85, v152, v153
v_fma_f32 v221, v41, v118, v119
v_mfma_f32_16x16x32_bf16 v[158:161], v[252:255], v[106:109], v[158:161]
v_cvt_pk_bf16_f32 v86, v154, v155
v_cvt_pk_bf16_f32 v87, v156, v157
v_mfma_f32_16x16x32_bf16 v[162:165], v[110:113], a[88:91], v[162:165]
s_waitcnt lgkmcnt(0)
buffer_store_dwordx2 v[136:137], v204, s[8:11], s29 offen sc1
v_fma_f32 v222, v42, v118, v119
v_mfma_f32_16x16x32_bf16 v[162:165], v[106:109], a[92:95], v[162:165]
s_add_u32 s29, s38, s61
v_cvt_pk_bf16_f32 v88, v158, v159
v_cvt_pk_bf16_f32 v89, v160, v161
v_mfma_f32_16x16x32_bf16 v[166:169], v[110:113], a[112:115], v[166:169]
v_fma_f32 v223, v43, v118, v119
v_cvt_pk_bf16_f32 v92, v220, v221
v_mfma_f32_16x16x32_bf16 v[166:169], v[106:109], a[116:119], v[166:169]
v_cvt_pk_bf16_f32 v93, v222, v223
v_fma_f32 v220, v44, v118, v119
v_mfma_f32_16x16x32_bf16 v[170:173], v[110:113], a[136:139], v[170:173]
ds_read_b64 v[112:113], v215 offset:528
v_fma_f32 v221, v45, v118, v119
v_mfma_f32_16x16x32_bf16 v[170:173], v[106:109], a[140:143], v[170:173]
ds_read_b128 v[108:111], v215 offset:512
v_fma_f32 v222, v46, v118, v119
v_mfma_f32_16x16x32_bf16 v[138:141], a[0:3], v[182:185], 0
ds_write_b128 v211, v[90:93] offset:20480
v_mfma_f32_16x16x32_bf16 v[138:141], a[4:7], v[186:189], v[138:141]
v_cvt_pk_bf16_f32 v132, v170, v171
v_cvt_pk_bf16_f32 v133, v172, v173
v_mfma_f32_16x16x32_bf16 v[142:145], a[24:27], v[182:185], 0
v_fma_f32 v223, v47, v118, v119
v_cvt_pk_bf16_f32 v94, v220, v221
v_mfma_f32_16x16x32_bf16 v[142:145], a[28:31], v[186:189], v[142:145]
ds_read_b128 v[170:173], v210 offset:14336
v_cvt_pk_bf16_f32 v95, v222, v223
v_mfma_f32_16x16x32_bf16 v[146:149], a[48:51], v[182:185], 0
s_nop 0
ds_read_b128 v[182:185], v210 offset:15360
v_fma_f32 v220, v48, v126, v127
v_mfma_f32_16x16x32_bf16 v[146:149], a[52:55], v[186:189], v[146:149]
s_waitcnt lgkmcnt(3)
ds_read_b128 v[186:189], v210 offset:16384
v_fma_f32 v221, v49, v126, v127
v_mfma_f32_16x16x32_bf16 v[150:153], v[108:111], v[72:75], v[206:209]
ds_write_b64 v212, v[94:95] offset:20480
v_mfma_f32_16x16x16_bf16 v[154:157], v[82:83], v[88:89], 0
v_fma_f32 v222, v50, v126, v127
v_fma_f32 v223, v51, v126, v127
v_cvt_pk_bf16_f32 v174, v220, v221
v_mfma_f32_16x16x16_bf16 v[158:161], v[100:101], v[88:89], 0
v_cvt_pk_bf16_f32 v175, v222, v223
v_fma_f32 v220, v52, v126, v127
v_fma_f32 v221, v53, v126, v127
s_waitcnt lgkmcnt(3)
v_mfma_f32_16x16x32_bf16 v[138:141], a[8:11], v[170:173], v[138:141]
s_waitcnt lgkmcnt(2)
v_fma_f32 v222, v54, v126, v127
v_fma_f32 v223, v55, v126, v127
v_mfma_f32_16x16x32_bf16 v[138:141], a[12:15], v[182:185], v[138:141]
v_cvt_pk_bf16_f32 v176, v220, v221
v_cvt_pk_bf16_f32 v177, v222, v223
v_mfma_f32_16x16x32_bf16 v[142:145], a[32:35], v[170:173], v[142:145]
ds_write_b128 v211, v[174:177] offset:26624
v_mfma_f32_16x16x32_bf16 v[142:145], a[36:39], v[182:185], v[142:145]
v_fma_f32 v220, v56, v126, v127
v_fma_f32 v221, v57, v126, v127
v_mfma_f32_16x16x32_bf16 v[146:149], a[56:59], v[170:173], v[146:149]
v_fma_f32 v222, v58, v126, v127
v_fma_f32 v223, v59, v126, v127
v_mfma_f32_16x16x32_bf16 v[146:149], a[60:63], v[182:185], v[146:149]
ds_read_b128 v[182:185], v210 offset:12288
ds_read_b128 v[170:173], v210 offset:17408
v_mfma_f32_16x16x32_bf16 v[154:157], v[78:81], v[84:87], v[154:157]
ds_read_b128 v[174:177], v210 offset:14336
v_cvt_pk_bf16_f32 v124, v166, v167
v_mfma_f32_16x16x32_bf16 v[158:161], v[96:99], v[84:87], v[158:161]
s_nop 0
v_cvt_pk_bf16_f32 v125, v168, v169
v_cvt_pk_bf16_f32 v178, v220, v221
s_waitcnt lgkmcnt(5)
v_mfma_f32_16x16x16_bf16 v[166:169], v[112:113], v[88:89], v[206:209]
v_cvt_pk_bf16_f32 v179, v222, v223
v_fma_f32 v220, v60, v134, v135
v_fma_f32 v221, v61, v134, v135
v_mfma_f32_16x16x16_bf16 v[150:153], v[112:113], v[76:77], v[150:153]
v_fma_f32 v222, v62, v134, v135
v_fma_f32 v223, v63, v134, v135
v_cvt_pk_bf16_f32 v90, v220, v221
v_cvt_pk_bf16_f32 v91, v222, v223
v_mfma_f32_16x16x32_bf16 v[138:141], a[16:19], v[186:189], v[138:141]
s_waitcnt lgkmcnt(2)
ds_write_b64 v212, v[178:179] offset:26624
v_mfma_f32_16x16x32_bf16 v[118:121], v[182:185], a[72:75], 0
v_fma_f32 v220, v64, v134, v135
v_fma_f32 v221, v65, v134, v135
v_mfma_f32_16x16x32_bf16 v[126:129], v[182:185], a[96:99], 0
s_waitcnt lgkmcnt(2)
ds_read_b128 v[178:181], v210 offset:15360
v_fma_f32 v222, v66, v134, v135
v_mfma_f32_16x16x32_bf16 v[138:141], a[20:23], v[170:173], v[138:141]
v_fma_f32 v223, v67, v134, v135
v_cvt_pk_bf16_f32 v92, v220, v221
v_mfma_f32_16x16x32_bf16 v[166:169], v[108:111], v[84:87], v[166:169]
v_cvt_pk_bf16_f32 v93, v222, v223
v_fma_f32 v220, v68, v134, v135
v_mfma_f32_16x16x32_bf16 v[142:145], a[40:43], v[186:189], v[142:145]
v_cvt_pk_bf16_f32 v102, v138, v139
v_cvt_pk_bf16_f32 v103, v140, v141
v_mfma_f32_16x16x32_bf16 v[138:141], v[78:81], v[72:75], 0
ds_write_b128 v211, v[90:93] offset:32768
v_mfma_f32_16x16x16_bf16 v[138:141], v[82:83], v[76:77], v[138:141]
v_fma_f32 v221, v69, v134, v135
v_fma_f32 v222, v70, v134, v135
v_fma_f32 v223, v71, v134, v135
v_cvt_pk_bf16_f32 v116, v162, v163
v_mfma_f32_16x16x32_bf16 v[134:137], v[182:185], a[120:123], 0
v_cvt_pk_bf16_f32 v117, v164, v165
v_cvt_pk_bf16_f32 v94, v220, v221
v_mfma_f32_16x16x32_bf16 v[90:93], a[216:219], v[182:185], 0
v_exp_f32 v138, v138
v_mfma_f32_16x16x32_bf16 v[142:145], a[44:47], v[170:173], v[142:145]
v_exp_f32 v139, v139
v_mfma_f32_16x16x32_bf16 v[146:149], a[64:67], v[186:189], v[146:149]
ds_read_b128 v[186:189], v210 offset:13312
v_cvt_pk_bf16_f32 v95, v222, v223
v_mfma_f32_16x16x32_bf16 v[220:223], v[232:235], v[182:185], 0
v_cvt_pk_bf16_f32 v104, v142, v143
v_cvt_pk_bf16_f32 v105, v144, v145
v_mfma_f32_16x16x32_bf16 v[142:145], v[96:99], v[72:75], 0
v_exp_f32 v140, v140
v_mfma_f32_16x16x32_bf16 v[146:149], a[68:71], v[170:173], v[146:149]
v_exp_f32 v141, v141
v_mfma_f32_16x16x32_bf16 v[170:173], a[240:243], v[182:185], 0
ds_read_b128 v[182:185], v210 offset:16384
v_exp_f32_e64 v154, v154
v_mfma_f32_16x16x16_bf16 v[142:145], v[100:101], v[76:77], v[142:145]
v_cvt_pk_bf16_f32 v106, v146, v147
v_cvt_pk_bf16_f32 v107, v148, v149
v_exp_f32 v155, v155
v_mfma_f32_16x16x32_bf16 v[146:149], v[102:105], v[72:75], 0
s_waitcnt lgkmcnt(1)
v_exp_f32 v156, v156
v_mfma_f32_16x16x32_bf16 v[118:121], v[186:189], a[76:79], v[118:121]
v_exp_f32 v142, v142
v_mfma_f32_16x16x32_bf16 v[126:129], v[186:189], a[100:103], v[126:129]
v_exp_f32 v143, v143
v_mfma_f32_16x16x32_bf16 v[134:137], v[186:189], a[124:127], v[134:137]
v_exp_f32 v144, v144
v_mfma_f32_16x16x32_bf16 v[90:93], a[220:223], v[186:189], v[90:93]
v_exp_f32 v145, v145
v_mfma_f32_16x16x32_bf16 v[170:173], a[244:247], v[186:189], v[170:173]
v_exp_f32 v157, v157
v_mfma_f32_16x16x32_bf16 v[220:223], v[236:239], v[186:189], v[220:223]
ds_read_b128 v[186:189], v210 offset:17408
ds_read_b128 v[72:75], v215
v_mfma_f32_16x16x32_bf16 v[118:121], v[174:177], a[80:83], v[118:121]
v_exp_f32 v158, v158
v_mfma_f32_16x16x32_bf16 v[118:121], v[178:181], a[84:87], v[118:121]
v_exp_f32 v159, v159
v_mfma_f32_16x16x32_bf16 v[126:129], v[174:177], a[104:107], v[126:129]
v_exp_f32 v160, v160
v_mfma_f32_16x16x32_bf16 v[126:129], v[178:181], a[108:111], v[126:129]
v_exp_f32 v161, v161
v_mfma_f32_16x16x16_bf16 v[162:165], v[106:107], v[88:89], 0
v_exp_f32 v150, v150
v_exp_f32 v166, v166
v_mfma_f32_16x16x32_bf16 v[134:137], v[174:177], a[128:131], v[134:137]
ds_write_b64 v212, v[94:95] offset:32768
v_mfma_f32_16x16x32_bf16 v[134:137], v[178:181], a[132:135], v[134:137]
v_mfma_f32_16x16x32_bf16 v[90:93], a[224:227], v[174:177], v[90:93]
v_mfma_f32_16x16x32_bf16 v[90:93], a[228:231], v[178:181], v[90:93]
v_mfma_f32_16x16x32_bf16 v[170:173], a[248:251], v[174:177], v[170:173]
v_mfma_f32_16x16x32_bf16 v[170:173], a[252:255], v[178:181], v[170:173]
v_mfma_f32_16x16x32_bf16 v[220:223], v[240:243], v[174:177], v[220:223]
v_cvt_pk_bf16_f32 v174, v138, v139
v_cvt_pk_bf16_f32 v175, v140, v141
v_mfma_f32_16x16x32_bf16 v[220:223], v[244:247], v[178:181], v[220:223]
v_cvt_pk_bf16_f32 v176, v142, v143
v_cvt_pk_bf16_f32 v177, v144, v145
v_mfma_f32_16x16x32_bf16 v[162:165], v[102:105], v[84:87], v[162:165]
s_waitcnt lgkmcnt(3)
v_cvt_pk_bf16_f32 v180, v150, 0
v_mov_b32 v181, 0
v_mfma_f32_16x16x32_bf16 v[118:121], v[182:185], a[88:91], v[118:121]
s_waitcnt lgkmcnt(2)
v_mfma_f32_16x16x16_bf16 v[146:149], v[106:107], v[76:77], v[146:149]
v_exp_f32 v162, v162
v_exp_f32 v163, v163
v_mfma_f32_16x16x32_bf16 v[118:121], v[186:189], a[92:95], v[118:121]
v_exp_f32 v164, v164
v_mfma_f32_16x16x32_bf16 v[126:129], v[182:185], a[112:115], v[126:129]
v_exp_f32 v146, v146
v_mfma_f32_16x16x32_bf16 v[126:129], v[186:189], a[116:119], v[126:129]
v_exp_f32 v147, v147
v_mfma_f32_16x16x32_bf16 v[134:137], v[182:185], a[136:139], v[134:137]
v_exp_f32 v148, v148
v_mfma_f32_16x16x32_bf16 v[134:137], v[186:189], a[140:143], v[134:137]
v_exp_f32 v149, v149
v_mfma_f32_16x16x32_bf16 v[90:93], a[232:235], v[182:185], v[90:93]
v_exp_f32_e64 v165, v165
v_mfma_f32_16x16x32_bf16 v[90:93], a[236:239], v[186:189], v[90:93]
v_cvt_pk_bf16_f32 v178, v146, v147
v_cvt_pk_bf16_f32 v179, v148, v149
v_mfma_f32_16x16x32_bf16 v[170:173], v[224:227], v[182:185], v[170:173]
v_cvt_pk_bf16_f32 v118, v118, v119
v_cvt_pk_bf16_f32 v119, v120, v121
v_mfma_f32_16x16x32_bf16 v[170:173], v[228:231], v[186:189], v[170:173]
ds_read_u16 v120, v205
v_mov_b32_e64 v121, 0
v_mfma_f32_16x16x32_bf16 v[220:223], v[248:251], v[182:185], v[220:223]
v_cvt_pk_bf16_f32 v126, v126, v127
v_cvt_pk_bf16_f32 v127, v128, v129
v_mfma_f32_16x16x32_bf16 v[220:223], v[252:255], v[186:189], v[220:223]
ds_read_u16 v128, v205 offset:32
v_mov_b32_e64 v129, 0
v_mfma_f32_16x16x32_bf16 v[150:153], v[190:193], v[174:177], 0
v_cvt_pk_bf16_f32 v134, v134, v135
v_cvt_pk_bf16_f32 v135, v136, v137
v_mfma_f32_16x16x32_bf16 v[150:153], v[190:193], v[178:181], v[150:153]
s_nop 0
ds_read_u16 v136, v205 offset:64
v_cvt_pk_bf16_f32 v90, v90, v91
v_mfma_f32_16x16x32_bf16 v[138:141], v[114:117], v[174:177], 0
s_waitcnt lgkmcnt(2)
v_cvt_pk_bf16_f32 v91, v92, v93
v_cvt_pk_bf16_f32 v92, v170, v171
v_mfma_f32_16x16x32_bf16 v[138:141], v[118:121], v[178:181], v[138:141]
v_rcp_f32 v151, v150
v_mfma_f32_16x16x32_bf16 v[142:145], v[122:125], v[174:177], 0
s_waitcnt lgkmcnt(1)
v_mul_f32_e64 v152, s3, v151
v_cvt_pk_bf16_f32 v93, v172, v173
v_mfma_f32_16x16x32_bf16 v[142:145], v[126:129], v[178:181], v[142:145]
v_mul_f32 v138, v138, v152
v_mul_f32 v139, v139, v152
v_mfma_f32_16x16x32_bf16 v[146:149], v[130:133], v[174:177], 0
v_cvt_pk_bf16_f32 v174, v154, v155
v_cvt_pk_bf16_f32 v175, v156, v157
v_cvt_pk_bf16_f32 v176, v158, v159
v_cvt_pk_bf16_f32 v177, v160, v161
v_mul_f32 v140, v140, v152
v_mul_f32 v141, v141, v152
v_mfma_f32_16x16x32_bf16 v[154:157], v[114:117], v[174:177], 0
v_cvt_pk_bf16_f32 v138, v138, v139
v_mul_f32_e64 v142, v142, v152
v_mfma_f32_16x16x32_bf16 v[158:161], v[122:125], v[174:177], 0
s_waitcnt lgkmcnt(0)
v_mul_f32 v143, v143, v152
v_mul_f32 v144, v144, v152
v_mul_f32 v145, v145, v152
v_cvt_pk_bf16_f32 v139, v140, v141
v_cvt_pk_bf16_f32 v140, v142, v143
v_cvt_pk_bf16_f32 v141, v144, v145
v_mov_b32_e64 v137, 0
v_max3_u32 v218, v218, v150, v151
v_cvt_pk_bf16_f32 v94, v220, v221
v_mfma_f32_16x16x32_bf16 v[146:149], v[134:137], v[178:181], v[146:149]
v_cvt_pk_bf16_f32 v180, v166, 0
v_cvt_pk_bf16_f32 v178, v162, v163
v_mfma_f32_16x16x32_bf16 v[166:169], v[190:193], v[174:177], 0
s_nop 0
v_cvt_pk_bf16_f32 v179, v164, v165
v_cvt_pk_bf16_f32 v95, v222, v223
s_nop 0
v_mfma_f32_16x16x32_bf16 v[166:169], v[190:193], v[178:181], v[166:169]
ds_write_b128 v211, v[138:141] offset:38912
v_mfma_f32_16x16x32_bf16 v[154:157], v[118:121], v[178:181], v[154:157]
v_rcp_f32 v167, v166
v_mfma_f32_16x16x32_bf16 v[158:161], v[126:129], v[178:181], v[158:161]
v_mul_f32 v168, s3, v167
v_mul_f32_e64 v146, v146, v152
v_mfma_f32_16x16x32_bf16 v[162:165], v[130:133], v[174:177], 0
v_mul_f32 v154, v154, v168
v_mul_f32 v155, v155, v168
v_mfma_f32_16x16x32_bf16 v[162:165], v[134:137], v[178:181], v[162:165]
v_mul_f32 v156, v156, v168
v_mul_f32 v157, v157, v168
v_mfma_f32_16x16x32_bf16 v[138:141], v[78:81], v[90:93], 0
v_cvt_pk_bf16_f32 v154, v154, v155
v_mul_f32 v158, v158, v168
v_mul_f32 v159, v159, v168
v_mul_f32 v160, v160, v168
v_mul_f32 v161, v161, v168
v_mfma_f32_16x16x16_bf16 v[138:141], v[82:83], v[94:95], v[138:141]
v_cvt_pk_bf16_f32 v155, v156, v157
v_cvt_pk_bf16_f32 v156, v158, v159
v_cvt_pk_bf16_f32 v157, v160, v161
v_mul_f32 v147, v147, v152
v_mul_f32 v148, v148, v152
v_mul_f32_e64 v149, v149, v152
v_mfma_f32_16x16x32_bf16 v[150:153], v[108:111], v[90:93], v[206:209]
ds_write_b128 v211, v[154:157] offset:45056
v_mfma_f32_16x16x16_bf16 v[150:153], v[112:113], v[94:95], v[150:153]
v_mul_f32 v162, v162, v168
v_mul_f32 v163, v163, v168
v_mul_f32 v164, v164, v168
v_mul_f32 v165, v165, v168
v_cvt_pk_bf16_f32 v142, v146, v147
v_cvt_pk_bf16_f32 v143, v148, v149
v_mfma_f32_16x16x32_bf16 v[146:149], v[102:105], v[90:93], 0
ds_write_b64 v212, v[142:143] offset:38912
v_mfma_f32_16x16x32_bf16 v[142:145], v[96:99], v[90:93], 0
v_cvt_pk_bf16_f32 v158, v162, v163
v_cvt_pk_bf16_f32 v159, v164, v165
v_exp_f32_e64 v138, v138
v_mfma_f32_16x16x16_bf16 v[146:149], v[106:107], v[94:95], v[146:149]
v_exp_f32 v139, v139
s_nop 0
v_cvt_pk_bf16_f32 v174, v138, v139
v_mfma_f32_16x16x16_bf16 v[142:145], v[100:101], v[94:95], v[142:145]
ds_write_b64 v212, v[158:159] offset:45056
v_exp_f32 v140, v140
v_exp_f32 v141, v141
s_nop 1
v_exp_f32 v142, v142
v_exp_f32 v143, v143
v_exp_f32 v144, v144
v_exp_f32 v145, v145
v_exp_f32 v150, v150
v_cvt_pk_bf16_f32 v175, v140, v141
v_cvt_pk_bf16_f32 v176, v142, v143
v_cvt_pk_bf16_f32 v177, v144, v145
v_cvt_pk_bf16_f32 v180, v150, 0
v_max3_u32 v218, v218, v166, v167
v_mfma_f32_16x16x32_bf16 v[150:153], v[190:193], v[174:177], 0
s_waitcnt lgkmcnt(0)
v_exp_f32 v146, v146
v_mfma_f32_16x16x32_bf16 v[138:141], v[114:117], v[174:177], 0
s_barrier
v_mfma_f32_16x16x32_bf16 v[142:145], v[122:125], v[174:177], 0
ds_read_b128 v[220:223], v210 offset:38912
ds_read_b128 v[170:173], v210 offset:40960
v_exp_f32 v147, v147
v_exp_f32 v148, v148
v_exp_f32 v149, v149
v_cvt_pk_bf16_f32 v178, v146, v147
v_cvt_pk_bf16_f32 v179, v148, v149
v_mfma_f32_16x16x32_bf16 v[146:149], v[130:133], v[174:177], 0
ds_read_b128 v[182:185], v210 offset:41984
ds_read_b128 v[186:189], v210 offset:43008
v_mfma_f32_16x16x32_bf16 v[150:153], v[190:193], v[178:181], v[150:153]
ds_read_b64 v[76:77], v215 offset:16
ds_read_b128 v[174:177], v210 offset:34816
v_mfma_f32_16x16x32_bf16 v[138:141], v[118:121], v[178:181], v[138:141]
v_add_u32 v205, 1424, v205
v_mfma_f32_16x16x32_bf16 v[142:145], v[126:129], v[178:181], v[142:145]
s_waitcnt lgkmcnt(5)
v_rcp_f32 v151, v150
v_mfma_f32_16x16x32_bf16 v[0:3], a[144:147], v[220:223], v[0:3]
v_mul_f32 v152, s3, v151
v_mul_f32 v138, v138, v152
v_mfma_f32_16x16x32_bf16 v[4:7], a[168:171], v[220:223], v[4:7]
v_mul_f32 v139, v139, v152
v_mul_f32 v140, v140, v152
v_mfma_f32_16x16x32_bf16 v[8:11], a[192:195], v[220:223], v[8:11]
ds_read_b128 v[220:223], v210 offset:44032
v_mul_f32 v141, v141, v152
v_mfma_f32_16x16x32_bf16 v[146:149], v[134:137], v[178:181], v[146:149]
s_waitcnt lgkmcnt(2)
v_cvt_pk_bf16_f32 v138, v138, v139
v_mul_f32 v142, v142, v152
v_mul_f32 v143, v143, v152
v_mfma_f32_16x16x16_bf16 v[154:157], v[76:77], v[82:83], 0
v_mul_f32 v144, v144, v152
v_mul_f32 v145, v145, v152
v_cvt_pk_bf16_f32 v139, v140, v141
v_mfma_f32_16x16x16_bf16 v[158:161], v[76:77], v[100:101], 0
v_cvt_pk_bf16_f32 v140, v142, v143
v_cvt_pk_bf16_f32 v141, v144, v145
v_mul_f32_e64 v146, v146, v152
v_mfma_f32_16x16x16_bf16 v[162:165], v[76:77], v[106:107], 0
v_mul_f32 v147, v147, v152
v_mul_f32 v148, v148, v152
v_mul_f32_e64 v149, v149, v152
v_mfma_f32_16x16x16_bf16 v[166:169], v[76:77], v[112:113], v[206:209]
v_cvt_pk_bf16_f32 v142, v146, v147
v_cvt_pk_bf16_f32 v143, v148, v149
v_max3_u32 v218, v218, v150, v151
v_mfma_f32_16x16x32_bf16 v[154:157], v[72:75], v[78:81], v[154:157]
ds_write_b128 v211, v[138:141] offset:51200
v_mfma_f32_16x16x32_bf16 v[158:161], v[72:75], v[96:99], v[158:161]
v_mfma_f32_16x16x32_bf16 v[162:165], v[72:75], v[102:105], v[162:165]
v_mfma_f32_16x16x32_bf16 v[166:169], v[72:75], v[108:111], v[166:169]
ds_read_b128 v[110:113], v210 offset:39936
ds_write_b64 v212, v[142:143] offset:51200
v_mov_b32_dpp v154, v158 quad_perm:[0,1,2,3] row_mask:0x2 bank_mask:0xf
s_nop 1
v_mov_b32_dpp v154, v162 quad_perm:[0,1,2,3] row_mask:0x4 bank_mask:0xf
s_nop 1
v_mov_b32_dpp v154, v167 quad_perm:[0,1,2,3] row_mask:0x8 bank_mask:0xf
v_exp_f32 v154, v154
s_nop 0
v_cvt_pk_bf16_f32 v154, v154, 0
ds_write_b16 v214, v154
ds_read_b128 v[84:87], v215
s_waitcnt lgkmcnt(3)
v_mfma_f32_16x16x32_bf16 v[0:3], a[148:151], v[110:113], v[0:3]
s_nop 0
ds_read_b128 v[88:91], v215 offset:16
v_add_u32 v215, 1424, v215
v_mfma_f32_16x16x32_bf16 v[0:3], a[152:155], v[170:173], v[0:3]
ds_read_b128 v[178:181], v210 offset:35840
v_mfma_f32_16x16x32_bf16 v[0:3], a[156:159], v[182:185], v[0:3]
v_mfma_f32_16x16x32_bf16 v[4:7], a[172:175], v[110:113], v[4:7]
v_mfma_f32_16x16x32_bf16 v[4:7], a[176:179], v[170:173], v[4:7]
v_mfma_f32_16x16x32_bf16 v[4:7], a[180:183], v[182:185], v[4:7]
v_mfma_f32_16x16x32_bf16 v[8:11], a[196:199], v[110:113], v[8:11]
ds_read_b128 v[110:113], v210 offset:45056
v_mfma_f32_16x16x32_bf16 v[8:11], a[200:203], v[170:173], v[8:11]
ds_read_b128 v[170:173], v210 offset:46080
v_mfma_f32_16x16x32_bf16 v[8:11], a[204:207], v[182:185], v[8:11]
ds_read_b128 v[182:185], v210 offset:47104
v_mfma_f32_16x16x32_bf16 v[8:11], a[208:211], v[186:189], v[8:11]
v_mfma_f32_16x16x32_bf16 v[8:11], a[212:215], v[220:223], v[8:11]
v_mfma_f32_16x16x32_bf16 v[0:3], a[160:163], v[186:189], v[0:3]
v_mfma_f32_16x16x32_bf16 v[0:3], a[164:167], v[220:223], v[0:3]
v_cvt_pk_bf16_f32 v8, v8, v9
v_cvt_pk_bf16_f32 v9, v10, v11
v_mfma_f32_16x16x32_bf16 v[4:7], a[184:187], v[186:189], v[4:7]
s_nop 0
ds_read_b128 v[186:189], v210 offset:48128
v_mfma_f32_16x16x32_bf16 v[4:7], a[188:191], v[220:223], v[4:7]
s_waitcnt lgkmcnt(3)
ds_read_b128 v[220:223], v210 offset:49152
v_cvt_pk_bf16_f32 v0, v0, v1
v_mfma_f32_16x16x32_bf16 v[12:15], a[144:147], v[110:113], v[12:15]
s_waitcnt lgkmcnt(3)
ds_write_b64 v203, v[8:9] offset:64
v_mfma_f32_16x16x32_bf16 v[12:15], a[148:151], v[170:173], v[12:15]
s_waitcnt lgkmcnt(3)
buffer_load_dwordx4 v[8:11], v210, s[24:27], s58 offen offset:2048
v_mfma_f32_16x16x32_bf16 v[12:15], a[152:155], v[182:185], v[12:15]
v_cvt_pk_bf16_f32 v1, v2, v3
v_cvt_pk_bf16_f32 v4, v4, v5
v_mfma_f32_16x16x32_bf16 v[16:19], a[168:171], v[110:113], v[16:19]
ds_write_b64 v203, v[0:1]
v_mfma_f32_16x16x32_bf16 v[16:19], a[172:175], v[170:173], v[16:19]
buffer_load_dwordx4 v[0:3], v210, s[24:27], s58 offen
v_mfma_f32_16x16x32_bf16 v[16:19], a[176:179], v[182:185], v[16:19]
s_nop 0
v_cvt_pk_bf16_f32 v5, v6, v7
s_waitcnt lgkmcnt(3)
v_mfma_f32_16x16x32_bf16 v[16:19], a[180:183], v[186:189], v[16:19]
ds_write_b64 v203, v[4:5] offset:32
v_mfma_f32_16x16x32_bf16 v[20:23], a[192:195], v[110:113], v[20:23]
buffer_load_dwordx4 v[4:7], v210, s[24:27], s58 offen offset:1024
v_mfma_f32_16x16x32_bf16 v[20:23], a[196:199], v[170:173], v[20:23]
ds_read_b128 v[110:113], v210 offset:50176
v_mfma_f32_16x16x32_bf16 v[20:23], a[200:203], v[182:185], v[20:23]
v_mfma_f32_16x16x32_bf16 v[20:23], a[204:207], v[186:189], v[20:23]
v_mfma_f32_16x16x32_bf16 v[12:15], a[156:159], v[186:189], v[12:15]
s_waitcnt lgkmcnt(4)
v_mfma_f32_16x16x32_bf16 v[12:15], a[160:163], v[220:223], v[12:15]
s_waitcnt lgkmcnt(1)
s_barrier
v_mfma_f32_16x16x32_bf16 v[16:19], a[184:187], v[220:223], v[16:19]
s_waitcnt lgkmcnt(0)
ds_read_b128 v[170:173], v210 offset:51200
ds_read_b128 v[182:185], v210 offset:52224
v_mfma_f32_16x16x32_bf16 v[16:19], a[188:191], v[110:113], v[16:19]
ds_read_b128 v[186:189], v210 offset:53248
v_mfma_f32_16x16x32_bf16 v[12:15], a[164:167], v[110:113], v[12:15]
v_mfma_f32_16x16x32_bf16 v[20:23], a[208:211], v[220:223], v[20:23]
ds_read_b128 v[220:223], v210 offset:54272
v_cvt_pk_bf16_f32 v16, v16, v17
v_mfma_f32_16x16x32_bf16 v[20:23], a[212:215], v[110:113], v[20:23]
ds_read_b128 v[110:113], v210 offset:55296
v_cvt_pk_bf16_f32 v12, v12, v13
v_mfma_f32_16x16x32_bf16 v[166:169], v[84:87], v[190:193], 0
v_cvt_pk_bf16_f32 v17, v18, v19
v_cvt_pk_bf16_f32 v13, v14, v15
v_mfma_f32_16x16x32_bf16 v[166:169], v[88:91], v[190:193], v[166:169]
ds_write_b64 v203, v[16:17] offset:6304
v_mfma_f32_16x16x32_bf16 v[154:157], v[84:87], v[114:117], 0
v_cvt_pk_bf16_f32 v20, v20, v21
v_cvt_pk_bf16_f32 v21, v22, v23
v_mfma_f32_16x16x32_bf16 v[154:157], v[88:91], v[118:121], v[154:157]
v_rcp_f32 v167, v166
v_mfma_f32_16x16x32_bf16 v[158:161], v[84:87], v[122:125], 0
v_mul_f32 v168, s3, v167
v_max3_u32 v218, v218, v166, v167
v_mfma_f32_16x16x32_bf16 v[158:161], v[88:91], v[126:129], v[158:161]
ds_read_b64 v[120:121], v204
ds_read_b64 v[128:129], v204 offset:392
v_mfma_f32_16x16x32_bf16 v[162:165], v[84:87], v[130:133], 0
ds_write_b64 v203, v[12:13] offset:6272
v_mfma_f32_16x16x32_bf16 v[162:165], v[88:91], v[134:137], v[162:165]
v_mov_b32_dpp v154, v158 quad_perm:[0,1,2,3] row_mask:0x2 bank_mask:0xf
s_waitcnt lgkmcnt(8)
v_mfma_f32_16x16x32_bf16 v[24:27], a[144:147], v[170:173], v[24:27]
s_waitcnt lgkmcnt(7)
ds_write_b64 v203, v[20:21] offset:6336
v_mfma_f32_16x16x32_bf16 v[24:27], a[148:151], v[182:185], v[24:27]
s_waitcnt lgkmcnt(7)
v_mov_b32_dpp v154, v162 quad_perm:[0,1,2,3] row_mask:0x4 bank_mask:0xf
v_mul_f32 v154, v154, v168
v_mfma_f32_16x16x32_bf16 v[24:27], a[152:155], v[186:189], v[24:27]
s_nop 0
v_cvt_pk_bf16_f32 v154, v154, 0
s_waitcnt lgkmcnt(6)
v_mfma_f32_16x16x32_bf16 v[24:27], a[156:159], v[220:223], v[24:27]
ds_write_b16 v214, v154
v_mfma_f32_16x16x32_bf16 v[28:31], a[168:171], v[170:173], v[28:31]
ds_read_b64 v[136:137], v204 offset:784
v_add_u32 v214, 1424, v214
v_mfma_f32_16x16x32_bf16 v[28:31], a[172:175], v[182:185], v[28:31]
s_waitcnt lgkmcnt(5)
buffer_store_dwordx2 v[120:121], v204, s[8:11], s28 offen sc1
ds_read_b64 v[120:121], v204 offset:1176
v_mfma_f32_16x16x32_bf16 v[28:31], a[176:179], v[186:189], v[28:31]
s_add_u32 s28, s38, s62
buffer_load_dwordx4 v[12:15], v210, s[24:27], s59 offen
v_mfma_f32_16x16x32_bf16 v[28:31], a[180:183], v[220:223], v[28:31]
buffer_load_dwordx4 v[16:19], v210, s[24:27], s59 offen offset:1024
v_mfma_f32_16x16x32_bf16 v[32:35], a[192:195], v[170:173], v[32:35]
ds_read_b128 v[170:173], v210 offset:56320
v_mfma_f32_16x16x32_bf16 v[32:35], a[196:199], v[182:185], v[32:35]
ds_read_b128 v[182:185], v210 offset:20480
v_mfma_f32_16x16x32_bf16 v[32:35], a[200:203], v[186:189], v[32:35]
ds_read_b128 v[186:189], v210 offset:21504
v_mfma_f32_16x16x32_bf16 v[32:35], a[204:207], v[220:223], v[32:35]
ds_read_b128 v[220:223], v210 offset:23552
v_mfma_f32_16x16x32_bf16 v[32:35], a[208:211], v[110:113], v[32:35]
buffer_load_dwordx4 v[20:23], v210, s[24:27], s59 offen offset:2048
v_mfma_f32_16x16x32_bf16 v[24:27], a[160:163], v[110:113], v[24:27]
s_waitcnt lgkmcnt(3)
v_mfma_f32_16x16x32_bf16 v[24:27], a[164:167], v[170:173], v[24:27]
v_mfma_f32_16x16x32_bf16 v[28:31], a[184:187], v[110:113], v[28:31]
ds_read_b128 v[110:113], v210 offset:22528
v_mfma_f32_16x16x32_bf16 v[28:31], a[188:191], v[170:173], v[28:31]
v_cvt_pk_bf16_f32 v24, v24, v25
v_cvt_pk_bf16_f32 v25, v26, v27
v_mfma_f32_16x16x32_bf16 v[32:35], a[212:215], v[170:173], v[32:35]
s_waitcnt lgkmcnt(3)
ds_write_b64 v203, v[24:25] offset:12544
v_mfma_f32_16x16x32_bf16 v[138:141], a[0:3], v[182:185], 0
s_waitcnt lgkmcnt(3)
v_subrev_u32 v24, 37120, v210
v_lshrrev_b32 v25, 4, v24
v_mfma_f32_16x16x32_bf16 v[138:141], a[4:7], v[186:189], v[138:141]
v_and_b32 v25, 15, v25
v_lshrrev_b32 v26, 8, v24
v_mfma_f32_16x16x32_bf16 v[142:145], a[24:27], v[182:185], 0
v_mul_u32_u24 v27, 1424, v25
v_lshl_add_u32 v27, v26, 5, v27
v_mfma_f32_16x16x32_bf16 v[142:145], a[28:31], v[186:189], v[142:145]
v_add_u32 v27, 94464, v27
v_cvt_pk_bf16_f32 v28, v28, v29
v_mfma_f32_16x16x32_bf16 v[146:149], a[48:51], v[182:185], 0
ds_read_b128 v[84:87], v27
ds_read_b128 v[88:91], v27 offset:128
v_mfma_f32_16x16x32_bf16 v[146:149], a[52:55], v[186:189], v[146:149]
ds_read_b128 v[92:95], v27 offset:256
ds_read_b128 v[96:99], v27 offset:384
v_mfma_f32_16x16x32_bf16 v[150:153], a[216:219], v[182:185], 0
ds_read_b64 v[100:101], v27 offset:16
ds_read_b64 v[102:103], v27 offset:144
v_mfma_f32_16x16x32_bf16 v[150:153], a[220:223], v[186:189], v[150:153]
ds_read_b64 v[104:105], v27 offset:272
ds_read_b64 v[106:107], v27 offset:400
v_mfma_f32_16x16x32_bf16 v[154:157], a[240:243], v[182:185], 0
s_nop 0
buffer_store_dwordx2 v[128:129], v204, s[8:11], s29 offen sc1
v_cvt_pk_bf16_f32 v32, v32, v33
v_mfma_f32_16x16x32_bf16 v[154:157], a[244:247], v[186:189], v[154:157]
s_add_u32 s29, s38, s63
v_cvt_pk_bf16_f32 v29, v30, v31
v_cvt_pk_bf16_f32 v33, v34, v35
v_mfma_f32_16x16x32_bf16 v[158:161], v[232:235], v[182:185], 0
ds_write_b64 v203, v[28:29] offset:12576
v_mfma_f32_16x16x32_bf16 v[158:161], v[236:239], v[186:189], v[158:161]
buffer_store_dwordx2 v[136:137], v204, s[8:11], s28 offen sc1
v_lshlrev_b32 v31, 5, v25
v_mfma_f32_16x16x32_bf16 v[162:165], v[182:185], a[72:75], 0
s_add_u32 s28, s38, s64
ds_write_b64 v203, v[32:33] offset:12608
v_mfma_f32_16x16x32_bf16 v[162:165], v[186:189], a[76:79], v[162:165]
s_waitcnt lgkmcnt(11)
v_add_u32 v31, s41, v31
v_mul_hi_u32 v32, v31, s42
v_mfma_f32_16x16x32_bf16 v[166:169], v[182:185], a[96:99], 0
s_mov_b32 s42, 1373568
buffer_store_dwordx2 v[120:121], v204, s[8:11], s29 offen sc1
v_mul_u32_u24 v29, 73, v32
v_mfma_f32_16x16x32_bf16 v[166:169], v[186:189], a[100:103], v[166:169]
s_add_u32 s29, s38, s65
v_mul_lo_u32 v32, v32, s42
v_sub_u32 v29, v31, v29
v_mfma_f32_16x16x32_bf16 v[170:173], v[182:185], a[120:123], 0
s_mul_i32 s42, s32, 96
ds_read_b128 v[182:185], v210 offset:24576
v_cmp_gt_u32 vcc, s34, v31
v_mfma_f32_16x16x32_bf16 v[170:173], v[186:189], a[124:127], v[170:173]
s_add_u32 s41, s33, 512
ds_read_b128 v[186:189], v210 offset:25600
v_mul_u32_u24 v29, 2688, v29
v_mfma_f32_16x16x32_bf16 v[138:141], a[8:11], v[110:113], v[138:141]
s_waitcnt lgkmcnt(2)
v_add3_u32 v29, v29, v32, s42
v_mov_b32 v32, 1879048192
v_mfma_f32_16x16x32_bf16 v[138:141], a[12:15], v[220:223], v[138:141]
s_barrier
v_mfma_f32_16x16x32_bf16 v[142:145], a[32:35], v[110:113], v[142:145]
s_mov_b32 s42, 58835169
ds_read_b64 v[128:129], v204 offset:6272
ds_read_b64 v[136:137], v204 offset:6664
v_mfma_f32_16x16x32_bf16 v[142:145], a[36:39], v[220:223], v[142:145]
ds_read_b64 v[120:121], v204 offset:7056
v_cndmask_b32 v29, v32, v29, vcc
v_mfma_f32_16x16x32_bf16 v[146:149], a[56:59], v[110:113], v[146:149]
v_cmp_gt_u32 vcc, 4, v25
v_lshlrev_b32 v31, 5, v25
v_mfma_f32_16x16x32_bf16 v[146:149], a[60:63], v[220:223], v[146:149]
s_nop 0
v_mov_b32 v32, 6000
v_add_u32 v31, s41, v31
v_mfma_f32_16x16x32_bf16 v[150:153], a[224:227], v[110:113], v[150:153]
v_cndmask_b32 v31, v32, v31, vcc
v_mul_hi_u32 v32, v31, s42
v_mfma_f32_16x16x32_bf16 v[150:153], a[228:231], v[220:223], v[150:153]
s_waitcnt lgkmcnt(2)
buffer_store_dwordx2 v[128:129], v204, s[8:11], s28 offen sc1
ds_read_b64 v[128:129], v204 offset:7448
v_mfma_f32_16x16x32_bf16 v[154:157], a[248:251], v[110:113], v[154:157]
s_add_u32 s28, s38, s66
v_mul_u32_u24 v30, 73, v32
v_sub_u32 v30, v31, v30
v_mfma_f32_16x16x32_bf16 v[154:157], a[252:255], v[220:223], v[154:157]
s_waitcnt lgkmcnt(2)
v_cmp_gt_u32 vcc, s34, v31
v_mul_u32_u24 v30, 2688, v30
v_mfma_f32_16x16x32_bf16 v[158:161], v[240:243], v[110:113], v[158:161]
s_mov_b32 s42, 1373568
buffer_store_dwordx2 v[136:137], v204, s[8:11], s29 offen sc1
ds_read_b64 v[136:137], v204 offset:12544
v_mfma_f32_16x16x32_bf16 v[158:161], v[244:247], v[220:223], v[158:161]
s_add_u32 s29, s38, s67
v_mul_lo_u32 v32, v32, s42
v_lshl_add_u32 v29, v26, 3, v29
v_mfma_f32_16x16x32_bf16 v[162:165], v[110:113], a[80:83], v[162:165]
s_mul_i32 s42, s32, 96
v_add3_u32 v30, v30, v32, s42
v_mov_b32 v32, 1879048192
v_mfma_f32_16x16x32_bf16 v[162:165], v[220:223], a[84:87], v[162:165]
s_waitcnt lgkmcnt(2)
buffer_store_dwordx2 v[120:121], v204, s[8:11], s28 offen sc1
ds_read_b64 v[120:121], v204 offset:12936
v_mfma_f32_16x16x32_bf16 v[166:169], v[110:113], a[104:107], v[166:169]
s_add_u32 s28, s38, s68
v_cndmask_b32 v30, v32, v30, vcc
v_lshl_add_u32 v30, v26, 3, v30
v_mfma_f32_16x16x32_bf16 v[166:169], v[220:223], a[108:111], v[166:169]
v_lshl_add_u32 v28, v26, 3, v205
v_add_u32 v29, 1047808, v29
v_mfma_f32_16x16x32_bf16 v[170:173], v[110:113], a[128:131], v[170:173]
ds_read_b128 v[110:113], v210 offset:26624
v_add_u32 v30, 1047808, v30
v_mfma_f32_16x16x32_bf16 v[170:173], v[220:223], a[132:135], v[170:173]
ds_read_b128 v[220:223], v210 offset:27648
v_mfma_f32_16x16x32_bf16 v[138:141], a[16:19], v[182:185], v[138:141]
s_waitcnt lgkmcnt(4)
buffer_store_dwordx2 v[128:129], v204, s[8:11], s29 offen sc1
ds_read_b64 v[128:129], v204 offset:13328
v_mfma_f32_16x16x32_bf16 v[138:141], a[20:23], v[186:189], v[138:141]
s_add_u32 s29, s38, s69
v_mfma_f32_16x16x32_bf16 v[142:145], a[40:43], v[182:185], v[142:145]
v_mfma_f32_16x16x32_bf16 v[142:145], a[44:47], v[186:189], v[142:145]
v_cvt_pk_bf16_f32 v78, v138, v139
v_cvt_pk_bf16_f32 v79, v140, v141
v_mfma_f32_16x16x32_bf16 v[146:149], a[64:67], v[182:185], v[146:149]
s_waitcnt lgkmcnt(4)
buffer_store_dwordx2 v[136:137], v204, s[8:11], s28 offen sc1
ds_read_b64 v[136:137], v204 offset:13720
v_mfma_f32_16x16x32_bf16 v[146:149], a[68:71], v[186:189], v[146:149]
s_add_u32 s28, s38, s70
v_cvt_pk_bf16_f32 v80, v142, v143
v_cvt_pk_bf16_f32 v81, v144, v145
v_mfma_f32_16x16x32_bf16 v[150:153], a[232:235], v[182:185], v[150:153]
v_mfma_f32_16x16x32_bf16 v[150:153], a[236:239], v[186:189], v[150:153]
v_cvt_pk_bf16_f32 v82, v146, v147
v_cvt_pk_bf16_f32 v83, v148, v149
v_mfma_f32_16x16x32_bf16 v[154:157], v[224:227], v[182:185], v[154:157]
s_waitcnt lgkmcnt(4)
buffer_store_dwordx2 v[120:121], v204, s[8:11], s29 offen sc1
s_add_u32 s29, s38, s71
v_mfma_f32_16x16x32_bf16 v[154:157], v[228:231], v[186:189], v[154:157]
v_cvt_pk_bf16_f32 v72, v150, v151
v_cvt_pk_bf16_f32 v73, v152, v153
v_mfma_f32_16x16x32_bf16 v[158:161], v[248:251], v[182:185], v[158:161]
v_mfma_f32_16x16x32_bf16 v[158:161], v[252:255], v[186:189], v[158:161]
v_cvt_pk_bf16_f32 v74, v154, v155
v_cvt_pk_bf16_f32 v75, v156, v157
v_mfma_f32_16x16x32_bf16 v[162:165], v[182:185], a[88:91], v[162:165]
s_waitcnt lgkmcnt(1)
buffer_store_dwordx2 v[128:129], v204, s[8:11], s28 offen sc1
s_add_u32 s28, s39, s60
v_mfma_f32_16x16x32_bf16 v[162:165], v[186:189], a[92:95], v[162:165]
v_cvt_pk_bf16_f32 v76, v158, v159
v_cvt_pk_bf16_f32 v77, v160, v161
v_mfma_f32_16x16x32_bf16 v[166:169], v[182:185], a[112:115], v[166:169]
v_mfma_f32_16x16x32_bf16 v[166:169], v[186:189], a[116:119], v[166:169]
v_cvt_pk_bf16_f32 v114, v162, v163
v_cvt_pk_bf16_f32 v115, v164, v165
v_mfma_f32_16x16x32_bf16 v[170:173], v[182:185], a[136:139], v[170:173]
ds_read_b128 v[182:185], v210 offset:28672
v_mfma_f32_16x16x32_bf16 v[170:173], v[186:189], a[140:143], v[170:173]
ds_read_b128 v[186:189], v210 offset:29696
v_cvt_pk_bf16_f32 v122, v166, v167
v_mfma_f32_16x16x32_bf16 v[138:141], a[0:3], v[110:113], 0
v_cvt_pk_bf16_f32 v123, v168, v169
v_mfma_f32_16x16x32_bf16 v[138:141], a[4:7], v[220:223], v[138:141]
v_cvt_pk_bf16_f32 v130, v170, v171
v_cvt_pk_bf16_f32 v131, v172, v173
v_mfma_f32_16x16x32_bf16 v[142:145], a[24:27], v[110:113], 0
s_waitcnt lgkmcnt(2)
buffer_store_dwordx2 v[136:137], v204, s[8:11], s29 offen sc1
s_add_u32 s29, s39, s61
v_mfma_f32_16x16x32_bf16 v[142:145], a[28:31], v[220:223], v[142:145]
v_mfma_f32_16x16x32_bf16 v[146:149], a[48:51], v[110:113], 0
v_mfma_f32_16x16x32_bf16 v[146:149], a[52:55], v[220:223], v[146:149]
s_waitcnt vmcnt(16)
v_mfma_f32_16x16x32_bf16 v[0:3], a[144:147], v[84:87], v[0:3]
v_mfma_f32_16x16x32_bf16 v[0:3], a[148:151], v[88:91], v[0:3]
v_mfma_f32_16x16x32_bf16 v[0:3], a[152:155], v[92:95], v[0:3]
v_mfma_f32_16x16x32_bf16 v[0:3], a[156:159], v[96:99], v[0:3]
v_mfma_f32_16x16x32_bf16 v[0:3], a[160:163], v[100:103], v[0:3]
v_mfma_f32_16x16x32_bf16 v[0:3], a[164:167], v[104:107], v[0:3]
v_mfma_f32_16x16x32_bf16 v[150:153], a[216:219], v[110:113], 0
v_mfma_f32_16x16x32_bf16 v[150:153], a[220:223], v[220:223], v[150:153]
s_waitcnt vmcnt(15)
v_cvt_pk_bf16_f32 v0, v0, v1
v_cvt_pk_bf16_f32 v1, v2, v3
v_mfma_f32_16x16x32_bf16 v[4:7], a[168:171], v[84:87], v[4:7]
buffer_store_dwordx2 v[0:1], v29, s[8:11], 0 offen
v_mfma_f32_16x16x32_bf16 v[4:7], a[172:175], v[88:91], v[4:7]
v_mfma_f32_16x16x32_bf16 v[4:7], a[176:179], v[92:95], v[4:7]
v_mfma_f32_16x16x32_bf16 v[4:7], a[180:183], v[96:99], v[4:7]
v_mfma_f32_16x16x32_bf16 v[4:7], a[184:187], v[100:103], v[4:7]
v_mfma_f32_16x16x32_bf16 v[4:7], a[188:191], v[104:107], v[4:7]
v_mfma_f32_16x16x32_bf16 v[154:157], a[240:243], v[110:113], 0
v_mfma_f32_16x16x32_bf16 v[154:157], a[244:247], v[220:223], v[154:157]
v_cvt_pk_bf16_f32 v4, v4, v5
v_cvt_pk_bf16_f32 v5, v6, v7
v_mfma_f32_16x16x32_bf16 v[158:161], v[232:235], v[110:113], 0
v_mfma_f32_16x16x32_bf16 v[158:161], v[236:239], v[220:223], v[158:161]
v_mfma_f32_16x16x32_bf16 v[8:11], a[192:195], v[84:87], v[8:11]
v_mfma_f32_16x16x32_bf16 v[8:11], a[196:199], v[88:91], v[8:11]
v_mfma_f32_16x16x32_bf16 v[8:11], a[200:203], v[92:95], v[8:11]
buffer_store_dwordx2 v[4:5], v29, s[8:11], 0 offen offset:32
v_mfma_f32_16x16x32_bf16 v[8:11], a[204:207], v[96:99], v[8:11]
v_mfma_f32_16x16x32_bf16 v[8:11], a[208:211], v[100:103], v[8:11]
v_mfma_f32_16x16x32_bf16 v[8:11], a[212:215], v[104:107], v[8:11]
ds_read_b128 v[106:109], v210 offset:31744
v_mfma_f32_16x16x32_bf16 v[162:165], v[110:113], a[72:75], 0
v_mfma_f32_16x16x32_bf16 v[162:165], v[220:223], a[76:79], v[162:165]
v_cvt_pk_bf16_f32 v8, v8, v9
v_cvt_pk_bf16_f32 v9, v10, v11
v_mfma_f32_16x16x32_bf16 v[166:169], v[110:113], a[96:99], 0
v_mfma_f32_16x16x32_bf16 v[166:169], v[220:223], a[100:103], v[166:169]
v_mfma_f32_16x16x32_bf16 v[170:173], v[110:113], a[120:123], 0
ds_read_b128 v[110:113], v210 offset:30720
v_mfma_f32_16x16x32_bf16 v[170:173], v[220:223], a[124:127], v[170:173]
s_waitcnt lgkmcnt(3)
v_mfma_f32_16x16x32_bf16 v[138:141], a[8:11], v[182:185], v[138:141]
s_waitcnt lgkmcnt(2)
v_mfma_f32_16x16x32_bf16 v[138:141], a[12:15], v[186:189], v[138:141]
v_mfma_f32_16x16x32_bf16 v[142:145], a[32:35], v[182:185], v[142:145]
v_mfma_f32_16x16x32_bf16 v[142:145], a[36:39], v[186:189], v[142:145]
v_mfma_f32_16x16x32_bf16 v[146:149], a[56:59], v[182:185], v[146:149]
v_mfma_f32_16x16x32_bf16 v[146:149], a[60:63], v[186:189], v[146:149]
v_mfma_f32_16x16x32_bf16 v[150:153], a[224:227], v[182:185], v[150:153]
buffer_store_dwordx2 v[8:9], v29, s[8:11], 0 offen offset:64
v_mfma_f32_16x16x32_bf16 v[150:153], a[228:231], v[186:189], v[150:153]
v_mfma_f32_16x16x32_bf16 v[154:157], a[248:251], v[182:185], v[154:157]
v_mfma_f32_16x16x32_bf16 v[154:157], a[252:255], v[186:189], v[154:157]
v_mfma_f32_16x16x32_bf16 v[158:161], v[240:243], v[182:185], v[158:161]
v_mfma_f32_16x16x32_bf16 v[158:161], v[244:247], v[186:189], v[158:161]
v_mfma_f32_16x16x32_bf16 v[162:165], v[182:185], a[80:83], v[162:165]
v_mfma_f32_16x16x32_bf16 v[162:165], v[186:189], a[84:87], v[162:165]
v_mfma_f32_16x16x32_bf16 v[166:169], v[182:185], a[104:107], v[166:169]
v_mfma_f32_16x16x32_bf16 v[166:169], v[186:189], a[108:111], v[166:169]
v_mfma_f32_16x16x32_bf16 v[170:173], v[182:185], a[128:131], v[170:173]
ds_read_b128 v[182:185], v210 offset:32768
v_mfma_f32_16x16x32_bf16 v[170:173], v[186:189], a[132:135], v[170:173]
s_nop 0
ds_read_b128 v[186:189], v210 offset:33792
s_waitcnt lgkmcnt(2)
v_mfma_f32_16x16x32_bf16 v[138:141], a[16:19], v[110:113], v[138:141]
v_mfma_f32_16x16x32_bf16 v[138:141], a[20:23], v[106:109], v[138:141]
v_mfma_f32_16x16x32_bf16 v[142:145], a[40:43], v[110:113], v[142:145]
v_mfma_f32_16x16x32_bf16 v[142:145], a[44:47], v[106:109], v[142:145]
v_cvt_pk_bf16_f32 v96, v138, v139
v_cvt_pk_bf16_f32 v97, v140, v141
v_mfma_f32_16x16x32_bf16 v[146:149], a[64:67], v[110:113], v[146:149]
v_mfma_f32_16x16x32_bf16 v[146:149], a[68:71], v[106:109], v[146:149]
v_cvt_pk_bf16_f32 v98, v142, v143
v_cvt_pk_bf16_f32 v99, v144, v145
v_mfma_f32_16x16x32_bf16 v[150:153], a[232:235], v[110:113], v[150:153]
v_mfma_f32_16x16x32_bf16 v[150:153], a[236:239], v[106:109], v[150:153]
v_cvt_pk_bf16_f32 v100, v146, v147
v_cvt_pk_bf16_f32 v101, v148, v149
v_mfma_f32_16x16x32_bf16 v[154:157], v[224:227], v[110:113], v[154:157]
v_mfma_f32_16x16x32_bf16 v[154:157], v[228:231], v[106:109], v[154:157]
v_cvt_pk_bf16_f32 v84, v150, v151
v_cvt_pk_bf16_f32 v85, v152, v153
v_mfma_f32_16x16x32_bf16 v[158:161], v[248:251], v[110:113], v[158:161]
v_mfma_f32_16x16x32_bf16 v[158:161], v[252:255], v[106:109], v[158:161]
v_cvt_pk_bf16_f32 v86, v154, v155
v_cvt_pk_bf16_f32 v87, v156, v157
v_mfma_f32_16x16x32_bf16 v[162:165], v[110:113], a[88:91], v[162:165]
v_mfma_f32_16x16x32_bf16 v[162:165], v[106:109], a[92:95], v[162:165]
v_cvt_pk_bf16_f32 v88, v158, v159
v_cvt_pk_bf16_f32 v89, v160, v161
v_mfma_f32_16x16x32_bf16 v[166:169], v[110:113], a[112:115], v[166:169]
v_mfma_f32_16x16x32_bf16 v[166:169], v[106:109], a[116:119], v[166:169]
v_cvt_pk_bf16_f32 v116, v162, v163
v_cvt_pk_bf16_f32 v117, v164, v165
v_mfma_f32_16x16x32_bf16 v[170:173], v[110:113], a[136:139], v[170:173]
s_nop 0
ds_read_b64 v[112:113], v215 offset:528
v_mfma_f32_16x16x32_bf16 v[170:173], v[106:109], a[140:143], v[170:173]
s_waitcnt lgkmcnt(2)
ds_read_b128 v[108:111], v215 offset:512
v_cvt_pk_bf16_f32 v124, v166, v167
v_mfma_f32_16x16x32_bf16 v[138:141], a[0:3], v[182:185], 0
s_nop 0
v_cvt_pk_bf16_f32 v125, v168, v169
s_waitcnt lgkmcnt(2)
v_mfma_f32_16x16x32_bf16 v[138:141], a[4:7], v[186:189], v[138:141]
v_cvt_pk_bf16_f32 v132, v170, v171
v_cvt_pk_bf16_f32 v133, v172, v173
v_mfma_f32_16x16x32_bf16 v[142:145], a[24:27], v[182:185], 0
ds_read_b128 v[170:173], v210 offset:34816
v_mfma_f32_16x16x32_bf16 v[142:145], a[28:31], v[186:189], v[142:145]
v_mfma_f32_16x16x32_bf16 v[146:149], a[48:51], v[182:185], 0
ds_read_b128 v[182:185], v210 offset:35840
v_mfma_f32_16x16x32_bf16 v[146:149], a[52:55], v[186:189], v[146:149]
s_nop 0
ds_read_b128 v[186:189], v210 offset:36864
s_waitcnt lgkmcnt(3)
v_mfma_f32_16x16x32_bf16 v[150:153], v[108:111], v[72:75], v[206:209]
v_mfma_f32_16x16x16_bf16 v[154:157], v[82:83], v[88:89], 0
v_mfma_f32_16x16x16_bf16 v[158:161], v[100:101], v[88:89], 0
v_mfma_f32_16x16x16_bf16 v[166:169], v[112:113], v[88:89], v[206:209]
s_waitcnt lgkmcnt(2)
v_mfma_f32_16x16x32_bf16 v[138:141], a[8:11], v[170:173], v[138:141]
s_waitcnt lgkmcnt(1)
v_mfma_f32_16x16x32_bf16 v[138:141], a[12:15], v[182:185], v[138:141]
v_mfma_f32_16x16x32_bf16 v[142:145], a[32:35], v[170:173], v[142:145]
v_mfma_f32_16x16x32_bf16 v[142:145], a[36:39], v[182:185], v[142:145]
v_mfma_f32_16x16x32_bf16 v[146:149], a[56:59], v[170:173], v[146:149]
ds_read_b128 v[170:173], v210 offset:37888
v_mfma_f32_16x16x32_bf16 v[146:149], a[60:63], v[182:185], v[146:149]
ds_read_b128 v[182:185], v210 offset:32768
v_mfma_f32_16x16x32_bf16 v[154:157], v[78:81], v[84:87], v[154:157]
v_mfma_f32_16x16x32_bf16 v[158:161], v[96:99], v[84:87], v[158:161]
s_waitcnt lgkmcnt(2)
v_mfma_f32_16x16x32_bf16 v[138:141], a[16:19], v[186:189], v[138:141]
v_exp_f32 v154, v154
v_mfma_f32_16x16x32_bf16 v[166:169], v[108:111], v[84:87], v[166:169]
v_exp_f32 v155, v155
v_mfma_f32_16x16x16_bf16 v[150:153], v[112:113], v[76:77], v[150:153]
v_exp_f32 v156, v156
v_exp_f32 v157, v157
s_waitcnt lgkmcnt(0)
v_mfma_f32_16x16x32_bf16 v[118:121], v[182:185], a[72:75], 0
v_exp_f32 v158, v158
v_mfma_f32_16x16x32_bf16 v[126:129], v[182:185], a[96:99], 0
v_exp_f32 v159, v159
v_mfma_f32_16x16x32_bf16 v[134:137], v[182:185], a[120:123], 0
v_exp_f32 v160, v160
v_mfma_f32_16x16x32_bf16 v[90:93], a[216:219], v[182:185], 0
v_exp_f32 v161, v161
v_mfma_f32_16x16x32_bf16 v[220:223], v[232:235], v[182:185], 0
v_exp_f32 v150, v150
v_mfma_f32_16x16x32_bf16 v[138:141], a[20:23], v[170:173], v[138:141]
v_exp_f32 v166, v166
v_mfma_f32_16x16x32_bf16 v[142:145], a[40:43], v[186:189], v[142:145]
v_mfma_f32_16x16x32_bf16 v[142:145], a[44:47], v[170:173], v[142:145]
v_cvt_pk_bf16_f32 v102, v138, v139
v_cvt_pk_bf16_f32 v103, v140, v141
v_mfma_f32_16x16x32_bf16 v[138:141], v[78:81], v[72:75], 0
v_mfma_f32_16x16x32_bf16 v[146:149], a[64:67], v[186:189], v[146:149]
ds_read_b128 v[186:189], v210 offset:33792
v_cvt_pk_bf16_f32 v104, v142, v143
v_cvt_pk_bf16_f32 v105, v144, v145
v_mfma_f32_16x16x32_bf16 v[142:145], v[96:99], v[72:75], 0
v_mfma_f32_16x16x16_bf16 v[138:141], v[82:83], v[76:77], v[138:141]
v_mfma_f32_16x16x16_bf16 v[142:145], v[100:101], v[76:77], v[142:145]
v_mfma_f32_16x16x32_bf16 v[146:149], a[68:71], v[170:173], v[146:149]
v_exp_f32 v138, v138
v_mfma_f32_16x16x32_bf16 v[170:173], a[240:243], v[182:185], 0
ds_read_b128 v[182:185], v210 offset:36864
s_waitcnt lgkmcnt(1)
v_mfma_f32_16x16x32_bf16 v[118:121], v[186:189], a[76:79], v[118:121]
v_cvt_pk_bf16_f32 v106, v146, v147
v_cvt_pk_bf16_f32 v107, v148, v149
v_mfma_f32_16x16x32_bf16 v[146:149], v[102:105], v[72:75], 0
v_exp_f32 v139, v139
v_mfma_f32_16x16x32_bf16 v[126:129], v[186:189], a[100:103], v[126:129]
v_exp_f32 v140, v140
v_mfma_f32_16x16x32_bf16 v[134:137], v[186:189], a[124:127], v[134:137]
v_exp_f32 v141, v141
v_mfma_f32_16x16x32_bf16 v[90:93], a[220:223], v[186:189], v[90:93]
v_exp_f32 v142, v142
v_mfma_f32_16x16x32_bf16 v[170:173], a[244:247], v[186:189], v[170:173]
v_exp_f32_e64 v143, v143
v_mfma_f32_16x16x32_bf16 v[220:223], v[236:239], v[186:189], v[220:223]
ds_read_b128 v[186:189], v210 offset:37888
ds_read_b128 v[72:75], v215
v_mfma_f32_16x16x32_bf16 v[118:121], v[174:177], a[80:83], v[118:121]
v_exp_f32 v144, v144
v_mfma_f32_16x16x32_bf16 v[118:121], v[178:181], a[84:87], v[118:121]
v_exp_f32 v145, v145
v_mfma_f32_16x16x32_bf16 v[126:129], v[174:177], a[104:107], v[126:129]
v_mfma_f32_16x16x32_bf16 v[126:129], v[178:181], a[108:111], v[126:129]
v_mfma_f32_16x16x16_bf16 v[162:165], v[106:107], v[88:89], 0
v_mfma_f32_16x16x16_bf16 v[146:149], v[106:107], v[76:77], v[146:149]
ds_read_b64 v[76:77], v215 offset:16
v_mfma_f32_16x16x32_bf16 v[134:137], v[174:177], a[128:131], v[134:137]
v_mfma_f32_16x16x32_bf16 v[134:137], v[178:181], a[132:135], v[134:137]
v_exp_f32 v146, v146
v_mfma_f32_16x16x32_bf16 v[90:93], a[224:227], v[174:177], v[90:93]
v_exp_f32 v147, v147
v_mfma_f32_16x16x32_bf16 v[90:93], a[228:231], v[178:181], v[90:93]
v_exp_f32 v148, v148
v_mfma_f32_16x16x32_bf16 v[170:173], a[248:251], v[174:177], v[170:173]
v_exp_f32 v149, v149
v_mfma_f32_16x16x32_bf16 v[170:173], a[252:255], v[178:181], v[170:173]
v_mfma_f32_16x16x32_bf16 v[220:223], v[240:243], v[174:177], v[220:223]
v_cvt_pk_bf16_f32 v174, v138, v139
v_cvt_pk_bf16_f32 v175, v140, v141
v_mfma_f32_16x16x32_bf16 v[220:223], v[244:247], v[178:181], v[220:223]
s_nop 0
v_cvt_pk_bf16_f32 v176, v142, v143
v_cvt_pk_bf16_f32 v177, v144, v145
v_mfma_f32_16x16x32_bf16 v[162:165], v[102:105], v[84:87], v[162:165]
s_waitcnt lgkmcnt(3)
v_cvt_pk_bf16_f32 v180, v150, 0
v_cvt_pk_bf16_f32 v178, v146, v147
v_mfma_f32_16x16x32_bf16 v[118:121], v[182:185], a[88:91], v[118:121]
s_waitcnt lgkmcnt(2)
v_cvt_pk_bf16_f32 v179, v148, v149
v_mov_b32 v181, 0
v_mfma_f32_16x16x32_bf16 v[118:121], v[186:189], a[92:95], v[118:121]
v_exp_f32 v162, v162
v_mfma_f32_16x16x32_bf16 v[126:129], v[182:185], a[112:115], v[126:129]
v_exp_f32 v163, v163
v_mfma_f32_16x16x32_bf16 v[126:129], v[186:189], a[116:119], v[126:129]
v_exp_f32 v164, v164
v_mfma_f32_16x16x32_bf16 v[134:137], v[182:185], a[136:139], v[134:137]
v_exp_f32 v165, v165
v_mfma_f32_16x16x32_bf16 v[134:137], v[186:189], a[140:143], v[134:137]
v_cvt_pk_bf16_f32 v118, v118, v119
v_cvt_pk_bf16_f32 v119, v120, v121
v_mfma_f32_16x16x32_bf16 v[90:93], a[232:235], v[182:185], v[90:93]
ds_read_u16 v120, v205
v_mov_b32_e64 v121, 0
v_mfma_f32_16x16x32_bf16 v[90:93], a[236:239], v[186:189], v[90:93]
v_cvt_pk_bf16_f32 v126, v126, v127
v_cvt_pk_bf16_f32 v127, v128, v129
v_mfma_f32_16x16x32_bf16 v[170:173], v[224:227], v[182:185], v[170:173]
ds_read_u16 v128, v205 offset:32
v_mov_b32_e64 v129, 0
v_mfma_f32_16x16x32_bf16 v[170:173], v[228:231], v[186:189], v[170:173]
v_cvt_pk_bf16_f32 v134, v134, v135
v_cvt_pk_bf16_f32 v135, v136, v137
v_mfma_f32_16x16x32_bf16 v[220:223], v[248:251], v[182:185], v[220:223]
ds_read_u16 v136, v205 offset:64
v_cvt_pk_bf16_f32 v90, v90, v91
v_mfma_f32_16x16x32_bf16 v[220:223], v[252:255], v[186:189], v[220:223]
v_cvt_pk_bf16_f32 v91, v92, v93
v_cvt_pk_bf16_f32 v92, v170, v171
v_mfma_f32_16x16x32_bf16 v[150:153], v[190:193], v[174:177], 0
v_cvt_pk_bf16_f32 v93, v172, v173
v_mov_b32_e64 v137, 0
v_mfma_f32_16x16x32_bf16 v[150:153], v[190:193], v[178:181], v[150:153]
v_cvt_pk_bf16_f32 v94, v220, v221
v_cvt_pk_bf16_f32 v95, v222, v223
v_mfma_f32_16x16x32_bf16 v[138:141], v[114:117], v[174:177], 0
v_add_u32 v205, 1424, v205
s_waitcnt lgkmcnt(2)
v_mfma_f32_16x16x32_bf16 v[138:141], v[118:121], v[178:181], v[138:141]
v_rcp_f32 v151, v150
v_mfma_f32_16x16x32_bf16 v[142:145], v[122:125], v[174:177], 0
s_waitcnt lgkmcnt(1)
v_mul_f32 v152, s3, v151
v_max3_u32 v218, v218, v150, v151
v_mfma_f32_16x16x32_bf16 v[142:145], v[126:129], v[178:181], v[142:145]
v_mul_f32_e64 v138, v138, v152
v_mul_f32 v139, v139, v152
v_mfma_f32_16x16x32_bf16 v[146:149], v[130:133], v[174:177], 0
s_waitcnt lgkmcnt(0)
v_cvt_pk_bf16_f32 v174, v154, v155
v_cvt_pk_bf16_f32 v175, v156, v157
v_mfma_f32_16x16x32_bf16 v[146:149], v[134:137], v[178:181], v[146:149]
v_cvt_pk_bf16_f32 v176, v158, v159
v_cvt_pk_bf16_f32 v177, v160, v161
v_cvt_pk_bf16_f32 v180, v166, 0
v_cvt_pk_bf16_f32 v178, v162, v163
v_mfma_f32_16x16x32_bf16 v[166:169], v[190:193], v[174:177], 0
v_cvt_pk_bf16_f32 v179, v164, v165
v_mul_f32_e64 v140, v140, v152
v_mfma_f32_16x16x32_bf16 v[154:157], v[114:117], v[174:177], 0
v_mul_f32_e64 v141, v141, v152
v_cvt_pk_bf16_f32 v138, v138, v139
v_mfma_f32_16x16x32_bf16 v[166:169], v[190:193], v[178:181], v[166:169]
v_mul_f32 v142, v142, v152
v_mul_f32 v143, v143, v152
v_mfma_f32_16x16x32_bf16 v[154:157], v[118:121], v[178:181], v[154:157]
v_mul_f32 v144, v144, v152
v_mul_f32 v145, v145, v152
v_mfma_f32_16x16x32_bf16 v[158:161], v[122:125], v[174:177], 0
v_rcp_f32 v167, v166
v_mfma_f32_16x16x32_bf16 v[158:161], v[126:129], v[178:181], v[158:161]
v_mul_f32 v168, s3, v167
v_mul_f32_e64 v154, v154, v168
v_mfma_f32_16x16x32_bf16 v[162:165], v[130:133], v[174:177], 0
v_mul_f32 v155, v155, v168
v_mul_f32 v156, v156, v168
v_mfma_f32_16x16x32_bf16 v[162:165], v[134:137], v[178:181], v[162:165]
v_mul_f32_e64 v157, v157, v168
v_cvt_pk_bf16_f32 v154, v154, v155
v_cvt_pk_bf16_f32 v139, v140, v141
v_mul_f32 v158, v158, v168
v_mul_f32 v159, v159, v168
v_mul_f32 v160, v160, v168
v_mul_f32 v161, v161, v168
v_cvt_pk_bf16_f32 v155, v156, v157
v_cvt_pk_bf16_f32 v140, v142, v143
v_cvt_pk_bf16_f32 v141, v144, v145
v_cvt_pk_bf16_f32 v156, v158, v159
v_cvt_pk_bf16_f32 v157, v160, v161
v_mul_f32 v146, v146, v152
v_mul_f32 v147, v147, v152
v_mul_f32 v148, v148, v152
v_mul_f32 v149, v149, v152
v_mfma_f32_16x16x32_bf16 v[150:153], v[108:111], v[90:93], v[206:209]
ds_write_b128 v211, v[138:141] offset:38912
v_mfma_f32_16x16x32_bf16 v[138:141], v[78:81], v[90:93], 0
v_mul_f32 v162, v162, v168
v_mul_f32 v163, v163, v168
v_mul_f32_e64 v164, v164, v168
v_mfma_f32_16x16x16_bf16 v[150:153], v[112:113], v[94:95], v[150:153]
v_mul_f32_e64 v165, v165, v168
v_cvt_pk_bf16_f32 v142, v146, v147
v_cvt_pk_bf16_f32 v143, v148, v149
v_mfma_f32_16x16x16_bf16 v[138:141], v[82:83], v[94:95], v[138:141]
v_cvt_pk_bf16_f32 v158, v162, v163
v_cvt_pk_bf16_f32 v159, v164, v165
v_max3_u32 v218, v218, v166, v167
v_mfma_f32_16x16x32_bf16 v[146:149], v[102:105], v[90:93], 0
ds_write_b128 v211, v[154:157] offset:45056
v_mfma_f32_16x16x16_bf16 v[146:149], v[106:107], v[94:95], v[146:149]
v_exp_f32 v138, v138
v_exp_f32 v139, v139
v_mfma_f32_16x16x16_bf16 v[154:157], v[76:77], v[82:83], 0
v_exp_f32_e64 v140, v140
v_cvt_pk_bf16_f32 v174, v138, v139
v_mfma_f32_16x16x16_bf16 v[162:165], v[76:77], v[106:107], 0
v_exp_f32 v141, v141
s_nop 0
v_cvt_pk_bf16_f32 v175, v140, v141
v_mfma_f32_16x16x16_bf16 v[166:169], v[76:77], v[112:113], v[206:209]
ds_write_b64 v212, v[142:143] offset:38912
v_mfma_f32_16x16x32_bf16 v[142:145], v[96:99], v[90:93], 0
v_exp_f32 v150, v150
v_mfma_f32_16x16x32_bf16 v[154:157], v[72:75], v[78:81], v[154:157]
ds_write_b64 v212, v[158:159] offset:45056
v_mfma_f32_16x16x16_bf16 v[142:145], v[100:101], v[94:95], v[142:145]
v_cvt_pk_bf16_f32 v180, v150, 0
v_exp_f32 v146, v146
v_mfma_f32_16x16x16_bf16 v[158:161], v[76:77], v[100:101], 0
v_exp_f32 v147, v147
v_exp_f32 v148, v148
v_mfma_f32_16x16x32_bf16 v[162:165], v[72:75], v[102:105], v[162:165]
v_exp_f32 v142, v142
v_mfma_f32_16x16x32_bf16 v[158:161], v[72:75], v[96:99], v[158:161]
v_exp_f32 v143, v143
v_mfma_f32_16x16x32_bf16 v[166:169], v[72:75], v[108:111], v[166:169]
v_exp_f32 v144, v144
v_exp_f32 v145, v145
v_cvt_pk_bf16_f32 v176, v142, v143
v_cvt_pk_bf16_f32 v177, v144, v145
v_exp_f32 v149, v149
v_mfma_f32_16x16x32_bf16 v[150:153], v[190:193], v[174:177], 0
s_waitcnt lgkmcnt(0)
v_cvt_pk_bf16_f32 v178, v146, v147
v_cvt_pk_bf16_f32 v179, v148, v149
v_mfma_f32_16x16x32_bf16 v[138:141], v[114:117], v[174:177], 0
s_barrier
v_mfma_f32_16x16x32_bf16 v[138:141], v[118:121], v[178:181], v[138:141]
s_nop 0
ds_read_b128 v[220:223], v210 offset:38912
ds_read_b128 v[110:113], v210 offset:39936
v_mfma_f32_16x16x32_bf16 v[150:153], v[190:193], v[178:181], v[150:153]
ds_read_b128 v[170:173], v210 offset:40960
ds_read_b128 v[182:185], v210 offset:41984
v_mfma_f32_16x16x32_bf16 v[142:145], v[122:125], v[174:177], 0
ds_read_b128 v[186:189], v210 offset:43008
v_mov_b32_dpp v154, v158 quad_perm:[0,1,2,3] row_mask:0x2 bank_mask:0xf
v_mfma_f32_16x16x32_bf16 v[142:145], v[126:129], v[178:181], v[142:145]
v_mov_b32_dpp v154, v162 quad_perm:[0,1,2,3] row_mask:0x4 bank_mask:0xf
v_mfma_f32_16x16x32_bf16 v[146:149], v[130:133], v[174:177], 0
v_mov_b32_dpp v154, v167 quad_perm:[0,1,2,3] row_mask:0x8 bank_mask:0xf
v_mfma_f32_16x16x32_bf16 v[146:149], v[134:137], v[178:181], v[146:149]
v_rcp_f32_e64 v151, v150
v_exp_f32 v154, v154
s_waitcnt lgkmcnt(4)
v_mfma_f32_16x16x32_bf16 v[36:39], a[144:147], v[220:223], v[36:39]
s_waitcnt lgkmcnt(3)
v_mul_f32 v152, s3, v151
v_cvt_pk_bf16_f32 v154, v154, 0
v_mfma_f32_16x16x32_bf16 v[36:39], a[148:151], v[110:113], v[36:39]
s_waitcnt lgkmcnt(2)
ds_write_b16 v214, v154
v_mfma_f32_16x16x32_bf16 v[36:39], a[152:155], v[170:173], v[36:39]
s_nop 0
ds_read_b128 v[84:87], v215
ds_read_b128 v[88:91], v215 offset:16
v_mfma_f32_16x16x32_bf16 v[40:43], a[168:171], v[220:223], v[40:43]
v_mul_f32 v138, v138, v152
v_mul_f32 v139, v139, v152
v_mfma_f32_16x16x32_bf16 v[40:43], a[172:175], v[110:113], v[40:43]
v_mul_f32_e64 v140, v140, v152
v_mul_f32 v141, v141, v152
v_mfma_f32_16x16x32_bf16 v[40:43], a[176:179], v[170:173], v[40:43]
s_waitcnt lgkmcnt(4)
v_cvt_pk_bf16_f32 v138, v138, v139
v_mul_f32_e64 v142, v142, v152
v_mfma_f32_16x16x32_bf16 v[40:43], a[180:183], v[182:185], v[40:43]
v_mul_f32 v143, v143, v152
v_mul_f32 v144, v144, v152
v_mfma_f32_16x16x32_bf16 v[44:47], a[192:195], v[220:223], v[44:47]
ds_read_b128 v[220:223], v210 offset:44032
v_mul_f32_e64 v145, v145, v152
v_mfma_f32_16x16x32_bf16 v[44:47], a[196:199], v[110:113], v[44:47]
ds_read_b128 v[110:113], v210 offset:45056
v_cvt_pk_bf16_f32 v139, v140, v141
v_mfma_f32_16x16x32_bf16 v[44:47], a[200:203], v[170:173], v[44:47]
ds_read_b128 v[170:173], v210 offset:46080
v_cvt_pk_bf16_f32 v140, v142, v143
v_mfma_f32_16x16x32_bf16 v[44:47], a[204:207], v[182:185], v[44:47]
v_cvt_pk_bf16_f32 v141, v144, v145
v_max3_u32 v218, v218, v150, v151
v_mfma_f32_16x16x32_bf16 v[36:39], a[156:159], v[182:185], v[36:39]
s_waitcnt lgkmcnt(6)
ds_read_b128 v[182:185], v210 offset:47104
v_mul_f32 v146, v146, v152
v_mfma_f32_16x16x32_bf16 v[36:39], a[160:163], v[186:189], v[36:39]
s_nop 0
ds_write_b128 v211, v[138:141] offset:51200
s_waitcnt lgkmcnt(4)
v_mfma_f32_16x16x32_bf16 v[36:39], a[164:167], v[220:223], v[36:39]
v_mul_f32 v147, v147, v152
v_mul_f32 v148, v148, v152
v_mfma_f32_16x16x32_bf16 v[40:43], a[184:187], v[186:189], v[40:43]
v_mul_f32_e64 v149, v149, v152
v_cvt_pk_bf16_f32 v142, v146, v147
v_mfma_f32_16x16x32_bf16 v[40:43], a[188:191], v[220:223], v[40:43]
v_cvt_pk_bf16_f32 v36, v36, v37
v_cvt_pk_bf16_f32 v143, v148, v149
v_mfma_f32_16x16x32_bf16 v[44:47], a[208:211], v[186:189], v[44:47]
s_nop 0
ds_read_b128 v[186:189], v210 offset:48128
v_cvt_pk_bf16_f32 v37, v38, v39
v_mfma_f32_16x16x32_bf16 v[44:47], a[212:215], v[220:223], v[44:47]
s_waitcnt lgkmcnt(4)
ds_read_b128 v[220:223], v210 offset:49152
v_cvt_pk_bf16_f32 v40, v40, v41
v_mfma_f32_16x16x32_bf16 v[48:51], a[144:147], v[110:113], v[48:51]
s_waitcnt lgkmcnt(4)
ds_write_b64 v212, v[142:143] offset:51200
v_mfma_f32_16x16x32_bf16 v[48:51], a[148:151], v[170:173], v[48:51]
s_waitcnt lgkmcnt(4)
v_cvt_pk_bf16_f32 v44, v44, v45
v_cvt_pk_bf16_f32 v41, v42, v43
v_mfma_f32_16x16x32_bf16 v[48:51], a[152:155], v[182:185], v[48:51]
ds_write_b64 v203, v[36:37]
v_mfma_f32_16x16x32_bf16 v[52:55], a[168:171], v[110:113], v[52:55]
v_cvt_pk_bf16_f32 v45, v46, v47
v_add_u32 v215, 1424, v215
v_mfma_f32_16x16x32_bf16 v[52:55], a[172:175], v[170:173], v[52:55]
ds_write_b64 v203, v[40:41] offset:32
v_mfma_f32_16x16x32_bf16 v[52:55], a[176:179], v[182:185], v[52:55]
s_waitcnt lgkmcnt(4)
v_mfma_f32_16x16x32_bf16 v[52:55], a[180:183], v[186:189], v[52:55]
ds_write_b64 v203, v[44:45] offset:64
v_mfma_f32_16x16x32_bf16 v[56:59], a[192:195], v[110:113], v[56:59]
v_mfma_f32_16x16x32_bf16 v[56:59], a[196:199], v[170:173], v[56:59]
ds_read_b128 v[110:113], v210 offset:50176
v_mfma_f32_16x16x32_bf16 v[56:59], a[200:203], v[182:185], v[56:59]
v_mfma_f32_16x16x32_bf16 v[56:59], a[204:207], v[186:189], v[56:59]
v_mfma_f32_16x16x32_bf16 v[48:51], a[156:159], v[186:189], v[48:51]
s_waitcnt lgkmcnt(5)
v_mfma_f32_16x16x32_bf16 v[48:51], a[160:163], v[220:223], v[48:51]
s_nop 0
v_mfma_f32_16x16x32_bf16 v[52:55], a[184:187], v[220:223], v[52:55]
s_waitcnt lgkmcnt(0)
v_mfma_f32_16x16x32_bf16 v[52:55], a[188:191], v[110:113], v[52:55]
v_mfma_f32_16x16x32_bf16 v[48:51], a[164:167], v[110:113], v[48:51]
v_mfma_f32_16x16x32_bf16 v[56:59], a[208:211], v[220:223], v[56:59]
v_cvt_pk_bf16_f32 v52, v52, v53
v_cvt_pk_bf16_f32 v53, v54, v55
v_mfma_f32_16x16x32_bf16 v[56:59], a[212:215], v[110:113], v[56:59]
ds_write_b64 v203, v[52:53] offset:6304
v_mfma_f32_16x16x32_bf16 v[166:169], v[84:87], v[190:193], 0
v_cvt_pk_bf16_f32 v48, v48, v49
v_cvt_pk_bf16_f32 v49, v50, v51
v_mfma_f32_16x16x32_bf16 v[166:169], v[88:91], v[190:193], v[166:169]
ds_write_b64 v203, v[48:49] offset:6272
v_mfma_f32_16x16x32_bf16 v[154:157], v[84:87], v[114:117], 0
v_cvt_pk_bf16_f32 v56, v56, v57
v_cvt_pk_bf16_f32 v57, v58, v59
v_mfma_f32_16x16x32_bf16 v[154:157], v[88:91], v[118:121], v[154:157]
v_rcp_f32_e64 v167, v166
v_mfma_f32_16x16x32_bf16 v[158:161], v[84:87], v[122:125], 0
v_max3_u32 v218, v218, v166, v167
v_cmp_lt_u32 vcc, 1602224128, v218
v_mfma_f32_16x16x32_bf16 v[158:161], v[88:91], v[126:129], v[158:161]
s_or_b32 s41, vcc_lo, vcc_hi
v_mul_f32 v168, s3, v167
v_mov_b32_e64 v33, s41
v_mfma_f32_16x16x32_bf16 v[162:165], v[84:87], v[130:133], 0
ds_write_b32 v209, v33
v_mfma_f32_16x16x32_bf16 v[162:165], v[88:91], v[134:137], v[162:165]
v_mov_b32_dpp v154, v158 quad_perm:[0,1,2,3] row_mask:0x2 bank_mask:0xf
ds_write_b64 v203, v[56:57] offset:6336
s_nop 4
v_mov_b32_dpp v154, v162 quad_perm:[0,1,2,3] row_mask:0x4 bank_mask:0xf
v_mul_f32 v154, v154, v168
v_cvt_pk_bf16_f32 v154, v154, 0
ds_write_b16 v214, v154
v_add_u32 v214, 1424, v214
s_waitcnt lgkmcnt(0)
s_barrier
ds_read_b128 v[170:173], v210 offset:51200
ds_read_b128 v[182:185], v210 offset:52224
ds_read_b128 v[84:87], v27 offset:22784
ds_read_b128 v[88:91], v27 offset:22912
ds_read_b128 v[92:95], v27 offset:23040
ds_read_b128 v[96:99], v27 offset:23168
s_waitcnt lgkmcnt(5)
v_mfma_f32_16x16x32_bf16 v[60:63], a[144:147], v[170:173], v[60:63]
ds_read_b64 v[100:101], v27 offset:22800
ds_read_b64 v[102:103], v27 offset:22928
v_mfma_f32_16x16x32_bf16 v[64:67], a[168:171], v[170:173], v[64:67]
s_waitcnt lgkmcnt(6)
ds_read_b64 v[104:105], v27 offset:23056
ds_read_b64 v[106:107], v27 offset:23184
v_mfma_f32_16x16x32_bf16 v[64:67], a[172:175], v[182:185], v[64:67]
ds_read_b128 v[186:189], v210 offset:53248
ds_read_b64 v[120:121], v204
v_mfma_f32_16x16x32_bf16 v[60:63], a[148:151], v[182:185], v[60:63]
s_waitcnt vmcnt(16) lgkmcnt(9)
ds_read_b128 v[220:223], v210 offset:54272
ds_read_b128 v[110:113], v210 offset:55296
v_mfma_f32_16x16x32_bf16 v[12:15], a[144:147], v[84:87], v[12:15]
s_waitcnt lgkmcnt(10)
ds_read_b64 v[128:129], v204 offset:392
ds_read_b64 v[136:137], v204 offset:784
v_mfma_f32_16x16x32_bf16 v[12:15], a[148:151], v[88:91], v[12:15]
ds_read_b128 v[174:177], v210 offset:18432
s_waitcnt lgkmcnt(12)
v_mfma_f32_16x16x32_bf16 v[12:15], a[152:155], v[92:95], v[12:15]
s_waitcnt lgkmcnt(11)
v_mfma_f32_16x16x32_bf16 v[12:15], a[156:159], v[96:99], v[12:15]
s_waitcnt lgkmcnt(9)
v_mfma_f32_16x16x32_bf16 v[12:15], a[160:163], v[100:103], v[12:15]
s_waitcnt lgkmcnt(5)
buffer_store_dwordx2 v[120:121], v204, s[8:11], s28 offen sc1
ds_read_b64 v[120:121], v204 offset:1176
v_mfma_f32_16x16x32_bf16 v[12:15], a[164:167], v[104:107], v[12:15]
s_add_u32 s28, s39, s62
v_mfma_f32_16x16x32_bf16 v[68:71], a[192:195], v[170:173], v[68:71]
ds_read_b128 v[170:173], v210 offset:56320
v_mfma_f32_16x16x32_bf16 v[68:71], a[196:199], v[182:185], v[68:71]
s_waitcnt lgkmcnt(4)
buffer_store_dwordx2 v[128:129], v204, s[8:11], s29 offen sc1
v_cvt_pk_bf16_f32 v12, v12, v13
v_mfma_f32_16x16x32_bf16 v[60:63], a[152:155], v[186:189], v[60:63]
s_waitcnt vmcnt(17) lgkmcnt(2)
v_or3_b32 v174, v174, v175, v176
v_or_b32 v174, v174, v177
v_mfma_f32_16x16x32_bf16 v[60:63], a[156:159], v[220:223], v[60:63]
s_add_u32 s29, s39, s63
v_cvt_pk_bf16_f32 v13, v14, v15
v_readfirstlane_b32 s43, v174
v_mfma_f32_16x16x32_bf16 v[16:19], a[168:171], v[84:87], v[16:19]
s_nop 0
buffer_store_dwordx2 v[136:137], v204, s[8:11], s28 offen sc1
s_add_u32 s28, s39, s64
v_mfma_f32_16x16x32_bf16 v[16:19], a[172:175], v[88:91], v[16:19]
buffer_store_dwordx2 v[12:13], v30, s[8:11], 0 offen
v_mfma_f32_16x16x32_bf16 v[16:19], a[176:179], v[92:95], v[16:19]
v_mfma_f32_16x16x32_bf16 v[16:19], a[180:183], v[96:99], v[16:19]
v_mfma_f32_16x16x32_bf16 v[16:19], a[184:187], v[100:103], v[16:19]
v_mfma_f32_16x16x32_bf16 v[16:19], a[188:191], v[104:107], v[16:19]
v_mfma_f32_16x16x32_bf16 v[64:67], a[176:179], v[186:189], v[64:67]
v_mfma_f32_16x16x32_bf16 v[64:67], a[180:183], v[220:223], v[64:67]
v_cvt_pk_bf16_f32 v16, v16, v17
v_cvt_pk_bf16_f32 v17, v18, v19
v_mfma_f32_16x16x32_bf16 v[68:71], a[200:203], v[186:189], v[68:71]
buffer_store_dwordx2 v[16:17], v30, s[8:11], 0 offen offset:32
v_mfma_f32_16x16x32_bf16 v[68:71], a[204:207], v[220:223], v[68:71]
s_waitcnt vmcnt(19)
v_mfma_f32_16x16x32_bf16 v[20:23], a[192:195], v[84:87], v[20:23]
v_mfma_f32_16x16x32_bf16 v[20:23], a[196:199], v[88:91], v[20:23]
v_mfma_f32_16x16x32_bf16 v[20:23], a[200:203], v[92:95], v[20:23]
v_mfma_f32_16x16x32_bf16 v[20:23], a[204:207], v[96:99], v[20:23]
v_mfma_f32_16x16x32_bf16 v[20:23], a[208:211], v[100:103], v[20:23]
s_waitcnt lgkmcnt(1)
buffer_store_dwordx2 v[120:121], v204, s[8:11], s29 offen sc1
s_add_u32 s29, s39, s65
v_mfma_f32_16x16x32_bf16 v[20:23], a[212:215], v[104:107], v[20:23]
v_mfma_f32_16x16x32_bf16 v[60:63], a[160:163], v[110:113], v[60:63]
s_waitcnt lgkmcnt(0)
v_mfma_f32_16x16x32_bf16 v[60:63], a[164:167], v[170:173], v[60:63]
v_cvt_pk_bf16_f32 v20, v20, v21
v_cvt_pk_bf16_f32 v21, v22, v23
v_mfma_f32_16x16x32_bf16 v[64:67], a[184:187], v[110:113], v[64:67]
buffer_store_dwordx2 v[20:21], v30, s[8:11], 0 offen offset:64
v_mfma_f32_16x16x32_bf16 v[64:67], a[188:191], v[170:173], v[64:67]
v_cvt_pk_bf16_f32 v60, v60, v61
v_cvt_pk_bf16_f32 v61, v62, v63
v_mfma_f32_16x16x32_bf16 v[68:71], a[208:211], v[110:113], v[68:71]
ds_write_b64 v203, v[60:61] offset:12544
v_mfma_f32_16x16x32_bf16 v[68:71], a[212:215], v[170:173], v[68:71]
s_nop 0
v_cvt_pk_bf16_f32 v64, v64, v65
v_cvt_pk_bf16_f32 v65, v66, v67
ds_write_b64 v203, v[64:65] offset:12576
s_nop 3
v_cvt_pk_bf16_f32 v68, v68, v69
v_cvt_pk_bf16_f32 v69, v70, v71
ds_write_b64 v203, v[68:69] offset:12608
s_waitcnt lgkmcnt(0)
s_barrier
ds_read_b64 v[128:129], v204 offset:6272
ds_read_b64 v[136:137], v204 offset:6664
ds_read_b64 v[120:121], v204 offset:7056
s_waitcnt lgkmcnt(2)
buffer_store_dwordx2 v[128:129], v204, s[8:11], s28 offen sc1
s_add_u32 s28, s39, s66
ds_read_b64 v[128:129], v204 offset:7448
s_waitcnt lgkmcnt(2)
buffer_store_dwordx2 v[136:137], v204, s[8:11], s29 offen sc1
s_add_u32 s29, s39, s67
ds_read_b64 v[136:137], v204 offset:12544
s_waitcnt lgkmcnt(2)
buffer_store_dwordx2 v[120:121], v204, s[8:11], s28 offen sc1
s_add_u32 s28, s39, s68
ds_read_b64 v[120:121], v204 offset:12936
s_waitcnt lgkmcnt(2)
buffer_store_dwordx2 v[128:129], v204, s[8:11], s29 offen sc1
s_add_u32 s29, s39, s69
ds_read_b64 v[128:129], v204 offset:13328
s_waitcnt lgkmcnt(2)
buffer_store_dwordx2 v[136:137], v204, s[8:11], s28 offen sc1
s_add_u32 s28, s39, s70
ds_read_b64 v[136:137], v204 offset:13720
s_waitcnt lgkmcnt(2)
buffer_store_dwordx2 v[120:121], v204, s[8:11], s29 offen sc1
s_add_u32 s29, s39, s71
s_waitcnt lgkmcnt(1)
buffer_store_dwordx2 v[128:129], v204, s[8:11], s28 offen sc1
s_waitcnt lgkmcnt(0)
buffer_store_dwordx2 v[136:137], v204, s[8:11], s29 offen sc1
s_branch L_fin
F_pf:
v_subrev_u32 v103, 37120, v211
s_mov_b32 s96, m0
s_mov_b32 m0, 3600
v_lshlrev_b32 v103, 3, v103
global_load_lds_dword v103, s[98:99]
s_mov_b32 m0, s96
s_nop 0
s_branch F_nopf
L_redo:
s_mov_b32 s47, 1
s_waitcnt vmcnt(0) lgkmcnt(0)
s_barrier
s_branch L_start
L_safe:
.p2align 3
s_add_u32 s28, s28, 32
s_cmp_ge_u32 s28, 73
s_cselect_b32 s21, 73, 0
s_cselect_b32 s22, 1177344, 0
s_sub_u32 s28, s28, s21
s_add_u32 s20, s20, s22
s_add_u32 s20, s20, 86016
s_add_u32 m0, s96, 71488
s_mov_b32 exec_hi, 4194303
buffer_load_dwordx4 v82, s[4:7], s20 offen nt lds
s_mov_b32 exec_hi, -1
s_add_u32 s28, s28, 32
s_cmp_ge_u32 s28, 73
s_cselect_b32 s21, 73, 0
s_cselect_b32 s22, 1177344, 0
s_sub_u32 s28, s28, s21
s_add_u32 s20, s20, s22
s_add_u32 s20, s20, 86016
s_add_u32 m0, s96, 74960
s_mov_b32 exec_hi, 4194303
buffer_load_dwordx4 v82, s[4:7], s20 offen nt lds
s_mov_b32 exec_hi, -1
s_add_u32 s28, s28, 32
s_cmp_ge_u32 s28, 73
s_cselect_b32 s21, 73, 0
s_cselect_b32 s22, 1177344, 0
s_sub_u32 s28, s28, s21
s_add_u32 s20, s20, s22
s_add_u32 s20, s20, 86016
s_add_u32 m0, s96, 78432
s_mov_b32 exec_hi, 4194303
buffer_load_dwordx4 v82, s[4:7], s20 offen nt lds
s_mov_b32 exec_hi, -1
s_add_u32 s28, s28, 32
s_cmp_ge_u32 s28, 73
s_cselect_b32 s21, 73, 0
s_cselect_b32 s22, 1177344, 0
s_sub_u32 s28, s28, s21
s_add_u32 s20, s20, s22
s_add_u32 s20, s20, 86016
s_add_u32 m0, s96, 81904
s_mov_b32 exec_hi, 4194303
buffer_load_dwordx4 v82, s[4:7], s20 offen nt lds
s_mov_b32 exec_hi, -1
s_add_u32 s28, s28, 32
s_cmp_ge_u32 s28, 73
s_cselect_b32 s21, 73, 0
s_cselect_b32 s22, 1177344, 0
s_sub_u32 s28, s28, s21
s_add_u32 s20, s20, s22
s_add_u32 s20, s20, 86016
s_add_u32 m0, s96, 85376
s_mov_b32 exec_hi, 4194303
buffer_load_dwordx4 v82, s[4:7], s20 offen nt lds
s_mov_b32 exec_hi, -1
s_add_u32 s28, s28, 32
s_cmp_ge_u32 s28, 73
s_cselect_b32 s21, 73, 0
s_cselect_b32 s22, 1177344, 0
s_sub_u32 s28, s28, s21
s_add_u32 s20, s20, s22
s_add_u32 s20, s20, 86016
s_add_u32 m0, s96, 88848
s_mov_b32 exec_hi, 4194303
buffer_load_dwordx4 v82, s[4:7], s20 offen nt lds
s_mov_b32 exec_hi, -1
s_add_u32 s28, s28, 32
s_cmp_ge_u32 s28, 73
s_cselect_b32 s21, 73, 0
s_cselect_b32 s22, 1177344, 0
s_sub_u32 s28, s28, s21
s_add_u32 s20, s20, s22
s_add_u32 s20, s20, 86016
s_add_u32 m0, s96, 92320
s_mov_b32 exec_hi, 4194303
buffer_load_dwordx4 v82, s[4:7], s20 offen nt lds
s_mov_b32 exec_hi, -1
s_add_u32 s28, s28, 32
s_cmp_ge_u32 s28, 73
s_cselect_b32 s21, 73, 0
s_cselect_b32 s22, 1177344, 0
s_sub_u32 s28, s28, s21
s_add_u32 s20, s20, s22
s_add_u32 s20, s20, 86016
s_add_u32 m0, s96, 95792
s_mov_b32 exec_hi, 4194303
buffer_load_dwordx4 v82, s[4:7], s20 offen nt lds
s_mov_b32 exec_hi, -1
s_add_u32 s28, s28, 32
s_cmp_ge_u32 s28, 73
s_cselect_b32 s21, 73, 0
s_cselect_b32 s22, 1177344, 0
s_sub_u32 s28, s28, s21
s_add_u32 s20, s20, s22
s_add_u32 s20, s20, 86016
s_add_u32 m0, s96, 99264
s_mov_b32 exec_hi, 4194303
buffer_load_dwordx4 v82, s[4:7], s20 offen nt lds
s_mov_b32 exec_hi, -1
s_add_u32 s28, s28, 32
s_cmp_ge_u32 s28, 73
s_cselect_b32 s21, 73, 0
s_cselect_b32 s22, 1177344, 0
s_sub_u32 s28, s28, s21
s_add_u32 s20, s20, s22
s_add_u32 s20, s20, 86016
s_add_u32 m0, s96, 102736
s_mov_b32 exec_hi, 4194303
buffer_load_dwordx4 v82, s[4:7], s20 offen nt lds
s_mov_b32 exec_hi, -1
s_add_u32 s28, s28, 32
s_cmp_ge_u32 s28, 73
s_cselect_b32 s21, 73, 0
s_cselect_b32 s22, 1177344, 0
s_sub_u32 s28, s28, s21
s_add_u32 s20, s20, s22
s_add_u32 s20, s20, 86016
s_add_u32 m0, s96, 106208
s_mov_b32 exec_hi, 4194303
buffer_load_dwordx4 v82, s[4:7], s20 offen nt lds
s_mov_b32 exec_hi, -1
s_add_u32 s28, s28, 32
s_cmp_ge_u32 s28, 73
s_cselect_b32 s21, 73, 0
s_cselect_b32 s22, 1177344, 0
s_sub_u32 s28, s28, s21
s_add_u32 s20, s20, s22
s_add_u32 s20, s20, 86016
s_add_u32 m0, s96, 109680
s_mov_b32 exec_hi, 4194303
buffer_load_dwordx4 v82, s[4:7], s20 offen nt lds
s_mov_b32 exec_hi, -1
s_add_u32 s28, s28, 32
s_cmp_ge_u32 s28, 73
s_cselect_b32 s21, 73, 0
s_cselect_b32 s22, 1177344, 0
s_sub_u32 s28, s28, s21
s_add_u32 s20, s20, s22
s_add_u32 s20, s20, 86016
s_add_u32 m0, s96, 113152
s_mov_b32 exec_hi, 4194303
buffer_load_dwordx4 v82, s[4:7], s20 offen nt lds
s_mov_b32 exec_hi, -1
s_add_u32 s28, s28, 32
s_cmp_ge_u32 s28, 73
s_cselect_b32 s21, 73, 0
s_cselect_b32 s22, 1177344, 0
s_sub_u32 s28, s28, s21
s_add_u32 s20, s20, s22
s_add_u32 s20, s20, 86016
s_add_u32 m0, s96, 116624
s_mov_b32 exec_hi, 4194303
buffer_load_dwordx4 v82, s[4:7], s20 offen nt lds
s_mov_b32 exec_hi, -1
s_add_u32 s28, s28, 32
s_cmp_ge_u32 s28, 73
s_cselect_b32 s21, 73, 0
s_cselect_b32 s22, 1177344, 0
s_sub_u32 s28, s28, s21
s_add_u32 s20, s20, s22
s_add_u32 s20, s20, 86016
s_add_u32 m0, s96, 120096
s_mov_b32 exec_hi, 4194303
buffer_load_dwordx4 v82, s[4:7], s20 offen nt lds
s_mov_b32 exec_hi, -1
s_add_u32 s28, s28, 32
s_cmp_ge_u32 s28, 73
s_cselect_b32 s21, 73, 0
s_cselect_b32 s22, 1177344, 0
s_sub_u32 s28, s28, s21
s_add_u32 s20, s20, s22
s_add_u32 s20, s20, 86016
s_add_u32 m0, s96, 123568
s_mov_b32 exec_hi, 4194303
buffer_load_dwordx4 v82, s[4:7], s20 offen nt lds
s_mov_b32 exec_hi, -1
s_add_u32 m0, s55, 131328
s_add_u32 s29, s54, 384
buffer_load_dwordx4 v72, s[12:15], s29 offen lds
s_add_u32 m0, s55, 132352
s_add_u32 s29, s54, 384
buffer_load_dwordx4 v73, s[12:15], s29 offen lds
s_add_u32 m0, s55, 133376
s_add_u32 s29, s54, 384
buffer_load_dwordx4 v74, s[12:15], s29 offen lds
ds_read_b128 v[84:87], v200
s_waitcnt lgkmcnt(0)
v_mfma_f32_16x16x32_bf16 v[0:3], v[138:141], v[84:87], 0
ds_read_b128 v[92:95], v201
s_waitcnt lgkmcnt(0)
v_mfma_f32_16x16x32_bf16 v[12:15], v[138:141], v[92:95], 0
ds_read_b128 v[100:103], v202
s_waitcnt lgkmcnt(0)
v_mfma_f32_16x16x32_bf16 v[24:27], v[138:141], v[100:103], 0
ds_read_b128 v[84:87], v194
ds_read_b128 v[88:91], v194 offset:16
s_waitcnt lgkmcnt(0)
v_smfmac_f32_16x16x64_bf16 v[0:3], v[142:145], v[84:91], v213
ds_read_b128 v[92:95], v195
ds_read_b128 v[96:99], v195 offset:16
s_waitcnt lgkmcnt(0)
v_smfmac_f32_16x16x64_bf16 v[12:15], v[142:145], v[92:99], v213
ds_read_b128 v[100:103], v196
ds_read_b128 v[104:107], v196 offset:16
s_waitcnt lgkmcnt(0)
v_smfmac_f32_16x16x64_bf16 v[24:27], v[142:145], v[100:107], v213
ds_read_b128 v[84:87], v197
ds_read_b128 v[88:91], v197 offset:16
s_waitcnt lgkmcnt(0)
v_smfmac_f32_16x16x64_bf16 v[0:3], v[146:149], v[84:91], v213
ds_read_b128 v[92:95], v198
ds_read_b128 v[96:99], v198 offset:16
s_waitcnt lgkmcnt(0)
v_smfmac_f32_16x16x64_bf16 v[12:15], v[146:149], v[92:99], v213
ds_read_b128 v[100:103], v199
ds_read_b128 v[104:107], v199 offset:16
s_waitcnt lgkmcnt(0)
v_smfmac_f32_16x16x64_bf16 v[24:27], v[146:149], v[100:107], v213
ds_read_b128 v[84:87], v200 offset:32
s_waitcnt lgkmcnt(0)
v_mfma_f32_16x16x32_bf16 v[4:7], v[150:153], v[84:87], 0
ds_read_b128 v[92:95], v201 offset:32
s_waitcnt lgkmcnt(0)
v_mfma_f32_16x16x32_bf16 v[16:19], v[150:153], v[92:95], 0
ds_read_b128 v[100:103], v202 offset:32
s_waitcnt lgkmcnt(0)
v_mfma_f32_16x16x32_bf16 v[28:31], v[150:153], v[100:103], 0
ds_read_b128 v[84:87], v194 offset:32
ds_read_b128 v[88:91], v194 offset:48
s_waitcnt lgkmcnt(0)
v_smfmac_f32_16x16x64_bf16 v[4:7], v[154:157], v[84:91], v213
ds_read_b128 v[92:95], v195 offset:32
ds_read_b128 v[96:99], v195 offset:48
s_waitcnt lgkmcnt(0)
v_smfmac_f32_16x16x64_bf16 v[16:19], v[154:157], v[92:99], v213
ds_read_b128 v[100:103], v196 offset:32
ds_read_b128 v[104:107], v196 offset:48
s_waitcnt lgkmcnt(0)
v_smfmac_f32_16x16x64_bf16 v[28:31], v[154:157], v[100:107], v213
ds_read_b128 v[84:87], v197 offset:32
ds_read_b128 v[88:91], v197 offset:48
s_waitcnt lgkmcnt(0)
v_smfmac_f32_16x16x64_bf16 v[4:7], v[158:161], v[84:91], v213
ds_read_b128 v[92:95], v198 offset:32
ds_read_b128 v[96:99], v198 offset:48
s_waitcnt lgkmcnt(0)
v_smfmac_f32_16x16x64_bf16 v[16:19], v[158:161], v[92:99], v213
ds_read_b128 v[100:103], v199 offset:32
ds_read_b128 v[104:107], v199 offset:48
s_waitcnt lgkmcnt(0)
v_smfmac_f32_16x16x64_bf16 v[28:31], v[158:161], v[100:107], v213
ds_read_b128 v[84:87], v200 offset:64
s_waitcnt lgkmcnt(0)
v_mfma_f32_16x16x32_bf16 v[8:11], v[162:165], v[84:87], 0
ds_read_b128 v[92:95], v201 offset:64
s_waitcnt lgkmcnt(0)
v_mfma_f32_16x16x32_bf16 v[20:23], v[162:165], v[92:95], 0
ds_read_b128 v[100:103], v202 offset:64
s_waitcnt lgkmcnt(0)
v_mfma_f32_16x16x32_bf16 v[32:35], v[162:165], v[100:103], 0
ds_read_b128 v[84:87], v194 offset:64
ds_read_b128 v[88:91], v194 offset:80
s_waitcnt lgkmcnt(0)
v_smfmac_f32_16x16x64_bf16 v[8:11], v[166:169], v[84:91], v213
ds_read_b128 v[92:95], v195 offset:64
ds_read_b128 v[96:99], v195 offset:80
s_waitcnt lgkmcnt(0)
v_smfmac_f32_16x16x64_bf16 v[20:23], v[166:169], v[92:99], v213
ds_read_b128 v[100:103], v196 offset:64
ds_read_b128 v[104:107], v196 offset:80
s_waitcnt lgkmcnt(0)
v_smfmac_f32_16x16x64_bf16 v[32:35], v[166:169], v[100:107], v213
ds_read_b128 v[84:87], v197 offset:64
ds_read_b128 v[88:91], v197 offset:80
s_waitcnt lgkmcnt(0)
v_smfmac_f32_16x16x64_bf16 v[8:11], v[170:173], v[84:91], v213
ds_read_b128 v[92:95], v198 offset:64
ds_read_b128 v[96:99], v198 offset:80
s_waitcnt lgkmcnt(0)
v_smfmac_f32_16x16x64_bf16 v[20:23], v[170:173], v[92:99], v213
ds_read_b128 v[100:103], v199 offset:64
ds_read_b128 v[104:107], v199 offset:80
s_waitcnt lgkmcnt(0)
v_smfmac_f32_16x16x64_bf16 v[32:35], v[170:173], v[100:107], v213
v_add_f32 v118, v0, v1
v_mul_f32 v119, v0, v0
v_add_f32 v118, v118, v2
v_fmac_f32 v119, v1, v1
v_add_f32 v118, v118, v3
v_fmac_f32 v119, v2, v2
v_fmac_f32 v119, v3, v3
v_add_f32 v126, v12, v13
v_mul_f32 v127, v12, v12
v_add_f32 v126, v126, v14
v_fmac_f32 v127, v13, v13
v_add_f32 v126, v126, v15
v_fmac_f32 v127, v14, v14
v_fmac_f32 v127, v15, v15
v_add_f32 v134, v24, v25
v_mul_f32 v135, v24, v24
v_add_f32 v134, v134, v26
v_fmac_f32 v135, v25, v25
v_add_f32 v134, v134, v27
v_fmac_f32 v135, v26, v26
v_fmac_f32 v135, v27, v27
v_add_f32 v118, v118, v4
v_fmac_f32 v119, v4, v4
v_add_f32 v118, v118, v5
v_fmac_f32 v119, v5, v5
v_add_f32 v118, v118, v6
v_fmac_f32 v119, v6, v6
v_add_f32 v118, v118, v7
v_fmac_f32 v119, v7, v7
v_add_f32 v126, v126, v16
v_fmac_f32 v127, v16, v16
v_add_f32 v126, v126, v17
v_fmac_f32 v127, v17, v17
v_add_f32 v126, v126, v18
v_fmac_f32 v127, v18, v18
v_add_f32 v126, v126, v19
v_fmac_f32 v127, v19, v19
v_add_f32 v134, v134, v28
v_fmac_f32 v135, v28, v28
v_add_f32 v134, v134, v29
v_fmac_f32 v135, v29, v29
v_add_f32 v134, v134, v30
v_fmac_f32 v135, v30, v30
v_add_f32 v134, v134, v31
v_fmac_f32 v135, v31, v31
v_add_f32 v118, v118, v8
v_fmac_f32 v119, v8, v8
v_add_f32 v118, v118, v9
v_fmac_f32 v119, v9, v9
v_add_f32 v118, v118, v10
v_fmac_f32 v119, v10, v10
v_add_f32 v118, v118, v11
v_fmac_f32 v119, v11, v11
v_add_f32 v126, v126, v20
v_fmac_f32 v127, v20, v20
v_add_f32 v126, v126, v21
v_fmac_f32 v127, v21, v21
v_add_f32 v126, v126, v22
v_fmac_f32 v127, v22, v22
v_add_f32 v126, v126, v23
v_fmac_f32 v127, v23, v23
v_add_f32 v134, v134, v32
v_fmac_f32 v135, v32, v32
v_add_f32 v134, v134, v33
v_fmac_f32 v135, v33, v33
v_add_f32 v134, v134, v34
v_fmac_f32 v135, v34, v34
v_add_f32 v134, v134, v35
v_fmac_f32 v135, v35, v35
v_permlane16_swap_b32 v118, v119
v_add_f32 v118, v118, v119
v_permlane16_swap_b32 v126, v127
v_add_f32 v126, v126, v127
v_permlane16_swap_b32 v134, v135
v_add_f32 v134, v134, v135
v_permlane32_swap_b32 v118, v126
v_add_f32 v118, v118, v126
ds_write_b32 v209, v118
v_mov_b32 v135, v134
s_nop 1
v_permlane32_swap_b32 v134, v135
v_add_f32 v134, v134, v135
ds_write_b32 v209, v134 offset:512
s_waitcnt lgkmcnt(0)
s_barrier
ds_read_b128 v[102:105], v210 offset:18432
ds_read_b128 v[106:109], v210 offset:19456
s_waitcnt lgkmcnt(1)
v_add_f32 v102, v102, v103
s_waitcnt lgkmcnt(0)
v_add_f32 v106, v106, v107
v_add_f32 v104, v104, v105
v_add_f32 v108, v108, v109
v_add_f32 v102, v102, v104
v_add_f32 v106, v106, v108
v_mul_f32 v103, s48, v102
v_mul_f32 v104, s73, v102
v_mul_f32 v106, s73, v106
v_fma_f32 v106, -v103, v104, v106
v_max_f32 v106, 0, v106
v_add_f32 v106, s49, v106
v_rsq_f32 v102, v106
s_nop 0
v_mul_f32_e64 v103, -v103, v102
ds_write_b64 v211, v[102:103]
ds_read_b64 v[118:119], v219
ds_read_b64 v[126:127], v219 offset:256
ds_read_b64 v[134:135], v219 offset:512
s_waitcnt lgkmcnt(2)
v_fma_f32 v220, v0, v118, v119
v_fma_f32 v221, v1, v118, v119
v_cvt_pk_bf16_f32 v90, v220, v221
v_fma_f32 v222, v2, v118, v119
v_fma_f32 v223, v3, v118, v119
v_cvt_pk_bf16_f32 v91, v222, v223
v_fma_f32 v220, v4, v118, v119
v_fma_f32 v221, v5, v118, v119
v_cvt_pk_bf16_f32 v92, v220, v221
v_fma_f32 v222, v6, v118, v119
v_fma_f32 v223, v7, v118, v119
v_cvt_pk_bf16_f32 v93, v222, v223
ds_write_b128 v211, v[90:93]
v_fma_f32 v220, v8, v118, v119
v_fma_f32 v221, v9, v118, v119
v_cvt_pk_bf16_f32 v94, v220, v221
v_fma_f32 v222, v10, v118, v119
v_fma_f32 v223, v11, v118, v119
v_cvt_pk_bf16_f32 v95, v222, v223
s_waitcnt lgkmcnt(2)
ds_write_b64 v212, v[94:95]
v_fma_f32 v220, v12, v126, v127
v_fma_f32 v221, v13, v126, v127
v_cvt_pk_bf16_f32 v174, v220, v221
v_fma_f32 v222, v14, v126, v127
v_fma_f32 v223, v15, v126, v127
v_cvt_pk_bf16_f32 v175, v222, v223
v_fma_f32 v220, v16, v126, v127
v_fma_f32 v221, v17, v126, v127
v_cvt_pk_bf16_f32 v176, v220, v221
v_fma_f32 v222, v18, v126, v127
v_fma_f32 v223, v19, v126, v127
v_cvt_pk_bf16_f32 v177, v222, v223
ds_write_b128 v211, v[174:177] offset:6144
v_fma_f32 v220, v20, v126, v127
v_fma_f32 v221, v21, v126, v127
v_cvt_pk_bf16_f32 v178, v220, v221
v_fma_f32 v222, v22, v126, v127
v_fma_f32 v223, v23, v126, v127
v_cvt_pk_bf16_f32 v179, v222, v223
s_waitcnt lgkmcnt(3)
ds_write_b64 v212, v[178:179] offset:6144
v_fma_f32 v220, v24, v134, v135
v_fma_f32 v221, v25, v134, v135
v_cvt_pk_bf16_f32 v90, v220, v221
v_fma_f32 v222, v26, v134, v135
v_fma_f32 v223, v27, v134, v135
v_cvt_pk_bf16_f32 v91, v222, v223
v_fma_f32 v220, v28, v134, v135
v_fma_f32 v221, v29, v134, v135
v_cvt_pk_bf16_f32 v92, v220, v221
v_fma_f32 v222, v30, v134, v135
v_fma_f32 v223, v31, v134, v135
v_cvt_pk_bf16_f32 v93, v222, v223
ds_write_b128 v211, v[90:93] offset:12288
v_fma_f32 v220, v32, v134, v135
v_fma_f32 v221, v33, v134, v135
v_cvt_pk_bf16_f32 v94, v220, v221
v_fma_f32 v222, v34, v134, v135
v_fma_f32 v223, v35, v134, v135
v_cvt_pk_bf16_f32 v95, v222, v223
ds_write_b64 v212, v[94:95] offset:12288
s_mov_b64 exec, s[30:31]
ds_write_b128 v217, v[138:141]
s_mov_b64 exec, -1
s_mov_b64 exec, s[30:31]
ds_write_b128 v217, v[142:145] offset:528
s_mov_b64 exec, -1
s_mov_b64 exec, s[30:31]
ds_write_b128 v217, v[146:149] offset:1056
s_mov_b64 exec, -1
s_mov_b64 exec, s[30:31]
ds_write_b128 v217, v[150:153] offset:1584
s_mov_b64 exec, -1
s_mov_b64 exec, s[30:31]
ds_write_b128 v217, v[154:157] offset:2112
s_mov_b64 exec, -1
s_mov_b64 exec, s[30:31]
ds_write_b128 v217, v[158:161] offset:2640
s_mov_b64 exec, -1
s_mov_b64 exec, s[30:31]
ds_write_b128 v217, v[162:165] offset:3168
s_mov_b64 exec, -1
s_mov_b64 exec, s[30:31]
ds_write_b128 v217, v[166:169] offset:3696
s_mov_b64 exec, -1
s_mov_b64 exec, s[30:31]
ds_write_b128 v217, v[170:173] offset:4224
s_mov_b64 exec, -1
s_add_u32 m0, s55, 0
s_add_u32 s29, s54, 37248
buffer_load_dwordx4 v72, s[12:15], s29 offen lds
s_add_u32 m0, s55, 1024
s_add_u32 s29, s54, 37248
buffer_load_dwordx4 v73, s[12:15], s29 offen lds
s_add_u32 m0, s55, 2048
s_add_u32 s29, s54, 37248
buffer_load_dwordx4 v74, s[12:15], s29 offen lds
s_add_u32 m0, s55, 12288
s_add_u32 s29, s54, 74112
buffer_load_dwordx4 v72, s[12:15], s29 offen lds
s_add_u32 m0, s55, 13312
s_add_u32 s29, s54, 74112
buffer_load_dwordx4 v73, s[12:15], s29 offen lds
s_add_u32 m0, s55, 14336
s_add_u32 s29, s54, 74112
buffer_load_dwordx4 v74, s[12:15], s29 offen lds
s_add_u32 m0, s55, 24576
s_add_u32 s29, s54, 110976
buffer_load_dwordx4 v72, s[12:15], s29 offen lds
s_add_u32 m0, s55, 25600
s_add_u32 s29, s54, 110976
buffer_load_dwordx4 v73, s[12:15], s29 offen lds
s_waitcnt vmcnt(11) lgkmcnt(9)
s_add_u32 m0, s55, 26624
s_add_u32 s29, s54, 110976
buffer_load_dwordx4 v74, s[12:15], s29 offen lds
s_barrier
ds_read_b128 v[84:87], v113
s_waitcnt lgkmcnt(0)
v_mfma_f32_16x16x32_bf16 v[36:39], v[138:141], v[84:87], 0
ds_read_b128 v[92:95], v113 offset:55552
s_waitcnt lgkmcnt(0)
v_mfma_f32_16x16x32_bf16 v[48:51], v[138:141], v[92:95], 0
ds_read_b128 v[100:103], v111
ds_read_b128 v[104:107], v111 offset:16
s_waitcnt lgkmcnt(0)
v_smfmac_f32_16x16x64_bf16 v[36:39], v[142:145], v[100:107], v213
ds_read_b128 v[84:87], v111 offset:55552
ds_read_b128 v[88:91], v111 offset:55568
s_waitcnt lgkmcnt(0)
v_smfmac_f32_16x16x64_bf16 v[48:51], v[142:145], v[84:91], v213
ds_read_b128 v[92:95], v112
ds_read_b128 v[96:99], v112 offset:16
s_waitcnt lgkmcnt(0)
v_smfmac_f32_16x16x64_bf16 v[36:39], v[146:149], v[92:99], v213
ds_read_b128 v[100:103], v112 offset:55552
ds_read_b128 v[104:107], v112 offset:55568
s_waitcnt lgkmcnt(0)
v_smfmac_f32_16x16x64_bf16 v[48:51], v[146:149], v[100:107], v213
ds_read_b128 v[84:87], v113 offset:32
s_waitcnt lgkmcnt(0)
v_mfma_f32_16x16x32_bf16 v[40:43], v[150:153], v[84:87], 0
ds_read_b128 v[92:95], v113 offset:55584
s_waitcnt lgkmcnt(0)
v_mfma_f32_16x16x32_bf16 v[52:55], v[150:153], v[92:95], 0
ds_read_b128 v[100:103], v111 offset:32
ds_read_b128 v[104:107], v111 offset:48
s_waitcnt lgkmcnt(0)
v_smfmac_f32_16x16x64_bf16 v[40:43], v[154:157], v[100:107], v213
ds_read_b128 v[84:87], v111 offset:55584
ds_read_b128 v[88:91], v111 offset:55600
s_waitcnt lgkmcnt(0)
v_smfmac_f32_16x16x64_bf16 v[52:55], v[154:157], v[84:91], v213
ds_read_b128 v[92:95], v112 offset:32
ds_read_b128 v[96:99], v112 offset:48
s_waitcnt lgkmcnt(0)
v_smfmac_f32_16x16x64_bf16 v[40:43], v[158:161], v[92:99], v213
ds_read_b128 v[100:103], v112 offset:55584
ds_read_b128 v[104:107], v112 offset:55600
s_waitcnt lgkmcnt(0)
v_smfmac_f32_16x16x64_bf16 v[52:55], v[158:161], v[100:107], v213
ds_read_b128 v[84:87], v113 offset:64
s_waitcnt lgkmcnt(0)
v_mfma_f32_16x16x32_bf16 v[44:47], v[162:165], v[84:87], 0
ds_read_b128 v[92:95], v113 offset:55616
s_waitcnt lgkmcnt(0)
v_mfma_f32_16x16x32_bf16 v[56:59], v[162:165], v[92:95], 0
ds_read_b128 v[100:103], v111 offset:64
ds_read_b128 v[104:107], v111 offset:80
s_waitcnt lgkmcnt(0)
v_smfmac_f32_16x16x64_bf16 v[44:47], v[166:169], v[100:107], v213
ds_read_b128 v[84:87], v111 offset:55616
ds_read_b128 v[88:91], v111 offset:55632
s_waitcnt lgkmcnt(0)
v_smfmac_f32_16x16x64_bf16 v[56:59], v[166:169], v[84:91], v213
ds_read_b128 v[92:95], v112 offset:64
ds_read_b128 v[96:99], v112 offset:80
s_waitcnt lgkmcnt(0)
v_smfmac_f32_16x16x64_bf16 v[44:47], v[170:173], v[92:99], v213
ds_read_b128 v[100:103], v112 offset:55616
ds_read_b128 v[104:107], v112 offset:55632
s_waitcnt lgkmcnt(0)
v_smfmac_f32_16x16x64_bf16 v[56:59], v[170:173], v[100:107], v213
s_barrier
v_add_f32 v118, v36, v37
v_mul_f32 v119, v36, v36
v_add_f32 v118, v118, v38
v_fmac_f32 v119, v37, v37
v_add_f32 v118, v118, v39
v_fmac_f32 v119, v38, v38
v_fmac_f32 v119, v39, v39
v_add_f32 v126, v48, v49
v_mul_f32 v127, v48, v48
v_add_f32 v126, v126, v50
v_fmac_f32 v127, v49, v49
v_add_f32 v126, v126, v51
v_fmac_f32 v127, v50, v50
v_fmac_f32 v127, v51, v51
v_add_f32 v118, v118, v40
v_fmac_f32 v119, v40, v40
v_add_f32 v118, v118, v41
v_fmac_f32 v119, v41, v41
v_add_f32 v118, v118, v42
v_fmac_f32 v119, v42, v42
v_add_f32 v118, v118, v43
v_fmac_f32 v119, v43, v43
v_add_f32 v126, v126, v52
v_fmac_f32 v127, v52, v52
v_add_f32 v126, v126, v53
v_fmac_f32 v127, v53, v53
v_add_f32 v126, v126, v54
v_fmac_f32 v127, v54, v54
v_add_f32 v126, v126, v55
v_fmac_f32 v127, v55, v55
v_add_f32 v118, v118, v44
v_fmac_f32 v119, v44, v44
v_add_f32 v118, v118, v45
v_fmac_f32 v119, v45, v45
v_add_f32 v118, v118, v46
v_fmac_f32 v119, v46, v46
v_add_f32 v118, v118, v47
v_fmac_f32 v119, v47, v47
v_add_f32 v126, v126, v56
v_fmac_f32 v127, v56, v56
v_add_f32 v126, v126, v57
v_fmac_f32 v127, v57, v57
v_add_f32 v126, v126, v58
v_fmac_f32 v127, v58, v58
v_add_f32 v126, v126, v59
v_fmac_f32 v127, v59, v59
v_permlane16_swap_b32 v118, v119
v_add_f32 v118, v118, v119
v_permlane16_swap_b32 v126, v127
v_add_f32 v126, v126, v127
s_nop 1
v_permlane32_swap_b32 v118, v126
v_add_f32 v118, v118, v126
ds_write_b32 v209, v118
s_add_u32 m0, s55, 94464
s_add_u32 s29, s54, 147840
buffer_load_dwordx4 v72, s[12:15], s29 offen lds
s_add_u32 m0, s55, 95488
s_add_u32 s29, s54, 147840
buffer_load_dwordx4 v73, s[12:15], s29 offen lds
s_add_u32 m0, s55, 96512
s_add_u32 s29, s54, 147840
buffer_load_dwordx4 v74, s[12:15], s29 offen lds
s_add_u32 m0, s55, 106752
s_add_u32 s29, s54, 184704
buffer_load_dwordx4 v72, s[12:15], s29 offen lds
s_add_u32 m0, s55, 107776
s_add_u32 s29, s54, 184704
buffer_load_dwordx4 v73, s[12:15], s29 offen lds
s_add_u32 m0, s55, 108800
s_add_u32 s29, s54, 184704
buffer_load_dwordx4 v74, s[12:15], s29 offen lds
s_add_u32 m0, s55, 119040
s_add_u32 s29, s54, 0
buffer_load_dwordx4 v72, s[12:15], s29 offen lds
s_add_u32 m0, s55, 120064
s_add_u32 s29, s54, 0
buffer_load_dwordx4 v73, s[12:15], s29 offen lds
s_add_u32 m0, s55, 121088
s_add_u32 s29, s54, 0
buffer_load_dwordx4 v74, s[12:15], s29 offen lds
s_add_u32 m0, s55, 69888
s_add_u32 s29, s54, 36864
buffer_load_dwordx4 v72, s[12:15], s29 offen lds
s_add_u32 m0, s55, 70912
s_add_u32 s29, s54, 36864
buffer_load_dwordx4 v73, s[12:15], s29 offen lds
s_add_u32 m0, s55, 71936
s_add_u32 s29, s54, 36864
buffer_load_dwordx4 v74, s[12:15], s29 offen lds
s_add_u32 m0, s55, 82176
s_add_u32 s29, s54, 73728
buffer_load_dwordx4 v72, s[12:15], s29 offen lds
s_add_u32 m0, s55, 83200
s_add_u32 s29, s54, 73728
buffer_load_dwordx4 v73, s[12:15], s29 offen lds
s_add_u32 m0, s55, 84224
s_add_u32 s29, s54, 73728
buffer_load_dwordx4 v74, s[12:15], s29 offen lds
s_waitcnt vmcnt(25)
ds_read_b64_tr_b16 a[0:1], v110 offset:36864
ds_read_b64_tr_b16 a[24:25], v110 offset:36896
ds_read_b64_tr_b16 a[48:49], v110 offset:36928
s_waitcnt vmcnt(24)
ds_read_b64_tr_b16 a[2:3], v110 offset:38400
ds_read_b64_tr_b16 a[26:27], v110 offset:38432
ds_read_b64_tr_b16 a[50:51], v110 offset:38464
s_waitcnt vmcnt(21)
ds_read_b64_tr_b16 a[4:5], v128 offset:1536
ds_read_b64_tr_b16 a[28:29], v128 offset:1568
ds_read_b64_tr_b16 a[52:53], v128 offset:1600
ds_read_b64_tr_b16 a[16:17], v128
ds_read_b64_tr_b16 a[40:41], v128 offset:32
ds_read_b64_tr_b16 a[64:65], v128 offset:64
s_waitcnt vmcnt(19)
ds_read_b64_tr_b16 a[6:7], v128 offset:12288
ds_read_b64_tr_b16 a[30:31], v128 offset:12320
ds_read_b64_tr_b16 a[54:55], v128 offset:12352
s_waitcnt vmcnt(18)
ds_read_b64_tr_b16 a[18:19], v128 offset:13824
ds_read_b64_tr_b16 a[42:43], v128 offset:13856
ds_read_b64_tr_b16 a[66:67], v128 offset:13888
s_waitcnt vmcnt(16)
ds_read_b64_tr_b16 a[8:9], v128 offset:24576
ds_read_b64_tr_b16 a[32:33], v128 offset:24608
ds_read_b64_tr_b16 a[56:57], v128 offset:24640
s_waitcnt vmcnt(15)
ds_read_b64_tr_b16 a[10:11], v128 offset:26112
ds_read_b64_tr_b16 a[34:35], v128 offset:26144
ds_read_b64_tr_b16 a[58:59], v128 offset:26176
v_mov_b32 v128, v83
s_waitcnt lgkmcnt(14)
s_add_u32 m0, s55, 131328
s_add_u32 s29, s54, 110592
buffer_load_dwordx4 v72, s[12:15], s29 offen lds
s_add_u32 m0, s55, 132352
s_add_u32 s29, s54, 110592
buffer_load_dwordx4 v73, s[12:15], s29 offen lds
s_add_u32 m0, s55, 133376
s_add_u32 s29, s54, 110592
buffer_load_dwordx4 v74, s[12:15], s29 offen lds
s_barrier
ds_read_b128 v[102:105], v210 offset:18432
ds_read_b128 v[106:109], v210 offset:19456
s_waitcnt lgkmcnt(1)
v_add_f32 v102, v102, v103
s_waitcnt lgkmcnt(0)
v_add_f32 v106, v106, v107
v_add_f32 v104, v104, v105
v_add_f32 v108, v108, v109
v_add_f32 v102, v102, v104
v_add_f32 v106, v106, v108
v_mul_f32 v103, s48, v102
v_mul_f32 v104, s73, v102
v_mul_f32 v106, s73, v106
v_fma_f32 v106, -v103, v104, v106
v_max_f32 v106, 0, v106
v_add_f32 v106, s49, v106
v_rsq_f32 v102, v106
s_nop 0
v_mul_f32_e64 v103, -v103, v102
ds_write_b64 v211, v[102:103] offset:20480
ds_read_b64 v[118:119], v219 offset:20480
ds_read_b64 v[126:127], v219 offset:20736
s_waitcnt lgkmcnt(1)
v_fma_f32 v220, v36, v118, v119
v_fma_f32 v221, v37, v118, v119
v_cvt_pk_bf16_f32 v90, v220, v221
v_fma_f32 v222, v38, v118, v119
v_fma_f32 v223, v39, v118, v119
v_cvt_pk_bf16_f32 v91, v222, v223
v_fma_f32 v220, v40, v118, v119
v_fma_f32 v221, v41, v118, v119
v_cvt_pk_bf16_f32 v92, v220, v221
v_fma_f32 v222, v42, v118, v119
v_fma_f32 v223, v43, v118, v119
v_cvt_pk_bf16_f32 v93, v222, v223
ds_write_b128 v211, v[90:93] offset:20480
v_fma_f32 v220, v44, v118, v119
v_fma_f32 v221, v45, v118, v119
v_cvt_pk_bf16_f32 v94, v220, v221
v_fma_f32 v222, v46, v118, v119
v_fma_f32 v223, v47, v118, v119
v_cvt_pk_bf16_f32 v95, v222, v223
s_waitcnt lgkmcnt(1)
ds_write_b64 v212, v[94:95] offset:20480
v_fma_f32 v220, v48, v126, v127
v_fma_f32 v221, v49, v126, v127
v_cvt_pk_bf16_f32 v174, v220, v221
v_fma_f32 v222, v50, v126, v127
v_fma_f32 v223, v51, v126, v127
v_cvt_pk_bf16_f32 v175, v222, v223
v_fma_f32 v220, v52, v126, v127
v_fma_f32 v221, v53, v126, v127
v_cvt_pk_bf16_f32 v176, v220, v221
v_fma_f32 v222, v54, v126, v127
v_fma_f32 v223, v55, v126, v127
v_cvt_pk_bf16_f32 v177, v222, v223
ds_write_b128 v211, v[174:177] offset:26624
v_fma_f32 v220, v56, v126, v127
v_fma_f32 v221, v57, v126, v127
v_cvt_pk_bf16_f32 v178, v220, v221
v_fma_f32 v222, v58, v126, v127
v_fma_f32 v223, v59, v126, v127
v_cvt_pk_bf16_f32 v179, v222, v223
ds_write_b64 v212, v[178:179] offset:26624
s_waitcnt vmcnt(15) lgkmcnt(0)
s_barrier
ds_read_b64_tr_b16 a[12:13], v110 offset:1536
ds_read_b64_tr_b16 a[36:37], v110 offset:1568
ds_read_b64_tr_b16 a[60:61], v110 offset:1600
ds_read_b64_tr_b16 a[20:21], v110
ds_read_b64_tr_b16 a[44:45], v110 offset:32
ds_read_b64_tr_b16 a[68:69], v110 offset:64
s_waitcnt lgkmcnt(0)
s_add_u32 m0, s55, 94464
s_add_u32 s29, s54, 147456
buffer_load_dwordx4 v72, s[12:15], s29 offen lds
s_add_u32 m0, s55, 95488
s_add_u32 s29, s54, 147456
buffer_load_dwordx4 v73, s[12:15], s29 offen lds
s_add_u32 m0, s55, 96512
s_add_u32 s29, s54, 147456
buffer_load_dwordx4 v74, s[12:15], s29 offen lds
s_waitcnt vmcnt(16)
ds_read_b64_tr_b16 a[14:15], v110 offset:12288
ds_read_b64_tr_b16 a[38:39], v110 offset:12320
ds_read_b64_tr_b16 a[62:63], v110 offset:12352
s_waitcnt vmcnt(15)
ds_read_b64_tr_b16 a[22:23], v110 offset:13824
ds_read_b64_tr_b16 a[46:47], v110 offset:13856
ds_read_b64_tr_b16 a[70:71], v110 offset:13888
s_waitcnt lgkmcnt(0)
s_add_u32 m0, s55, 106752
s_add_u32 s29, s54, 184320
buffer_load_dwordx4 v72, s[12:15], s29 offen lds
s_add_u32 m0, s55, 107776
s_add_u32 s29, s54, 184320
buffer_load_dwordx4 v73, s[12:15], s29 offen lds
s_add_u32 m0, s55, 108800
s_add_u32 s29, s54, 184320
buffer_load_dwordx4 v74, s[12:15], s29 offen lds
s_waitcnt vmcnt(16)
ds_read_b64_tr_b16 a[216:217], v110 offset:24576
ds_read_b64_tr_b16 a[240:241], v110 offset:24608
ds_read_b64_tr_b16 v[232:233], v110 offset:24640
s_waitcnt vmcnt(15)
ds_read_b64_tr_b16 a[218:219], v110 offset:26112
ds_read_b64_tr_b16 a[242:243], v110 offset:26144
ds_read_b64_tr_b16 v[234:235], v110 offset:26176
s_waitcnt lgkmcnt(0)
s_add_u32 m0, s55, 119040
s_add_u32 s29, s54, 768
buffer_load_dwordx4 v72, s[12:15], s29 offen lds
s_add_u32 m0, s55, 120064
s_add_u32 s29, s54, 768
buffer_load_dwordx4 v73, s[12:15], s29 offen lds
s_add_u32 m0, s55, 121088
s_add_u32 s29, s54, 768
buffer_load_dwordx4 v74, s[12:15], s29 offen lds
s_waitcnt vmcnt(15)
ds_read_b64_tr_b16 a[220:221], v129 offset:1536
ds_read_b64_tr_b16 a[244:245], v129 offset:1568
ds_read_b64_tr_b16 v[236:237], v129 offset:1600
ds_read_b64_tr_b16 a[232:233], v129
ds_read_b64_tr_b16 v[224:225], v129 offset:32
ds_read_b64_tr_b16 v[248:249], v129 offset:64
s_waitcnt lgkmcnt(0)
s_add_u32 m0, s55, 69888
s_add_u32 s29, s54, 37632
buffer_load_dwordx4 v72, s[12:15], s29 offen lds
s_add_u32 m0, s55, 70912
s_add_u32 s29, s54, 37632
buffer_load_dwordx4 v73, s[12:15], s29 offen lds
s_add_u32 m0, s55, 71936
s_add_u32 s29, s54, 37632
buffer_load_dwordx4 v74, s[12:15], s29 offen lds
s_waitcnt vmcnt(16)
ds_read_b64_tr_b16 a[222:223], v129 offset:12288
ds_read_b64_tr_b16 a[246:247], v129 offset:12320
ds_read_b64_tr_b16 v[238:239], v129 offset:12352
s_waitcnt vmcnt(15)
ds_read_b64_tr_b16 a[234:235], v129 offset:13824
ds_read_b64_tr_b16 v[226:227], v129 offset:13856
ds_read_b64_tr_b16 v[250:251], v129 offset:13888
s_waitcnt lgkmcnt(0)
s_add_u32 m0, s55, 82176
s_add_u32 s29, s54, 74496
buffer_load_dwordx4 v72, s[12:15], s29 offen lds
s_add_u32 m0, s55, 83200
s_add_u32 s29, s54, 74496
buffer_load_dwordx4 v73, s[12:15], s29 offen lds
s_add_u32 m0, s55, 84224
s_add_u32 s29, s54, 74496
buffer_load_dwordx4 v74, s[12:15], s29 offen lds
s_waitcnt vmcnt(16)
ds_read_b64_tr_b16 a[224:225], v110 offset:36864
ds_read_b64_tr_b16 a[248:249], v110 offset:36896
ds_read_b64_tr_b16 v[240:241], v110 offset:36928
s_waitcnt vmcnt(15)
ds_read_b64_tr_b16 a[226:227], v110 offset:38400
ds_read_b64_tr_b16 a[250:251], v110 offset:38432
ds_read_b64_tr_b16 v[242:243], v110 offset:38464
s_waitcnt lgkmcnt(0)
s_add_u32 m0, s55, 131328
s_add_u32 s29, s54, 111360
buffer_load_dwordx4 v72, s[12:15], s29 offen lds
s_add_u32 m0, s55, 132352
s_add_u32 s29, s54, 111360
buffer_load_dwordx4 v73, s[12:15], s29 offen lds
s_add_u32 m0, s55, 133376
s_add_u32 s29, s54, 111360
buffer_load_dwordx4 v74, s[12:15], s29 offen lds
s_waitcnt vmcnt(15)
ds_read_b64_tr_b16 a[228:229], v110 offset:1536
ds_read_b64_tr_b16 a[252:253], v110 offset:1568
ds_read_b64_tr_b16 v[244:245], v110 offset:1600
ds_read_b64_tr_b16 a[236:237], v110
ds_read_b64_tr_b16 v[228:229], v110 offset:32
ds_read_b64_tr_b16 v[252:253], v110 offset:64
s_waitcnt lgkmcnt(0)
s_add_u32 m0, s55, 94464
s_add_u32 s29, s54, 148224
buffer_load_dwordx4 v72, s[12:15], s29 offen lds
s_add_u32 m0, s55, 95488
s_add_u32 s29, s54, 148224
buffer_load_dwordx4 v73, s[12:15], s29 offen lds
s_add_u32 m0, s55, 96512
s_add_u32 s29, s54, 148224
buffer_load_dwordx4 v74, s[12:15], s29 offen lds
s_waitcnt vmcnt(16)
ds_read_b64_tr_b16 a[230:231], v110 offset:12288
ds_read_b64_tr_b16 a[254:255], v110 offset:12320
ds_read_b64_tr_b16 v[246:247], v110 offset:12352
s_waitcnt vmcnt(15)
ds_read_b64_tr_b16 a[238:239], v110 offset:13824
ds_read_b64_tr_b16 v[230:231], v110 offset:13856
ds_read_b64_tr_b16 v[254:255], v110 offset:13888
s_waitcnt lgkmcnt(0)
s_add_u32 m0, s55, 106752
s_add_u32 s29, s54, 185088
buffer_load_dwordx4 v72, s[12:15], s29 offen lds
s_add_u32 m0, s55, 107776
s_add_u32 s29, s54, 185088
buffer_load_dwordx4 v73, s[12:15], s29 offen lds
s_add_u32 m0, s55, 108800
s_add_u32 s29, s54, 185088
buffer_load_dwordx4 v74, s[12:15], s29 offen lds
s_mul_hi_u32 s41, s35, 58835169
s_mul_i32 s42, s41, 73
s_sub_u32 s42, s35, s42
s_mul_i32 s43, s41, 1373568
s_mul_i32 s51, s42, 2688
s_add_u32 s50, s43, s51
s_add_u32 s35, s35, 32
s_min_u32 s41, s41, 1
s_sub_u32 s41, 1, s41
s_lshl_b32 s41, s41, 30
s_add_u32 s52, s50, s41
s_min_u32 s43, s42, 1
s_lshl_b32 s43, s43, 27
s_sub_u32 s43, 536870911, s43
s_add_u32 s51, s42, 56
s_and_b32 s51, s51, 128
s_lshl_b32 s51, s51, 22
s_or_b32 s44, s43, s51
s_mov_b32 s37, s50
v_and_b32 v216, s44, v208
s_add_u32 m0, s45, 0
s_nop 0
buffer_load_dwordx4 v216, s[4:7], s52 offen nt lds
s_add_u32 m0, s45, 4112
s_add_u32 s40, s37, 196224
buffer_load_dwordx4 v216, s[4:7], s40 offen nt lds
s_add_u32 m0, s45, 8224
s_add_u32 s40, s37, 392448
buffer_load_dwordx4 v216, s[4:7], s40 offen nt lds
s_add_u32 m0, s45, 12336
s_add_u32 s40, s37, 588672
buffer_load_dwordx4 v216, s[4:7], s40 offen nt lds
s_add_u32 m0, s45, 16448
s_add_u32 s40, s37, 784896
buffer_load_dwordx4 v216, s[4:7], s40 offen nt lds
s_add_u32 m0, s45, 20560
s_add_u32 s40, s37, 981120
buffer_load_dwordx4 v216, s[4:7], s40 offen nt lds
s_add_u32 m0, s45, 24672
s_add_u32 s40, s37, 1177344
buffer_load_dwordx4 v216, s[4:7], s40 offen nt lds
s_add_u32 m0, s45, 28784
s_add_u32 s40, s37, 1373568
buffer_load_dwordx4 v216, s[4:7], s40 offen nt lds
s_add_u32 m0, s45, 32896
s_add_u32 s40, s37, 1569792
buffer_load_dwordx4 v216, s[4:7], s40 offen nt lds
s_waitcnt vmcnt(25)
ds_read_b64_tr_b16 a[72:73], v110 offset:24576
ds_read_b64_tr_b16 a[96:97], v110 offset:24608
ds_read_b64_tr_b16 a[120:121], v110 offset:24640
s_waitcnt vmcnt(24)
ds_read_b64_tr_b16 a[74:75], v110 offset:26112
ds_read_b64_tr_b16 a[98:99], v110 offset:26144
ds_read_b64_tr_b16 a[122:123], v110 offset:26176
s_waitcnt vmcnt(21)
ds_read_b64_tr_b16 a[76:77], v129 offset:1536
ds_read_b64_tr_b16 a[100:101], v129 offset:1568
ds_read_b64_tr_b16 a[124:125], v129 offset:1600
ds_read_b64_tr_b16 a[88:89], v129
ds_read_b64_tr_b16 a[112:113], v129 offset:32
ds_read_b64_tr_b16 a[136:137], v129 offset:64
s_waitcnt lgkmcnt(0)
s_add_u32 m0, s55, 69888
s_add_u32 s29, s54, 0
buffer_load_dwordx4 v136, s[16:19], s29 offen lds
s_add_u32 m0, s55, 70912
s_add_u32 s29, s54, 0
buffer_load_dwordx4 v137, s[16:19], s29 offen lds
s_add_u32 m0, s55, 71936
s_add_u32 s29, s54, 0
buffer_load_dwordx4 v128, s[16:19], s29 offen lds
s_waitcnt vmcnt(22)
ds_read_b64_tr_b16 a[78:79], v129 offset:12288
ds_read_b64_tr_b16 a[102:103], v129 offset:12320
ds_read_b64_tr_b16 a[126:127], v129 offset:12352
s_waitcnt vmcnt(21)
ds_read_b64_tr_b16 a[90:91], v129 offset:13824
ds_read_b64_tr_b16 a[114:115], v129 offset:13856
ds_read_b64_tr_b16 a[138:139], v129 offset:13888
s_waitcnt lgkmcnt(0)
s_add_u32 m0, s55, 82176
s_add_u32 s29, s54, 12288
buffer_load_dwordx4 v136, s[16:19], s29 offen lds
s_add_u32 m0, s55, 83200
s_add_u32 s29, s54, 12288
buffer_load_dwordx4 v137, s[16:19], s29 offen lds
s_add_u32 m0, s55, 84224
s_add_u32 s29, s54, 12288
buffer_load_dwordx4 v128, s[16:19], s29 offen lds
s_waitcnt vmcnt(22)
ds_read_b64_tr_b16 a[80:81], v110 offset:36864
ds_read_b64_tr_b16 a[104:105], v110 offset:36896
ds_read_b64_tr_b16 a[128:129], v110 offset:36928
s_waitcnt vmcnt(21)
ds_read_b64_tr_b16 a[82:83], v110 offset:38400
ds_read_b64_tr_b16 a[106:107], v110 offset:38432
ds_read_b64_tr_b16 a[130:131], v110 offset:38464
s_waitcnt vmcnt(18)
ds_read_b64_tr_b16 a[84:85], v110 offset:1536
ds_read_b64_tr_b16 a[108:109], v110 offset:1568
ds_read_b64_tr_b16 a[132:133], v110 offset:1600
ds_read_b64_tr_b16 a[92:93], v110
ds_read_b64_tr_b16 a[116:117], v110 offset:32
ds_read_b64_tr_b16 a[140:141], v110 offset:64
s_waitcnt vmcnt(16)
ds_read_b64_tr_b16 a[86:87], v110 offset:12288
ds_read_b64_tr_b16 a[110:111], v110 offset:12320
ds_read_b64_tr_b16 a[134:135], v110 offset:12352
s_waitcnt vmcnt(15)
ds_read_b64_tr_b16 a[94:95], v110 offset:13824
ds_read_b64_tr_b16 a[118:119], v110 offset:13856
ds_read_b64_tr_b16 a[142:143], v110 offset:13888
s_waitcnt vmcnt(4)
ds_read_b64_tr_b16 a[144:145], v129
ds_read_b64_tr_b16 a[168:169], v129 offset:32
ds_read_b64_tr_b16 a[192:193], v129 offset:64
s_waitcnt vmcnt(3)
ds_read_b64_tr_b16 a[146:147], v129 offset:1536
ds_read_b64_tr_b16 a[170:171], v129 offset:1568
ds_read_b64_tr_b16 a[194:195], v129 offset:1600
s_waitcnt lgkmcnt(0)
s_add_u32 m0, s55, 69888
s_add_u32 s29, s54, 24576
buffer_load_dwordx4 v136, s[16:19], s29 offen lds
s_add_u32 m0, s55, 70912
s_add_u32 s29, s54, 24576
buffer_load_dwordx4 v137, s[16:19], s29 offen lds
s_add_u32 m0, s55, 71936
s_add_u32 s29, s54, 24576
buffer_load_dwordx4 v128, s[16:19], s29 offen lds
s_waitcnt vmcnt(3)
ds_read_b64_tr_b16 a[148:149], v129 offset:13824
ds_read_b64_tr_b16 a[172:173], v129 offset:13856
ds_read_b64_tr_b16 a[196:197], v129 offset:13888
ds_read_b64_tr_b16 a[160:161], v129 offset:12288
ds_read_b64_tr_b16 a[184:185], v129 offset:12320
ds_read_b64_tr_b16 a[208:209], v129 offset:12352
s_waitcnt lgkmcnt(0)
s_add_u32 m0, s55, 82176
s_add_u32 s29, s54, 36864
buffer_load_dwordx4 v136, s[16:19], s29 offen lds
s_add_u32 m0, s55, 83200
s_add_u32 s29, s54, 36864
buffer_load_dwordx4 v137, s[16:19], s29 offen lds
s_add_u32 m0, s55, 84224
s_add_u32 s29, s54, 36864
buffer_load_dwordx4 v128, s[16:19], s29 offen lds
s_waitcnt vmcnt(4)
ds_read_b64_tr_b16 a[150:151], v129
ds_read_b64_tr_b16 a[174:175], v129 offset:32
ds_read_b64_tr_b16 a[198:199], v129 offset:64
s_waitcnt vmcnt(3)
ds_read_b64_tr_b16 a[162:163], v129 offset:1536
ds_read_b64_tr_b16 a[186:187], v129 offset:1568
ds_read_b64_tr_b16 a[210:211], v129 offset:1600
s_waitcnt lgkmcnt(0)
s_add_u32 m0, s55, 69888
s_add_u32 s29, s54, 49152
buffer_load_dwordx4 v136, s[16:19], s29 offen lds
s_add_u32 m0, s55, 70912
s_add_u32 s29, s54, 49152
buffer_load_dwordx4 v137, s[16:19], s29 offen lds
s_add_u32 m0, s55, 71936
s_add_u32 s29, s54, 49152
buffer_load_dwordx4 v128, s[16:19], s29 offen lds
s_waitcnt vmcnt(4)
ds_read_b64_tr_b16 a[152:153], v129 offset:12288
ds_read_b64_tr_b16 a[176:177], v129 offset:12320
ds_read_b64_tr_b16 a[200:201], v129 offset:12352
s_waitcnt vmcnt(3)
ds_read_b64_tr_b16 a[154:155], v129 offset:13824
ds_read_b64_tr_b16 a[178:179], v129 offset:13856
ds_read_b64_tr_b16 a[202:203], v129 offset:13888
s_waitcnt lgkmcnt(0)
s_add_u32 m0, s55, 82176
s_add_u32 s29, s54, 61440
buffer_load_dwordx4 v136, s[16:19], s29 offen lds
s_add_u32 m0, s55, 83200
s_add_u32 s29, s54, 61440
buffer_load_dwordx4 v137, s[16:19], s29 offen lds
s_add_u32 m0, s55, 84224
s_add_u32 s29, s54, 61440
buffer_load_dwordx4 v128, s[16:19], s29 offen lds
s_waitcnt vmcnt(3)
ds_read_b64_tr_b16 a[156:157], v129 offset:1536
ds_read_b64_tr_b16 a[180:181], v129 offset:1568
ds_read_b64_tr_b16 a[204:205], v129 offset:1600
ds_read_b64_tr_b16 a[164:165], v129
ds_read_b64_tr_b16 a[188:189], v129 offset:32
ds_read_b64_tr_b16 a[212:213], v129 offset:64
s_waitcnt vmcnt(1)
ds_read_b64_tr_b16 a[158:159], v129 offset:12288
ds_read_b64_tr_b16 a[182:183], v129 offset:12320
ds_read_b64_tr_b16 a[206:207], v129 offset:12352
s_waitcnt vmcnt(0)
ds_read_b64_tr_b16 a[166:167], v129 offset:13824
ds_read_b64_tr_b16 a[190:191], v129 offset:13856
ds_read_b64_tr_b16 a[214:215], v129 offset:13888
ds_read_b128 v[182:185], v210 offset:20480
s_waitcnt lgkmcnt(0)
v_mfma_f32_16x16x32_bf16 v[138:141], a[0:3], v[182:185], 0
v_mfma_f32_16x16x32_bf16 v[142:145], a[24:27], v[182:185], 0
v_mfma_f32_16x16x32_bf16 v[146:149], a[48:51], v[182:185], 0
ds_read_b128 v[186:189], v210 offset:26624
s_waitcnt lgkmcnt(0)
v_mfma_f32_16x16x32_bf16 v[150:153], a[0:3], v[186:189], 0
v_mfma_f32_16x16x32_bf16 v[154:157], a[24:27], v[186:189], 0
v_mfma_f32_16x16x32_bf16 v[158:161], a[48:51], v[186:189], 0
ds_read_b128 v[114:117], v210 offset:21504
s_waitcnt lgkmcnt(0)
v_mfma_f32_16x16x32_bf16 v[138:141], a[4:7], v[114:117], v[138:141]
v_mfma_f32_16x16x32_bf16 v[142:145], a[28:31], v[114:117], v[142:145]
v_mfma_f32_16x16x32_bf16 v[146:149], a[52:55], v[114:117], v[146:149]
ds_read_b128 v[122:125], v210 offset:27648
s_waitcnt lgkmcnt(0)
v_mfma_f32_16x16x32_bf16 v[150:153], a[4:7], v[122:125], v[150:153]
v_mfma_f32_16x16x32_bf16 v[154:157], a[28:31], v[122:125], v[154:157]
v_mfma_f32_16x16x32_bf16 v[158:161], a[52:55], v[122:125], v[158:161]
ds_read_b128 v[182:185], v210 offset:24576
s_waitcnt lgkmcnt(0)
v_mfma_f32_16x16x32_bf16 v[138:141], a[16:19], v[182:185], v[138:141]
v_mfma_f32_16x16x32_bf16 v[142:145], a[40:43], v[182:185], v[142:145]
v_mfma_f32_16x16x32_bf16 v[146:149], a[64:67], v[182:185], v[146:149]
ds_read_b128 v[186:189], v210 offset:30720
s_waitcnt lgkmcnt(0)
v_mfma_f32_16x16x32_bf16 v[150:153], a[16:19], v[186:189], v[150:153]
v_mfma_f32_16x16x32_bf16 v[154:157], a[40:43], v[186:189], v[154:157]
v_mfma_f32_16x16x32_bf16 v[158:161], a[64:67], v[186:189], v[158:161]
ds_read_b128 v[114:117], v210 offset:22528
s_waitcnt lgkmcnt(0)
v_mfma_f32_16x16x32_bf16 v[138:141], a[8:11], v[114:117], v[138:141]
v_mfma_f32_16x16x32_bf16 v[142:145], a[32:35], v[114:117], v[142:145]
v_mfma_f32_16x16x32_bf16 v[146:149], a[56:59], v[114:117], v[146:149]
ds_read_b128 v[122:125], v210 offset:28672
s_waitcnt lgkmcnt(0)
v_mfma_f32_16x16x32_bf16 v[150:153], a[8:11], v[122:125], v[150:153]
v_mfma_f32_16x16x32_bf16 v[154:157], a[32:35], v[122:125], v[154:157]
v_mfma_f32_16x16x32_bf16 v[158:161], a[56:59], v[122:125], v[158:161]
ds_read_b128 v[182:185], v210 offset:23552
s_waitcnt lgkmcnt(0)
v_mfma_f32_16x16x32_bf16 v[138:141], a[12:15], v[182:185], v[138:141]
v_mfma_f32_16x16x32_bf16 v[142:145], a[36:39], v[182:185], v[142:145]
v_mfma_f32_16x16x32_bf16 v[146:149], a[60:63], v[182:185], v[146:149]
ds_read_b128 v[186:189], v210 offset:29696
s_waitcnt lgkmcnt(0)
v_mfma_f32_16x16x32_bf16 v[150:153], a[12:15], v[186:189], v[150:153]
v_mfma_f32_16x16x32_bf16 v[154:157], a[36:39], v[186:189], v[154:157]
v_mfma_f32_16x16x32_bf16 v[158:161], a[60:63], v[186:189], v[158:161]
ds_read_b128 v[114:117], v210 offset:25600
s_waitcnt lgkmcnt(0)
v_mfma_f32_16x16x32_bf16 v[138:141], a[20:23], v[114:117], v[138:141]
v_mfma_f32_16x16x32_bf16 v[142:145], a[44:47], v[114:117], v[142:145]
v_mfma_f32_16x16x32_bf16 v[146:149], a[68:71], v[114:117], v[146:149]
ds_read_b128 v[122:125], v210 offset:31744
s_waitcnt lgkmcnt(0)
v_mfma_f32_16x16x32_bf16 v[150:153], a[20:23], v[122:125], v[150:153]
v_mfma_f32_16x16x32_bf16 v[154:157], a[44:47], v[122:125], v[154:157]
v_mfma_f32_16x16x32_bf16 v[158:161], a[68:71], v[122:125], v[158:161]
v_cvt_pk_bf16_f32 v60, v138, v139
v_cvt_pk_bf16_f32 v61, v140, v141
v_cvt_pk_bf16_f32 v62, v142, v143
v_cvt_pk_bf16_f32 v63, v144, v145
v_cvt_pk_bf16_f32 v64, v146, v147
v_cvt_pk_bf16_f32 v65, v148, v149
v_cvt_pk_bf16_f32 v66, v150, v151
v_cvt_pk_bf16_f32 v67, v152, v153
v_cvt_pk_bf16_f32 v68, v154, v155
v_cvt_pk_bf16_f32 v69, v156, v157
v_cvt_pk_bf16_f32 v70, v158, v159
v_cvt_pk_bf16_f32 v71, v160, v161
ds_read_b128 v[182:185], v210 offset:20480
s_waitcnt lgkmcnt(0)
v_mfma_f32_16x16x32_bf16 v[162:165], a[216:219], v[182:185], 0
v_mfma_f32_16x16x32_bf16 v[166:169], a[240:243], v[182:185], 0
v_mfma_f32_16x16x32_bf16 v[170:173], v[232:235], v[182:185], 0
ds_read_b128 v[186:189], v210 offset:26624
s_waitcnt lgkmcnt(0)
v_mfma_f32_16x16x32_bf16 v[138:141], a[216:219], v[186:189], 0
v_mfma_f32_16x16x32_bf16 v[142:145], a[240:243], v[186:189], 0
v_mfma_f32_16x16x32_bf16 v[146:149], v[232:235], v[186:189], 0
ds_read_b128 v[114:117], v210 offset:21504
s_waitcnt lgkmcnt(0)
v_mfma_f32_16x16x32_bf16 v[162:165], a[220:223], v[114:117], v[162:165]
v_mfma_f32_16x16x32_bf16 v[166:169], a[244:247], v[114:117], v[166:169]
v_mfma_f32_16x16x32_bf16 v[170:173], v[236:239], v[114:117], v[170:173]
ds_read_b128 v[122:125], v210 offset:27648
s_waitcnt lgkmcnt(0)
v_mfma_f32_16x16x32_bf16 v[138:141], a[220:223], v[122:125], v[138:141]
v_mfma_f32_16x16x32_bf16 v[142:145], a[244:247], v[122:125], v[142:145]
v_mfma_f32_16x16x32_bf16 v[146:149], v[236:239], v[122:125], v[146:149]
ds_read_b128 v[182:185], v210 offset:24576
s_waitcnt lgkmcnt(0)
v_mfma_f32_16x16x32_bf16 v[162:165], a[232:235], v[182:185], v[162:165]
v_mfma_f32_16x16x32_bf16 v[166:169], v[224:227], v[182:185], v[166:169]
v_mfma_f32_16x16x32_bf16 v[170:173], v[248:251], v[182:185], v[170:173]
ds_read_b128 v[186:189], v210 offset:30720
s_waitcnt lgkmcnt(0)
v_mfma_f32_16x16x32_bf16 v[138:141], a[232:235], v[186:189], v[138:141]
v_mfma_f32_16x16x32_bf16 v[142:145], v[224:227], v[186:189], v[142:145]
v_mfma_f32_16x16x32_bf16 v[146:149], v[248:251], v[186:189], v[146:149]
ds_read_b128 v[114:117], v210 offset:22528
s_waitcnt lgkmcnt(0)
v_mfma_f32_16x16x32_bf16 v[162:165], a[224:227], v[114:117], v[162:165]
v_mfma_f32_16x16x32_bf16 v[166:169], a[248:251], v[114:117], v[166:169]
v_mfma_f32_16x16x32_bf16 v[170:173], v[240:243], v[114:117], v[170:173]
ds_read_b128 v[122:125], v210 offset:28672
s_waitcnt lgkmcnt(0)
v_mfma_f32_16x16x32_bf16 v[138:141], a[224:227], v[122:125], v[138:141]
v_mfma_f32_16x16x32_bf16 v[142:145], a[248:251], v[122:125], v[142:145]
v_mfma_f32_16x16x32_bf16 v[146:149], v[240:243], v[122:125], v[146:149]
ds_read_b128 v[182:185], v210 offset:23552
s_waitcnt lgkmcnt(0)
v_mfma_f32_16x16x32_bf16 v[162:165], a[228:231], v[182:185], v[162:165]
v_mfma_f32_16x16x32_bf16 v[166:169], a[252:255], v[182:185], v[166:169]
v_mfma_f32_16x16x32_bf16 v[170:173], v[244:247], v[182:185], v[170:173]
ds_read_b128 v[186:189], v210 offset:29696
s_waitcnt lgkmcnt(0)
v_mfma_f32_16x16x32_bf16 v[138:141], a[228:231], v[186:189], v[138:141]
v_mfma_f32_16x16x32_bf16 v[142:145], a[252:255], v[186:189], v[142:145]
v_mfma_f32_16x16x32_bf16 v[146:149], v[244:247], v[186:189], v[146:149]
ds_read_b128 v[114:117], v210 offset:25600
s_waitcnt lgkmcnt(0)
v_mfma_f32_16x16x32_bf16 v[162:165], a[236:239], v[114:117], v[162:165]
v_mfma_f32_16x16x32_bf16 v[166:169], v[228:231], v[114:117], v[166:169]
v_mfma_f32_16x16x32_bf16 v[170:173], v[252:255], v[114:117], v[170:173]
ds_read_b128 v[122:125], v210 offset:31744
s_waitcnt lgkmcnt(0)
v_mfma_f32_16x16x32_bf16 v[138:141], a[236:239], v[122:125], v[138:141]
v_mfma_f32_16x16x32_bf16 v[142:145], v[228:231], v[122:125], v[142:145]
v_mfma_f32_16x16x32_bf16 v[146:149], v[252:255], v[122:125], v[146:149]
v_cvt_pk_bf16_f32 v84, v162, v163
v_cvt_pk_bf16_f32 v85, v164, v165
v_cvt_pk_bf16_f32 v86, v166, v167
v_cvt_pk_bf16_f32 v87, v168, v169
v_cvt_pk_bf16_f32 v88, v170, v171
v_cvt_pk_bf16_f32 v89, v172, v173
v_cvt_pk_bf16_f32 v96, v138, v139
v_cvt_pk_bf16_f32 v97, v140, v141
v_cvt_pk_bf16_f32 v98, v142, v143
v_cvt_pk_bf16_f32 v99, v144, v145
v_cvt_pk_bf16_f32 v100, v146, v147
v_cvt_pk_bf16_f32 v101, v148, v149
ds_read_b128 v[182:185], v210 offset:20480
s_waitcnt lgkmcnt(0)
v_mfma_f32_16x16x32_bf16 v[150:153], a[72:75], v[182:185], 0
v_mfma_f32_16x16x32_bf16 v[154:157], a[96:99], v[182:185], 0
v_mfma_f32_16x16x32_bf16 v[158:161], a[120:123], v[182:185], 0
ds_read_b128 v[186:189], v210 offset:26624
s_waitcnt lgkmcnt(0)
v_mfma_f32_16x16x32_bf16 v[162:165], a[72:75], v[186:189], 0
v_mfma_f32_16x16x32_bf16 v[166:169], a[96:99], v[186:189], 0
v_mfma_f32_16x16x32_bf16 v[170:173], a[120:123], v[186:189], 0
ds_read_b128 v[114:117], v210 offset:21504
s_waitcnt lgkmcnt(0)
v_mfma_f32_16x16x32_bf16 v[150:153], a[76:79], v[114:117], v[150:153]
v_mfma_f32_16x16x32_bf16 v[154:157], a[100:103], v[114:117], v[154:157]
v_mfma_f32_16x16x32_bf16 v[158:161], a[124:127], v[114:117], v[158:161]
ds_read_b128 v[122:125], v210 offset:27648
s_waitcnt lgkmcnt(0)
v_mfma_f32_16x16x32_bf16 v[162:165], a[76:79], v[122:125], v[162:165]
v_mfma_f32_16x16x32_bf16 v[166:169], a[100:103], v[122:125], v[166:169]
v_mfma_f32_16x16x32_bf16 v[170:173], a[124:127], v[122:125], v[170:173]
ds_read_b128 v[182:185], v210 offset:24576
s_waitcnt lgkmcnt(0)
v_mfma_f32_16x16x32_bf16 v[150:153], a[88:91], v[182:185], v[150:153]
v_mfma_f32_16x16x32_bf16 v[154:157], a[112:115], v[182:185], v[154:157]
v_mfma_f32_16x16x32_bf16 v[158:161], a[136:139], v[182:185], v[158:161]
ds_read_b128 v[186:189], v210 offset:30720
s_waitcnt lgkmcnt(0)
v_mfma_f32_16x16x32_bf16 v[162:165], a[88:91], v[186:189], v[162:165]
v_mfma_f32_16x16x32_bf16 v[166:169], a[112:115], v[186:189], v[166:169]
v_mfma_f32_16x16x32_bf16 v[170:173], a[136:139], v[186:189], v[170:173]
ds_read_b128 v[114:117], v210 offset:22528
s_waitcnt lgkmcnt(0)
v_mfma_f32_16x16x32_bf16 v[150:153], a[80:83], v[114:117], v[150:153]
v_mfma_f32_16x16x32_bf16 v[154:157], a[104:107], v[114:117], v[154:157]
v_mfma_f32_16x16x32_bf16 v[158:161], a[128:131], v[114:117], v[158:161]
ds_read_b128 v[122:125], v210 offset:28672
s_waitcnt lgkmcnt(0)
v_mfma_f32_16x16x32_bf16 v[162:165], a[80:83], v[122:125], v[162:165]
v_mfma_f32_16x16x32_bf16 v[166:169], a[104:107], v[122:125], v[166:169]
v_mfma_f32_16x16x32_bf16 v[170:173], a[128:131], v[122:125], v[170:173]
ds_read_b128 v[182:185], v210 offset:23552
s_waitcnt lgkmcnt(0)
v_mfma_f32_16x16x32_bf16 v[150:153], a[84:87], v[182:185], v[150:153]
v_mfma_f32_16x16x32_bf16 v[154:157], a[108:111], v[182:185], v[154:157]
v_mfma_f32_16x16x32_bf16 v[158:161], a[132:135], v[182:185], v[158:161]
ds_read_b128 v[186:189], v210 offset:29696
s_waitcnt lgkmcnt(0)
v_mfma_f32_16x16x32_bf16 v[162:165], a[84:87], v[186:189], v[162:165]
v_mfma_f32_16x16x32_bf16 v[166:169], a[108:111], v[186:189], v[166:169]
v_mfma_f32_16x16x32_bf16 v[170:173], a[132:135], v[186:189], v[170:173]
ds_read_b128 v[114:117], v210 offset:25600
s_waitcnt lgkmcnt(0)
v_mfma_f32_16x16x32_bf16 v[150:153], a[92:95], v[114:117], v[150:153]
v_mfma_f32_16x16x32_bf16 v[154:157], a[116:119], v[114:117], v[154:157]
v_mfma_f32_16x16x32_bf16 v[158:161], a[140:143], v[114:117], v[158:161]
ds_read_b128 v[122:125], v210 offset:31744
s_waitcnt lgkmcnt(0)
v_mfma_f32_16x16x32_bf16 v[162:165], a[92:95], v[122:125], v[162:165]
v_mfma_f32_16x16x32_bf16 v[166:169], a[116:119], v[122:125], v[166:169]
v_mfma_f32_16x16x32_bf16 v[170:173], a[140:143], v[122:125], v[170:173]
v_cvt_pk_bf16_f32 v90, v150, v151
v_cvt_pk_bf16_f32 v91, v152, v153
v_cvt_pk_bf16_f32 v92, v154, v155
v_cvt_pk_bf16_f32 v93, v156, v157
v_cvt_pk_bf16_f32 v94, v158, v159
v_cvt_pk_bf16_f32 v95, v160, v161
v_cvt_pk_bf16_f32 v102, v162, v163
v_cvt_pk_bf16_f32 v103, v164, v165
v_cvt_pk_bf16_f32 v104, v166, v167
v_cvt_pk_bf16_f32 v105, v168, v169
v_cvt_pk_bf16_f32 v106, v170, v171
v_cvt_pk_bf16_f32 v107, v172, v173
s_barrier
buffer_store_dwordx4 v[36:39], v210, s[24:27], s58 offen sc1
buffer_store_dwordx4 v[40:43], v210, s[24:27], s58 offen offset:1024 sc1
buffer_store_dwordx4 v[44:47], v210, s[24:27], s58 offen offset:2048 sc1
ds_write_b64 v121, v[90:91]
ds_write_b64 v121, v[92:93] offset:32
ds_write_b64 v121, v[94:95] offset:64
ds_write_b128 v120, v[84:87]
ds_write_b64 v120, v[88:89] offset:16
ds_write_b128 v120, v[60:63] offset:512
ds_write_b64 v120, v[64:65] offset:528
buffer_store_dwordx4 v[48:51], v210, s[24:27], s59 offen sc1
buffer_store_dwordx4 v[52:55], v210, s[24:27], s59 offen offset:1024 sc1
buffer_store_dwordx4 v[56:59], v210, s[24:27], s59 offen offset:2048 sc1
s_mov_b64 exec, s[56:57]
ds_write_b64 v121, v[102:103] offset:22784
s_mov_b64 exec, -1
s_mov_b64 exec, s[56:57]
ds_write_b64 v121, v[104:105] offset:22816
s_mov_b64 exec, -1
s_mov_b64 exec, s[56:57]
ds_write_b64 v121, v[106:107] offset:22848
s_mov_b64 exec, -1
s_mov_b64 exec, s[56:57]
ds_write_b128 v120, v[96:99] offset:22784
s_mov_b64 exec, -1
s_mov_b64 exec, s[56:57]
ds_write_b64 v120, v[100:101] offset:22800
s_mov_b64 exec, -1
s_mov_b64 exec, s[56:57]
ds_write_b128 v120, v[66:69] offset:23296
s_mov_b64 exec, -1
s_mov_b64 exec, s[56:57]
ds_write_b64 v120, v[70:71] offset:23312
s_mov_b64 exec, -1
s_nop 0
s_barrier
s_mov_b32 s38, s36
ds_read_b128 v[174:177], v217
ds_read_b128 v[84:87], v200
s_waitcnt lgkmcnt(0)
v_mfma_f32_16x16x32_bf16 v[36:39], v[174:177], v[84:87], 0
ds_read_b128 v[92:95], v201
s_waitcnt lgkmcnt(0)
v_mfma_f32_16x16x32_bf16 v[48:51], v[174:177], v[92:95], 0
ds_read_b128 v[100:103], v202
s_waitcnt lgkmcnt(0)
v_mfma_f32_16x16x32_bf16 v[60:63], v[174:177], v[100:103], 0
ds_read_b128 v[178:181], v217 offset:528
ds_read_b128 v[84:87], v194
ds_read_b128 v[88:91], v194 offset:16
s_waitcnt lgkmcnt(0)
v_smfmac_f32_16x16x64_bf16 v[36:39], v[178:181], v[84:91], v213
ds_read_b128 v[92:95], v195
ds_read_b128 v[96:99], v195 offset:16
s_waitcnt lgkmcnt(0)
v_smfmac_f32_16x16x64_bf16 v[48:51], v[178:181], v[92:99], v213
ds_read_b128 v[100:103], v196
ds_read_b128 v[104:107], v196 offset:16
s_waitcnt lgkmcnt(0)
v_smfmac_f32_16x16x64_bf16 v[60:63], v[178:181], v[100:107], v213
ds_read_b128 v[174:177], v217 offset:1056
ds_read_b128 v[84:87], v197
ds_read_b128 v[88:91], v197 offset:16
s_waitcnt lgkmcnt(0)
v_smfmac_f32_16x16x64_bf16 v[36:39], v[174:177], v[84:91], v213
ds_read_b128 v[92:95], v198
ds_read_b128 v[96:99], v198 offset:16
s_waitcnt lgkmcnt(0)
v_smfmac_f32_16x16x64_bf16 v[48:51], v[174:177], v[92:99], v213
ds_read_b128 v[100:103], v199
ds_read_b128 v[104:107], v199 offset:16
s_waitcnt lgkmcnt(0)
v_smfmac_f32_16x16x64_bf16 v[60:63], v[174:177], v[100:107], v213
ds_read_b128 v[178:181], v217 offset:1584
ds_read_b128 v[84:87], v200 offset:32
s_waitcnt lgkmcnt(0)
v_mfma_f32_16x16x32_bf16 v[40:43], v[178:181], v[84:87], 0
ds_read_b128 v[92:95], v201 offset:32
s_waitcnt lgkmcnt(0)
v_mfma_f32_16x16x32_bf16 v[52:55], v[178:181], v[92:95], 0
ds_read_b128 v[100:103], v202 offset:32
s_waitcnt lgkmcnt(0)
v_mfma_f32_16x16x32_bf16 v[64:67], v[178:181], v[100:103], 0
ds_read_b128 v[174:177], v217 offset:2112
ds_read_b128 v[84:87], v194 offset:32
ds_read_b128 v[88:91], v194 offset:48
s_waitcnt lgkmcnt(0)
v_smfmac_f32_16x16x64_bf16 v[40:43], v[174:177], v[84:91], v213
ds_read_b128 v[92:95], v195 offset:32
ds_read_b128 v[96:99], v195 offset:48
s_waitcnt lgkmcnt(0)
v_smfmac_f32_16x16x64_bf16 v[52:55], v[174:177], v[92:99], v213
ds_read_b128 v[100:103], v196 offset:32
ds_read_b128 v[104:107], v196 offset:48
s_waitcnt lgkmcnt(0)
v_smfmac_f32_16x16x64_bf16 v[64:67], v[174:177], v[100:107], v213
ds_read_b128 v[178:181], v217 offset:2640
ds_read_b128 v[84:87], v197 offset:32
ds_read_b128 v[88:91], v197 offset:48
s_waitcnt lgkmcnt(0)
v_smfmac_f32_16x16x64_bf16 v[40:43], v[178:181], v[84:91], v213
ds_read_b128 v[92:95], v198 offset:32
ds_read_b128 v[96:99], v198 offset:48
s_waitcnt lgkmcnt(0)
v_smfmac_f32_16x16x64_bf16 v[52:55], v[178:181], v[92:99], v213
ds_read_b128 v[100:103], v199 offset:32
ds_read_b128 v[104:107], v199 offset:48
s_waitcnt lgkmcnt(0)
v_smfmac_f32_16x16x64_bf16 v[64:67], v[178:181], v[100:107], v213
ds_read_b128 v[174:177], v217 offset:3168
ds_read_b128 v[84:87], v200 offset:64
s_waitcnt lgkmcnt(0)
v_mfma_f32_16x16x32_bf16 v[44:47], v[174:177], v[84:87], 0
ds_read_b128 v[92:95], v201 offset:64
s_waitcnt lgkmcnt(0)
v_mfma_f32_16x16x32_bf16 v[56:59], v[174:177], v[92:95], 0
ds_read_b128 v[100:103], v202 offset:64
s_waitcnt lgkmcnt(0)
v_mfma_f32_16x16x32_bf16 v[68:71], v[174:177], v[100:103], 0
ds_read_b128 v[178:181], v217 offset:3696
ds_read_b128 v[84:87], v194 offset:64
ds_read_b128 v[88:91], v194 offset:80
s_waitcnt lgkmcnt(0)
v_smfmac_f32_16x16x64_bf16 v[44:47], v[178:181], v[84:91], v213
ds_read_b128 v[92:95], v195 offset:64
ds_read_b128 v[96:99], v195 offset:80
s_waitcnt lgkmcnt(0)
v_smfmac_f32_16x16x64_bf16 v[56:59], v[178:181], v[92:99], v213
ds_read_b128 v[100:103], v196 offset:64
ds_read_b128 v[104:107], v196 offset:80
s_waitcnt lgkmcnt(0)
v_smfmac_f32_16x16x64_bf16 v[68:71], v[178:181], v[100:107], v213
ds_read_b128 v[174:177], v217 offset:4224
ds_read_b128 v[84:87], v197 offset:64
ds_read_b128 v[88:91], v197 offset:80
s_waitcnt lgkmcnt(0)
v_smfmac_f32_16x16x64_bf16 v[44:47], v[174:177], v[84:91], v213
ds_read_b128 v[92:95], v198 offset:64
ds_read_b128 v[96:99], v198 offset:80
s_waitcnt lgkmcnt(0)
v_smfmac_f32_16x16x64_bf16 v[56:59], v[174:177], v[92:99], v213
ds_read_b128 v[100:103], v199 offset:64
ds_read_b128 v[104:107], v199 offset:80
s_waitcnt lgkmcnt(0)
v_smfmac_f32_16x16x64_bf16 v[68:71], v[174:177], v[100:107], v213
v_add_f32 v118, v36, v37
v_mul_f32 v119, v36, v36
v_add_f32 v118, v118, v38
v_fmac_f32 v119, v37, v37
v_add_f32 v118, v118, v39
v_fmac_f32 v119, v38, v38
v_fmac_f32 v119, v39, v39
v_add_f32 v126, v48, v49
v_mul_f32 v127, v48, v48
v_add_f32 v126, v126, v50
v_fmac_f32 v127, v49, v49
v_add_f32 v126, v126, v51
v_fmac_f32 v127, v50, v50
v_fmac_f32 v127, v51, v51
v_add_f32 v134, v60, v61
v_mul_f32 v135, v60, v60
v_add_f32 v134, v134, v62
v_fmac_f32 v135, v61, v61
v_add_f32 v134, v134, v63
v_fmac_f32 v135, v62, v62
v_fmac_f32 v135, v63, v63
v_add_f32 v118, v118, v40
v_fmac_f32 v119, v40, v40
v_add_f32 v118, v118, v41
v_fmac_f32 v119, v41, v41
v_add_f32 v118, v118, v42
v_fmac_f32 v119, v42, v42
v_add_f32 v118, v118, v43
v_fmac_f32 v119, v43, v43
v_add_f32 v126, v126, v52
v_fmac_f32 v127, v52, v52
v_add_f32 v126, v126, v53
v_fmac_f32 v127, v53, v53
v_add_f32 v126, v126, v54
v_fmac_f32 v127, v54, v54
v_add_f32 v126, v126, v55
v_fmac_f32 v127, v55, v55
v_add_f32 v134, v134, v64
v_fmac_f32 v135, v64, v64
v_add_f32 v134, v134, v65
v_fmac_f32 v135, v65, v65
v_add_f32 v134, v134, v66
v_fmac_f32 v135, v66, v66
v_add_f32 v134, v134, v67
v_fmac_f32 v135, v67, v67
v_add_f32 v118, v118, v44
v_fmac_f32 v119, v44, v44
v_add_f32 v118, v118, v45
v_fmac_f32 v119, v45, v45
v_add_f32 v118, v118, v46
v_fmac_f32 v119, v46, v46
v_add_f32 v118, v118, v47
v_fmac_f32 v119, v47, v47
v_add_f32 v126, v126, v56
v_fmac_f32 v127, v56, v56
v_add_f32 v126, v126, v57
v_fmac_f32 v127, v57, v57
v_add_f32 v126, v126, v58
v_fmac_f32 v127, v58, v58
v_add_f32 v126, v126, v59
v_fmac_f32 v127, v59, v59
v_add_f32 v134, v134, v68
v_fmac_f32 v135, v68, v68
v_add_f32 v134, v134, v69
v_fmac_f32 v135, v69, v69
v_add_f32 v134, v134, v70
v_fmac_f32 v135, v70, v70
v_add_f32 v134, v134, v71
v_fmac_f32 v135, v71, v71
v_permlane16_swap_b32 v118, v119
v_add_f32 v118, v118, v119
v_permlane16_swap_b32 v126, v127
v_add_f32 v126, v126, v127
v_permlane16_swap_b32 v134, v135
v_add_f32 v134, v134, v135
v_permlane32_swap_b32 v118, v126
v_add_f32 v118, v118, v126
ds_write_b32 v209, v118
v_mov_b32 v135, v134
s_nop 1
v_permlane32_swap_b32 v134, v135
v_add_f32 v134, v134, v135
ds_write_b32 v209, v134 offset:512
s_waitcnt lgkmcnt(0)
s_barrier
s_mul_hi_u32 s41, s35, 58835169
s_mul_i32 s42, s41, 73
s_sub_u32 s42, s35, s42
s_mul_i32 s43, s41, 1373568
s_mul_i32 s51, s42, 2688
s_add_u32 s50, s43, s51
s_add_u32 s35, s35, 32
s_min_u32 s41, s41, 1
s_sub_u32 s41, 1, s41
s_lshl_b32 s41, s41, 30
s_add_u32 s52, s50, s41
s_min_u32 s43, s42, 1
s_lshl_b32 s43, s43, 27
s_sub_u32 s43, 536870911, s43
s_add_u32 s51, s42, 56
s_and_b32 s51, s51, 128
s_lshl_b32 s51, s51, 22
s_or_b32 s44, s43, s51
s_mov_b32 s36, s50
v_and_b32 v216, s44, v208
s_add_u32 m0, s45, 0
s_nop 0
buffer_load_dwordx4 v216, s[4:7], s52 offen nt lds
s_add_u32 m0, s45, 4112
s_add_u32 s40, s36, 196224
buffer_load_dwordx4 v216, s[4:7], s40 offen nt lds
s_add_u32 m0, s45, 8224
s_add_u32 s40, s36, 392448
buffer_load_dwordx4 v216, s[4:7], s40 offen nt lds
s_add_u32 m0, s45, 12336
s_add_u32 s40, s36, 588672
buffer_load_dwordx4 v216, s[4:7], s40 offen nt lds
s_add_u32 m0, s45, 16448
s_add_u32 s40, s36, 784896
buffer_load_dwordx4 v216, s[4:7], s40 offen nt lds
s_add_u32 m0, s45, 20560
s_add_u32 s40, s36, 981120
buffer_load_dwordx4 v216, s[4:7], s40 offen nt lds
s_add_u32 m0, s45, 24672
s_add_u32 s40, s36, 1177344
buffer_load_dwordx4 v216, s[4:7], s40 offen nt lds
s_add_u32 m0, s45, 28784
s_add_u32 s40, s36, 1373568
buffer_load_dwordx4 v216, s[4:7], s40 offen nt lds
s_add_u32 m0, s45, 32896
s_add_u32 s40, s36, 1569792
buffer_load_dwordx4 v216, s[4:7], s40 offen nt lds
ds_read_b128 v[182:185], v210
ds_read_b128 v[186:189], v210 offset:1024
s_waitcnt lgkmcnt(1)
v_mfma_f32_16x16x32_bf16 v[138:141], a[0:3], v[182:185], 0
s_waitcnt lgkmcnt(0)
v_mfma_f32_16x16x32_bf16 v[138:141], a[4:7], v[186:189], v[138:141]
v_mfma_f32_16x16x32_bf16 v[142:145], a[24:27], v[182:185], 0
v_mfma_f32_16x16x32_bf16 v[142:145], a[28:31], v[186:189], v[142:145]
v_mfma_f32_16x16x32_bf16 v[146:149], a[48:51], v[182:185], 0
v_mfma_f32_16x16x32_bf16 v[146:149], a[52:55], v[186:189], v[146:149]
v_mfma_f32_16x16x32_bf16 v[150:153], a[216:219], v[182:185], 0
v_mfma_f32_16x16x32_bf16 v[150:153], a[220:223], v[186:189], v[150:153]
v_mfma_f32_16x16x32_bf16 v[154:157], a[240:243], v[182:185], 0
v_mfma_f32_16x16x32_bf16 v[154:157], a[244:247], v[186:189], v[154:157]
v_mfma_f32_16x16x32_bf16 v[158:161], v[232:235], v[182:185], 0
v_mfma_f32_16x16x32_bf16 v[158:161], v[236:239], v[186:189], v[158:161]
v_mfma_f32_16x16x32_bf16 v[162:165], v[182:185], a[72:75], 0
v_mfma_f32_16x16x32_bf16 v[162:165], v[186:189], a[76:79], v[162:165]
v_mfma_f32_16x16x32_bf16 v[166:169], v[182:185], a[96:99], 0
v_mfma_f32_16x16x32_bf16 v[166:169], v[186:189], a[100:103], v[166:169]
v_mfma_f32_16x16x32_bf16 v[170:173], v[182:185], a[120:123], 0
v_mfma_f32_16x16x32_bf16 v[170:173], v[186:189], a[124:127], v[170:173]
ds_read_b128 v[110:113], v210 offset:2048
ds_read_b128 v[220:223], v210 offset:3072
s_waitcnt lgkmcnt(1)
v_mfma_f32_16x16x32_bf16 v[138:141], a[8:11], v[110:113], v[138:141]
s_waitcnt lgkmcnt(0)
v_mfma_f32_16x16x32_bf16 v[138:141], a[12:15], v[220:223], v[138:141]
v_mfma_f32_16x16x32_bf16 v[142:145], a[32:35], v[110:113], v[142:145]
v_mfma_f32_16x16x32_bf16 v[142:145], a[36:39], v[220:223], v[142:145]
v_mfma_f32_16x16x32_bf16 v[146:149], a[56:59], v[110:113], v[146:149]
v_mfma_f32_16x16x32_bf16 v[146:149], a[60:63], v[220:223], v[146:149]
v_mfma_f32_16x16x32_bf16 v[150:153], a[224:227], v[110:113], v[150:153]
v_mfma_f32_16x16x32_bf16 v[150:153], a[228:231], v[220:223], v[150:153]
v_mfma_f32_16x16x32_bf16 v[154:157], a[248:251], v[110:113], v[154:157]
v_mfma_f32_16x16x32_bf16 v[154:157], a[252:255], v[220:223], v[154:157]
v_mfma_f32_16x16x32_bf16 v[158:161], v[240:243], v[110:113], v[158:161]
v_mfma_f32_16x16x32_bf16 v[158:161], v[244:247], v[220:223], v[158:161]
v_mfma_f32_16x16x32_bf16 v[162:165], v[110:113], a[80:83], v[162:165]
v_mfma_f32_16x16x32_bf16 v[162:165], v[220:223], a[84:87], v[162:165]
v_mfma_f32_16x16x32_bf16 v[166:169], v[110:113], a[104:107], v[166:169]
v_mfma_f32_16x16x32_bf16 v[166:169], v[220:223], a[108:111], v[166:169]
v_mfma_f32_16x16x32_bf16 v[170:173], v[110:113], a[128:131], v[170:173]
v_mfma_f32_16x16x32_bf16 v[170:173], v[220:223], a[132:135], v[170:173]
ds_read_b128 v[182:185], v210 offset:4096
ds_read_b128 v[186:189], v210 offset:5120
s_waitcnt lgkmcnt(1)
v_mfma_f32_16x16x32_bf16 v[138:141], a[16:19], v[182:185], v[138:141]
s_waitcnt lgkmcnt(0)
v_mfma_f32_16x16x32_bf16 v[138:141], a[20:23], v[186:189], v[138:141]
v_mfma_f32_16x16x32_bf16 v[142:145], a[40:43], v[182:185], v[142:145]
v_mfma_f32_16x16x32_bf16 v[142:145], a[44:47], v[186:189], v[142:145]
v_mfma_f32_16x16x32_bf16 v[146:149], a[64:67], v[182:185], v[146:149]
v_mfma_f32_16x16x32_bf16 v[146:149], a[68:71], v[186:189], v[146:149]
v_mfma_f32_16x16x32_bf16 v[150:153], a[232:235], v[182:185], v[150:153]
v_mfma_f32_16x16x32_bf16 v[150:153], a[236:239], v[186:189], v[150:153]
v_mfma_f32_16x16x32_bf16 v[154:157], v[224:227], v[182:185], v[154:157]
v_mfma_f32_16x16x32_bf16 v[154:157], v[228:231], v[186:189], v[154:157]
v_mfma_f32_16x16x32_bf16 v[158:161], v[248:251], v[182:185], v[158:161]
v_mfma_f32_16x16x32_bf16 v[158:161], v[252:255], v[186:189], v[158:161]
v_mfma_f32_16x16x32_bf16 v[162:165], v[182:185], a[88:91], v[162:165]
v_mfma_f32_16x16x32_bf16 v[162:165], v[186:189], a[92:95], v[162:165]
v_mfma_f32_16x16x32_bf16 v[166:169], v[182:185], a[112:115], v[166:169]
v_mfma_f32_16x16x32_bf16 v[166:169], v[186:189], a[116:119], v[166:169]
v_mfma_f32_16x16x32_bf16 v[170:173], v[182:185], a[136:139], v[170:173]
v_mfma_f32_16x16x32_bf16 v[170:173], v[186:189], a[140:143], v[170:173]
v_cvt_pk_bf16_f32 v78, v138, v139
v_cvt_pk_bf16_f32 v79, v140, v141
v_cvt_pk_bf16_f32 v80, v142, v143
v_cvt_pk_bf16_f32 v81, v144, v145
v_cvt_pk_bf16_f32 v82, v146, v147
v_cvt_pk_bf16_f32 v83, v148, v149
v_cvt_pk_bf16_f32 v72, v150, v151
v_cvt_pk_bf16_f32 v73, v152, v153
v_cvt_pk_bf16_f32 v74, v154, v155
v_cvt_pk_bf16_f32 v75, v156, v157
v_cvt_pk_bf16_f32 v76, v158, v159
v_cvt_pk_bf16_f32 v77, v160, v161
v_cvt_pk_bf16_f32 v114, v162, v163
v_cvt_pk_bf16_f32 v115, v164, v165
v_cvt_pk_bf16_f32 v122, v166, v167
v_cvt_pk_bf16_f32 v123, v168, v169
v_cvt_pk_bf16_f32 v130, v170, v171
v_cvt_pk_bf16_f32 v131, v172, v173
ds_read_b128 v[110:113], v210 offset:6144
ds_read_b128 v[220:223], v210 offset:7168
s_waitcnt lgkmcnt(1)
v_mfma_f32_16x16x32_bf16 v[138:141], a[0:3], v[110:113], 0
s_waitcnt lgkmcnt(0)
v_mfma_f32_16x16x32_bf16 v[138:141], a[4:7], v[220:223], v[138:141]
v_mfma_f32_16x16x32_bf16 v[142:145], a[24:27], v[110:113], 0
v_mfma_f32_16x16x32_bf16 v[142:145], a[28:31], v[220:223], v[142:145]
v_mfma_f32_16x16x32_bf16 v[146:149], a[48:51], v[110:113], 0
v_mfma_f32_16x16x32_bf16 v[146:149], a[52:55], v[220:223], v[146:149]
v_mfma_f32_16x16x32_bf16 v[150:153], a[216:219], v[110:113], 0
v_mfma_f32_16x16x32_bf16 v[150:153], a[220:223], v[220:223], v[150:153]
v_mfma_f32_16x16x32_bf16 v[154:157], a[240:243], v[110:113], 0
v_mfma_f32_16x16x32_bf16 v[154:157], a[244:247], v[220:223], v[154:157]
v_mfma_f32_16x16x32_bf16 v[158:161], v[232:235], v[110:113], 0
v_mfma_f32_16x16x32_bf16 v[158:161], v[236:239], v[220:223], v[158:161]
v_mfma_f32_16x16x32_bf16 v[162:165], v[110:113], a[72:75], 0
v_mfma_f32_16x16x32_bf16 v[162:165], v[220:223], a[76:79], v[162:165]
v_mfma_f32_16x16x32_bf16 v[166:169], v[110:113], a[96:99], 0
v_mfma_f32_16x16x32_bf16 v[166:169], v[220:223], a[100:103], v[166:169]
v_mfma_f32_16x16x32_bf16 v[170:173], v[110:113], a[120:123], 0
v_mfma_f32_16x16x32_bf16 v[170:173], v[220:223], a[124:127], v[170:173]
ds_read_b128 v[102:105], v210 offset:18432
ds_read_b128 v[106:109], v210 offset:19456
s_waitcnt lgkmcnt(1)
v_add_f32 v102, v102, v103
s_waitcnt lgkmcnt(0)
v_add_f32 v106, v106, v107
v_add_f32 v104, v104, v105
v_add_f32 v108, v108, v109
v_add_f32 v102, v102, v104
v_add_f32 v106, v106, v108
v_mul_f32 v103, s48, v102
v_mul_f32 v104, s73, v102
v_mul_f32 v106, s73, v106
v_fma_f32 v106, -v103, v104, v106
v_max_f32 v106, 0, v106
v_add_f32 v106, s49, v106
v_rsq_f32 v102, v106
s_nop 0
v_mul_f32_e64 v103, -v103, v102
ds_write_b64 v211, v[102:103] offset:20480
ds_read_b64 v[118:119], v219 offset:20480
ds_read_b64 v[126:127], v219 offset:20736
ds_read_b64 v[134:135], v219 offset:20992
s_waitcnt lgkmcnt(2)
v_fma_f32 v220, v36, v118, v119
v_fma_f32 v221, v37, v118, v119
v_cvt_pk_bf16_f32 v90, v220, v221
v_fma_f32 v222, v38, v118, v119
v_fma_f32 v223, v39, v118, v119
v_cvt_pk_bf16_f32 v91, v222, v223
v_fma_f32 v220, v40, v118, v119
v_fma_f32 v221, v41, v118, v119
v_cvt_pk_bf16_f32 v92, v220, v221
v_fma_f32 v222, v42, v118, v119
v_fma_f32 v223, v43, v118, v119
v_cvt_pk_bf16_f32 v93, v222, v223
ds_write_b128 v211, v[90:93] offset:20480
v_fma_f32 v220, v44, v118, v119
v_fma_f32 v221, v45, v118, v119
v_cvt_pk_bf16_f32 v94, v220, v221
v_fma_f32 v222, v46, v118, v119
v_fma_f32 v223, v47, v118, v119
v_cvt_pk_bf16_f32 v95, v222, v223
s_waitcnt lgkmcnt(2)
ds_write_b64 v212, v[94:95] offset:20480
v_fma_f32 v220, v48, v126, v127
v_fma_f32 v221, v49, v126, v127
v_cvt_pk_bf16_f32 v174, v220, v221
v_fma_f32 v222, v50, v126, v127
v_fma_f32 v223, v51, v126, v127
v_cvt_pk_bf16_f32 v175, v222, v223
v_fma_f32 v220, v52, v126, v127
v_fma_f32 v221, v53, v126, v127
v_cvt_pk_bf16_f32 v176, v220, v221
v_fma_f32 v222, v54, v126, v127
v_fma_f32 v223, v55, v126, v127
v_cvt_pk_bf16_f32 v177, v222, v223
ds_write_b128 v211, v[174:177] offset:26624
v_fma_f32 v220, v56, v126, v127
v_fma_f32 v221, v57, v126, v127
v_cvt_pk_bf16_f32 v178, v220, v221
v_fma_f32 v222, v58, v126, v127
v_fma_f32 v223, v59, v126, v127
v_cvt_pk_bf16_f32 v179, v222, v223
s_waitcnt lgkmcnt(3)
ds_write_b64 v212, v[178:179] offset:26624
v_fma_f32 v220, v60, v134, v135
v_fma_f32 v221, v61, v134, v135
v_cvt_pk_bf16_f32 v90, v220, v221
v_fma_f32 v222, v62, v134, v135
v_fma_f32 v223, v63, v134, v135
v_cvt_pk_bf16_f32 v91, v222, v223
v_fma_f32 v220, v64, v134, v135
v_fma_f32 v221, v65, v134, v135
v_cvt_pk_bf16_f32 v92, v220, v221
v_fma_f32 v222, v66, v134, v135
v_fma_f32 v223, v67, v134, v135
v_cvt_pk_bf16_f32 v93, v222, v223
ds_write_b128 v211, v[90:93] offset:32768
v_fma_f32 v220, v68, v134, v135
v_fma_f32 v221, v69, v134, v135
v_cvt_pk_bf16_f32 v94, v220, v221
v_fma_f32 v222, v70, v134, v135
v_fma_f32 v223, v71, v134, v135
v_cvt_pk_bf16_f32 v95, v222, v223
ds_write_b64 v212, v[94:95] offset:32768
ds_read_b128 v[182:185], v210 offset:8192
ds_read_b128 v[186:189], v210 offset:9216
s_waitcnt lgkmcnt(1)
v_mfma_f32_16x16x32_bf16 v[138:141], a[8:11], v[182:185], v[138:141]
s_waitcnt lgkmcnt(0)
v_mfma_f32_16x16x32_bf16 v[138:141], a[12:15], v[186:189], v[138:141]
v_mfma_f32_16x16x32_bf16 v[142:145], a[32:35], v[182:185], v[142:145]
v_mfma_f32_16x16x32_bf16 v[142:145], a[36:39], v[186:189], v[142:145]
v_mfma_f32_16x16x32_bf16 v[146:149], a[56:59], v[182:185], v[146:149]
v_mfma_f32_16x16x32_bf16 v[146:149], a[60:63], v[186:189], v[146:149]
v_mfma_f32_16x16x32_bf16 v[150:153], a[224:227], v[182:185], v[150:153]
v_mfma_f32_16x16x32_bf16 v[150:153], a[228:231], v[186:189], v[150:153]
v_mfma_f32_16x16x32_bf16 v[154:157], a[248:251], v[182:185], v[154:157]
v_mfma_f32_16x16x32_bf16 v[154:157], a[252:255], v[186:189], v[154:157]
v_mfma_f32_16x16x32_bf16 v[158:161], v[240:243], v[182:185], v[158:161]
v_mfma_f32_16x16x32_bf16 v[158:161], v[244:247], v[186:189], v[158:161]
v_mfma_f32_16x16x32_bf16 v[162:165], v[182:185], a[80:83], v[162:165]
v_mfma_f32_16x16x32_bf16 v[162:165], v[186:189], a[84:87], v[162:165]
v_mfma_f32_16x16x32_bf16 v[166:169], v[182:185], a[104:107], v[166:169]
v_mfma_f32_16x16x32_bf16 v[166:169], v[186:189], a[108:111], v[166:169]
v_mfma_f32_16x16x32_bf16 v[170:173], v[182:185], a[128:131], v[170:173]
v_mfma_f32_16x16x32_bf16 v[170:173], v[186:189], a[132:135], v[170:173]
ds_read_b128 v[110:113], v210 offset:10240
ds_read_b128 v[106:109], v210 offset:11264
s_waitcnt lgkmcnt(1)
v_mfma_f32_16x16x32_bf16 v[138:141], a[16:19], v[110:113], v[138:141]
s_waitcnt lgkmcnt(0)
v_mfma_f32_16x16x32_bf16 v[138:141], a[20:23], v[106:109], v[138:141]
v_mfma_f32_16x16x32_bf16 v[142:145], a[40:43], v[110:113], v[142:145]
v_mfma_f32_16x16x32_bf16 v[142:145], a[44:47], v[106:109], v[142:145]
v_mfma_f32_16x16x32_bf16 v[146:149], a[64:67], v[110:113], v[146:149]
v_mfma_f32_16x16x32_bf16 v[146:149], a[68:71], v[106:109], v[146:149]
v_mfma_f32_16x16x32_bf16 v[150:153], a[232:235], v[110:113], v[150:153]
v_mfma_f32_16x16x32_bf16 v[150:153], a[236:239], v[106:109], v[150:153]
v_mfma_f32_16x16x32_bf16 v[154:157], v[224:227], v[110:113], v[154:157]
v_mfma_f32_16x16x32_bf16 v[154:157], v[228:231], v[106:109], v[154:157]
v_mfma_f32_16x16x32_bf16 v[158:161], v[248:251], v[110:113], v[158:161]
v_mfma_f32_16x16x32_bf16 v[158:161], v[252:255], v[106:109], v[158:161]
v_mfma_f32_16x16x32_bf16 v[162:165], v[110:113], a[88:91], v[162:165]
v_mfma_f32_16x16x32_bf16 v[162:165], v[106:109], a[92:95], v[162:165]
v_mfma_f32_16x16x32_bf16 v[166:169], v[110:113], a[112:115], v[166:169]
v_mfma_f32_16x16x32_bf16 v[166:169], v[106:109], a[116:119], v[166:169]
v_mfma_f32_16x16x32_bf16 v[170:173], v[110:113], a[136:139], v[170:173]
v_mfma_f32_16x16x32_bf16 v[170:173], v[106:109], a[140:143], v[170:173]
v_cvt_pk_bf16_f32 v96, v138, v139
v_cvt_pk_bf16_f32 v97, v140, v141
v_cvt_pk_bf16_f32 v98, v142, v143
v_cvt_pk_bf16_f32 v99, v144, v145
v_cvt_pk_bf16_f32 v100, v146, v147
v_cvt_pk_bf16_f32 v101, v148, v149
v_cvt_pk_bf16_f32 v84, v150, v151
v_cvt_pk_bf16_f32 v85, v152, v153
v_cvt_pk_bf16_f32 v86, v154, v155
v_cvt_pk_bf16_f32 v87, v156, v157
v_cvt_pk_bf16_f32 v88, v158, v159
v_cvt_pk_bf16_f32 v89, v160, v161
v_cvt_pk_bf16_f32 v116, v162, v163
v_cvt_pk_bf16_f32 v117, v164, v165
v_cvt_pk_bf16_f32 v124, v166, v167
v_cvt_pk_bf16_f32 v125, v168, v169
v_cvt_pk_bf16_f32 v132, v170, v171
v_cvt_pk_bf16_f32 v133, v172, v173
ds_read_b128 v[182:185], v210 offset:12288
ds_read_b128 v[186:189], v210 offset:13312
s_waitcnt lgkmcnt(1)
v_mfma_f32_16x16x32_bf16 v[138:141], a[0:3], v[182:185], 0
s_waitcnt lgkmcnt(0)
v_mfma_f32_16x16x32_bf16 v[138:141], a[4:7], v[186:189], v[138:141]
v_mfma_f32_16x16x32_bf16 v[142:145], a[24:27], v[182:185], 0
v_mfma_f32_16x16x32_bf16 v[142:145], a[28:31], v[186:189], v[142:145]
v_mfma_f32_16x16x32_bf16 v[146:149], a[48:51], v[182:185], 0
v_mfma_f32_16x16x32_bf16 v[146:149], a[52:55], v[186:189], v[146:149]
ds_read_b128 v[170:173], v210 offset:14336
ds_read_b128 v[182:185], v210 offset:15360
s_waitcnt lgkmcnt(1)
v_mfma_f32_16x16x32_bf16 v[138:141], a[8:11], v[170:173], v[138:141]
s_waitcnt lgkmcnt(0)
v_mfma_f32_16x16x32_bf16 v[138:141], a[12:15], v[182:185], v[138:141]
v_mfma_f32_16x16x32_bf16 v[142:145], a[32:35], v[170:173], v[142:145]
v_mfma_f32_16x16x32_bf16 v[142:145], a[36:39], v[182:185], v[142:145]
v_mfma_f32_16x16x32_bf16 v[146:149], a[56:59], v[170:173], v[146:149]
v_mfma_f32_16x16x32_bf16 v[146:149], a[60:63], v[182:185], v[146:149]
ds_read_b128 v[186:189], v210 offset:16384
ds_read_b128 v[170:173], v210 offset:17408
s_waitcnt lgkmcnt(1)
v_mfma_f32_16x16x32_bf16 v[138:141], a[16:19], v[186:189], v[138:141]
s_waitcnt lgkmcnt(0)
v_mfma_f32_16x16x32_bf16 v[138:141], a[20:23], v[170:173], v[138:141]
v_mfma_f32_16x16x32_bf16 v[142:145], a[40:43], v[186:189], v[142:145]
v_mfma_f32_16x16x32_bf16 v[142:145], a[44:47], v[170:173], v[142:145]
v_mfma_f32_16x16x32_bf16 v[146:149], a[64:67], v[186:189], v[146:149]
v_mfma_f32_16x16x32_bf16 v[146:149], a[68:71], v[170:173], v[146:149]
v_cvt_pk_bf16_f32 v102, v138, v139
v_cvt_pk_bf16_f32 v103, v140, v141
v_cvt_pk_bf16_f32 v104, v142, v143
v_cvt_pk_bf16_f32 v105, v144, v145
s_nop 2
v_cvt_pk_bf16_f32 v106, v146, v147
v_cvt_pk_bf16_f32 v107, v148, v149
ds_read_b128 v[108:111], v215 offset:512
ds_read_b64 v[112:113], v215 offset:528
v_mfma_f32_16x16x32_bf16 v[138:141], v[78:81], v[72:75], 0
v_mfma_f32_16x16x32_bf16 v[142:145], v[96:99], v[72:75], 0
s_waitcnt lgkmcnt(1)
v_mfma_f32_16x16x32_bf16 v[150:153], v[108:111], v[72:75], v[206:209]
v_mfma_f32_16x16x32_bf16 v[146:149], v[102:105], v[72:75], 0
v_mfma_f32_16x16x16_bf16 v[138:141], v[82:83], v[76:77], v[138:141]
v_mfma_f32_16x16x16_bf16 v[142:145], v[100:101], v[76:77], v[142:145]
s_waitcnt lgkmcnt(0)
v_mfma_f32_16x16x16_bf16 v[150:153], v[112:113], v[76:77], v[150:153]
v_mfma_f32_16x16x16_bf16 v[146:149], v[106:107], v[76:77], v[146:149]
ds_read_b128 v[72:75], v215
ds_read_b64 v[76:77], v215 offset:16
v_mfma_f32_16x16x16_bf16 v[154:157], v[82:83], v[88:89], 0
v_mfma_f32_16x16x16_bf16 v[158:161], v[100:101], v[88:89], 0
v_mfma_f32_16x16x16_bf16 v[166:169], v[112:113], v[88:89], v[206:209]
v_mfma_f32_16x16x16_bf16 v[162:165], v[106:107], v[88:89], 0
v_mfma_f32_16x16x32_bf16 v[154:157], v[78:81], v[84:87], v[154:157]
v_mfma_f32_16x16x32_bf16 v[158:161], v[96:99], v[84:87], v[158:161]
v_mfma_f32_16x16x32_bf16 v[166:169], v[108:111], v[84:87], v[166:169]
v_mfma_f32_16x16x32_bf16 v[162:165], v[102:105], v[84:87], v[162:165]
ds_read_b128 v[182:185], v210 offset:12288
ds_read_b128 v[186:189], v210 offset:13312
s_waitcnt lgkmcnt(1)
v_mfma_f32_16x16x32_bf16 v[118:121], v[182:185], a[72:75], 0
s_waitcnt lgkmcnt(0)
v_mfma_f32_16x16x32_bf16 v[118:121], v[186:189], a[76:79], v[118:121]
v_mfma_f32_16x16x32_bf16 v[126:129], v[182:185], a[96:99], 0
v_mfma_f32_16x16x32_bf16 v[126:129], v[186:189], a[100:103], v[126:129]
v_mfma_f32_16x16x32_bf16 v[134:137], v[182:185], a[120:123], 0
v_mfma_f32_16x16x32_bf16 v[134:137], v[186:189], a[124:127], v[134:137]
v_mfma_f32_16x16x32_bf16 v[90:93], a[216:219], v[182:185], 0
v_mfma_f32_16x16x32_bf16 v[90:93], a[220:223], v[186:189], v[90:93]
v_mfma_f32_16x16x32_bf16 v[170:173], a[240:243], v[182:185], 0
v_mfma_f32_16x16x32_bf16 v[170:173], a[244:247], v[186:189], v[170:173]
v_mfma_f32_16x16x32_bf16 v[220:223], v[232:235], v[182:185], 0
v_mfma_f32_16x16x32_bf16 v[220:223], v[236:239], v[186:189], v[220:223]
ds_read_b128 v[174:177], v210 offset:14336
ds_read_b128 v[178:181], v210 offset:15360
s_waitcnt lgkmcnt(1)
v_mfma_f32_16x16x32_bf16 v[118:121], v[174:177], a[80:83], v[118:121]
s_waitcnt lgkmcnt(0)
v_mfma_f32_16x16x32_bf16 v[118:121], v[178:181], a[84:87], v[118:121]
v_mfma_f32_16x16x32_bf16 v[126:129], v[174:177], a[104:107], v[126:129]
v_mfma_f32_16x16x32_bf16 v[126:129], v[178:181], a[108:111], v[126:129]
v_mfma_f32_16x16x32_bf16 v[134:137], v[174:177], a[128:131], v[134:137]
v_mfma_f32_16x16x32_bf16 v[134:137], v[178:181], a[132:135], v[134:137]
v_mfma_f32_16x16x32_bf16 v[90:93], a[224:227], v[174:177], v[90:93]
v_mfma_f32_16x16x32_bf16 v[90:93], a[228:231], v[178:181], v[90:93]
v_mfma_f32_16x16x32_bf16 v[170:173], a[248:251], v[174:177], v[170:173]
v_mfma_f32_16x16x32_bf16 v[170:173], a[252:255], v[178:181], v[170:173]
v_mfma_f32_16x16x32_bf16 v[220:223], v[240:243], v[174:177], v[220:223]
v_mfma_f32_16x16x32_bf16 v[220:223], v[244:247], v[178:181], v[220:223]
ds_read_b128 v[182:185], v210 offset:16384
ds_read_b128 v[186:189], v210 offset:17408
s_waitcnt lgkmcnt(1)
v_mfma_f32_16x16x32_bf16 v[118:121], v[182:185], a[88:91], v[118:121]
s_waitcnt lgkmcnt(0)
v_mfma_f32_16x16x32_bf16 v[118:121], v[186:189], a[92:95], v[118:121]
v_mfma_f32_16x16x32_bf16 v[126:129], v[182:185], a[112:115], v[126:129]
v_mfma_f32_16x16x32_bf16 v[126:129], v[186:189], a[116:119], v[126:129]
v_mfma_f32_16x16x32_bf16 v[134:137], v[182:185], a[136:139], v[134:137]
v_mfma_f32_16x16x32_bf16 v[134:137], v[186:189], a[140:143], v[134:137]
v_mfma_f32_16x16x32_bf16 v[90:93], a[232:235], v[182:185], v[90:93]
v_mfma_f32_16x16x32_bf16 v[90:93], a[236:239], v[186:189], v[90:93]
v_mfma_f32_16x16x32_bf16 v[170:173], v[224:227], v[182:185], v[170:173]
v_mfma_f32_16x16x32_bf16 v[170:173], v[228:231], v[186:189], v[170:173]
v_mfma_f32_16x16x32_bf16 v[220:223], v[248:251], v[182:185], v[220:223]
v_mfma_f32_16x16x32_bf16 v[220:223], v[252:255], v[186:189], v[220:223]
v_mov_b32 v181, 0
v_cvt_pk_bf16_f32 v118, v118, v119
v_cvt_pk_bf16_f32 v119, v120, v121
ds_read_u16 v120, v205
v_mov_b32 v121, 0
v_cvt_pk_bf16_f32 v126, v126, v127
v_cvt_pk_bf16_f32 v127, v128, v129
ds_read_u16 v128, v205 offset:32
v_mov_b32 v129, 0
v_cvt_pk_bf16_f32 v134, v134, v135
v_cvt_pk_bf16_f32 v135, v136, v137
ds_read_u16 v136, v205 offset:64
v_mov_b32 v137, 0
v_add_u32 v205, 1424, v205
v_cvt_pk_bf16_f32 v90, v90, v91
v_cvt_pk_bf16_f32 v91, v92, v93
v_cvt_pk_bf16_f32 v92, v170, v171
v_cvt_pk_bf16_f32 v93, v172, v173
v_cvt_pk_bf16_f32 v94, v220, v221
v_cvt_pk_bf16_f32 v95, v222, v223
v_max3_f32 v151, v138, v139, v140
v_max3_f32 v151, v151, v141, v142
v_max3_f32 v151, v151, v143, v144
v_max3_f32 v151, v151, v145, v146
v_max3_f32 v151, v151, v147, v148
v_max3_f32 v151, v151, v149, v150
v_mov_b32 v152, v151
s_nop 1
v_permlane16_swap_b32 v151, v152
v_max_f32 v151, v151, v152
v_mov_b32 v152, v151
s_nop 1
v_permlane32_swap_b32 v151, v152
v_max_f32 v151, v151, v152
v_sub_f32 v138, v138, v151
v_sub_f32 v139, v139, v151
v_sub_f32 v140, v140, v151
v_sub_f32 v141, v141, v151
v_sub_f32 v142, v142, v151
v_sub_f32 v143, v143, v151
v_sub_f32 v144, v144, v151
v_sub_f32 v145, v145, v151
v_sub_f32 v150, v150, v151
v_sub_f32 v146, v146, v151
v_sub_f32 v147, v147, v151
v_sub_f32 v148, v148, v151
v_sub_f32 v149, v149, v151
v_exp_f32 v138, v138
v_exp_f32 v139, v139
v_exp_f32 v140, v140
v_exp_f32 v141, v141
v_exp_f32 v142, v142
v_exp_f32 v143, v143
v_exp_f32 v144, v144
v_exp_f32 v145, v145
v_exp_f32 v150, v150
v_exp_f32 v146, v146
v_exp_f32 v147, v147
v_exp_f32 v148, v148
v_exp_f32 v149, v149
v_cvt_pk_bf16_f32 v174, v138, v139
v_cvt_pk_bf16_f32 v175, v140, v141
v_cvt_pk_bf16_f32 v176, v142, v143
v_cvt_pk_bf16_f32 v177, v144, v145
v_cvt_pk_bf16_f32 v178, v146, v147
v_cvt_pk_bf16_f32 v179, v148, v149
v_cvt_pk_bf16_f32 v180, v150, 0
v_mfma_f32_16x16x32_bf16 v[150:153], v[190:193], v[174:177], 0
v_mfma_f32_16x16x32_bf16 v[150:153], v[190:193], v[178:181], v[150:153]
v_mfma_f32_16x16x32_bf16 v[138:141], v[114:117], v[174:177], 0
s_waitcnt lgkmcnt(2)
v_mfma_f32_16x16x32_bf16 v[138:141], v[118:121], v[178:181], v[138:141]
v_mfma_f32_16x16x32_bf16 v[142:145], v[122:125], v[174:177], 0
s_waitcnt lgkmcnt(1)
v_mfma_f32_16x16x32_bf16 v[142:145], v[126:129], v[178:181], v[142:145]
v_mfma_f32_16x16x32_bf16 v[146:149], v[130:133], v[174:177], 0
s_waitcnt lgkmcnt(0)
v_mfma_f32_16x16x32_bf16 v[146:149], v[134:137], v[178:181], v[146:149]
v_max3_f32 v167, v154, v155, v156
v_max3_f32 v167, v167, v157, v158
v_max3_f32 v167, v167, v159, v160
v_max3_f32 v167, v167, v161, v162
v_max3_f32 v167, v167, v163, v164
v_max3_f32 v167, v167, v165, v166
v_mov_b32 v168, v167
s_nop 1
v_permlane16_swap_b32 v167, v168
v_max_f32 v167, v167, v168
v_mov_b32 v168, v167
s_nop 1
v_permlane32_swap_b32 v167, v168
v_max_f32 v167, v167, v168
v_sub_f32 v154, v154, v167
v_sub_f32 v155, v155, v167
v_sub_f32 v156, v156, v167
v_sub_f32 v157, v157, v167
v_sub_f32 v158, v158, v167
v_sub_f32 v159, v159, v167
v_sub_f32 v160, v160, v167
v_sub_f32 v161, v161, v167
v_sub_f32 v166, v166, v167
v_sub_f32 v162, v162, v167
v_sub_f32 v163, v163, v167
v_sub_f32 v164, v164, v167
v_sub_f32 v165, v165, v167
v_exp_f32 v154, v154
v_exp_f32 v155, v155
v_exp_f32 v156, v156
v_exp_f32 v157, v157
v_exp_f32 v158, v158
v_exp_f32 v159, v159
v_exp_f32 v160, v160
v_exp_f32 v161, v161
v_exp_f32 v166, v166
v_exp_f32 v162, v162
v_exp_f32 v163, v163
v_exp_f32 v164, v164
v_exp_f32 v165, v165
v_cvt_pk_bf16_f32 v174, v154, v155
v_cvt_pk_bf16_f32 v175, v156, v157
v_cvt_pk_bf16_f32 v176, v158, v159
v_cvt_pk_bf16_f32 v177, v160, v161
v_cvt_pk_bf16_f32 v178, v162, v163
v_cvt_pk_bf16_f32 v179, v164, v165
v_cvt_pk_bf16_f32 v180, v166, 0
v_mfma_f32_16x16x32_bf16 v[166:169], v[190:193], v[174:177], 0
v_mfma_f32_16x16x32_bf16 v[166:169], v[190:193], v[178:181], v[166:169]
v_mfma_f32_16x16x32_bf16 v[154:157], v[114:117], v[174:177], 0
v_mfma_f32_16x16x32_bf16 v[154:157], v[118:121], v[178:181], v[154:157]
v_mfma_f32_16x16x32_bf16 v[158:161], v[122:125], v[174:177], 0
v_mfma_f32_16x16x32_bf16 v[158:161], v[126:129], v[178:181], v[158:161]
v_mfma_f32_16x16x32_bf16 v[162:165], v[130:133], v[174:177], 0
v_mfma_f32_16x16x32_bf16 v[162:165], v[134:137], v[178:181], v[162:165]
v_rcp_f32 v151, v150
s_nop 0
v_mul_f32 v152, s3, v151
v_mul_f32 v138, v138, v152
v_mul_f32 v139, v139, v152
v_cvt_pk_bf16_f32 v138, v138, v139
v_mul_f32 v140, v140, v152
v_mul_f32 v141, v141, v152
v_cvt_pk_bf16_f32 v139, v140, v141
v_mul_f32 v142, v142, v152
v_mul_f32 v143, v143, v152
v_cvt_pk_bf16_f32 v140, v142, v143
v_mul_f32 v144, v144, v152
v_mul_f32 v145, v145, v152
v_cvt_pk_bf16_f32 v141, v144, v145
ds_write_b128 v211, v[138:141] offset:38912
v_mul_f32 v146, v146, v152
v_mul_f32 v147, v147, v152
v_cvt_pk_bf16_f32 v142, v146, v147
v_mul_f32 v148, v148, v152
v_mul_f32 v149, v149, v152
v_cvt_pk_bf16_f32 v143, v148, v149
ds_write_b64 v212, v[142:143] offset:38912
v_mfma_f32_16x16x32_bf16 v[138:141], v[78:81], v[90:93], 0
v_mfma_f32_16x16x32_bf16 v[142:145], v[96:99], v[90:93], 0
v_mfma_f32_16x16x32_bf16 v[150:153], v[108:111], v[90:93], v[206:209]
v_mfma_f32_16x16x32_bf16 v[146:149], v[102:105], v[90:93], 0
v_mfma_f32_16x16x16_bf16 v[138:141], v[82:83], v[94:95], v[138:141]
v_mfma_f32_16x16x16_bf16 v[142:145], v[100:101], v[94:95], v[142:145]
v_mfma_f32_16x16x16_bf16 v[150:153], v[112:113], v[94:95], v[150:153]
v_mfma_f32_16x16x16_bf16 v[146:149], v[106:107], v[94:95], v[146:149]
v_rcp_f32 v167, v166
s_nop 0
v_mul_f32 v168, s3, v167
v_mul_f32 v154, v154, v168
v_mul_f32 v155, v155, v168
v_cvt_pk_bf16_f32 v154, v154, v155
v_mul_f32 v156, v156, v168
v_mul_f32 v157, v157, v168
v_cvt_pk_bf16_f32 v155, v156, v157
v_mul_f32 v158, v158, v168
v_mul_f32 v159, v159, v168
v_cvt_pk_bf16_f32 v156, v158, v159
v_mul_f32 v160, v160, v168
v_mul_f32 v161, v161, v168
v_cvt_pk_bf16_f32 v157, v160, v161
ds_write_b128 v211, v[154:157] offset:45056
v_mul_f32 v162, v162, v168
v_mul_f32 v163, v163, v168
v_cvt_pk_bf16_f32 v158, v162, v163
v_mul_f32 v164, v164, v168
v_mul_f32 v165, v165, v168
v_cvt_pk_bf16_f32 v159, v164, v165
ds_write_b64 v212, v[158:159] offset:45056
v_mfma_f32_16x16x16_bf16 v[154:157], v[76:77], v[82:83], 0
v_mfma_f32_16x16x16_bf16 v[158:161], v[76:77], v[100:101], 0
v_mfma_f32_16x16x16_bf16 v[162:165], v[76:77], v[106:107], 0
v_mfma_f32_16x16x16_bf16 v[166:169], v[76:77], v[112:113], v[206:209]
v_mfma_f32_16x16x32_bf16 v[154:157], v[72:75], v[78:81], v[154:157]
v_mfma_f32_16x16x32_bf16 v[158:161], v[72:75], v[96:99], v[158:161]
v_mfma_f32_16x16x32_bf16 v[162:165], v[72:75], v[102:105], v[162:165]
v_mfma_f32_16x16x32_bf16 v[166:169], v[72:75], v[108:111], v[166:169]
v_mov_b32_dpp v154, v158 quad_perm:[0,1,2,3] row_mask:0x2 bank_mask:0xf
s_nop 1
v_mov_b32_dpp v154, v162 quad_perm:[0,1,2,3] row_mask:0x4 bank_mask:0xf
s_nop 2
v_mov_b32_dpp v154, v167 quad_perm:[0,1,2,3] row_mask:0x8 bank_mask:0xf
v_mov_b32 v155, v154
s_nop 1
v_max_f32_dpp v155, v155, v155 row_ror:8 row_mask:0xf bank_mask:0xf
s_nop 1
v_max_f32_dpp v155, v155, v155 row_ror:4 row_mask:0xf bank_mask:0xf
s_nop 1
v_max_f32_dpp v155, v155, v155 row_ror:2 row_mask:0xf bank_mask:0xf
s_nop 1
v_max_f32_dpp v155, v155, v155 row_ror:1 row_mask:0xf bank_mask:0xf
v_mov_b32 v156, v155
s_nop 1
v_permlane16_swap_b32 v155, v156
v_max_f32 v155, v155, v156
v_mov_b32 v156, v155
s_nop 1
v_permlane32_swap_b32 v155, v156
v_max_f32 v155, v155, v156
v_sub_f32 v154, v154, v155
v_exp_f32 v154, v154
s_nop 0
v_cvt_pk_bf16_f32 v154, v154, 0
ds_write_b16 v214, v154
ds_read_b128 v[84:87], v215
s_waitcnt lgkmcnt(2)
ds_read_b128 v[88:91], v215 offset:16
v_add_u32 v215, 1424, v215
s_barrier
ds_read_b128 v[220:223], v210 offset:38912
ds_read_b128 v[110:113], v210 offset:39936
s_waitcnt lgkmcnt(1)
v_mfma_f32_16x16x32_bf16 v[0:3], a[144:147], v[220:223], v[0:3]
s_waitcnt lgkmcnt(0)
v_mfma_f32_16x16x32_bf16 v[0:3], a[148:151], v[110:113], v[0:3]
v_mfma_f32_16x16x32_bf16 v[4:7], a[168:171], v[220:223], v[4:7]
v_mfma_f32_16x16x32_bf16 v[4:7], a[172:175], v[110:113], v[4:7]
v_mfma_f32_16x16x32_bf16 v[8:11], a[192:195], v[220:223], v[8:11]
v_mfma_f32_16x16x32_bf16 v[8:11], a[196:199], v[110:113], v[8:11]
ds_read_b128 v[170:173], v210 offset:40960
ds_read_b128 v[182:185], v210 offset:41984
s_waitcnt lgkmcnt(1)
v_mfma_f32_16x16x32_bf16 v[0:3], a[152:155], v[170:173], v[0:3]
s_waitcnt lgkmcnt(0)
v_mfma_f32_16x16x32_bf16 v[0:3], a[156:159], v[182:185], v[0:3]
v_mfma_f32_16x16x32_bf16 v[4:7], a[176:179], v[170:173], v[4:7]
v_mfma_f32_16x16x32_bf16 v[4:7], a[180:183], v[182:185], v[4:7]
v_mfma_f32_16x16x32_bf16 v[8:11], a[200:203], v[170:173], v[8:11]
v_mfma_f32_16x16x32_bf16 v[8:11], a[204:207], v[182:185], v[8:11]
ds_read_b128 v[186:189], v210 offset:43008
ds_read_b128 v[220:223], v210 offset:44032
s_waitcnt lgkmcnt(1)
v_mfma_f32_16x16x32_bf16 v[0:3], a[160:163], v[186:189], v[0:3]
s_waitcnt lgkmcnt(0)
v_mfma_f32_16x16x32_bf16 v[0:3], a[164:167], v[220:223], v[0:3]
v_mfma_f32_16x16x32_bf16 v[4:7], a[184:187], v[186:189], v[4:7]
v_mfma_f32_16x16x32_bf16 v[4:7], a[188:191], v[220:223], v[4:7]
v_mfma_f32_16x16x32_bf16 v[8:11], a[208:211], v[186:189], v[8:11]
v_mfma_f32_16x16x32_bf16 v[8:11], a[212:215], v[220:223], v[8:11]
v_cvt_pk_bf16_f32 v0, v0, v1
v_cvt_pk_bf16_f32 v1, v2, v3
ds_write_b64 v203, v[0:1]
v_cvt_pk_bf16_f32 v4, v4, v5
v_cvt_pk_bf16_f32 v5, v6, v7
ds_write_b64 v203, v[4:5] offset:32
v_cvt_pk_bf16_f32 v8, v8, v9
v_cvt_pk_bf16_f32 v9, v10, v11
ds_write_b64 v203, v[8:9] offset:64
v_max3_f32 v151, v138, v139, v140
v_max3_f32 v151, v151, v141, v142
v_max3_f32 v151, v151, v143, v144
v_max3_f32 v151, v151, v145, v146
v_max3_f32 v151, v151, v147, v148
v_max3_f32 v151, v151, v149, v150
v_mov_b32 v152, v151
s_nop 1
v_permlane16_swap_b32 v151, v152
v_max_f32 v151, v151, v152
v_mov_b32 v152, v151
s_nop 1
v_permlane32_swap_b32 v151, v152
v_max_f32 v151, v151, v152
v_sub_f32 v138, v138, v151
v_sub_f32 v139, v139, v151
v_sub_f32 v140, v140, v151
v_sub_f32 v141, v141, v151
v_sub_f32 v142, v142, v151
v_sub_f32 v143, v143, v151
v_sub_f32 v144, v144, v151
v_sub_f32 v145, v145, v151
v_sub_f32 v150, v150, v151
v_sub_f32 v146, v146, v151
v_sub_f32 v147, v147, v151
v_sub_f32 v148, v148, v151
v_sub_f32 v149, v149, v151
v_exp_f32 v138, v138
v_exp_f32 v139, v139
v_exp_f32 v140, v140
v_exp_f32 v141, v141
v_exp_f32 v142, v142
v_exp_f32 v143, v143
v_exp_f32 v144, v144
v_exp_f32 v145, v145
v_exp_f32 v150, v150
v_exp_f32 v146, v146
v_exp_f32 v147, v147
v_exp_f32 v148, v148
v_exp_f32 v149, v149
v_cvt_pk_bf16_f32 v174, v138, v139
v_cvt_pk_bf16_f32 v175, v140, v141
v_cvt_pk_bf16_f32 v176, v142, v143
v_cvt_pk_bf16_f32 v177, v144, v145
v_cvt_pk_bf16_f32 v178, v146, v147
v_cvt_pk_bf16_f32 v179, v148, v149
v_cvt_pk_bf16_f32 v180, v150, 0
v_mfma_f32_16x16x32_bf16 v[150:153], v[190:193], v[174:177], 0
v_mfma_f32_16x16x32_bf16 v[150:153], v[190:193], v[178:181], v[150:153]
v_mfma_f32_16x16x32_bf16 v[138:141], v[114:117], v[174:177], 0
v_mfma_f32_16x16x32_bf16 v[138:141], v[118:121], v[178:181], v[138:141]
v_mfma_f32_16x16x32_bf16 v[142:145], v[122:125], v[174:177], 0
v_mfma_f32_16x16x32_bf16 v[142:145], v[126:129], v[178:181], v[142:145]
v_mfma_f32_16x16x32_bf16 v[146:149], v[130:133], v[174:177], 0
v_mfma_f32_16x16x32_bf16 v[146:149], v[134:137], v[178:181], v[146:149]
v_rcp_f32 v151, v150
s_nop 0
v_mul_f32 v152, s3, v151
v_mul_f32 v138, v138, v152
v_mul_f32 v139, v139, v152
v_cvt_pk_bf16_f32 v138, v138, v139
v_mul_f32 v140, v140, v152
v_mul_f32 v141, v141, v152
v_cvt_pk_bf16_f32 v139, v140, v141
v_mul_f32 v142, v142, v152
v_mul_f32 v143, v143, v152
v_cvt_pk_bf16_f32 v140, v142, v143
v_mul_f32 v144, v144, v152
v_mul_f32 v145, v145, v152
v_cvt_pk_bf16_f32 v141, v144, v145
ds_write_b128 v211, v[138:141] offset:51200
v_mul_f32 v146, v146, v152
v_mul_f32 v147, v147, v152
v_cvt_pk_bf16_f32 v142, v146, v147
v_mul_f32 v148, v148, v152
v_mul_f32 v149, v149, v152
v_cvt_pk_bf16_f32 v143, v148, v149
ds_write_b64 v212, v[142:143] offset:51200
v_mfma_f32_16x16x32_bf16 v[166:169], v[84:87], v[190:193], 0
v_mfma_f32_16x16x32_bf16 v[166:169], v[88:91], v[190:193], v[166:169]
v_mfma_f32_16x16x32_bf16 v[154:157], v[84:87], v[114:117], 0
v_mfma_f32_16x16x32_bf16 v[154:157], v[88:91], v[118:121], v[154:157]
v_mfma_f32_16x16x32_bf16 v[158:161], v[84:87], v[122:125], 0
v_mfma_f32_16x16x32_bf16 v[158:161], v[88:91], v[126:129], v[158:161]
v_mfma_f32_16x16x32_bf16 v[162:165], v[84:87], v[130:133], 0
v_mfma_f32_16x16x32_bf16 v[162:165], v[88:91], v[134:137], v[162:165]
v_rcp_f32 v167, v166
v_mov_b32_dpp v154, v158 quad_perm:[0,1,2,3] row_mask:0x2 bank_mask:0xf
s_nop 3
v_mov_b32_dpp v154, v162 quad_perm:[0,1,2,3] row_mask:0x4 bank_mask:0xf
v_mul_f32 v168, s3, v167
v_mul_f32 v154, v154, v168
v_cvt_pk_bf16_f32 v154, v154, 0
ds_write_b16 v214, v154
v_add_u32 v214, 1424, v214
ds_read_b128 v[110:113], v210 offset:45056
ds_read_b128 v[170:173], v210 offset:46080
s_waitcnt lgkmcnt(1)
v_mfma_f32_16x16x32_bf16 v[12:15], a[144:147], v[110:113], v[12:15]
s_waitcnt lgkmcnt(0)
v_mfma_f32_16x16x32_bf16 v[12:15], a[148:151], v[170:173], v[12:15]
v_mfma_f32_16x16x32_bf16 v[16:19], a[168:171], v[110:113], v[16:19]
v_mfma_f32_16x16x32_bf16 v[16:19], a[172:175], v[170:173], v[16:19]
v_mfma_f32_16x16x32_bf16 v[20:23], a[192:195], v[110:113], v[20:23]
v_mfma_f32_16x16x32_bf16 v[20:23], a[196:199], v[170:173], v[20:23]
ds_read_b128 v[182:185], v210 offset:47104
ds_read_b128 v[186:189], v210 offset:48128
s_waitcnt lgkmcnt(1)
v_mfma_f32_16x16x32_bf16 v[12:15], a[152:155], v[182:185], v[12:15]
s_waitcnt lgkmcnt(0)
v_mfma_f32_16x16x32_bf16 v[12:15], a[156:159], v[186:189], v[12:15]
v_mfma_f32_16x16x32_bf16 v[16:19], a[176:179], v[182:185], v[16:19]
v_mfma_f32_16x16x32_bf16 v[16:19], a[180:183], v[186:189], v[16:19]
v_mfma_f32_16x16x32_bf16 v[20:23], a[200:203], v[182:185], v[20:23]
v_mfma_f32_16x16x32_bf16 v[20:23], a[204:207], v[186:189], v[20:23]
ds_read_b128 v[220:223], v210 offset:49152
ds_read_b128 v[110:113], v210 offset:50176
s_waitcnt lgkmcnt(1)
v_mfma_f32_16x16x32_bf16 v[12:15], a[160:163], v[220:223], v[12:15]
s_waitcnt lgkmcnt(0)
v_mfma_f32_16x16x32_bf16 v[12:15], a[164:167], v[110:113], v[12:15]
v_mfma_f32_16x16x32_bf16 v[16:19], a[184:187], v[220:223], v[16:19]
v_mfma_f32_16x16x32_bf16 v[16:19], a[188:191], v[110:113], v[16:19]
v_mfma_f32_16x16x32_bf16 v[20:23], a[208:211], v[220:223], v[20:23]
v_mfma_f32_16x16x32_bf16 v[20:23], a[212:215], v[110:113], v[20:23]
v_cvt_pk_bf16_f32 v12, v12, v13
v_cvt_pk_bf16_f32 v13, v14, v15
ds_write_b64 v203, v[12:13] offset:6272
v_cvt_pk_bf16_f32 v16, v16, v17
v_cvt_pk_bf16_f32 v17, v18, v19
ds_write_b64 v203, v[16:17] offset:6304
v_cvt_pk_bf16_f32 v20, v20, v21
v_cvt_pk_bf16_f32 v21, v22, v23
ds_write_b64 v203, v[20:21] offset:6336
s_mov_b32 s46, 7
.p2align 6
G_loop:
s_waitcnt vmcnt(0)
s_barrier
ds_read_b64 v[120:121], v204
s_add_u32 s28, s38, s60
s_waitcnt lgkmcnt(0)
buffer_store_dwordx2 v[120:121], v204, s[8:11], s28 offen sc1
ds_read_b64 v[128:129], v204 offset:392
s_add_u32 s29, s38, s61
s_waitcnt lgkmcnt(0)
buffer_store_dwordx2 v[128:129], v204, s[8:11], s29 offen sc1
ds_read_b64 v[136:137], v204 offset:784
s_add_u32 s28, s38, s62
s_waitcnt lgkmcnt(0)
buffer_store_dwordx2 v[136:137], v204, s[8:11], s28 offen sc1
ds_read_b64 v[120:121], v204 offset:1176
s_add_u32 s29, s38, s63
s_waitcnt lgkmcnt(0)
buffer_store_dwordx2 v[120:121], v204, s[8:11], s29 offen sc1
ds_read_b128 v[170:173], v210 offset:51200
ds_read_b128 v[182:185], v210 offset:52224
s_waitcnt lgkmcnt(1)
v_mfma_f32_16x16x32_bf16 v[24:27], a[144:147], v[170:173], v[24:27]
s_waitcnt lgkmcnt(0)
v_mfma_f32_16x16x32_bf16 v[24:27], a[148:151], v[182:185], v[24:27]
v_mfma_f32_16x16x32_bf16 v[28:31], a[168:171], v[170:173], v[28:31]
v_mfma_f32_16x16x32_bf16 v[28:31], a[172:175], v[182:185], v[28:31]
v_mfma_f32_16x16x32_bf16 v[32:35], a[192:195], v[170:173], v[32:35]
v_mfma_f32_16x16x32_bf16 v[32:35], a[196:199], v[182:185], v[32:35]
ds_read_b128 v[186:189], v210 offset:53248
ds_read_b128 v[220:223], v210 offset:54272
s_waitcnt lgkmcnt(1)
v_mfma_f32_16x16x32_bf16 v[24:27], a[152:155], v[186:189], v[24:27]
s_waitcnt lgkmcnt(0)
v_mfma_f32_16x16x32_bf16 v[24:27], a[156:159], v[220:223], v[24:27]
v_mfma_f32_16x16x32_bf16 v[28:31], a[176:179], v[186:189], v[28:31]
v_mfma_f32_16x16x32_bf16 v[28:31], a[180:183], v[220:223], v[28:31]
v_mfma_f32_16x16x32_bf16 v[32:35], a[200:203], v[186:189], v[32:35]
v_mfma_f32_16x16x32_bf16 v[32:35], a[204:207], v[220:223], v[32:35]
ds_read_b128 v[110:113], v210 offset:55296
ds_read_b128 v[170:173], v210 offset:56320
s_waitcnt lgkmcnt(1)
v_mfma_f32_16x16x32_bf16 v[24:27], a[160:163], v[110:113], v[24:27]
s_waitcnt lgkmcnt(0)
v_mfma_f32_16x16x32_bf16 v[24:27], a[164:167], v[170:173], v[24:27]
v_mfma_f32_16x16x32_bf16 v[28:31], a[184:187], v[110:113], v[28:31]
v_mfma_f32_16x16x32_bf16 v[28:31], a[188:191], v[170:173], v[28:31]
v_mfma_f32_16x16x32_bf16 v[32:35], a[208:211], v[110:113], v[32:35]
v_mfma_f32_16x16x32_bf16 v[32:35], a[212:215], v[170:173], v[32:35]
v_cvt_pk_bf16_f32 v24, v24, v25
v_cvt_pk_bf16_f32 v25, v26, v27
ds_write_b64 v203, v[24:25] offset:12544
v_cvt_pk_bf16_f32 v28, v28, v29
v_cvt_pk_bf16_f32 v29, v30, v31
ds_write_b64 v203, v[28:29] offset:12576
v_cvt_pk_bf16_f32 v32, v32, v33
v_cvt_pk_bf16_f32 v33, v34, v35
ds_write_b64 v203, v[32:33] offset:12608
s_mov_b32 s39, s37
ds_read_b128 v[174:177], v217
ds_read_b128 v[84:87], v200
s_waitcnt lgkmcnt(0)
v_mfma_f32_16x16x32_bf16 v[0:3], v[174:177], v[84:87], 0
ds_read_b128 v[92:95], v201
s_waitcnt lgkmcnt(0)
v_mfma_f32_16x16x32_bf16 v[12:15], v[174:177], v[92:95], 0
ds_read_b128 v[100:103], v202
s_waitcnt lgkmcnt(0)
v_mfma_f32_16x16x32_bf16 v[24:27], v[174:177], v[100:103], 0
ds_read_b128 v[178:181], v217 offset:528
ds_read_b128 v[84:87], v194
ds_read_b128 v[88:91], v194 offset:16
s_waitcnt lgkmcnt(0)
v_smfmac_f32_16x16x64_bf16 v[0:3], v[178:181], v[84:91], v213
ds_read_b128 v[92:95], v195
ds_read_b128 v[96:99], v195 offset:16
s_waitcnt lgkmcnt(0)
v_smfmac_f32_16x16x64_bf16 v[12:15], v[178:181], v[92:99], v213
ds_read_b128 v[100:103], v196
ds_read_b128 v[104:107], v196 offset:16
s_waitcnt lgkmcnt(0)
v_smfmac_f32_16x16x64_bf16 v[24:27], v[178:181], v[100:107], v213
ds_read_b128 v[174:177], v217 offset:1056
ds_read_b128 v[84:87], v197
ds_read_b128 v[88:91], v197 offset:16
s_waitcnt lgkmcnt(0)
v_smfmac_f32_16x16x64_bf16 v[0:3], v[174:177], v[84:91], v213
ds_read_b128 v[92:95], v198
ds_read_b128 v[96:99], v198 offset:16
s_waitcnt lgkmcnt(0)
v_smfmac_f32_16x16x64_bf16 v[12:15], v[174:177], v[92:99], v213
ds_read_b128 v[100:103], v199
ds_read_b128 v[104:107], v199 offset:16
s_waitcnt lgkmcnt(0)
v_smfmac_f32_16x16x64_bf16 v[24:27], v[174:177], v[100:107], v213
ds_read_b128 v[178:181], v217 offset:1584
ds_read_b128 v[84:87], v200 offset:32
s_waitcnt lgkmcnt(0)
v_mfma_f32_16x16x32_bf16 v[4:7], v[178:181], v[84:87], 0
ds_read_b128 v[92:95], v201 offset:32
s_waitcnt lgkmcnt(0)
v_mfma_f32_16x16x32_bf16 v[16:19], v[178:181], v[92:95], 0
ds_read_b128 v[100:103], v202 offset:32
s_waitcnt lgkmcnt(0)
v_mfma_f32_16x16x32_bf16 v[28:31], v[178:181], v[100:103], 0
ds_read_b128 v[174:177], v217 offset:2112
ds_read_b128 v[84:87], v194 offset:32
ds_read_b128 v[88:91], v194 offset:48
s_waitcnt lgkmcnt(0)
v_smfmac_f32_16x16x64_bf16 v[4:7], v[174:177], v[84:91], v213
ds_read_b128 v[92:95], v195 offset:32
ds_read_b128 v[96:99], v195 offset:48
s_waitcnt lgkmcnt(0)
v_smfmac_f32_16x16x64_bf16 v[16:19], v[174:177], v[92:99], v213
ds_read_b128 v[100:103], v196 offset:32
ds_read_b128 v[104:107], v196 offset:48
s_waitcnt lgkmcnt(0)
v_smfmac_f32_16x16x64_bf16 v[28:31], v[174:177], v[100:107], v213
ds_read_b128 v[178:181], v217 offset:2640
ds_read_b128 v[84:87], v197 offset:32
ds_read_b128 v[88:91], v197 offset:48
s_waitcnt lgkmcnt(0)
v_smfmac_f32_16x16x64_bf16 v[4:7], v[178:181], v[84:91], v213
ds_read_b128 v[92:95], v198 offset:32
ds_read_b128 v[96:99], v198 offset:48
s_waitcnt lgkmcnt(0)
v_smfmac_f32_16x16x64_bf16 v[16:19], v[178:181], v[92:99], v213
ds_read_b128 v[100:103], v199 offset:32
ds_read_b128 v[104:107], v199 offset:48
s_waitcnt lgkmcnt(0)
v_smfmac_f32_16x16x64_bf16 v[28:31], v[178:181], v[100:107], v213
ds_read_b128 v[174:177], v217 offset:3168
ds_read_b128 v[84:87], v200 offset:64
s_waitcnt lgkmcnt(0)
v_mfma_f32_16x16x32_bf16 v[8:11], v[174:177], v[84:87], 0
ds_read_b128 v[92:95], v201 offset:64
s_waitcnt lgkmcnt(0)
v_mfma_f32_16x16x32_bf16 v[20:23], v[174:177], v[92:95], 0
ds_read_b128 v[100:103], v202 offset:64
s_waitcnt lgkmcnt(0)
v_mfma_f32_16x16x32_bf16 v[32:35], v[174:177], v[100:103], 0
ds_read_b128 v[178:181], v217 offset:3696
ds_read_b128 v[84:87], v194 offset:64
ds_read_b128 v[88:91], v194 offset:80
s_waitcnt lgkmcnt(0)
v_smfmac_f32_16x16x64_bf16 v[8:11], v[178:181], v[84:91], v213
ds_read_b128 v[92:95], v195 offset:64
ds_read_b128 v[96:99], v195 offset:80
s_waitcnt lgkmcnt(0)
v_smfmac_f32_16x16x64_bf16 v[20:23], v[178:181], v[92:99], v213
ds_read_b128 v[100:103], v196 offset:64
ds_read_b128 v[104:107], v196 offset:80
s_waitcnt lgkmcnt(0)
v_smfmac_f32_16x16x64_bf16 v[32:35], v[178:181], v[100:107], v213
ds_read_b128 v[174:177], v217 offset:4224
ds_read_b128 v[84:87], v197 offset:64
ds_read_b128 v[88:91], v197 offset:80
s_waitcnt lgkmcnt(0)
v_smfmac_f32_16x16x64_bf16 v[8:11], v[174:177], v[84:91], v213
ds_read_b128 v[92:95], v198 offset:64
ds_read_b128 v[96:99], v198 offset:80
s_waitcnt lgkmcnt(0)
v_smfmac_f32_16x16x64_bf16 v[20:23], v[174:177], v[92:99], v213
ds_read_b128 v[100:103], v199 offset:64
ds_read_b128 v[104:107], v199 offset:80
s_waitcnt lgkmcnt(0)
v_smfmac_f32_16x16x64_bf16 v[32:35], v[174:177], v[100:107], v213
v_add_f32 v118, v0, v1
v_mul_f32 v119, v0, v0
v_add_f32 v118, v118, v2
v_fmac_f32 v119, v1, v1
v_add_f32 v118, v118, v3
v_fmac_f32 v119, v2, v2
v_fmac_f32 v119, v3, v3
v_add_f32 v126, v12, v13
v_mul_f32 v127, v12, v12
v_add_f32 v126, v126, v14
v_fmac_f32 v127, v13, v13
v_add_f32 v126, v126, v15
v_fmac_f32 v127, v14, v14
v_fmac_f32 v127, v15, v15
v_add_f32 v134, v24, v25
v_mul_f32 v135, v24, v24
v_add_f32 v134, v134, v26
v_fmac_f32 v135, v25, v25
v_add_f32 v134, v134, v27
v_fmac_f32 v135, v26, v26
v_fmac_f32 v135, v27, v27
v_add_f32 v118, v118, v4
v_fmac_f32 v119, v4, v4
v_add_f32 v118, v118, v5
v_fmac_f32 v119, v5, v5
v_add_f32 v118, v118, v6
v_fmac_f32 v119, v6, v6
v_add_f32 v118, v118, v7
v_fmac_f32 v119, v7, v7
v_add_f32 v126, v126, v16
v_fmac_f32 v127, v16, v16
v_add_f32 v126, v126, v17
v_fmac_f32 v127, v17, v17
v_add_f32 v126, v126, v18
v_fmac_f32 v127, v18, v18
v_add_f32 v126, v126, v19
v_fmac_f32 v127, v19, v19
v_add_f32 v134, v134, v28
v_fmac_f32 v135, v28, v28
v_add_f32 v134, v134, v29
v_fmac_f32 v135, v29, v29
v_add_f32 v134, v134, v30
v_fmac_f32 v135, v30, v30
v_add_f32 v134, v134, v31
v_fmac_f32 v135, v31, v31
v_add_f32 v118, v118, v8
v_fmac_f32 v119, v8, v8
v_add_f32 v118, v118, v9
v_fmac_f32 v119, v9, v9
v_add_f32 v118, v118, v10
v_fmac_f32 v119, v10, v10
v_add_f32 v118, v118, v11
v_fmac_f32 v119, v11, v11
v_add_f32 v126, v126, v20
v_fmac_f32 v127, v20, v20
v_add_f32 v126, v126, v21
v_fmac_f32 v127, v21, v21
v_add_f32 v126, v126, v22
v_fmac_f32 v127, v22, v22
v_add_f32 v126, v126, v23
v_fmac_f32 v127, v23, v23
v_add_f32 v134, v134, v32
v_fmac_f32 v135, v32, v32
v_add_f32 v134, v134, v33
v_fmac_f32 v135, v33, v33
v_add_f32 v134, v134, v34
v_fmac_f32 v135, v34, v34
v_add_f32 v134, v134, v35
v_fmac_f32 v135, v35, v35
v_permlane16_swap_b32 v118, v119
v_add_f32 v118, v118, v119
v_permlane16_swap_b32 v126, v127
v_add_f32 v126, v126, v127
v_permlane16_swap_b32 v134, v135
v_add_f32 v134, v134, v135
v_permlane32_swap_b32 v118, v126
v_add_f32 v118, v118, v126
ds_write_b32 v209, v118
v_mov_b32 v135, v134
s_nop 1
v_permlane32_swap_b32 v134, v135
v_add_f32 v134, v134, v135
ds_write_b32 v209, v134 offset:512
s_waitcnt lgkmcnt(0)
s_barrier
ds_read_b64 v[128:129], v204 offset:6272
s_add_u32 s28, s38, s64
s_waitcnt lgkmcnt(0)
buffer_store_dwordx2 v[128:129], v204, s[8:11], s28 offen sc1
ds_read_b64 v[136:137], v204 offset:6664
s_add_u32 s29, s38, s65
s_waitcnt lgkmcnt(0)
buffer_store_dwordx2 v[136:137], v204, s[8:11], s29 offen sc1
ds_read_b64 v[120:121], v204 offset:7056
s_add_u32 s28, s38, s66
s_waitcnt lgkmcnt(0)
buffer_store_dwordx2 v[120:121], v204, s[8:11], s28 offen sc1
ds_read_b64 v[128:129], v204 offset:7448
s_add_u32 s29, s38, s67
s_waitcnt lgkmcnt(0)
buffer_store_dwordx2 v[128:129], v204, s[8:11], s29 offen sc1
ds_read_b64 v[136:137], v204 offset:12544
s_add_u32 s28, s38, s68
s_waitcnt lgkmcnt(0)
buffer_store_dwordx2 v[136:137], v204, s[8:11], s28 offen sc1
ds_read_b64 v[120:121], v204 offset:12936
s_add_u32 s29, s38, s69
s_waitcnt lgkmcnt(0)
buffer_store_dwordx2 v[120:121], v204, s[8:11], s29 offen sc1
ds_read_b64 v[128:129], v204 offset:13328
s_add_u32 s28, s38, s70
s_waitcnt lgkmcnt(0)
buffer_store_dwordx2 v[128:129], v204, s[8:11], s28 offen sc1
ds_read_b64 v[136:137], v204 offset:13720
s_add_u32 s29, s38, s71
s_waitcnt lgkmcnt(0)
buffer_store_dwordx2 v[136:137], v204, s[8:11], s29 offen sc1
s_mul_hi_u32 s41, s35, 58835169
s_mul_i32 s42, s41, 73
s_sub_u32 s42, s35, s42
s_mul_i32 s43, s41, 1373568
s_mul_i32 s51, s42, 2688
s_add_u32 s50, s43, s51
s_add_u32 s35, s35, 32
s_min_u32 s41, s41, 1
s_sub_u32 s41, 1, s41
s_lshl_b32 s41, s41, 30
s_add_u32 s52, s50, s41
s_min_u32 s43, s42, 1
s_lshl_b32 s43, s43, 27
s_sub_u32 s43, 536870911, s43
s_add_u32 s51, s42, 56
s_and_b32 s51, s51, 128
s_lshl_b32 s51, s51, 22
s_or_b32 s44, s43, s51
s_mov_b32 s37, s50
v_and_b32 v216, s44, v208
s_add_u32 m0, s45, 0
s_nop 0
buffer_load_dwordx4 v216, s[4:7], s52 offen nt lds
s_add_u32 m0, s45, 4112
s_add_u32 s40, s37, 196224
buffer_load_dwordx4 v216, s[4:7], s40 offen nt lds
s_add_u32 m0, s45, 8224
s_add_u32 s40, s37, 392448
buffer_load_dwordx4 v216, s[4:7], s40 offen nt lds
s_add_u32 m0, s45, 12336
s_add_u32 s40, s37, 588672
buffer_load_dwordx4 v216, s[4:7], s40 offen nt lds
s_add_u32 m0, s45, 16448
s_add_u32 s40, s37, 784896
buffer_load_dwordx4 v216, s[4:7], s40 offen nt lds
s_add_u32 m0, s45, 20560
s_add_u32 s40, s37, 981120
buffer_load_dwordx4 v216, s[4:7], s40 offen nt lds
s_add_u32 m0, s45, 24672
s_add_u32 s40, s37, 1177344
buffer_load_dwordx4 v216, s[4:7], s40 offen nt lds
s_add_u32 m0, s45, 28784
s_add_u32 s40, s37, 1373568
buffer_load_dwordx4 v216, s[4:7], s40 offen nt lds
s_add_u32 m0, s45, 32896
s_add_u32 s40, s37, 1569792
buffer_load_dwordx4 v216, s[4:7], s40 offen nt lds
ds_read_b128 v[182:185], v210 offset:20480
ds_read_b128 v[186:189], v210 offset:21504
s_waitcnt lgkmcnt(1)
v_mfma_f32_16x16x32_bf16 v[138:141], a[0:3], v[182:185], 0
s_waitcnt lgkmcnt(0)
v_mfma_f32_16x16x32_bf16 v[138:141], a[4:7], v[186:189], v[138:141]
v_mfma_f32_16x16x32_bf16 v[142:145], a[24:27], v[182:185], 0
v_mfma_f32_16x16x32_bf16 v[142:145], a[28:31], v[186:189], v[142:145]
v_mfma_f32_16x16x32_bf16 v[146:149], a[48:51], v[182:185], 0
v_mfma_f32_16x16x32_bf16 v[146:149], a[52:55], v[186:189], v[146:149]
v_mfma_f32_16x16x32_bf16 v[150:153], a[216:219], v[182:185], 0
v_mfma_f32_16x16x32_bf16 v[150:153], a[220:223], v[186:189], v[150:153]
v_mfma_f32_16x16x32_bf16 v[154:157], a[240:243], v[182:185], 0
v_mfma_f32_16x16x32_bf16 v[154:157], a[244:247], v[186:189], v[154:157]
v_mfma_f32_16x16x32_bf16 v[158:161], v[232:235], v[182:185], 0
v_mfma_f32_16x16x32_bf16 v[158:161], v[236:239], v[186:189], v[158:161]
v_mfma_f32_16x16x32_bf16 v[162:165], v[182:185], a[72:75], 0
v_mfma_f32_16x16x32_bf16 v[162:165], v[186:189], a[76:79], v[162:165]
v_mfma_f32_16x16x32_bf16 v[166:169], v[182:185], a[96:99], 0
v_mfma_f32_16x16x32_bf16 v[166:169], v[186:189], a[100:103], v[166:169]
v_mfma_f32_16x16x32_bf16 v[170:173], v[182:185], a[120:123], 0
v_mfma_f32_16x16x32_bf16 v[170:173], v[186:189], a[124:127], v[170:173]
ds_read_b128 v[110:113], v210 offset:22528
ds_read_b128 v[220:223], v210 offset:23552
s_waitcnt lgkmcnt(1)
v_mfma_f32_16x16x32_bf16 v[138:141], a[8:11], v[110:113], v[138:141]
s_waitcnt lgkmcnt(0)
v_mfma_f32_16x16x32_bf16 v[138:141], a[12:15], v[220:223], v[138:141]
v_mfma_f32_16x16x32_bf16 v[142:145], a[32:35], v[110:113], v[142:145]
v_mfma_f32_16x16x32_bf16 v[142:145], a[36:39], v[220:223], v[142:145]
v_mfma_f32_16x16x32_bf16 v[146:149], a[56:59], v[110:113], v[146:149]
v_mfma_f32_16x16x32_bf16 v[146:149], a[60:63], v[220:223], v[146:149]
v_mfma_f32_16x16x32_bf16 v[150:153], a[224:227], v[110:113], v[150:153]
v_mfma_f32_16x16x32_bf16 v[150:153], a[228:231], v[220:223], v[150:153]
v_mfma_f32_16x16x32_bf16 v[154:157], a[248:251], v[110:113], v[154:157]
v_mfma_f32_16x16x32_bf16 v[154:157], a[252:255], v[220:223], v[154:157]
v_mfma_f32_16x16x32_bf16 v[158:161], v[240:243], v[110:113], v[158:161]
v_mfma_f32_16x16x32_bf16 v[158:161], v[244:247], v[220:223], v[158:161]
v_mfma_f32_16x16x32_bf16 v[162:165], v[110:113], a[80:83], v[162:165]
v_mfma_f32_16x16x32_bf16 v[162:165], v[220:223], a[84:87], v[162:165]
v_mfma_f32_16x16x32_bf16 v[166:169], v[110:113], a[104:107], v[166:169]
v_mfma_f32_16x16x32_bf16 v[166:169], v[220:223], a[108:111], v[166:169]
v_mfma_f32_16x16x32_bf16 v[170:173], v[110:113], a[128:131], v[170:173]
v_mfma_f32_16x16x32_bf16 v[170:173], v[220:223], a[132:135], v[170:173]
ds_read_b128 v[182:185], v210 offset:24576
ds_read_b128 v[186:189], v210 offset:25600
s_waitcnt lgkmcnt(1)
v_mfma_f32_16x16x32_bf16 v[138:141], a[16:19], v[182:185], v[138:141]
s_waitcnt lgkmcnt(0)
v_mfma_f32_16x16x32_bf16 v[138:141], a[20:23], v[186:189], v[138:141]
v_mfma_f32_16x16x32_bf16 v[142:145], a[40:43], v[182:185], v[142:145]
v_mfma_f32_16x16x32_bf16 v[142:145], a[44:47], v[186:189], v[142:145]
v_mfma_f32_16x16x32_bf16 v[146:149], a[64:67], v[182:185], v[146:149]
v_mfma_f32_16x16x32_bf16 v[146:149], a[68:71], v[186:189], v[146:149]
v_mfma_f32_16x16x32_bf16 v[150:153], a[232:235], v[182:185], v[150:153]
v_mfma_f32_16x16x32_bf16 v[150:153], a[236:239], v[186:189], v[150:153]
v_mfma_f32_16x16x32_bf16 v[154:157], v[224:227], v[182:185], v[154:157]
v_mfma_f32_16x16x32_bf16 v[154:157], v[228:231], v[186:189], v[154:157]
v_mfma_f32_16x16x32_bf16 v[158:161], v[248:251], v[182:185], v[158:161]
v_mfma_f32_16x16x32_bf16 v[158:161], v[252:255], v[186:189], v[158:161]
v_mfma_f32_16x16x32_bf16 v[162:165], v[182:185], a[88:91], v[162:165]
v_mfma_f32_16x16x32_bf16 v[162:165], v[186:189], a[92:95], v[162:165]
v_mfma_f32_16x16x32_bf16 v[166:169], v[182:185], a[112:115], v[166:169]
v_mfma_f32_16x16x32_bf16 v[166:169], v[186:189], a[116:119], v[166:169]
v_mfma_f32_16x16x32_bf16 v[170:173], v[182:185], a[136:139], v[170:173]
v_mfma_f32_16x16x32_bf16 v[170:173], v[186:189], a[140:143], v[170:173]
v_cvt_pk_bf16_f32 v78, v138, v139
v_cvt_pk_bf16_f32 v79, v140, v141
v_cvt_pk_bf16_f32 v80, v142, v143
v_cvt_pk_bf16_f32 v81, v144, v145
v_cvt_pk_bf16_f32 v82, v146, v147
v_cvt_pk_bf16_f32 v83, v148, v149
v_cvt_pk_bf16_f32 v72, v150, v151
v_cvt_pk_bf16_f32 v73, v152, v153
v_cvt_pk_bf16_f32 v74, v154, v155
v_cvt_pk_bf16_f32 v75, v156, v157
v_cvt_pk_bf16_f32 v76, v158, v159
v_cvt_pk_bf16_f32 v77, v160, v161
v_cvt_pk_bf16_f32 v114, v162, v163
v_cvt_pk_bf16_f32 v115, v164, v165
v_cvt_pk_bf16_f32 v122, v166, v167
v_cvt_pk_bf16_f32 v123, v168, v169
v_cvt_pk_bf16_f32 v130, v170, v171
v_cvt_pk_bf16_f32 v131, v172, v173
ds_read_b128 v[110:113], v210 offset:26624
ds_read_b128 v[220:223], v210 offset:27648
s_waitcnt lgkmcnt(1)
v_mfma_f32_16x16x32_bf16 v[138:141], a[0:3], v[110:113], 0
s_waitcnt lgkmcnt(0)
v_mfma_f32_16x16x32_bf16 v[138:141], a[4:7], v[220:223], v[138:141]
v_mfma_f32_16x16x32_bf16 v[142:145], a[24:27], v[110:113], 0
v_mfma_f32_16x16x32_bf16 v[142:145], a[28:31], v[220:223], v[142:145]
v_mfma_f32_16x16x32_bf16 v[146:149], a[48:51], v[110:113], 0
v_mfma_f32_16x16x32_bf16 v[146:149], a[52:55], v[220:223], v[146:149]
v_mfma_f32_16x16x32_bf16 v[150:153], a[216:219], v[110:113], 0
v_mfma_f32_16x16x32_bf16 v[150:153], a[220:223], v[220:223], v[150:153]
v_mfma_f32_16x16x32_bf16 v[154:157], a[240:243], v[110:113], 0
v_mfma_f32_16x16x32_bf16 v[154:157], a[244:247], v[220:223], v[154:157]
v_mfma_f32_16x16x32_bf16 v[158:161], v[232:235], v[110:113], 0
v_mfma_f32_16x16x32_bf16 v[158:161], v[236:239], v[220:223], v[158:161]
v_mfma_f32_16x16x32_bf16 v[162:165], v[110:113], a[72:75], 0
v_mfma_f32_16x16x32_bf16 v[162:165], v[220:223], a[76:79], v[162:165]
v_mfma_f32_16x16x32_bf16 v[166:169], v[110:113], a[96:99], 0
v_mfma_f32_16x16x32_bf16 v[166:169], v[220:223], a[100:103], v[166:169]
v_mfma_f32_16x16x32_bf16 v[170:173], v[110:113], a[120:123], 0
v_mfma_f32_16x16x32_bf16 v[170:173], v[220:223], a[124:127], v[170:173]
ds_read_b128 v[102:105], v210 offset:18432
ds_read_b128 v[106:109], v210 offset:19456
s_waitcnt lgkmcnt(1)
v_add_f32 v102, v102, v103
s_waitcnt lgkmcnt(0)
v_add_f32 v106, v106, v107
v_add_f32 v104, v104, v105
v_add_f32 v108, v108, v109
v_add_f32 v102, v102, v104
v_add_f32 v106, v106, v108
v_mul_f32 v103, s48, v102
v_mul_f32 v104, s73, v102
v_mul_f32 v106, s73, v106
v_fma_f32 v106, -v103, v104, v106
v_max_f32 v106, 0, v106
v_add_f32 v106, s49, v106
v_rsq_f32 v102, v106
s_nop 0
v_mul_f32_e64 v103, -v103, v102
ds_write_b64 v211, v[102:103]
ds_read_b64 v[118:119], v219
ds_read_b64 v[126:127], v219 offset:256
ds_read_b64 v[134:135], v219 offset:512
s_waitcnt lgkmcnt(2)
v_fma_f32 v220, v0, v118, v119
v_fma_f32 v221, v1, v118, v119
v_cvt_pk_bf16_f32 v90, v220, v221
v_fma_f32 v222, v2, v118, v119
v_fma_f32 v223, v3, v118, v119
v_cvt_pk_bf16_f32 v91, v222, v223
v_fma_f32 v220, v4, v118, v119
v_fma_f32 v221, v5, v118, v119
v_cvt_pk_bf16_f32 v92, v220, v221
v_fma_f32 v222, v6, v118, v119
v_fma_f32 v223, v7, v118, v119
v_cvt_pk_bf16_f32 v93, v222, v223
ds_write_b128 v211, v[90:93]
v_fma_f32 v220, v8, v118, v119
v_fma_f32 v221, v9, v118, v119
v_cvt_pk_bf16_f32 v94, v220, v221
v_fma_f32 v222, v10, v118, v119
v_fma_f32 v223, v11, v118, v119
v_cvt_pk_bf16_f32 v95, v222, v223
s_waitcnt lgkmcnt(2)
ds_write_b64 v212, v[94:95]
v_fma_f32 v220, v12, v126, v127
v_fma_f32 v221, v13, v126, v127
v_cvt_pk_bf16_f32 v174, v220, v221
v_fma_f32 v222, v14, v126, v127
v_fma_f32 v223, v15, v126, v127
v_cvt_pk_bf16_f32 v175, v222, v223
v_fma_f32 v220, v16, v126, v127
v_fma_f32 v221, v17, v126, v127
v_cvt_pk_bf16_f32 v176, v220, v221
v_fma_f32 v222, v18, v126, v127
v_fma_f32 v223, v19, v126, v127
v_cvt_pk_bf16_f32 v177, v222, v223
ds_write_b128 v211, v[174:177] offset:6144
v_fma_f32 v220, v20, v126, v127
v_fma_f32 v221, v21, v126, v127
v_cvt_pk_bf16_f32 v178, v220, v221
v_fma_f32 v222, v22, v126, v127
v_fma_f32 v223, v23, v126, v127
v_cvt_pk_bf16_f32 v179, v222, v223
s_waitcnt lgkmcnt(3)
ds_write_b64 v212, v[178:179] offset:6144
v_fma_f32 v220, v24, v134, v135
v_fma_f32 v221, v25, v134, v135
v_cvt_pk_bf16_f32 v90, v220, v221
v_fma_f32 v222, v26, v134, v135
v_fma_f32 v223, v27, v134, v135
v_cvt_pk_bf16_f32 v91, v222, v223
v_fma_f32 v220, v28, v134, v135
v_fma_f32 v221, v29, v134, v135
v_cvt_pk_bf16_f32 v92, v220, v221
v_fma_f32 v222, v30, v134, v135
v_fma_f32 v223, v31, v134, v135
v_cvt_pk_bf16_f32 v93, v222, v223
ds_write_b128 v211, v[90:93] offset:12288
v_fma_f32 v220, v32, v134, v135
v_fma_f32 v221, v33, v134, v135
v_cvt_pk_bf16_f32 v94, v220, v221
v_fma_f32 v222, v34, v134, v135
v_fma_f32 v223, v35, v134, v135
v_cvt_pk_bf16_f32 v95, v222, v223
ds_write_b64 v212, v[94:95] offset:12288
ds_read_b128 v[182:185], v210 offset:28672
ds_read_b128 v[186:189], v210 offset:29696
s_waitcnt lgkmcnt(1)
v_mfma_f32_16x16x32_bf16 v[138:141], a[8:11], v[182:185], v[138:141]
s_waitcnt lgkmcnt(0)
v_mfma_f32_16x16x32_bf16 v[138:141], a[12:15], v[186:189], v[138:141]
v_mfma_f32_16x16x32_bf16 v[142:145], a[32:35], v[182:185], v[142:145]
v_mfma_f32_16x16x32_bf16 v[142:145], a[36:39], v[186:189], v[142:145]
v_mfma_f32_16x16x32_bf16 v[146:149], a[56:59], v[182:185], v[146:149]
v_mfma_f32_16x16x32_bf16 v[146:149], a[60:63], v[186:189], v[146:149]
v_mfma_f32_16x16x32_bf16 v[150:153], a[224:227], v[182:185], v[150:153]
v_mfma_f32_16x16x32_bf16 v[150:153], a[228:231], v[186:189], v[150:153]
v_mfma_f32_16x16x32_bf16 v[154:157], a[248:251], v[182:185], v[154:157]
v_mfma_f32_16x16x32_bf16 v[154:157], a[252:255], v[186:189], v[154:157]
v_mfma_f32_16x16x32_bf16 v[158:161], v[240:243], v[182:185], v[158:161]
v_mfma_f32_16x16x32_bf16 v[158:161], v[244:247], v[186:189], v[158:161]
v_mfma_f32_16x16x32_bf16 v[162:165], v[182:185], a[80:83], v[162:165]
v_mfma_f32_16x16x32_bf16 v[162:165], v[186:189], a[84:87], v[162:165]
v_mfma_f32_16x16x32_bf16 v[166:169], v[182:185], a[104:107], v[166:169]
v_mfma_f32_16x16x32_bf16 v[166:169], v[186:189], a[108:111], v[166:169]
v_mfma_f32_16x16x32_bf16 v[170:173], v[182:185], a[128:131], v[170:173]
v_mfma_f32_16x16x32_bf16 v[170:173], v[186:189], a[132:135], v[170:173]
ds_read_b128 v[110:113], v210 offset:30720
ds_read_b128 v[106:109], v210 offset:31744
s_waitcnt lgkmcnt(1)
v_mfma_f32_16x16x32_bf16 v[138:141], a[16:19], v[110:113], v[138:141]
s_waitcnt lgkmcnt(0)
v_mfma_f32_16x16x32_bf16 v[138:141], a[20:23], v[106:109], v[138:141]
v_mfma_f32_16x16x32_bf16 v[142:145], a[40:43], v[110:113], v[142:145]
v_mfma_f32_16x16x32_bf16 v[142:145], a[44:47], v[106:109], v[142:145]
v_mfma_f32_16x16x32_bf16 v[146:149], a[64:67], v[110:113], v[146:149]
v_mfma_f32_16x16x32_bf16 v[146:149], a[68:71], v[106:109], v[146:149]
v_mfma_f32_16x16x32_bf16 v[150:153], a[232:235], v[110:113], v[150:153]
v_mfma_f32_16x16x32_bf16 v[150:153], a[236:239], v[106:109], v[150:153]
v_mfma_f32_16x16x32_bf16 v[154:157], v[224:227], v[110:113], v[154:157]
v_mfma_f32_16x16x32_bf16 v[154:157], v[228:231], v[106:109], v[154:157]
v_mfma_f32_16x16x32_bf16 v[158:161], v[248:251], v[110:113], v[158:161]
v_mfma_f32_16x16x32_bf16 v[158:161], v[252:255], v[106:109], v[158:161]
v_mfma_f32_16x16x32_bf16 v[162:165], v[110:113], a[88:91], v[162:165]
v_mfma_f32_16x16x32_bf16 v[162:165], v[106:109], a[92:95], v[162:165]
v_mfma_f32_16x16x32_bf16 v[166:169], v[110:113], a[112:115], v[166:169]
v_mfma_f32_16x16x32_bf16 v[166:169], v[106:109], a[116:119], v[166:169]
v_mfma_f32_16x16x32_bf16 v[170:173], v[110:113], a[136:139], v[170:173]
v_mfma_f32_16x16x32_bf16 v[170:173], v[106:109], a[140:143], v[170:173]
v_cvt_pk_bf16_f32 v96, v138, v139
v_cvt_pk_bf16_f32 v97, v140, v141
v_cvt_pk_bf16_f32 v98, v142, v143
v_cvt_pk_bf16_f32 v99, v144, v145
v_cvt_pk_bf16_f32 v100, v146, v147
v_cvt_pk_bf16_f32 v101, v148, v149
v_cvt_pk_bf16_f32 v84, v150, v151
v_cvt_pk_bf16_f32 v85, v152, v153
v_cvt_pk_bf16_f32 v86, v154, v155
v_cvt_pk_bf16_f32 v87, v156, v157
v_cvt_pk_bf16_f32 v88, v158, v159
v_cvt_pk_bf16_f32 v89, v160, v161
v_cvt_pk_bf16_f32 v116, v162, v163
v_cvt_pk_bf16_f32 v117, v164, v165
v_cvt_pk_bf16_f32 v124, v166, v167
v_cvt_pk_bf16_f32 v125, v168, v169
v_cvt_pk_bf16_f32 v132, v170, v171
v_cvt_pk_bf16_f32 v133, v172, v173
ds_read_b128 v[182:185], v210 offset:32768
ds_read_b128 v[186:189], v210 offset:33792
s_waitcnt lgkmcnt(1)
v_mfma_f32_16x16x32_bf16 v[138:141], a[0:3], v[182:185], 0
s_waitcnt lgkmcnt(0)
v_mfma_f32_16x16x32_bf16 v[138:141], a[4:7], v[186:189], v[138:141]
v_mfma_f32_16x16x32_bf16 v[142:145], a[24:27], v[182:185], 0
v_mfma_f32_16x16x32_bf16 v[142:145], a[28:31], v[186:189], v[142:145]
v_mfma_f32_16x16x32_bf16 v[146:149], a[48:51], v[182:185], 0
v_mfma_f32_16x16x32_bf16 v[146:149], a[52:55], v[186:189], v[146:149]
ds_read_b128 v[170:173], v210 offset:34816
ds_read_b128 v[182:185], v210 offset:35840
s_waitcnt lgkmcnt(1)
v_mfma_f32_16x16x32_bf16 v[138:141], a[8:11], v[170:173], v[138:141]
s_waitcnt lgkmcnt(0)
v_mfma_f32_16x16x32_bf16 v[138:141], a[12:15], v[182:185], v[138:141]
v_mfma_f32_16x16x32_bf16 v[142:145], a[32:35], v[170:173], v[142:145]
v_mfma_f32_16x16x32_bf16 v[142:145], a[36:39], v[182:185], v[142:145]
v_mfma_f32_16x16x32_bf16 v[146:149], a[56:59], v[170:173], v[146:149]
v_mfma_f32_16x16x32_bf16 v[146:149], a[60:63], v[182:185], v[146:149]
ds_read_b128 v[186:189], v210 offset:36864
ds_read_b128 v[170:173], v210 offset:37888
s_waitcnt lgkmcnt(1)
v_mfma_f32_16x16x32_bf16 v[138:141], a[16:19], v[186:189], v[138:141]
s_waitcnt lgkmcnt(0)
v_mfma_f32_16x16x32_bf16 v[138:141], a[20:23], v[170:173], v[138:141]
v_mfma_f32_16x16x32_bf16 v[142:145], a[40:43], v[186:189], v[142:145]
v_mfma_f32_16x16x32_bf16 v[142:145], a[44:47], v[170:173], v[142:145]
v_mfma_f32_16x16x32_bf16 v[146:149], a[64:67], v[186:189], v[146:149]
v_mfma_f32_16x16x32_bf16 v[146:149], a[68:71], v[170:173], v[146:149]
v_cvt_pk_bf16_f32 v102, v138, v139
v_cvt_pk_bf16_f32 v103, v140, v141
v_cvt_pk_bf16_f32 v104, v142, v143
v_cvt_pk_bf16_f32 v105, v144, v145
s_nop 2
v_cvt_pk_bf16_f32 v106, v146, v147
v_cvt_pk_bf16_f32 v107, v148, v149
ds_read_b128 v[108:111], v215 offset:512
ds_read_b64 v[112:113], v215 offset:528
v_mfma_f32_16x16x32_bf16 v[138:141], v[78:81], v[72:75], 0
v_mfma_f32_16x16x32_bf16 v[142:145], v[96:99], v[72:75], 0
s_waitcnt lgkmcnt(1)
v_mfma_f32_16x16x32_bf16 v[150:153], v[108:111], v[72:75], v[206:209]
v_mfma_f32_16x16x32_bf16 v[146:149], v[102:105], v[72:75], 0
v_mfma_f32_16x16x16_bf16 v[138:141], v[82:83], v[76:77], v[138:141]
v_mfma_f32_16x16x16_bf16 v[142:145], v[100:101], v[76:77], v[142:145]
s_waitcnt lgkmcnt(0)
v_mfma_f32_16x16x16_bf16 v[150:153], v[112:113], v[76:77], v[150:153]
v_mfma_f32_16x16x16_bf16 v[146:149], v[106:107], v[76:77], v[146:149]
ds_read_b128 v[72:75], v215
ds_read_b64 v[76:77], v215 offset:16
v_mfma_f32_16x16x16_bf16 v[154:157], v[82:83], v[88:89], 0
v_mfma_f32_16x16x16_bf16 v[158:161], v[100:101], v[88:89], 0
v_mfma_f32_16x16x16_bf16 v[166:169], v[112:113], v[88:89], v[206:209]
v_mfma_f32_16x16x16_bf16 v[162:165], v[106:107], v[88:89], 0
v_mfma_f32_16x16x32_bf16 v[154:157], v[78:81], v[84:87], v[154:157]
v_mfma_f32_16x16x32_bf16 v[158:161], v[96:99], v[84:87], v[158:161]
v_mfma_f32_16x16x32_bf16 v[166:169], v[108:111], v[84:87], v[166:169]
v_mfma_f32_16x16x32_bf16 v[162:165], v[102:105], v[84:87], v[162:165]
ds_read_b128 v[182:185], v210 offset:32768
ds_read_b128 v[186:189], v210 offset:33792
s_waitcnt lgkmcnt(1)
v_mfma_f32_16x16x32_bf16 v[118:121], v[182:185], a[72:75], 0
s_waitcnt lgkmcnt(0)
v_mfma_f32_16x16x32_bf16 v[118:121], v[186:189], a[76:79], v[118:121]
v_mfma_f32_16x16x32_bf16 v[126:129], v[182:185], a[96:99], 0
v_mfma_f32_16x16x32_bf16 v[126:129], v[186:189], a[100:103], v[126:129]
v_mfma_f32_16x16x32_bf16 v[134:137], v[182:185], a[120:123], 0
v_mfma_f32_16x16x32_bf16 v[134:137], v[186:189], a[124:127], v[134:137]
v_mfma_f32_16x16x32_bf16 v[90:93], a[216:219], v[182:185], 0
v_mfma_f32_16x16x32_bf16 v[90:93], a[220:223], v[186:189], v[90:93]
v_mfma_f32_16x16x32_bf16 v[170:173], a[240:243], v[182:185], 0
v_mfma_f32_16x16x32_bf16 v[170:173], a[244:247], v[186:189], v[170:173]
v_mfma_f32_16x16x32_bf16 v[220:223], v[232:235], v[182:185], 0
v_mfma_f32_16x16x32_bf16 v[220:223], v[236:239], v[186:189], v[220:223]
ds_read_b128 v[174:177], v210 offset:34816
ds_read_b128 v[178:181], v210 offset:35840
s_waitcnt lgkmcnt(1)
v_mfma_f32_16x16x32_bf16 v[118:121], v[174:177], a[80:83], v[118:121]
s_waitcnt lgkmcnt(0)
v_mfma_f32_16x16x32_bf16 v[118:121], v[178:181], a[84:87], v[118:121]
v_mfma_f32_16x16x32_bf16 v[126:129], v[174:177], a[104:107], v[126:129]
v_mfma_f32_16x16x32_bf16 v[126:129], v[178:181], a[108:111], v[126:129]
v_mfma_f32_16x16x32_bf16 v[134:137], v[174:177], a[128:131], v[134:137]
v_mfma_f32_16x16x32_bf16 v[134:137], v[178:181], a[132:135], v[134:137]
v_mfma_f32_16x16x32_bf16 v[90:93], a[224:227], v[174:177], v[90:93]
v_mfma_f32_16x16x32_bf16 v[90:93], a[228:231], v[178:181], v[90:93]
v_mfma_f32_16x16x32_bf16 v[170:173], a[248:251], v[174:177], v[170:173]
v_mfma_f32_16x16x32_bf16 v[170:173], a[252:255], v[178:181], v[170:173]
v_mfma_f32_16x16x32_bf16 v[220:223], v[240:243], v[174:177], v[220:223]
v_mfma_f32_16x16x32_bf16 v[220:223], v[244:247], v[178:181], v[220:223]
ds_read_b128 v[182:185], v210 offset:36864
ds_read_b128 v[186:189], v210 offset:37888
s_waitcnt lgkmcnt(1)
v_mfma_f32_16x16x32_bf16 v[118:121], v[182:185], a[88:91], v[118:121]
s_waitcnt lgkmcnt(0)
v_mfma_f32_16x16x32_bf16 v[118:121], v[186:189], a[92:95], v[118:121]
v_mfma_f32_16x16x32_bf16 v[126:129], v[182:185], a[112:115], v[126:129]
v_mfma_f32_16x16x32_bf16 v[126:129], v[186:189], a[116:119], v[126:129]
v_mfma_f32_16x16x32_bf16 v[134:137], v[182:185], a[136:139], v[134:137]
v_mfma_f32_16x16x32_bf16 v[134:137], v[186:189], a[140:143], v[134:137]
v_mfma_f32_16x16x32_bf16 v[90:93], a[232:235], v[182:185], v[90:93]
v_mfma_f32_16x16x32_bf16 v[90:93], a[236:239], v[186:189], v[90:93]
v_mfma_f32_16x16x32_bf16 v[170:173], v[224:227], v[182:185], v[170:173]
v_mfma_f32_16x16x32_bf16 v[170:173], v[228:231], v[186:189], v[170:173]
v_mfma_f32_16x16x32_bf16 v[220:223], v[248:251], v[182:185], v[220:223]
v_mfma_f32_16x16x32_bf16 v[220:223], v[252:255], v[186:189], v[220:223]
v_mov_b32 v181, 0
v_cvt_pk_bf16_f32 v118, v118, v119
v_cvt_pk_bf16_f32 v119, v120, v121
ds_read_u16 v120, v205
v_mov_b32 v121, 0
v_cvt_pk_bf16_f32 v126, v126, v127
v_cvt_pk_bf16_f32 v127, v128, v129
ds_read_u16 v128, v205 offset:32
v_mov_b32 v129, 0
v_cvt_pk_bf16_f32 v134, v134, v135
v_cvt_pk_bf16_f32 v135, v136, v137
ds_read_u16 v136, v205 offset:64
v_mov_b32 v137, 0
v_add_u32 v205, 1424, v205
v_cvt_pk_bf16_f32 v90, v90, v91
v_cvt_pk_bf16_f32 v91, v92, v93
v_cvt_pk_bf16_f32 v92, v170, v171
v_cvt_pk_bf16_f32 v93, v172, v173
v_cvt_pk_bf16_f32 v94, v220, v221
v_cvt_pk_bf16_f32 v95, v222, v223
v_max3_f32 v151, v138, v139, v140
v_max3_f32 v151, v151, v141, v142
v_max3_f32 v151, v151, v143, v144
v_max3_f32 v151, v151, v145, v146
v_max3_f32 v151, v151, v147, v148
v_max3_f32 v151, v151, v149, v150
v_mov_b32 v152, v151
s_nop 1
v_permlane16_swap_b32 v151, v152
v_max_f32 v151, v151, v152
v_mov_b32 v152, v151
s_nop 1
v_permlane32_swap_b32 v151, v152
v_max_f32 v151, v151, v152
v_sub_f32 v138, v138, v151
v_sub_f32 v139, v139, v151
v_sub_f32 v140, v140, v151
v_sub_f32 v141, v141, v151
v_sub_f32 v142, v142, v151
v_sub_f32 v143, v143, v151
v_sub_f32 v144, v144, v151
v_sub_f32 v145, v145, v151
v_sub_f32 v150, v150, v151
v_sub_f32 v146, v146, v151
v_sub_f32 v147, v147, v151
v_sub_f32 v148, v148, v151
v_sub_f32 v149, v149, v151
v_exp_f32 v138, v138
v_exp_f32 v139, v139
v_exp_f32 v140, v140
v_exp_f32 v141, v141
v_exp_f32 v142, v142
v_exp_f32 v143, v143
v_exp_f32 v144, v144
v_exp_f32 v145, v145
v_exp_f32 v150, v150
v_exp_f32 v146, v146
v_exp_f32 v147, v147
v_exp_f32 v148, v148
v_exp_f32 v149, v149
v_cvt_pk_bf16_f32 v174, v138, v139
v_cvt_pk_bf16_f32 v175, v140, v141
v_cvt_pk_bf16_f32 v176, v142, v143
v_cvt_pk_bf16_f32 v177, v144, v145
v_cvt_pk_bf16_f32 v178, v146, v147
v_cvt_pk_bf16_f32 v179, v148, v149
v_cvt_pk_bf16_f32 v180, v150, 0
v_mfma_f32_16x16x32_bf16 v[150:153], v[190:193], v[174:177], 0
v_mfma_f32_16x16x32_bf16 v[150:153], v[190:193], v[178:181], v[150:153]
v_mfma_f32_16x16x32_bf16 v[138:141], v[114:117], v[174:177], 0
s_waitcnt lgkmcnt(2)
v_mfma_f32_16x16x32_bf16 v[138:141], v[118:121], v[178:181], v[138:141]
v_mfma_f32_16x16x32_bf16 v[142:145], v[122:125], v[174:177], 0
s_waitcnt lgkmcnt(1)
v_mfma_f32_16x16x32_bf16 v[142:145], v[126:129], v[178:181], v[142:145]
v_mfma_f32_16x16x32_bf16 v[146:149], v[130:133], v[174:177], 0
s_waitcnt lgkmcnt(0)
v_mfma_f32_16x16x32_bf16 v[146:149], v[134:137], v[178:181], v[146:149]
v_max3_f32 v167, v154, v155, v156
v_max3_f32 v167, v167, v157, v158
v_max3_f32 v167, v167, v159, v160
v_max3_f32 v167, v167, v161, v162
v_max3_f32 v167, v167, v163, v164
v_max3_f32 v167, v167, v165, v166
v_mov_b32 v168, v167
s_nop 1
v_permlane16_swap_b32 v167, v168
v_max_f32 v167, v167, v168
v_mov_b32 v168, v167
s_nop 1
v_permlane32_swap_b32 v167, v168
v_max_f32 v167, v167, v168
v_sub_f32 v154, v154, v167
v_sub_f32 v155, v155, v167
v_sub_f32 v156, v156, v167
v_sub_f32 v157, v157, v167
v_sub_f32 v158, v158, v167
v_sub_f32 v159, v159, v167
v_sub_f32 v160, v160, v167
v_sub_f32 v161, v161, v167
v_sub_f32 v166, v166, v167
v_sub_f32 v162, v162, v167
v_sub_f32 v163, v163, v167
v_sub_f32 v164, v164, v167
v_sub_f32 v165, v165, v167
v_exp_f32 v154, v154
v_exp_f32 v155, v155
v_exp_f32 v156, v156
v_exp_f32 v157, v157
v_exp_f32 v158, v158
v_exp_f32 v159, v159
v_exp_f32 v160, v160
v_exp_f32 v161, v161
v_exp_f32 v166, v166
v_exp_f32 v162, v162
v_exp_f32 v163, v163
v_exp_f32 v164, v164
v_exp_f32 v165, v165
v_cvt_pk_bf16_f32 v174, v154, v155
v_cvt_pk_bf16_f32 v175, v156, v157
v_cvt_pk_bf16_f32 v176, v158, v159
v_cvt_pk_bf16_f32 v177, v160, v161
v_cvt_pk_bf16_f32 v178, v162, v163
v_cvt_pk_bf16_f32 v179, v164, v165
v_cvt_pk_bf16_f32 v180, v166, 0
v_mfma_f32_16x16x32_bf16 v[166:169], v[190:193], v[174:177], 0
v_mfma_f32_16x16x32_bf16 v[166:169], v[190:193], v[178:181], v[166:169]
v_mfma_f32_16x16x32_bf16 v[154:157], v[114:117], v[174:177], 0
v_mfma_f32_16x16x32_bf16 v[154:157], v[118:121], v[178:181], v[154:157]
v_mfma_f32_16x16x32_bf16 v[158:161], v[122:125], v[174:177], 0
v_mfma_f32_16x16x32_bf16 v[158:161], v[126:129], v[178:181], v[158:161]
v_mfma_f32_16x16x32_bf16 v[162:165], v[130:133], v[174:177], 0
v_mfma_f32_16x16x32_bf16 v[162:165], v[134:137], v[178:181], v[162:165]
v_rcp_f32 v151, v150
s_nop 0
v_mul_f32 v152, s3, v151
v_mul_f32 v138, v138, v152
v_mul_f32 v139, v139, v152
v_cvt_pk_bf16_f32 v138, v138, v139
v_mul_f32 v140, v140, v152
v_mul_f32 v141, v141, v152
v_cvt_pk_bf16_f32 v139, v140, v141
v_mul_f32 v142, v142, v152
v_mul_f32 v143, v143, v152
v_cvt_pk_bf16_f32 v140, v142, v143
v_mul_f32 v144, v144, v152
v_mul_f32 v145, v145, v152
v_cvt_pk_bf16_f32 v141, v144, v145
ds_write_b128 v211, v[138:141] offset:38912
v_mul_f32 v146, v146, v152
v_mul_f32 v147, v147, v152
v_cvt_pk_bf16_f32 v142, v146, v147
v_mul_f32 v148, v148, v152
v_mul_f32 v149, v149, v152
v_cvt_pk_bf16_f32 v143, v148, v149
ds_write_b64 v212, v[142:143] offset:38912
v_mfma_f32_16x16x32_bf16 v[138:141], v[78:81], v[90:93], 0
v_mfma_f32_16x16x32_bf16 v[142:145], v[96:99], v[90:93], 0
v_mfma_f32_16x16x32_bf16 v[150:153], v[108:111], v[90:93], v[206:209]
v_mfma_f32_16x16x32_bf16 v[146:149], v[102:105], v[90:93], 0
v_mfma_f32_16x16x16_bf16 v[138:141], v[82:83], v[94:95], v[138:141]
v_mfma_f32_16x16x16_bf16 v[142:145], v[100:101], v[94:95], v[142:145]
v_mfma_f32_16x16x16_bf16 v[150:153], v[112:113], v[94:95], v[150:153]
v_mfma_f32_16x16x16_bf16 v[146:149], v[106:107], v[94:95], v[146:149]
v_rcp_f32 v167, v166
s_nop 0
v_mul_f32 v168, s3, v167
v_mul_f32 v154, v154, v168
v_mul_f32 v155, v155, v168
v_cvt_pk_bf16_f32 v154, v154, v155
v_mul_f32 v156, v156, v168
v_mul_f32 v157, v157, v168
v_cvt_pk_bf16_f32 v155, v156, v157
v_mul_f32 v158, v158, v168
v_mul_f32 v159, v159, v168
v_cvt_pk_bf16_f32 v156, v158, v159
v_mul_f32 v160, v160, v168
v_mul_f32 v161, v161, v168
v_cvt_pk_bf16_f32 v157, v160, v161
ds_write_b128 v211, v[154:157] offset:45056
v_mul_f32 v162, v162, v168
v_mul_f32 v163, v163, v168
v_cvt_pk_bf16_f32 v158, v162, v163
v_mul_f32 v164, v164, v168
v_mul_f32 v165, v165, v168
v_cvt_pk_bf16_f32 v159, v164, v165
ds_write_b64 v212, v[158:159] offset:45056
v_mfma_f32_16x16x16_bf16 v[154:157], v[76:77], v[82:83], 0
v_mfma_f32_16x16x16_bf16 v[158:161], v[76:77], v[100:101], 0
v_mfma_f32_16x16x16_bf16 v[162:165], v[76:77], v[106:107], 0
v_mfma_f32_16x16x16_bf16 v[166:169], v[76:77], v[112:113], v[206:209]
v_mfma_f32_16x16x32_bf16 v[154:157], v[72:75], v[78:81], v[154:157]
v_mfma_f32_16x16x32_bf16 v[158:161], v[72:75], v[96:99], v[158:161]
v_mfma_f32_16x16x32_bf16 v[162:165], v[72:75], v[102:105], v[162:165]
v_mfma_f32_16x16x32_bf16 v[166:169], v[72:75], v[108:111], v[166:169]
v_mov_b32_dpp v154, v158 quad_perm:[0,1,2,3] row_mask:0x2 bank_mask:0xf
s_nop 1
v_mov_b32_dpp v154, v162 quad_perm:[0,1,2,3] row_mask:0x4 bank_mask:0xf
s_nop 2
v_mov_b32_dpp v154, v167 quad_perm:[0,1,2,3] row_mask:0x8 bank_mask:0xf
v_mov_b32 v155, v154
s_nop 1
v_max_f32_dpp v155, v155, v155 row_ror:8 row_mask:0xf bank_mask:0xf
s_nop 1
v_max_f32_dpp v155, v155, v155 row_ror:4 row_mask:0xf bank_mask:0xf
s_nop 1
v_max_f32_dpp v155, v155, v155 row_ror:2 row_mask:0xf bank_mask:0xf
s_nop 1
v_max_f32_dpp v155, v155, v155 row_ror:1 row_mask:0xf bank_mask:0xf
v_mov_b32 v156, v155
s_nop 1
v_permlane16_swap_b32 v155, v156
v_max_f32 v155, v155, v156
v_mov_b32 v156, v155
s_nop 1
v_permlane32_swap_b32 v155, v156
v_max_f32 v155, v155, v156
v_sub_f32 v154, v154, v155
v_exp_f32 v154, v154
s_nop 0
v_cvt_pk_bf16_f32 v154, v154, 0
ds_write_b16 v214, v154
ds_read_b128 v[84:87], v215
s_waitcnt lgkmcnt(2)
ds_read_b128 v[88:91], v215 offset:16
v_add_u32 v215, 1424, v215
s_barrier
ds_read_b128 v[220:223], v210 offset:38912
ds_read_b128 v[110:113], v210 offset:39936
s_waitcnt lgkmcnt(1)
v_mfma_f32_16x16x32_bf16 v[36:39], a[144:147], v[220:223], v[36:39]
s_waitcnt lgkmcnt(0)
v_mfma_f32_16x16x32_bf16 v[36:39], a[148:151], v[110:113], v[36:39]
v_mfma_f32_16x16x32_bf16 v[40:43], a[168:171], v[220:223], v[40:43]
v_mfma_f32_16x16x32_bf16 v[40:43], a[172:175], v[110:113], v[40:43]
v_mfma_f32_16x16x32_bf16 v[44:47], a[192:195], v[220:223], v[44:47]
v_mfma_f32_16x16x32_bf16 v[44:47], a[196:199], v[110:113], v[44:47]
ds_read_b128 v[170:173], v210 offset:40960
ds_read_b128 v[182:185], v210 offset:41984
s_waitcnt lgkmcnt(1)
v_mfma_f32_16x16x32_bf16 v[36:39], a[152:155], v[170:173], v[36:39]
s_waitcnt lgkmcnt(0)
v_mfma_f32_16x16x32_bf16 v[36:39], a[156:159], v[182:185], v[36:39]
v_mfma_f32_16x16x32_bf16 v[40:43], a[176:179], v[170:173], v[40:43]
v_mfma_f32_16x16x32_bf16 v[40:43], a[180:183], v[182:185], v[40:43]
v_mfma_f32_16x16x32_bf16 v[44:47], a[200:203], v[170:173], v[44:47]
v_mfma_f32_16x16x32_bf16 v[44:47], a[204:207], v[182:185], v[44:47]
ds_read_b128 v[186:189], v210 offset:43008
ds_read_b128 v[220:223], v210 offset:44032
s_waitcnt lgkmcnt(1)
v_mfma_f32_16x16x32_bf16 v[36:39], a[160:163], v[186:189], v[36:39]
s_waitcnt lgkmcnt(0)
v_mfma_f32_16x16x32_bf16 v[36:39], a[164:167], v[220:223], v[36:39]
v_mfma_f32_16x16x32_bf16 v[40:43], a[184:187], v[186:189], v[40:43]
v_mfma_f32_16x16x32_bf16 v[40:43], a[188:191], v[220:223], v[40:43]
v_mfma_f32_16x16x32_bf16 v[44:47], a[208:211], v[186:189], v[44:47]
v_mfma_f32_16x16x32_bf16 v[44:47], a[212:215], v[220:223], v[44:47]
v_cvt_pk_bf16_f32 v36, v36, v37
v_cvt_pk_bf16_f32 v37, v38, v39
ds_write_b64 v203, v[36:37]
v_cvt_pk_bf16_f32 v40, v40, v41
v_cvt_pk_bf16_f32 v41, v42, v43
ds_write_b64 v203, v[40:41] offset:32
v_cvt_pk_bf16_f32 v44, v44, v45
v_cvt_pk_bf16_f32 v45, v46, v47
ds_write_b64 v203, v[44:45] offset:64
v_max3_f32 v151, v138, v139, v140
v_max3_f32 v151, v151, v141, v142
v_max3_f32 v151, v151, v143, v144
v_max3_f32 v151, v151, v145, v146
v_max3_f32 v151, v151, v147, v148
v_max3_f32 v151, v151, v149, v150
v_mov_b32 v152, v151
s_nop 1
v_permlane16_swap_b32 v151, v152
v_max_f32 v151, v151, v152
v_mov_b32 v152, v151
s_nop 1
v_permlane32_swap_b32 v151, v152
v_max_f32 v151, v151, v152
v_sub_f32 v138, v138, v151
v_sub_f32 v139, v139, v151
v_sub_f32 v140, v140, v151
v_sub_f32 v141, v141, v151
v_sub_f32 v142, v142, v151
v_sub_f32 v143, v143, v151
v_sub_f32 v144, v144, v151
v_sub_f32 v145, v145, v151
v_sub_f32 v150, v150, v151
v_sub_f32 v146, v146, v151
v_sub_f32 v147, v147, v151
v_sub_f32 v148, v148, v151
v_sub_f32 v149, v149, v151
v_exp_f32 v138, v138
v_exp_f32 v139, v139
v_exp_f32 v140, v140
v_exp_f32 v141, v141
v_exp_f32 v142, v142
v_exp_f32 v143, v143
v_exp_f32 v144, v144
v_exp_f32 v145, v145
v_exp_f32 v150, v150
v_exp_f32 v146, v146
v_exp_f32 v147, v147
v_exp_f32 v148, v148
v_exp_f32 v149, v149
v_cvt_pk_bf16_f32 v174, v138, v139
v_cvt_pk_bf16_f32 v175, v140, v141
v_cvt_pk_bf16_f32 v176, v142, v143
v_cvt_pk_bf16_f32 v177, v144, v145
v_cvt_pk_bf16_f32 v178, v146, v147
v_cvt_pk_bf16_f32 v179, v148, v149
v_cvt_pk_bf16_f32 v180, v150, 0
v_mfma_f32_16x16x32_bf16 v[150:153], v[190:193], v[174:177], 0
v_mfma_f32_16x16x32_bf16 v[150:153], v[190:193], v[178:181], v[150:153]
v_mfma_f32_16x16x32_bf16 v[138:141], v[114:117], v[174:177], 0
v_mfma_f32_16x16x32_bf16 v[138:141], v[118:121], v[178:181], v[138:141]
v_mfma_f32_16x16x32_bf16 v[142:145], v[122:125], v[174:177], 0
v_mfma_f32_16x16x32_bf16 v[142:145], v[126:129], v[178:181], v[142:145]
v_mfma_f32_16x16x32_bf16 v[146:149], v[130:133], v[174:177], 0
v_mfma_f32_16x16x32_bf16 v[146:149], v[134:137], v[178:181], v[146:149]
v_rcp_f32 v151, v150
s_nop 0
v_mul_f32 v152, s3, v151
v_mul_f32 v138, v138, v152
v_mul_f32 v139, v139, v152
v_cvt_pk_bf16_f32 v138, v138, v139
v_mul_f32 v140, v140, v152
v_mul_f32 v141, v141, v152
v_cvt_pk_bf16_f32 v139, v140, v141
v_mul_f32 v142, v142, v152
v_mul_f32 v143, v143, v152
v_cvt_pk_bf16_f32 v140, v142, v143
v_mul_f32 v144, v144, v152
v_mul_f32 v145, v145, v152
v_cvt_pk_bf16_f32 v141, v144, v145
ds_write_b128 v211, v[138:141] offset:51200
v_mul_f32 v146, v146, v152
v_mul_f32 v147, v147, v152
v_cvt_pk_bf16_f32 v142, v146, v147
v_mul_f32 v148, v148, v152
v_mul_f32 v149, v149, v152
v_cvt_pk_bf16_f32 v143, v148, v149
ds_write_b64 v212, v[142:143] offset:51200
v_mfma_f32_16x16x32_bf16 v[166:169], v[84:87], v[190:193], 0
v_mfma_f32_16x16x32_bf16 v[166:169], v[88:91], v[190:193], v[166:169]
v_mfma_f32_16x16x32_bf16 v[154:157], v[84:87], v[114:117], 0
v_mfma_f32_16x16x32_bf16 v[154:157], v[88:91], v[118:121], v[154:157]
v_mfma_f32_16x16x32_bf16 v[158:161], v[84:87], v[122:125], 0
v_mfma_f32_16x16x32_bf16 v[158:161], v[88:91], v[126:129], v[158:161]
v_mfma_f32_16x16x32_bf16 v[162:165], v[84:87], v[130:133], 0
v_mfma_f32_16x16x32_bf16 v[162:165], v[88:91], v[134:137], v[162:165]
v_rcp_f32 v167, v166
v_mov_b32_dpp v154, v158 quad_perm:[0,1,2,3] row_mask:0x2 bank_mask:0xf
s_nop 3
v_mov_b32_dpp v154, v162 quad_perm:[0,1,2,3] row_mask:0x4 bank_mask:0xf
v_mul_f32 v168, s3, v167
v_mul_f32 v154, v154, v168
v_cvt_pk_bf16_f32 v154, v154, 0
ds_write_b16 v214, v154
v_add_u32 v214, 1424, v214
ds_read_b128 v[110:113], v210 offset:45056
ds_read_b128 v[170:173], v210 offset:46080
s_waitcnt lgkmcnt(1)
v_mfma_f32_16x16x32_bf16 v[48:51], a[144:147], v[110:113], v[48:51]
s_waitcnt lgkmcnt(0)
v_mfma_f32_16x16x32_bf16 v[48:51], a[148:151], v[170:173], v[48:51]
v_mfma_f32_16x16x32_bf16 v[52:55], a[168:171], v[110:113], v[52:55]
v_mfma_f32_16x16x32_bf16 v[52:55], a[172:175], v[170:173], v[52:55]
v_mfma_f32_16x16x32_bf16 v[56:59], a[192:195], v[110:113], v[56:59]
v_mfma_f32_16x16x32_bf16 v[56:59], a[196:199], v[170:173], v[56:59]
ds_read_b128 v[182:185], v210 offset:47104
ds_read_b128 v[186:189], v210 offset:48128
s_waitcnt lgkmcnt(1)
v_mfma_f32_16x16x32_bf16 v[48:51], a[152:155], v[182:185], v[48:51]
s_waitcnt lgkmcnt(0)
v_mfma_f32_16x16x32_bf16 v[48:51], a[156:159], v[186:189], v[48:51]
v_mfma_f32_16x16x32_bf16 v[52:55], a[176:179], v[182:185], v[52:55]
v_mfma_f32_16x16x32_bf16 v[52:55], a[180:183], v[186:189], v[52:55]
v_mfma_f32_16x16x32_bf16 v[56:59], a[200:203], v[182:185], v[56:59]
v_mfma_f32_16x16x32_bf16 v[56:59], a[204:207], v[186:189], v[56:59]
ds_read_b128 v[220:223], v210 offset:49152
ds_read_b128 v[110:113], v210 offset:50176
s_waitcnt lgkmcnt(1)
v_mfma_f32_16x16x32_bf16 v[48:51], a[160:163], v[220:223], v[48:51]
s_waitcnt lgkmcnt(0)
v_mfma_f32_16x16x32_bf16 v[48:51], a[164:167], v[110:113], v[48:51]
v_mfma_f32_16x16x32_bf16 v[52:55], a[184:187], v[220:223], v[52:55]
v_mfma_f32_16x16x32_bf16 v[52:55], a[188:191], v[110:113], v[52:55]
v_mfma_f32_16x16x32_bf16 v[56:59], a[208:211], v[220:223], v[56:59]
v_mfma_f32_16x16x32_bf16 v[56:59], a[212:215], v[110:113], v[56:59]
v_cvt_pk_bf16_f32 v48, v48, v49
v_cvt_pk_bf16_f32 v49, v50, v51
ds_write_b64 v203, v[48:49] offset:6272
v_cvt_pk_bf16_f32 v52, v52, v53
v_cvt_pk_bf16_f32 v53, v54, v55
ds_write_b64 v203, v[52:53] offset:6304
v_cvt_pk_bf16_f32 v56, v56, v57
v_cvt_pk_bf16_f32 v57, v58, v59
ds_write_b64 v203, v[56:57] offset:6336
s_waitcnt vmcnt(0)
s_barrier
ds_read_b64 v[120:121], v204
s_add_u32 s28, s39, s60
s_waitcnt lgkmcnt(0)
buffer_store_dwordx2 v[120:121], v204, s[8:11], s28 offen sc1
ds_read_b64 v[128:129], v204 offset:392
s_add_u32 s29, s39, s61
s_waitcnt lgkmcnt(0)
buffer_store_dwordx2 v[128:129], v204, s[8:11], s29 offen sc1
ds_read_b64 v[136:137], v204 offset:784
s_add_u32 s28, s39, s62
s_waitcnt lgkmcnt(0)
buffer_store_dwordx2 v[136:137], v204, s[8:11], s28 offen sc1
ds_read_b64 v[120:121], v204 offset:1176
s_add_u32 s29, s39, s63
s_waitcnt lgkmcnt(0)
buffer_store_dwordx2 v[120:121], v204, s[8:11], s29 offen sc1
ds_read_b128 v[170:173], v210 offset:51200
ds_read_b128 v[182:185], v210 offset:52224
s_waitcnt lgkmcnt(1)
v_mfma_f32_16x16x32_bf16 v[60:63], a[144:147], v[170:173], v[60:63]
s_waitcnt lgkmcnt(0)
v_mfma_f32_16x16x32_bf16 v[60:63], a[148:151], v[182:185], v[60:63]
v_mfma_f32_16x16x32_bf16 v[64:67], a[168:171], v[170:173], v[64:67]
v_mfma_f32_16x16x32_bf16 v[64:67], a[172:175], v[182:185], v[64:67]
v_mfma_f32_16x16x32_bf16 v[68:71], a[192:195], v[170:173], v[68:71]
v_mfma_f32_16x16x32_bf16 v[68:71], a[196:199], v[182:185], v[68:71]
ds_read_b128 v[186:189], v210 offset:53248
ds_read_b128 v[220:223], v210 offset:54272
s_waitcnt lgkmcnt(1)
v_mfma_f32_16x16x32_bf16 v[60:63], a[152:155], v[186:189], v[60:63]
s_waitcnt lgkmcnt(0)
v_mfma_f32_16x16x32_bf16 v[60:63], a[156:159], v[220:223], v[60:63]
v_mfma_f32_16x16x32_bf16 v[64:67], a[176:179], v[186:189], v[64:67]
v_mfma_f32_16x16x32_bf16 v[64:67], a[180:183], v[220:223], v[64:67]
v_mfma_f32_16x16x32_bf16 v[68:71], a[200:203], v[186:189], v[68:71]
v_mfma_f32_16x16x32_bf16 v[68:71], a[204:207], v[220:223], v[68:71]
ds_read_b128 v[110:113], v210 offset:55296
ds_read_b128 v[170:173], v210 offset:56320
s_waitcnt lgkmcnt(1)
v_mfma_f32_16x16x32_bf16 v[60:63], a[160:163], v[110:113], v[60:63]
s_waitcnt lgkmcnt(0)
v_mfma_f32_16x16x32_bf16 v[60:63], a[164:167], v[170:173], v[60:63]
v_mfma_f32_16x16x32_bf16 v[64:67], a[184:187], v[110:113], v[64:67]
v_mfma_f32_16x16x32_bf16 v[64:67], a[188:191], v[170:173], v[64:67]
v_mfma_f32_16x16x32_bf16 v[68:71], a[208:211], v[110:113], v[68:71]
v_mfma_f32_16x16x32_bf16 v[68:71], a[212:215], v[170:173], v[68:71]
v_cvt_pk_bf16_f32 v60, v60, v61
v_cvt_pk_bf16_f32 v61, v62, v63
ds_write_b64 v203, v[60:61] offset:12544
v_cvt_pk_bf16_f32 v64, v64, v65
v_cvt_pk_bf16_f32 v65, v66, v67
ds_write_b64 v203, v[64:65] offset:12576
v_cvt_pk_bf16_f32 v68, v68, v69
v_cvt_pk_bf16_f32 v69, v70, v71
ds_write_b64 v203, v[68:69] offset:12608
s_mov_b32 s38, s36
ds_read_b128 v[174:177], v217
ds_read_b128 v[84:87], v200
s_waitcnt lgkmcnt(0)
v_mfma_f32_16x16x32_bf16 v[36:39], v[174:177], v[84:87], 0
ds_read_b128 v[92:95], v201
s_waitcnt lgkmcnt(0)
v_mfma_f32_16x16x32_bf16 v[48:51], v[174:177], v[92:95], 0
ds_read_b128 v[100:103], v202
s_waitcnt lgkmcnt(0)
v_mfma_f32_16x16x32_bf16 v[60:63], v[174:177], v[100:103], 0
ds_read_b128 v[178:181], v217 offset:528
ds_read_b128 v[84:87], v194
ds_read_b128 v[88:91], v194 offset:16
s_waitcnt lgkmcnt(0)
v_smfmac_f32_16x16x64_bf16 v[36:39], v[178:181], v[84:91], v213
ds_read_b128 v[92:95], v195
ds_read_b128 v[96:99], v195 offset:16
s_waitcnt lgkmcnt(0)
v_smfmac_f32_16x16x64_bf16 v[48:51], v[178:181], v[92:99], v213
ds_read_b128 v[100:103], v196
ds_read_b128 v[104:107], v196 offset:16
s_waitcnt lgkmcnt(0)
v_smfmac_f32_16x16x64_bf16 v[60:63], v[178:181], v[100:107], v213
ds_read_b128 v[174:177], v217 offset:1056
ds_read_b128 v[84:87], v197
ds_read_b128 v[88:91], v197 offset:16
s_waitcnt lgkmcnt(0)
v_smfmac_f32_16x16x64_bf16 v[36:39], v[174:177], v[84:91], v213
ds_read_b128 v[92:95], v198
ds_read_b128 v[96:99], v198 offset:16
s_waitcnt lgkmcnt(0)
v_smfmac_f32_16x16x64_bf16 v[48:51], v[174:177], v[92:99], v213
ds_read_b128 v[100:103], v199
ds_read_b128 v[104:107], v199 offset:16
s_waitcnt lgkmcnt(0)
v_smfmac_f32_16x16x64_bf16 v[60:63], v[174:177], v[100:107], v213
ds_read_b128 v[178:181], v217 offset:1584
ds_read_b128 v[84:87], v200 offset:32
s_waitcnt lgkmcnt(0)
v_mfma_f32_16x16x32_bf16 v[40:43], v[178:181], v[84:87], 0
ds_read_b128 v[92:95], v201 offset:32
s_waitcnt lgkmcnt(0)
v_mfma_f32_16x16x32_bf16 v[52:55], v[178:181], v[92:95], 0
ds_read_b128 v[100:103], v202 offset:32
s_waitcnt lgkmcnt(0)
v_mfma_f32_16x16x32_bf16 v[64:67], v[178:181], v[100:103], 0
ds_read_b128 v[174:177], v217 offset:2112
ds_read_b128 v[84:87], v194 offset:32
ds_read_b128 v[88:91], v194 offset:48
s_waitcnt lgkmcnt(0)
v_smfmac_f32_16x16x64_bf16 v[40:43], v[174:177], v[84:91], v213
ds_read_b128 v[92:95], v195 offset:32
ds_read_b128 v[96:99], v195 offset:48
s_waitcnt lgkmcnt(0)
v_smfmac_f32_16x16x64_bf16 v[52:55], v[174:177], v[92:99], v213
ds_read_b128 v[100:103], v196 offset:32
ds_read_b128 v[104:107], v196 offset:48
s_waitcnt lgkmcnt(0)
v_smfmac_f32_16x16x64_bf16 v[64:67], v[174:177], v[100:107], v213
ds_read_b128 v[178:181], v217 offset:2640
ds_read_b128 v[84:87], v197 offset:32
ds_read_b128 v[88:91], v197 offset:48
s_waitcnt lgkmcnt(0)
v_smfmac_f32_16x16x64_bf16 v[40:43], v[178:181], v[84:91], v213
ds_read_b128 v[92:95], v198 offset:32
ds_read_b128 v[96:99], v198 offset:48
s_waitcnt lgkmcnt(0)
v_smfmac_f32_16x16x64_bf16 v[52:55], v[178:181], v[92:99], v213
ds_read_b128 v[100:103], v199 offset:32
ds_read_b128 v[104:107], v199 offset:48
s_waitcnt lgkmcnt(0)
v_smfmac_f32_16x16x64_bf16 v[64:67], v[178:181], v[100:107], v213
ds_read_b128 v[174:177], v217 offset:3168
ds_read_b128 v[84:87], v200 offset:64
s_waitcnt lgkmcnt(0)
v_mfma_f32_16x16x32_bf16 v[44:47], v[174:177], v[84:87], 0
ds_read_b128 v[92:95], v201 offset:64
s_waitcnt lgkmcnt(0)
v_mfma_f32_16x16x32_bf16 v[56:59], v[174:177], v[92:95], 0
ds_read_b128 v[100:103], v202 offset:64
s_waitcnt lgkmcnt(0)
v_mfma_f32_16x16x32_bf16 v[68:71], v[174:177], v[100:103], 0
ds_read_b128 v[178:181], v217 offset:3696
ds_read_b128 v[84:87], v194 offset:64
ds_read_b128 v[88:91], v194 offset:80
s_waitcnt lgkmcnt(0)
v_smfmac_f32_16x16x64_bf16 v[44:47], v[178:181], v[84:91], v213
ds_read_b128 v[92:95], v195 offset:64
ds_read_b128 v[96:99], v195 offset:80
s_waitcnt lgkmcnt(0)
v_smfmac_f32_16x16x64_bf16 v[56:59], v[178:181], v[92:99], v213
ds_read_b128 v[100:103], v196 offset:64
ds_read_b128 v[104:107], v196 offset:80
s_waitcnt lgkmcnt(0)
v_smfmac_f32_16x16x64_bf16 v[68:71], v[178:181], v[100:107], v213
ds_read_b128 v[174:177], v217 offset:4224
ds_read_b128 v[84:87], v197 offset:64
ds_read_b128 v[88:91], v197 offset:80
s_waitcnt lgkmcnt(0)
v_smfmac_f32_16x16x64_bf16 v[44:47], v[174:177], v[84:91], v213
ds_read_b128 v[92:95], v198 offset:64
ds_read_b128 v[96:99], v198 offset:80
s_waitcnt lgkmcnt(0)
v_smfmac_f32_16x16x64_bf16 v[56:59], v[174:177], v[92:99], v213
ds_read_b128 v[100:103], v199 offset:64
ds_read_b128 v[104:107], v199 offset:80
s_waitcnt lgkmcnt(0)
v_smfmac_f32_16x16x64_bf16 v[68:71], v[174:177], v[100:107], v213
v_add_f32 v118, v36, v37
v_mul_f32 v119, v36, v36
v_add_f32 v118, v118, v38
v_fmac_f32 v119, v37, v37
v_add_f32 v118, v118, v39
v_fmac_f32 v119, v38, v38
v_fmac_f32 v119, v39, v39
v_add_f32 v126, v48, v49
v_mul_f32 v127, v48, v48
v_add_f32 v126, v126, v50
v_fmac_f32 v127, v49, v49
v_add_f32 v126, v126, v51
v_fmac_f32 v127, v50, v50
v_fmac_f32 v127, v51, v51
v_add_f32 v134, v60, v61
v_mul_f32 v135, v60, v60
v_add_f32 v134, v134, v62
v_fmac_f32 v135, v61, v61
v_add_f32 v134, v134, v63
v_fmac_f32 v135, v62, v62
v_fmac_f32 v135, v63, v63
v_add_f32 v118, v118, v40
v_fmac_f32 v119, v40, v40
v_add_f32 v118, v118, v41
v_fmac_f32 v119, v41, v41
v_add_f32 v118, v118, v42
v_fmac_f32 v119, v42, v42
v_add_f32 v118, v118, v43
v_fmac_f32 v119, v43, v43
v_add_f32 v126, v126, v52
v_fmac_f32 v127, v52, v52
v_add_f32 v126, v126, v53
v_fmac_f32 v127, v53, v53
v_add_f32 v126, v126, v54
v_fmac_f32 v127, v54, v54
v_add_f32 v126, v126, v55
v_fmac_f32 v127, v55, v55
v_add_f32 v134, v134, v64
v_fmac_f32 v135, v64, v64
v_add_f32 v134, v134, v65
v_fmac_f32 v135, v65, v65
v_add_f32 v134, v134, v66
v_fmac_f32 v135, v66, v66
v_add_f32 v134, v134, v67
v_fmac_f32 v135, v67, v67
v_add_f32 v118, v118, v44
v_fmac_f32 v119, v44, v44
v_add_f32 v118, v118, v45
v_fmac_f32 v119, v45, v45
v_add_f32 v118, v118, v46
v_fmac_f32 v119, v46, v46
v_add_f32 v118, v118, v47
v_fmac_f32 v119, v47, v47
v_add_f32 v126, v126, v56
v_fmac_f32 v127, v56, v56
v_add_f32 v126, v126, v57
v_fmac_f32 v127, v57, v57
v_add_f32 v126, v126, v58
v_fmac_f32 v127, v58, v58
v_add_f32 v126, v126, v59
v_fmac_f32 v127, v59, v59
v_add_f32 v134, v134, v68
v_fmac_f32 v135, v68, v68
v_add_f32 v134, v134, v69
v_fmac_f32 v135, v69, v69
v_add_f32 v134, v134, v70
v_fmac_f32 v135, v70, v70
v_add_f32 v134, v134, v71
v_fmac_f32 v135, v71, v71
v_permlane16_swap_b32 v118, v119
v_add_f32 v118, v118, v119
v_permlane16_swap_b32 v126, v127
v_add_f32 v126, v126, v127
v_permlane16_swap_b32 v134, v135
v_add_f32 v134, v134, v135
v_permlane32_swap_b32 v118, v126
v_add_f32 v118, v118, v126
ds_write_b32 v209, v118
v_mov_b32 v135, v134
s_nop 1
v_permlane32_swap_b32 v134, v135
v_add_f32 v134, v134, v135
ds_write_b32 v209, v134 offset:512
s_waitcnt lgkmcnt(0)
s_barrier
ds_read_b64 v[128:129], v204 offset:6272
s_add_u32 s28, s39, s64
s_waitcnt lgkmcnt(0)
buffer_store_dwordx2 v[128:129], v204, s[8:11], s28 offen sc1
ds_read_b64 v[136:137], v204 offset:6664
s_add_u32 s29, s39, s65
s_waitcnt lgkmcnt(0)
buffer_store_dwordx2 v[136:137], v204, s[8:11], s29 offen sc1
ds_read_b64 v[120:121], v204 offset:7056
s_add_u32 s28, s39, s66
s_waitcnt lgkmcnt(0)
buffer_store_dwordx2 v[120:121], v204, s[8:11], s28 offen sc1
ds_read_b64 v[128:129], v204 offset:7448
s_add_u32 s29, s39, s67
s_waitcnt lgkmcnt(0)
buffer_store_dwordx2 v[128:129], v204, s[8:11], s29 offen sc1
ds_read_b64 v[136:137], v204 offset:12544
s_add_u32 s28, s39, s68
s_waitcnt lgkmcnt(0)
buffer_store_dwordx2 v[136:137], v204, s[8:11], s28 offen sc1
ds_read_b64 v[120:121], v204 offset:12936
s_add_u32 s29, s39, s69
s_waitcnt lgkmcnt(0)
buffer_store_dwordx2 v[120:121], v204, s[8:11], s29 offen sc1
ds_read_b64 v[128:129], v204 offset:13328
s_add_u32 s28, s39, s70
s_waitcnt lgkmcnt(0)
buffer_store_dwordx2 v[128:129], v204, s[8:11], s28 offen sc1
ds_read_b64 v[136:137], v204 offset:13720
s_add_u32 s29, s39, s71
s_waitcnt lgkmcnt(0)
buffer_store_dwordx2 v[136:137], v204, s[8:11], s29 offen sc1
s_mul_hi_u32 s41, s35, 58835169
s_mul_i32 s42, s41, 73
s_sub_u32 s42, s35, s42
s_mul_i32 s43, s41, 1373568
s_mul_i32 s51, s42, 2688
s_add_u32 s50, s43, s51
s_add_u32 s35, s35, 32
s_min_u32 s41, s41, 1
s_sub_u32 s41, 1, s41
s_lshl_b32 s41, s41, 30
s_add_u32 s52, s50, s41
s_min_u32 s43, s42, 1
s_lshl_b32 s43, s43, 27
s_sub_u32 s43, 536870911, s43
s_add_u32 s51, s42, 56
s_and_b32 s51, s51, 128
s_lshl_b32 s51, s51, 22
s_or_b32 s44, s43, s51
s_mov_b32 s36, s50
v_and_b32 v216, s44, v208
s_add_u32 m0, s45, 0
s_nop 0
buffer_load_dwordx4 v216, s[4:7], s52 offen nt lds
s_add_u32 m0, s45, 4112
s_add_u32 s40, s36, 196224
buffer_load_dwordx4 v216, s[4:7], s40 offen nt lds
s_add_u32 m0, s45, 8224
s_add_u32 s40, s36, 392448
buffer_load_dwordx4 v216, s[4:7], s40 offen nt lds
s_add_u32 m0, s45, 12336
s_add_u32 s40, s36, 588672
buffer_load_dwordx4 v216, s[4:7], s40 offen nt lds
s_add_u32 m0, s45, 16448
s_add_u32 s40, s36, 784896
buffer_load_dwordx4 v216, s[4:7], s40 offen nt lds
s_add_u32 m0, s45, 20560
s_add_u32 s40, s36, 981120
buffer_load_dwordx4 v216, s[4:7], s40 offen nt lds
s_add_u32 m0, s45, 24672
s_add_u32 s40, s36, 1177344
buffer_load_dwordx4 v216, s[4:7], s40 offen nt lds
s_add_u32 m0, s45, 28784
s_add_u32 s40, s36, 1373568
buffer_load_dwordx4 v216, s[4:7], s40 offen nt lds
s_add_u32 m0, s45, 32896
s_add_u32 s40, s36, 1569792
buffer_load_dwordx4 v216, s[4:7], s40 offen nt lds
ds_read_b128 v[182:185], v210
ds_read_b128 v[186:189], v210 offset:1024
s_waitcnt lgkmcnt(1)
v_mfma_f32_16x16x32_bf16 v[138:141], a[0:3], v[182:185], 0
s_waitcnt lgkmcnt(0)
v_mfma_f32_16x16x32_bf16 v[138:141], a[4:7], v[186:189], v[138:141]
v_mfma_f32_16x16x32_bf16 v[142:145], a[24:27], v[182:185], 0
v_mfma_f32_16x16x32_bf16 v[142:145], a[28:31], v[186:189], v[142:145]
v_mfma_f32_16x16x32_bf16 v[146:149], a[48:51], v[182:185], 0
v_mfma_f32_16x16x32_bf16 v[146:149], a[52:55], v[186:189], v[146:149]
v_mfma_f32_16x16x32_bf16 v[150:153], a[216:219], v[182:185], 0
v_mfma_f32_16x16x32_bf16 v[150:153], a[220:223], v[186:189], v[150:153]
v_mfma_f32_16x16x32_bf16 v[154:157], a[240:243], v[182:185], 0
v_mfma_f32_16x16x32_bf16 v[154:157], a[244:247], v[186:189], v[154:157]
v_mfma_f32_16x16x32_bf16 v[158:161], v[232:235], v[182:185], 0
v_mfma_f32_16x16x32_bf16 v[158:161], v[236:239], v[186:189], v[158:161]
v_mfma_f32_16x16x32_bf16 v[162:165], v[182:185], a[72:75], 0
v_mfma_f32_16x16x32_bf16 v[162:165], v[186:189], a[76:79], v[162:165]
v_mfma_f32_16x16x32_bf16 v[166:169], v[182:185], a[96:99], 0
v_mfma_f32_16x16x32_bf16 v[166:169], v[186:189], a[100:103], v[166:169]
v_mfma_f32_16x16x32_bf16 v[170:173], v[182:185], a[120:123], 0
v_mfma_f32_16x16x32_bf16 v[170:173], v[186:189], a[124:127], v[170:173]
ds_read_b128 v[110:113], v210 offset:2048
ds_read_b128 v[220:223], v210 offset:3072
s_waitcnt lgkmcnt(1)
v_mfma_f32_16x16x32_bf16 v[138:141], a[8:11], v[110:113], v[138:141]
s_waitcnt lgkmcnt(0)
v_mfma_f32_16x16x32_bf16 v[138:141], a[12:15], v[220:223], v[138:141]
v_mfma_f32_16x16x32_bf16 v[142:145], a[32:35], v[110:113], v[142:145]
v_mfma_f32_16x16x32_bf16 v[142:145], a[36:39], v[220:223], v[142:145]
v_mfma_f32_16x16x32_bf16 v[146:149], a[56:59], v[110:113], v[146:149]
v_mfma_f32_16x16x32_bf16 v[146:149], a[60:63], v[220:223], v[146:149]
v_mfma_f32_16x16x32_bf16 v[150:153], a[224:227], v[110:113], v[150:153]
v_mfma_f32_16x16x32_bf16 v[150:153], a[228:231], v[220:223], v[150:153]
v_mfma_f32_16x16x32_bf16 v[154:157], a[248:251], v[110:113], v[154:157]
v_mfma_f32_16x16x32_bf16 v[154:157], a[252:255], v[220:223], v[154:157]
v_mfma_f32_16x16x32_bf16 v[158:161], v[240:243], v[110:113], v[158:161]
v_mfma_f32_16x16x32_bf16 v[158:161], v[244:247], v[220:223], v[158:161]
v_mfma_f32_16x16x32_bf16 v[162:165], v[110:113], a[80:83], v[162:165]
v_mfma_f32_16x16x32_bf16 v[162:165], v[220:223], a[84:87], v[162:165]
v_mfma_f32_16x16x32_bf16 v[166:169], v[110:113], a[104:107], v[166:169]
v_mfma_f32_16x16x32_bf16 v[166:169], v[220:223], a[108:111], v[166:169]
v_mfma_f32_16x16x32_bf16 v[170:173], v[110:113], a[128:131], v[170:173]
v_mfma_f32_16x16x32_bf16 v[170:173], v[220:223], a[132:135], v[170:173]
ds_read_b128 v[182:185], v210 offset:4096
ds_read_b128 v[186:189], v210 offset:5120
s_waitcnt lgkmcnt(1)
v_mfma_f32_16x16x32_bf16 v[138:141], a[16:19], v[182:185], v[138:141]
s_waitcnt lgkmcnt(0)
v_mfma_f32_16x16x32_bf16 v[138:141], a[20:23], v[186:189], v[138:141]
v_mfma_f32_16x16x32_bf16 v[142:145], a[40:43], v[182:185], v[142:145]
v_mfma_f32_16x16x32_bf16 v[142:145], a[44:47], v[186:189], v[142:145]
v_mfma_f32_16x16x32_bf16 v[146:149], a[64:67], v[182:185], v[146:149]
v_mfma_f32_16x16x32_bf16 v[146:149], a[68:71], v[186:189], v[146:149]
v_mfma_f32_16x16x32_bf16 v[150:153], a[232:235], v[182:185], v[150:153]
v_mfma_f32_16x16x32_bf16 v[150:153], a[236:239], v[186:189], v[150:153]
v_mfma_f32_16x16x32_bf16 v[154:157], v[224:227], v[182:185], v[154:157]
v_mfma_f32_16x16x32_bf16 v[154:157], v[228:231], v[186:189], v[154:157]
v_mfma_f32_16x16x32_bf16 v[158:161], v[248:251], v[182:185], v[158:161]
v_mfma_f32_16x16x32_bf16 v[158:161], v[252:255], v[186:189], v[158:161]
v_mfma_f32_16x16x32_bf16 v[162:165], v[182:185], a[88:91], v[162:165]
v_mfma_f32_16x16x32_bf16 v[162:165], v[186:189], a[92:95], v[162:165]
v_mfma_f32_16x16x32_bf16 v[166:169], v[182:185], a[112:115], v[166:169]
v_mfma_f32_16x16x32_bf16 v[166:169], v[186:189], a[116:119], v[166:169]
v_mfma_f32_16x16x32_bf16 v[170:173], v[182:185], a[136:139], v[170:173]
v_mfma_f32_16x16x32_bf16 v[170:173], v[186:189], a[140:143], v[170:173]
v_cvt_pk_bf16_f32 v78, v138, v139
v_cvt_pk_bf16_f32 v79, v140, v141
v_cvt_pk_bf16_f32 v80, v142, v143
v_cvt_pk_bf16_f32 v81, v144, v145
v_cvt_pk_bf16_f32 v82, v146, v147
v_cvt_pk_bf16_f32 v83, v148, v149
v_cvt_pk_bf16_f32 v72, v150, v151
v_cvt_pk_bf16_f32 v73, v152, v153
v_cvt_pk_bf16_f32 v74, v154, v155
v_cvt_pk_bf16_f32 v75, v156, v157
v_cvt_pk_bf16_f32 v76, v158, v159
v_cvt_pk_bf16_f32 v77, v160, v161
v_cvt_pk_bf16_f32 v114, v162, v163
v_cvt_pk_bf16_f32 v115, v164, v165
v_cvt_pk_bf16_f32 v122, v166, v167
v_cvt_pk_bf16_f32 v123, v168, v169
v_cvt_pk_bf16_f32 v130, v170, v171
v_cvt_pk_bf16_f32 v131, v172, v173
ds_read_b128 v[110:113], v210 offset:6144
ds_read_b128 v[220:223], v210 offset:7168
s_waitcnt lgkmcnt(1)
v_mfma_f32_16x16x32_bf16 v[138:141], a[0:3], v[110:113], 0
s_waitcnt lgkmcnt(0)
v_mfma_f32_16x16x32_bf16 v[138:141], a[4:7], v[220:223], v[138:141]
v_mfma_f32_16x16x32_bf16 v[142:145], a[24:27], v[110:113], 0
v_mfma_f32_16x16x32_bf16 v[142:145], a[28:31], v[220:223], v[142:145]
v_mfma_f32_16x16x32_bf16 v[146:149], a[48:51], v[110:113], 0
v_mfma_f32_16x16x32_bf16 v[146:149], a[52:55], v[220:223], v[146:149]
v_mfma_f32_16x16x32_bf16 v[150:153], a[216:219], v[110:113], 0
v_mfma_f32_16x16x32_bf16 v[150:153], a[220:223], v[220:223], v[150:153]
v_mfma_f32_16x16x32_bf16 v[154:157], a[240:243], v[110:113], 0
v_mfma_f32_16x16x32_bf16 v[154:157], a[244:247], v[220:223], v[154:157]
v_mfma_f32_16x16x32_bf16 v[158:161], v[232:235], v[110:113], 0
v_mfma_f32_16x16x32_bf16 v[158:161], v[236:239], v[220:223], v[158:161]
v_mfma_f32_16x16x32_bf16 v[162:165], v[110:113], a[72:75], 0
v_mfma_f32_16x16x32_bf16 v[162:165], v[220:223], a[76:79], v[162:165]
v_mfma_f32_16x16x32_bf16 v[166:169], v[110:113], a[96:99], 0
v_mfma_f32_16x16x32_bf16 v[166:169], v[220:223], a[100:103], v[166:169]
v_mfma_f32_16x16x32_bf16 v[170:173], v[110:113], a[120:123], 0
v_mfma_f32_16x16x32_bf16 v[170:173], v[220:223], a[124:127], v[170:173]
ds_read_b128 v[102:105], v210 offset:18432
ds_read_b128 v[106:109], v210 offset:19456
s_waitcnt lgkmcnt(1)
v_add_f32 v102, v102, v103
s_waitcnt lgkmcnt(0)
v_add_f32 v106, v106, v107
v_add_f32 v104, v104, v105
v_add_f32 v108, v108, v109
v_add_f32 v102, v102, v104
v_add_f32 v106, v106, v108
v_mul_f32 v103, s48, v102
v_mul_f32 v104, s73, v102
v_mul_f32 v106, s73, v106
v_fma_f32 v106, -v103, v104, v106
v_max_f32 v106, 0, v106
v_add_f32 v106, s49, v106
v_rsq_f32 v102, v106
s_nop 0
v_mul_f32_e64 v103, -v103, v102
ds_write_b64 v211, v[102:103] offset:20480
ds_read_b64 v[118:119], v219 offset:20480
ds_read_b64 v[126:127], v219 offset:20736
ds_read_b64 v[134:135], v219 offset:20992
s_waitcnt lgkmcnt(2)
v_fma_f32 v220, v36, v118, v119
v_fma_f32 v221, v37, v118, v119
v_cvt_pk_bf16_f32 v90, v220, v221
v_fma_f32 v222, v38, v118, v119
v_fma_f32 v223, v39, v118, v119
v_cvt_pk_bf16_f32 v91, v222, v223
v_fma_f32 v220, v40, v118, v119
v_fma_f32 v221, v41, v118, v119
v_cvt_pk_bf16_f32 v92, v220, v221
v_fma_f32 v222, v42, v118, v119
v_fma_f32 v223, v43, v118, v119
v_cvt_pk_bf16_f32 v93, v222, v223
ds_write_b128 v211, v[90:93] offset:20480
v_fma_f32 v220, v44, v118, v119
v_fma_f32 v221, v45, v118, v119
v_cvt_pk_bf16_f32 v94, v220, v221
v_fma_f32 v222, v46, v118, v119
v_fma_f32 v223, v47, v118, v119
v_cvt_pk_bf16_f32 v95, v222, v223
s_waitcnt lgkmcnt(2)
ds_write_b64 v212, v[94:95] offset:20480
v_fma_f32 v220, v48, v126, v127
v_fma_f32 v221, v49, v126, v127
v_cvt_pk_bf16_f32 v174, v220, v221
v_fma_f32 v222, v50, v126, v127
v_fma_f32 v223, v51, v126, v127
v_cvt_pk_bf16_f32 v175, v222, v223
v_fma_f32 v220, v52, v126, v127
v_fma_f32 v221, v53, v126, v127
v_cvt_pk_bf16_f32 v176, v220, v221
v_fma_f32 v222, v54, v126, v127
v_fma_f32 v223, v55, v126, v127
v_cvt_pk_bf16_f32 v177, v222, v223
ds_write_b128 v211, v[174:177] offset:26624
v_fma_f32 v220, v56, v126, v127
v_fma_f32 v221, v57, v126, v127
v_cvt_pk_bf16_f32 v178, v220, v221
v_fma_f32 v222, v58, v126, v127
v_fma_f32 v223, v59, v126, v127
v_cvt_pk_bf16_f32 v179, v222, v223
s_waitcnt lgkmcnt(3)
ds_write_b64 v212, v[178:179] offset:26624
v_fma_f32 v220, v60, v134, v135
v_fma_f32 v221, v61, v134, v135
v_cvt_pk_bf16_f32 v90, v220, v221
v_fma_f32 v222, v62, v134, v135
v_fma_f32 v223, v63, v134, v135
v_cvt_pk_bf16_f32 v91, v222, v223
v_fma_f32 v220, v64, v134, v135
v_fma_f32 v221, v65, v134, v135
v_cvt_pk_bf16_f32 v92, v220, v221
v_fma_f32 v222, v66, v134, v135
v_fma_f32 v223, v67, v134, v135
v_cvt_pk_bf16_f32 v93, v222, v223
ds_write_b128 v211, v[90:93] offset:32768
v_fma_f32 v220, v68, v134, v135
v_fma_f32 v221, v69, v134, v135
v_cvt_pk_bf16_f32 v94, v220, v221
v_fma_f32 v222, v70, v134, v135
v_fma_f32 v223, v71, v134, v135
v_cvt_pk_bf16_f32 v95, v222, v223
ds_write_b64 v212, v[94:95] offset:32768
ds_read_b128 v[182:185], v210 offset:8192
ds_read_b128 v[186:189], v210 offset:9216
s_waitcnt lgkmcnt(1)
v_mfma_f32_16x16x32_bf16 v[138:141], a[8:11], v[182:185], v[138:141]
s_waitcnt lgkmcnt(0)
v_mfma_f32_16x16x32_bf16 v[138:141], a[12:15], v[186:189], v[138:141]
v_mfma_f32_16x16x32_bf16 v[142:145], a[32:35], v[182:185], v[142:145]
v_mfma_f32_16x16x32_bf16 v[142:145], a[36:39], v[186:189], v[142:145]
v_mfma_f32_16x16x32_bf16 v[146:149], a[56:59], v[182:185], v[146:149]
v_mfma_f32_16x16x32_bf16 v[146:149], a[60:63], v[186:189], v[146:149]
v_mfma_f32_16x16x32_bf16 v[150:153], a[224:227], v[182:185], v[150:153]
v_mfma_f32_16x16x32_bf16 v[150:153], a[228:231], v[186:189], v[150:153]
v_mfma_f32_16x16x32_bf16 v[154:157], a[248:251], v[182:185], v[154:157]
v_mfma_f32_16x16x32_bf16 v[154:157], a[252:255], v[186:189], v[154:157]
v_mfma_f32_16x16x32_bf16 v[158:161], v[240:243], v[182:185], v[158:161]
v_mfma_f32_16x16x32_bf16 v[158:161], v[244:247], v[186:189], v[158:161]
v_mfma_f32_16x16x32_bf16 v[162:165], v[182:185], a[80:83], v[162:165]
v_mfma_f32_16x16x32_bf16 v[162:165], v[186:189], a[84:87], v[162:165]
v_mfma_f32_16x16x32_bf16 v[166:169], v[182:185], a[104:107], v[166:169]
v_mfma_f32_16x16x32_bf16 v[166:169], v[186:189], a[108:111], v[166:169]
v_mfma_f32_16x16x32_bf16 v[170:173], v[182:185], a[128:131], v[170:173]
v_mfma_f32_16x16x32_bf16 v[170:173], v[186:189], a[132:135], v[170:173]
ds_read_b128 v[110:113], v210 offset:10240
ds_read_b128 v[106:109], v210 offset:11264
s_waitcnt lgkmcnt(1)
v_mfma_f32_16x16x32_bf16 v[138:141], a[16:19], v[110:113], v[138:141]
s_waitcnt lgkmcnt(0)
v_mfma_f32_16x16x32_bf16 v[138:141], a[20:23], v[106:109], v[138:141]
v_mfma_f32_16x16x32_bf16 v[142:145], a[40:43], v[110:113], v[142:145]
v_mfma_f32_16x16x32_bf16 v[142:145], a[44:47], v[106:109], v[142:145]
v_mfma_f32_16x16x32_bf16 v[146:149], a[64:67], v[110:113], v[146:149]
v_mfma_f32_16x16x32_bf16 v[146:149], a[68:71], v[106:109], v[146:149]
v_mfma_f32_16x16x32_bf16 v[150:153], a[232:235], v[110:113], v[150:153]
v_mfma_f32_16x16x32_bf16 v[150:153], a[236:239], v[106:109], v[150:153]
v_mfma_f32_16x16x32_bf16 v[154:157], v[224:227], v[110:113], v[154:157]
v_mfma_f32_16x16x32_bf16 v[154:157], v[228:231], v[106:109], v[154:157]
v_mfma_f32_16x16x32_bf16 v[158:161], v[248:251], v[110:113], v[158:161]
v_mfma_f32_16x16x32_bf16 v[158:161], v[252:255], v[106:109], v[158:161]
v_mfma_f32_16x16x32_bf16 v[162:165], v[110:113], a[88:91], v[162:165]
v_mfma_f32_16x16x32_bf16 v[162:165], v[106:109], a[92:95], v[162:165]
v_mfma_f32_16x16x32_bf16 v[166:169], v[110:113], a[112:115], v[166:169]
v_mfma_f32_16x16x32_bf16 v[166:169], v[106:109], a[116:119], v[166:169]
v_mfma_f32_16x16x32_bf16 v[170:173], v[110:113], a[136:139], v[170:173]
v_mfma_f32_16x16x32_bf16 v[170:173], v[106:109], a[140:143], v[170:173]
v_cvt_pk_bf16_f32 v96, v138, v139
v_cvt_pk_bf16_f32 v97, v140, v141
v_cvt_pk_bf16_f32 v98, v142, v143
v_cvt_pk_bf16_f32 v99, v144, v145
v_cvt_pk_bf16_f32 v100, v146, v147
v_cvt_pk_bf16_f32 v101, v148, v149
v_cvt_pk_bf16_f32 v84, v150, v151
v_cvt_pk_bf16_f32 v85, v152, v153
v_cvt_pk_bf16_f32 v86, v154, v155
v_cvt_pk_bf16_f32 v87, v156, v157
v_cvt_pk_bf16_f32 v88, v158, v159
v_cvt_pk_bf16_f32 v89, v160, v161
v_cvt_pk_bf16_f32 v116, v162, v163
v_cvt_pk_bf16_f32 v117, v164, v165
v_cvt_pk_bf16_f32 v124, v166, v167
v_cvt_pk_bf16_f32 v125, v168, v169
v_cvt_pk_bf16_f32 v132, v170, v171
v_cvt_pk_bf16_f32 v133, v172, v173
ds_read_b128 v[182:185], v210 offset:12288
ds_read_b128 v[186:189], v210 offset:13312
s_waitcnt lgkmcnt(1)
v_mfma_f32_16x16x32_bf16 v[138:141], a[0:3], v[182:185], 0
s_waitcnt lgkmcnt(0)
v_mfma_f32_16x16x32_bf16 v[138:141], a[4:7], v[186:189], v[138:141]
v_mfma_f32_16x16x32_bf16 v[142:145], a[24:27], v[182:185], 0
v_mfma_f32_16x16x32_bf16 v[142:145], a[28:31], v[186:189], v[142:145]
v_mfma_f32_16x16x32_bf16 v[146:149], a[48:51], v[182:185], 0
v_mfma_f32_16x16x32_bf16 v[146:149], a[52:55], v[186:189], v[146:149]
ds_read_b128 v[170:173], v210 offset:14336
ds_read_b128 v[182:185], v210 offset:15360
s_waitcnt lgkmcnt(1)
v_mfma_f32_16x16x32_bf16 v[138:141], a[8:11], v[170:173], v[138:141]
s_waitcnt lgkmcnt(0)
v_mfma_f32_16x16x32_bf16 v[138:141], a[12:15], v[182:185], v[138:141]
v_mfma_f32_16x16x32_bf16 v[142:145], a[32:35], v[170:173], v[142:145]
v_mfma_f32_16x16x32_bf16 v[142:145], a[36:39], v[182:185], v[142:145]
v_mfma_f32_16x16x32_bf16 v[146:149], a[56:59], v[170:173], v[146:149]
v_mfma_f32_16x16x32_bf16 v[146:149], a[60:63], v[182:185], v[146:149]
ds_read_b128 v[186:189], v210 offset:16384
ds_read_b128 v[170:173], v210 offset:17408
s_waitcnt lgkmcnt(1)
v_mfma_f32_16x16x32_bf16 v[138:141], a[16:19], v[186:189], v[138:141]
s_waitcnt lgkmcnt(0)
v_mfma_f32_16x16x32_bf16 v[138:141], a[20:23], v[170:173], v[138:141]
v_mfma_f32_16x16x32_bf16 v[142:145], a[40:43], v[186:189], v[142:145]
v_mfma_f32_16x16x32_bf16 v[142:145], a[44:47], v[170:173], v[142:145]
v_mfma_f32_16x16x32_bf16 v[146:149], a[64:67], v[186:189], v[146:149]
v_mfma_f32_16x16x32_bf16 v[146:149], a[68:71], v[170:173], v[146:149]
v_cvt_pk_bf16_f32 v102, v138, v139
v_cvt_pk_bf16_f32 v103, v140, v141
v_cvt_pk_bf16_f32 v104, v142, v143
v_cvt_pk_bf16_f32 v105, v144, v145
s_nop 2
v_cvt_pk_bf16_f32 v106, v146, v147
v_cvt_pk_bf16_f32 v107, v148, v149
ds_read_b128 v[108:111], v215 offset:512
ds_read_b64 v[112:113], v215 offset:528
v_mfma_f32_16x16x32_bf16 v[138:141], v[78:81], v[72:75], 0
v_mfma_f32_16x16x32_bf16 v[142:145], v[96:99], v[72:75], 0
s_waitcnt lgkmcnt(1)
v_mfma_f32_16x16x32_bf16 v[150:153], v[108:111], v[72:75], v[206:209]
v_mfma_f32_16x16x32_bf16 v[146:149], v[102:105], v[72:75], 0
v_mfma_f32_16x16x16_bf16 v[138:141], v[82:83], v[76:77], v[138:141]
v_mfma_f32_16x16x16_bf16 v[142:145], v[100:101], v[76:77], v[142:145]
s_waitcnt lgkmcnt(0)
v_mfma_f32_16x16x16_bf16 v[150:153], v[112:113], v[76:77], v[150:153]
v_mfma_f32_16x16x16_bf16 v[146:149], v[106:107], v[76:77], v[146:149]
ds_read_b128 v[72:75], v215
ds_read_b64 v[76:77], v215 offset:16
v_mfma_f32_16x16x16_bf16 v[154:157], v[82:83], v[88:89], 0
v_mfma_f32_16x16x16_bf16 v[158:161], v[100:101], v[88:89], 0
v_mfma_f32_16x16x16_bf16 v[166:169], v[112:113], v[88:89], v[206:209]
v_mfma_f32_16x16x16_bf16 v[162:165], v[106:107], v[88:89], 0
v_mfma_f32_16x16x32_bf16 v[154:157], v[78:81], v[84:87], v[154:157]
v_mfma_f32_16x16x32_bf16 v[158:161], v[96:99], v[84:87], v[158:161]
v_mfma_f32_16x16x32_bf16 v[166:169], v[108:111], v[84:87], v[166:169]
v_mfma_f32_16x16x32_bf16 v[162:165], v[102:105], v[84:87], v[162:165]
ds_read_b128 v[182:185], v210 offset:12288
ds_read_b128 v[186:189], v210 offset:13312
s_waitcnt lgkmcnt(1)
v_mfma_f32_16x16x32_bf16 v[118:121], v[182:185], a[72:75], 0
s_waitcnt lgkmcnt(0)
v_mfma_f32_16x16x32_bf16 v[118:121], v[186:189], a[76:79], v[118:121]
v_mfma_f32_16x16x32_bf16 v[126:129], v[182:185], a[96:99], 0
v_mfma_f32_16x16x32_bf16 v[126:129], v[186:189], a[100:103], v[126:129]
v_mfma_f32_16x16x32_bf16 v[134:137], v[182:185], a[120:123], 0
v_mfma_f32_16x16x32_bf16 v[134:137], v[186:189], a[124:127], v[134:137]
v_mfma_f32_16x16x32_bf16 v[90:93], a[216:219], v[182:185], 0
v_mfma_f32_16x16x32_bf16 v[90:93], a[220:223], v[186:189], v[90:93]
v_mfma_f32_16x16x32_bf16 v[170:173], a[240:243], v[182:185], 0
v_mfma_f32_16x16x32_bf16 v[170:173], a[244:247], v[186:189], v[170:173]
v_mfma_f32_16x16x32_bf16 v[220:223], v[232:235], v[182:185], 0
v_mfma_f32_16x16x32_bf16 v[220:223], v[236:239], v[186:189], v[220:223]
ds_read_b128 v[174:177], v210 offset:14336
ds_read_b128 v[178:181], v210 offset:15360
s_waitcnt lgkmcnt(1)
v_mfma_f32_16x16x32_bf16 v[118:121], v[174:177], a[80:83], v[118:121]
s_waitcnt lgkmcnt(0)
v_mfma_f32_16x16x32_bf16 v[118:121], v[178:181], a[84:87], v[118:121]
v_mfma_f32_16x16x32_bf16 v[126:129], v[174:177], a[104:107], v[126:129]
v_mfma_f32_16x16x32_bf16 v[126:129], v[178:181], a[108:111], v[126:129]
v_mfma_f32_16x16x32_bf16 v[134:137], v[174:177], a[128:131], v[134:137]
v_mfma_f32_16x16x32_bf16 v[134:137], v[178:181], a[132:135], v[134:137]
v_mfma_f32_16x16x32_bf16 v[90:93], a[224:227], v[174:177], v[90:93]
v_mfma_f32_16x16x32_bf16 v[90:93], a[228:231], v[178:181], v[90:93]
v_mfma_f32_16x16x32_bf16 v[170:173], a[248:251], v[174:177], v[170:173]
v_mfma_f32_16x16x32_bf16 v[170:173], a[252:255], v[178:181], v[170:173]
v_mfma_f32_16x16x32_bf16 v[220:223], v[240:243], v[174:177], v[220:223]
v_mfma_f32_16x16x32_bf16 v[220:223], v[244:247], v[178:181], v[220:223]
ds_read_b128 v[182:185], v210 offset:16384
ds_read_b128 v[186:189], v210 offset:17408
s_waitcnt lgkmcnt(1)
v_mfma_f32_16x16x32_bf16 v[118:121], v[182:185], a[88:91], v[118:121]
s_waitcnt lgkmcnt(0)
v_mfma_f32_16x16x32_bf16 v[118:121], v[186:189], a[92:95], v[118:121]
v_mfma_f32_16x16x32_bf16 v[126:129], v[182:185], a[112:115], v[126:129]
v_mfma_f32_16x16x32_bf16 v[126:129], v[186:189], a[116:119], v[126:129]
v_mfma_f32_16x16x32_bf16 v[134:137], v[182:185], a[136:139], v[134:137]
v_mfma_f32_16x16x32_bf16 v[134:137], v[186:189], a[140:143], v[134:137]
v_mfma_f32_16x16x32_bf16 v[90:93], a[232:235], v[182:185], v[90:93]
v_mfma_f32_16x16x32_bf16 v[90:93], a[236:239], v[186:189], v[90:93]
v_mfma_f32_16x16x32_bf16 v[170:173], v[224:227], v[182:185], v[170:173]
v_mfma_f32_16x16x32_bf16 v[170:173], v[228:231], v[186:189], v[170:173]
v_mfma_f32_16x16x32_bf16 v[220:223], v[248:251], v[182:185], v[220:223]
v_mfma_f32_16x16x32_bf16 v[220:223], v[252:255], v[186:189], v[220:223]
v_mov_b32 v181, 0
v_cvt_pk_bf16_f32 v118, v118, v119
v_cvt_pk_bf16_f32 v119, v120, v121
ds_read_u16 v120, v205
v_mov_b32 v121, 0
v_cvt_pk_bf16_f32 v126, v126, v127
v_cvt_pk_bf16_f32 v127, v128, v129
ds_read_u16 v128, v205 offset:32
v_mov_b32 v129, 0
v_cvt_pk_bf16_f32 v134, v134, v135
v_cvt_pk_bf16_f32 v135, v136, v137
ds_read_u16 v136, v205 offset:64
v_mov_b32 v137, 0
v_add_u32 v205, 1424, v205
v_cvt_pk_bf16_f32 v90, v90, v91
v_cvt_pk_bf16_f32 v91, v92, v93
v_cvt_pk_bf16_f32 v92, v170, v171
v_cvt_pk_bf16_f32 v93, v172, v173
v_cvt_pk_bf16_f32 v94, v220, v221
v_cvt_pk_bf16_f32 v95, v222, v223
v_max3_f32 v151, v138, v139, v140
v_max3_f32 v151, v151, v141, v142
v_max3_f32 v151, v151, v143, v144
v_max3_f32 v151, v151, v145, v146
v_max3_f32 v151, v151, v147, v148
v_max3_f32 v151, v151, v149, v150
v_mov_b32 v152, v151
s_nop 1
v_permlane16_swap_b32 v151, v152
v_max_f32 v151, v151, v152
v_mov_b32 v152, v151
s_nop 1
v_permlane32_swap_b32 v151, v152
v_max_f32 v151, v151, v152
v_sub_f32 v138, v138, v151
v_sub_f32 v139, v139, v151
v_sub_f32 v140, v140, v151
v_sub_f32 v141, v141, v151
v_sub_f32 v142, v142, v151
v_sub_f32 v143, v143, v151
v_sub_f32 v144, v144, v151
v_sub_f32 v145, v145, v151
v_sub_f32 v150, v150, v151
v_sub_f32 v146, v146, v151
v_sub_f32 v147, v147, v151
v_sub_f32 v148, v148, v151
v_sub_f32 v149, v149, v151
v_exp_f32 v138, v138
v_exp_f32 v139, v139
v_exp_f32 v140, v140
v_exp_f32 v141, v141
v_exp_f32 v142, v142
v_exp_f32 v143, v143
v_exp_f32 v144, v144
v_exp_f32 v145, v145
v_exp_f32 v150, v150
v_exp_f32 v146, v146
v_exp_f32 v147, v147
v_exp_f32 v148, v148
v_exp_f32 v149, v149
v_cvt_pk_bf16_f32 v174, v138, v139
v_cvt_pk_bf16_f32 v175, v140, v141
v_cvt_pk_bf16_f32 v176, v142, v143
v_cvt_pk_bf16_f32 v177, v144, v145
v_cvt_pk_bf16_f32 v178, v146, v147
v_cvt_pk_bf16_f32 v179, v148, v149
v_cvt_pk_bf16_f32 v180, v150, 0
v_mfma_f32_16x16x32_bf16 v[150:153], v[190:193], v[174:177], 0
v_mfma_f32_16x16x32_bf16 v[150:153], v[190:193], v[178:181], v[150:153]
v_mfma_f32_16x16x32_bf16 v[138:141], v[114:117], v[174:177], 0
s_waitcnt lgkmcnt(2)
v_mfma_f32_16x16x32_bf16 v[138:141], v[118:121], v[178:181], v[138:141]
v_mfma_f32_16x16x32_bf16 v[142:145], v[122:125], v[174:177], 0
s_waitcnt lgkmcnt(1)
v_mfma_f32_16x16x32_bf16 v[142:145], v[126:129], v[178:181], v[142:145]
v_mfma_f32_16x16x32_bf16 v[146:149], v[130:133], v[174:177], 0
s_waitcnt lgkmcnt(0)
v_mfma_f32_16x16x32_bf16 v[146:149], v[134:137], v[178:181], v[146:149]
v_max3_f32 v167, v154, v155, v156
v_max3_f32 v167, v167, v157, v158
v_max3_f32 v167, v167, v159, v160
v_max3_f32 v167, v167, v161, v162
v_max3_f32 v167, v167, v163, v164
v_max3_f32 v167, v167, v165, v166
v_mov_b32 v168, v167
s_nop 1
v_permlane16_swap_b32 v167, v168
v_max_f32 v167, v167, v168
v_mov_b32 v168, v167
s_nop 1
v_permlane32_swap_b32 v167, v168
v_max_f32 v167, v167, v168
v_sub_f32 v154, v154, v167
v_sub_f32 v155, v155, v167
v_sub_f32 v156, v156, v167
v_sub_f32 v157, v157, v167
v_sub_f32 v158, v158, v167
v_sub_f32 v159, v159, v167
v_sub_f32 v160, v160, v167
v_sub_f32 v161, v161, v167
v_sub_f32 v166, v166, v167
v_sub_f32 v162, v162, v167
v_sub_f32 v163, v163, v167
v_sub_f32 v164, v164, v167
v_sub_f32 v165, v165, v167
v_exp_f32 v154, v154
v_exp_f32 v155, v155
v_exp_f32 v156, v156
v_exp_f32 v157, v157
v_exp_f32 v158, v158
v_exp_f32 v159, v159
v_exp_f32 v160, v160
v_exp_f32 v161, v161
v_exp_f32 v166, v166
v_exp_f32 v162, v162
v_exp_f32 v163, v163
v_exp_f32 v164, v164
v_exp_f32 v165, v165
v_cvt_pk_bf16_f32 v174, v154, v155
v_cvt_pk_bf16_f32 v175, v156, v157
v_cvt_pk_bf16_f32 v176, v158, v159
v_cvt_pk_bf16_f32 v177, v160, v161
v_cvt_pk_bf16_f32 v178, v162, v163
v_cvt_pk_bf16_f32 v179, v164, v165
v_cvt_pk_bf16_f32 v180, v166, 0
v_mfma_f32_16x16x32_bf16 v[166:169], v[190:193], v[174:177], 0
v_mfma_f32_16x16x32_bf16 v[166:169], v[190:193], v[178:181], v[166:169]
v_mfma_f32_16x16x32_bf16 v[154:157], v[114:117], v[174:177], 0
v_mfma_f32_16x16x32_bf16 v[154:157], v[118:121], v[178:181], v[154:157]
v_mfma_f32_16x16x32_bf16 v[158:161], v[122:125], v[174:177], 0
v_mfma_f32_16x16x32_bf16 v[158:161], v[126:129], v[178:181], v[158:161]
v_mfma_f32_16x16x32_bf16 v[162:165], v[130:133], v[174:177], 0
v_mfma_f32_16x16x32_bf16 v[162:165], v[134:137], v[178:181], v[162:165]
v_rcp_f32 v151, v150
s_nop 0
v_mul_f32 v152, s3, v151
v_mul_f32 v138, v138, v152
v_mul_f32 v139, v139, v152
v_cvt_pk_bf16_f32 v138, v138, v139
v_mul_f32 v140, v140, v152
v_mul_f32 v141, v141, v152
v_cvt_pk_bf16_f32 v139, v140, v141
v_mul_f32 v142, v142, v152
v_mul_f32 v143, v143, v152
v_cvt_pk_bf16_f32 v140, v142, v143
v_mul_f32 v144, v144, v152
v_mul_f32 v145, v145, v152
v_cvt_pk_bf16_f32 v141, v144, v145
ds_write_b128 v211, v[138:141] offset:38912
v_mul_f32 v146, v146, v152
v_mul_f32 v147, v147, v152
v_cvt_pk_bf16_f32 v142, v146, v147
v_mul_f32 v148, v148, v152
v_mul_f32 v149, v149, v152
v_cvt_pk_bf16_f32 v143, v148, v149
ds_write_b64 v212, v[142:143] offset:38912
v_mfma_f32_16x16x32_bf16 v[138:141], v[78:81], v[90:93], 0
v_mfma_f32_16x16x32_bf16 v[142:145], v[96:99], v[90:93], 0
v_mfma_f32_16x16x32_bf16 v[150:153], v[108:111], v[90:93], v[206:209]
v_mfma_f32_16x16x32_bf16 v[146:149], v[102:105], v[90:93], 0
v_mfma_f32_16x16x16_bf16 v[138:141], v[82:83], v[94:95], v[138:141]
v_mfma_f32_16x16x16_bf16 v[142:145], v[100:101], v[94:95], v[142:145]
v_mfma_f32_16x16x16_bf16 v[150:153], v[112:113], v[94:95], v[150:153]
v_mfma_f32_16x16x16_bf16 v[146:149], v[106:107], v[94:95], v[146:149]
v_rcp_f32 v167, v166
s_nop 0
v_mul_f32 v168, s3, v167
v_mul_f32 v154, v154, v168
v_mul_f32 v155, v155, v168
v_cvt_pk_bf16_f32 v154, v154, v155
v_mul_f32 v156, v156, v168
v_mul_f32 v157, v157, v168
v_cvt_pk_bf16_f32 v155, v156, v157
v_mul_f32 v158, v158, v168
v_mul_f32 v159, v159, v168
v_cvt_pk_bf16_f32 v156, v158, v159
v_mul_f32 v160, v160, v168
v_mul_f32 v161, v161, v168
v_cvt_pk_bf16_f32 v157, v160, v161
ds_write_b128 v211, v[154:157] offset:45056
v_mul_f32 v162, v162, v168
v_mul_f32 v163, v163, v168
v_cvt_pk_bf16_f32 v158, v162, v163
v_mul_f32 v164, v164, v168
v_mul_f32 v165, v165, v168
v_cvt_pk_bf16_f32 v159, v164, v165
ds_write_b64 v212, v[158:159] offset:45056
v_mfma_f32_16x16x16_bf16 v[154:157], v[76:77], v[82:83], 0
v_mfma_f32_16x16x16_bf16 v[158:161], v[76:77], v[100:101], 0
v_mfma_f32_16x16x16_bf16 v[162:165], v[76:77], v[106:107], 0
v_mfma_f32_16x16x16_bf16 v[166:169], v[76:77], v[112:113], v[206:209]
v_mfma_f32_16x16x32_bf16 v[154:157], v[72:75], v[78:81], v[154:157]
v_mfma_f32_16x16x32_bf16 v[158:161], v[72:75], v[96:99], v[158:161]
v_mfma_f32_16x16x32_bf16 v[162:165], v[72:75], v[102:105], v[162:165]
v_mfma_f32_16x16x32_bf16 v[166:169], v[72:75], v[108:111], v[166:169]
v_mov_b32_dpp v154, v158 quad_perm:[0,1,2,3] row_mask:0x2 bank_mask:0xf
s_nop 1
v_mov_b32_dpp v154, v162 quad_perm:[0,1,2,3] row_mask:0x4 bank_mask:0xf
s_nop 2
v_mov_b32_dpp v154, v167 quad_perm:[0,1,2,3] row_mask:0x8 bank_mask:0xf
v_mov_b32 v155, v154
s_nop 1
v_max_f32_dpp v155, v155, v155 row_ror:8 row_mask:0xf bank_mask:0xf
s_nop 1
v_max_f32_dpp v155, v155, v155 row_ror:4 row_mask:0xf bank_mask:0xf
s_nop 1
v_max_f32_dpp v155, v155, v155 row_ror:2 row_mask:0xf bank_mask:0xf
s_nop 1
v_max_f32_dpp v155, v155, v155 row_ror:1 row_mask:0xf bank_mask:0xf
v_mov_b32 v156, v155
s_nop 1
v_permlane16_swap_b32 v155, v156
v_max_f32 v155, v155, v156
v_mov_b32 v156, v155
s_nop 1
v_permlane32_swap_b32 v155, v156
v_max_f32 v155, v155, v156
v_sub_f32 v154, v154, v155
v_exp_f32 v154, v154
s_nop 0
v_cvt_pk_bf16_f32 v154, v154, 0
ds_write_b16 v214, v154
ds_read_b128 v[84:87], v215
s_waitcnt lgkmcnt(2)
ds_read_b128 v[88:91], v215 offset:16
v_add_u32 v215, 1424, v215
s_barrier
ds_read_b128 v[220:223], v210 offset:38912
ds_read_b128 v[110:113], v210 offset:39936
s_waitcnt lgkmcnt(1)
v_mfma_f32_16x16x32_bf16 v[0:3], a[144:147], v[220:223], v[0:3]
s_waitcnt lgkmcnt(0)
v_mfma_f32_16x16x32_bf16 v[0:3], a[148:151], v[110:113], v[0:3]
v_mfma_f32_16x16x32_bf16 v[4:7], a[168:171], v[220:223], v[4:7]
v_mfma_f32_16x16x32_bf16 v[4:7], a[172:175], v[110:113], v[4:7]
v_mfma_f32_16x16x32_bf16 v[8:11], a[192:195], v[220:223], v[8:11]
v_mfma_f32_16x16x32_bf16 v[8:11], a[196:199], v[110:113], v[8:11]
ds_read_b128 v[170:173], v210 offset:40960
ds_read_b128 v[182:185], v210 offset:41984
s_waitcnt lgkmcnt(1)
v_mfma_f32_16x16x32_bf16 v[0:3], a[152:155], v[170:173], v[0:3]
s_waitcnt lgkmcnt(0)
v_mfma_f32_16x16x32_bf16 v[0:3], a[156:159], v[182:185], v[0:3]
v_mfma_f32_16x16x32_bf16 v[4:7], a[176:179], v[170:173], v[4:7]
v_mfma_f32_16x16x32_bf16 v[4:7], a[180:183], v[182:185], v[4:7]
v_mfma_f32_16x16x32_bf16 v[8:11], a[200:203], v[170:173], v[8:11]
v_mfma_f32_16x16x32_bf16 v[8:11], a[204:207], v[182:185], v[8:11]
ds_read_b128 v[186:189], v210 offset:43008
ds_read_b128 v[220:223], v210 offset:44032
s_waitcnt lgkmcnt(1)
v_mfma_f32_16x16x32_bf16 v[0:3], a[160:163], v[186:189], v[0:3]
s_waitcnt lgkmcnt(0)
v_mfma_f32_16x16x32_bf16 v[0:3], a[164:167], v[220:223], v[0:3]
v_mfma_f32_16x16x32_bf16 v[4:7], a[184:187], v[186:189], v[4:7]
v_mfma_f32_16x16x32_bf16 v[4:7], a[188:191], v[220:223], v[4:7]
v_mfma_f32_16x16x32_bf16 v[8:11], a[208:211], v[186:189], v[8:11]
v_mfma_f32_16x16x32_bf16 v[8:11], a[212:215], v[220:223], v[8:11]
v_cvt_pk_bf16_f32 v0, v0, v1
v_cvt_pk_bf16_f32 v1, v2, v3
ds_write_b64 v203, v[0:1]
v_cvt_pk_bf16_f32 v4, v4, v5
v_cvt_pk_bf16_f32 v5, v6, v7
ds_write_b64 v203, v[4:5] offset:32
v_cvt_pk_bf16_f32 v8, v8, v9
v_cvt_pk_bf16_f32 v9, v10, v11
ds_write_b64 v203, v[8:9] offset:64
v_max3_f32 v151, v138, v139, v140
v_max3_f32 v151, v151, v141, v142
v_max3_f32 v151, v151, v143, v144
v_max3_f32 v151, v151, v145, v146
v_max3_f32 v151, v151, v147, v148
v_max3_f32 v151, v151, v149, v150
v_mov_b32 v152, v151
s_nop 1
v_permlane16_swap_b32 v151, v152
v_max_f32 v151, v151, v152
v_mov_b32 v152, v151
s_nop 1
v_permlane32_swap_b32 v151, v152
v_max_f32 v151, v151, v152
v_sub_f32 v138, v138, v151
v_sub_f32 v139, v139, v151
v_sub_f32 v140, v140, v151
v_sub_f32 v141, v141, v151
v_sub_f32 v142, v142, v151
v_sub_f32 v143, v143, v151
v_sub_f32 v144, v144, v151
v_sub_f32 v145, v145, v151
v_sub_f32 v150, v150, v151
v_sub_f32 v146, v146, v151
v_sub_f32 v147, v147, v151
v_sub_f32 v148, v148, v151
v_sub_f32 v149, v149, v151
v_exp_f32 v138, v138
v_exp_f32 v139, v139
v_exp_f32 v140, v140
v_exp_f32 v141, v141
v_exp_f32 v142, v142
v_exp_f32 v143, v143
v_exp_f32 v144, v144
v_exp_f32 v145, v145
v_exp_f32 v150, v150
v_exp_f32 v146, v146
v_exp_f32 v147, v147
v_exp_f32 v148, v148
v_exp_f32 v149, v149
v_cvt_pk_bf16_f32 v174, v138, v139
v_cvt_pk_bf16_f32 v175, v140, v141
v_cvt_pk_bf16_f32 v176, v142, v143
v_cvt_pk_bf16_f32 v177, v144, v145
v_cvt_pk_bf16_f32 v178, v146, v147
v_cvt_pk_bf16_f32 v179, v148, v149
v_cvt_pk_bf16_f32 v180, v150, 0
v_mfma_f32_16x16x32_bf16 v[150:153], v[190:193], v[174:177], 0
v_mfma_f32_16x16x32_bf16 v[150:153], v[190:193], v[178:181], v[150:153]
v_mfma_f32_16x16x32_bf16 v[138:141], v[114:117], v[174:177], 0
v_mfma_f32_16x16x32_bf16 v[138:141], v[118:121], v[178:181], v[138:141]
v_mfma_f32_16x16x32_bf16 v[142:145], v[122:125], v[174:177], 0
v_mfma_f32_16x16x32_bf16 v[142:145], v[126:129], v[178:181], v[142:145]
v_mfma_f32_16x16x32_bf16 v[146:149], v[130:133], v[174:177], 0
v_mfma_f32_16x16x32_bf16 v[146:149], v[134:137], v[178:181], v[146:149]
v_rcp_f32 v151, v150
s_nop 0
v_mul_f32 v152, s3, v151
v_mul_f32 v138, v138, v152
v_mul_f32 v139, v139, v152
v_cvt_pk_bf16_f32 v138, v138, v139
v_mul_f32 v140, v140, v152
v_mul_f32 v141, v141, v152
v_cvt_pk_bf16_f32 v139, v140, v141
v_mul_f32 v142, v142, v152
v_mul_f32 v143, v143, v152
v_cvt_pk_bf16_f32 v140, v142, v143
v_mul_f32 v144, v144, v152
v_mul_f32 v145, v145, v152
v_cvt_pk_bf16_f32 v141, v144, v145
ds_write_b128 v211, v[138:141] offset:51200
v_mul_f32 v146, v146, v152
v_mul_f32 v147, v147, v152
v_cvt_pk_bf16_f32 v142, v146, v147
v_mul_f32 v148, v148, v152
v_mul_f32 v149, v149, v152
v_cvt_pk_bf16_f32 v143, v148, v149
ds_write_b64 v212, v[142:143] offset:51200
v_mfma_f32_16x16x32_bf16 v[166:169], v[84:87], v[190:193], 0
v_mfma_f32_16x16x32_bf16 v[166:169], v[88:91], v[190:193], v[166:169]
v_mfma_f32_16x16x32_bf16 v[154:157], v[84:87], v[114:117], 0
v_mfma_f32_16x16x32_bf16 v[154:157], v[88:91], v[118:121], v[154:157]
v_mfma_f32_16x16x32_bf16 v[158:161], v[84:87], v[122:125], 0
v_mfma_f32_16x16x32_bf16 v[158:161], v[88:91], v[126:129], v[158:161]
v_mfma_f32_16x16x32_bf16 v[162:165], v[84:87], v[130:133], 0
v_mfma_f32_16x16x32_bf16 v[162:165], v[88:91], v[134:137], v[162:165]
v_rcp_f32 v167, v166
v_mov_b32_dpp v154, v158 quad_perm:[0,1,2,3] row_mask:0x2 bank_mask:0xf
s_nop 3
v_mov_b32_dpp v154, v162 quad_perm:[0,1,2,3] row_mask:0x4 bank_mask:0xf
v_mul_f32 v168, s3, v167
v_mul_f32 v154, v154, v168
v_cvt_pk_bf16_f32 v154, v154, 0
ds_write_b16 v214, v154
v_add_u32 v214, 1424, v214
ds_read_b128 v[110:113], v210 offset:45056
ds_read_b128 v[170:173], v210 offset:46080
s_waitcnt lgkmcnt(1)
v_mfma_f32_16x16x32_bf16 v[12:15], a[144:147], v[110:113], v[12:15]
s_waitcnt lgkmcnt(0)
v_mfma_f32_16x16x32_bf16 v[12:15], a[148:151], v[170:173], v[12:15]
v_mfma_f32_16x16x32_bf16 v[16:19], a[168:171], v[110:113], v[16:19]
v_mfma_f32_16x16x32_bf16 v[16:19], a[172:175], v[170:173], v[16:19]
v_mfma_f32_16x16x32_bf16 v[20:23], a[192:195], v[110:113], v[20:23]
v_mfma_f32_16x16x32_bf16 v[20:23], a[196:199], v[170:173], v[20:23]
ds_read_b128 v[182:185], v210 offset:47104
ds_read_b128 v[186:189], v210 offset:48128
s_waitcnt lgkmcnt(1)
v_mfma_f32_16x16x32_bf16 v[12:15], a[152:155], v[182:185], v[12:15]
s_waitcnt lgkmcnt(0)
v_mfma_f32_16x16x32_bf16 v[12:15], a[156:159], v[186:189], v[12:15]
v_mfma_f32_16x16x32_bf16 v[16:19], a[176:179], v[182:185], v[16:19]
v_mfma_f32_16x16x32_bf16 v[16:19], a[180:183], v[186:189], v[16:19]
v_mfma_f32_16x16x32_bf16 v[20:23], a[200:203], v[182:185], v[20:23]
v_mfma_f32_16x16x32_bf16 v[20:23], a[204:207], v[186:189], v[20:23]
ds_read_b128 v[220:223], v210 offset:49152
ds_read_b128 v[110:113], v210 offset:50176
s_waitcnt lgkmcnt(1)
v_mfma_f32_16x16x32_bf16 v[12:15], a[160:163], v[220:223], v[12:15]
s_waitcnt lgkmcnt(0)
v_mfma_f32_16x16x32_bf16 v[12:15], a[164:167], v[110:113], v[12:15]
v_mfma_f32_16x16x32_bf16 v[16:19], a[184:187], v[220:223], v[16:19]
v_mfma_f32_16x16x32_bf16 v[16:19], a[188:191], v[110:113], v[16:19]
v_mfma_f32_16x16x32_bf16 v[20:23], a[208:211], v[220:223], v[20:23]
v_mfma_f32_16x16x32_bf16 v[20:23], a[212:215], v[110:113], v[20:23]
s_sub_u32 s46, s46, 1
v_cvt_pk_bf16_f32 v12, v12, v13
v_cvt_pk_bf16_f32 v13, v14, v15
ds_write_b64 v203, v[12:13] offset:6272
v_cvt_pk_bf16_f32 v16, v16, v17
v_cvt_pk_bf16_f32 v17, v18, v19
ds_write_b64 v203, v[16:17] offset:6304
v_cvt_pk_bf16_f32 v20, v20, v21
v_cvt_pk_bf16_f32 v21, v22, v23
ds_write_b64 v203, v[20:21] offset:6336
s_cbranch_scc0 G_loop
G_tail:
s_waitcnt vmcnt(0)
s_barrier
ds_read_b64 v[120:121], v204
s_add_u32 s28, s38, s60
s_waitcnt lgkmcnt(0)
buffer_store_dwordx2 v[120:121], v204, s[8:11], s28 offen sc1
ds_read_b64 v[128:129], v204 offset:392
s_add_u32 s29, s38, s61
s_waitcnt lgkmcnt(0)
buffer_store_dwordx2 v[128:129], v204, s[8:11], s29 offen sc1
ds_read_b64 v[136:137], v204 offset:784
s_add_u32 s28, s38, s62
s_waitcnt lgkmcnt(0)
buffer_store_dwordx2 v[136:137], v204, s[8:11], s28 offen sc1
ds_read_b64 v[120:121], v204 offset:1176
s_add_u32 s29, s38, s63
s_waitcnt lgkmcnt(0)
buffer_store_dwordx2 v[120:121], v204, s[8:11], s29 offen sc1
ds_read_b128 v[170:173], v210 offset:51200
ds_read_b128 v[182:185], v210 offset:52224
s_waitcnt lgkmcnt(1)
v_mfma_f32_16x16x32_bf16 v[24:27], a[144:147], v[170:173], v[24:27]
s_waitcnt lgkmcnt(0)
v_mfma_f32_16x16x32_bf16 v[24:27], a[148:151], v[182:185], v[24:27]
v_mfma_f32_16x16x32_bf16 v[28:31], a[168:171], v[170:173], v[28:31]
v_mfma_f32_16x16x32_bf16 v[28:31], a[172:175], v[182:185], v[28:31]
v_mfma_f32_16x16x32_bf16 v[32:35], a[192:195], v[170:173], v[32:35]
v_mfma_f32_16x16x32_bf16 v[32:35], a[196:199], v[182:185], v[32:35]
ds_read_b128 v[186:189], v210 offset:53248
ds_read_b128 v[220:223], v210 offset:54272
s_waitcnt lgkmcnt(1)
v_mfma_f32_16x16x32_bf16 v[24:27], a[152:155], v[186:189], v[24:27]
s_waitcnt lgkmcnt(0)
v_mfma_f32_16x16x32_bf16 v[24:27], a[156:159], v[220:223], v[24:27]
v_mfma_f32_16x16x32_bf16 v[28:31], a[176:179], v[186:189], v[28:31]
v_mfma_f32_16x16x32_bf16 v[28:31], a[180:183], v[220:223], v[28:31]
v_mfma_f32_16x16x32_bf16 v[32:35], a[200:203], v[186:189], v[32:35]
v_mfma_f32_16x16x32_bf16 v[32:35], a[204:207], v[220:223], v[32:35]
ds_read_b128 v[110:113], v210 offset:55296
ds_read_b128 v[170:173], v210 offset:56320
s_waitcnt lgkmcnt(1)
v_mfma_f32_16x16x32_bf16 v[24:27], a[160:163], v[110:113], v[24:27]
s_waitcnt lgkmcnt(0)
v_mfma_f32_16x16x32_bf16 v[24:27], a[164:167], v[170:173], v[24:27]
v_mfma_f32_16x16x32_bf16 v[28:31], a[184:187], v[110:113], v[28:31]
v_mfma_f32_16x16x32_bf16 v[28:31], a[188:191], v[170:173], v[28:31]
v_mfma_f32_16x16x32_bf16 v[32:35], a[208:211], v[110:113], v[32:35]
v_mfma_f32_16x16x32_bf16 v[32:35], a[212:215], v[170:173], v[32:35]
v_cvt_pk_bf16_f32 v24, v24, v25
v_cvt_pk_bf16_f32 v25, v26, v27
ds_write_b64 v203, v[24:25] offset:12544
v_cvt_pk_bf16_f32 v28, v28, v29
v_cvt_pk_bf16_f32 v29, v30, v31
ds_write_b64 v203, v[28:29] offset:12576
v_cvt_pk_bf16_f32 v32, v32, v33
v_cvt_pk_bf16_f32 v33, v34, v35
ds_write_b64 v203, v[32:33] offset:12608
s_mov_b32 s39, s37
ds_read_b128 v[174:177], v217
ds_read_b128 v[84:87], v200
s_waitcnt lgkmcnt(0)
v_mfma_f32_16x16x32_bf16 v[0:3], v[174:177], v[84:87], 0
ds_read_b128 v[92:95], v201
s_waitcnt lgkmcnt(0)
v_mfma_f32_16x16x32_bf16 v[12:15], v[174:177], v[92:95], 0
ds_read_b128 v[100:103], v202
s_waitcnt lgkmcnt(0)
v_mfma_f32_16x16x32_bf16 v[24:27], v[174:177], v[100:103], 0
ds_read_b128 v[178:181], v217 offset:528
ds_read_b128 v[84:87], v194
ds_read_b128 v[88:91], v194 offset:16
s_waitcnt lgkmcnt(0)
v_smfmac_f32_16x16x64_bf16 v[0:3], v[178:181], v[84:91], v213
ds_read_b128 v[92:95], v195
ds_read_b128 v[96:99], v195 offset:16
s_waitcnt lgkmcnt(0)
v_smfmac_f32_16x16x64_bf16 v[12:15], v[178:181], v[92:99], v213
ds_read_b128 v[100:103], v196
ds_read_b128 v[104:107], v196 offset:16
s_waitcnt lgkmcnt(0)
v_smfmac_f32_16x16x64_bf16 v[24:27], v[178:181], v[100:107], v213
ds_read_b128 v[174:177], v217 offset:1056
ds_read_b128 v[84:87], v197
ds_read_b128 v[88:91], v197 offset:16
s_waitcnt lgkmcnt(0)
v_smfmac_f32_16x16x64_bf16 v[0:3], v[174:177], v[84:91], v213
ds_read_b128 v[92:95], v198
ds_read_b128 v[96:99], v198 offset:16
s_waitcnt lgkmcnt(0)
v_smfmac_f32_16x16x64_bf16 v[12:15], v[174:177], v[92:99], v213
ds_read_b128 v[100:103], v199
ds_read_b128 v[104:107], v199 offset:16
s_waitcnt lgkmcnt(0)
v_smfmac_f32_16x16x64_bf16 v[24:27], v[174:177], v[100:107], v213
ds_read_b128 v[178:181], v217 offset:1584
ds_read_b128 v[84:87], v200 offset:32
s_waitcnt lgkmcnt(0)
v_mfma_f32_16x16x32_bf16 v[4:7], v[178:181], v[84:87], 0
ds_read_b128 v[92:95], v201 offset:32
s_waitcnt lgkmcnt(0)
v_mfma_f32_16x16x32_bf16 v[16:19], v[178:181], v[92:95], 0
ds_read_b128 v[100:103], v202 offset:32
s_waitcnt lgkmcnt(0)
v_mfma_f32_16x16x32_bf16 v[28:31], v[178:181], v[100:103], 0
ds_read_b128 v[174:177], v217 offset:2112
ds_read_b128 v[84:87], v194 offset:32
ds_read_b128 v[88:91], v194 offset:48
s_waitcnt lgkmcnt(0)
v_smfmac_f32_16x16x64_bf16 v[4:7], v[174:177], v[84:91], v213
ds_read_b128 v[92:95], v195 offset:32
ds_read_b128 v[96:99], v195 offset:48
s_waitcnt lgkmcnt(0)
v_smfmac_f32_16x16x64_bf16 v[16:19], v[174:177], v[92:99], v213
ds_read_b128 v[100:103], v196 offset:32
ds_read_b128 v[104:107], v196 offset:48
s_waitcnt lgkmcnt(0)
v_smfmac_f32_16x16x64_bf16 v[28:31], v[174:177], v[100:107], v213
ds_read_b128 v[178:181], v217 offset:2640
ds_read_b128 v[84:87], v197 offset:32
ds_read_b128 v[88:91], v197 offset:48
s_waitcnt lgkmcnt(0)
v_smfmac_f32_16x16x64_bf16 v[4:7], v[178:181], v[84:91], v213
ds_read_b128 v[92:95], v198 offset:32
ds_read_b128 v[96:99], v198 offset:48
s_waitcnt lgkmcnt(0)
v_smfmac_f32_16x16x64_bf16 v[16:19], v[178:181], v[92:99], v213
ds_read_b128 v[100:103], v199 offset:32
ds_read_b128 v[104:107], v199 offset:48
s_waitcnt lgkmcnt(0)
v_smfmac_f32_16x16x64_bf16 v[28:31], v[178:181], v[100:107], v213
ds_read_b128 v[174:177], v217 offset:3168
ds_read_b128 v[84:87], v200 offset:64
s_waitcnt lgkmcnt(0)
v_mfma_f32_16x16x32_bf16 v[8:11], v[174:177], v[84:87], 0
ds_read_b128 v[92:95], v201 offset:64
s_waitcnt lgkmcnt(0)
v_mfma_f32_16x16x32_bf16 v[20:23], v[174:177], v[92:95], 0
ds_read_b128 v[100:103], v202 offset:64
s_waitcnt lgkmcnt(0)
v_mfma_f32_16x16x32_bf16 v[32:35], v[174:177], v[100:103], 0
ds_read_b128 v[178:181], v217 offset:3696
ds_read_b128 v[84:87], v194 offset:64
ds_read_b128 v[88:91], v194 offset:80
s_waitcnt lgkmcnt(0)
v_smfmac_f32_16x16x64_bf16 v[8:11], v[178:181], v[84:91], v213
ds_read_b128 v[92:95], v195 offset:64
ds_read_b128 v[96:99], v195 offset:80
s_waitcnt lgkmcnt(0)
v_smfmac_f32_16x16x64_bf16 v[20:23], v[178:181], v[92:99], v213
ds_read_b128 v[100:103], v196 offset:64
ds_read_b128 v[104:107], v196 offset:80
s_waitcnt lgkmcnt(0)
v_smfmac_f32_16x16x64_bf16 v[32:35], v[178:181], v[100:107], v213
ds_read_b128 v[174:177], v217 offset:4224
ds_read_b128 v[84:87], v197 offset:64
ds_read_b128 v[88:91], v197 offset:80
s_waitcnt lgkmcnt(0)
v_smfmac_f32_16x16x64_bf16 v[8:11], v[174:177], v[84:91], v213
ds_read_b128 v[92:95], v198 offset:64
ds_read_b128 v[96:99], v198 offset:80
s_waitcnt lgkmcnt(0)
v_smfmac_f32_16x16x64_bf16 v[20:23], v[174:177], v[92:99], v213
ds_read_b128 v[100:103], v199 offset:64
ds_read_b128 v[104:107], v199 offset:80
s_waitcnt lgkmcnt(0)
v_smfmac_f32_16x16x64_bf16 v[32:35], v[174:177], v[100:107], v213
v_add_f32 v118, v0, v1
v_mul_f32 v119, v0, v0
v_add_f32 v118, v118, v2
v_fmac_f32 v119, v1, v1
v_add_f32 v118, v118, v3
v_fmac_f32 v119, v2, v2
v_fmac_f32 v119, v3, v3
v_add_f32 v126, v12, v13
v_mul_f32 v127, v12, v12
v_add_f32 v126, v126, v14
v_fmac_f32 v127, v13, v13
v_add_f32 v126, v126, v15
v_fmac_f32 v127, v14, v14
v_fmac_f32 v127, v15, v15
v_add_f32 v134, v24, v25
v_mul_f32 v135, v24, v24
v_add_f32 v134, v134, v26
v_fmac_f32 v135, v25, v25
v_add_f32 v134, v134, v27
v_fmac_f32 v135, v26, v26
v_fmac_f32 v135, v27, v27
v_add_f32 v118, v118, v4
v_fmac_f32 v119, v4, v4
v_add_f32 v118, v118, v5
v_fmac_f32 v119, v5, v5
v_add_f32 v118, v118, v6
v_fmac_f32 v119, v6, v6
v_add_f32 v118, v118, v7
v_fmac_f32 v119, v7, v7
v_add_f32 v126, v126, v16
v_fmac_f32 v127, v16, v16
v_add_f32 v126, v126, v17
v_fmac_f32 v127, v17, v17
v_add_f32 v126, v126, v18
v_fmac_f32 v127, v18, v18
v_add_f32 v126, v126, v19
v_fmac_f32 v127, v19, v19
v_add_f32 v134, v134, v28
v_fmac_f32 v135, v28, v28
v_add_f32 v134, v134, v29
v_fmac_f32 v135, v29, v29
v_add_f32 v134, v134, v30
v_fmac_f32 v135, v30, v30
v_add_f32 v134, v134, v31
v_fmac_f32 v135, v31, v31
v_add_f32 v118, v118, v8
v_fmac_f32 v119, v8, v8
v_add_f32 v118, v118, v9
v_fmac_f32 v119, v9, v9
v_add_f32 v118, v118, v10
v_fmac_f32 v119, v10, v10
v_add_f32 v118, v118, v11
v_fmac_f32 v119, v11, v11
v_add_f32 v126, v126, v20
v_fmac_f32 v127, v20, v20
v_add_f32 v126, v126, v21
v_fmac_f32 v127, v21, v21
v_add_f32 v126, v126, v22
v_fmac_f32 v127, v22, v22
v_add_f32 v126, v126, v23
v_fmac_f32 v127, v23, v23
v_add_f32 v134, v134, v32
v_fmac_f32 v135, v32, v32
v_add_f32 v134, v134, v33
v_fmac_f32 v135, v33, v33
v_add_f32 v134, v134, v34
v_fmac_f32 v135, v34, v34
v_add_f32 v134, v134, v35
v_fmac_f32 v135, v35, v35
v_permlane16_swap_b32 v118, v119
v_add_f32 v118, v118, v119
v_permlane16_swap_b32 v126, v127
v_add_f32 v126, v126, v127
v_permlane16_swap_b32 v134, v135
v_add_f32 v134, v134, v135
v_permlane32_swap_b32 v118, v126
v_add_f32 v118, v118, v126
ds_write_b32 v209, v118
v_mov_b32 v135, v134
s_nop 1
v_permlane32_swap_b32 v134, v135
v_add_f32 v134, v134, v135
ds_write_b32 v209, v134 offset:512
s_waitcnt lgkmcnt(0)
s_barrier
ds_read_b64 v[128:129], v204 offset:6272
s_add_u32 s28, s38, s64
s_waitcnt lgkmcnt(0)
buffer_store_dwordx2 v[128:129], v204, s[8:11], s28 offen sc1
ds_read_b64 v[136:137], v204 offset:6664
s_add_u32 s29, s38, s65
s_waitcnt lgkmcnt(0)
buffer_store_dwordx2 v[136:137], v204, s[8:11], s29 offen sc1
ds_read_b64 v[120:121], v204 offset:7056
s_add_u32 s28, s38, s66
s_waitcnt lgkmcnt(0)
buffer_store_dwordx2 v[120:121], v204, s[8:11], s28 offen sc1
ds_read_b64 v[128:129], v204 offset:7448
s_add_u32 s29, s38, s67
s_waitcnt lgkmcnt(0)
buffer_store_dwordx2 v[128:129], v204, s[8:11], s29 offen sc1
ds_read_b64 v[136:137], v204 offset:12544
s_add_u32 s28, s38, s68
s_waitcnt lgkmcnt(0)
buffer_store_dwordx2 v[136:137], v204, s[8:11], s28 offen sc1
ds_read_b64 v[120:121], v204 offset:12936
s_add_u32 s29, s38, s69
s_waitcnt lgkmcnt(0)
buffer_store_dwordx2 v[120:121], v204, s[8:11], s29 offen sc1
ds_read_b64 v[128:129], v204 offset:13328
s_add_u32 s28, s38, s70
s_waitcnt lgkmcnt(0)
buffer_store_dwordx2 v[128:129], v204, s[8:11], s28 offen sc1
ds_read_b64 v[136:137], v204 offset:13720
s_add_u32 s29, s38, s71
s_waitcnt lgkmcnt(0)
buffer_store_dwordx2 v[136:137], v204, s[8:11], s29 offen sc1
s_mul_hi_u32 s41, s35, 58835169
s_mul_i32 s42, s41, 73
s_sub_u32 s42, s35, s42
s_mul_i32 s43, s41, 1373568
s_mul_i32 s51, s42, 2688
s_add_u32 s50, s43, s51
s_add_u32 s35, s35, 32
s_min_u32 s41, s41, 1
s_sub_u32 s41, 1, s41
s_lshl_b32 s41, s41, 30
s_add_u32 s52, s50, s41
s_min_u32 s43, s42, 1
s_lshl_b32 s43, s43, 27
s_sub_u32 s43, 536870911, s43
s_add_u32 s51, s42, 56
s_and_b32 s51, s51, 128
s_lshl_b32 s51, s51, 22
s_or_b32 s44, s43, s51
s_mov_b32 s37, s50
v_and_b32 v216, s44, v208
s_add_u32 m0, s45, 0
s_nop 0
buffer_load_dwordx4 v216, s[4:7], s52 offen nt lds
s_add_u32 m0, s45, 4112
s_add_u32 s40, s37, 196224
buffer_load_dwordx4 v216, s[4:7], s40 offen nt lds
s_add_u32 m0, s45, 8224
s_add_u32 s40, s37, 392448
buffer_load_dwordx4 v216, s[4:7], s40 offen nt lds
s_add_u32 m0, s45, 12336
s_add_u32 s40, s37, 588672
buffer_load_dwordx4 v216, s[4:7], s40 offen nt lds
s_add_u32 m0, s45, 16448
s_add_u32 s40, s37, 784896
buffer_load_dwordx4 v216, s[4:7], s40 offen nt lds
s_add_u32 m0, s45, 20560
s_add_u32 s40, s37, 981120
buffer_load_dwordx4 v216, s[4:7], s40 offen nt lds
s_add_u32 m0, s45, 24672
s_add_u32 s40, s37, 1177344
buffer_load_dwordx4 v216, s[4:7], s40 offen nt lds
s_add_u32 m0, s45, 28784
s_add_u32 s40, s37, 1373568
buffer_load_dwordx4 v216, s[4:7], s40 offen nt lds
s_add_u32 m0, s45, 32896
s_add_u32 s40, s37, 1569792
buffer_load_dwordx4 v216, s[4:7], s40 offen nt lds
ds_read_b128 v[182:185], v210 offset:20480
ds_read_b128 v[186:189], v210 offset:21504
s_waitcnt lgkmcnt(1)
v_mfma_f32_16x16x32_bf16 v[138:141], a[0:3], v[182:185], 0
s_waitcnt lgkmcnt(0)
v_mfma_f32_16x16x32_bf16 v[138:141], a[4:7], v[186:189], v[138:141]
v_mfma_f32_16x16x32_bf16 v[142:145], a[24:27], v[182:185], 0
v_mfma_f32_16x16x32_bf16 v[142:145], a[28:31], v[186:189], v[142:145]
v_mfma_f32_16x16x32_bf16 v[146:149], a[48:51], v[182:185], 0
v_mfma_f32_16x16x32_bf16 v[146:149], a[52:55], v[186:189], v[146:149]
v_mfma_f32_16x16x32_bf16 v[150:153], a[216:219], v[182:185], 0
v_mfma_f32_16x16x32_bf16 v[150:153], a[220:223], v[186:189], v[150:153]
v_mfma_f32_16x16x32_bf16 v[154:157], a[240:243], v[182:185], 0
v_mfma_f32_16x16x32_bf16 v[154:157], a[244:247], v[186:189], v[154:157]
v_mfma_f32_16x16x32_bf16 v[158:161], v[232:235], v[182:185], 0
v_mfma_f32_16x16x32_bf16 v[158:161], v[236:239], v[186:189], v[158:161]
v_mfma_f32_16x16x32_bf16 v[162:165], v[182:185], a[72:75], 0
v_mfma_f32_16x16x32_bf16 v[162:165], v[186:189], a[76:79], v[162:165]
v_mfma_f32_16x16x32_bf16 v[166:169], v[182:185], a[96:99], 0
v_mfma_f32_16x16x32_bf16 v[166:169], v[186:189], a[100:103], v[166:169]
v_mfma_f32_16x16x32_bf16 v[170:173], v[182:185], a[120:123], 0
v_mfma_f32_16x16x32_bf16 v[170:173], v[186:189], a[124:127], v[170:173]
ds_read_b128 v[110:113], v210 offset:22528
ds_read_b128 v[220:223], v210 offset:23552
s_waitcnt lgkmcnt(1)
v_mfma_f32_16x16x32_bf16 v[138:141], a[8:11], v[110:113], v[138:141]
s_waitcnt lgkmcnt(0)
v_mfma_f32_16x16x32_bf16 v[138:141], a[12:15], v[220:223], v[138:141]
v_mfma_f32_16x16x32_bf16 v[142:145], a[32:35], v[110:113], v[142:145]
v_mfma_f32_16x16x32_bf16 v[142:145], a[36:39], v[220:223], v[142:145]
v_mfma_f32_16x16x32_bf16 v[146:149], a[56:59], v[110:113], v[146:149]
v_mfma_f32_16x16x32_bf16 v[146:149], a[60:63], v[220:223], v[146:149]
v_mfma_f32_16x16x32_bf16 v[150:153], a[224:227], v[110:113], v[150:153]
v_mfma_f32_16x16x32_bf16 v[150:153], a[228:231], v[220:223], v[150:153]
v_mfma_f32_16x16x32_bf16 v[154:157], a[248:251], v[110:113], v[154:157]
v_mfma_f32_16x16x32_bf16 v[154:157], a[252:255], v[220:223], v[154:157]
v_mfma_f32_16x16x32_bf16 v[158:161], v[240:243], v[110:113], v[158:161]
v_mfma_f32_16x16x32_bf16 v[158:161], v[244:247], v[220:223], v[158:161]
v_mfma_f32_16x16x32_bf16 v[162:165], v[110:113], a[80:83], v[162:165]
v_mfma_f32_16x16x32_bf16 v[162:165], v[220:223], a[84:87], v[162:165]
v_mfma_f32_16x16x32_bf16 v[166:169], v[110:113], a[104:107], v[166:169]
v_mfma_f32_16x16x32_bf16 v[166:169], v[220:223], a[108:111], v[166:169]
v_mfma_f32_16x16x32_bf16 v[170:173], v[110:113], a[128:131], v[170:173]
v_mfma_f32_16x16x32_bf16 v[170:173], v[220:223], a[132:135], v[170:173]
ds_read_b128 v[182:185], v210 offset:24576
ds_read_b128 v[186:189], v210 offset:25600
s_waitcnt lgkmcnt(1)
v_mfma_f32_16x16x32_bf16 v[138:141], a[16:19], v[182:185], v[138:141]
s_waitcnt lgkmcnt(0)
v_mfma_f32_16x16x32_bf16 v[138:141], a[20:23], v[186:189], v[138:141]
v_mfma_f32_16x16x32_bf16 v[142:145], a[40:43], v[182:185], v[142:145]
v_mfma_f32_16x16x32_bf16 v[142:145], a[44:47], v[186:189], v[142:145]
v_mfma_f32_16x16x32_bf16 v[146:149], a[64:67], v[182:185], v[146:149]
v_mfma_f32_16x16x32_bf16 v[146:149], a[68:71], v[186:189], v[146:149]
v_mfma_f32_16x16x32_bf16 v[150:153], a[232:235], v[182:185], v[150:153]
v_mfma_f32_16x16x32_bf16 v[150:153], a[236:239], v[186:189], v[150:153]
v_mfma_f32_16x16x32_bf16 v[154:157], v[224:227], v[182:185], v[154:157]
v_mfma_f32_16x16x32_bf16 v[154:157], v[228:231], v[186:189], v[154:157]
v_mfma_f32_16x16x32_bf16 v[158:161], v[248:251], v[182:185], v[158:161]
v_mfma_f32_16x16x32_bf16 v[158:161], v[252:255], v[186:189], v[158:161]
v_mfma_f32_16x16x32_bf16 v[162:165], v[182:185], a[88:91], v[162:165]
v_mfma_f32_16x16x32_bf16 v[162:165], v[186:189], a[92:95], v[162:165]
v_mfma_f32_16x16x32_bf16 v[166:169], v[182:185], a[112:115], v[166:169]
v_mfma_f32_16x16x32_bf16 v[166:169], v[186:189], a[116:119], v[166:169]
v_mfma_f32_16x16x32_bf16 v[170:173], v[182:185], a[136:139], v[170:173]
v_mfma_f32_16x16x32_bf16 v[170:173], v[186:189], a[140:143], v[170:173]
v_cvt_pk_bf16_f32 v78, v138, v139
v_cvt_pk_bf16_f32 v79, v140, v141
v_cvt_pk_bf16_f32 v80, v142, v143
v_cvt_pk_bf16_f32 v81, v144, v145
v_cvt_pk_bf16_f32 v82, v146, v147
v_cvt_pk_bf16_f32 v83, v148, v149
v_cvt_pk_bf16_f32 v72, v150, v151
v_cvt_pk_bf16_f32 v73, v152, v153
v_cvt_pk_bf16_f32 v74, v154, v155
v_cvt_pk_bf16_f32 v75, v156, v157
v_cvt_pk_bf16_f32 v76, v158, v159
v_cvt_pk_bf16_f32 v77, v160, v161
v_cvt_pk_bf16_f32 v114, v162, v163
v_cvt_pk_bf16_f32 v115, v164, v165
v_cvt_pk_bf16_f32 v122, v166, v167
v_cvt_pk_bf16_f32 v123, v168, v169
v_cvt_pk_bf16_f32 v130, v170, v171
v_cvt_pk_bf16_f32 v131, v172, v173
ds_read_b128 v[110:113], v210 offset:26624
ds_read_b128 v[220:223], v210 offset:27648
s_waitcnt lgkmcnt(1)
v_mfma_f32_16x16x32_bf16 v[138:141], a[0:3], v[110:113], 0
s_waitcnt lgkmcnt(0)
v_mfma_f32_16x16x32_bf16 v[138:141], a[4:7], v[220:223], v[138:141]
v_mfma_f32_16x16x32_bf16 v[142:145], a[24:27], v[110:113], 0
v_mfma_f32_16x16x32_bf16 v[142:145], a[28:31], v[220:223], v[142:145]
v_mfma_f32_16x16x32_bf16 v[146:149], a[48:51], v[110:113], 0
v_mfma_f32_16x16x32_bf16 v[146:149], a[52:55], v[220:223], v[146:149]
v_mfma_f32_16x16x32_bf16 v[150:153], a[216:219], v[110:113], 0
v_mfma_f32_16x16x32_bf16 v[150:153], a[220:223], v[220:223], v[150:153]
v_mfma_f32_16x16x32_bf16 v[154:157], a[240:243], v[110:113], 0
v_mfma_f32_16x16x32_bf16 v[154:157], a[244:247], v[220:223], v[154:157]
v_mfma_f32_16x16x32_bf16 v[158:161], v[232:235], v[110:113], 0
v_mfma_f32_16x16x32_bf16 v[158:161], v[236:239], v[220:223], v[158:161]
v_mfma_f32_16x16x32_bf16 v[162:165], v[110:113], a[72:75], 0
v_mfma_f32_16x16x32_bf16 v[162:165], v[220:223], a[76:79], v[162:165]
v_mfma_f32_16x16x32_bf16 v[166:169], v[110:113], a[96:99], 0
v_mfma_f32_16x16x32_bf16 v[166:169], v[220:223], a[100:103], v[166:169]
v_mfma_f32_16x16x32_bf16 v[170:173], v[110:113], a[120:123], 0
v_mfma_f32_16x16x32_bf16 v[170:173], v[220:223], a[124:127], v[170:173]
ds_read_b128 v[102:105], v210 offset:18432
ds_read_b128 v[106:109], v210 offset:19456
s_waitcnt lgkmcnt(1)
v_add_f32 v102, v102, v103
s_waitcnt lgkmcnt(0)
v_add_f32 v106, v106, v107
v_add_f32 v104, v104, v105
v_add_f32 v108, v108, v109
v_add_f32 v102, v102, v104
v_add_f32 v106, v106, v108
v_mul_f32 v103, s48, v102
v_mul_f32 v104, s73, v102
v_mul_f32 v106, s73, v106
v_fma_f32 v106, -v103, v104, v106
v_max_f32 v106, 0, v106
v_add_f32 v106, s49, v106
v_rsq_f32 v102, v106
s_nop 0
v_mul_f32_e64 v103, -v103, v102
ds_write_b64 v211, v[102:103]
ds_read_b64 v[118:119], v219
ds_read_b64 v[126:127], v219 offset:256
ds_read_b64 v[134:135], v219 offset:512
s_waitcnt lgkmcnt(2)
v_fma_f32 v220, v0, v118, v119
v_fma_f32 v221, v1, v118, v119
v_cvt_pk_bf16_f32 v90, v220, v221
v_fma_f32 v222, v2, v118, v119
v_fma_f32 v223, v3, v118, v119
v_cvt_pk_bf16_f32 v91, v222, v223
v_fma_f32 v220, v4, v118, v119
v_fma_f32 v221, v5, v118, v119
v_cvt_pk_bf16_f32 v92, v220, v221
v_fma_f32 v222, v6, v118, v119
v_fma_f32 v223, v7, v118, v119
v_cvt_pk_bf16_f32 v93, v222, v223
ds_write_b128 v211, v[90:93]
v_fma_f32 v220, v8, v118, v119
v_fma_f32 v221, v9, v118, v119
v_cvt_pk_bf16_f32 v94, v220, v221
v_fma_f32 v222, v10, v118, v119
v_fma_f32 v223, v11, v118, v119
v_cvt_pk_bf16_f32 v95, v222, v223
s_waitcnt lgkmcnt(2)
ds_write_b64 v212, v[94:95]
v_fma_f32 v220, v12, v126, v127
v_fma_f32 v221, v13, v126, v127
v_cvt_pk_bf16_f32 v174, v220, v221
v_fma_f32 v222, v14, v126, v127
v_fma_f32 v223, v15, v126, v127
v_cvt_pk_bf16_f32 v175, v222, v223
v_fma_f32 v220, v16, v126, v127
v_fma_f32 v221, v17, v126, v127
v_cvt_pk_bf16_f32 v176, v220, v221
v_fma_f32 v222, v18, v126, v127
v_fma_f32 v223, v19, v126, v127
v_cvt_pk_bf16_f32 v177, v222, v223
ds_write_b128 v211, v[174:177] offset:6144
v_fma_f32 v220, v20, v126, v127
v_fma_f32 v221, v21, v126, v127
v_cvt_pk_bf16_f32 v178, v220, v221
v_fma_f32 v222, v22, v126, v127
v_fma_f32 v223, v23, v126, v127
v_cvt_pk_bf16_f32 v179, v222, v223
s_waitcnt lgkmcnt(3)
ds_write_b64 v212, v[178:179] offset:6144
v_fma_f32 v220, v24, v134, v135
v_fma_f32 v221, v25, v134, v135
v_cvt_pk_bf16_f32 v90, v220, v221
v_fma_f32 v222, v26, v134, v135
v_fma_f32 v223, v27, v134, v135
v_cvt_pk_bf16_f32 v91, v222, v223
v_fma_f32 v220, v28, v134, v135
v_fma_f32 v221, v29, v134, v135
v_cvt_pk_bf16_f32 v92, v220, v221
v_fma_f32 v222, v30, v134, v135
v_fma_f32 v223, v31, v134, v135
v_cvt_pk_bf16_f32 v93, v222, v223
ds_write_b128 v211, v[90:93] offset:12288
v_fma_f32 v220, v32, v134, v135
v_fma_f32 v221, v33, v134, v135
v_cvt_pk_bf16_f32 v94, v220, v221
v_fma_f32 v222, v34, v134, v135
v_fma_f32 v223, v35, v134, v135
v_cvt_pk_bf16_f32 v95, v222, v223
ds_write_b64 v212, v[94:95] offset:12288
ds_read_b128 v[182:185], v210 offset:28672
ds_read_b128 v[186:189], v210 offset:29696
s_waitcnt lgkmcnt(1)
v_mfma_f32_16x16x32_bf16 v[138:141], a[8:11], v[182:185], v[138:141]
s_waitcnt lgkmcnt(0)
v_mfma_f32_16x16x32_bf16 v[138:141], a[12:15], v[186:189], v[138:141]
v_mfma_f32_16x16x32_bf16 v[142:145], a[32:35], v[182:185], v[142:145]
v_mfma_f32_16x16x32_bf16 v[142:145], a[36:39], v[186:189], v[142:145]
v_mfma_f32_16x16x32_bf16 v[146:149], a[56:59], v[182:185], v[146:149]
v_mfma_f32_16x16x32_bf16 v[146:149], a[60:63], v[186:189], v[146:149]
v_mfma_f32_16x16x32_bf16 v[150:153], a[224:227], v[182:185], v[150:153]
v_mfma_f32_16x16x32_bf16 v[150:153], a[228:231], v[186:189], v[150:153]
v_mfma_f32_16x16x32_bf16 v[154:157], a[248:251], v[182:185], v[154:157]
v_mfma_f32_16x16x32_bf16 v[154:157], a[252:255], v[186:189], v[154:157]
v_mfma_f32_16x16x32_bf16 v[158:161], v[240:243], v[182:185], v[158:161]
v_mfma_f32_16x16x32_bf16 v[158:161], v[244:247], v[186:189], v[158:161]
v_mfma_f32_16x16x32_bf16 v[162:165], v[182:185], a[80:83], v[162:165]
v_mfma_f32_16x16x32_bf16 v[162:165], v[186:189], a[84:87], v[162:165]
v_mfma_f32_16x16x32_bf16 v[166:169], v[182:185], a[104:107], v[166:169]
v_mfma_f32_16x16x32_bf16 v[166:169], v[186:189], a[108:111], v[166:169]
v_mfma_f32_16x16x32_bf16 v[170:173], v[182:185], a[128:131], v[170:173]
v_mfma_f32_16x16x32_bf16 v[170:173], v[186:189], a[132:135], v[170:173]
ds_read_b128 v[110:113], v210 offset:30720
ds_read_b128 v[106:109], v210 offset:31744
s_waitcnt lgkmcnt(1)
v_mfma_f32_16x16x32_bf16 v[138:141], a[16:19], v[110:113], v[138:141]
s_waitcnt lgkmcnt(0)
v_mfma_f32_16x16x32_bf16 v[138:141], a[20:23], v[106:109], v[138:141]
v_mfma_f32_16x16x32_bf16 v[142:145], a[40:43], v[110:113], v[142:145]
v_mfma_f32_16x16x32_bf16 v[142:145], a[44:47], v[106:109], v[142:145]
v_mfma_f32_16x16x32_bf16 v[146:149], a[64:67], v[110:113], v[146:149]
v_mfma_f32_16x16x32_bf16 v[146:149], a[68:71], v[106:109], v[146:149]
v_mfma_f32_16x16x32_bf16 v[150:153], a[232:235], v[110:113], v[150:153]
v_mfma_f32_16x16x32_bf16 v[150:153], a[236:239], v[106:109], v[150:153]
v_mfma_f32_16x16x32_bf16 v[154:157], v[224:227], v[110:113], v[154:157]
v_mfma_f32_16x16x32_bf16 v[154:157], v[228:231], v[106:109], v[154:157]
v_mfma_f32_16x16x32_bf16 v[158:161], v[248:251], v[110:113], v[158:161]
v_mfma_f32_16x16x32_bf16 v[158:161], v[252:255], v[106:109], v[158:161]
v_mfma_f32_16x16x32_bf16 v[162:165], v[110:113], a[88:91], v[162:165]
v_mfma_f32_16x16x32_bf16 v[162:165], v[106:109], a[92:95], v[162:165]
v_mfma_f32_16x16x32_bf16 v[166:169], v[110:113], a[112:115], v[166:169]
v_mfma_f32_16x16x32_bf16 v[166:169], v[106:109], a[116:119], v[166:169]
v_mfma_f32_16x16x32_bf16 v[170:173], v[110:113], a[136:139], v[170:173]
v_mfma_f32_16x16x32_bf16 v[170:173], v[106:109], a[140:143], v[170:173]
v_cvt_pk_bf16_f32 v96, v138, v139
v_cvt_pk_bf16_f32 v97, v140, v141
v_cvt_pk_bf16_f32 v98, v142, v143
v_cvt_pk_bf16_f32 v99, v144, v145
v_cvt_pk_bf16_f32 v100, v146, v147
v_cvt_pk_bf16_f32 v101, v148, v149
v_cvt_pk_bf16_f32 v84, v150, v151
v_cvt_pk_bf16_f32 v85, v152, v153
v_cvt_pk_bf16_f32 v86, v154, v155
v_cvt_pk_bf16_f32 v87, v156, v157
v_cvt_pk_bf16_f32 v88, v158, v159
v_cvt_pk_bf16_f32 v89, v160, v161
v_cvt_pk_bf16_f32 v116, v162, v163
v_cvt_pk_bf16_f32 v117, v164, v165
v_cvt_pk_bf16_f32 v124, v166, v167
v_cvt_pk_bf16_f32 v125, v168, v169
v_cvt_pk_bf16_f32 v132, v170, v171
v_cvt_pk_bf16_f32 v133, v172, v173
ds_read_b128 v[182:185], v210 offset:32768
ds_read_b128 v[186:189], v210 offset:33792
s_waitcnt lgkmcnt(1)
v_mfma_f32_16x16x32_bf16 v[138:141], a[0:3], v[182:185], 0
s_waitcnt lgkmcnt(0)
v_mfma_f32_16x16x32_bf16 v[138:141], a[4:7], v[186:189], v[138:141]
v_mfma_f32_16x16x32_bf16 v[142:145], a[24:27], v[182:185], 0
v_mfma_f32_16x16x32_bf16 v[142:145], a[28:31], v[186:189], v[142:145]
v_mfma_f32_16x16x32_bf16 v[146:149], a[48:51], v[182:185], 0
v_mfma_f32_16x16x32_bf16 v[146:149], a[52:55], v[186:189], v[146:149]
ds_read_b128 v[170:173], v210 offset:34816
ds_read_b128 v[182:185], v210 offset:35840
s_waitcnt lgkmcnt(1)
v_mfma_f32_16x16x32_bf16 v[138:141], a[8:11], v[170:173], v[138:141]
s_waitcnt lgkmcnt(0)
v_mfma_f32_16x16x32_bf16 v[138:141], a[12:15], v[182:185], v[138:141]
v_mfma_f32_16x16x32_bf16 v[142:145], a[32:35], v[170:173], v[142:145]
v_mfma_f32_16x16x32_bf16 v[142:145], a[36:39], v[182:185], v[142:145]
v_mfma_f32_16x16x32_bf16 v[146:149], a[56:59], v[170:173], v[146:149]
v_mfma_f32_16x16x32_bf16 v[146:149], a[60:63], v[182:185], v[146:149]
ds_read_b128 v[186:189], v210 offset:36864
ds_read_b128 v[170:173], v210 offset:37888
s_waitcnt lgkmcnt(1)
v_mfma_f32_16x16x32_bf16 v[138:141], a[16:19], v[186:189], v[138:141]
s_waitcnt lgkmcnt(0)
v_mfma_f32_16x16x32_bf16 v[138:141], a[20:23], v[170:173], v[138:141]
v_mfma_f32_16x16x32_bf16 v[142:145], a[40:43], v[186:189], v[142:145]
v_mfma_f32_16x16x32_bf16 v[142:145], a[44:47], v[170:173], v[142:145]
v_mfma_f32_16x16x32_bf16 v[146:149], a[64:67], v[186:189], v[146:149]
v_mfma_f32_16x16x32_bf16 v[146:149], a[68:71], v[170:173], v[146:149]
v_cvt_pk_bf16_f32 v102, v138, v139
v_cvt_pk_bf16_f32 v103, v140, v141
v_cvt_pk_bf16_f32 v104, v142, v143
v_cvt_pk_bf16_f32 v105, v144, v145
s_nop 2
v_cvt_pk_bf16_f32 v106, v146, v147
v_cvt_pk_bf16_f32 v107, v148, v149
ds_read_b128 v[108:111], v215 offset:512
ds_read_b64 v[112:113], v215 offset:528
v_mfma_f32_16x16x32_bf16 v[138:141], v[78:81], v[72:75], 0
v_mfma_f32_16x16x32_bf16 v[142:145], v[96:99], v[72:75], 0
s_waitcnt lgkmcnt(1)
v_mfma_f32_16x16x32_bf16 v[150:153], v[108:111], v[72:75], v[206:209]
v_mfma_f32_16x16x32_bf16 v[146:149], v[102:105], v[72:75], 0
v_mfma_f32_16x16x16_bf16 v[138:141], v[82:83], v[76:77], v[138:141]
v_mfma_f32_16x16x16_bf16 v[142:145], v[100:101], v[76:77], v[142:145]
s_waitcnt lgkmcnt(0)
v_mfma_f32_16x16x16_bf16 v[150:153], v[112:113], v[76:77], v[150:153]
v_mfma_f32_16x16x16_bf16 v[146:149], v[106:107], v[76:77], v[146:149]
ds_read_b128 v[72:75], v215
ds_read_b64 v[76:77], v215 offset:16
v_mfma_f32_16x16x16_bf16 v[154:157], v[82:83], v[88:89], 0
v_mfma_f32_16x16x16_bf16 v[158:161], v[100:101], v[88:89], 0
v_mfma_f32_16x16x16_bf16 v[166:169], v[112:113], v[88:89], v[206:209]
v_mfma_f32_16x16x16_bf16 v[162:165], v[106:107], v[88:89], 0
v_mfma_f32_16x16x32_bf16 v[154:157], v[78:81], v[84:87], v[154:157]
v_mfma_f32_16x16x32_bf16 v[158:161], v[96:99], v[84:87], v[158:161]
v_mfma_f32_16x16x32_bf16 v[166:169], v[108:111], v[84:87], v[166:169]
v_mfma_f32_16x16x32_bf16 v[162:165], v[102:105], v[84:87], v[162:165]
ds_read_b128 v[182:185], v210 offset:32768
ds_read_b128 v[186:189], v210 offset:33792
s_waitcnt lgkmcnt(1)
v_mfma_f32_16x16x32_bf16 v[118:121], v[182:185], a[72:75], 0
s_waitcnt lgkmcnt(0)
v_mfma_f32_16x16x32_bf16 v[118:121], v[186:189], a[76:79], v[118:121]
v_mfma_f32_16x16x32_bf16 v[126:129], v[182:185], a[96:99], 0
v_mfma_f32_16x16x32_bf16 v[126:129], v[186:189], a[100:103], v[126:129]
v_mfma_f32_16x16x32_bf16 v[134:137], v[182:185], a[120:123], 0
v_mfma_f32_16x16x32_bf16 v[134:137], v[186:189], a[124:127], v[134:137]
v_mfma_f32_16x16x32_bf16 v[90:93], a[216:219], v[182:185], 0
v_mfma_f32_16x16x32_bf16 v[90:93], a[220:223], v[186:189], v[90:93]
v_mfma_f32_16x16x32_bf16 v[170:173], a[240:243], v[182:185], 0
v_mfma_f32_16x16x32_bf16 v[170:173], a[244:247], v[186:189], v[170:173]
v_mfma_f32_16x16x32_bf16 v[220:223], v[232:235], v[182:185], 0
v_mfma_f32_16x16x32_bf16 v[220:223], v[236:239], v[186:189], v[220:223]
ds_read_b128 v[174:177], v210 offset:34816
ds_read_b128 v[178:181], v210 offset:35840
s_waitcnt lgkmcnt(1)
v_mfma_f32_16x16x32_bf16 v[118:121], v[174:177], a[80:83], v[118:121]
s_waitcnt lgkmcnt(0)
v_mfma_f32_16x16x32_bf16 v[118:121], v[178:181], a[84:87], v[118:121]
v_mfma_f32_16x16x32_bf16 v[126:129], v[174:177], a[104:107], v[126:129]
v_mfma_f32_16x16x32_bf16 v[126:129], v[178:181], a[108:111], v[126:129]
v_mfma_f32_16x16x32_bf16 v[134:137], v[174:177], a[128:131], v[134:137]
v_mfma_f32_16x16x32_bf16 v[134:137], v[178:181], a[132:135], v[134:137]
v_mfma_f32_16x16x32_bf16 v[90:93], a[224:227], v[174:177], v[90:93]
v_mfma_f32_16x16x32_bf16 v[90:93], a[228:231], v[178:181], v[90:93]
v_mfma_f32_16x16x32_bf16 v[170:173], a[248:251], v[174:177], v[170:173]
v_mfma_f32_16x16x32_bf16 v[170:173], a[252:255], v[178:181], v[170:173]
v_mfma_f32_16x16x32_bf16 v[220:223], v[240:243], v[174:177], v[220:223]
v_mfma_f32_16x16x32_bf16 v[220:223], v[244:247], v[178:181], v[220:223]
ds_read_b128 v[182:185], v210 offset:36864
ds_read_b128 v[186:189], v210 offset:37888
s_waitcnt lgkmcnt(1)
v_mfma_f32_16x16x32_bf16 v[118:121], v[182:185], a[88:91], v[118:121]
s_waitcnt lgkmcnt(0)
v_mfma_f32_16x16x32_bf16 v[118:121], v[186:189], a[92:95], v[118:121]
v_mfma_f32_16x16x32_bf16 v[126:129], v[182:185], a[112:115], v[126:129]
v_mfma_f32_16x16x32_bf16 v[126:129], v[186:189], a[116:119], v[126:129]
v_mfma_f32_16x16x32_bf16 v[134:137], v[182:185], a[136:139], v[134:137]
v_mfma_f32_16x16x32_bf16 v[134:137], v[186:189], a[140:143], v[134:137]
v_mfma_f32_16x16x32_bf16 v[90:93], a[232:235], v[182:185], v[90:93]
v_mfma_f32_16x16x32_bf16 v[90:93], a[236:239], v[186:189], v[90:93]
v_mfma_f32_16x16x32_bf16 v[170:173], v[224:227], v[182:185], v[170:173]
v_mfma_f32_16x16x32_bf16 v[170:173], v[228:231], v[186:189], v[170:173]
v_mfma_f32_16x16x32_bf16 v[220:223], v[248:251], v[182:185], v[220:223]
v_mfma_f32_16x16x32_bf16 v[220:223], v[252:255], v[186:189], v[220:223]
v_mov_b32 v181, 0
v_cvt_pk_bf16_f32 v118, v118, v119
v_cvt_pk_bf16_f32 v119, v120, v121
ds_read_u16 v120, v205
v_mov_b32 v121, 0
v_cvt_pk_bf16_f32 v126, v126, v127
v_cvt_pk_bf16_f32 v127, v128, v129
ds_read_u16 v128, v205 offset:32
v_mov_b32 v129, 0
v_cvt_pk_bf16_f32 v134, v134, v135
v_cvt_pk_bf16_f32 v135, v136, v137
ds_read_u16 v136, v205 offset:64
v_mov_b32 v137, 0
v_add_u32 v205, 1424, v205
v_cvt_pk_bf16_f32 v90, v90, v91
v_cvt_pk_bf16_f32 v91, v92, v93
v_cvt_pk_bf16_f32 v92, v170, v171
v_cvt_pk_bf16_f32 v93, v172, v173
v_cvt_pk_bf16_f32 v94, v220, v221
v_cvt_pk_bf16_f32 v95, v222, v223
v_max3_f32 v151, v138, v139, v140
v_max3_f32 v151, v151, v141, v142
v_max3_f32 v151, v151, v143, v144
v_max3_f32 v151, v151, v145, v146
v_max3_f32 v151, v151, v147, v148
v_max3_f32 v151, v151, v149, v150
v_mov_b32 v152, v151
s_nop 1
v_permlane16_swap_b32 v151, v152
v_max_f32 v151, v151, v152
v_mov_b32 v152, v151
s_nop 1
v_permlane32_swap_b32 v151, v152
v_max_f32 v151, v151, v152
v_sub_f32 v138, v138, v151
v_sub_f32 v139, v139, v151
v_sub_f32 v140, v140, v151
v_sub_f32 v141, v141, v151
v_sub_f32 v142, v142, v151
v_sub_f32 v143, v143, v151
v_sub_f32 v144, v144, v151
v_sub_f32 v145, v145, v151
v_sub_f32 v150, v150, v151
v_sub_f32 v146, v146, v151
v_sub_f32 v147, v147, v151
v_sub_f32 v148, v148, v151
v_sub_f32 v149, v149, v151
v_exp_f32 v138, v138
v_exp_f32 v139, v139
v_exp_f32 v140, v140
v_exp_f32 v141, v141
v_exp_f32 v142, v142
v_exp_f32 v143, v143
v_exp_f32 v144, v144
v_exp_f32 v145, v145
v_exp_f32 v150, v150
v_exp_f32 v146, v146
v_exp_f32 v147, v147
v_exp_f32 v148, v148
v_exp_f32 v149, v149
v_cvt_pk_bf16_f32 v174, v138, v139
v_cvt_pk_bf16_f32 v175, v140, v141
v_cvt_pk_bf16_f32 v176, v142, v143
v_cvt_pk_bf16_f32 v177, v144, v145
v_cvt_pk_bf16_f32 v178, v146, v147
v_cvt_pk_bf16_f32 v179, v148, v149
v_cvt_pk_bf16_f32 v180, v150, 0
v_mfma_f32_16x16x32_bf16 v[150:153], v[190:193], v[174:177], 0
v_mfma_f32_16x16x32_bf16 v[150:153], v[190:193], v[178:181], v[150:153]
v_mfma_f32_16x16x32_bf16 v[138:141], v[114:117], v[174:177], 0
s_waitcnt lgkmcnt(2)
v_mfma_f32_16x16x32_bf16 v[138:141], v[118:121], v[178:181], v[138:141]
v_mfma_f32_16x16x32_bf16 v[142:145], v[122:125], v[174:177], 0
s_waitcnt lgkmcnt(1)
v_mfma_f32_16x16x32_bf16 v[142:145], v[126:129], v[178:181], v[142:145]
v_mfma_f32_16x16x32_bf16 v[146:149], v[130:133], v[174:177], 0
s_waitcnt lgkmcnt(0)
v_mfma_f32_16x16x32_bf16 v[146:149], v[134:137], v[178:181], v[146:149]
v_max3_f32 v167, v154, v155, v156
v_max3_f32 v167, v167, v157, v158
v_max3_f32 v167, v167, v159, v160
v_max3_f32 v167, v167, v161, v162
v_max3_f32 v167, v167, v163, v164
v_max3_f32 v167, v167, v165, v166
v_mov_b32 v168, v167
s_nop 1
v_permlane16_swap_b32 v167, v168
v_max_f32 v167, v167, v168
v_mov_b32 v168, v167
s_nop 1
v_permlane32_swap_b32 v167, v168
v_max_f32 v167, v167, v168
v_sub_f32 v154, v154, v167
v_sub_f32 v155, v155, v167
v_sub_f32 v156, v156, v167
v_sub_f32 v157, v157, v167
v_sub_f32 v158, v158, v167
v_sub_f32 v159, v159, v167
v_sub_f32 v160, v160, v167
v_sub_f32 v161, v161, v167
v_sub_f32 v166, v166, v167
v_sub_f32 v162, v162, v167
v_sub_f32 v163, v163, v167
v_sub_f32 v164, v164, v167
v_sub_f32 v165, v165, v167
v_exp_f32 v154, v154
v_exp_f32 v155, v155
v_exp_f32 v156, v156
v_exp_f32 v157, v157
v_exp_f32 v158, v158
v_exp_f32 v159, v159
v_exp_f32 v160, v160
v_exp_f32 v161, v161
v_exp_f32 v166, v166
v_exp_f32 v162, v162
v_exp_f32 v163, v163
v_exp_f32 v164, v164
v_exp_f32 v165, v165
v_cvt_pk_bf16_f32 v174, v154, v155
v_cvt_pk_bf16_f32 v175, v156, v157
v_cvt_pk_bf16_f32 v176, v158, v159
v_cvt_pk_bf16_f32 v177, v160, v161
v_cvt_pk_bf16_f32 v178, v162, v163
v_cvt_pk_bf16_f32 v179, v164, v165
v_cvt_pk_bf16_f32 v180, v166, 0
v_mfma_f32_16x16x32_bf16 v[166:169], v[190:193], v[174:177], 0
v_mfma_f32_16x16x32_bf16 v[166:169], v[190:193], v[178:181], v[166:169]
v_mfma_f32_16x16x32_bf16 v[154:157], v[114:117], v[174:177], 0
v_mfma_f32_16x16x32_bf16 v[154:157], v[118:121], v[178:181], v[154:157]
v_mfma_f32_16x16x32_bf16 v[158:161], v[122:125], v[174:177], 0
v_mfma_f32_16x16x32_bf16 v[158:161], v[126:129], v[178:181], v[158:161]
v_mfma_f32_16x16x32_bf16 v[162:165], v[130:133], v[174:177], 0
v_mfma_f32_16x16x32_bf16 v[162:165], v[134:137], v[178:181], v[162:165]
v_rcp_f32 v151, v150
s_nop 0
v_mul_f32 v152, s3, v151
v_mul_f32 v138, v138, v152
v_mul_f32 v139, v139, v152
v_cvt_pk_bf16_f32 v138, v138, v139
v_mul_f32 v140, v140, v152
v_mul_f32 v141, v141, v152
v_cvt_pk_bf16_f32 v139, v140, v141
v_mul_f32 v142, v142, v152
v_mul_f32 v143, v143, v152
v_cvt_pk_bf16_f32 v140, v142, v143
v_mul_f32 v144, v144, v152
v_mul_f32 v145, v145, v152
v_cvt_pk_bf16_f32 v141, v144, v145
ds_write_b128 v211, v[138:141] offset:38912
v_mul_f32 v146, v146, v152
v_mul_f32 v147, v147, v152
v_cvt_pk_bf16_f32 v142, v146, v147
v_mul_f32 v148, v148, v152
v_mul_f32 v149, v149, v152
v_cvt_pk_bf16_f32 v143, v148, v149
ds_write_b64 v212, v[142:143] offset:38912
v_mfma_f32_16x16x32_bf16 v[138:141], v[78:81], v[90:93], 0
v_mfma_f32_16x16x32_bf16 v[142:145], v[96:99], v[90:93], 0
v_mfma_f32_16x16x32_bf16 v[150:153], v[108:111], v[90:93], v[206:209]
v_mfma_f32_16x16x32_bf16 v[146:149], v[102:105], v[90:93], 0
v_mfma_f32_16x16x16_bf16 v[138:141], v[82:83], v[94:95], v[138:141]
v_mfma_f32_16x16x16_bf16 v[142:145], v[100:101], v[94:95], v[142:145]
v_mfma_f32_16x16x16_bf16 v[150:153], v[112:113], v[94:95], v[150:153]
v_mfma_f32_16x16x16_bf16 v[146:149], v[106:107], v[94:95], v[146:149]
v_rcp_f32 v167, v166
s_nop 0
v_mul_f32 v168, s3, v167
v_mul_f32 v154, v154, v168
v_mul_f32 v155, v155, v168
v_cvt_pk_bf16_f32 v154, v154, v155
v_mul_f32 v156, v156, v168
v_mul_f32 v157, v157, v168
v_cvt_pk_bf16_f32 v155, v156, v157
v_mul_f32 v158, v158, v168
v_mul_f32 v159, v159, v168
v_cvt_pk_bf16_f32 v156, v158, v159
v_mul_f32 v160, v160, v168
v_mul_f32 v161, v161, v168
v_cvt_pk_bf16_f32 v157, v160, v161
ds_write_b128 v211, v[154:157] offset:45056
v_mul_f32 v162, v162, v168
v_mul_f32 v163, v163, v168
v_cvt_pk_bf16_f32 v158, v162, v163
v_mul_f32 v164, v164, v168
v_mul_f32 v165, v165, v168
v_cvt_pk_bf16_f32 v159, v164, v165
ds_write_b64 v212, v[158:159] offset:45056
v_mfma_f32_16x16x16_bf16 v[154:157], v[76:77], v[82:83], 0
v_mfma_f32_16x16x16_bf16 v[158:161], v[76:77], v[100:101], 0
v_mfma_f32_16x16x16_bf16 v[162:165], v[76:77], v[106:107], 0
v_mfma_f32_16x16x16_bf16 v[166:169], v[76:77], v[112:113], v[206:209]
v_mfma_f32_16x16x32_bf16 v[154:157], v[72:75], v[78:81], v[154:157]
v_mfma_f32_16x16x32_bf16 v[158:161], v[72:75], v[96:99], v[158:161]
v_mfma_f32_16x16x32_bf16 v[162:165], v[72:75], v[102:105], v[162:165]
v_mfma_f32_16x16x32_bf16 v[166:169], v[72:75], v[108:111], v[166:169]
v_mov_b32_dpp v154, v158 quad_perm:[0,1,2,3] row_mask:0x2 bank_mask:0xf
s_nop 1
v_mov_b32_dpp v154, v162 quad_perm:[0,1,2,3] row_mask:0x4 bank_mask:0xf
s_nop 2
v_mov_b32_dpp v154, v167 quad_perm:[0,1,2,3] row_mask:0x8 bank_mask:0xf
v_mov_b32 v155, v154
s_nop 1
v_max_f32_dpp v155, v155, v155 row_ror:8 row_mask:0xf bank_mask:0xf
s_nop 1
v_max_f32_dpp v155, v155, v155 row_ror:4 row_mask:0xf bank_mask:0xf
s_nop 1
v_max_f32_dpp v155, v155, v155 row_ror:2 row_mask:0xf bank_mask:0xf
s_nop 1
v_max_f32_dpp v155, v155, v155 row_ror:1 row_mask:0xf bank_mask:0xf
v_mov_b32 v156, v155
s_nop 1
v_permlane16_swap_b32 v155, v156
v_max_f32 v155, v155, v156
v_mov_b32 v156, v155
s_nop 1
v_permlane32_swap_b32 v155, v156
v_max_f32 v155, v155, v156
v_sub_f32 v154, v154, v155
v_exp_f32 v154, v154
s_nop 0
v_cvt_pk_bf16_f32 v154, v154, 0
ds_write_b16 v214, v154
ds_read_b128 v[84:87], v215
s_waitcnt lgkmcnt(2)
ds_read_b128 v[88:91], v215 offset:16
v_add_u32 v215, 1424, v215
s_barrier
ds_read_b128 v[220:223], v210 offset:38912
ds_read_b128 v[110:113], v210 offset:39936
s_waitcnt lgkmcnt(1)
v_mfma_f32_16x16x32_bf16 v[36:39], a[144:147], v[220:223], v[36:39]
s_waitcnt lgkmcnt(0)
v_mfma_f32_16x16x32_bf16 v[36:39], a[148:151], v[110:113], v[36:39]
v_mfma_f32_16x16x32_bf16 v[40:43], a[168:171], v[220:223], v[40:43]
v_mfma_f32_16x16x32_bf16 v[40:43], a[172:175], v[110:113], v[40:43]
v_mfma_f32_16x16x32_bf16 v[44:47], a[192:195], v[220:223], v[44:47]
v_mfma_f32_16x16x32_bf16 v[44:47], a[196:199], v[110:113], v[44:47]
ds_read_b128 v[170:173], v210 offset:40960
ds_read_b128 v[182:185], v210 offset:41984
s_waitcnt lgkmcnt(1)
v_mfma_f32_16x16x32_bf16 v[36:39], a[152:155], v[170:173], v[36:39]
s_waitcnt lgkmcnt(0)
v_mfma_f32_16x16x32_bf16 v[36:39], a[156:159], v[182:185], v[36:39]
v_mfma_f32_16x16x32_bf16 v[40:43], a[176:179], v[170:173], v[40:43]
v_mfma_f32_16x16x32_bf16 v[40:43], a[180:183], v[182:185], v[40:43]
v_mfma_f32_16x16x32_bf16 v[44:47], a[200:203], v[170:173], v[44:47]
v_mfma_f32_16x16x32_bf16 v[44:47], a[204:207], v[182:185], v[44:47]
ds_read_b128 v[186:189], v210 offset:43008
ds_read_b128 v[220:223], v210 offset:44032
s_waitcnt lgkmcnt(1)
v_mfma_f32_16x16x32_bf16 v[36:39], a[160:163], v[186:189], v[36:39]
s_waitcnt lgkmcnt(0)
v_mfma_f32_16x16x32_bf16 v[36:39], a[164:167], v[220:223], v[36:39]
v_mfma_f32_16x16x32_bf16 v[40:43], a[184:187], v[186:189], v[40:43]
v_mfma_f32_16x16x32_bf16 v[40:43], a[188:191], v[220:223], v[40:43]
v_mfma_f32_16x16x32_bf16 v[44:47], a[208:211], v[186:189], v[44:47]
v_mfma_f32_16x16x32_bf16 v[44:47], a[212:215], v[220:223], v[44:47]
v_cvt_pk_bf16_f32 v36, v36, v37
v_cvt_pk_bf16_f32 v37, v38, v39
ds_write_b64 v203, v[36:37]
v_cvt_pk_bf16_f32 v40, v40, v41
v_cvt_pk_bf16_f32 v41, v42, v43
ds_write_b64 v203, v[40:41] offset:32
v_cvt_pk_bf16_f32 v44, v44, v45
v_cvt_pk_bf16_f32 v45, v46, v47
ds_write_b64 v203, v[44:45] offset:64
v_max3_f32 v151, v138, v139, v140
v_max3_f32 v151, v151, v141, v142
v_max3_f32 v151, v151, v143, v144
v_max3_f32 v151, v151, v145, v146
v_max3_f32 v151, v151, v147, v148
v_max3_f32 v151, v151, v149, v150
v_mov_b32 v152, v151
s_nop 1
v_permlane16_swap_b32 v151, v152
v_max_f32 v151, v151, v152
v_mov_b32 v152, v151
s_nop 1
v_permlane32_swap_b32 v151, v152
v_max_f32 v151, v151, v152
v_sub_f32 v138, v138, v151
v_sub_f32 v139, v139, v151
v_sub_f32 v140, v140, v151
v_sub_f32 v141, v141, v151
v_sub_f32 v142, v142, v151
v_sub_f32 v143, v143, v151
v_sub_f32 v144, v144, v151
v_sub_f32 v145, v145, v151
v_sub_f32 v150, v150, v151
v_sub_f32 v146, v146, v151
v_sub_f32 v147, v147, v151
v_sub_f32 v148, v148, v151
v_sub_f32 v149, v149, v151
v_exp_f32 v138, v138
v_exp_f32 v139, v139
v_exp_f32 v140, v140
v_exp_f32 v141, v141
v_exp_f32 v142, v142
v_exp_f32 v143, v143
v_exp_f32 v144, v144
v_exp_f32 v145, v145
v_exp_f32 v150, v150
v_exp_f32 v146, v146
v_exp_f32 v147, v147
v_exp_f32 v148, v148
v_exp_f32 v149, v149
v_cvt_pk_bf16_f32 v174, v138, v139
v_cvt_pk_bf16_f32 v175, v140, v141
v_cvt_pk_bf16_f32 v176, v142, v143
v_cvt_pk_bf16_f32 v177, v144, v145
v_cvt_pk_bf16_f32 v178, v146, v147
v_cvt_pk_bf16_f32 v179, v148, v149
v_cvt_pk_bf16_f32 v180, v150, 0
v_mfma_f32_16x16x32_bf16 v[150:153], v[190:193], v[174:177], 0
v_mfma_f32_16x16x32_bf16 v[150:153], v[190:193], v[178:181], v[150:153]
v_mfma_f32_16x16x32_bf16 v[138:141], v[114:117], v[174:177], 0
v_mfma_f32_16x16x32_bf16 v[138:141], v[118:121], v[178:181], v[138:141]
v_mfma_f32_16x16x32_bf16 v[142:145], v[122:125], v[174:177], 0
v_mfma_f32_16x16x32_bf16 v[142:145], v[126:129], v[178:181], v[142:145]
v_mfma_f32_16x16x32_bf16 v[146:149], v[130:133], v[174:177], 0
v_mfma_f32_16x16x32_bf16 v[146:149], v[134:137], v[178:181], v[146:149]
v_rcp_f32 v151, v150
s_nop 0
v_mul_f32 v152, s3, v151
v_mul_f32 v138, v138, v152
v_mul_f32 v139, v139, v152
v_cvt_pk_bf16_f32 v138, v138, v139
v_mul_f32 v140, v140, v152
v_mul_f32 v141, v141, v152
v_cvt_pk_bf16_f32 v139, v140, v141
v_mul_f32 v142, v142, v152
v_mul_f32 v143, v143, v152
v_cvt_pk_bf16_f32 v140, v142, v143
v_mul_f32 v144, v144, v152
v_mul_f32 v145, v145, v152
v_cvt_pk_bf16_f32 v141, v144, v145
ds_write_b128 v211, v[138:141] offset:51200
v_mul_f32 v146, v146, v152
v_mul_f32 v147, v147, v152
v_cvt_pk_bf16_f32 v142, v146, v147
v_mul_f32 v148, v148, v152
v_mul_f32 v149, v149, v152
v_cvt_pk_bf16_f32 v143, v148, v149
ds_write_b64 v212, v[142:143] offset:51200
v_mfma_f32_16x16x32_bf16 v[166:169], v[84:87], v[190:193], 0
v_mfma_f32_16x16x32_bf16 v[166:169], v[88:91], v[190:193], v[166:169]
v_mfma_f32_16x16x32_bf16 v[154:157], v[84:87], v[114:117], 0
v_mfma_f32_16x16x32_bf16 v[154:157], v[88:91], v[118:121], v[154:157]
v_mfma_f32_16x16x32_bf16 v[158:161], v[84:87], v[122:125], 0
v_mfma_f32_16x16x32_bf16 v[158:161], v[88:91], v[126:129], v[158:161]
v_mfma_f32_16x16x32_bf16 v[162:165], v[84:87], v[130:133], 0
v_mfma_f32_16x16x32_bf16 v[162:165], v[88:91], v[134:137], v[162:165]
v_rcp_f32 v167, v166
v_mov_b32_dpp v154, v158 quad_perm:[0,1,2,3] row_mask:0x2 bank_mask:0xf
s_nop 3
v_mov_b32_dpp v154, v162 quad_perm:[0,1,2,3] row_mask:0x4 bank_mask:0xf
v_mul_f32 v168, s3, v167
v_mul_f32 v154, v154, v168
v_cvt_pk_bf16_f32 v154, v154, 0
ds_write_b16 v214, v154
v_add_u32 v214, 1424, v214
ds_read_b128 v[110:113], v210 offset:45056
ds_read_b128 v[170:173], v210 offset:46080
s_waitcnt lgkmcnt(1)
v_mfma_f32_16x16x32_bf16 v[48:51], a[144:147], v[110:113], v[48:51]
s_waitcnt lgkmcnt(0)
v_mfma_f32_16x16x32_bf16 v[48:51], a[148:151], v[170:173], v[48:51]
v_mfma_f32_16x16x32_bf16 v[52:55], a[168:171], v[110:113], v[52:55]
v_mfma_f32_16x16x32_bf16 v[52:55], a[172:175], v[170:173], v[52:55]
v_mfma_f32_16x16x32_bf16 v[56:59], a[192:195], v[110:113], v[56:59]
v_mfma_f32_16x16x32_bf16 v[56:59], a[196:199], v[170:173], v[56:59]
ds_read_b128 v[182:185], v210 offset:47104
ds_read_b128 v[186:189], v210 offset:48128
s_waitcnt lgkmcnt(1)
v_mfma_f32_16x16x32_bf16 v[48:51], a[152:155], v[182:185], v[48:51]
s_waitcnt lgkmcnt(0)
v_mfma_f32_16x16x32_bf16 v[48:51], a[156:159], v[186:189], v[48:51]
v_mfma_f32_16x16x32_bf16 v[52:55], a[176:179], v[182:185], v[52:55]
v_mfma_f32_16x16x32_bf16 v[52:55], a[180:183], v[186:189], v[52:55]
v_mfma_f32_16x16x32_bf16 v[56:59], a[200:203], v[182:185], v[56:59]
v_mfma_f32_16x16x32_bf16 v[56:59], a[204:207], v[186:189], v[56:59]
ds_read_b128 v[220:223], v210 offset:49152
ds_read_b128 v[110:113], v210 offset:50176
s_waitcnt lgkmcnt(1)
v_mfma_f32_16x16x32_bf16 v[48:51], a[160:163], v[220:223], v[48:51]
s_waitcnt lgkmcnt(0)
v_mfma_f32_16x16x32_bf16 v[48:51], a[164:167], v[110:113], v[48:51]
v_mfma_f32_16x16x32_bf16 v[52:55], a[184:187], v[220:223], v[52:55]
v_mfma_f32_16x16x32_bf16 v[52:55], a[188:191], v[110:113], v[52:55]
v_mfma_f32_16x16x32_bf16 v[56:59], a[208:211], v[220:223], v[56:59]
v_mfma_f32_16x16x32_bf16 v[56:59], a[212:215], v[110:113], v[56:59]
v_cvt_pk_bf16_f32 v48, v48, v49
v_cvt_pk_bf16_f32 v49, v50, v51
ds_write_b64 v203, v[48:49] offset:6272
v_cvt_pk_bf16_f32 v52, v52, v53
v_cvt_pk_bf16_f32 v53, v54, v55
ds_write_b64 v203, v[52:53] offset:6304
v_cvt_pk_bf16_f32 v56, v56, v57
v_cvt_pk_bf16_f32 v57, v58, v59
ds_write_b64 v203, v[56:57] offset:6336
s_waitcnt vmcnt(0)
s_barrier
ds_read_b64 v[120:121], v204
s_add_u32 s28, s39, s60
s_waitcnt lgkmcnt(0)
buffer_store_dwordx2 v[120:121], v204, s[8:11], s28 offen sc1
ds_read_b64 v[128:129], v204 offset:392
s_add_u32 s29, s39, s61
s_waitcnt lgkmcnt(0)
buffer_store_dwordx2 v[128:129], v204, s[8:11], s29 offen sc1
ds_read_b64 v[136:137], v204 offset:784
s_add_u32 s28, s39, s62
s_waitcnt lgkmcnt(0)
buffer_store_dwordx2 v[136:137], v204, s[8:11], s28 offen sc1
ds_read_b64 v[120:121], v204 offset:1176
s_add_u32 s29, s39, s63
s_waitcnt lgkmcnt(0)
buffer_store_dwordx2 v[120:121], v204, s[8:11], s29 offen sc1
ds_read_b128 v[170:173], v210 offset:51200
ds_read_b128 v[182:185], v210 offset:52224
s_waitcnt lgkmcnt(1)
v_mfma_f32_16x16x32_bf16 v[60:63], a[144:147], v[170:173], v[60:63]
s_waitcnt lgkmcnt(0)
v_mfma_f32_16x16x32_bf16 v[60:63], a[148:151], v[182:185], v[60:63]
v_mfma_f32_16x16x32_bf16 v[64:67], a[168:171], v[170:173], v[64:67]
v_mfma_f32_16x16x32_bf16 v[64:67], a[172:175], v[182:185], v[64:67]
v_mfma_f32_16x16x32_bf16 v[68:71], a[192:195], v[170:173], v[68:71]
v_mfma_f32_16x16x32_bf16 v[68:71], a[196:199], v[182:185], v[68:71]
ds_read_b128 v[186:189], v210 offset:53248
ds_read_b128 v[220:223], v210 offset:54272
s_waitcnt lgkmcnt(1)
v_mfma_f32_16x16x32_bf16 v[60:63], a[152:155], v[186:189], v[60:63]
s_waitcnt lgkmcnt(0)
v_mfma_f32_16x16x32_bf16 v[60:63], a[156:159], v[220:223], v[60:63]
v_mfma_f32_16x16x32_bf16 v[64:67], a[176:179], v[186:189], v[64:67]
v_mfma_f32_16x16x32_bf16 v[64:67], a[180:183], v[220:223], v[64:67]
v_mfma_f32_16x16x32_bf16 v[68:71], a[200:203], v[186:189], v[68:71]
v_mfma_f32_16x16x32_bf16 v[68:71], a[204:207], v[220:223], v[68:71]
ds_read_b128 v[110:113], v210 offset:55296
ds_read_b128 v[170:173], v210 offset:56320
s_waitcnt lgkmcnt(1)
v_mfma_f32_16x16x32_bf16 v[60:63], a[160:163], v[110:113], v[60:63]
s_waitcnt lgkmcnt(0)
v_mfma_f32_16x16x32_bf16 v[60:63], a[164:167], v[170:173], v[60:63]
v_mfma_f32_16x16x32_bf16 v[64:67], a[184:187], v[110:113], v[64:67]
v_mfma_f32_16x16x32_bf16 v[64:67], a[188:191], v[170:173], v[64:67]
v_mfma_f32_16x16x32_bf16 v[68:71], a[208:211], v[110:113], v[68:71]
v_mfma_f32_16x16x32_bf16 v[68:71], a[212:215], v[170:173], v[68:71]
v_cvt_pk_bf16_f32 v60, v60, v61
v_cvt_pk_bf16_f32 v61, v62, v63
ds_write_b64 v203, v[60:61] offset:12544
v_cvt_pk_bf16_f32 v64, v64, v65
v_cvt_pk_bf16_f32 v65, v66, v67
ds_write_b64 v203, v[64:65] offset:12576
v_cvt_pk_bf16_f32 v68, v68, v69
v_cvt_pk_bf16_f32 v69, v70, v71
ds_write_b64 v203, v[68:69] offset:12608
s_mov_b32 s38, s36
ds_read_b128 v[174:177], v217
ds_read_b128 v[84:87], v200
s_waitcnt lgkmcnt(0)
v_mfma_f32_16x16x32_bf16 v[36:39], v[174:177], v[84:87], 0
ds_read_b128 v[92:95], v201
s_waitcnt lgkmcnt(0)
v_mfma_f32_16x16x32_bf16 v[48:51], v[174:177], v[92:95], 0
ds_read_b128 v[100:103], v202
s_waitcnt lgkmcnt(0)
v_mfma_f32_16x16x32_bf16 v[60:63], v[174:177], v[100:103], 0
ds_read_b128 v[178:181], v217 offset:528
ds_read_b128 v[84:87], v194
ds_read_b128 v[88:91], v194 offset:16
s_waitcnt lgkmcnt(0)
v_smfmac_f32_16x16x64_bf16 v[36:39], v[178:181], v[84:91], v213
ds_read_b128 v[92:95], v195
ds_read_b128 v[96:99], v195 offset:16
s_waitcnt lgkmcnt(0)
v_smfmac_f32_16x16x64_bf16 v[48:51], v[178:181], v[92:99], v213
ds_read_b128 v[100:103], v196
ds_read_b128 v[104:107], v196 offset:16
s_waitcnt lgkmcnt(0)
v_smfmac_f32_16x16x64_bf16 v[60:63], v[178:181], v[100:107], v213
ds_read_b128 v[174:177], v217 offset:1056
ds_read_b128 v[84:87], v197
ds_read_b128 v[88:91], v197 offset:16
s_waitcnt lgkmcnt(0)
v_smfmac_f32_16x16x64_bf16 v[36:39], v[174:177], v[84:91], v213
ds_read_b128 v[92:95], v198
ds_read_b128 v[96:99], v198 offset:16
s_waitcnt lgkmcnt(0)
v_smfmac_f32_16x16x64_bf16 v[48:51], v[174:177], v[92:99], v213
ds_read_b128 v[100:103], v199
ds_read_b128 v[104:107], v199 offset:16
s_waitcnt lgkmcnt(0)
v_smfmac_f32_16x16x64_bf16 v[60:63], v[174:177], v[100:107], v213
ds_read_b128 v[178:181], v217 offset:1584
ds_read_b128 v[84:87], v200 offset:32
s_waitcnt lgkmcnt(0)
v_mfma_f32_16x16x32_bf16 v[40:43], v[178:181], v[84:87], 0
ds_read_b128 v[92:95], v201 offset:32
s_waitcnt lgkmcnt(0)
v_mfma_f32_16x16x32_bf16 v[52:55], v[178:181], v[92:95], 0
ds_read_b128 v[100:103], v202 offset:32
s_waitcnt lgkmcnt(0)
v_mfma_f32_16x16x32_bf16 v[64:67], v[178:181], v[100:103], 0
ds_read_b128 v[174:177], v217 offset:2112
ds_read_b128 v[84:87], v194 offset:32
ds_read_b128 v[88:91], v194 offset:48
s_waitcnt lgkmcnt(0)
v_smfmac_f32_16x16x64_bf16 v[40:43], v[174:177], v[84:91], v213
ds_read_b128 v[92:95], v195 offset:32
ds_read_b128 v[96:99], v195 offset:48
s_waitcnt lgkmcnt(0)
v_smfmac_f32_16x16x64_bf16 v[52:55], v[174:177], v[92:99], v213
ds_read_b128 v[100:103], v196 offset:32
ds_read_b128 v[104:107], v196 offset:48
s_waitcnt lgkmcnt(0)
v_smfmac_f32_16x16x64_bf16 v[64:67], v[174:177], v[100:107], v213
ds_read_b128 v[178:181], v217 offset:2640
ds_read_b128 v[84:87], v197 offset:32
ds_read_b128 v[88:91], v197 offset:48
s_waitcnt lgkmcnt(0)
v_smfmac_f32_16x16x64_bf16 v[40:43], v[178:181], v[84:91], v213
ds_read_b128 v[92:95], v198 offset:32
ds_read_b128 v[96:99], v198 offset:48
s_waitcnt lgkmcnt(0)
v_smfmac_f32_16x16x64_bf16 v[52:55], v[178:181], v[92:99], v213
ds_read_b128 v[100:103], v199 offset:32
ds_read_b128 v[104:107], v199 offset:48
s_waitcnt lgkmcnt(0)
v_smfmac_f32_16x16x64_bf16 v[64:67], v[178:181], v[100:107], v213
ds_read_b128 v[174:177], v217 offset:3168
ds_read_b128 v[84:87], v200 offset:64
s_waitcnt lgkmcnt(0)
v_mfma_f32_16x16x32_bf16 v[44:47], v[174:177], v[84:87], 0
ds_read_b128 v[92:95], v201 offset:64
s_waitcnt lgkmcnt(0)
v_mfma_f32_16x16x32_bf16 v[56:59], v[174:177], v[92:95], 0
ds_read_b128 v[100:103], v202 offset:64
s_waitcnt lgkmcnt(0)
v_mfma_f32_16x16x32_bf16 v[68:71], v[174:177], v[100:103], 0
ds_read_b128 v[178:181], v217 offset:3696
ds_read_b128 v[84:87], v194 offset:64
ds_read_b128 v[88:91], v194 offset:80
s_waitcnt lgkmcnt(0)
v_smfmac_f32_16x16x64_bf16 v[44:47], v[178:181], v[84:91], v213
ds_read_b128 v[92:95], v195 offset:64
ds_read_b128 v[96:99], v195 offset:80
s_waitcnt lgkmcnt(0)
v_smfmac_f32_16x16x64_bf16 v[56:59], v[178:181], v[92:99], v213
ds_read_b128 v[100:103], v196 offset:64
ds_read_b128 v[104:107], v196 offset:80
s_waitcnt lgkmcnt(0)
v_smfmac_f32_16x16x64_bf16 v[68:71], v[178:181], v[100:107], v213
ds_read_b128 v[174:177], v217 offset:4224
ds_read_b128 v[84:87], v197 offset:64
ds_read_b128 v[88:91], v197 offset:80
s_waitcnt lgkmcnt(0)
v_smfmac_f32_16x16x64_bf16 v[44:47], v[174:177], v[84:91], v213
ds_read_b128 v[92:95], v198 offset:64
ds_read_b128 v[96:99], v198 offset:80
s_waitcnt lgkmcnt(0)
v_smfmac_f32_16x16x64_bf16 v[56:59], v[174:177], v[92:99], v213
ds_read_b128 v[100:103], v199 offset:64
ds_read_b128 v[104:107], v199 offset:80
s_waitcnt lgkmcnt(0)
v_smfmac_f32_16x16x64_bf16 v[68:71], v[174:177], v[100:107], v213
v_add_f32 v118, v36, v37
v_mul_f32 v119, v36, v36
v_add_f32 v118, v118, v38
v_fmac_f32 v119, v37, v37
v_add_f32 v118, v118, v39
v_fmac_f32 v119, v38, v38
v_fmac_f32 v119, v39, v39
v_add_f32 v126, v48, v49
v_mul_f32 v127, v48, v48
v_add_f32 v126, v126, v50
v_fmac_f32 v127, v49, v49
v_add_f32 v126, v126, v51
v_fmac_f32 v127, v50, v50
v_fmac_f32 v127, v51, v51
v_add_f32 v134, v60, v61
v_mul_f32 v135, v60, v60
v_add_f32 v134, v134, v62
v_fmac_f32 v135, v61, v61
v_add_f32 v134, v134, v63
v_fmac_f32 v135, v62, v62
v_fmac_f32 v135, v63, v63
v_add_f32 v118, v118, v40
v_fmac_f32 v119, v40, v40
v_add_f32 v118, v118, v41
v_fmac_f32 v119, v41, v41
v_add_f32 v118, v118, v42
v_fmac_f32 v119, v42, v42
v_add_f32 v118, v118, v43
v_fmac_f32 v119, v43, v43
v_add_f32 v126, v126, v52
v_fmac_f32 v127, v52, v52
v_add_f32 v126, v126, v53
v_fmac_f32 v127, v53, v53
v_add_f32 v126, v126, v54
v_fmac_f32 v127, v54, v54
v_add_f32 v126, v126, v55
v_fmac_f32 v127, v55, v55
v_add_f32 v134, v134, v64
v_fmac_f32 v135, v64, v64
v_add_f32 v134, v134, v65
v_fmac_f32 v135, v65, v65
v_add_f32 v134, v134, v66
v_fmac_f32 v135, v66, v66
v_add_f32 v134, v134, v67
v_fmac_f32 v135, v67, v67
v_add_f32 v118, v118, v44
v_fmac_f32 v119, v44, v44
v_add_f32 v118, v118, v45
v_fmac_f32 v119, v45, v45
v_add_f32 v118, v118, v46
v_fmac_f32 v119, v46, v46
v_add_f32 v118, v118, v47
v_fmac_f32 v119, v47, v47
v_add_f32 v126, v126, v56
v_fmac_f32 v127, v56, v56
v_add_f32 v126, v126, v57
v_fmac_f32 v127, v57, v57
v_add_f32 v126, v126, v58
v_fmac_f32 v127, v58, v58
v_add_f32 v126, v126, v59
v_fmac_f32 v127, v59, v59
v_add_f32 v134, v134, v68
v_fmac_f32 v135, v68, v68
v_add_f32 v134, v134, v69
v_fmac_f32 v135, v69, v69
v_add_f32 v134, v134, v70
v_fmac_f32 v135, v70, v70
v_add_f32 v134, v134, v71
v_fmac_f32 v135, v71, v71
v_permlane16_swap_b32 v118, v119
v_add_f32 v118, v118, v119
v_permlane16_swap_b32 v126, v127
v_add_f32 v126, v126, v127
v_permlane16_swap_b32 v134, v135
v_add_f32 v134, v134, v135
v_permlane32_swap_b32 v118, v126
v_add_f32 v118, v118, v126
ds_write_b32 v209, v118
v_mov_b32 v135, v134
s_nop 1
v_permlane32_swap_b32 v134, v135
v_add_f32 v134, v134, v135
ds_write_b32 v209, v134 offset:512
s_waitcnt lgkmcnt(0)
s_barrier
ds_read_b64 v[128:129], v204 offset:6272
s_add_u32 s28, s39, s64
s_waitcnt lgkmcnt(0)
buffer_store_dwordx2 v[128:129], v204, s[8:11], s28 offen sc1
ds_read_b64 v[136:137], v204 offset:6664
s_add_u32 s29, s39, s65
s_waitcnt lgkmcnt(0)
buffer_store_dwordx2 v[136:137], v204, s[8:11], s29 offen sc1
ds_read_b64 v[120:121], v204 offset:7056
s_add_u32 s28, s39, s66
s_waitcnt lgkmcnt(0)
buffer_store_dwordx2 v[120:121], v204, s[8:11], s28 offen sc1
ds_read_b64 v[128:129], v204 offset:7448
s_add_u32 s29, s39, s67
s_waitcnt lgkmcnt(0)
buffer_store_dwordx2 v[128:129], v204, s[8:11], s29 offen sc1
ds_read_b64 v[136:137], v204 offset:12544
s_add_u32 s28, s39, s68
s_waitcnt lgkmcnt(0)
buffer_store_dwordx2 v[136:137], v204, s[8:11], s28 offen sc1
ds_read_b64 v[120:121], v204 offset:12936
s_add_u32 s29, s39, s69
s_waitcnt lgkmcnt(0)
buffer_store_dwordx2 v[120:121], v204, s[8:11], s29 offen sc1
ds_read_b64 v[128:129], v204 offset:13328
s_add_u32 s28, s39, s70
s_waitcnt lgkmcnt(0)
buffer_store_dwordx2 v[128:129], v204, s[8:11], s28 offen sc1
ds_read_b64 v[136:137], v204 offset:13720
s_add_u32 s29, s39, s71
s_waitcnt lgkmcnt(0)
buffer_store_dwordx2 v[136:137], v204, s[8:11], s29 offen sc1
s_mov_b32 s35, s97
s_mul_hi_u32 s41, s35, 58835169
s_mul_i32 s42, s41, 73
s_sub_u32 s42, s35, s42
s_mul_i32 s43, s41, 1373568
s_mul_i32 s51, s42, 2688
s_add_u32 s50, s43, s51
s_add_u32 s35, s35, 32
s_min_u32 s41, s41, 1
s_sub_u32 s41, 1, s41
s_lshl_b32 s41, s41, 30
s_add_u32 s52, s50, s41
s_min_u32 s43, s42, 1
s_lshl_b32 s43, s43, 27
s_sub_u32 s43, 536870911, s43
s_add_u32 s51, s42, 56
s_and_b32 s51, s51, 128
s_lshl_b32 s51, s51, 22
s_or_b32 s44, s43, s51
s_mov_b32 s36, s50
v_and_b32 v216, s44, v208
s_add_u32 m0, s45, 0
s_nop 0
buffer_load_dwordx4 v216, s[4:7], s52 offen nt lds
s_add_u32 m0, s45, 4112
s_add_u32 s40, s36, 196224
buffer_load_dwordx4 v216, s[4:7], s40 offen nt lds
s_add_u32 m0, s45, 8224
s_add_u32 s40, s36, 392448
buffer_load_dwordx4 v216, s[4:7], s40 offen nt lds
s_add_u32 m0, s45, 12336
s_add_u32 s40, s36, 588672
buffer_load_dwordx4 v216, s[4:7], s40 offen nt lds
s_add_u32 m0, s45, 16448
s_add_u32 s40, s36, 784896
buffer_load_dwordx4 v216, s[4:7], s40 offen nt lds
s_add_u32 m0, s45, 20560
s_add_u32 s40, s36, 981120
buffer_load_dwordx4 v216, s[4:7], s40 offen nt lds
s_add_u32 m0, s45, 24672
s_add_u32 s40, s36, 1177344
buffer_load_dwordx4 v216, s[4:7], s40 offen nt lds
s_add_u32 m0, s45, 28784
s_add_u32 s40, s36, 1373568
buffer_load_dwordx4 v216, s[4:7], s40 offen nt lds
s_add_u32 m0, s45, 32896
s_add_u32 s40, s36, 1569792
buffer_load_dwordx4 v216, s[4:7], s40 offen nt lds
ds_read_b128 v[182:185], v210
ds_read_b128 v[186:189], v210 offset:1024
s_waitcnt lgkmcnt(1)
v_mfma_f32_16x16x32_bf16 v[138:141], a[0:3], v[182:185], 0
s_waitcnt lgkmcnt(0)
v_mfma_f32_16x16x32_bf16 v[138:141], a[4:7], v[186:189], v[138:141]
v_mfma_f32_16x16x32_bf16 v[142:145], a[24:27], v[182:185], 0
v_mfma_f32_16x16x32_bf16 v[142:145], a[28:31], v[186:189], v[142:145]
v_mfma_f32_16x16x32_bf16 v[146:149], a[48:51], v[182:185], 0
v_mfma_f32_16x16x32_bf16 v[146:149], a[52:55], v[186:189], v[146:149]
v_mfma_f32_16x16x32_bf16 v[150:153], a[216:219], v[182:185], 0
v_mfma_f32_16x16x32_bf16 v[150:153], a[220:223], v[186:189], v[150:153]
v_mfma_f32_16x16x32_bf16 v[154:157], a[240:243], v[182:185], 0
v_mfma_f32_16x16x32_bf16 v[154:157], a[244:247], v[186:189], v[154:157]
v_mfma_f32_16x16x32_bf16 v[158:161], v[232:235], v[182:185], 0
v_mfma_f32_16x16x32_bf16 v[158:161], v[236:239], v[186:189], v[158:161]
v_mfma_f32_16x16x32_bf16 v[162:165], v[182:185], a[72:75], 0
v_mfma_f32_16x16x32_bf16 v[162:165], v[186:189], a[76:79], v[162:165]
v_mfma_f32_16x16x32_bf16 v[166:169], v[182:185], a[96:99], 0
v_mfma_f32_16x16x32_bf16 v[166:169], v[186:189], a[100:103], v[166:169]
v_mfma_f32_16x16x32_bf16 v[170:173], v[182:185], a[120:123], 0
v_mfma_f32_16x16x32_bf16 v[170:173], v[186:189], a[124:127], v[170:173]
ds_read_b128 v[110:113], v210 offset:2048
ds_read_b128 v[220:223], v210 offset:3072
s_waitcnt lgkmcnt(1)
v_mfma_f32_16x16x32_bf16 v[138:141], a[8:11], v[110:113], v[138:141]
s_waitcnt lgkmcnt(0)
v_mfma_f32_16x16x32_bf16 v[138:141], a[12:15], v[220:223], v[138:141]
v_mfma_f32_16x16x32_bf16 v[142:145], a[32:35], v[110:113], v[142:145]
v_mfma_f32_16x16x32_bf16 v[142:145], a[36:39], v[220:223], v[142:145]
v_mfma_f32_16x16x32_bf16 v[146:149], a[56:59], v[110:113], v[146:149]
v_mfma_f32_16x16x32_bf16 v[146:149], a[60:63], v[220:223], v[146:149]
v_mfma_f32_16x16x32_bf16 v[150:153], a[224:227], v[110:113], v[150:153]
v_mfma_f32_16x16x32_bf16 v[150:153], a[228:231], v[220:223], v[150:153]
v_mfma_f32_16x16x32_bf16 v[154:157], a[248:251], v[110:113], v[154:157]
v_mfma_f32_16x16x32_bf16 v[154:157], a[252:255], v[220:223], v[154:157]
v_mfma_f32_16x16x32_bf16 v[158:161], v[240:243], v[110:113], v[158:161]
v_mfma_f32_16x16x32_bf16 v[158:161], v[244:247], v[220:223], v[158:161]
v_mfma_f32_16x16x32_bf16 v[162:165], v[110:113], a[80:83], v[162:165]
v_mfma_f32_16x16x32_bf16 v[162:165], v[220:223], a[84:87], v[162:165]
v_mfma_f32_16x16x32_bf16 v[166:169], v[110:113], a[104:107], v[166:169]
v_mfma_f32_16x16x32_bf16 v[166:169], v[220:223], a[108:111], v[166:169]
v_mfma_f32_16x16x32_bf16 v[170:173], v[110:113], a[128:131], v[170:173]
v_mfma_f32_16x16x32_bf16 v[170:173], v[220:223], a[132:135], v[170:173]
ds_read_b128 v[182:185], v210 offset:4096
ds_read_b128 v[186:189], v210 offset:5120
s_waitcnt lgkmcnt(1)
v_mfma_f32_16x16x32_bf16 v[138:141], a[16:19], v[182:185], v[138:141]
s_waitcnt lgkmcnt(0)
v_mfma_f32_16x16x32_bf16 v[138:141], a[20:23], v[186:189], v[138:141]
v_mfma_f32_16x16x32_bf16 v[142:145], a[40:43], v[182:185], v[142:145]
v_mfma_f32_16x16x32_bf16 v[142:145], a[44:47], v[186:189], v[142:145]
v_mfma_f32_16x16x32_bf16 v[146:149], a[64:67], v[182:185], v[146:149]
v_mfma_f32_16x16x32_bf16 v[146:149], a[68:71], v[186:189], v[146:149]
v_mfma_f32_16x16x32_bf16 v[150:153], a[232:235], v[182:185], v[150:153]
v_mfma_f32_16x16x32_bf16 v[150:153], a[236:239], v[186:189], v[150:153]
v_mfma_f32_16x16x32_bf16 v[154:157], v[224:227], v[182:185], v[154:157]
v_mfma_f32_16x16x32_bf16 v[154:157], v[228:231], v[186:189], v[154:157]
v_mfma_f32_16x16x32_bf16 v[158:161], v[248:251], v[182:185], v[158:161]
v_mfma_f32_16x16x32_bf16 v[158:161], v[252:255], v[186:189], v[158:161]
v_mfma_f32_16x16x32_bf16 v[162:165], v[182:185], a[88:91], v[162:165]
v_mfma_f32_16x16x32_bf16 v[162:165], v[186:189], a[92:95], v[162:165]
v_mfma_f32_16x16x32_bf16 v[166:169], v[182:185], a[112:115], v[166:169]
v_mfma_f32_16x16x32_bf16 v[166:169], v[186:189], a[116:119], v[166:169]
v_mfma_f32_16x16x32_bf16 v[170:173], v[182:185], a[136:139], v[170:173]
v_mfma_f32_16x16x32_bf16 v[170:173], v[186:189], a[140:143], v[170:173]
v_cvt_pk_bf16_f32 v78, v138, v139
v_cvt_pk_bf16_f32 v79, v140, v141
v_cvt_pk_bf16_f32 v80, v142, v143
v_cvt_pk_bf16_f32 v81, v144, v145
v_cvt_pk_bf16_f32 v82, v146, v147
v_cvt_pk_bf16_f32 v83, v148, v149
v_cvt_pk_bf16_f32 v72, v150, v151
v_cvt_pk_bf16_f32 v73, v152, v153
v_cvt_pk_bf16_f32 v74, v154, v155
v_cvt_pk_bf16_f32 v75, v156, v157
v_cvt_pk_bf16_f32 v76, v158, v159
v_cvt_pk_bf16_f32 v77, v160, v161
v_cvt_pk_bf16_f32 v114, v162, v163
v_cvt_pk_bf16_f32 v115, v164, v165
v_cvt_pk_bf16_f32 v122, v166, v167
v_cvt_pk_bf16_f32 v123, v168, v169
v_cvt_pk_bf16_f32 v130, v170, v171
v_cvt_pk_bf16_f32 v131, v172, v173
ds_read_b128 v[110:113], v210 offset:6144
ds_read_b128 v[220:223], v210 offset:7168
s_waitcnt lgkmcnt(1)
v_mfma_f32_16x16x32_bf16 v[138:141], a[0:3], v[110:113], 0
s_waitcnt lgkmcnt(0)
v_mfma_f32_16x16x32_bf16 v[138:141], a[4:7], v[220:223], v[138:141]
v_mfma_f32_16x16x32_bf16 v[142:145], a[24:27], v[110:113], 0
v_mfma_f32_16x16x32_bf16 v[142:145], a[28:31], v[220:223], v[142:145]
v_mfma_f32_16x16x32_bf16 v[146:149], a[48:51], v[110:113], 0
v_mfma_f32_16x16x32_bf16 v[146:149], a[52:55], v[220:223], v[146:149]
v_mfma_f32_16x16x32_bf16 v[150:153], a[216:219], v[110:113], 0
v_mfma_f32_16x16x32_bf16 v[150:153], a[220:223], v[220:223], v[150:153]
v_mfma_f32_16x16x32_bf16 v[154:157], a[240:243], v[110:113], 0
v_mfma_f32_16x16x32_bf16 v[154:157], a[244:247], v[220:223], v[154:157]
v_mfma_f32_16x16x32_bf16 v[158:161], v[232:235], v[110:113], 0
v_mfma_f32_16x16x32_bf16 v[158:161], v[236:239], v[220:223], v[158:161]
v_mfma_f32_16x16x32_bf16 v[162:165], v[110:113], a[72:75], 0
v_mfma_f32_16x16x32_bf16 v[162:165], v[220:223], a[76:79], v[162:165]
v_mfma_f32_16x16x32_bf16 v[166:169], v[110:113], a[96:99], 0
v_mfma_f32_16x16x32_bf16 v[166:169], v[220:223], a[100:103], v[166:169]
v_mfma_f32_16x16x32_bf16 v[170:173], v[110:113], a[120:123], 0
v_mfma_f32_16x16x32_bf16 v[170:173], v[220:223], a[124:127], v[170:173]
ds_read_b128 v[102:105], v210 offset:18432
ds_read_b128 v[106:109], v210 offset:19456
s_waitcnt lgkmcnt(1)
v_add_f32 v102, v102, v103
s_waitcnt lgkmcnt(0)
v_add_f32 v106, v106, v107
v_add_f32 v104, v104, v105
v_add_f32 v108, v108, v109
v_add_f32 v102, v102, v104
v_add_f32 v106, v106, v108
v_mul_f32 v103, s48, v102
v_mul_f32 v104, s73, v102
v_mul_f32 v106, s73, v106
v_fma_f32 v106, -v103, v104, v106
v_max_f32 v106, 0, v106
v_add_f32 v106, s49, v106
v_rsq_f32 v102, v106
s_nop 0
v_mul_f32_e64 v103, -v103, v102
ds_write_b64 v211, v[102:103] offset:20480
ds_read_b64 v[118:119], v219 offset:20480
ds_read_b64 v[126:127], v219 offset:20736
ds_read_b64 v[134:135], v219 offset:20992
s_waitcnt lgkmcnt(2)
v_fma_f32 v220, v36, v118, v119
v_fma_f32 v221, v37, v118, v119
v_cvt_pk_bf16_f32 v90, v220, v221
v_fma_f32 v222, v38, v118, v119
v_fma_f32 v223, v39, v118, v119
v_cvt_pk_bf16_f32 v91, v222, v223
v_fma_f32 v220, v40, v118, v119
v_fma_f32 v221, v41, v118, v119
v_cvt_pk_bf16_f32 v92, v220, v221
v_fma_f32 v222, v42, v118, v119
v_fma_f32 v223, v43, v118, v119
v_cvt_pk_bf16_f32 v93, v222, v223
ds_write_b128 v211, v[90:93] offset:20480
v_fma_f32 v220, v44, v118, v119
v_fma_f32 v221, v45, v118, v119
v_cvt_pk_bf16_f32 v94, v220, v221
v_fma_f32 v222, v46, v118, v119
v_fma_f32 v223, v47, v118, v119
v_cvt_pk_bf16_f32 v95, v222, v223
s_waitcnt lgkmcnt(2)
ds_write_b64 v212, v[94:95] offset:20480
v_fma_f32 v220, v48, v126, v127
v_fma_f32 v221, v49, v126, v127
v_cvt_pk_bf16_f32 v174, v220, v221
v_fma_f32 v222, v50, v126, v127
v_fma_f32 v223, v51, v126, v127
v_cvt_pk_bf16_f32 v175, v222, v223
v_fma_f32 v220, v52, v126, v127
v_fma_f32 v221, v53, v126, v127
v_cvt_pk_bf16_f32 v176, v220, v221
v_fma_f32 v222, v54, v126, v127
v_fma_f32 v223, v55, v126, v127
v_cvt_pk_bf16_f32 v177, v222, v223
ds_write_b128 v211, v[174:177] offset:26624
v_fma_f32 v220, v56, v126, v127
v_fma_f32 v221, v57, v126, v127
v_cvt_pk_bf16_f32 v178, v220, v221
v_fma_f32 v222, v58, v126, v127
v_fma_f32 v223, v59, v126, v127
v_cvt_pk_bf16_f32 v179, v222, v223
s_waitcnt lgkmcnt(3)
ds_write_b64 v212, v[178:179] offset:26624
v_fma_f32 v220, v60, v134, v135
v_fma_f32 v221, v61, v134, v135
v_cvt_pk_bf16_f32 v90, v220, v221
v_fma_f32 v222, v62, v134, v135
v_fma_f32 v223, v63, v134, v135
v_cvt_pk_bf16_f32 v91, v222, v223
v_fma_f32 v220, v64, v134, v135
v_fma_f32 v221, v65, v134, v135
v_cvt_pk_bf16_f32 v92, v220, v221
v_fma_f32 v222, v66, v134, v135
v_fma_f32 v223, v67, v134, v135
v_cvt_pk_bf16_f32 v93, v222, v223
ds_write_b128 v211, v[90:93] offset:32768
v_fma_f32 v220, v68, v134, v135
v_fma_f32 v221, v69, v134, v135
v_cvt_pk_bf16_f32 v94, v220, v221
v_fma_f32 v222, v70, v134, v135
v_fma_f32 v223, v71, v134, v135
v_cvt_pk_bf16_f32 v95, v222, v223
ds_write_b64 v212, v[94:95] offset:32768
ds_read_b128 v[182:185], v210 offset:8192
ds_read_b128 v[186:189], v210 offset:9216
s_waitcnt lgkmcnt(1)
v_mfma_f32_16x16x32_bf16 v[138:141], a[8:11], v[182:185], v[138:141]
s_waitcnt lgkmcnt(0)
v_mfma_f32_16x16x32_bf16 v[138:141], a[12:15], v[186:189], v[138:141]
v_mfma_f32_16x16x32_bf16 v[142:145], a[32:35], v[182:185], v[142:145]
v_mfma_f32_16x16x32_bf16 v[142:145], a[36:39], v[186:189], v[142:145]
v_mfma_f32_16x16x32_bf16 v[146:149], a[56:59], v[182:185], v[146:149]
v_mfma_f32_16x16x32_bf16 v[146:149], a[60:63], v[186:189], v[146:149]
v_mfma_f32_16x16x32_bf16 v[150:153], a[224:227], v[182:185], v[150:153]
v_mfma_f32_16x16x32_bf16 v[150:153], a[228:231], v[186:189], v[150:153]
v_mfma_f32_16x16x32_bf16 v[154:157], a[248:251], v[182:185], v[154:157]
v_mfma_f32_16x16x32_bf16 v[154:157], a[252:255], v[186:189], v[154:157]
v_mfma_f32_16x16x32_bf16 v[158:161], v[240:243], v[182:185], v[158:161]
v_mfma_f32_16x16x32_bf16 v[158:161], v[244:247], v[186:189], v[158:161]
v_mfma_f32_16x16x32_bf16 v[162:165], v[182:185], a[80:83], v[162:165]
v_mfma_f32_16x16x32_bf16 v[162:165], v[186:189], a[84:87], v[162:165]
v_mfma_f32_16x16x32_bf16 v[166:169], v[182:185], a[104:107], v[166:169]
v_mfma_f32_16x16x32_bf16 v[166:169], v[186:189], a[108:111], v[166:169]
v_mfma_f32_16x16x32_bf16 v[170:173], v[182:185], a[128:131], v[170:173]
v_mfma_f32_16x16x32_bf16 v[170:173], v[186:189], a[132:135], v[170:173]
ds_read_b128 v[110:113], v210 offset:10240
ds_read_b128 v[106:109], v210 offset:11264
s_waitcnt lgkmcnt(1)
v_mfma_f32_16x16x32_bf16 v[138:141], a[16:19], v[110:113], v[138:141]
s_waitcnt lgkmcnt(0)
v_mfma_f32_16x16x32_bf16 v[138:141], a[20:23], v[106:109], v[138:141]
v_mfma_f32_16x16x32_bf16 v[142:145], a[40:43], v[110:113], v[142:145]
v_mfma_f32_16x16x32_bf16 v[142:145], a[44:47], v[106:109], v[142:145]
v_mfma_f32_16x16x32_bf16 v[146:149], a[64:67], v[110:113], v[146:149]
v_mfma_f32_16x16x32_bf16 v[146:149], a[68:71], v[106:109], v[146:149]
v_mfma_f32_16x16x32_bf16 v[150:153], a[232:235], v[110:113], v[150:153]
v_mfma_f32_16x16x32_bf16 v[150:153], a[236:239], v[106:109], v[150:153]
v_mfma_f32_16x16x32_bf16 v[154:157], v[224:227], v[110:113], v[154:157]
v_mfma_f32_16x16x32_bf16 v[154:157], v[228:231], v[106:109], v[154:157]
v_mfma_f32_16x16x32_bf16 v[158:161], v[248:251], v[110:113], v[158:161]
v_mfma_f32_16x16x32_bf16 v[158:161], v[252:255], v[106:109], v[158:161]
v_mfma_f32_16x16x32_bf16 v[162:165], v[110:113], a[88:91], v[162:165]
v_mfma_f32_16x16x32_bf16 v[162:165], v[106:109], a[92:95], v[162:165]
v_mfma_f32_16x16x32_bf16 v[166:169], v[110:113], a[112:115], v[166:169]
v_mfma_f32_16x16x32_bf16 v[166:169], v[106:109], a[116:119], v[166:169]
v_mfma_f32_16x16x32_bf16 v[170:173], v[110:113], a[136:139], v[170:173]
v_mfma_f32_16x16x32_bf16 v[170:173], v[106:109], a[140:143], v[170:173]
v_cvt_pk_bf16_f32 v96, v138, v139
v_cvt_pk_bf16_f32 v97, v140, v141
v_cvt_pk_bf16_f32 v98, v142, v143
v_cvt_pk_bf16_f32 v99, v144, v145
v_cvt_pk_bf16_f32 v100, v146, v147
v_cvt_pk_bf16_f32 v101, v148, v149
v_cvt_pk_bf16_f32 v84, v150, v151
v_cvt_pk_bf16_f32 v85, v152, v153
v_cvt_pk_bf16_f32 v86, v154, v155
v_cvt_pk_bf16_f32 v87, v156, v157
v_cvt_pk_bf16_f32 v88, v158, v159
v_cvt_pk_bf16_f32 v89, v160, v161
v_cvt_pk_bf16_f32 v116, v162, v163
v_cvt_pk_bf16_f32 v117, v164, v165
v_cvt_pk_bf16_f32 v124, v166, v167
v_cvt_pk_bf16_f32 v125, v168, v169
v_cvt_pk_bf16_f32 v132, v170, v171
v_cvt_pk_bf16_f32 v133, v172, v173
ds_read_b128 v[182:185], v210 offset:12288
ds_read_b128 v[186:189], v210 offset:13312
s_waitcnt lgkmcnt(1)
v_mfma_f32_16x16x32_bf16 v[138:141], a[0:3], v[182:185], 0
s_waitcnt lgkmcnt(0)
v_mfma_f32_16x16x32_bf16 v[138:141], a[4:7], v[186:189], v[138:141]
v_mfma_f32_16x16x32_bf16 v[142:145], a[24:27], v[182:185], 0
v_mfma_f32_16x16x32_bf16 v[142:145], a[28:31], v[186:189], v[142:145]
v_mfma_f32_16x16x32_bf16 v[146:149], a[48:51], v[182:185], 0
v_mfma_f32_16x16x32_bf16 v[146:149], a[52:55], v[186:189], v[146:149]
ds_read_b128 v[170:173], v210 offset:14336
ds_read_b128 v[182:185], v210 offset:15360
s_waitcnt lgkmcnt(1)
v_mfma_f32_16x16x32_bf16 v[138:141], a[8:11], v[170:173], v[138:141]
s_waitcnt lgkmcnt(0)
v_mfma_f32_16x16x32_bf16 v[138:141], a[12:15], v[182:185], v[138:141]
v_mfma_f32_16x16x32_bf16 v[142:145], a[32:35], v[170:173], v[142:145]
v_mfma_f32_16x16x32_bf16 v[142:145], a[36:39], v[182:185], v[142:145]
v_mfma_f32_16x16x32_bf16 v[146:149], a[56:59], v[170:173], v[146:149]
v_mfma_f32_16x16x32_bf16 v[146:149], a[60:63], v[182:185], v[146:149]
ds_read_b128 v[186:189], v210 offset:16384
ds_read_b128 v[170:173], v210 offset:17408
s_waitcnt lgkmcnt(1)
v_mfma_f32_16x16x32_bf16 v[138:141], a[16:19], v[186:189], v[138:141]
s_waitcnt lgkmcnt(0)
v_mfma_f32_16x16x32_bf16 v[138:141], a[20:23], v[170:173], v[138:141]
v_mfma_f32_16x16x32_bf16 v[142:145], a[40:43], v[186:189], v[142:145]
v_mfma_f32_16x16x32_bf16 v[142:145], a[44:47], v[170:173], v[142:145]
v_mfma_f32_16x16x32_bf16 v[146:149], a[64:67], v[186:189], v[146:149]
v_mfma_f32_16x16x32_bf16 v[146:149], a[68:71], v[170:173], v[146:149]
v_cvt_pk_bf16_f32 v102, v138, v139
v_cvt_pk_bf16_f32 v103, v140, v141
v_cvt_pk_bf16_f32 v104, v142, v143
v_cvt_pk_bf16_f32 v105, v144, v145
s_nop 2
v_cvt_pk_bf16_f32 v106, v146, v147
v_cvt_pk_bf16_f32 v107, v148, v149
ds_read_b128 v[108:111], v215 offset:512
ds_read_b64 v[112:113], v215 offset:528
v_mfma_f32_16x16x32_bf16 v[138:141], v[78:81], v[72:75], 0
v_mfma_f32_16x16x32_bf16 v[142:145], v[96:99], v[72:75], 0
s_waitcnt lgkmcnt(1)
v_mfma_f32_16x16x32_bf16 v[150:153], v[108:111], v[72:75], v[206:209]
v_mfma_f32_16x16x32_bf16 v[146:149], v[102:105], v[72:75], 0
v_mfma_f32_16x16x16_bf16 v[138:141], v[82:83], v[76:77], v[138:141]
v_mfma_f32_16x16x16_bf16 v[142:145], v[100:101], v[76:77], v[142:145]
s_waitcnt lgkmcnt(0)
v_mfma_f32_16x16x16_bf16 v[150:153], v[112:113], v[76:77], v[150:153]
v_mfma_f32_16x16x16_bf16 v[146:149], v[106:107], v[76:77], v[146:149]
ds_read_b128 v[72:75], v215
ds_read_b64 v[76:77], v215 offset:16
v_mfma_f32_16x16x16_bf16 v[154:157], v[82:83], v[88:89], 0
v_mfma_f32_16x16x16_bf16 v[158:161], v[100:101], v[88:89], 0
v_mfma_f32_16x16x16_bf16 v[166:169], v[112:113], v[88:89], v[206:209]
v_mfma_f32_16x16x16_bf16 v[162:165], v[106:107], v[88:89], 0
v_mfma_f32_16x16x32_bf16 v[154:157], v[78:81], v[84:87], v[154:157]
v_mfma_f32_16x16x32_bf16 v[158:161], v[96:99], v[84:87], v[158:161]
v_mfma_f32_16x16x32_bf16 v[166:169], v[108:111], v[84:87], v[166:169]
v_mfma_f32_16x16x32_bf16 v[162:165], v[102:105], v[84:87], v[162:165]
ds_read_b128 v[182:185], v210 offset:12288
ds_read_b128 v[186:189], v210 offset:13312
s_waitcnt lgkmcnt(1)
v_mfma_f32_16x16x32_bf16 v[118:121], v[182:185], a[72:75], 0
s_waitcnt lgkmcnt(0)
v_mfma_f32_16x16x32_bf16 v[118:121], v[186:189], a[76:79], v[118:121]
v_mfma_f32_16x16x32_bf16 v[126:129], v[182:185], a[96:99], 0
v_mfma_f32_16x16x32_bf16 v[126:129], v[186:189], a[100:103], v[126:129]
v_mfma_f32_16x16x32_bf16 v[134:137], v[182:185], a[120:123], 0
v_mfma_f32_16x16x32_bf16 v[134:137], v[186:189], a[124:127], v[134:137]
v_mfma_f32_16x16x32_bf16 v[90:93], a[216:219], v[182:185], 0
v_mfma_f32_16x16x32_bf16 v[90:93], a[220:223], v[186:189], v[90:93]
v_mfma_f32_16x16x32_bf16 v[170:173], a[240:243], v[182:185], 0
v_mfma_f32_16x16x32_bf16 v[170:173], a[244:247], v[186:189], v[170:173]
v_mfma_f32_16x16x32_bf16 v[220:223], v[232:235], v[182:185], 0
v_mfma_f32_16x16x32_bf16 v[220:223], v[236:239], v[186:189], v[220:223]
ds_read_b128 v[174:177], v210 offset:14336
ds_read_b128 v[178:181], v210 offset:15360
s_waitcnt lgkmcnt(1)
v_mfma_f32_16x16x32_bf16 v[118:121], v[174:177], a[80:83], v[118:121]
s_waitcnt lgkmcnt(0)
v_mfma_f32_16x16x32_bf16 v[118:121], v[178:181], a[84:87], v[118:121]
v_mfma_f32_16x16x32_bf16 v[126:129], v[174:177], a[104:107], v[126:129]
v_mfma_f32_16x16x32_bf16 v[126:129], v[178:181], a[108:111], v[126:129]
v_mfma_f32_16x16x32_bf16 v[134:137], v[174:177], a[128:131], v[134:137]
v_mfma_f32_16x16x32_bf16 v[134:137], v[178:181], a[132:135], v[134:137]
v_mfma_f32_16x16x32_bf16 v[90:93], a[224:227], v[174:177], v[90:93]
v_mfma_f32_16x16x32_bf16 v[90:93], a[228:231], v[178:181], v[90:93]
v_mfma_f32_16x16x32_bf16 v[170:173], a[248:251], v[174:177], v[170:173]
v_mfma_f32_16x16x32_bf16 v[170:173], a[252:255], v[178:181], v[170:173]
v_mfma_f32_16x16x32_bf16 v[220:223], v[240:243], v[174:177], v[220:223]
v_mfma_f32_16x16x32_bf16 v[220:223], v[244:247], v[178:181], v[220:223]
ds_read_b128 v[182:185], v210 offset:16384
ds_read_b128 v[186:189], v210 offset:17408
s_waitcnt lgkmcnt(1)
v_mfma_f32_16x16x32_bf16 v[118:121], v[182:185], a[88:91], v[118:121]
s_waitcnt lgkmcnt(0)
v_mfma_f32_16x16x32_bf16 v[118:121], v[186:189], a[92:95], v[118:121]
v_mfma_f32_16x16x32_bf16 v[126:129], v[182:185], a[112:115], v[126:129]
v_mfma_f32_16x16x32_bf16 v[126:129], v[186:189], a[116:119], v[126:129]
v_mfma_f32_16x16x32_bf16 v[134:137], v[182:185], a[136:139], v[134:137]
v_mfma_f32_16x16x32_bf16 v[134:137], v[186:189], a[140:143], v[134:137]
v_mfma_f32_16x16x32_bf16 v[90:93], a[232:235], v[182:185], v[90:93]
v_mfma_f32_16x16x32_bf16 v[90:93], a[236:239], v[186:189], v[90:93]
v_mfma_f32_16x16x32_bf16 v[170:173], v[224:227], v[182:185], v[170:173]
v_mfma_f32_16x16x32_bf16 v[170:173], v[228:231], v[186:189], v[170:173]
v_mfma_f32_16x16x32_bf16 v[220:223], v[248:251], v[182:185], v[220:223]
v_mfma_f32_16x16x32_bf16 v[220:223], v[252:255], v[186:189], v[220:223]
v_mov_b32 v181, 0
v_cvt_pk_bf16_f32 v118, v118, v119
v_cvt_pk_bf16_f32 v119, v120, v121
ds_read_u16 v120, v205
v_mov_b32 v121, 0
v_cvt_pk_bf16_f32 v126, v126, v127
v_cvt_pk_bf16_f32 v127, v128, v129
ds_read_u16 v128, v205 offset:32
v_mov_b32 v129, 0
v_cvt_pk_bf16_f32 v134, v134, v135
v_cvt_pk_bf16_f32 v135, v136, v137
ds_read_u16 v136, v205 offset:64
v_mov_b32 v137, 0
v_add_u32 v205, 1424, v205
v_cvt_pk_bf16_f32 v90, v90, v91
v_cvt_pk_bf16_f32 v91, v92, v93
v_cvt_pk_bf16_f32 v92, v170, v171
v_cvt_pk_bf16_f32 v93, v172, v173
v_cvt_pk_bf16_f32 v94, v220, v221
v_cvt_pk_bf16_f32 v95, v222, v223
v_max3_f32 v151, v138, v139, v140
v_max3_f32 v151, v151, v141, v142
v_max3_f32 v151, v151, v143, v144
v_max3_f32 v151, v151, v145, v146
v_max3_f32 v151, v151, v147, v148
v_max3_f32 v151, v151, v149, v150
v_mov_b32 v152, v151
s_nop 1
v_permlane16_swap_b32 v151, v152
v_max_f32 v151, v151, v152
v_mov_b32 v152, v151
s_nop 1
v_permlane32_swap_b32 v151, v152
v_max_f32 v151, v151, v152
v_sub_f32 v138, v138, v151
v_sub_f32 v139, v139, v151
v_sub_f32 v140, v140, v151
v_sub_f32 v141, v141, v151
v_sub_f32 v142, v142, v151
v_sub_f32 v143, v143, v151
v_sub_f32 v144, v144, v151
v_sub_f32 v145, v145, v151
v_sub_f32 v150, v150, v151
v_sub_f32 v146, v146, v151
v_sub_f32 v147, v147, v151
v_sub_f32 v148, v148, v151
v_sub_f32 v149, v149, v151
v_exp_f32 v138, v138
v_exp_f32 v139, v139
v_exp_f32 v140, v140
v_exp_f32 v141, v141
v_exp_f32 v142, v142
v_exp_f32 v143, v143
v_exp_f32 v144, v144
v_exp_f32 v145, v145
v_exp_f32 v150, v150
v_exp_f32 v146, v146
v_exp_f32 v147, v147
v_exp_f32 v148, v148
v_exp_f32 v149, v149
v_cvt_pk_bf16_f32 v174, v138, v139
v_cvt_pk_bf16_f32 v175, v140, v141
v_cvt_pk_bf16_f32 v176, v142, v143
v_cvt_pk_bf16_f32 v177, v144, v145
v_cvt_pk_bf16_f32 v178, v146, v147
v_cvt_pk_bf16_f32 v179, v148, v149
v_cvt_pk_bf16_f32 v180, v150, 0
v_mfma_f32_16x16x32_bf16 v[150:153], v[190:193], v[174:177], 0
v_mfma_f32_16x16x32_bf16 v[150:153], v[190:193], v[178:181], v[150:153]
v_mfma_f32_16x16x32_bf16 v[138:141], v[114:117], v[174:177], 0
s_waitcnt lgkmcnt(2)
v_mfma_f32_16x16x32_bf16 v[138:141], v[118:121], v[178:181], v[138:141]
v_mfma_f32_16x16x32_bf16 v[142:145], v[122:125], v[174:177], 0
s_waitcnt lgkmcnt(1)
v_mfma_f32_16x16x32_bf16 v[142:145], v[126:129], v[178:181], v[142:145]
v_mfma_f32_16x16x32_bf16 v[146:149], v[130:133], v[174:177], 0
s_waitcnt lgkmcnt(0)
v_mfma_f32_16x16x32_bf16 v[146:149], v[134:137], v[178:181], v[146:149]
v_max3_f32 v167, v154, v155, v156
v_max3_f32 v167, v167, v157, v158
v_max3_f32 v167, v167, v159, v160
v_max3_f32 v167, v167, v161, v162
v_max3_f32 v167, v167, v163, v164
v_max3_f32 v167, v167, v165, v166
v_mov_b32 v168, v167
s_nop 1
v_permlane16_swap_b32 v167, v168
v_max_f32 v167, v167, v168
v_mov_b32 v168, v167
s_nop 1
v_permlane32_swap_b32 v167, v168
v_max_f32 v167, v167, v168
v_sub_f32 v154, v154, v167
v_sub_f32 v155, v155, v167
v_sub_f32 v156, v156, v167
v_sub_f32 v157, v157, v167
v_sub_f32 v158, v158, v167
v_sub_f32 v159, v159, v167
v_sub_f32 v160, v160, v167
v_sub_f32 v161, v161, v167
v_sub_f32 v166, v166, v167
v_sub_f32 v162, v162, v167
v_sub_f32 v163, v163, v167
v_sub_f32 v164, v164, v167
v_sub_f32 v165, v165, v167
v_exp_f32 v154, v154
v_exp_f32 v155, v155
v_exp_f32 v156, v156
v_exp_f32 v157, v157
v_exp_f32 v158, v158
v_exp_f32 v159, v159
v_exp_f32 v160, v160
v_exp_f32 v161, v161
v_exp_f32 v166, v166
v_exp_f32 v162, v162
v_exp_f32 v163, v163
v_exp_f32 v164, v164
v_exp_f32 v165, v165
v_cvt_pk_bf16_f32 v174, v154, v155
v_cvt_pk_bf16_f32 v175, v156, v157
v_cvt_pk_bf16_f32 v176, v158, v159
v_cvt_pk_bf16_f32 v177, v160, v161
v_cvt_pk_bf16_f32 v178, v162, v163
v_cvt_pk_bf16_f32 v179, v164, v165
v_cvt_pk_bf16_f32 v180, v166, 0
v_mfma_f32_16x16x32_bf16 v[166:169], v[190:193], v[174:177], 0
v_mfma_f32_16x16x32_bf16 v[166:169], v[190:193], v[178:181], v[166:169]
v_mfma_f32_16x16x32_bf16 v[154:157], v[114:117], v[174:177], 0
v_mfma_f32_16x16x32_bf16 v[154:157], v[118:121], v[178:181], v[154:157]
v_mfma_f32_16x16x32_bf16 v[158:161], v[122:125], v[174:177], 0
v_mfma_f32_16x16x32_bf16 v[158:161], v[126:129], v[178:181], v[158:161]
v_mfma_f32_16x16x32_bf16 v[162:165], v[130:133], v[174:177], 0
v_mfma_f32_16x16x32_bf16 v[162:165], v[134:137], v[178:181], v[162:165]
v_rcp_f32 v151, v150
s_nop 0
v_mul_f32 v152, s3, v151
v_mul_f32 v138, v138, v152
v_mul_f32 v139, v139, v152
v_cvt_pk_bf16_f32 v138, v138, v139
v_mul_f32 v140, v140, v152
v_mul_f32 v141, v141, v152
v_cvt_pk_bf16_f32 v139, v140, v141
v_mul_f32 v142, v142, v152
v_mul_f32 v143, v143, v152
v_cvt_pk_bf16_f32 v140, v142, v143
v_mul_f32 v144, v144, v152
v_mul_f32 v145, v145, v152
v_cvt_pk_bf16_f32 v141, v144, v145
ds_write_b128 v211, v[138:141] offset:38912
v_mul_f32 v146, v146, v152
v_mul_f32 v147, v147, v152
v_cvt_pk_bf16_f32 v142, v146, v147
v_mul_f32 v148, v148, v152
v_mul_f32 v149, v149, v152
v_cvt_pk_bf16_f32 v143, v148, v149
ds_write_b64 v212, v[142:143] offset:38912
v_mfma_f32_16x16x32_bf16 v[138:141], v[78:81], v[90:93], 0
v_mfma_f32_16x16x32_bf16 v[142:145], v[96:99], v[90:93], 0
v_mfma_f32_16x16x32_bf16 v[150:153], v[108:111], v[90:93], v[206:209]
v_mfma_f32_16x16x32_bf16 v[146:149], v[102:105], v[90:93], 0
v_mfma_f32_16x16x16_bf16 v[138:141], v[82:83], v[94:95], v[138:141]
v_mfma_f32_16x16x16_bf16 v[142:145], v[100:101], v[94:95], v[142:145]
v_mfma_f32_16x16x16_bf16 v[150:153], v[112:113], v[94:95], v[150:153]
v_mfma_f32_16x16x16_bf16 v[146:149], v[106:107], v[94:95], v[146:149]
v_rcp_f32 v167, v166
s_nop 0
v_mul_f32 v168, s3, v167
v_mul_f32 v154, v154, v168
v_mul_f32 v155, v155, v168
v_cvt_pk_bf16_f32 v154, v154, v155
v_mul_f32 v156, v156, v168
v_mul_f32 v157, v157, v168
v_cvt_pk_bf16_f32 v155, v156, v157
v_mul_f32 v158, v158, v168
v_mul_f32 v159, v159, v168
v_cvt_pk_bf16_f32 v156, v158, v159
v_mul_f32 v160, v160, v168
v_mul_f32 v161, v161, v168
v_cvt_pk_bf16_f32 v157, v160, v161
ds_write_b128 v211, v[154:157] offset:45056
v_mul_f32 v162, v162, v168
v_mul_f32 v163, v163, v168
v_cvt_pk_bf16_f32 v158, v162, v163
v_mul_f32 v164, v164, v168
v_mul_f32 v165, v165, v168
v_cvt_pk_bf16_f32 v159, v164, v165
ds_write_b64 v212, v[158:159] offset:45056
v_mfma_f32_16x16x16_bf16 v[154:157], v[76:77], v[82:83], 0
v_mfma_f32_16x16x16_bf16 v[158:161], v[76:77], v[100:101], 0
v_mfma_f32_16x16x16_bf16 v[162:165], v[76:77], v[106:107], 0
v_mfma_f32_16x16x16_bf16 v[166:169], v[76:77], v[112:113], v[206:209]
v_mfma_f32_16x16x32_bf16 v[154:157], v[72:75], v[78:81], v[154:157]
v_mfma_f32_16x16x32_bf16 v[158:161], v[72:75], v[96:99], v[158:161]
v_mfma_f32_16x16x32_bf16 v[162:165], v[72:75], v[102:105], v[162:165]
v_mfma_f32_16x16x32_bf16 v[166:169], v[72:75], v[108:111], v[166:169]
v_mov_b32_dpp v154, v158 quad_perm:[0,1,2,3] row_mask:0x2 bank_mask:0xf
s_nop 1
v_mov_b32_dpp v154, v162 quad_perm:[0,1,2,3] row_mask:0x4 bank_mask:0xf
s_nop 2
v_mov_b32_dpp v154, v167 quad_perm:[0,1,2,3] row_mask:0x8 bank_mask:0xf
v_mov_b32 v155, v154
s_nop 1
v_max_f32_dpp v155, v155, v155 row_ror:8 row_mask:0xf bank_mask:0xf
s_nop 1
v_max_f32_dpp v155, v155, v155 row_ror:4 row_mask:0xf bank_mask:0xf
s_nop 1
v_max_f32_dpp v155, v155, v155 row_ror:2 row_mask:0xf bank_mask:0xf
s_nop 1
v_max_f32_dpp v155, v155, v155 row_ror:1 row_mask:0xf bank_mask:0xf
v_mov_b32 v156, v155
s_nop 1
v_permlane16_swap_b32 v155, v156
v_max_f32 v155, v155, v156
v_mov_b32 v156, v155
s_nop 1
v_permlane32_swap_b32 v155, v156
v_max_f32 v155, v155, v156
v_sub_f32 v154, v154, v155
v_exp_f32 v154, v154
s_nop 0
v_cvt_pk_bf16_f32 v154, v154, 0
ds_write_b16 v214, v154
ds_read_b128 v[84:87], v215
s_waitcnt lgkmcnt(2)
ds_read_b128 v[88:91], v215 offset:16
v_add_u32 v215, 1424, v215
s_barrier
ds_read_b128 v[220:223], v210 offset:38912
ds_read_b128 v[110:113], v210 offset:39936
s_waitcnt lgkmcnt(1)
v_mfma_f32_16x16x32_bf16 v[0:3], a[144:147], v[220:223], v[0:3]
s_waitcnt lgkmcnt(0)
v_mfma_f32_16x16x32_bf16 v[0:3], a[148:151], v[110:113], v[0:3]
v_mfma_f32_16x16x32_bf16 v[4:7], a[168:171], v[220:223], v[4:7]
v_mfma_f32_16x16x32_bf16 v[4:7], a[172:175], v[110:113], v[4:7]
v_mfma_f32_16x16x32_bf16 v[8:11], a[192:195], v[220:223], v[8:11]
v_mfma_f32_16x16x32_bf16 v[8:11], a[196:199], v[110:113], v[8:11]
ds_read_b128 v[170:173], v210 offset:40960
ds_read_b128 v[182:185], v210 offset:41984
s_waitcnt lgkmcnt(1)
v_mfma_f32_16x16x32_bf16 v[0:3], a[152:155], v[170:173], v[0:3]
s_waitcnt lgkmcnt(0)
v_mfma_f32_16x16x32_bf16 v[0:3], a[156:159], v[182:185], v[0:3]
v_mfma_f32_16x16x32_bf16 v[4:7], a[176:179], v[170:173], v[4:7]
v_mfma_f32_16x16x32_bf16 v[4:7], a[180:183], v[182:185], v[4:7]
v_mfma_f32_16x16x32_bf16 v[8:11], a[200:203], v[170:173], v[8:11]
v_mfma_f32_16x16x32_bf16 v[8:11], a[204:207], v[182:185], v[8:11]
ds_read_b128 v[186:189], v210 offset:43008
ds_read_b128 v[220:223], v210 offset:44032
s_waitcnt lgkmcnt(1)
v_mfma_f32_16x16x32_bf16 v[0:3], a[160:163], v[186:189], v[0:3]
s_waitcnt lgkmcnt(0)
v_mfma_f32_16x16x32_bf16 v[0:3], a[164:167], v[220:223], v[0:3]
v_mfma_f32_16x16x32_bf16 v[4:7], a[184:187], v[186:189], v[4:7]
v_mfma_f32_16x16x32_bf16 v[4:7], a[188:191], v[220:223], v[4:7]
v_mfma_f32_16x16x32_bf16 v[8:11], a[208:211], v[186:189], v[8:11]
v_mfma_f32_16x16x32_bf16 v[8:11], a[212:215], v[220:223], v[8:11]
v_cvt_pk_bf16_f32 v0, v0, v1
v_cvt_pk_bf16_f32 v1, v2, v3
ds_write_b64 v203, v[0:1]
v_cvt_pk_bf16_f32 v4, v4, v5
v_cvt_pk_bf16_f32 v5, v6, v7
ds_write_b64 v203, v[4:5] offset:32
v_cvt_pk_bf16_f32 v8, v8, v9
v_cvt_pk_bf16_f32 v9, v10, v11
ds_write_b64 v203, v[8:9] offset:64
v_max3_f32 v151, v138, v139, v140
v_max3_f32 v151, v151, v141, v142
v_max3_f32 v151, v151, v143, v144
v_max3_f32 v151, v151, v145, v146
v_max3_f32 v151, v151, v147, v148
v_max3_f32 v151, v151, v149, v150
v_mov_b32 v152, v151
s_nop 1
v_permlane16_swap_b32 v151, v152
v_max_f32 v151, v151, v152
v_mov_b32 v152, v151
s_nop 1
v_permlane32_swap_b32 v151, v152
v_max_f32 v151, v151, v152
v_sub_f32 v138, v138, v151
v_sub_f32 v139, v139, v151
v_sub_f32 v140, v140, v151
v_sub_f32 v141, v141, v151
v_sub_f32 v142, v142, v151
v_sub_f32 v143, v143, v151
v_sub_f32 v144, v144, v151
v_sub_f32 v145, v145, v151
v_sub_f32 v150, v150, v151
v_sub_f32 v146, v146, v151
v_sub_f32 v147, v147, v151
v_sub_f32 v148, v148, v151
v_sub_f32 v149, v149, v151
v_exp_f32 v138, v138
v_exp_f32 v139, v139
v_exp_f32 v140, v140
v_exp_f32 v141, v141
v_exp_f32 v142, v142
v_exp_f32 v143, v143
v_exp_f32 v144, v144
v_exp_f32 v145, v145
v_exp_f32 v150, v150
v_exp_f32 v146, v146
v_exp_f32 v147, v147
v_exp_f32 v148, v148
v_exp_f32 v149, v149
v_cvt_pk_bf16_f32 v174, v138, v139
v_cvt_pk_bf16_f32 v175, v140, v141
v_cvt_pk_bf16_f32 v176, v142, v143
v_cvt_pk_bf16_f32 v177, v144, v145
v_cvt_pk_bf16_f32 v178, v146, v147
v_cvt_pk_bf16_f32 v179, v148, v149
v_cvt_pk_bf16_f32 v180, v150, 0
v_mfma_f32_16x16x32_bf16 v[150:153], v[190:193], v[174:177], 0
v_mfma_f32_16x16x32_bf16 v[150:153], v[190:193], v[178:181], v[150:153]
v_mfma_f32_16x16x32_bf16 v[138:141], v[114:117], v[174:177], 0
v_mfma_f32_16x16x32_bf16 v[138:141], v[118:121], v[178:181], v[138:141]
v_mfma_f32_16x16x32_bf16 v[142:145], v[122:125], v[174:177], 0
v_mfma_f32_16x16x32_bf16 v[142:145], v[126:129], v[178:181], v[142:145]
v_mfma_f32_16x16x32_bf16 v[146:149], v[130:133], v[174:177], 0
v_mfma_f32_16x16x32_bf16 v[146:149], v[134:137], v[178:181], v[146:149]
v_rcp_f32 v151, v150
s_nop 0
v_mul_f32 v152, s3, v151
v_mul_f32 v138, v138, v152
v_mul_f32 v139, v139, v152
v_cvt_pk_bf16_f32 v138, v138, v139
v_mul_f32 v140, v140, v152
v_mul_f32 v141, v141, v152
v_cvt_pk_bf16_f32 v139, v140, v141
v_mul_f32 v142, v142, v152
v_mul_f32 v143, v143, v152
v_cvt_pk_bf16_f32 v140, v142, v143
v_mul_f32 v144, v144, v152
v_mul_f32 v145, v145, v152
v_cvt_pk_bf16_f32 v141, v144, v145
ds_write_b128 v211, v[138:141] offset:51200
v_mul_f32 v146, v146, v152
v_mul_f32 v147, v147, v152
v_cvt_pk_bf16_f32 v142, v146, v147
v_mul_f32 v148, v148, v152
v_mul_f32 v149, v149, v152
v_cvt_pk_bf16_f32 v143, v148, v149
ds_write_b64 v212, v[142:143] offset:51200
v_mfma_f32_16x16x32_bf16 v[166:169], v[84:87], v[190:193], 0
v_mfma_f32_16x16x32_bf16 v[166:169], v[88:91], v[190:193], v[166:169]
v_mfma_f32_16x16x32_bf16 v[154:157], v[84:87], v[114:117], 0
v_mfma_f32_16x16x32_bf16 v[154:157], v[88:91], v[118:121], v[154:157]
v_mfma_f32_16x16x32_bf16 v[158:161], v[84:87], v[122:125], 0
v_mfma_f32_16x16x32_bf16 v[158:161], v[88:91], v[126:129], v[158:161]
v_mfma_f32_16x16x32_bf16 v[162:165], v[84:87], v[130:133], 0
v_mfma_f32_16x16x32_bf16 v[162:165], v[88:91], v[134:137], v[162:165]
v_rcp_f32 v167, v166
v_mov_b32_dpp v154, v158 quad_perm:[0,1,2,3] row_mask:0x2 bank_mask:0xf
s_nop 3
v_mov_b32_dpp v154, v162 quad_perm:[0,1,2,3] row_mask:0x4 bank_mask:0xf
v_mul_f32 v168, s3, v167
v_mul_f32 v154, v154, v168
v_cvt_pk_bf16_f32 v154, v154, 0
ds_write_b16 v214, v154
v_add_u32 v214, 1424, v214
ds_read_b128 v[110:113], v210 offset:45056
ds_read_b128 v[170:173], v210 offset:46080
s_waitcnt lgkmcnt(1)
v_mfma_f32_16x16x32_bf16 v[12:15], a[144:147], v[110:113], v[12:15]
s_waitcnt lgkmcnt(0)
v_mfma_f32_16x16x32_bf16 v[12:15], a[148:151], v[170:173], v[12:15]
v_mfma_f32_16x16x32_bf16 v[16:19], a[168:171], v[110:113], v[16:19]
v_mfma_f32_16x16x32_bf16 v[16:19], a[172:175], v[170:173], v[16:19]
v_mfma_f32_16x16x32_bf16 v[20:23], a[192:195], v[110:113], v[20:23]
v_mfma_f32_16x16x32_bf16 v[20:23], a[196:199], v[170:173], v[20:23]
ds_read_b128 v[182:185], v210 offset:47104
ds_read_b128 v[186:189], v210 offset:48128
s_waitcnt lgkmcnt(1)
v_mfma_f32_16x16x32_bf16 v[12:15], a[152:155], v[182:185], v[12:15]
s_waitcnt lgkmcnt(0)
v_mfma_f32_16x16x32_bf16 v[12:15], a[156:159], v[186:189], v[12:15]
v_mfma_f32_16x16x32_bf16 v[16:19], a[176:179], v[182:185], v[16:19]
v_mfma_f32_16x16x32_bf16 v[16:19], a[180:183], v[186:189], v[16:19]
v_mfma_f32_16x16x32_bf16 v[20:23], a[200:203], v[182:185], v[20:23]
v_mfma_f32_16x16x32_bf16 v[20:23], a[204:207], v[186:189], v[20:23]
ds_read_b128 v[220:223], v210 offset:49152
ds_read_b128 v[110:113], v210 offset:50176
s_waitcnt lgkmcnt(1)
v_mfma_f32_16x16x32_bf16 v[12:15], a[160:163], v[220:223], v[12:15]
s_waitcnt lgkmcnt(0)
v_mfma_f32_16x16x32_bf16 v[12:15], a[164:167], v[110:113], v[12:15]
v_mfma_f32_16x16x32_bf16 v[16:19], a[184:187], v[220:223], v[16:19]
v_mfma_f32_16x16x32_bf16 v[16:19], a[188:191], v[110:113], v[16:19]
v_mfma_f32_16x16x32_bf16 v[20:23], a[208:211], v[220:223], v[20:23]
v_mfma_f32_16x16x32_bf16 v[20:23], a[212:215], v[110:113], v[20:23]
v_cvt_pk_bf16_f32 v12, v12, v13
v_cvt_pk_bf16_f32 v13, v14, v15
ds_write_b64 v203, v[12:13] offset:6272
v_cvt_pk_bf16_f32 v16, v16, v17
v_cvt_pk_bf16_f32 v17, v18, v19
ds_write_b64 v203, v[16:17] offset:6304
v_cvt_pk_bf16_f32 v20, v20, v21
v_cvt_pk_bf16_f32 v21, v22, v23
ds_write_b64 v203, v[20:21] offset:6336
s_waitcnt vmcnt(0)
s_barrier
ds_read_b64 v[120:121], v204
s_add_u32 s28, s38, s60
s_waitcnt lgkmcnt(0)
buffer_store_dwordx2 v[120:121], v204, s[8:11], s28 offen sc1
ds_read_b64 v[128:129], v204 offset:392
s_add_u32 s29, s38, s61
s_waitcnt lgkmcnt(0)
buffer_store_dwordx2 v[128:129], v204, s[8:11], s29 offen sc1
ds_read_b64 v[136:137], v204 offset:784
s_add_u32 s28, s38, s62
s_waitcnt lgkmcnt(0)
buffer_store_dwordx2 v[136:137], v204, s[8:11], s28 offen sc1
ds_read_b64 v[120:121], v204 offset:1176
s_add_u32 s29, s38, s63
s_waitcnt lgkmcnt(0)
buffer_store_dwordx2 v[120:121], v204, s[8:11], s29 offen sc1
ds_read_b128 v[170:173], v210 offset:51200
ds_read_b128 v[182:185], v210 offset:52224
s_waitcnt lgkmcnt(1)
v_mfma_f32_16x16x32_bf16 v[24:27], a[144:147], v[170:173], v[24:27]
s_waitcnt lgkmcnt(0)
v_mfma_f32_16x16x32_bf16 v[24:27], a[148:151], v[182:185], v[24:27]
v_mfma_f32_16x16x32_bf16 v[28:31], a[168:171], v[170:173], v[28:31]
v_mfma_f32_16x16x32_bf16 v[28:31], a[172:175], v[182:185], v[28:31]
v_mfma_f32_16x16x32_bf16 v[32:35], a[192:195], v[170:173], v[32:35]
v_mfma_f32_16x16x32_bf16 v[32:35], a[196:199], v[182:185], v[32:35]
ds_read_b128 v[186:189], v210 offset:53248
ds_read_b128 v[220:223], v210 offset:54272
s_waitcnt lgkmcnt(1)
v_mfma_f32_16x16x32_bf16 v[24:27], a[152:155], v[186:189], v[24:27]
s_waitcnt lgkmcnt(0)
v_mfma_f32_16x16x32_bf16 v[24:27], a[156:159], v[220:223], v[24:27]
v_mfma_f32_16x16x32_bf16 v[28:31], a[176:179], v[186:189], v[28:31]
v_mfma_f32_16x16x32_bf16 v[28:31], a[180:183], v[220:223], v[28:31]
v_mfma_f32_16x16x32_bf16 v[32:35], a[200:203], v[186:189], v[32:35]
v_mfma_f32_16x16x32_bf16 v[32:35], a[204:207], v[220:223], v[32:35]
ds_read_b128 v[110:113], v210 offset:55296
ds_read_b128 v[170:173], v210 offset:56320
s_waitcnt lgkmcnt(1)
v_mfma_f32_16x16x32_bf16 v[24:27], a[160:163], v[110:113], v[24:27]
s_waitcnt lgkmcnt(0)
v_mfma_f32_16x16x32_bf16 v[24:27], a[164:167], v[170:173], v[24:27]
v_mfma_f32_16x16x32_bf16 v[28:31], a[184:187], v[110:113], v[28:31]
v_mfma_f32_16x16x32_bf16 v[28:31], a[188:191], v[170:173], v[28:31]
v_mfma_f32_16x16x32_bf16 v[32:35], a[208:211], v[110:113], v[32:35]
v_mfma_f32_16x16x32_bf16 v[32:35], a[212:215], v[170:173], v[32:35]
v_cvt_pk_bf16_f32 v24, v24, v25
v_cvt_pk_bf16_f32 v25, v26, v27
ds_write_b64 v203, v[24:25] offset:12544
v_cvt_pk_bf16_f32 v28, v28, v29
v_cvt_pk_bf16_f32 v29, v30, v31
ds_write_b64 v203, v[28:29] offset:12576
v_cvt_pk_bf16_f32 v32, v32, v33
v_cvt_pk_bf16_f32 v33, v34, v35
ds_write_b64 v203, v[32:33] offset:12608
s_mov_b32 s39, s37
ds_read_b128 v[174:177], v217
ds_read_b128 v[84:87], v200
s_waitcnt lgkmcnt(0)
v_mfma_f32_16x16x32_bf16 v[0:3], v[174:177], v[84:87], 0
ds_read_b128 v[92:95], v201
s_waitcnt lgkmcnt(0)
v_mfma_f32_16x16x32_bf16 v[12:15], v[174:177], v[92:95], 0
ds_read_b128 v[100:103], v202
s_waitcnt lgkmcnt(0)
v_mfma_f32_16x16x32_bf16 v[24:27], v[174:177], v[100:103], 0
ds_read_b128 v[178:181], v217 offset:528
ds_read_b128 v[84:87], v194
ds_read_b128 v[88:91], v194 offset:16
s_waitcnt lgkmcnt(0)
v_smfmac_f32_16x16x64_bf16 v[0:3], v[178:181], v[84:91], v213
ds_read_b128 v[92:95], v195
ds_read_b128 v[96:99], v195 offset:16
s_waitcnt lgkmcnt(0)
v_smfmac_f32_16x16x64_bf16 v[12:15], v[178:181], v[92:99], v213
ds_read_b128 v[100:103], v196
ds_read_b128 v[104:107], v196 offset:16
s_waitcnt lgkmcnt(0)
v_smfmac_f32_16x16x64_bf16 v[24:27], v[178:181], v[100:107], v213
ds_read_b128 v[174:177], v217 offset:1056
ds_read_b128 v[84:87], v197
ds_read_b128 v[88:91], v197 offset:16
s_waitcnt lgkmcnt(0)
v_smfmac_f32_16x16x64_bf16 v[0:3], v[174:177], v[84:91], v213
ds_read_b128 v[92:95], v198
ds_read_b128 v[96:99], v198 offset:16
s_waitcnt lgkmcnt(0)
v_smfmac_f32_16x16x64_bf16 v[12:15], v[174:177], v[92:99], v213
ds_read_b128 v[100:103], v199
ds_read_b128 v[104:107], v199 offset:16
s_waitcnt lgkmcnt(0)
v_smfmac_f32_16x16x64_bf16 v[24:27], v[174:177], v[100:107], v213
ds_read_b128 v[178:181], v217 offset:1584
ds_read_b128 v[84:87], v200 offset:32
s_waitcnt lgkmcnt(0)
v_mfma_f32_16x16x32_bf16 v[4:7], v[178:181], v[84:87], 0
ds_read_b128 v[92:95], v201 offset:32
s_waitcnt lgkmcnt(0)
v_mfma_f32_16x16x32_bf16 v[16:19], v[178:181], v[92:95], 0
ds_read_b128 v[100:103], v202 offset:32
s_waitcnt lgkmcnt(0)
v_mfma_f32_16x16x32_bf16 v[28:31], v[178:181], v[100:103], 0
ds_read_b128 v[174:177], v217 offset:2112
ds_read_b128 v[84:87], v194 offset:32
ds_read_b128 v[88:91], v194 offset:48
s_waitcnt lgkmcnt(0)
v_smfmac_f32_16x16x64_bf16 v[4:7], v[174:177], v[84:91], v213
ds_read_b128 v[92:95], v195 offset:32
ds_read_b128 v[96:99], v195 offset:48
s_waitcnt lgkmcnt(0)
v_smfmac_f32_16x16x64_bf16 v[16:19], v[174:177], v[92:99], v213
ds_read_b128 v[100:103], v196 offset:32
ds_read_b128 v[104:107], v196 offset:48
s_waitcnt lgkmcnt(0)
v_smfmac_f32_16x16x64_bf16 v[28:31], v[174:177], v[100:107], v213
ds_read_b128 v[178:181], v217 offset:2640
ds_read_b128 v[84:87], v197 offset:32
ds_read_b128 v[88:91], v197 offset:48
s_waitcnt lgkmcnt(0)
v_smfmac_f32_16x16x64_bf16 v[4:7], v[178:181], v[84:91], v213
ds_read_b128 v[92:95], v198 offset:32
ds_read_b128 v[96:99], v198 offset:48
s_waitcnt lgkmcnt(0)
v_smfmac_f32_16x16x64_bf16 v[16:19], v[178:181], v[92:99], v213
ds_read_b128 v[100:103], v199 offset:32
ds_read_b128 v[104:107], v199 offset:48
s_waitcnt lgkmcnt(0)
v_smfmac_f32_16x16x64_bf16 v[28:31], v[178:181], v[100:107], v213
ds_read_b128 v[174:177], v217 offset:3168
ds_read_b128 v[84:87], v200 offset:64
s_waitcnt lgkmcnt(0)
v_mfma_f32_16x16x32_bf16 v[8:11], v[174:177], v[84:87], 0
ds_read_b128 v[92:95], v201 offset:64
s_waitcnt lgkmcnt(0)
v_mfma_f32_16x16x32_bf16 v[20:23], v[174:177], v[92:95], 0
ds_read_b128 v[100:103], v202 offset:64
s_waitcnt lgkmcnt(0)
v_mfma_f32_16x16x32_bf16 v[32:35], v[174:177], v[100:103], 0
ds_read_b128 v[178:181], v217 offset:3696
ds_read_b128 v[84:87], v194 offset:64
ds_read_b128 v[88:91], v194 offset:80
s_waitcnt lgkmcnt(0)
v_smfmac_f32_16x16x64_bf16 v[8:11], v[178:181], v[84:91], v213
ds_read_b128 v[92:95], v195 offset:64
ds_read_b128 v[96:99], v195 offset:80
s_waitcnt lgkmcnt(0)
v_smfmac_f32_16x16x64_bf16 v[20:23], v[178:181], v[92:99], v213
ds_read_b128 v[100:103], v196 offset:64
ds_read_b128 v[104:107], v196 offset:80
s_waitcnt lgkmcnt(0)
v_smfmac_f32_16x16x64_bf16 v[32:35], v[178:181], v[100:107], v213
ds_read_b128 v[174:177], v217 offset:4224
ds_read_b128 v[84:87], v197 offset:64
ds_read_b128 v[88:91], v197 offset:80
s_waitcnt lgkmcnt(0)
v_smfmac_f32_16x16x64_bf16 v[8:11], v[174:177], v[84:91], v213
ds_read_b128 v[92:95], v198 offset:64
ds_read_b128 v[96:99], v198 offset:80
s_waitcnt lgkmcnt(0)
v_smfmac_f32_16x16x64_bf16 v[20:23], v[174:177], v[92:99], v213
ds_read_b128 v[100:103], v199 offset:64
ds_read_b128 v[104:107], v199 offset:80
s_waitcnt lgkmcnt(0)
v_smfmac_f32_16x16x64_bf16 v[32:35], v[174:177], v[100:107], v213
v_add_f32 v118, v0, v1
v_mul_f32 v119, v0, v0
v_add_f32 v118, v118, v2
v_fmac_f32 v119, v1, v1
v_add_f32 v118, v118, v3
v_fmac_f32 v119, v2, v2
v_fmac_f32 v119, v3, v3
v_add_f32 v126, v12, v13
v_mul_f32 v127, v12, v12
v_add_f32 v126, v126, v14
v_fmac_f32 v127, v13, v13
v_add_f32 v126, v126, v15
v_fmac_f32 v127, v14, v14
v_fmac_f32 v127, v15, v15
v_add_f32 v134, v24, v25
v_mul_f32 v135, v24, v24
v_add_f32 v134, v134, v26
v_fmac_f32 v135, v25, v25
v_add_f32 v134, v134, v27
v_fmac_f32 v135, v26, v26
v_fmac_f32 v135, v27, v27
v_add_f32 v118, v118, v4
v_fmac_f32 v119, v4, v4
v_add_f32 v118, v118, v5
v_fmac_f32 v119, v5, v5
v_add_f32 v118, v118, v6
v_fmac_f32 v119, v6, v6
v_add_f32 v118, v118, v7
v_fmac_f32 v119, v7, v7
v_add_f32 v126, v126, v16
v_fmac_f32 v127, v16, v16
v_add_f32 v126, v126, v17
v_fmac_f32 v127, v17, v17
v_add_f32 v126, v126, v18
v_fmac_f32 v127, v18, v18
v_add_f32 v126, v126, v19
v_fmac_f32 v127, v19, v19
v_add_f32 v134, v134, v28
v_fmac_f32 v135, v28, v28
v_add_f32 v134, v134, v29
v_fmac_f32 v135, v29, v29
v_add_f32 v134, v134, v30
v_fmac_f32 v135, v30, v30
v_add_f32 v134, v134, v31
v_fmac_f32 v135, v31, v31
v_add_f32 v118, v118, v8
v_fmac_f32 v119, v8, v8
v_add_f32 v118, v118, v9
v_fmac_f32 v119, v9, v9
v_add_f32 v118, v118, v10
v_fmac_f32 v119, v10, v10
v_add_f32 v118, v118, v11
v_fmac_f32 v119, v11, v11
v_add_f32 v126, v126, v20
v_fmac_f32 v127, v20, v20
v_add_f32 v126, v126, v21
v_fmac_f32 v127, v21, v21
v_add_f32 v126, v126, v22
v_fmac_f32 v127, v22, v22
v_add_f32 v126, v126, v23
v_fmac_f32 v127, v23, v23
v_add_f32 v134, v134, v32
v_fmac_f32 v135, v32, v32
v_add_f32 v134, v134, v33
v_fmac_f32 v135, v33, v33
v_add_f32 v134, v134, v34
v_fmac_f32 v135, v34, v34
v_add_f32 v134, v134, v35
v_fmac_f32 v135, v35, v35
v_permlane16_swap_b32 v118, v119
v_add_f32 v118, v118, v119
v_permlane16_swap_b32 v126, v127
v_add_f32 v126, v126, v127
v_permlane16_swap_b32 v134, v135
v_add_f32 v134, v134, v135
v_permlane32_swap_b32 v118, v126
v_add_f32 v118, v118, v126
ds_write_b32 v209, v118
v_mov_b32 v135, v134
s_nop 1
v_permlane32_swap_b32 v134, v135
v_add_f32 v134, v134, v135
ds_write_b32 v209, v134 offset:512
s_waitcnt lgkmcnt(0)
s_barrier
ds_read_b64 v[128:129], v204 offset:6272
s_add_u32 s28, s38, s64
s_waitcnt lgkmcnt(0)
buffer_store_dwordx2 v[128:129], v204, s[8:11], s28 offen sc1
ds_read_b64 v[136:137], v204 offset:6664
s_add_u32 s29, s38, s65
s_waitcnt lgkmcnt(0)
buffer_store_dwordx2 v[136:137], v204, s[8:11], s29 offen sc1
ds_read_b64 v[120:121], v204 offset:7056
s_add_u32 s28, s38, s66
s_waitcnt lgkmcnt(0)
buffer_store_dwordx2 v[120:121], v204, s[8:11], s28 offen sc1
ds_read_b64 v[128:129], v204 offset:7448
s_add_u32 s29, s38, s67
s_waitcnt lgkmcnt(0)
buffer_store_dwordx2 v[128:129], v204, s[8:11], s29 offen sc1
ds_read_b64 v[136:137], v204 offset:12544
s_add_u32 s28, s38, s68
s_waitcnt lgkmcnt(0)
buffer_store_dwordx2 v[136:137], v204, s[8:11], s28 offen sc1
ds_read_b64 v[120:121], v204 offset:12936
s_add_u32 s29, s38, s69
s_waitcnt lgkmcnt(0)
buffer_store_dwordx2 v[120:121], v204, s[8:11], s29 offen sc1
ds_read_b64 v[128:129], v204 offset:13328
s_add_u32 s28, s38, s70
s_waitcnt lgkmcnt(0)
buffer_store_dwordx2 v[128:129], v204, s[8:11], s28 offen sc1
ds_read_b64 v[136:137], v204 offset:13720
s_add_u32 s29, s38, s71
s_waitcnt lgkmcnt(0)
buffer_store_dwordx2 v[136:137], v204, s[8:11], s29 offen sc1
ds_read_b128 v[182:185], v210 offset:20480
ds_read_b128 v[186:189], v210 offset:21504
s_waitcnt lgkmcnt(1)
v_mfma_f32_16x16x32_bf16 v[138:141], a[0:3], v[182:185], 0
s_waitcnt lgkmcnt(0)
v_mfma_f32_16x16x32_bf16 v[138:141], a[4:7], v[186:189], v[138:141]
v_mfma_f32_16x16x32_bf16 v[142:145], a[24:27], v[182:185], 0
v_mfma_f32_16x16x32_bf16 v[142:145], a[28:31], v[186:189], v[142:145]
v_mfma_f32_16x16x32_bf16 v[146:149], a[48:51], v[182:185], 0
v_mfma_f32_16x16x32_bf16 v[146:149], a[52:55], v[186:189], v[146:149]
v_mfma_f32_16x16x32_bf16 v[150:153], a[216:219], v[182:185], 0
v_mfma_f32_16x16x32_bf16 v[150:153], a[220:223], v[186:189], v[150:153]
v_mfma_f32_16x16x32_bf16 v[154:157], a[240:243], v[182:185], 0
v_mfma_f32_16x16x32_bf16 v[154:157], a[244:247], v[186:189], v[154:157]
v_mfma_f32_16x16x32_bf16 v[158:161], v[232:235], v[182:185], 0
v_mfma_f32_16x16x32_bf16 v[158:161], v[236:239], v[186:189], v[158:161]
v_mfma_f32_16x16x32_bf16 v[162:165], v[182:185], a[72:75], 0
v_mfma_f32_16x16x32_bf16 v[162:165], v[186:189], a[76:79], v[162:165]
v_mfma_f32_16x16x32_bf16 v[166:169], v[182:185], a[96:99], 0
v_mfma_f32_16x16x32_bf16 v[166:169], v[186:189], a[100:103], v[166:169]
v_mfma_f32_16x16x32_bf16 v[170:173], v[182:185], a[120:123], 0
v_mfma_f32_16x16x32_bf16 v[170:173], v[186:189], a[124:127], v[170:173]
ds_read_b128 v[110:113], v210 offset:22528
ds_read_b128 v[220:223], v210 offset:23552
s_waitcnt lgkmcnt(1)
v_mfma_f32_16x16x32_bf16 v[138:141], a[8:11], v[110:113], v[138:141]
s_waitcnt lgkmcnt(0)
v_mfma_f32_16x16x32_bf16 v[138:141], a[12:15], v[220:223], v[138:141]
v_mfma_f32_16x16x32_bf16 v[142:145], a[32:35], v[110:113], v[142:145]
v_mfma_f32_16x16x32_bf16 v[142:145], a[36:39], v[220:223], v[142:145]
v_mfma_f32_16x16x32_bf16 v[146:149], a[56:59], v[110:113], v[146:149]
v_mfma_f32_16x16x32_bf16 v[146:149], a[60:63], v[220:223], v[146:149]
v_mfma_f32_16x16x32_bf16 v[150:153], a[224:227], v[110:113], v[150:153]
v_mfma_f32_16x16x32_bf16 v[150:153], a[228:231], v[220:223], v[150:153]
v_mfma_f32_16x16x32_bf16 v[154:157], a[248:251], v[110:113], v[154:157]
v_mfma_f32_16x16x32_bf16 v[154:157], a[252:255], v[220:223], v[154:157]
v_mfma_f32_16x16x32_bf16 v[158:161], v[240:243], v[110:113], v[158:161]
v_mfma_f32_16x16x32_bf16 v[158:161], v[244:247], v[220:223], v[158:161]
v_mfma_f32_16x16x32_bf16 v[162:165], v[110:113], a[80:83], v[162:165]
v_mfma_f32_16x16x32_bf16 v[162:165], v[220:223], a[84:87], v[162:165]
v_mfma_f32_16x16x32_bf16 v[166:169], v[110:113], a[104:107], v[166:169]
v_mfma_f32_16x16x32_bf16 v[166:169], v[220:223], a[108:111], v[166:169]
v_mfma_f32_16x16x32_bf16 v[170:173], v[110:113], a[128:131], v[170:173]
v_mfma_f32_16x16x32_bf16 v[170:173], v[220:223], a[132:135], v[170:173]
ds_read_b128 v[182:185], v210 offset:24576
ds_read_b128 v[186:189], v210 offset:25600
s_waitcnt lgkmcnt(1)
v_mfma_f32_16x16x32_bf16 v[138:141], a[16:19], v[182:185], v[138:141]
s_waitcnt lgkmcnt(0)
v_mfma_f32_16x16x32_bf16 v[138:141], a[20:23], v[186:189], v[138:141]
v_mfma_f32_16x16x32_bf16 v[142:145], a[40:43], v[182:185], v[142:145]
v_mfma_f32_16x16x32_bf16 v[142:145], a[44:47], v[186:189], v[142:145]
v_mfma_f32_16x16x32_bf16 v[146:149], a[64:67], v[182:185], v[146:149]
v_mfma_f32_16x16x32_bf16 v[146:149], a[68:71], v[186:189], v[146:149]
v_mfma_f32_16x16x32_bf16 v[150:153], a[232:235], v[182:185], v[150:153]
v_mfma_f32_16x16x32_bf16 v[150:153], a[236:239], v[186:189], v[150:153]
v_mfma_f32_16x16x32_bf16 v[154:157], v[224:227], v[182:185], v[154:157]
v_mfma_f32_16x16x32_bf16 v[154:157], v[228:231], v[186:189], v[154:157]
v_mfma_f32_16x16x32_bf16 v[158:161], v[248:251], v[182:185], v[158:161]
v_mfma_f32_16x16x32_bf16 v[158:161], v[252:255], v[186:189], v[158:161]
v_mfma_f32_16x16x32_bf16 v[162:165], v[182:185], a[88:91], v[162:165]
v_mfma_f32_16x16x32_bf16 v[162:165], v[186:189], a[92:95], v[162:165]
v_mfma_f32_16x16x32_bf16 v[166:169], v[182:185], a[112:115], v[166:169]
v_mfma_f32_16x16x32_bf16 v[166:169], v[186:189], a[116:119], v[166:169]
v_mfma_f32_16x16x32_bf16 v[170:173], v[182:185], a[136:139], v[170:173]
v_mfma_f32_16x16x32_bf16 v[170:173], v[186:189], a[140:143], v[170:173]
v_cvt_pk_bf16_f32 v78, v138, v139
v_cvt_pk_bf16_f32 v79, v140, v141
v_cvt_pk_bf16_f32 v80, v142, v143
v_cvt_pk_bf16_f32 v81, v144, v145
v_cvt_pk_bf16_f32 v82, v146, v147
v_cvt_pk_bf16_f32 v83, v148, v149
v_cvt_pk_bf16_f32 v72, v150, v151
v_cvt_pk_bf16_f32 v73, v152, v153
v_cvt_pk_bf16_f32 v74, v154, v155
v_cvt_pk_bf16_f32 v75, v156, v157
v_cvt_pk_bf16_f32 v76, v158, v159
v_cvt_pk_bf16_f32 v77, v160, v161
v_cvt_pk_bf16_f32 v114, v162, v163
v_cvt_pk_bf16_f32 v115, v164, v165
v_cvt_pk_bf16_f32 v122, v166, v167
v_cvt_pk_bf16_f32 v123, v168, v169
v_cvt_pk_bf16_f32 v130, v170, v171
v_cvt_pk_bf16_f32 v131, v172, v173
ds_read_b128 v[110:113], v210 offset:26624
ds_read_b128 v[220:223], v210 offset:27648
s_waitcnt lgkmcnt(1)
v_mfma_f32_16x16x32_bf16 v[138:141], a[0:3], v[110:113], 0
s_waitcnt lgkmcnt(0)
v_mfma_f32_16x16x32_bf16 v[138:141], a[4:7], v[220:223], v[138:141]
v_mfma_f32_16x16x32_bf16 v[142:145], a[24:27], v[110:113], 0
v_mfma_f32_16x16x32_bf16 v[142:145], a[28:31], v[220:223], v[142:145]
v_mfma_f32_16x16x32_bf16 v[146:149], a[48:51], v[110:113], 0
v_mfma_f32_16x16x32_bf16 v[146:149], a[52:55], v[220:223], v[146:149]
v_mfma_f32_16x16x32_bf16 v[150:153], a[216:219], v[110:113], 0
v_mfma_f32_16x16x32_bf16 v[150:153], a[220:223], v[220:223], v[150:153]
v_mfma_f32_16x16x32_bf16 v[154:157], a[240:243], v[110:113], 0
v_mfma_f32_16x16x32_bf16 v[154:157], a[244:247], v[220:223], v[154:157]
v_mfma_f32_16x16x32_bf16 v[158:161], v[232:235], v[110:113], 0
v_mfma_f32_16x16x32_bf16 v[158:161], v[236:239], v[220:223], v[158:161]
v_mfma_f32_16x16x32_bf16 v[162:165], v[110:113], a[72:75], 0
v_mfma_f32_16x16x32_bf16 v[162:165], v[220:223], a[76:79], v[162:165]
v_mfma_f32_16x16x32_bf16 v[166:169], v[110:113], a[96:99], 0
v_mfma_f32_16x16x32_bf16 v[166:169], v[220:223], a[100:103], v[166:169]
v_mfma_f32_16x16x32_bf16 v[170:173], v[110:113], a[120:123], 0
v_mfma_f32_16x16x32_bf16 v[170:173], v[220:223], a[124:127], v[170:173]
ds_read_b128 v[102:105], v210 offset:18432
ds_read_b128 v[106:109], v210 offset:19456
s_waitcnt lgkmcnt(1)
v_add_f32 v102, v102, v103
s_waitcnt lgkmcnt(0)
v_add_f32 v106, v106, v107
v_add_f32 v104, v104, v105
v_add_f32 v108, v108, v109
v_add_f32 v102, v102, v104
v_add_f32 v106, v106, v108
v_mul_f32 v103, s48, v102
v_mul_f32 v104, s73, v102
v_mul_f32 v106, s73, v106
v_fma_f32 v106, -v103, v104, v106
v_max_f32 v106, 0, v106
v_add_f32 v106, s49, v106
v_rsq_f32 v102, v106
s_nop 0
v_mul_f32_e64 v103, -v103, v102
ds_write_b64 v211, v[102:103]
ds_read_b64 v[118:119], v219
ds_read_b64 v[126:127], v219 offset:256
ds_read_b64 v[134:135], v219 offset:512
s_waitcnt lgkmcnt(2)
v_fma_f32 v220, v0, v118, v119
v_fma_f32 v221, v1, v118, v119
v_cvt_pk_bf16_f32 v90, v220, v221
v_fma_f32 v222, v2, v118, v119
v_fma_f32 v223, v3, v118, v119
v_cvt_pk_bf16_f32 v91, v222, v223
v_fma_f32 v220, v4, v118, v119
v_fma_f32 v221, v5, v118, v119
v_cvt_pk_bf16_f32 v92, v220, v221
v_fma_f32 v222, v6, v118, v119
v_fma_f32 v223, v7, v118, v119
v_cvt_pk_bf16_f32 v93, v222, v223
ds_write_b128 v211, v[90:93]
v_fma_f32 v220, v8, v118, v119
v_fma_f32 v221, v9, v118, v119
v_cvt_pk_bf16_f32 v94, v220, v221
v_fma_f32 v222, v10, v118, v119
v_fma_f32 v223, v11, v118, v119
v_cvt_pk_bf16_f32 v95, v222, v223
s_waitcnt lgkmcnt(2)
ds_write_b64 v212, v[94:95]
v_fma_f32 v220, v12, v126, v127
v_fma_f32 v221, v13, v126, v127
v_cvt_pk_bf16_f32 v174, v220, v221
v_fma_f32 v222, v14, v126, v127
v_fma_f32 v223, v15, v126, v127
v_cvt_pk_bf16_f32 v175, v222, v223
v_fma_f32 v220, v16, v126, v127
v_fma_f32 v221, v17, v126, v127
v_cvt_pk_bf16_f32 v176, v220, v221
v_fma_f32 v222, v18, v126, v127
v_fma_f32 v223, v19, v126, v127
v_cvt_pk_bf16_f32 v177, v222, v223
ds_write_b128 v211, v[174:177] offset:6144
v_fma_f32 v220, v20, v126, v127
v_fma_f32 v221, v21, v126, v127
v_cvt_pk_bf16_f32 v178, v220, v221
v_fma_f32 v222, v22, v126, v127
v_fma_f32 v223, v23, v126, v127
v_cvt_pk_bf16_f32 v179, v222, v223
s_waitcnt lgkmcnt(3)
ds_write_b64 v212, v[178:179] offset:6144
v_fma_f32 v220, v24, v134, v135
v_fma_f32 v221, v25, v134, v135
v_cvt_pk_bf16_f32 v90, v220, v221
v_fma_f32 v222, v26, v134, v135
v_fma_f32 v223, v27, v134, v135
v_cvt_pk_bf16_f32 v91, v222, v223
v_fma_f32 v220, v28, v134, v135
v_fma_f32 v221, v29, v134, v135
v_cvt_pk_bf16_f32 v92, v220, v221
v_fma_f32 v222, v30, v134, v135
v_fma_f32 v223, v31, v134, v135
v_cvt_pk_bf16_f32 v93, v222, v223
ds_write_b128 v211, v[90:93] offset:12288
v_fma_f32 v220, v32, v134, v135
v_fma_f32 v221, v33, v134, v135
v_cvt_pk_bf16_f32 v94, v220, v221
v_fma_f32 v222, v34, v134, v135
v_fma_f32 v223, v35, v134, v135
v_cvt_pk_bf16_f32 v95, v222, v223
ds_write_b64 v212, v[94:95] offset:12288
ds_read_b128 v[182:185], v210 offset:28672
ds_read_b128 v[186:189], v210 offset:29696
s_waitcnt lgkmcnt(1)
v_mfma_f32_16x16x32_bf16 v[138:141], a[8:11], v[182:185], v[138:141]
s_waitcnt lgkmcnt(0)
v_mfma_f32_16x16x32_bf16 v[138:141], a[12:15], v[186:189], v[138:141]
v_mfma_f32_16x16x32_bf16 v[142:145], a[32:35], v[182:185], v[142:145]
v_mfma_f32_16x16x32_bf16 v[142:145], a[36:39], v[186:189], v[142:145]
v_mfma_f32_16x16x32_bf16 v[146:149], a[56:59], v[182:185], v[146:149]
v_mfma_f32_16x16x32_bf16 v[146:149], a[60:63], v[186:189], v[146:149]
v_mfma_f32_16x16x32_bf16 v[150:153], a[224:227], v[182:185], v[150:153]
v_mfma_f32_16x16x32_bf16 v[150:153], a[228:231], v[186:189], v[150:153]
v_mfma_f32_16x16x32_bf16 v[154:157], a[248:251], v[182:185], v[154:157]
v_mfma_f32_16x16x32_bf16 v[154:157], a[252:255], v[186:189], v[154:157]
v_mfma_f32_16x16x32_bf16 v[158:161], v[240:243], v[182:185], v[158:161]
v_mfma_f32_16x16x32_bf16 v[158:161], v[244:247], v[186:189], v[158:161]
v_mfma_f32_16x16x32_bf16 v[162:165], v[182:185], a[80:83], v[162:165]
v_mfma_f32_16x16x32_bf16 v[162:165], v[186:189], a[84:87], v[162:165]
v_mfma_f32_16x16x32_bf16 v[166:169], v[182:185], a[104:107], v[166:169]
v_mfma_f32_16x16x32_bf16 v[166:169], v[186:189], a[108:111], v[166:169]
v_mfma_f32_16x16x32_bf16 v[170:173], v[182:185], a[128:131], v[170:173]
v_mfma_f32_16x16x32_bf16 v[170:173], v[186:189], a[132:135], v[170:173]
ds_read_b128 v[110:113], v210 offset:30720
ds_read_b128 v[106:109], v210 offset:31744
s_waitcnt lgkmcnt(1)
v_mfma_f32_16x16x32_bf16 v[138:141], a[16:19], v[110:113], v[138:141]
s_waitcnt lgkmcnt(0)
v_mfma_f32_16x16x32_bf16 v[138:141], a[20:23], v[106:109], v[138:141]
v_mfma_f32_16x16x32_bf16 v[142:145], a[40:43], v[110:113], v[142:145]
v_mfma_f32_16x16x32_bf16 v[142:145], a[44:47], v[106:109], v[142:145]
v_mfma_f32_16x16x32_bf16 v[146:149], a[64:67], v[110:113], v[146:149]
v_mfma_f32_16x16x32_bf16 v[146:149], a[68:71], v[106:109], v[146:149]
v_mfma_f32_16x16x32_bf16 v[150:153], a[232:235], v[110:113], v[150:153]
v_mfma_f32_16x16x32_bf16 v[150:153], a[236:239], v[106:109], v[150:153]
v_mfma_f32_16x16x32_bf16 v[154:157], v[224:227], v[110:113], v[154:157]
v_mfma_f32_16x16x32_bf16 v[154:157], v[228:231], v[106:109], v[154:157]
v_mfma_f32_16x16x32_bf16 v[158:161], v[248:251], v[110:113], v[158:161]
v_mfma_f32_16x16x32_bf16 v[158:161], v[252:255], v[106:109], v[158:161]
v_mfma_f32_16x16x32_bf16 v[162:165], v[110:113], a[88:91], v[162:165]
v_mfma_f32_16x16x32_bf16 v[162:165], v[106:109], a[92:95], v[162:165]
v_mfma_f32_16x16x32_bf16 v[166:169], v[110:113], a[112:115], v[166:169]
v_mfma_f32_16x16x32_bf16 v[166:169], v[106:109], a[116:119], v[166:169]
v_mfma_f32_16x16x32_bf16 v[170:173], v[110:113], a[136:139], v[170:173]
v_mfma_f32_16x16x32_bf16 v[170:173], v[106:109], a[140:143], v[170:173]
v_cvt_pk_bf16_f32 v96, v138, v139
v_cvt_pk_bf16_f32 v97, v140, v141
v_cvt_pk_bf16_f32 v98, v142, v143
v_cvt_pk_bf16_f32 v99, v144, v145
v_cvt_pk_bf16_f32 v100, v146, v147
v_cvt_pk_bf16_f32 v101, v148, v149
v_cvt_pk_bf16_f32 v84, v150, v151
v_cvt_pk_bf16_f32 v85, v152, v153
v_cvt_pk_bf16_f32 v86, v154, v155
v_cvt_pk_bf16_f32 v87, v156, v157
v_cvt_pk_bf16_f32 v88, v158, v159
v_cvt_pk_bf16_f32 v89, v160, v161
v_cvt_pk_bf16_f32 v116, v162, v163
v_cvt_pk_bf16_f32 v117, v164, v165
v_cvt_pk_bf16_f32 v124, v166, v167
v_cvt_pk_bf16_f32 v125, v168, v169
v_cvt_pk_bf16_f32 v132, v170, v171
v_cvt_pk_bf16_f32 v133, v172, v173
ds_read_b128 v[182:185], v210 offset:32768
ds_read_b128 v[186:189], v210 offset:33792
s_waitcnt lgkmcnt(1)
v_mfma_f32_16x16x32_bf16 v[138:141], a[0:3], v[182:185], 0
s_waitcnt lgkmcnt(0)
v_mfma_f32_16x16x32_bf16 v[138:141], a[4:7], v[186:189], v[138:141]
v_mfma_f32_16x16x32_bf16 v[142:145], a[24:27], v[182:185], 0
v_mfma_f32_16x16x32_bf16 v[142:145], a[28:31], v[186:189], v[142:145]
v_mfma_f32_16x16x32_bf16 v[146:149], a[48:51], v[182:185], 0
v_mfma_f32_16x16x32_bf16 v[146:149], a[52:55], v[186:189], v[146:149]
ds_read_b128 v[170:173], v210 offset:34816
ds_read_b128 v[182:185], v210 offset:35840
s_waitcnt lgkmcnt(1)
v_mfma_f32_16x16x32_bf16 v[138:141], a[8:11], v[170:173], v[138:141]
s_waitcnt lgkmcnt(0)
v_mfma_f32_16x16x32_bf16 v[138:141], a[12:15], v[182:185], v[138:141]
v_mfma_f32_16x16x32_bf16 v[142:145], a[32:35], v[170:173], v[142:145]
v_mfma_f32_16x16x32_bf16 v[142:145], a[36:39], v[182:185], v[142:145]
v_mfma_f32_16x16x32_bf16 v[146:149], a[56:59], v[170:173], v[146:149]
v_mfma_f32_16x16x32_bf16 v[146:149], a[60:63], v[182:185], v[146:149]
ds_read_b128 v[186:189], v210 offset:36864
ds_read_b128 v[170:173], v210 offset:37888
s_waitcnt lgkmcnt(1)
v_mfma_f32_16x16x32_bf16 v[138:141], a[16:19], v[186:189], v[138:141]
s_waitcnt lgkmcnt(0)
v_mfma_f32_16x16x32_bf16 v[138:141], a[20:23], v[170:173], v[138:141]
v_mfma_f32_16x16x32_bf16 v[142:145], a[40:43], v[186:189], v[142:145]
v_mfma_f32_16x16x32_bf16 v[142:145], a[44:47], v[170:173], v[142:145]
v_mfma_f32_16x16x32_bf16 v[146:149], a[64:67], v[186:189], v[146:149]
v_mfma_f32_16x16x32_bf16 v[146:149], a[68:71], v[170:173], v[146:149]
v_cvt_pk_bf16_f32 v102, v138, v139
v_cvt_pk_bf16_f32 v103, v140, v141
v_cvt_pk_bf16_f32 v104, v142, v143
v_cvt_pk_bf16_f32 v105, v144, v145
s_nop 2
v_cvt_pk_bf16_f32 v106, v146, v147
v_cvt_pk_bf16_f32 v107, v148, v149
ds_read_b128 v[108:111], v215 offset:512
ds_read_b64 v[112:113], v215 offset:528
v_mfma_f32_16x16x32_bf16 v[138:141], v[78:81], v[72:75], 0
v_mfma_f32_16x16x32_bf16 v[142:145], v[96:99], v[72:75], 0
s_waitcnt lgkmcnt(1)
v_mfma_f32_16x16x32_bf16 v[150:153], v[108:111], v[72:75], v[206:209]
v_mfma_f32_16x16x32_bf16 v[146:149], v[102:105], v[72:75], 0
v_mfma_f32_16x16x16_bf16 v[138:141], v[82:83], v[76:77], v[138:141]
v_mfma_f32_16x16x16_bf16 v[142:145], v[100:101], v[76:77], v[142:145]
s_waitcnt lgkmcnt(0)
v_mfma_f32_16x16x16_bf16 v[150:153], v[112:113], v[76:77], v[150:153]
v_mfma_f32_16x16x16_bf16 v[146:149], v[106:107], v[76:77], v[146:149]
ds_read_b128 v[72:75], v215
ds_read_b64 v[76:77], v215 offset:16
v_mfma_f32_16x16x16_bf16 v[154:157], v[82:83], v[88:89], 0
v_mfma_f32_16x16x16_bf16 v[158:161], v[100:101], v[88:89], 0
v_mfma_f32_16x16x16_bf16 v[166:169], v[112:113], v[88:89], v[206:209]
v_mfma_f32_16x16x16_bf16 v[162:165], v[106:107], v[88:89], 0
v_mfma_f32_16x16x32_bf16 v[154:157], v[78:81], v[84:87], v[154:157]
v_mfma_f32_16x16x32_bf16 v[158:161], v[96:99], v[84:87], v[158:161]
v_mfma_f32_16x16x32_bf16 v[166:169], v[108:111], v[84:87], v[166:169]
v_mfma_f32_16x16x32_bf16 v[162:165], v[102:105], v[84:87], v[162:165]
ds_read_b128 v[182:185], v210 offset:32768
ds_read_b128 v[186:189], v210 offset:33792
s_waitcnt lgkmcnt(1)
v_mfma_f32_16x16x32_bf16 v[118:121], v[182:185], a[72:75], 0
s_waitcnt lgkmcnt(0)
v_mfma_f32_16x16x32_bf16 v[118:121], v[186:189], a[76:79], v[118:121]
v_mfma_f32_16x16x32_bf16 v[126:129], v[182:185], a[96:99], 0
v_mfma_f32_16x16x32_bf16 v[126:129], v[186:189], a[100:103], v[126:129]
v_mfma_f32_16x16x32_bf16 v[134:137], v[182:185], a[120:123], 0
v_mfma_f32_16x16x32_bf16 v[134:137], v[186:189], a[124:127], v[134:137]
v_mfma_f32_16x16x32_bf16 v[90:93], a[216:219], v[182:185], 0
v_mfma_f32_16x16x32_bf16 v[90:93], a[220:223], v[186:189], v[90:93]
v_mfma_f32_16x16x32_bf16 v[170:173], a[240:243], v[182:185], 0
v_mfma_f32_16x16x32_bf16 v[170:173], a[244:247], v[186:189], v[170:173]
v_mfma_f32_16x16x32_bf16 v[220:223], v[232:235], v[182:185], 0
v_mfma_f32_16x16x32_bf16 v[220:223], v[236:239], v[186:189], v[220:223]
ds_read_b128 v[174:177], v210 offset:34816
ds_read_b128 v[178:181], v210 offset:35840
s_waitcnt lgkmcnt(1)
v_mfma_f32_16x16x32_bf16 v[118:121], v[174:177], a[80:83], v[118:121]
s_waitcnt lgkmcnt(0)
v_mfma_f32_16x16x32_bf16 v[118:121], v[178:181], a[84:87], v[118:121]
v_mfma_f32_16x16x32_bf16 v[126:129], v[174:177], a[104:107], v[126:129]
v_mfma_f32_16x16x32_bf16 v[126:129], v[178:181], a[108:111], v[126:129]
v_mfma_f32_16x16x32_bf16 v[134:137], v[174:177], a[128:131], v[134:137]
v_mfma_f32_16x16x32_bf16 v[134:137], v[178:181], a[132:135], v[134:137]
v_mfma_f32_16x16x32_bf16 v[90:93], a[224:227], v[174:177], v[90:93]
v_mfma_f32_16x16x32_bf16 v[90:93], a[228:231], v[178:181], v[90:93]
v_mfma_f32_16x16x32_bf16 v[170:173], a[248:251], v[174:177], v[170:173]
v_mfma_f32_16x16x32_bf16 v[170:173], a[252:255], v[178:181], v[170:173]
v_mfma_f32_16x16x32_bf16 v[220:223], v[240:243], v[174:177], v[220:223]
v_mfma_f32_16x16x32_bf16 v[220:223], v[244:247], v[178:181], v[220:223]
ds_read_b128 v[182:185], v210 offset:36864
ds_read_b128 v[186:189], v210 offset:37888
s_waitcnt lgkmcnt(1)
v_mfma_f32_16x16x32_bf16 v[118:121], v[182:185], a[88:91], v[118:121]
s_waitcnt lgkmcnt(0)
v_mfma_f32_16x16x32_bf16 v[118:121], v[186:189], a[92:95], v[118:121]
v_mfma_f32_16x16x32_bf16 v[126:129], v[182:185], a[112:115], v[126:129]
v_mfma_f32_16x16x32_bf16 v[126:129], v[186:189], a[116:119], v[126:129]
v_mfma_f32_16x16x32_bf16 v[134:137], v[182:185], a[136:139], v[134:137]
v_mfma_f32_16x16x32_bf16 v[134:137], v[186:189], a[140:143], v[134:137]
v_mfma_f32_16x16x32_bf16 v[90:93], a[232:235], v[182:185], v[90:93]
v_mfma_f32_16x16x32_bf16 v[90:93], a[236:239], v[186:189], v[90:93]
v_mfma_f32_16x16x32_bf16 v[170:173], v[224:227], v[182:185], v[170:173]
v_mfma_f32_16x16x32_bf16 v[170:173], v[228:231], v[186:189], v[170:173]
v_mfma_f32_16x16x32_bf16 v[220:223], v[248:251], v[182:185], v[220:223]
v_mfma_f32_16x16x32_bf16 v[220:223], v[252:255], v[186:189], v[220:223]
v_mov_b32 v181, 0
v_cvt_pk_bf16_f32 v118, v118, v119
v_cvt_pk_bf16_f32 v119, v120, v121
ds_read_u16 v120, v205
v_mov_b32 v121, 0
v_cvt_pk_bf16_f32 v126, v126, v127
v_cvt_pk_bf16_f32 v127, v128, v129
ds_read_u16 v128, v205 offset:32
v_mov_b32 v129, 0
v_cvt_pk_bf16_f32 v134, v134, v135
v_cvt_pk_bf16_f32 v135, v136, v137
ds_read_u16 v136, v205 offset:64
v_mov_b32 v137, 0
v_add_u32 v205, 1424, v205
v_cvt_pk_bf16_f32 v90, v90, v91
v_cvt_pk_bf16_f32 v91, v92, v93
v_cvt_pk_bf16_f32 v92, v170, v171
v_cvt_pk_bf16_f32 v93, v172, v173
v_cvt_pk_bf16_f32 v94, v220, v221
v_cvt_pk_bf16_f32 v95, v222, v223
v_max3_f32 v151, v138, v139, v140
v_max3_f32 v151, v151, v141, v142
v_max3_f32 v151, v151, v143, v144
v_max3_f32 v151, v151, v145, v146
v_max3_f32 v151, v151, v147, v148
v_max3_f32 v151, v151, v149, v150
v_mov_b32 v152, v151
s_nop 1
v_permlane16_swap_b32 v151, v152
v_max_f32 v151, v151, v152
v_mov_b32 v152, v151
s_nop 1
v_permlane32_swap_b32 v151, v152
v_max_f32 v151, v151, v152
v_sub_f32 v138, v138, v151
v_sub_f32 v139, v139, v151
v_sub_f32 v140, v140, v151
v_sub_f32 v141, v141, v151
v_sub_f32 v142, v142, v151
v_sub_f32 v143, v143, v151
v_sub_f32 v144, v144, v151
v_sub_f32 v145, v145, v151
v_sub_f32 v150, v150, v151
v_sub_f32 v146, v146, v151
v_sub_f32 v147, v147, v151
v_sub_f32 v148, v148, v151
v_sub_f32 v149, v149, v151
v_exp_f32 v138, v138
v_exp_f32 v139, v139
v_exp_f32 v140, v140
v_exp_f32 v141, v141
v_exp_f32 v142, v142
v_exp_f32 v143, v143
v_exp_f32 v144, v144
v_exp_f32 v145, v145
v_exp_f32 v150, v150
v_exp_f32 v146, v146
v_exp_f32 v147, v147
v_exp_f32 v148, v148
v_exp_f32 v149, v149
v_cvt_pk_bf16_f32 v174, v138, v139
v_cvt_pk_bf16_f32 v175, v140, v141
v_cvt_pk_bf16_f32 v176, v142, v143
v_cvt_pk_bf16_f32 v177, v144, v145
v_cvt_pk_bf16_f32 v178, v146, v147
v_cvt_pk_bf16_f32 v179, v148, v149
v_cvt_pk_bf16_f32 v180, v150, 0
v_mfma_f32_16x16x32_bf16 v[150:153], v[190:193], v[174:177], 0
v_mfma_f32_16x16x32_bf16 v[150:153], v[190:193], v[178:181], v[150:153]
v_mfma_f32_16x16x32_bf16 v[138:141], v[114:117], v[174:177], 0
s_waitcnt lgkmcnt(2)
v_mfma_f32_16x16x32_bf16 v[138:141], v[118:121], v[178:181], v[138:141]
v_mfma_f32_16x16x32_bf16 v[142:145], v[122:125], v[174:177], 0
s_waitcnt lgkmcnt(1)
v_mfma_f32_16x16x32_bf16 v[142:145], v[126:129], v[178:181], v[142:145]
v_mfma_f32_16x16x32_bf16 v[146:149], v[130:133], v[174:177], 0
s_waitcnt lgkmcnt(0)
v_mfma_f32_16x16x32_bf16 v[146:149], v[134:137], v[178:181], v[146:149]
v_max3_f32 v167, v154, v155, v156
v_max3_f32 v167, v167, v157, v158
v_max3_f32 v167, v167, v159, v160
v_max3_f32 v167, v167, v161, v162
v_max3_f32 v167, v167, v163, v164
v_max3_f32 v167, v167, v165, v166
v_mov_b32 v168, v167
s_nop 1
v_permlane16_swap_b32 v167, v168
v_max_f32 v167, v167, v168
v_mov_b32 v168, v167
s_nop 1
v_permlane32_swap_b32 v167, v168
v_max_f32 v167, v167, v168
v_sub_f32 v154, v154, v167
v_sub_f32 v155, v155, v167
v_sub_f32 v156, v156, v167
v_sub_f32 v157, v157, v167
v_sub_f32 v158, v158, v167
v_sub_f32 v159, v159, v167
v_sub_f32 v160, v160, v167
v_sub_f32 v161, v161, v167
v_sub_f32 v166, v166, v167
v_sub_f32 v162, v162, v167
v_sub_f32 v163, v163, v167
v_sub_f32 v164, v164, v167
v_sub_f32 v165, v165, v167
v_exp_f32 v154, v154
v_exp_f32 v155, v155
v_exp_f32 v156, v156
v_exp_f32 v157, v157
v_exp_f32 v158, v158
v_exp_f32 v159, v159
v_exp_f32 v160, v160
v_exp_f32 v161, v161
v_exp_f32 v166, v166
v_exp_f32 v162, v162
v_exp_f32 v163, v163
v_exp_f32 v164, v164
v_exp_f32 v165, v165
v_cvt_pk_bf16_f32 v174, v154, v155
v_cvt_pk_bf16_f32 v175, v156, v157
v_cvt_pk_bf16_f32 v176, v158, v159
v_cvt_pk_bf16_f32 v177, v160, v161
v_cvt_pk_bf16_f32 v178, v162, v163
v_cvt_pk_bf16_f32 v179, v164, v165
v_cvt_pk_bf16_f32 v180, v166, 0
v_mfma_f32_16x16x32_bf16 v[166:169], v[190:193], v[174:177], 0
v_mfma_f32_16x16x32_bf16 v[166:169], v[190:193], v[178:181], v[166:169]
v_mfma_f32_16x16x32_bf16 v[154:157], v[114:117], v[174:177], 0
v_mfma_f32_16x16x32_bf16 v[154:157], v[118:121], v[178:181], v[154:157]
v_mfma_f32_16x16x32_bf16 v[158:161], v[122:125], v[174:177], 0
v_mfma_f32_16x16x32_bf16 v[158:161], v[126:129], v[178:181], v[158:161]
v_mfma_f32_16x16x32_bf16 v[162:165], v[130:133], v[174:177], 0
v_mfma_f32_16x16x32_bf16 v[162:165], v[134:137], v[178:181], v[162:165]
v_rcp_f32 v151, v150
s_nop 0
v_mul_f32 v152, s3, v151
v_mul_f32 v138, v138, v152
v_mul_f32 v139, v139, v152
v_cvt_pk_bf16_f32 v138, v138, v139
v_mul_f32 v140, v140, v152
v_mul_f32 v141, v141, v152
v_cvt_pk_bf16_f32 v139, v140, v141
v_mul_f32 v142, v142, v152
v_mul_f32 v143, v143, v152
v_cvt_pk_bf16_f32 v140, v142, v143
v_mul_f32 v144, v144, v152
v_mul_f32 v145, v145, v152
v_cvt_pk_bf16_f32 v141, v144, v145
ds_write_b128 v211, v[138:141] offset:38912
v_mul_f32 v146, v146, v152
v_mul_f32 v147, v147, v152
v_cvt_pk_bf16_f32 v142, v146, v147
v_mul_f32 v148, v148, v152
v_mul_f32 v149, v149, v152
v_cvt_pk_bf16_f32 v143, v148, v149
ds_write_b64 v212, v[142:143] offset:38912
v_mfma_f32_16x16x32_bf16 v[138:141], v[78:81], v[90:93], 0
v_mfma_f32_16x16x32_bf16 v[142:145], v[96:99], v[90:93], 0
v_mfma_f32_16x16x32_bf16 v[150:153], v[108:111], v[90:93], v[206:209]
v_mfma_f32_16x16x32_bf16 v[146:149], v[102:105], v[90:93], 0
v_mfma_f32_16x16x16_bf16 v[138:141], v[82:83], v[94:95], v[138:141]
v_mfma_f32_16x16x16_bf16 v[142:145], v[100:101], v[94:95], v[142:145]
v_mfma_f32_16x16x16_bf16 v[150:153], v[112:113], v[94:95], v[150:153]
v_mfma_f32_16x16x16_bf16 v[146:149], v[106:107], v[94:95], v[146:149]
v_rcp_f32 v167, v166
s_nop 0
v_mul_f32 v168, s3, v167
v_mul_f32 v154, v154, v168
v_mul_f32 v155, v155, v168
v_cvt_pk_bf16_f32 v154, v154, v155
v_mul_f32 v156, v156, v168
v_mul_f32 v157, v157, v168
v_cvt_pk_bf16_f32 v155, v156, v157
v_mul_f32 v158, v158, v168
v_mul_f32 v159, v159, v168
v_cvt_pk_bf16_f32 v156, v158, v159
v_mul_f32 v160, v160, v168
v_mul_f32 v161, v161, v168
v_cvt_pk_bf16_f32 v157, v160, v161
ds_write_b128 v211, v[154:157] offset:45056
v_mul_f32 v162, v162, v168
v_mul_f32 v163, v163, v168
v_cvt_pk_bf16_f32 v158, v162, v163
v_mul_f32 v164, v164, v168
v_mul_f32 v165, v165, v168
v_cvt_pk_bf16_f32 v159, v164, v165
ds_write_b64 v212, v[158:159] offset:45056
v_mfma_f32_16x16x16_bf16 v[154:157], v[76:77], v[82:83], 0
v_mfma_f32_16x16x16_bf16 v[158:161], v[76:77], v[100:101], 0
v_mfma_f32_16x16x16_bf16 v[162:165], v[76:77], v[106:107], 0
v_mfma_f32_16x16x16_bf16 v[166:169], v[76:77], v[112:113], v[206:209]
v_mfma_f32_16x16x32_bf16 v[154:157], v[72:75], v[78:81], v[154:157]
v_mfma_f32_16x16x32_bf16 v[158:161], v[72:75], v[96:99], v[158:161]
v_mfma_f32_16x16x32_bf16 v[162:165], v[72:75], v[102:105], v[162:165]
v_mfma_f32_16x16x32_bf16 v[166:169], v[72:75], v[108:111], v[166:169]
v_mov_b32_dpp v154, v158 quad_perm:[0,1,2,3] row_mask:0x2 bank_mask:0xf
s_nop 1
v_mov_b32_dpp v154, v162 quad_perm:[0,1,2,3] row_mask:0x4 bank_mask:0xf
s_nop 2
v_mov_b32_dpp v154, v167 quad_perm:[0,1,2,3] row_mask:0x8 bank_mask:0xf
v_mov_b32 v155, v154
s_nop 1
v_max_f32_dpp v155, v155, v155 row_ror:8 row_mask:0xf bank_mask:0xf
s_nop 1
v_max_f32_dpp v155, v155, v155 row_ror:4 row_mask:0xf bank_mask:0xf
s_nop 1
v_max_f32_dpp v155, v155, v155 row_ror:2 row_mask:0xf bank_mask:0xf
s_nop 1
v_max_f32_dpp v155, v155, v155 row_ror:1 row_mask:0xf bank_mask:0xf
v_mov_b32 v156, v155
s_nop 1
v_permlane16_swap_b32 v155, v156
v_max_f32 v155, v155, v156
v_mov_b32 v156, v155
s_nop 1
v_permlane32_swap_b32 v155, v156
v_max_f32 v155, v155, v156
v_sub_f32 v154, v154, v155
v_exp_f32 v154, v154
s_nop 0
v_cvt_pk_bf16_f32 v154, v154, 0
ds_write_b16 v214, v154
ds_read_b128 v[84:87], v215
s_waitcnt lgkmcnt(2)
ds_read_b128 v[88:91], v215 offset:16
v_add_u32 v215, 1424, v215
s_barrier
ds_read_b128 v[220:223], v210 offset:38912
ds_read_b128 v[110:113], v210 offset:39936
s_waitcnt lgkmcnt(1)
v_mfma_f32_16x16x32_bf16 v[36:39], a[144:147], v[220:223], v[36:39]
s_waitcnt lgkmcnt(0)
v_mfma_f32_16x16x32_bf16 v[36:39], a[148:151], v[110:113], v[36:39]
v_mfma_f32_16x16x32_bf16 v[40:43], a[168:171], v[220:223], v[40:43]
v_mfma_f32_16x16x32_bf16 v[40:43], a[172:175], v[110:113], v[40:43]
v_mfma_f32_16x16x32_bf16 v[44:47], a[192:195], v[220:223], v[44:47]
v_mfma_f32_16x16x32_bf16 v[44:47], a[196:199], v[110:113], v[44:47]
ds_read_b128 v[170:173], v210 offset:40960
ds_read_b128 v[182:185], v210 offset:41984
s_waitcnt lgkmcnt(1)
v_mfma_f32_16x16x32_bf16 v[36:39], a[152:155], v[170:173], v[36:39]
s_waitcnt lgkmcnt(0)
v_mfma_f32_16x16x32_bf16 v[36:39], a[156:159], v[182:185], v[36:39]
v_mfma_f32_16x16x32_bf16 v[40:43], a[176:179], v[170:173], v[40:43]
v_mfma_f32_16x16x32_bf16 v[40:43], a[180:183], v[182:185], v[40:43]
v_mfma_f32_16x16x32_bf16 v[44:47], a[200:203], v[170:173], v[44:47]
v_mfma_f32_16x16x32_bf16 v[44:47], a[204:207], v[182:185], v[44:47]
ds_read_b128 v[186:189], v210 offset:43008
ds_read_b128 v[220:223], v210 offset:44032
s_waitcnt lgkmcnt(1)
v_mfma_f32_16x16x32_bf16 v[36:39], a[160:163], v[186:189], v[36:39]
s_waitcnt lgkmcnt(0)
v_mfma_f32_16x16x32_bf16 v[36:39], a[164:167], v[220:223], v[36:39]
v_mfma_f32_16x16x32_bf16 v[40:43], a[184:187], v[186:189], v[40:43]
v_mfma_f32_16x16x32_bf16 v[40:43], a[188:191], v[220:223], v[40:43]
v_mfma_f32_16x16x32_bf16 v[44:47], a[208:211], v[186:189], v[44:47]
v_mfma_f32_16x16x32_bf16 v[44:47], a[212:215], v[220:223], v[44:47]
v_cvt_pk_bf16_f32 v36, v36, v37
v_cvt_pk_bf16_f32 v37, v38, v39
ds_write_b64 v203, v[36:37]
v_cvt_pk_bf16_f32 v40, v40, v41
v_cvt_pk_bf16_f32 v41, v42, v43
ds_write_b64 v203, v[40:41] offset:32
v_cvt_pk_bf16_f32 v44, v44, v45
v_cvt_pk_bf16_f32 v45, v46, v47
ds_write_b64 v203, v[44:45] offset:64
v_max3_f32 v151, v138, v139, v140
v_max3_f32 v151, v151, v141, v142
v_max3_f32 v151, v151, v143, v144
v_max3_f32 v151, v151, v145, v146
v_max3_f32 v151, v151, v147, v148
v_max3_f32 v151, v151, v149, v150
v_mov_b32 v152, v151
s_nop 1
v_permlane16_swap_b32 v151, v152
v_max_f32 v151, v151, v152
v_mov_b32 v152, v151
s_nop 1
v_permlane32_swap_b32 v151, v152
v_max_f32 v151, v151, v152
v_sub_f32 v138, v138, v151
v_sub_f32 v139, v139, v151
v_sub_f32 v140, v140, v151
v_sub_f32 v141, v141, v151
v_sub_f32 v142, v142, v151
v_sub_f32 v143, v143, v151
v_sub_f32 v144, v144, v151
v_sub_f32 v145, v145, v151
v_sub_f32 v150, v150, v151
v_sub_f32 v146, v146, v151
v_sub_f32 v147, v147, v151
v_sub_f32 v148, v148, v151
v_sub_f32 v149, v149, v151
v_exp_f32 v138, v138
v_exp_f32 v139, v139
v_exp_f32 v140, v140
v_exp_f32 v141, v141
v_exp_f32 v142, v142
v_exp_f32 v143, v143
v_exp_f32 v144, v144
v_exp_f32 v145, v145
v_exp_f32 v150, v150
v_exp_f32 v146, v146
v_exp_f32 v147, v147
v_exp_f32 v148, v148
v_exp_f32 v149, v149
v_cvt_pk_bf16_f32 v174, v138, v139
v_cvt_pk_bf16_f32 v175, v140, v141
v_cvt_pk_bf16_f32 v176, v142, v143
v_cvt_pk_bf16_f32 v177, v144, v145
v_cvt_pk_bf16_f32 v178, v146, v147
v_cvt_pk_bf16_f32 v179, v148, v149
v_cvt_pk_bf16_f32 v180, v150, 0
v_mfma_f32_16x16x32_bf16 v[150:153], v[190:193], v[174:177], 0
v_mfma_f32_16x16x32_bf16 v[150:153], v[190:193], v[178:181], v[150:153]
v_mfma_f32_16x16x32_bf16 v[138:141], v[114:117], v[174:177], 0
v_mfma_f32_16x16x32_bf16 v[138:141], v[118:121], v[178:181], v[138:141]
v_mfma_f32_16x16x32_bf16 v[142:145], v[122:125], v[174:177], 0
v_mfma_f32_16x16x32_bf16 v[142:145], v[126:129], v[178:181], v[142:145]
v_mfma_f32_16x16x32_bf16 v[146:149], v[130:133], v[174:177], 0
v_mfma_f32_16x16x32_bf16 v[146:149], v[134:137], v[178:181], v[146:149]
v_rcp_f32 v151, v150
s_nop 0
v_mul_f32 v152, s3, v151
v_mul_f32 v138, v138, v152
v_mul_f32 v139, v139, v152
v_cvt_pk_bf16_f32 v138, v138, v139
v_mul_f32 v140, v140, v152
v_mul_f32 v141, v141, v152
v_cvt_pk_bf16_f32 v139, v140, v141
v_mul_f32 v142, v142, v152
v_mul_f32 v143, v143, v152
v_cvt_pk_bf16_f32 v140, v142, v143
v_mul_f32 v144, v144, v152
v_mul_f32 v145, v145, v152
v_cvt_pk_bf16_f32 v141, v144, v145
ds_write_b128 v211, v[138:141] offset:51200
v_mul_f32 v146, v146, v152
v_mul_f32 v147, v147, v152
v_cvt_pk_bf16_f32 v142, v146, v147
v_mul_f32 v148, v148, v152
v_mul_f32 v149, v149, v152
v_cvt_pk_bf16_f32 v143, v148, v149
ds_write_b64 v212, v[142:143] offset:51200
v_mfma_f32_16x16x32_bf16 v[166:169], v[84:87], v[190:193], 0
v_mfma_f32_16x16x32_bf16 v[166:169], v[88:91], v[190:193], v[166:169]
v_mfma_f32_16x16x32_bf16 v[154:157], v[84:87], v[114:117], 0
v_mfma_f32_16x16x32_bf16 v[154:157], v[88:91], v[118:121], v[154:157]
v_mfma_f32_16x16x32_bf16 v[158:161], v[84:87], v[122:125], 0
v_mfma_f32_16x16x32_bf16 v[158:161], v[88:91], v[126:129], v[158:161]
v_mfma_f32_16x16x32_bf16 v[162:165], v[84:87], v[130:133], 0
v_mfma_f32_16x16x32_bf16 v[162:165], v[88:91], v[134:137], v[162:165]
v_rcp_f32 v167, v166
v_mov_b32_dpp v154, v158 quad_perm:[0,1,2,3] row_mask:0x2 bank_mask:0xf
s_nop 3
v_mov_b32_dpp v154, v162 quad_perm:[0,1,2,3] row_mask:0x4 bank_mask:0xf
v_mul_f32 v168, s3, v167
v_mul_f32 v154, v154, v168
v_cvt_pk_bf16_f32 v154, v154, 0
ds_write_b16 v214, v154
v_add_u32 v214, 1424, v214
ds_read_b128 v[110:113], v210 offset:45056
ds_read_b128 v[170:173], v210 offset:46080
s_waitcnt lgkmcnt(1)
v_mfma_f32_16x16x32_bf16 v[48:51], a[144:147], v[110:113], v[48:51]
s_waitcnt lgkmcnt(0)
v_mfma_f32_16x16x32_bf16 v[48:51], a[148:151], v[170:173], v[48:51]
v_mfma_f32_16x16x32_bf16 v[52:55], a[168:171], v[110:113], v[52:55]
v_mfma_f32_16x16x32_bf16 v[52:55], a[172:175], v[170:173], v[52:55]
v_mfma_f32_16x16x32_bf16 v[56:59], a[192:195], v[110:113], v[56:59]
v_mfma_f32_16x16x32_bf16 v[56:59], a[196:199], v[170:173], v[56:59]
ds_read_b128 v[182:185], v210 offset:47104
ds_read_b128 v[186:189], v210 offset:48128
s_waitcnt lgkmcnt(1)
v_mfma_f32_16x16x32_bf16 v[48:51], a[152:155], v[182:185], v[48:51]
s_waitcnt lgkmcnt(0)
v_mfma_f32_16x16x32_bf16 v[48:51], a[156:159], v[186:189], v[48:51]
v_mfma_f32_16x16x32_bf16 v[52:55], a[176:179], v[182:185], v[52:55]
v_mfma_f32_16x16x32_bf16 v[52:55], a[180:183], v[186:189], v[52:55]
v_mfma_f32_16x16x32_bf16 v[56:59], a[200:203], v[182:185], v[56:59]
v_mfma_f32_16x16x32_bf16 v[56:59], a[204:207], v[186:189], v[56:59]
ds_read_b128 v[220:223], v210 offset:49152
ds_read_b128 v[110:113], v210 offset:50176
s_waitcnt lgkmcnt(1)
v_mfma_f32_16x16x32_bf16 v[48:51], a[160:163], v[220:223], v[48:51]
s_waitcnt lgkmcnt(0)
v_mfma_f32_16x16x32_bf16 v[48:51], a[164:167], v[110:113], v[48:51]
v_mfma_f32_16x16x32_bf16 v[52:55], a[184:187], v[220:223], v[52:55]
v_mfma_f32_16x16x32_bf16 v[52:55], a[188:191], v[110:113], v[52:55]
v_mfma_f32_16x16x32_bf16 v[56:59], a[208:211], v[220:223], v[56:59]
v_mfma_f32_16x16x32_bf16 v[56:59], a[212:215], v[110:113], v[56:59]
v_cvt_pk_bf16_f32 v48, v48, v49
v_cvt_pk_bf16_f32 v49, v50, v51
ds_write_b64 v203, v[48:49] offset:6272
v_cvt_pk_bf16_f32 v52, v52, v53
v_cvt_pk_bf16_f32 v53, v54, v55
ds_write_b64 v203, v[52:53] offset:6304
v_cvt_pk_bf16_f32 v56, v56, v57
v_cvt_pk_bf16_f32 v57, v58, v59
ds_write_b64 v203, v[56:57] offset:6336
s_barrier
ds_read_b64 v[120:121], v204
s_add_u32 s28, s39, s60
s_waitcnt lgkmcnt(0)
buffer_store_dwordx2 v[120:121], v204, s[8:11], s28 offen sc1
ds_read_b64 v[128:129], v204 offset:392
s_add_u32 s29, s39, s61
s_waitcnt lgkmcnt(0)
buffer_store_dwordx2 v[128:129], v204, s[8:11], s29 offen sc1
ds_read_b64 v[136:137], v204 offset:784
s_add_u32 s28, s39, s62
s_waitcnt lgkmcnt(0)
buffer_store_dwordx2 v[136:137], v204, s[8:11], s28 offen sc1
ds_read_b64 v[120:121], v204 offset:1176
s_add_u32 s29, s39, s63
s_waitcnt lgkmcnt(0)
buffer_store_dwordx2 v[120:121], v204, s[8:11], s29 offen sc1
ds_read_b128 v[170:173], v210 offset:51200
ds_read_b128 v[182:185], v210 offset:52224
s_waitcnt lgkmcnt(1)
v_mfma_f32_16x16x32_bf16 v[60:63], a[144:147], v[170:173], v[60:63]
s_waitcnt lgkmcnt(0)
v_mfma_f32_16x16x32_bf16 v[60:63], a[148:151], v[182:185], v[60:63]
v_mfma_f32_16x16x32_bf16 v[64:67], a[168:171], v[170:173], v[64:67]
v_mfma_f32_16x16x32_bf16 v[64:67], a[172:175], v[182:185], v[64:67]
v_mfma_f32_16x16x32_bf16 v[68:71], a[192:195], v[170:173], v[68:71]
v_mfma_f32_16x16x32_bf16 v[68:71], a[196:199], v[182:185], v[68:71]
ds_read_b128 v[186:189], v210 offset:53248
ds_read_b128 v[220:223], v210 offset:54272
s_waitcnt lgkmcnt(1)
v_mfma_f32_16x16x32_bf16 v[60:63], a[152:155], v[186:189], v[60:63]
s_waitcnt lgkmcnt(0)
v_mfma_f32_16x16x32_bf16 v[60:63], a[156:159], v[220:223], v[60:63]
v_mfma_f32_16x16x32_bf16 v[64:67], a[176:179], v[186:189], v[64:67]
v_mfma_f32_16x16x32_bf16 v[64:67], a[180:183], v[220:223], v[64:67]
v_mfma_f32_16x16x32_bf16 v[68:71], a[200:203], v[186:189], v[68:71]
v_mfma_f32_16x16x32_bf16 v[68:71], a[204:207], v[220:223], v[68:71]
ds_read_b128 v[110:113], v210 offset:55296
ds_read_b128 v[170:173], v210 offset:56320
s_waitcnt lgkmcnt(1)
v_mfma_f32_16x16x32_bf16 v[60:63], a[160:163], v[110:113], v[60:63]
s_waitcnt lgkmcnt(0)
v_mfma_f32_16x16x32_bf16 v[60:63], a[164:167], v[170:173], v[60:63]
v_mfma_f32_16x16x32_bf16 v[64:67], a[184:187], v[110:113], v[64:67]
v_mfma_f32_16x16x32_bf16 v[64:67], a[188:191], v[170:173], v[64:67]
v_mfma_f32_16x16x32_bf16 v[68:71], a[208:211], v[110:113], v[68:71]
v_mfma_f32_16x16x32_bf16 v[68:71], a[212:215], v[170:173], v[68:71]
v_cvt_pk_bf16_f32 v60, v60, v61
v_cvt_pk_bf16_f32 v61, v62, v63
ds_write_b64 v203, v[60:61] offset:12544
v_cvt_pk_bf16_f32 v64, v64, v65
v_cvt_pk_bf16_f32 v65, v66, v67
ds_write_b64 v203, v[64:65] offset:12576
v_cvt_pk_bf16_f32 v68, v68, v69
v_cvt_pk_bf16_f32 v69, v70, v71
ds_write_b64 v203, v[68:69] offset:12608
v_subrev_u32 v60, 37120, v210
v_lshrrev_b32 v61, 4, v60
v_and_b32 v61, 15, v61
v_lshrrev_b32 v62, 8, v60
v_mul_u32_u24 v63, 1424, v61
v_lshl_add_u32 v63, v62, 5, v63
v_add_u32 v63, 94464, v63
v_lshl_add_u32 v64, v62, 3, v205
buffer_load_dwordx4 v[36:39], v210, s[24:27], s58 offen
buffer_load_dwordx4 v[40:43], v210, s[24:27], s58 offen offset:1024
buffer_load_dwordx4 v[44:47], v210, s[24:27], s58 offen offset:2048
v_lshlrev_b32 v67, 5, v61
s_add_u32 s41, s33, 0
v_add_u32 v67, s41, v67
s_mov_b32 s42, 58835169
v_mul_hi_u32 v68, v67, s42
v_mul_u32_u24 v65, 73, v68
v_sub_u32 v65, v67, v65
v_mul_u32_u24 v65, 2688, v65
s_mov_b32 s42, 1373568
v_mul_lo_u32 v68, v68, s42
s_mul_i32 s42, s32, 96
v_add3_u32 v65, v65, v68, s42
v_cmp_gt_u32 vcc, s34, v67
v_mov_b32 v68, 1879048192
s_nop 0
v_cndmask_b32 v65, v68, v65, vcc
v_lshl_add_u32 v65, v62, 3, v65
v_add_u32 v65, 1047808, v65
v_lshlrev_b32 v67, 5, v61
s_add_u32 s41, s33, 512
v_add_u32 v67, s41, v67
v_mov_b32 v68, s97
v_cmp_gt_u32 vcc, 4, v61
s_nop 1
v_cndmask_b32 v67, v68, v67, vcc
v_mov_b32 v68, 6000
v_cmp_gt_u32 vcc, 5, v61
s_nop 1
v_cndmask_b32 v67, v68, v67, vcc
s_mov_b32 s42, 58835169
v_mul_hi_u32 v68, v67, s42
v_mul_u32_u24 v66, 73, v68
v_sub_u32 v66, v67, v66
v_mul_u32_u24 v66, 2688, v66
s_mov_b32 s42, 1373568
v_mul_lo_u32 v68, v68, s42
s_mul_i32 s42, s32, 96
v_add3_u32 v66, v66, v68, s42
v_cmp_gt_u32 vcc, s34, v67
v_mov_b32 v68, 1879048192
s_nop 0
v_cndmask_b32 v66, v68, v66, vcc
v_lshl_add_u32 v66, v62, 3, v66
v_add_u32 v66, 1047808, v66
v_mov_b32_dpp v69, v194 row_newbcast:0 row_mask:0xf bank_mask:0xf
v_add_u32 v69, 17248, v69
v_mov_b32_dpp v70, v197 row_newbcast:0 row_mask:0xf bank_mask:0xf
v_add_u32 v70, 17248, v70
v_mov_b32_dpp v71, v200 row_newbcast:0 row_mask:0xf bank_mask:0xf
v_add_u32 v71, 17248, v71
ds_read_b128 v[174:177], v217
ds_read_b128 v[84:87], v71
s_waitcnt lgkmcnt(0)
v_mfma_f32_16x16x32_bf16 v[48:51], v[174:177], v[84:87], 0
ds_read_b128 v[178:181], v217 offset:528
ds_read_b128 v[92:95], v69
ds_read_b128 v[96:99], v69 offset:16
s_waitcnt lgkmcnt(0)
s_nop 0
v_smfmac_f32_16x16x64_bf16 v[48:51], v[178:181], v[92:99], v213
ds_read_b128 v[174:177], v217 offset:1056
ds_read_b128 v[100:103], v70
ds_read_b128 v[104:107], v70 offset:16
s_waitcnt lgkmcnt(0)
v_smfmac_f32_16x16x64_bf16 v[48:51], v[174:177], v[100:107], v213
ds_read_b128 v[178:181], v217 offset:1584
ds_read_b128 v[84:87], v71 offset:32
s_waitcnt lgkmcnt(0)
v_mfma_f32_16x16x32_bf16 v[52:55], v[178:181], v[84:87], 0
ds_read_b128 v[174:177], v217 offset:2112
ds_read_b128 v[92:95], v69 offset:32
ds_read_b128 v[96:99], v69 offset:48
s_waitcnt lgkmcnt(0)
s_nop 0
v_smfmac_f32_16x16x64_bf16 v[52:55], v[174:177], v[92:99], v213
ds_read_b128 v[178:181], v217 offset:2640
ds_read_b128 v[100:103], v70 offset:32
ds_read_b128 v[104:107], v70 offset:48
s_waitcnt lgkmcnt(0)
v_smfmac_f32_16x16x64_bf16 v[52:55], v[178:181], v[100:107], v213
ds_read_b128 v[174:177], v217 offset:3168
ds_read_b128 v[84:87], v71 offset:64
s_waitcnt lgkmcnt(0)
v_mfma_f32_16x16x32_bf16 v[56:59], v[174:177], v[84:87], 0
ds_read_b128 v[178:181], v217 offset:3696
ds_read_b128 v[92:95], v69 offset:64
ds_read_b128 v[96:99], v69 offset:80
s_waitcnt lgkmcnt(0)
s_nop 0
v_smfmac_f32_16x16x64_bf16 v[56:59], v[178:181], v[92:99], v213
ds_read_b128 v[174:177], v217 offset:4224
ds_read_b128 v[100:103], v70 offset:64
ds_read_b128 v[104:107], v70 offset:80
s_waitcnt lgkmcnt(0)
v_smfmac_f32_16x16x64_bf16 v[56:59], v[174:177], v[100:107], v213
v_add_f32 v118, v48, v49
v_mul_f32 v119, v48, v48
v_add_f32 v118, v118, v50
v_fmac_f32 v119, v49, v49
v_add_f32 v118, v118, v51
v_fmac_f32 v119, v50, v50
v_fmac_f32 v119, v51, v51
v_add_f32 v118, v118, v52
v_fmac_f32 v119, v52, v52
v_add_f32 v118, v118, v53
v_fmac_f32 v119, v53, v53
v_add_f32 v118, v118, v54
v_fmac_f32 v119, v54, v54
v_add_f32 v118, v118, v55
v_fmac_f32 v119, v55, v55
v_add_f32 v118, v118, v56
v_fmac_f32 v119, v56, v56
v_add_f32 v118, v118, v57
v_fmac_f32 v119, v57, v57
v_add_f32 v118, v118, v58
v_fmac_f32 v119, v58, v58
v_add_f32 v118, v118, v59
v_fmac_f32 v119, v59, v59
s_nop 1
v_permlane16_swap_b32 v118, v119
v_add_f32 v118, v118, v119
v_mov_b32 v126, v118
s_nop 1
v_permlane32_swap_b32 v118, v126
v_add_f32 v118, v118, v126
ds_write_b32 v209, v118
s_mov_b32 s38, s36
s_waitcnt lgkmcnt(0)
s_barrier
ds_read_b64 v[128:129], v204 offset:6272
s_add_u32 s28, s39, s64
s_waitcnt lgkmcnt(0)
buffer_store_dwordx2 v[128:129], v204, s[8:11], s28 offen sc1
ds_read_b64 v[136:137], v204 offset:6664
s_add_u32 s29, s39, s65
s_waitcnt lgkmcnt(0)
buffer_store_dwordx2 v[136:137], v204, s[8:11], s29 offen sc1
ds_read_b64 v[120:121], v204 offset:7056
s_add_u32 s28, s39, s66
s_waitcnt lgkmcnt(0)
buffer_store_dwordx2 v[120:121], v204, s[8:11], s28 offen sc1
ds_read_b64 v[128:129], v204 offset:7448
s_add_u32 s29, s39, s67
s_waitcnt lgkmcnt(0)
buffer_store_dwordx2 v[128:129], v204, s[8:11], s29 offen sc1
ds_read_b64 v[136:137], v204 offset:12544
s_add_u32 s28, s39, s68
s_waitcnt lgkmcnt(0)
buffer_store_dwordx2 v[136:137], v204, s[8:11], s28 offen sc1
ds_read_b64 v[120:121], v204 offset:12936
s_add_u32 s29, s39, s69
s_waitcnt lgkmcnt(0)
buffer_store_dwordx2 v[120:121], v204, s[8:11], s29 offen sc1
ds_read_b64 v[128:129], v204 offset:13328
s_add_u32 s28, s39, s70
s_waitcnt lgkmcnt(0)
buffer_store_dwordx2 v[128:129], v204, s[8:11], s28 offen sc1
ds_read_b64 v[136:137], v204 offset:13720
s_add_u32 s29, s39, s71
s_waitcnt lgkmcnt(0)
buffer_store_dwordx2 v[136:137], v204, s[8:11], s29 offen sc1
ds_read_b128 v[84:87], v63
ds_read_b128 v[88:91], v63 offset:128
ds_read_b128 v[92:95], v63 offset:256
ds_read_b128 v[96:99], v63 offset:384
ds_read_b64 v[100:101], v63 offset:16
ds_read_b64 v[102:103], v63 offset:144
ds_read_b64 v[104:105], v63 offset:272
s_waitcnt vmcnt(10) lgkmcnt(6)
ds_read_b64 v[106:107], v63 offset:400
v_mfma_f32_16x16x32_bf16 v[36:39], a[144:147], v[84:87], v[36:39]
s_waitcnt lgkmcnt(6)
v_mfma_f32_16x16x32_bf16 v[36:39], a[148:151], v[88:91], v[36:39]
s_waitcnt lgkmcnt(5)
v_mfma_f32_16x16x32_bf16 v[36:39], a[152:155], v[92:95], v[36:39]
s_waitcnt lgkmcnt(4)
v_mfma_f32_16x16x32_bf16 v[36:39], a[156:159], v[96:99], v[36:39]
s_waitcnt lgkmcnt(2)
v_mfma_f32_16x16x32_bf16 v[36:39], a[160:163], v[100:103], v[36:39]
s_waitcnt lgkmcnt(0)
v_mfma_f32_16x16x32_bf16 v[36:39], a[164:167], v[104:107], v[36:39]
s_nop 7
v_cvt_pk_bf16_f32 v36, v36, v37
v_cvt_pk_bf16_f32 v37, v38, v39
buffer_store_dwordx2 v[36:37], v65, s[8:11], 0 offen
s_waitcnt vmcnt(10)
v_mfma_f32_16x16x32_bf16 v[40:43], a[168:171], v[84:87], v[40:43]
v_mfma_f32_16x16x32_bf16 v[40:43], a[172:175], v[88:91], v[40:43]
v_mfma_f32_16x16x32_bf16 v[40:43], a[176:179], v[92:95], v[40:43]
v_mfma_f32_16x16x32_bf16 v[40:43], a[180:183], v[96:99], v[40:43]
v_mfma_f32_16x16x32_bf16 v[40:43], a[184:187], v[100:103], v[40:43]
v_mfma_f32_16x16x32_bf16 v[40:43], a[188:191], v[104:107], v[40:43]
s_nop 7
v_cvt_pk_bf16_f32 v40, v40, v41
v_cvt_pk_bf16_f32 v41, v42, v43
buffer_store_dwordx2 v[40:41], v65, s[8:11], 0 offen offset:32
s_waitcnt vmcnt(10)
v_mfma_f32_16x16x32_bf16 v[44:47], a[192:195], v[84:87], v[44:47]
v_mfma_f32_16x16x32_bf16 v[44:47], a[196:199], v[88:91], v[44:47]
v_mfma_f32_16x16x32_bf16 v[44:47], a[200:203], v[92:95], v[44:47]
v_mfma_f32_16x16x32_bf16 v[44:47], a[204:207], v[96:99], v[44:47]
v_mfma_f32_16x16x32_bf16 v[44:47], a[208:211], v[100:103], v[44:47]
v_mfma_f32_16x16x32_bf16 v[44:47], a[212:215], v[104:107], v[44:47]
s_nop 7
v_cvt_pk_bf16_f32 v44, v44, v45
v_cvt_pk_bf16_f32 v45, v46, v47
buffer_store_dwordx2 v[44:45], v65, s[8:11], 0 offen offset:64
ds_read_b128 v[182:185], v210
ds_read_b128 v[186:189], v210 offset:1024
s_waitcnt lgkmcnt(1)
v_mfma_f32_16x16x32_bf16 v[138:141], a[0:3], v[182:185], 0
s_waitcnt lgkmcnt(0)
v_mfma_f32_16x16x32_bf16 v[138:141], a[4:7], v[186:189], v[138:141]
v_mfma_f32_16x16x32_bf16 v[142:145], a[24:27], v[182:185], 0
v_mfma_f32_16x16x32_bf16 v[142:145], a[28:31], v[186:189], v[142:145]
v_mfma_f32_16x16x32_bf16 v[146:149], a[48:51], v[182:185], 0
v_mfma_f32_16x16x32_bf16 v[146:149], a[52:55], v[186:189], v[146:149]
v_mfma_f32_16x16x32_bf16 v[150:153], a[216:219], v[182:185], 0
v_mfma_f32_16x16x32_bf16 v[150:153], a[220:223], v[186:189], v[150:153]
v_mfma_f32_16x16x32_bf16 v[154:157], a[240:243], v[182:185], 0
v_mfma_f32_16x16x32_bf16 v[154:157], a[244:247], v[186:189], v[154:157]
v_mfma_f32_16x16x32_bf16 v[158:161], v[232:235], v[182:185], 0
v_mfma_f32_16x16x32_bf16 v[158:161], v[236:239], v[186:189], v[158:161]
v_mfma_f32_16x16x32_bf16 v[162:165], v[182:185], a[72:75], 0
v_mfma_f32_16x16x32_bf16 v[162:165], v[186:189], a[76:79], v[162:165]
v_mfma_f32_16x16x32_bf16 v[166:169], v[182:185], a[96:99], 0
v_mfma_f32_16x16x32_bf16 v[166:169], v[186:189], a[100:103], v[166:169]
v_mfma_f32_16x16x32_bf16 v[170:173], v[182:185], a[120:123], 0
v_mfma_f32_16x16x32_bf16 v[170:173], v[186:189], a[124:127], v[170:173]
ds_read_b128 v[110:113], v210 offset:2048
ds_read_b128 v[220:223], v210 offset:3072
s_waitcnt lgkmcnt(1)
v_mfma_f32_16x16x32_bf16 v[138:141], a[8:11], v[110:113], v[138:141]
s_waitcnt lgkmcnt(0)
v_mfma_f32_16x16x32_bf16 v[138:141], a[12:15], v[220:223], v[138:141]
v_mfma_f32_16x16x32_bf16 v[142:145], a[32:35], v[110:113], v[142:145]
v_mfma_f32_16x16x32_bf16 v[142:145], a[36:39], v[220:223], v[142:145]
v_mfma_f32_16x16x32_bf16 v[146:149], a[56:59], v[110:113], v[146:149]
v_mfma_f32_16x16x32_bf16 v[146:149], a[60:63], v[220:223], v[146:149]
v_mfma_f32_16x16x32_bf16 v[150:153], a[224:227], v[110:113], v[150:153]
v_mfma_f32_16x16x32_bf16 v[150:153], a[228:231], v[220:223], v[150:153]
v_mfma_f32_16x16x32_bf16 v[154:157], a[248:251], v[110:113], v[154:157]
v_mfma_f32_16x16x32_bf16 v[154:157], a[252:255], v[220:223], v[154:157]
v_mfma_f32_16x16x32_bf16 v[158:161], v[240:243], v[110:113], v[158:161]
v_mfma_f32_16x16x32_bf16 v[158:161], v[244:247], v[220:223], v[158:161]
v_mfma_f32_16x16x32_bf16 v[162:165], v[110:113], a[80:83], v[162:165]
v_mfma_f32_16x16x32_bf16 v[162:165], v[220:223], a[84:87], v[162:165]
v_mfma_f32_16x16x32_bf16 v[166:169], v[110:113], a[104:107], v[166:169]
v_mfma_f32_16x16x32_bf16 v[166:169], v[220:223], a[108:111], v[166:169]
v_mfma_f32_16x16x32_bf16 v[170:173], v[110:113], a[128:131], v[170:173]
v_mfma_f32_16x16x32_bf16 v[170:173], v[220:223], a[132:135], v[170:173]
ds_read_b128 v[182:185], v210 offset:4096
ds_read_b128 v[186:189], v210 offset:5120
s_waitcnt lgkmcnt(1)
v_mfma_f32_16x16x32_bf16 v[138:141], a[16:19], v[182:185], v[138:141]
s_waitcnt lgkmcnt(0)
v_mfma_f32_16x16x32_bf16 v[138:141], a[20:23], v[186:189], v[138:141]
v_mfma_f32_16x16x32_bf16 v[142:145], a[40:43], v[182:185], v[142:145]
v_mfma_f32_16x16x32_bf16 v[142:145], a[44:47], v[186:189], v[142:145]
v_mfma_f32_16x16x32_bf16 v[146:149], a[64:67], v[182:185], v[146:149]
v_mfma_f32_16x16x32_bf16 v[146:149], a[68:71], v[186:189], v[146:149]
v_mfma_f32_16x16x32_bf16 v[150:153], a[232:235], v[182:185], v[150:153]
v_mfma_f32_16x16x32_bf16 v[150:153], a[236:239], v[186:189], v[150:153]
v_mfma_f32_16x16x32_bf16 v[154:157], v[224:227], v[182:185], v[154:157]
v_mfma_f32_16x16x32_bf16 v[154:157], v[228:231], v[186:189], v[154:157]
v_mfma_f32_16x16x32_bf16 v[158:161], v[248:251], v[182:185], v[158:161]
v_mfma_f32_16x16x32_bf16 v[158:161], v[252:255], v[186:189], v[158:161]
v_mfma_f32_16x16x32_bf16 v[162:165], v[182:185], a[88:91], v[162:165]
v_mfma_f32_16x16x32_bf16 v[162:165], v[186:189], a[92:95], v[162:165]
v_mfma_f32_16x16x32_bf16 v[166:169], v[182:185], a[112:115], v[166:169]
v_mfma_f32_16x16x32_bf16 v[166:169], v[186:189], a[116:119], v[166:169]
v_mfma_f32_16x16x32_bf16 v[170:173], v[182:185], a[136:139], v[170:173]
v_mfma_f32_16x16x32_bf16 v[170:173], v[186:189], a[140:143], v[170:173]
v_cvt_pk_bf16_f32 v78, v138, v139
v_cvt_pk_bf16_f32 v79, v140, v141
v_cvt_pk_bf16_f32 v80, v142, v143
v_cvt_pk_bf16_f32 v81, v144, v145
v_cvt_pk_bf16_f32 v82, v146, v147
v_cvt_pk_bf16_f32 v83, v148, v149
v_cvt_pk_bf16_f32 v72, v150, v151
v_cvt_pk_bf16_f32 v73, v152, v153
v_cvt_pk_bf16_f32 v74, v154, v155
v_cvt_pk_bf16_f32 v75, v156, v157
v_cvt_pk_bf16_f32 v76, v158, v159
v_cvt_pk_bf16_f32 v77, v160, v161
v_cvt_pk_bf16_f32 v114, v162, v163
v_cvt_pk_bf16_f32 v115, v164, v165
v_cvt_pk_bf16_f32 v122, v166, v167
v_cvt_pk_bf16_f32 v123, v168, v169
v_cvt_pk_bf16_f32 v130, v170, v171
v_cvt_pk_bf16_f32 v131, v172, v173
ds_read_b128 v[110:113], v210 offset:6144
ds_read_b128 v[220:223], v210 offset:7168
s_waitcnt lgkmcnt(1)
v_mfma_f32_16x16x32_bf16 v[138:141], a[0:3], v[110:113], 0
s_waitcnt lgkmcnt(0)
v_mfma_f32_16x16x32_bf16 v[138:141], a[4:7], v[220:223], v[138:141]
v_mfma_f32_16x16x32_bf16 v[142:145], a[24:27], v[110:113], 0
v_mfma_f32_16x16x32_bf16 v[142:145], a[28:31], v[220:223], v[142:145]
v_mfma_f32_16x16x32_bf16 v[146:149], a[48:51], v[110:113], 0
v_mfma_f32_16x16x32_bf16 v[146:149], a[52:55], v[220:223], v[146:149]
v_mfma_f32_16x16x32_bf16 v[150:153], a[216:219], v[110:113], 0
v_mfma_f32_16x16x32_bf16 v[150:153], a[220:223], v[220:223], v[150:153]
v_mfma_f32_16x16x32_bf16 v[154:157], a[240:243], v[110:113], 0
v_mfma_f32_16x16x32_bf16 v[154:157], a[244:247], v[220:223], v[154:157]
v_mfma_f32_16x16x32_bf16 v[158:161], v[232:235], v[110:113], 0
v_mfma_f32_16x16x32_bf16 v[158:161], v[236:239], v[220:223], v[158:161]
v_mfma_f32_16x16x32_bf16 v[162:165], v[110:113], a[72:75], 0
v_mfma_f32_16x16x32_bf16 v[162:165], v[220:223], a[76:79], v[162:165]
v_mfma_f32_16x16x32_bf16 v[166:169], v[110:113], a[96:99], 0
v_mfma_f32_16x16x32_bf16 v[166:169], v[220:223], a[100:103], v[166:169]
v_mfma_f32_16x16x32_bf16 v[170:173], v[110:113], a[120:123], 0
v_mfma_f32_16x16x32_bf16 v[170:173], v[220:223], a[124:127], v[170:173]
ds_read_b128 v[102:105], v210 offset:18432
ds_read_b128 v[106:109], v210 offset:19456
s_waitcnt lgkmcnt(1)
v_add_f32 v102, v102, v103
s_waitcnt lgkmcnt(0)
v_add_f32 v106, v106, v107
v_add_f32 v104, v104, v105
v_add_f32 v108, v108, v109
v_add_f32 v102, v102, v104
v_add_f32 v106, v106, v108
v_mul_f32 v103, s48, v102
v_mul_f32 v104, s73, v102
v_mul_f32 v106, s73, v106
v_fma_f32 v106, -v103, v104, v106
v_max_f32 v106, 0, v106
v_add_f32 v106, s49, v106
v_rsq_f32 v102, v106
s_nop 0
v_mul_f32_e64 v103, -v103, v102
ds_write_b64 v211, v[102:103] offset:20480
ds_read_b64 v[118:119], v219 offset:20480
s_waitcnt lgkmcnt(0)
v_fma_f32 v220, v48, v118, v119
v_fma_f32 v221, v49, v118, v119
v_cvt_pk_bf16_f32 v90, v220, v221
v_fma_f32 v222, v50, v118, v119
v_fma_f32 v223, v51, v118, v119
v_cvt_pk_bf16_f32 v91, v222, v223
v_fma_f32 v220, v52, v118, v119
v_fma_f32 v221, v53, v118, v119
v_cvt_pk_bf16_f32 v92, v220, v221
v_fma_f32 v222, v54, v118, v119
v_fma_f32 v223, v55, v118, v119
v_cvt_pk_bf16_f32 v93, v222, v223
ds_write_b128 v211, v[90:93] offset:20480
v_fma_f32 v220, v56, v118, v119
v_fma_f32 v221, v57, v118, v119
v_cvt_pk_bf16_f32 v94, v220, v221
v_fma_f32 v222, v58, v118, v119
v_fma_f32 v223, v59, v118, v119
v_cvt_pk_bf16_f32 v95, v222, v223
ds_write_b64 v212, v[94:95] offset:20480
s_mov_b64 exec, s[56:57]
buffer_load_dwordx4 v[48:51], v210, s[24:27], s59 offen
s_mov_b64 exec, -1
s_mov_b64 exec, s[56:57]
buffer_load_dwordx4 v[52:55], v210, s[24:27], s59 offen offset:1024
s_mov_b64 exec, -1
s_mov_b64 exec, s[56:57]
buffer_load_dwordx4 v[56:59], v210, s[24:27], s59 offen offset:2048
s_mov_b64 exec, -1
s_waitcnt lgkmcnt(0)
s_barrier
ds_read_b128 v[182:185], v210 offset:8192
ds_read_b128 v[186:189], v210 offset:9216
s_waitcnt lgkmcnt(1)
v_mfma_f32_16x16x32_bf16 v[138:141], a[8:11], v[182:185], v[138:141]
s_waitcnt lgkmcnt(0)
v_mfma_f32_16x16x32_bf16 v[138:141], a[12:15], v[186:189], v[138:141]
v_mfma_f32_16x16x32_bf16 v[142:145], a[32:35], v[182:185], v[142:145]
v_mfma_f32_16x16x32_bf16 v[142:145], a[36:39], v[186:189], v[142:145]
v_mfma_f32_16x16x32_bf16 v[146:149], a[56:59], v[182:185], v[146:149]
v_mfma_f32_16x16x32_bf16 v[146:149], a[60:63], v[186:189], v[146:149]
v_mfma_f32_16x16x32_bf16 v[150:153], a[224:227], v[182:185], v[150:153]
v_mfma_f32_16x16x32_bf16 v[150:153], a[228:231], v[186:189], v[150:153]
v_mfma_f32_16x16x32_bf16 v[154:157], a[248:251], v[182:185], v[154:157]
v_mfma_f32_16x16x32_bf16 v[154:157], a[252:255], v[186:189], v[154:157]
v_mfma_f32_16x16x32_bf16 v[158:161], v[240:243], v[182:185], v[158:161]
v_mfma_f32_16x16x32_bf16 v[158:161], v[244:247], v[186:189], v[158:161]
v_mfma_f32_16x16x32_bf16 v[162:165], v[182:185], a[80:83], v[162:165]
v_mfma_f32_16x16x32_bf16 v[162:165], v[186:189], a[84:87], v[162:165]
v_mfma_f32_16x16x32_bf16 v[166:169], v[182:185], a[104:107], v[166:169]
v_mfma_f32_16x16x32_bf16 v[166:169], v[186:189], a[108:111], v[166:169]
v_mfma_f32_16x16x32_bf16 v[170:173], v[182:185], a[128:131], v[170:173]
v_mfma_f32_16x16x32_bf16 v[170:173], v[186:189], a[132:135], v[170:173]
ds_read_b128 v[110:113], v210 offset:10240
ds_read_b128 v[106:109], v210 offset:11264
s_waitcnt lgkmcnt(1)
v_mfma_f32_16x16x32_bf16 v[138:141], a[16:19], v[110:113], v[138:141]
s_waitcnt lgkmcnt(0)
v_mfma_f32_16x16x32_bf16 v[138:141], a[20:23], v[106:109], v[138:141]
v_mfma_f32_16x16x32_bf16 v[142:145], a[40:43], v[110:113], v[142:145]
v_mfma_f32_16x16x32_bf16 v[142:145], a[44:47], v[106:109], v[142:145]
v_mfma_f32_16x16x32_bf16 v[146:149], a[64:67], v[110:113], v[146:149]
v_mfma_f32_16x16x32_bf16 v[146:149], a[68:71], v[106:109], v[146:149]
v_mfma_f32_16x16x32_bf16 v[150:153], a[232:235], v[110:113], v[150:153]
v_mfma_f32_16x16x32_bf16 v[150:153], a[236:239], v[106:109], v[150:153]
v_mfma_f32_16x16x32_bf16 v[154:157], v[224:227], v[110:113], v[154:157]
v_mfma_f32_16x16x32_bf16 v[154:157], v[228:231], v[106:109], v[154:157]
v_mfma_f32_16x16x32_bf16 v[158:161], v[248:251], v[110:113], v[158:161]
v_mfma_f32_16x16x32_bf16 v[158:161], v[252:255], v[106:109], v[158:161]
v_mfma_f32_16x16x32_bf16 v[162:165], v[110:113], a[88:91], v[162:165]
v_mfma_f32_16x16x32_bf16 v[162:165], v[106:109], a[92:95], v[162:165]
v_mfma_f32_16x16x32_bf16 v[166:169], v[110:113], a[112:115], v[166:169]
v_mfma_f32_16x16x32_bf16 v[166:169], v[106:109], a[116:119], v[166:169]
v_mfma_f32_16x16x32_bf16 v[170:173], v[110:113], a[136:139], v[170:173]
v_mfma_f32_16x16x32_bf16 v[170:173], v[106:109], a[140:143], v[170:173]
v_cvt_pk_bf16_f32 v96, v138, v139
v_cvt_pk_bf16_f32 v97, v140, v141
v_cvt_pk_bf16_f32 v98, v142, v143
v_cvt_pk_bf16_f32 v99, v144, v145
v_cvt_pk_bf16_f32 v100, v146, v147
v_cvt_pk_bf16_f32 v101, v148, v149
v_cvt_pk_bf16_f32 v84, v150, v151
v_cvt_pk_bf16_f32 v85, v152, v153
v_cvt_pk_bf16_f32 v86, v154, v155
v_cvt_pk_bf16_f32 v87, v156, v157
v_cvt_pk_bf16_f32 v88, v158, v159
v_cvt_pk_bf16_f32 v89, v160, v161
v_cvt_pk_bf16_f32 v116, v162, v163
v_cvt_pk_bf16_f32 v117, v164, v165
v_cvt_pk_bf16_f32 v124, v166, v167
v_cvt_pk_bf16_f32 v125, v168, v169
v_cvt_pk_bf16_f32 v132, v170, v171
v_cvt_pk_bf16_f32 v133, v172, v173
ds_read_b128 v[182:185], v210 offset:20480
s_waitcnt lgkmcnt(0)
v_mfma_f32_16x16x32_bf16 v[138:141], a[216:219], v[182:185], 0
v_mfma_f32_16x16x32_bf16 v[142:145], a[240:243], v[182:185], 0
v_mfma_f32_16x16x32_bf16 v[146:149], v[232:235], v[182:185], 0
v_mfma_f32_16x16x32_bf16 v[150:153], a[0:3], v[182:185], 0
v_mfma_f32_16x16x32_bf16 v[154:157], a[24:27], v[182:185], 0
v_mfma_f32_16x16x32_bf16 v[158:161], a[48:51], v[182:185], 0
v_mfma_f32_16x16x32_bf16 v[162:165], a[72:75], v[182:185], 0
v_mfma_f32_16x16x32_bf16 v[166:169], a[96:99], v[182:185], 0
v_mfma_f32_16x16x32_bf16 v[170:173], a[120:123], v[182:185], 0
ds_read_b128 v[186:189], v210 offset:21504
s_waitcnt lgkmcnt(0)
v_mfma_f32_16x16x32_bf16 v[138:141], a[220:223], v[186:189], v[138:141]
v_mfma_f32_16x16x32_bf16 v[142:145], a[244:247], v[186:189], v[142:145]
v_mfma_f32_16x16x32_bf16 v[146:149], v[236:239], v[186:189], v[146:149]
v_mfma_f32_16x16x32_bf16 v[150:153], a[4:7], v[186:189], v[150:153]
v_mfma_f32_16x16x32_bf16 v[154:157], a[28:31], v[186:189], v[154:157]
v_mfma_f32_16x16x32_bf16 v[158:161], a[52:55], v[186:189], v[158:161]
v_mfma_f32_16x16x32_bf16 v[162:165], a[76:79], v[186:189], v[162:165]
v_mfma_f32_16x16x32_bf16 v[166:169], a[100:103], v[186:189], v[166:169]
v_mfma_f32_16x16x32_bf16 v[170:173], a[124:127], v[186:189], v[170:173]
ds_read_b128 v[182:185], v210 offset:22528
s_waitcnt lgkmcnt(0)
v_mfma_f32_16x16x32_bf16 v[138:141], a[224:227], v[182:185], v[138:141]
v_mfma_f32_16x16x32_bf16 v[142:145], a[248:251], v[182:185], v[142:145]
v_mfma_f32_16x16x32_bf16 v[146:149], v[240:243], v[182:185], v[146:149]
v_mfma_f32_16x16x32_bf16 v[150:153], a[8:11], v[182:185], v[150:153]
v_mfma_f32_16x16x32_bf16 v[154:157], a[32:35], v[182:185], v[154:157]
v_mfma_f32_16x16x32_bf16 v[158:161], a[56:59], v[182:185], v[158:161]
v_mfma_f32_16x16x32_bf16 v[162:165], a[80:83], v[182:185], v[162:165]
v_mfma_f32_16x16x32_bf16 v[166:169], a[104:107], v[182:185], v[166:169]
v_mfma_f32_16x16x32_bf16 v[170:173], a[128:131], v[182:185], v[170:173]
ds_read_b128 v[186:189], v210 offset:23552
s_waitcnt lgkmcnt(0)
v_mfma_f32_16x16x32_bf16 v[138:141], a[228:231], v[186:189], v[138:141]
v_mfma_f32_16x16x32_bf16 v[142:145], a[252:255], v[186:189], v[142:145]
v_mfma_f32_16x16x32_bf16 v[146:149], v[244:247], v[186:189], v[146:149]
v_mfma_f32_16x16x32_bf16 v[150:153], a[12:15], v[186:189], v[150:153]
v_mfma_f32_16x16x32_bf16 v[154:157], a[36:39], v[186:189], v[154:157]
v_mfma_f32_16x16x32_bf16 v[158:161], a[60:63], v[186:189], v[158:161]
v_mfma_f32_16x16x32_bf16 v[162:165], a[84:87], v[186:189], v[162:165]
v_mfma_f32_16x16x32_bf16 v[166:169], a[108:111], v[186:189], v[166:169]
v_mfma_f32_16x16x32_bf16 v[170:173], a[132:135], v[186:189], v[170:173]
ds_read_b128 v[182:185], v210 offset:24576
s_waitcnt lgkmcnt(0)
v_mfma_f32_16x16x32_bf16 v[138:141], a[232:235], v[182:185], v[138:141]
v_mfma_f32_16x16x32_bf16 v[142:145], v[224:227], v[182:185], v[142:145]
v_mfma_f32_16x16x32_bf16 v[146:149], v[248:251], v[182:185], v[146:149]
v_mfma_f32_16x16x32_bf16 v[150:153], a[16:19], v[182:185], v[150:153]
v_mfma_f32_16x16x32_bf16 v[154:157], a[40:43], v[182:185], v[154:157]
v_mfma_f32_16x16x32_bf16 v[158:161], a[64:67], v[182:185], v[158:161]
v_mfma_f32_16x16x32_bf16 v[162:165], a[88:91], v[182:185], v[162:165]
v_mfma_f32_16x16x32_bf16 v[166:169], a[112:115], v[182:185], v[166:169]
v_mfma_f32_16x16x32_bf16 v[170:173], a[136:139], v[182:185], v[170:173]
ds_read_b128 v[186:189], v210 offset:25600
s_waitcnt lgkmcnt(0)
v_mfma_f32_16x16x32_bf16 v[138:141], a[236:239], v[186:189], v[138:141]
v_mfma_f32_16x16x32_bf16 v[142:145], v[228:231], v[186:189], v[142:145]
v_mfma_f32_16x16x32_bf16 v[146:149], v[252:255], v[186:189], v[146:149]
v_mfma_f32_16x16x32_bf16 v[150:153], a[20:23], v[186:189], v[150:153]
v_mfma_f32_16x16x32_bf16 v[154:157], a[44:47], v[186:189], v[154:157]
v_mfma_f32_16x16x32_bf16 v[158:161], a[68:71], v[186:189], v[158:161]
v_mfma_f32_16x16x32_bf16 v[162:165], a[92:95], v[186:189], v[162:165]
v_mfma_f32_16x16x32_bf16 v[166:169], a[116:119], v[186:189], v[166:169]
v_mfma_f32_16x16x32_bf16 v[170:173], a[140:143], v[186:189], v[170:173]
s_mov_b32 s30, 65537
s_mov_b32 s31, 65537
v_cvt_pk_bf16_f32 v90, v138, v139
v_cvt_pk_bf16_f32 v91, v140, v141
v_cvt_pk_bf16_f32 v92, v142, v143
v_cvt_pk_bf16_f32 v93, v144, v145
v_cvt_pk_bf16_f32 v94, v146, v147
v_cvt_pk_bf16_f32 v95, v148, v149
s_mov_b64 exec, s[30:31]
ds_write_b128 v215, v[90:93]
s_mov_b64 exec, -1
s_mov_b64 exec, s[30:31]
ds_write_b64 v215, v[94:95] offset:16
s_mov_b64 exec, -1
v_cvt_pk_bf16_f32 v102, v150, v151
v_cvt_pk_bf16_f32 v103, v152, v153
v_cvt_pk_bf16_f32 v104, v154, v155
v_cvt_pk_bf16_f32 v105, v156, v157
v_cvt_pk_bf16_f32 v106, v158, v159
v_cvt_pk_bf16_f32 v107, v160, v161
s_mov_b64 exec, s[30:31]
ds_write_b128 v215, v[102:105] offset:512
s_mov_b64 exec, -1
s_mov_b64 exec, s[30:31]
ds_write_b64 v215, v[106:107] offset:528
s_mov_b64 exec, -1
v_cvt_pk_bf16_f32 v108, v162, v163
v_cvt_pk_bf16_f32 v109, v164, v165
v_cvt_pk_bf16_f32 v110, v166, v167
v_cvt_pk_bf16_f32 v111, v168, v169
v_cvt_pk_bf16_f32 v112, v170, v171
v_cvt_pk_bf16_f32 v113, v172, v173
s_mov_b64 exec, s[30:31]
ds_write_b64 v64, v[108:109]
s_mov_b64 exec, -1
s_mov_b64 exec, s[30:31]
ds_write_b64 v64, v[110:111] offset:32
s_mov_b64 exec, -1
s_mov_b64 exec, s[30:31]
ds_write_b64 v64, v[112:113] offset:64
s_mov_b64 exec, -1
ds_read_b128 v[182:185], v210 offset:12288
ds_read_b128 v[186:189], v210 offset:13312
s_waitcnt lgkmcnt(1)
v_mfma_f32_16x16x32_bf16 v[138:141], a[0:3], v[182:185], 0
s_waitcnt lgkmcnt(0)
v_mfma_f32_16x16x32_bf16 v[138:141], a[4:7], v[186:189], v[138:141]
v_mfma_f32_16x16x32_bf16 v[142:145], a[24:27], v[182:185], 0
v_mfma_f32_16x16x32_bf16 v[142:145], a[28:31], v[186:189], v[142:145]
v_mfma_f32_16x16x32_bf16 v[146:149], a[48:51], v[182:185], 0
v_mfma_f32_16x16x32_bf16 v[146:149], a[52:55], v[186:189], v[146:149]
ds_read_b128 v[170:173], v210 offset:14336
ds_read_b128 v[182:185], v210 offset:15360
s_waitcnt lgkmcnt(1)
v_mfma_f32_16x16x32_bf16 v[138:141], a[8:11], v[170:173], v[138:141]
s_waitcnt lgkmcnt(0)
v_mfma_f32_16x16x32_bf16 v[138:141], a[12:15], v[182:185], v[138:141]
v_mfma_f32_16x16x32_bf16 v[142:145], a[32:35], v[170:173], v[142:145]
v_mfma_f32_16x16x32_bf16 v[142:145], a[36:39], v[182:185], v[142:145]
v_mfma_f32_16x16x32_bf16 v[146:149], a[56:59], v[170:173], v[146:149]
v_mfma_f32_16x16x32_bf16 v[146:149], a[60:63], v[182:185], v[146:149]
ds_read_b128 v[186:189], v210 offset:16384
ds_read_b128 v[170:173], v210 offset:17408
s_waitcnt lgkmcnt(1)
v_mfma_f32_16x16x32_bf16 v[138:141], a[16:19], v[186:189], v[138:141]
s_waitcnt lgkmcnt(0)
v_mfma_f32_16x16x32_bf16 v[138:141], a[20:23], v[170:173], v[138:141]
v_mfma_f32_16x16x32_bf16 v[142:145], a[40:43], v[186:189], v[142:145]
v_mfma_f32_16x16x32_bf16 v[142:145], a[44:47], v[170:173], v[142:145]
v_mfma_f32_16x16x32_bf16 v[146:149], a[64:67], v[186:189], v[146:149]
v_mfma_f32_16x16x32_bf16 v[146:149], a[68:71], v[170:173], v[146:149]
v_cvt_pk_bf16_f32 v102, v138, v139
v_cvt_pk_bf16_f32 v103, v140, v141
v_cvt_pk_bf16_f32 v104, v142, v143
v_cvt_pk_bf16_f32 v105, v144, v145
s_nop 2
v_cvt_pk_bf16_f32 v106, v146, v147
v_cvt_pk_bf16_f32 v107, v148, v149
ds_read_b128 v[108:111], v215 offset:512
ds_read_b64 v[112:113], v215 offset:528
v_mfma_f32_16x16x32_bf16 v[138:141], v[78:81], v[72:75], 0
v_mfma_f32_16x16x32_bf16 v[142:145], v[96:99], v[72:75], 0
s_waitcnt lgkmcnt(1)
v_mfma_f32_16x16x32_bf16 v[150:153], v[108:111], v[72:75], v[206:209]
v_mfma_f32_16x16x32_bf16 v[146:149], v[102:105], v[72:75], 0
v_mfma_f32_16x16x16_bf16 v[138:141], v[82:83], v[76:77], v[138:141]
v_mfma_f32_16x16x16_bf16 v[142:145], v[100:101], v[76:77], v[142:145]
s_waitcnt lgkmcnt(0)
v_mfma_f32_16x16x16_bf16 v[150:153], v[112:113], v[76:77], v[150:153]
v_mfma_f32_16x16x16_bf16 v[146:149], v[106:107], v[76:77], v[146:149]
ds_read_b128 v[72:75], v215
ds_read_b64 v[76:77], v215 offset:16
v_mfma_f32_16x16x16_bf16 v[154:157], v[82:83], v[88:89], 0
v_mfma_f32_16x16x16_bf16 v[158:161], v[100:101], v[88:89], 0
v_mfma_f32_16x16x16_bf16 v[166:169], v[112:113], v[88:89], v[206:209]
v_mfma_f32_16x16x16_bf16 v[162:165], v[106:107], v[88:89], 0
v_mfma_f32_16x16x32_bf16 v[154:157], v[78:81], v[84:87], v[154:157]
v_mfma_f32_16x16x32_bf16 v[158:161], v[96:99], v[84:87], v[158:161]
v_mfma_f32_16x16x32_bf16 v[166:169], v[108:111], v[84:87], v[166:169]
v_mfma_f32_16x16x32_bf16 v[162:165], v[102:105], v[84:87], v[162:165]
ds_read_b128 v[182:185], v210 offset:12288
ds_read_b128 v[186:189], v210 offset:13312
s_waitcnt lgkmcnt(1)
v_mfma_f32_16x16x32_bf16 v[118:121], v[182:185], a[72:75], 0
s_waitcnt lgkmcnt(0)
v_mfma_f32_16x16x32_bf16 v[118:121], v[186:189], a[76:79], v[118:121]
v_mfma_f32_16x16x32_bf16 v[126:129], v[182:185], a[96:99], 0
v_mfma_f32_16x16x32_bf16 v[126:129], v[186:189], a[100:103], v[126:129]
v_mfma_f32_16x16x32_bf16 v[134:137], v[182:185], a[120:123], 0
v_mfma_f32_16x16x32_bf16 v[134:137], v[186:189], a[124:127], v[134:137]
v_mfma_f32_16x16x32_bf16 v[90:93], a[216:219], v[182:185], 0
v_mfma_f32_16x16x32_bf16 v[90:93], a[220:223], v[186:189], v[90:93]
v_mfma_f32_16x16x32_bf16 v[170:173], a[240:243], v[182:185], 0
v_mfma_f32_16x16x32_bf16 v[170:173], a[244:247], v[186:189], v[170:173]
v_mfma_f32_16x16x32_bf16 v[220:223], v[232:235], v[182:185], 0
v_mfma_f32_16x16x32_bf16 v[220:223], v[236:239], v[186:189], v[220:223]
ds_read_b128 v[174:177], v210 offset:14336
ds_read_b128 v[178:181], v210 offset:15360
s_waitcnt lgkmcnt(1)
v_mfma_f32_16x16x32_bf16 v[118:121], v[174:177], a[80:83], v[118:121]
s_waitcnt lgkmcnt(0)
v_mfma_f32_16x16x32_bf16 v[118:121], v[178:181], a[84:87], v[118:121]
v_mfma_f32_16x16x32_bf16 v[126:129], v[174:177], a[104:107], v[126:129]
v_mfma_f32_16x16x32_bf16 v[126:129], v[178:181], a[108:111], v[126:129]
v_mfma_f32_16x16x32_bf16 v[134:137], v[174:177], a[128:131], v[134:137]
v_mfma_f32_16x16x32_bf16 v[134:137], v[178:181], a[132:135], v[134:137]
v_mfma_f32_16x16x32_bf16 v[90:93], a[224:227], v[174:177], v[90:93]
v_mfma_f32_16x16x32_bf16 v[90:93], a[228:231], v[178:181], v[90:93]
v_mfma_f32_16x16x32_bf16 v[170:173], a[248:251], v[174:177], v[170:173]
v_mfma_f32_16x16x32_bf16 v[170:173], a[252:255], v[178:181], v[170:173]
v_mfma_f32_16x16x32_bf16 v[220:223], v[240:243], v[174:177], v[220:223]
v_mfma_f32_16x16x32_bf16 v[220:223], v[244:247], v[178:181], v[220:223]
ds_read_b128 v[182:185], v210 offset:16384
ds_read_b128 v[186:189], v210 offset:17408
s_waitcnt lgkmcnt(1)
v_mfma_f32_16x16x32_bf16 v[118:121], v[182:185], a[88:91], v[118:121]
s_waitcnt lgkmcnt(0)
v_mfma_f32_16x16x32_bf16 v[118:121], v[186:189], a[92:95], v[118:121]
v_mfma_f32_16x16x32_bf16 v[126:129], v[182:185], a[112:115], v[126:129]
v_mfma_f32_16x16x32_bf16 v[126:129], v[186:189], a[116:119], v[126:129]
v_mfma_f32_16x16x32_bf16 v[134:137], v[182:185], a[136:139], v[134:137]
v_mfma_f32_16x16x32_bf16 v[134:137], v[186:189], a[140:143], v[134:137]
v_mfma_f32_16x16x32_bf16 v[90:93], a[232:235], v[182:185], v[90:93]
v_mfma_f32_16x16x32_bf16 v[90:93], a[236:239], v[186:189], v[90:93]
v_mfma_f32_16x16x32_bf16 v[170:173], v[224:227], v[182:185], v[170:173]
v_mfma_f32_16x16x32_bf16 v[170:173], v[228:231], v[186:189], v[170:173]
v_mfma_f32_16x16x32_bf16 v[220:223], v[248:251], v[182:185], v[220:223]
v_mfma_f32_16x16x32_bf16 v[220:223], v[252:255], v[186:189], v[220:223]
v_mov_b32 v181, 0
v_cvt_pk_bf16_f32 v118, v118, v119
v_cvt_pk_bf16_f32 v119, v120, v121
ds_read_u16 v120, v205
v_mov_b32 v121, 0
v_cvt_pk_bf16_f32 v126, v126, v127
v_cvt_pk_bf16_f32 v127, v128, v129
ds_read_u16 v128, v205 offset:32
v_mov_b32 v129, 0
v_cvt_pk_bf16_f32 v134, v134, v135
v_cvt_pk_bf16_f32 v135, v136, v137
ds_read_u16 v136, v205 offset:64
v_mov_b32 v137, 0
v_add_u32 v205, 1424, v205
v_cvt_pk_bf16_f32 v90, v90, v91
v_cvt_pk_bf16_f32 v91, v92, v93
v_cvt_pk_bf16_f32 v92, v170, v171
v_cvt_pk_bf16_f32 v93, v172, v173
v_cvt_pk_bf16_f32 v94, v220, v221
v_cvt_pk_bf16_f32 v95, v222, v223
v_max3_f32 v151, v138, v139, v140
v_max3_f32 v151, v151, v141, v142
v_max3_f32 v151, v151, v143, v144
v_max3_f32 v151, v151, v145, v146
v_max3_f32 v151, v151, v147, v148
v_max3_f32 v151, v151, v149, v150
v_mov_b32 v152, v151
s_nop 1
v_permlane16_swap_b32 v151, v152
v_max_f32 v151, v151, v152
v_mov_b32 v152, v151
s_nop 1
v_permlane32_swap_b32 v151, v152
v_max_f32 v151, v151, v152
v_sub_f32 v138, v138, v151
v_sub_f32 v139, v139, v151
v_sub_f32 v140, v140, v151
v_sub_f32 v141, v141, v151
v_sub_f32 v142, v142, v151
v_sub_f32 v143, v143, v151
v_sub_f32 v144, v144, v151
v_sub_f32 v145, v145, v151
v_sub_f32 v150, v150, v151
v_sub_f32 v146, v146, v151
v_sub_f32 v147, v147, v151
v_sub_f32 v148, v148, v151
v_sub_f32 v149, v149, v151
v_exp_f32 v138, v138
v_exp_f32 v139, v139
v_exp_f32 v140, v140
v_exp_f32 v141, v141
v_exp_f32 v142, v142
v_exp_f32 v143, v143
v_exp_f32 v144, v144
v_exp_f32 v145, v145
v_exp_f32 v150, v150
v_exp_f32 v146, v146
v_exp_f32 v147, v147
v_exp_f32 v148, v148
v_exp_f32 v149, v149
v_cvt_pk_bf16_f32 v174, v138, v139
v_cvt_pk_bf16_f32 v175, v140, v141
v_cvt_pk_bf16_f32 v176, v142, v143
v_cvt_pk_bf16_f32 v177, v144, v145
v_cvt_pk_bf16_f32 v178, v146, v147
v_cvt_pk_bf16_f32 v179, v148, v149
v_cvt_pk_bf16_f32 v180, v150, 0
v_mfma_f32_16x16x32_bf16 v[150:153], v[190:193], v[174:177], 0
v_mfma_f32_16x16x32_bf16 v[150:153], v[190:193], v[178:181], v[150:153]
v_mfma_f32_16x16x32_bf16 v[138:141], v[114:117], v[174:177], 0
s_waitcnt lgkmcnt(2)
v_mfma_f32_16x16x32_bf16 v[138:141], v[118:121], v[178:181], v[138:141]
v_mfma_f32_16x16x32_bf16 v[142:145], v[122:125], v[174:177], 0
s_waitcnt lgkmcnt(1)
v_mfma_f32_16x16x32_bf16 v[142:145], v[126:129], v[178:181], v[142:145]
v_mfma_f32_16x16x32_bf16 v[146:149], v[130:133], v[174:177], 0
s_waitcnt lgkmcnt(0)
v_mfma_f32_16x16x32_bf16 v[146:149], v[134:137], v[178:181], v[146:149]
v_max3_f32 v167, v154, v155, v156
v_max3_f32 v167, v167, v157, v158
v_max3_f32 v167, v167, v159, v160
v_max3_f32 v167, v167, v161, v162
v_max3_f32 v167, v167, v163, v164
v_max3_f32 v167, v167, v165, v166
v_mov_b32 v168, v167
s_nop 1
v_permlane16_swap_b32 v167, v168
v_max_f32 v167, v167, v168
v_mov_b32 v168, v167
s_nop 1
v_permlane32_swap_b32 v167, v168
v_max_f32 v167, v167, v168
v_sub_f32 v154, v154, v167
v_sub_f32 v155, v155, v167
v_sub_f32 v156, v156, v167
v_sub_f32 v157, v157, v167
v_sub_f32 v158, v158, v167
v_sub_f32 v159, v159, v167
v_sub_f32 v160, v160, v167
v_sub_f32 v161, v161, v167
v_sub_f32 v166, v166, v167
v_sub_f32 v162, v162, v167
v_sub_f32 v163, v163, v167
v_sub_f32 v164, v164, v167
v_sub_f32 v165, v165, v167
v_exp_f32 v154, v154
v_exp_f32 v155, v155
v_exp_f32 v156, v156
v_exp_f32 v157, v157
v_exp_f32 v158, v158
v_exp_f32 v159, v159
v_exp_f32 v160, v160
v_exp_f32 v161, v161
v_exp_f32 v166, v166
v_exp_f32 v162, v162
v_exp_f32 v163, v163
v_exp_f32 v164, v164
v_exp_f32 v165, v165
v_cvt_pk_bf16_f32 v174, v154, v155
v_cvt_pk_bf16_f32 v175, v156, v157
v_cvt_pk_bf16_f32 v176, v158, v159
v_cvt_pk_bf16_f32 v177, v160, v161
v_cvt_pk_bf16_f32 v178, v162, v163
v_cvt_pk_bf16_f32 v179, v164, v165
v_cvt_pk_bf16_f32 v180, v166, 0
v_mfma_f32_16x16x32_bf16 v[166:169], v[190:193], v[174:177], 0
v_mfma_f32_16x16x32_bf16 v[166:169], v[190:193], v[178:181], v[166:169]
v_mfma_f32_16x16x32_bf16 v[154:157], v[114:117], v[174:177], 0
v_mfma_f32_16x16x32_bf16 v[154:157], v[118:121], v[178:181], v[154:157]
v_mfma_f32_16x16x32_bf16 v[158:161], v[122:125], v[174:177], 0
v_mfma_f32_16x16x32_bf16 v[158:161], v[126:129], v[178:181], v[158:161]
v_mfma_f32_16x16x32_bf16 v[162:165], v[130:133], v[174:177], 0
v_mfma_f32_16x16x32_bf16 v[162:165], v[134:137], v[178:181], v[162:165]
v_rcp_f32 v151, v150
s_nop 0
v_mul_f32 v152, s3, v151
v_mul_f32 v138, v138, v152
v_mul_f32 v139, v139, v152
v_cvt_pk_bf16_f32 v138, v138, v139
v_mul_f32 v140, v140, v152
v_mul_f32 v141, v141, v152
v_cvt_pk_bf16_f32 v139, v140, v141
v_mul_f32 v142, v142, v152
v_mul_f32 v143, v143, v152
v_cvt_pk_bf16_f32 v140, v142, v143
v_mul_f32 v144, v144, v152
v_mul_f32 v145, v145, v152
v_cvt_pk_bf16_f32 v141, v144, v145
ds_write_b128 v211, v[138:141] offset:38912
v_mul_f32 v146, v146, v152
v_mul_f32 v147, v147, v152
v_cvt_pk_bf16_f32 v142, v146, v147
v_mul_f32 v148, v148, v152
v_mul_f32 v149, v149, v152
v_cvt_pk_bf16_f32 v143, v148, v149
ds_write_b64 v212, v[142:143] offset:38912
v_mfma_f32_16x16x32_bf16 v[138:141], v[78:81], v[90:93], 0
v_mfma_f32_16x16x32_bf16 v[142:145], v[96:99], v[90:93], 0
v_mfma_f32_16x16x32_bf16 v[150:153], v[108:111], v[90:93], v[206:209]
v_mfma_f32_16x16x32_bf16 v[146:149], v[102:105], v[90:93], 0
v_mfma_f32_16x16x16_bf16 v[138:141], v[82:83], v[94:95], v[138:141]
v_mfma_f32_16x16x16_bf16 v[142:145], v[100:101], v[94:95], v[142:145]
v_mfma_f32_16x16x16_bf16 v[150:153], v[112:113], v[94:95], v[150:153]
v_mfma_f32_16x16x16_bf16 v[146:149], v[106:107], v[94:95], v[146:149]
v_rcp_f32 v167, v166
s_nop 0
v_mul_f32 v168, s3, v167
v_mul_f32 v154, v154, v168
v_mul_f32 v155, v155, v168
v_cvt_pk_bf16_f32 v154, v154, v155
v_mul_f32 v156, v156, v168
v_mul_f32 v157, v157, v168
v_cvt_pk_bf16_f32 v155, v156, v157
v_mul_f32 v158, v158, v168
v_mul_f32 v159, v159, v168
v_cvt_pk_bf16_f32 v156, v158, v159
v_mul_f32 v160, v160, v168
v_mul_f32 v161, v161, v168
v_cvt_pk_bf16_f32 v157, v160, v161
ds_write_b128 v211, v[154:157] offset:45056
v_mul_f32 v162, v162, v168
v_mul_f32 v163, v163, v168
v_cvt_pk_bf16_f32 v158, v162, v163
v_mul_f32 v164, v164, v168
v_mul_f32 v165, v165, v168
v_cvt_pk_bf16_f32 v159, v164, v165
ds_write_b64 v212, v[158:159] offset:45056
v_mfma_f32_16x16x16_bf16 v[154:157], v[76:77], v[82:83], 0
v_mfma_f32_16x16x16_bf16 v[158:161], v[76:77], v[100:101], 0
v_mfma_f32_16x16x16_bf16 v[162:165], v[76:77], v[106:107], 0
v_mfma_f32_16x16x16_bf16 v[166:169], v[76:77], v[112:113], v[206:209]
v_mfma_f32_16x16x32_bf16 v[154:157], v[72:75], v[78:81], v[154:157]
v_mfma_f32_16x16x32_bf16 v[158:161], v[72:75], v[96:99], v[158:161]
v_mfma_f32_16x16x32_bf16 v[162:165], v[72:75], v[102:105], v[162:165]
v_mfma_f32_16x16x32_bf16 v[166:169], v[72:75], v[108:111], v[166:169]
v_mov_b32_dpp v154, v158 quad_perm:[0,1,2,3] row_mask:0x2 bank_mask:0xf
s_nop 1
v_mov_b32_dpp v154, v162 quad_perm:[0,1,2,3] row_mask:0x4 bank_mask:0xf
s_nop 2
v_mov_b32_dpp v154, v167 quad_perm:[0,1,2,3] row_mask:0x8 bank_mask:0xf
v_mov_b32 v155, v154
s_nop 1
v_max_f32_dpp v155, v155, v155 row_ror:8 row_mask:0xf bank_mask:0xf
s_nop 1
v_max_f32_dpp v155, v155, v155 row_ror:4 row_mask:0xf bank_mask:0xf
s_nop 1
v_max_f32_dpp v155, v155, v155 row_ror:2 row_mask:0xf bank_mask:0xf
s_nop 1
v_max_f32_dpp v155, v155, v155 row_ror:1 row_mask:0xf bank_mask:0xf
v_mov_b32 v156, v155
s_nop 1
v_permlane16_swap_b32 v155, v156
v_max_f32 v155, v155, v156
v_mov_b32 v156, v155
s_nop 1
v_permlane32_swap_b32 v155, v156
v_max_f32 v155, v155, v156
v_sub_f32 v154, v154, v155
v_exp_f32 v154, v154
s_nop 0
v_cvt_pk_bf16_f32 v154, v154, 0
ds_write_b16 v214, v154
ds_read_b128 v[84:87], v215
s_waitcnt lgkmcnt(2)
ds_read_b128 v[88:91], v215 offset:16
v_add_u32 v215, 1424, v215
s_barrier
ds_read_b128 v[220:223], v210 offset:38912
ds_read_b128 v[110:113], v210 offset:39936
s_waitcnt lgkmcnt(1)
v_mfma_f32_16x16x32_bf16 v[0:3], a[144:147], v[220:223], v[0:3]
s_waitcnt lgkmcnt(0)
v_mfma_f32_16x16x32_bf16 v[0:3], a[148:151], v[110:113], v[0:3]
v_mfma_f32_16x16x32_bf16 v[4:7], a[168:171], v[220:223], v[4:7]
v_mfma_f32_16x16x32_bf16 v[4:7], a[172:175], v[110:113], v[4:7]
v_mfma_f32_16x16x32_bf16 v[8:11], a[192:195], v[220:223], v[8:11]
v_mfma_f32_16x16x32_bf16 v[8:11], a[196:199], v[110:113], v[8:11]
ds_read_b128 v[170:173], v210 offset:40960
ds_read_b128 v[182:185], v210 offset:41984
s_waitcnt lgkmcnt(1)
v_mfma_f32_16x16x32_bf16 v[0:3], a[152:155], v[170:173], v[0:3]
s_waitcnt lgkmcnt(0)
v_mfma_f32_16x16x32_bf16 v[0:3], a[156:159], v[182:185], v[0:3]
v_mfma_f32_16x16x32_bf16 v[4:7], a[176:179], v[170:173], v[4:7]
v_mfma_f32_16x16x32_bf16 v[4:7], a[180:183], v[182:185], v[4:7]
v_mfma_f32_16x16x32_bf16 v[8:11], a[200:203], v[170:173], v[8:11]
v_mfma_f32_16x16x32_bf16 v[8:11], a[204:207], v[182:185], v[8:11]
ds_read_b128 v[186:189], v210 offset:43008
ds_read_b128 v[220:223], v210 offset:44032
s_waitcnt lgkmcnt(1)
v_mfma_f32_16x16x32_bf16 v[0:3], a[160:163], v[186:189], v[0:3]
s_waitcnt lgkmcnt(0)
v_mfma_f32_16x16x32_bf16 v[0:3], a[164:167], v[220:223], v[0:3]
v_mfma_f32_16x16x32_bf16 v[4:7], a[184:187], v[186:189], v[4:7]
v_mfma_f32_16x16x32_bf16 v[4:7], a[188:191], v[220:223], v[4:7]
v_mfma_f32_16x16x32_bf16 v[8:11], a[208:211], v[186:189], v[8:11]
v_mfma_f32_16x16x32_bf16 v[8:11], a[212:215], v[220:223], v[8:11]
v_cvt_pk_bf16_f32 v0, v0, v1
v_cvt_pk_bf16_f32 v1, v2, v3
ds_write_b64 v203, v[0:1]
v_cvt_pk_bf16_f32 v4, v4, v5
v_cvt_pk_bf16_f32 v5, v6, v7
ds_write_b64 v203, v[4:5] offset:32
v_cvt_pk_bf16_f32 v8, v8, v9
v_cvt_pk_bf16_f32 v9, v10, v11
ds_write_b64 v203, v[8:9] offset:64
v_max3_f32 v151, v138, v139, v140
v_max3_f32 v151, v151, v141, v142
v_max3_f32 v151, v151, v143, v144
v_max3_f32 v151, v151, v145, v146
v_max3_f32 v151, v151, v147, v148
v_max3_f32 v151, v151, v149, v150
v_mov_b32 v152, v151
s_nop 1
v_permlane16_swap_b32 v151, v152
v_max_f32 v151, v151, v152
v_mov_b32 v152, v151
s_nop 1
v_permlane32_swap_b32 v151, v152
v_max_f32 v151, v151, v152
v_sub_f32 v138, v138, v151
v_sub_f32 v139, v139, v151
v_sub_f32 v140, v140, v151
v_sub_f32 v141, v141, v151
v_sub_f32 v142, v142, v151
v_sub_f32 v143, v143, v151
v_sub_f32 v144, v144, v151
v_sub_f32 v145, v145, v151
v_sub_f32 v150, v150, v151
v_sub_f32 v146, v146, v151
v_sub_f32 v147, v147, v151
v_sub_f32 v148, v148, v151
v_sub_f32 v149, v149, v151
v_exp_f32 v138, v138
v_exp_f32 v139, v139
v_exp_f32 v140, v140
v_exp_f32 v141, v141
v_exp_f32 v142, v142
v_exp_f32 v143, v143
v_exp_f32 v144, v144
v_exp_f32 v145, v145
v_exp_f32 v150, v150
v_exp_f32 v146, v146
v_exp_f32 v147, v147
v_exp_f32 v148, v148
v_exp_f32 v149, v149
v_cvt_pk_bf16_f32 v174, v138, v139
v_cvt_pk_bf16_f32 v175, v140, v141
v_cvt_pk_bf16_f32 v176, v142, v143
v_cvt_pk_bf16_f32 v177, v144, v145
v_cvt_pk_bf16_f32 v178, v146, v147
v_cvt_pk_bf16_f32 v179, v148, v149
v_cvt_pk_bf16_f32 v180, v150, 0
v_mfma_f32_16x16x32_bf16 v[150:153], v[190:193], v[174:177], 0
v_mfma_f32_16x16x32_bf16 v[150:153], v[190:193], v[178:181], v[150:153]
v_mfma_f32_16x16x32_bf16 v[138:141], v[114:117], v[174:177], 0
v_mfma_f32_16x16x32_bf16 v[138:141], v[118:121], v[178:181], v[138:141]
v_mfma_f32_16x16x32_bf16 v[142:145], v[122:125], v[174:177], 0
v_mfma_f32_16x16x32_bf16 v[142:145], v[126:129], v[178:181], v[142:145]
v_mfma_f32_16x16x32_bf16 v[146:149], v[130:133], v[174:177], 0
v_mfma_f32_16x16x32_bf16 v[146:149], v[134:137], v[178:181], v[146:149]
v_rcp_f32 v151, v150
s_nop 0
v_mul_f32 v152, s3, v151
v_mul_f32 v138, v138, v152
v_mul_f32 v139, v139, v152
v_cvt_pk_bf16_f32 v138, v138, v139
v_mul_f32 v140, v140, v152
v_mul_f32 v141, v141, v152
v_cvt_pk_bf16_f32 v139, v140, v141
v_mul_f32 v142, v142, v152
v_mul_f32 v143, v143, v152
v_cvt_pk_bf16_f32 v140, v142, v143
v_mul_f32 v144, v144, v152
v_mul_f32 v145, v145, v152
v_cvt_pk_bf16_f32 v141, v144, v145
ds_write_b128 v211, v[138:141] offset:51200
v_mul_f32 v146, v146, v152
v_mul_f32 v147, v147, v152
v_cvt_pk_bf16_f32 v142, v146, v147
v_mul_f32 v148, v148, v152
v_mul_f32 v149, v149, v152
v_cvt_pk_bf16_f32 v143, v148, v149
ds_write_b64 v212, v[142:143] offset:51200
v_mfma_f32_16x16x32_bf16 v[166:169], v[84:87], v[190:193], 0
v_mfma_f32_16x16x32_bf16 v[166:169], v[88:91], v[190:193], v[166:169]
v_mfma_f32_16x16x32_bf16 v[154:157], v[84:87], v[114:117], 0
v_mfma_f32_16x16x32_bf16 v[154:157], v[88:91], v[118:121], v[154:157]
v_mfma_f32_16x16x32_bf16 v[158:161], v[84:87], v[122:125], 0
v_mfma_f32_16x16x32_bf16 v[158:161], v[88:91], v[126:129], v[158:161]
v_mfma_f32_16x16x32_bf16 v[162:165], v[84:87], v[130:133], 0
v_mfma_f32_16x16x32_bf16 v[162:165], v[88:91], v[134:137], v[162:165]
v_rcp_f32 v167, v166
v_mov_b32_dpp v154, v158 quad_perm:[0,1,2,3] row_mask:0x2 bank_mask:0xf
s_nop 3
v_mov_b32_dpp v154, v162 quad_perm:[0,1,2,3] row_mask:0x4 bank_mask:0xf
v_mul_f32 v168, s3, v167
v_mul_f32 v154, v154, v168
v_cvt_pk_bf16_f32 v154, v154, 0
ds_write_b16 v214, v154
v_add_u32 v214, 1424, v214
ds_read_b128 v[110:113], v210 offset:45056
ds_read_b128 v[170:173], v210 offset:46080
s_waitcnt lgkmcnt(1)
v_mfma_f32_16x16x32_bf16 v[12:15], a[144:147], v[110:113], v[12:15]
s_waitcnt lgkmcnt(0)
v_mfma_f32_16x16x32_bf16 v[12:15], a[148:151], v[170:173], v[12:15]
v_mfma_f32_16x16x32_bf16 v[16:19], a[168:171], v[110:113], v[16:19]
v_mfma_f32_16x16x32_bf16 v[16:19], a[172:175], v[170:173], v[16:19]
v_mfma_f32_16x16x32_bf16 v[20:23], a[192:195], v[110:113], v[20:23]
v_mfma_f32_16x16x32_bf16 v[20:23], a[196:199], v[170:173], v[20:23]
ds_read_b128 v[182:185], v210 offset:47104
ds_read_b128 v[186:189], v210 offset:48128
s_waitcnt lgkmcnt(1)
v_mfma_f32_16x16x32_bf16 v[12:15], a[152:155], v[182:185], v[12:15]
s_waitcnt lgkmcnt(0)
v_mfma_f32_16x16x32_bf16 v[12:15], a[156:159], v[186:189], v[12:15]
v_mfma_f32_16x16x32_bf16 v[16:19], a[176:179], v[182:185], v[16:19]
v_mfma_f32_16x16x32_bf16 v[16:19], a[180:183], v[186:189], v[16:19]
v_mfma_f32_16x16x32_bf16 v[20:23], a[200:203], v[182:185], v[20:23]
v_mfma_f32_16x16x32_bf16 v[20:23], a[204:207], v[186:189], v[20:23]
ds_read_b128 v[220:223], v210 offset:49152
ds_read_b128 v[110:113], v210 offset:50176
s_waitcnt lgkmcnt(1)
v_mfma_f32_16x16x32_bf16 v[12:15], a[160:163], v[220:223], v[12:15]
s_waitcnt lgkmcnt(0)
v_mfma_f32_16x16x32_bf16 v[12:15], a[164:167], v[110:113], v[12:15]
v_mfma_f32_16x16x32_bf16 v[16:19], a[184:187], v[220:223], v[16:19]
v_mfma_f32_16x16x32_bf16 v[16:19], a[188:191], v[110:113], v[16:19]
v_mfma_f32_16x16x32_bf16 v[20:23], a[208:211], v[220:223], v[20:23]
v_mfma_f32_16x16x32_bf16 v[20:23], a[212:215], v[110:113], v[20:23]
v_cvt_pk_bf16_f32 v12, v12, v13
v_cvt_pk_bf16_f32 v13, v14, v15
ds_write_b64 v203, v[12:13] offset:6272
v_cvt_pk_bf16_f32 v16, v16, v17
v_cvt_pk_bf16_f32 v17, v18, v19
ds_write_b64 v203, v[16:17] offset:6304
v_cvt_pk_bf16_f32 v20, v20, v21
v_cvt_pk_bf16_f32 v21, v22, v23
ds_write_b64 v203, v[20:21] offset:6336
v_cmp_lt_u32 vcc, 1602224128, v218
s_nop 0
s_or_b32 s41, vcc_lo, vcc_hi
v_mov_b32 v69, s41
ds_write_b32 v209, v69
s_waitcnt lgkmcnt(0)
s_barrier
ds_read_b64 v[120:121], v204
s_add_u32 s28, s38, s60
s_waitcnt lgkmcnt(0)
buffer_store_dwordx2 v[120:121], v204, s[8:11], s28 offen sc1
ds_read_b64 v[128:129], v204 offset:392
s_add_u32 s29, s38, s61
s_waitcnt lgkmcnt(0)
buffer_store_dwordx2 v[128:129], v204, s[8:11], s29 offen sc1
ds_read_b64 v[136:137], v204 offset:784
s_add_u32 s28, s38, s62
s_waitcnt lgkmcnt(0)
buffer_store_dwordx2 v[136:137], v204, s[8:11], s28 offen sc1
ds_read_b64 v[120:121], v204 offset:1176
s_add_u32 s29, s38, s63
s_waitcnt lgkmcnt(0)
buffer_store_dwordx2 v[120:121], v204, s[8:11], s29 offen sc1
ds_read_b128 v[170:173], v210 offset:51200
ds_read_b128 v[182:185], v210 offset:52224
s_waitcnt lgkmcnt(1)
v_mfma_f32_16x16x32_bf16 v[24:27], a[144:147], v[170:173], v[24:27]
s_waitcnt lgkmcnt(0)
v_mfma_f32_16x16x32_bf16 v[24:27], a[148:151], v[182:185], v[24:27]
v_mfma_f32_16x16x32_bf16 v[28:31], a[168:171], v[170:173], v[28:31]
v_mfma_f32_16x16x32_bf16 v[28:31], a[172:175], v[182:185], v[28:31]
v_mfma_f32_16x16x32_bf16 v[32:35], a[192:195], v[170:173], v[32:35]
v_mfma_f32_16x16x32_bf16 v[32:35], a[196:199], v[182:185], v[32:35]
ds_read_b128 v[186:189], v210 offset:53248
ds_read_b128 v[220:223], v210 offset:54272
s_waitcnt lgkmcnt(1)
v_mfma_f32_16x16x32_bf16 v[24:27], a[152:155], v[186:189], v[24:27]
s_waitcnt lgkmcnt(0)
v_mfma_f32_16x16x32_bf16 v[24:27], a[156:159], v[220:223], v[24:27]
v_mfma_f32_16x16x32_bf16 v[28:31], a[176:179], v[186:189], v[28:31]
v_mfma_f32_16x16x32_bf16 v[28:31], a[180:183], v[220:223], v[28:31]
v_mfma_f32_16x16x32_bf16 v[32:35], a[200:203], v[186:189], v[32:35]
v_mfma_f32_16x16x32_bf16 v[32:35], a[204:207], v[220:223], v[32:35]
ds_read_b128 v[110:113], v210 offset:55296
ds_read_b128 v[170:173], v210 offset:56320
s_waitcnt lgkmcnt(1)
v_mfma_f32_16x16x32_bf16 v[24:27], a[160:163], v[110:113], v[24:27]
s_waitcnt lgkmcnt(0)
v_mfma_f32_16x16x32_bf16 v[24:27], a[164:167], v[170:173], v[24:27]
v_mfma_f32_16x16x32_bf16 v[28:31], a[184:187], v[110:113], v[28:31]
v_mfma_f32_16x16x32_bf16 v[28:31], a[188:191], v[170:173], v[28:31]
v_mfma_f32_16x16x32_bf16 v[32:35], a[208:211], v[110:113], v[32:35]
v_mfma_f32_16x16x32_bf16 v[32:35], a[212:215], v[170:173], v[32:35]
v_cvt_pk_bf16_f32 v24, v24, v25
v_cvt_pk_bf16_f32 v25, v26, v27
ds_write_b64 v203, v[24:25] offset:12544
v_cvt_pk_bf16_f32 v28, v28, v29
v_cvt_pk_bf16_f32 v29, v30, v31
ds_write_b64 v203, v[28:29] offset:12576
v_cvt_pk_bf16_f32 v32, v32, v33
v_cvt_pk_bf16_f32 v33, v34, v35
ds_write_b64 v203, v[32:33] offset:12608
ds_read_b128 v[84:87], v63 offset:22784
ds_read_b128 v[88:91], v63 offset:22912
ds_read_b128 v[92:95], v63 offset:23040
ds_read_b128 v[96:99], v63 offset:23168
ds_read_b64 v[100:101], v63 offset:22800
ds_read_b64 v[102:103], v63 offset:22928
ds_read_b64 v[104:105], v63 offset:23056
s_waitcnt vmcnt(6) lgkmcnt(6)
ds_read_b64 v[106:107], v63 offset:23184
v_mfma_f32_16x16x32_bf16 v[48:51], a[144:147], v[84:87], v[48:51]
s_waitcnt lgkmcnt(6)
v_mfma_f32_16x16x32_bf16 v[48:51], a[148:151], v[88:91], v[48:51]
s_waitcnt lgkmcnt(5)
v_mfma_f32_16x16x32_bf16 v[48:51], a[152:155], v[92:95], v[48:51]
s_waitcnt lgkmcnt(4)
v_mfma_f32_16x16x32_bf16 v[48:51], a[156:159], v[96:99], v[48:51]
s_waitcnt lgkmcnt(2)
v_mfma_f32_16x16x32_bf16 v[48:51], a[160:163], v[100:103], v[48:51]
s_waitcnt lgkmcnt(0)
v_mfma_f32_16x16x32_bf16 v[48:51], a[164:167], v[104:107], v[48:51]
s_nop 7
v_cvt_pk_bf16_f32 v48, v48, v49
v_cvt_pk_bf16_f32 v49, v50, v51
buffer_store_dwordx2 v[48:49], v66, s[8:11], 0 offen
s_waitcnt vmcnt(6)
v_mfma_f32_16x16x32_bf16 v[52:55], a[168:171], v[84:87], v[52:55]
v_mfma_f32_16x16x32_bf16 v[52:55], a[172:175], v[88:91], v[52:55]
v_mfma_f32_16x16x32_bf16 v[52:55], a[176:179], v[92:95], v[52:55]
v_mfma_f32_16x16x32_bf16 v[52:55], a[180:183], v[96:99], v[52:55]
v_mfma_f32_16x16x32_bf16 v[52:55], a[184:187], v[100:103], v[52:55]
v_mfma_f32_16x16x32_bf16 v[52:55], a[188:191], v[104:107], v[52:55]
s_nop 7
v_cvt_pk_bf16_f32 v52, v52, v53
v_cvt_pk_bf16_f32 v53, v54, v55
buffer_store_dwordx2 v[52:53], v66, s[8:11], 0 offen offset:32
s_waitcnt vmcnt(6)
v_mfma_f32_16x16x32_bf16 v[56:59], a[192:195], v[84:87], v[56:59]
v_mfma_f32_16x16x32_bf16 v[56:59], a[196:199], v[88:91], v[56:59]
v_mfma_f32_16x16x32_bf16 v[56:59], a[200:203], v[92:95], v[56:59]
v_mfma_f32_16x16x32_bf16 v[56:59], a[204:207], v[96:99], v[56:59]
v_mfma_f32_16x16x32_bf16 v[56:59], a[208:211], v[100:103], v[56:59]
v_mfma_f32_16x16x32_bf16 v[56:59], a[212:215], v[104:107], v[56:59]
s_nop 7
v_cvt_pk_bf16_f32 v56, v56, v57
v_cvt_pk_bf16_f32 v57, v58, v59
buffer_store_dwordx2 v[56:57], v66, s[8:11], 0 offen offset:64
s_barrier
ds_read_b64 v[128:129], v204 offset:6272
s_add_u32 s28, s38, s64
s_waitcnt lgkmcnt(0)
buffer_store_dwordx2 v[128:129], v204, s[8:11], s28 offen sc1
ds_read_b64 v[136:137], v204 offset:6664
s_add_u32 s29, s38, s65
s_waitcnt lgkmcnt(0)
buffer_store_dwordx2 v[136:137], v204, s[8:11], s29 offen sc1
ds_read_b64 v[120:121], v204 offset:7056
s_add_u32 s28, s38, s66
s_waitcnt lgkmcnt(0)
buffer_store_dwordx2 v[120:121], v204, s[8:11], s28 offen sc1
ds_read_b64 v[128:129], v204 offset:7448
s_add_u32 s29, s38, s67
s_waitcnt lgkmcnt(0)
buffer_store_dwordx2 v[128:129], v204, s[8:11], s29 offen sc1
ds_read_b64 v[136:137], v204 offset:12544
s_add_u32 s28, s38, s68
s_waitcnt lgkmcnt(0)
buffer_store_dwordx2 v[136:137], v204, s[8:11], s28 offen sc1
ds_read_b64 v[120:121], v204 offset:12936
s_add_u32 s29, s38, s69
s_waitcnt lgkmcnt(0)
buffer_store_dwordx2 v[120:121], v204, s[8:11], s29 offen sc1
ds_read_b64 v[128:129], v204 offset:13328
s_add_u32 s28, s38, s70
s_waitcnt lgkmcnt(0)
buffer_store_dwordx2 v[128:129], v204, s[8:11], s28 offen sc1
ds_read_b64 v[136:137], v204 offset:13720
s_add_u32 s29, s38, s71
s_waitcnt lgkmcnt(0)
buffer_store_dwordx2 v[136:137], v204, s[8:11], s29 offen sc1
ds_read_b128 v[174:177], v210 offset:18432
s_waitcnt lgkmcnt(0)
v_or3_b32 v174, v174, v175, v176
v_or_b32 v174, v174, v177
s_nop 0
v_readfirstlane_b32 s43, v174
s_endpgm
.p2align 6
.type L_tab,@object
L_tab:
.long 0x0,0x3800,0x5500,0x190,0x320,0x2020,0x5820,0x4b0,0x640,0x2340,0x4040,0x7d0,0x960,0x2660,0x6060,0xaf0
.long 0x1010,0x4810,0x6510,0x11a0,0x1330,0x3030,0x6830,0x14c0,0x1650,0x3350,0x5050,0x17e0,0x1970,0x3670,0x5370,0x1b00
.long 0x190,0x3990,0x5690,0x320,0x4b0,0x21b0,0x59b0,0x640,0x7d0,0x24d0,0x41d0,0x960,0x27f0,0x44f0,0x61f0,0x2980
.long 0x2980,0x4680,0x6380,0x2b10,0x11a0,0x49a0,0x66a0,0x1330,0x14c0,0x31c0,0x69c0,0x1650,0x17e0,0x34e0,0x51e0,0x1970
.long 0x320,0x3b20,0x5820,0x1010,0x640,0x2340,0x5b40,0x1330,0x960,0x2660,0x4360,0x1650,0xc80,0x2980,0x6380,0x1970
.long 0x1330,0x4b30,0x6830,0x2020,0x1650,0x3350,0x6b50,0x2340,0x1970,0x3670,0x5370,0x2660,0x1c90,0x3990,0x5690,0x2980
.long 0x4b0,0x3cb0,0x59b0,0x11a0,0x7d0,0x24d0,0x5cd0,0x14c0,0xaf0,0x27f0,0x44f0,0x17e0,0x2b10,0x4810,0x6510,0x3800
.long 0x2ca0,0x49a0,0x66a0,0x3990,0x14c0,0x4cc0,0x69c0,0x21b0,0x17e0,0x34e0,0x6ce0,0x24d0,0x1b00,0x3800,0x5500,0x27f0
.long 0x2020,0x5820,0x7520,0x1330,0x2340,0x4040,0x7840,0x1650,0x2660,0x4360,0x6060,0x1970,0x2980,0x4680,0x8080,0x1c90
.long 0x3030,0x6830,0x8530,0x2340,0x3350,0x5050,0x8850,0x2660,0x3670,0x5370,0x7070,0x2980,0x3990,0x5690,0x7390,0x2ca0
.long 0x21b0,0x59b0,0x76b0,0x14c0,0x24d0,0x41d0,0x79d0,0x17e0,0x27f0,0x44f0,0x61f0,0x1b00,0x4810,0x6510,0x8210,0x3b20
.long 0x49a0,0x66a0,0x83a0,0x3cb0,0x31c0,0x69c0,0x86c0,0x24d0,0x34e0,0x51e0,0x89e0,0x27f0,0x3800,0x5500,0x7200,0x2b10
.long 0x2340,0x5b40,0x7840,0x21b0,0x2660,0x4360,0x7b60,0x24d0,0x2980,0x4680,0x6380,0x27f0,0x2ca0,0x49a0,0x83a0,0x2b10
.long 0x3350,0x6b50,0x8850,0x31c0,0x3670,0x5370,0x8b70,0x34e0,0x3990,0x5690,0x7390,0x3800,0x3cb0,0x59b0,0x76b0,0x3b20
.long 0x24d0,0x5cd0,0x79d0,0x2340,0x27f0,0x44f0,0x7cf0,0x2660,0x2b10,0x4810,0x6510,0x2980,0x4b30,0x6830,0x8530,0x49a0
.long 0x4cc0,0x69c0,0x86c0,0x4b30,0x34e0,0x6ce0,0x89e0,0x3350,0x3800,0x5500,0x8d00,0x3670,0x3b20,0x5820,0x7520,0x3990
.long 0x3990,0x5690,0x11a0,0x49a0,0x21b0,0x59b0,0x14c0,0x31c0,0x24d0,0x41d0,0x17e0,0x34e0,0x27f0,0x61f0,0x1b00,0x3800
.long 0x49a0,0x66a0,0x21b0,0x59b0,0x31c0,0x69c0,0x24d0,0x41d0,0x34e0,0x51e0,0x27f0,0x44f0,0x3800,0x5500,0x2b10,0x4810
.long 0x3b20,0x5820,0x1330,0x4b30,0x2340,0x5b40,0x1650,0x3350,0x2660,0x4360,0x1970,0x3670,0x4680,0x6380,0x3990,0x5690
.long 0x4810,0x6510,0x3b20,0x5820,0x4b30,0x6830,0x2340,0x5b40,0x3350,0x6b50,0x2660,0x4360,0x3670,0x5370,0x2980,0x4680
.long 0x4810,0x6510,0x11a0,0x49a0,0x3030,0x6830,0x14c0,0x31c0,0x3350,0x5050,0x17e0,0x34e0,0x3670,0x7070,0x1b00,0x3800
.long 0x5820,0x7520,0x21b0,0x59b0,0x4040,0x7840,0x24d0,0x41d0,0x4360,0x6060,0x27f0,0x44f0,0x4680,0x6380,0x2b10,0x4810
.long 0x49a0,0x66a0,0x1330,0x4b30,0x31c0,0x69c0,0x1650,0x3350,0x34e0,0x51e0,0x1970,0x3670,0x5500,0x7200,0x3990,0x5690
.long 0x5690,0x7390,0x3b20,0x5820,0x59b0,0x76b0,0x2340,0x5b40,0x41d0,0x79d0,0x2660,0x4360,0x44f0,0x61f0,0x2980,0x4680
.long 0x4b30,0x6830,0x11b0,0x49b0,0x3350,0x6b50,0x14d0,0x31d0,0x3670,0x5370,0x17f0,0x34f0,0x3990,0x7390,0x1b10,0x3810
.long 0x5b40,0x7840,0x21c0,0x59c0,0x4360,0x7b60,0x24e0,0x41e0,0x4680,0x6380,0x2800,0x4500,0x49a0,0x66a0,0x2b20,0x4820
.long 0x4cc0,0x69c0,0x1340,0x4b40,0x34e0,0x6ce0,0x1660,0x3360,0x3800,0x5500,0x1980,0x3680,0x5820,0x7520,0x39a0,0x56a0
.long 0x59b0,0x76b0,0x3b30,0x5830,0x5cd0,0x79d0,0x2350,0x5b50,0x44f0,0x7cf0,0x2670,0x4370,0x4810,0x6510,0x2990,0x4690
.long 0x59b0,0x76b0,0x11b0,0x49b0,0x41d0,0x79d0,0x14d0,0x31d0,0x44f0,0x61f0,0x17f0,0x34f0,0x4810,0x8210,0x1b10,0x3810
.long 0x69c0,0x86c0,0x21c0,0x59c0,0x51e0,0x89e0,0x24e0,0x41e0,0x5500,0x7200,0x2800,0x4500,0x5820,0x7520,0x2b20,0x4820
.long 0x5b40,0x7840,0x1340,0x4b40,0x4360,0x7b60,0x1660,0x3360,0x4680,0x6380,0x1980,0x3680,0x66a0,0x83a0,0x39a0,0x56a0
.long 0x6830,0x8530,0x3b30,0x5830,0x6b50,0x8850,0x2350,0x5b50,0x5370,0x8b70,0x2670,0x4370,0x5690,0x7390,0x2990,0x4690
.long 0x66a0,0x1e5d0,0x1e5d0,0x17500,0x69c0,0x1e758,0x1e5d8,0x17502,0x51e0,0x1e8e0,0x1e5e0,0x17504,0x7200,0x1ea68,0x1e5e8,0x17506
.long 0x76b0,0x1ebf0,0x1e5f0,0x17508,0x79d0,0x1ed78,0x1e5f8,0x1750a,0x61f0,0x1ef00,0x1e600,0x1750c,0x6510,0x1f088,0x1e608,0x1750e
.long 0x6830,0x1f210,0x1e610,0x17510,0x6b50,0x1f398,0x1e618,0x17512,0x5370,0x1f520,0x1e620,0x17514,0x7390,0x1f6a8,0x1e628,0x17516
.long 0x7520,0x1f830,0x1e630,0x17518,0x7840,0x1f9b8,0x1e638,0x1751a,0x7b60,0x1fb40,0x1e640,0x1751c,0x6380,0x1fcc8,0x1e648,0x1751e
.long 0x66a0,0x1e5d8,0x1e650,0x17500,0x69c0,0x1e760,0x1e658,0x17502,0x51e0,0x1e8e8,0x1e660,0x17504,0x7200,0x1ea70,0x1e668,0x17506
.long 0x76b0,0x1ebf8,0x1e670,0x17508,0x79d0,0x1ed80,0x1e678,0x1750a,0x61f0,0x1ef08,0x1e680,0x1750c,0x6510,0x1f090,0x1e688,0x1750e
.long 0x6830,0x1f218,0x1e690,0x17510,0x6b50,0x1f3a0,0x1e698,0x17512,0x5370,0x1f528,0x1e6a0,0x17514,0x7390,0x1f6b0,0x1e6a8,0x17516
.long 0x7520,0x1f838,0x1e6b0,0x17518,0x7840,0x1f9c0,0x1e6b8,0x1751a,0x7b60,0x1fb48,0x1e6c0,0x1751c,0x6380,0x1fcd0,0x1e6c8,0x1751e
.long 0x66b0,0x1e5e0,0x1e6d0,0x17500,0x69d0,0x1e768,0x1e6d8,0x17502,0x51f0,0x1e8f0,0x1e6e0,0x17504,0x7210,0x1ea78,0x1e6e8,0x17506
.long 0x76c0,0x1ec00,0x1e6f0,0x17508,0x79e0,0x1ed88,0x1e6f8,0x1750a,0x6200,0x1ef10,0x1e700,0x1750c,0x6520,0x1f098,0x1e708,0x1750e
.long 0x6840,0x1f220,0x1e710,0x17510,0x6b60,0x1f3a8,0x1e718,0x17512,0x5380,0x1f530,0x1e720,0x17514,0x73a0,0x1f6b8,0x1e728,0x17516
.long 0x7530,0x1f840,0x1e730,0x17518,0x7850,0x1f9c8,0x1e738,0x1751a,0x7b70,0x1fb50,0x1e740,0x1751c,0x6390,0x1fcd8,0x1e748,0x1751e
.long 0x66b0,0x1e5e8,0x10000000,0x17500,0x69d0,0x1e770,0x10000000,0x17502,0x51f0,0x1e8f8,0x10000000,0x17504,0x7210,0x1ea80,0x10000000,0x17506
.long 0x76c0,0x1ec08,0x10000000,0x17508,0x79e0,0x1ed90,0x10000000,0x1750a,0x6200,0x1ef18,0x10000000,0x1750c,0x6520,0x1f0a0,0x10000000,0x1750e
.long 0x6840,0x1f228,0x10000000,0x17510,0x6b60,0x1f3b0,0x10000000,0x17512,0x5380,0x1f538,0x10000000,0x17514,0x73a0,0x1f6c0,0x10000000,0x17516
.long 0x7530,0x1f848,0x10000000,0x17518,0x7850,0x1f9d0,0x10000000,0x1751a,0x7b70,0x1fb58,0x10000000,0x1751c,0x6390,0x1fce0,0x10000000,0x1751e
.long 0x0,0x0,0x9100,0xd900,0x0,0xff800000,0x9110,0xd910,0x0,0xff800000,0x9120,0xd920,0x0,0xff800000,0x9130,0xd930
.long 0x0,0xff800000,0x9140,0xd940,0x0,0xff800000,0x9150,0xd950,0x0,0xff800000,0x9160,0xd960,0x0,0xff800000,0x9170,0xd970
.long 0x0,0xff800000,0x9180,0xd980,0x0,0xff800000,0x9190,0xd990,0x0,0xff800000,0x91a0,0xd9a0,0x0,0xff800000,0x91b0,0xd9b0
.long 0x0,0xff800000,0x91c0,0xd9c0,0x0,0xff800000,0x91d0,0xd9d0,0x0,0xff800000,0x91e0,0xd9e0,0x0,0xff800000,0x91f0,0xd9f0
.long 0xff800000,0x0,0x9100,0xdd00,0xff800000,0xff800000,0x9110,0xdd10,0xff800000,0xff800000,0x9120,0xdd20,0xff800000,0xff800000,0x9130,0xdd30
.long 0xff800000,0xff800000,0x9140,0xdd40,0xff800000,0xff800000,0x9150,0xdd50,0xff800000,0xff800000,0x9160,0xdd60,0xff800000,0xff800000,0x9170,0xdd70
.long 0xff800000,0xff800000,0x9180,0xdd80,0xff800000,0xff800000,0x9190,0xdd90,0xff800000,0xff800000,0x91a0,0xdda0,0xff800000,0xff800000,0x91b0,0xddb0
.long 0xff800000,0xff800000,0x91c0,0xddc0,0xff800000,0xff800000,0x91d0,0xddd0,0xff800000,0xff800000,0x91e0,0xdde0,0xff800000,0xff800000,0x91f0,0xddf0
.long 0xff800000,0x0,0x9100,0xda00,0xff800000,0xff800000,0x9110,0xda10,0xff800000,0xff800000,0x9120,0xda20,0xff800000,0xff800000,0x9130,0xda30
.long 0xff800000,0xff800000,0x9140,0xda40,0xff800000,0xff800000,0x9150,0xda50,0xff800000,0xff800000,0x9160,0xda60,0xff800000,0xff800000,0x9170,0xda70
.long 0xff800000,0xff800000,0x9180,0xda80,0xff800000,0xff800000,0x9190,0xda90,0xff800000,0xff800000,0x91a0,0xdaa0,0xff800000,0xff800000,0x91b0,0xdab0
.long 0xff800000,0xff800000,0x91c0,0xdac0,0xff800000,0xff800000,0x91d0,0xdad0,0xff800000,0xff800000,0x91e0,0xdae0,0xff800000,0xff800000,0x91f0,0xdaf0
.long 0xff800000,0x0,0x9100,0xde00,0xff800000,0xff800000,0x9110,0xde10,0xff800000,0xff800000,0x9120,0xde20,0xff800000,0xff800000,0x9130,0xde30
.long 0xff800000,0xff800000,0x9140,0xde40,0xff800000,0xff800000,0x9150,0xde50,0xff800000,0xff800000,0x9160,0xde60,0xff800000,0xff800000,0x9170,0xde70
.long 0xff800000,0xff800000,0x9180,0xde80,0xff800000,0xff800000,0x9190,0xde90,0xff800000,0xff800000,0x91a0,0xdea0,0xff800000,0xff800000,0x91b0,0xdeb0
.long 0xff800000,0xff800000,0x91c0,0xdec0,0xff800000,0xff800000,0x91d0,0xded0,0xff800000,0xff800000,0x91e0,0xdee0,0xff800000,0xff800000,0x91f0,0xdef0
.long 0x9100,0x9100,0xa100,0x0,0x9110,0x9110,0xa110,0x55555555,0x9120,0x9120,0xa120,0xaaaaaaaa,0x9130,0x9130,0xa130,0xffffffff
.long 0x9140,0x9140,0xa140,0x0,0x9150,0x9150,0xa150,0x55555555,0x9160,0x9160,0xa160,0xaaaaaaaa,0x9170,0x9170,0xa170,0xffffffff
.long 0x9180,0x9180,0xa180,0x0,0x9190,0x9190,0xa190,0x55555555,0x91a0,0x91a0,0xa1a0,0xaaaaaaaa,0x91b0,0x91b0,0xa1b0,0xffffffff
.long 0x91c0,0x91c0,0xa1c0,0x0,0x91d0,0x91d0,0xa1d0,0x55555555,0x91e0,0x91e0,0xa1e0,0xaaaaaaaa,0x91f0,0x91f0,0xa1f0,0xffffffff
.long 0x9200,0x9200,0xa200,0x0,0x9210,0x9210,0xa210,0x55555555,0x9220,0x9220,0xa220,0xaaaaaaaa,0x9230,0x9230,0xa230,0xffffffff
.long 0x9240,0x9240,0xa240,0x0,0x9250,0x9250,0xa250,0x55555555,0x9260,0x9260,0xa260,0xaaaaaaaa,0x9270,0x9270,0xa270,0xffffffff
.long 0x9280,0x9280,0xa280,0x0,0x9290,0x9290,0xa290,0x55555555,0x92a0,0x92a0,0xa2a0,0xaaaaaaaa,0x92b0,0x92b0,0xa2b0,0xffffffff
.long 0x92c0,0x92c0,0xa2c0,0x0,0x92d0,0x92d0,0xa2d0,0x55555555,0x92e0,0x92e0,0xa2e0,0xaaaaaaaa,0x92f0,0x92f0,0xa2f0,0xffffffff
.long 0x9300,0x9300,0xa300,0x0,0x9310,0x9310,0xa310,0x55555555,0x9320,0x9320,0xa320,0xaaaaaaaa,0x9330,0x9330,0xa330,0xffffffff
.long 0x9340,0x9340,0xa340,0x0,0x9350,0x9350,0xa350,0x55555555,0x9360,0x9360,0xa360,0xaaaaaaaa,0x9370,0x9370,0xa370,0xffffffff
.long 0x9380,0x9380,0xa380,0x0,0x9390,0x9390,0xa390,0x55555555,0x93a0,0x93a0,0xa3a0,0xaaaaaaaa,0x93b0,0x93b0,0xa3b0,0xffffffff
.long 0x93c0,0x93c0,0xa3c0,0x0,0x93d0,0x93d0,0xa3d0,0x55555555,0x93e0,0x93e0,0xa3e0,0xaaaaaaaa,0x93f0,0x93f0,0xa3f0,0xffffffff
.long 0x9400,0x9400,0xa400,0x0,0x9410,0x9410,0xa410,0x55555555,0x9420,0x9420,0xa420,0xaaaaaaaa,0x9430,0x9430,0xa430,0xffffffff
.long 0x9440,0x9440,0xa440,0x0,0x9450,0x9450,0xa450,0x55555555,0x9460,0x9460,0xa460,0xaaaaaaaa,0x9470,0x9470,0xa470,0xffffffff
.long 0x9480,0x9480,0xa480,0x0,0x9490,0x9490,0xa490,0x55555555,0x94a0,0x94a0,0xa4a0,0xaaaaaaaa,0x94b0,0x94b0,0xa4b0,0xffffffff
.long 0x94c0,0x94c0,0xa4c0,0x0,0x94d0,0x94d0,0xa4d0,0x55555555,0x94e0,0x94e0,0xa4e0,0xaaaaaaaa,0x94f0,0x94f0,0xa4f0,0xffffffff
.long 0x17100,0x17100,0x0,0x23100,0x17102,0x17100,0x0,0x23110,0x17104,0x17100,0x0,0x23120,0x17106,0x17100,0x0,0x23130
.long 0x17120,0x17100,0x0,0x23140,0x17122,0x17100,0x0,0x23150,0x17124,0x17100,0x0,0x23160,0x17126,0x17100,0x0,0x23170
.long 0x17140,0x17100,0x0,0x23300,0x17142,0x17100,0x0,0x23300,0x17144,0x17100,0x0,0x23300,0x17146,0x17100,0x0,0x23300
.long 0x17160,0x17100,0x0,0x23300,0x17162,0x17100,0x0,0x23300,0x17164,0x17100,0x0,0x23300,0x17166,0x17100,0x0,0x23300
.long 0x17108,0x17120,0x0,0x23200,0x1710a,0x17120,0x0,0x23210,0x1710c,0x17120,0x0,0x23220,0x1710e,0x17120,0x0,0x23230
.long 0x17128,0x17120,0x0,0x23240,0x1712a,0x17120,0x0,0x23250,0x1712c,0x17120,0x0,0x23260,0x1712e,0x17120,0x0,0x23270
.long 0x17148,0x17120,0x0,0x23300,0x1714a,0x17120,0x0,0x23300,0x1714c,0x17120,0x0,0x23300,0x1714e,0x17120,0x0,0x23300
.long 0x17168,0x17120,0x0,0x23300,0x1716a,0x17120,0x0,0x23300,0x1716c,0x17120,0x0,0x23300,0x1716e,0x17120,0x0,0x23300
.long 0x17110,0x17140,0x0,0x23300,0x17112,0x17140,0x0,0x23300,0x17114,0x17140,0x0,0x23300,0x17116,0x17140,0x0,0x23300
.long 0x17130,0x17140,0x0,0x23300,0x17132,0x17140,0x0,0x23300,0x17134,0x17140,0x0,0x23300,0x17136,0x17140,0x0,0x23300
.long 0x17150,0x17140,0x0,0x23180,0x17152,0x17140,0x0,0x23190,0x17154,0x17140,0x0,0x231a0,0x17156,0x17140,0x0,0x231b0
.long 0x17170,0x17140,0x0,0x231c0,0x17172,0x17140,0x0,0x231d0,0x17174,0x17140,0x0,0x231e0,0x17176,0x17140,0x0,0x231f0
.long 0x17118,0x17160,0x0,0x23300,0x1711a,0x17160,0x0,0x23300,0x1711c,0x17160,0x0,0x23300,0x1711e,0x17160,0x0,0x23300
.long 0x17138,0x17160,0x0,0x23300,0x1713a,0x17160,0x0,0x23300,0x1713c,0x17160,0x0,0x23300,0x1713e,0x17160,0x0,0x23300
.long 0x17158,0x17160,0x0,0x23280,0x1715a,0x17160,0x0,0x23290,0x1715c,0x17160,0x0,0x232a0,0x1715e,0x17160,0x0,0x232b0
.long 0x17178,0x17160,0x0,0x232c0,0x1717a,0x17160,0x0,0x232d0,0x1717c,0x17160,0x0,0x232e0,0x1717e,0x17160,0x0,0x232f0
.long 0x17100,0xe100,0xe280,0xe700,0x17108,0xee90,0xf010,0xf490,0x17110,0xfc20,0xfda0,0x10220,0x17118,0x109b0,0x10b30,0x10fb0
.long 0x17160,0x11740,0x118c0,0x11d40,0x17168,0x124d0,0x12650,0x12ad0,0x17170,0x13260,0x133e0,0x13860,0x17178,0x13ff0,0x14170,0x145f0
.long 0x171c0,0x14d80,0x14f00,0x15380,0x171c8,0x15b10,0x15c90,0x16110,0x171d0,0x168a0,0x16a20,0x16ea0,0x171d8,0x17630,0x177b0,0x17c30
.long 0x17220,0x183c0,0x18540,0x189c0,0x17228,0x19150,0x192d0,0x19750,0x17230,0x19ee0,0x1a060,0x1a4e0,0x17238,0x1ac70,0x1adf0,0x1b270
.long 0x17280,0xe400,0xe580,0xe700,0x17288,0xf190,0xf310,0xf490,0x17290,0xff20,0x100a0,0x10220,0x17298,0x10cb0,0x10e30,0x10fb0
.long 0x172e0,0x11a40,0x11bc0,0x11d40,0x172e8,0x127d0,0x12950,0x12ad0,0x172f0,0x13560,0x136e0,0x13860,0x172f8,0x142f0,0x14470,0x145f0
.long 0x17340,0x15080,0x15200,0x15380,0x17348,0x15e10,0x15f90,0x16110,0x17350,0x16ba0,0x16d20,0x16ea0,0x17358,0x17930,0x17ab0,0x17c30
.long 0x173a0,0x186c0,0x18840,0x189c0,0x173a8,0x19450,0x195d0,0x19750,0x173b0,0x1a1e0,0x1a360,0x1a4e0,0x173b8,0x1af70,0x1b0f0,0x1b270
.long 0x17400,0xea00,0xe880,0xe710,0x17408,0xf790,0xf610,0xf4a0,0x17410,0x10520,0x103a0,0x10230,0x17418,0x112b0,0x11130,0x10fc0
.long 0x17460,0x12040,0x11ec0,0x11d50,0x17468,0x12dd0,0x12c50,0x12ae0,0x17470,0x13b60,0x139e0,0x13870,0x17478,0x148f0,0x14770,0x14600
.long 0x174c0,0x15680,0x15500,0x15390,0x174c8,0x16410,0x16290,0x16120,0x174d0,0x171a0,0x17020,0x16eb0,0x174d8,0x17f30,0x17db0,0x17c40
.long 0x17520,0x18cc0,0x18b40,0x189d0,0x17528,0x19a50,0x198d0,0x19760,0x17530,0x1a7e0,0x1a660,0x1a4f0,0x17538,0x1b570,0x1b3f0,0x1b280
.long 0x17580,0xed00,0xeb80,0xe710,0x17588,0xfa90,0xf910,0xf4a0,0x17590,0x10820,0x106a0,0x10230,0x17598,0x115b0,0x11430,0x10fc0
.long 0x175e0,0x12340,0x121c0,0x11d50,0x175e8,0x130d0,0x12f50,0x12ae0,0x175f0,0x13e60,0x13ce0,0x13870,0x175f8,0x14bf0,0x14a70,0x14600
.long 0x17640,0x15980,0x15800,0x15390,0x17648,0x16710,0x16590,0x16120,0x17650,0x174a0,0x17320,0x16eb0,0x17658,0x18230,0x180b0,0x17c40
.long 0x176a0,0x18fc0,0x18e40,0x189d0,0x176a8,0x19d50,0x19bd0,0x19760,0x176b0,0x1aae0,0x1a960,0x1a4f0,0x176b8,0x1b870,0x1b6f0,0x1b280
.long 0x17100,0x17500,0x0,0x0,0x17690,0x17a90,0x0,0x0,0x17c20,0x18020,0x0,0x0,0x181b0,0x185b0,0x0,0x0
.long 0x18740,0x18b40,0x0,0x0,0x18cd0,0x190d0,0x0,0x0,0x19260,0x19660,0x0,0x0,0x197f0,0x19bf0,0x0,0x0
.long 0x19d80,0x1a180,0x0,0x0,0x1a310,0x1a710,0x0,0x0,0x1a8a0,0x1aca0,0x0,0x0,0x1ae30,0x1b230,0x0,0x0
.long 0x1b3c0,0x1b7c0,0x0,0x0,0x1b950,0x1bd50,0x0,0x0,0x1bee0,0x1c2e0,0x0,0x0,0x1c470,0x1c870,0x0,0x0
.long 0x17120,0x17508,0x0,0x0,0x176b0,0x17a98,0x0,0x0,0x17c40,0x18028,0x0,0x0,0x181d0,0x185b8,0x0,0x0
.long 0x18760,0x18b48,0x0,0x0,0x18cf0,0x190d8,0x0,0x0,0x19280,0x19668,0x0,0x0,0x19810,0x19bf8,0x0,0x0
.long 0x19da0,0x1a188,0x0,0x0,0x1a330,0x1a718,0x0,0x0,0x1a8c0,0x1aca8,0x0,0x0,0x1ae50,0x1b238,0x0,0x0
.long 0x1b3e0,0x1b7c8,0x0,0x0,0x1b970,0x1bd58,0x0,0x0,0x1bf00,0x1c2e8,0x0,0x0,0x1c490,0x1c878,0x0,0x0
.long 0x17140,0x17510,0x0,0x0,0x176d0,0x17aa0,0x0,0x0,0x17c60,0x18030,0x0,0x0,0x181f0,0x185c0,0x0,0x0
.long 0x18780,0x18b50,0x0,0x0,0x18d10,0x190e0,0x0,0x0,0x192a0,0x19670,0x0,0x0,0x19830,0x19c00,0x0,0x0
.long 0x19dc0,0x1a190,0x0,0x0,0x1a350,0x1a720,0x0,0x0,0x1a8e0,0x1acb0,0x0,0x0,0x1ae70,0x1b240,0x0,0x0
.long 0x1b400,0x1b7d0,0x0,0x0,0x1b990,0x1bd60,0x0,0x0,0x1bf20,0x1c2f0,0x0,0x0,0x1c4b0,0x1c880,0x0,0x0
.long 0x17160,0x17518,0x0,0x0,0x176f0,0x17aa8,0x0,0x0,0x17c80,0x18038,0x0,0x0,0x18210,0x185c8,0x0,0x0
.long 0x187a0,0x18b58,0x0,0x0,0x18d30,0x190e8,0x0,0x0,0x192c0,0x19678,0x0,0x0,0x19850,0x19c08,0x0,0x0
.long 0x19de0,0x1a198,0x0,0x0,0x1a370,0x1a728,0x0,0x0,0x1a900,0x1acb8,0x0,0x0,0x1ae90,0x1b248,0x0,0x0
.long 0x1b420,0x1b7d8,0x0,0x0,0x1b9b0,0x1bd68,0x0,0x0,0x1bf40,0x1c2f8,0x0,0x0,0x1c4d0,0x1c888,0x0,0x0
.long 0x26100,0x26160,0x26280,0x0,0x26102,0x26162,0x26282,0x0,0x26104,0x26164,0x26284,0x0,0x26106,0x26166,0x26286,0x0
.long 0x26108,0x26168,0x26288,0x0,0x2610a,0x2616a,0x2628a,0x0,0x2610c,0x2616c,0x2628c,0x0,0x2610e,0x2616e,0x2628e,0x0
.long 0x26110,0x26170,0x26290,0x0,0x26112,0x26172,0x26292,0x0,0x26114,0x26174,0x26294,0x0,0x26116,0x26176,0x26296,0x0
.long 0x26118,0x26178,0x26298,0x0,0x2611a,0x2617a,0x2629a,0x0,0x2611c,0x2617c,0x2629c,0x0,0x2611e,0x2617e,0x2629e,0x0
.long 0x26340,0x262e0,0x26280,0x0,0x26342,0x262e2,0x26282,0x0,0x26344,0x262e4,0x26284,0x0,0x26346,0x262e6,0x26286,0x0
.long 0x26348,0x262e8,0x26288,0x0,0x2634a,0x262ea,0x2628a,0x0,0x2634c,0x262ec,0x2628c,0x0,0x2634e,0x262ee,0x2628e,0x0
.long 0x26350,0x262f0,0x26290,0x0,0x26352,0x262f2,0x26292,0x0,0x26354,0x262f4,0x26294,0x0,0x26356,0x262f6,0x26296,0x0
.long 0x26358,0x262f8,0x26298,0x0,0x2635a,0x262fa,0x2629a,0x0,0x2635c,0x262fc,0x2629c,0x0,0x2635e,0x262fe,0x2629e,0x0
.long 0x26100,0x26160,0x26280,0x0,0x26102,0x26162,0x26282,0x0,0x26104,0x26164,0x26284,0x0,0x26106,0x26166,0x26286,0x0
.long 0x26108,0x26168,0x26288,0x0,0x2610a,0x2616a,0x2628a,0x0,0x2610c,0x2616c,0x2628c,0x0,0x2610e,0x2616e,0x2628e,0x0
.long 0x26110,0x26170,0x26290,0x0,0x26112,0x26172,0x26292,0x0,0x26114,0x26174,0x26294,0x0,0x26116,0x26176,0x26296,0x0
.long 0x26118,0x26178,0x26298,0x0,0x2611a,0x2617a,0x2629a,0x0,0x2611c,0x2617c,0x2629c,0x0,0x2611e,0x2617e,0x2629e,0x0
.long 0x26340,0x262e0,0x26280,0x0,0x26342,0x262e2,0x26282,0x0,0x26344,0x262e4,0x26284,0x0,0x26346,0x262e6,0x26286,0x0
.long 0x26348,0x262e8,0x26288,0x0,0x2634a,0x262ea,0x2628a,0x0,0x2634c,0x262ec,0x2628c,0x0,0x2634e,0x262ee,0x2628e,0x0
.long 0x26350,0x262f0,0x26290,0x0,0x26352,0x262f2,0x26292,0x0,0x26354,0x262f4,0x26294,0x0,0x26356,0x262f6,0x26296,0x0
.long 0x26358,0x262f8,0x26298,0x0,0x2635a,0x262fa,0x2629a,0x0,0x2635c,0x262fc,0x2629c,0x0,0x2635e,0x262fe,0x2629e,0x0
.long 0xffffffff,0x0,0xffff,0x0,0xffffffff,0x0,0xffff,0x0,0xffffffff,0x0,0xffff,0x0,0xffffffff,0x0,0xffff,0x0
.long 0x0,0xffffffff,0xffff,0x0,0x0,0xffffffff,0xffff,0x0,0x0,0xffffffff,0xffff,0x0,0x0,0xffffffff,0xffff,0x0
.long 0x0,0x0,0xffff,0x0,0x0,0x0,0xffff,0x0,0x0,0x0,0xffff,0x0,0x0,0x0,0xffff,0x0
.long 0x0,0x0,0xffff,0x0,0x0,0x0,0xffff,0x0,0x0,0x0,0xffff,0x0,0x0,0x0,0xffff,0x0
.long 0xffffffff,0x0,0x0,0x3f80,0xffffffff,0x0,0x0,0x3f80,0xffffffff,0x0,0x0,0x3f80,0xffffffff,0x0,0x0,0x3f80
.long 0x0,0xffffffff,0x0,0x3f80,0x0,0xffffffff,0x0,0x3f80,0x0,0xffffffff,0x0,0x3f80,0x0,0xffffffff,0x0,0x3f80
.long 0x0,0x0,0x0,0x3f80,0x0,0x0,0x0,0x3f80,0x0,0x0,0x0,0x3f80,0x0,0x0,0x0,0x3f80
.long 0x0,0x0,0x0,0x3f80,0x0,0x0,0x0,0x3f80,0x0,0x0,0x0,0x3f80,0x0,0x0,0x0,0x3f80
.long 0x0,0x0,0xffff,0x0,0x0,0x0,0xffff,0x0,0x0,0x0,0xffff,0x0,0x0,0x0,0xffff,0x0
.long 0x0,0x0,0xffff,0x0,0x0,0x0,0xffff,0x0,0x0,0x0,0xffff,0x0,0x0,0x0,0xffff,0x0
.long 0xffffffff,0x0,0xffff,0x0,0xffffffff,0x0,0xffff,0x0,0xffffffff,0x0,0xffff,0x0,0xffffffff,0x0,0xffff,0x0
.long 0x0,0xffffffff,0xffff,0x0,0x0,0xffffffff,0xffff,0x0,0x0,0xffffffff,0xffff,0x0,0x0,0xffffffff,0xffff,0x0
.long 0x0,0x0,0x0,0x3f80,0x0,0x0,0x0,0x3f80,0x0,0x0,0x0,0x3f80,0x0,0x0,0x0,0x3f80
.long 0x0,0x0,0x0,0x3f80,0x0,0x0,0x0,0x3f80,0x0,0x0,0x0,0x3f80,0x0,0x0,0x0,0x3f80
.long 0xffffffff,0x0,0x0,0x3f80,0xffffffff,0x0,0x0,0x3f80,0xffffffff,0x0,0x0,0x3f80,0xffffffff,0x0,0x0,0x3f80
.long 0x0,0xffffffff,0x0,0x3f80,0x0,0xffffffff,0x0,0x3f80,0x0,0xffffffff,0x0,0x3f80,0x0,0xffffffff,0x0,0x3f80
.long 0xffff,0x0,0x0,0x0,0xffff0000,0x0,0x0,0x0,0x0,0xffff,0x0,0x0,0x0,0xffff0000,0x0,0x0
.long 0x0,0x0,0xffff,0x0,0x0,0x0,0xffff0000,0x0,0x0,0x0,0x0,0xffff,0x0,0x0,0x0,0xffff0000
.long 0x0,0x0,0x0,0x0,0x0,0x0,0x0,0x0,0x0,0x0,0x0,0x0,0x0,0x0,0x0,0x0
.long 0x0,0x0,0x0,0x0,0x0,0x0,0x0,0x0,0x0,0x0,0x0,0x0,0x0,0x0,0x0,0x0
.long 0xffff,0x0,0x0,0x0,0xffff0000,0x0,0x0,0x0,0x0,0xffff,0x0,0x0,0x0,0xffff0000,0x0,0x0
.long 0x0,0x0,0xffff,0x0,0x0,0x0,0xffff0000,0x0,0x0,0x0,0x0,0xffff,0x0,0x0,0x0,0xffff0000
.long 0x0,0x0,0x0,0x0,0x0,0x0,0x0,0x0,0x0,0x0,0x0,0x0,0x0,0x0,0x0,0x0
.long 0x0,0x0,0x0,0x0,0x0,0x0,0x0,0x0,0x0,0x0,0x0,0x0,0x0,0x0,0x0,0x0
.long 0x0,0x0,0x0,0x0,0x0,0x0,0x0,0x0,0x0,0x0,0x0,0x0,0x0,0x0,0x0,0x0
.long 0x0,0x0,0x0,0x0,0x0,0x0,0x0,0x0,0x0,0x0,0x0,0x0,0x0,0x0,0x0,0x0
.long 0xffff,0x0,0x0,0x0,0xffff0000,0x0,0x0,0x0,0x0,0xffff,0x0,0x0,0x0,0xffff0000,0x0,0x0
.long 0x0,0x0,0xffff,0x0,0x0,0x0,0xffff0000,0x0,0x0,0x0,0x0,0xffff,0x0,0x0,0x0,0xffff0000
.long 0x0,0x0,0x0,0x0,0x0,0x0,0x0,0x0,0x0,0x0,0x0,0x0,0x0,0x0,0x0,0x0
.long 0x0,0x0,0x0,0x0,0x0,0x0,0x0,0x0,0x0,0x0,0x0,0x0,0x0,0x0,0x0,0x0
.long 0xffff,0x0,0x0,0x0,0xffff0000,0x0,0x0,0x0,0x0,0xffff,0x0,0x0,0x0,0xffff0000,0x0,0x0
.long 0x0,0x0,0xffff,0x0,0x0,0x0,0xffff0000,0x0,0x0,0x0,0x0,0xffff,0x0,0x0,0x0,0xffff0000
.long 0x21a30,0x21d30,0x22030,0x22330,0xb1d30,0x81730,0x81a30,0x81d30,0x111730,0x111a30,0xe1430,0x141130,0x0,0x0,0x0,0x0
.long 0x51290,0x51590,0x51890,0x51b90,0xe1590,0xb0f90,0xb1290,0xb1590,0x140f90,0x141290,0x110c90,0x110f90,0x0,0x0,0x0,0x0
.long 0x20f70,0x21270,0x21570,0x81270,0xb1270,0x80c70,0x80f70,0xe0c70,0x110c70,0x110f70,0xe0970,0x140670,0x0,0x0,0x0,0x0
.long 0x80dd0,0x507d0,0x50ad0,0x50dd0,0xe07d0,0xe0ad0,0xb04d0,0xb07d0,0x1401d0,0x1404d0,0x1407d0,0x1101d0,0x0,0x0,0x0,0x0
.long 0x0,0x0,0x0,0x0,0x0,0x0,0x0,0x0,0x0,0x0,0x0,0x0,0x0,0x0,0x0,0x0
.long 0x0,0x0,0x0,0x0,0x0,0x0,0x0,0x0,0x0,0x0,0x0,0x0,0x0,0x0,0x0,0x0
.long 0x0,0x0,0x0,0x0,0x0,0x0,0x0,0x0,0x0,0x0,0x0,0x0,0x0,0x0,0x0,0x0
.long 0x0,0x0,0x0,0x0,0x0,0x0,0x0,0x0,0x0,0x0,0x0,0x0,0x0,0x0,0x0,0x0
.long 0x0,0x0,0x0,0x0,0x0,0x0,0x0,0x0,0x0,0x0,0x0,0x0,0x0,0x0,0x0,0x0
.long 0x0,0x0,0x0,0x0,0x0,0x0,0x0,0x0,0x0,0x0,0x0,0x0,0x0,0x0,0x0,0x0
.long 0x0,0x0,0x0,0x0,0x0,0x0,0x0,0x0,0x0,0x0,0x0,0x0,0x0,0x0,0x0,0x0
.long 0x0,0x0,0x0,0x0,0x0,0x0,0x0,0x0,0x0,0x0,0x0,0x0,0x0,0x0,0x0,0x0
.long 0x0,0x0,0x0,0x0,0x0,0x0,0x0,0x0,0x0,0x0,0x0,0x0,0x0,0x0,0x0,0x0
.long 0x0,0x0,0x0,0x0,0x0,0x0,0x0,0x0,0x0,0x0,0x0,0x0,0x0,0x0,0x0,0x0
.long 0x0,0x0,0x0,0x0,0x0,0x0,0x0,0x0,0x0,0x0,0x0,0x0,0x0,0x0,0x0,0x0
.long 0x0,0x0,0x0,0x0,0x0,0x0,0x0,0x0,0x0,0x0,0x0,0x0,0x0,0x0,0x0,0x0
.size L_tab, 12288
.section .rodata,"a"
.p2align 6
.amdhsa_kernel standalone__window_attn_davit__vision_kernel
  .amdhsa_next_free_vgpr 512
  .amdhsa_next_free_sgpr 102
  .amdhsa_accum_offset 256
  .amdhsa_group_segment_fixed_size 0
  .amdhsa_kernarg_size 56
  .amdhsa_user_sgpr_count 2
  .amdhsa_user_sgpr_kernarg_segment_ptr 1
  .amdhsa_system_sgpr_workgroup_id_x 1
.end_amdhsa_kernel
```

```asm
; @launch grid=(256,1,1) block=(256,1,1) lds=163840
.amdgcn_target "amdgcn-amd-amdhsa--gfx950"
.text
.globl standalone__window_attn_davit__vision_kernel
.p2align 8
.type standalone__window_attn_davit__vision_kernel,@function
standalone__window_attn_davit__vision_kernel:
s_cmp_ge_u32 s2, 256
s_cbranch_scc1 L_end
v_lshrrev_b32 v1, 6, v0
s_mov_b32 s53, s2
s_mov_b32 s47, 0
v_readfirstlane_b32 s32, v1
s_nop 3
L_start:

s_load_dwordx8 s[56:63], s[0:1], 0
s_load_dwordx2 s[64:65], s[0:1], 32
s_load_dwordx2 s[66:67], s[0:1], 48
s_load_dwordx2 s[100:101], s[0:1], 40
s_getpc_b64 s[68:69]
L_pc:
v_mbcnt_lo_u32_b32 v0, -1, 0
v_mbcnt_hi_u32_b32 v0, -1, v0
s_add_u32 s70, s68, L_tab-L_pc
s_addc_u32 s71, s69, 0
s_add_u32 s98, s68, F_tail-L_pc
s_addc_u32 s99, s69, 0
s_and_b32 s41, s53, 8
s_lshl_b32 s41, s41, 11
s_add_u32 s98, s98, s41
s_addc_u32 s99, s99, 0
s_lshl_b32 s45, s32, 10
v_lshl_add_u32 v1, v0, 4, s45
s_add_u32 m0, s45, 143616
s_nop 0
global_load_lds_dwordx4 v1, s[70:71]
v_add_u32 v1, 4096, v1
s_add_u32 m0, s45, 147712
s_nop 0
global_load_lds_dwordx4 v1, s[70:71]
v_add_u32 v1, 4096, v1
s_add_u32 m0, s45, 151808
s_nop 0
global_load_lds_dwordx4 v1, s[70:71]
s_lshr_b32 s42, s53, 3
s_and_b32 s41, s42, 1
s_lshl_b32 s41, s41, 2
s_add_u32 s41, s41, s32
s_lshl_b32 s41, s41, 13
v_lshlrev_b32 v2, 7, v0
v_add_u32 v3, s41, v2
s_cmp_lt_u32 s42, 4
s_cbranch_scc0 L_nopf
global_load_dword v255, v3, s[68:69]
L_nopf:
s_and_b32 s41, s53, 7
s_mul_i32 s43, s41, 640
s_mov_b32 s34, 5329
s_add_u32 s33, s43, s42
s_mov_b32 s35, s33
s_mul_i32 s54, s32, 96
s_mul_i32 s55, s32, 3072
s_mul_hi_u32 s41, s33, 58835169
s_mul_i32 s28, s41, 73
s_sub_u32 s28, s33, s28
s_mul_i32 s29, s41, 1373568
s_mul_i32 s41, s28, 2688
s_add_u32 s29, s29, s41
s_lshl_b32 s41, s32, 6
v_add_u32 v4, s41, v0
v_mul_u32_u24 v5, 2622, v4
v_lshrrev_b32 v5, 16, v5
v_mul_u32_u24 v6, 25, v5
v_sub_u32 v6, v4, v6
v_mul_u32_u24 v7, 384, v5
v_lshl_add_u32 v7, v6, 4, v7
v_cmp_eq_u32 vcc, 0, v5
v_or_b32 v10, 134217728, v7
s_nop 0
v_cndmask_b32 v7, v7, v10, vcc
v_cmp_eq_u32 vcc, 8, v5
v_or_b32 v10, 536870912, v7
s_nop 0
v_cndmask_b32 v7, v7, v10, vcc
v_cmp_lt_u32 vcc, 8, v5
v_or_b32 v10, 268435456, v7
s_nop 0
v_cndmask_b32 v7, v7, v10, vcc
v_cmp_eq_u32 vcc, 24, v6
v_or_b32 v10, 268435456, v7
s_nop 0
v_cndmask_b32 v7, v7, v10, vcc
v_mov_b32 v208, v7
v_add_u32 v4, 0, v0
v_mul_u32_u24 v5, 171, v4
v_lshrrev_b32 v5, 10, v5
v_mul_u32_u24 v6, 6, v5
v_sub_u32 v6, v4, v6
v_lshlrev_b32 v6, 4, v6
v_mul_u32_u24 v8, 1152, v5
v_add_u32 v72, v8, v6
v_mul_u32_u24 v8, 384, v5
v_add_u32 v136, v8, v6
s_lshl_b32 s96, s42, 13
s_mul_hi_u32 s41, s35, 58835169
s_mul_i32 s42, s41, 73
s_sub_u32 s42, s35, s42
s_mul_i32 s43, s41, 1373568
s_mul_i32 s51, s42, 2688
s_add_u32 s50, s43, s51
s_add_u32 s35, s35, 32
s_min_u32 s41, s41, 1
s_sub_u32 s41, 1, s41
s_lshl_b32 s41, s41, 30
s_add_u32 s52, s50, s41
s_min_u32 s43, s42, 1
s_lshl_b32 s43, s43, 27
s_sub_u32 s43, 536870911, s43
s_add_u32 s51, s42, 56
s_and_b32 s51, s51, 128
s_lshl_b32 s51, s51, 22
s_or_b32 s44, s43, s51
s_waitcnt lgkmcnt(0)
s_mov_b32 s12, s60
s_mov_b32 s13, s61
s_mov_b32 s14, 221184
s_mov_b32 s15, 131072
s_mov_b32 s16, s62
s_mov_b32 s17, s63
s_mov_b32 s18, 73728
s_mov_b32 s19, 131072
s_cmp_eq_u32 s32, 0
s_cbranch_scc0 L_nopf2
buffer_load_dword v255, v2, s[12:15], s96 offen
L_nopf2:
s_and_b32 s96, s96, 131071
s_cmp_eq_u32 s32, 1
s_cbranch_scc0 L_nopf3
buffer_load_dword v255, v2, s[16:19], s96 offen
L_nopf3:
s_sub_u32 s4, s56, 196608
s_subb_u32 s5, s57, 0
s_mov_b32 s6, 100467072
s_mov_b32 s7, 131072
s_mov_b32 s20, s58
s_mov_b32 s21, s59
s_mov_b32 s22, 3456
s_mov_b32 s23, 131072
s_mul_i32 s96, s32, 864
s_mov_b32 exec_hi, 4194303
s_add_u32 m0, s96, 155904
s_nop 0
buffer_load_dwordx4 v136, s[20:23], s54 offen lds
s_mov_b64 exec, -1
s_mov_b32 s36, s50
v_and_b32 v216, s44, v208
s_add_u32 m0, s45, 0
s_nop 0
buffer_load_dwordx4 v216, s[4:7], s52 offen nt lds
s_add_u32 m0, s45, 4112
s_add_u32 s40, s36, 196224
buffer_load_dwordx4 v216, s[4:7], s40 offen nt lds
s_add_u32 m0, s45, 8224
s_add_u32 s40, s36, 392448
buffer_load_dwordx4 v216, s[4:7], s40 offen nt lds
s_add_u32 m0, s45, 12336
s_add_u32 s40, s36, 588672
buffer_load_dwordx4 v216, s[4:7], s40 offen nt lds
s_add_u32 m0, s45, 16448
s_add_u32 s40, s36, 784896
buffer_load_dwordx4 v216, s[4:7], s40 offen nt lds
s_add_u32 m0, s45, 20560
s_add_u32 s40, s36, 981120
buffer_load_dwordx4 v216, s[4:7], s40 offen nt lds
s_add_u32 m0, s45, 24672
s_add_u32 s40, s36, 1177344
buffer_load_dwordx4 v216, s[4:7], s40 offen nt lds
s_add_u32 m0, s45, 28784
s_add_u32 s40, s36, 1373568
buffer_load_dwordx4 v216, s[4:7], s40 offen nt lds
s_add_u32 m0, s45, 32896
s_add_u32 s40, s36, 1569792
buffer_load_dwordx4 v216, s[4:7], s40 offen nt lds
s_mul_i32 s41, s32, 54
v_add_u32 v4, s41, v0
v_mul_u32_u24 v5, 911, v4
v_lshrrev_b32 v5, 16, v5
v_mul_u32_u24 v6, 72, v5
v_sub_u32 v6, v4, v6
s_mov_b32 s43, 196224
v_mul_lo_u32 v5, v5, s43
v_lshl_add_u32 v82, v6, 4, v5
s_add_u32 s20, s29, 785664
s_add_u32 m0, s96, 57600
s_mov_b32 exec_hi, 4194303
buffer_load_dwordx4 v82, s[4:7], s20 offen nt lds
s_mov_b32 exec_hi, -1
s_add_u32 s28, s28, 32
s_cmp_ge_u32 s28, 73
s_cselect_b32 s21, 73, 0
s_cselect_b32 s22, 1177344, 0
s_sub_u32 s28, s28, s21
s_add_u32 s20, s20, s22
s_add_u32 s20, s20, 86016
s_add_u32 m0, s96, 61072
s_mov_b32 exec_hi, 4194303
buffer_load_dwordx4 v82, s[4:7], s20 offen nt lds
s_mov_b32 exec_hi, -1
s_add_u32 s28, s28, 32
s_cmp_ge_u32 s28, 73
s_cselect_b32 s21, 73, 0
s_cselect_b32 s22, 1177344, 0
s_sub_u32 s28, s28, s21
s_add_u32 s20, s20, s22
s_add_u32 s20, s20, 86016
s_add_u32 m0, s96, 64544
s_mov_b32 exec_hi, 4194303
buffer_load_dwordx4 v82, s[4:7], s20 offen nt lds
s_mov_b32 exec_hi, -1
s_add_u32 s28, s28, 32
s_cmp_ge_u32 s28, 73
s_cselect_b32 s21, 73, 0
s_cselect_b32 s22, 1177344, 0
s_sub_u32 s28, s28, s21
s_add_u32 s20, s20, s22
s_add_u32 s20, s20, 86016
s_add_u32 m0, s96, 68016
s_mov_b32 exec_hi, 4194303
buffer_load_dwordx4 v82, s[4:7], s20 offen nt lds
s_mov_b32 exec_hi, -1
v_add_u32 v4, 64, v0
v_mul_u32_u24 v5, 171, v4
v_lshrrev_b32 v5, 10, v5
v_mul_u32_u24 v6, 6, v5
v_sub_u32 v6, v4, v6
v_lshlrev_b32 v6, 4, v6
v_mul_u32_u24 v8, 1152, v5
v_add_u32 v73, v8, v6
v_mul_u32_u24 v8, 384, v5
v_add_u32 v137, v8, v6
s_sub_u32 s8, s64, 262144
s_subb_u32 s9, s65, 0
s_mov_b32 s10, 100532608
s_mov_b32 s11, 131072
s_mov_b32 s24, s66
s_mov_b32 s25, s67
s_mov_b32 s26, 6356992
s_mov_b32 s27, 131072
s_lshl_b32 s41, s32, 6
s_add_u32 s58, s70, s41
s_addc_u32 s59, s71, 0
s_load_dwordx8 s[60:67], s[58:59], 11264
s_load_dwordx4 s[68:71], s[58:59], 11296
s_mov_b32 s48, 1001040555
s_mov_b32 s73, 1020061065
s_mov_b32 s49, 944335852
s_mov_b32 s3, 1074544643
v_lshlrev_b32 v11, 4, v0
v_add_u32 v11, 143616, v11
s_waitcnt vmcnt(13) lgkmcnt(0)
s_mul_i32 s58, s53, 24576
s_mul_i32 s41, s32, 6144
s_add_u32 s58, s58, s41
s_add_u32 s59, s58, 3072
s_barrier
ds_read_b128 v[194:197], v11
ds_read_b128 v[198:201], v11 offset:1024
ds_read_b128 v[202:205], v11 offset:2048
ds_read_b128 v[206:209], v11 offset:3072
ds_read_b128 v[210:213], v11 offset:4096
ds_read_b128 v[214:217], v11 offset:5120
ds_read_b128 v[110:113], v11 offset:6144
ds_read_b128 v[78:81], v11 offset:7168
ds_read_b128 v[36:39], v11 offset:8192
ds_read_b128 v[40:43], v11 offset:9216
s_waitcnt lgkmcnt(6)
ds_read_b128 v[44:47], v11 offset:10240
v_add_u32 v219, s45, v208
v_mov_b32 v208, v7
v_add_u32 v4, 128, v0
v_mul_u32_u24 v5, 171, v4
v_lshrrev_b32 v5, 10, v5
v_mul_u32_u24 v6, 6, v5
v_sub_u32 v6, v4, v6
v_lshlrev_b32 v6, 4, v6
v_mul_u32_u24 v8, 1152, v5
v_add_u32 v74, v8, v6
v_mul_u32_u24 v8, 384, v5
v_add_u32 v83, v8, v6
s_waitcnt lgkmcnt(2)
v_add_u32 v36, s96, v36
v_add_u32 v37, s96, v37
v_add_u32 v38, s96, v38
ds_read_u16 v48, v36
ds_read_u16 v49, v36 offset:192
ds_read_u16 v50, v37
ds_read_u16 v51, v37 offset:192
ds_read_u16 v52, v38
ds_read_u16 v53, v36 offset:32
ds_read_u16 v54, v36 offset:224
ds_read_u16 v55, v37 offset:32
ds_read_u16 v56, v37 offset:224
ds_read_u16 v57, v38 offset:32
ds_read_u16 v58, v36 offset:64
ds_read_u16 v59, v36 offset:256
ds_read_u16 v60, v37 offset:64
ds_read_u16 v61, v37 offset:256
s_waitcnt lgkmcnt(9)
ds_read_u16 v62, v38 offset:64
v_add_u32 v194, s54, v194
v_add_u32 v195, s54, v195
v_add_u32 v196, s54, v196
v_add_u32 v197, s54, v197
v_add_u32 v198, s54, v198
v_add_u32 v199, s54, v199
v_add_u32 v200, s54, v200
v_add_u32 v201, s54, v201
v_add_u32 v202, s54, v202
v_add_u32 v203, s54, v203
v_add_u32 v205, s54, v205
v_add_u32 v111, s54, v111
v_add_u32 v112, s54, v112
v_add_u32 v113, s54, v113
v_add_u32 v211, s45, v211
v_add_u32 v110, s55, v110
v_subrev_u32 v128, 94464, v110
v_subrev_u32 v129, 24576, v110
v_add_u32 v121, s54, v79
s_mul_i32 s41, s32, 1568
v_add_u32 v204, s41, v204
s_lshr_b32 s41, s32, 1
s_lshl_b32 s41, s41, 10
s_and_b32 s42, s32, 1
s_lshl_b32 s42, s42, 3
s_add_u32 s41, s41, s42
v_add_u32 v212, s41, v212
s_lshl_b32 s41, s32, 2
v_add_u32 v209, s41, v209
s_lshl_b32 s41, s32, 7
v_add_u32 v215, s41, v215
v_add_u32 v214, s41, v214
v_add_u32 v120, s41, v78
v_add_u32 v132, s41, v80
s_mul_i32 s41, s32, 4752
v_add_u32 v217, s41, v217
v_and_or_b32 v52, v52, v42, v43
v_lshl_or_b32 v52, v52, 16, v52
v_and_b32 v138, v52, v44
v_and_b32 v139, v52, v45
v_and_b32 v140, v52, v46
v_and_b32 v141, v52, v47
v_and_b32 v142, v48, v40
v_and_b32 v143, v48, v41
v_and_b32 v144, v49, v40
v_and_b32 v145, v49, v41
v_and_b32 v146, v50, v40
v_and_b32 v147, v50, v41
v_and_b32 v148, v51, v40
v_and_b32 v149, v51, v41
s_waitcnt lgkmcnt(0)
v_and_or_b32 v57, v57, v42, v43
v_lshl_or_b32 v57, v57, 16, v57
v_and_b32 v150, v57, v44
v_and_b32 v151, v57, v45
v_and_b32 v152, v57, v46
v_and_b32 v153, v57, v47
v_and_b32 v154, v53, v40
v_and_b32 v155, v53, v41
v_and_b32 v156, v54, v40
v_and_b32 v157, v54, v41
v_and_b32 v158, v55, v40
v_and_b32 v159, v55, v41
v_and_b32 v160, v56, v40
v_and_b32 v161, v56, v41
v_and_or_b32 v62, v62, v42, v43
v_lshl_or_b32 v62, v62, 16, v62
v_and_b32 v162, v62, v44
v_and_b32 v163, v62, v45
v_and_b32 v164, v62, v46
v_and_b32 v165, v62, v47
v_and_b32 v166, v58, v40
v_and_b32 v167, v58, v41
v_and_b32 v168, v59, v40
v_and_b32 v169, v59, v41
v_and_b32 v170, v60, v40
v_and_b32 v171, v60, v41
v_and_b32 v172, v61, v40
v_and_b32 v173, v61, v41
v_mov_b32 v191, 1065369472
v_cmp_eq_u32 vcc, 0, v213
s_nop 1
v_cndmask_b32 v190, 0, v191, vcc
v_mov_b32 v191, v190
v_mov_b32 v192, v190
v_mov_b32 v193, v190
v_mov_b32 v218, 0
s_mov_b32 s30, 16712191
s_mov_b32 s31, 4278255360
s_mov_b32 s56, 983055
s_mov_b32 s57, 983055
s_waitcnt vmcnt(4) lgkmcnt(0)
s_barrier

s_cmp_lg_u32 s47, 0
s_cbranch_scc1 L_safe
.p2align 3
s_add_u32 s28, s28, 32
s_cmp_ge_u32 s28, 73
s_cselect_b32 s21, 73, 0
s_cselect_b32 s22, 1177344, 0
s_sub_u32 s28, s28, s21
s_add_u32 s20, s20, s22
s_add_u32 s20, s20, 86016
s_add_u32 m0, s96, 71488
s_mov_b32 exec_hi, 4194303
buffer_load_dwordx4 v82, s[4:7], s20 offen nt lds
s_mov_b32 exec_hi, -1
s_add_u32 s28, s28, 32
s_cmp_ge_u32 s28, 73
s_cselect_b32 s21, 73, 0
s_cselect_b32 s22, 1177344, 0
s_sub_u32 s28, s28, s21
s_add_u32 s20, s20, s22
s_add_u32 s20, s20, 86016
s_add_u32 m0, s96, 74960
s_mov_b32 exec_hi, 4194303
buffer_load_dwordx4 v82, s[4:7], s20 offen nt lds
s_mov_b32 exec_hi, -1
s_mul_hi_u32 s41, s35, 58835169
s_mul_i32 s42, s41, 73
s_sub_u32 s42, s35, s42
s_mul_i32 s43, s41, 1373568
s_mul_i32 s51, s42, 2688
s_add_u32 s50, s43, s51
s_add_u32 s35, s35, 32
s_min_u32 s41, s41, 1
s_sub_u32 s41, 1, s41
s_lshl_b32 s41, s41, 30
s_add_u32 s52, s50, s41
s_min_u32 s43, s42, 1
s_lshl_b32 s43, s43, 27
s_sub_u32 s43, 536870911, s43
s_add_u32 s51, s42, 56
s_and_b32 s51, s51, 128
s_lshl_b32 s51, s51, 22
s_or_b32 s44, s43, s51
s_add_u32 s28, s28, 32
s_cmp_ge_u32 s28, 73
s_cselect_b32 s21, 73, 0
s_cselect_b32 s22, 1177344, 0
s_sub_u32 s28, s28, s21
s_add_u32 s20, s20, s22
s_add_u32 s20, s20, 86016
s_add_u32 m0, s96, 78432
s_mov_b32 exec_hi, 4194303
buffer_load_dwordx4 v82, s[4:7], s20 offen nt lds
s_mov_b32 exec_hi, -1
v_and_b32_e64 v216, s44, v208
s_mov_b32 s37, s50
s_mul_hi_u32 s41, s35, 58835169
s_add_u32 s28, s28, 32
s_cmp_ge_u32 s28, 73
s_cselect_b32 s21, 73, 0
s_cselect_b32 s22, 1177344, 0
s_sub_u32 s28, s28, s21
s_add_u32 s20, s20, s22
s_add_u32 s20, s20, 86016
s_add_u32 m0, s96, 81904
s_mov_b32 exec_hi, 4194303
buffer_load_dwordx4 v82, s[4:7], s20 offen nt lds
s_mov_b32 exec_hi, -1
s_add_u32 s28, s28, 32
s_cmp_ge_u32 s28, 73
s_cselect_b32 s21, 73, 0
s_cselect_b32 s22, 1177344, 0
s_sub_u32 s28, s28, s21
s_add_u32 s20, s20, s22
s_add_u32 s20, s20, 86016
s_add_u32 m0, s96, 85376
s_mov_b32 exec_hi, 4194303
buffer_load_dwordx4 v82, s[4:7], s20 offen nt lds
s_mov_b32 exec_hi, -1
s_mul_i32 s42, s41, 73
s_sub_u32 s42, s35, s42
s_mul_i32 s43, s41, 1373568
s_add_u32 s28, s28, 32
s_cmp_ge_u32 s28, 73
s_cselect_b32 s21, 73, 0
s_cselect_b32 s22, 1177344, 0
s_sub_u32 s28, s28, s21
s_add_u32 s20, s20, s22
s_add_u32 s20, s20, 86016
s_add_u32 m0, s96, 88848
s_mov_b32 exec_hi, 4194303
buffer_load_dwordx4 v82, s[4:7], s20 offen nt lds
s_mov_b32 exec_hi, -1
s_mul_i32 s51, s42, 2688
s_add_u32 s50, s43, s51
s_min_u32 s43, s42, 1
s_add_u32 s28, s28, 32
s_cmp_ge_u32 s28, 73
s_cselect_b32 s21, 73, 0
s_cselect_b32 s22, 1177344, 0
s_sub_u32 s28, s28, s21
s_add_u32 s20, s20, s22
s_add_u32 s20, s20, 86016
s_add_u32 m0, s96, 92320
s_mov_b32 exec_hi, 4194303
buffer_load_dwordx4 v82, s[4:7], s20 offen nt lds
s_mov_b32 exec_hi, -1
s_add_u32 s51, s42, 56
s_min_u32 s41, s41, 1
s_lshl_b32 s43, s43, 27
s_add_u32 s28, s28, 32
s_cmp_ge_u32 s28, 73
s_cselect_b32 s21, 73, 0
s_cselect_b32 s22, 1177344, 0
s_sub_u32 s28, s28, s21
s_add_u32 s20, s20, s22
s_add_u32 s20, s20, 86016
s_add_u32 m0, s96, 95792
s_mov_b32 exec_hi, 4194303
buffer_load_dwordx4 v82, s[4:7], s20 offen nt lds
s_mov_b32 exec_hi, -1
s_and_b32 s51, s51, 128
s_sub_u32 s41, 1, s41
s_sub_u32 s43, 536870911, s43
ds_read_b128 v[84:87], v200
s_lshl_b32 s51, s51, 22
s_lshl_b32 s41, s41, 30
s_or_b32 s44, s43, s51
ds_read_b128 v[92:95], v201
s_mov_b32 s38, s36
s_mov_b32 s36, s50
s_add_u32 s35, s35, 32
ds_read_b128 v[100:103], v202
s_mov_b32 s39, s37
s_add_u32 s28, s28, 32
s_cmp_ge_u32 s28, 73
s_cselect_b32 s21, 73, 0
s_cselect_b32 s22, 1177344, 0
s_sub_u32 s28, s28, s21
s_add_u32 s20, s20, s22
s_add_u32 s20, s20, 86016
s_add_u32 m0, s96, 99264
s_mov_b32 exec_hi, 4194303
buffer_load_dwordx4 v82, s[4:7], s20 offen nt lds
s_mov_b32 exec_hi, -1
s_waitcnt lgkmcnt(2)
v_mfma_f32_16x16x32_bf16 v[0:3], v[138:141], v[84:87], 0
s_waitcnt lgkmcnt(1)
ds_read_b128 v[84:87], v194
ds_read_b128 v[88:91], v194 offset:16
v_mfma_f32_16x16x32_bf16 v[12:15], v[138:141], v[92:95], 0
s_waitcnt lgkmcnt(2)
ds_read_b128 v[92:95], v195
ds_read_b128 v[96:99], v195 offset:16
v_mfma_f32_16x16x32_bf16 v[24:27], v[138:141], v[100:103], 0
ds_read_b128 v[100:103], v196
ds_read_b128 v[104:107], v196 offset:16
s_mov_b64 exec, s[30:31]
ds_write_b128 v217, v[138:141]
s_mov_b64 exec, -1
s_waitcnt lgkmcnt(5)
v_smfmac_f32_16x16x64_bf16 v[0:3], v[142:145], v[84:91], v213
ds_read_b128 v[84:87], v197
ds_read_b128 v[88:91], v197 offset:16
s_waitcnt lgkmcnt(5)
v_smfmac_f32_16x16x64_bf16 v[12:15], v[142:145], v[92:99], v213
ds_read_b128 v[92:95], v198
ds_read_b128 v[96:99], v198 offset:16
s_waitcnt lgkmcnt(5)
v_smfmac_f32_16x16x64_bf16 v[24:27], v[142:145], v[100:107], v213
ds_read_b128 v[100:103], v199
ds_read_b128 v[104:107], v199 offset:16
s_mov_b64 exec, s[30:31]
ds_write_b128 v217, v[142:145] offset:528
s_mov_b64 exec, -1
s_add_u32 s28, s28, 32
s_cmp_ge_u32 s28, 73
s_cselect_b32 s21, 73, 0
s_cselect_b32 s22, 1177344, 0
s_sub_u32 s28, s28, s21
s_add_u32 s20, s20, s22
s_add_u32 s20, s20, 86016
s_add_u32 m0, s96, 102736
s_mov_b32 exec_hi, 4194303
buffer_load_dwordx4 v82, s[4:7], s20 offen nt lds
s_mov_b32 exec_hi, -1
s_waitcnt lgkmcnt(5)
v_smfmac_f32_16x16x64_bf16 v[0:3], v[146:149], v[84:91], v213
s_waitcnt lgkmcnt(3)
ds_read_b128 v[84:87], v200 offset:32
ds_read_b128 v[88:91], v194 offset:48
v_smfmac_f32_16x16x64_bf16 v[12:15], v[146:149], v[92:99], v213
s_waitcnt lgkmcnt(3)
ds_read_b128 v[92:95], v201 offset:32
ds_read_b128 v[96:99], v195 offset:48
v_smfmac_f32_16x16x64_bf16 v[24:27], v[146:149], v[100:107], v213
ds_read_b128 v[100:103], v202 offset:32
ds_read_b128 v[104:107], v196 offset:48
v_add_f32 v118, v0, v1
v_mul_f32 v119, v0, v0
v_add_f32 v118, v118, v2
v_fmac_f32 v119, v1, v1
v_add_f32 v118, v118, v3
v_fmac_f32 v119, v2, v2
v_fmac_f32 v119, v3, v3
v_add_f32 v126, v12, v13
v_mul_f32 v127, v12, v12
v_add_f32 v126, v126, v14
v_fmac_f32 v127, v13, v13
v_add_f32 v126, v126, v15
v_fmac_f32_e64 v127, v14, v14
v_fmac_f32 v127, v15, v15
s_waitcnt lgkmcnt(5)
v_mfma_f32_16x16x32_bf16 v[4:7], v[150:153], v[84:87], 0
ds_read_b128 v[84:87], v194 offset:32
v_add_f32 v134, v24, v25
v_mul_f32 v135, v24, v24
v_add_f32_e64 v134, v134, v26
v_fmac_f32 v135, v25, v25
s_waitcnt lgkmcnt(4)
v_mfma_f32_16x16x32_bf16 v[16:19], v[150:153], v[92:95], 0
ds_read_b128 v[92:95], v195 offset:32
v_add_f32 v134, v134, v27
v_fmac_f32 v135, v26, v26
v_fmac_f32 v135, v27, v27
s_waitcnt lgkmcnt(3)
v_mfma_f32_16x16x32_bf16 v[28:31], v[150:153], v[100:103], 0
s_nop 0
ds_read_b128 v[100:103], v196 offset:32
s_mov_b64 exec, s[30:31]
ds_write_b128 v217, v[146:149] offset:1056
s_mov_b64 exec, -1
s_waitcnt lgkmcnt(3)
v_smfmac_f32_16x16x64_bf16 v[4:7], v[154:157], v[84:91], v213
s_add_u32 s28, s28, 32
s_cmp_ge_u32 s28, 73
s_cselect_b32 s21, 73, 0
s_cselect_b32 s22, 1177344, 0
s_sub_u32 s28, s28, s21
s_add_u32 s20, s20, s22
s_add_u32 s20, s20, 86016
s_add_u32 m0, s96, 106208
s_mov_b32 exec_hi, 4194303
buffer_load_dwordx4 v82, s[4:7], s20 offen nt lds
s_mov_b32 exec_hi, -1
s_waitcnt lgkmcnt(2)
v_smfmac_f32_16x16x64_bf16 v[16:19], v[154:157], v[92:99], v213
s_waitcnt lgkmcnt(1)
ds_read_b128 v[84:87], v197 offset:32
ds_read_b128 v[88:91], v197 offset:48
v_smfmac_f32_16x16x64_bf16 v[28:31], v[154:157], v[100:107], v213
ds_read_b128 v[92:95], v198 offset:32
ds_read_b128 v[96:99], v198 offset:48
ds_read_b128 v[100:103], v199 offset:32
ds_read_b128 v[104:107], v199 offset:48
s_mov_b64 exec, s[30:31]
ds_write_b128 v217, v[150:153] offset:1584
s_mov_b64 exec, -1
s_waitcnt lgkmcnt(5)
v_smfmac_f32_16x16x64_bf16 v[4:7], v[158:161], v[84:91], v213
ds_read_b128 v[84:87], v200 offset:64
ds_read_b128 v[88:91], v194 offset:80
s_waitcnt lgkmcnt(5)
v_smfmac_f32_16x16x64_bf16 v[16:19], v[158:161], v[92:99], v213
ds_read_b128 v[92:95], v201 offset:64
ds_read_b128 v[96:99], v195 offset:80
v_add_f32 v118, v118, v4
v_fmac_f32 v119, v4, v4
v_add_f32 v118, v118, v5
v_fmac_f32 v119, v5, v5
v_add_f32_e64 v118, v118, v6
v_fmac_f32 v119, v6, v6
s_waitcnt lgkmcnt(5)
v_smfmac_f32_16x16x64_bf16 v[28:31], v[158:161], v[100:107], v213
ds_read_b128 v[100:103], v202 offset:64
ds_read_b128 v[104:107], v196 offset:80
v_add_f32_e64 v118, v118, v7
s_add_u32 s28, s28, 32
s_cmp_ge_u32 s28, 73
s_cselect_b32 s21, 73, 0
s_cselect_b32 s22, 1177344, 0
s_sub_u32 s28, s28, s21
s_add_u32 s20, s20, s22
s_add_u32 s20, s20, 86016
s_add_u32 m0, s96, 109680
s_mov_b32 exec_hi, 4194303
buffer_load_dwordx4 v82, s[4:7], s20 offen nt lds
s_mov_b32 exec_hi, -1
s_waitcnt lgkmcnt(5)
v_mfma_f32_16x16x32_bf16 v[8:11], v[162:165], v[84:87], 0
s_waitcnt lgkmcnt(3)
ds_read_b128 v[84:87], v194 offset:64
v_fmac_f32_e64 v119, v7, v7
v_mfma_f32_16x16x32_bf16 v[20:23], v[162:165], v[92:95], 0
ds_read_b128 v[92:95], v195 offset:64
v_add_f32 v126, v126, v16
v_fmac_f32 v127, v16, v16
v_add_f32 v126, v126, v17
v_fmac_f32 v127, v17, v17
v_add_f32 v126, v126, v18
s_waitcnt lgkmcnt(3)
v_mfma_f32_16x16x32_bf16 v[32:35], v[162:165], v[100:103], 0
ds_read_b128 v[100:103], v196 offset:64
v_fmac_f32 v127, v18, v18
v_add_f32 v126, v126, v19
v_fmac_f32 v127, v19, v19
v_add_f32 v134, v134, v28
v_fmac_f32 v135, v28, v28
v_add_f32 v134, v134, v29
v_fmac_f32 v135, v29, v29
v_add_f32 v134, v134, v30
v_fmac_f32 v135, v30, v30
v_add_f32 v134, v134, v31
s_waitcnt lgkmcnt(2)
v_smfmac_f32_16x16x64_bf16 v[8:11], v[166:169], v[84:91], v213
s_waitcnt lgkmcnt(1)
ds_read_b128 v[84:87], v197 offset:64
ds_read_b128 v[88:91], v197 offset:80
v_smfmac_f32_16x16x64_bf16 v[20:23], v[166:169], v[92:99], v213
ds_read_b128 v[92:95], v198 offset:64
ds_read_b128 v[96:99], v198 offset:80
v_fmac_f32 v135, v31, v31
s_waitcnt lgkmcnt(4)
v_smfmac_f32_16x16x64_bf16 v[32:35], v[166:169], v[100:107], v213
s_nop 0
ds_read_b128 v[100:103], v199 offset:64
ds_read_b128 v[104:107], v199 offset:80
s_mov_b64 exec, s[30:31]
ds_write_b128 v217, v[154:157] offset:2112
s_mov_b64 exec, -1
s_waitcnt lgkmcnt(5)
v_smfmac_f32_16x16x64_bf16 v[8:11], v[170:173], v[84:91], v213
s_add_u32 s28, s28, 32
s_cmp_ge_u32 s28, 73
s_cselect_b32 s21, 73, 0
s_cselect_b32 s22, 1177344, 0
s_sub_u32 s28, s28, s21
s_add_u32 s20, s20, s22
s_add_u32 s20, s20, 86016
s_add_u32 m0, s96, 113152
s_mov_b32 exec_hi, 4194303
buffer_load_dwordx4 v82, s[4:7], s20 offen nt lds
s_mov_b32 exec_hi, -1
s_waitcnt lgkmcnt(3)
v_smfmac_f32_16x16x64_bf16 v[20:23], v[170:173], v[92:99], v213
s_waitcnt lgkmcnt(1)
s_mov_b64 exec, s[30:31]
ds_write_b128 v217, v[158:161] offset:2640
s_mov_b64 exec, -1
v_smfmac_f32_16x16x64_bf16 v[32:35], v[170:173], v[100:107], v213
v_add_f32 v118, v118, v8
v_fmac_f32 v119, v8, v8
v_add_f32 v118, v118, v9
v_fmac_f32 v119, v9, v9
v_add_f32 v118, v118, v10
v_fmac_f32 v119, v10, v10
v_add_f32 v118, v118, v11
v_fmac_f32 v119, v11, v11
v_add_f32 v126, v126, v20
v_fmac_f32 v127, v20, v20
v_add_f32 v126, v126, v21
v_fmac_f32 v127, v21, v21
v_add_f32 v126, v126, v22
v_fmac_f32 v127, v22, v22
v_add_f32 v126, v126, v23
v_fmac_f32 v127, v23, v23
v_add_f32 v134, v134, v32
v_fmac_f32 v135, v32, v32
v_add_f32 v134, v134, v33
v_fmac_f32 v135, v33, v33
v_add_f32 v134, v134, v34
v_fmac_f32 v135, v34, v34
v_add_f32 v134, v134, v35
v_fmac_f32 v135, v35, v35
v_permlane16_swap_b32 v118, v119
v_add_f32 v118, v118, v119
v_permlane16_swap_b32 v126, v127
v_add_f32 v126, v126, v127
v_permlane16_swap_b32 v134, v135
v_add_f32 v134, v134, v135
v_permlane32_swap_b32 v118, v126
v_add_f32 v118, v118, v126
v_mov_b32 v135, v134
ds_write_b32 v209, v118
v_permlane32_swap_b32 v134, v135
s_add_u32 s28, s28, 32
s_cmp_ge_u32 s28, 73
s_cselect_b32 s21, 73, 0
s_cselect_b32 s22, 1177344, 0
s_sub_u32 s28, s28, s21
s_add_u32 s20, s20, s22
s_add_u32 s20, s20, 86016
s_add_u32 m0, s96, 116624
s_mov_b32 exec_hi, 4194303
buffer_load_dwordx4 v82, s[4:7], s20 offen nt lds
s_mov_b32 exec_hi, -1
v_add_f32 v134, v134, v135
ds_write_b32 v209, v134 offset:512
s_mov_b64 exec, s[30:31]
ds_write_b128 v217, v[162:165] offset:3168
s_mov_b64 exec, -1
s_mov_b64 exec, s[30:31]
ds_write_b128 v217, v[166:169] offset:3696
s_mov_b64 exec, -1
s_waitcnt lgkmcnt(2)
s_barrier
ds_read_b128 v[102:105], v210 offset:18432
ds_read_b128 v[106:109], v210 offset:19456
s_mov_b64 exec, s[30:31]
ds_write_b128 v217, v[170:173] offset:4224
s_mov_b64 exec, -1
s_waitcnt lgkmcnt(2)
v_add_f32 v102, v102, v103
v_add_f32 v104, v104, v105
s_waitcnt lgkmcnt(1)
s_add_u32 s28, s28, 32
s_cmp_ge_u32 s28, 73
s_cselect_b32 s21, 73, 0
s_cselect_b32 s22, 1177344, 0
s_sub_u32 s28, s28, s21
s_add_u32 s20, s20, s22
s_add_u32 s20, s20, 86016
s_add_u32 m0, s96, 120096
s_mov_b32 exec_hi, 4194303
buffer_load_dwordx4 v82, s[4:7], s20 offen nt lds
s_mov_b32 exec_hi, -1
v_add_f32 v102, v102, v104
v_mul_f32 v103, s48, v102
v_mul_f32 v104, s73, v102
v_add_f32 v106, v106, v107
v_add_f32 v108, v108, v109
v_add_f32 v106, v106, v108
v_mul_f32 v106, s73, v106
v_fma_f32 v106, -v103, v104, v106
v_max_f32 v106, 0, v106
v_add_f32 v106, s49, v106
v_rsq_f32 v102, v106
s_nop 0
v_mul_f32_e64 v103, -v103, v102
ds_write_b64 v211, v[102:103]
ds_read_b64 v[118:119], v219
ds_read_b64 v[126:127], v219 offset:256
ds_read_b64 v[134:135], v219 offset:512
s_waitcnt lgkmcnt(2)
v_fma_f32 v220, v0, v118, v119
v_fma_f32 v221, v1, v118, v119
v_cvt_pk_bf16_f32 v174, v220, v221
v_fma_f32 v222, v2, v118, v119
v_fma_f32 v223, v3, v118, v119
v_cvt_pk_bf16_f32 v175, v222, v223
v_fma_f32 v220, v4, v118, v119
v_fma_f32 v221, v5, v118, v119
v_cvt_pk_bf16_f32 v176, v220, v221
v_fma_f32 v222, v6, v118, v119
v_fma_f32 v223, v7, v118, v119
v_cvt_pk_bf16_f32 v177, v222, v223
v_fma_f32 v220, v8, v118, v119
v_fma_f32 v221, v9, v118, v119
s_add_u32 s28, s28, 32
s_cmp_ge_u32 s28, 73
s_cselect_b32 s21, 73, 0
s_cselect_b32 s22, 1177344, 0
s_sub_u32 s28, s28, s21
s_add_u32 s20, s20, s22
s_add_u32 s20, s20, 86016
s_add_u32 m0, s96, 123568
s_mov_b32 exec_hi, 4194303
buffer_load_dwordx4 v82, s[4:7], s20 offen nt lds
s_mov_b32 exec_hi, -1
s_add_u32 m0, s55, 131328
s_add_u32 s29, s54, 384
buffer_load_dwordx4 v72, s[12:15], s29 offen lds
v_cvt_pk_bf16_f32 v178, v220, v221
s_waitcnt lgkmcnt(1)
s_add_u32 m0, s55, 132352
s_add_u32 s29, s54, 384
buffer_load_dwordx4 v73, s[12:15], s29 offen lds
s_add_u32 m0, s55, 133376
s_add_u32 s29, s54, 384
buffer_load_dwordx4 v74, s[12:15], s29 offen lds
v_fma_f32 v222, v10, v118, v119
v_fma_f32 v223, v11, v118, v119
v_cvt_pk_bf16_f32 v179, v222, v223
v_fma_f32 v220, v12, v126, v127
v_fma_f32 v221, v13, v126, v127
v_cvt_pk_bf16_f32 v90, v220, v221
ds_write_b128 v211, v[174:177]
s_add_u32 m0, s55, 0
s_add_u32 s29, s54, 37248
buffer_load_dwordx4 v72, s[12:15], s29 offen lds
v_fma_f32 v222, v14, v126, v127
v_fma_f32 v223, v15, v126, v127
v_cvt_pk_bf16_f32 v91, v222, v223
v_fma_f32 v220, v16, v126, v127
v_fma_f32 v221, v17, v126, v127
v_cvt_pk_bf16_f32 v92, v220, v221
v_fma_f32 v222, v18, v126, v127
s_waitcnt lgkmcnt(1)
ds_write_b64 v212, v[178:179]
s_add_u32 m0, s55, 1024
s_add_u32 s29, s54, 37248
buffer_load_dwordx4 v73, s[12:15], s29 offen lds
v_fma_f32 v223, v19, v126, v127
v_cvt_pk_bf16_f32 v93, v222, v223
v_fma_f32 v220, v20, v126, v127
v_fma_f32 v221, v21, v126, v127
v_cvt_pk_bf16_f32 v94, v220, v221
v_fma_f32 v222, v22, v126, v127
v_fma_f32 v223, v23, v126, v127
v_cvt_pk_bf16_f32 v95, v222, v223
v_fma_f32 v220, v24, v134, v135
v_fma_f32 v221, v25, v134, v135
ds_write_b128 v211, v[90:93] offset:6144
s_add_u32 m0, s55, 2048
s_add_u32 s29, s54, 37248
buffer_load_dwordx4 v74, s[12:15], s29 offen lds
v_cvt_pk_bf16_f32 v90, v220, v221
v_fma_f32 v222, v26, v134, v135
v_fma_f32 v223, v27, v134, v135
v_cvt_pk_bf16_f32 v91, v222, v223
v_fma_f32 v220, v28, v134, v135
v_fma_f32 v221, v29, v134, v135
v_cvt_pk_bf16_f32 v92, v220, v221
v_fma_f32 v222, v30, v134, v135
ds_write_b64 v212, v[94:95] offset:6144
s_add_u32 m0, s55, 12288
s_add_u32 s29, s54, 74112
buffer_load_dwordx4 v72, s[12:15], s29 offen lds
v_fma_f32 v223, v31, v134, v135
v_cvt_pk_bf16_f32 v93, v222, v223
v_fma_f32 v220, v32, v134, v135
v_fma_f32 v221, v33, v134, v135
v_cvt_pk_bf16_f32 v94, v220, v221
v_fma_f32 v222, v34, v134, v135
v_fma_f32 v223, v35, v134, v135
v_cvt_pk_bf16_f32 v95, v222, v223
s_add_u32 s28, s38, s60
ds_write_b128 v211, v[90:93] offset:12288
s_add_u32 m0, s55, 13312
s_add_u32 s29, s54, 74112
buffer_load_dwordx4 v73, s[12:15], s29 offen lds
s_add_u32 m0, s55, 14336
s_add_u32 s29, s54, 74112
buffer_load_dwordx4 v74, s[12:15], s29 offen lds
ds_write_b64 v212, v[94:95] offset:12288
s_add_u32 m0, s55, 24576
s_add_u32 s29, s54, 110976
buffer_load_dwordx4 v72, s[12:15], s29 offen lds
s_add_u32 m0, s55, 25600
s_add_u32 s29, s54, 110976
buffer_load_dwordx4 v73, s[12:15], s29 offen lds
s_add_u32 m0, s55, 26624
s_add_u32 s29, s54, 110976
buffer_load_dwordx4 v74, s[12:15], s29 offen lds
s_waitcnt vmcnt(10) lgkmcnt(0)
ds_read_b64_tr_b16 a[0:1], v110 offset:36864
s_barrier
ds_read_b128 v[84:87], v113
ds_read_b128 v[92:95], v113 offset:55552
ds_read_b128 v[100:103], v111
ds_read_b128 v[104:107], v111 offset:16
ds_read_b128 v[88:91], v111 offset:55568
ds_read_b128 v[96:99], v112 offset:16
s_waitcnt lgkmcnt(5)
v_mfma_f32_16x16x32_bf16 v[36:39], v[138:141], v[84:87], 0
s_nop 0
ds_read_b128 v[84:87], v111 offset:55552
ds_read_b64_tr_b16 a[24:25], v110 offset:36896
s_waitcnt lgkmcnt(6)
v_mfma_f32_16x16x32_bf16 v[48:51], v[138:141], v[92:95], 0
ds_read_b128 v[92:95], v112
ds_read_b64_tr_b16 a[48:49], v110 offset:36928
s_waitcnt lgkmcnt(6)
v_smfmac_f32_16x16x64_bf16 v[36:39], v[142:145], v[100:107], v213
ds_read_b128 v[100:103], v112 offset:55552
ds_read_b128 v[104:107], v112 offset:55568
s_waitcnt vmcnt(9)
ds_read_b64_tr_b16 a[2:3], v110 offset:38400
ds_read_b64_tr_b16 a[26:27], v110 offset:38432
s_waitcnt lgkmcnt(7)
v_smfmac_f32_16x16x64_bf16 v[48:51], v[142:145], v[84:91], v213
ds_read_b128 v[84:87], v113 offset:32
ds_read_b128 v[88:91], v111 offset:55600
s_waitcnt lgkmcnt(7)
v_smfmac_f32_16x16x64_bf16 v[36:39], v[146:149], v[92:99], v213
ds_read_b128 v[92:95], v113 offset:55584
ds_read_b128 v[96:99], v112 offset:48
ds_read_b64_tr_b16 a[50:51], v110 offset:38464
s_nop 3
v_add_f32 v118, v36, v37
v_mul_f32 v119, v36, v36
v_add_f32 v118, v118, v38
v_fmac_f32 v119, v37, v37
s_waitcnt lgkmcnt(7)
v_smfmac_f32_16x16x64_bf16 v[48:51], v[146:149], v[100:107], v213
ds_read_b128 v[100:103], v111 offset:32
ds_read_b128 v[104:107], v111 offset:48
v_add_f32 v118, v118, v39
v_fmac_f32 v119, v38, v38
v_fmac_f32 v119, v39, v39
s_waitcnt lgkmcnt(6)
v_mfma_f32_16x16x32_bf16 v[40:43], v[150:153], v[84:87], 0
ds_read_b128 v[84:87], v111 offset:55584
v_add_f32 v126, v48, v49
v_mul_f32 v127, v48, v48
v_add_f32_e64 v126, v126, v50
v_fmac_f32 v127, v49, v49
s_waitcnt lgkmcnt(5)
v_mfma_f32_16x16x32_bf16 v[52:55], v[150:153], v[92:95], 0
ds_read_b128 v[92:95], v112 offset:32
v_add_f32 v126, v126, v51
v_fmac_f32 v127, v50, v50
v_fmac_f32 v127, v51, v51
s_waitcnt vmcnt(6)
ds_read_b64_tr_b16 a[4:5], v128 offset:1536
ds_read_b64_tr_b16 a[28:29], v128 offset:1568
s_waitcnt lgkmcnt(4)
v_smfmac_f32_16x16x64_bf16 v[40:43], v[154:157], v[100:107], v213
ds_read_b128 v[100:103], v112 offset:55584
ds_read_b128 v[104:107], v112 offset:55600
s_waitcnt lgkmcnt(5)
v_smfmac_f32_16x16x64_bf16 v[52:55], v[154:157], v[84:91], v213
ds_read_b128 v[84:87], v113 offset:64
ds_read_b128 v[88:91], v111 offset:55632
s_waitcnt lgkmcnt(6)
v_smfmac_f32_16x16x64_bf16 v[40:43], v[158:161], v[92:99], v213
ds_read_b128 v[92:95], v113 offset:55616
ds_read_b128 v[96:99], v112 offset:80
ds_read_b64_tr_b16 a[52:53], v128 offset:1600
s_nop 3
v_add_f32 v118, v118, v40
v_fmac_f32 v119, v40, v40
v_add_f32 v118, v118, v41
v_fmac_f32 v119, v41, v41
v_add_f32 v118, v118, v42
v_fmac_f32 v119, v42, v42
v_add_f32 v118, v118, v43
v_fmac_f32 v119, v43, v43
s_waitcnt lgkmcnt(5)
v_smfmac_f32_16x16x64_bf16 v[52:55], v[158:161], v[100:107], v213
s_waitcnt lgkmcnt(4)
ds_read_b128 v[100:103], v111 offset:64
ds_read_b128 v[104:107], v111 offset:80
v_mfma_f32_16x16x32_bf16 v[44:47], v[162:165], v[84:87], 0
s_nop 0
ds_read_b128 v[84:87], v111 offset:55616
ds_read_b64_tr_b16 a[16:17], v128
s_waitcnt lgkmcnt(6)
v_mfma_f32_16x16x32_bf16 v[56:59], v[162:165], v[92:95], 0
ds_read_b128 v[92:95], v112 offset:64
v_add_f32 v126, v126, v52
v_fmac_f32 v127, v52, v52
v_add_f32 v126, v126, v53
v_fmac_f32 v127, v53, v53
v_add_f32 v126, v126, v54
v_fmac_f32 v127, v54, v54
v_add_f32_e64 v126, v126, v55
v_fmac_f32 v127, v55, v55
ds_read_b64_tr_b16 a[40:41], v128 offset:32
ds_read_b64_tr_b16 a[64:65], v128 offset:64
s_waitcnt lgkmcnt(5)
v_smfmac_f32_16x16x64_bf16 v[44:47], v[166:169], v[100:107], v213
ds_read_b128 v[100:103], v112 offset:55616
ds_read_b128 v[104:107], v112 offset:55632
s_waitcnt lgkmcnt(6)
v_smfmac_f32_16x16x64_bf16 v[56:59], v[166:169], v[84:91], v213
s_waitcnt vmcnt(4)
ds_read_b64_tr_b16 a[6:7], v128 offset:12288
ds_read_b64_tr_b16 a[30:31], v128 offset:12320
s_waitcnt lgkmcnt(6)
v_smfmac_f32_16x16x64_bf16 v[44:47], v[170:173], v[92:99], v213
s_waitcnt vmcnt(3)
ds_read_b64_tr_b16 a[54:55], v128 offset:12352
ds_read_b64_tr_b16 a[18:19], v128 offset:13824
ds_read_b64_tr_b16 a[42:43], v128 offset:13856
s_nop 3
v_add_f32 v118, v118, v44
v_fmac_f32 v119, v44, v44
v_add_f32 v118, v118, v45
v_fmac_f32 v119, v45, v45
v_add_f32 v118, v118, v46
v_fmac_f32 v119, v46, v46
v_add_f32 v118, v118, v47
v_fmac_f32 v119, v47, v47
s_waitcnt lgkmcnt(5)
v_smfmac_f32_16x16x64_bf16 v[56:59], v[170:173], v[100:107], v213
s_barrier
v_permlane16_swap_b32 v118, v119
v_add_f32 v118, v118, v119
s_nop 3
v_add_f32 v126, v126, v56
v_fmac_f32 v127, v56, v56
v_add_f32 v126, v126, v57
v_fmac_f32 v127, v57, v57
v_add_f32 v126, v126, v58
v_fmac_f32 v127, v58, v58
v_add_f32 v126, v126, v59
v_fmac_f32 v127, v59, v59
s_nop 1
v_permlane16_swap_b32 v126, v127
v_add_f32 v126, v126, v127
s_nop 1
v_permlane32_swap_b32 v118, v126
v_add_f32 v118, v118, v126
ds_write_b32 v209, v118
s_add_u32 m0, s55, 94464
s_add_u32 s29, s54, 147840
buffer_load_dwordx4 v72, s[12:15], s29 offen lds
s_add_u32 m0, s55, 95488
s_add_u32 s29, s54, 147840
buffer_load_dwordx4 v73, s[12:15], s29 offen lds
s_add_u32 m0, s55, 96512
s_add_u32 s29, s54, 147840
buffer_load_dwordx4 v74, s[12:15], s29 offen lds
s_waitcnt lgkmcnt(0)
s_barrier
ds_read_b128 v[102:105], v210 offset:18432
ds_read_b128 v[106:109], v210 offset:19456
s_add_u32 m0, s55, 106752
s_add_u32 s29, s54, 184704
buffer_load_dwordx4 v72, s[12:15], s29 offen lds
s_add_u32 m0, s55, 107776
s_add_u32 s29, s54, 184704
buffer_load_dwordx4 v73, s[12:15], s29 offen lds
s_waitcnt lgkmcnt(1)
v_add_f32 v102, v102, v103
v_add_f32 v104, v104, v105
v_add_f32 v102, v102, v104
v_mul_f32 v103, s48, v102
v_mul_f32 v104, s73, v102
s_waitcnt lgkmcnt(0)
v_add_f32 v106, v106, v107
v_add_f32 v108, v108, v109
v_add_f32 v106, v106, v108
v_mul_f32_e64 v106, s73, v106
v_fma_f32 v106, -v103, v104, v106
v_max_f32 v106, 0, v106
v_add_f32 v106, s49, v106
v_rsq_f32_e64 v102, v106
s_nop 0
v_mul_f32_e64 v103, -v103, v102
ds_write_b64 v211, v[102:103] offset:20480
s_add_u32 m0, s55, 108800
s_add_u32 s29, s54, 184704
buffer_load_dwordx4 v74, s[12:15], s29 offen lds
ds_read_b64 v[118:119], v219 offset:20480
ds_read_b64 v[126:127], v219 offset:20736
s_add_u32 m0, s55, 119040
s_add_u32 s29, s54, 0
buffer_load_dwordx4 v72, s[12:15], s29 offen lds
s_add_u32 m0, s55, 120064
s_add_u32 s29, s54, 0
buffer_load_dwordx4 v73, s[12:15], s29 offen lds
s_waitcnt lgkmcnt(1)
v_fma_f32 v220, v36, v118, v119
v_fma_f32 v221, v37, v118, v119
v_cvt_pk_bf16_f32 v174, v220, v221
v_fma_f32 v222, v38, v118, v119
v_fma_f32 v223, v39, v118, v119
v_cvt_pk_bf16_f32 v175, v222, v223
v_fma_f32 v220, v40, v118, v119
v_fma_f32 v221, v41, v118, v119
v_cvt_pk_bf16_f32 v176, v220, v221
v_fma_f32 v222, v42, v118, v119
v_fma_f32 v223, v43, v118, v119
v_cvt_pk_bf16_f32 v177, v222, v223
v_fma_f32 v220, v44, v118, v119
v_fma_f32 v221, v45, v118, v119
v_cvt_pk_bf16_f32 v178, v220, v221
v_fma_f32 v222, v46, v118, v119
v_fma_f32 v223, v47, v118, v119
v_cvt_pk_bf16_f32 v179, v222, v223
s_waitcnt lgkmcnt(0)
v_fma_f32 v220, v48, v126, v127
v_fma_f32 v221, v49, v126, v127
v_cvt_pk_bf16_f32 v90, v220, v221
ds_write_b128 v211, v[174:177] offset:20480
v_fma_f32 v222, v50, v126, v127
v_fma_f32 v223, v51, v126, v127
v_cvt_pk_bf16_f32 v91, v222, v223
v_fma_f32 v220, v52, v126, v127
v_fma_f32 v221, v53, v126, v127
v_cvt_pk_bf16_f32 v92, v220, v221
v_fma_f32 v222, v54, v126, v127
ds_write_b64 v212, v[178:179] offset:20480
v_fma_f32 v223, v55, v126, v127
v_cvt_pk_bf16_f32 v93, v222, v223
v_fma_f32 v220, v56, v126, v127
v_fma_f32 v221, v57, v126, v127
v_cvt_pk_bf16_f32 v94, v220, v221
v_fma_f32 v222, v58, v126, v127
v_fma_f32 v223, v59, v126, v127
v_cvt_pk_bf16_f32 v95, v222, v223
ds_write_b128 v211, v[90:93] offset:26624
s_add_u32 m0, s55, 121088
s_add_u32 s29, s54, 0
buffer_load_dwordx4 v74, s[12:15], s29 offen lds
s_add_u32 m0, s55, 69888
s_add_u32 s29, s54, 36864
buffer_load_dwordx4 v72, s[12:15], s29 offen lds
ds_write_b64 v212, v[94:95] offset:26624
s_add_u32 m0, s55, 70912
s_add_u32 s29, s54, 36864
buffer_load_dwordx4 v73, s[12:15], s29 offen lds
s_add_u32 m0, s55, 71936
s_add_u32 s29, s54, 36864
buffer_load_dwordx4 v74, s[12:15], s29 offen lds
s_add_u32 m0, s55, 82176
s_add_u32 s29, s54, 73728
buffer_load_dwordx4 v72, s[12:15], s29 offen lds
s_add_u32 m0, s55, 83200
s_add_u32 s29, s54, 73728
buffer_load_dwordx4 v73, s[12:15], s29 offen lds
s_add_u32 m0, s55, 84224
s_add_u32 s29, s54, 73728
buffer_load_dwordx4 v74, s[12:15], s29 offen lds
ds_read_b64_tr_b16 a[66:67], v128 offset:13888
s_waitcnt vmcnt(16)
ds_read_b64_tr_b16 a[8:9], v128 offset:24576
ds_read_b64_tr_b16 a[32:33], v128 offset:24608
ds_read_b64_tr_b16 a[56:57], v128 offset:24640
s_waitcnt vmcnt(15)
ds_read_b64_tr_b16 a[10:11], v128 offset:26112
ds_read_b64_tr_b16 a[34:35], v128 offset:26144
ds_read_b64_tr_b16 a[58:59], v128 offset:26176
v_mov_b32 v128, v83
s_add_u32 m0, s55, 131328
s_add_u32 s29, s54, 110592
buffer_load_dwordx4 v72, s[12:15], s29 offen lds
s_add_u32 m0, s55, 132352
s_add_u32 s29, s54, 110592
buffer_load_dwordx4 v73, s[12:15], s29 offen lds
s_waitcnt vmcnt(14)
ds_read_b64_tr_b16 a[12:13], v110 offset:1536
s_waitcnt lgkmcnt(1)
s_add_u32 m0, s55, 133376
s_add_u32 s29, s54, 110592
buffer_load_dwordx4 v74, s[12:15], s29 offen lds
s_barrier
ds_read_b64_tr_b16 a[36:37], v110 offset:1568
ds_read_b64_tr_b16 a[60:61], v110 offset:1600
ds_read_b64_tr_b16 a[20:21], v110
ds_read_b64_tr_b16 a[44:45], v110 offset:32
ds_read_b64_tr_b16 a[68:69], v110 offset:64
s_waitcnt vmcnt(13)
ds_read_b64_tr_b16 a[14:15], v110 offset:12288
ds_read_b64_tr_b16 a[38:39], v110 offset:12320
ds_read_b64_tr_b16 a[62:63], v110 offset:12352
s_waitcnt vmcnt(12)
ds_read_b64_tr_b16 a[22:23], v110 offset:13824
s_waitcnt lgkmcnt(4)
s_add_u32 m0, s55, 94464
s_add_u32 s29, s54, 147456
buffer_load_dwordx4 v72, s[12:15], s29 offen lds
s_add_u32 m0, s55, 95488
s_add_u32 s29, s54, 147456
buffer_load_dwordx4 v73, s[12:15], s29 offen lds
s_add_u32 m0, s55, 96512
s_add_u32 s29, s54, 147456
buffer_load_dwordx4 v74, s[12:15], s29 offen lds
ds_read_b64_tr_b16 a[46:47], v110 offset:13856
ds_read_b64_tr_b16 a[70:71], v110 offset:13888
s_waitcnt vmcnt(13)
ds_read_b64_tr_b16 a[216:217], v110 offset:24576
ds_read_b64_tr_b16 a[240:241], v110 offset:24608
ds_read_b64_tr_b16 v[232:233], v110 offset:24640
s_waitcnt vmcnt(12)
ds_read_b64_tr_b16 a[218:219], v110 offset:26112
s_waitcnt lgkmcnt(4)
s_add_u32 m0, s55, 106752
s_add_u32 s29, s54, 184320
buffer_load_dwordx4 v72, s[12:15], s29 offen lds
s_add_u32 m0, s55, 107776
s_add_u32 s29, s54, 184320
buffer_load_dwordx4 v73, s[12:15], s29 offen lds
ds_read_b64_tr_b16 a[242:243], v110 offset:26144
ds_read_b64_tr_b16 v[234:235], v110 offset:26176
s_add_u32 m0, s55, 108800
s_add_u32 s29, s54, 184320
buffer_load_dwordx4 v74, s[12:15], s29 offen lds
s_waitcnt vmcnt(12)
ds_read_b64_tr_b16 a[220:221], v129 offset:1536
ds_read_b64_tr_b16 a[244:245], v129 offset:1568
s_waitcnt lgkmcnt(2)
s_add_u32 m0, s55, 119040
s_add_u32 s29, s54, 768
buffer_load_dwordx4 v72, s[12:15], s29 offen lds
ds_read_b64_tr_b16 v[236:237], v129 offset:1600
ds_read_b64_tr_b16 a[232:233], v129
ds_read_b64_tr_b16 v[224:225], v129 offset:32
s_add_u32 m0, s55, 120064
s_add_u32 s29, s54, 768
buffer_load_dwordx4 v73, s[12:15], s29 offen lds
ds_read_b64_tr_b16 v[248:249], v129 offset:64
s_waitcnt vmcnt(12)
ds_read_b64_tr_b16 a[222:223], v129 offset:12288
ds_read_b64_tr_b16 a[246:247], v129 offset:12320
s_add_u32 m0, s55, 121088
s_add_u32 s29, s54, 768
buffer_load_dwordx4 v74, s[12:15], s29 offen lds
ds_read_b64_tr_b16 v[238:239], v129 offset:12352
s_waitcnt vmcnt(12)
ds_read_b64_tr_b16 a[234:235], v129 offset:13824
ds_read_b64_tr_b16 v[226:227], v129 offset:13856
s_waitcnt lgkmcnt(5)
s_add_u32 m0, s55, 69888
s_add_u32 s29, s54, 37632
buffer_load_dwordx4 v72, s[12:15], s29 offen lds
ds_read_b64_tr_b16 v[250:251], v129 offset:13888
s_waitcnt vmcnt(11)
ds_read_b64_tr_b16 a[224:225], v110 offset:36864
s_add_u32 m0, s55, 70912
s_add_u32 s29, s54, 37632
buffer_load_dwordx4 v73, s[12:15], s29 offen lds
ds_read_b64_tr_b16 a[248:249], v110 offset:36896
ds_read_b64_tr_b16 v[240:241], v110 offset:36928
s_waitcnt vmcnt(11)
ds_read_b64_tr_b16 a[226:227], v110 offset:38400
s_add_u32 m0, s55, 71936
s_add_u32 s29, s54, 37632
buffer_load_dwordx4 v74, s[12:15], s29 offen lds
ds_read_b64_tr_b16 a[250:251], v110 offset:38432
ds_read_b64_tr_b16 v[242:243], v110 offset:38464
ds_read_b128 v[182:185], v210 offset:20480
s_waitcnt lgkmcnt(7)
s_add_u32 m0, s55, 82176
s_add_u32 s29, s54, 74496
buffer_load_dwordx4 v72, s[12:15], s29 offen lds
s_waitcnt vmcnt(11)
ds_read_b64_tr_b16 a[236:237], v110
ds_read_b64_tr_b16 v[228:229], v110 offset:32
ds_read_b64_tr_b16 v[252:253], v110 offset:64
s_waitcnt lgkmcnt(3)
v_mfma_f32_16x16x32_bf16 v[138:141], a[0:3], v[182:185], 0
s_nop 0
s_add_u32 m0, s55, 83200
s_add_u32 s29, s54, 74496
buffer_load_dwordx4 v73, s[12:15], s29 offen lds
v_mfma_f32_16x16x32_bf16 v[142:145], a[24:27], v[182:185], 0
s_waitcnt vmcnt(11)
ds_read_b64_tr_b16 a[228:229], v110 offset:1536
ds_read_b64_tr_b16 a[252:253], v110 offset:1568
v_mfma_f32_16x16x32_bf16 v[146:149], a[48:51], v[182:185], 0
ds_read_b64_tr_b16 v[244:245], v110 offset:1600
ds_read_b128 v[186:189], v210 offset:26624
s_add_u32 m0, s55, 84224
s_add_u32 s29, s54, 74496
buffer_load_dwordx4 v74, s[12:15], s29 offen lds
ds_read_b128 v[114:117], v210 offset:21504
ds_read_b128 v[122:125], v210 offset:27648
ds_read_b128 v[182:185], v210 offset:24576
s_waitcnt lgkmcnt(3)
v_mfma_f32_16x16x32_bf16 v[150:153], a[0:3], v[186:189], 0
s_add_u32 m0, s55, 131328
s_add_u32 s29, s54, 111360
buffer_load_dwordx4 v72, s[12:15], s29 offen lds
v_mfma_f32_16x16x32_bf16 v[154:157], a[24:27], v[186:189], 0
s_waitcnt vmcnt(11)
ds_read_b64_tr_b16 a[230:231], v110 offset:12288
ds_read_b64_tr_b16 a[254:255], v110 offset:12320
v_mfma_f32_16x16x32_bf16 v[158:161], a[48:51], v[186:189], 0
s_waitcnt lgkmcnt(4)
ds_read_b64_tr_b16 v[246:247], v110 offset:12352
ds_read_b128 v[186:189], v210 offset:30720
v_mfma_f32_16x16x32_bf16 v[138:141], a[4:7], v[114:117], v[138:141]
ds_read_b128 v[220:223], v210 offset:3072
s_waitcnt lgkmcnt(5)
v_mfma_f32_16x16x32_bf16 v[138:141], a[16:19], v[182:185], v[138:141]
s_nop 0
s_add_u32 m0, s55, 132352
s_add_u32 s29, s54, 111360
buffer_load_dwordx4 v73, s[12:15], s29 offen lds
v_mfma_f32_16x16x32_bf16 v[142:145], a[28:31], v[114:117], v[142:145]
s_waitcnt vmcnt(11)
ds_read_b64_tr_b16 a[238:239], v110 offset:13824
ds_read_b64_tr_b16 v[230:231], v110 offset:13856
v_mfma_f32_16x16x32_bf16 v[142:145], a[40:43], v[182:185], v[142:145]
ds_read_b64_tr_b16 v[254:255], v110 offset:13888
v_mfma_f32_16x16x32_bf16 v[146:149], a[52:55], v[114:117], v[146:149]
ds_read_b128 v[114:117], v210 offset:22528
v_mfma_f32_16x16x32_bf16 v[146:149], a[64:67], v[182:185], v[146:149]
s_add_u32 m0, s55, 133376
s_add_u32 s29, s54, 111360
buffer_load_dwordx4 v74, s[12:15], s29 offen lds
v_mfma_f32_16x16x32_bf16 v[150:153], a[4:7], v[122:125], v[150:153]
s_nop 0
ds_read_b128 v[182:185], v210 offset:23552
s_waitcnt lgkmcnt(6)
v_mfma_f32_16x16x32_bf16 v[150:153], a[16:19], v[186:189], v[150:153]
v_mfma_f32_16x16x32_bf16 v[154:157], a[28:31], v[122:125], v[154:157]
v_mfma_f32_16x16x32_bf16 v[154:157], a[40:43], v[186:189], v[154:157]
s_add_u32 m0, s55, 94464
s_add_u32 s29, s54, 148224
buffer_load_dwordx4 v72, s[12:15], s29 offen lds
v_mfma_f32_16x16x32_bf16 v[158:161], a[52:55], v[122:125], v[158:161]
s_waitcnt vmcnt(11)
ds_read_b64_tr_b16 a[72:73], v110 offset:24576
ds_read_b64_tr_b16 a[96:97], v110 offset:24608
v_mfma_f32_16x16x32_bf16 v[158:161], a[64:67], v[186:189], v[158:161]
s_waitcnt lgkmcnt(3)
ds_read_b64_tr_b16 a[120:121], v110 offset:24640
ds_read_b128 v[122:125], v210 offset:28672
v_mfma_f32_16x16x32_bf16 v[138:141], a[8:11], v[114:117], v[138:141]
ds_read_b128 v[186:189], v210 offset:29696
s_waitcnt lgkmcnt(5)
v_mfma_f32_16x16x32_bf16 v[138:141], a[12:15], v[182:185], v[138:141]
s_add_u32 m0, s55, 95488
s_add_u32 s29, s54, 148224
buffer_load_dwordx4 v73, s[12:15], s29 offen lds
v_mfma_f32_16x16x32_bf16 v[142:145], a[32:35], v[114:117], v[142:145]
s_waitcnt vmcnt(11)
ds_read_b64_tr_b16 a[74:75], v110 offset:26112
ds_read_b64_tr_b16 a[98:99], v110 offset:26144
v_mfma_f32_16x16x32_bf16 v[142:145], a[36:39], v[182:185], v[142:145]
ds_read_b64_tr_b16 a[122:123], v110 offset:26176
v_mfma_f32_16x16x32_bf16 v[146:149], a[56:59], v[114:117], v[146:149]
ds_read_b128 v[114:117], v210 offset:25600
v_mfma_f32_16x16x32_bf16 v[146:149], a[60:63], v[182:185], v[146:149]
s_waitcnt lgkmcnt(5)
s_add_u32 m0, s55, 96512
s_add_u32 s29, s54, 148224
buffer_load_dwordx4 v74, s[12:15], s29 offen lds
v_mfma_f32_16x16x32_bf16 v[150:153], a[8:11], v[122:125], v[150:153]
ds_read_b128 v[182:185], v210 offset:20480
s_waitcnt lgkmcnt(5)
v_mfma_f32_16x16x32_bf16 v[150:153], a[12:15], v[186:189], v[150:153]
v_mfma_f32_16x16x32_bf16 v[154:157], a[32:35], v[122:125], v[154:157]
v_mfma_f32_16x16x32_bf16 v[154:157], a[36:39], v[186:189], v[154:157]
s_add_u32 m0, s55, 106752
s_add_u32 s29, s54, 185088
buffer_load_dwordx4 v72, s[12:15], s29 offen lds
v_mfma_f32_16x16x32_bf16 v[158:161], a[56:59], v[122:125], v[158:161]
s_waitcnt vmcnt(11)
ds_read_b64_tr_b16 a[88:89], v129
ds_read_b64_tr_b16 a[112:113], v129 offset:32
v_mfma_f32_16x16x32_bf16 v[158:161], a[60:63], v[186:189], v[158:161]
s_waitcnt lgkmcnt(3)
ds_read_b64_tr_b16 a[136:137], v129 offset:64
ds_read_b128 v[122:125], v210 offset:31744
v_mfma_f32_16x16x32_bf16 v[138:141], a[20:23], v[114:117], v[138:141]
ds_read_b128 v[186:189], v210 offset:26624
v_mfma_f32_16x16x32_bf16 v[142:145], a[44:47], v[114:117], v[142:145]
s_nop 0
s_add_u32 m0, s55, 107776
s_add_u32 s29, s54, 185088
buffer_load_dwordx4 v73, s[12:15], s29 offen lds
v_mfma_f32_16x16x32_bf16 v[146:149], a[68:71], v[114:117], v[146:149]
s_waitcnt vmcnt(11) lgkmcnt(5)
ds_read_b64_tr_b16 a[76:77], v129 offset:1536
ds_read_b64_tr_b16 a[100:101], v129 offset:1568
v_mfma_f32_16x16x32_bf16 v[162:165], a[216:219], v[182:185], 0
ds_read_b64_tr_b16 a[124:125], v129 offset:1600
ds_read_b128 v[114:117], v210 offset:21504
v_mfma_f32_16x16x32_bf16 v[166:169], a[240:243], v[182:185], 0
s_nop 0
v_cvt_pk_bf16_f32 v60, v138, v139
v_cvt_pk_bf16_f32 v61, v140, v141
v_mfma_f32_16x16x32_bf16 v[170:173], v[232:235], v[182:185], 0
s_waitcnt lgkmcnt(5)
s_add_u32 m0, s55, 108800
s_add_u32 s29, s54, 185088
buffer_load_dwordx4 v74, s[12:15], s29 offen lds
v_mfma_f32_16x16x32_bf16 v[150:153], a[20:23], v[122:125], v[150:153]
ds_read_b128 v[182:185], v210 offset:24576
v_cvt_pk_bf16_f32 v62, v142, v143
v_mfma_f32_16x16x32_bf16 v[154:157], a[44:47], v[122:125], v[154:157]
s_nop 0
v_cvt_pk_bf16_f32 v63, v144, v145
v_cvt_pk_bf16_f32 v64, v146, v147
v_mfma_f32_16x16x32_bf16 v[158:161], a[68:71], v[122:125], v[158:161]
s_waitcnt lgkmcnt(5)
ds_read_b128 v[122:125], v210 offset:27648
v_cvt_pk_bf16_f32 v65, v148, v149
v_mfma_f32_16x16x32_bf16 v[138:141], a[216:219], v[186:189], 0
s_add_u32 m0, s45, 0
s_nop 0
buffer_load_dwordx4 v216, s[4:7], s52 offen nt lds
v_mfma_f32_16x16x32_bf16 v[142:145], a[240:243], v[186:189], 0
s_waitcnt vmcnt(11) lgkmcnt(2)
ds_read_b64_tr_b16 a[78:79], v129 offset:12288
ds_read_b64_tr_b16 a[102:103], v129 offset:12320
v_mfma_f32_16x16x32_bf16 v[146:149], v[232:235], v[186:189], 0
s_add_u32 s52, s50, s41
ds_read_b64_tr_b16 a[126:127], v129 offset:12352
ds_read_b128 v[186:189], v210 offset:30720
v_mfma_f32_16x16x32_bf16 v[162:165], a[220:223], v[114:117], v[162:165]
s_waitcnt lgkmcnt(5)
s_add_u32 m0, s45, 4112
s_add_u32 s40, s37, 196224
buffer_load_dwordx4 v216, s[4:7], s40 offen nt lds
v_mfma_f32_16x16x32_bf16 v[162:165], a[232:235], v[182:185], v[162:165]
v_cvt_pk_bf16_f32 v66, v150, v151
v_cvt_pk_bf16_f32 v67, v152, v153
v_mfma_f32_16x16x32_bf16 v[166:169], a[244:247], v[114:117], v[166:169]
s_waitcnt vmcnt(11) lgkmcnt(4)
ds_read_b64_tr_b16 a[90:91], v129 offset:13824
ds_read_b64_tr_b16 a[114:115], v129 offset:13856
v_mfma_f32_16x16x32_bf16 v[166:169], v[224:227], v[182:185], v[166:169]
s_mul_hi_u32 s41, s35, 58835169
ds_read_b64_tr_b16 a[138:139], v129 offset:13888
v_cvt_pk_bf16_f32 v68, v154, v155
v_mfma_f32_16x16x32_bf16 v[170:173], v[236:239], v[114:117], v[170:173]
s_mul_i32 s42, s41, 73
s_add_u32 m0, s45, 8224
s_add_u32 s40, s37, 392448
buffer_load_dwordx4 v216, s[4:7], s40 offen nt lds
v_mfma_f32_16x16x32_bf16 v[170:173], v[248:251], v[182:185], v[170:173]
s_sub_u32 s42, s35, s42
ds_read_b128 v[114:117], v210 offset:22528
ds_read_b128 v[182:185], v210 offset:23552
v_mfma_f32_16x16x32_bf16 v[138:141], a[220:223], v[122:125], v[138:141]
s_waitcnt lgkmcnt(5)
v_cvt_pk_bf16_f32 v69, v156, v157
v_cvt_pk_bf16_f32 v70, v158, v159
v_mfma_f32_16x16x32_bf16 v[138:141], a[232:235], v[186:189], v[138:141]
s_mul_i32 s43, s41, 1373568
s_add_u32 m0, s45, 12336
s_add_u32 s40, s37, 588672
buffer_load_dwordx4 v216, s[4:7], s40 offen nt lds
v_mfma_f32_16x16x32_bf16 v[142:145], a[244:247], v[122:125], v[142:145]
s_mul_i32 s51, s42, 2688
v_cvt_pk_bf16_f32 v71, v160, v161
s_add_u32 s50, s43, s51
v_mfma_f32_16x16x32_bf16 v[142:145], v[224:227], v[186:189], v[142:145]
s_min_u32 s43, s42, 1
s_add_u32 s51, s42, 56
s_min_u32 s41, s41, 1
v_mfma_f32_16x16x32_bf16 v[146:149], v[236:239], v[122:125], v[146:149]
s_waitcnt vmcnt(11) lgkmcnt(1)
ds_read_b64_tr_b16 a[80:81], v110 offset:36864
ds_read_b64_tr_b16 a[104:105], v110 offset:36896
v_mfma_f32_16x16x32_bf16 v[146:149], v[248:251], v[186:189], v[146:149]
s_lshl_b32 s43, s43, 27
s_add_u32 m0, s45, 16448
s_add_u32 s40, s37, 784896
buffer_load_dwordx4 v216, s[4:7], s40 offen nt lds
v_mfma_f32_16x16x32_bf16 v[162:165], a[224:227], v[114:117], v[162:165]
s_waitcnt lgkmcnt(2)
ds_read_b64_tr_b16 a[128:129], v110 offset:36928
ds_read_b128 v[122:125], v210 offset:28672
v_mfma_f32_16x16x32_bf16 v[162:165], a[228:231], v[182:185], v[162:165]
s_and_b32 s51, s51, 128
ds_read_b128 v[186:189], v210 offset:29696
s_sub_u32 s41, 1, s41
v_mfma_f32_16x16x32_bf16 v[166:169], a[248:251], v[114:117], v[166:169]
s_waitcnt vmcnt(11)
s_add_u32 m0, s45, 20560
s_add_u32 s40, s37, 981120
buffer_load_dwordx4 v216, s[4:7], s40 offen nt lds
v_mfma_f32_16x16x32_bf16 v[166:169], a[252:255], v[182:185], v[166:169]
s_sub_u32 s43, 536870911, s43
ds_read_b64_tr_b16 a[82:83], v110 offset:38400
ds_read_b64_tr_b16 a[106:107], v110 offset:38432
v_mfma_f32_16x16x32_bf16 v[170:173], v[240:243], v[114:117], v[170:173]
s_lshl_b32 s51, s51, 22
ds_read_b64_tr_b16 a[130:131], v110 offset:38464
ds_read_b128 v[114:117], v210 offset:25600
v_mfma_f32_16x16x32_bf16 v[170:173], v[244:247], v[182:185], v[170:173]
s_lshl_b32 s41, s41, 30
ds_read_b128 v[182:185], v210 offset:20480
s_waitcnt lgkmcnt(6)
v_mfma_f32_16x16x32_bf16 v[138:141], a[224:227], v[122:125], v[138:141]
s_nop 0
s_add_u32 m0, s45, 24672
s_add_u32 s40, s37, 1177344
buffer_load_dwordx4 v216, s[4:7], s40 offen nt lds
v_mfma_f32_16x16x32_bf16 v[142:145], a[248:251], v[122:125], v[142:145]
s_waitcnt lgkmcnt(5)
v_mfma_f32_16x16x32_bf16 v[142:145], a[252:255], v[186:189], v[142:145]
v_mfma_f32_16x16x32_bf16 v[146:149], v[240:243], v[122:125], v[146:149]
s_add_u32 m0, s45, 28784
s_add_u32 s40, s37, 1373568
buffer_load_dwordx4 v216, s[4:7], s40 offen nt lds
v_mfma_f32_16x16x32_bf16 v[146:149], v[244:247], v[186:189], v[146:149]
s_waitcnt vmcnt(12)
ds_read_b64_tr_b16 a[92:93], v110
ds_read_b64_tr_b16 a[116:117], v110 offset:32
v_mfma_f32_16x16x32_bf16 v[138:141], a[228:231], v[186:189], v[138:141]
s_waitcnt lgkmcnt(3)
ds_read_b64_tr_b16 a[140:141], v110 offset:64
ds_read_b128 v[122:125], v210 offset:31744
v_mfma_f32_16x16x32_bf16 v[162:165], a[236:239], v[114:117], v[162:165]
ds_read_b128 v[186:189], v210 offset:26624
v_mfma_f32_16x16x32_bf16 v[166:169], v[228:231], v[114:117], v[166:169]
s_nop 0
s_add_u32 m0, s45, 32896
s_add_u32 s40, s37, 1569792
buffer_load_dwordx4 v216, s[4:7], s40 offen nt lds
v_mfma_f32_16x16x32_bf16 v[170:173], v[252:255], v[114:117], v[170:173]
s_waitcnt vmcnt(12) lgkmcnt(5)
ds_read_b64_tr_b16 a[84:85], v110 offset:1536
ds_read_b64_tr_b16 a[108:109], v110 offset:1568
v_mfma_f32_16x16x32_bf16 v[150:153], a[72:75], v[182:185], 0
s_add_u32 s40, s36, 196224
ds_read_b64_tr_b16 a[132:133], v110 offset:1600
ds_read_b128 v[114:117], v210 offset:21504
v_mfma_f32_16x16x32_bf16 v[154:157], a[96:99], v[182:185], 0
s_mov_b32 s37, s50
s_add_u32 m0, s55, 69888
s_add_u32 s29, s54, 0
buffer_load_dwordx4 v136, s[16:19], s29 offen lds
v_mfma_f32_16x16x32_bf16 v[158:161], a[120:123], v[182:185], 0
s_waitcnt lgkmcnt(5)
ds_read_b128 v[182:185], v210 offset:24576
v_cvt_pk_bf16_f32 v84, v162, v163
v_mfma_f32_16x16x32_bf16 v[138:141], a[236:239], v[122:125], v[138:141]
s_nop 0
v_cvt_pk_bf16_f32 v85, v164, v165
v_cvt_pk_bf16_f32 v86, v166, v167
v_mfma_f32_16x16x32_bf16 v[142:145], v[228:231], v[122:125], v[142:145]
s_nop 0
v_cvt_pk_bf16_f32 v87, v168, v169
v_cvt_pk_bf16_f32 v88, v170, v171
v_mfma_f32_16x16x32_bf16 v[146:149], v[252:255], v[122:125], v[146:149]
s_waitcnt lgkmcnt(5)
s_add_u32 m0, s55, 70912
s_add_u32 s29, s54, 0
buffer_load_dwordx4 v137, s[16:19], s29 offen lds
v_mfma_f32_16x16x32_bf16 v[162:165], a[72:75], v[186:189], 0
s_waitcnt vmcnt(12)
ds_read_b64_tr_b16 a[86:87], v110 offset:12288
ds_read_b64_tr_b16 a[110:111], v110 offset:12320
v_mfma_f32_16x16x32_bf16 v[166:169], a[96:99], v[186:189], 0
s_waitcnt lgkmcnt(3)
ds_read_b64_tr_b16 a[134:135], v110 offset:12352
ds_read_b128 v[122:125], v210 offset:27648
v_mfma_f32_16x16x32_bf16 v[150:153], a[76:79], v[114:117], v[150:153]
s_waitcnt lgkmcnt(4)
v_cvt_pk_bf16_f32 v89, v172, v173
v_cvt_pk_bf16_f32 v96, v138, v139
v_mfma_f32_16x16x32_bf16 v[150:153], a[88:91], v[182:185], v[150:153]
s_add_u32 m0, s55, 71936
s_add_u32 s29, s54, 0
buffer_load_dwordx4 v128, s[16:19], s29 offen lds
v_mfma_f32_16x16x32_bf16 v[170:173], a[120:123], v[186:189], 0
s_waitcnt vmcnt(12)
ds_read_b64_tr_b16 a[94:95], v110 offset:13824
ds_read_b64_tr_b16 a[118:119], v110 offset:13856
v_mfma_f32_16x16x32_bf16 v[154:157], a[100:103], v[114:117], v[154:157]
ds_read_b64_tr_b16 a[142:143], v110 offset:13888
ds_read_b128 v[186:189], v210 offset:30720
v_mfma_f32_16x16x32_bf16 v[154:157], a[112:115], v[182:185], v[154:157]
v_cvt_pk_bf16_f32 v97, v140, v141
v_cvt_pk_bf16_f32 v98, v142, v143
v_mfma_f32_16x16x32_bf16 v[158:161], a[124:127], v[114:117], v[158:161]
s_nop 0
s_add_u32 m0, s55, 82176
s_add_u32 s29, s54, 12288
buffer_load_dwordx4 v136, s[16:19], s29 offen lds
v_mfma_f32_16x16x32_bf16 v[158:161], a[136:139], v[182:185], v[158:161]
s_waitcnt lgkmcnt(4)
ds_read_b128 v[114:117], v210 offset:22528
ds_read_b128 v[182:185], v210 offset:23552
v_mfma_f32_16x16x32_bf16 v[162:165], a[76:79], v[122:125], v[162:165]
v_cvt_pk_bf16_f32 v99, v144, v145
v_cvt_pk_bf16_f32 v100, v146, v147
v_mfma_f32_16x16x32_bf16 v[166:169], a[100:103], v[122:125], v[166:169]
v_cvt_pk_bf16_f32 v101, v148, v149
v_and_b32 v216, s44, v208
v_mfma_f32_16x16x32_bf16 v[170:173], a[124:127], v[122:125], v[170:173]
s_waitcnt lgkmcnt(2)
s_add_u32 m0, s55, 83200
s_add_u32 s29, s54, 12288
buffer_load_dwordx4 v137, s[16:19], s29 offen lds
v_mfma_f32_16x16x32_bf16 v[170:173], a[136:139], v[186:189], v[170:173]
s_barrier
v_mfma_f32_16x16x32_bf16 v[162:165], a[88:91], v[186:189], v[162:165]
ds_read_b128 v[122:125], v210 offset:28672
ds_read_b128 v[110:113], v210 offset:2048
v_mfma_f32_16x16x32_bf16 v[166:169], a[112:115], v[186:189], v[166:169]
s_or_b32 s44, s43, s51
ds_read_b128 v[186:189], v210 offset:29696
s_waitcnt lgkmcnt(4)
v_mfma_f32_16x16x32_bf16 v[150:153], a[80:83], v[114:117], v[150:153]
s_waitcnt lgkmcnt(3)
s_add_u32 m0, s55, 84224
s_add_u32 s29, s54, 12288
buffer_load_dwordx4 v128, s[16:19], s29 offen lds
v_mfma_f32_16x16x32_bf16 v[150:153], a[84:87], v[182:185], v[150:153]
ds_write_b128 v120, v[84:87]
v_mfma_f32_16x16x32_bf16 v[154:157], a[104:107], v[114:117], v[154:157]
v_mfma_f32_16x16x32_bf16 v[154:157], a[108:111], v[182:185], v[154:157]
v_mfma_f32_16x16x32_bf16 v[158:161], a[128:131], v[114:117], v[158:161]
ds_read_b128 v[114:117], v210 offset:25600
v_mfma_f32_16x16x32_bf16 v[158:161], a[132:135], v[182:185], v[158:161]
ds_read_b128 v[182:185], v210
s_waitcnt lgkmcnt(5)
v_mfma_f32_16x16x32_bf16 v[162:165], a[80:83], v[122:125], v[162:165]
s_waitcnt lgkmcnt(3)
ds_write_b64 v120, v[88:89] offset:16
v_mfma_f32_16x16x32_bf16 v[162:165], a[84:87], v[186:189], v[162:165]
v_mfma_f32_16x16x32_bf16 v[166:169], a[104:107], v[122:125], v[166:169]
ds_write_b128 v120, v[60:63] offset:512
v_mfma_f32_16x16x32_bf16 v[166:169], a[108:111], v[186:189], v[166:169]
v_mfma_f32_16x16x32_bf16 v[170:173], a[128:131], v[122:125], v[170:173]
s_nop 0
v_mfma_f32_16x16x32_bf16 v[170:173], a[132:135], v[186:189], v[170:173]
s_waitcnt lgkmcnt(3)
ds_read_b128 v[122:125], v210 offset:31744
ds_read_b128 v[186:189], v210 offset:1024
v_mfma_f32_16x16x32_bf16 v[150:153], a[92:95], v[114:117], v[150:153]
ds_write_b64 v120, v[64:65] offset:528
v_mfma_f32_16x16x32_bf16 v[154:157], a[116:119], v[114:117], v[154:157]
v_mfma_f32_16x16x32_bf16 v[158:161], a[140:143], v[114:117], v[158:161]
v_cvt_pk_bf16_f32 v90, v150, v151
v_cvt_pk_bf16_f32 v91, v152, v153
v_mfma_f32_16x16x32_bf16 v[174:177], v[84:87], v[60:63], 0
s_nop 0
v_cvt_pk_bf16_f32 v92, v154, v155
v_cvt_pk_bf16_f32 v93, v156, v157
v_mfma_f32_16x16x32_bf16 v[178:181], v[96:99], v[66:69], 0
s_waitcnt lgkmcnt(2)
v_cvt_pk_bf16_f32 v94, v158, v159
v_cvt_pk_bf16_f32 v95, v160, v161
v_mfma_f32_16x16x32_bf16 v[162:165], a[92:95], v[122:125], v[162:165]
s_nop 0
buffer_store_dwordx4 v[36:39], v210, s[24:27], s58 offen sc1
ds_write_b64 v121, v[90:91]
v_mfma_f32_16x16x32_bf16 v[166:169], a[116:119], v[122:125], v[166:169]
s_nop 1
v_cvt_pk_bf16_f32 v102, v162, v163
v_cvt_pk_bf16_f32 v103, v164, v165
v_mfma_f32_16x16x32_bf16 v[170:173], a[140:143], v[122:125], v[170:173]
buffer_store_dwordx4 v[40:43], v210, s[24:27], s58 offen offset:1024 sc1
ds_write_b64 v121, v[92:93] offset:32
v_mfma_f32_16x16x16_bf16 v[174:177], v[88:89], v[64:65], v[174:177]
v_cvt_pk_bf16_f32 v104, v166, v167
v_cvt_pk_bf16_f32 v105, v168, v169
v_cvt_pk_bf16_f32 v106, v170, v171
v_mfma_f32_16x16x16_bf16 v[178:181], v[100:101], v[70:71], v[178:181]
v_cvt_pk_bf16_f32 v107, v172, v173
v_mfma_f32_16x16x32_bf16 v[138:141], a[0:3], v[182:185], 0
s_waitcnt lgkmcnt(3)
buffer_store_dwordx4 v[44:47], v210, s[24:27], s58 offen offset:2048 sc1
ds_write_b64 v121, v[94:95] offset:64
v_mfma_f32_16x16x32_bf16 v[138:141], a[4:7], v[186:189], v[138:141]
v_mfma_f32_16x16x32_bf16 v[142:145], a[24:27], v[182:185], 0
buffer_store_dwordx4 v[48:51], v210, s[24:27], s59 offen sc1
s_mov_b64 exec, s[56:57]
ds_write_b64 v121, v[102:103] offset:22784
s_mov_b64 exec, -1
v_mfma_f32_16x16x32_bf16 v[142:145], a[28:31], v[186:189], v[142:145]
s_mov_b64 exec, s[56:57]
ds_write_b64 v121, v[104:105] offset:22816
s_mov_b64 exec, -1
v_mfma_f32_16x16x32_bf16 v[146:149], a[48:51], v[182:185], 0
buffer_store_dwordx4 v[52:55], v210, s[24:27], s59 offen offset:1024 sc1
s_mov_b64 exec, s[56:57]
ds_write_b64 v121, v[106:107] offset:22848
s_mov_b64 exec, -1
v_mfma_f32_16x16x32_bf16 v[146:149], a[52:55], v[186:189], v[146:149]
s_mov_b64 exec, s[56:57]
ds_write_b128 v120, v[96:99] offset:22784
s_mov_b64 exec, -1
v_mfma_f32_16x16x32_bf16 v[150:153], a[216:219], v[182:185], 0
buffer_store_dwordx4 v[56:59], v210, s[24:27], s59 offen offset:2048 sc1
v_mfma_f32_16x16x32_bf16 v[150:153], a[220:223], v[186:189], v[150:153]
s_mov_b64 exec, s[56:57]
ds_write_b64 v120, v[100:101] offset:22800
s_mov_b64 exec, -1
v_mfma_f32_16x16x32_bf16 v[154:157], a[240:243], v[182:185], 0
s_mov_b64 exec, s[56:57]
ds_write_b128 v120, v[66:69] offset:23296
s_mov_b64 exec, -1
v_mfma_f32_16x16x32_bf16 v[154:157], a[244:247], v[186:189], v[154:157]
v_mfma_f32_16x16x32_bf16 v[158:161], v[232:235], v[182:185], 0
s_mov_b64 exec, s[56:57]
ds_write_b64 v120, v[70:71] offset:23312
s_mov_b64 exec, -1
v_mfma_f32_16x16x32_bf16 v[158:161], v[236:239], v[186:189], v[158:161]
s_mov_b32 exec_lo, 0x100001
s_mov_b32 exec_hi, 0x10000100
ds_write_b32 v132, v174
s_mov_b64 exec, -1
v_mfma_f32_16x16x32_bf16 v[162:165], v[182:185], a[72:75], 0
s_mov_b32 exec_lo, 0x200002
s_mov_b32 exec_hi, 0x20000200
ds_write_b32 v132, v175
s_mov_b64 exec, -1
v_mfma_f32_16x16x32_bf16 v[162:165], v[186:189], a[76:79], v[162:165]
s_mov_b32 exec_lo, 0x400004
s_mov_b32 exec_hi, 0x40000400
ds_write_b32 v132, v176
s_mov_b64 exec, -1
v_mfma_f32_16x16x32_bf16 v[166:169], v[182:185], a[96:99], 0
s_mov_b32 exec_lo, 0x800008
s_mov_b32 exec_hi, 0x80000800
ds_write_b32 v132, v177
s_mov_b64 exec, -1
v_mfma_f32_16x16x32_bf16 v[166:169], v[186:189], a[100:103], v[166:169]
ds_read_b128 v[174:177], v217
v_mfma_f32_16x16x32_bf16 v[170:173], v[182:185], a[120:123], 0
ds_read_b128 v[182:185], v210 offset:4096
v_mfma_f32_16x16x32_bf16 v[170:173], v[186:189], a[124:127], v[170:173]
ds_read_b128 v[186:189], v210 offset:5120
v_mfma_f32_16x16x32_bf16 v[138:141], a[8:11], v[110:113], v[138:141]
s_waitcnt vmcnt(10)
ds_read_b64_tr_b16 a[144:145], v129
ds_read_b64_tr_b16 a[168:169], v129 offset:32
v_mfma_f32_16x16x32_bf16 v[138:141], a[12:15], v[220:223], v[138:141]
s_barrier
v_mfma_f32_16x16x32_bf16 v[142:145], a[32:35], v[110:113], v[142:145]
s_waitcnt vmcnt(9)
ds_read_b64_tr_b16 a[192:193], v129 offset:64
ds_read_b64_tr_b16 a[146:147], v129 offset:1536
v_mfma_f32_16x16x32_bf16 v[142:145], a[36:39], v[220:223], v[142:145]
s_nop 0
ds_read_b64_tr_b16 a[170:171], v129 offset:1568
ds_read_b64_tr_b16 a[194:195], v129 offset:1600
v_mfma_f32_16x16x32_bf16 v[146:149], a[56:59], v[110:113], v[146:149]
s_waitcnt vmcnt(6)
ds_read_b64_tr_b16 a[148:149], v129 offset:13824
ds_read_b64_tr_b16 a[172:173], v129 offset:13856
v_mfma_f32_16x16x32_bf16 v[146:149], a[60:63], v[220:223], v[146:149]
ds_read_b64_tr_b16 a[196:197], v129 offset:13888
ds_read_b64_tr_b16 a[160:161], v129 offset:12288
v_mfma_f32_16x16x32_bf16 v[150:153], a[224:227], v[110:113], v[150:153]
ds_read_b64_tr_b16 a[184:185], v129 offset:12320
ds_read_b64_tr_b16 a[208:209], v129 offset:12352
v_mfma_f32_16x16x32_bf16 v[150:153], a[228:231], v[220:223], v[150:153]
ds_read_b128 v[84:87], v200
ds_read_b128 v[92:95], v201
v_mfma_f32_16x16x32_bf16 v[154:157], a[248:251], v[110:113], v[154:157]
ds_read_b128 v[100:103], v202
ds_read_b128 v[88:91], v194 offset:16
v_mfma_f32_16x16x32_bf16 v[154:157], a[252:255], v[220:223], v[154:157]
s_waitcnt lgkmcnt(10)
s_add_u32 m0, s55, 69888
s_add_u32 s29, s54, 24576
buffer_load_dwordx4 v136, s[16:19], s29 offen lds
v_mfma_f32_16x16x32_bf16 v[158:161], v[240:243], v[110:113], v[158:161]
s_add_u32 m0, s55, 70912
s_add_u32 s29, s54, 24576
buffer_load_dwordx4 v137, s[16:19], s29 offen lds
v_mfma_f32_16x16x32_bf16 v[158:161], v[244:247], v[220:223], v[158:161]
s_add_u32 m0, s55, 71936
s_add_u32 s29, s54, 24576
buffer_load_dwordx4 v128, s[16:19], s29 offen lds
s_waitcnt lgkmcnt(3)
v_mfma_f32_16x16x32_bf16 v[36:39], v[174:177], v[84:87], 0
s_waitcnt lgkmcnt(2)
s_add_u32 m0, s55, 82176
s_add_u32 s29, s54, 36864
buffer_load_dwordx4 v136, s[16:19], s29 offen lds
v_mfma_f32_16x16x32_bf16 v[48:51], v[174:177], v[92:95], 0
s_waitcnt lgkmcnt(1)
s_add_u32 m0, s55, 83200
s_add_u32 s29, s54, 36864
buffer_load_dwordx4 v137, s[16:19], s29 offen lds
v_mfma_f32_16x16x32_bf16 v[60:63], v[174:177], v[100:103], 0
s_add_u32 m0, s55, 84224
s_add_u32 s29, s54, 36864
buffer_load_dwordx4 v128, s[16:19], s29 offen lds
v_mfma_f32_16x16x32_bf16 v[162:165], v[110:113], a[80:83], v[162:165]
ds_read_b128 v[84:87], v194
ds_read_b128 v[92:95], v195
v_mfma_f32_16x16x32_bf16 v[162:165], v[220:223], a[84:87], v[162:165]
ds_read_b128 v[100:103], v196
ds_read_b128 v[96:99], v195 offset:16
v_mfma_f32_16x16x32_bf16 v[166:169], v[110:113], a[104:107], v[166:169]
ds_read_b128 v[104:107], v196 offset:16
ds_read_b128 v[174:177], v217 offset:1056
v_mfma_f32_16x16x32_bf16 v[166:169], v[220:223], a[108:111], v[166:169]
s_mov_b32 exec_lo, 0x1
s_mov_b32 exec_hi, 0x0
ds_write_b32 v132, v178 offset:22784
s_mov_b64 exec, -1
v_mfma_f32_16x16x32_bf16 v[170:173], v[110:113], a[128:131], v[170:173]
ds_read_b128 v[110:113], v210 offset:6144
v_mfma_f32_16x16x32_bf16 v[170:173], v[220:223], a[132:135], v[170:173]
ds_read_b128 v[220:223], v210 offset:7168
v_mfma_f32_16x16x32_bf16 v[138:141], a[16:19], v[182:185], v[138:141]
s_mov_b32 exec_lo, 0x2
s_mov_b32 exec_hi, 0x0
ds_write_b32 v132, v179 offset:22784
s_mov_b64 exec, -1
v_mfma_f32_16x16x32_bf16 v[138:141], a[20:23], v[186:189], v[138:141]
s_nop 0
s_mov_b32 exec_lo, 0x4
s_mov_b32 exec_hi, 0x0
ds_write_b32 v132, v180 offset:22784
s_mov_b64 exec, -1
v_mfma_f32_16x16x32_bf16 v[142:145], a[40:43], v[182:185], v[142:145]
v_cvt_pk_bf16_f32 v78, v138, v139
v_cvt_pk_bf16_f32 v79, v140, v141
v_mfma_f32_16x16x32_bf16 v[142:145], a[44:47], v[186:189], v[142:145]
s_mov_b32 exec_lo, 0x8
s_mov_b32 exec_hi, 0x0
ds_write_b32 v132, v181 offset:22784
s_mov_b64 exec, -1
v_mfma_f32_16x16x32_bf16 v[146:149], a[64:67], v[182:185], v[146:149]
ds_read_b128 v[178:181], v217 offset:528
v_cvt_pk_bf16_f32 v80, v142, v143
v_mfma_f32_16x16x32_bf16 v[146:149], a[68:71], v[186:189], v[146:149]
s_nop 0
v_cvt_pk_bf16_f32 v81, v144, v145
v_mfma_f32_16x16x32_bf16 v[150:153], a[232:235], v[182:185], v[150:153]
v_mfma_f32_16x16x32_bf16 v[150:153], a[236:239], v[186:189], v[150:153]
v_cvt_pk_bf16_f32 v82, v146, v147
v_cvt_pk_bf16_f32 v83, v148, v149
v_mfma_f32_16x16x32_bf16 v[154:157], v[224:227], v[182:185], v[154:157]
v_mfma_f32_16x16x32_bf16 v[154:157], v[228:231], v[186:189], v[154:157]
v_cvt_pk_bf16_f32 v72, v150, v151
v_cvt_pk_bf16_f32 v73, v152, v153
v_mfma_f32_16x16x32_bf16 v[158:161], v[248:251], v[182:185], v[158:161]
s_waitcnt lgkmcnt(0)
v_smfmac_f32_16x16x64_bf16 v[36:39], v[178:181], v[84:91], v213
s_nop 0
ds_read_b128 v[84:87], v197
ds_read_b128 v[88:91], v197 offset:16
v_smfmac_f32_16x16x64_bf16 v[48:51], v[178:181], v[92:99], v213
ds_read_b128 v[92:95], v198
ds_read_b128 v[96:99], v198 offset:16
v_smfmac_f32_16x16x64_bf16 v[60:63], v[178:181], v[100:107], v213
ds_read_b128 v[100:103], v199
ds_read_b128 v[104:107], v199 offset:16
v_mfma_f32_16x16x32_bf16 v[158:161], v[252:255], v[186:189], v[158:161]
ds_read_b128 v[178:181], v217 offset:1584
v_cvt_pk_bf16_f32 v74, v154, v155
v_mfma_f32_16x16x32_bf16 v[162:165], v[182:185], a[88:91], v[162:165]
v_cvt_pk_bf16_f32 v75, v156, v157
v_mfma_f32_16x16x32_bf16 v[162:165], v[186:189], a[92:95], v[162:165]
v_cvt_pk_bf16_f32 v76, v158, v159
v_cvt_pk_bf16_f32 v77, v160, v161
v_mfma_f32_16x16x32_bf16 v[166:169], v[182:185], a[112:115], v[166:169]
s_waitcnt lgkmcnt(5)
v_smfmac_f32_16x16x64_bf16 v[36:39], v[174:177], v[84:91], v213
s_nop 0
ds_read_b128 v[84:87], v200 offset:32
ds_read_b128 v[88:91], v194 offset:48
v_mfma_f32_16x16x32_bf16 v[166:169], v[186:189], a[116:119], v[166:169]
v_cvt_pk_bf16_f32 v114, v162, v163
v_cvt_pk_bf16_f32 v115, v164, v165
v_mfma_f32_16x16x32_bf16 v[170:173], v[182:185], a[136:139], v[170:173]
s_waitcnt lgkmcnt(5)
ds_read_b128 v[182:185], v210 offset:8192
v_mul_f32 v119, v36, v36
v_smfmac_f32_16x16x64_bf16 v[48:51], v[174:177], v[92:99], v213
s_waitcnt vmcnt(4)
ds_read_b64_tr_b16 a[150:151], v129
ds_read_b64_tr_b16 a[174:175], v129 offset:32
v_mfma_f32_16x16x32_bf16 v[170:173], v[186:189], a[140:143], v[170:173]
s_waitcnt lgkmcnt(6)
ds_read_b64_tr_b16 a[198:199], v129 offset:64
ds_read_b128 v[92:95], v201 offset:32
v_smfmac_f32_16x16x64_bf16 v[60:63], v[174:177], v[100:107], v213
s_nop 0
ds_read_b128 v[100:103], v202 offset:32
ds_read_b128 v[174:177], v217 offset:2112
v_mfma_f32_16x16x32_bf16 v[138:141], a[0:3], v[110:113], 0
s_waitcnt lgkmcnt(8)
ds_read_b128 v[96:99], v195 offset:48
ds_read_b128 v[104:107], v196 offset:48
v_mfma_f32_16x16x32_bf16 v[40:43], v[178:181], v[84:87], 0
ds_read_b128 v[84:87], v194 offset:32
v_mul_f32 v135, v60, v60
v_mfma_f32_16x16x32_bf16 v[138:141], a[4:7], v[220:223], v[138:141]
s_waitcnt vmcnt(3)
ds_read_b64_tr_b16 a[162:163], v129 offset:1536
ds_read_b64_tr_b16 a[186:187], v129 offset:1568
v_mfma_f32_16x16x32_bf16 v[142:145], a[24:27], v[110:113], 0
ds_read_b64_tr_b16 a[210:211], v129 offset:1600
ds_read_b128 v[186:189], v210 offset:9216
v_mfma_f32_16x16x32_bf16 v[142:145], a[28:31], v[220:223], v[142:145]
s_waitcnt lgkmcnt(9)
v_mul_f32 v127, v48, v48
v_add_f32 v134, v60, v61
v_mfma_f32_16x16x32_bf16 v[52:55], v[178:181], v[92:95], 0
s_waitcnt lgkmcnt(8)
ds_read_b128 v[92:95], v195 offset:32
v_fmac_f32_e64 v135, v61, v61
v_mfma_f32_16x16x32_bf16 v[64:67], v[178:181], v[100:103], 0
ds_read_b128 v[100:103], v196 offset:32
ds_read_b128 v[178:181], v217 offset:2640
v_mfma_f32_16x16x32_bf16 v[146:149], a[48:51], v[110:113], 0
v_add_f32 v118, v36, v37
v_fmac_f32 v119, v37, v37
v_mfma_f32_16x16x32_bf16 v[146:149], a[52:55], v[220:223], v[146:149]
v_add_f32 v126, v48, v49
v_fmac_f32 v127, v49, v49
v_mfma_f32_16x16x32_bf16 v[150:153], a[216:219], v[110:113], 0
s_waitcnt lgkmcnt(7)
v_add_f32 v134, v134, v62
v_fmac_f32_e64 v135, v62, v62
v_smfmac_f32_16x16x64_bf16 v[40:43], v[174:177], v[84:91], v213
s_nop 0
ds_read_b128 v[84:87], v197 offset:32
ds_read_b128 v[88:91], v197 offset:48
v_mfma_f32_16x16x32_bf16 v[150:153], a[220:223], v[220:223], v[150:153]
s_waitcnt lgkmcnt(6)
s_add_u32 m0, s55, 69888
s_add_u32 s29, s54, 49152
buffer_load_dwordx4 v136, s[16:19], s29 offen lds
v_mfma_f32_16x16x32_bf16 v[154:157], a[240:243], v[110:113], 0
s_waitcnt lgkmcnt(4)
s_add_u32 m0, s55, 70912
s_add_u32 s29, s54, 49152
buffer_load_dwordx4 v137, s[16:19], s29 offen lds
v_smfmac_f32_16x16x64_bf16 v[52:55], v[174:177], v[92:99], v213
s_waitcnt lgkmcnt(3)
s_add_u32 m0, s55, 71936
s_add_u32 s29, s54, 49152
buffer_load_dwordx4 v128, s[16:19], s29 offen lds
v_smfmac_f32_16x16x64_bf16 v[64:67], v[174:177], v[100:107], v213
s_waitcnt vmcnt(4)
ds_read_b64_tr_b16 a[152:153], v129 offset:12288
ds_read_b64_tr_b16 a[176:177], v129 offset:12320
v_mfma_f32_16x16x32_bf16 v[154:157], a[244:247], v[220:223], v[154:157]
s_waitcnt vmcnt(3) lgkmcnt(2)
ds_read_b64_tr_b16 a[200:201], v129 offset:12352
ds_read_b64_tr_b16 a[154:155], v129 offset:13824
v_smfmac_f32_16x16x64_bf16 v[40:43], v[178:181], v[84:91], v213
ds_read_b64_tr_b16 a[178:179], v129 offset:13856
ds_read_b64_tr_b16 a[202:203], v129 offset:13888
v_mfma_f32_16x16x32_bf16 v[158:161], v[232:235], v[110:113], 0
ds_read_b128 v[92:95], v198 offset:32
ds_read_b128 v[100:103], v199 offset:32
v_mfma_f32_16x16x32_bf16 v[158:161], v[236:239], v[220:223], v[158:161]
ds_read_b128 v[96:99], v198 offset:48
ds_read_b128 v[104:107], v199 offset:48
v_mfma_f32_16x16x32_bf16 v[162:165], v[110:113], a[72:75], 0
ds_read_b128 v[84:87], v200 offset:64
ds_read_b128 v[174:177], v217 offset:3168
v_mfma_f32_16x16x32_bf16 v[162:165], v[220:223], a[76:79], v[162:165]
ds_read_b128 v[88:91], v194 offset:80
v_add_f32_e64 v118, v118, v38
v_mfma_f32_16x16x32_bf16 v[138:141], a[8:11], v[182:185], v[138:141]
v_fmac_f32_e64 v119, v38, v38
v_add_f32 v126, v126, v50
v_mfma_f32_16x16x32_bf16 v[138:141], a[12:15], v[186:189], v[138:141]
s_waitcnt lgkmcnt(7)
s_add_u32 m0, s55, 82176
s_add_u32 s29, s54, 61440
buffer_load_dwordx4 v136, s[16:19], s29 offen lds
v_mfma_f32_16x16x32_bf16 v[142:145], a[32:35], v[182:185], v[142:145]
s_add_u32 m0, s55, 83200
s_add_u32 s29, s54, 61440
buffer_load_dwordx4 v137, s[16:19], s29 offen lds
v_mfma_f32_16x16x32_bf16 v[142:145], a[36:39], v[186:189], v[142:145]
s_waitcnt lgkmcnt(4)
s_add_u32 m0, s55, 84224
s_add_u32 s29, s54, 61440
buffer_load_dwordx4 v128, s[16:19], s29 offen lds
v_smfmac_f32_16x16x64_bf16 v[52:55], v[178:181], v[92:99], v213
s_waitcnt lgkmcnt(3)
ds_read_b128 v[92:95], v201 offset:64
ds_read_b128 v[96:99], v195 offset:80
v_smfmac_f32_16x16x64_bf16 v[64:67], v[178:181], v[100:107], v213
s_waitcnt lgkmcnt(3)
ds_read_b128 v[100:103], v202 offset:64
ds_read_b128 v[178:181], v217 offset:3696
v_mfma_f32_16x16x32_bf16 v[44:47], v[174:177], v[84:87], 0
s_add_u32 m0, s45, 0
ds_read_b128 v[84:87], v194 offset:64
ds_read_b128 v[104:107], v196 offset:80
v_mfma_f32_16x16x32_bf16 v[146:149], a[56:59], v[182:185], v[146:149]
s_add_u32 s29, s38, s61
v_fmac_f32 v127, v50, v50
v_add_f32_e64 v134, v134, v63
v_mfma_f32_16x16x32_bf16 v[146:149], a[60:63], v[186:189], v[146:149]
v_fmac_f32 v135, v63, v63
v_add_f32 v118, v118, v39
v_mfma_f32_16x16x32_bf16 v[150:153], a[224:227], v[182:185], v[150:153]
v_fmac_f32 v119, v39, v39
v_add_f32 v126, v126, v51
v_mfma_f32_16x16x32_bf16 v[150:153], a[228:231], v[186:189], v[150:153]
s_waitcnt lgkmcnt(5)
v_fmac_f32 v127, v51, v51
v_add_f32_e64 v134, v134, v64
v_mfma_f32_16x16x32_bf16 v[56:59], v[174:177], v[92:95], 0
ds_read_b128 v[92:95], v195 offset:64
v_fmac_f32_e64 v135, v64, v64
v_mfma_f32_16x16x32_bf16 v[154:157], a[248:251], v[182:185], v[154:157]
s_waitcnt lgkmcnt(4)
v_add_f32 v118, v118, v40
v_fmac_f32_e64 v119, v40, v40
v_mfma_f32_16x16x32_bf16 v[68:71], v[174:177], v[100:103], 0
ds_read_b128 v[100:103], v196 offset:64
ds_read_b128 v[174:177], v217 offset:4224
v_mfma_f32_16x16x32_bf16 v[154:157], a[252:255], v[186:189], v[154:157]
s_waitcnt lgkmcnt(4)
v_add_f32 v126, v126, v52
v_fmac_f32_e64 v127, v52, v52
v_smfmac_f32_16x16x64_bf16 v[44:47], v[178:181], v[84:91], v213
ds_read_b128 v[84:87], v197 offset:64
ds_read_b128 v[88:91], v197 offset:80
v_mfma_f32_16x16x32_bf16 v[158:161], v[240:243], v[182:185], v[158:161]
v_add_f32 v134, v134, v65
v_fmac_f32 v135, v65, v65
v_mfma_f32_16x16x32_bf16 v[158:161], v[244:247], v[186:189], v[158:161]
s_waitcnt lgkmcnt(4)
v_add_f32 v118, v118, v41
v_fmac_f32_e64 v119, v41, v41
v_smfmac_f32_16x16x64_bf16 v[56:59], v[178:181], v[92:99], v213
ds_read_b128 v[92:95], v198 offset:64
ds_read_b128 v[96:99], v198 offset:80
v_mfma_f32_16x16x32_bf16 v[162:165], v[182:185], a[80:83], v[162:165]
s_waitcnt lgkmcnt(5)
v_add_f32 v126, v126, v53
v_fmac_f32_e64 v127, v53, v53
v_smfmac_f32_16x16x64_bf16 v[68:71], v[178:181], v[100:107], v213
ds_read_b128 v[100:103], v199 offset:64
ds_read_b128 v[104:107], v199 offset:80
v_mfma_f32_16x16x32_bf16 v[162:165], v[186:189], a[84:87], v[162:165]
v_add_f32 v134, v134, v66
v_fmac_f32 v135, v66, v66
v_add_f32_e64 v118, v118, v42
v_fmac_f32 v119, v42, v42
s_waitcnt lgkmcnt(4)
v_smfmac_f32_16x16x64_bf16 v[44:47], v[174:177], v[84:91], v213
v_add_f32 v126, v126, v54
v_fmac_f32 v127, v54, v54
v_add_f32 v134, v134, v67
v_fmac_f32 v135, v67, v67
v_add_f32 v118, v118, v43
v_fmac_f32 v119, v43, v43
v_add_f32_e64 v126, v126, v55
v_fmac_f32 v127, v55, v55
s_waitcnt lgkmcnt(2)
v_smfmac_f32_16x16x64_bf16 v[56:59], v[174:177], v[92:99], v213
v_add_f32 v118, v118, v44
v_fmac_f32 v119, v44, v44
v_add_f32 v118, v118, v45
v_fmac_f32 v119, v45, v45
s_waitcnt lgkmcnt(0)
v_smfmac_f32_16x16x64_bf16 v[68:71], v[174:177], v[100:107], v213
s_waitcnt vmcnt(4)
ds_read_b64_tr_b16 a[164:165], v129
ds_read_b64_tr_b16 a[188:189], v129 offset:32
v_add_f32 v126, v126, v56
ds_read_b64_tr_b16 a[212:213], v129 offset:64
v_fmac_f32 v127, v56, v56
s_nop 1
v_add_f32 v134, v134, v68
v_fmac_f32 v135, v68, v68
v_add_f32 v134, v134, v69
v_fmac_f32 v135, v69, v69
v_add_f32 v126, v126, v57
v_fmac_f32 v127, v57, v57
s_waitcnt vmcnt(3)
ds_read_b64_tr_b16 a[156:157], v129 offset:1536
ds_read_b64_tr_b16 a[180:181], v129 offset:1568
v_add_f32 v134, v134, v70
ds_read_b64_tr_b16 a[204:205], v129 offset:1600
v_fmac_f32 v135, v70, v70
v_add_f32 v118, v118, v46
v_fmac_f32 v119, v46, v46
v_add_f32 v126, v126, v58
v_fmac_f32 v127, v58, v58
v_add_f32 v134, v134, v71
v_fmac_f32 v135, v71, v71
v_add_f32 v118, v118, v47
v_fmac_f32 v119, v47, v47
v_add_f32 v126, v126, v59
v_fmac_f32 v127, v59, v59
v_permlane16_swap_b32 v134, v135
v_permlane16_swap_b32 v118, v119
v_permlane16_swap_b32 v126, v127
v_add_f32 v134, v134, v135
v_add_f32 v118, v118, v119
v_add_f32 v126, v126, v127
v_mov_b32_e64 v135, v134
v_cvt_pk_bf16_f32 v122, v166, v167
v_permlane32_swap_b32 v118, v126
v_permlane32_swap_b32 v134, v135
v_add_f32_e64 v118, v118, v126
v_add_f32 v134, v134, v135
s_waitcnt vmcnt(1)
ds_read_b64_tr_b16 a[158:159], v129 offset:12288
ds_read_b64_tr_b16 a[182:183], v129 offset:12320
v_cvt_pk_bf16_f32 v123, v168, v169
v_mfma_f32_16x16x32_bf16 v[166:169], v[110:113], a[96:99], 0
ds_read_b64_tr_b16 a[206:207], v129 offset:12352
v_cvt_pk_bf16_f32 v130, v170, v171
v_mfma_f32_16x16x32_bf16 v[166:169], v[220:223], a[100:103], v[166:169]
ds_write_b32 v209, v118
v_mfma_f32_16x16x32_bf16 v[166:169], v[182:185], a[104:107], v[166:169]
s_nop 0
ds_write_b32 v209, v134 offset:512
v_mfma_f32_16x16x32_bf16 v[166:169], v[186:189], a[108:111], v[166:169]
s_waitcnt vmcnt(0)
ds_read_b64_tr_b16 a[166:167], v129 offset:13824
ds_read_b64_tr_b16 a[190:191], v129 offset:13856
v_cvt_pk_bf16_f32 v131, v172, v173
v_mfma_f32_16x16x32_bf16 v[170:173], v[110:113], a[120:123], 0
ds_read_b64_tr_b16 a[214:215], v129 offset:13888
ds_read_b128 v[110:113], v210 offset:10240
v_mfma_f32_16x16x32_bf16 v[170:173], v[220:223], a[124:127], v[170:173]
v_mfma_f32_16x16x32_bf16 v[170:173], v[182:185], a[128:131], v[170:173]
ds_read_b128 v[182:185], v210 offset:12288
v_mfma_f32_16x16x32_bf16 v[170:173], v[186:189], a[132:135], v[170:173]
ds_read_b128 v[186:189], v210 offset:13312
s_waitcnt lgkmcnt(3)
s_barrier
buffer_load_dwordx4 v216, s[4:7], s52 offen nt lds
s_add_u32 m0, s45, 4112
s_waitcnt lgkmcnt(2)
v_mfma_f32_16x16x32_bf16 v[138:141], a[16:19], v[110:113], v[138:141]
s_add_u32 s52, s50, s41
ds_read_b128 v[102:105], v210 offset:18432
ds_read_b128 v[106:109], v210 offset:19456
v_mfma_f32_16x16x32_bf16 v[142:145], a[40:43], v[110:113], v[142:145]
v_mfma_f32_16x16x32_bf16 v[146:149], a[64:67], v[110:113], v[146:149]
v_mfma_f32_16x16x32_bf16 v[150:153], a[232:235], v[110:113], v[150:153]
v_mfma_f32_16x16x32_bf16 v[154:157], v[224:227], v[110:113], v[154:157]
v_mfma_f32_16x16x32_bf16 v[158:161], v[248:251], v[110:113], v[158:161]
s_waitcnt lgkmcnt(1)
v_add_f32 v102, v102, v103
v_mfma_f32_16x16x32_bf16 v[162:165], v[110:113], a[88:91], v[162:165]
v_add_f32 v104, v104, v105
v_add_f32 v102, v102, v104
v_mfma_f32_16x16x32_bf16 v[166:169], v[110:113], a[112:115], v[166:169]
s_waitcnt lgkmcnt(0)
v_add_f32 v106, v106, v107
v_add_f32_e64 v108, v108, v109
v_mfma_f32_16x16x32_bf16 v[170:173], v[110:113], a[136:139], v[170:173]
buffer_load_dwordx4 v216, s[4:7], s40 offen nt lds
v_add_f32 v106, v106, v108
v_mul_f32 v103, s48, v102
v_mul_f32 v104, s73, v102
v_mul_f32 v106, s73, v106
v_fma_f32 v106, -v103, v104, v106
v_max_f32 v106, 0, v106
v_add_f32 v106, s49, v106
v_rsq_f32_e64 v102, v106
ds_read_b128 v[106:109], v210 offset:11264
ds_read_b64 v[112:113], v215 offset:528
s_add_u32 m0, s45, 8224
s_add_u32 s40, s36, 392448
v_mul_f32_e64 v103, -v103, v102
ds_write_b64 v211, v[102:103] offset:20480
ds_read_b64 v[118:119], v219 offset:20480
ds_read_b64 v[126:127], v219 offset:20736
s_waitcnt lgkmcnt(4)
v_mfma_f32_16x16x32_bf16 v[138:141], a[20:23], v[106:109], v[138:141]
s_nop 0
buffer_load_dwordx4 v216, s[4:7], s40 offen nt lds
v_mfma_f32_16x16x32_bf16 v[142:145], a[44:47], v[106:109], v[142:145]
s_add_u32 m0, s45, 12336
ds_read_b64 v[134:135], v219 offset:20992
s_add_u32 s40, s36, 588672
v_mfma_f32_16x16x32_bf16 v[146:149], a[68:71], v[106:109], v[146:149]
s_nop 0
v_cvt_pk_bf16_f32 v96, v138, v139
v_cvt_pk_bf16_f32 v97, v140, v141
v_mfma_f32_16x16x32_bf16 v[150:153], a[236:239], v[106:109], v[150:153]
s_waitcnt lgkmcnt(2)
v_fma_f32 v220, v36, v118, v119
v_fma_f32 v221, v37, v118, v119
v_mfma_f32_16x16x32_bf16 v[154:157], v[228:231], v[106:109], v[154:157]
v_cvt_pk_bf16_f32 v100, v146, v147
v_cvt_pk_bf16_f32 v101, v148, v149
v_mfma_f32_16x16x32_bf16 v[158:161], v[252:255], v[106:109], v[158:161]
v_cvt_pk_bf16_f32 v84, v150, v151
v_cvt_pk_bf16_f32 v85, v152, v153
v_mfma_f32_16x16x32_bf16 v[162:165], v[106:109], a[92:95], v[162:165]
v_fma_f32 v222, v38, v118, v119
v_fma_f32 v223, v39, v118, v119
v_mfma_f32_16x16x32_bf16 v[166:169], v[106:109], a[116:119], v[166:169]
v_cvt_pk_bf16_f32 v174, v220, v221
v_cvt_pk_bf16_f32 v175, v222, v223
v_mfma_f32_16x16x32_bf16 v[170:173], v[106:109], a[140:143], v[170:173]
ds_read_b128 v[108:111], v215 offset:512
v_cvt_pk_bf16_f32 v98, v142, v143
v_mfma_f32_16x16x32_bf16 v[138:141], a[0:3], v[182:185], 0
buffer_load_dwordx4 v216, s[4:7], s40 offen nt lds
v_mfma_f32_16x16x32_bf16 v[138:141], a[4:7], v[186:189], v[138:141]
s_add_u32 m0, s45, 16448
v_cvt_pk_bf16_f32 v99, v144, v145
v_fma_f32 v220, v40, v118, v119
v_mfma_f32_16x16x32_bf16 v[142:145], a[24:27], v[182:185], 0
s_add_u32 s40, s36, 784896
v_fma_f32 v221, v41, v118, v119
v_fma_f32 v222, v42, v118, v119
v_mfma_f32_16x16x32_bf16 v[142:145], a[28:31], v[186:189], v[142:145]
v_fma_f32 v223, v43, v118, v119
v_cvt_pk_bf16_f32 v176, v220, v221
v_mfma_f32_16x16x32_bf16 v[146:149], a[48:51], v[182:185], 0
s_nop 0
ds_read_b128 v[182:185], v210 offset:16384
v_cvt_pk_bf16_f32 v177, v222, v223
v_mfma_f32_16x16x32_bf16 v[146:149], a[52:55], v[186:189], v[146:149]
s_waitcnt lgkmcnt(1)
ds_write_b128 v211, v[174:177] offset:20480
v_mfma_f32_16x16x16_bf16 v[150:153], v[112:113], v[76:77], v[206:209]
v_fma_f32 v220, v44, v118, v119
v_fma_f32 v221, v45, v118, v119
v_fma_f32 v222, v46, v118, v119
v_fma_f32 v223, v47, v118, v119
v_cvt_pk_bf16_f32 v178, v220, v221
v_cvt_pk_bf16_f32 v179, v222, v223
v_mfma_f32_16x16x32_bf16 v[150:153], v[108:111], v[72:75], v[150:153]
s_nop 0
ds_read_b128 v[174:177], v210 offset:14336
ds_write_b64 v212, v[178:179] offset:20480
v_cvt_pk_bf16_f32 v88, v158, v159
v_cvt_pk_bf16_f32 v89, v160, v161
s_waitcnt lgkmcnt(3)
v_mfma_f32_16x16x32_bf16 v[118:121], v[182:185], a[88:91], 0
buffer_load_dwordx4 v216, s[4:7], s40 offen nt lds
ds_read_b128 v[178:181], v210 offset:15360
v_mfma_f32_16x16x16_bf16 v[158:161], v[100:101], v[88:89], 0
ds_read_b128 v[186:189], v210 offset:17408
s_add_u32 m0, s45, 20560
s_add_u32 s40, s36, 981120
v_cvt_pk_bf16_f32 v86, v154, v155
v_cvt_pk_bf16_f32 v87, v156, v157
v_mfma_f32_16x16x16_bf16 v[154:157], v[82:83], v[88:89], 0
v_cvt_pk_bf16_f32 v124, v166, v167
v_cvt_pk_bf16_f32 v125, v168, v169
v_cvt_pk_bf16_f32 v116, v162, v163
v_mfma_f32_16x16x16_bf16 v[166:169], v[112:113], v[88:89], v[206:209]
v_cvt_pk_bf16_f32 v117, v164, v165
v_fma_f32 v220, v48, v126, v127
v_fma_f32 v221, v49, v126, v127
v_fma_f32 v222, v50, v126, v127
v_mfma_f32_16x16x32_bf16 v[154:157], v[78:81], v[84:87], v[154:157]
s_waitcnt lgkmcnt(3)
v_fma_f32 v223, v51, v126, v127
v_cvt_pk_bf16_f32 v90, v220, v221
v_mfma_f32_16x16x32_bf16 v[138:141], a[8:11], v[174:177], v[138:141]
s_waitcnt lgkmcnt(1)
v_cvt_pk_bf16_f32 v91, v222, v223
v_fma_f32 v220, v52, v126, v127
v_mfma_f32_16x16x32_bf16 v[138:141], a[12:15], v[178:181], v[138:141]
v_fma_f32 v221, v53, v126, v127
v_fma_f32 v222, v54, v126, v127
v_mfma_f32_16x16x32_bf16 v[158:161], v[96:99], v[84:87], v[158:161]
v_fma_f32 v223, v55, v126, v127
v_cvt_pk_bf16_f32 v92, v220, v221
v_mfma_f32_16x16x32_bf16 v[166:169], v[108:111], v[84:87], v[166:169]
buffer_load_dwordx4 v216, s[4:7], s40 offen nt lds
v_mfma_f32_16x16x32_bf16 v[142:145], a[32:35], v[174:177], v[142:145]
s_add_u32 m0, s45, 24672
v_cvt_pk_bf16_f32 v93, v222, v223
v_fma_f32 v220, v56, v126, v127
v_mfma_f32_16x16x32_bf16 v[142:145], a[36:39], v[178:181], v[142:145]
s_add_u32 s40, s36, 1177344
ds_write_b128 v211, v[90:93] offset:26624
v_mfma_f32_16x16x32_bf16 v[146:149], a[56:59], v[174:177], v[146:149]
s_nop 0
v_fma_f32 v221, v57, v126, v127
v_fma_f32 v222, v58, v126, v127
v_mfma_f32_16x16x32_bf16 v[146:149], a[60:63], v[178:181], v[146:149]
s_waitcnt lgkmcnt(1)
v_fma_f32 v223, v59, v126, v127
v_cvt_pk_bf16_f32 v94, v220, v221
v_mfma_f32_16x16x32_bf16 v[118:121], v[186:189], a[92:95], v[118:121]
v_cvt_pk_bf16_f32 v95, v222, v223
v_fma_f32 v220, v60, v134, v135
v_mfma_f32_16x16x32_bf16 v[126:129], v[182:185], a[112:115], 0
v_fma_f32 v221, v61, v134, v135
v_fma_f32 v222, v62, v134, v135
v_mfma_f32_16x16x32_bf16 v[126:129], v[186:189], a[116:119], v[126:129]
v_fma_f32 v223, v63, v134, v135
v_cvt_pk_bf16_f32 v90, v220, v221
v_mfma_f32_16x16x32_bf16 v[126:129], v[174:177], a[104:107], v[126:129]
v_cvt_pk_bf16_f32 v91, v222, v223
v_fma_f32 v220, v64, v134, v135
v_mfma_f32_16x16x32_bf16 v[138:141], a[16:19], v[182:185], v[138:141]
buffer_load_dwordx4 v216, s[4:7], s40 offen nt lds
v_mfma_f32_16x16x32_bf16 v[138:141], a[20:23], v[186:189], v[138:141]
s_add_u32 m0, s45, 28784
v_fma_f32 v221, v65, v134, v135
v_fma_f32 v222, v66, v134, v135
v_mfma_f32_16x16x32_bf16 v[118:121], v[174:177], a[80:83], v[118:121]
s_add_u32 s40, s36, 1373568
v_fma_f32 v223, v67, v134, v135
v_cvt_pk_bf16_f32 v92, v220, v221
v_mfma_f32_16x16x32_bf16 v[118:121], v[178:181], a[84:87], v[118:121]
v_cvt_pk_bf16_f32 v102, v138, v139
v_cvt_pk_bf16_f32 v103, v140, v141
v_mfma_f32_16x16x16_bf16 v[138:141], v[82:83], v[76:77], 0
v_cvt_pk_bf16_f32 v93, v222, v223
v_fma_f32 v220, v68, v134, v135
v_fma_f32 v221, v69, v134, v135
v_fma_f32 v222, v70, v134, v135
v_mfma_f32_16x16x32_bf16 v[126:129], v[178:181], a[108:111], v[126:129]
ds_write_b128 v211, v[90:93] offset:32768
v_mfma_f32_16x16x32_bf16 v[138:141], v[78:81], v[72:75], v[138:141]
v_fma_f32 v223, v71, v134, v135
v_cvt_pk_bf16_f32 v132, v170, v171
v_mfma_f32_16x16x32_bf16 v[134:137], v[182:185], a[136:139], 0
v_cvt_pk_bf16_f32 v133, v172, v173
v_mfma_f32_16x16x32_bf16 v[134:137], v[186:189], a[140:143], v[134:137]
buffer_load_dwordx4 v216, s[4:7], s40 offen nt lds
v_mfma_f32_16x16x32_bf16 v[90:93], a[232:235], v[182:185], 0
s_add_u32 m0, s45, 32896
ds_write_b64 v212, v[94:95] offset:26624
v_mfma_f32_16x16x32_bf16 v[90:93], a[236:239], v[186:189], v[90:93]
s_add_u32 s40, s36, 1569792
v_exp_f32 v138, v138
v_mfma_f32_16x16x32_bf16 v[170:173], v[224:227], v[182:185], 0
v_exp_f32 v139, v139
v_mfma_f32_16x16x32_bf16 v[170:173], v[228:231], v[186:189], v[170:173]
v_exp_f32 v140, v140
v_mfma_f32_16x16x32_bf16 v[170:173], a[248:251], v[174:177], v[170:173]
v_exp_f32 v141, v141
v_mfma_f32_16x16x32_bf16 v[142:145], a[40:43], v[182:185], v[142:145]
v_exp_f32 v154, v154
v_mfma_f32_16x16x32_bf16 v[142:145], a[44:47], v[186:189], v[142:145]
v_exp_f32 v155, v155
v_mfma_f32_16x16x32_bf16 v[134:137], v[174:177], a[128:131], v[134:137]
v_exp_f32_e64 v156, v156
v_mfma_f32_16x16x32_bf16 v[134:137], v[178:181], a[132:135], v[134:137]
v_cvt_pk_bf16_f32 v104, v142, v143
v_cvt_pk_bf16_f32 v105, v144, v145
v_mfma_f32_16x16x16_bf16 v[142:145], v[100:101], v[76:77], 0
buffer_load_dwordx4 v216, s[4:7], s40 offen nt lds
v_exp_f32 v157, v157
v_mfma_f32_16x16x32_bf16 v[90:93], a[224:227], v[174:177], v[90:93]
s_add_u32 m0, s45, 0
v_exp_f32_e64 v158, v158
v_mfma_f32_16x16x32_bf16 v[142:145], v[96:99], v[72:75], v[142:145]
s_add_u32 s40, s37, 196224
v_exp_f32 v159, v159
v_mfma_f32_16x16x32_bf16 v[90:93], a[228:231], v[178:181], v[90:93]
v_exp_f32 v160, v160
v_mfma_f32_16x16x32_bf16 v[146:149], a[64:67], v[182:185], v[146:149]
v_exp_f32 v142, v142
v_mfma_f32_16x16x32_bf16 v[146:149], a[68:71], v[186:189], v[146:149]
v_exp_f32 v143, v143
v_mfma_f32_16x16x32_bf16 v[170:173], a[252:255], v[178:181], v[170:173]
v_exp_f32 v144, v144
v_exp_f32 v145, v145
v_cvt_pk_bf16_f32 v106, v146, v147
v_cvt_pk_bf16_f32 v107, v148, v149
v_exp_f32 v161, v161
v_mfma_f32_16x16x16_bf16 v[146:149], v[106:107], v[76:77], 0
v_exp_f32 v150, v150
v_cvt_pk_bf16_f32 v94, v220, v221
v_mfma_f32_16x16x16_bf16 v[162:165], v[106:107], v[88:89], 0
v_exp_f32 v166, v166
v_cvt_pk_bf16_f32 v95, v222, v223
v_and_b32 v216, s44, v208
v_mfma_f32_16x16x32_bf16 v[146:149], v[102:105], v[72:75], v[146:149]
ds_write_b64 v212, v[94:95] offset:32768
v_mfma_f32_16x16x32_bf16 v[162:165], v[102:105], v[84:87], v[162:165]
v_mfma_f32_16x16x32_bf16 v[220:223], v[248:251], v[182:185], 0
v_exp_f32 v146, v146
v_mfma_f32_16x16x32_bf16 v[220:223], v[252:255], v[186:189], v[220:223]
v_exp_f32 v147, v147
v_mfma_f32_16x16x32_bf16 v[220:223], v[240:243], v[174:177], v[220:223]
v_cvt_pk_bf16_f32 v174, v138, v139
v_cvt_pk_bf16_f32 v175, v140, v141
v_mfma_f32_16x16x32_bf16 v[220:223], v[244:247], v[178:181], v[220:223]
v_cvt_pk_bf16_f32 v176, v142, v143
v_cvt_pk_bf16_f32 v177, v144, v145
v_cvt_pk_bf16_f32 v180, v150, 0
v_exp_f32 v148, v148
v_mfma_f32_16x16x32_bf16 v[150:153], v[190:193], v[174:177], 0
v_exp_f32 v149, v149
v_mfma_f32_16x16x32_bf16 v[138:141], v[114:117], v[174:177], 0
v_exp_f32 v162, v162
v_mfma_f32_16x16x32_bf16 v[142:145], v[122:125], v[174:177], 0
v_exp_f32 v163, v163
v_exp_f32 v164, v164
v_exp_f32 v165, v165
v_cvt_pk_bf16_f32 v178, v146, v147
v_cvt_pk_bf16_f32 v179, v148, v149
v_mfma_f32_16x16x32_bf16 v[146:149], v[130:133], v[174:177], 0
v_cvt_pk_bf16_f32 v174, v154, v155
v_cvt_pk_bf16_f32 v175, v156, v157
v_cvt_pk_bf16_f32 v176, v158, v159
v_cvt_pk_bf16_f32 v177, v160, v161
v_mov_b32 v181, 0
s_nop 0
v_mfma_f32_16x16x32_bf16 v[154:157], v[114:117], v[174:177], 0
ds_read_b128 v[182:185], v210 offset:12288
ds_read_b128 v[186:189], v210 offset:13312
v_mfma_f32_16x16x32_bf16 v[158:161], v[122:125], v[174:177], 0
ds_read_b128 v[72:75], v215
ds_read_b64 v[76:77], v215 offset:16
v_mfma_f32_16x16x32_bf16 v[150:153], v[190:193], v[178:181], v[150:153]
s_nop 7
v_rcp_f32 v151, v150
s_nop 0
v_mul_f32 v152, s3, v151
v_max3_u32 v218, v218, v150, v151
s_waitcnt lgkmcnt(3)
v_mfma_f32_16x16x32_bf16 v[118:121], v[182:185], a[72:75], v[118:121]
s_waitcnt lgkmcnt(2)
v_mfma_f32_16x16x32_bf16 v[118:121], v[186:189], a[76:79], v[118:121]
v_mfma_f32_16x16x32_bf16 v[126:129], v[182:185], a[96:99], v[126:129]
v_mfma_f32_16x16x32_bf16 v[126:129], v[186:189], a[100:103], v[126:129]
v_cvt_pk_bf16_f32 v118, v118, v119
v_cvt_pk_bf16_f32 v119, v120, v121
v_mfma_f32_16x16x32_bf16 v[134:137], v[182:185], a[120:123], v[134:137]
ds_read_u16 v120, v205
v_mov_b32_e64 v121, 0
v_mfma_f32_16x16x32_bf16 v[134:137], v[186:189], a[124:127], v[134:137]
v_cvt_pk_bf16_f32 v126, v126, v127
v_cvt_pk_bf16_f32 v127, v128, v129
v_mfma_f32_16x16x32_bf16 v[90:93], a[216:219], v[182:185], v[90:93]
ds_read_u16 v128, v205 offset:32
v_mov_b32_e64 v129, 0
v_mfma_f32_16x16x32_bf16 v[90:93], a[220:223], v[186:189], v[90:93]
v_cvt_pk_bf16_f32 v134, v134, v135
v_cvt_pk_bf16_f32 v135, v136, v137
v_mfma_f32_16x16x32_bf16 v[170:173], a[240:243], v[182:185], v[170:173]
ds_read_u16 v136, v205 offset:64
v_mov_b32_e64 v137, 0
v_mfma_f32_16x16x32_bf16 v[170:173], a[244:247], v[186:189], v[170:173]
v_cvt_pk_bf16_f32 v90, v90, v91
v_cvt_pk_bf16_f32 v91, v92, v93
v_mfma_f32_16x16x32_bf16 v[220:223], v[232:235], v[182:185], v[220:223]
s_nop 0
v_add_u32 v205, 1424, v205
v_mfma_f32_16x16x32_bf16 v[220:223], v[236:239], v[186:189], v[220:223]
s_waitcnt lgkmcnt(2)
v_cvt_pk_bf16_f32 v92, v170, v171
v_cvt_pk_bf16_f32 v93, v172, v173
v_mfma_f32_16x16x32_bf16 v[138:141], v[118:121], v[178:181], v[138:141]
s_waitcnt lgkmcnt(1)
v_mfma_f32_16x16x32_bf16 v[142:145], v[126:129], v[178:181], v[142:145]
s_waitcnt lgkmcnt(0)
v_cvt_pk_bf16_f32 v94, v220, v221
v_cvt_pk_bf16_f32 v95, v222, v223
v_mfma_f32_16x16x32_bf16 v[146:149], v[134:137], v[178:181], v[146:149]
v_mul_f32 v138, v138, v152
v_mul_f32 v139, v139, v152
v_mul_f32 v140, v140, v152
v_mul_f32 v141, v141, v152
v_cvt_pk_bf16_f32 v138, v138, v139
v_mul_f32 v142, v142, v152
v_mul_f32 v143, v143, v152
v_mul_f32 v144, v144, v152
v_mul_f32 v145, v145, v152
v_cvt_pk_bf16_f32 v139, v140, v141
v_cvt_pk_bf16_f32 v140, v142, v143
v_cvt_pk_bf16_f32 v141, v144, v145
v_cvt_pk_bf16_f32 v180, v166, 0
v_mfma_f32_16x16x32_bf16 v[166:169], v[190:193], v[174:177], 0
ds_write_b128 v211, v[138:141] offset:38912
v_mfma_f32_16x16x32_bf16 v[138:141], v[78:81], v[90:93], 0
v_cvt_pk_bf16_f32 v178, v162, v163
v_cvt_pk_bf16_f32 v179, v164, v165
v_mfma_f32_16x16x32_bf16 v[162:165], v[130:133], v[174:177], 0
v_mul_f32 v146, v146, v152
v_mul_f32 v147, v147, v152
v_mfma_f32_16x16x32_bf16 v[166:169], v[190:193], v[178:181], v[166:169]
v_mul_f32 v148, v148, v152
v_mul_f32 v149, v149, v152
v_mfma_f32_16x16x32_bf16 v[154:157], v[118:121], v[178:181], v[154:157]
v_cvt_pk_bf16_f32 v142, v146, v147
v_cvt_pk_bf16_f32 v143, v148, v149
v_mfma_f32_16x16x32_bf16 v[158:161], v[126:129], v[178:181], v[158:161]
ds_write_b64 v212, v[142:143] offset:38912
v_mfma_f32_16x16x32_bf16 v[162:165], v[134:137], v[178:181], v[162:165]
v_rcp_f32 v167, v166
v_mfma_f32_16x16x32_bf16 v[142:145], v[96:99], v[90:93], 0
v_mul_f32 v168, s3, v167
v_mul_f32_e64 v154, v154, v168
v_mfma_f32_16x16x32_bf16 v[150:153], v[108:111], v[90:93], v[206:209]
v_mul_f32 v155, v155, v168
v_mul_f32 v156, v156, v168
v_mfma_f32_16x16x32_bf16 v[146:149], v[102:105], v[90:93], 0
v_mul_f32 v157, v157, v168
v_cvt_pk_bf16_f32 v154, v154, v155
v_mul_f32 v158, v158, v168
v_mfma_f32_16x16x16_bf16 v[138:141], v[82:83], v[94:95], v[138:141]
v_mul_f32 v159, v159, v168
v_mul_f32 v160, v160, v168
v_mul_f32_e64 v161, v161, v168
v_mfma_f32_16x16x16_bf16 v[142:145], v[100:101], v[94:95], v[142:145]
v_cvt_pk_bf16_f32 v155, v156, v157
v_cvt_pk_bf16_f32 v156, v158, v159
v_cvt_pk_bf16_f32 v157, v160, v161
v_mfma_f32_16x16x16_bf16 v[150:153], v[112:113], v[94:95], v[150:153]
v_mul_f32 v162, v162, v168
v_mul_f32 v163, v163, v168
v_mul_f32_e64 v164, v164, v168
v_mfma_f32_16x16x16_bf16 v[146:149], v[106:107], v[94:95], v[146:149]
v_mul_f32_e64 v165, v165, v168
v_cvt_pk_bf16_f32 v158, v162, v163
v_cvt_pk_bf16_f32 v159, v164, v165
v_exp_f32 v138, v138
v_mfma_f32_16x16x32_bf16 v[162:165], v[72:75], v[102:105], 0
ds_write_b128 v211, v[154:157] offset:45056
v_mfma_f32_16x16x32_bf16 v[154:157], v[72:75], v[78:81], 0
v_exp_f32 v139, v139
v_exp_f32 v140, v140
v_mfma_f32_16x16x16_bf16 v[162:165], v[76:77], v[106:107], v[162:165]
v_exp_f32 v141, v141
v_cvt_pk_bf16_f32 v174, v138, v139
v_mfma_f32_16x16x16_bf16 v[154:157], v[76:77], v[82:83], v[154:157]
ds_write_b64 v212, v[158:159] offset:45056
v_mfma_f32_16x16x32_bf16 v[158:161], v[72:75], v[96:99], 0
v_exp_f32 v142, v142
v_exp_f32 v143, v143
v_exp_f32 v144, v144
v_mfma_f32_16x16x16_bf16 v[158:161], v[76:77], v[100:101], v[158:161]
v_exp_f32 v145, v145
v_exp_f32_e64 v150, v150
v_cvt_pk_bf16_f32 v175, v140, v141
v_cvt_pk_bf16_f32 v176, v142, v143
v_cvt_pk_bf16_f32 v177, v144, v145
v_cvt_pk_bf16_f32 v180, v150, 0
v_max3_u32 v218, v218, v166, v167
v_mfma_f32_16x16x32_bf16 v[150:153], v[190:193], v[174:177], 0
v_exp_f32 v146, v146
v_mfma_f32_16x16x32_bf16 v[138:141], v[114:117], v[174:177], 0
s_waitcnt lgkmcnt(0)
v_exp_f32 v147, v147
v_mfma_f32_16x16x32_bf16 v[142:145], v[122:125], v[174:177], 0
s_barrier
ds_read_b128 v[220:223], v210 offset:38912
ds_read_b128 v[110:113], v210 offset:39936
v_exp_f32 v148, v148
v_exp_f32 v149, v149
v_cvt_pk_bf16_f32 v178, v146, v147
v_cvt_pk_bf16_f32 v179, v148, v149
v_mfma_f32_16x16x32_bf16 v[146:149], v[130:133], v[174:177], 0
ds_read_b128 v[170:173], v210 offset:40960
ds_read_b128 v[182:185], v210 offset:41984
v_mfma_f32_16x16x32_bf16 v[150:153], v[190:193], v[178:181], v[150:153]
ds_read_b128 v[186:189], v210 offset:43008
ds_read_b32 v166, v215 offset:536
v_mfma_f32_16x16x32_bf16 v[138:141], v[118:121], v[178:181], v[138:141]
ds_read_b128 v[174:177], v217
v_mov_b32_dpp v154, v158 quad_perm:[0,1,2,3] row_mask:0x2 bank_mask:0xf
v_mfma_f32_16x16x32_bf16 v[142:145], v[126:129], v[178:181], v[142:145]
s_waitcnt lgkmcnt(6)
v_rcp_f32 v151, v150
v_mfma_f32_16x16x32_bf16 v[0:3], a[144:147], v[220:223], v[0:3]
s_waitcnt lgkmcnt(5)
v_mul_f32 v152, s3, v151
v_mul_f32_e64 v138, v138, v152
v_mfma_f32_16x16x32_bf16 v[0:3], a[148:151], v[110:113], v[0:3]
v_mul_f32 v139, v139, v152
v_mul_f32 v140, v140, v152
v_mfma_f32_16x16x32_bf16 v[4:7], a[168:171], v[220:223], v[4:7]
v_mul_f32_e64 v141, v141, v152
v_cvt_pk_bf16_f32 v138, v138, v139
v_mfma_f32_16x16x32_bf16 v[4:7], a[172:175], v[110:113], v[4:7]
s_waitcnt lgkmcnt(4)
v_mul_f32 v142, v142, v152
v_mul_f32_e64 v143, v143, v152
v_mfma_f32_16x16x32_bf16 v[4:7], a[176:179], v[170:173], v[4:7]
s_waitcnt lgkmcnt(3)
v_mul_f32 v144, v144, v152
v_mul_f32_e64 v145, v145, v152
v_mfma_f32_16x16x32_bf16 v[4:7], a[180:183], v[182:185], v[4:7]
v_cvt_pk_bf16_f32 v139, v140, v141
v_cvt_pk_bf16_f32 v140, v142, v143
v_mfma_f32_16x16x32_bf16 v[8:11], a[192:195], v[220:223], v[8:11]
ds_read_b128 v[220:223], v210 offset:44032
v_cvt_pk_bf16_f32 v141, v144, v145
v_mfma_f32_16x16x32_bf16 v[8:11], a[196:199], v[110:113], v[8:11]
ds_read_b128 v[110:113], v210 offset:45056
v_mov_b32_dpp v154, v162 quad_perm:[0,1,2,3] row_mask:0x4 bank_mask:0xf
v_mfma_f32_16x16x32_bf16 v[8:11], a[200:203], v[170:173], v[8:11]
s_nop 0
ds_write_b128 v211, v[138:141] offset:51200
v_mfma_f32_16x16x32_bf16 v[8:11], a[204:207], v[182:185], v[8:11]
s_waitcnt lgkmcnt(4)
v_add_f32_dpp v154, v166, v207 quad_perm:[0,1,2,3] row_mask:0x8 bank_mask:0xf
v_mfma_f32_16x16x32_bf16 v[0:3], a[152:155], v[170:173], v[0:3]
v_exp_f32 v166, v154
v_mfma_f32_16x16x32_bf16 v[0:3], a[156:159], v[182:185], v[0:3]
ds_read_b128 v[170:173], v210 offset:46080
ds_read_b128 v[182:185], v210 offset:47104
v_mfma_f32_16x16x32_bf16 v[0:3], a[160:163], v[186:189], v[0:3]
s_waitcnt lgkmcnt(4)
v_cvt_pk_bf16_f32 v154, v166, 0
v_add_f32_dpp v166, v166, v166 row_ror:8 row_mask:0xf bank_mask:0xf
v_mfma_f32_16x16x32_bf16 v[0:3], a[164:167], v[220:223], v[0:3]
ds_write_b16 v214, v154
v_mfma_f32_16x16x32_bf16 v[146:149], v[134:137], v[178:181], v[146:149]
ds_read_b128 v[84:87], v215
ds_read_b128 v[88:91], v215 offset:16
v_mfma_f32_16x16x32_bf16 v[4:7], a[184:187], v[186:189], v[4:7]
ds_read_b128 v[178:181], v217 offset:528
v_cvt_pk_bf16_f32 v0, v0, v1
v_mfma_f32_16x16x32_bf16 v[4:7], a[188:191], v[220:223], v[4:7]
s_waitcnt lgkmcnt(7)
v_mul_f32 v146, v146, v152
v_mul_f32_e64 v147, v147, v152
v_mfma_f32_16x16x32_bf16 v[12:15], a[144:147], v[110:113], v[12:15]
s_waitcnt lgkmcnt(5)
v_mul_f32 v148, v148, v152
v_mul_f32 v149, v149, v152
v_mfma_f32_16x16x32_bf16 v[12:15], a[148:151], v[170:173], v[12:15]
s_waitcnt lgkmcnt(4)
v_cvt_pk_bf16_f32 v142, v146, v147
v_cvt_pk_bf16_f32 v143, v148, v149
v_mfma_f32_16x16x32_bf16 v[12:15], a[152:155], v[182:185], v[12:15]
ds_write_b64 v212, v[142:143] offset:51200
v_mfma_f32_16x16x32_bf16 v[16:19], a[168:171], v[110:113], v[16:19]
v_cvt_pk_bf16_f32 v1, v2, v3
v_add_f32_dpp v166, v166, v166 row_ror:4 row_mask:0xf bank_mask:0xf
v_mfma_f32_16x16x32_bf16 v[16:19], a[172:175], v[170:173], v[16:19]
ds_write_b64 v203, v[0:1]
v_mfma_f32_16x16x32_bf16 v[16:19], a[176:179], v[182:185], v[16:19]
v_add_f32_dpp v166, v166, v166 row_ror:2 row_mask:0xf bank_mask:0xf
v_cvt_pk_bf16_f32 v4, v4, v5
v_mfma_f32_16x16x32_bf16 v[20:23], a[192:195], v[110:113], v[20:23]
ds_read_b128 v[110:113], v210 offset:50176
v_add_f32_dpp v166, v166, v166 row_ror:1 row_mask:0xf bank_mask:0xf
v_mfma_f32_16x16x32_bf16 v[20:23], a[196:199], v[170:173], v[20:23]
v_add_f32_dpp v166, v166, v166 row_bcast:15 row_mask:0xa bank_mask:0xf
v_cvt_pk_bf16_f32 v5, v6, v7
v_mfma_f32_16x16x32_bf16 v[20:23], a[200:203], v[182:185], v[20:23]
s_waitcnt vmcnt(0) lgkmcnt(2)
ds_write_b64 v203, v[4:5] offset:32
v_mfma_f32_16x16x32_bf16 v[8:11], a[208:211], v[186:189], v[8:11]
s_barrier
v_mfma_f32_16x16x32_bf16 v[8:11], a[212:215], v[220:223], v[8:11]
ds_read_b128 v[186:189], v210 offset:48128
ds_read_b128 v[220:223], v210 offset:49152
v_mfma_f32_16x16x32_bf16 v[154:157], v[84:87], v[114:117], 0
ds_read_b128 v[92:95], v201
ds_read_b128 v[100:103], v202
v_mfma_f32_16x16x32_bf16 v[154:157], v[88:91], v[118:121], v[154:157]
ds_read_b128 v[170:173], v210 offset:51200
ds_read_b128 v[182:185], v210 offset:52224
v_mfma_f32_16x16x32_bf16 v[158:161], v[84:87], v[122:125], 0
ds_read_b128 v[96:99], v195 offset:16
v_add_f32_dpp v166, v166, v166 row_bcast:31 row_mask:0xc bank_mask:0xf
v_mfma_f32_16x16x32_bf16 v[158:161], v[88:91], v[126:129], v[158:161]
ds_read_b128 v[104:107], v196 offset:16
v_readlane_b32 s72, v166, 63
v_mfma_f32_16x16x32_bf16 v[162:165], v[84:87], v[130:133], 0
s_nop 0
ds_read_b128 v[84:87], v200
v_cvt_pk_bf16_f32 v8, v8, v9
v_mfma_f32_16x16x32_bf16 v[162:165], v[88:91], v[134:137], v[162:165]
s_waitcnt lgkmcnt(8)
ds_read_b128 v[88:91], v194 offset:16
v_mov_b32_dpp v154, v158 quad_perm:[0,1,2,3] row_mask:0x2 bank_mask:0xf
v_mfma_f32_16x16x32_bf16 v[12:15], a[156:159], v[186:189], v[12:15]
s_waitcnt lgkmcnt(8)
v_rcp_f32 v167, s72
v_mfma_f32_16x16x32_bf16 v[12:15], a[160:163], v[220:223], v[12:15]
v_max3_u32 v218, v218, s72, v167
v_max3_u32 v218, v218, v150, v151
v_mfma_f32_16x16x32_bf16 v[12:15], a[164:167], v[110:113], v[12:15]
v_mov_b32_dpp v154, v162 quad_perm:[0,1,2,3] row_mask:0x4 bank_mask:0xf
v_mul_f32_e64 v168, s3, v167
v_mfma_f32_16x16x32_bf16 v[16:19], a[180:183], v[186:189], v[16:19]
v_mul_f32_e64 v154, v154, v168
v_cvt_pk_bf16_f32 v154, v154, 0
v_mfma_f32_16x16x32_bf16 v[16:19], a[184:187], v[220:223], v[16:19]
v_cvt_pk_bf16_f32 v12, v12, v13
v_cvt_pk_bf16_f32 v13, v14, v15
v_mfma_f32_16x16x32_bf16 v[16:19], a[188:191], v[110:113], v[16:19]
ds_write_b64 v203, v[12:13] offset:6272
v_mfma_f32_16x16x32_bf16 v[20:23], a[204:207], v[186:189], v[20:23]
v_cvt_pk_bf16_f32 v9, v10, v11
v_add_u32 v215, 1424, v215
v_mfma_f32_16x16x32_bf16 v[20:23], a[208:211], v[220:223], v[20:23]
s_nop 0
ds_read_b128 v[186:189], v210 offset:53248
ds_read_b128 v[220:223], v210 offset:54272
v_mfma_f32_16x16x32_bf16 v[20:23], a[212:215], v[110:113], v[20:23]
s_waitcnt lgkmcnt(4)
ds_read_b128 v[110:113], v210 offset:55296
v_cvt_pk_bf16_f32 v16, v16, v17
v_mfma_f32_16x16x32_bf16 v[0:3], v[174:177], v[84:87], 0
ds_read_b128 v[84:87], v194
v_cvt_pk_bf16_f32 v17, v18, v19
v_mfma_f32_16x16x32_bf16 v[12:15], v[174:177], v[92:95], 0
ds_read_b128 v[92:95], v195
v_cvt_pk_bf16_f32 v20, v20, v21
v_mfma_f32_16x16x32_bf16 v[24:27], a[144:147], v[170:173], v[24:27]
ds_write_b16 v214, v154
v_mfma_f32_16x16x32_bf16 v[24:27], a[148:151], v[182:185], v[24:27]
ds_write_b64 v203, v[16:17] offset:6304
v_mfma_f32_16x16x32_bf16 v[28:31], a[168:171], v[170:173], v[28:31]
v_cvt_pk_bf16_f32 v21, v22, v23
v_mfma_f32_16x16x32_bf16 v[28:31], a[172:175], v[182:185], v[28:31]
s_waitcnt lgkmcnt(6)
ds_write_b64 v203, v[8:9] offset:64
v_mfma_f32_16x16x32_bf16 v[28:31], a[176:179], v[186:189], v[28:31]
s_waitcnt lgkmcnt(6)
v_mfma_f32_16x16x32_bf16 v[28:31], a[180:183], v[220:223], v[28:31]
ds_write_b64 v203, v[20:21] offset:6336
v_mfma_f32_16x16x32_bf16 v[32:35], a[192:195], v[170:173], v[32:35]
v_mfma_f32_16x16x32_bf16 v[32:35], a[196:199], v[182:185], v[32:35]
ds_read_b128 v[170:173], v210 offset:56320
ds_read_b128 v[182:185], v210 offset:20480
v_mfma_f32_16x16x32_bf16 v[32:35], a[200:203], v[186:189], v[32:35]
s_waitcnt lgkmcnt(7)
v_smfmac_f32_16x16x64_bf16 v[0:3], v[178:181], v[84:91], v213
s_nop 0
ds_read_b128 v[84:87], v197
ds_read_b128 v[88:91], v197 offset:16
v_mfma_f32_16x16x32_bf16 v[24:27], a[152:155], v[186:189], v[24:27]
ds_read_b128 v[186:189], v210 offset:21504
v_mfma_f32_16x16x32_bf16 v[24:27], a[156:159], v[220:223], v[24:27]
s_nop 0
v_mfma_f32_16x16x32_bf16 v[24:27], a[160:163], v[110:113], v[24:27]
s_waitcnt lgkmcnt(4)
v_mfma_f32_16x16x32_bf16 v[24:27], a[164:167], v[170:173], v[24:27]
v_mfma_f32_16x16x32_bf16 v[32:35], a[204:207], v[220:223], v[32:35]
ds_read_b128 v[220:223], v210 offset:23552
v_mfma_f32_16x16x32_bf16 v[32:35], a[208:211], v[110:113], v[32:35]
v_cvt_pk_bf16_f32 v24, v24, v25
v_cvt_pk_bf16_f32 v25, v26, v27
v_mfma_f32_16x16x32_bf16 v[32:35], a[212:215], v[170:173], v[32:35]
ds_write_b64 v203, v[24:25] offset:12544
v_mfma_f32_16x16x32_bf16 v[24:27], v[174:177], v[100:103], 0
v_mfma_f32_16x16x32_bf16 v[28:31], a[184:187], v[110:113], v[28:31]
ds_read_b128 v[100:103], v196
ds_read_b128 v[174:177], v217 offset:1056
v_mfma_f32_16x16x32_bf16 v[28:31], a[188:191], v[170:173], v[28:31]
ds_read_b128 v[110:113], v210 offset:22528
v_cvt_pk_bf16_f32 v32, v32, v33
v_smfmac_f32_16x16x64_bf16 v[12:15], v[178:181], v[92:99], v213
s_waitcnt lgkmcnt(8)
ds_read_b128 v[92:95], v198
ds_read_b128 v[96:99], v198 offset:16
v_mfma_f32_16x16x32_bf16 v[138:141], a[0:3], v[182:185], 0
s_waitcnt lgkmcnt(7)
v_cvt_pk_bf16_f32 v28, v28, v29
v_cvt_pk_bf16_f32 v29, v30, v31
v_mfma_f32_16x16x32_bf16 v[138:141], a[4:7], v[186:189], v[138:141]
ds_write_b64 v203, v[28:29] offset:12576
v_mfma_f32_16x16x32_bf16 v[142:145], a[24:27], v[182:185], 0
v_cvt_pk_bf16_f32 v33, v34, v35
v_mfma_f32_16x16x32_bf16 v[142:145], a[28:31], v[186:189], v[142:145]
s_waitcnt lgkmcnt(5)
ds_write_b64 v203, v[32:33] offset:12608
v_smfmac_f32_16x16x64_bf16 v[24:27], v[178:181], v[100:107], v213
s_waitcnt lgkmcnt(5)
v_smfmac_f32_16x16x64_bf16 v[0:3], v[174:177], v[84:91], v213
ds_read_b128 v[100:103], v199
ds_read_b128 v[84:87], v200 offset:32
v_mfma_f32_16x16x32_bf16 v[146:149], a[48:51], v[182:185], 0
ds_read_b128 v[104:107], v199 offset:16
ds_read_b128 v[178:181], v217 offset:1584
v_mfma_f32_16x16x32_bf16 v[146:149], a[52:55], v[186:189], v[146:149]
s_waitcnt lgkmcnt(6)
ds_read_b128 v[88:91], v194 offset:48
v_mul_f32 v119, v0, v0
v_smfmac_f32_16x16x64_bf16 v[12:15], v[174:177], v[92:99], v213
ds_read_b128 v[92:95], v201 offset:32
ds_read_b128 v[96:99], v195 offset:48
v_mfma_f32_16x16x32_bf16 v[150:153], a[216:219], v[182:185], 0
v_add_f32 v118, v0, v1
v_fmac_f32 v119, v1, v1
v_mfma_f32_16x16x32_bf16 v[150:153], a[220:223], v[186:189], v[150:153]
s_waitcnt lgkmcnt(7)
v_mul_f32 v127, v12, v12
v_add_f32 v126, v12, v13
v_mfma_f32_16x16x32_bf16 v[154:157], a[240:243], v[182:185], 0
s_barrier
v_mfma_f32_16x16x32_bf16 v[154:157], a[244:247], v[186:189], v[154:157]
s_waitcnt lgkmcnt(4)
ds_read_b64 v[120:121], v204
ds_read_b64 v[128:129], v204 offset:392
v_smfmac_f32_16x16x64_bf16 v[24:27], v[174:177], v[100:107], v213
s_waitcnt lgkmcnt(5)
ds_read_b128 v[100:103], v202 offset:32
ds_read_b128 v[174:177], v217 offset:2112
v_mfma_f32_16x16x32_bf16 v[4:7], v[178:181], v[84:87], 0
ds_read_b128 v[84:87], v194 offset:32
ds_read_b128 v[104:107], v196 offset:48
v_mfma_f32_16x16x32_bf16 v[158:161], v[232:235], v[182:185], 0
ds_read_b64 v[136:137], v204 offset:784
v_fmac_f32_e64 v127, v13, v13
v_mfma_f32_16x16x32_bf16 v[158:161], v[236:239], v[186:189], v[158:161]
s_waitcnt lgkmcnt(8)
v_add_f32 v118, v118, v2
v_fmac_f32_e64 v119, v2, v2
v_mfma_f32_16x16x32_bf16 v[16:19], v[178:181], v[92:95], 0
ds_read_b128 v[92:95], v195 offset:32
v_add_f32 v126, v126, v14
v_mfma_f32_16x16x32_bf16 v[162:165], v[182:185], a[72:75], 0
s_waitcnt lgkmcnt(7)
buffer_store_dwordx2 v[120:121], v204, s[8:11], s28 offen sc1
ds_read_b64 v[120:121], v204 offset:1176
v_mfma_f32_16x16x32_bf16 v[162:165], v[186:189], a[76:79], v[162:165]
s_waitcnt lgkmcnt(6)
v_mul_f32 v135, v24, v24
v_fmac_f32 v127, v14, v14
v_mfma_f32_16x16x32_bf16 v[28:31], v[178:181], v[100:103], 0
s_add_u32 s28, s38, s62
ds_read_b128 v[100:103], v196 offset:32
ds_read_b128 v[178:181], v217 offset:2640
v_mfma_f32_16x16x32_bf16 v[166:169], v[182:185], a[96:99], 0
s_waitcnt lgkmcnt(6)
buffer_store_dwordx2 v[128:129], v204, s[8:11], s29 offen sc1
ds_read_b64 v[128:129], v204 offset:6272
v_mfma_f32_16x16x32_bf16 v[166:169], v[186:189], a[100:103], v[166:169]
s_add_u32 s29, s38, s63
v_add_f32 v134, v24, v25
v_add_f32 v118, v118, v3
v_smfmac_f32_16x16x64_bf16 v[4:7], v[174:177], v[84:91], v213
ds_read_b128 v[84:87], v197 offset:32
ds_read_b128 v[88:91], v197 offset:48
v_mfma_f32_16x16x32_bf16 v[170:173], v[182:185], a[120:123], 0
ds_read_b128 v[182:185], v210 offset:24576
v_fmac_f32 v119, v3, v3
v_mfma_f32_16x16x32_bf16 v[170:173], v[186:189], a[124:127], v[170:173]
s_waitcnt lgkmcnt(7)
ds_read_b128 v[186:189], v210 offset:25600
v_add_f32 v126, v126, v15
v_smfmac_f32_16x16x64_bf16 v[16:19], v[174:177], v[92:99], v213
s_waitcnt lgkmcnt(6)
ds_read_b128 v[92:95], v198 offset:32
ds_read_b128 v[96:99], v198 offset:48
v_smfmac_f32_16x16x64_bf16 v[28:31], v[174:177], v[100:107], v213
ds_read_b128 v[100:103], v199 offset:32
ds_read_b128 v[104:107], v199 offset:48
v_mfma_f32_16x16x32_bf16 v[138:141], a[8:11], v[110:113], v[138:141]
ds_read_b128 v[174:177], v217 offset:3168
v_fmac_f32_e64 v135, v25, v25
v_mfma_f32_16x16x32_bf16 v[138:141], a[12:15], v[220:223], v[138:141]
buffer_store_dwordx2 v[136:137], v204, s[8:11], s28 offen sc1
ds_read_b64 v[136:137], v204 offset:6664
v_mfma_f32_16x16x32_bf16 v[142:145], a[32:35], v[110:113], v[142:145]
s_waitcnt lgkmcnt(8)
v_fmac_f32 v127, v15, v15
v_add_f32_e64 v134, v134, v26
v_mfma_f32_16x16x32_bf16 v[142:145], a[36:39], v[220:223], v[142:145]
s_add_u32 s28, s38, s64
v_fmac_f32 v135, v26, v26
v_add_f32_e64 v134, v134, v27
v_smfmac_f32_16x16x64_bf16 v[4:7], v[178:181], v[84:91], v213
s_nop 0
ds_read_b128 v[84:87], v200 offset:64
ds_read_b128 v[88:91], v194 offset:80
v_mfma_f32_16x16x32_bf16 v[146:149], a[56:59], v[110:113], v[146:149]
s_waitcnt lgkmcnt(6)
buffer_store_dwordx2 v[120:121], v204, s[8:11], s29 offen sc1
ds_read_b64 v[120:121], v204 offset:7056
v_mfma_f32_16x16x32_bf16 v[146:149], a[60:63], v[220:223], v[146:149]
s_add_u32 s29, s38, s65
v_add_f32 v118, v118, v4
v_fmac_f32 v119, v4, v4
v_smfmac_f32_16x16x64_bf16 v[16:19], v[178:181], v[92:99], v213
s_waitcnt lgkmcnt(5)
ds_read_b128 v[92:95], v201 offset:64
ds_read_b128 v[96:99], v195 offset:80
v_smfmac_f32_16x16x64_bf16 v[28:31], v[178:181], v[100:107], v213
ds_read_b128 v[100:103], v202 offset:64
ds_read_b128 v[178:181], v217 offset:3696
v_mfma_f32_16x16x32_bf16 v[150:153], a[224:227], v[110:113], v[150:153]
ds_read_b128 v[104:107], v196 offset:80
v_add_f32 v126, v126, v16
v_mfma_f32_16x16x32_bf16 v[150:153], a[228:231], v[220:223], v[150:153]
s_waitcnt lgkmcnt(7)
buffer_store_dwordx2 v[128:129], v204, s[8:11], s28 offen sc1
ds_read_b64 v[128:129], v204 offset:7448
v_mfma_f32_16x16x32_bf16 v[8:11], v[174:177], v[84:87], 0
s_add_u32 s28, s38, s66
ds_read_b128 v[84:87], v194 offset:64
v_fmac_f32 v127, v16, v16
v_mfma_f32_16x16x32_bf16 v[154:157], a[248:251], v[110:113], v[154:157]
v_fmac_f32 v135, v27, v27
v_add_f32 v118, v118, v5
v_mfma_f32_16x16x32_bf16 v[154:157], a[252:255], v[220:223], v[154:157]
s_waitcnt lgkmcnt(6)
buffer_store_dwordx2 v[136:137], v204, s[8:11], s29 offen sc1
ds_read_b64 v[136:137], v204 offset:12544
v_mfma_f32_16x16x32_bf16 v[20:23], v[174:177], v[92:95], 0
s_waitcnt lgkmcnt(5)
ds_read_b128 v[92:95], v195 offset:64
v_fmac_f32 v119, v5, v5
v_mfma_f32_16x16x32_bf16 v[32:35], v[174:177], v[100:103], 0
s_add_u32 s29, s38, s67
ds_read_b128 v[100:103], v196 offset:64
ds_read_b128 v[174:177], v217 offset:4224
v_mfma_f32_16x16x32_bf16 v[158:161], v[240:243], v[110:113], v[158:161]
buffer_store_dwordx2 v[120:121], v204, s[8:11], s28 offen sc1
ds_read_b64 v[120:121], v204 offset:12936
v_mfma_f32_16x16x32_bf16 v[158:161], v[244:247], v[220:223], v[158:161]
s_add_u32 s28, s38, s68
v_add_f32 v126, v126, v17
v_fmac_f32_e64 v127, v17, v17
v_mfma_f32_16x16x32_bf16 v[162:165], v[110:113], a[80:83], v[162:165]
v_add_f32 v134, v134, v28
v_fmac_f32 v135, v28, v28
v_mfma_f32_16x16x32_bf16 v[162:165], v[220:223], a[84:87], v[162:165]
s_waitcnt lgkmcnt(5)
buffer_store_dwordx2 v[128:129], v204, s[8:11], s29 offen sc1
ds_read_b64 v[128:129], v204 offset:13328
v_smfmac_f32_16x16x64_bf16 v[8:11], v[178:181], v[84:91], v213
s_waitcnt lgkmcnt(4)
ds_read_b128 v[84:87], v197 offset:64
ds_read_b128 v[88:91], v197 offset:80
v_smfmac_f32_16x16x64_bf16 v[20:23], v[178:181], v[92:99], v213
s_add_u32 s29, s38, s69
ds_read_b128 v[92:95], v198 offset:64
ds_read_b128 v[96:99], v198 offset:80
v_mfma_f32_16x16x32_bf16 v[166:169], v[110:113], a[104:107], v[166:169]
s_waitcnt lgkmcnt(7)
buffer_store_dwordx2 v[136:137], v204, s[8:11], s28 offen sc1
ds_read_b64 v[136:137], v204 offset:13720
v_mfma_f32_16x16x32_bf16 v[166:169], v[220:223], a[108:111], v[166:169]
s_add_u32 s28, s38, s70
v_add_f32 v118, v118, v6
v_fmac_f32_e64 v119, v6, v6
v_smfmac_f32_16x16x64_bf16 v[32:35], v[178:181], v[100:107], v213
ds_read_b128 v[100:103], v199 offset:64
ds_read_b128 v[104:107], v199 offset:80
v_mfma_f32_16x16x32_bf16 v[170:173], v[110:113], a[128:131], v[170:173]
ds_read_b128 v[110:113], v210 offset:26624
v_add_f32 v126, v126, v18
v_mfma_f32_16x16x32_bf16 v[170:173], v[220:223], a[132:135], v[170:173]
s_waitcnt lgkmcnt(6)
ds_read_b128 v[220:223], v210 offset:27648
v_fmac_f32_e64 v127, v18, v18
v_smfmac_f32_16x16x64_bf16 v[8:11], v[174:177], v[84:91], v213
buffer_store_dwordx2 v[120:121], v204, s[8:11], s29 offen sc1
v_add_f32 v134, v134, v29
v_mfma_f32_16x16x32_bf16 v[138:141], a[16:19], v[182:185], v[138:141]
s_waitcnt lgkmcnt(5)
v_fmac_f32 v135, v29, v29
v_add_f32 v118, v118, v7
v_mfma_f32_16x16x32_bf16 v[138:141], a[20:23], v[186:189], v[138:141]
s_add_u32 s29, s38, s71
v_fmac_f32 v119, v7, v7
v_add_f32_e64 v126, v126, v19
v_smfmac_f32_16x16x64_bf16 v[20:23], v[174:177], v[92:99], v213
buffer_store_dwordx2 v[128:129], v204, s[8:11], s28 offen sc1
v_fmac_f32_e64 v127, v19, v19
v_mfma_f32_16x16x32_bf16 v[142:145], a[40:43], v[182:185], v[142:145]
v_cvt_pk_bf16_f32 v78, v138, v139
v_cvt_pk_bf16_f32 v79, v140, v141
v_mfma_f32_16x16x32_bf16 v[142:145], a[44:47], v[186:189], v[142:145]
s_waitcnt lgkmcnt(2)
v_add_f32 v134, v134, v30
v_fmac_f32_e64 v135, v30, v30
v_smfmac_f32_16x16x64_bf16 v[32:35], v[174:177], v[100:107], v213
buffer_store_dwordx2 v[136:137], v204, s[8:11], s29 offen sc1
v_add_f32_e64 v118, v118, v8
v_mfma_f32_16x16x32_bf16 v[146:149], a[64:67], v[182:185], v[146:149]
v_cvt_pk_bf16_f32 v80, v142, v143
v_cvt_pk_bf16_f32 v81, v144, v145
v_mfma_f32_16x16x32_bf16 v[146:149], a[68:71], v[186:189], v[146:149]
v_fmac_f32 v119, v8, v8
v_add_f32 v126, v126, v20
v_mfma_f32_16x16x32_bf16 v[150:153], a[232:235], v[182:185], v[150:153]
v_fmac_f32 v127, v20, v20
v_add_f32 v134, v134, v31
v_mfma_f32_16x16x32_bf16 v[150:153], a[236:239], v[186:189], v[150:153]
v_cvt_pk_bf16_f32 v82, v146, v147
v_cvt_pk_bf16_f32 v83, v148, v149
v_mfma_f32_16x16x32_bf16 v[154:157], v[224:227], v[182:185], v[154:157]
v_fmac_f32 v135, v31, v31
v_add_f32 v118, v118, v9
v_mfma_f32_16x16x32_bf16 v[154:157], v[228:231], v[186:189], v[154:157]
v_fmac_f32 v119, v9, v9
v_add_f32 v126, v126, v21
v_mfma_f32_16x16x32_bf16 v[158:161], v[248:251], v[182:185], v[158:161]
v_fmac_f32 v127, v21, v21
v_add_f32 v134, v134, v32
v_mfma_f32_16x16x32_bf16 v[158:161], v[252:255], v[186:189], v[158:161]
v_fmac_f32 v135, v32, v32
v_add_f32 v118, v118, v10
v_mfma_f32_16x16x32_bf16 v[162:165], v[182:185], a[88:91], v[162:165]
v_fmac_f32 v119, v10, v10
v_add_f32 v126, v126, v22
v_mfma_f32_16x16x32_bf16 v[162:165], v[186:189], a[92:95], v[162:165]
v_fmac_f32 v127, v22, v22
v_add_f32 v134, v134, v33
v_mfma_f32_16x16x32_bf16 v[166:169], v[182:185], a[112:115], v[166:169]
v_fmac_f32 v135, v33, v33
v_add_f32 v118, v118, v11
v_mfma_f32_16x16x32_bf16 v[166:169], v[186:189], a[116:119], v[166:169]
v_fmac_f32 v119, v11, v11
v_add_f32 v126, v126, v23
v_mfma_f32_16x16x32_bf16 v[170:173], v[182:185], a[136:139], v[170:173]
ds_read_b128 v[182:185], v210 offset:28672
v_fmac_f32 v127, v23, v23
v_mfma_f32_16x16x32_bf16 v[170:173], v[186:189], a[140:143], v[170:173]
s_waitcnt lgkmcnt(2)
ds_read_b128 v[186:189], v210 offset:29696
v_add_f32_e64 v134, v134, v34
v_mfma_f32_16x16x32_bf16 v[138:141], a[0:3], v[110:113], 0
s_waitcnt lgkmcnt(2)
v_fmac_f32 v135, v34, v34
v_add_f32_e64 v134, v134, v35
v_mfma_f32_16x16x32_bf16 v[138:141], a[4:7], v[220:223], v[138:141]
v_fmac_f32_e64 v135, v35, v35
v_cvt_pk_bf16_f32 v72, v150, v151
v_mfma_f32_16x16x32_bf16 v[142:145], a[24:27], v[110:113], 0
v_permlane16_swap_b32 v118, v119
v_mfma_f32_16x16x32_bf16 v[142:145], a[28:31], v[220:223], v[142:145]
v_permlane16_swap_b32 v126, v127
v_mfma_f32_16x16x32_bf16 v[146:149], a[48:51], v[110:113], 0
v_permlane16_swap_b32 v134, v135
v_mfma_f32_16x16x32_bf16 v[146:149], a[52:55], v[220:223], v[146:149]
s_waitcnt lgkmcnt(1)
v_add_f32 v118, v118, v119
v_add_f32 v126, v126, v127
v_mfma_f32_16x16x32_bf16 v[146:149], a[56:59], v[182:185], v[146:149]
s_waitcnt lgkmcnt(0)
v_add_f32 v134, v134, v135
v_mov_b32_e64 v135, v134
v_mfma_f32_16x16x32_bf16 v[146:149], a[60:63], v[186:189], v[146:149]
s_nop 0
v_permlane32_swap_b32 v118, v126
s_mov_b32 s46, 7
.p2align 6
F_loop:
v_permlane32_swap_b32 v134, v135
v_mfma_f32_16x16x32_bf16 v[142:145], a[32:35], v[182:185], v[142:145]
v_add_f32 v118, v118, v126
v_add_f32 v134, v134, v135
v_mfma_f32_16x16x32_bf16 v[142:145], a[36:39], v[186:189], v[142:145]
ds_write_b32 v209, v118
v_mfma_f32_16x16x32_bf16 v[138:141], a[8:11], v[182:185], v[138:141]
ds_write_b32 v209, v134 offset:512
v_mfma_f32_16x16x32_bf16 v[138:141], a[12:15], v[186:189], v[138:141]
v_cvt_pk_bf16_f32 v76, v158, v159
v_cvt_pk_bf16_f32 v73, v152, v153
v_mfma_f32_16x16x32_bf16 v[150:153], a[216:219], v[110:113], 0
s_add_u32 s35, s35, 32
v_cvt_pk_bf16_f32 v74, v154, v155
v_cvt_pk_bf16_f32 v123, v168, v169
v_mfma_f32_16x16x32_bf16 v[150:153], a[220:223], v[220:223], v[150:153]
v_cvt_pk_bf16_f32 v131, v172, v173
v_mfma_f32_16x16x32_bf16 v[150:153], a[224:227], v[182:185], v[150:153]
s_mul_hi_u32 s41, s35, 58835169
v_cvt_pk_bf16_f32 v75, v156, v157
v_mfma_f32_16x16x32_bf16 v[150:153], a[228:231], v[186:189], v[150:153]
v_cvt_pk_bf16_f32 v77, v160, v161
s_waitcnt lgkmcnt(0)
v_mfma_f32_16x16x32_bf16 v[154:157], a[240:243], v[110:113], 0
s_barrier
v_mfma_f32_16x16x32_bf16 v[154:157], a[244:247], v[220:223], v[154:157]
s_mul_i32 s42, s41, 73
ds_read_b128 v[106:109], v210 offset:19456
ds_read_b128 v[102:105], v210 offset:18432
v_mfma_f32_16x16x32_bf16 v[154:157], a[248:251], v[182:185], v[154:157]
buffer_load_dwordx4 v216, s[4:7], s52 offen nt lds
v_mfma_f32_16x16x32_bf16 v[158:161], v[232:235], v[110:113], 0
v_cvt_pk_bf16_f32 v130, v170, v171
v_cvt_pk_bf16_f32 v115, v164, v165
v_mfma_f32_16x16x32_bf16 v[158:161], v[236:239], v[220:223], v[158:161]
v_cvt_pk_bf16_f32 v114, v162, v163
v_mfma_f32_16x16x32_bf16 v[158:161], v[240:243], v[182:185], v[158:161]
v_cvt_pk_bf16_f32 v122, v166, v167
v_mfma_f32_16x16x32_bf16 v[158:161], v[244:247], v[186:189], v[158:161]
s_waitcnt lgkmcnt(1)
v_add_f32 v108, v108, v109
v_mfma_f32_16x16x32_bf16 v[170:173], v[110:113], a[120:123], 0
v_add_f32 v106, v106, v107
v_add_f32 v106, v106, v108
v_mfma_f32_16x16x32_bf16 v[170:173], v[220:223], a[124:127], v[170:173]
s_waitcnt lgkmcnt(0)
v_add_f32 v102, v102, v103
v_add_f32_e64 v104, v104, v105
v_mfma_f32_16x16x32_bf16 v[166:169], v[110:113], a[96:99], 0
s_add_u32 m0, s45, 4112
v_add_f32 v102, v102, v104
v_mul_f32 v104, s73, v102
v_mfma_f32_16x16x32_bf16 v[166:169], v[220:223], a[100:103], v[166:169]
v_mul_f32 v103, s48, v102
v_mul_f32 v106, s73, v106
v_mfma_f32_16x16x32_bf16 v[162:165], v[110:113], a[72:75], 0
buffer_load_dwordx4 v216, s[4:7], s40 offen nt lds
v_mfma_f32_16x16x32_bf16 v[162:165], v[220:223], a[76:79], v[162:165]
v_fma_f32 v106, -v103, v104, v106
v_max_f32_e64 v106, 0, v106
v_mfma_f32_16x16x32_bf16 v[162:165], v[182:185], a[80:83], v[162:165]
ds_read_b128 v[110:113], v210 offset:30720
v_add_f32_e64 v106, s49, v106
v_mfma_f32_16x16x32_bf16 v[162:165], v[186:189], a[84:87], v[162:165]
s_add_u32 s40, s37, 392448
v_rsq_f32_e64 v102, v106
v_mfma_f32_16x16x32_bf16 v[170:173], v[182:185], a[128:131], v[170:173]
ds_read_b128 v[106:109], v210 offset:31744
v_mul_f32_e64 v103, -v103, v102
v_mfma_f32_16x16x32_bf16 v[170:173], v[186:189], a[132:135], v[170:173]
ds_write_b64 v211, v[102:103]
v_mfma_f32_16x16x32_bf16 v[166:169], v[182:185], a[104:107], v[166:169]
v_mfma_f32_16x16x32_bf16 v[166:169], v[186:189], a[108:111], v[166:169]
ds_read_b64 v[118:119], v219
v_add_u32 v214, 1424, v214
v_mfma_f32_16x16x32_bf16 v[154:157], a[252:255], v[186:189], v[154:157]
s_add_u32 m0, s45, 8224
ds_read_b64 v[134:135], v219 offset:512
s_waitcnt lgkmcnt(4)
v_mfma_f32_16x16x32_bf16 v[154:157], v[224:227], v[110:113], v[154:157]
buffer_load_dwordx4 v216, s[4:7], s40 offen nt lds
v_mfma_f32_16x16x32_bf16 v[142:145], a[40:43], v[110:113], v[142:145]
ds_read_b128 v[182:185], v210 offset:32768
s_waitcnt lgkmcnt(4)
v_mfma_f32_16x16x32_bf16 v[142:145], a[44:47], v[106:109], v[142:145]
s_nop 0
ds_read_b128 v[186:189], v210 offset:33792
ds_read_b64 v[126:127], v219 offset:256
v_mfma_f32_16x16x32_bf16 v[150:153], a[232:235], v[110:113], v[150:153]
s_waitcnt lgkmcnt(4)
v_fma_f32 v223, v3, v118, v119
v_fma_f32 v221, v1, v118, v119
v_mfma_f32_16x16x32_bf16 v[150:153], a[236:239], v[106:109], v[150:153]
s_nop 0
v_fma_f32 v220, v0, v118, v119
v_fma_f32 v222, v2, v118, v119
v_mfma_f32_16x16x32_bf16 v[146:149], a[64:67], v[110:113], v[146:149]
s_sub_u32 s42, s35, s42
v_cvt_pk_bf16_f32 v175, v222, v223
v_fma_f32 v222, v6, v118, v119
v_mfma_f32_16x16x32_bf16 v[146:149], a[68:71], v[106:109], v[146:149]
v_cvt_pk_bf16_f32 v99, v144, v145
v_cvt_pk_bf16_f32 v174, v220, v221
v_mfma_f32_16x16x32_bf16 v[166:169], v[110:113], a[112:115], v[166:169]
s_add_u32 m0, s45, 12336
v_fma_f32 v223, v7, v118, v119
v_fma_f32 v220, v4, v118, v119
v_mfma_f32_16x16x32_bf16 v[166:169], v[106:109], a[116:119], v[166:169]
s_add_u32 s40, s37, 588672
v_cvt_pk_bf16_f32 v100, v146, v147
v_fma_f32 v221, v5, v118, v119
v_mfma_f32_16x16x32_bf16 v[154:157], v[228:231], v[106:109], v[154:157]
buffer_load_dwordx4 v216, s[4:7], s40 offen nt lds
v_mfma_f32_16x16x32_bf16 v[138:141], a[16:19], v[110:113], v[138:141]
v_cvt_pk_bf16_f32 v177, v222, v223
v_cvt_pk_bf16_f32 v176, v220, v221
v_mfma_f32_16x16x32_bf16 v[138:141], a[20:23], v[106:109], v[138:141]
ds_write_b128 v211, v[174:177]
v_mfma_f32_16x16x32_bf16 v[158:161], v[248:251], v[110:113], v[158:161]
v_cvt_pk_bf16_f32 v97, v140, v141
v_fma_f32 v223, v11, v118, v119
v_mfma_f32_16x16x32_bf16 v[158:161], v[252:255], v[106:109], v[158:161]
s_add_u32 s40, s37, 784896
v_fma_f32 v222, v10, v118, v119
v_cvt_pk_bf16_f32 v125, v168, v169
v_mfma_f32_16x16x32_bf16 v[170:173], v[110:113], a[136:139], v[170:173]
v_fma_f32 v220, v8, v118, v119
v_fma_f32 v221, v9, v118, v119
v_mfma_f32_16x16x32_bf16 v[170:173], v[106:109], a[140:143], v[170:173]
v_cvt_pk_bf16_f32 v86, v154, v155
v_cvt_pk_bf16_f32 v179, v222, v223
v_mfma_f32_16x16x32_bf16 v[162:165], v[110:113], a[88:91], v[162:165]
s_add_u32 m0, s45, 16448
v_cvt_pk_bf16_f32 v124, v166, v167
v_cvt_pk_bf16_f32 v98, v142, v143
v_mfma_f32_16x16x32_bf16 v[162:165], v[106:109], a[92:95], v[162:165]
s_waitcnt lgkmcnt(1)
ds_read_b64 v[112:113], v215 offset:528
v_fma_f32 v223, v15, v126, v127
v_mfma_f32_16x16x32_bf16 v[142:145], a[24:27], v[182:185], 0
s_nop 0
v_cvt_pk_bf16_f32 v178, v220, v221
v_cvt_pk_bf16_f32 v101, v148, v149
v_mfma_f32_16x16x32_bf16 v[142:145], a[28:31], v[186:189], v[142:145]
v_cvt_pk_bf16_f32 v96, v138, v139
v_fma_f32 v222, v14, v126, v127
v_mfma_f32_16x16x32_bf16 v[146:149], a[48:51], v[182:185], 0
buffer_load_dwordx4 v216, s[4:7], s40 offen nt lds
v_mfma_f32_16x16x32_bf16 v[146:149], a[52:55], v[186:189], v[146:149]
ds_read_b128 v[174:177], v210 offset:34816
v_cvt_pk_bf16_f32 v89, v160, v161
v_mfma_f32_16x16x32_bf16 v[138:141], a[0:3], v[182:185], 0
s_nop 0
v_cvt_pk_bf16_f32 v88, v158, v159
v_cvt_pk_bf16_f32 v84, v150, v151
v_mfma_f32_16x16x32_bf16 v[138:141], a[4:7], v[186:189], v[138:141]
s_add_u32 s40, s37, 981120
ds_write_b64 v212, v[178:179]
v_mfma_f32_16x16x16_bf16 v[158:161], v[100:101], v[88:89], 0
v_cvt_pk_bf16_f32 v91, v222, v223
v_cvt_pk_bf16_f32 v87, v156, v157
v_fma_f32 v222, v18, v126, v127
v_mfma_f32_16x16x16_bf16 v[154:157], v[82:83], v[88:89], 0
s_waitcnt lgkmcnt(2)
ds_read_b128 v[178:181], v210 offset:35840
v_fma_f32 v223, v19, v126, v127
v_mfma_f32_16x16x16_bf16 v[166:169], v[112:113], v[88:89], v[206:209]
v_fma_f32 v221, v13, v126, v127
v_fma_f32 v220, v12, v126, v127
v_cvt_pk_bf16_f32 v85, v152, v153
v_mfma_f32_16x16x16_bf16 v[150:153], v[112:113], v[76:77], v[206:209]
v_cvt_pk_bf16_f32 v93, v222, v223
v_fma_f32 v223, v23, v126, v127
v_cvt_pk_bf16_f32 v90, v220, v221
v_fma_f32 v220, v16, v126, v127
v_mfma_f32_16x16x32_bf16 v[154:157], v[78:81], v[84:87], v[154:157]
s_add_u32 m0, s45, 20560
ds_read_b128 v[108:111], v215 offset:512
v_fma_f32 v221, v17, v126, v127
v_mfma_f32_16x16x32_bf16 v[158:161], v[96:99], v[84:87], v[158:161]
s_waitcnt lgkmcnt(3)
ds_read_b128 v[186:189], v210 offset:37888
v_fma_f32 v222, v22, v126, v127
v_mfma_f32_16x16x32_bf16 v[138:141], a[8:11], v[174:177], v[138:141]
s_waitcnt lgkmcnt(2)
buffer_load_dwordx4 v216, s[4:7], s40 offen nt lds
v_mfma_f32_16x16x32_bf16 v[138:141], a[12:15], v[178:181], v[138:141]
s_add_u32 m0, s45, 24672
ds_read_b128 v[182:185], v210 offset:36864
v_cvt_pk_bf16_f32 v92, v220, v221
v_mfma_f32_16x16x32_bf16 v[142:145], a[32:35], v[174:177], v[142:145]
v_cvt_pk_bf16_f32 v95, v222, v223
v_fma_f32 v221, v21, v126, v127
v_mfma_f32_16x16x32_bf16 v[142:145], a[36:39], v[178:181], v[142:145]
s_mul_i32 s43, s41, 1373568
ds_write_b128 v211, v[90:93] offset:6144
v_mfma_f32_16x16x32_bf16 v[146:149], a[56:59], v[174:177], v[146:149]
s_waitcnt lgkmcnt(3)
v_exp_f32 v161, v161
v_mfma_f32_16x16x32_bf16 v[146:149], a[60:63], v[178:181], v[146:149]
s_mul_i32 s51, s42, 2688
v_fma_f32 v223, v27, v134, v135
v_fma_f32 v222, v26, v134, v135
v_mfma_f32_16x16x32_bf16 v[166:169], v[108:111], v[84:87], v[166:169]
s_waitcnt lgkmcnt(1)
v_fma_f32 v220, v20, v126, v127
v_cvt_pk_bf16_f32 v91, v222, v223
v_mfma_f32_16x16x32_bf16 v[126:129], v[182:185], a[112:115], 0
s_nop 0
v_cvt_pk_bf16_f32 v94, v220, v221
v_fma_f32 v222, v30, v134, v135
v_mfma_f32_16x16x32_bf16 v[126:129], v[186:189], a[116:119], v[126:129]
s_add_u32 s40, s37, 1177344
v_fma_f32 v221, v25, v134, v135
v_cvt_pk_bf16_f32 v133, v172, v173
v_mfma_f32_16x16x32_bf16 v[126:129], v[174:177], a[104:107], v[126:129]
buffer_load_dwordx4 v216, s[4:7], s40 offen nt lds
v_mfma_f32_16x16x32_bf16 v[138:141], a[16:19], v[182:185], v[138:141]
v_fma_f32 v223, v31, v134, v135
v_fma_f32 v220, v24, v134, v135
v_mfma_f32_16x16x32_bf16 v[138:141], a[20:23], v[186:189], v[138:141]
s_add_u32 s50, s43, s51
v_exp_f32 v160, v160
v_mfma_f32_16x16x32_bf16 v[142:145], a[40:43], v[182:185], v[142:145]
s_add_u32 m0, s45, 28784
v_cvt_pk_bf16_f32 v90, v220, v221
v_fma_f32 v221, v29, v134, v135
v_mfma_f32_16x16x32_bf16 v[142:145], a[44:47], v[186:189], v[142:145]
v_fma_f32 v220, v28, v134, v135
v_cvt_pk_bf16_f32 v102, v138, v139
v_mfma_f32_16x16x32_bf16 v[146:149], a[64:67], v[182:185], v[146:149]
s_nop 0
v_cvt_pk_bf16_f32 v92, v220, v221
v_cvt_pk_bf16_f32 v103, v140, v141
v_mfma_f32_16x16x32_bf16 v[146:149], a[68:71], v[186:189], v[146:149]
s_mov_b32 s38, s36
v_cvt_pk_bf16_f32 v93, v222, v223
v_fma_f32 v220, v32, v134, v135
v_mfma_f32_16x16x32_bf16 v[118:121], v[182:185], a[88:91], 0
ds_write_b64 v212, v[94:95] offset:6144
v_mfma_f32_16x16x32_bf16 v[118:121], v[186:189], a[92:95], v[118:121]
s_add_u32 s40, s37, 1373568
v_exp_f32_e64 v158, v158
v_mfma_f32_16x16x32_bf16 v[118:121], v[174:177], a[80:83], v[118:121]
buffer_load_dwordx4 v216, s[4:7], s40 offen nt lds
v_mfma_f32_16x16x32_bf16 v[118:121], v[178:181], a[84:87], v[118:121]
v_cvt_pk_bf16_f32 v132, v170, v171
v_fma_f32 v222, v34, v134, v135
v_mfma_f32_16x16x16_bf16 v[138:141], v[82:83], v[76:77], 0
ds_write_b128 v211, v[90:93] offset:12288
v_mfma_f32_16x16x32_bf16 v[150:153], v[108:111], v[72:75], v[150:153]
v_cvt_pk_bf16_f32 v107, v148, v149
v_fma_f32 v223, v35, v134, v135
v_mfma_f32_16x16x32_bf16 v[138:141], v[78:81], v[72:75], v[138:141]
v_fma_f32 v221, v33, v134, v135
v_cvt_pk_bf16_f32 v95, v222, v223
v_mfma_f32_16x16x32_bf16 v[90:93], a[232:235], v[182:185], 0
v_cvt_pk_bf16_f32 v105, v144, v145
v_cvt_pk_bf16_f32 v106, v146, v147
v_mfma_f32_16x16x32_bf16 v[170:173], v[224:227], v[182:185], 0
v_exp_f32_e64 v140, v140
v_mfma_f32_16x16x32_bf16 v[170:173], v[228:231], v[186:189], v[170:173]
v_cvt_pk_bf16_f32 v94, v220, v221
v_cvt_pk_bf16_f32 v104, v142, v143
v_mfma_f32_16x16x32_bf16 v[170:173], a[248:251], v[174:177], v[170:173]
s_add_u32 m0, s45, 32896
v_cvt_pk_bf16_f32 v117, v164, v165
v_cvt_pk_bf16_f32 v116, v162, v163
v_mfma_f32_16x16x32_bf16 v[134:137], v[182:185], a[136:139], 0
s_add_u32 s40, s37, 1569792
v_exp_f32 v141, v141
v_mfma_f32_16x16x32_bf16 v[134:137], v[186:189], a[140:143], v[134:137]
buffer_load_dwordx4 v216, s[4:7], s40 offen nt lds
v_mfma_f32_16x16x32_bf16 v[220:223], v[248:251], v[182:185], 0
v_exp_f32 v155, v155
v_mfma_f32_16x16x32_bf16 v[220:223], v[252:255], v[186:189], v[220:223]
s_add_u32 s51, s42, 56
v_exp_f32 v156, v156
v_mfma_f32_16x16x32_bf16 v[220:223], v[240:243], v[174:177], v[220:223]
s_min_u32 s43, s42, 1
v_exp_f32 v150, v150
v_mfma_f32_16x16x32_bf16 v[90:93], a[236:239], v[186:189], v[90:93]
v_exp_f32 v166, v166
v_mfma_f32_16x16x32_bf16 v[90:93], a[224:227], v[174:177], v[90:93]
ds_write_b64 v212, v[94:95] offset:12288
v_mfma_f32_16x16x16_bf16 v[142:145], v[100:101], v[76:77], 0
v_exp_f32 v157, v157
v_exp_f32 v159, v159
v_mfma_f32_16x16x32_bf16 v[126:129], v[178:181], a[108:111], v[126:129]
v_exp_f32 v139, v139
v_mfma_f32_16x16x32_bf16 v[142:145], v[96:99], v[72:75], v[142:145]
v_exp_f32_e64 v138, v138
v_mfma_f32_16x16x32_bf16 v[134:137], v[174:177], a[128:131], v[134:137]
ds_read_b128 v[182:185], v210 offset:32768
v_cvt_pk_bf16_f32 v175, v140, v141
v_mfma_f32_16x16x32_bf16 v[134:137], v[178:181], a[132:135], v[134:137]
ds_read_b128 v[186:189], v210 offset:33792
v_exp_f32 v142, v142
v_mfma_f32_16x16x16_bf16 v[146:149], v[106:107], v[76:77], 0
v_cvt_pk_bf16_f32 v174, v138, v139
v_exp_f32 v145, v145
v_mfma_f32_16x16x16_bf16 v[162:165], v[106:107], v[88:89], 0
v_exp_f32 v143, v143
v_exp_f32 v144, v144
v_mfma_f32_16x16x32_bf16 v[146:149], v[102:105], v[72:75], v[146:149]
ds_read_b128 v[72:75], v215
ds_read_b64 v[76:77], v215 offset:16
v_mfma_f32_16x16x32_bf16 v[162:165], v[102:105], v[84:87], v[162:165]
s_waitcnt lgkmcnt(3)
v_exp_f32 v154, v154
v_mfma_f32_16x16x32_bf16 v[118:121], v[182:185], a[72:75], v[118:121]
s_waitcnt lgkmcnt(2)
v_exp_f32 v149, v149
v_mfma_f32_16x16x32_bf16 v[118:121], v[186:189], a[76:79], v[118:121]
v_exp_f32 v165, v165
v_mfma_f32_16x16x32_bf16 v[134:137], v[182:185], a[120:123], v[134:137]
v_exp_f32 v146, v146
v_mfma_f32_16x16x32_bf16 v[134:137], v[186:189], a[124:127], v[134:137]
s_min_u32 s41, s41, 1
v_exp_f32 v163, v163
v_mfma_f32_16x16x32_bf16 v[126:129], v[182:185], a[96:99], v[126:129]
v_cvt_pk_bf16_f32 v176, v142, v143
v_cvt_pk_bf16_f32 v118, v118, v119
v_mfma_f32_16x16x32_bf16 v[126:129], v[186:189], a[100:103], v[126:129]
v_exp_f32_e64 v148, v148
v_mfma_f32_16x16x32_bf16 v[170:173], a[252:255], v[178:181], v[170:173]
v_cvt_pk_bf16_f32 v119, v120, v121
v_cvt_pk_bf16_f32 v134, v134, v135
v_mfma_f32_16x16x32_bf16 v[220:223], v[244:247], v[178:181], v[220:223]
v_cvt_pk_bf16_f32 v126, v126, v127
v_cvt_pk_bf16_f32 v135, v136, v137
v_cvt_pk_bf16_f32 v177, v144, v145
v_cvt_pk_bf16_f32 v127, v128, v129
v_mfma_f32_16x16x32_bf16 v[220:223], v[232:235], v[182:185], v[220:223]
s_lshl_b32 s43, s43, 27
ds_read_u16 v128, v205 offset:32
ds_read_u16 v120, v205
v_mfma_f32_16x16x32_bf16 v[90:93], a[228:231], v[178:181], v[90:93]
v_exp_f32 v147, v147
v_cvt_pk_bf16_f32 v180, v150, 0
v_mfma_f32_16x16x32_bf16 v[90:93], a[216:219], v[182:185], v[90:93]
v_mov_b32 v181, 0
v_mov_b32 v129, 0
v_mfma_f32_16x16x32_bf16 v[90:93], a[220:223], v[186:189], v[90:93]
v_cvt_pk_bf16_f32 v178, v146, v147
v_cvt_pk_bf16_f32 v179, v148, v149
v_mfma_f32_16x16x32_bf16 v[150:153], v[190:193], v[174:177], 0
s_add_u32 s28, s39, s60
v_exp_f32 v162, v162
v_mfma_f32_16x16x32_bf16 v[150:153], v[190:193], v[178:181], v[150:153]
s_add_u32 m0, s45, 0
ds_read_u16 v136, v205 offset:64
v_mov_b32 v121, 0
v_mfma_f32_16x16x32_bf16 v[138:141], v[114:117], v[174:177], 0
s_waitcnt lgkmcnt(1)
v_exp_f32 v164, v164
v_mfma_f32_16x16x32_bf16 v[138:141], v[118:121], v[178:181], v[138:141]
v_rcp_f32 v151, v150
v_mfma_f32_16x16x32_bf16 v[142:145], v[122:125], v[174:177], 0
v_mov_b32 v137, 0
v_mul_f32_e64 v152, s3, v151
v_mfma_f32_16x16x32_bf16 v[142:145], v[126:129], v[178:181], v[142:145]
v_mul_f32_e64 v139, v139, v152
v_mul_f32 v138, v138, v152
v_mfma_f32_16x16x32_bf16 v[146:149], v[130:133], v[174:177], 0
s_waitcnt lgkmcnt(0)
v_cvt_pk_bf16_f32 v174, v154, v155
v_cvt_pk_bf16_f32 v90, v90, v91
v_cvt_pk_bf16_f32 v91, v92, v93
v_cvt_pk_bf16_f32 v175, v156, v157
v_mfma_f32_16x16x32_bf16 v[146:149], v[134:137], v[178:181], v[146:149]
v_cvt_pk_bf16_f32 v176, v158, v159
v_cvt_pk_bf16_f32 v178, v162, v163
v_mfma_f32_16x16x32_bf16 v[220:223], v[236:239], v[186:189], v[220:223]
v_cvt_pk_bf16_f32 v138, v138, v139
v_mul_f32_e64 v145, v145, v152
v_cvt_pk_bf16_f32 v177, v160, v161
v_mul_f32_e64 v141, v141, v152
v_cvt_pk_bf16_f32 v179, v164, v165
v_mul_f32_e64 v149, v149, v152
v_mfma_f32_16x16x32_bf16 v[170:173], a[240:243], v[182:185], v[170:173]
v_mul_f32_e64 v142, v142, v152
v_cvt_pk_bf16_f32 v180, v166, 0
v_mfma_f32_16x16x32_bf16 v[170:173], a[244:247], v[186:189], v[170:173]
v_mul_f32 v148, v148, v152
v_mul_f32 v147, v147, v152
v_mfma_f32_16x16x32_bf16 v[166:169], v[190:193], v[174:177], 0
v_mul_f32 v144, v144, v152
v_mul_f32 v140, v140, v152
v_mfma_f32_16x16x32_bf16 v[166:169], v[190:193], v[178:181], v[166:169]
v_mul_f32 v146, v146, v152
v_mul_f32 v143, v143, v152
v_mfma_f32_16x16x32_bf16 v[158:161], v[122:125], v[174:177], 0
v_cvt_pk_bf16_f32 v95, v222, v223
v_cvt_pk_bf16_f32 v139, v140, v141
v_mfma_f32_16x16x32_bf16 v[158:161], v[126:129], v[178:181], v[158:161]
v_cvt_pk_bf16_f32 v140, v142, v143
v_cvt_pk_bf16_f32 v141, v144, v145
v_mfma_f32_16x16x32_bf16 v[162:165], v[130:133], v[174:177], 0
ds_write_b128 v211, v[138:141] offset:38912
v_mfma_f32_16x16x32_bf16 v[162:165], v[134:137], v[178:181], v[162:165]
v_max3_u32 v218, v218, v150, v151
v_rcp_f32_e64 v167, v166
v_mfma_f32_16x16x32_bf16 v[154:157], v[114:117], v[174:177], 0
v_cvt_pk_bf16_f32 v94, v220, v221
v_cvt_pk_bf16_f32 v142, v146, v147
v_cvt_pk_bf16_f32 v92, v170, v171
v_mfma_f32_16x16x32_bf16 v[154:157], v[118:121], v[178:181], v[154:157]
v_cvt_pk_bf16_f32 v93, v172, v173
v_mul_f32 v168, s3, v167
v_mul_f32 v164, v164, v168
v_mfma_f32_16x16x32_bf16 v[138:141], v[78:81], v[90:93], 0
v_cvt_pk_bf16_f32 v143, v148, v149
v_mul_f32_e64 v162, v162, v168
v_mfma_f32_16x16x32_bf16 v[150:153], v[108:111], v[90:93], v[206:209]
ds_write_b64 v212, v[142:143] offset:38912
v_mfma_f32_16x16x32_bf16 v[142:145], v[96:99], v[90:93], 0
s_sub_u32 s41, 1, s41
v_mul_f32 v159, v159, v168
v_mul_f32 v155, v155, v168
v_mul_f32 v160, v160, v168
v_mul_f32_e64 v163, v163, v168
v_mfma_f32_16x16x32_bf16 v[146:149], v[102:105], v[90:93], 0
v_mul_f32 v154, v154, v168
v_mul_f32 v157, v157, v168
v_mul_f32_e64 v156, v156, v168
v_cvt_pk_bf16_f32 v154, v154, v155
v_mfma_f32_16x16x16_bf16 v[142:145], v[100:101], v[94:95], v[142:145]
v_mul_f32 v161, v161, v168
v_mul_f32 v158, v158, v168
v_mul_f32_e64 v165, v165, v168
v_mfma_f32_16x16x16_bf16 v[146:149], v[106:107], v[94:95], v[146:149]
v_cvt_pk_bf16_f32 v155, v156, v157
v_cvt_pk_bf16_f32 v156, v158, v159
v_cvt_pk_bf16_f32 v159, v164, v165
v_mfma_f32_16x16x16_bf16 v[150:153], v[112:113], v[94:95], v[150:153]
v_cvt_pk_bf16_f32 v157, v160, v161
v_cvt_pk_bf16_f32 v158, v162, v163
v_exp_f32 v142, v142
v_mfma_f32_16x16x32_bf16 v[162:165], v[72:75], v[102:105], 0
ds_write_b64 v212, v[158:159] offset:45056
v_mfma_f32_16x16x16_bf16 v[138:141], v[82:83], v[94:95], v[138:141]
v_exp_f32 v144, v144
v_exp_f32 v143, v143
v_exp_f32 v148, v148
v_exp_f32_e64 v149, v149
v_mfma_f32_16x16x32_bf16 v[158:161], v[72:75], v[96:99], 0
s_and_b32 s51, s51, 128
ds_write_b128 v211, v[154:157] offset:45056
v_exp_f32 v145, v145
v_mfma_f32_16x16x16_bf16 v[162:165], v[76:77], v[106:107], v[162:165]
v_cvt_pk_bf16_f32 v176, v142, v143
v_exp_f32 v141, v141
v_cvt_pk_bf16_f32 v179, v148, v149
v_mfma_f32_16x16x32_bf16 v[154:157], v[72:75], v[78:81], 0
v_cvt_pk_bf16_f32 v177, v144, v145
v_exp_f32 v139, v139
v_exp_f32 v140, v140
v_mfma_f32_16x16x16_bf16 v[158:161], v[76:77], v[100:101], v[158:161]
v_exp_f32 v138, v138
v_exp_f32 v146, v146
v_mfma_f32_16x16x16_bf16 v[154:157], v[76:77], v[82:83], v[154:157]
v_cvt_pk_bf16_f32 v174, v138, v139
v_cvt_pk_bf16_f32 v175, v140, v141
v_exp_f32_e64 v147, v147
v_mfma_f32_16x16x32_bf16 v[142:145], v[122:125], v[174:177], 0
v_exp_f32 v150, v150
v_mfma_f32_16x16x32_bf16 v[138:141], v[114:117], v[174:177], 0
s_waitcnt lgkmcnt(0)
v_cvt_pk_bf16_f32 v178, v146, v147
v_cvt_pk_bf16_f32 v180, v150, 0
v_mfma_f32_16x16x32_bf16 v[150:153], v[190:193], v[174:177], 0
s_barrier
ds_read_b128 v[220:223], v210 offset:38912
v_mfma_f32_16x16x32_bf16 v[150:153], v[190:193], v[178:181], v[150:153]
ds_read_b128 v[110:113], v210 offset:39936
v_mfma_f32_16x16x32_bf16 v[138:141], v[118:121], v[178:181], v[138:141]
v_max3_u32 v218, v218, v166, v167
v_mfma_f32_16x16x32_bf16 v[142:145], v[126:129], v[178:181], v[142:145]
v_rcp_f32 v151, v150
v_mfma_f32_16x16x32_bf16 v[146:149], v[130:133], v[174:177], 0
ds_read_b128 v[182:185], v210 offset:41984
ds_read_b128 v[170:173], v210 offset:40960
v_mfma_f32_16x16x32_bf16 v[146:149], v[134:137], v[178:181], v[146:149]
s_nop 0
ds_read_b32 v166, v215 offset:536
s_waitcnt lgkmcnt(4)
v_mfma_f32_16x16x32_bf16 v[44:47], a[192:195], v[220:223], v[44:47]
v_mul_f32 v152, s3, v151
s_waitcnt lgkmcnt(3)
v_mfma_f32_16x16x32_bf16 v[44:47], a[196:199], v[110:113], v[44:47]
ds_read_b128 v[186:189], v210 offset:43008
v_mfma_f32_16x16x32_bf16 v[40:43], a[168:171], v[220:223], v[40:43]
v_mov_b32_dpp v154, v158 quad_perm:[0,1,2,3] row_mask:0x2 bank_mask:0xf
v_mul_f32_e64 v138, v138, v152
v_mfma_f32_16x16x32_bf16 v[40:43], a[172:175], v[110:113], v[40:43]
v_mul_f32 v147, v147, v152
v_mfma_f32_16x16x32_bf16 v[36:39], a[144:147], v[220:223], v[36:39]
ds_read_b128 v[220:223], v210 offset:44032
v_mov_b32_dpp v154, v162 quad_perm:[0,1,2,3] row_mask:0x4 bank_mask:0xf
v_mfma_f32_16x16x32_bf16 v[36:39], a[148:151], v[110:113], v[36:39]
s_waitcnt lgkmcnt(2)
v_add_f32_dpp v154, v166, v207 quad_perm:[0,1,2,3] row_mask:0x8 bank_mask:0xf
v_mul_f32_e64 v145, v145, v152
v_mfma_f32_16x16x32_bf16 v[36:39], a[152:155], v[170:173], v[36:39]
v_mul_f32 v140, v140, v152
v_mul_f32 v142, v142, v152
v_mfma_f32_16x16x32_bf16 v[36:39], a[156:159], v[182:185], v[36:39]
ds_read_b128 v[110:113], v210 offset:45056
v_mul_f32_e64 v149, v149, v152
v_mfma_f32_16x16x32_bf16 v[40:43], a[176:179], v[170:173], v[40:43]
v_mul_f32 v144, v144, v152
v_mul_f32 v139, v139, v152
v_mfma_f32_16x16x32_bf16 v[40:43], a[180:183], v[182:185], v[40:43]
v_exp_f32 v166, v154
v_mfma_f32_16x16x32_bf16 v[44:47], a[200:203], v[170:173], v[44:47]
ds_read_b128 v[170:173], v210 offset:46080
v_cvt_pk_bf16_f32 v154, v166, 0
v_mfma_f32_16x16x32_bf16 v[44:47], a[204:207], v[182:185], v[44:47]
s_waitcnt lgkmcnt(2)
v_cvt_pk_bf16_f32 v138, v138, v139
v_mul_f32_e64 v141, v141, v152
v_mfma_f32_16x16x32_bf16 v[44:47], a[208:211], v[186:189], v[44:47]
s_lshl_b32 s51, s51, 22
v_mul_f32 v146, v146, v152
v_add_u32 v205, 1424, v205
v_mfma_f32_16x16x32_bf16 v[44:47], a[212:215], v[220:223], v[44:47]
ds_write_b16 v214, v154
v_mfma_f32_16x16x32_bf16 v[40:43], a[184:187], v[186:189], v[40:43]
ds_read_b128 v[88:91], v215 offset:16
v_mul_f32 v148, v148, v152
v_mfma_f32_16x16x32_bf16 v[40:43], a[188:191], v[220:223], v[40:43]
ds_read_b128 v[174:177], v217
v_cvt_pk_bf16_f32 v139, v140, v141
v_mfma_f32_16x16x32_bf16 v[36:39], a[160:163], v[186:189], v[36:39]
s_lshl_b32 s41, s41, 30
ds_read_b128 v[186:189], v210 offset:48128
ds_read_b128 v[182:185], v210 offset:47104
v_mfma_f32_16x16x32_bf16 v[36:39], a[164:167], v[220:223], v[36:39]
s_waitcnt lgkmcnt(6)
v_mul_f32 v143, v143, v152
s_sub_u32 s43, 536870911, s43
v_mfma_f32_16x16x32_bf16 v[48:51], a[144:147], v[110:113], v[48:51]
s_waitcnt lgkmcnt(5)
ds_read_b128 v[220:223], v210 offset:49152
v_cvt_pk_bf16_f32 v141, v144, v145
v_mfma_f32_16x16x32_bf16 v[48:51], a[148:151], v[170:173], v[48:51]
s_add_u32 s52, s50, s41
v_cvt_pk_bf16_f32 v140, v142, v143
v_cvt_pk_bf16_f32 v143, v148, v149
v_mfma_f32_16x16x32_bf16 v[52:55], a[168:171], v[110:113], v[52:55]
ds_write_b128 v211, v[138:141] offset:51200
v_mfma_f32_16x16x32_bf16 v[52:55], a[172:175], v[170:173], v[52:55]
v_add_f32_dpp v166, v166, v166 row_ror:8 row_mask:0xf bank_mask:0xf
v_cvt_pk_bf16_f32 v36, v36, v37
v_mfma_f32_16x16x32_bf16 v[56:59], a[192:195], v[110:113], v[56:59]
s_nop 0
v_add_f32_dpp v166, v166, v166 row_ror:4 row_mask:0xf bank_mask:0xf
v_cvt_pk_bf16_f32 v142, v146, v147
v_mfma_f32_16x16x32_bf16 v[56:59], a[196:199], v[170:173], v[56:59]
s_waitcnt lgkmcnt(2)
ds_read_b128 v[110:113], v210 offset:50176
ds_read_b128 v[84:87], v215
v_mfma_f32_16x16x32_bf16 v[56:59], a[200:203], v[182:185], v[56:59]
v_add_u32 v215, 1424, v215
v_add_f32_dpp v166, v166, v166 row_ror:2 row_mask:0xf bank_mask:0xf
v_mfma_f32_16x16x32_bf16 v[56:59], a[204:207], v[186:189], v[56:59]
ds_write_b64 v212, v[142:143] offset:51200
v_mfma_f32_16x16x32_bf16 v[52:55], a[176:179], v[182:185], v[52:55]
v_add_f32_dpp v166, v166, v166 row_ror:1 row_mask:0xf bank_mask:0xf
v_cvt_pk_bf16_f32 v44, v44, v45
v_mfma_f32_16x16x32_bf16 v[52:55], a[180:183], v[186:189], v[52:55]
ds_read_b128 v[178:181], v217 offset:528
v_cvt_pk_bf16_f32 v45, v46, v47
v_mfma_f32_16x16x32_bf16 v[48:51], a[152:155], v[182:185], v[48:51]
v_cvt_pk_bf16_f32 v37, v38, v39
v_cvt_pk_bf16_f32 v40, v40, v41
v_mfma_f32_16x16x32_bf16 v[48:51], a[156:159], v[186:189], v[48:51]
s_waitcnt lgkmcnt(5)
ds_write_b64 v203, v[44:45] offset:64
v_mfma_f32_16x16x32_bf16 v[48:51], a[160:163], v[220:223], v[48:51]
v_cvt_pk_bf16_f32 v41, v42, v43
s_waitcnt lgkmcnt(4)
v_mfma_f32_16x16x32_bf16 v[48:51], a[164:167], v[110:113], v[48:51]
s_waitcnt vmcnt(0) lgkmcnt(2)
ds_write_b64 v203, v[40:41] offset:32
v_mfma_f32_16x16x32_bf16 v[162:165], v[84:87], v[130:133], 0
s_barrier
v_mfma_f32_16x16x32_bf16 v[162:165], v[88:91], v[134:137], v[162:165]
ds_read_b128 v[186:189], v210 offset:53248
v_add_f32_dpp v166, v166, v166 row_bcast:15 row_mask:0xa bank_mask:0xf
v_mfma_f32_16x16x32_bf16 v[154:157], v[84:87], v[114:117], 0
ds_read_b128 v[182:185], v210 offset:52224
ds_read_b128 v[92:95], v201
v_mfma_f32_16x16x32_bf16 v[154:157], v[88:91], v[118:121], v[154:157]
s_nop 0
ds_read_b128 v[170:173], v210 offset:51200
v_mfma_f32_16x16x32_bf16 v[158:161], v[84:87], v[122:125], 0
s_or_b32 s44, s43, s51
ds_read_b128 v[96:99], v195 offset:16
v_add_f32_dpp v166, v166, v166 row_bcast:31 row_mask:0xc bank_mask:0xf
v_mfma_f32_16x16x32_bf16 v[158:161], v[88:91], v[126:129], v[158:161]
v_mfma_f32_16x16x32_bf16 v[52:55], a[184:187], v[220:223], v[52:55]
ds_read_b128 v[84:87], v200
v_cvt_pk_bf16_f32 v48, v48, v49
v_mfma_f32_16x16x32_bf16 v[52:55], a[188:191], v[110:113], v[52:55]
v_and_b32_e64 v216, s44, v208
v_cvt_pk_bf16_f32 v49, v50, v51
v_mfma_f32_16x16x32_bf16 v[56:59], a[208:211], v[220:223], v[56:59]
s_mov_b32 s36, s50
ds_write_b64 v203, v[36:37]
v_mfma_f32_16x16x32_bf16 v[56:59], a[212:215], v[110:113], v[56:59]
s_waitcnt lgkmcnt(3)
v_mov_b32_dpp v154, v158 quad_perm:[0,1,2,3] row_mask:0x2 bank_mask:0xf
v_cvt_pk_bf16_f32 v52, v52, v53
v_mfma_f32_16x16x32_bf16 v[64:67], a[168:171], v[170:173], v[64:67]
ds_read_b128 v[220:223], v210 offset:54272
ds_read_b128 v[110:113], v210 offset:55296
v_mfma_f32_16x16x32_bf16 v[60:63], a[144:147], v[170:173], v[60:63]
s_nop 0
ds_write_b64 v203, v[48:49] offset:6272
v_mfma_f32_16x16x32_bf16 v[48:51], v[174:177], v[92:95], 0
s_waitcnt lgkmcnt(4)
v_readlane_b32 s72, v166, 63
v_cvt_pk_bf16_f32 v56, v56, v57
v_mfma_f32_16x16x32_bf16 v[36:39], v[174:177], v[84:87], 0
ds_read_b128 v[92:95], v195
v_mfma_f32_16x16x32_bf16 v[68:71], a[192:195], v[170:173], v[68:71]
ds_read_b128 v[84:87], v194
v_mfma_f32_16x16x32_bf16 v[68:71], a[196:199], v[182:185], v[68:71]
ds_read_b128 v[170:173], v210 offset:56320
v_mov_b32_dpp v154, v162 quad_perm:[0,1,2,3] row_mask:0x4 bank_mask:0xf
v_mfma_f32_16x16x32_bf16 v[68:71], a[200:203], v[186:189], v[68:71]
ds_read_b128 v[88:91], v194 offset:16
ds_read_b128 v[100:103], v202
v_mfma_f32_16x16x32_bf16 v[64:67], a[172:175], v[182:185], v[64:67]
v_cvt_pk_bf16_f32 v53, v54, v55
v_cvt_pk_bf16_f32 v57, v58, v59
v_mfma_f32_16x16x32_bf16 v[64:67], a[176:179], v[186:189], v[64:67]
ds_write_b64 v203, v[56:57] offset:6336
v_mfma_f32_16x16x32_bf16 v[60:63], a[148:151], v[182:185], v[60:63]
v_rcp_f32_e64 v167, s72
v_mfma_f32_16x16x32_bf16 v[60:63], a[152:155], v[186:189], v[60:63]
s_waitcnt lgkmcnt(8)
ds_write_b64 v203, v[52:53] offset:6304
v_mfma_f32_16x16x32_bf16 v[60:63], a[156:159], v[220:223], v[60:63]
s_waitcnt lgkmcnt(8)
v_max3_u32 v218, v218, s72, v167
v_max3_u32 v218, v218, v150, v151
v_mfma_f32_16x16x32_bf16 v[60:63], a[160:163], v[110:113], v[60:63]
s_waitcnt lgkmcnt(4)
ds_read_b128 v[182:185], v210
v_mul_f32 v168, s3, v167
v_mfma_f32_16x16x32_bf16 v[60:63], a[164:167], v[170:173], v[60:63]
s_nop 0
ds_read_b128 v[186:189], v210 offset:1024
s_waitcnt lgkmcnt(5)
v_smfmac_f32_16x16x64_bf16 v[36:39], v[178:181], v[84:91], v213
ds_read_b128 v[104:107], v196 offset:16
ds_read_b128 v[84:87], v197
v_smfmac_f32_16x16x64_bf16 v[48:51], v[178:181], v[92:99], v213
ds_read_b128 v[92:95], v198
ds_read_b128 v[88:91], v197 offset:16
v_mfma_f32_16x16x32_bf16 v[68:71], a[204:207], v[220:223], v[68:71]
s_nop 0
v_cvt_pk_bf16_f32 v60, v60, v61
v_cvt_pk_bf16_f32 v61, v62, v63
v_mfma_f32_16x16x32_bf16 v[68:71], a[208:211], v[110:113], v[68:71]
s_waitcnt lgkmcnt(8)
ds_write_b64 v203, v[60:61] offset:12544
v_mfma_f32_16x16x32_bf16 v[68:71], a[212:215], v[170:173], v[68:71]
s_add_u32 s29, s39, s61
v_mul_f32 v154, v154, v168
v_cvt_pk_bf16_f32 v154, v154, 0
v_mfma_f32_16x16x32_bf16 v[60:63], v[174:177], v[100:103], 0
ds_read_b128 v[174:177], v217 offset:1056
s_add_u32 s40, s36, 196224
v_mfma_f32_16x16x32_bf16 v[64:67], a[180:183], v[220:223], v[64:67]
v_cvt_pk_bf16_f32 v68, v68, v69
v_cvt_pk_bf16_f32 v69, v70, v71
v_mfma_f32_16x16x32_bf16 v[64:67], a[184:187], v[110:113], v[64:67]
ds_read_b128 v[100:103], v196
ds_read_b128 v[96:99], v198 offset:16
v_mfma_f32_16x16x32_bf16 v[64:67], a[188:191], v[170:173], v[64:67]
s_waitcnt lgkmcnt(9)
ds_write_b16 v214, v154
v_mfma_f32_16x16x32_bf16 v[138:141], a[0:3], v[182:185], 0
s_waitcnt lgkmcnt(9)
ds_write_b64 v203, v[68:69] offset:12608
v_mfma_f32_16x16x32_bf16 v[138:141], a[4:7], v[186:189], v[138:141]
s_nop 0
v_cvt_pk_bf16_f32 v64, v64, v65
v_cvt_pk_bf16_f32 v65, v66, v67
v_mfma_f32_16x16x32_bf16 v[146:149], a[48:51], v[182:185], 0
s_waitcnt lgkmcnt(4)
ds_write_b64 v203, v[64:65] offset:12576
v_smfmac_f32_16x16x64_bf16 v[36:39], v[174:177], v[84:91], v213
s_waitcnt lgkmcnt(4)
v_smfmac_f32_16x16x64_bf16 v[60:63], v[178:181], v[100:107], v213
s_waitcnt lgkmcnt(3)
ds_read_b128 v[104:107], v199 offset:16
ds_read_b128 v[84:87], v200 offset:32
v_smfmac_f32_16x16x64_bf16 v[48:51], v[174:177], v[92:99], v213
ds_read_b128 v[100:103], v199
ds_read_b128 v[178:181], v217 offset:1584
v_mfma_f32_16x16x32_bf16 v[150:153], a[216:219], v[182:185], 0
v_mul_f32 v119, v36, v36
v_add_f32 v118, v36, v37
v_mfma_f32_16x16x32_bf16 v[150:153], a[220:223], v[186:189], v[150:153]
ds_read_b128 v[92:95], v201 offset:32
v_fmac_f32_e64 v119, v37, v37
v_mfma_f32_16x16x32_bf16 v[158:161], v[232:235], v[182:185], 0
ds_read_b128 v[110:113], v210 offset:2048
v_add_f32 v118, v118, v38
v_mfma_f32_16x16x32_bf16 v[158:161], v[236:239], v[186:189], v[158:161]
s_waitcnt lgkmcnt(6)
ds_read_b128 v[88:91], v194 offset:48
v_add_f32_e64 v126, v48, v49
v_mfma_f32_16x16x32_bf16 v[154:157], a[240:243], v[182:185], 0
s_barrier
v_mfma_f32_16x16x32_bf16 v[154:157], a[244:247], v[186:189], v[154:157]
s_waitcnt lgkmcnt(4)
ds_read_b64 v[120:121], v204
ds_read_b64 v[128:129], v204 offset:392
v_smfmac_f32_16x16x64_bf16 v[60:63], v[174:177], v[100:107], v213
s_waitcnt lgkmcnt(5)
ds_read_b128 v[100:103], v202 offset:32
ds_read_b128 v[96:99], v195 offset:48
v_mfma_f32_16x16x32_bf16 v[40:43], v[178:181], v[84:87], 0
s_waitcnt lgkmcnt(6)
ds_read_b128 v[84:87], v194 offset:32
ds_read_b128 v[174:177], v217 offset:2112
v_mfma_f32_16x16x32_bf16 v[52:55], v[178:181], v[92:95], 0
ds_read_b128 v[92:95], v195 offset:32
v_add_f32_e64 v126, v126, v50
v_mfma_f32_16x16x32_bf16 v[170:173], v[182:185], a[120:123], 0
v_mul_f32_e64 v135, v60, v60
v_mul_f32 v127, v48, v48
v_mfma_f32_16x16x32_bf16 v[170:173], v[186:189], a[124:127], v[170:173]
s_waitcnt lgkmcnt(6)
buffer_store_dwordx2 v[120:121], v204, s[8:11], s28 offen sc1
v_fmac_f32 v119, v38, v38
v_mfma_f32_16x16x32_bf16 v[170:173], v[110:113], a[128:131], v[170:173]
s_waitcnt lgkmcnt(4)
ds_read_b128 v[104:107], v196 offset:48
v_add_f32_e64 v134, v60, v61
v_mfma_f32_16x16x32_bf16 v[64:67], v[178:181], v[100:103], 0
ds_read_b128 v[100:103], v196 offset:32
ds_read_b64 v[136:137], v204 offset:784
v_mfma_f32_16x16x32_bf16 v[146:149], a[52:55], v[186:189], v[146:149]
s_nop 0
ds_read_b128 v[178:181], v217 offset:2640
ds_read_b64 v[120:121], v204 offset:1176
v_mfma_f32_16x16x32_bf16 v[146:149], a[56:59], v[110:113], v[146:149]
s_waitcnt lgkmcnt(6)
buffer_store_dwordx2 v[128:129], v204, s[8:11], s29 offen sc1
v_fmac_f32 v119, v39, v39
v_smfmac_f32_16x16x64_bf16 v[40:43], v[174:177], v[84:91], v213
s_waitcnt lgkmcnt(5)
ds_read_b128 v[88:91], v197 offset:48
v_add_f32 v134, v134, v62
v_mfma_f32_16x16x32_bf16 v[150:153], a[224:227], v[110:113], v[150:153]
s_add_u32 s28, s39, s62
ds_read_b128 v[84:87], v197 offset:32
v_fmac_f32 v127, v49, v49
v_smfmac_f32_16x16x64_bf16 v[52:55], v[174:177], v[92:99], v213
s_waitcnt lgkmcnt(5)
ds_read_b128 v[92:95], v198 offset:32
ds_read_b128 v[96:99], v198 offset:48
v_smfmac_f32_16x16x64_bf16 v[64:67], v[174:177], v[100:107], v213
ds_read_b128 v[104:107], v199 offset:48
v_add_f32_e64 v126, v126, v51
v_mfma_f32_16x16x32_bf16 v[142:145], a[24:27], v[182:185], 0
ds_read_b128 v[100:103], v199 offset:32
v_fmac_f32 v135, v61, v61
v_mfma_f32_16x16x32_bf16 v[142:145], a[28:31], v[186:189], v[142:145]
s_add_u32 s29, s39, s63
ds_read_b128 v[220:223], v210 offset:3072
v_add_f32 v118, v118, v39
v_mfma_f32_16x16x32_bf16 v[142:145], a[32:35], v[110:113], v[142:145]
s_waitcnt lgkmcnt(9)
buffer_store_dwordx2 v[136:137], v204, s[8:11], s28 offen sc1
v_fmac_f32 v135, v62, v62
v_mfma_f32_16x16x32_bf16 v[138:141], a[8:11], v[110:113], v[138:141]
s_waitcnt lgkmcnt(5)
ds_read_b64 v[128:129], v204 offset:6272
v_fmac_f32 v127, v50, v50
v_smfmac_f32_16x16x64_bf16 v[40:43], v[178:181], v[84:91], v213
s_waitcnt lgkmcnt(4)
ds_read_b128 v[174:177], v217 offset:3168
v_fmac_f32_e64 v135, v63, v63
v_smfmac_f32_16x16x64_bf16 v[52:55], v[178:181], v[92:99], v213
ds_read_b128 v[92:95], v201 offset:64
ds_read_b128 v[84:87], v200 offset:64
v_mfma_f32_16x16x32_bf16 v[162:165], v[182:185], a[72:75], 0
ds_read_b128 v[96:99], v195 offset:80
v_fmac_f32 v127, v51, v51
v_mfma_f32_16x16x32_bf16 v[162:165], v[186:189], a[76:79], v[162:165]
s_waitcnt lgkmcnt(6)
buffer_store_dwordx2 v[120:121], v204, s[8:11], s29 offen sc1
v_fmac_f32 v127, v52, v52
v_smfmac_f32_16x16x64_bf16 v[64:67], v[178:181], v[100:107], v213
ds_read_b128 v[100:103], v202 offset:64
ds_read_b128 v[178:181], v217 offset:3696
v_mfma_f32_16x16x32_bf16 v[154:157], a[248:251], v[110:113], v[154:157]
s_waitcnt lgkmcnt(7)
ds_read_b64 v[120:121], v204 offset:7056
ds_read_b128 v[88:91], v194 offset:80
v_mfma_f32_16x16x32_bf16 v[154:157], a[252:255], v[220:223], v[154:157]
s_waitcnt lgkmcnt(6)
v_add_f32 v134, v134, v63
v_add_f32_e64 v126, v126, v52
v_mfma_f32_16x16x32_bf16 v[158:161], v[240:243], v[110:113], v[158:161]
s_add_u32 s28, s39, s64
v_add_f32 v126, v126, v53
v_fmac_f32_e64 v135, v64, v64
v_mfma_f32_16x16x32_bf16 v[56:59], v[174:177], v[92:95], 0
s_waitcnt lgkmcnt(5)
buffer_store_dwordx2 v[128:129], v204, s[8:11], s28 offen sc1
ds_read_b64 v[136:137], v204 offset:6664
v_mfma_f32_16x16x32_bf16 v[138:141], a[12:15], v[220:223], v[138:141]
s_add_u32 s29, s39, s65
ds_read_b128 v[92:95], v195 offset:64
ds_read_b64 v[128:129], v204 offset:7448
v_mfma_f32_16x16x32_bf16 v[44:47], v[174:177], v[84:87], 0
s_waitcnt lgkmcnt(6)
ds_read_b128 v[84:87], v194 offset:64
v_add_f32 v134, v134, v64
v_mfma_f32_16x16x32_bf16 v[68:71], v[174:177], v[100:103], 0
ds_read_b128 v[104:107], v196 offset:80
v_fmac_f32_e64 v127, v53, v53
v_mfma_f32_16x16x32_bf16 v[166:169], v[182:185], a[96:99], 0
ds_read_b128 v[182:185], v210 offset:4096
v_add_f32_e64 v118, v118, v40
v_mfma_f32_16x16x32_bf16 v[166:169], v[186:189], a[100:103], v[166:169]
s_add_u32 s28, s39, s66
v_fmac_f32 v127, v54, v54
v_fmac_f32 v135, v65, v65
v_mfma_f32_16x16x32_bf16 v[166:169], v[110:113], a[104:107], v[166:169]
s_waitcnt lgkmcnt(5)
buffer_store_dwordx2 v[136:137], v204, s[8:11], s29 offen sc1
ds_read_b128 v[100:103], v196 offset:64
v_mfma_f32_16x16x32_bf16 v[166:169], v[220:223], a[108:111], v[166:169]
ds_read_b128 v[186:189], v210 offset:5120
v_fmac_f32_e64 v135, v66, v66
v_mfma_f32_16x16x32_bf16 v[162:165], v[110:113], a[80:83], v[162:165]
ds_read_b64 v[136:137], v204 offset:12544
v_fmac_f32 v119, v40, v40
v_mfma_f32_16x16x32_bf16 v[162:165], v[220:223], a[84:87], v[162:165]
s_waitcnt lgkmcnt(5)
ds_read_b128 v[174:177], v217 offset:4224
v_add_f32_e64 v118, v118, v41
v_smfmac_f32_16x16x64_bf16 v[44:47], v[178:181], v[84:91], v213
ds_read_b128 v[88:91], v197 offset:80
v_add_f32_e64 v134, v134, v65
v_mfma_f32_16x16x32_bf16 v[170:173], v[220:223], a[132:135], v[170:173]
ds_read_b128 v[84:87], v197 offset:64
v_add_f32 v118, v118, v42
v_smfmac_f32_16x16x64_bf16 v[56:59], v[178:181], v[92:99], v213
s_waitcnt lgkmcnt(5)
buffer_store_dwordx2 v[120:121], v204, s[8:11], s28 offen sc1
v_add_f32_e64 v126, v126, v54
v_smfmac_f32_16x16x64_bf16 v[68:71], v[178:181], v[100:107], v213
ds_read_b128 v[96:99], v198 offset:80
ds_read_b128 v[100:103], v199 offset:64
v_mfma_f32_16x16x32_bf16 v[158:161], v[244:247], v[220:223], v[158:161]
s_add_u32 s29, s39, s67
v_add_f32 v118, v118, v43
v_fmac_f32 v119, v41, v41
v_mfma_f32_16x16x32_bf16 v[146:149], a[60:63], v[220:223], v[146:149]
s_add_u32 s28, s39, s68
ds_read_b128 v[92:95], v198 offset:64
v_fmac_f32_e64 v135, v67, v67
v_mfma_f32_16x16x32_bf16 v[142:145], a[36:39], v[220:223], v[142:145]
s_waitcnt lgkmcnt(3)
v_fmac_f32 v119, v42, v42
v_fmac_f32_e64 v119, v43, v43
v_smfmac_f32_16x16x64_bf16 v[44:47], v[174:177], v[84:91], v213
ds_read_b128 v[104:107], v199 offset:80
ds_read_b128 v[110:113], v210 offset:6144
v_mfma_f32_16x16x32_bf16 v[150:153], a[228:231], v[220:223], v[150:153]
buffer_store_dwordx2 v[128:129], v204, s[8:11], s29 offen sc1
v_fmac_f32_e64 v127, v55, v55
v_mfma_f32_16x16x32_bf16 v[150:153], a[232:235], v[182:185], v[150:153]
v_add_f32 v134, v134, v66
v_fmac_f32 v119, v44, v44
v_mfma_f32_16x16x32_bf16 v[150:153], a[236:239], v[186:189], v[150:153]
s_waitcnt lgkmcnt(2)
v_add_f32 v126, v126, v55
v_fmac_f32_e64 v119, v45, v45
v_smfmac_f32_16x16x64_bf16 v[56:59], v[174:177], v[92:99], v213
ds_read_b128 v[220:223], v210 offset:7168
ds_read_b64 v[120:121], v204 offset:12936
v_mfma_f32_16x16x32_bf16 v[154:157], v[224:227], v[182:185], v[154:157]
s_waitcnt lgkmcnt(3)
buffer_store_dwordx2 v[136:137], v204, s[8:11], s28 offen sc1
v_add_f32 v118, v118, v44
v_smfmac_f32_16x16x64_bf16 v[68:71], v[174:177], v[100:107], v213
ds_read_b64 v[128:129], v204 offset:13328
v_fmac_f32_e64 v127, v56, v56
v_mfma_f32_16x16x32_bf16 v[142:145], a[40:43], v[182:185], v[142:145]
v_add_f32 v134, v134, v67
v_fmac_f32 v127, v57, v57
v_mfma_f32_16x16x32_bf16 v[142:145], a[44:47], v[186:189], v[142:145]
v_cvt_pk_bf16_f32 v72, v150, v151
v_add_f32_e64 v118, v118, v45
v_mfma_f32_16x16x32_bf16 v[138:141], a[16:19], v[182:185], v[138:141]
v_fmac_f32 v135, v68, v68
v_add_f32 v134, v134, v68
v_mfma_f32_16x16x32_bf16 v[138:141], a[20:23], v[186:189], v[138:141]
ds_read_b64 v[136:137], v204 offset:13720
v_add_f32_e64 v126, v126, v56
v_mfma_f32_16x16x32_bf16 v[146:149], a[64:67], v[182:185], v[146:149]
v_add_f32 v126, v126, v57
v_add_f32 v134, v134, v69
v_mfma_f32_16x16x32_bf16 v[146:149], a[68:71], v[186:189], v[146:149]
v_add_f32 v126, v126, v58
v_add_f32 v118, v118, v46
v_mfma_f32_16x16x32_bf16 v[158:161], v[248:251], v[182:185], v[158:161]
v_fmac_f32 v119, v46, v46
v_fmac_f32 v135, v69, v69
v_mfma_f32_16x16x32_bf16 v[158:161], v[252:255], v[186:189], v[158:161]
v_cvt_pk_bf16_f32 v80, v142, v143
v_cvt_pk_bf16_f32 v79, v140, v141
v_mfma_f32_16x16x32_bf16 v[154:157], v[228:231], v[186:189], v[154:157]
s_add_u32 s28, s39, s70
v_cvt_pk_bf16_f32 v78, v138, v139
v_add_f32 v134, v134, v70
v_mfma_f32_16x16x32_bf16 v[166:169], v[182:185], a[112:115], v[166:169]
v_cvt_pk_bf16_f32 v83, v148, v149
v_cvt_pk_bf16_f32 v81, v144, v145
v_mfma_f32_16x16x32_bf16 v[166:169], v[186:189], a[116:119], v[166:169]
s_add_u32 s29, s39, s69
v_add_f32 v118, v118, v47
v_fmac_f32_e64 v119, v47, v47
v_mfma_f32_16x16x32_bf16 v[162:165], v[182:185], a[88:91], v[162:165]
v_permlane16_swap_b32 v118, v119
v_mfma_f32_16x16x32_bf16 v[162:165], v[186:189], a[92:95], v[162:165]
s_waitcnt lgkmcnt(2)
buffer_store_dwordx2 v[120:121], v204, s[8:11], s29 offen sc1
v_fmac_f32 v135, v70, v70
v_mfma_f32_16x16x32_bf16 v[170:173], v[182:185], a[136:139], v[170:173]
s_add_u32 s29, s39, s71
v_add_f32 v118, v118, v119
v_fmac_f32 v135, v71, v71
v_mfma_f32_16x16x32_bf16 v[170:173], v[186:189], a[140:143], v[170:173]
ds_read_b128 v[186:189], v210 offset:9216
ds_read_b128 v[182:185], v210 offset:8192
v_mfma_f32_16x16x32_bf16 v[142:145], a[24:27], v[110:113], 0
v_add_f32_e64 v134, v134, v71
v_fmac_f32 v127, v58, v58
v_mfma_f32_16x16x32_bf16 v[142:145], a[28:31], v[220:223], v[142:145]
s_waitcnt lgkmcnt(3)
buffer_store_dwordx2 v[128:129], v204, s[8:11], s28 offen sc1
v_add_f32 v126, v126, v59
v_mfma_f32_16x16x32_bf16 v[138:141], a[0:3], v[110:113], 0
v_permlane16_swap_b32 v134, v135
v_mfma_f32_16x16x32_bf16 v[138:141], a[4:7], v[220:223], v[138:141]
v_cvt_pk_bf16_f32 v82, v146, v147
v_fmac_f32 v127, v59, v59
v_mfma_f32_16x16x32_bf16 v[146:149], a[48:51], v[110:113], 0
s_waitcnt lgkmcnt(2)
buffer_store_dwordx2 v[136:137], v204, s[8:11], s29 offen sc1
v_add_f32_e64 v134, v134, v135
v_mfma_f32_16x16x32_bf16 v[146:149], a[52:55], v[220:223], v[146:149]
s_waitcnt lgkmcnt(0)
v_permlane16_swap_b32 v126, v127
v_mfma_f32_16x16x32_bf16 v[146:149], a[56:59], v[182:185], v[146:149]
v_add_f32 v126, v126, v127
v_mov_b32 v135, v134
v_mfma_f32_16x16x32_bf16 v[146:149], a[60:63], v[186:189], v[146:149]
s_nop 0
v_permlane32_swap_b32 v118, v126
s_cmp_eq_u32 s46, 1
s_cbranch_scc1 F_pf
F_nopf:
v_permlane32_swap_b32 v134, v135
v_mfma_f32_16x16x32_bf16 v[142:145], a[32:35], v[182:185], v[142:145]
v_add_f32 v118, v118, v126
v_add_f32 v134, v134, v135
v_mfma_f32_16x16x32_bf16 v[142:145], a[36:39], v[186:189], v[142:145]
ds_write_b32 v209, v118
v_mfma_f32_16x16x32_bf16 v[138:141], a[8:11], v[182:185], v[138:141]
ds_write_b32 v209, v134 offset:512
v_mfma_f32_16x16x32_bf16 v[138:141], a[12:15], v[186:189], v[138:141]
v_cvt_pk_bf16_f32 v76, v158, v159
v_cvt_pk_bf16_f32 v73, v152, v153
v_mfma_f32_16x16x32_bf16 v[150:153], a[216:219], v[110:113], 0
s_add_u32 s35, s35, 32
v_cvt_pk_bf16_f32 v74, v154, v155
v_cvt_pk_bf16_f32 v123, v168, v169
v_mfma_f32_16x16x32_bf16 v[150:153], a[220:223], v[220:223], v[150:153]
v_cvt_pk_bf16_f32 v131, v172, v173
v_mfma_f32_16x16x32_bf16 v[150:153], a[224:227], v[182:185], v[150:153]
s_mul_hi_u32 s41, s35, 58835169
v_cvt_pk_bf16_f32 v75, v156, v157
v_mfma_f32_16x16x32_bf16 v[150:153], a[228:231], v[186:189], v[150:153]
v_cvt_pk_bf16_f32 v77, v160, v161
s_waitcnt lgkmcnt(0)
v_mfma_f32_16x16x32_bf16 v[154:157], a[240:243], v[110:113], 0
s_barrier
v_mfma_f32_16x16x32_bf16 v[154:157], a[244:247], v[220:223], v[154:157]
s_mul_i32 s42, s41, 73
ds_read_b128 v[106:109], v210 offset:19456
ds_read_b128 v[102:105], v210 offset:18432
v_mfma_f32_16x16x32_bf16 v[154:157], a[248:251], v[182:185], v[154:157]
buffer_load_dwordx4 v216, s[4:7], s52 offen nt lds
v_mfma_f32_16x16x32_bf16 v[158:161], v[232:235], v[110:113], 0
v_cvt_pk_bf16_f32 v130, v170, v171
v_cvt_pk_bf16_f32 v115, v164, v165
v_mfma_f32_16x16x32_bf16 v[158:161], v[236:239], v[220:223], v[158:161]
v_cvt_pk_bf16_f32 v114, v162, v163
v_mfma_f32_16x16x32_bf16 v[158:161], v[240:243], v[182:185], v[158:161]
v_cvt_pk_bf16_f32 v122, v166, v167
v_mfma_f32_16x16x32_bf16 v[158:161], v[244:247], v[186:189], v[158:161]
s_waitcnt lgkmcnt(1)
v_add_f32 v108, v108, v109
v_mfma_f32_16x16x32_bf16 v[170:173], v[110:113], a[120:123], 0
v_add_f32 v106, v106, v107
v_add_f32 v106, v106, v108
v_mfma_f32_16x16x32_bf16 v[170:173], v[220:223], a[124:127], v[170:173]
s_waitcnt lgkmcnt(0)
v_add_f32 v102, v102, v103
v_add_f32_e64 v104, v104, v105
v_mfma_f32_16x16x32_bf16 v[166:169], v[110:113], a[96:99], 0
s_add_u32 m0, s45, 4112
v_add_f32 v102, v102, v104
v_mul_f32 v104, s73, v102
v_mfma_f32_16x16x32_bf16 v[166:169], v[220:223], a[100:103], v[166:169]
v_mul_f32 v103, s48, v102
v_mul_f32 v106, s73, v106
v_mfma_f32_16x16x32_bf16 v[162:165], v[110:113], a[72:75], 0
buffer_load_dwordx4 v216, s[4:7], s40 offen nt lds
v_mfma_f32_16x16x32_bf16 v[162:165], v[220:223], a[76:79], v[162:165]
v_fma_f32 v106, -v103, v104, v106
v_max_f32_e64 v106, 0, v106
v_mfma_f32_16x16x32_bf16 v[162:165], v[182:185], a[80:83], v[162:165]
ds_read_b128 v[110:113], v210 offset:10240
v_add_f32_e64 v106, s49, v106
v_mfma_f32_16x16x32_bf16 v[162:165], v[186:189], a[84:87], v[162:165]
s_add_u32 s40, s36, 392448
v_rsq_f32_e64 v102, v106
v_mfma_f32_16x16x32_bf16 v[170:173], v[182:185], a[128:131], v[170:173]
ds_read_b128 v[106:109], v210 offset:11264
v_mul_f32_e64 v103, -v103, v102
v_mfma_f32_16x16x32_bf16 v[170:173], v[186:189], a[132:135], v[170:173]
ds_write_b64 v211, v[102:103] offset:20480
v_mfma_f32_16x16x32_bf16 v[166:169], v[182:185], a[104:107], v[166:169]
v_mfma_f32_16x16x32_bf16 v[166:169], v[186:189], a[108:111], v[166:169]
ds_read_b64 v[118:119], v219 offset:20480
v_add_u32 v214, 1424, v214
v_mfma_f32_16x16x32_bf16 v[154:157], a[252:255], v[186:189], v[154:157]
s_add_u32 m0, s45, 8224
ds_read_b64 v[134:135], v219 offset:20992
s_waitcnt lgkmcnt(4)
v_mfma_f32_16x16x32_bf16 v[154:157], v[224:227], v[110:113], v[154:157]
buffer_load_dwordx4 v216, s[4:7], s40 offen nt lds
v_mfma_f32_16x16x32_bf16 v[142:145], a[40:43], v[110:113], v[142:145]
ds_read_b128 v[182:185], v210 offset:12288
s_waitcnt lgkmcnt(4)
v_mfma_f32_16x16x32_bf16 v[142:145], a[44:47], v[106:109], v[142:145]
s_nop 0
ds_read_b128 v[186:189], v210 offset:13312
ds_read_b64 v[126:127], v219 offset:20736
v_mfma_f32_16x16x32_bf16 v[150:153], a[232:235], v[110:113], v[150:153]
s_waitcnt lgkmcnt(4)
v_fma_f32 v223, v39, v118, v119
v_fma_f32 v221, v37, v118, v119
v_mfma_f32_16x16x32_bf16 v[150:153], a[236:239], v[106:109], v[150:153]
s_nop 0
v_fma_f32 v220, v36, v118, v119
v_fma_f32 v222, v38, v118, v119
v_mfma_f32_16x16x32_bf16 v[146:149], a[64:67], v[110:113], v[146:149]
s_sub_u32 s42, s35, s42
v_cvt_pk_bf16_f32 v175, v222, v223
v_fma_f32 v222, v42, v118, v119
v_mfma_f32_16x16x32_bf16 v[146:149], a[68:71], v[106:109], v[146:149]
v_cvt_pk_bf16_f32 v99, v144, v145
v_cvt_pk_bf16_f32 v174, v220, v221
v_mfma_f32_16x16x32_bf16 v[166:169], v[110:113], a[112:115], v[166:169]
s_add_u32 m0, s45, 12336
v_fma_f32 v223, v43, v118, v119
v_fma_f32 v220, v40, v118, v119
v_mfma_f32_16x16x32_bf16 v[166:169], v[106:109], a[116:119], v[166:169]
s_add_u32 s40, s36, 588672
v_cvt_pk_bf16_f32 v100, v146, v147
v_fma_f32 v221, v41, v118, v119
v_mfma_f32_16x16x32_bf16 v[154:157], v[228:231], v[106:109], v[154:157]
buffer_load_dwordx4 v216, s[4:7], s40 offen nt lds
v_mfma_f32_16x16x32_bf16 v[138:141], a[16:19], v[110:113], v[138:141]
v_cvt_pk_bf16_f32 v177, v222, v223
v_cvt_pk_bf16_f32 v176, v220, v221
v_mfma_f32_16x16x32_bf16 v[138:141], a[20:23], v[106:109], v[138:141]
ds_write_b128 v211, v[174:177] offset:20480
v_mfma_f32_16x16x32_bf16 v[158:161], v[248:251], v[110:113], v[158:161]
v_cvt_pk_bf16_f32 v97, v140, v141
v_fma_f32 v223, v47, v118, v119
v_mfma_f32_16x16x32_bf16 v[158:161], v[252:255], v[106:109], v[158:161]
s_add_u32 s40, s36, 784896
v_fma_f32 v222, v46, v118, v119
v_cvt_pk_bf16_f32 v125, v168, v169
v_mfma_f32_16x16x32_bf16 v[170:173], v[110:113], a[136:139], v[170:173]
v_fma_f32 v220, v44, v118, v119
v_fma_f32 v221, v45, v118, v119
v_mfma_f32_16x16x32_bf16 v[170:173], v[106:109], a[140:143], v[170:173]
v_cvt_pk_bf16_f32 v86, v154, v155
v_cvt_pk_bf16_f32 v179, v222, v223
v_mfma_f32_16x16x32_bf16 v[162:165], v[110:113], a[88:91], v[162:165]
s_add_u32 m0, s45, 16448
v_cvt_pk_bf16_f32 v124, v166, v167
v_cvt_pk_bf16_f32 v98, v142, v143
v_mfma_f32_16x16x32_bf16 v[162:165], v[106:109], a[92:95], v[162:165]
s_waitcnt lgkmcnt(1)
ds_read_b64 v[112:113], v215 offset:528
v_fma_f32 v223, v51, v126, v127
v_mfma_f32_16x16x32_bf16 v[142:145], a[24:27], v[182:185], 0
s_nop 0
v_cvt_pk_bf16_f32 v178, v220, v221
v_cvt_pk_bf16_f32 v101, v148, v149
v_mfma_f32_16x16x32_bf16 v[142:145], a[28:31], v[186:189], v[142:145]
v_cvt_pk_bf16_f32 v96, v138, v139
v_fma_f32 v222, v50, v126, v127
v_mfma_f32_16x16x32_bf16 v[146:149], a[48:51], v[182:185], 0
buffer_load_dwordx4 v216, s[4:7], s40 offen nt lds
v_mfma_f32_16x16x32_bf16 v[146:149], a[52:55], v[186:189], v[146:149]
ds_read_b128 v[174:177], v210 offset:14336
v_cvt_pk_bf16_f32 v89, v160, v161
v_mfma_f32_16x16x32_bf16 v[138:141], a[0:3], v[182:185], 0
s_nop 0
v_cvt_pk_bf16_f32 v88, v158, v159
v_cvt_pk_bf16_f32 v84, v150, v151
v_mfma_f32_16x16x32_bf16 v[138:141], a[4:7], v[186:189], v[138:141]
s_add_u32 s40, s36, 981120
ds_write_b64 v212, v[178:179] offset:20480
v_mfma_f32_16x16x16_bf16 v[158:161], v[100:101], v[88:89], 0
v_cvt_pk_bf16_f32 v91, v222, v223
v_cvt_pk_bf16_f32 v87, v156, v157
v_fma_f32 v222, v54, v126, v127
v_mfma_f32_16x16x16_bf16 v[154:157], v[82:83], v[88:89], 0
s_waitcnt lgkmcnt(2)
ds_read_b128 v[178:181], v210 offset:15360
v_fma_f32 v223, v55, v126, v127
v_mfma_f32_16x16x16_bf16 v[166:169], v[112:113], v[88:89], v[206:209]
v_fma_f32 v221, v49, v126, v127
v_fma_f32 v220, v48, v126, v127
v_cvt_pk_bf16_f32 v85, v152, v153
v_mfma_f32_16x16x16_bf16 v[150:153], v[112:113], v[76:77], v[206:209]
v_cvt_pk_bf16_f32 v93, v222, v223
v_fma_f32 v223, v59, v126, v127
v_cvt_pk_bf16_f32 v90, v220, v221
v_fma_f32 v220, v52, v126, v127
v_mfma_f32_16x16x32_bf16 v[154:157], v[78:81], v[84:87], v[154:157]
s_add_u32 m0, s45, 20560
ds_read_b128 v[108:111], v215 offset:512
v_fma_f32 v221, v53, v126, v127
v_mfma_f32_16x16x32_bf16 v[158:161], v[96:99], v[84:87], v[158:161]
s_waitcnt lgkmcnt(3)
ds_read_b128 v[186:189], v210 offset:17408
v_fma_f32 v222, v58, v126, v127
v_mfma_f32_16x16x32_bf16 v[138:141], a[8:11], v[174:177], v[138:141]
s_waitcnt lgkmcnt(2)
buffer_load_dwordx4 v216, s[4:7], s40 offen nt lds
v_mfma_f32_16x16x32_bf16 v[138:141], a[12:15], v[178:181], v[138:141]
s_add_u32 m0, s45, 24672
ds_read_b128 v[182:185], v210 offset:16384
v_cvt_pk_bf16_f32 v92, v220, v221
v_mfma_f32_16x16x32_bf16 v[142:145], a[32:35], v[174:177], v[142:145]
v_cvt_pk_bf16_f32 v95, v222, v223
v_fma_f32 v221, v57, v126, v127
v_mfma_f32_16x16x32_bf16 v[142:145], a[36:39], v[178:181], v[142:145]
s_mul_i32 s43, s41, 1373568
ds_write_b128 v211, v[90:93] offset:26624
v_mfma_f32_16x16x32_bf16 v[146:149], a[56:59], v[174:177], v[146:149]
s_waitcnt lgkmcnt(3)
v_exp_f32 v161, v161
v_mfma_f32_16x16x32_bf16 v[146:149], a[60:63], v[178:181], v[146:149]
s_mul_i32 s51, s42, 2688
v_fma_f32 v223, v63, v134, v135
v_fma_f32 v222, v62, v134, v135
v_mfma_f32_16x16x32_bf16 v[166:169], v[108:111], v[84:87], v[166:169]
s_waitcnt lgkmcnt(1)
v_fma_f32 v220, v56, v126, v127
v_cvt_pk_bf16_f32 v91, v222, v223
v_mfma_f32_16x16x32_bf16 v[126:129], v[182:185], a[112:115], 0
s_nop 0
v_cvt_pk_bf16_f32 v94, v220, v221
v_fma_f32 v222, v66, v134, v135
v_mfma_f32_16x16x32_bf16 v[126:129], v[186:189], a[116:119], v[126:129]
s_add_u32 s40, s36, 1177344
v_fma_f32 v221, v61, v134, v135
v_cvt_pk_bf16_f32 v133, v172, v173
v_mfma_f32_16x16x32_bf16 v[126:129], v[174:177], a[104:107], v[126:129]
buffer_load_dwordx4 v216, s[4:7], s40 offen nt lds
v_mfma_f32_16x16x32_bf16 v[138:141], a[16:19], v[182:185], v[138:141]
v_fma_f32 v223, v67, v134, v135
v_fma_f32 v220, v60, v134, v135
v_mfma_f32_16x16x32_bf16 v[138:141], a[20:23], v[186:189], v[138:141]
s_add_u32 s50, s43, s51
v_exp_f32 v160, v160
v_mfma_f32_16x16x32_bf16 v[142:145], a[40:43], v[182:185], v[142:145]
s_add_u32 m0, s45, 28784
v_cvt_pk_bf16_f32 v90, v220, v221
v_fma_f32 v221, v65, v134, v135
v_mfma_f32_16x16x32_bf16 v[142:145], a[44:47], v[186:189], v[142:145]
v_fma_f32 v220, v64, v134, v135
v_cvt_pk_bf16_f32 v102, v138, v139
v_mfma_f32_16x16x32_bf16 v[146:149], a[64:67], v[182:185], v[146:149]
s_nop 0
v_cvt_pk_bf16_f32 v92, v220, v221
v_cvt_pk_bf16_f32 v103, v140, v141
v_mfma_f32_16x16x32_bf16 v[146:149], a[68:71], v[186:189], v[146:149]
s_mov_b32 s39, s37
v_cvt_pk_bf16_f32 v93, v222, v223
v_fma_f32 v220, v68, v134, v135
v_mfma_f32_16x16x32_bf16 v[118:121], v[182:185], a[88:91], 0
ds_write_b64 v212, v[94:95] offset:26624
v_mfma_f32_16x16x32_bf16 v[118:121], v[186:189], a[92:95], v[118:121]
s_add_u32 s40, s36, 1373568
v_exp_f32_e64 v158, v158
v_mfma_f32_16x16x32_bf16 v[118:121], v[174:177], a[80:83], v[118:121]
buffer_load_dwordx4 v216, s[4:7], s40 offen nt lds
v_mfma_f32_16x16x32_bf16 v[118:121], v[178:181], a[84:87], v[118:121]
v_cvt_pk_bf16_f32 v132, v170, v171
v_fma_f32 v222, v70, v134, v135
v_mfma_f32_16x16x16_bf16 v[138:141], v[82:83], v[76:77], 0
ds_write_b128 v211, v[90:93] offset:32768
v_mfma_f32_16x16x32_bf16 v[150:153], v[108:111], v[72:75], v[150:153]
v_cvt_pk_bf16_f32 v107, v148, v149
v_fma_f32 v223, v71, v134, v135
v_mfma_f32_16x16x32_bf16 v[138:141], v[78:81], v[72:75], v[138:141]
v_fma_f32 v221, v69, v134, v135
v_cvt_pk_bf16_f32 v95, v222, v223
v_mfma_f32_16x16x32_bf16 v[90:93], a[232:235], v[182:185], 0
v_cvt_pk_bf16_f32 v105, v144, v145
v_cvt_pk_bf16_f32 v106, v146, v147
v_mfma_f32_16x16x32_bf16 v[170:173], v[224:227], v[182:185], 0
v_exp_f32_e64 v140, v140
v_mfma_f32_16x16x32_bf16 v[170:173], v[228:231], v[186:189], v[170:173]
v_cvt_pk_bf16_f32 v94, v220, v221
v_cvt_pk_bf16_f32 v104, v142, v143
v_mfma_f32_16x16x32_bf16 v[170:173], a[248:251], v[174:177], v[170:173]
s_add_u32 m0, s45, 32896
v_cvt_pk_bf16_f32 v117, v164, v165
v_cvt_pk_bf16_f32 v116, v162, v163
v_mfma_f32_16x16x32_bf16 v[134:137], v[182:185], a[136:139], 0
s_add_u32 s40, s36, 1569792
v_exp_f32 v141, v141
v_mfma_f32_16x16x32_bf16 v[134:137], v[186:189], a[140:143], v[134:137]
buffer_load_dwordx4 v216, s[4:7], s40 offen nt lds
v_mfma_f32_16x16x32_bf16 v[220:223], v[248:251], v[182:185], 0
v_exp_f32 v155, v155
v_mfma_f32_16x16x32_bf16 v[220:223], v[252:255], v[186:189], v[220:223]
s_add_u32 s51, s42, 56
v_exp_f32 v156, v156
v_mfma_f32_16x16x32_bf16 v[220:223], v[240:243], v[174:177], v[220:223]
s_min_u32 s43, s42, 1
v_exp_f32 v150, v150
v_mfma_f32_16x16x32_bf16 v[90:93], a[236:239], v[186:189], v[90:93]
v_exp_f32 v166, v166
v_mfma_f32_16x16x32_bf16 v[90:93], a[224:227], v[174:177], v[90:93]
ds_write_b64 v212, v[94:95] offset:32768
v_mfma_f32_16x16x16_bf16 v[142:145], v[100:101], v[76:77], 0
v_exp_f32 v157, v157
v_exp_f32 v159, v159
v_mfma_f32_16x16x32_bf16 v[126:129], v[178:181], a[108:111], v[126:129]
v_exp_f32 v139, v139
v_mfma_f32_16x16x32_bf16 v[142:145], v[96:99], v[72:75], v[142:145]
v_exp_f32_e64 v138, v138
v_mfma_f32_16x16x32_bf16 v[134:137], v[174:177], a[128:131], v[134:137]
ds_read_b128 v[182:185], v210 offset:12288
v_cvt_pk_bf16_f32 v175, v140, v141
v_mfma_f32_16x16x32_bf16 v[134:137], v[178:181], a[132:135], v[134:137]
ds_read_b128 v[186:189], v210 offset:13312
v_exp_f32 v142, v142
v_mfma_f32_16x16x16_bf16 v[146:149], v[106:107], v[76:77], 0
v_cvt_pk_bf16_f32 v174, v138, v139
v_exp_f32 v145, v145
v_mfma_f32_16x16x16_bf16 v[162:165], v[106:107], v[88:89], 0
v_exp_f32 v143, v143
v_exp_f32 v144, v144
v_mfma_f32_16x16x32_bf16 v[146:149], v[102:105], v[72:75], v[146:149]
ds_read_b128 v[72:75], v215
ds_read_b64 v[76:77], v215 offset:16
v_mfma_f32_16x16x32_bf16 v[162:165], v[102:105], v[84:87], v[162:165]
s_waitcnt lgkmcnt(3)
v_exp_f32 v154, v154
v_mfma_f32_16x16x32_bf16 v[118:121], v[182:185], a[72:75], v[118:121]
s_waitcnt lgkmcnt(2)
v_exp_f32 v149, v149
v_mfma_f32_16x16x32_bf16 v[118:121], v[186:189], a[76:79], v[118:121]
v_exp_f32 v165, v165
v_mfma_f32_16x16x32_bf16 v[134:137], v[182:185], a[120:123], v[134:137]
v_exp_f32 v146, v146
v_mfma_f32_16x16x32_bf16 v[134:137], v[186:189], a[124:127], v[134:137]
s_min_u32 s41, s41, 1
v_exp_f32 v163, v163
v_mfma_f32_16x16x32_bf16 v[126:129], v[182:185], a[96:99], v[126:129]
v_cvt_pk_bf16_f32 v176, v142, v143
v_cvt_pk_bf16_f32 v118, v118, v119
v_mfma_f32_16x16x32_bf16 v[126:129], v[186:189], a[100:103], v[126:129]
v_exp_f32_e64 v148, v148
v_mfma_f32_16x16x32_bf16 v[170:173], a[252:255], v[178:181], v[170:173]
v_cvt_pk_bf16_f32 v119, v120, v121
v_cvt_pk_bf16_f32 v134, v134, v135
v_mfma_f32_16x16x32_bf16 v[220:223], v[244:247], v[178:181], v[220:223]
v_cvt_pk_bf16_f32 v126, v126, v127
v_cvt_pk_bf16_f32 v135, v136, v137
v_cvt_pk_bf16_f32 v177, v144, v145
v_cvt_pk_bf16_f32 v127, v128, v129
v_mfma_f32_16x16x32_bf16 v[220:223], v[232:235], v[182:185], v[220:223]
s_lshl_b32 s43, s43, 27
ds_read_u16 v128, v205 offset:32
ds_read_u16 v120, v205
v_mfma_f32_16x16x32_bf16 v[90:93], a[228:231], v[178:181], v[90:93]
v_exp_f32 v147, v147
v_cvt_pk_bf16_f32 v180, v150, 0
v_mfma_f32_16x16x32_bf16 v[90:93], a[216:219], v[182:185], v[90:93]
v_mov_b32 v181, 0
v_mov_b32 v129, 0
v_mfma_f32_16x16x32_bf16 v[90:93], a[220:223], v[186:189], v[90:93]
v_cvt_pk_bf16_f32 v178, v146, v147
v_cvt_pk_bf16_f32 v179, v148, v149
v_mfma_f32_16x16x32_bf16 v[150:153], v[190:193], v[174:177], 0
s_add_u32 s28, s38, s60
v_exp_f32 v162, v162
v_mfma_f32_16x16x32_bf16 v[150:153], v[190:193], v[178:181], v[150:153]
s_add_u32 m0, s45, 0
ds_read_u16 v136, v205 offset:64
v_mov_b32 v121, 0
v_mfma_f32_16x16x32_bf16 v[138:141], v[114:117], v[174:177], 0
s_waitcnt lgkmcnt(1)
v_exp_f32 v164, v164
v_mfma_f32_16x16x32_bf16 v[138:141], v[118:121], v[178:181], v[138:141]
v_rcp_f32 v151, v150
v_mfma_f32_16x16x32_bf16 v[142:145], v[122:125], v[174:177], 0
v_mov_b32 v137, 0
v_mul_f32_e64 v152, s3, v151
v_mfma_f32_16x16x32_bf16 v[142:145], v[126:129], v[178:181], v[142:145]
v_mul_f32_e64 v139, v139, v152
v_mul_f32 v138, v138, v152
v_mfma_f32_16x16x32_bf16 v[146:149], v[130:133], v[174:177], 0
s_waitcnt lgkmcnt(0)
v_cvt_pk_bf16_f32 v174, v154, v155
v_cvt_pk_bf16_f32 v90, v90, v91
v_cvt_pk_bf16_f32 v91, v92, v93
v_cvt_pk_bf16_f32 v175, v156, v157
v_mfma_f32_16x16x32_bf16 v[146:149], v[134:137], v[178:181], v[146:149]
v_cvt_pk_bf16_f32 v176, v158, v159
v_cvt_pk_bf16_f32 v178, v162, v163
v_mfma_f32_16x16x32_bf16 v[220:223], v[236:239], v[186:189], v[220:223]
v_cvt_pk_bf16_f32 v138, v138, v139
v_mul_f32_e64 v145, v145, v152
v_cvt_pk_bf16_f32 v177, v160, v161
v_mul_f32_e64 v141, v141, v152
v_cvt_pk_bf16_f32 v179, v164, v165
v_mul_f32_e64 v149, v149, v152
v_mfma_f32_16x16x32_bf16 v[170:173], a[240:243], v[182:185], v[170:173]
v_mul_f32_e64 v142, v142, v152
v_cvt_pk_bf16_f32 v180, v166, 0
v_mfma_f32_16x16x32_bf16 v[170:173], a[244:247], v[186:189], v[170:173]
v_mul_f32 v148, v148, v152
v_mul_f32 v147, v147, v152
v_mfma_f32_16x16x32_bf16 v[166:169], v[190:193], v[174:177], 0
v_mul_f32 v144, v144, v152
v_mul_f32 v140, v140, v152
v_mfma_f32_16x16x32_bf16 v[166:169], v[190:193], v[178:181], v[166:169]
v_mul_f32 v146, v146, v152
v_mul_f32 v143, v143, v152
v_mfma_f32_16x16x32_bf16 v[158:161], v[122:125], v[174:177], 0
v_cvt_pk_bf16_f32 v95, v222, v223
v_cvt_pk_bf16_f32 v139, v140, v141
v_mfma_f32_16x16x32_bf16 v[158:161], v[126:129], v[178:181], v[158:161]
v_cvt_pk_bf16_f32 v140, v142, v143
v_cvt_pk_bf16_f32 v141, v144, v145
v_mfma_f32_16x16x32_bf16 v[162:165], v[130:133], v[174:177], 0
ds_write_b128 v211, v[138:141] offset:38912
v_mfma_f32_16x16x32_bf16 v[162:165], v[134:137], v[178:181], v[162:165]
v_max3_u32 v218, v218, v150, v151
v_rcp_f32_e64 v167, v166
v_mfma_f32_16x16x32_bf16 v[154:157], v[114:117], v[174:177], 0
v_cvt_pk_bf16_f32 v94, v220, v221
v_cvt_pk_bf16_f32 v142, v146, v147
v_cvt_pk_bf16_f32 v92, v170, v171
v_mfma_f32_16x16x32_bf16 v[154:157], v[118:121], v[178:181], v[154:157]
v_cvt_pk_bf16_f32 v93, v172, v173
v_mul_f32 v168, s3, v167
v_mul_f32 v164, v164, v168
v_mfma_f32_16x16x32_bf16 v[138:141], v[78:81], v[90:93], 0
v_cvt_pk_bf16_f32 v143, v148, v149
v_mul_f32_e64 v162, v162, v168
v_mfma_f32_16x16x32_bf16 v[150:153], v[108:111], v[90:93], v[206:209]
ds_write_b64 v212, v[142:143] offset:38912
v_mfma_f32_16x16x32_bf16 v[142:145], v[96:99], v[90:93], 0
s_sub_u32 s41, 1, s41
v_mul_f32 v159, v159, v168
v_mul_f32 v155, v155, v168
v_mul_f32 v160, v160, v168
v_mul_f32_e64 v163, v163, v168
v_mfma_f32_16x16x32_bf16 v[146:149], v[102:105], v[90:93], 0
v_mul_f32 v154, v154, v168
v_mul_f32 v157, v157, v168
v_mul_f32_e64 v156, v156, v168
v_cvt_pk_bf16_f32 v154, v154, v155
v_mfma_f32_16x16x16_bf16 v[142:145], v[100:101], v[94:95], v[142:145]
v_mul_f32 v161, v161, v168
v_mul_f32 v158, v158, v168
v_mul_f32_e64 v165, v165, v168
v_mfma_f32_16x16x16_bf16 v[146:149], v[106:107], v[94:95], v[146:149]
v_cvt_pk_bf16_f32 v155, v156, v157
v_cvt_pk_bf16_f32 v156, v158, v159
v_cvt_pk_bf16_f32 v159, v164, v165
v_mfma_f32_16x16x16_bf16 v[150:153], v[112:113], v[94:95], v[150:153]
v_cvt_pk_bf16_f32 v157, v160, v161
v_cvt_pk_bf16_f32 v158, v162, v163
v_exp_f32 v142, v142
v_mfma_f32_16x16x32_bf16 v[162:165], v[72:75], v[102:105], 0
ds_write_b64 v212, v[158:159] offset:45056
v_mfma_f32_16x16x16_bf16 v[138:141], v[82:83], v[94:95], v[138:141]
v_exp_f32 v144, v144
v_exp_f32 v143, v143
v_exp_f32 v148, v148
v_exp_f32_e64 v149, v149
v_mfma_f32_16x16x32_bf16 v[158:161], v[72:75], v[96:99], 0
s_and_b32 s51, s51, 128
ds_write_b128 v211, v[154:157] offset:45056
v_exp_f32 v145, v145
v_mfma_f32_16x16x16_bf16 v[162:165], v[76:77], v[106:107], v[162:165]
v_cvt_pk_bf16_f32 v176, v142, v143
v_exp_f32 v141, v141
v_cvt_pk_bf16_f32 v179, v148, v149
v_mfma_f32_16x16x32_bf16 v[154:157], v[72:75], v[78:81], 0
v_cvt_pk_bf16_f32 v177, v144, v145
v_exp_f32 v139, v139
v_exp_f32 v140, v140
v_mfma_f32_16x16x16_bf16 v[158:161], v[76:77], v[100:101], v[158:161]
v_exp_f32 v138, v138
v_exp_f32 v146, v146
v_mfma_f32_16x16x16_bf16 v[154:157], v[76:77], v[82:83], v[154:157]
v_cvt_pk_bf16_f32 v174, v138, v139
v_cvt_pk_bf16_f32 v175, v140, v141
v_exp_f32_e64 v147, v147
v_mfma_f32_16x16x32_bf16 v[142:145], v[122:125], v[174:177], 0
v_exp_f32 v150, v150
v_mfma_f32_16x16x32_bf16 v[138:141], v[114:117], v[174:177], 0
s_waitcnt lgkmcnt(0)
v_cvt_pk_bf16_f32 v178, v146, v147
v_cvt_pk_bf16_f32 v180, v150, 0
v_mfma_f32_16x16x32_bf16 v[150:153], v[190:193], v[174:177], 0
s_barrier
ds_read_b128 v[220:223], v210 offset:38912
v_mfma_f32_16x16x32_bf16 v[150:153], v[190:193], v[178:181], v[150:153]
ds_read_b128 v[110:113], v210 offset:39936
v_mfma_f32_16x16x32_bf16 v[138:141], v[118:121], v[178:181], v[138:141]
v_max3_u32 v218, v218, v166, v167
v_mfma_f32_16x16x32_bf16 v[142:145], v[126:129], v[178:181], v[142:145]
v_rcp_f32 v151, v150
v_mfma_f32_16x16x32_bf16 v[146:149], v[130:133], v[174:177], 0
ds_read_b128 v[182:185], v210 offset:41984
ds_read_b128 v[170:173], v210 offset:40960
v_mfma_f32_16x16x32_bf16 v[146:149], v[134:137], v[178:181], v[146:149]
s_nop 0
ds_read_b32 v166, v215 offset:536
s_waitcnt lgkmcnt(4)
v_mfma_f32_16x16x32_bf16 v[8:11], a[192:195], v[220:223], v[8:11]
v_mul_f32 v152, s3, v151
s_waitcnt lgkmcnt(3)
v_mfma_f32_16x16x32_bf16 v[8:11], a[196:199], v[110:113], v[8:11]
ds_read_b128 v[186:189], v210 offset:43008
v_mfma_f32_16x16x32_bf16 v[4:7], a[168:171], v[220:223], v[4:7]
v_mov_b32_dpp v154, v158 quad_perm:[0,1,2,3] row_mask:0x2 bank_mask:0xf
v_mul_f32_e64 v138, v138, v152
v_mfma_f32_16x16x32_bf16 v[4:7], a[172:175], v[110:113], v[4:7]
v_mul_f32 v147, v147, v152
v_mfma_f32_16x16x32_bf16 v[0:3], a[144:147], v[220:223], v[0:3]
ds_read_b128 v[220:223], v210 offset:44032
v_mov_b32_dpp v154, v162 quad_perm:[0,1,2,3] row_mask:0x4 bank_mask:0xf
v_mfma_f32_16x16x32_bf16 v[0:3], a[148:151], v[110:113], v[0:3]
s_waitcnt lgkmcnt(2)
v_add_f32_dpp v154, v166, v207 quad_perm:[0,1,2,3] row_mask:0x8 bank_mask:0xf
v_mul_f32_e64 v145, v145, v152
v_mfma_f32_16x16x32_bf16 v[0:3], a[152:155], v[170:173], v[0:3]
v_mul_f32 v140, v140, v152
v_mul_f32 v142, v142, v152
v_mfma_f32_16x16x32_bf16 v[0:3], a[156:159], v[182:185], v[0:3]
ds_read_b128 v[110:113], v210 offset:45056
v_mul_f32_e64 v149, v149, v152
v_mfma_f32_16x16x32_bf16 v[4:7], a[176:179], v[170:173], v[4:7]
v_mul_f32 v144, v144, v152
v_mul_f32 v139, v139, v152
v_mfma_f32_16x16x32_bf16 v[4:7], a[180:183], v[182:185], v[4:7]
v_exp_f32 v166, v154
v_mfma_f32_16x16x32_bf16 v[8:11], a[200:203], v[170:173], v[8:11]
ds_read_b128 v[170:173], v210 offset:46080
v_cvt_pk_bf16_f32 v154, v166, 0
v_mfma_f32_16x16x32_bf16 v[8:11], a[204:207], v[182:185], v[8:11]
s_waitcnt lgkmcnt(2)
v_cvt_pk_bf16_f32 v138, v138, v139
v_mul_f32_e64 v141, v141, v152
v_mfma_f32_16x16x32_bf16 v[8:11], a[208:211], v[186:189], v[8:11]
s_lshl_b32 s51, s51, 22
v_mul_f32 v146, v146, v152
v_add_u32 v205, 1424, v205
v_mfma_f32_16x16x32_bf16 v[8:11], a[212:215], v[220:223], v[8:11]
ds_write_b16 v214, v154
v_mfma_f32_16x16x32_bf16 v[4:7], a[184:187], v[186:189], v[4:7]
ds_read_b128 v[88:91], v215 offset:16
v_mul_f32 v148, v148, v152
v_mfma_f32_16x16x32_bf16 v[4:7], a[188:191], v[220:223], v[4:7]
ds_read_b128 v[174:177], v217
v_cvt_pk_bf16_f32 v139, v140, v141
v_mfma_f32_16x16x32_bf16 v[0:3], a[160:163], v[186:189], v[0:3]
s_lshl_b32 s41, s41, 30
ds_read_b128 v[186:189], v210 offset:48128
ds_read_b128 v[182:185], v210 offset:47104
v_mfma_f32_16x16x32_bf16 v[0:3], a[164:167], v[220:223], v[0:3]
s_waitcnt lgkmcnt(6)
v_mul_f32 v143, v143, v152
s_sub_u32 s43, 536870911, s43
v_mfma_f32_16x16x32_bf16 v[12:15], a[144:147], v[110:113], v[12:15]
s_waitcnt lgkmcnt(5)
ds_read_b128 v[220:223], v210 offset:49152
v_cvt_pk_bf16_f32 v141, v144, v145
v_mfma_f32_16x16x32_bf16 v[12:15], a[148:151], v[170:173], v[12:15]
s_add_u32 s52, s50, s41
v_cvt_pk_bf16_f32 v140, v142, v143
v_cvt_pk_bf16_f32 v143, v148, v149
v_mfma_f32_16x16x32_bf16 v[16:19], a[168:171], v[110:113], v[16:19]
ds_write_b128 v211, v[138:141] offset:51200
v_mfma_f32_16x16x32_bf16 v[16:19], a[172:175], v[170:173], v[16:19]
v_add_f32_dpp v166, v166, v166 row_ror:8 row_mask:0xf bank_mask:0xf
v_cvt_pk_bf16_f32 v0, v0, v1
v_mfma_f32_16x16x32_bf16 v[20:23], a[192:195], v[110:113], v[20:23]
s_nop 0
v_add_f32_dpp v166, v166, v166 row_ror:4 row_mask:0xf bank_mask:0xf
v_cvt_pk_bf16_f32 v142, v146, v147
v_mfma_f32_16x16x32_bf16 v[20:23], a[196:199], v[170:173], v[20:23]
s_waitcnt lgkmcnt(2)
ds_read_b128 v[110:113], v210 offset:50176
ds_read_b128 v[84:87], v215
v_mfma_f32_16x16x32_bf16 v[20:23], a[200:203], v[182:185], v[20:23]
v_add_u32 v215, 1424, v215
v_add_f32_dpp v166, v166, v166 row_ror:2 row_mask:0xf bank_mask:0xf
v_mfma_f32_16x16x32_bf16 v[20:23], a[204:207], v[186:189], v[20:23]
ds_write_b64 v212, v[142:143] offset:51200
v_mfma_f32_16x16x32_bf16 v[16:19], a[176:179], v[182:185], v[16:19]
v_add_f32_dpp v166, v166, v166 row_ror:1 row_mask:0xf bank_mask:0xf
v_cvt_pk_bf16_f32 v8, v8, v9
v_mfma_f32_16x16x32_bf16 v[16:19], a[180:183], v[186:189], v[16:19]
ds_read_b128 v[178:181], v217 offset:528
v_cvt_pk_bf16_f32 v9, v10, v11
v_mfma_f32_16x16x32_bf16 v[12:15], a[152:155], v[182:185], v[12:15]
v_cvt_pk_bf16_f32 v1, v2, v3
v_cvt_pk_bf16_f32 v4, v4, v5
v_mfma_f32_16x16x32_bf16 v[12:15], a[156:159], v[186:189], v[12:15]
s_waitcnt lgkmcnt(5)
ds_write_b64 v203, v[8:9] offset:64
v_mfma_f32_16x16x32_bf16 v[12:15], a[160:163], v[220:223], v[12:15]
v_cvt_pk_bf16_f32 v5, v6, v7
s_waitcnt lgkmcnt(4)
v_mfma_f32_16x16x32_bf16 v[12:15], a[164:167], v[110:113], v[12:15]
s_waitcnt vmcnt(0) lgkmcnt(2)
ds_write_b64 v203, v[4:5] offset:32
v_mfma_f32_16x16x32_bf16 v[162:165], v[84:87], v[130:133], 0
s_barrier
v_mfma_f32_16x16x32_bf16 v[162:165], v[88:91], v[134:137], v[162:165]
ds_read_b128 v[186:189], v210 offset:53248
v_add_f32_dpp v166, v166, v166 row_bcast:15 row_mask:0xa bank_mask:0xf
v_mfma_f32_16x16x32_bf16 v[154:157], v[84:87], v[114:117], 0
ds_read_b128 v[182:185], v210 offset:52224
ds_read_b128 v[92:95], v201
v_mfma_f32_16x16x32_bf16 v[154:157], v[88:91], v[118:121], v[154:157]
s_nop 0
ds_read_b128 v[170:173], v210 offset:51200
v_mfma_f32_16x16x32_bf16 v[158:161], v[84:87], v[122:125], 0
s_or_b32 s44, s43, s51
ds_read_b128 v[96:99], v195 offset:16
v_add_f32_dpp v166, v166, v166 row_bcast:31 row_mask:0xc bank_mask:0xf
v_mfma_f32_16x16x32_bf16 v[158:161], v[88:91], v[126:129], v[158:161]
v_mfma_f32_16x16x32_bf16 v[16:19], a[184:187], v[220:223], v[16:19]
ds_read_b128 v[84:87], v200
v_cvt_pk_bf16_f32 v12, v12, v13
v_mfma_f32_16x16x32_bf16 v[16:19], a[188:191], v[110:113], v[16:19]
v_and_b32_e64 v216, s44, v208
v_cvt_pk_bf16_f32 v13, v14, v15
v_mfma_f32_16x16x32_bf16 v[20:23], a[208:211], v[220:223], v[20:23]
s_mov_b32 s37, s50
ds_write_b64 v203, v[0:1]
v_mfma_f32_16x16x32_bf16 v[20:23], a[212:215], v[110:113], v[20:23]
s_waitcnt lgkmcnt(3)
v_mov_b32_dpp v154, v158 quad_perm:[0,1,2,3] row_mask:0x2 bank_mask:0xf
v_cvt_pk_bf16_f32 v16, v16, v17
v_mfma_f32_16x16x32_bf16 v[28:31], a[168:171], v[170:173], v[28:31]
ds_read_b128 v[220:223], v210 offset:54272
ds_read_b128 v[110:113], v210 offset:55296
v_mfma_f32_16x16x32_bf16 v[24:27], a[144:147], v[170:173], v[24:27]
s_nop 0
ds_write_b64 v203, v[12:13] offset:6272
v_mfma_f32_16x16x32_bf16 v[12:15], v[174:177], v[92:95], 0
s_waitcnt lgkmcnt(4)
v_readlane_b32 s72, v166, 63
v_cvt_pk_bf16_f32 v20, v20, v21
v_mfma_f32_16x16x32_bf16 v[0:3], v[174:177], v[84:87], 0
ds_read_b128 v[92:95], v195
v_mfma_f32_16x16x32_bf16 v[32:35], a[192:195], v[170:173], v[32:35]
ds_read_b128 v[84:87], v194
v_mfma_f32_16x16x32_bf16 v[32:35], a[196:199], v[182:185], v[32:35]
ds_read_b128 v[170:173], v210 offset:56320
v_mov_b32_dpp v154, v162 quad_perm:[0,1,2,3] row_mask:0x4 bank_mask:0xf
v_mfma_f32_16x16x32_bf16 v[32:35], a[200:203], v[186:189], v[32:35]
ds_read_b128 v[88:91], v194 offset:16
ds_read_b128 v[100:103], v202
v_mfma_f32_16x16x32_bf16 v[28:31], a[172:175], v[182:185], v[28:31]
v_cvt_pk_bf16_f32 v17, v18, v19
v_cvt_pk_bf16_f32 v21, v22, v23
v_mfma_f32_16x16x32_bf16 v[28:31], a[176:179], v[186:189], v[28:31]
ds_write_b64 v203, v[20:21] offset:6336
v_mfma_f32_16x16x32_bf16 v[24:27], a[148:151], v[182:185], v[24:27]
v_rcp_f32_e64 v167, s72
v_mfma_f32_16x16x32_bf16 v[24:27], a[152:155], v[186:189], v[24:27]
s_waitcnt lgkmcnt(8)
ds_write_b64 v203, v[16:17] offset:6304
v_mfma_f32_16x16x32_bf16 v[24:27], a[156:159], v[220:223], v[24:27]
s_waitcnt lgkmcnt(8)
v_max3_u32 v218, v218, s72, v167
v_max3_u32 v218, v218, v150, v151
v_mfma_f32_16x16x32_bf16 v[24:27], a[160:163], v[110:113], v[24:27]
s_waitcnt lgkmcnt(4)
ds_read_b128 v[182:185], v210 offset:20480
v_mul_f32 v168, s3, v167
v_mfma_f32_16x16x32_bf16 v[24:27], a[164:167], v[170:173], v[24:27]
s_nop 0
ds_read_b128 v[186:189], v210 offset:21504
s_waitcnt lgkmcnt(5)
v_smfmac_f32_16x16x64_bf16 v[0:3], v[178:181], v[84:91], v213
ds_read_b128 v[104:107], v196 offset:16
ds_read_b128 v[84:87], v197
v_smfmac_f32_16x16x64_bf16 v[12:15], v[178:181], v[92:99], v213
ds_read_b128 v[92:95], v198
ds_read_b128 v[88:91], v197 offset:16
v_mfma_f32_16x16x32_bf16 v[32:35], a[204:207], v[220:223], v[32:35]
s_nop 0
v_cvt_pk_bf16_f32 v24, v24, v25
v_cvt_pk_bf16_f32 v25, v26, v27
v_mfma_f32_16x16x32_bf16 v[32:35], a[208:211], v[110:113], v[32:35]
s_waitcnt lgkmcnt(8)
ds_write_b64 v203, v[24:25] offset:12544
v_mfma_f32_16x16x32_bf16 v[32:35], a[212:215], v[170:173], v[32:35]
s_add_u32 s29, s38, s61
v_mul_f32 v154, v154, v168
v_cvt_pk_bf16_f32 v154, v154, 0
v_mfma_f32_16x16x32_bf16 v[24:27], v[174:177], v[100:103], 0
ds_read_b128 v[174:177], v217 offset:1056
s_add_u32 s40, s37, 196224
v_mfma_f32_16x16x32_bf16 v[28:31], a[180:183], v[220:223], v[28:31]
v_cvt_pk_bf16_f32 v32, v32, v33
v_cvt_pk_bf16_f32 v33, v34, v35
v_mfma_f32_16x16x32_bf16 v[28:31], a[184:187], v[110:113], v[28:31]
ds_read_b128 v[100:103], v196
ds_read_b128 v[96:99], v198 offset:16
v_mfma_f32_16x16x32_bf16 v[28:31], a[188:191], v[170:173], v[28:31]
s_waitcnt lgkmcnt(9)
ds_write_b16 v214, v154
v_mfma_f32_16x16x32_bf16 v[138:141], a[0:3], v[182:185], 0
s_waitcnt lgkmcnt(9)
ds_write_b64 v203, v[32:33] offset:12608
v_mfma_f32_16x16x32_bf16 v[138:141], a[4:7], v[186:189], v[138:141]
s_nop 0
v_cvt_pk_bf16_f32 v28, v28, v29
v_cvt_pk_bf16_f32 v29, v30, v31
v_mfma_f32_16x16x32_bf16 v[146:149], a[48:51], v[182:185], 0
s_waitcnt lgkmcnt(4)
ds_write_b64 v203, v[28:29] offset:12576
v_smfmac_f32_16x16x64_bf16 v[0:3], v[174:177], v[84:91], v213
s_waitcnt lgkmcnt(4)
v_smfmac_f32_16x16x64_bf16 v[24:27], v[178:181], v[100:107], v213
s_waitcnt lgkmcnt(3)
ds_read_b128 v[104:107], v199 offset:16
ds_read_b128 v[84:87], v200 offset:32
v_smfmac_f32_16x16x64_bf16 v[12:15], v[174:177], v[92:99], v213
ds_read_b128 v[100:103], v199
ds_read_b128 v[178:181], v217 offset:1584
v_mfma_f32_16x16x32_bf16 v[150:153], a[216:219], v[182:185], 0
v_mul_f32 v119, v0, v0
v_add_f32 v118, v0, v1
v_mfma_f32_16x16x32_bf16 v[150:153], a[220:223], v[186:189], v[150:153]
ds_read_b128 v[92:95], v201 offset:32
v_fmac_f32_e64 v119, v1, v1
v_mfma_f32_16x16x32_bf16 v[158:161], v[232:235], v[182:185], 0
ds_read_b128 v[110:113], v210 offset:22528
v_add_f32 v118, v118, v2
v_mfma_f32_16x16x32_bf16 v[158:161], v[236:239], v[186:189], v[158:161]
s_waitcnt lgkmcnt(6)
ds_read_b128 v[88:91], v194 offset:48
v_add_f32_e64 v126, v12, v13
v_mfma_f32_16x16x32_bf16 v[154:157], a[240:243], v[182:185], 0
s_barrier
v_mfma_f32_16x16x32_bf16 v[154:157], a[244:247], v[186:189], v[154:157]
s_waitcnt lgkmcnt(4)
ds_read_b64 v[120:121], v204
ds_read_b64 v[128:129], v204 offset:392
v_smfmac_f32_16x16x64_bf16 v[24:27], v[174:177], v[100:107], v213
s_waitcnt lgkmcnt(5)
ds_read_b128 v[100:103], v202 offset:32
ds_read_b128 v[96:99], v195 offset:48
v_mfma_f32_16x16x32_bf16 v[4:7], v[178:181], v[84:87], 0
s_waitcnt lgkmcnt(6)
ds_read_b128 v[84:87], v194 offset:32
ds_read_b128 v[174:177], v217 offset:2112
v_mfma_f32_16x16x32_bf16 v[16:19], v[178:181], v[92:95], 0
ds_read_b128 v[92:95], v195 offset:32
v_add_f32_e64 v126, v126, v14
v_mfma_f32_16x16x32_bf16 v[170:173], v[182:185], a[120:123], 0
v_mul_f32_e64 v135, v24, v24
v_mul_f32 v127, v12, v12
v_mfma_f32_16x16x32_bf16 v[170:173], v[186:189], a[124:127], v[170:173]
s_waitcnt lgkmcnt(6)
buffer_store_dwordx2 v[120:121], v204, s[8:11], s28 offen sc1
v_fmac_f32 v119, v2, v2
v_mfma_f32_16x16x32_bf16 v[170:173], v[110:113], a[128:131], v[170:173]
s_waitcnt lgkmcnt(4)
ds_read_b128 v[104:107], v196 offset:48
v_add_f32_e64 v134, v24, v25
v_mfma_f32_16x16x32_bf16 v[28:31], v[178:181], v[100:103], 0
ds_read_b128 v[100:103], v196 offset:32
ds_read_b64 v[136:137], v204 offset:784
v_mfma_f32_16x16x32_bf16 v[146:149], a[52:55], v[186:189], v[146:149]
s_nop 0
ds_read_b128 v[178:181], v217 offset:2640
ds_read_b64 v[120:121], v204 offset:1176
v_mfma_f32_16x16x32_bf16 v[146:149], a[56:59], v[110:113], v[146:149]
s_waitcnt lgkmcnt(6)
buffer_store_dwordx2 v[128:129], v204, s[8:11], s29 offen sc1
v_fmac_f32 v119, v3, v3
v_smfmac_f32_16x16x64_bf16 v[4:7], v[174:177], v[84:91], v213
s_waitcnt lgkmcnt(5)
ds_read_b128 v[88:91], v197 offset:48
v_add_f32 v134, v134, v26
v_mfma_f32_16x16x32_bf16 v[150:153], a[224:227], v[110:113], v[150:153]
s_add_u32 s28, s38, s62
ds_read_b128 v[84:87], v197 offset:32
v_fmac_f32 v127, v13, v13
v_smfmac_f32_16x16x64_bf16 v[16:19], v[174:177], v[92:99], v213
s_waitcnt lgkmcnt(5)
ds_read_b128 v[92:95], v198 offset:32
ds_read_b128 v[96:99], v198 offset:48
v_smfmac_f32_16x16x64_bf16 v[28:31], v[174:177], v[100:107], v213
ds_read_b128 v[104:107], v199 offset:48
v_add_f32_e64 v126, v126, v15
v_mfma_f32_16x16x32_bf16 v[142:145], a[24:27], v[182:185], 0
ds_read_b128 v[100:103], v199 offset:32
v_fmac_f32 v135, v25, v25
v_mfma_f32_16x16x32_bf16 v[142:145], a[28:31], v[186:189], v[142:145]
s_add_u32 s29, s38, s63
ds_read_b128 v[220:223], v210 offset:23552
v_add_f32 v118, v118, v3
v_mfma_f32_16x16x32_bf16 v[142:145], a[32:35], v[110:113], v[142:145]
s_waitcnt lgkmcnt(9)
buffer_store_dwordx2 v[136:137], v204, s[8:11], s28 offen sc1
v_fmac_f32 v135, v26, v26
v_mfma_f32_16x16x32_bf16 v[138:141], a[8:11], v[110:113], v[138:141]
s_waitcnt lgkmcnt(5)
ds_read_b64 v[128:129], v204 offset:6272
v_fmac_f32 v127, v14, v14
v_smfmac_f32_16x16x64_bf16 v[4:7], v[178:181], v[84:91], v213
s_waitcnt lgkmcnt(4)
ds_read_b128 v[174:177], v217 offset:3168
v_fmac_f32_e64 v135, v27, v27
v_smfmac_f32_16x16x64_bf16 v[16:19], v[178:181], v[92:99], v213
ds_read_b128 v[92:95], v201 offset:64
ds_read_b128 v[84:87], v200 offset:64
v_mfma_f32_16x16x32_bf16 v[162:165], v[182:185], a[72:75], 0
ds_read_b128 v[96:99], v195 offset:80
v_fmac_f32 v127, v15, v15
v_mfma_f32_16x16x32_bf16 v[162:165], v[186:189], a[76:79], v[162:165]
s_waitcnt lgkmcnt(6)
buffer_store_dwordx2 v[120:121], v204, s[8:11], s29 offen sc1
v_fmac_f32 v127, v16, v16
v_smfmac_f32_16x16x64_bf16 v[28:31], v[178:181], v[100:107], v213
ds_read_b128 v[100:103], v202 offset:64
ds_read_b128 v[178:181], v217 offset:3696
v_mfma_f32_16x16x32_bf16 v[154:157], a[248:251], v[110:113], v[154:157]
s_waitcnt lgkmcnt(7)
ds_read_b64 v[120:121], v204 offset:7056
ds_read_b128 v[88:91], v194 offset:80
v_mfma_f32_16x16x32_bf16 v[154:157], a[252:255], v[220:223], v[154:157]
s_waitcnt lgkmcnt(6)
v_add_f32 v134, v134, v27
v_add_f32_e64 v126, v126, v16
v_mfma_f32_16x16x32_bf16 v[158:161], v[240:243], v[110:113], v[158:161]
s_add_u32 s28, s38, s64
v_add_f32 v126, v126, v17
v_fmac_f32_e64 v135, v28, v28
v_mfma_f32_16x16x32_bf16 v[20:23], v[174:177], v[92:95], 0
s_waitcnt lgkmcnt(5)
buffer_store_dwordx2 v[128:129], v204, s[8:11], s28 offen sc1
ds_read_b64 v[136:137], v204 offset:6664
v_mfma_f32_16x16x32_bf16 v[138:141], a[12:15], v[220:223], v[138:141]
s_add_u32 s29, s38, s65
ds_read_b128 v[92:95], v195 offset:64
ds_read_b64 v[128:129], v204 offset:7448
v_mfma_f32_16x16x32_bf16 v[8:11], v[174:177], v[84:87], 0
s_waitcnt lgkmcnt(6)
ds_read_b128 v[84:87], v194 offset:64
v_add_f32 v134, v134, v28
v_mfma_f32_16x16x32_bf16 v[32:35], v[174:177], v[100:103], 0
ds_read_b128 v[104:107], v196 offset:80
v_fmac_f32_e64 v127, v17, v17
v_mfma_f32_16x16x32_bf16 v[166:169], v[182:185], a[96:99], 0
ds_read_b128 v[182:185], v210 offset:24576
v_add_f32_e64 v118, v118, v4
v_mfma_f32_16x16x32_bf16 v[166:169], v[186:189], a[100:103], v[166:169]
s_add_u32 s28, s38, s66
v_fmac_f32 v127, v18, v18
v_fmac_f32 v135, v29, v29
v_mfma_f32_16x16x32_bf16 v[166:169], v[110:113], a[104:107], v[166:169]
s_waitcnt lgkmcnt(5)
buffer_store_dwordx2 v[136:137], v204, s[8:11], s29 offen sc1
ds_read_b128 v[100:103], v196 offset:64
v_mfma_f32_16x16x32_bf16 v[166:169], v[220:223], a[108:111], v[166:169]
ds_read_b128 v[186:189], v210 offset:25600
v_fmac_f32_e64 v135, v30, v30
v_mfma_f32_16x16x32_bf16 v[162:165], v[110:113], a[80:83], v[162:165]
ds_read_b64 v[136:137], v204 offset:12544
v_fmac_f32 v119, v4, v4
v_mfma_f32_16x16x32_bf16 v[162:165], v[220:223], a[84:87], v[162:165]
s_waitcnt lgkmcnt(5)
ds_read_b128 v[174:177], v217 offset:4224
v_add_f32_e64 v118, v118, v5
v_smfmac_f32_16x16x64_bf16 v[8:11], v[178:181], v[84:91], v213
ds_read_b128 v[88:91], v197 offset:80
v_add_f32_e64 v134, v134, v29
v_mfma_f32_16x16x32_bf16 v[170:173], v[220:223], a[132:135], v[170:173]
ds_read_b128 v[84:87], v197 offset:64
v_add_f32 v118, v118, v6
v_smfmac_f32_16x16x64_bf16 v[20:23], v[178:181], v[92:99], v213
s_waitcnt lgkmcnt(5)
buffer_store_dwordx2 v[120:121], v204, s[8:11], s28 offen sc1
v_add_f32_e64 v126, v126, v18
v_smfmac_f32_16x16x64_bf16 v[32:35], v[178:181], v[100:107], v213
ds_read_b128 v[96:99], v198 offset:80
ds_read_b128 v[100:103], v199 offset:64
v_mfma_f32_16x16x32_bf16 v[158:161], v[244:247], v[220:223], v[158:161]
s_add_u32 s29, s38, s67
v_add_f32 v118, v118, v7
v_fmac_f32 v119, v5, v5
v_mfma_f32_16x16x32_bf16 v[146:149], a[60:63], v[220:223], v[146:149]
s_add_u32 s28, s38, s68
ds_read_b128 v[92:95], v198 offset:64
v_fmac_f32_e64 v135, v31, v31
v_mfma_f32_16x16x32_bf16 v[142:145], a[36:39], v[220:223], v[142:145]
s_waitcnt lgkmcnt(3)
v_fmac_f32 v119, v6, v6
v_fmac_f32_e64 v119, v7, v7
v_smfmac_f32_16x16x64_bf16 v[8:11], v[174:177], v[84:91], v213
ds_read_b128 v[104:107], v199 offset:80
ds_read_b128 v[110:113], v210 offset:26624
v_mfma_f32_16x16x32_bf16 v[150:153], a[228:231], v[220:223], v[150:153]
buffer_store_dwordx2 v[128:129], v204, s[8:11], s29 offen sc1
v_fmac_f32_e64 v127, v19, v19
v_mfma_f32_16x16x32_bf16 v[150:153], a[232:235], v[182:185], v[150:153]
v_add_f32 v134, v134, v30
v_fmac_f32 v119, v8, v8
v_mfma_f32_16x16x32_bf16 v[150:153], a[236:239], v[186:189], v[150:153]
s_waitcnt lgkmcnt(2)
v_add_f32 v126, v126, v19
v_fmac_f32_e64 v119, v9, v9
v_smfmac_f32_16x16x64_bf16 v[20:23], v[174:177], v[92:99], v213
ds_read_b128 v[220:223], v210 offset:27648
ds_read_b64 v[120:121], v204 offset:12936
v_mfma_f32_16x16x32_bf16 v[154:157], v[224:227], v[182:185], v[154:157]
s_waitcnt lgkmcnt(3)
buffer_store_dwordx2 v[136:137], v204, s[8:11], s28 offen sc1
v_add_f32 v118, v118, v8
v_smfmac_f32_16x16x64_bf16 v[32:35], v[174:177], v[100:107], v213
ds_read_b64 v[128:129], v204 offset:13328
v_fmac_f32_e64 v127, v20, v20
v_mfma_f32_16x16x32_bf16 v[142:145], a[40:43], v[182:185], v[142:145]
v_add_f32 v134, v134, v31
v_fmac_f32 v127, v21, v21
v_mfma_f32_16x16x32_bf16 v[142:145], a[44:47], v[186:189], v[142:145]
v_cvt_pk_bf16_f32 v72, v150, v151
v_add_f32_e64 v118, v118, v9
v_mfma_f32_16x16x32_bf16 v[138:141], a[16:19], v[182:185], v[138:141]
v_fmac_f32 v135, v32, v32
v_add_f32 v134, v134, v32
v_mfma_f32_16x16x32_bf16 v[138:141], a[20:23], v[186:189], v[138:141]
ds_read_b64 v[136:137], v204 offset:13720
v_add_f32_e64 v126, v126, v20
v_mfma_f32_16x16x32_bf16 v[146:149], a[64:67], v[182:185], v[146:149]
v_add_f32 v126, v126, v21
v_add_f32 v134, v134, v33
v_mfma_f32_16x16x32_bf16 v[146:149], a[68:71], v[186:189], v[146:149]
v_add_f32 v126, v126, v22
v_add_f32 v118, v118, v10
v_mfma_f32_16x16x32_bf16 v[158:161], v[248:251], v[182:185], v[158:161]
v_fmac_f32 v119, v10, v10
v_fmac_f32 v135, v33, v33
v_mfma_f32_16x16x32_bf16 v[158:161], v[252:255], v[186:189], v[158:161]
v_cvt_pk_bf16_f32 v80, v142, v143
v_cvt_pk_bf16_f32 v79, v140, v141
v_mfma_f32_16x16x32_bf16 v[154:157], v[228:231], v[186:189], v[154:157]
s_add_u32 s28, s38, s70
v_cvt_pk_bf16_f32 v78, v138, v139
v_add_f32 v134, v134, v34
v_mfma_f32_16x16x32_bf16 v[166:169], v[182:185], a[112:115], v[166:169]
v_cvt_pk_bf16_f32 v83, v148, v149
v_cvt_pk_bf16_f32 v81, v144, v145
v_mfma_f32_16x16x32_bf16 v[166:169], v[186:189], a[116:119], v[166:169]
s_add_u32 s29, s38, s69
v_add_f32 v118, v118, v11
v_fmac_f32_e64 v119, v11, v11
v_mfma_f32_16x16x32_bf16 v[162:165], v[182:185], a[88:91], v[162:165]
v_permlane16_swap_b32 v118, v119
v_mfma_f32_16x16x32_bf16 v[162:165], v[186:189], a[92:95], v[162:165]
s_waitcnt lgkmcnt(2)
buffer_store_dwordx2 v[120:121], v204, s[8:11], s29 offen sc1
v_fmac_f32 v135, v34, v34
v_mfma_f32_16x16x32_bf16 v[170:173], v[182:185], a[136:139], v[170:173]
s_add_u32 s29, s38, s71
v_add_f32 v118, v118, v119
v_fmac_f32 v135, v35, v35
v_mfma_f32_16x16x32_bf16 v[170:173], v[186:189], a[140:143], v[170:173]
ds_read_b128 v[186:189], v210 offset:29696
ds_read_b128 v[182:185], v210 offset:28672
v_mfma_f32_16x16x32_bf16 v[142:145], a[24:27], v[110:113], 0
v_add_f32_e64 v134, v134, v35
v_fmac_f32 v127, v22, v22
v_mfma_f32_16x16x32_bf16 v[142:145], a[28:31], v[220:223], v[142:145]
s_waitcnt lgkmcnt(3)
buffer_store_dwordx2 v[128:129], v204, s[8:11], s28 offen sc1
v_add_f32 v126, v126, v23
v_mfma_f32_16x16x32_bf16 v[138:141], a[0:3], v[110:113], 0
v_permlane16_swap_b32 v134, v135
v_mfma_f32_16x16x32_bf16 v[138:141], a[4:7], v[220:223], v[138:141]
v_cvt_pk_bf16_f32 v82, v146, v147
v_fmac_f32 v127, v23, v23
v_mfma_f32_16x16x32_bf16 v[146:149], a[48:51], v[110:113], 0
s_waitcnt lgkmcnt(2)
buffer_store_dwordx2 v[136:137], v204, s[8:11], s29 offen sc1
v_add_f32 v134, v134, v135
v_mfma_f32_16x16x32_bf16 v[146:149], a[52:55], v[220:223], v[146:149]
s_waitcnt lgkmcnt(0)
v_permlane16_swap_b32 v126, v127
v_mfma_f32_16x16x32_bf16 v[146:149], a[56:59], v[182:185], v[146:149]
v_add_f32 v126, v126, v127
v_mov_b32 v135, v134
v_mfma_f32_16x16x32_bf16 v[146:149], a[60:63], v[186:189], v[146:149]
s_sub_u32 s46, s46, 1
v_permlane32_swap_b32 v118, v126
s_cbranch_scc0 F_loop
F_tail:
s_mov_b32 s31, 0
s_mov_b32 s30, 1
s_mov_b32 s23, 131072
s_mov_b32 s22, 256
s_mov_b32 s21, s101
s_mov_b32 s20, s100
v_permlane32_swap_b32 v134, v135
v_mfma_f32_16x16x32_bf16 v[142:145], a[32:35], v[182:185], v[142:145]
v_add_f32 v118, v118, v126
v_add_f32 v134, v134, v135
v_mfma_f32_16x16x32_bf16 v[142:145], a[36:39], v[186:189], v[142:145]
ds_write_b32 v209, v118
v_mfma_f32_16x16x32_bf16 v[138:141], a[8:11], v[182:185], v[138:141]
ds_write_b32 v209, v134 offset:512
v_mfma_f32_16x16x32_bf16 v[138:141], a[12:15], v[186:189], v[138:141]
v_cvt_pk_bf16_f32 v76, v158, v159
v_cvt_pk_bf16_f32 v73, v152, v153
v_mfma_f32_16x16x32_bf16 v[150:153], a[216:219], v[110:113], 0
s_add_u32 s35, s35, 32
v_cvt_pk_bf16_f32 v74, v154, v155
v_cvt_pk_bf16_f32 v123, v168, v169
v_mfma_f32_16x16x32_bf16 v[150:153], a[220:223], v[220:223], v[150:153]
v_cvt_pk_bf16_f32 v131, v172, v173
v_mfma_f32_16x16x32_bf16 v[150:153], a[224:227], v[182:185], v[150:153]
v_cvt_pk_bf16_f32 v75, v156, v157
v_mfma_f32_16x16x32_bf16 v[150:153], a[228:231], v[186:189], v[150:153]
v_cvt_pk_bf16_f32 v77, v160, v161
s_waitcnt lgkmcnt(0)
v_mfma_f32_16x16x32_bf16 v[154:157], a[240:243], v[110:113], 0
s_barrier
v_mfma_f32_16x16x32_bf16 v[154:157], a[244:247], v[220:223], v[154:157]
ds_read_b128 v[106:109], v210 offset:19456
ds_read_b128 v[102:105], v210 offset:18432
v_mfma_f32_16x16x32_bf16 v[154:157], a[248:251], v[182:185], v[154:157]
buffer_load_dwordx4 v216, s[4:7], s52 offen nt lds
v_mfma_f32_16x16x32_bf16 v[158:161], v[232:235], v[110:113], 0
v_cvt_pk_bf16_f32 v130, v170, v171
v_cvt_pk_bf16_f32 v115, v164, v165
v_mfma_f32_16x16x32_bf16 v[158:161], v[236:239], v[220:223], v[158:161]
v_cvt_pk_bf16_f32 v114, v162, v163
v_mfma_f32_16x16x32_bf16 v[158:161], v[240:243], v[182:185], v[158:161]
v_cvt_pk_bf16_f32 v122, v166, v167
v_mfma_f32_16x16x32_bf16 v[158:161], v[244:247], v[186:189], v[158:161]
s_waitcnt lgkmcnt(1)
v_add_f32 v108, v108, v109
v_mfma_f32_16x16x32_bf16 v[170:173], v[110:113], a[120:123], 0
v_add_f32 v106, v106, v107
v_add_f32 v106, v106, v108
v_mfma_f32_16x16x32_bf16 v[170:173], v[220:223], a[124:127], v[170:173]
s_waitcnt lgkmcnt(0)
v_add_f32 v102, v102, v103
v_add_f32_e64 v104, v104, v105
v_mfma_f32_16x16x32_bf16 v[166:169], v[110:113], a[96:99], 0
s_add_u32 m0, s45, 4112
v_add_f32 v102, v102, v104
v_mul_f32 v104, s73, v102
v_mfma_f32_16x16x32_bf16 v[166:169], v[220:223], a[100:103], v[166:169]
v_mul_f32 v103, s48, v102
v_mul_f32 v106, s73, v106
v_mfma_f32_16x16x32_bf16 v[162:165], v[110:113], a[72:75], 0
buffer_load_dwordx4 v216, s[4:7], s40 offen nt lds
v_mfma_f32_16x16x32_bf16 v[162:165], v[220:223], a[76:79], v[162:165]
v_fma_f32 v106, -v103, v104, v106
v_max_f32_e64 v106, 0, v106
v_mfma_f32_16x16x32_bf16 v[162:165], v[182:185], a[80:83], v[162:165]
ds_read_b128 v[110:113], v210 offset:30720
v_add_f32_e64 v106, s49, v106
v_mfma_f32_16x16x32_bf16 v[162:165], v[186:189], a[84:87], v[162:165]
s_add_u32 s40, s37, 392448
v_rsq_f32_e64 v102, v106
v_mfma_f32_16x16x32_bf16 v[170:173], v[182:185], a[128:131], v[170:173]
ds_read_b128 v[106:109], v210 offset:31744
v_mul_f32_e64 v103, -v103, v102
v_mfma_f32_16x16x32_bf16 v[170:173], v[186:189], a[132:135], v[170:173]
ds_write_b64 v211, v[102:103]
v_mfma_f32_16x16x32_bf16 v[166:169], v[182:185], a[104:107], v[166:169]
v_mfma_f32_16x16x32_bf16 v[166:169], v[186:189], a[108:111], v[166:169]
ds_read_b64 v[118:119], v219
v_add_u32 v214, 1424, v214
v_mfma_f32_16x16x32_bf16 v[154:157], a[252:255], v[186:189], v[154:157]
s_add_u32 m0, s45, 8224
ds_read_b64 v[134:135], v219 offset:512
s_waitcnt lgkmcnt(4)
v_mfma_f32_16x16x32_bf16 v[154:157], v[224:227], v[110:113], v[154:157]
buffer_load_dwordx4 v216, s[4:7], s40 offen nt lds
v_mfma_f32_16x16x32_bf16 v[142:145], a[40:43], v[110:113], v[142:145]
ds_read_b128 v[182:185], v210 offset:32768
s_waitcnt lgkmcnt(4)
v_mfma_f32_16x16x32_bf16 v[142:145], a[44:47], v[106:109], v[142:145]
s_nop 0
ds_read_b128 v[186:189], v210 offset:33792
ds_read_b64 v[126:127], v219 offset:256
v_mfma_f32_16x16x32_bf16 v[150:153], a[232:235], v[110:113], v[150:153]
s_waitcnt lgkmcnt(4)
v_fma_f32 v223, v3, v118, v119
v_fma_f32 v221, v1, v118, v119
v_mfma_f32_16x16x32_bf16 v[150:153], a[236:239], v[106:109], v[150:153]
v_fma_f32 v220, v0, v118, v119
v_fma_f32 v222, v2, v118, v119
v_mfma_f32_16x16x32_bf16 v[146:149], a[64:67], v[110:113], v[146:149]
v_cvt_pk_bf16_f32 v175, v222, v223
v_fma_f32 v222, v6, v118, v119
v_mfma_f32_16x16x32_bf16 v[146:149], a[68:71], v[106:109], v[146:149]
v_cvt_pk_bf16_f32 v99, v144, v145
v_cvt_pk_bf16_f32 v174, v220, v221
v_mfma_f32_16x16x32_bf16 v[166:169], v[110:113], a[112:115], v[166:169]
s_add_u32 m0, s45, 12336
v_fma_f32 v223, v7, v118, v119
v_fma_f32 v220, v4, v118, v119
v_mfma_f32_16x16x32_bf16 v[166:169], v[106:109], a[116:119], v[166:169]
s_add_u32 s40, s37, 588672
v_cvt_pk_bf16_f32 v100, v146, v147
v_fma_f32 v221, v5, v118, v119
v_mfma_f32_16x16x32_bf16 v[154:157], v[228:231], v[106:109], v[154:157]
buffer_load_dwordx4 v216, s[4:7], s40 offen nt lds
v_mfma_f32_16x16x32_bf16 v[138:141], a[16:19], v[110:113], v[138:141]
v_cvt_pk_bf16_f32 v177, v222, v223
v_cvt_pk_bf16_f32 v176, v220, v221
v_mfma_f32_16x16x32_bf16 v[138:141], a[20:23], v[106:109], v[138:141]
ds_write_b128 v211, v[174:177]
v_mfma_f32_16x16x32_bf16 v[158:161], v[248:251], v[110:113], v[158:161]
v_cvt_pk_bf16_f32 v97, v140, v141
v_fma_f32 v223, v11, v118, v119
v_mfma_f32_16x16x32_bf16 v[158:161], v[252:255], v[106:109], v[158:161]
s_add_u32 s40, s37, 784896
v_fma_f32 v222, v10, v118, v119
v_cvt_pk_bf16_f32 v125, v168, v169
v_mfma_f32_16x16x32_bf16 v[170:173], v[110:113], a[136:139], v[170:173]
v_fma_f32 v220, v8, v118, v119
v_fma_f32 v221, v9, v118, v119
v_mfma_f32_16x16x32_bf16 v[170:173], v[106:109], a[140:143], v[170:173]
v_cvt_pk_bf16_f32 v86, v154, v155
v_cvt_pk_bf16_f32 v179, v222, v223
v_mfma_f32_16x16x32_bf16 v[162:165], v[110:113], a[88:91], v[162:165]
s_add_u32 m0, s45, 16448
v_cvt_pk_bf16_f32 v124, v166, v167
v_cvt_pk_bf16_f32 v98, v142, v143
v_mfma_f32_16x16x32_bf16 v[162:165], v[106:109], a[92:95], v[162:165]
s_waitcnt lgkmcnt(1)
ds_read_b64 v[112:113], v215 offset:528
v_fma_f32 v223, v15, v126, v127
v_mfma_f32_16x16x32_bf16 v[142:145], a[24:27], v[182:185], 0
s_nop 0
v_cvt_pk_bf16_f32 v178, v220, v221
v_cvt_pk_bf16_f32 v101, v148, v149
v_mfma_f32_16x16x32_bf16 v[142:145], a[28:31], v[186:189], v[142:145]
v_cvt_pk_bf16_f32 v96, v138, v139
v_fma_f32 v222, v14, v126, v127
v_mfma_f32_16x16x32_bf16 v[146:149], a[48:51], v[182:185], 0
buffer_load_dwordx4 v216, s[4:7], s40 offen nt lds
v_mfma_f32_16x16x32_bf16 v[146:149], a[52:55], v[186:189], v[146:149]
ds_read_b128 v[174:177], v210 offset:34816
v_cvt_pk_bf16_f32 v89, v160, v161
v_mfma_f32_16x16x32_bf16 v[138:141], a[0:3], v[182:185], 0
s_nop 0
v_cvt_pk_bf16_f32 v88, v158, v159
v_cvt_pk_bf16_f32 v84, v150, v151
v_mfma_f32_16x16x32_bf16 v[138:141], a[4:7], v[186:189], v[138:141]
s_add_u32 s40, s37, 981120
ds_write_b64 v212, v[178:179]
v_mfma_f32_16x16x16_bf16 v[158:161], v[100:101], v[88:89], 0
v_cvt_pk_bf16_f32 v91, v222, v223
v_cvt_pk_bf16_f32 v87, v156, v157
v_fma_f32 v222, v18, v126, v127
v_mfma_f32_16x16x16_bf16 v[154:157], v[82:83], v[88:89], 0
s_waitcnt lgkmcnt(2)
ds_read_b128 v[178:181], v210 offset:35840
v_fma_f32 v223, v19, v126, v127
v_mfma_f32_16x16x16_bf16 v[166:169], v[112:113], v[88:89], v[206:209]
v_fma_f32 v221, v13, v126, v127
v_fma_f32 v220, v12, v126, v127
v_cvt_pk_bf16_f32 v85, v152, v153
v_mfma_f32_16x16x16_bf16 v[150:153], v[112:113], v[76:77], v[206:209]
v_cvt_pk_bf16_f32 v93, v222, v223
v_fma_f32 v223, v23, v126, v127
v_cvt_pk_bf16_f32 v90, v220, v221
v_fma_f32 v220, v16, v126, v127
v_mfma_f32_16x16x32_bf16 v[154:157], v[78:81], v[84:87], v[154:157]
s_add_u32 m0, s45, 20560
ds_read_b128 v[108:111], v215 offset:512
v_fma_f32 v221, v17, v126, v127
v_mfma_f32_16x16x32_bf16 v[158:161], v[96:99], v[84:87], v[158:161]
s_waitcnt lgkmcnt(3)
ds_read_b128 v[186:189], v210 offset:37888
v_fma_f32 v222, v22, v126, v127
v_mfma_f32_16x16x32_bf16 v[138:141], a[8:11], v[174:177], v[138:141]
s_waitcnt lgkmcnt(2)
buffer_load_dwordx4 v216, s[4:7], s40 offen nt lds
v_mfma_f32_16x16x32_bf16 v[138:141], a[12:15], v[178:181], v[138:141]
s_add_u32 m0, s45, 24672
ds_read_b128 v[182:185], v210 offset:36864
v_cvt_pk_bf16_f32 v92, v220, v221
v_mfma_f32_16x16x32_bf16 v[142:145], a[32:35], v[174:177], v[142:145]
v_cvt_pk_bf16_f32 v95, v222, v223
v_fma_f32 v221, v21, v126, v127
v_mfma_f32_16x16x32_bf16 v[142:145], a[36:39], v[178:181], v[142:145]
ds_write_b128 v211, v[90:93] offset:6144
v_mfma_f32_16x16x32_bf16 v[146:149], a[56:59], v[174:177], v[146:149]
v_exp_f32_e64 v161, v161
v_mfma_f32_16x16x32_bf16 v[146:149], a[60:63], v[178:181], v[146:149]
s_waitcnt lgkmcnt(3)
v_fma_f32 v223, v27, v134, v135
v_fma_f32 v222, v26, v134, v135
v_mfma_f32_16x16x32_bf16 v[166:169], v[108:111], v[84:87], v[166:169]
s_waitcnt lgkmcnt(1)
v_fma_f32 v220, v20, v126, v127
v_cvt_pk_bf16_f32 v91, v222, v223
v_mfma_f32_16x16x32_bf16 v[126:129], v[182:185], a[112:115], 0
v_cvt_pk_bf16_f32 v94, v220, v221
v_fma_f32 v222, v30, v134, v135
v_mfma_f32_16x16x32_bf16 v[126:129], v[186:189], a[116:119], v[126:129]
s_add_u32 s40, s37, 1177344
v_fma_f32 v221, v25, v134, v135
v_cvt_pk_bf16_f32 v133, v172, v173
v_mfma_f32_16x16x32_bf16 v[126:129], v[174:177], a[104:107], v[126:129]
buffer_load_dwordx4 v216, s[4:7], s40 offen nt lds
v_mfma_f32_16x16x32_bf16 v[138:141], a[16:19], v[182:185], v[138:141]
v_fma_f32 v223, v31, v134, v135
v_fma_f32 v220, v24, v134, v135
v_mfma_f32_16x16x32_bf16 v[138:141], a[20:23], v[186:189], v[138:141]
v_exp_f32_e64 v160, v160
v_mfma_f32_16x16x32_bf16 v[142:145], a[40:43], v[182:185], v[142:145]
s_add_u32 m0, s45, 28784
v_cvt_pk_bf16_f32 v90, v220, v221
v_fma_f32 v221, v29, v134, v135
v_mfma_f32_16x16x32_bf16 v[142:145], a[44:47], v[186:189], v[142:145]
v_fma_f32 v220, v28, v134, v135
v_cvt_pk_bf16_f32 v102, v138, v139
v_mfma_f32_16x16x32_bf16 v[146:149], a[64:67], v[182:185], v[146:149]
s_nop 0
v_cvt_pk_bf16_f32 v92, v220, v221
v_cvt_pk_bf16_f32 v103, v140, v141
v_mfma_f32_16x16x32_bf16 v[146:149], a[68:71], v[186:189], v[146:149]
s_mov_b32 s38, s36
v_cvt_pk_bf16_f32 v93, v222, v223
v_fma_f32 v220, v32, v134, v135
v_mfma_f32_16x16x32_bf16 v[118:121], v[182:185], a[88:91], 0
ds_write_b64 v212, v[94:95] offset:6144
v_mfma_f32_16x16x32_bf16 v[118:121], v[186:189], a[92:95], v[118:121]
s_add_u32 s40, s37, 1373568
v_exp_f32_e64 v158, v158
v_mfma_f32_16x16x32_bf16 v[118:121], v[174:177], a[80:83], v[118:121]
buffer_load_dwordx4 v216, s[4:7], s40 offen nt lds
v_mfma_f32_16x16x32_bf16 v[118:121], v[178:181], a[84:87], v[118:121]
v_cvt_pk_bf16_f32 v132, v170, v171
v_fma_f32 v222, v34, v134, v135
v_mfma_f32_16x16x16_bf16 v[138:141], v[82:83], v[76:77], 0
ds_write_b128 v211, v[90:93] offset:12288
v_mfma_f32_16x16x32_bf16 v[150:153], v[108:111], v[72:75], v[150:153]
v_cvt_pk_bf16_f32 v107, v148, v149
v_fma_f32 v223, v35, v134, v135
v_mfma_f32_16x16x32_bf16 v[138:141], v[78:81], v[72:75], v[138:141]
v_fma_f32 v221, v33, v134, v135
v_cvt_pk_bf16_f32 v95, v222, v223
v_mfma_f32_16x16x32_bf16 v[90:93], a[232:235], v[182:185], 0
v_cvt_pk_bf16_f32 v105, v144, v145
v_cvt_pk_bf16_f32 v106, v146, v147
v_mfma_f32_16x16x32_bf16 v[170:173], v[224:227], v[182:185], 0
v_exp_f32_e64 v140, v140
v_mfma_f32_16x16x32_bf16 v[170:173], v[228:231], v[186:189], v[170:173]
v_cvt_pk_bf16_f32 v94, v220, v221
v_cvt_pk_bf16_f32 v104, v142, v143
v_mfma_f32_16x16x32_bf16 v[170:173], a[248:251], v[174:177], v[170:173]
s_add_u32 m0, s45, 32896
v_cvt_pk_bf16_f32 v117, v164, v165
v_cvt_pk_bf16_f32 v116, v162, v163
v_mfma_f32_16x16x32_bf16 v[134:137], v[182:185], a[136:139], 0
s_add_u32 s40, s37, 1569792
v_exp_f32 v141, v141
v_mfma_f32_16x16x32_bf16 v[134:137], v[186:189], a[140:143], v[134:137]
buffer_load_dwordx4 v216, s[4:7], s40 offen nt lds
v_mov_b32 v216, 1
s_mov_b64 exec, s[30:31]
buffer_atomic_add v216, off, s[20:23], s45 sc0
s_mov_b64 exec, -1
v_mfma_f32_16x16x32_bf16 v[220:223], v[248:251], v[182:185], 0
v_exp_f32 v155, v155
v_mfma_f32_16x16x32_bf16 v[220:223], v[252:255], v[186:189], v[220:223]
v_exp_f32 v156, v156
v_mfma_f32_16x16x32_bf16 v[220:223], v[240:243], v[174:177], v[220:223]
v_exp_f32 v150, v150
v_mfma_f32_16x16x32_bf16 v[90:93], a[236:239], v[186:189], v[90:93]
v_exp_f32 v166, v166
v_mfma_f32_16x16x32_bf16 v[90:93], a[224:227], v[174:177], v[90:93]
ds_write_b64 v212, v[94:95] offset:12288
v_mfma_f32_16x16x16_bf16 v[142:145], v[100:101], v[76:77], 0
v_exp_f32 v157, v157
v_exp_f32 v159, v159
v_mfma_f32_16x16x32_bf16 v[126:129], v[178:181], a[108:111], v[126:129]
v_exp_f32 v139, v139
v_mfma_f32_16x16x32_bf16 v[142:145], v[96:99], v[72:75], v[142:145]
v_exp_f32 v138, v138
v_mfma_f32_16x16x32_bf16 v[134:137], v[174:177], a[128:131], v[134:137]
ds_read_b128 v[182:185], v210 offset:32768
v_cvt_pk_bf16_f32 v175, v140, v141
v_mfma_f32_16x16x32_bf16 v[134:137], v[178:181], a[132:135], v[134:137]
ds_read_b128 v[186:189], v210 offset:33792
v_exp_f32 v142, v142
v_mfma_f32_16x16x16_bf16 v[146:149], v[106:107], v[76:77], 0
v_cvt_pk_bf16_f32 v174, v138, v139
v_exp_f32 v145, v145
v_mfma_f32_16x16x16_bf16 v[162:165], v[106:107], v[88:89], 0
v_exp_f32 v143, v143
v_exp_f32 v144, v144
v_mfma_f32_16x16x32_bf16 v[146:149], v[102:105], v[72:75], v[146:149]
ds_read_b128 v[72:75], v215
ds_read_b64 v[76:77], v215 offset:16
v_mfma_f32_16x16x32_bf16 v[162:165], v[102:105], v[84:87], v[162:165]
s_waitcnt lgkmcnt(3)
v_exp_f32 v154, v154
v_mfma_f32_16x16x32_bf16 v[118:121], v[182:185], a[72:75], v[118:121]
s_waitcnt lgkmcnt(2)
v_exp_f32 v149, v149
v_mfma_f32_16x16x32_bf16 v[118:121], v[186:189], a[76:79], v[118:121]
v_exp_f32 v165, v165
v_mfma_f32_16x16x32_bf16 v[134:137], v[182:185], a[120:123], v[134:137]
v_exp_f32 v146, v146
v_mfma_f32_16x16x32_bf16 v[134:137], v[186:189], a[124:127], v[134:137]
v_exp_f32_e64 v163, v163
v_mfma_f32_16x16x32_bf16 v[126:129], v[182:185], a[96:99], v[126:129]
v_cvt_pk_bf16_f32 v176, v142, v143
v_cvt_pk_bf16_f32 v118, v118, v119
v_mfma_f32_16x16x32_bf16 v[126:129], v[186:189], a[100:103], v[126:129]
v_exp_f32_e64 v148, v148
v_mfma_f32_16x16x32_bf16 v[170:173], a[252:255], v[178:181], v[170:173]
v_cvt_pk_bf16_f32 v119, v120, v121
v_cvt_pk_bf16_f32 v134, v134, v135
v_mfma_f32_16x16x32_bf16 v[220:223], v[244:247], v[178:181], v[220:223]
v_cvt_pk_bf16_f32 v126, v126, v127
v_cvt_pk_bf16_f32 v135, v136, v137
v_cvt_pk_bf16_f32 v177, v144, v145
v_cvt_pk_bf16_f32 v127, v128, v129
v_mfma_f32_16x16x32_bf16 v[220:223], v[232:235], v[182:185], v[220:223]
ds_read_u16 v128, v205 offset:32
ds_read_u16 v120, v205
v_mfma_f32_16x16x32_bf16 v[90:93], a[228:231], v[178:181], v[90:93]
v_exp_f32_e64 v147, v147
v_cvt_pk_bf16_f32 v180, v150, 0
v_mfma_f32_16x16x32_bf16 v[90:93], a[216:219], v[182:185], v[90:93]
v_mov_b32 v181, 0
v_mov_b32 v129, 0
v_mfma_f32_16x16x32_bf16 v[90:93], a[220:223], v[186:189], v[90:93]
v_cvt_pk_bf16_f32 v178, v146, v147
v_cvt_pk_bf16_f32 v179, v148, v149
v_mfma_f32_16x16x32_bf16 v[150:153], v[190:193], v[174:177], 0
s_add_u32 s28, s39, s60
v_exp_f32 v162, v162
v_mfma_f32_16x16x32_bf16 v[150:153], v[190:193], v[178:181], v[150:153]
ds_read_u16 v136, v205 offset:64
v_mov_b32_e64 v121, 0
v_mfma_f32_16x16x32_bf16 v[138:141], v[114:117], v[174:177], 0
s_waitcnt lgkmcnt(1)
v_exp_f32 v164, v164
v_mfma_f32_16x16x32_bf16 v[138:141], v[118:121], v[178:181], v[138:141]
v_rcp_f32 v151, v150
v_mfma_f32_16x16x32_bf16 v[142:145], v[122:125], v[174:177], 0
v_mov_b32 v137, 0
v_mul_f32_e64 v152, s3, v151
v_mfma_f32_16x16x32_bf16 v[142:145], v[126:129], v[178:181], v[142:145]
v_mul_f32_e64 v139, v139, v152
v_mul_f32 v138, v138, v152
v_mfma_f32_16x16x32_bf16 v[146:149], v[130:133], v[174:177], 0
s_waitcnt lgkmcnt(0)
v_cvt_pk_bf16_f32 v174, v154, v155
v_cvt_pk_bf16_f32 v90, v90, v91
v_cvt_pk_bf16_f32 v91, v92, v93
v_cvt_pk_bf16_f32 v175, v156, v157
v_mfma_f32_16x16x32_bf16 v[146:149], v[134:137], v[178:181], v[146:149]
v_cvt_pk_bf16_f32 v176, v158, v159
v_cvt_pk_bf16_f32 v178, v162, v163
v_mfma_f32_16x16x32_bf16 v[220:223], v[236:239], v[186:189], v[220:223]
v_cvt_pk_bf16_f32 v138, v138, v139
v_mul_f32_e64 v145, v145, v152
v_cvt_pk_bf16_f32 v177, v160, v161
v_mul_f32_e64 v141, v141, v152
v_cvt_pk_bf16_f32 v179, v164, v165
v_mul_f32_e64 v149, v149, v152
v_mfma_f32_16x16x32_bf16 v[170:173], a[240:243], v[182:185], v[170:173]
v_mul_f32_e64 v142, v142, v152
v_cvt_pk_bf16_f32 v180, v166, 0
v_mfma_f32_16x16x32_bf16 v[170:173], a[244:247], v[186:189], v[170:173]
v_mul_f32 v148, v148, v152
v_mul_f32 v147, v147, v152
v_mfma_f32_16x16x32_bf16 v[166:169], v[190:193], v[174:177], 0
v_mul_f32 v144, v144, v152
v_mul_f32 v140, v140, v152
v_mfma_f32_16x16x32_bf16 v[166:169], v[190:193], v[178:181], v[166:169]
v_mul_f32 v146, v146, v152
v_mul_f32 v143, v143, v152
v_mfma_f32_16x16x32_bf16 v[158:161], v[122:125], v[174:177], 0
v_cvt_pk_bf16_f32 v95, v222, v223
v_cvt_pk_bf16_f32 v139, v140, v141
v_mfma_f32_16x16x32_bf16 v[158:161], v[126:129], v[178:181], v[158:161]
v_cvt_pk_bf16_f32 v140, v142, v143
v_cvt_pk_bf16_f32 v141, v144, v145
v_mfma_f32_16x16x32_bf16 v[162:165], v[130:133], v[174:177], 0
ds_write_b128 v211, v[138:141] offset:38912
v_mfma_f32_16x16x32_bf16 v[162:165], v[134:137], v[178:181], v[162:165]
v_max3_u32 v218, v218, v150, v151
v_rcp_f32_e64 v167, v166
v_mfma_f32_16x16x32_bf16 v[154:157], v[114:117], v[174:177], 0
v_cvt_pk_bf16_f32 v94, v220, v221
v_cvt_pk_bf16_f32 v142, v146, v147
v_cvt_pk_bf16_f32 v92, v170, v171
v_mfma_f32_16x16x32_bf16 v[154:157], v[118:121], v[178:181], v[154:157]
v_cvt_pk_bf16_f32 v93, v172, v173
v_mul_f32 v168, s3, v167
v_mul_f32 v164, v164, v168
v_mfma_f32_16x16x32_bf16 v[138:141], v[78:81], v[90:93], 0
v_cvt_pk_bf16_f32 v143, v148, v149
v_mul_f32_e64 v162, v162, v168
v_mfma_f32_16x16x32_bf16 v[150:153], v[108:111], v[90:93], v[206:209]
ds_write_b64 v212, v[142:143] offset:38912
v_mfma_f32_16x16x32_bf16 v[142:145], v[96:99], v[90:93], 0
v_mul_f32 v159, v159, v168
v_mul_f32 v155, v155, v168
v_mul_f32 v160, v160, v168
v_mul_f32 v163, v163, v168
v_mfma_f32_16x16x32_bf16 v[146:149], v[102:105], v[90:93], 0
v_mul_f32 v154, v154, v168
v_mul_f32 v157, v157, v168
v_mul_f32_e64 v156, v156, v168
v_cvt_pk_bf16_f32 v154, v154, v155
v_mfma_f32_16x16x16_bf16 v[142:145], v[100:101], v[94:95], v[142:145]
v_mul_f32 v161, v161, v168
v_mul_f32 v158, v158, v168
v_mul_f32_e64 v165, v165, v168
v_mfma_f32_16x16x16_bf16 v[146:149], v[106:107], v[94:95], v[146:149]
v_cvt_pk_bf16_f32 v155, v156, v157
v_cvt_pk_bf16_f32 v156, v158, v159
v_cvt_pk_bf16_f32 v159, v164, v165
v_mfma_f32_16x16x16_bf16 v[150:153], v[112:113], v[94:95], v[150:153]
v_cvt_pk_bf16_f32 v157, v160, v161
v_cvt_pk_bf16_f32 v158, v162, v163
v_exp_f32 v142, v142
v_mfma_f32_16x16x32_bf16 v[162:165], v[72:75], v[102:105], 0
ds_write_b64 v212, v[158:159] offset:45056
v_mfma_f32_16x16x16_bf16 v[138:141], v[82:83], v[94:95], v[138:141]
v_exp_f32 v144, v144
v_exp_f32 v143, v143
v_exp_f32 v148, v148
v_exp_f32 v149, v149
v_mfma_f32_16x16x32_bf16 v[158:161], v[72:75], v[96:99], 0
ds_write_b128 v211, v[154:157] offset:45056
v_exp_f32 v145, v145
v_mfma_f32_16x16x16_bf16 v[162:165], v[76:77], v[106:107], v[162:165]
v_cvt_pk_bf16_f32 v176, v142, v143
v_exp_f32_e64 v141, v141
v_cvt_pk_bf16_f32 v179, v148, v149
v_mfma_f32_16x16x32_bf16 v[154:157], v[72:75], v[78:81], 0
v_cvt_pk_bf16_f32 v177, v144, v145
v_exp_f32 v139, v139
v_exp_f32 v140, v140
v_mfma_f32_16x16x16_bf16 v[158:161], v[76:77], v[100:101], v[158:161]
v_exp_f32 v138, v138
v_exp_f32 v146, v146
v_mfma_f32_16x16x16_bf16 v[154:157], v[76:77], v[82:83], v[154:157]
v_cvt_pk_bf16_f32 v174, v138, v139
v_cvt_pk_bf16_f32 v175, v140, v141
v_exp_f32_e64 v147, v147
v_mfma_f32_16x16x32_bf16 v[142:145], v[122:125], v[174:177], 0
v_exp_f32 v150, v150
v_mfma_f32_16x16x32_bf16 v[138:141], v[114:117], v[174:177], 0
s_waitcnt lgkmcnt(0)
v_cvt_pk_bf16_f32 v178, v146, v147
v_cvt_pk_bf16_f32 v180, v150, 0
v_mfma_f32_16x16x32_bf16 v[150:153], v[190:193], v[174:177], 0
s_barrier
ds_read_b128 v[220:223], v210 offset:38912
v_mfma_f32_16x16x32_bf16 v[150:153], v[190:193], v[178:181], v[150:153]
ds_read_b128 v[110:113], v210 offset:39936
v_mfma_f32_16x16x32_bf16 v[138:141], v[118:121], v[178:181], v[138:141]
v_max3_u32 v218, v218, v166, v167
v_mfma_f32_16x16x32_bf16 v[142:145], v[126:129], v[178:181], v[142:145]
v_rcp_f32 v151, v150
v_mfma_f32_16x16x32_bf16 v[146:149], v[130:133], v[174:177], 0
ds_read_b128 v[182:185], v210 offset:41984
ds_read_b128 v[170:173], v210 offset:40960
v_mfma_f32_16x16x32_bf16 v[146:149], v[134:137], v[178:181], v[146:149]
s_nop 0
ds_read_b32 v166, v215 offset:536
s_waitcnt lgkmcnt(4)
v_mfma_f32_16x16x32_bf16 v[44:47], a[192:195], v[220:223], v[44:47]
v_mul_f32 v152, s3, v151
s_waitcnt lgkmcnt(3)
v_mfma_f32_16x16x32_bf16 v[44:47], a[196:199], v[110:113], v[44:47]
ds_read_b128 v[186:189], v210 offset:43008
v_mfma_f32_16x16x32_bf16 v[40:43], a[168:171], v[220:223], v[40:43]
v_mov_b32_dpp v154, v158 quad_perm:[0,1,2,3] row_mask:0x2 bank_mask:0xf
v_mul_f32_e64 v138, v138, v152
v_mfma_f32_16x16x32_bf16 v[40:43], a[172:175], v[110:113], v[40:43]
v_mul_f32 v147, v147, v152
v_mfma_f32_16x16x32_bf16 v[36:39], a[144:147], v[220:223], v[36:39]
ds_read_b128 v[220:223], v210 offset:44032
v_mov_b32_dpp v154, v162 quad_perm:[0,1,2,3] row_mask:0x4 bank_mask:0xf
v_mfma_f32_16x16x32_bf16 v[36:39], a[148:151], v[110:113], v[36:39]
s_waitcnt lgkmcnt(2)
v_add_f32_dpp v154, v166, v207 quad_perm:[0,1,2,3] row_mask:0x8 bank_mask:0xf
v_mul_f32_e64 v145, v145, v152
v_mfma_f32_16x16x32_bf16 v[36:39], a[152:155], v[170:173], v[36:39]
v_mul_f32 v140, v140, v152
v_mul_f32 v142, v142, v152
v_mfma_f32_16x16x32_bf16 v[36:39], a[156:159], v[182:185], v[36:39]
ds_read_b128 v[110:113], v210 offset:45056
v_mul_f32_e64 v149, v149, v152
v_mfma_f32_16x16x32_bf16 v[40:43], a[176:179], v[170:173], v[40:43]
v_mul_f32 v144, v144, v152
v_mul_f32 v139, v139, v152
v_mfma_f32_16x16x32_bf16 v[40:43], a[180:183], v[182:185], v[40:43]
v_exp_f32 v166, v154
v_mfma_f32_16x16x32_bf16 v[44:47], a[200:203], v[170:173], v[44:47]
ds_read_b128 v[170:173], v210 offset:46080
v_cvt_pk_bf16_f32 v154, v166, 0
v_mfma_f32_16x16x32_bf16 v[44:47], a[204:207], v[182:185], v[44:47]
s_waitcnt lgkmcnt(3)
v_cvt_pk_bf16_f32 v138, v138, v139
v_mul_f32_e64 v141, v141, v152
v_mfma_f32_16x16x32_bf16 v[44:47], a[208:211], v[186:189], v[44:47]
s_waitcnt lgkmcnt(2)
v_mul_f32 v146, v146, v152
v_add_u32 v205, 1424, v205
v_mfma_f32_16x16x32_bf16 v[44:47], a[212:215], v[220:223], v[44:47]
ds_write_b16 v214, v154
v_mfma_f32_16x16x32_bf16 v[40:43], a[184:187], v[186:189], v[40:43]
ds_read_b128 v[88:91], v215 offset:16
v_mul_f32_e64 v148, v148, v152
v_mfma_f32_16x16x32_bf16 v[40:43], a[188:191], v[220:223], v[40:43]
ds_read_b128 v[174:177], v217
v_cvt_pk_bf16_f32 v139, v140, v141
v_mfma_f32_16x16x32_bf16 v[36:39], a[160:163], v[186:189], v[36:39]
ds_read_b128 v[186:189], v210 offset:48128
ds_read_b128 v[182:185], v210 offset:47104
v_mfma_f32_16x16x32_bf16 v[36:39], a[164:167], v[220:223], v[36:39]
v_mul_f32_e64 v143, v143, v152
s_waitcnt lgkmcnt(6)
v_mfma_f32_16x16x32_bf16 v[48:51], a[144:147], v[110:113], v[48:51]
s_waitcnt lgkmcnt(5)
ds_read_b128 v[220:223], v210 offset:49152
v_cvt_pk_bf16_f32 v141, v144, v145
v_mfma_f32_16x16x32_bf16 v[48:51], a[148:151], v[170:173], v[48:51]
v_cvt_pk_bf16_f32 v140, v142, v143
v_cvt_pk_bf16_f32 v143, v148, v149
v_mfma_f32_16x16x32_bf16 v[52:55], a[168:171], v[110:113], v[52:55]
ds_write_b128 v211, v[138:141] offset:51200
v_mfma_f32_16x16x32_bf16 v[52:55], a[172:175], v[170:173], v[52:55]
v_add_f32_dpp v166, v166, v166 row_ror:8 row_mask:0xf bank_mask:0xf
v_cvt_pk_bf16_f32 v36, v36, v37
v_mfma_f32_16x16x32_bf16 v[56:59], a[192:195], v[110:113], v[56:59]
s_nop 0
v_add_f32_dpp v166, v166, v166 row_ror:4 row_mask:0xf bank_mask:0xf
v_cvt_pk_bf16_f32 v142, v146, v147
v_mfma_f32_16x16x32_bf16 v[56:59], a[196:199], v[170:173], v[56:59]
s_waitcnt lgkmcnt(2)
ds_read_b128 v[110:113], v210 offset:50176
ds_read_b128 v[84:87], v215
v_mfma_f32_16x16x32_bf16 v[56:59], a[200:203], v[182:185], v[56:59]
v_add_u32 v215, 1424, v215
v_add_f32_dpp v166, v166, v166 row_ror:2 row_mask:0xf bank_mask:0xf
v_mfma_f32_16x16x32_bf16 v[56:59], a[204:207], v[186:189], v[56:59]
ds_write_b64 v212, v[142:143] offset:51200
v_mfma_f32_16x16x32_bf16 v[52:55], a[176:179], v[182:185], v[52:55]
v_add_f32_dpp v166, v166, v166 row_ror:1 row_mask:0xf bank_mask:0xf
v_cvt_pk_bf16_f32 v44, v44, v45
v_mfma_f32_16x16x32_bf16 v[52:55], a[180:183], v[186:189], v[52:55]
ds_read_b128 v[178:181], v217 offset:528
v_cvt_pk_bf16_f32 v45, v46, v47
v_mfma_f32_16x16x32_bf16 v[48:51], a[152:155], v[182:185], v[48:51]
v_cvt_pk_bf16_f32 v37, v38, v39
v_cvt_pk_bf16_f32 v40, v40, v41
v_mfma_f32_16x16x32_bf16 v[48:51], a[156:159], v[186:189], v[48:51]
s_waitcnt lgkmcnt(5)
ds_write_b64 v203, v[44:45] offset:64
v_mfma_f32_16x16x32_bf16 v[48:51], a[160:163], v[220:223], v[48:51]
v_cvt_pk_bf16_f32 v41, v42, v43
s_waitcnt lgkmcnt(4)
v_mfma_f32_16x16x32_bf16 v[48:51], a[164:167], v[110:113], v[48:51]
s_waitcnt vmcnt(1) lgkmcnt(2)
ds_write_b64 v203, v[40:41] offset:32
v_mfma_f32_16x16x32_bf16 v[162:165], v[84:87], v[130:133], 0
s_barrier
v_mfma_f32_16x16x32_bf16 v[162:165], v[88:91], v[134:137], v[162:165]
ds_read_b128 v[186:189], v210 offset:53248
v_add_f32_dpp v166, v166, v166 row_bcast:15 row_mask:0xa bank_mask:0xf
v_mfma_f32_16x16x32_bf16 v[154:157], v[84:87], v[114:117], 0
ds_read_b128 v[182:185], v210 offset:52224
ds_read_b128 v[92:95], v201
v_mfma_f32_16x16x32_bf16 v[154:157], v[88:91], v[118:121], v[154:157]
ds_read_b128 v[170:173], v210 offset:51200
v_mfma_f32_16x16x32_bf16 v[158:161], v[84:87], v[122:125], 0
ds_read_b128 v[96:99], v195 offset:16
v_add_f32_dpp v166, v166, v166 row_bcast:31 row_mask:0xc bank_mask:0xf
v_mfma_f32_16x16x32_bf16 v[158:161], v[88:91], v[126:129], v[158:161]
v_mfma_f32_16x16x32_bf16 v[52:55], a[184:187], v[220:223], v[52:55]
ds_read_b128 v[84:87], v200
v_cvt_pk_bf16_f32 v48, v48, v49
v_mfma_f32_16x16x32_bf16 v[52:55], a[188:191], v[110:113], v[52:55]
v_cvt_pk_bf16_f32 v49, v50, v51
v_mfma_f32_16x16x32_bf16 v[56:59], a[208:211], v[220:223], v[56:59]
s_nop 0
ds_write_b64 v203, v[36:37]
v_mfma_f32_16x16x32_bf16 v[56:59], a[212:215], v[110:113], v[56:59]
s_waitcnt lgkmcnt(3)
v_mov_b32_dpp v154, v158 quad_perm:[0,1,2,3] row_mask:0x2 bank_mask:0xf
v_cvt_pk_bf16_f32 v52, v52, v53
v_mfma_f32_16x16x32_bf16 v[64:67], a[168:171], v[170:173], v[64:67]
ds_read_b128 v[220:223], v210 offset:54272
ds_read_b128 v[110:113], v210 offset:55296
v_mfma_f32_16x16x32_bf16 v[60:63], a[144:147], v[170:173], v[60:63]
s_nop 0
ds_write_b64 v203, v[48:49] offset:6272
v_mfma_f32_16x16x32_bf16 v[48:51], v[174:177], v[92:95], 0
s_waitcnt lgkmcnt(4)
v_readlane_b32 s72, v166, 63
v_cvt_pk_bf16_f32 v56, v56, v57
v_mfma_f32_16x16x32_bf16 v[36:39], v[174:177], v[84:87], 0
ds_read_b128 v[92:95], v195
v_mfma_f32_16x16x32_bf16 v[68:71], a[192:195], v[170:173], v[68:71]
ds_read_b128 v[84:87], v194
v_mfma_f32_16x16x32_bf16 v[68:71], a[196:199], v[182:185], v[68:71]
ds_read_b128 v[170:173], v210 offset:56320
v_mov_b32_dpp v154, v162 quad_perm:[0,1,2,3] row_mask:0x4 bank_mask:0xf
v_mfma_f32_16x16x32_bf16 v[68:71], a[200:203], v[186:189], v[68:71]
ds_read_b128 v[88:91], v194 offset:16
ds_read_b128 v[100:103], v202
v_mfma_f32_16x16x32_bf16 v[64:67], a[172:175], v[182:185], v[64:67]
v_cvt_pk_bf16_f32 v53, v54, v55
v_cvt_pk_bf16_f32 v57, v58, v59
v_mfma_f32_16x16x32_bf16 v[64:67], a[176:179], v[186:189], v[64:67]
ds_write_b64 v203, v[56:57] offset:6336
v_mfma_f32_16x16x32_bf16 v[60:63], a[148:151], v[182:185], v[60:63]
v_rcp_f32_e64 v167, s72
v_mfma_f32_16x16x32_bf16 v[60:63], a[152:155], v[186:189], v[60:63]
ds_write_b64 v203, v[52:53] offset:6304
s_waitcnt vmcnt(0) lgkmcnt(9)
s_mov_b64 exec, s[30:31]
ds_write_b32 v209, v216 offset:39424
s_mov_b64 exec, -1
v_mfma_f32_16x16x32_bf16 v[60:63], a[156:159], v[220:223], v[60:63]
s_waitcnt lgkmcnt(9)
v_max3_u32 v218, v218, s72, v167
v_max3_u32 v218, v218, v150, v151
v_mfma_f32_16x16x32_bf16 v[60:63], a[160:163], v[110:113], v[60:63]
s_waitcnt lgkmcnt(5)
ds_read_b128 v[182:185], v210
v_mul_f32 v168, s3, v167
v_mfma_f32_16x16x32_bf16 v[60:63], a[164:167], v[170:173], v[60:63]
s_nop 0
ds_read_b128 v[186:189], v210 offset:1024
s_waitcnt lgkmcnt(6)
v_smfmac_f32_16x16x64_bf16 v[36:39], v[178:181], v[84:91], v213
ds_read_b128 v[104:107], v196 offset:16
ds_read_b128 v[84:87], v197
v_smfmac_f32_16x16x64_bf16 v[48:51], v[178:181], v[92:99], v213
ds_read_b128 v[92:95], v198
ds_read_b128 v[88:91], v197 offset:16
v_mfma_f32_16x16x32_bf16 v[68:71], a[204:207], v[220:223], v[68:71]
s_nop 0
v_cvt_pk_bf16_f32 v60, v60, v61
v_cvt_pk_bf16_f32 v61, v62, v63
v_mfma_f32_16x16x32_bf16 v[68:71], a[208:211], v[110:113], v[68:71]
s_waitcnt lgkmcnt(9)
ds_write_b64 v203, v[60:61] offset:12544
v_mfma_f32_16x16x32_bf16 v[68:71], a[212:215], v[170:173], v[68:71]
s_add_u32 s29, s39, s61
v_mul_f32 v154, v154, v168
v_cvt_pk_bf16_f32 v154, v154, 0
v_mfma_f32_16x16x32_bf16 v[60:63], v[174:177], v[100:103], 0
ds_read_b128 v[174:177], v217 offset:1056
v_mfma_f32_16x16x32_bf16 v[64:67], a[180:183], v[220:223], v[64:67]
v_cvt_pk_bf16_f32 v68, v68, v69
v_cvt_pk_bf16_f32 v69, v70, v71
v_mfma_f32_16x16x32_bf16 v[64:67], a[184:187], v[110:113], v[64:67]
ds_read_b128 v[100:103], v196
ds_read_b128 v[96:99], v198 offset:16
v_mfma_f32_16x16x32_bf16 v[64:67], a[188:191], v[170:173], v[64:67]
s_waitcnt lgkmcnt(9)
ds_write_b16 v214, v154
v_mfma_f32_16x16x32_bf16 v[138:141], a[0:3], v[182:185], 0
s_waitcnt lgkmcnt(9)
ds_write_b64 v203, v[68:69] offset:12608
v_mfma_f32_16x16x32_bf16 v[138:141], a[4:7], v[186:189], v[138:141]
s_nop 0
v_cvt_pk_bf16_f32 v64, v64, v65
v_cvt_pk_bf16_f32 v65, v66, v67
v_mfma_f32_16x16x32_bf16 v[146:149], a[48:51], v[182:185], 0
s_waitcnt lgkmcnt(4)
ds_write_b64 v203, v[64:65] offset:12576
v_smfmac_f32_16x16x64_bf16 v[36:39], v[174:177], v[84:91], v213
s_waitcnt lgkmcnt(4)
v_smfmac_f32_16x16x64_bf16 v[60:63], v[178:181], v[100:107], v213
s_waitcnt lgkmcnt(3)
ds_read_b128 v[104:107], v199 offset:16
ds_read_b128 v[84:87], v200 offset:32
v_smfmac_f32_16x16x64_bf16 v[48:51], v[174:177], v[92:99], v213
ds_read_b128 v[100:103], v199
ds_read_b128 v[178:181], v217 offset:1584
v_mfma_f32_16x16x32_bf16 v[150:153], a[216:219], v[182:185], 0
v_mul_f32 v119, v36, v36
v_add_f32 v118, v36, v37
v_mfma_f32_16x16x32_bf16 v[150:153], a[220:223], v[186:189], v[150:153]
ds_read_b128 v[92:95], v201 offset:32
v_fmac_f32_e64 v119, v37, v37
v_mfma_f32_16x16x32_bf16 v[158:161], v[232:235], v[182:185], 0
ds_read_b128 v[110:113], v210 offset:2048
v_add_f32 v118, v118, v38
v_mfma_f32_16x16x32_bf16 v[158:161], v[236:239], v[186:189], v[158:161]
s_waitcnt lgkmcnt(6)
ds_read_b128 v[88:91], v194 offset:48
v_add_f32_e64 v126, v48, v49
v_mfma_f32_16x16x32_bf16 v[154:157], a[240:243], v[182:185], 0
s_barrier
v_mfma_f32_16x16x32_bf16 v[154:157], a[244:247], v[186:189], v[154:157]
s_waitcnt lgkmcnt(4)
ds_read_b64 v[120:121], v204
ds_read_b64 v[128:129], v204 offset:392
v_smfmac_f32_16x16x64_bf16 v[60:63], v[174:177], v[100:107], v213
s_waitcnt lgkmcnt(5)
ds_read_b128 v[100:103], v202 offset:32
ds_read_b128 v[96:99], v195 offset:48
v_mfma_f32_16x16x32_bf16 v[40:43], v[178:181], v[84:87], 0
s_waitcnt lgkmcnt(6)
ds_read_b128 v[84:87], v194 offset:32
ds_read_b128 v[174:177], v217 offset:2112
v_mfma_f32_16x16x32_bf16 v[52:55], v[178:181], v[92:95], 0
ds_read_b128 v[92:95], v195 offset:32
v_add_f32_e64 v126, v126, v50
v_mfma_f32_16x16x32_bf16 v[170:173], v[182:185], a[120:123], 0
v_mul_f32_e64 v135, v60, v60
v_mul_f32 v127, v48, v48
v_mfma_f32_16x16x32_bf16 v[170:173], v[186:189], a[124:127], v[170:173]
s_waitcnt lgkmcnt(6)
buffer_store_dwordx2 v[120:121], v204, s[8:11], s28 offen sc1
v_fmac_f32 v119, v38, v38
v_mfma_f32_16x16x32_bf16 v[170:173], v[110:113], a[128:131], v[170:173]
s_waitcnt lgkmcnt(4)
ds_read_b128 v[104:107], v196 offset:48
v_add_f32_e64 v134, v60, v61
v_mfma_f32_16x16x32_bf16 v[64:67], v[178:181], v[100:103], 0
ds_read_b128 v[100:103], v196 offset:32
ds_read_b64 v[136:137], v204 offset:784
v_mfma_f32_16x16x32_bf16 v[146:149], a[52:55], v[186:189], v[146:149]
s_nop 0
ds_read_b128 v[178:181], v217 offset:2640
ds_read_b64 v[120:121], v204 offset:1176
v_mfma_f32_16x16x32_bf16 v[146:149], a[56:59], v[110:113], v[146:149]
s_waitcnt lgkmcnt(6)
buffer_store_dwordx2 v[128:129], v204, s[8:11], s29 offen sc1
v_fmac_f32 v119, v39, v39
v_smfmac_f32_16x16x64_bf16 v[40:43], v[174:177], v[84:91], v213
s_waitcnt lgkmcnt(5)
ds_read_b128 v[88:91], v197 offset:48
v_add_f32 v134, v134, v62
v_mfma_f32_16x16x32_bf16 v[150:153], a[224:227], v[110:113], v[150:153]
s_add_u32 s28, s39, s62
ds_read_b128 v[84:87], v197 offset:32
v_fmac_f32 v127, v49, v49
v_smfmac_f32_16x16x64_bf16 v[52:55], v[174:177], v[92:99], v213
s_waitcnt lgkmcnt(5)
ds_read_b128 v[92:95], v198 offset:32
ds_read_b128 v[96:99], v198 offset:48
v_smfmac_f32_16x16x64_bf16 v[64:67], v[174:177], v[100:107], v213
ds_read_b128 v[104:107], v199 offset:48
v_add_f32_e64 v126, v126, v51
v_mfma_f32_16x16x32_bf16 v[142:145], a[24:27], v[182:185], 0
ds_read_b128 v[100:103], v199 offset:32
v_fmac_f32 v135, v61, v61
v_mfma_f32_16x16x32_bf16 v[142:145], a[28:31], v[186:189], v[142:145]
s_add_u32 s29, s39, s63
ds_read_b128 v[220:223], v210 offset:3072
v_add_f32 v118, v118, v39
v_mfma_f32_16x16x32_bf16 v[142:145], a[32:35], v[110:113], v[142:145]
s_waitcnt lgkmcnt(9)
buffer_store_dwordx2 v[136:137], v204, s[8:11], s28 offen sc1
v_fmac_f32 v135, v62, v62
v_mfma_f32_16x16x32_bf16 v[138:141], a[8:11], v[110:113], v[138:141]
s_waitcnt lgkmcnt(5)
ds_read_b64 v[128:129], v204 offset:6272
v_fmac_f32 v127, v50, v50
v_smfmac_f32_16x16x64_bf16 v[40:43], v[178:181], v[84:91], v213
s_waitcnt lgkmcnt(4)
ds_read_b128 v[174:177], v217 offset:3168
v_fmac_f32_e64 v135, v63, v63
v_smfmac_f32_16x16x64_bf16 v[52:55], v[178:181], v[92:99], v213
ds_read_b128 v[92:95], v201 offset:64
ds_read_b128 v[84:87], v200 offset:64
v_mfma_f32_16x16x32_bf16 v[162:165], v[182:185], a[72:75], 0
ds_read_b128 v[96:99], v195 offset:80
v_fmac_f32 v127, v51, v51
v_mfma_f32_16x16x32_bf16 v[162:165], v[186:189], a[76:79], v[162:165]
s_waitcnt lgkmcnt(6)
buffer_store_dwordx2 v[120:121], v204, s[8:11], s29 offen sc1
v_fmac_f32 v127, v52, v52
v_smfmac_f32_16x16x64_bf16 v[64:67], v[178:181], v[100:107], v213
ds_read_b128 v[100:103], v202 offset:64
ds_read_b128 v[178:181], v217 offset:3696
v_mfma_f32_16x16x32_bf16 v[154:157], a[248:251], v[110:113], v[154:157]
s_waitcnt lgkmcnt(7)
ds_read_b64 v[120:121], v204 offset:7056
ds_read_b128 v[88:91], v194 offset:80
v_mfma_f32_16x16x32_bf16 v[154:157], a[252:255], v[220:223], v[154:157]
s_waitcnt lgkmcnt(6)
v_add_f32 v134, v134, v63
v_add_f32_e64 v126, v126, v52
v_mfma_f32_16x16x32_bf16 v[158:161], v[240:243], v[110:113], v[158:161]
s_add_u32 s28, s39, s64
v_add_f32 v126, v126, v53
v_fmac_f32_e64 v135, v64, v64
v_mfma_f32_16x16x32_bf16 v[56:59], v[174:177], v[92:95], 0
s_waitcnt lgkmcnt(5)
buffer_store_dwordx2 v[128:129], v204, s[8:11], s28 offen sc1
ds_read_b64 v[136:137], v204 offset:6664
v_mfma_f32_16x16x32_bf16 v[138:141], a[12:15], v[220:223], v[138:141]
s_add_u32 s29, s39, s65
ds_read_b128 v[92:95], v195 offset:64
ds_read_b64 v[128:129], v204 offset:7448
v_mfma_f32_16x16x32_bf16 v[44:47], v[174:177], v[84:87], 0
s_waitcnt lgkmcnt(6)
ds_read_b128 v[84:87], v194 offset:64
v_add_f32 v134, v134, v64
v_mfma_f32_16x16x32_bf16 v[68:71], v[174:177], v[100:103], 0
ds_read_b128 v[104:107], v196 offset:80
v_fmac_f32_e64 v127, v53, v53
v_mfma_f32_16x16x32_bf16 v[166:169], v[182:185], a[96:99], 0
ds_read_b128 v[182:185], v210 offset:4096
v_add_f32_e64 v118, v118, v40
v_mfma_f32_16x16x32_bf16 v[166:169], v[186:189], a[100:103], v[166:169]
s_add_u32 s28, s39, s66
v_fmac_f32 v127, v54, v54
v_fmac_f32 v135, v65, v65
v_mfma_f32_16x16x32_bf16 v[166:169], v[110:113], a[104:107], v[166:169]
s_waitcnt lgkmcnt(5)
buffer_store_dwordx2 v[136:137], v204, s[8:11], s29 offen sc1
ds_read_b128 v[100:103], v196 offset:64
v_mfma_f32_16x16x32_bf16 v[166:169], v[220:223], a[108:111], v[166:169]
ds_read_b128 v[186:189], v210 offset:5120
v_fmac_f32_e64 v135, v66, v66
v_mfma_f32_16x16x32_bf16 v[162:165], v[110:113], a[80:83], v[162:165]
ds_read_b64 v[136:137], v204 offset:12544
v_fmac_f32 v119, v40, v40
v_mfma_f32_16x16x32_bf16 v[162:165], v[220:223], a[84:87], v[162:165]
s_waitcnt lgkmcnt(5)
ds_read_b128 v[174:177], v217 offset:4224
v_add_f32_e64 v118, v118, v41
v_smfmac_f32_16x16x64_bf16 v[44:47], v[178:181], v[84:91], v213
ds_read_b128 v[88:91], v197 offset:80
v_add_f32_e64 v134, v134, v65
v_mfma_f32_16x16x32_bf16 v[170:173], v[220:223], a[132:135], v[170:173]
ds_read_b128 v[84:87], v197 offset:64
v_add_f32 v118, v118, v42
v_smfmac_f32_16x16x64_bf16 v[56:59], v[178:181], v[92:99], v213
s_waitcnt lgkmcnt(5)
buffer_store_dwordx2 v[120:121], v204, s[8:11], s28 offen sc1
v_add_f32_e64 v126, v126, v54
v_smfmac_f32_16x16x64_bf16 v[68:71], v[178:181], v[100:107], v213
ds_read_b128 v[96:99], v198 offset:80
ds_read_b128 v[100:103], v199 offset:64
v_mfma_f32_16x16x32_bf16 v[158:161], v[244:247], v[220:223], v[158:161]
s_add_u32 s29, s39, s67
v_add_f32 v118, v118, v43
v_fmac_f32 v119, v41, v41
v_mfma_f32_16x16x32_bf16 v[146:149], a[60:63], v[220:223], v[146:149]
s_add_u32 s28, s39, s68
ds_read_b128 v[92:95], v198 offset:64
v_fmac_f32_e64 v135, v67, v67
v_mfma_f32_16x16x32_bf16 v[142:145], a[36:39], v[220:223], v[142:145]
s_waitcnt lgkmcnt(3)
v_fmac_f32 v119, v42, v42
v_fmac_f32_e64 v119, v43, v43
v_smfmac_f32_16x16x64_bf16 v[44:47], v[174:177], v[84:91], v213
ds_read_b128 v[104:107], v199 offset:80
ds_read_b128 v[110:113], v210 offset:6144
v_mfma_f32_16x16x32_bf16 v[150:153], a[228:231], v[220:223], v[150:153]
buffer_store_dwordx2 v[128:129], v204, s[8:11], s29 offen sc1
v_fmac_f32_e64 v127, v55, v55
v_mfma_f32_16x16x32_bf16 v[150:153], a[232:235], v[182:185], v[150:153]
v_add_f32 v134, v134, v66
v_fmac_f32 v119, v44, v44
v_mfma_f32_16x16x32_bf16 v[150:153], a[236:239], v[186:189], v[150:153]
s_waitcnt lgkmcnt(2)
v_add_f32 v126, v126, v55
v_fmac_f32_e64 v119, v45, v45
v_smfmac_f32_16x16x64_bf16 v[56:59], v[174:177], v[92:99], v213
ds_read_b128 v[220:223], v210 offset:7168
ds_read_b64 v[120:121], v204 offset:12936
v_mfma_f32_16x16x32_bf16 v[154:157], v[224:227], v[182:185], v[154:157]
s_waitcnt lgkmcnt(3)
buffer_store_dwordx2 v[136:137], v204, s[8:11], s28 offen sc1
v_add_f32 v118, v118, v44
v_smfmac_f32_16x16x64_bf16 v[68:71], v[174:177], v[100:107], v213
ds_read_b64 v[128:129], v204 offset:13328
v_fmac_f32_e64 v127, v56, v56
v_mfma_f32_16x16x32_bf16 v[142:145], a[40:43], v[182:185], v[142:145]
v_add_f32 v134, v134, v67
v_fmac_f32 v127, v57, v57
v_mfma_f32_16x16x32_bf16 v[142:145], a[44:47], v[186:189], v[142:145]
v_cvt_pk_bf16_f32 v72, v150, v151
v_add_f32_e64 v118, v118, v45
v_mfma_f32_16x16x32_bf16 v[138:141], a[16:19], v[182:185], v[138:141]
v_fmac_f32 v135, v68, v68
ds_read_b32 v216, v210 offset:57856
v_add_f32 v134, v134, v68
v_mfma_f32_16x16x32_bf16 v[138:141], a[20:23], v[186:189], v[138:141]
ds_read_b64 v[136:137], v204 offset:13720
v_add_f32_e64 v126, v126, v56
v_mfma_f32_16x16x32_bf16 v[146:149], a[64:67], v[182:185], v[146:149]
v_add_f32 v126, v126, v57
v_add_f32 v134, v134, v69
v_mfma_f32_16x16x32_bf16 v[146:149], a[68:71], v[186:189], v[146:149]
v_add_f32 v126, v126, v58
v_add_f32 v118, v118, v46
v_mfma_f32_16x16x32_bf16 v[158:161], v[248:251], v[182:185], v[158:161]
v_fmac_f32 v119, v46, v46
s_waitcnt lgkmcnt(1)
v_readfirstlane_b32 s97, v216
s_nop 0
s_and_b32 s97, s97, 255
s_add_u32 s97, s97, 5120
v_fmac_f32_e64 v135, v69, v69
v_mfma_f32_16x16x32_bf16 v[158:161], v[252:255], v[186:189], v[158:161]
v_cvt_pk_bf16_f32 v80, v142, v143
v_cvt_pk_bf16_f32 v79, v140, v141
v_mfma_f32_16x16x32_bf16 v[154:157], v[228:231], v[186:189], v[154:157]
s_add_u32 s28, s39, s70
v_cvt_pk_bf16_f32 v78, v138, v139
v_add_f32 v134, v134, v70
v_mfma_f32_16x16x32_bf16 v[166:169], v[182:185], a[112:115], v[166:169]
v_cvt_pk_bf16_f32 v83, v148, v149
v_cvt_pk_bf16_f32 v81, v144, v145
v_mfma_f32_16x16x32_bf16 v[166:169], v[186:189], a[116:119], v[166:169]
s_add_u32 s29, s39, s69
v_add_f32 v118, v118, v47
v_fmac_f32_e64 v119, v47, v47
v_mfma_f32_16x16x32_bf16 v[162:165], v[182:185], a[88:91], v[162:165]
v_permlane16_swap_b32 v118, v119
v_mfma_f32_16x16x32_bf16 v[162:165], v[186:189], a[92:95], v[162:165]
buffer_store_dwordx2 v[120:121], v204, s[8:11], s29 offen sc1
v_fmac_f32 v135, v70, v70
v_mfma_f32_16x16x32_bf16 v[170:173], v[182:185], a[136:139], v[170:173]
s_add_u32 s29, s39, s71
v_add_f32 v118, v118, v119
v_fmac_f32_e64 v135, v71, v71
v_mfma_f32_16x16x32_bf16 v[170:173], v[186:189], a[140:143], v[170:173]
ds_read_b128 v[186:189], v210 offset:9216
ds_read_b128 v[182:185], v210 offset:8192
v_mfma_f32_16x16x32_bf16 v[142:145], a[24:27], v[110:113], 0
v_add_f32 v134, v134, v71
v_fmac_f32 v127, v58, v58
v_mfma_f32_16x16x32_bf16 v[142:145], a[28:31], v[220:223], v[142:145]
buffer_store_dwordx2 v[128:129], v204, s[8:11], s28 offen sc1
v_add_f32 v126, v126, v59
v_mfma_f32_16x16x32_bf16 v[138:141], a[0:3], v[110:113], 0
v_permlane16_swap_b32 v134, v135
v_mfma_f32_16x16x32_bf16 v[138:141], a[4:7], v[220:223], v[138:141]
v_cvt_pk_bf16_f32 v82, v146, v147
v_fmac_f32 v127, v59, v59
v_mfma_f32_16x16x32_bf16 v[146:149], a[48:51], v[110:113], 0
s_waitcnt lgkmcnt(2)
buffer_store_dwordx2 v[136:137], v204, s[8:11], s29 offen sc1
v_add_f32_e64 v134, v134, v135
v_mfma_f32_16x16x32_bf16 v[146:149], a[52:55], v[220:223], v[146:149]
s_waitcnt lgkmcnt(0)
v_permlane16_swap_b32 v126, v127
v_mfma_f32_16x16x32_bf16 v[146:149], a[56:59], v[182:185], v[146:149]
v_add_f32 v126, v126, v127
v_mov_b32 v135, v134
v_mfma_f32_16x16x32_bf16 v[146:149], a[60:63], v[186:189], v[146:149]
s_nop 0
v_permlane32_swap_b32 v118, v126
s_cmp_lt_u32 s97, s34
s_cbranch_scc0 L_tailb
s_mov_b32 s35, s97
s_mul_hi_u32 s41, s35, 58835169
s_mul_i32 s42, s41, 73
s_sub_u32 s42, s35, s42
s_mul_i32 s43, s41, 1373568
s_mul_i32 s51, s42, 2688
s_add_u32 s50, s43, s51
s_min_u32 s41, s41, 1
s_sub_u32 s41, 1, s41
s_lshl_b32 s41, s41, 30
s_add_u32 s52, s50, s41
s_min_u32 s43, s42, 1
s_lshl_b32 s43, s43, 27
s_sub_u32 s43, 536870911, s43
s_add_u32 s51, s42, 56
s_and_b32 s51, s51, 128
s_lshl_b32 s51, s51, 22
s_or_b32 s44, s43, s51
s_mov_b32 s36, s50
v_and_b32 v216, s44, v208
s_add_u32 m0, s45, 0
s_add_u32 s40, s36, 196224
v_permlane32_swap_b32 v134, v135
v_mfma_f32_16x16x32_bf16 v[142:145], a[32:35], v[182:185], v[142:145]
v_add_f32 v118, v118, v126
v_add_f32 v134, v134, v135
v_mfma_f32_16x16x32_bf16 v[142:145], a[36:39], v[186:189], v[142:145]
ds_write_b32 v209, v118
v_mfma_f32_16x16x32_bf16 v[138:141], a[8:11], v[182:185], v[138:141]
ds_write_b32 v209, v134 offset:512
v_mfma_f32_16x16x32_bf16 v[138:141], a[12:15], v[186:189], v[138:141]
s_nop 0
v_cvt_pk_bf16_f32 v76, v158, v159
v_cvt_pk_bf16_f32 v73, v152, v153
v_mfma_f32_16x16x32_bf16 v[150:153], a[216:219], v[110:113], 0
s_add_u32 s35, s35, 32
v_cvt_pk_bf16_f32 v74, v154, v155
v_cvt_pk_bf16_f32 v123, v168, v169
v_mfma_f32_16x16x32_bf16 v[150:153], a[220:223], v[220:223], v[150:153]
v_cvt_pk_bf16_f32 v131, v172, v173
v_mfma_f32_16x16x32_bf16 v[150:153], a[224:227], v[182:185], v[150:153]
v_cvt_pk_bf16_f32 v75, v156, v157
v_mfma_f32_16x16x32_bf16 v[150:153], a[228:231], v[186:189], v[150:153]
v_cvt_pk_bf16_f32 v77, v160, v161
s_waitcnt lgkmcnt(0)
v_mfma_f32_16x16x32_bf16 v[154:157], a[240:243], v[110:113], 0
s_barrier
v_mfma_f32_16x16x32_bf16 v[154:157], a[244:247], v[220:223], v[154:157]
ds_read_b128 v[106:109], v210 offset:19456
ds_read_b128 v[102:105], v210 offset:18432
v_mfma_f32_16x16x32_bf16 v[154:157], a[248:251], v[182:185], v[154:157]
buffer_load_dwordx4 v216, s[4:7], s52 offen nt lds
v_mfma_f32_16x16x32_bf16 v[158:161], v[232:235], v[110:113], 0
v_cvt_pk_bf16_f32 v130, v170, v171
v_cvt_pk_bf16_f32 v115, v164, v165
v_mfma_f32_16x16x32_bf16 v[158:161], v[236:239], v[220:223], v[158:161]
v_cvt_pk_bf16_f32 v114, v162, v163
v_mfma_f32_16x16x32_bf16 v[158:161], v[240:243], v[182:185], v[158:161]
v_cvt_pk_bf16_f32 v122, v166, v167
v_mfma_f32_16x16x32_bf16 v[158:161], v[244:247], v[186:189], v[158:161]
s_waitcnt lgkmcnt(1)
v_add_f32 v108, v108, v109
v_mfma_f32_16x16x32_bf16 v[170:173], v[110:113], a[120:123], 0
v_add_f32 v106, v106, v107
v_add_f32 v106, v106, v108
v_mfma_f32_16x16x32_bf16 v[170:173], v[220:223], a[124:127], v[170:173]
s_waitcnt lgkmcnt(0)
v_add_f32 v102, v102, v103
v_add_f32_e64 v104, v104, v105
v_mfma_f32_16x16x32_bf16 v[166:169], v[110:113], a[96:99], 0
s_add_u32 m0, s45, 4112
v_add_f32 v102, v102, v104
v_mul_f32 v104, s73, v102
v_mfma_f32_16x16x32_bf16 v[166:169], v[220:223], a[100:103], v[166:169]
v_mul_f32 v103, s48, v102
v_mul_f32 v106, s73, v106
v_mfma_f32_16x16x32_bf16 v[162:165], v[110:113], a[72:75], 0
buffer_load_dwordx4 v216, s[4:7], s40 offen nt lds
v_mfma_f32_16x16x32_bf16 v[162:165], v[220:223], a[76:79], v[162:165]
v_fma_f32 v106, -v103, v104, v106
v_max_f32_e64 v106, 0, v106
v_mfma_f32_16x16x32_bf16 v[162:165], v[182:185], a[80:83], v[162:165]
ds_read_b128 v[110:113], v210 offset:10240
v_add_f32_e64 v106, s49, v106
v_mfma_f32_16x16x32_bf16 v[162:165], v[186:189], a[84:87], v[162:165]
s_add_u32 s40, s36, 392448
v_rsq_f32_e64 v102, v106
v_mfma_f32_16x16x32_bf16 v[170:173], v[182:185], a[128:131], v[170:173]
ds_read_b128 v[106:109], v210 offset:11264
v_mul_f32_e64 v103, -v103, v102
v_mfma_f32_16x16x32_bf16 v[170:173], v[186:189], a[132:135], v[170:173]
ds_write_b64 v211, v[102:103] offset:20480
v_mfma_f32_16x16x32_bf16 v[166:169], v[182:185], a[104:107], v[166:169]
v_mfma_f32_16x16x32_bf16 v[166:169], v[186:189], a[108:111], v[166:169]
ds_read_b64 v[118:119], v219 offset:20480
v_add_u32 v214, 1424, v214
v_mfma_f32_16x16x32_bf16 v[154:157], a[252:255], v[186:189], v[154:157]
s_add_u32 m0, s45, 8224
ds_read_b64 v[134:135], v219 offset:20992
s_waitcnt lgkmcnt(4)
v_mfma_f32_16x16x32_bf16 v[154:157], v[224:227], v[110:113], v[154:157]
buffer_load_dwordx4 v216, s[4:7], s40 offen nt lds
v_mfma_f32_16x16x32_bf16 v[142:145], a[40:43], v[110:113], v[142:145]
ds_read_b128 v[182:185], v210 offset:12288
s_waitcnt lgkmcnt(4)
v_mfma_f32_16x16x32_bf16 v[142:145], a[44:47], v[106:109], v[142:145]
s_nop 0
ds_read_b128 v[186:189], v210 offset:13312
ds_read_b64 v[126:127], v219 offset:20736
v_mfma_f32_16x16x32_bf16 v[150:153], a[232:235], v[110:113], v[150:153]
s_waitcnt lgkmcnt(4)
v_fma_f32 v223, v39, v118, v119
v_fma_f32 v221, v37, v118, v119
v_mfma_f32_16x16x32_bf16 v[150:153], a[236:239], v[106:109], v[150:153]
v_fma_f32 v220, v36, v118, v119
v_fma_f32 v222, v38, v118, v119
v_mfma_f32_16x16x32_bf16 v[146:149], a[64:67], v[110:113], v[146:149]
v_cvt_pk_bf16_f32 v175, v222, v223
v_fma_f32 v222, v42, v118, v119
v_mfma_f32_16x16x32_bf16 v[146:149], a[68:71], v[106:109], v[146:149]
v_cvt_pk_bf16_f32 v99, v144, v145
v_cvt_pk_bf16_f32 v174, v220, v221
v_mfma_f32_16x16x32_bf16 v[166:169], v[110:113], a[112:115], v[166:169]
s_add_u32 m0, s45, 12336
v_fma_f32 v223, v43, v118, v119
v_fma_f32 v220, v40, v118, v119
v_mfma_f32_16x16x32_bf16 v[166:169], v[106:109], a[116:119], v[166:169]
s_add_u32 s40, s36, 588672
v_cvt_pk_bf16_f32 v100, v146, v147
v_fma_f32 v221, v41, v118, v119
v_mfma_f32_16x16x32_bf16 v[154:157], v[228:231], v[106:109], v[154:157]
buffer_load_dwordx4 v216, s[4:7], s40 offen nt lds
v_mfma_f32_16x16x32_bf16 v[138:141], a[16:19], v[110:113], v[138:141]
v_cvt_pk_bf16_f32 v177, v222, v223
v_cvt_pk_bf16_f32 v176, v220, v221
v_mfma_f32_16x16x32_bf16 v[138:141], a[20:23], v[106:109], v[138:141]
ds_write_b128 v211, v[174:177] offset:20480
v_mfma_f32_16x16x32_bf16 v[158:161], v[248:251], v[110:113], v[158:161]
v_cvt_pk_bf16_f32 v97, v140, v141
v_fma_f32 v223, v47, v118, v119
v_mfma_f32_16x16x32_bf16 v[158:161], v[252:255], v[106:109], v[158:161]
s_add_u32 s40, s36, 784896
v_fma_f32 v222, v46, v118, v119
v_cvt_pk_bf16_f32 v125, v168, v169
v_mfma_f32_16x16x32_bf16 v[170:173], v[110:113], a[136:139], v[170:173]
v_fma_f32 v220, v44, v118, v119
v_fma_f32 v221, v45, v118, v119
v_mfma_f32_16x16x32_bf16 v[170:173], v[106:109], a[140:143], v[170:173]
v_cvt_pk_bf16_f32 v86, v154, v155
v_cvt_pk_bf16_f32 v179, v222, v223
v_mfma_f32_16x16x32_bf16 v[162:165], v[110:113], a[88:91], v[162:165]
s_add_u32 m0, s45, 16448
v_cvt_pk_bf16_f32 v124, v166, v167
v_cvt_pk_bf16_f32 v98, v142, v143
v_mfma_f32_16x16x32_bf16 v[162:165], v[106:109], a[92:95], v[162:165]
s_waitcnt lgkmcnt(1)
ds_read_b64 v[112:113], v215 offset:528
v_fma_f32 v223, v51, v126, v127
v_mfma_f32_16x16x32_bf16 v[142:145], a[24:27], v[182:185], 0
s_nop 0
v_cvt_pk_bf16_f32 v178, v220, v221
v_cvt_pk_bf16_f32 v101, v148, v149
v_mfma_f32_16x16x32_bf16 v[142:145], a[28:31], v[186:189], v[142:145]
v_cvt_pk_bf16_f32 v96, v138, v139
v_fma_f32 v222, v50, v126, v127
v_mfma_f32_16x16x32_bf16 v[146:149], a[48:51], v[182:185], 0
buffer_load_dwordx4 v216, s[4:7], s40 offen nt lds
v_mfma_f32_16x16x32_bf16 v[146:149], a[52:55], v[186:189], v[146:149]
ds_read_b128 v[174:177], v210 offset:14336
v_cvt_pk_bf16_f32 v89, v160, v161
v_mfma_f32_16x16x32_bf16 v[138:141], a[0:3], v[182:185], 0
s_nop 0
v_cvt_pk_bf16_f32 v88, v158, v159
v_cvt_pk_bf16_f32 v84, v150, v151
v_mfma_f32_16x16x32_bf16 v[138:141], a[4:7], v[186:189], v[138:141]
s_add_u32 s40, s36, 981120
ds_write_b64 v212, v[178:179] offset:20480
v_mfma_f32_16x16x16_bf16 v[158:161], v[100:101], v[88:89], 0
v_cvt_pk_bf16_f32 v91, v222, v223
v_cvt_pk_bf16_f32 v87, v156, v157
v_fma_f32 v222, v54, v126, v127
v_mfma_f32_16x16x16_bf16 v[154:157], v[82:83], v[88:89], 0
s_waitcnt lgkmcnt(2)
ds_read_b128 v[178:181], v210 offset:15360
v_fma_f32 v223, v55, v126, v127
v_mfma_f32_16x16x16_bf16 v[166:169], v[112:113], v[88:89], v[206:209]
v_fma_f32 v221, v49, v126, v127
v_fma_f32 v220, v48, v126, v127
v_cvt_pk_bf16_f32 v85, v152, v153
v_mfma_f32_16x16x16_bf16 v[150:153], v[112:113], v[76:77], v[206:209]
v_cvt_pk_bf16_f32 v93, v222, v223
v_fma_f32 v223, v59, v126, v127
v_cvt_pk_bf16_f32 v90, v220, v221
v_fma_f32 v220, v52, v126, v127
v_mfma_f32_16x16x32_bf16 v[154:157], v[78:81], v[84:87], v[154:157]
s_add_u32 m0, s45, 20560
ds_read_b128 v[108:111], v215 offset:512
v_fma_f32 v221, v53, v126, v127
v_mfma_f32_16x16x32_bf16 v[158:161], v[96:99], v[84:87], v[158:161]
s_waitcnt lgkmcnt(3)
ds_read_b128 v[186:189], v210 offset:17408
v_fma_f32 v222, v58, v126, v127
v_mfma_f32_16x16x32_bf16 v[138:141], a[8:11], v[174:177], v[138:141]
s_waitcnt lgkmcnt(2)
buffer_load_dwordx4 v216, s[4:7], s40 offen nt lds
v_mfma_f32_16x16x32_bf16 v[138:141], a[12:15], v[178:181], v[138:141]
s_add_u32 m0, s45, 24672
ds_read_b128 v[182:185], v210 offset:16384
v_cvt_pk_bf16_f32 v92, v220, v221
v_mfma_f32_16x16x32_bf16 v[142:145], a[32:35], v[174:177], v[142:145]
v_cvt_pk_bf16_f32 v95, v222, v223
v_fma_f32 v221, v57, v126, v127
v_mfma_f32_16x16x32_bf16 v[142:145], a[36:39], v[178:181], v[142:145]
ds_write_b128 v211, v[90:93] offset:26624
v_mfma_f32_16x16x32_bf16 v[146:149], a[56:59], v[174:177], v[146:149]
v_exp_f32_e64 v161, v161
v_mfma_f32_16x16x32_bf16 v[146:149], a[60:63], v[178:181], v[146:149]
s_waitcnt lgkmcnt(3)
v_fma_f32 v223, v63, v134, v135
v_fma_f32 v222, v62, v134, v135
v_mfma_f32_16x16x32_bf16 v[166:169], v[108:111], v[84:87], v[166:169]
s_waitcnt lgkmcnt(1)
v_fma_f32 v220, v56, v126, v127
v_cvt_pk_bf16_f32 v91, v222, v223
v_mfma_f32_16x16x32_bf16 v[126:129], v[182:185], a[112:115], 0
v_cvt_pk_bf16_f32 v94, v220, v221
v_fma_f32 v222, v66, v134, v135
v_mfma_f32_16x16x32_bf16 v[126:129], v[186:189], a[116:119], v[126:129]
s_add_u32 s40, s36, 1177344
v_fma_f32 v221, v61, v134, v135
v_cvt_pk_bf16_f32 v133, v172, v173
v_mfma_f32_16x16x32_bf16 v[126:129], v[174:177], a[104:107], v[126:129]
buffer_load_dwordx4 v216, s[4:7], s40 offen nt lds
v_mfma_f32_16x16x32_bf16 v[138:141], a[16:19], v[182:185], v[138:141]
v_fma_f32 v223, v67, v134, v135
v_fma_f32 v220, v60, v134, v135
v_mfma_f32_16x16x32_bf16 v[138:141], a[20:23], v[186:189], v[138:141]
v_exp_f32_e64 v160, v160
v_mfma_f32_16x16x32_bf16 v[142:145], a[40:43], v[182:185], v[142:145]
s_add_u32 m0, s45, 28784
v_cvt_pk_bf16_f32 v90, v220, v221
v_fma_f32 v221, v65, v134, v135
v_mfma_f32_16x16x32_bf16 v[142:145], a[44:47], v[186:189], v[142:145]
v_fma_f32 v220, v64, v134, v135
v_cvt_pk_bf16_f32 v102, v138, v139
v_mfma_f32_16x16x32_bf16 v[146:149], a[64:67], v[182:185], v[146:149]
s_nop 0
v_cvt_pk_bf16_f32 v92, v220, v221
v_cvt_pk_bf16_f32 v103, v140, v141
v_mfma_f32_16x16x32_bf16 v[146:149], a[68:71], v[186:189], v[146:149]
s_mov_b32 s39, s37
v_cvt_pk_bf16_f32 v93, v222, v223
v_fma_f32 v220, v68, v134, v135
v_mfma_f32_16x16x32_bf16 v[118:121], v[182:185], a[88:91], 0
ds_write_b64 v212, v[94:95] offset:26624
v_mfma_f32_16x16x32_bf16 v[118:121], v[186:189], a[92:95], v[118:121]
s_add_u32 s40, s36, 1373568
v_exp_f32_e64 v158, v158
v_mfma_f32_16x16x32_bf16 v[118:121], v[174:177], a[80:83], v[118:121]
buffer_load_dwordx4 v216, s[4:7], s40 offen nt lds
v_mfma_f32_16x16x32_bf16 v[118:121], v[178:181], a[84:87], v[118:121]
v_cvt_pk_bf16_f32 v132, v170, v171
v_fma_f32 v222, v70, v134, v135
v_mfma_f32_16x16x16_bf16 v[138:141], v[82:83], v[76:77], 0
ds_write_b128 v211, v[90:93] offset:32768
v_mfma_f32_16x16x32_bf16 v[150:153], v[108:111], v[72:75], v[150:153]
v_cvt_pk_bf16_f32 v107, v148, v149
v_fma_f32 v223, v71, v134, v135
v_mfma_f32_16x16x32_bf16 v[138:141], v[78:81], v[72:75], v[138:141]
v_fma_f32 v221, v69, v134, v135
v_cvt_pk_bf16_f32 v95, v222, v223
v_mfma_f32_16x16x32_bf16 v[90:93], a[232:235], v[182:185], 0
v_cvt_pk_bf16_f32 v105, v144, v145
v_cvt_pk_bf16_f32 v106, v146, v147
v_mfma_f32_16x16x32_bf16 v[170:173], v[224:227], v[182:185], 0
v_exp_f32_e64 v140, v140
v_mfma_f32_16x16x32_bf16 v[170:173], v[228:231], v[186:189], v[170:173]
v_cvt_pk_bf16_f32 v94, v220, v221
v_cvt_pk_bf16_f32 v104, v142, v143
v_mfma_f32_16x16x32_bf16 v[170:173], a[248:251], v[174:177], v[170:173]
s_add_u32 m0, s45, 32896
v_cvt_pk_bf16_f32 v117, v164, v165
v_cvt_pk_bf16_f32 v116, v162, v163
v_mfma_f32_16x16x32_bf16 v[134:137], v[182:185], a[136:139], 0
s_add_u32 s40, s36, 1569792
v_exp_f32 v141, v141
v_mfma_f32_16x16x32_bf16 v[134:137], v[186:189], a[140:143], v[134:137]
buffer_load_dwordx4 v216, s[4:7], s40 offen nt lds
v_mfma_f32_16x16x32_bf16 v[220:223], v[248:251], v[182:185], 0
v_exp_f32 v155, v155
v_mfma_f32_16x16x32_bf16 v[220:223], v[252:255], v[186:189], v[220:223]
v_exp_f32 v156, v156
v_mfma_f32_16x16x32_bf16 v[220:223], v[240:243], v[174:177], v[220:223]
v_exp_f32 v150, v150
v_mfma_f32_16x16x32_bf16 v[90:93], a[236:239], v[186:189], v[90:93]
v_exp_f32 v166, v166
v_mfma_f32_16x16x32_bf16 v[90:93], a[224:227], v[174:177], v[90:93]
ds_write_b64 v212, v[94:95] offset:32768
v_mfma_f32_16x16x16_bf16 v[142:145], v[100:101], v[76:77], 0
v_exp_f32 v157, v157
v_exp_f32 v159, v159
v_mfma_f32_16x16x32_bf16 v[126:129], v[178:181], a[108:111], v[126:129]
v_exp_f32 v139, v139
v_mfma_f32_16x16x32_bf16 v[142:145], v[96:99], v[72:75], v[142:145]
v_exp_f32_e64 v138, v138
v_mfma_f32_16x16x32_bf16 v[134:137], v[174:177], a[128:131], v[134:137]
ds_read_b128 v[182:185], v210 offset:12288
v_cvt_pk_bf16_f32 v175, v140, v141
v_mfma_f32_16x16x32_bf16 v[134:137], v[178:181], a[132:135], v[134:137]
ds_read_b128 v[186:189], v210 offset:13312
v_exp_f32 v142, v142
v_mfma_f32_16x16x16_bf16 v[146:149], v[106:107], v[76:77], 0
v_cvt_pk_bf16_f32 v174, v138, v139
v_exp_f32 v145, v145
v_mfma_f32_16x16x16_bf16 v[162:165], v[106:107], v[88:89], 0
v_exp_f32 v143, v143
v_exp_f32 v144, v144
v_mfma_f32_16x16x32_bf16 v[146:149], v[102:105], v[72:75], v[146:149]
ds_read_b128 v[72:75], v215
ds_read_b64 v[76:77], v215 offset:16
v_mfma_f32_16x16x32_bf16 v[162:165], v[102:105], v[84:87], v[162:165]
s_waitcnt lgkmcnt(3)
v_exp_f32 v154, v154
v_mfma_f32_16x16x32_bf16 v[118:121], v[182:185], a[72:75], v[118:121]
s_waitcnt lgkmcnt(2)
v_exp_f32 v149, v149
v_mfma_f32_16x16x32_bf16 v[118:121], v[186:189], a[76:79], v[118:121]
v_exp_f32 v165, v165
v_mfma_f32_16x16x32_bf16 v[134:137], v[182:185], a[120:123], v[134:137]
v_exp_f32 v146, v146
v_mfma_f32_16x16x32_bf16 v[134:137], v[186:189], a[124:127], v[134:137]
v_exp_f32_e64 v163, v163
v_mfma_f32_16x16x32_bf16 v[126:129], v[182:185], a[96:99], v[126:129]
v_cvt_pk_bf16_f32 v176, v142, v143
v_cvt_pk_bf16_f32 v118, v118, v119
v_mfma_f32_16x16x32_bf16 v[126:129], v[186:189], a[100:103], v[126:129]
v_exp_f32_e64 v148, v148
v_mfma_f32_16x16x32_bf16 v[170:173], a[252:255], v[178:181], v[170:173]
v_cvt_pk_bf16_f32 v119, v120, v121
v_cvt_pk_bf16_f32 v134, v134, v135
v_mfma_f32_16x16x32_bf16 v[220:223], v[244:247], v[178:181], v[220:223]
v_cvt_pk_bf16_f32 v126, v126, v127
v_cvt_pk_bf16_f32 v135, v136, v137
v_cvt_pk_bf16_f32 v177, v144, v145
v_cvt_pk_bf16_f32 v127, v128, v129
v_mfma_f32_16x16x32_bf16 v[220:223], v[232:235], v[182:185], v[220:223]
ds_read_u16 v128, v205 offset:32
ds_read_u16 v120, v205
v_mfma_f32_16x16x32_bf16 v[90:93], a[228:231], v[178:181], v[90:93]
v_exp_f32_e64 v147, v147
v_cvt_pk_bf16_f32 v180, v150, 0
v_mfma_f32_16x16x32_bf16 v[90:93], a[216:219], v[182:185], v[90:93]
v_mov_b32 v181, 0
v_mov_b32 v129, 0
v_mfma_f32_16x16x32_bf16 v[90:93], a[220:223], v[186:189], v[90:93]
v_cvt_pk_bf16_f32 v178, v146, v147
v_cvt_pk_bf16_f32 v179, v148, v149
v_mfma_f32_16x16x32_bf16 v[150:153], v[190:193], v[174:177], 0
s_add_u32 s28, s38, s60
v_exp_f32 v162, v162
v_mfma_f32_16x16x32_bf16 v[150:153], v[190:193], v[178:181], v[150:153]
ds_read_u16 v136, v205 offset:64
v_mov_b32_e64 v121, 0
v_mfma_f32_16x16x32_bf16 v[138:141], v[114:117], v[174:177], 0
s_waitcnt lgkmcnt(1)
v_exp_f32 v164, v164
v_mfma_f32_16x16x32_bf16 v[138:141], v[118:121], v[178:181], v[138:141]
v_rcp_f32 v151, v150
v_mfma_f32_16x16x32_bf16 v[142:145], v[122:125], v[174:177], 0
v_mov_b32 v137, 0
v_mul_f32_e64 v152, s3, v151
v_mfma_f32_16x16x32_bf16 v[142:145], v[126:129], v[178:181], v[142:145]
v_mul_f32_e64 v139, v139, v152
v_mul_f32 v138, v138, v152
v_mfma_f32_16x16x32_bf16 v[146:149], v[130:133], v[174:177], 0
s_waitcnt lgkmcnt(0)
v_cvt_pk_bf16_f32 v174, v154, v155
v_cvt_pk_bf16_f32 v90, v90, v91
v_cvt_pk_bf16_f32 v91, v92, v93
v_cvt_pk_bf16_f32 v175, v156, v157
v_mfma_f32_16x16x32_bf16 v[146:149], v[134:137], v[178:181], v[146:149]
v_cvt_pk_bf16_f32 v176, v158, v159
v_cvt_pk_bf16_f32 v178, v162, v163
v_mfma_f32_16x16x32_bf16 v[220:223], v[236:239], v[186:189], v[220:223]
v_cvt_pk_bf16_f32 v138, v138, v139
v_mul_f32_e64 v145, v145, v152
v_cvt_pk_bf16_f32 v177, v160, v161
v_mul_f32_e64 v141, v141, v152
v_cvt_pk_bf16_f32 v179, v164, v165
v_mul_f32_e64 v149, v149, v152
v_mfma_f32_16x16x32_bf16 v[170:173], a[240:243], v[182:185], v[170:173]
v_mul_f32_e64 v142, v142, v152
v_cvt_pk_bf16_f32 v180, v166, 0
v_mfma_f32_16x16x32_bf16 v[170:173], a[244:247], v[186:189], v[170:173]
v_mul_f32 v148, v148, v152
v_mul_f32 v147, v147, v152
v_mfma_f32_16x16x32_bf16 v[166:169], v[190:193], v[174:177], 0
v_mul_f32 v144, v144, v152
v_mul_f32 v140, v140, v152
v_mfma_f32_16x16x32_bf16 v[166:169], v[190:193], v[178:181], v[166:169]
v_mul_f32 v146, v146, v152
v_mul_f32 v143, v143, v152
v_mfma_f32_16x16x32_bf16 v[158:161], v[122:125], v[174:177], 0
v_cvt_pk_bf16_f32 v95, v222, v223
v_cvt_pk_bf16_f32 v139, v140, v141
v_mfma_f32_16x16x32_bf16 v[158:161], v[126:129], v[178:181], v[158:161]
v_cvt_pk_bf16_f32 v140, v142, v143
v_cvt_pk_bf16_f32 v141, v144, v145
v_mfma_f32_16x16x32_bf16 v[162:165], v[130:133], v[174:177], 0
ds_write_b128 v211, v[138:141] offset:38912
v_mfma_f32_16x16x32_bf16 v[162:165], v[134:137], v[178:181], v[162:165]
v_max3_u32 v218, v218, v150, v151
v_rcp_f32_e64 v167, v166
v_mfma_f32_16x16x32_bf16 v[154:157], v[114:117], v[174:177], 0
v_cvt_pk_bf16_f32 v94, v220, v221
v_cvt_pk_bf16_f32 v142, v146, v147
v_cvt_pk_bf16_f32 v92, v170, v171
v_mfma_f32_16x16x32_bf16 v[154:157], v[118:121], v[178:181], v[154:157]
v_cvt_pk_bf16_f32 v93, v172, v173
v_mul_f32 v168, s3, v167
v_mul_f32 v164, v164, v168
v_mfma_f32_16x16x32_bf16 v[138:141], v[78:81], v[90:93], 0
v_cvt_pk_bf16_f32 v143, v148, v149
v_mul_f32_e64 v162, v162, v168
v_mfma_f32_16x16x32_bf16 v[150:153], v[108:111], v[90:93], v[206:209]
ds_write_b64 v212, v[142:143] offset:38912
v_mfma_f32_16x16x32_bf16 v[142:145], v[96:99], v[90:93], 0
v_mul_f32 v159, v159, v168
v_mul_f32 v155, v155, v168
v_mul_f32 v160, v160, v168
v_mul_f32 v163, v163, v168
v_mfma_f32_16x16x32_bf16 v[146:149], v[102:105], v[90:93], 0
v_mul_f32 v154, v154, v168
v_mul_f32 v157, v157, v168
v_mul_f32_e64 v156, v156, v168
v_cvt_pk_bf16_f32 v154, v154, v155
v_mfma_f32_16x16x16_bf16 v[142:145], v[100:101], v[94:95], v[142:145]
v_mul_f32 v161, v161, v168
v_mul_f32 v158, v158, v168
v_mul_f32_e64 v165, v165, v168
v_mfma_f32_16x16x16_bf16 v[146:149], v[106:107], v[94:95], v[146:149]
v_cvt_pk_bf16_f32 v155, v156, v157
v_cvt_pk_bf16_f32 v156, v158, v159
v_cvt_pk_bf16_f32 v159, v164, v165
v_mfma_f32_16x16x16_bf16 v[150:153], v[112:113], v[94:95], v[150:153]
v_cvt_pk_bf16_f32 v157, v160, v161
v_cvt_pk_bf16_f32 v158, v162, v163
v_exp_f32 v142, v142
v_mfma_f32_16x16x32_bf16 v[162:165], v[72:75], v[102:105], 0
ds_write_b64 v212, v[158:159] offset:45056
v_mfma_f32_16x16x16_bf16 v[138:141], v[82:83], v[94:95], v[138:141]
v_exp_f32 v144, v144
v_exp_f32 v143, v143
v_exp_f32 v148, v148
v_exp_f32 v149, v149
v_mfma_f32_16x16x32_bf16 v[158:161], v[72:75], v[96:99], 0
ds_write_b128 v211, v[154:157] offset:45056
v_exp_f32 v145, v145
v_mfma_f32_16x16x16_bf16 v[162:165], v[76:77], v[106:107], v[162:165]
v_cvt_pk_bf16_f32 v176, v142, v143
v_exp_f32_e64 v141, v141
v_cvt_pk_bf16_f32 v179, v148, v149
v_mfma_f32_16x16x32_bf16 v[154:157], v[72:75], v[78:81], 0
v_cvt_pk_bf16_f32 v177, v144, v145
v_exp_f32 v139, v139
v_exp_f32 v140, v140
v_mfma_f32_16x16x16_bf16 v[158:161], v[76:77], v[100:101], v[158:161]
v_exp_f32 v138, v138
v_exp_f32 v146, v146
v_mfma_f32_16x16x16_bf16 v[154:157], v[76:77], v[82:83], v[154:157]
v_cvt_pk_bf16_f32 v174, v138, v139
v_cvt_pk_bf16_f32 v175, v140, v141
v_exp_f32_e64 v147, v147
v_mfma_f32_16x16x32_bf16 v[142:145], v[122:125], v[174:177], 0
v_exp_f32 v150, v150
v_mfma_f32_16x16x32_bf16 v[138:141], v[114:117], v[174:177], 0
s_waitcnt lgkmcnt(0)
v_cvt_pk_bf16_f32 v178, v146, v147
v_cvt_pk_bf16_f32 v180, v150, 0
v_mfma_f32_16x16x32_bf16 v[150:153], v[190:193], v[174:177], 0
s_barrier
ds_read_b128 v[220:223], v210 offset:38912
v_mfma_f32_16x16x32_bf16 v[150:153], v[190:193], v[178:181], v[150:153]
ds_read_b128 v[110:113], v210 offset:39936
v_mfma_f32_16x16x32_bf16 v[138:141], v[118:121], v[178:181], v[138:141]
v_max3_u32 v218, v218, v166, v167
v_mfma_f32_16x16x32_bf16 v[142:145], v[126:129], v[178:181], v[142:145]
v_rcp_f32 v151, v150
v_mfma_f32_16x16x32_bf16 v[146:149], v[130:133], v[174:177], 0
ds_read_b128 v[182:185], v210 offset:41984
ds_read_b128 v[170:173], v210 offset:40960
v_mfma_f32_16x16x32_bf16 v[146:149], v[134:137], v[178:181], v[146:149]
s_nop 0
ds_read_b32 v166, v215 offset:536
s_waitcnt lgkmcnt(4)
v_mfma_f32_16x16x32_bf16 v[8:11], a[192:195], v[220:223], v[8:11]
v_mul_f32 v152, s3, v151
s_waitcnt lgkmcnt(3)
v_mfma_f32_16x16x32_bf16 v[8:11], a[196:199], v[110:113], v[8:11]
ds_read_b128 v[186:189], v210 offset:43008
v_mfma_f32_16x16x32_bf16 v[4:7], a[168:171], v[220:223], v[4:7]
v_mov_b32_dpp v154, v158 quad_perm:[0,1,2,3] row_mask:0x2 bank_mask:0xf
v_mul_f32_e64 v138, v138, v152
v_mfma_f32_16x16x32_bf16 v[4:7], a[172:175], v[110:113], v[4:7]
v_mul_f32 v147, v147, v152
v_mfma_f32_16x16x32_bf16 v[0:3], a[144:147], v[220:223], v[0:3]
ds_read_b128 v[220:223], v210 offset:44032
v_mov_b32_dpp v154, v162 quad_perm:[0,1,2,3] row_mask:0x4 bank_mask:0xf
v_mfma_f32_16x16x32_bf16 v[0:3], a[148:151], v[110:113], v[0:3]
s_waitcnt lgkmcnt(2)
v_add_f32_dpp v154, v166, v207 quad_perm:[0,1,2,3] row_mask:0x8 bank_mask:0xf
v_mul_f32_e64 v145, v145, v152
v_mfma_f32_16x16x32_bf16 v[0:3], a[152:155], v[170:173], v[0:3]
v_mul_f32 v140, v140, v152
v_mul_f32 v142, v142, v152
v_mfma_f32_16x16x32_bf16 v[0:3], a[156:159], v[182:185], v[0:3]
ds_read_b128 v[110:113], v210 offset:45056
v_mul_f32_e64 v149, v149, v152
v_mfma_f32_16x16x32_bf16 v[4:7], a[176:179], v[170:173], v[4:7]
v_mul_f32 v144, v144, v152
v_mul_f32 v139, v139, v152
v_mfma_f32_16x16x32_bf16 v[4:7], a[180:183], v[182:185], v[4:7]
v_exp_f32 v166, v154
v_mfma_f32_16x16x32_bf16 v[8:11], a[200:203], v[170:173], v[8:11]
ds_read_b128 v[170:173], v210 offset:46080
v_cvt_pk_bf16_f32 v154, v166, 0
v_mfma_f32_16x16x32_bf16 v[8:11], a[204:207], v[182:185], v[8:11]
s_waitcnt lgkmcnt(3)
v_cvt_pk_bf16_f32 v138, v138, v139
v_mul_f32_e64 v141, v141, v152
v_mfma_f32_16x16x32_bf16 v[8:11], a[208:211], v[186:189], v[8:11]
s_waitcnt lgkmcnt(2)
v_mul_f32 v146, v146, v152
v_add_u32 v205, 1424, v205
v_mfma_f32_16x16x32_bf16 v[8:11], a[212:215], v[220:223], v[8:11]
ds_write_b16 v214, v154
v_mfma_f32_16x16x32_bf16 v[4:7], a[184:187], v[186:189], v[4:7]
ds_read_b128 v[88:91], v215 offset:16
v_mul_f32_e64 v148, v148, v152
v_mfma_f32_16x16x32_bf16 v[4:7], a[188:191], v[220:223], v[4:7]
ds_read_b128 v[174:177], v217
v_cvt_pk_bf16_f32 v139, v140, v141
v_mfma_f32_16x16x32_bf16 v[0:3], a[160:163], v[186:189], v[0:3]
ds_read_b128 v[186:189], v210 offset:48128
ds_read_b128 v[182:185], v210 offset:47104
v_mfma_f32_16x16x32_bf16 v[0:3], a[164:167], v[220:223], v[0:3]
v_mul_f32_e64 v143, v143, v152
s_waitcnt lgkmcnt(6)
v_mfma_f32_16x16x32_bf16 v[12:15], a[144:147], v[110:113], v[12:15]
s_waitcnt lgkmcnt(5)
ds_read_b128 v[220:223], v210 offset:49152
v_cvt_pk_bf16_f32 v141, v144, v145
v_mfma_f32_16x16x32_bf16 v[12:15], a[148:151], v[170:173], v[12:15]
v_cvt_pk_bf16_f32 v140, v142, v143
v_cvt_pk_bf16_f32 v143, v148, v149
v_mfma_f32_16x16x32_bf16 v[16:19], a[168:171], v[110:113], v[16:19]
ds_write_b128 v211, v[138:141] offset:51200
v_mfma_f32_16x16x32_bf16 v[16:19], a[172:175], v[170:173], v[16:19]
v_add_f32_dpp v166, v166, v166 row_ror:8 row_mask:0xf bank_mask:0xf
v_cvt_pk_bf16_f32 v0, v0, v1
v_mfma_f32_16x16x32_bf16 v[20:23], a[192:195], v[110:113], v[20:23]
s_nop 0
v_add_f32_dpp v166, v166, v166 row_ror:4 row_mask:0xf bank_mask:0xf
v_cvt_pk_bf16_f32 v142, v146, v147
v_mfma_f32_16x16x32_bf16 v[20:23], a[196:199], v[170:173], v[20:23]
s_waitcnt lgkmcnt(2)
ds_read_b128 v[110:113], v210 offset:50176
ds_read_b128 v[84:87], v215
v_mfma_f32_16x16x32_bf16 v[20:23], a[200:203], v[182:185], v[20:23]
v_add_u32 v215, 1424, v215
v_add_f32_dpp v166, v166, v166 row_ror:2 row_mask:0xf bank_mask:0xf
v_mfma_f32_16x16x32_bf16 v[20:23], a[204:207], v[186:189], v[20:23]
ds_write_b64 v212, v[142:143] offset:51200
v_mfma_f32_16x16x32_bf16 v[16:19], a[176:179], v[182:185], v[16:19]
v_add_f32_dpp v166, v166, v166 row_ror:1 row_mask:0xf bank_mask:0xf
v_cvt_pk_bf16_f32 v8, v8, v9
v_mfma_f32_16x16x32_bf16 v[16:19], a[180:183], v[186:189], v[16:19]
ds_read_b128 v[178:181], v217 offset:528
v_cvt_pk_bf16_f32 v9, v10, v11
v_mfma_f32_16x16x32_bf16 v[12:15], a[152:155], v[182:185], v[12:15]
v_cvt_pk_bf16_f32 v1, v2, v3
v_cvt_pk_bf16_f32 v4, v4, v5
v_mfma_f32_16x16x32_bf16 v[12:15], a[156:159], v[186:189], v[12:15]
s_waitcnt lgkmcnt(5)
ds_write_b64 v203, v[8:9] offset:64
v_mfma_f32_16x16x32_bf16 v[12:15], a[160:163], v[220:223], v[12:15]
v_cvt_pk_bf16_f32 v5, v6, v7
s_waitcnt lgkmcnt(4)
v_mfma_f32_16x16x32_bf16 v[12:15], a[164:167], v[110:113], v[12:15]
s_waitcnt vmcnt(0) lgkmcnt(2)
ds_write_b64 v203, v[4:5] offset:32
v_mfma_f32_16x16x32_bf16 v[162:165], v[84:87], v[130:133], 0
s_barrier
v_mfma_f32_16x16x32_bf16 v[162:165], v[88:91], v[134:137], v[162:165]
ds_read_b128 v[186:189], v210 offset:53248
v_add_f32_dpp v166, v166, v166 row_bcast:15 row_mask:0xa bank_mask:0xf
v_mfma_f32_16x16x32_bf16 v[154:157], v[84:87], v[114:117], 0
ds_read_b128 v[182:185], v210 offset:52224
ds_read_b128 v[92:95], v201
v_mfma_f32_16x16x32_bf16 v[154:157], v[88:91], v[118:121], v[154:157]
ds_read_b128 v[170:173], v210 offset:51200
v_mfma_f32_16x16x32_bf16 v[158:161], v[84:87], v[122:125], 0
ds_read_b128 v[96:99], v195 offset:16
v_add_f32_dpp v166, v166, v166 row_bcast:31 row_mask:0xc bank_mask:0xf
v_mfma_f32_16x16x32_bf16 v[158:161], v[88:91], v[126:129], v[158:161]
v_mfma_f32_16x16x32_bf16 v[16:19], a[184:187], v[220:223], v[16:19]
ds_read_b128 v[84:87], v200
v_cvt_pk_bf16_f32 v12, v12, v13
v_mfma_f32_16x16x32_bf16 v[16:19], a[188:191], v[110:113], v[16:19]
v_cvt_pk_bf16_f32 v13, v14, v15
v_mfma_f32_16x16x32_bf16 v[20:23], a[208:211], v[220:223], v[20:23]
s_nop 0
ds_write_b64 v203, v[0:1]
v_mfma_f32_16x16x32_bf16 v[20:23], a[212:215], v[110:113], v[20:23]
s_waitcnt lgkmcnt(3)
v_mov_b32_dpp v154, v158 quad_perm:[0,1,2,3] row_mask:0x2 bank_mask:0xf
v_cvt_pk_bf16_f32 v16, v16, v17
v_mfma_f32_16x16x32_bf16 v[28:31], a[168:171], v[170:173], v[28:31]
ds_read_b128 v[220:223], v210 offset:54272
ds_read_b128 v[110:113], v210 offset:55296
v_mfma_f32_16x16x32_bf16 v[24:27], a[144:147], v[170:173], v[24:27]
s_nop 0
ds_write_b64 v203, v[12:13] offset:6272
v_mfma_f32_16x16x32_bf16 v[12:15], v[174:177], v[92:95], 0
s_waitcnt lgkmcnt(4)
v_readlane_b32 s72, v166, 63
v_cvt_pk_bf16_f32 v20, v20, v21
v_mfma_f32_16x16x32_bf16 v[0:3], v[174:177], v[84:87], 0
ds_read_b128 v[92:95], v195
v_mfma_f32_16x16x32_bf16 v[32:35], a[192:195], v[170:173], v[32:35]
ds_read_b128 v[84:87], v194
v_mfma_f32_16x16x32_bf16 v[32:35], a[196:199], v[182:185], v[32:35]
ds_read_b128 v[170:173], v210 offset:56320
v_mov_b32_dpp v154, v162 quad_perm:[0,1,2,3] row_mask:0x4 bank_mask:0xf
v_mfma_f32_16x16x32_bf16 v[32:35], a[200:203], v[186:189], v[32:35]
ds_read_b128 v[88:91], v194 offset:16
ds_read_b128 v[100:103], v202
v_mfma_f32_16x16x32_bf16 v[28:31], a[172:175], v[182:185], v[28:31]
v_cvt_pk_bf16_f32 v17, v18, v19
v_cvt_pk_bf16_f32 v21, v22, v23
v_mfma_f32_16x16x32_bf16 v[28:31], a[176:179], v[186:189], v[28:31]
ds_write_b64 v203, v[20:21] offset:6336
v_mfma_f32_16x16x32_bf16 v[24:27], a[148:151], v[182:185], v[24:27]
v_rcp_f32_e64 v167, s72
v_mfma_f32_16x16x32_bf16 v[24:27], a[152:155], v[186:189], v[24:27]
s_waitcnt lgkmcnt(8)
ds_write_b64 v203, v[16:17] offset:6304
v_mfma_f32_16x16x32_bf16 v[24:27], a[156:159], v[220:223], v[24:27]
s_waitcnt lgkmcnt(8)
v_max3_u32 v218, v218, s72, v167
v_max3_u32 v218, v218, v150, v151
v_mfma_f32_16x16x32_bf16 v[24:27], a[160:163], v[110:113], v[24:27]
s_waitcnt lgkmcnt(4)
ds_read_b128 v[182:185], v210 offset:20480
v_mul_f32 v168, s3, v167
v_mfma_f32_16x16x32_bf16 v[24:27], a[164:167], v[170:173], v[24:27]
s_nop 0
ds_read_b128 v[186:189], v210 offset:21504
s_waitcnt lgkmcnt(5)
v_smfmac_f32_16x16x64_bf16 v[0:3], v[178:181], v[84:91], v213
ds_read_b128 v[104:107], v196 offset:16
ds_read_b128 v[84:87], v197
v_smfmac_f32_16x16x64_bf16 v[12:15], v[178:181], v[92:99], v213
ds_read_b128 v[92:95], v198
ds_read_b128 v[88:91], v197 offset:16
v_mfma_f32_16x16x32_bf16 v[32:35], a[204:207], v[220:223], v[32:35]
s_nop 0
v_cvt_pk_bf16_f32 v24, v24, v25
v_cvt_pk_bf16_f32 v25, v26, v27
v_mfma_f32_16x16x32_bf16 v[32:35], a[208:211], v[110:113], v[32:35]
s_waitcnt lgkmcnt(8)
ds_write_b64 v203, v[24:25] offset:12544
v_mfma_f32_16x16x32_bf16 v[32:35], a[212:215], v[170:173], v[32:35]
s_add_u32 s29, s38, s61
v_mul_f32 v154, v154, v168
v_cvt_pk_bf16_f32 v154, v154, 0
v_mfma_f32_16x16x32_bf16 v[24:27], v[174:177], v[100:103], 0
ds_read_b128 v[174:177], v217 offset:1056
v_mfma_f32_16x16x32_bf16 v[28:31], a[180:183], v[220:223], v[28:31]
v_cvt_pk_bf16_f32 v32, v32, v33
v_cvt_pk_bf16_f32 v33, v34, v35
v_mfma_f32_16x16x32_bf16 v[28:31], a[184:187], v[110:113], v[28:31]
ds_read_b128 v[100:103], v196
ds_read_b128 v[96:99], v198 offset:16
v_mfma_f32_16x16x32_bf16 v[28:31], a[188:191], v[170:173], v[28:31]
s_waitcnt lgkmcnt(9)
ds_write_b16 v214, v154
v_mfma_f32_16x16x32_bf16 v[138:141], a[0:3], v[182:185], 0
s_waitcnt lgkmcnt(9)
ds_write_b64 v203, v[32:33] offset:12608
v_mfma_f32_16x16x32_bf16 v[138:141], a[4:7], v[186:189], v[138:141]
s_nop 0
v_cvt_pk_bf16_f32 v28, v28, v29
v_cvt_pk_bf16_f32 v29, v30, v31
v_mfma_f32_16x16x32_bf16 v[146:149], a[48:51], v[182:185], 0
s_waitcnt lgkmcnt(4)
ds_write_b64 v203, v[28:29] offset:12576
v_smfmac_f32_16x16x64_bf16 v[0:3], v[174:177], v[84:91], v213
s_waitcnt lgkmcnt(4)
v_smfmac_f32_16x16x64_bf16 v[24:27], v[178:181], v[100:107], v213
s_waitcnt lgkmcnt(3)
ds_read_b128 v[104:107], v199 offset:16
ds_read_b128 v[84:87], v200 offset:32
v_smfmac_f32_16x16x64_bf16 v[12:15], v[174:177], v[92:99], v213
ds_read_b128 v[100:103], v199
ds_read_b128 v[178:181], v217 offset:1584
v_mfma_f32_16x16x32_bf16 v[150:153], a[216:219], v[182:185], 0
v_mul_f32 v119, v0, v0
v_add_f32 v118, v0, v1
v_mfma_f32_16x16x32_bf16 v[150:153], a[220:223], v[186:189], v[150:153]
ds_read_b128 v[92:95], v201 offset:32
v_fmac_f32_e64 v119, v1, v1
v_mfma_f32_16x16x32_bf16 v[158:161], v[232:235], v[182:185], 0
ds_read_b128 v[110:113], v210 offset:22528
v_add_f32 v118, v118, v2
v_mfma_f32_16x16x32_bf16 v[158:161], v[236:239], v[186:189], v[158:161]
s_waitcnt lgkmcnt(6)
ds_read_b128 v[88:91], v194 offset:48
v_add_f32_e64 v126, v12, v13
v_mfma_f32_16x16x32_bf16 v[154:157], a[240:243], v[182:185], 0
s_barrier
v_mfma_f32_16x16x32_bf16 v[154:157], a[244:247], v[186:189], v[154:157]
s_waitcnt lgkmcnt(4)
ds_read_b64 v[120:121], v204
ds_read_b64 v[128:129], v204 offset:392
v_smfmac_f32_16x16x64_bf16 v[24:27], v[174:177], v[100:107], v213
s_waitcnt lgkmcnt(5)
ds_read_b128 v[100:103], v202 offset:32
ds_read_b128 v[96:99], v195 offset:48
v_mfma_f32_16x16x32_bf16 v[4:7], v[178:181], v[84:87], 0
s_waitcnt lgkmcnt(6)
ds_read_b128 v[84:87], v194 offset:32
ds_read_b128 v[174:177], v217 offset:2112
v_mfma_f32_16x16x32_bf16 v[16:19], v[178:181], v[92:95], 0
ds_read_b128 v[92:95], v195 offset:32
v_add_f32_e64 v126, v126, v14
v_mfma_f32_16x16x32_bf16 v[170:173], v[182:185], a[120:123], 0
v_mul_f32_e64 v135, v24, v24
v_mul_f32 v127, v12, v12
v_mfma_f32_16x16x32_bf16 v[170:173], v[186:189], a[124:127], v[170:173]
s_waitcnt lgkmcnt(6)
buffer_store_dwordx2 v[120:121], v204, s[8:11], s28 offen sc1
v_fmac_f32 v119, v2, v2
v_mfma_f32_16x16x32_bf16 v[170:173], v[110:113], a[128:131], v[170:173]
s_waitcnt lgkmcnt(4)
ds_read_b128 v[104:107], v196 offset:48
v_add_f32_e64 v134, v24, v25
v_mfma_f32_16x16x32_bf16 v[28:31], v[178:181], v[100:103], 0
ds_read_b128 v[100:103], v196 offset:32
ds_read_b64 v[136:137], v204 offset:784
v_mfma_f32_16x16x32_bf16 v[146:149], a[52:55], v[186:189], v[146:149]
s_nop 0
ds_read_b128 v[178:181], v217 offset:2640
ds_read_b64 v[120:121], v204 offset:1176
v_mfma_f32_16x16x32_bf16 v[146:149], a[56:59], v[110:113], v[146:149]
s_waitcnt lgkmcnt(6)
buffer_store_dwordx2 v[128:129], v204, s[8:11], s29 offen sc1
v_fmac_f32 v119, v3, v3
v_smfmac_f32_16x16x64_bf16 v[4:7], v[174:177], v[84:91], v213
s_waitcnt lgkmcnt(5)
ds_read_b128 v[88:91], v197 offset:48
v_add_f32 v134, v134, v26
v_mfma_f32_16x16x32_bf16 v[150:153], a[224:227], v[110:113], v[150:153]
s_add_u32 s28, s38, s62
ds_read_b128 v[84:87], v197 offset:32
v_fmac_f32 v127, v13, v13
v_smfmac_f32_16x16x64_bf16 v[16:19], v[174:177], v[92:99], v213
s_waitcnt lgkmcnt(5)
ds_read_b128 v[92:95], v198 offset:32
ds_read_b128 v[96:99], v198 offset:48
v_smfmac_f32_16x16x64_bf16 v[28:31], v[174:177], v[100:107], v213
ds_read_b128 v[104:107], v199 offset:48
v_add_f32_e64 v126, v126, v15
v_mfma_f32_16x16x32_bf16 v[142:145], a[24:27], v[182:185], 0
ds_read_b128 v[100:103], v199 offset:32
v_fmac_f32 v135, v25, v25
v_mfma_f32_16x16x32_bf16 v[142:145], a[28:31], v[186:189], v[142:145]
s_add_u32 s29, s38, s63
ds_read_b128 v[220:223], v210 offset:23552
v_add_f32 v118, v118, v3
v_mfma_f32_16x16x32_bf16 v[142:145], a[32:35], v[110:113], v[142:145]
s_waitcnt lgkmcnt(9)
buffer_store_dwordx2 v[136:137], v204, s[8:11], s28 offen sc1
v_fmac_f32 v135, v26, v26
v_mfma_f32_16x16x32_bf16 v[138:141], a[8:11], v[110:113], v[138:141]
s_waitcnt lgkmcnt(5)
ds_read_b64 v[128:129], v204 offset:6272
v_fmac_f32 v127, v14, v14
v_smfmac_f32_16x16x64_bf16 v[4:7], v[178:181], v[84:91], v213
s_waitcnt lgkmcnt(4)
ds_read_b128 v[174:177], v217 offset:3168
v_fmac_f32_e64 v135, v27, v27
v_smfmac_f32_16x16x64_bf16 v[16:19], v[178:181], v[92:99], v213
ds_read_b128 v[92:95], v201 offset:64
ds_read_b128 v[84:87], v200 offset:64
v_mfma_f32_16x16x32_bf16 v[162:165], v[182:185], a[72:75], 0
ds_read_b128 v[96:99], v195 offset:80
v_fmac_f32 v127, v15, v15
v_mfma_f32_16x16x32_bf16 v[162:165], v[186:189], a[76:79], v[162:165]
s_waitcnt lgkmcnt(6)
buffer_store_dwordx2 v[120:121], v204, s[8:11], s29 offen sc1
v_fmac_f32 v127, v16, v16
v_smfmac_f32_16x16x64_bf16 v[28:31], v[178:181], v[100:107], v213
ds_read_b128 v[100:103], v202 offset:64
ds_read_b128 v[178:181], v217 offset:3696
v_mfma_f32_16x16x32_bf16 v[154:157], a[248:251], v[110:113], v[154:157]
s_waitcnt lgkmcnt(7)
ds_read_b64 v[120:121], v204 offset:7056
ds_read_b128 v[88:91], v194 offset:80
v_mfma_f32_16x16x32_bf16 v[154:157], a[252:255], v[220:223], v[154:157]
s_waitcnt lgkmcnt(6)
v_add_f32 v134, v134, v27
v_add_f32_e64 v126, v126, v16
v_mfma_f32_16x16x32_bf16 v[158:161], v[240:243], v[110:113], v[158:161]
s_add_u32 s28, s38, s64
v_add_f32 v126, v126, v17
v_fmac_f32_e64 v135, v28, v28
v_mfma_f32_16x16x32_bf16 v[20:23], v[174:177], v[92:95], 0
s_waitcnt lgkmcnt(5)
buffer_store_dwordx2 v[128:129], v204, s[8:11], s28 offen sc1
ds_read_b64 v[136:137], v204 offset:6664
v_mfma_f32_16x16x32_bf16 v[138:141], a[12:15], v[220:223], v[138:141]
s_add_u32 s29, s38, s65
ds_read_b128 v[92:95], v195 offset:64
ds_read_b64 v[128:129], v204 offset:7448
v_mfma_f32_16x16x32_bf16 v[8:11], v[174:177], v[84:87], 0
s_waitcnt lgkmcnt(6)
ds_read_b128 v[84:87], v194 offset:64
v_add_f32 v134, v134, v28
v_mfma_f32_16x16x32_bf16 v[32:35], v[174:177], v[100:103], 0
ds_read_b128 v[104:107], v196 offset:80
v_fmac_f32_e64 v127, v17, v17
v_mfma_f32_16x16x32_bf16 v[166:169], v[182:185], a[96:99], 0
ds_read_b128 v[182:185], v210 offset:24576
v_add_f32_e64 v118, v118, v4
v_mfma_f32_16x16x32_bf16 v[166:169], v[186:189], a[100:103], v[166:169]
s_add_u32 s28, s38, s66
v_fmac_f32 v127, v18, v18
v_fmac_f32 v135, v29, v29
v_mfma_f32_16x16x32_bf16 v[166:169], v[110:113], a[104:107], v[166:169]
s_waitcnt lgkmcnt(5)
buffer_store_dwordx2 v[136:137], v204, s[8:11], s29 offen sc1
ds_read_b128 v[100:103], v196 offset:64
v_mfma_f32_16x16x32_bf16 v[166:169], v[220:223], a[108:111], v[166:169]
ds_read_b128 v[186:189], v210 offset:25600
v_fmac_f32_e64 v135, v30, v30
v_mfma_f32_16x16x32_bf16 v[162:165], v[110:113], a[80:83], v[162:165]
ds_read_b64 v[136:137], v204 offset:12544
v_fmac_f32 v119, v4, v4
v_mfma_f32_16x16x32_bf16 v[162:165], v[220:223], a[84:87], v[162:165]
s_waitcnt lgkmcnt(5)
ds_read_b128 v[174:177], v217 offset:4224
v_add_f32_e64 v118, v118, v5
v_smfmac_f32_16x16x64_bf16 v[8:11], v[178:181], v[84:91], v213
ds_read_b128 v[88:91], v197 offset:80
v_add_f32_e64 v134, v134, v29
v_mfma_f32_16x16x32_bf16 v[170:173], v[220:223], a[132:135], v[170:173]
ds_read_b128 v[84:87], v197 offset:64
v_add_f32 v118, v118, v6
v_smfmac_f32_16x16x64_bf16 v[20:23], v[178:181], v[92:99], v213
s_waitcnt lgkmcnt(5)
buffer_store_dwordx2 v[120:121], v204, s[8:11], s28 offen sc1
v_add_f32_e64 v126, v126, v18
v_smfmac_f32_16x16x64_bf16 v[32:35], v[178:181], v[100:107], v213
ds_read_b128 v[96:99], v198 offset:80
ds_read_b128 v[100:103], v199 offset:64
v_mfma_f32_16x16x32_bf16 v[158:161], v[244:247], v[220:223], v[158:161]
s_add_u32 s29, s38, s67
v_add_f32 v118, v118, v7
v_fmac_f32 v119, v5, v5
v_mfma_f32_16x16x32_bf16 v[146:149], a[60:63], v[220:223], v[146:149]
s_add_u32 s28, s38, s68
ds_read_b128 v[92:95], v198 offset:64
v_fmac_f32_e64 v135, v31, v31
v_mfma_f32_16x16x32_bf16 v[142:145], a[36:39], v[220:223], v[142:145]
s_waitcnt lgkmcnt(3)
v_fmac_f32 v119, v6, v6
v_fmac_f32_e64 v119, v7, v7
v_smfmac_f32_16x16x64_bf16 v[8:11], v[174:177], v[84:91], v213
ds_read_b128 v[104:107], v199 offset:80
ds_read_b128 v[110:113], v210 offset:26624
v_mfma_f32_16x16x32_bf16 v[150:153], a[228:231], v[220:223], v[150:153]
buffer_store_dwordx2 v[128:129], v204, s[8:11], s29 offen sc1
v_fmac_f32_e64 v127, v19, v19
v_mfma_f32_16x16x32_bf16 v[150:153], a[232:235], v[182:185], v[150:153]
v_add_f32 v134, v134, v30
v_fmac_f32 v119, v8, v8
v_mfma_f32_16x16x32_bf16 v[150:153], a[236:239], v[186:189], v[150:153]
s_waitcnt lgkmcnt(2)
v_add_f32 v126, v126, v19
v_fmac_f32_e64 v119, v9, v9
v_smfmac_f32_16x16x64_bf16 v[20:23], v[174:177], v[92:99], v213
ds_read_b128 v[220:223], v210 offset:27648
ds_read_b64 v[120:121], v204 offset:12936
v_mfma_f32_16x16x32_bf16 v[154:157], v[224:227], v[182:185], v[154:157]
s_waitcnt lgkmcnt(3)
buffer_store_dwordx2 v[136:137], v204, s[8:11], s28 offen sc1
v_add_f32 v118, v118, v8
v_smfmac_f32_16x16x64_bf16 v[32:35], v[174:177], v[100:107], v213
ds_read_b64 v[128:129], v204 offset:13328
v_fmac_f32_e64 v127, v20, v20
v_mfma_f32_16x16x32_bf16 v[142:145], a[40:43], v[182:185], v[142:145]
v_add_f32 v134, v134, v31
v_fmac_f32 v127, v21, v21
v_mfma_f32_16x16x32_bf16 v[142:145], a[44:47], v[186:189], v[142:145]
v_cvt_pk_bf16_f32 v72, v150, v151
v_add_f32_e64 v118, v118, v9
v_mfma_f32_16x16x32_bf16 v[138:141], a[16:19], v[182:185], v[138:141]
v_fmac_f32 v135, v32, v32
v_add_f32 v134, v134, v32
v_mfma_f32_16x16x32_bf16 v[138:141], a[20:23], v[186:189], v[138:141]
ds_read_b64 v[136:137], v204 offset:13720
v_add_f32_e64 v126, v126, v20
v_mfma_f32_16x16x32_bf16 v[146:149], a[64:67], v[182:185], v[146:149]
v_add_f32 v126, v126, v21
v_add_f32 v134, v134, v33
v_mfma_f32_16x16x32_bf16 v[146:149], a[68:71], v[186:189], v[146:149]
v_add_f32 v126, v126, v22
v_add_f32 v118, v118, v10
v_mfma_f32_16x16x32_bf16 v[158:161], v[248:251], v[182:185], v[158:161]
v_fmac_f32 v119, v10, v10
v_fmac_f32 v135, v33, v33
v_mfma_f32_16x16x32_bf16 v[158:161], v[252:255], v[186:189], v[158:161]
v_cvt_pk_bf16_f32 v80, v142, v143
v_cvt_pk_bf16_f32 v79, v140, v141
v_mfma_f32_16x16x32_bf16 v[154:157], v[228:231], v[186:189], v[154:157]
s_add_u32 s28, s38, s70
v_cvt_pk_bf16_f32 v78, v138, v139
v_add_f32 v134, v134, v34
v_mfma_f32_16x16x32_bf16 v[166:169], v[182:185], a[112:115], v[166:169]
v_cvt_pk_bf16_f32 v83, v148, v149
v_cvt_pk_bf16_f32 v81, v144, v145
v_mfma_f32_16x16x32_bf16 v[166:169], v[186:189], a[116:119], v[166:169]
s_add_u32 s29, s38, s69
v_add_f32 v118, v118, v11
v_fmac_f32_e64 v119, v11, v11
v_mfma_f32_16x16x32_bf16 v[162:165], v[182:185], a[88:91], v[162:165]
v_permlane16_swap_b32 v118, v119
v_mfma_f32_16x16x32_bf16 v[162:165], v[186:189], a[92:95], v[162:165]
s_waitcnt lgkmcnt(2)
buffer_store_dwordx2 v[120:121], v204, s[8:11], s29 offen sc1
v_fmac_f32 v135, v34, v34
v_mfma_f32_16x16x32_bf16 v[170:173], v[182:185], a[136:139], v[170:173]
s_add_u32 s29, s38, s71
v_add_f32 v118, v118, v119
v_fmac_f32 v135, v35, v35
v_mfma_f32_16x16x32_bf16 v[170:173], v[186:189], a[140:143], v[170:173]
ds_read_b128 v[186:189], v210 offset:29696
ds_read_b128 v[182:185], v210 offset:28672
v_mfma_f32_16x16x32_bf16 v[142:145], a[24:27], v[110:113], 0
v_add_f32_e64 v134, v134, v35
v_fmac_f32 v127, v22, v22
v_mfma_f32_16x16x32_bf16 v[142:145], a[28:31], v[220:223], v[142:145]
s_waitcnt lgkmcnt(3)
buffer_store_dwordx2 v[128:129], v204, s[8:11], s28 offen sc1
v_add_f32 v126, v126, v23
v_mfma_f32_16x16x32_bf16 v[138:141], a[0:3], v[110:113], 0
v_permlane16_swap_b32 v134, v135
v_mfma_f32_16x16x32_bf16 v[138:141], a[4:7], v[220:223], v[138:141]
v_cvt_pk_bf16_f32 v82, v146, v147
v_fmac_f32 v127, v23, v23
v_mfma_f32_16x16x32_bf16 v[146:149], a[48:51], v[110:113], 0
s_waitcnt lgkmcnt(2)
buffer_store_dwordx2 v[136:137], v204, s[8:11], s29 offen sc1
v_add_f32_e64 v134, v134, v135
v_mfma_f32_16x16x32_bf16 v[146:149], a[52:55], v[220:223], v[146:149]
s_waitcnt lgkmcnt(0)
v_permlane16_swap_b32 v126, v127
v_mfma_f32_16x16x32_bf16 v[146:149], a[56:59], v[182:185], v[146:149]
v_add_f32 v126, v126, v127
v_mov_b32 v135, v134
v_mfma_f32_16x16x32_bf16 v[146:149], a[60:63], v[186:189], v[146:149]
v_permlane32_swap_b32 v118, v126
v_mfma_f32_16x16x32_bf16 v[138:141], a[8:11], v[182:185], v[138:141]
s_mov_b32 s30, 65537
v_permlane32_swap_b32 v134, v135
v_mfma_f32_16x16x32_bf16 v[138:141], a[12:15], v[186:189], v[138:141]
s_mov_b32 s31, 65537
v_add_f32_e64 v118, v118, v126
v_add_f32 v134, v134, v135
v_mfma_f32_16x16x32_bf16 v[142:145], a[32:35], v[182:185], v[142:145]
s_add_u32 s28, s39, s60
ds_write_b32 v209, v118
v_mfma_f32_16x16x32_bf16 v[142:145], a[36:39], v[186:189], v[142:145]
s_add_u32 s29, s39, s61
ds_write_b32 v209, v134 offset:512
v_cvt_pk_bf16_f32 v73, v152, v153
v_mfma_f32_16x16x32_bf16 v[150:153], a[216:219], v[110:113], 0
s_add_u32 s41, s33, 0
v_cvt_pk_bf16_f32 v74, v154, v155
v_cvt_pk_bf16_f32 v75, v156, v157
v_mfma_f32_16x16x32_bf16 v[150:153], a[220:223], v[220:223], v[150:153]
s_mov_b32 s42, 58835169
v_cvt_pk_bf16_f32 v76, v158, v159
v_cvt_pk_bf16_f32 v77, v160, v161
v_mfma_f32_16x16x32_bf16 v[154:157], a[240:243], v[110:113], 0
s_mov_b32 s38, s36
v_cvt_pk_bf16_f32 v114, v162, v163
v_cvt_pk_bf16_f32 v115, v164, v165
v_mfma_f32_16x16x32_bf16 v[154:157], a[244:247], v[220:223], v[154:157]
v_cvt_pk_bf16_f32 v122, v166, v167
v_cvt_pk_bf16_f32 v123, v168, v169
v_mfma_f32_16x16x32_bf16 v[158:161], v[232:235], v[110:113], 0
s_waitcnt lgkmcnt(0)
v_cvt_pk_bf16_f32 v130, v170, v171
v_cvt_pk_bf16_f32 v131, v172, v173
v_mfma_f32_16x16x32_bf16 v[158:161], v[236:239], v[220:223], v[158:161]
s_barrier
v_mfma_f32_16x16x32_bf16 v[162:165], v[110:113], a[72:75], 0
s_nop 0
ds_read_b128 v[102:105], v210 offset:18432
ds_read_b128 v[106:109], v210 offset:19456
v_mfma_f32_16x16x32_bf16 v[162:165], v[220:223], a[76:79], v[162:165]
v_add_u32 v214, 1424, v214
v_mfma_f32_16x16x32_bf16 v[166:169], v[110:113], a[96:99], 0
v_mfma_f32_16x16x32_bf16 v[166:169], v[220:223], a[100:103], v[166:169]
v_mfma_f32_16x16x32_bf16 v[170:173], v[110:113], a[120:123], 0
ds_read_b128 v[110:113], v210 offset:30720
v_mfma_f32_16x16x32_bf16 v[170:173], v[220:223], a[124:127], v[170:173]
s_waitcnt lgkmcnt(2)
v_add_f32 v102, v102, v103
v_mfma_f32_16x16x32_bf16 v[150:153], a[224:227], v[182:185], v[150:153]
v_add_f32 v104, v104, v105
v_add_f32 v102, v102, v104
v_mfma_f32_16x16x32_bf16 v[150:153], a[228:231], v[186:189], v[150:153]
s_waitcnt lgkmcnt(1)
v_add_f32 v106, v106, v107
v_add_f32_e64 v108, v108, v109
v_mfma_f32_16x16x32_bf16 v[154:157], a[248:251], v[182:185], v[154:157]
v_add_f32 v106, v106, v108
v_mul_f32 v103, s48, v102
v_mfma_f32_16x16x32_bf16 v[154:157], a[252:255], v[186:189], v[154:157]
v_mul_f32 v104, s73, v102
v_mul_f32 v106, s73, v106
v_mfma_f32_16x16x32_bf16 v[158:161], v[240:243], v[182:185], v[158:161]
v_fma_f32 v106, -v103, v104, v106
v_max_f32_e64 v106, 0, v106
v_mfma_f32_16x16x32_bf16 v[158:161], v[244:247], v[186:189], v[158:161]
v_add_f32 v106, s49, v106
v_mfma_f32_16x16x32_bf16 v[162:165], v[182:185], a[80:83], v[162:165]
v_rsq_f32 v102, v106
v_mfma_f32_16x16x32_bf16 v[162:165], v[186:189], a[84:87], v[162:165]
ds_read_b128 v[106:109], v210 offset:31744
v_mul_f32_e64 v103, -v103, v102
v_mfma_f32_16x16x32_bf16 v[166:169], v[182:185], a[104:107], v[166:169]
ds_write_b64 v211, v[102:103]
v_mfma_f32_16x16x32_bf16 v[166:169], v[186:189], a[108:111], v[166:169]
v_mfma_f32_16x16x32_bf16 v[170:173], v[182:185], a[128:131], v[170:173]
s_nop 0
ds_read_b128 v[182:185], v210 offset:32768
ds_read_b64 v[118:119], v219
v_mfma_f32_16x16x32_bf16 v[170:173], v[186:189], a[132:135], v[170:173]
s_waitcnt lgkmcnt(4)
ds_read_b128 v[186:189], v210 offset:33792
ds_read_b64 v[126:127], v219 offset:256
v_mfma_f32_16x16x32_bf16 v[138:141], a[16:19], v[110:113], v[138:141]
ds_read_b64 v[134:135], v219 offset:512
s_waitcnt lgkmcnt(6)
v_mfma_f32_16x16x32_bf16 v[138:141], a[20:23], v[106:109], v[138:141]
v_mfma_f32_16x16x32_bf16 v[142:145], a[40:43], v[110:113], v[142:145]
v_mfma_f32_16x16x32_bf16 v[142:145], a[44:47], v[106:109], v[142:145]
v_cvt_pk_bf16_f32 v96, v138, v139
v_cvt_pk_bf16_f32 v97, v140, v141
v_mfma_f32_16x16x32_bf16 v[146:149], a[64:67], v[110:113], v[146:149]
s_waitcnt lgkmcnt(3)
v_fma_f32 v220, v0, v118, v119
v_fma_f32 v221, v1, v118, v119
v_mfma_f32_16x16x32_bf16 v[146:149], a[68:71], v[106:109], v[146:149]
v_fma_f32 v222, v2, v118, v119
v_fma_f32 v223, v3, v118, v119
v_mfma_f32_16x16x32_bf16 v[150:153], a[232:235], v[110:113], v[150:153]
v_cvt_pk_bf16_f32 v174, v220, v221
v_cvt_pk_bf16_f32 v175, v222, v223
v_mfma_f32_16x16x32_bf16 v[150:153], a[236:239], v[106:109], v[150:153]
v_cvt_pk_bf16_f32 v100, v146, v147
v_cvt_pk_bf16_f32 v101, v148, v149
v_mfma_f32_16x16x32_bf16 v[154:157], v[224:227], v[110:113], v[154:157]
v_cvt_pk_bf16_f32 v98, v142, v143
v_cvt_pk_bf16_f32 v99, v144, v145
v_mfma_f32_16x16x32_bf16 v[154:157], v[228:231], v[106:109], v[154:157]
v_cvt_pk_bf16_f32 v84, v150, v151
v_cvt_pk_bf16_f32 v85, v152, v153
v_mfma_f32_16x16x32_bf16 v[158:161], v[248:251], v[110:113], v[158:161]
v_fma_f32 v220, v4, v118, v119
v_fma_f32 v221, v5, v118, v119
v_mfma_f32_16x16x32_bf16 v[158:161], v[252:255], v[106:109], v[158:161]
v_fma_f32 v222, v6, v118, v119
v_fma_f32 v223, v7, v118, v119
v_mfma_f32_16x16x32_bf16 v[162:165], v[110:113], a[88:91], v[162:165]
v_cvt_pk_bf16_f32 v176, v220, v221
v_cvt_pk_bf16_f32 v177, v222, v223
v_mfma_f32_16x16x32_bf16 v[162:165], v[106:109], a[92:95], v[162:165]
ds_write_b128 v211, v[174:177]
v_mfma_f32_16x16x32_bf16 v[166:169], v[110:113], a[112:115], v[166:169]
v_fma_f32 v220, v8, v118, v119
v_fma_f32 v221, v9, v118, v119
v_mfma_f32_16x16x32_bf16 v[166:169], v[106:109], a[116:119], v[166:169]
v_fma_f32 v222, v10, v118, v119
v_fma_f32 v223, v11, v118, v119
v_mfma_f32_16x16x32_bf16 v[170:173], v[110:113], a[136:139], v[170:173]
ds_read_b64 v[112:113], v215 offset:528
ds_read_b128 v[174:177], v210 offset:34816
v_mfma_f32_16x16x32_bf16 v[170:173], v[106:109], a[140:143], v[170:173]
s_nop 0
ds_read_b128 v[108:111], v215 offset:512
v_cvt_pk_bf16_f32 v178, v220, v221
v_mfma_f32_16x16x32_bf16 v[138:141], a[0:3], v[182:185], 0
s_waitcnt lgkmcnt(6)
v_cvt_pk_bf16_f32 v179, v222, v223
v_cvt_pk_bf16_f32 v88, v158, v159
v_mfma_f32_16x16x32_bf16 v[138:141], a[4:7], v[186:189], v[138:141]
ds_write_b64 v212, v[178:179]
v_mfma_f32_16x16x32_bf16 v[142:145], a[24:27], v[182:185], 0
v_cvt_pk_bf16_f32 v89, v160, v161
v_cvt_pk_bf16_f32 v86, v154, v155
v_mfma_f32_16x16x32_bf16 v[142:145], a[28:31], v[186:189], v[142:145]
ds_read_b128 v[178:181], v210 offset:35840
v_cvt_pk_bf16_f32 v87, v156, v157
v_mfma_f32_16x16x32_bf16 v[146:149], a[48:51], v[182:185], 0
ds_read_b128 v[182:185], v210 offset:36864
v_cvt_pk_bf16_f32 v124, v166, v167
v_mfma_f32_16x16x32_bf16 v[146:149], a[52:55], v[186:189], v[146:149]
s_nop 0
ds_read_b128 v[186:189], v210 offset:37888
v_cvt_pk_bf16_f32 v125, v168, v169
s_waitcnt lgkmcnt(5)
v_mfma_f32_16x16x16_bf16 v[150:153], v[112:113], v[76:77], v[206:209]
v_cvt_pk_bf16_f32 v116, v162, v163
v_cvt_pk_bf16_f32 v117, v164, v165
v_fma_f32 v220, v12, v126, v127
v_mfma_f32_16x16x16_bf16 v[154:157], v[82:83], v[88:89], 0
v_fma_f32 v221, v13, v126, v127
v_fma_f32 v222, v14, v126, v127
v_fma_f32 v223, v15, v126, v127
v_mfma_f32_16x16x16_bf16 v[158:161], v[100:101], v[88:89], 0
v_cvt_pk_bf16_f32 v90, v220, v221
v_cvt_pk_bf16_f32 v91, v222, v223
v_fma_f32 v220, v16, v126, v127
v_mfma_f32_16x16x16_bf16 v[166:169], v[112:113], v[88:89], v[206:209]
v_fma_f32 v221, v17, v126, v127
v_fma_f32 v222, v18, v126, v127
v_fma_f32 v223, v19, v126, v127
v_cvt_pk_bf16_f32 v92, v220, v221
v_mfma_f32_16x16x32_bf16 v[138:141], a[8:11], v[174:177], v[138:141]
s_waitcnt lgkmcnt(2)
v_cvt_pk_bf16_f32 v93, v222, v223
v_fma_f32 v220, v20, v126, v127
v_mfma_f32_16x16x32_bf16 v[138:141], a[12:15], v[178:181], v[138:141]
s_nop 0
ds_write_b128 v211, v[90:93] offset:6144
v_mfma_f32_16x16x32_bf16 v[154:157], v[78:81], v[84:87], v[154:157]
v_fma_f32 v221, v21, v126, v127
v_fma_f32 v222, v22, v126, v127
v_mfma_f32_16x16x32_bf16 v[150:153], v[108:111], v[72:75], v[150:153]
v_fma_f32 v223, v23, v126, v127
v_cvt_pk_bf16_f32 v94, v220, v221
v_mfma_f32_16x16x32_bf16 v[158:161], v[96:99], v[84:87], v[158:161]
v_cvt_pk_bf16_f32 v95, v222, v223
v_fma_f32 v220, v24, v134, v135
v_mfma_f32_16x16x32_bf16 v[166:169], v[108:111], v[84:87], v[166:169]
v_fma_f32 v221, v25, v134, v135
v_fma_f32 v222, v26, v134, v135
v_mfma_f32_16x16x32_bf16 v[142:145], a[32:35], v[174:177], v[142:145]
v_fma_f32 v223, v27, v134, v135
v_cvt_pk_bf16_f32 v90, v220, v221
v_mfma_f32_16x16x32_bf16 v[142:145], a[36:39], v[178:181], v[142:145]
v_cvt_pk_bf16_f32 v91, v222, v223
v_fma_f32 v220, v28, v134, v135
v_mfma_f32_16x16x32_bf16 v[146:149], a[56:59], v[174:177], v[146:149]
v_fma_f32 v221, v29, v134, v135
v_fma_f32 v222, v30, v134, v135
v_mfma_f32_16x16x32_bf16 v[146:149], a[60:63], v[178:181], v[146:149]
s_waitcnt lgkmcnt(2)
v_fma_f32 v223, v31, v134, v135
v_cvt_pk_bf16_f32 v92, v220, v221
v_mfma_f32_16x16x32_bf16 v[118:121], v[182:185], a[88:91], 0
s_waitcnt lgkmcnt(1)
v_cvt_pk_bf16_f32 v93, v222, v223
v_fma_f32 v220, v32, v134, v135
v_mfma_f32_16x16x32_bf16 v[118:121], v[186:189], a[92:95], v[118:121]
ds_write_b128 v211, v[90:93] offset:12288
v_mfma_f32_16x16x32_bf16 v[126:129], v[182:185], a[112:115], 0
v_fma_f32 v221, v33, v134, v135
v_fma_f32 v222, v34, v134, v135
v_mfma_f32_16x16x32_bf16 v[126:129], v[186:189], a[116:119], v[126:129]
v_fma_f32 v223, v35, v134, v135
v_cvt_pk_bf16_f32 v132, v170, v171
v_mfma_f32_16x16x32_bf16 v[134:137], v[182:185], a[136:139], 0
ds_write_b64 v212, v[94:95] offset:6144
v_mfma_f32_16x16x32_bf16 v[134:137], v[186:189], a[140:143], v[134:137]
v_cvt_pk_bf16_f32 v133, v172, v173
v_cvt_pk_bf16_f32 v94, v220, v221
v_mfma_f32_16x16x32_bf16 v[90:93], a[232:235], v[182:185], 0
v_exp_f32 v154, v154
v_mfma_f32_16x16x32_bf16 v[90:93], a[236:239], v[186:189], v[90:93]
v_exp_f32 v155, v155
v_mfma_f32_16x16x32_bf16 v[170:173], v[224:227], v[182:185], 0
v_exp_f32 v156, v156
v_mfma_f32_16x16x32_bf16 v[170:173], v[228:231], v[186:189], v[170:173]
v_exp_f32 v157, v157
v_mfma_f32_16x16x32_bf16 v[138:141], a[16:19], v[182:185], v[138:141]
v_exp_f32 v158, v158
v_mfma_f32_16x16x32_bf16 v[138:141], a[20:23], v[186:189], v[138:141]
v_exp_f32 v159, v159
v_mfma_f32_16x16x32_bf16 v[118:121], v[174:177], a[80:83], v[118:121]
v_exp_f32 v160, v160
v_mfma_f32_16x16x32_bf16 v[118:121], v[178:181], a[84:87], v[118:121]
v_cvt_pk_bf16_f32 v102, v138, v139
v_cvt_pk_bf16_f32 v103, v140, v141
v_mfma_f32_16x16x16_bf16 v[138:141], v[82:83], v[76:77], 0
v_exp_f32 v161, v161
v_exp_f32 v150, v150
v_mfma_f32_16x16x32_bf16 v[126:129], v[174:177], a[104:107], v[126:129]
v_exp_f32 v166, v166
v_mfma_f32_16x16x32_bf16 v[138:141], v[78:81], v[72:75], v[138:141]
v_cvt_pk_bf16_f32 v95, v222, v223
v_mfma_f32_16x16x32_bf16 v[220:223], v[248:251], v[182:185], 0
ds_write_b64 v212, v[94:95] offset:12288
v_mfma_f32_16x16x32_bf16 v[220:223], v[252:255], v[186:189], v[220:223]
v_exp_f32 v138, v138
v_mfma_f32_16x16x32_bf16 v[126:129], v[178:181], a[108:111], v[126:129]
v_exp_f32 v139, v139
v_mfma_f32_16x16x32_bf16 v[142:145], a[40:43], v[182:185], v[142:145]
v_exp_f32 v140, v140
v_mfma_f32_16x16x32_bf16 v[142:145], a[44:47], v[186:189], v[142:145]
v_exp_f32 v141, v141
v_mfma_f32_16x16x32_bf16 v[134:137], v[174:177], a[128:131], v[134:137]
v_mfma_f32_16x16x32_bf16 v[134:137], v[178:181], a[132:135], v[134:137]
v_cvt_pk_bf16_f32 v104, v142, v143
v_cvt_pk_bf16_f32 v105, v144, v145
v_mfma_f32_16x16x16_bf16 v[142:145], v[100:101], v[76:77], 0
v_mfma_f32_16x16x32_bf16 v[90:93], a[224:227], v[174:177], v[90:93]
v_mfma_f32_16x16x32_bf16 v[142:145], v[96:99], v[72:75], v[142:145]
v_mfma_f32_16x16x32_bf16 v[90:93], a[228:231], v[178:181], v[90:93]
v_mfma_f32_16x16x32_bf16 v[170:173], a[248:251], v[174:177], v[170:173]
v_exp_f32 v142, v142
v_mfma_f32_16x16x32_bf16 v[170:173], a[252:255], v[178:181], v[170:173]
v_exp_f32 v143, v143
v_mfma_f32_16x16x32_bf16 v[146:149], a[64:67], v[182:185], v[146:149]
v_exp_f32 v144, v144
v_mfma_f32_16x16x32_bf16 v[146:149], a[68:71], v[186:189], v[146:149]
v_exp_f32 v145, v145
v_mfma_f32_16x16x32_bf16 v[220:223], v[240:243], v[174:177], v[220:223]
v_cvt_pk_bf16_f32 v174, v138, v139
v_cvt_pk_bf16_f32 v175, v140, v141
v_mfma_f32_16x16x32_bf16 v[220:223], v[244:247], v[178:181], v[220:223]
v_cvt_pk_bf16_f32 v106, v146, v147
v_cvt_pk_bf16_f32 v107, v148, v149
v_cvt_pk_bf16_f32 v176, v142, v143
v_cvt_pk_bf16_f32 v177, v144, v145
v_mfma_f32_16x16x16_bf16 v[146:149], v[106:107], v[76:77], 0
v_cvt_pk_bf16_f32 v180, v150, 0
v_mov_b32_e64 v181, 0
v_mfma_f32_16x16x16_bf16 v[162:165], v[106:107], v[88:89], 0
ds_read_b128 v[182:185], v210 offset:32768
ds_read_b128 v[186:189], v210 offset:33792
v_mfma_f32_16x16x32_bf16 v[146:149], v[102:105], v[72:75], v[146:149]
ds_read_b128 v[72:75], v215
ds_read_b64 v[76:77], v215 offset:16
v_mfma_f32_16x16x32_bf16 v[162:165], v[102:105], v[84:87], v[162:165]
v_mfma_f32_16x16x32_bf16 v[150:153], v[190:193], v[174:177], 0
v_exp_f32 v146, v146
v_mfma_f32_16x16x32_bf16 v[138:141], v[114:117], v[174:177], 0
v_exp_f32 v147, v147
v_mfma_f32_16x16x32_bf16 v[142:145], v[122:125], v[174:177], 0
s_waitcnt lgkmcnt(3)
v_exp_f32 v148, v148
v_mfma_f32_16x16x32_bf16 v[118:121], v[182:185], a[72:75], v[118:121]
s_waitcnt lgkmcnt(2)
v_exp_f32 v149, v149
v_mfma_f32_16x16x32_bf16 v[118:121], v[186:189], a[76:79], v[118:121]
v_exp_f32 v162, v162
v_mfma_f32_16x16x32_bf16 v[126:129], v[182:185], a[96:99], v[126:129]
v_exp_f32 v163, v163
v_mfma_f32_16x16x32_bf16 v[126:129], v[186:189], a[100:103], v[126:129]
v_cvt_pk_bf16_f32 v118, v118, v119
v_cvt_pk_bf16_f32 v119, v120, v121
v_mfma_f32_16x16x32_bf16 v[134:137], v[182:185], a[120:123], v[134:137]
ds_read_u16 v120, v205
v_cvt_pk_bf16_f32 v178, v146, v147
v_mfma_f32_16x16x32_bf16 v[134:137], v[186:189], a[124:127], v[134:137]
v_cvt_pk_bf16_f32 v126, v126, v127
v_cvt_pk_bf16_f32 v127, v128, v129
v_mfma_f32_16x16x32_bf16 v[90:93], a[216:219], v[182:185], v[90:93]
ds_read_u16 v128, v205 offset:32
v_cvt_pk_bf16_f32 v179, v148, v149
v_mfma_f32_16x16x32_bf16 v[90:93], a[220:223], v[186:189], v[90:93]
v_cvt_pk_bf16_f32 v134, v134, v135
v_cvt_pk_bf16_f32 v135, v136, v137
v_mfma_f32_16x16x32_bf16 v[170:173], a[240:243], v[182:185], v[170:173]
ds_read_u16 v136, v205 offset:64
v_mov_b32_e64 v121, 0
v_mfma_f32_16x16x32_bf16 v[170:173], a[244:247], v[186:189], v[170:173]
v_cvt_pk_bf16_f32 v90, v90, v91
v_cvt_pk_bf16_f32 v91, v92, v93
v_mfma_f32_16x16x32_bf16 v[220:223], v[232:235], v[182:185], v[220:223]
v_exp_f32_e64 v164, v164
v_mfma_f32_16x16x32_bf16 v[220:223], v[236:239], v[186:189], v[220:223]
v_cvt_pk_bf16_f32 v92, v170, v171
v_cvt_pk_bf16_f32 v93, v172, v173
v_mfma_f32_16x16x32_bf16 v[150:153], v[190:193], v[178:181], v[150:153]
s_waitcnt lgkmcnt(2)
v_exp_f32 v165, v165
v_mfma_f32_16x16x32_bf16 v[138:141], v[118:121], v[178:181], v[138:141]
v_mov_b32 v129, 0
v_mov_b32 v137, 0
v_mfma_f32_16x16x32_bf16 v[146:149], v[130:133], v[174:177], 0
s_waitcnt lgkmcnt(0)
v_rcp_f32 v151, v150
v_mfma_f32_16x16x32_bf16 v[146:149], v[134:137], v[178:181], v[146:149]
v_mul_f32 v152, s3, v151
v_mul_f32 v138, v138, v152
v_mfma_f32_16x16x32_bf16 v[142:145], v[126:129], v[178:181], v[142:145]
v_mul_f32 v139, v139, v152
v_mul_f32 v140, v140, v152
v_mul_f32_e64 v141, v141, v152
v_cvt_pk_bf16_f32 v138, v138, v139
v_cvt_pk_bf16_f32 v174, v154, v155
v_cvt_pk_bf16_f32 v175, v156, v157
v_cvt_pk_bf16_f32 v176, v158, v159
v_cvt_pk_bf16_f32 v177, v160, v161
v_mul_f32 v142, v142, v152
v_mul_f32 v143, v143, v152
v_mfma_f32_16x16x32_bf16 v[154:157], v[114:117], v[174:177], 0
v_mul_f32 v144, v144, v152
v_mul_f32 v145, v145, v152
v_mfma_f32_16x16x32_bf16 v[158:161], v[122:125], v[174:177], 0
v_cvt_pk_bf16_f32 v139, v140, v141
v_cvt_pk_bf16_f32 v140, v142, v143
v_cvt_pk_bf16_f32 v141, v144, v145
v_cvt_pk_bf16_f32 v180, v166, 0
v_mfma_f32_16x16x32_bf16 v[166:169], v[190:193], v[174:177], 0
ds_write_b128 v211, v[138:141] offset:38912
v_mfma_f32_16x16x32_bf16 v[138:141], v[78:81], v[90:93], 0
v_cvt_pk_bf16_f32 v178, v162, v163
v_cvt_pk_bf16_f32 v179, v164, v165
v_mfma_f32_16x16x32_bf16 v[162:165], v[130:133], v[174:177], 0
v_mul_f32 v146, v146, v152
v_mul_f32 v147, v147, v152
v_mfma_f32_16x16x32_bf16 v[166:169], v[190:193], v[178:181], v[166:169]
v_mul_f32 v148, v148, v152
v_mul_f32 v149, v149, v152
v_mfma_f32_16x16x32_bf16 v[154:157], v[118:121], v[178:181], v[154:157]
v_cvt_pk_bf16_f32 v142, v146, v147
v_cvt_pk_bf16_f32 v143, v148, v149
v_mfma_f32_16x16x32_bf16 v[158:161], v[126:129], v[178:181], v[158:161]
ds_write_b64 v212, v[142:143] offset:38912
v_mfma_f32_16x16x32_bf16 v[162:165], v[134:137], v[178:181], v[162:165]
v_rcp_f32 v167, v166
v_mfma_f32_16x16x32_bf16 v[142:145], v[96:99], v[90:93], 0
v_mul_f32 v168, s3, v167
v_mul_f32_e64 v154, v154, v168
v_mfma_f32_16x16x32_bf16 v[146:149], v[102:105], v[90:93], 0
v_mul_f32 v155, v155, v168
v_mul_f32 v156, v156, v168
v_mul_f32_e64 v157, v157, v168
v_cvt_pk_bf16_f32 v154, v154, v155
v_mul_f32 v158, v158, v168
v_mul_f32 v159, v159, v168
v_mul_f32 v160, v160, v168
v_mul_f32 v161, v161, v168
v_cvt_pk_bf16_f32 v155, v156, v157
v_cvt_pk_bf16_f32 v156, v158, v159
v_cvt_pk_bf16_f32 v157, v160, v161
v_mul_f32 v162, v162, v168
v_mul_f32 v163, v163, v168
v_mul_f32 v164, v164, v168
v_mul_f32 v165, v165, v168
v_max3_u32 v218, v218, v150, v151
v_mfma_f32_16x16x32_bf16 v[150:153], v[108:111], v[90:93], v[206:209]
ds_write_b128 v211, v[154:157] offset:45056
v_mfma_f32_16x16x32_bf16 v[154:157], v[72:75], v[78:81], 0
v_cvt_pk_bf16_f32 v158, v162, v163
v_cvt_pk_bf16_f32 v159, v164, v165
v_mfma_f32_16x16x32_bf16 v[162:165], v[72:75], v[102:105], 0
s_nop 0
v_cvt_pk_bf16_f32 v94, v220, v221
v_cvt_pk_bf16_f32 v95, v222, v223
v_max3_u32 v218, v218, v166, v167
s_nop 0
v_mfma_f32_16x16x16_bf16 v[138:141], v[82:83], v[94:95], v[138:141]
ds_write_b64 v212, v[158:159] offset:45056
v_mfma_f32_16x16x16_bf16 v[142:145], v[100:101], v[94:95], v[142:145]
v_add_u32 v205, 1424, v205
v_mfma_f32_16x16x16_bf16 v[150:153], v[112:113], v[94:95], v[150:153]
v_exp_f32_e64 v138, v138
v_mfma_f32_16x16x16_bf16 v[146:149], v[106:107], v[94:95], v[146:149]
v_exp_f32 v139, v139
s_nop 0
v_cvt_pk_bf16_f32 v174, v138, v139
v_mfma_f32_16x16x16_bf16 v[154:157], v[76:77], v[82:83], v[154:157]
v_exp_f32 v140, v140
v_exp_f32 v141, v141
v_mfma_f32_16x16x32_bf16 v[158:161], v[72:75], v[96:99], 0
v_exp_f32 v142, v142
v_exp_f32 v143, v143
v_mfma_f32_16x16x16_bf16 v[162:165], v[76:77], v[106:107], v[162:165]
v_exp_f32 v144, v144
v_cvt_pk_bf16_f32 v175, v140, v141
v_mfma_f32_16x16x16_bf16 v[158:161], v[76:77], v[100:101], v[158:161]
v_exp_f32 v145, v145
v_exp_f32 v150, v150
v_cvt_pk_bf16_f32 v176, v142, v143
v_cvt_pk_bf16_f32 v177, v144, v145
v_cvt_pk_bf16_f32 v180, v150, 0
s_nop 0
v_mfma_f32_16x16x32_bf16 v[150:153], v[190:193], v[174:177], 0
s_waitcnt lgkmcnt(0)
s_barrier
v_mfma_f32_16x16x32_bf16 v[138:141], v[114:117], v[174:177], 0
ds_read_b128 v[220:223], v210 offset:38912
ds_read_b128 v[110:113], v210 offset:39936
v_mfma_f32_16x16x32_bf16 v[142:145], v[122:125], v[174:177], 0
ds_read_b128 v[170:173], v210 offset:40960
ds_read_b128 v[182:185], v210 offset:41984
v_exp_f32 v146, v146
v_exp_f32 v147, v147
v_exp_f32 v148, v148
v_exp_f32 v149, v149
v_cvt_pk_bf16_f32 v178, v146, v147
v_cvt_pk_bf16_f32 v179, v148, v149
v_mfma_f32_16x16x32_bf16 v[146:149], v[130:133], v[174:177], 0
ds_read_b128 v[186:189], v210 offset:43008
ds_read_b32 v166, v215 offset:536
v_mfma_f32_16x16x32_bf16 v[150:153], v[190:193], v[178:181], v[150:153]
ds_read_b128 v[174:177], v217
v_mov_b32_dpp v154, v158 quad_perm:[0,1,2,3] row_mask:0x2 bank_mask:0xf
v_mfma_f32_16x16x32_bf16 v[138:141], v[118:121], v[178:181], v[138:141]
v_mov_b32_dpp v154, v162 quad_perm:[0,1,2,3] row_mask:0x4 bank_mask:0xf
v_mfma_f32_16x16x32_bf16 v[142:145], v[126:129], v[178:181], v[142:145]
s_waitcnt lgkmcnt(6)
v_rcp_f32 v151, v150
v_mfma_f32_16x16x32_bf16 v[36:39], a[144:147], v[220:223], v[36:39]
s_waitcnt lgkmcnt(5)
v_mul_f32 v152, s3, v151
v_mul_f32_e64 v138, v138, v152
v_mfma_f32_16x16x32_bf16 v[36:39], a[148:151], v[110:113], v[36:39]
s_waitcnt lgkmcnt(4)
v_mul_f32 v139, v139, v152
v_mul_f32 v140, v140, v152
v_mfma_f32_16x16x32_bf16 v[36:39], a[152:155], v[170:173], v[36:39]
s_waitcnt lgkmcnt(1)
v_add_f32_dpp v154, v166, v207 quad_perm:[0,1,2,3] row_mask:0x8 bank_mask:0xf
v_mul_f32_e64 v141, v141, v152
v_mfma_f32_16x16x32_bf16 v[36:39], a[156:159], v[182:185], v[36:39]
v_exp_f32_e64 v166, v154
v_mfma_f32_16x16x32_bf16 v[40:43], a[168:171], v[220:223], v[40:43]
v_cvt_pk_bf16_f32 v154, v166, 0
v_cvt_pk_bf16_f32 v138, v138, v139
v_mfma_f32_16x16x32_bf16 v[40:43], a[172:175], v[110:113], v[40:43]
ds_write_b16 v214, v154
v_mfma_f32_16x16x32_bf16 v[40:43], a[176:179], v[170:173], v[40:43]
ds_read_b128 v[84:87], v215
ds_read_b128 v[88:91], v215 offset:16
v_mfma_f32_16x16x32_bf16 v[40:43], a[180:183], v[182:185], v[40:43]
v_mul_f32 v142, v142, v152
v_mul_f32 v143, v143, v152
v_mfma_f32_16x16x32_bf16 v[44:47], a[192:195], v[220:223], v[44:47]
ds_read_b128 v[220:223], v210 offset:44032
v_mul_f32_e64 v144, v144, v152
v_mfma_f32_16x16x32_bf16 v[44:47], a[196:199], v[110:113], v[44:47]
ds_read_b128 v[110:113], v210 offset:45056
v_mul_f32_e64 v145, v145, v152
v_mfma_f32_16x16x32_bf16 v[44:47], a[200:203], v[170:173], v[44:47]
ds_read_b128 v[170:173], v210 offset:46080
v_cvt_pk_bf16_f32 v139, v140, v141
v_mfma_f32_16x16x32_bf16 v[44:47], a[204:207], v[182:185], v[44:47]
ds_read_b128 v[182:185], v210 offset:47104
v_cvt_pk_bf16_f32 v140, v142, v143
v_mfma_f32_16x16x32_bf16 v[146:149], v[134:137], v[178:181], v[146:149]
ds_read_b128 v[178:181], v217 offset:528
v_cvt_pk_bf16_f32 v141, v144, v145
v_mfma_f32_16x16x32_bf16 v[36:39], a[160:163], v[186:189], v[36:39]
s_nop 0
ds_write_b128 v211, v[138:141] offset:51200
s_waitcnt lgkmcnt(5)
v_mfma_f32_16x16x32_bf16 v[36:39], a[164:167], v[220:223], v[36:39]
v_mul_f32 v146, v146, v152
v_mul_f32 v147, v147, v152
v_mfma_f32_16x16x32_bf16 v[40:43], a[184:187], v[186:189], v[40:43]
v_mul_f32_e64 v148, v148, v152
v_mul_f32 v149, v149, v152
v_mfma_f32_16x16x32_bf16 v[40:43], a[188:191], v[220:223], v[40:43]
s_waitcnt lgkmcnt(4)
v_cvt_pk_bf16_f32 v142, v146, v147
v_cvt_pk_bf16_f32 v143, v148, v149
v_mfma_f32_16x16x32_bf16 v[48:51], a[144:147], v[110:113], v[48:51]
s_waitcnt lgkmcnt(3)
ds_write_b64 v212, v[142:143] offset:51200
v_mfma_f32_16x16x32_bf16 v[48:51], a[148:151], v[170:173], v[48:51]
s_waitcnt lgkmcnt(3)
v_cvt_pk_bf16_f32 v36, v36, v37
v_cvt_pk_bf16_f32 v37, v38, v39
v_mfma_f32_16x16x32_bf16 v[48:51], a[152:155], v[182:185], v[48:51]
ds_write_b64 v203, v[36:37]
v_mfma_f32_16x16x32_bf16 v[52:55], a[168:171], v[110:113], v[52:55]
buffer_load_dwordx4 v[36:39], v210, s[24:27], s58 offen
v_mfma_f32_16x16x32_bf16 v[52:55], a[172:175], v[170:173], v[52:55]
v_cvt_pk_bf16_f32 v40, v40, v41
v_cvt_pk_bf16_f32 v41, v42, v43
v_mfma_f32_16x16x32_bf16 v[52:55], a[176:179], v[182:185], v[52:55]
ds_write_b64 v203, v[40:41] offset:32
v_mfma_f32_16x16x32_bf16 v[56:59], a[192:195], v[110:113], v[56:59]
s_waitcnt lgkmcnt(2)
buffer_load_dwordx4 v[40:43], v210, s[24:27], s58 offen offset:1024
v_mfma_f32_16x16x32_bf16 v[56:59], a[196:199], v[170:173], v[56:59]
s_barrier
v_mfma_f32_16x16x32_bf16 v[56:59], a[200:203], v[182:185], v[56:59]
ds_read_b128 v[110:113], v210 offset:50176
ds_read_b128 v[170:173], v210 offset:51200
v_mfma_f32_16x16x32_bf16 v[44:47], a[208:211], v[186:189], v[44:47]
ds_read_b128 v[186:189], v210 offset:48128
ds_read_b128 v[182:185], v210 offset:52224
v_mfma_f32_16x16x32_bf16 v[44:47], a[212:215], v[220:223], v[44:47]
ds_read_b128 v[220:223], v210 offset:49152
v_add_f32_dpp v166, v166, v166 row_ror:8 row_mask:0xf bank_mask:0xf
v_mfma_f32_16x16x32_bf16 v[154:157], v[84:87], v[114:117], 0
v_add_f32_dpp v166, v166, v166 row_ror:4 row_mask:0xf bank_mask:0xf
v_add_u32 v215, 1424, v215
v_mfma_f32_16x16x32_bf16 v[154:157], v[88:91], v[118:121], v[154:157]
v_cvt_pk_bf16_f32 v44, v44, v45
v_cvt_pk_bf16_f32 v45, v46, v47
v_mfma_f32_16x16x32_bf16 v[158:161], v[84:87], v[122:125], 0
ds_write_b64 v203, v[44:45] offset:64
v_mfma_f32_16x16x32_bf16 v[158:161], v[88:91], v[126:129], v[158:161]
buffer_load_dwordx4 v[44:47], v210, s[24:27], s58 offen offset:2048
v_mfma_f32_16x16x32_bf16 v[162:165], v[84:87], v[130:133], 0
s_nop 0
v_add_f32_dpp v166, v166, v166 row_ror:2 row_mask:0xf bank_mask:0xf
s_waitcnt lgkmcnt(3)
v_mfma_f32_16x16x32_bf16 v[48:51], a[156:159], v[186:189], v[48:51]
v_add_f32_dpp v166, v166, v166 row_ror:1 row_mask:0xf bank_mask:0xf
v_mov_b32_dpp v154, v158 quad_perm:[0,1,2,3] row_mask:0x2 bank_mask:0xf
v_mfma_f32_16x16x32_bf16 v[52:55], a[180:183], v[186:189], v[52:55]
s_nop 0
v_add_f32_dpp v166, v166, v166 row_bcast:15 row_mask:0xa bank_mask:0xf
s_waitcnt lgkmcnt(1)
v_mfma_f32_16x16x32_bf16 v[52:55], a[184:187], v[220:223], v[52:55]
v_add_f32_dpp v166, v166, v166 row_bcast:31 row_mask:0xc bank_mask:0xf
v_mfma_f32_16x16x32_bf16 v[52:55], a[188:191], v[110:113], v[52:55]
v_readlane_b32 s72, v166, 63
v_mfma_f32_16x16x32_bf16 v[56:59], a[204:207], v[186:189], v[56:59]
ds_read_b128 v[186:189], v210 offset:53248
v_mfma_f32_16x16x32_bf16 v[56:59], a[208:211], v[220:223], v[56:59]
v_cvt_pk_bf16_f32 v52, v52, v53
v_cvt_pk_bf16_f32 v53, v54, v55
v_mfma_f32_16x16x32_bf16 v[56:59], a[212:215], v[110:113], v[56:59]
ds_write_b64 v203, v[52:53] offset:6304
v_mfma_f32_16x16x32_bf16 v[48:51], a[160:163], v[220:223], v[48:51]
v_rcp_f32_e64 v167, s72
v_mfma_f32_16x16x32_bf16 v[48:51], a[164:167], v[110:113], v[48:51]
ds_read_b128 v[220:223], v210 offset:54272
ds_read_b128 v[110:113], v210 offset:55296
v_mfma_f32_16x16x32_bf16 v[162:165], v[88:91], v[134:137], v[162:165]
v_cvt_pk_bf16_f32 v56, v56, v57
v_cvt_pk_bf16_f32 v57, v58, v59
v_mfma_f32_16x16x32_bf16 v[60:63], a[144:147], v[170:173], v[60:63]
s_nop 0
v_cvt_pk_bf16_f32 v48, v48, v49
v_cvt_pk_bf16_f32 v49, v50, v51
v_mfma_f32_16x16x32_bf16 v[60:63], a[148:151], v[182:185], v[60:63]
s_waitcnt lgkmcnt(3)
ds_write_b64 v203, v[48:49] offset:6272
v_mfma_f32_16x16x32_bf16 v[60:63], a[152:155], v[186:189], v[60:63]
v_max3_u32 v218, v218, s72, v167
v_max3_u32 v218, v218, v150, v151
v_mfma_f32_16x16x32_bf16 v[64:67], a[168:171], v[170:173], v[64:67]
ds_write_b64 v203, v[56:57] offset:6336
v_mfma_f32_16x16x32_bf16 v[64:67], a[172:175], v[182:185], v[64:67]
v_mul_f32_e64 v168, s3, v167
v_mov_b32_dpp v154, v162 quad_perm:[0,1,2,3] row_mask:0x4 bank_mask:0xf
v_mfma_f32_16x16x32_bf16 v[64:67], a[176:179], v[186:189], v[64:67]
s_waitcnt lgkmcnt(3)
v_mul_f32 v154, v154, v168
v_cvt_pk_bf16_f32 v154, v154, 0
v_mfma_f32_16x16x32_bf16 v[64:67], a[180:183], v[220:223], v[64:67]
ds_write_b16 v214, v154
v_mfma_f32_16x16x32_bf16 v[68:71], a[192:195], v[170:173], v[68:71]
ds_read_b128 v[170:173], v210 offset:56320
v_add_u32 v214, 1424, v214
v_mfma_f32_16x16x32_bf16 v[68:71], a[196:199], v[182:185], v[68:71]
ds_read_b128 v[182:185], v210
v_mfma_f32_16x16x32_bf16 v[68:71], a[200:203], v[186:189], v[68:71]
ds_read_b128 v[186:189], v210 offset:1024
v_mfma_f32_16x16x32_bf16 v[60:63], a[156:159], v[220:223], v[60:63]
s_waitcnt lgkmcnt(6)
v_mfma_f32_16x16x32_bf16 v[60:63], a[160:163], v[110:113], v[60:63]
v_mfma_f32_16x16x32_bf16 v[68:71], a[204:207], v[220:223], v[68:71]
ds_read_b128 v[220:223], v210 offset:3072
v_mfma_f32_16x16x32_bf16 v[68:71], a[208:211], v[110:113], v[68:71]
s_waitcnt lgkmcnt(3)
v_mfma_f32_16x16x32_bf16 v[68:71], a[212:215], v[170:173], v[68:71]
v_mfma_f32_16x16x32_bf16 v[60:63], a[164:167], v[170:173], v[60:63]
v_mfma_f32_16x16x32_bf16 v[64:67], a[184:187], v[110:113], v[64:67]
v_cvt_pk_bf16_f32 v68, v68, v69
v_cvt_pk_bf16_f32 v69, v70, v71
v_mfma_f32_16x16x32_bf16 v[64:67], a[188:191], v[170:173], v[64:67]
s_waitcnt lgkmcnt(2)
ds_write_b64 v203, v[68:69] offset:12608
v_mfma_f32_16x16x32_bf16 v[138:141], a[0:3], v[182:185], 0
s_waitcnt lgkmcnt(2)
v_mov_b32_dpp v71, v200 row_newbcast:0 row_mask:0xf bank_mask:0xf
v_add_u32 v71, 17248, v71
v_mfma_f32_16x16x32_bf16 v[138:141], a[4:7], v[186:189], v[138:141]
ds_read_b128 v[84:87], v71
v_mov_b32_dpp v69, v194 row_newbcast:0 row_mask:0xf bank_mask:0xf
v_mfma_f32_16x16x32_bf16 v[142:145], a[24:27], v[182:185], 0
v_add_u32 v69, 17248, v69
v_mov_b32_dpp v70, v197 row_newbcast:0 row_mask:0xf bank_mask:0xf
v_mfma_f32_16x16x32_bf16 v[142:145], a[28:31], v[186:189], v[142:145]
ds_read_b128 v[92:95], v69
ds_read_b128 v[96:99], v69 offset:16
v_mfma_f32_16x16x32_bf16 v[146:149], a[48:51], v[182:185], 0
v_add_u32 v70, 17248, v70
v_cvt_pk_bf16_f32 v60, v60, v61
v_mfma_f32_16x16x32_bf16 v[146:149], a[52:55], v[186:189], v[146:149]
ds_read_b128 v[100:103], v70
ds_read_b128 v[104:107], v70 offset:16
v_mfma_f32_16x16x32_bf16 v[150:153], a[216:219], v[182:185], 0
s_nop 0
ds_read_b128 v[110:113], v210 offset:2048
v_cvt_pk_bf16_f32 v61, v62, v63
v_mfma_f32_16x16x32_bf16 v[150:153], a[220:223], v[186:189], v[150:153]
s_waitcnt lgkmcnt(5)
ds_write_b64 v203, v[60:61] offset:12544
v_mfma_f32_16x16x32_bf16 v[48:51], v[174:177], v[84:87], 0
v_subrev_u32 v60, 37120, v210
v_lshrrev_b32 v61, 4, v60
v_mfma_f32_16x16x32_bf16 v[154:157], a[240:243], v[182:185], 0
s_waitcnt lgkmcnt(4)
ds_read_b128 v[174:177], v217 offset:1056
ds_read_b128 v[84:87], v71 offset:32
v_smfmac_f32_16x16x64_bf16 v[48:51], v[178:181], v[92:99], v213
ds_read_b128 v[178:181], v217 offset:1584
ds_read_b128 v[92:95], v69 offset:32
v_mfma_f32_16x16x32_bf16 v[154:157], a[244:247], v[186:189], v[154:157]
ds_read_b128 v[96:99], v69 offset:48
v_and_b32 v61, 15, v61
v_mfma_f32_16x16x32_bf16 v[158:161], v[232:235], v[182:185], 0
v_lshrrev_b32 v62, 8, v60
v_mul_u32_u24 v63, 1424, v61
v_mfma_f32_16x16x32_bf16 v[158:161], v[236:239], v[186:189], v[158:161]
v_lshl_add_u32 v63, v62, 5, v63
v_add_u32 v63, 94464, v63
v_mfma_f32_16x16x32_bf16 v[162:165], v[182:185], a[72:75], 0
ds_read_b128 v[88:91], v63 offset:128
v_cvt_pk_bf16_f32 v64, v64, v65
v_mfma_f32_16x16x32_bf16 v[162:165], v[186:189], a[76:79], v[162:165]
s_waitcnt lgkmcnt(5)
v_cvt_pk_bf16_f32 v65, v66, v67
v_lshlrev_b32 v67, 5, v61
v_smfmac_f32_16x16x64_bf16 v[48:51], v[174:177], v[100:107], v213
ds_read_b128 v[174:177], v217 offset:2112
ds_read_b128 v[100:103], v70 offset:32
v_mfma_f32_16x16x32_bf16 v[166:169], v[182:185], a[96:99], 0
s_waitcnt lgkmcnt(5)
ds_read_b128 v[104:107], v70 offset:48
v_add_u32 v67, s41, v67
v_mfma_f32_16x16x32_bf16 v[52:55], v[178:181], v[84:87], 0
s_add_u32 s41, s33, 512
ds_read_b128 v[178:181], v217 offset:2640
ds_read_b128 v[84:87], v71 offset:64
v_mfma_f32_16x16x32_bf16 v[166:169], v[186:189], a[100:103], v[166:169]
ds_write_b64 v203, v[64:65] offset:12576
v_mfma_f32_16x16x32_bf16 v[170:173], v[182:185], a[120:123], 0
v_mul_f32_e64 v119, v48, v48
v_add_f32 v118, v48, v49
v_mfma_f32_16x16x32_bf16 v[170:173], v[186:189], a[124:127], v[170:173]
s_waitcnt lgkmcnt(5)
ds_read_b128 v[182:185], v210 offset:4096
ds_read_b128 v[186:189], v210 offset:5120
v_smfmac_f32_16x16x64_bf16 v[52:55], v[174:177], v[92:99], v213
ds_read_b128 v[174:177], v217 offset:3168
v_fmac_f32_e64 v119, v49, v49
v_mfma_f32_16x16x32_bf16 v[138:141], a[8:11], v[110:113], v[138:141]
ds_read_b128 v[92:95], v69 offset:64
v_add_f32 v118, v118, v50
v_mfma_f32_16x16x32_bf16 v[138:141], a[12:15], v[220:223], v[138:141]
s_waitcnt lgkmcnt(6)
ds_read_b128 v[96:99], v69 offset:80
v_fmac_f32_e64 v119, v50, v50
v_smfmac_f32_16x16x64_bf16 v[52:55], v[178:181], v[100:107], v213
ds_read_b128 v[178:181], v217 offset:3696
v_add_f32_e64 v118, v118, v51
v_mfma_f32_16x16x32_bf16 v[142:145], a[32:35], v[110:113], v[142:145]
ds_read_b128 v[100:103], v70 offset:64
v_fmac_f32_e64 v119, v51, v51
v_mfma_f32_16x16x32_bf16 v[142:145], a[36:39], v[220:223], v[142:145]
ds_read_b128 v[104:107], v70 offset:80
v_add_f32_e64 v118, v118, v52
v_mfma_f32_16x16x32_bf16 v[146:149], a[56:59], v[110:113], v[146:149]
s_waitcnt lgkmcnt(8)
v_fmac_f32 v119, v52, v52
v_add_f32_e64 v118, v118, v53
v_mfma_f32_16x16x32_bf16 v[146:149], a[60:63], v[220:223], v[146:149]
s_barrier
v_mfma_f32_16x16x32_bf16 v[150:153], a[224:227], v[110:113], v[150:153]
s_waitcnt lgkmcnt(5)
v_fmac_f32 v119, v53, v53
v_add_f32 v118, v118, v54
v_mfma_f32_16x16x32_bf16 v[56:59], v[174:177], v[84:87], 0
ds_read_b128 v[174:177], v217 offset:4224
ds_read_b128 v[84:87], v63
v_mfma_f32_16x16x32_bf16 v[150:153], a[228:231], v[220:223], v[150:153]
v_fmac_f32 v119, v54, v54
v_add_f32 v118, v118, v55
v_mfma_f32_16x16x32_bf16 v[154:157], a[248:251], v[110:113], v[154:157]
s_waitcnt lgkmcnt(4)
v_fmac_f32 v119, v55, v55
v_lshl_add_u32 v64, v62, 3, v205
v_smfmac_f32_16x16x64_bf16 v[56:59], v[178:181], v[92:99], v213
ds_read_b128 v[92:95], v63 offset:256
ds_read_b128 v[96:99], v63 offset:384
v_mfma_f32_16x16x32_bf16 v[154:157], a[252:255], v[220:223], v[154:157]
ds_read_b64 v[120:121], v204
ds_read_b64 v[128:129], v204 offset:392
v_mfma_f32_16x16x32_bf16 v[158:161], v[240:243], v[110:113], v[158:161]
ds_read_b64 v[136:137], v204 offset:784
v_mul_hi_u32 v68, v67, s42
v_mfma_f32_16x16x32_bf16 v[158:161], v[244:247], v[220:223], v[158:161]
s_waitcnt lgkmcnt(6)
v_mul_u32_u24 v65, 73, v68
v_sub_u32 v65, v67, v65
v_smfmac_f32_16x16x64_bf16 v[56:59], v[174:177], v[100:107], v213
s_mov_b32 s42, 1373568
ds_read_b64 v[100:101], v63 offset:16
ds_read_b64 v[102:103], v63 offset:144
v_mfma_f32_16x16x32_bf16 v[162:165], v[110:113], a[80:83], v[162:165]
ds_read_b64 v[104:105], v63 offset:272
ds_read_b64 v[106:107], v63 offset:400
v_mfma_f32_16x16x32_bf16 v[162:165], v[220:223], a[84:87], v[162:165]
v_add_f32 v118, v118, v56
v_fmac_f32 v119, v56, v56
v_mfma_f32_16x16x32_bf16 v[166:169], v[110:113], a[104:107], v[166:169]
v_add_f32 v118, v118, v57
v_fmac_f32 v119, v57, v57
v_mfma_f32_16x16x32_bf16 v[166:169], v[220:223], a[108:111], v[166:169]
v_add_f32 v118, v118, v58
v_fmac_f32 v119, v58, v58
v_mfma_f32_16x16x32_bf16 v[170:173], v[110:113], a[128:131], v[170:173]
ds_read_b128 v[110:113], v210 offset:6144
v_add_f32_e64 v118, v118, v59
v_mfma_f32_16x16x32_bf16 v[170:173], v[220:223], a[132:135], v[170:173]
ds_read_b128 v[220:223], v210 offset:7168
v_fmac_f32_e64 v119, v59, v59
v_mfma_f32_16x16x32_bf16 v[138:141], a[16:19], v[182:185], v[138:141]
v_permlane16_swap_b32 v118, v119
v_mfma_f32_16x16x32_bf16 v[138:141], a[20:23], v[186:189], v[138:141]
v_add_f32 v118, v118, v119
v_mov_b32 v126, v118
v_mfma_f32_16x16x32_bf16 v[142:145], a[40:43], v[182:185], v[142:145]
v_permlane32_swap_b32 v118, v126
v_mfma_f32_16x16x32_bf16 v[142:145], a[44:47], v[186:189], v[142:145]
v_cvt_pk_bf16_f32 v78, v138, v139
v_cvt_pk_bf16_f32 v79, v140, v141
v_mfma_f32_16x16x32_bf16 v[146:149], a[64:67], v[182:185], v[146:149]
v_add_f32_e64 v118, v118, v126
v_mul_lo_u32 v68, v68, s42
v_mfma_f32_16x16x32_bf16 v[146:149], a[68:71], v[186:189], v[146:149]
s_mul_i32 s42, s32, 96
v_cvt_pk_bf16_f32 v80, v142, v143
v_cvt_pk_bf16_f32 v81, v144, v145
v_mfma_f32_16x16x32_bf16 v[150:153], a[232:235], v[182:185], v[150:153]
ds_write_b32 v209, v118
v_mfma_f32_16x16x32_bf16 v[150:153], a[236:239], v[186:189], v[150:153]
v_cvt_pk_bf16_f32 v82, v146, v147
v_cvt_pk_bf16_f32 v83, v148, v149
v_mfma_f32_16x16x32_bf16 v[154:157], v[224:227], v[182:185], v[154:157]
s_waitcnt lgkmcnt(9)
buffer_store_dwordx2 v[120:121], v204, s[8:11], s28 offen sc1
ds_read_b64 v[120:121], v204 offset:1176
v_mfma_f32_16x16x32_bf16 v[154:157], v[228:231], v[186:189], v[154:157]
s_add_u32 s28, s39, s62
v_cvt_pk_bf16_f32 v72, v150, v151
v_cvt_pk_bf16_f32 v73, v152, v153
v_mfma_f32_16x16x32_bf16 v[158:161], v[248:251], v[182:185], v[158:161]
v_cmp_gt_u32 vcc, s34, v67
v_mul_u32_u24 v65, 2688, v65
v_mfma_f32_16x16x32_bf16 v[158:161], v[252:255], v[186:189], v[158:161]
s_waitcnt lgkmcnt(1)
v_cvt_pk_bf16_f32 v74, v154, v155
v_cvt_pk_bf16_f32 v75, v156, v157
v_mfma_f32_16x16x32_bf16 v[162:165], v[182:185], a[88:91], v[162:165]
s_barrier
v_mfma_f32_16x16x32_bf16 v[162:165], v[186:189], a[92:95], v[162:165]
s_nop 0
v_cvt_pk_bf16_f32 v76, v158, v159
v_cvt_pk_bf16_f32 v77, v160, v161
v_mfma_f32_16x16x32_bf16 v[166:169], v[182:185], a[112:115], v[166:169]
s_nop 0
buffer_store_dwordx2 v[128:129], v204, s[8:11], s29 offen sc1
ds_read_b64 v[128:129], v204 offset:6272
v_mfma_f32_16x16x32_bf16 v[166:169], v[186:189], a[116:119], v[166:169]
s_add_u32 s29, s39, s63
v_cvt_pk_bf16_f32 v114, v162, v163
v_cvt_pk_bf16_f32 v115, v164, v165
v_mfma_f32_16x16x32_bf16 v[170:173], v[182:185], a[136:139], v[170:173]
ds_read_b128 v[182:185], v210 offset:8192
v_add3_u32 v65, v65, v68, s42
v_mfma_f32_16x16x32_bf16 v[170:173], v[186:189], a[140:143], v[170:173]
s_mov_b32 s42, 58835169
ds_read_b128 v[186:189], v210 offset:9216
v_cvt_pk_bf16_f32 v122, v166, v167
v_mfma_f32_16x16x32_bf16 v[138:141], a[0:3], v[110:113], 0
v_cvt_pk_bf16_f32 v123, v168, v169
v_mov_b32 v68, 1879048192
v_mfma_f32_16x16x32_bf16 v[138:141], a[4:7], v[220:223], v[138:141]
v_cvt_pk_bf16_f32 v130, v170, v171
v_cvt_pk_bf16_f32 v131, v172, v173
v_mfma_f32_16x16x32_bf16 v[142:145], a[24:27], v[110:113], 0
s_nop 0
buffer_store_dwordx2 v[136:137], v204, s[8:11], s28 offen sc1
ds_read_b64 v[136:137], v204 offset:6664
v_mfma_f32_16x16x32_bf16 v[142:145], a[28:31], v[220:223], v[142:145]
s_add_u32 s28, s39, s64
v_cndmask_b32 v65, v68, v65, vcc
v_cmp_gt_u32 vcc, 4, v61
v_mfma_f32_16x16x32_bf16 v[146:149], a[48:51], v[110:113], 0
v_lshlrev_b32 v67, 5, v61
v_mov_b32 v68, s97
v_mfma_f32_16x16x32_bf16 v[146:149], a[52:55], v[220:223], v[146:149]
s_waitcnt lgkmcnt(4)
buffer_store_dwordx2 v[120:121], v204, s[8:11], s29 offen sc1
ds_read_b64 v[120:121], v204 offset:7056
v_mfma_f32_16x16x32_bf16 v[150:153], a[216:219], v[110:113], 0
s_add_u32 s29, s39, s65
v_add_u32 v67, s41, v67
v_cndmask_b32 v67, v68, v67, vcc
v_mfma_f32_16x16x32_bf16 v[150:153], a[220:223], v[220:223], v[150:153]
v_cmp_gt_u32 vcc, 5, v61
v_mov_b32 v68, 6000
v_mfma_f32_16x16x32_bf16 v[154:157], a[240:243], v[110:113], 0
s_waitcnt lgkmcnt(4)
buffer_store_dwordx2 v[128:129], v204, s[8:11], s28 offen sc1
ds_read_b64 v[128:129], v204 offset:7448
v_mfma_f32_16x16x32_bf16 v[154:157], a[244:247], v[220:223], v[154:157]
s_waitcnt vmcnt(7) lgkmcnt(2)
v_cndmask_b32 v67, v68, v67, vcc
v_mul_hi_u32 v68, v67, s42
v_mfma_f32_16x16x32_bf16 v[158:161], v[232:235], v[110:113], 0
s_add_u32 s28, s39, s66
v_mul_u32_u24 v66, 73, v68
v_sub_u32 v66, v67, v66
v_mfma_f32_16x16x32_bf16 v[158:161], v[236:239], v[220:223], v[158:161]
s_mov_b32 s42, 1373568
buffer_store_dwordx2 v[136:137], v204, s[8:11], s29 offen sc1
ds_read_b64 v[136:137], v204 offset:12544
v_mfma_f32_16x16x32_bf16 v[36:39], a[144:147], v[84:87], v[36:39]
s_add_u32 s29, s39, s67
v_mul_lo_u32 v68, v68, s42
v_cmp_gt_u32 vcc, s34, v67
v_mfma_f32_16x16x32_bf16 v[36:39], a[148:151], v[88:91], v[36:39]
s_waitcnt lgkmcnt(2)
v_mul_u32_u24 v66, 2688, v66
v_lshl_add_u32 v65, v62, 3, v65
v_mfma_f32_16x16x32_bf16 v[36:39], a[152:155], v[92:95], v[36:39]
s_mul_i32 s42, s32, 96
buffer_store_dwordx2 v[120:121], v204, s[8:11], s28 offen sc1
ds_read_b64 v[120:121], v204 offset:12936
v_mfma_f32_16x16x32_bf16 v[36:39], a[156:159], v[96:99], v[36:39]
s_add_u32 s28, s39, s68
v_add3_u32 v66, v66, v68, s42
v_mov_b32 v68, 1879048192
v_mfma_f32_16x16x32_bf16 v[36:39], a[160:163], v[100:103], v[36:39]
s_nop 0
v_cndmask_b32 v66, v68, v66, vcc
v_lshl_add_u32 v66, v62, 3, v66
v_mfma_f32_16x16x32_bf16 v[36:39], a[164:167], v[104:107], v[36:39]
s_waitcnt lgkmcnt(2)
buffer_store_dwordx2 v[128:129], v204, s[8:11], s29 offen sc1
ds_read_b64 v[128:129], v204 offset:13328
v_mfma_f32_16x16x32_bf16 v[162:165], v[110:113], a[72:75], 0
s_add_u32 s29, s39, s69
v_add_u32 v65, 1047808, v65
v_add_u32 v66, 1047808, v66
v_mfma_f32_16x16x32_bf16 v[162:165], v[220:223], a[76:79], v[162:165]
v_cvt_pk_bf16_f32 v36, v36, v37
v_cvt_pk_bf16_f32 v37, v38, v39
v_mfma_f32_16x16x32_bf16 v[166:169], v[110:113], a[96:99], 0
s_waitcnt lgkmcnt(2)
buffer_store_dwordx2 v[136:137], v204, s[8:11], s28 offen sc1
ds_read_b64 v[136:137], v204 offset:13720
v_mfma_f32_16x16x32_bf16 v[166:169], v[220:223], a[100:103], v[166:169]
s_add_u32 s28, s39, s70
buffer_store_dwordx2 v[36:37], v65, s[8:11], 0 offen
s_waitcnt vmcnt(11)
v_mfma_f32_16x16x32_bf16 v[40:43], a[168:171], v[84:87], v[40:43]
v_mfma_f32_16x16x32_bf16 v[40:43], a[172:175], v[88:91], v[40:43]
v_mfma_f32_16x16x32_bf16 v[40:43], a[176:179], v[92:95], v[40:43]
v_mfma_f32_16x16x32_bf16 v[40:43], a[180:183], v[96:99], v[40:43]
v_mfma_f32_16x16x32_bf16 v[40:43], a[184:187], v[100:103], v[40:43]
v_mfma_f32_16x16x32_bf16 v[40:43], a[188:191], v[104:107], v[40:43]
v_mfma_f32_16x16x32_bf16 v[170:173], v[110:113], a[120:123], 0
ds_read_b128 v[110:113], v210 offset:10240
v_mfma_f32_16x16x32_bf16 v[170:173], v[220:223], a[124:127], v[170:173]
s_waitcnt vmcnt(10)
v_cvt_pk_bf16_f32 v40, v40, v41
v_cvt_pk_bf16_f32 v41, v42, v43
v_mfma_f32_16x16x32_bf16 v[44:47], a[192:195], v[84:87], v[44:47]
v_mfma_f32_16x16x32_bf16 v[44:47], a[196:199], v[88:91], v[44:47]
v_mfma_f32_16x16x32_bf16 v[44:47], a[200:203], v[92:95], v[44:47]
v_mfma_f32_16x16x32_bf16 v[44:47], a[204:207], v[96:99], v[44:47]
v_mfma_f32_16x16x32_bf16 v[44:47], a[208:211], v[100:103], v[44:47]
v_mfma_f32_16x16x32_bf16 v[44:47], a[212:215], v[104:107], v[44:47]
ds_read_b128 v[102:105], v210 offset:18432
ds_read_b128 v[106:109], v210 offset:19456
v_mfma_f32_16x16x32_bf16 v[138:141], a[8:11], v[182:185], v[138:141]
buffer_store_dwordx2 v[40:41], v65, s[8:11], 0 offen offset:32
v_mfma_f32_16x16x32_bf16 v[138:141], a[12:15], v[186:189], v[138:141]
v_cvt_pk_bf16_f32 v44, v44, v45
v_cvt_pk_bf16_f32 v45, v46, v47
v_mfma_f32_16x16x32_bf16 v[142:145], a[32:35], v[182:185], v[142:145]
v_mfma_f32_16x16x32_bf16 v[142:145], a[36:39], v[186:189], v[142:145]
v_mfma_f32_16x16x32_bf16 v[146:149], a[56:59], v[182:185], v[146:149]
s_waitcnt lgkmcnt(1)
v_add_f32 v102, v102, v103
v_add_f32_e64 v104, v104, v105
v_mfma_f32_16x16x32_bf16 v[146:149], a[60:63], v[186:189], v[146:149]
s_waitcnt lgkmcnt(0)
v_add_f32 v106, v106, v107
v_add_f32_e64 v108, v108, v109
v_mfma_f32_16x16x32_bf16 v[150:153], a[224:227], v[182:185], v[150:153]
v_add_f32 v102, v102, v104
v_add_f32 v106, v106, v108
v_mfma_f32_16x16x32_bf16 v[150:153], a[228:231], v[186:189], v[150:153]
v_mul_f32 v103, s48, v102
v_mul_f32 v104, s73, v102
v_mfma_f32_16x16x32_bf16 v[154:157], a[248:251], v[182:185], v[154:157]
v_mul_f32_e64 v106, s73, v106
v_fma_f32 v106, -v103, v104, v106
v_mfma_f32_16x16x32_bf16 v[154:157], a[252:255], v[186:189], v[154:157]
v_max_f32 v106, 0, v106
v_add_f32 v106, s49, v106
v_mfma_f32_16x16x32_bf16 v[158:161], v[240:243], v[182:185], v[158:161]
v_rsq_f32_e64 v102, v106
v_mfma_f32_16x16x32_bf16 v[158:161], v[244:247], v[186:189], v[158:161]
ds_read_b128 v[106:109], v210 offset:11264
v_mul_f32_e64 v103, -v103, v102
v_mfma_f32_16x16x32_bf16 v[162:165], v[182:185], a[80:83], v[162:165]
ds_write_b64 v211, v[102:103] offset:20480
v_mfma_f32_16x16x32_bf16 v[162:165], v[186:189], a[84:87], v[162:165]
v_mfma_f32_16x16x32_bf16 v[166:169], v[182:185], a[104:107], v[166:169]
ds_read_b64 v[118:119], v219 offset:20480
v_mfma_f32_16x16x32_bf16 v[166:169], v[186:189], a[108:111], v[166:169]
buffer_store_dwordx2 v[44:45], v65, s[8:11], 0 offen offset:64
v_mfma_f32_16x16x32_bf16 v[170:173], v[182:185], a[128:131], v[170:173]
v_mfma_f32_16x16x32_bf16 v[170:173], v[186:189], a[132:135], v[170:173]
v_mfma_f32_16x16x32_bf16 v[138:141], a[16:19], v[110:113], v[138:141]
s_waitcnt lgkmcnt(2)
v_mfma_f32_16x16x32_bf16 v[138:141], a[20:23], v[106:109], v[138:141]
s_waitcnt lgkmcnt(0)
v_fma_f32 v220, v48, v118, v119
v_fma_f32 v221, v49, v118, v119
v_mfma_f32_16x16x32_bf16 v[142:145], a[40:43], v[110:113], v[142:145]
v_fma_f32 v222, v50, v118, v119
v_fma_f32 v223, v51, v118, v119
v_mfma_f32_16x16x32_bf16 v[142:145], a[44:47], v[106:109], v[142:145]
v_cvt_pk_bf16_f32 v174, v220, v221
v_cvt_pk_bf16_f32 v175, v222, v223
v_mfma_f32_16x16x32_bf16 v[146:149], a[64:67], v[110:113], v[146:149]
v_fma_f32 v220, v52, v118, v119
v_fma_f32 v221, v53, v118, v119
v_mfma_f32_16x16x32_bf16 v[146:149], a[68:71], v[106:109], v[146:149]
v_fma_f32 v222, v54, v118, v119
v_fma_f32 v223, v55, v118, v119
v_mfma_f32_16x16x32_bf16 v[150:153], a[232:235], v[110:113], v[150:153]
v_cvt_pk_bf16_f32 v176, v220, v221
v_cvt_pk_bf16_f32 v177, v222, v223
v_mfma_f32_16x16x32_bf16 v[150:153], a[236:239], v[106:109], v[150:153]
ds_write_b128 v211, v[174:177] offset:20480
v_mfma_f32_16x16x32_bf16 v[154:157], v[224:227], v[110:113], v[154:157]
v_fma_f32 v220, v56, v118, v119
v_fma_f32 v221, v57, v118, v119
v_mfma_f32_16x16x32_bf16 v[154:157], v[228:231], v[106:109], v[154:157]
v_fma_f32 v222, v58, v118, v119
v_fma_f32 v223, v59, v118, v119
v_mfma_f32_16x16x32_bf16 v[158:161], v[248:251], v[110:113], v[158:161]
v_cvt_pk_bf16_f32 v178, v220, v221
v_cvt_pk_bf16_f32 v179, v222, v223
v_mfma_f32_16x16x32_bf16 v[158:161], v[252:255], v[106:109], v[158:161]
ds_write_b64 v212, v[178:179] offset:20480
v_mfma_f32_16x16x32_bf16 v[162:165], v[110:113], a[88:91], v[162:165]
v_cvt_pk_bf16_f32 v96, v138, v139
v_cvt_pk_bf16_f32 v97, v140, v141
v_mfma_f32_16x16x32_bf16 v[162:165], v[106:109], a[92:95], v[162:165]
v_cvt_pk_bf16_f32 v98, v142, v143
v_cvt_pk_bf16_f32 v99, v144, v145
v_mfma_f32_16x16x32_bf16 v[166:169], v[110:113], a[112:115], v[166:169]
v_cvt_pk_bf16_f32 v100, v146, v147
v_cvt_pk_bf16_f32 v101, v148, v149
v_mfma_f32_16x16x32_bf16 v[166:169], v[106:109], a[116:119], v[166:169]
v_cvt_pk_bf16_f32 v84, v150, v151
v_cvt_pk_bf16_f32 v85, v152, v153
v_mfma_f32_16x16x32_bf16 v[170:173], v[110:113], a[136:139], v[170:173]
v_cvt_pk_bf16_f32 v86, v154, v155
v_cvt_pk_bf16_f32 v87, v156, v157
v_mfma_f32_16x16x32_bf16 v[170:173], v[106:109], a[140:143], v[170:173]
s_waitcnt lgkmcnt(0)
s_barrier
ds_read_b128 v[182:185], v210 offset:20480
ds_read_b128 v[186:189], v210 offset:21504
v_cvt_pk_bf16_f32 v88, v158, v159
v_cvt_pk_bf16_f32 v89, v160, v161
ds_read_b128 v[174:177], v210 offset:22528
ds_read_b128 v[178:181], v210 offset:23552
v_cvt_pk_bf16_f32 v116, v162, v163
v_cvt_pk_bf16_f32 v117, v164, v165
v_cvt_pk_bf16_f32 v124, v166, v167
v_cvt_pk_bf16_f32 v125, v168, v169
v_cvt_pk_bf16_f32 v132, v170, v171
v_cvt_pk_bf16_f32 v133, v172, v173
ds_read_b128 v[220:223], v210 offset:24576
buffer_store_dwordx2 v[120:121], v204, s[8:11], s29 offen sc1
s_add_u32 s29, s39, s71
s_waitcnt lgkmcnt(4)
v_mfma_f32_16x16x32_bf16 v[138:141], a[216:219], v[182:185], 0
s_nop 0
ds_read_b128 v[118:121], v210 offset:25600
s_waitcnt lgkmcnt(4)
v_mfma_f32_16x16x32_bf16 v[138:141], a[220:223], v[186:189], v[138:141]
s_mov_b64 exec, s[56:57]
buffer_load_dwordx4 v[48:51], v210, s[24:27], s59 offen
s_mov_b64 exec, -1
v_mfma_f32_16x16x32_bf16 v[142:145], a[240:243], v[182:185], 0
s_mov_b64 exec, s[56:57]
buffer_load_dwordx4 v[52:55], v210, s[24:27], s59 offen offset:1024
s_mov_b64 exec, -1
v_mfma_f32_16x16x32_bf16 v[142:145], a[244:247], v[186:189], v[142:145]
s_mov_b64 exec, s[56:57]
buffer_load_dwordx4 v[56:59], v210, s[24:27], s59 offen offset:2048
s_mov_b64 exec, -1
v_mfma_f32_16x16x32_bf16 v[146:149], v[232:235], v[182:185], 0
v_mfma_f32_16x16x32_bf16 v[146:149], v[236:239], v[186:189], v[146:149]
v_mfma_f32_16x16x32_bf16 v[150:153], a[0:3], v[182:185], 0
v_mfma_f32_16x16x32_bf16 v[150:153], a[4:7], v[186:189], v[150:153]
v_mfma_f32_16x16x32_bf16 v[154:157], a[24:27], v[182:185], 0
v_mfma_f32_16x16x32_bf16 v[154:157], a[28:31], v[186:189], v[154:157]
v_mfma_f32_16x16x32_bf16 v[158:161], a[48:51], v[182:185], 0
v_mfma_f32_16x16x32_bf16 v[158:161], a[52:55], v[186:189], v[158:161]
v_mfma_f32_16x16x32_bf16 v[162:165], a[72:75], v[182:185], 0
buffer_store_dwordx2 v[128:129], v204, s[8:11], s28 offen sc1
s_add_u32 s28, s38, s60
v_mfma_f32_16x16x32_bf16 v[162:165], a[76:79], v[186:189], v[162:165]
v_mfma_f32_16x16x32_bf16 v[166:169], a[96:99], v[182:185], 0
v_mfma_f32_16x16x32_bf16 v[166:169], a[100:103], v[186:189], v[166:169]
buffer_store_dwordx2 v[136:137], v204, s[8:11], s29 offen sc1
s_add_u32 s29, s38, s61
v_mfma_f32_16x16x32_bf16 v[170:173], a[120:123], v[182:185], 0
ds_read_b128 v[182:185], v210 offset:12288
v_mfma_f32_16x16x32_bf16 v[170:173], a[124:127], v[186:189], v[170:173]
ds_read_b128 v[186:189], v210 offset:13312
s_waitcnt lgkmcnt(5)
v_mfma_f32_16x16x32_bf16 v[138:141], a[224:227], v[174:177], v[138:141]
s_waitcnt lgkmcnt(4)
v_mfma_f32_16x16x32_bf16 v[138:141], a[228:231], v[178:181], v[138:141]
v_mfma_f32_16x16x32_bf16 v[142:145], a[248:251], v[174:177], v[142:145]
v_mfma_f32_16x16x32_bf16 v[142:145], a[252:255], v[178:181], v[142:145]
v_mfma_f32_16x16x32_bf16 v[146:149], v[240:243], v[174:177], v[146:149]
v_mfma_f32_16x16x32_bf16 v[146:149], v[244:247], v[178:181], v[146:149]
v_mfma_f32_16x16x32_bf16 v[150:153], a[8:11], v[174:177], v[150:153]
v_mfma_f32_16x16x32_bf16 v[150:153], a[12:15], v[178:181], v[150:153]
v_mfma_f32_16x16x32_bf16 v[154:157], a[32:35], v[174:177], v[154:157]
v_mfma_f32_16x16x32_bf16 v[154:157], a[36:39], v[178:181], v[154:157]
v_mfma_f32_16x16x32_bf16 v[158:161], a[56:59], v[174:177], v[158:161]
v_mfma_f32_16x16x32_bf16 v[158:161], a[60:63], v[178:181], v[158:161]
v_mfma_f32_16x16x32_bf16 v[162:165], a[80:83], v[174:177], v[162:165]
v_mfma_f32_16x16x32_bf16 v[162:165], a[84:87], v[178:181], v[162:165]
v_mfma_f32_16x16x32_bf16 v[166:169], a[104:107], v[174:177], v[166:169]
v_mfma_f32_16x16x32_bf16 v[166:169], a[108:111], v[178:181], v[166:169]
v_mfma_f32_16x16x32_bf16 v[170:173], a[128:131], v[174:177], v[170:173]
ds_read_b128 v[174:177], v210 offset:14336
v_mfma_f32_16x16x32_bf16 v[170:173], a[132:135], v[178:181], v[170:173]
ds_read_b128 v[178:181], v210 offset:15360
s_waitcnt lgkmcnt(5)
v_mfma_f32_16x16x32_bf16 v[138:141], a[232:235], v[220:223], v[138:141]
s_waitcnt lgkmcnt(4)
v_mfma_f32_16x16x32_bf16 v[138:141], a[236:239], v[118:121], v[138:141]
v_mfma_f32_16x16x32_bf16 v[142:145], v[224:227], v[220:223], v[142:145]
v_mfma_f32_16x16x32_bf16 v[142:145], v[228:231], v[118:121], v[142:145]
v_cvt_pk_bf16_f32 v90, v138, v139
v_cvt_pk_bf16_f32 v91, v140, v141
v_mfma_f32_16x16x32_bf16 v[146:149], v[248:251], v[220:223], v[146:149]
v_mfma_f32_16x16x32_bf16 v[146:149], v[252:255], v[118:121], v[146:149]
v_cvt_pk_bf16_f32 v92, v142, v143
v_cvt_pk_bf16_f32 v93, v144, v145
v_mfma_f32_16x16x32_bf16 v[150:153], a[16:19], v[220:223], v[150:153]
s_mov_b64 exec, s[30:31]
ds_write_b128 v215, v[90:93]
s_mov_b64 exec, -1
v_mfma_f32_16x16x32_bf16 v[150:153], a[20:23], v[118:121], v[150:153]
v_cvt_pk_bf16_f32 v94, v146, v147
v_cvt_pk_bf16_f32 v95, v148, v149
v_mfma_f32_16x16x32_bf16 v[154:157], a[40:43], v[220:223], v[154:157]
s_mov_b64 exec, s[30:31]
ds_write_b64 v215, v[94:95] offset:16
s_mov_b64 exec, -1
v_mfma_f32_16x16x32_bf16 v[154:157], a[44:47], v[118:121], v[154:157]
v_cvt_pk_bf16_f32 v102, v150, v151
v_cvt_pk_bf16_f32 v103, v152, v153
v_mfma_f32_16x16x32_bf16 v[158:161], a[64:67], v[220:223], v[158:161]
v_mfma_f32_16x16x32_bf16 v[158:161], a[68:71], v[118:121], v[158:161]
v_cvt_pk_bf16_f32 v104, v154, v155
v_cvt_pk_bf16_f32 v105, v156, v157
v_mfma_f32_16x16x32_bf16 v[162:165], a[88:91], v[220:223], v[162:165]
s_mov_b64 exec, s[30:31]
ds_write_b128 v215, v[102:105] offset:512
s_mov_b64 exec, -1
v_mfma_f32_16x16x32_bf16 v[162:165], a[92:95], v[118:121], v[162:165]
v_cvt_pk_bf16_f32 v106, v158, v159
v_cvt_pk_bf16_f32 v107, v160, v161
v_mfma_f32_16x16x32_bf16 v[166:169], a[112:115], v[220:223], v[166:169]
s_mov_b64 exec, s[30:31]
ds_write_b64 v215, v[106:107] offset:528
s_mov_b64 exec, -1
v_mfma_f32_16x16x32_bf16 v[166:169], a[116:119], v[118:121], v[166:169]
v_cvt_pk_bf16_f32 v108, v162, v163
v_cvt_pk_bf16_f32 v109, v164, v165
v_mfma_f32_16x16x32_bf16 v[170:173], a[136:139], v[220:223], v[170:173]
v_mfma_f32_16x16x32_bf16 v[170:173], a[140:143], v[118:121], v[170:173]
v_cvt_pk_bf16_f32 v110, v166, v167
v_cvt_pk_bf16_f32 v111, v168, v169
v_mfma_f32_16x16x32_bf16 v[220:223], v[90:93], v[102:105], 0
s_waitcnt lgkmcnt(7)
v_mfma_f32_16x16x32_bf16 v[138:141], a[0:3], v[182:185], 0
s_waitcnt lgkmcnt(6)
v_cvt_pk_bf16_f32 v112, v170, v171
v_cvt_pk_bf16_f32 v113, v172, v173
v_mfma_f32_16x16x32_bf16 v[138:141], a[4:7], v[186:189], v[138:141]
v_mfma_f32_16x16x32_bf16 v[142:145], a[24:27], v[182:185], 0
v_mfma_f32_16x16x16_bf16 v[220:223], v[94:95], v[106:107], v[220:223]
v_mfma_f32_16x16x16_bf16 v[154:157], v[82:83], v[88:89], 0
v_mfma_f32_16x16x16_bf16 v[158:161], v[100:101], v[88:89], 0
s_mov_b64 exec, s[30:31]
ds_write_b32 v215, v220 offset:536
s_mov_b64 exec, -1
v_mfma_f32_16x16x32_bf16 v[142:145], a[28:31], v[186:189], v[142:145]
s_mov_b64 exec, s[30:31]
ds_write_b64 v64, v[108:109]
s_mov_b64 exec, -1
v_mfma_f32_16x16x32_bf16 v[146:149], a[48:51], v[182:185], 0
s_mov_b64 exec, s[30:31]
ds_write_b64 v64, v[110:111] offset:32
s_mov_b64 exec, -1
v_mfma_f32_16x16x32_bf16 v[146:149], a[52:55], v[186:189], v[146:149]
s_waitcnt lgkmcnt(8)
s_mov_b64 exec, s[30:31]
ds_write_b64 v64, v[112:113] offset:64
s_mov_b64 exec, -1
v_mfma_f32_16x16x32_bf16 v[138:141], a[8:11], v[174:177], v[138:141]
s_waitcnt lgkmcnt(8)
ds_read_b64 v[112:113], v215 offset:528
ds_read_b128 v[108:111], v215 offset:512
v_mfma_f32_16x16x32_bf16 v[138:141], a[12:15], v[178:181], v[138:141]
ds_read_b128 v[182:185], v210 offset:16384
ds_read_b128 v[186:189], v210 offset:17408
v_mfma_f32_16x16x32_bf16 v[154:157], v[78:81], v[84:87], v[154:157]
v_mfma_f32_16x16x32_bf16 v[158:161], v[96:99], v[84:87], v[158:161]
v_mfma_f32_16x16x32_bf16 v[142:145], a[32:35], v[174:177], v[142:145]
v_exp_f32_e64 v154, v154
v_mfma_f32_16x16x32_bf16 v[142:145], a[36:39], v[178:181], v[142:145]
v_exp_f32 v155, v155
s_waitcnt lgkmcnt(3)
v_mfma_f32_16x16x16_bf16 v[150:153], v[112:113], v[76:77], v[206:209]
v_exp_f32 v156, v156
s_waitcnt lgkmcnt(2)
v_mfma_f32_16x16x16_bf16 v[166:169], v[112:113], v[88:89], v[206:209]
v_exp_f32 v157, v157
v_exp_f32 v158, v158
v_mfma_f32_16x16x32_bf16 v[150:153], v[108:111], v[72:75], v[150:153]
v_exp_f32 v159, v159
v_mfma_f32_16x16x32_bf16 v[166:169], v[108:111], v[84:87], v[166:169]
v_exp_f32 v160, v160
v_mfma_f32_16x16x32_bf16 v[146:149], a[56:59], v[174:177], v[146:149]
v_exp_f32 v161, v161
v_mfma_f32_16x16x32_bf16 v[146:149], a[60:63], v[178:181], v[146:149]
s_waitcnt lgkmcnt(1)
v_exp_f32 v150, v150
v_mfma_f32_16x16x32_bf16 v[118:121], v[182:185], a[88:91], 0
s_waitcnt lgkmcnt(0)
v_exp_f32_e64 v166, v166
v_mfma_f32_16x16x32_bf16 v[118:121], v[186:189], a[92:95], v[118:121]
v_mfma_f32_16x16x32_bf16 v[126:129], v[182:185], a[112:115], 0
v_mfma_f32_16x16x32_bf16 v[126:129], v[186:189], a[116:119], v[126:129]
v_mfma_f32_16x16x32_bf16 v[134:137], v[182:185], a[136:139], 0
v_mfma_f32_16x16x32_bf16 v[134:137], v[186:189], a[140:143], v[134:137]
v_mfma_f32_16x16x32_bf16 v[90:93], a[232:235], v[182:185], 0
v_mfma_f32_16x16x32_bf16 v[90:93], a[236:239], v[186:189], v[90:93]
v_mfma_f32_16x16x32_bf16 v[170:173], v[224:227], v[182:185], 0
v_mfma_f32_16x16x32_bf16 v[170:173], v[228:231], v[186:189], v[170:173]
v_mfma_f32_16x16x32_bf16 v[138:141], a[16:19], v[182:185], v[138:141]
v_mfma_f32_16x16x32_bf16 v[138:141], a[20:23], v[186:189], v[138:141]
v_mfma_f32_16x16x32_bf16 v[220:223], v[248:251], v[182:185], 0
v_mfma_f32_16x16x32_bf16 v[220:223], v[252:255], v[186:189], v[220:223]
v_cvt_pk_bf16_f32 v102, v138, v139
v_cvt_pk_bf16_f32 v103, v140, v141
v_mfma_f32_16x16x16_bf16 v[138:141], v[82:83], v[76:77], 0
v_mfma_f32_16x16x32_bf16 v[118:121], v[174:177], a[80:83], v[118:121]
v_mfma_f32_16x16x32_bf16 v[138:141], v[78:81], v[72:75], v[138:141]
v_mfma_f32_16x16x32_bf16 v[118:121], v[178:181], a[84:87], v[118:121]
v_mfma_f32_16x16x32_bf16 v[126:129], v[174:177], a[104:107], v[126:129]
v_exp_f32 v138, v138
v_mfma_f32_16x16x32_bf16 v[126:129], v[178:181], a[108:111], v[126:129]
v_exp_f32 v139, v139
v_mfma_f32_16x16x32_bf16 v[142:145], a[40:43], v[182:185], v[142:145]
v_exp_f32 v140, v140
v_mfma_f32_16x16x32_bf16 v[142:145], a[44:47], v[186:189], v[142:145]
v_exp_f32 v141, v141
v_mfma_f32_16x16x32_bf16 v[134:137], v[174:177], a[128:131], v[134:137]
v_mfma_f32_16x16x32_bf16 v[134:137], v[178:181], a[132:135], v[134:137]
v_cvt_pk_bf16_f32 v104, v142, v143
v_cvt_pk_bf16_f32 v105, v144, v145
v_mfma_f32_16x16x16_bf16 v[142:145], v[100:101], v[76:77], 0
v_mfma_f32_16x16x32_bf16 v[90:93], a[224:227], v[174:177], v[90:93]
v_mfma_f32_16x16x32_bf16 v[142:145], v[96:99], v[72:75], v[142:145]
v_mfma_f32_16x16x32_bf16 v[90:93], a[228:231], v[178:181], v[90:93]
v_mfma_f32_16x16x32_bf16 v[170:173], a[248:251], v[174:177], v[170:173]
v_exp_f32 v142, v142
v_mfma_f32_16x16x32_bf16 v[170:173], a[252:255], v[178:181], v[170:173]
v_exp_f32 v143, v143
v_mfma_f32_16x16x32_bf16 v[146:149], a[64:67], v[182:185], v[146:149]
v_exp_f32 v144, v144
v_mfma_f32_16x16x32_bf16 v[146:149], a[68:71], v[186:189], v[146:149]
v_exp_f32 v145, v145
v_mfma_f32_16x16x32_bf16 v[220:223], v[240:243], v[174:177], v[220:223]
v_cvt_pk_bf16_f32 v174, v138, v139
v_cvt_pk_bf16_f32 v175, v140, v141
v_mfma_f32_16x16x32_bf16 v[220:223], v[244:247], v[178:181], v[220:223]
v_cvt_pk_bf16_f32 v106, v146, v147
v_cvt_pk_bf16_f32 v107, v148, v149
v_cvt_pk_bf16_f32 v176, v142, v143
v_cvt_pk_bf16_f32 v177, v144, v145
v_mfma_f32_16x16x16_bf16 v[146:149], v[106:107], v[76:77], 0
v_cvt_pk_bf16_f32 v180, v150, 0
v_mov_b32_e64 v181, 0
v_mfma_f32_16x16x16_bf16 v[162:165], v[106:107], v[88:89], 0
ds_read_b128 v[182:185], v210 offset:12288
ds_read_b128 v[186:189], v210 offset:13312
v_mfma_f32_16x16x32_bf16 v[146:149], v[102:105], v[72:75], v[146:149]
ds_read_b128 v[72:75], v215
ds_read_b64 v[76:77], v215 offset:16
v_mfma_f32_16x16x32_bf16 v[162:165], v[102:105], v[84:87], v[162:165]
v_mfma_f32_16x16x32_bf16 v[150:153], v[190:193], v[174:177], 0
v_exp_f32 v146, v146
v_mfma_f32_16x16x32_bf16 v[138:141], v[114:117], v[174:177], 0
v_exp_f32 v147, v147
v_mfma_f32_16x16x32_bf16 v[142:145], v[122:125], v[174:177], 0
s_waitcnt lgkmcnt(3)
v_exp_f32 v148, v148
v_mfma_f32_16x16x32_bf16 v[118:121], v[182:185], a[72:75], v[118:121]
s_waitcnt lgkmcnt(2)
v_exp_f32 v149, v149
v_mfma_f32_16x16x32_bf16 v[118:121], v[186:189], a[76:79], v[118:121]
v_exp_f32 v162, v162
v_mfma_f32_16x16x32_bf16 v[126:129], v[182:185], a[96:99], v[126:129]
v_exp_f32 v163, v163
v_mfma_f32_16x16x32_bf16 v[126:129], v[186:189], a[100:103], v[126:129]
v_cvt_pk_bf16_f32 v118, v118, v119
v_cvt_pk_bf16_f32 v119, v120, v121
v_mfma_f32_16x16x32_bf16 v[134:137], v[182:185], a[120:123], v[134:137]
ds_read_u16 v120, v205
v_cvt_pk_bf16_f32 v178, v146, v147
v_mfma_f32_16x16x32_bf16 v[134:137], v[186:189], a[124:127], v[134:137]
v_cvt_pk_bf16_f32 v126, v126, v127
v_cvt_pk_bf16_f32 v127, v128, v129
v_mfma_f32_16x16x32_bf16 v[90:93], a[216:219], v[182:185], v[90:93]
ds_read_u16 v128, v205 offset:32
v_cvt_pk_bf16_f32 v179, v148, v149
v_mfma_f32_16x16x32_bf16 v[90:93], a[220:223], v[186:189], v[90:93]
v_cvt_pk_bf16_f32 v134, v134, v135
v_cvt_pk_bf16_f32 v135, v136, v137
v_mfma_f32_16x16x32_bf16 v[170:173], a[240:243], v[182:185], v[170:173]
ds_read_u16 v136, v205 offset:64
v_mov_b32_e64 v121, 0
v_mfma_f32_16x16x32_bf16 v[170:173], a[244:247], v[186:189], v[170:173]
v_cvt_pk_bf16_f32 v90, v90, v91
v_cvt_pk_bf16_f32 v91, v92, v93
v_mfma_f32_16x16x32_bf16 v[220:223], v[232:235], v[182:185], v[220:223]
v_exp_f32_e64 v164, v164
v_mfma_f32_16x16x32_bf16 v[220:223], v[236:239], v[186:189], v[220:223]
v_cvt_pk_bf16_f32 v92, v170, v171
v_cvt_pk_bf16_f32 v93, v172, v173
v_mfma_f32_16x16x32_bf16 v[150:153], v[190:193], v[178:181], v[150:153]
s_waitcnt lgkmcnt(2)
v_exp_f32 v165, v165
v_mfma_f32_16x16x32_bf16 v[138:141], v[118:121], v[178:181], v[138:141]
v_mov_b32 v129, 0
v_mov_b32 v137, 0
v_mfma_f32_16x16x32_bf16 v[146:149], v[130:133], v[174:177], 0
s_waitcnt lgkmcnt(0)
v_rcp_f32 v151, v150
v_mfma_f32_16x16x32_bf16 v[146:149], v[134:137], v[178:181], v[146:149]
v_mul_f32 v152, s3, v151
v_mul_f32 v138, v138, v152
v_mfma_f32_16x16x32_bf16 v[142:145], v[126:129], v[178:181], v[142:145]
v_mul_f32 v139, v139, v152
v_mul_f32 v140, v140, v152
v_mul_f32_e64 v141, v141, v152
v_cvt_pk_bf16_f32 v138, v138, v139
v_cvt_pk_bf16_f32 v174, v154, v155
v_cvt_pk_bf16_f32 v175, v156, v157
v_cvt_pk_bf16_f32 v176, v158, v159
v_cvt_pk_bf16_f32 v177, v160, v161
v_mul_f32 v142, v142, v152
v_mul_f32 v143, v143, v152
v_mfma_f32_16x16x32_bf16 v[154:157], v[114:117], v[174:177], 0
v_mul_f32 v144, v144, v152
v_mul_f32 v145, v145, v152
v_mfma_f32_16x16x32_bf16 v[158:161], v[122:125], v[174:177], 0
v_cvt_pk_bf16_f32 v139, v140, v141
v_cvt_pk_bf16_f32 v140, v142, v143
v_cvt_pk_bf16_f32 v141, v144, v145
v_cvt_pk_bf16_f32 v180, v166, 0
v_mfma_f32_16x16x32_bf16 v[166:169], v[190:193], v[174:177], 0
ds_write_b128 v211, v[138:141] offset:38912
v_mfma_f32_16x16x32_bf16 v[138:141], v[78:81], v[90:93], 0
v_cvt_pk_bf16_f32 v178, v162, v163
v_cvt_pk_bf16_f32 v179, v164, v165
v_mfma_f32_16x16x32_bf16 v[162:165], v[130:133], v[174:177], 0
v_mul_f32 v146, v146, v152
v_mul_f32 v147, v147, v152
v_mfma_f32_16x16x32_bf16 v[166:169], v[190:193], v[178:181], v[166:169]
v_mul_f32 v148, v148, v152
v_mul_f32 v149, v149, v152
v_mfma_f32_16x16x32_bf16 v[154:157], v[118:121], v[178:181], v[154:157]
v_cvt_pk_bf16_f32 v142, v146, v147
v_cvt_pk_bf16_f32 v143, v148, v149
v_mfma_f32_16x16x32_bf16 v[158:161], v[126:129], v[178:181], v[158:161]
ds_write_b64 v212, v[142:143] offset:38912
v_mfma_f32_16x16x32_bf16 v[162:165], v[134:137], v[178:181], v[162:165]
v_rcp_f32 v167, v166
v_mfma_f32_16x16x32_bf16 v[142:145], v[96:99], v[90:93], 0
v_mul_f32 v168, s3, v167
v_mul_f32_e64 v154, v154, v168
v_mfma_f32_16x16x32_bf16 v[146:149], v[102:105], v[90:93], 0
v_mul_f32 v155, v155, v168
v_mul_f32 v156, v156, v168
v_mul_f32_e64 v157, v157, v168
v_cvt_pk_bf16_f32 v154, v154, v155
v_mul_f32 v158, v158, v168
v_mul_f32 v159, v159, v168
v_mul_f32 v160, v160, v168
v_mul_f32 v161, v161, v168
v_cvt_pk_bf16_f32 v155, v156, v157
v_cvt_pk_bf16_f32 v156, v158, v159
v_cvt_pk_bf16_f32 v157, v160, v161
v_mul_f32 v162, v162, v168
v_mul_f32 v163, v163, v168
v_mul_f32 v164, v164, v168
v_mul_f32 v165, v165, v168
v_max3_u32 v218, v218, v150, v151
v_mfma_f32_16x16x32_bf16 v[150:153], v[108:111], v[90:93], v[206:209]
ds_write_b128 v211, v[154:157] offset:45056
v_mfma_f32_16x16x32_bf16 v[154:157], v[72:75], v[78:81], 0
v_cvt_pk_bf16_f32 v158, v162, v163
v_cvt_pk_bf16_f32 v159, v164, v165
v_mfma_f32_16x16x32_bf16 v[162:165], v[72:75], v[102:105], 0
s_nop 0
v_cvt_pk_bf16_f32 v94, v220, v221
v_cvt_pk_bf16_f32 v95, v222, v223
v_max3_u32 v218, v218, v166, v167
s_nop 0
v_mfma_f32_16x16x16_bf16 v[138:141], v[82:83], v[94:95], v[138:141]
ds_write_b64 v212, v[158:159] offset:45056
v_mfma_f32_16x16x16_bf16 v[142:145], v[100:101], v[94:95], v[142:145]
v_add_u32 v205, 1424, v205
v_mfma_f32_16x16x16_bf16 v[150:153], v[112:113], v[94:95], v[150:153]
v_exp_f32_e64 v138, v138
v_mfma_f32_16x16x16_bf16 v[146:149], v[106:107], v[94:95], v[146:149]
v_exp_f32 v139, v139
s_nop 0
v_cvt_pk_bf16_f32 v174, v138, v139
v_mfma_f32_16x16x16_bf16 v[154:157], v[76:77], v[82:83], v[154:157]
v_exp_f32 v140, v140
v_exp_f32 v141, v141
v_mfma_f32_16x16x32_bf16 v[158:161], v[72:75], v[96:99], 0
v_exp_f32 v142, v142
v_exp_f32 v143, v143
v_mfma_f32_16x16x16_bf16 v[162:165], v[76:77], v[106:107], v[162:165]
v_exp_f32 v144, v144
v_cvt_pk_bf16_f32 v175, v140, v141
v_mfma_f32_16x16x16_bf16 v[158:161], v[76:77], v[100:101], v[158:161]
v_exp_f32 v145, v145
v_exp_f32 v150, v150
v_cvt_pk_bf16_f32 v176, v142, v143
v_cvt_pk_bf16_f32 v177, v144, v145
v_cvt_pk_bf16_f32 v180, v150, 0
s_nop 0
v_mfma_f32_16x16x32_bf16 v[150:153], v[190:193], v[174:177], 0
s_waitcnt lgkmcnt(0)
s_barrier
v_mfma_f32_16x16x32_bf16 v[138:141], v[114:117], v[174:177], 0
ds_read_b128 v[220:223], v210 offset:38912
ds_read_b128 v[110:113], v210 offset:39936
v_mfma_f32_16x16x32_bf16 v[142:145], v[122:125], v[174:177], 0
ds_read_b128 v[170:173], v210 offset:40960
ds_read_b128 v[182:185], v210 offset:41984
v_exp_f32 v146, v146
v_exp_f32 v147, v147
v_exp_f32 v148, v148
v_exp_f32 v149, v149
v_cvt_pk_bf16_f32 v178, v146, v147
v_cvt_pk_bf16_f32 v179, v148, v149
v_mfma_f32_16x16x32_bf16 v[146:149], v[130:133], v[174:177], 0
ds_read_b128 v[186:189], v210 offset:43008
ds_read_b32 v166, v215 offset:536
v_mfma_f32_16x16x32_bf16 v[150:153], v[190:193], v[178:181], v[150:153]
v_mov_b32_dpp v154, v158 quad_perm:[0,1,2,3] row_mask:0x2 bank_mask:0xf
v_mfma_f32_16x16x32_bf16 v[138:141], v[118:121], v[178:181], v[138:141]
v_mov_b32_dpp v154, v162 quad_perm:[0,1,2,3] row_mask:0x4 bank_mask:0xf
v_mfma_f32_16x16x32_bf16 v[142:145], v[126:129], v[178:181], v[142:145]
s_waitcnt lgkmcnt(5)
v_rcp_f32 v151, v150
v_mfma_f32_16x16x32_bf16 v[0:3], a[144:147], v[220:223], v[0:3]
s_waitcnt lgkmcnt(4)
v_mul_f32 v152, s3, v151
v_mul_f32_e64 v138, v138, v152
v_mfma_f32_16x16x32_bf16 v[0:3], a[148:151], v[110:113], v[0:3]
s_waitcnt lgkmcnt(3)
v_mul_f32 v139, v139, v152
v_mul_f32 v140, v140, v152
v_mfma_f32_16x16x32_bf16 v[0:3], a[152:155], v[170:173], v[0:3]
s_waitcnt lgkmcnt(0)
v_add_f32_dpp v154, v166, v207 quad_perm:[0,1,2,3] row_mask:0x8 bank_mask:0xf
v_mul_f32_e64 v141, v141, v152
v_mfma_f32_16x16x32_bf16 v[0:3], a[156:159], v[182:185], v[0:3]
v_exp_f32_e64 v166, v154
v_mfma_f32_16x16x32_bf16 v[4:7], a[168:171], v[220:223], v[4:7]
v_cvt_pk_bf16_f32 v154, v166, 0
v_add_f32_dpp v166, v166, v166 row_ror:8 row_mask:0xf bank_mask:0xf
v_mfma_f32_16x16x32_bf16 v[4:7], a[172:175], v[110:113], v[4:7]
ds_write_b16 v214, v154
v_mfma_f32_16x16x32_bf16 v[4:7], a[176:179], v[170:173], v[4:7]
ds_read_b128 v[84:87], v215
ds_read_b128 v[88:91], v215 offset:16
v_mfma_f32_16x16x32_bf16 v[4:7], a[180:183], v[182:185], v[4:7]
v_add_f32_dpp v166, v166, v166 row_ror:4 row_mask:0xf bank_mask:0xf
v_cvt_pk_bf16_f32 v138, v138, v139
v_mfma_f32_16x16x32_bf16 v[8:11], a[192:195], v[220:223], v[8:11]
ds_read_b128 v[220:223], v210 offset:44032
v_add_f32_dpp v166, v166, v166 row_ror:2 row_mask:0xf bank_mask:0xf
v_mfma_f32_16x16x32_bf16 v[8:11], a[196:199], v[110:113], v[8:11]
ds_read_b128 v[110:113], v210 offset:45056
v_add_f32_dpp v166, v166, v166 row_ror:1 row_mask:0xf bank_mask:0xf
v_mfma_f32_16x16x32_bf16 v[8:11], a[200:203], v[170:173], v[8:11]
ds_read_b128 v[170:173], v210 offset:46080
v_add_f32_dpp v166, v166, v166 row_bcast:15 row_mask:0xa bank_mask:0xf
v_mfma_f32_16x16x32_bf16 v[8:11], a[204:207], v[182:185], v[8:11]
ds_read_b128 v[182:185], v210 offset:47104
v_add_f32_dpp v166, v166, v166 row_bcast:31 row_mask:0xc bank_mask:0xf
v_mfma_f32_16x16x32_bf16 v[146:149], v[134:137], v[178:181], v[146:149]
v_readlane_b32 s72, v166, 63
v_mul_f32_e64 v142, v142, v152
v_mfma_f32_16x16x32_bf16 v[0:3], a[160:163], v[186:189], v[0:3]
v_mul_f32 v143, v143, v152
v_mul_f32 v144, v144, v152
v_mfma_f32_16x16x32_bf16 v[4:7], a[184:187], v[186:189], v[4:7]
s_waitcnt lgkmcnt(3)
v_mul_f32 v145, v145, v152
v_cvt_pk_bf16_f32 v139, v140, v141
v_mfma_f32_16x16x32_bf16 v[4:7], a[188:191], v[220:223], v[4:7]
v_rcp_f32 v167, s72
v_mfma_f32_16x16x32_bf16 v[0:3], a[164:167], v[220:223], v[0:3]
s_waitcnt lgkmcnt(2)
v_cvt_pk_bf16_f32 v140, v142, v143
v_cvt_pk_bf16_f32 v141, v144, v145
v_mfma_f32_16x16x32_bf16 v[12:15], a[144:147], v[110:113], v[12:15]
s_waitcnt lgkmcnt(1)
ds_write_b128 v211, v[138:141] offset:51200
v_mfma_f32_16x16x32_bf16 v[12:15], a[148:151], v[170:173], v[12:15]
s_waitcnt lgkmcnt(1)
v_max3_u32 v218, v218, s72, v167
v_max3_u32 v218, v218, v150, v151
v_mfma_f32_16x16x32_bf16 v[12:15], a[152:155], v[182:185], v[12:15]
v_cmp_lt_u32 vcc, 1602224128, v218
v_mul_f32_e64 v146, v146, v152
v_mfma_f32_16x16x32_bf16 v[16:19], a[168:171], v[110:113], v[16:19]
s_or_b32 s41, vcc_lo, vcc_hi
v_mul_f32 v147, v147, v152
v_mul_f32_e64 v148, v148, v152
v_mfma_f32_16x16x32_bf16 v[16:19], a[172:175], v[170:173], v[16:19]
v_mul_f32_e64 v149, v149, v152
v_cvt_pk_bf16_f32 v142, v146, v147
v_mfma_f32_16x16x32_bf16 v[16:19], a[176:179], v[182:185], v[16:19]
v_cvt_pk_bf16_f32 v143, v148, v149
v_mul_f32_e64 v168, s3, v167
v_mfma_f32_16x16x32_bf16 v[20:23], a[192:195], v[110:113], v[20:23]
ds_read_b128 v[110:113], v210 offset:50176
v_mov_b32_e64 v69, s41
v_mfma_f32_16x16x32_bf16 v[20:23], a[196:199], v[170:173], v[20:23]
ds_write_b64 v212, v[142:143] offset:51200
v_mfma_f32_16x16x32_bf16 v[20:23], a[200:203], v[182:185], v[20:23]
v_cvt_pk_bf16_f32 v4, v4, v5
v_cvt_pk_bf16_f32 v0, v0, v1
v_mfma_f32_16x16x32_bf16 v[8:11], a[208:211], v[186:189], v[8:11]
ds_read_b128 v[186:189], v210 offset:48128
v_cvt_pk_bf16_f32 v5, v6, v7
v_mfma_f32_16x16x32_bf16 v[8:11], a[212:215], v[220:223], v[8:11]
ds_read_b128 v[220:223], v210 offset:49152
v_cvt_pk_bf16_f32 v1, v2, v3
v_mfma_f32_16x16x32_bf16 v[154:157], v[84:87], v[114:117], 0
ds_write_b32 v209, v69
v_mfma_f32_16x16x32_bf16 v[154:157], v[88:91], v[118:121], v[154:157]
ds_write_b64 v203, v[4:5] offset:32
v_mfma_f32_16x16x32_bf16 v[158:161], v[84:87], v[122:125], 0
v_cvt_pk_bf16_f32 v8, v8, v9
v_cvt_pk_bf16_f32 v9, v10, v11
v_mfma_f32_16x16x32_bf16 v[158:161], v[88:91], v[126:129], v[158:161]
s_waitcnt lgkmcnt(3)
ds_write_b64 v203, v[0:1]
v_mfma_f32_16x16x32_bf16 v[12:15], a[156:159], v[186:189], v[12:15]
v_add_u32 v215, 1424, v215
s_waitcnt lgkmcnt(3)
v_mfma_f32_16x16x32_bf16 v[12:15], a[160:163], v[220:223], v[12:15]
v_mov_b32_dpp v154, v158 quad_perm:[0,1,2,3] row_mask:0x2 bank_mask:0xf
v_mfma_f32_16x16x32_bf16 v[12:15], a[164:167], v[110:113], v[12:15]
ds_write_b64 v203, v[8:9] offset:64
v_mfma_f32_16x16x32_bf16 v[16:19], a[180:183], v[186:189], v[16:19]
v_mfma_f32_16x16x32_bf16 v[16:19], a[184:187], v[220:223], v[16:19]
v_cvt_pk_bf16_f32 v12, v12, v13
v_cvt_pk_bf16_f32 v13, v14, v15
v_mfma_f32_16x16x32_bf16 v[16:19], a[188:191], v[110:113], v[16:19]
ds_write_b64 v203, v[12:13] offset:6272
v_mfma_f32_16x16x32_bf16 v[20:23], a[204:207], v[186:189], v[20:23]
v_mfma_f32_16x16x32_bf16 v[20:23], a[208:211], v[220:223], v[20:23]
v_cvt_pk_bf16_f32 v16, v16, v17
v_cvt_pk_bf16_f32 v17, v18, v19
v_mfma_f32_16x16x32_bf16 v[20:23], a[212:215], v[110:113], v[20:23]
ds_write_b64 v203, v[16:17] offset:6304
v_mfma_f32_16x16x32_bf16 v[162:165], v[84:87], v[130:133], 0
v_mfma_f32_16x16x32_bf16 v[162:165], v[88:91], v[134:137], v[162:165]
v_cvt_pk_bf16_f32 v20, v20, v21
v_cvt_pk_bf16_f32 v21, v22, v23
ds_write_b64 v203, v[20:21] offset:6336
s_nop 3
v_mov_b32_dpp v154, v162 quad_perm:[0,1,2,3] row_mask:0x4 bank_mask:0xf
v_mul_f32 v154, v154, v168
v_cvt_pk_bf16_f32 v154, v154, 0
ds_write_b16 v214, v154
v_add_u32 v214, 1424, v214
s_waitcnt lgkmcnt(0)
s_barrier
ds_read_b128 v[170:173], v210 offset:51200
ds_read_b128 v[182:185], v210 offset:52224
ds_read_b128 v[84:87], v63 offset:22784
ds_read_b128 v[88:91], v63 offset:22912
ds_read_b128 v[92:95], v63 offset:23040
ds_read_b128 v[96:99], v63 offset:23168
s_waitcnt lgkmcnt(5)
v_mfma_f32_16x16x32_bf16 v[24:27], a[144:147], v[170:173], v[24:27]
ds_read_b64 v[100:101], v63 offset:22800
ds_read_b64 v[102:103], v63 offset:22928
v_mfma_f32_16x16x32_bf16 v[28:31], a[168:171], v[170:173], v[28:31]
s_waitcnt lgkmcnt(6)
ds_read_b64 v[104:105], v63 offset:23056
ds_read_b64 v[106:107], v63 offset:23184
v_mfma_f32_16x16x32_bf16 v[28:31], a[172:175], v[182:185], v[28:31]
s_nop 0
ds_read_b128 v[186:189], v210 offset:53248
ds_read_b128 v[220:223], v210 offset:54272
v_mfma_f32_16x16x32_bf16 v[24:27], a[148:151], v[182:185], v[24:27]
s_waitcnt vmcnt(4) lgkmcnt(9)
ds_read_b128 v[110:113], v210 offset:55296
ds_read_b128 v[174:177], v210 offset:18432
v_mfma_f32_16x16x32_bf16 v[48:51], a[144:147], v[84:87], v[48:51]
s_waitcnt lgkmcnt(10)
v_mfma_f32_16x16x32_bf16 v[48:51], a[148:151], v[88:91], v[48:51]
s_waitcnt lgkmcnt(9)
v_mfma_f32_16x16x32_bf16 v[48:51], a[152:155], v[92:95], v[48:51]
s_waitcnt lgkmcnt(8)
v_mfma_f32_16x16x32_bf16 v[48:51], a[156:159], v[96:99], v[48:51]
s_waitcnt lgkmcnt(6)
v_mfma_f32_16x16x32_bf16 v[48:51], a[160:163], v[100:103], v[48:51]
s_waitcnt lgkmcnt(4)
v_mfma_f32_16x16x32_bf16 v[48:51], a[164:167], v[104:107], v[48:51]
v_mfma_f32_16x16x32_bf16 v[32:35], a[192:195], v[170:173], v[32:35]
ds_read_b128 v[170:173], v210 offset:56320
v_mfma_f32_16x16x32_bf16 v[32:35], a[196:199], v[182:185], v[32:35]
s_waitcnt lgkmcnt(1)
v_or3_b32 v174, v174, v175, v176
v_cvt_pk_bf16_f32 v48, v48, v49
v_mfma_f32_16x16x32_bf16 v[24:27], a[152:155], v[186:189], v[24:27]
v_or_b32 v174, v174, v177
v_cvt_pk_bf16_f32 v49, v50, v51
v_mfma_f32_16x16x32_bf16 v[24:27], a[156:159], v[220:223], v[24:27]
s_waitcnt vmcnt(3)
buffer_store_dwordx2 v[48:49], v66, s[8:11], 0 offen
v_readfirstlane_b32 s43, v174
v_mfma_f32_16x16x32_bf16 v[52:55], a[168:171], v[84:87], v[52:55]
v_mfma_f32_16x16x32_bf16 v[52:55], a[172:175], v[88:91], v[52:55]
v_mfma_f32_16x16x32_bf16 v[52:55], a[176:179], v[92:95], v[52:55]
v_mfma_f32_16x16x32_bf16 v[52:55], a[180:183], v[96:99], v[52:55]
v_mfma_f32_16x16x32_bf16 v[28:31], a[176:179], v[186:189], v[28:31]
v_mfma_f32_16x16x32_bf16 v[28:31], a[180:183], v[220:223], v[28:31]
v_mfma_f32_16x16x32_bf16 v[32:35], a[200:203], v[186:189], v[32:35]
v_mfma_f32_16x16x32_bf16 v[32:35], a[204:207], v[220:223], v[32:35]
v_mfma_f32_16x16x32_bf16 v[52:55], a[184:187], v[100:103], v[52:55]
v_mfma_f32_16x16x32_bf16 v[52:55], a[188:191], v[104:107], v[52:55]
s_waitcnt vmcnt(3)
v_mfma_f32_16x16x32_bf16 v[56:59], a[192:195], v[84:87], v[56:59]
v_mfma_f32_16x16x32_bf16 v[56:59], a[196:199], v[88:91], v[56:59]
v_cvt_pk_bf16_f32 v52, v52, v53
v_cvt_pk_bf16_f32 v53, v54, v55
v_mfma_f32_16x16x32_bf16 v[56:59], a[200:203], v[92:95], v[56:59]
buffer_store_dwordx2 v[52:53], v66, s[8:11], 0 offen offset:32
v_mfma_f32_16x16x32_bf16 v[56:59], a[204:207], v[96:99], v[56:59]
v_mfma_f32_16x16x32_bf16 v[56:59], a[208:211], v[100:103], v[56:59]
v_mfma_f32_16x16x32_bf16 v[56:59], a[212:215], v[104:107], v[56:59]
s_nop 0
v_mfma_f32_16x16x32_bf16 v[24:27], a[160:163], v[110:113], v[24:27]
s_waitcnt lgkmcnt(0)
v_mfma_f32_16x16x32_bf16 v[24:27], a[164:167], v[170:173], v[24:27]
v_cvt_pk_bf16_f32 v56, v56, v57
v_cvt_pk_bf16_f32 v57, v58, v59
v_mfma_f32_16x16x32_bf16 v[28:31], a[184:187], v[110:113], v[28:31]
buffer_store_dwordx2 v[56:57], v66, s[8:11], 0 offen offset:64
v_mfma_f32_16x16x32_bf16 v[28:31], a[188:191], v[170:173], v[28:31]
v_cvt_pk_bf16_f32 v24, v24, v25
v_cvt_pk_bf16_f32 v25, v26, v27
v_mfma_f32_16x16x32_bf16 v[32:35], a[208:211], v[110:113], v[32:35]
ds_write_b64 v203, v[24:25] offset:12544
v_mfma_f32_16x16x32_bf16 v[32:35], a[212:215], v[170:173], v[32:35]
s_nop 0
v_cvt_pk_bf16_f32 v28, v28, v29
v_cvt_pk_bf16_f32 v29, v30, v31
ds_write_b64 v203, v[28:29] offset:12576
s_nop 3
v_cvt_pk_bf16_f32 v32, v32, v33
v_cvt_pk_bf16_f32 v33, v34, v35
ds_write_b64 v203, v[32:33] offset:12608
s_waitcnt lgkmcnt(0)
s_barrier
ds_read_b64 v[120:121], v204
ds_read_b64 v[128:129], v204 offset:392
ds_read_b64 v[136:137], v204 offset:784
s_waitcnt lgkmcnt(2)
buffer_store_dwordx2 v[120:121], v204, s[8:11], s28 offen sc1
s_add_u32 s28, s38, s62
ds_read_b64 v[120:121], v204 offset:1176
s_waitcnt lgkmcnt(2)
buffer_store_dwordx2 v[128:129], v204, s[8:11], s29 offen sc1
s_add_u32 s29, s38, s63
ds_read_b64 v[128:129], v204 offset:6272
s_waitcnt lgkmcnt(2)
buffer_store_dwordx2 v[136:137], v204, s[8:11], s28 offen sc1
s_add_u32 s28, s38, s64
ds_read_b64 v[136:137], v204 offset:6664
s_waitcnt lgkmcnt(2)
buffer_store_dwordx2 v[120:121], v204, s[8:11], s29 offen sc1
s_add_u32 s29, s38, s65
ds_read_b64 v[120:121], v204 offset:7056
s_waitcnt lgkmcnt(2)
buffer_store_dwordx2 v[128:129], v204, s[8:11], s28 offen sc1
s_add_u32 s28, s38, s66
ds_read_b64 v[128:129], v204 offset:7448
s_waitcnt lgkmcnt(2)
buffer_store_dwordx2 v[136:137], v204, s[8:11], s29 offen sc1
s_add_u32 s29, s38, s67
ds_read_b64 v[136:137], v204 offset:12544
s_waitcnt lgkmcnt(2)
buffer_store_dwordx2 v[120:121], v204, s[8:11], s28 offen sc1
s_add_u32 s28, s38, s68
ds_read_b64 v[120:121], v204 offset:12936
s_waitcnt lgkmcnt(2)
buffer_store_dwordx2 v[128:129], v204, s[8:11], s29 offen sc1
s_add_u32 s29, s38, s69
ds_read_b64 v[128:129], v204 offset:13328
s_waitcnt lgkmcnt(2)
buffer_store_dwordx2 v[136:137], v204, s[8:11], s28 offen sc1
s_add_u32 s28, s38, s70
ds_read_b64 v[136:137], v204 offset:13720
s_waitcnt lgkmcnt(2)
buffer_store_dwordx2 v[120:121], v204, s[8:11], s29 offen sc1
s_add_u32 s29, s38, s71
s_waitcnt lgkmcnt(1)
buffer_store_dwordx2 v[128:129], v204, s[8:11], s28 offen sc1
s_waitcnt lgkmcnt(0)
buffer_store_dwordx2 v[136:137], v204, s[8:11], s29 offen sc1
L_fin:
s_nop 1
s_cmp_lg_u32 s43, 0
s_cbranch_scc1 L_redo
L_end:
s_endpgm
.p2align 3
L_tailb:
v_mfma_f32_16x16x32_bf16 v[138:141], a[8:11], v[182:185], v[138:141]
s_add_u32 s28, s38, s60
v_permlane32_swap_b32 v134, v135
v_mfma_f32_16x16x32_bf16 v[138:141], a[12:15], v[186:189], v[138:141]
s_add_u32 s29, s38, s61
v_add_f32 v118, v118, v126
v_add_f32_e64 v134, v134, v135
v_mfma_f32_16x16x32_bf16 v[142:145], a[32:35], v[182:185], v[142:145]
s_add_u32 s41, s33, 0
ds_write_b32 v209, v118
v_mfma_f32_16x16x32_bf16 v[142:145], a[36:39], v[186:189], v[142:145]
s_mov_b32 s42, 58835169
ds_write_b32 v209, v134 offset:512
v_cvt_pk_bf16_f32 v73, v152, v153
v_mfma_f32_16x16x32_bf16 v[150:153], a[216:219], v[110:113], 0
s_mov_b32 s39, s37
v_cvt_pk_bf16_f32 v74, v154, v155
v_cvt_pk_bf16_f32 v75, v156, v157
v_mfma_f32_16x16x32_bf16 v[150:153], a[220:223], v[220:223], v[150:153]
v_cvt_pk_bf16_f32 v76, v158, v159
v_cvt_pk_bf16_f32 v77, v160, v161
v_mfma_f32_16x16x32_bf16 v[154:157], a[240:243], v[110:113], 0
v_cvt_pk_bf16_f32 v114, v162, v163
v_cvt_pk_bf16_f32 v115, v164, v165
v_mfma_f32_16x16x32_bf16 v[154:157], a[244:247], v[220:223], v[154:157]
s_nop 0
v_cvt_pk_bf16_f32 v122, v166, v167
v_cvt_pk_bf16_f32 v123, v168, v169
v_mfma_f32_16x16x32_bf16 v[158:161], v[232:235], v[110:113], 0
s_waitcnt lgkmcnt(0)
v_cvt_pk_bf16_f32 v130, v170, v171
v_cvt_pk_bf16_f32 v131, v172, v173
v_mfma_f32_16x16x32_bf16 v[158:161], v[236:239], v[220:223], v[158:161]
s_barrier
v_mfma_f32_16x16x32_bf16 v[162:165], v[110:113], a[72:75], 0
s_nop 0
ds_read_b128 v[102:105], v210 offset:18432
ds_read_b128 v[106:109], v210 offset:19456
v_mfma_f32_16x16x32_bf16 v[162:165], v[220:223], a[76:79], v[162:165]
v_add_u32 v214, 1424, v214
v_mfma_f32_16x16x32_bf16 v[166:169], v[110:113], a[96:99], 0
v_mfma_f32_16x16x32_bf16 v[166:169], v[220:223], a[100:103], v[166:169]
v_mfma_f32_16x16x32_bf16 v[170:173], v[110:113], a[120:123], 0
ds_read_b128 v[110:113], v210 offset:10240
v_mfma_f32_16x16x32_bf16 v[170:173], v[220:223], a[124:127], v[170:173]
s_waitcnt lgkmcnt(2)
v_add_f32 v102, v102, v103
v_mfma_f32_16x16x32_bf16 v[150:153], a[224:227], v[182:185], v[150:153]
v_add_f32 v104, v104, v105
v_add_f32 v102, v102, v104
v_mfma_f32_16x16x32_bf16 v[150:153], a[228:231], v[186:189], v[150:153]
s_waitcnt lgkmcnt(1)
v_add_f32 v106, v106, v107
v_add_f32_e64 v108, v108, v109
v_mfma_f32_16x16x32_bf16 v[154:157], a[248:251], v[182:185], v[154:157]
v_add_f32 v106, v106, v108
v_mul_f32 v103, s48, v102
v_mfma_f32_16x16x32_bf16 v[154:157], a[252:255], v[186:189], v[154:157]
v_mul_f32 v104, s73, v102
v_mul_f32 v106, s73, v106
v_mfma_f32_16x16x32_bf16 v[158:161], v[240:243], v[182:185], v[158:161]
v_fma_f32 v106, -v103, v104, v106
v_max_f32_e64 v106, 0, v106
v_mfma_f32_16x16x32_bf16 v[158:161], v[244:247], v[186:189], v[158:161]
v_add_f32 v106, s49, v106
v_mfma_f32_16x16x32_bf16 v[162:165], v[182:185], a[80:83], v[162:165]
v_rsq_f32 v102, v106
v_mfma_f32_16x16x32_bf16 v[162:165], v[186:189], a[84:87], v[162:165]
ds_read_b128 v[106:109], v210 offset:11264
v_mul_f32_e64 v103, -v103, v102
v_mfma_f32_16x16x32_bf16 v[166:169], v[182:185], a[104:107], v[166:169]
ds_write_b64 v211, v[102:103] offset:20480
v_mfma_f32_16x16x32_bf16 v[166:169], v[186:189], a[108:111], v[166:169]
v_mfma_f32_16x16x32_bf16 v[170:173], v[182:185], a[128:131], v[170:173]
s_nop 0
ds_read_b128 v[182:185], v210 offset:12288
ds_read_b64 v[118:119], v219 offset:20480
v_mfma_f32_16x16x32_bf16 v[170:173], v[186:189], a[132:135], v[170:173]
s_waitcnt lgkmcnt(4)
ds_read_b128 v[186:189], v210 offset:13312
ds_read_b64 v[126:127], v219 offset:20736
v_mfma_f32_16x16x32_bf16 v[138:141], a[16:19], v[110:113], v[138:141]
ds_read_b64 v[134:135], v219 offset:20992
s_waitcnt lgkmcnt(6)
v_mfma_f32_16x16x32_bf16 v[138:141], a[20:23], v[106:109], v[138:141]
v_mfma_f32_16x16x32_bf16 v[142:145], a[40:43], v[110:113], v[142:145]
v_mfma_f32_16x16x32_bf16 v[142:145], a[44:47], v[106:109], v[142:145]
v_cvt_pk_bf16_f32 v96, v138, v139
v_cvt_pk_bf16_f32 v97, v140, v141
v_mfma_f32_16x16x32_bf16 v[146:149], a[64:67], v[110:113], v[146:149]
s_waitcnt lgkmcnt(3)
v_fma_f32 v220, v36, v118, v119
v_fma_f32 v221, v37, v118, v119
v_mfma_f32_16x16x32_bf16 v[146:149], a[68:71], v[106:109], v[146:149]
v_fma_f32 v222, v38, v118, v119
v_fma_f32 v223, v39, v118, v119
v_mfma_f32_16x16x32_bf16 v[150:153], a[232:235], v[110:113], v[150:153]
v_cvt_pk_bf16_f32 v174, v220, v221
v_cvt_pk_bf16_f32 v175, v222, v223
v_mfma_f32_16x16x32_bf16 v[150:153], a[236:239], v[106:109], v[150:153]
v_cvt_pk_bf16_f32 v100, v146, v147
v_cvt_pk_bf16_f32 v101, v148, v149
v_mfma_f32_16x16x32_bf16 v[154:157], v[224:227], v[110:113], v[154:157]
v_cvt_pk_bf16_f32 v98, v142, v143
v_cvt_pk_bf16_f32 v99, v144, v145
v_mfma_f32_16x16x32_bf16 v[154:157], v[228:231], v[106:109], v[154:157]
v_cvt_pk_bf16_f32 v84, v150, v151
v_cvt_pk_bf16_f32 v85, v152, v153
v_mfma_f32_16x16x32_bf16 v[158:161], v[248:251], v[110:113], v[158:161]
v_fma_f32 v220, v40, v118, v119
v_fma_f32 v221, v41, v118, v119
v_mfma_f32_16x16x32_bf16 v[158:161], v[252:255], v[106:109], v[158:161]
v_fma_f32 v222, v42, v118, v119
v_fma_f32 v223, v43, v118, v119
v_mfma_f32_16x16x32_bf16 v[162:165], v[110:113], a[88:91], v[162:165]
v_cvt_pk_bf16_f32 v176, v220, v221
v_cvt_pk_bf16_f32 v177, v222, v223
v_mfma_f32_16x16x32_bf16 v[162:165], v[106:109], a[92:95], v[162:165]
ds_write_b128 v211, v[174:177] offset:20480
v_mfma_f32_16x16x32_bf16 v[166:169], v[110:113], a[112:115], v[166:169]
v_fma_f32 v220, v44, v118, v119
v_fma_f32 v221, v45, v118, v119
v_mfma_f32_16x16x32_bf16 v[166:169], v[106:109], a[116:119], v[166:169]
v_fma_f32 v222, v46, v118, v119
v_fma_f32 v223, v47, v118, v119
v_mfma_f32_16x16x32_bf16 v[170:173], v[110:113], a[136:139], v[170:173]
ds_read_b64 v[112:113], v215 offset:528
ds_read_b128 v[174:177], v210 offset:14336
v_mfma_f32_16x16x32_bf16 v[170:173], v[106:109], a[140:143], v[170:173]
s_nop 0
ds_read_b128 v[108:111], v215 offset:512
v_cvt_pk_bf16_f32 v178, v220, v221
v_mfma_f32_16x16x32_bf16 v[138:141], a[0:3], v[182:185], 0
s_waitcnt lgkmcnt(6)
v_cvt_pk_bf16_f32 v179, v222, v223
v_cvt_pk_bf16_f32 v88, v158, v159
v_mfma_f32_16x16x32_bf16 v[138:141], a[4:7], v[186:189], v[138:141]
ds_write_b64 v212, v[178:179] offset:20480
v_mfma_f32_16x16x32_bf16 v[142:145], a[24:27], v[182:185], 0
v_cvt_pk_bf16_f32 v89, v160, v161
v_cvt_pk_bf16_f32 v86, v154, v155
v_mfma_f32_16x16x32_bf16 v[142:145], a[28:31], v[186:189], v[142:145]
ds_read_b128 v[178:181], v210 offset:15360
v_cvt_pk_bf16_f32 v87, v156, v157
v_mfma_f32_16x16x32_bf16 v[146:149], a[48:51], v[182:185], 0
ds_read_b128 v[182:185], v210 offset:16384
v_cvt_pk_bf16_f32 v124, v166, v167
v_mfma_f32_16x16x32_bf16 v[146:149], a[52:55], v[186:189], v[146:149]
s_nop 0
ds_read_b128 v[186:189], v210 offset:17408
v_cvt_pk_bf16_f32 v125, v168, v169
s_waitcnt lgkmcnt(5)
v_mfma_f32_16x16x16_bf16 v[150:153], v[112:113], v[76:77], v[206:209]
v_cvt_pk_bf16_f32 v116, v162, v163
v_cvt_pk_bf16_f32 v117, v164, v165
v_fma_f32 v220, v48, v126, v127
v_mfma_f32_16x16x16_bf16 v[154:157], v[82:83], v[88:89], 0
v_fma_f32 v221, v49, v126, v127
v_fma_f32 v222, v50, v126, v127
v_fma_f32 v223, v51, v126, v127
v_mfma_f32_16x16x16_bf16 v[158:161], v[100:101], v[88:89], 0
v_cvt_pk_bf16_f32 v90, v220, v221
v_cvt_pk_bf16_f32 v91, v222, v223
v_fma_f32 v220, v52, v126, v127
v_mfma_f32_16x16x16_bf16 v[166:169], v[112:113], v[88:89], v[206:209]
v_fma_f32 v221, v53, v126, v127
v_fma_f32 v222, v54, v126, v127
v_fma_f32 v223, v55, v126, v127
v_cvt_pk_bf16_f32 v92, v220, v221
v_mfma_f32_16x16x32_bf16 v[138:141], a[8:11], v[174:177], v[138:141]
s_waitcnt lgkmcnt(2)
v_cvt_pk_bf16_f32 v93, v222, v223
v_fma_f32 v220, v56, v126, v127
v_mfma_f32_16x16x32_bf16 v[138:141], a[12:15], v[178:181], v[138:141]
s_nop 0
ds_write_b128 v211, v[90:93] offset:26624
v_mfma_f32_16x16x32_bf16 v[154:157], v[78:81], v[84:87], v[154:157]
v_fma_f32 v221, v57, v126, v127
v_fma_f32 v222, v58, v126, v127
v_mfma_f32_16x16x32_bf16 v[150:153], v[108:111], v[72:75], v[150:153]
v_fma_f32 v223, v59, v126, v127
v_cvt_pk_bf16_f32 v94, v220, v221
v_mfma_f32_16x16x32_bf16 v[158:161], v[96:99], v[84:87], v[158:161]
v_cvt_pk_bf16_f32 v95, v222, v223
v_fma_f32 v220, v60, v134, v135
v_mfma_f32_16x16x32_bf16 v[166:169], v[108:111], v[84:87], v[166:169]
v_fma_f32 v221, v61, v134, v135
v_fma_f32 v222, v62, v134, v135
v_mfma_f32_16x16x32_bf16 v[142:145], a[32:35], v[174:177], v[142:145]
v_fma_f32 v223, v63, v134, v135
v_cvt_pk_bf16_f32 v90, v220, v221
v_mfma_f32_16x16x32_bf16 v[142:145], a[36:39], v[178:181], v[142:145]
v_cvt_pk_bf16_f32 v91, v222, v223
v_fma_f32 v220, v64, v134, v135
v_mfma_f32_16x16x32_bf16 v[146:149], a[56:59], v[174:177], v[146:149]
v_fma_f32 v221, v65, v134, v135
v_fma_f32 v222, v66, v134, v135
v_mfma_f32_16x16x32_bf16 v[146:149], a[60:63], v[178:181], v[146:149]
s_waitcnt lgkmcnt(2)
v_fma_f32 v223, v67, v134, v135
v_cvt_pk_bf16_f32 v92, v220, v221
v_mfma_f32_16x16x32_bf16 v[118:121], v[182:185], a[88:91], 0
s_waitcnt lgkmcnt(1)
v_cvt_pk_bf16_f32 v93, v222, v223
v_fma_f32 v220, v68, v134, v135
v_mfma_f32_16x16x32_bf16 v[118:121], v[186:189], a[92:95], v[118:121]
ds_write_b128 v211, v[90:93] offset:32768
v_mfma_f32_16x16x32_bf16 v[126:129], v[182:185], a[112:115], 0
v_fma_f32 v221, v69, v134, v135
v_fma_f32 v222, v70, v134, v135
v_mfma_f32_16x16x32_bf16 v[126:129], v[186:189], a[116:119], v[126:129]
v_fma_f32 v223, v71, v134, v135
v_cvt_pk_bf16_f32 v132, v170, v171
v_mfma_f32_16x16x32_bf16 v[134:137], v[182:185], a[136:139], 0
ds_write_b64 v212, v[94:95] offset:26624
v_mfma_f32_16x16x32_bf16 v[134:137], v[186:189], a[140:143], v[134:137]
v_cvt_pk_bf16_f32 v133, v172, v173
v_cvt_pk_bf16_f32 v94, v220, v221
v_mfma_f32_16x16x32_bf16 v[90:93], a[232:235], v[182:185], 0
v_exp_f32 v154, v154
v_mfma_f32_16x16x32_bf16 v[90:93], a[236:239], v[186:189], v[90:93]
v_exp_f32 v155, v155
v_mfma_f32_16x16x32_bf16 v[170:173], v[224:227], v[182:185], 0
v_exp_f32 v156, v156
v_mfma_f32_16x16x32_bf16 v[170:173], v[228:231], v[186:189], v[170:173]
v_exp_f32 v157, v157
v_mfma_f32_16x16x32_bf16 v[138:141], a[16:19], v[182:185], v[138:141]
v_exp_f32 v158, v158
v_mfma_f32_16x16x32_bf16 v[138:141], a[20:23], v[186:189], v[138:141]
v_exp_f32 v159, v159
v_mfma_f32_16x16x32_bf16 v[118:121], v[174:177], a[80:83], v[118:121]
v_exp_f32 v160, v160
v_mfma_f32_16x16x32_bf16 v[118:121], v[178:181], a[84:87], v[118:121]
v_cvt_pk_bf16_f32 v102, v138, v139
v_cvt_pk_bf16_f32 v103, v140, v141
v_mfma_f32_16x16x16_bf16 v[138:141], v[82:83], v[76:77], 0
v_exp_f32 v161, v161
v_exp_f32 v150, v150
v_mfma_f32_16x16x32_bf16 v[126:129], v[174:177], a[104:107], v[126:129]
v_exp_f32 v166, v166
v_mfma_f32_16x16x32_bf16 v[138:141], v[78:81], v[72:75], v[138:141]
v_cvt_pk_bf16_f32 v95, v222, v223
v_mfma_f32_16x16x32_bf16 v[220:223], v[248:251], v[182:185], 0
ds_write_b64 v212, v[94:95] offset:32768
v_mfma_f32_16x16x32_bf16 v[220:223], v[252:255], v[186:189], v[220:223]
v_exp_f32 v138, v138
v_mfma_f32_16x16x32_bf16 v[126:129], v[178:181], a[108:111], v[126:129]
v_exp_f32 v139, v139
v_mfma_f32_16x16x32_bf16 v[142:145], a[40:43], v[182:185], v[142:145]
v_exp_f32 v140, v140
v_mfma_f32_16x16x32_bf16 v[142:145], a[44:47], v[186:189], v[142:145]
v_exp_f32 v141, v141
v_mfma_f32_16x16x32_bf16 v[134:137], v[174:177], a[128:131], v[134:137]
v_mfma_f32_16x16x32_bf16 v[134:137], v[178:181], a[132:135], v[134:137]
v_cvt_pk_bf16_f32 v104, v142, v143
v_cvt_pk_bf16_f32 v105, v144, v145
v_mfma_f32_16x16x16_bf16 v[142:145], v[100:101], v[76:77], 0
v_mfma_f32_16x16x32_bf16 v[90:93], a[224:227], v[174:177], v[90:93]
v_mfma_f32_16x16x32_bf16 v[142:145], v[96:99], v[72:75], v[142:145]
v_mfma_f32_16x16x32_bf16 v[90:93], a[228:231], v[178:181], v[90:93]
v_mfma_f32_16x16x32_bf16 v[170:173], a[248:251], v[174:177], v[170:173]
v_exp_f32 v142, v142
v_mfma_f32_16x16x32_bf16 v[170:173], a[252:255], v[178:181], v[170:173]
v_exp_f32 v143, v143
v_mfma_f32_16x16x32_bf16 v[146:149], a[64:67], v[182:185], v[146:149]
v_exp_f32 v144, v144
v_mfma_f32_16x16x32_bf16 v[146:149], a[68:71], v[186:189], v[146:149]
v_exp_f32 v145, v145
v_mfma_f32_16x16x32_bf16 v[220:223], v[240:243], v[174:177], v[220:223]
v_cvt_pk_bf16_f32 v174, v138, v139
v_cvt_pk_bf16_f32 v175, v140, v141
v_mfma_f32_16x16x32_bf16 v[220:223], v[244:247], v[178:181], v[220:223]
v_cvt_pk_bf16_f32 v106, v146, v147
v_cvt_pk_bf16_f32 v107, v148, v149
v_cvt_pk_bf16_f32 v176, v142, v143
v_cvt_pk_bf16_f32 v177, v144, v145
v_mfma_f32_16x16x16_bf16 v[146:149], v[106:107], v[76:77], 0
v_cvt_pk_bf16_f32 v180, v150, 0
v_mov_b32_e64 v181, 0
v_mfma_f32_16x16x16_bf16 v[162:165], v[106:107], v[88:89], 0
ds_read_b128 v[182:185], v210 offset:12288
ds_read_b128 v[186:189], v210 offset:13312
v_mfma_f32_16x16x32_bf16 v[146:149], v[102:105], v[72:75], v[146:149]
ds_read_b128 v[72:75], v215
ds_read_b64 v[76:77], v215 offset:16
v_mfma_f32_16x16x32_bf16 v[162:165], v[102:105], v[84:87], v[162:165]
v_mfma_f32_16x16x32_bf16 v[150:153], v[190:193], v[174:177], 0
v_exp_f32 v146, v146
v_mfma_f32_16x16x32_bf16 v[138:141], v[114:117], v[174:177], 0
v_exp_f32 v147, v147
v_mfma_f32_16x16x32_bf16 v[142:145], v[122:125], v[174:177], 0
s_waitcnt lgkmcnt(3)
v_exp_f32 v148, v148
v_mfma_f32_16x16x32_bf16 v[118:121], v[182:185], a[72:75], v[118:121]
s_waitcnt lgkmcnt(2)
v_exp_f32 v149, v149
v_mfma_f32_16x16x32_bf16 v[118:121], v[186:189], a[76:79], v[118:121]
v_exp_f32 v162, v162
v_mfma_f32_16x16x32_bf16 v[126:129], v[182:185], a[96:99], v[126:129]
v_exp_f32 v163, v163
v_mfma_f32_16x16x32_bf16 v[126:129], v[186:189], a[100:103], v[126:129]
v_cvt_pk_bf16_f32 v118, v118, v119
v_cvt_pk_bf16_f32 v119, v120, v121
v_mfma_f32_16x16x32_bf16 v[134:137], v[182:185], a[120:123], v[134:137]
ds_read_u16 v120, v205
v_cvt_pk_bf16_f32 v178, v146, v147
v_mfma_f32_16x16x32_bf16 v[134:137], v[186:189], a[124:127], v[134:137]
v_cvt_pk_bf16_f32 v126, v126, v127
v_cvt_pk_bf16_f32 v127, v128, v129
v_mfma_f32_16x16x32_bf16 v[90:93], a[216:219], v[182:185], v[90:93]
ds_read_u16 v128, v205 offset:32
v_cvt_pk_bf16_f32 v179, v148, v149
v_mfma_f32_16x16x32_bf16 v[90:93], a[220:223], v[186:189], v[90:93]
v_cvt_pk_bf16_f32 v134, v134, v135
v_cvt_pk_bf16_f32 v135, v136, v137
v_mfma_f32_16x16x32_bf16 v[170:173], a[240:243], v[182:185], v[170:173]
ds_read_u16 v136, v205 offset:64
v_mov_b32_e64 v121, 0
v_mfma_f32_16x16x32_bf16 v[170:173], a[244:247], v[186:189], v[170:173]
v_cvt_pk_bf16_f32 v90, v90, v91
v_cvt_pk_bf16_f32 v91, v92, v93
v_mfma_f32_16x16x32_bf16 v[220:223], v[232:235], v[182:185], v[220:223]
v_exp_f32_e64 v164, v164
v_mfma_f32_16x16x32_bf16 v[220:223], v[236:239], v[186:189], v[220:223]
v_cvt_pk_bf16_f32 v92, v170, v171
v_cvt_pk_bf16_f32 v93, v172, v173
v_mfma_f32_16x16x32_bf16 v[150:153], v[190:193], v[178:181], v[150:153]
s_waitcnt lgkmcnt(2)
v_exp_f32 v165, v165
v_mfma_f32_16x16x32_bf16 v[138:141], v[118:121], v[178:181], v[138:141]
v_mov_b32 v129, 0
v_mov_b32 v137, 0
v_mfma_f32_16x16x32_bf16 v[146:149], v[130:133], v[174:177], 0
s_waitcnt lgkmcnt(0)
v_rcp_f32 v151, v150
v_mfma_f32_16x16x32_bf16 v[146:149], v[134:137], v[178:181], v[146:149]
v_mul_f32 v152, s3, v151
v_mul_f32 v138, v138, v152
v_mfma_f32_16x16x32_bf16 v[142:145], v[126:129], v[178:181], v[142:145]
v_mul_f32 v139, v139, v152
v_mul_f32 v140, v140, v152
v_mul_f32_e64 v141, v141, v152
v_cvt_pk_bf16_f32 v138, v138, v139
v_cvt_pk_bf16_f32 v174, v154, v155
v_cvt_pk_bf16_f32 v175, v156, v157
v_cvt_pk_bf16_f32 v176, v158, v159
v_cvt_pk_bf16_f32 v177, v160, v161
v_mul_f32 v142, v142, v152
v_mul_f32 v143, v143, v152
v_mfma_f32_16x16x32_bf16 v[154:157], v[114:117], v[174:177], 0
v_mul_f32 v144, v144, v152
v_mul_f32 v145, v145, v152
v_mfma_f32_16x16x32_bf16 v[158:161], v[122:125], v[174:177], 0
v_cvt_pk_bf16_f32 v139, v140, v141
v_cvt_pk_bf16_f32 v140, v142, v143
v_cvt_pk_bf16_f32 v141, v144, v145
v_cvt_pk_bf16_f32 v180, v166, 0
v_mfma_f32_16x16x32_bf16 v[166:169], v[190:193], v[174:177], 0
ds_write_b128 v211, v[138:141] offset:38912
v_mfma_f32_16x16x32_bf16 v[138:141], v[78:81], v[90:93], 0
v_cvt_pk_bf16_f32 v178, v162, v163
v_cvt_pk_bf16_f32 v179, v164, v165
v_mfma_f32_16x16x32_bf16 v[162:165], v[130:133], v[174:177], 0
v_mul_f32 v146, v146, v152
v_mul_f32 v147, v147, v152
v_mfma_f32_16x16x32_bf16 v[166:169], v[190:193], v[178:181], v[166:169]
v_mul_f32 v148, v148, v152
v_mul_f32 v149, v149, v152
v_mfma_f32_16x16x32_bf16 v[154:157], v[118:121], v[178:181], v[154:157]
v_cvt_pk_bf16_f32 v142, v146, v147
v_cvt_pk_bf16_f32 v143, v148, v149
v_mfma_f32_16x16x32_bf16 v[158:161], v[126:129], v[178:181], v[158:161]
ds_write_b64 v212, v[142:143] offset:38912
v_mfma_f32_16x16x32_bf16 v[162:165], v[134:137], v[178:181], v[162:165]
v_rcp_f32 v167, v166
v_mfma_f32_16x16x32_bf16 v[142:145], v[96:99], v[90:93], 0
v_mul_f32 v168, s3, v167
v_mul_f32_e64 v154, v154, v168
v_mfma_f32_16x16x32_bf16 v[146:149], v[102:105], v[90:93], 0
v_mul_f32 v155, v155, v168
v_mul_f32 v156, v156, v168
v_mul_f32_e64 v157, v157, v168
v_cvt_pk_bf16_f32 v154, v154, v155
v_mul_f32 v158, v158, v168
v_mul_f32 v159, v159, v168
v_mul_f32 v160, v160, v168
v_mul_f32 v161, v161, v168
v_cvt_pk_bf16_f32 v155, v156, v157
v_cvt_pk_bf16_f32 v156, v158, v159
v_cvt_pk_bf16_f32 v157, v160, v161
v_mul_f32 v162, v162, v168
v_mul_f32 v163, v163, v168
v_mul_f32 v164, v164, v168
v_mul_f32 v165, v165, v168
v_max3_u32 v218, v218, v150, v151
v_mfma_f32_16x16x32_bf16 v[150:153], v[108:111], v[90:93], v[206:209]
ds_write_b128 v211, v[154:157] offset:45056
v_mfma_f32_16x16x32_bf16 v[154:157], v[72:75], v[78:81], 0
v_cvt_pk_bf16_f32 v158, v162, v163
v_cvt_pk_bf16_f32 v159, v164, v165
v_mfma_f32_16x16x32_bf16 v[162:165], v[72:75], v[102:105], 0
s_nop 0
v_cvt_pk_bf16_f32 v94, v220, v221
v_cvt_pk_bf16_f32 v95, v222, v223
v_max3_u32 v218, v218, v166, v167
s_nop 0
v_mfma_f32_16x16x16_bf16 v[138:141], v[82:83], v[94:95], v[138:141]
ds_write_b64 v212, v[158:159] offset:45056
v_mfma_f32_16x16x16_bf16 v[142:145], v[100:101], v[94:95], v[142:145]
v_add_u32 v205, 1424, v205
v_mfma_f32_16x16x16_bf16 v[150:153], v[112:113], v[94:95], v[150:153]
v_exp_f32_e64 v138, v138
v_mfma_f32_16x16x16_bf16 v[146:149], v[106:107], v[94:95], v[146:149]
v_exp_f32 v139, v139
s_nop 0
v_cvt_pk_bf16_f32 v174, v138, v139
v_mfma_f32_16x16x16_bf16 v[154:157], v[76:77], v[82:83], v[154:157]
v_exp_f32 v140, v140
v_exp_f32 v141, v141
v_mfma_f32_16x16x32_bf16 v[158:161], v[72:75], v[96:99], 0
v_exp_f32 v142, v142
v_exp_f32 v143, v143
v_mfma_f32_16x16x16_bf16 v[162:165], v[76:77], v[106:107], v[162:165]
v_exp_f32 v144, v144
v_cvt_pk_bf16_f32 v175, v140, v141
v_mfma_f32_16x16x16_bf16 v[158:161], v[76:77], v[100:101], v[158:161]
v_exp_f32 v145, v145
v_exp_f32 v150, v150
v_cvt_pk_bf16_f32 v176, v142, v143
v_cvt_pk_bf16_f32 v177, v144, v145
v_cvt_pk_bf16_f32 v180, v150, 0
s_nop 0
v_mfma_f32_16x16x32_bf16 v[150:153], v[190:193], v[174:177], 0
s_waitcnt lgkmcnt(0)
s_barrier
v_mfma_f32_16x16x32_bf16 v[138:141], v[114:117], v[174:177], 0
ds_read_b128 v[220:223], v210 offset:38912
ds_read_b128 v[110:113], v210 offset:39936
v_mfma_f32_16x16x32_bf16 v[142:145], v[122:125], v[174:177], 0
ds_read_b128 v[170:173], v210 offset:40960
ds_read_b128 v[182:185], v210 offset:41984
v_exp_f32 v146, v146
v_exp_f32 v147, v147
v_exp_f32 v148, v148
v_exp_f32 v149, v149
v_cvt_pk_bf16_f32 v178, v146, v147
v_cvt_pk_bf16_f32 v179, v148, v149
v_mfma_f32_16x16x32_bf16 v[146:149], v[130:133], v[174:177], 0
ds_read_b128 v[186:189], v210 offset:43008
ds_read_b32 v166, v215 offset:536
v_mfma_f32_16x16x32_bf16 v[150:153], v[190:193], v[178:181], v[150:153]
v_mov_b32_dpp v154, v158 quad_perm:[0,1,2,3] row_mask:0x2 bank_mask:0xf
v_mfma_f32_16x16x32_bf16 v[138:141], v[118:121], v[178:181], v[138:141]
v_mov_b32_dpp v154, v162 quad_perm:[0,1,2,3] row_mask:0x4 bank_mask:0xf
v_mfma_f32_16x16x32_bf16 v[142:145], v[126:129], v[178:181], v[142:145]
s_waitcnt lgkmcnt(5)
v_rcp_f32 v151, v150
v_mfma_f32_16x16x32_bf16 v[0:3], a[144:147], v[220:223], v[0:3]
s_waitcnt lgkmcnt(4)
v_mul_f32 v152, s3, v151
v_mul_f32_e64 v138, v138, v152
v_mfma_f32_16x16x32_bf16 v[0:3], a[148:151], v[110:113], v[0:3]
s_waitcnt lgkmcnt(3)
v_mul_f32 v139, v139, v152
v_mul_f32_e64 v140, v140, v152
v_mfma_f32_16x16x32_bf16 v[0:3], a[152:155], v[170:173], v[0:3]
s_waitcnt lgkmcnt(2)
v_mul_f32 v141, v141, v152
v_cvt_pk_bf16_f32 v138, v138, v139
v_mfma_f32_16x16x32_bf16 v[0:3], a[156:159], v[182:185], v[0:3]
v_mul_f32 v142, v142, v152
v_mul_f32 v143, v143, v152
v_mfma_f32_16x16x32_bf16 v[4:7], a[168:171], v[220:223], v[4:7]
v_mul_f32 v144, v144, v152
v_mul_f32 v145, v145, v152
v_mfma_f32_16x16x32_bf16 v[4:7], a[172:175], v[110:113], v[4:7]
s_nop 0
v_cvt_pk_bf16_f32 v139, v140, v141
v_cvt_pk_bf16_f32 v140, v142, v143
v_mfma_f32_16x16x32_bf16 v[4:7], a[176:179], v[170:173], v[4:7]
s_waitcnt lgkmcnt(0)
v_cvt_pk_bf16_f32 v141, v144, v145
v_add_f32_dpp v154, v166, v207 quad_perm:[0,1,2,3] row_mask:0x8 bank_mask:0xf
v_mfma_f32_16x16x32_bf16 v[4:7], a[180:183], v[182:185], v[4:7]
ds_write_b128 v211, v[138:141] offset:51200
v_mfma_f32_16x16x32_bf16 v[8:11], a[192:195], v[220:223], v[8:11]
v_exp_f32_e64 v166, v154
v_mfma_f32_16x16x32_bf16 v[8:11], a[196:199], v[110:113], v[8:11]
v_cvt_pk_bf16_f32 v154, v166, 0
v_add_f32_dpp v166, v166, v166 row_ror:8 row_mask:0xf bank_mask:0xf
v_mfma_f32_16x16x32_bf16 v[8:11], a[200:203], v[170:173], v[8:11]
ds_read_b128 v[220:223], v210 offset:44032
ds_read_b128 v[110:113], v210 offset:45056
v_mfma_f32_16x16x32_bf16 v[8:11], a[204:207], v[182:185], v[8:11]
ds_read_b128 v[170:173], v210 offset:46080
ds_read_b128 v[182:185], v210 offset:47104
v_mfma_f32_16x16x32_bf16 v[146:149], v[134:137], v[178:181], v[146:149]
ds_write_b16 v214, v154
v_mfma_f32_16x16x32_bf16 v[0:3], a[160:163], v[186:189], v[0:3]
ds_read_b128 v[84:87], v215
ds_read_b128 v[88:91], v215 offset:16
v_mfma_f32_16x16x32_bf16 v[4:7], a[184:187], v[186:189], v[4:7]
v_mul_f32 v146, v146, v152
v_mul_f32 v147, v147, v152
v_mfma_f32_16x16x32_bf16 v[8:11], a[208:211], v[186:189], v[8:11]
ds_read_b128 v[186:189], v210 offset:48128
v_mul_f32 v148, v148, v152
v_mul_f32 v149, v149, v152
v_cvt_pk_bf16_f32 v142, v146, v147
s_waitcnt lgkmcnt(7)
v_mfma_f32_16x16x32_bf16 v[0:3], a[164:167], v[220:223], v[0:3]
s_waitcnt lgkmcnt(6)
v_cvt_pk_bf16_f32 v143, v148, v149
v_add_f32_dpp v166, v166, v166 row_ror:4 row_mask:0xf bank_mask:0xf
v_mfma_f32_16x16x32_bf16 v[12:15], a[144:147], v[110:113], v[12:15]
s_waitcnt lgkmcnt(5)
ds_write_b64 v212, v[142:143] offset:51200
v_mfma_f32_16x16x32_bf16 v[12:15], a[148:151], v[170:173], v[12:15]
s_waitcnt lgkmcnt(5)
v_cvt_pk_bf16_f32 v0, v0, v1
v_cvt_pk_bf16_f32 v1, v2, v3
v_mfma_f32_16x16x32_bf16 v[12:15], a[152:155], v[182:185], v[12:15]
ds_write_b64 v203, v[0:1]
v_mfma_f32_16x16x32_bf16 v[4:7], a[188:191], v[220:223], v[4:7]
buffer_load_dwordx4 v[0:3], v210, s[24:27], s58 offen
v_mfma_f32_16x16x32_bf16 v[16:19], a[168:171], v[110:113], v[16:19]
v_add_f32_dpp v166, v166, v166 row_ror:2 row_mask:0xf bank_mask:0xf
v_add_u32 v215, 1424, v215
v_mfma_f32_16x16x32_bf16 v[16:19], a[172:175], v[170:173], v[16:19]
v_cvt_pk_bf16_f32 v4, v4, v5
v_cvt_pk_bf16_f32 v5, v6, v7
v_mfma_f32_16x16x32_bf16 v[16:19], a[176:179], v[182:185], v[16:19]
s_waitcnt lgkmcnt(1)
ds_write_b64 v203, v[4:5] offset:32
v_mfma_f32_16x16x32_bf16 v[16:19], a[180:183], v[186:189], v[16:19]
s_barrier
v_mfma_f32_16x16x32_bf16 v[20:23], a[192:195], v[110:113], v[20:23]
ds_read_b128 v[110:113], v210 offset:50176
v_add_f32_dpp v166, v166, v166 row_ror:1 row_mask:0xf bank_mask:0xf
v_mfma_f32_16x16x32_bf16 v[20:23], a[196:199], v[170:173], v[20:23]
ds_read_b128 v[170:173], v210 offset:51200
v_add_f32_dpp v166, v166, v166 row_bcast:15 row_mask:0xa bank_mask:0xf
v_mfma_f32_16x16x32_bf16 v[20:23], a[200:203], v[182:185], v[20:23]
ds_read_b128 v[182:185], v210 offset:52224
v_add_f32_dpp v166, v166, v166 row_bcast:31 row_mask:0xc bank_mask:0xf
v_mfma_f32_16x16x32_bf16 v[20:23], a[204:207], v[186:189], v[20:23]
buffer_load_dwordx4 v[4:7], v210, s[24:27], s58 offen offset:1024
v_mfma_f32_16x16x32_bf16 v[12:15], a[156:159], v[186:189], v[12:15]
ds_read_b128 v[186:189], v210 offset:53248
v_readlane_b32 s72, v166, 63
v_mfma_f32_16x16x32_bf16 v[8:11], a[212:215], v[220:223], v[8:11]
ds_read_b128 v[220:223], v210 offset:49152
ds_read_b128 v[174:177], v210 offset:34816
v_mfma_f32_16x16x32_bf16 v[154:157], v[84:87], v[114:117], 0
v_rcp_f32_e64 v167, s72
v_mfma_f32_16x16x32_bf16 v[154:157], v[88:91], v[118:121], v[154:157]
v_cvt_pk_bf16_f32 v8, v8, v9
v_cvt_pk_bf16_f32 v9, v10, v11
v_mfma_f32_16x16x32_bf16 v[158:161], v[84:87], v[122:125], 0
ds_write_b64 v203, v[8:9] offset:64
v_mfma_f32_16x16x32_bf16 v[158:161], v[88:91], v[126:129], v[158:161]
s_nop 0
buffer_load_dwordx4 v[8:11], v210, s[24:27], s58 offen offset:2048
v_mfma_f32_16x16x32_bf16 v[162:165], v[84:87], v[130:133], 0
s_waitcnt lgkmcnt(2)
v_max3_u32 v218, v218, s72, v167
v_max3_u32 v218, v218, v150, v151
v_mfma_f32_16x16x32_bf16 v[12:15], a[160:163], v[220:223], v[12:15]
v_mov_b32_dpp v154, v158 quad_perm:[0,1,2,3] row_mask:0x2 bank_mask:0xf
v_mul_f32_e64 v168, s3, v167
v_mfma_f32_16x16x32_bf16 v[12:15], a[164:167], v[110:113], v[12:15]
ds_read_b128 v[178:181], v210 offset:35840
v_mfma_f32_16x16x32_bf16 v[16:19], a[184:187], v[220:223], v[16:19]
v_mfma_f32_16x16x32_bf16 v[16:19], a[188:191], v[110:113], v[16:19]
v_cvt_pk_bf16_f32 v12, v12, v13
v_cvt_pk_bf16_f32 v13, v14, v15
v_mfma_f32_16x16x32_bf16 v[20:23], a[208:211], v[220:223], v[20:23]
ds_read_b128 v[220:223], v210 offset:54272
v_mfma_f32_16x16x32_bf16 v[20:23], a[212:215], v[110:113], v[20:23]
ds_read_b128 v[110:113], v210 offset:55296
v_cvt_pk_bf16_f32 v16, v16, v17
v_mfma_f32_16x16x32_bf16 v[162:165], v[88:91], v[134:137], v[162:165]
ds_write_b64 v203, v[12:13] offset:6272
v_mfma_f32_16x16x32_bf16 v[24:27], a[144:147], v[170:173], v[24:27]
v_cvt_pk_bf16_f32 v20, v20, v21
v_cvt_pk_bf16_f32 v17, v18, v19
v_mfma_f32_16x16x32_bf16 v[24:27], a[148:151], v[182:185], v[24:27]
v_mov_b32_dpp v154, v162 quad_perm:[0,1,2,3] row_mask:0x4 bank_mask:0xf
v_mul_f32 v154, v154, v168
v_mfma_f32_16x16x32_bf16 v[24:27], a[152:155], v[186:189], v[24:27]
s_waitcnt lgkmcnt(2)
v_cvt_pk_bf16_f32 v154, v154, 0
v_cvt_pk_bf16_f32 v21, v22, v23
v_mfma_f32_16x16x32_bf16 v[24:27], a[156:159], v[220:223], v[24:27]
ds_write_b16 v214, v154
v_mfma_f32_16x16x32_bf16 v[28:31], a[168:171], v[170:173], v[28:31]
ds_write_b64 v203, v[16:17] offset:6304
v_mfma_f32_16x16x32_bf16 v[28:31], a[172:175], v[182:185], v[28:31]
buffer_load_dwordx4 v[12:15], v210, s[24:27], s59 offen
v_mfma_f32_16x16x32_bf16 v[28:31], a[176:179], v[186:189], v[28:31]
ds_write_b64 v203, v[20:21] offset:6336
v_mfma_f32_16x16x32_bf16 v[28:31], a[180:183], v[220:223], v[28:31]
buffer_load_dwordx4 v[16:19], v210, s[24:27], s59 offen offset:1024
v_mfma_f32_16x16x32_bf16 v[32:35], a[192:195], v[170:173], v[32:35]
ds_read_b128 v[170:173], v210 offset:56320
v_add_u32 v214, 1424, v214
v_mfma_f32_16x16x32_bf16 v[32:35], a[196:199], v[182:185], v[32:35]
ds_read_b128 v[182:185], v210 offset:20480
v_mfma_f32_16x16x32_bf16 v[32:35], a[200:203], v[186:189], v[32:35]
ds_read_b128 v[186:189], v210 offset:21504
v_mfma_f32_16x16x32_bf16 v[32:35], a[204:207], v[220:223], v[32:35]
s_nop 0
ds_read_b128 v[220:223], v210 offset:23552
s_waitcnt lgkmcnt(8)
v_mfma_f32_16x16x32_bf16 v[32:35], a[208:211], v[110:113], v[32:35]
buffer_load_dwordx4 v[20:23], v210, s[24:27], s59 offen offset:2048
v_mfma_f32_16x16x32_bf16 v[24:27], a[160:163], v[110:113], v[24:27]
s_waitcnt lgkmcnt(3)
v_mfma_f32_16x16x32_bf16 v[24:27], a[164:167], v[170:173], v[24:27]
v_mfma_f32_16x16x32_bf16 v[28:31], a[184:187], v[110:113], v[28:31]
ds_read_b128 v[110:113], v210 offset:22528
v_mfma_f32_16x16x32_bf16 v[28:31], a[188:191], v[170:173], v[28:31]
v_cvt_pk_bf16_f32 v24, v24, v25
v_cvt_pk_bf16_f32 v25, v26, v27
v_mfma_f32_16x16x32_bf16 v[32:35], a[212:215], v[170:173], v[32:35]
s_waitcnt lgkmcnt(3)
ds_write_b64 v203, v[24:25] offset:12544
v_mfma_f32_16x16x32_bf16 v[138:141], a[0:3], v[182:185], 0
s_waitcnt lgkmcnt(3)
v_subrev_u32 v24, 37120, v210
v_lshrrev_b32 v25, 4, v24
v_mfma_f32_16x16x32_bf16 v[138:141], a[4:7], v[186:189], v[138:141]
v_and_b32 v25, 15, v25
v_lshrrev_b32 v26, 8, v24
v_mfma_f32_16x16x32_bf16 v[142:145], a[24:27], v[182:185], 0
v_mul_u32_u24 v27, 1424, v25
v_lshl_add_u32 v27, v26, 5, v27
v_mfma_f32_16x16x32_bf16 v[142:145], a[28:31], v[186:189], v[142:145]
v_add_u32 v27, 94464, v27
v_cvt_pk_bf16_f32 v28, v28, v29
v_mfma_f32_16x16x32_bf16 v[146:149], a[48:51], v[182:185], 0
ds_read_b128 v[84:87], v27
ds_read_b128 v[88:91], v27 offset:128
v_mfma_f32_16x16x32_bf16 v[146:149], a[52:55], v[186:189], v[146:149]
ds_read_b128 v[92:95], v27 offset:256
ds_read_b128 v[96:99], v27 offset:384
v_mfma_f32_16x16x32_bf16 v[150:153], a[216:219], v[182:185], 0
ds_read_b64 v[100:101], v27 offset:16
ds_read_b64 v[102:103], v27 offset:144
v_mfma_f32_16x16x32_bf16 v[150:153], a[220:223], v[186:189], v[150:153]
ds_read_b64 v[104:105], v27 offset:272
ds_read_b64 v[106:107], v27 offset:400
v_mfma_f32_16x16x32_bf16 v[154:157], a[240:243], v[182:185], 0
v_cvt_pk_bf16_f32 v32, v32, v33
v_cvt_pk_bf16_f32 v29, v30, v31
v_mfma_f32_16x16x32_bf16 v[154:157], a[244:247], v[186:189], v[154:157]
ds_write_b64 v203, v[28:29] offset:12576
v_mfma_f32_16x16x32_bf16 v[158:161], v[232:235], v[182:185], 0
v_cvt_pk_bf16_f32 v33, v34, v35
v_lshlrev_b32 v31, 5, v25
v_mfma_f32_16x16x32_bf16 v[158:161], v[236:239], v[186:189], v[158:161]
ds_write_b64 v203, v[32:33] offset:12608
v_mfma_f32_16x16x32_bf16 v[162:165], v[182:185], a[72:75], 0
v_add_u32 v31, s41, v31
v_mul_hi_u32 v32, v31, s42
v_mfma_f32_16x16x32_bf16 v[162:165], v[186:189], a[76:79], v[162:165]
s_mov_b32 s42, 1373568
v_mul_u32_u24 v29, 73, v32
v_mul_lo_u32 v32, v32, s42
v_mfma_f32_16x16x32_bf16 v[166:169], v[182:185], a[96:99], 0
s_mul_i32 s42, s32, 96
v_sub_u32 v29, v31, v29
v_cmp_gt_u32 vcc, s34, v31
v_mfma_f32_16x16x32_bf16 v[166:169], v[186:189], a[100:103], v[166:169]
s_add_u32 s41, s33, 512
v_mul_u32_u24 v29, 2688, v29
v_add3_u32 v29, v29, v32, s42
v_mfma_f32_16x16x32_bf16 v[170:173], v[182:185], a[120:123], 0
s_mov_b32 s42, 58835169
ds_read_b128 v[182:185], v210 offset:24576
v_mov_b32 v32, 1879048192
v_mfma_f32_16x16x32_bf16 v[170:173], v[186:189], a[124:127], v[170:173]
s_waitcnt lgkmcnt(12)
ds_read_b128 v[186:189], v210 offset:25600
v_cndmask_b32 v29, v32, v29, vcc
v_mfma_f32_16x16x32_bf16 v[138:141], a[8:11], v[110:113], v[138:141]
s_waitcnt lgkmcnt(2)
v_cmp_gt_u32 vcc, 4, v25
v_lshlrev_b32 v31, 5, v25
v_mfma_f32_16x16x32_bf16 v[138:141], a[12:15], v[220:223], v[138:141]
s_barrier
v_mfma_f32_16x16x32_bf16 v[142:145], a[32:35], v[110:113], v[142:145]
s_barrier
v_mfma_f32_16x16x32_bf16 v[142:145], a[36:39], v[220:223], v[142:145]
s_nop 0
ds_read_b64 v[120:121], v204
ds_read_b64 v[128:129], v204 offset:392
v_mfma_f32_16x16x32_bf16 v[146:149], a[56:59], v[110:113], v[146:149]
ds_read_b64 v[136:137], v204 offset:784
v_mov_b32 v32, 6000
v_mfma_f32_16x16x32_bf16 v[146:149], a[60:63], v[220:223], v[146:149]
v_add_u32 v31, s41, v31
v_cndmask_b32 v31, v32, v31, vcc
v_mfma_f32_16x16x32_bf16 v[150:153], a[224:227], v[110:113], v[150:153]
v_mul_hi_u32 v32, v31, s42
v_mul_u32_u24 v30, 73, v32
v_mfma_f32_16x16x32_bf16 v[150:153], a[228:231], v[220:223], v[150:153]
s_mov_b32 s42, 1373568
v_mul_lo_u32 v32, v32, s42
v_sub_u32 v30, v31, v30
v_mfma_f32_16x16x32_bf16 v[154:157], a[248:251], v[110:113], v[154:157]
s_waitcnt lgkmcnt(2)
buffer_store_dwordx2 v[120:121], v204, s[8:11], s28 offen sc1
ds_read_b64 v[120:121], v204 offset:1176
v_mfma_f32_16x16x32_bf16 v[154:157], a[252:255], v[220:223], v[154:157]
s_add_u32 s28, s38, s62
v_cmp_gt_u32 vcc, s34, v31
v_mul_u32_u24 v30, 2688, v30
v_mfma_f32_16x16x32_bf16 v[158:161], v[240:243], v[110:113], v[158:161]
s_waitcnt lgkmcnt(2)
v_lshl_add_u32 v29, v26, 3, v29
v_lshl_add_u32 v28, v26, 3, v205
v_mfma_f32_16x16x32_bf16 v[158:161], v[244:247], v[220:223], v[158:161]
s_mul_i32 s42, s32, 96
buffer_store_dwordx2 v[128:129], v204, s[8:11], s29 offen sc1
ds_read_b64 v[128:129], v204 offset:6272
v_mfma_f32_16x16x32_bf16 v[162:165], v[110:113], a[80:83], v[162:165]
s_add_u32 s29, s38, s63
v_add3_u32 v30, v30, v32, s42
v_mov_b32 v32, 1879048192
v_mfma_f32_16x16x32_bf16 v[162:165], v[220:223], a[84:87], v[162:165]
s_nop 0
v_cndmask_b32 v30, v32, v30, vcc
v_lshl_add_u32 v30, v26, 3, v30
v_mfma_f32_16x16x32_bf16 v[166:169], v[110:113], a[104:107], v[166:169]
s_waitcnt lgkmcnt(2)
buffer_store_dwordx2 v[136:137], v204, s[8:11], s28 offen sc1
ds_read_b64 v[136:137], v204 offset:6664
v_mfma_f32_16x16x32_bf16 v[166:169], v[220:223], a[108:111], v[166:169]
s_add_u32 s28, s38, s64
v_add_u32 v29, 1047808, v29
v_add_u32 v30, 1047808, v30
v_mfma_f32_16x16x32_bf16 v[170:173], v[110:113], a[128:131], v[170:173]
ds_read_b128 v[110:113], v210 offset:26624
v_mfma_f32_16x16x32_bf16 v[170:173], v[220:223], a[132:135], v[170:173]
ds_read_b128 v[220:223], v210 offset:27648
v_mfma_f32_16x16x32_bf16 v[138:141], a[16:19], v[182:185], v[138:141]
s_waitcnt lgkmcnt(4)
buffer_store_dwordx2 v[120:121], v204, s[8:11], s29 offen sc1
ds_read_b64 v[120:121], v204 offset:7056
v_mfma_f32_16x16x32_bf16 v[138:141], a[20:23], v[186:189], v[138:141]
s_add_u32 s29, s38, s65
v_mfma_f32_16x16x32_bf16 v[142:145], a[40:43], v[182:185], v[142:145]
v_mfma_f32_16x16x32_bf16 v[142:145], a[44:47], v[186:189], v[142:145]
v_cvt_pk_bf16_f32 v78, v138, v139
v_cvt_pk_bf16_f32 v79, v140, v141
v_mfma_f32_16x16x32_bf16 v[146:149], a[64:67], v[182:185], v[146:149]
s_waitcnt lgkmcnt(4)
buffer_store_dwordx2 v[128:129], v204, s[8:11], s28 offen sc1
ds_read_b64 v[128:129], v204 offset:7448
v_mfma_f32_16x16x32_bf16 v[146:149], a[68:71], v[186:189], v[146:149]
s_add_u32 s28, s38, s66
v_cvt_pk_bf16_f32 v80, v142, v143
v_cvt_pk_bf16_f32 v81, v144, v145
v_mfma_f32_16x16x32_bf16 v[150:153], a[232:235], v[182:185], v[150:153]
v_mfma_f32_16x16x32_bf16 v[150:153], a[236:239], v[186:189], v[150:153]
v_cvt_pk_bf16_f32 v82, v146, v147
v_cvt_pk_bf16_f32 v83, v148, v149
v_mfma_f32_16x16x32_bf16 v[154:157], v[224:227], v[182:185], v[154:157]
s_waitcnt lgkmcnt(4)
buffer_store_dwordx2 v[136:137], v204, s[8:11], s29 offen sc1
ds_read_b64 v[136:137], v204 offset:12544
v_mfma_f32_16x16x32_bf16 v[154:157], v[228:231], v[186:189], v[154:157]
s_add_u32 s29, s38, s67
v_cvt_pk_bf16_f32 v72, v150, v151
v_cvt_pk_bf16_f32 v73, v152, v153
v_mfma_f32_16x16x32_bf16 v[158:161], v[248:251], v[182:185], v[158:161]
v_mfma_f32_16x16x32_bf16 v[158:161], v[252:255], v[186:189], v[158:161]
v_cvt_pk_bf16_f32 v74, v154, v155
v_cvt_pk_bf16_f32 v75, v156, v157
v_mfma_f32_16x16x32_bf16 v[162:165], v[182:185], a[88:91], v[162:165]
s_waitcnt lgkmcnt(2)
buffer_store_dwordx2 v[120:121], v204, s[8:11], s28 offen sc1
ds_read_b64 v[120:121], v204 offset:12936
v_mfma_f32_16x16x32_bf16 v[162:165], v[186:189], a[92:95], v[162:165]
s_add_u32 s28, s38, s68
v_cvt_pk_bf16_f32 v76, v158, v159
v_cvt_pk_bf16_f32 v77, v160, v161
v_mfma_f32_16x16x32_bf16 v[166:169], v[182:185], a[112:115], v[166:169]
v_mfma_f32_16x16x32_bf16 v[166:169], v[186:189], a[116:119], v[166:169]
v_cvt_pk_bf16_f32 v114, v162, v163
v_cvt_pk_bf16_f32 v115, v164, v165
v_mfma_f32_16x16x32_bf16 v[170:173], v[182:185], a[136:139], v[170:173]
ds_read_b128 v[182:185], v210 offset:28672
v_mfma_f32_16x16x32_bf16 v[170:173], v[186:189], a[140:143], v[170:173]
ds_read_b128 v[186:189], v210 offset:29696
v_cvt_pk_bf16_f32 v122, v166, v167
v_mfma_f32_16x16x32_bf16 v[138:141], a[0:3], v[110:113], 0
v_cvt_pk_bf16_f32 v123, v168, v169
v_mfma_f32_16x16x32_bf16 v[138:141], a[4:7], v[220:223], v[138:141]
s_nop 0
v_cvt_pk_bf16_f32 v130, v170, v171
v_cvt_pk_bf16_f32 v131, v172, v173
v_mfma_f32_16x16x32_bf16 v[142:145], a[24:27], v[110:113], 0
s_waitcnt lgkmcnt(4)
buffer_store_dwordx2 v[128:129], v204, s[8:11], s29 offen sc1
ds_read_b64 v[128:129], v204 offset:13328
v_mfma_f32_16x16x32_bf16 v[142:145], a[28:31], v[220:223], v[142:145]
s_add_u32 s29, s38, s69
v_mfma_f32_16x16x32_bf16 v[146:149], a[48:51], v[110:113], 0
v_mfma_f32_16x16x32_bf16 v[146:149], a[52:55], v[220:223], v[146:149]
s_waitcnt lgkmcnt(4)
buffer_store_dwordx2 v[136:137], v204, s[8:11], s28 offen sc1
ds_read_b64 v[136:137], v204 offset:13720
v_mfma_f32_16x16x32_bf16 v[150:153], a[216:219], v[110:113], 0
s_add_u32 s28, s38, s70
v_mfma_f32_16x16x32_bf16 v[150:153], a[220:223], v[220:223], v[150:153]
v_mfma_f32_16x16x32_bf16 v[154:157], a[240:243], v[110:113], 0
s_waitcnt lgkmcnt(4)
buffer_store_dwordx2 v[120:121], v204, s[8:11], s29 offen sc1
s_add_u32 s29, s38, s71
v_mfma_f32_16x16x32_bf16 v[154:157], a[244:247], v[220:223], v[154:157]
v_mfma_f32_16x16x32_bf16 v[158:161], v[232:235], v[110:113], 0
v_mfma_f32_16x16x32_bf16 v[158:161], v[236:239], v[220:223], v[158:161]
s_waitcnt vmcnt(15) lgkmcnt(1)
buffer_store_dwordx2 v[128:129], v204, s[8:11], s28 offen sc1
s_add_u32 s28, s39, s60
v_mfma_f32_16x16x32_bf16 v[0:3], a[144:147], v[84:87], v[0:3]
v_mfma_f32_16x16x32_bf16 v[0:3], a[148:151], v[88:91], v[0:3]
v_mfma_f32_16x16x32_bf16 v[0:3], a[152:155], v[92:95], v[0:3]
s_waitcnt lgkmcnt(0)
buffer_store_dwordx2 v[136:137], v204, s[8:11], s29 offen sc1
s_add_u32 s29, s39, s61
v_mfma_f32_16x16x32_bf16 v[0:3], a[156:159], v[96:99], v[0:3]
s_nop 0
v_mfma_f32_16x16x32_bf16 v[0:3], a[160:163], v[100:103], v[0:3]
v_mfma_f32_16x16x32_bf16 v[0:3], a[164:167], v[104:107], v[0:3]
v_mfma_f32_16x16x32_bf16 v[162:165], v[110:113], a[72:75], 0
v_mfma_f32_16x16x32_bf16 v[162:165], v[220:223], a[76:79], v[162:165]
v_cvt_pk_bf16_f32 v0, v0, v1
v_cvt_pk_bf16_f32 v1, v2, v3
v_mfma_f32_16x16x32_bf16 v[166:169], v[110:113], a[96:99], 0
buffer_store_dwordx2 v[0:1], v29, s[8:11], 0 offen
v_mfma_f32_16x16x32_bf16 v[166:169], v[220:223], a[100:103], v[166:169]
s_waitcnt vmcnt(17)
v_mfma_f32_16x16x32_bf16 v[4:7], a[168:171], v[84:87], v[4:7]
v_mfma_f32_16x16x32_bf16 v[4:7], a[172:175], v[88:91], v[4:7]
v_mfma_f32_16x16x32_bf16 v[4:7], a[176:179], v[92:95], v[4:7]
v_mfma_f32_16x16x32_bf16 v[4:7], a[180:183], v[96:99], v[4:7]
v_mfma_f32_16x16x32_bf16 v[4:7], a[184:187], v[100:103], v[4:7]
v_mfma_f32_16x16x32_bf16 v[4:7], a[188:191], v[104:107], v[4:7]
v_mfma_f32_16x16x32_bf16 v[170:173], v[110:113], a[120:123], 0
ds_read_b128 v[110:113], v210 offset:30720
v_mfma_f32_16x16x32_bf16 v[170:173], v[220:223], a[124:127], v[170:173]
s_waitcnt vmcnt(16)
v_cvt_pk_bf16_f32 v4, v4, v5
v_cvt_pk_bf16_f32 v5, v6, v7
v_mfma_f32_16x16x32_bf16 v[8:11], a[192:195], v[84:87], v[8:11]
v_mfma_f32_16x16x32_bf16 v[8:11], a[196:199], v[88:91], v[8:11]
v_mfma_f32_16x16x32_bf16 v[8:11], a[200:203], v[92:95], v[8:11]
buffer_store_dwordx2 v[4:5], v29, s[8:11], 0 offen offset:32
v_mfma_f32_16x16x32_bf16 v[8:11], a[204:207], v[96:99], v[8:11]
v_mfma_f32_16x16x32_bf16 v[8:11], a[208:211], v[100:103], v[8:11]
v_mfma_f32_16x16x32_bf16 v[8:11], a[212:215], v[104:107], v[8:11]
ds_read_b128 v[106:109], v210 offset:31744
v_mfma_f32_16x16x32_bf16 v[138:141], a[8:11], v[182:185], v[138:141]
v_mfma_f32_16x16x32_bf16 v[138:141], a[12:15], v[186:189], v[138:141]
v_cvt_pk_bf16_f32 v8, v8, v9
v_cvt_pk_bf16_f32 v9, v10, v11
v_mfma_f32_16x16x32_bf16 v[142:145], a[32:35], v[182:185], v[142:145]
v_mfma_f32_16x16x32_bf16 v[142:145], a[36:39], v[186:189], v[142:145]
v_mfma_f32_16x16x32_bf16 v[146:149], a[56:59], v[182:185], v[146:149]
v_mfma_f32_16x16x32_bf16 v[146:149], a[60:63], v[186:189], v[146:149]
v_mfma_f32_16x16x32_bf16 v[150:153], a[224:227], v[182:185], v[150:153]
v_mfma_f32_16x16x32_bf16 v[150:153], a[228:231], v[186:189], v[150:153]
v_mfma_f32_16x16x32_bf16 v[154:157], a[248:251], v[182:185], v[154:157]
v_mfma_f32_16x16x32_bf16 v[154:157], a[252:255], v[186:189], v[154:157]
v_mfma_f32_16x16x32_bf16 v[158:161], v[240:243], v[182:185], v[158:161]
v_mfma_f32_16x16x32_bf16 v[158:161], v[244:247], v[186:189], v[158:161]
v_mfma_f32_16x16x32_bf16 v[162:165], v[182:185], a[80:83], v[162:165]
buffer_store_dwordx2 v[8:9], v29, s[8:11], 0 offen offset:64
v_mfma_f32_16x16x32_bf16 v[162:165], v[186:189], a[84:87], v[162:165]
v_mfma_f32_16x16x32_bf16 v[166:169], v[182:185], a[104:107], v[166:169]
v_mfma_f32_16x16x32_bf16 v[166:169], v[186:189], a[108:111], v[166:169]
v_mfma_f32_16x16x32_bf16 v[170:173], v[182:185], a[128:131], v[170:173]
ds_read_b128 v[182:185], v210 offset:32768
v_mfma_f32_16x16x32_bf16 v[170:173], v[186:189], a[132:135], v[170:173]
ds_read_b128 v[186:189], v210 offset:33792
s_waitcnt lgkmcnt(3)
v_mfma_f32_16x16x32_bf16 v[138:141], a[16:19], v[110:113], v[138:141]
s_waitcnt lgkmcnt(2)
v_mfma_f32_16x16x32_bf16 v[138:141], a[20:23], v[106:109], v[138:141]
v_mfma_f32_16x16x32_bf16 v[142:145], a[40:43], v[110:113], v[142:145]
v_mfma_f32_16x16x32_bf16 v[142:145], a[44:47], v[106:109], v[142:145]
v_cvt_pk_bf16_f32 v96, v138, v139
v_cvt_pk_bf16_f32 v97, v140, v141
v_mfma_f32_16x16x32_bf16 v[146:149], a[64:67], v[110:113], v[146:149]
v_mfma_f32_16x16x32_bf16 v[146:149], a[68:71], v[106:109], v[146:149]
v_cvt_pk_bf16_f32 v98, v142, v143
v_cvt_pk_bf16_f32 v99, v144, v145
v_mfma_f32_16x16x32_bf16 v[150:153], a[232:235], v[110:113], v[150:153]
v_mfma_f32_16x16x32_bf16 v[150:153], a[236:239], v[106:109], v[150:153]
v_cvt_pk_bf16_f32 v100, v146, v147
v_cvt_pk_bf16_f32 v101, v148, v149
v_mfma_f32_16x16x32_bf16 v[154:157], v[224:227], v[110:113], v[154:157]
v_mfma_f32_16x16x32_bf16 v[154:157], v[228:231], v[106:109], v[154:157]
v_cvt_pk_bf16_f32 v84, v150, v151
v_cvt_pk_bf16_f32 v85, v152, v153
v_mfma_f32_16x16x32_bf16 v[158:161], v[248:251], v[110:113], v[158:161]
v_mfma_f32_16x16x32_bf16 v[158:161], v[252:255], v[106:109], v[158:161]
v_cvt_pk_bf16_f32 v86, v154, v155
v_cvt_pk_bf16_f32 v87, v156, v157
v_mfma_f32_16x16x32_bf16 v[162:165], v[110:113], a[88:91], v[162:165]
v_mfma_f32_16x16x32_bf16 v[162:165], v[106:109], a[92:95], v[162:165]
v_cvt_pk_bf16_f32 v88, v158, v159
v_cvt_pk_bf16_f32 v89, v160, v161
v_mfma_f32_16x16x32_bf16 v[166:169], v[110:113], a[112:115], v[166:169]
v_mfma_f32_16x16x32_bf16 v[166:169], v[106:109], a[116:119], v[166:169]
v_cvt_pk_bf16_f32 v116, v162, v163
v_cvt_pk_bf16_f32 v117, v164, v165
v_mfma_f32_16x16x32_bf16 v[170:173], v[110:113], a[136:139], v[170:173]
s_nop 0
ds_read_b64 v[112:113], v215 offset:528
v_mfma_f32_16x16x32_bf16 v[170:173], v[106:109], a[140:143], v[170:173]
s_waitcnt lgkmcnt(2)
ds_read_b128 v[108:111], v215 offset:512
v_cvt_pk_bf16_f32 v124, v166, v167
v_mfma_f32_16x16x32_bf16 v[138:141], a[0:3], v[182:185], 0
s_nop 0
v_cvt_pk_bf16_f32 v125, v168, v169
s_waitcnt lgkmcnt(2)
v_mfma_f32_16x16x32_bf16 v[138:141], a[4:7], v[186:189], v[138:141]
v_cvt_pk_bf16_f32 v132, v170, v171
v_cvt_pk_bf16_f32 v133, v172, v173
v_mfma_f32_16x16x32_bf16 v[142:145], a[24:27], v[182:185], 0
v_mfma_f32_16x16x32_bf16 v[142:145], a[28:31], v[186:189], v[142:145]
v_mfma_f32_16x16x32_bf16 v[146:149], a[48:51], v[182:185], 0
ds_read_b128 v[182:185], v210 offset:36864
v_mfma_f32_16x16x32_bf16 v[146:149], a[52:55], v[186:189], v[146:149]
ds_read_b128 v[186:189], v210 offset:37888
s_waitcnt lgkmcnt(3)
v_mfma_f32_16x16x16_bf16 v[150:153], v[112:113], v[76:77], v[206:209]
v_mfma_f32_16x16x16_bf16 v[154:157], v[82:83], v[88:89], 0
v_mfma_f32_16x16x16_bf16 v[158:161], v[100:101], v[88:89], 0
v_mfma_f32_16x16x16_bf16 v[166:169], v[112:113], v[88:89], v[206:209]
v_mfma_f32_16x16x32_bf16 v[138:141], a[8:11], v[174:177], v[138:141]
v_mfma_f32_16x16x32_bf16 v[138:141], a[12:15], v[178:181], v[138:141]
v_mfma_f32_16x16x32_bf16 v[154:157], v[78:81], v[84:87], v[154:157]
s_waitcnt lgkmcnt(2)
v_mfma_f32_16x16x32_bf16 v[150:153], v[108:111], v[72:75], v[150:153]
v_mfma_f32_16x16x32_bf16 v[158:161], v[96:99], v[84:87], v[158:161]
v_exp_f32 v154, v154
v_mfma_f32_16x16x32_bf16 v[166:169], v[108:111], v[84:87], v[166:169]
v_exp_f32 v155, v155
v_mfma_f32_16x16x32_bf16 v[142:145], a[32:35], v[174:177], v[142:145]
v_exp_f32 v156, v156
v_mfma_f32_16x16x32_bf16 v[142:145], a[36:39], v[178:181], v[142:145]
v_exp_f32 v157, v157
v_mfma_f32_16x16x32_bf16 v[146:149], a[56:59], v[174:177], v[146:149]
v_exp_f32 v158, v158
v_mfma_f32_16x16x32_bf16 v[146:149], a[60:63], v[178:181], v[146:149]
s_waitcnt lgkmcnt(1)
v_exp_f32 v159, v159
v_mfma_f32_16x16x32_bf16 v[118:121], v[182:185], a[88:91], 0
s_waitcnt lgkmcnt(0)
v_exp_f32 v160, v160
v_mfma_f32_16x16x32_bf16 v[118:121], v[186:189], a[92:95], v[118:121]
v_exp_f32 v161, v161
v_mfma_f32_16x16x32_bf16 v[126:129], v[182:185], a[112:115], 0
v_exp_f32 v150, v150
v_mfma_f32_16x16x32_bf16 v[126:129], v[186:189], a[116:119], v[126:129]
v_exp_f32 v166, v166
v_mfma_f32_16x16x32_bf16 v[134:137], v[182:185], a[136:139], 0
v_mfma_f32_16x16x32_bf16 v[134:137], v[186:189], a[140:143], v[134:137]
v_mfma_f32_16x16x32_bf16 v[90:93], a[232:235], v[182:185], 0
v_mfma_f32_16x16x32_bf16 v[90:93], a[236:239], v[186:189], v[90:93]
v_mfma_f32_16x16x32_bf16 v[170:173], v[224:227], v[182:185], 0
v_mfma_f32_16x16x32_bf16 v[170:173], v[228:231], v[186:189], v[170:173]
v_mfma_f32_16x16x32_bf16 v[138:141], a[16:19], v[182:185], v[138:141]
v_mfma_f32_16x16x32_bf16 v[138:141], a[20:23], v[186:189], v[138:141]
v_mfma_f32_16x16x32_bf16 v[220:223], v[248:251], v[182:185], 0
v_mfma_f32_16x16x32_bf16 v[220:223], v[252:255], v[186:189], v[220:223]
v_cvt_pk_bf16_f32 v102, v138, v139
v_cvt_pk_bf16_f32 v103, v140, v141
v_mfma_f32_16x16x16_bf16 v[138:141], v[82:83], v[76:77], 0
v_mfma_f32_16x16x32_bf16 v[118:121], v[174:177], a[80:83], v[118:121]
v_mfma_f32_16x16x32_bf16 v[138:141], v[78:81], v[72:75], v[138:141]
v_mfma_f32_16x16x32_bf16 v[118:121], v[178:181], a[84:87], v[118:121]
v_mfma_f32_16x16x32_bf16 v[126:129], v[174:177], a[104:107], v[126:129]
v_exp_f32 v138, v138
v_mfma_f32_16x16x32_bf16 v[126:129], v[178:181], a[108:111], v[126:129]
v_exp_f32 v139, v139
v_mfma_f32_16x16x32_bf16 v[142:145], a[40:43], v[182:185], v[142:145]
v_exp_f32 v140, v140
v_mfma_f32_16x16x32_bf16 v[142:145], a[44:47], v[186:189], v[142:145]
v_exp_f32 v141, v141
v_mfma_f32_16x16x32_bf16 v[134:137], v[174:177], a[128:131], v[134:137]
v_mfma_f32_16x16x32_bf16 v[134:137], v[178:181], a[132:135], v[134:137]
v_cvt_pk_bf16_f32 v104, v142, v143
v_cvt_pk_bf16_f32 v105, v144, v145
v_mfma_f32_16x16x16_bf16 v[142:145], v[100:101], v[76:77], 0
v_mfma_f32_16x16x32_bf16 v[90:93], a[224:227], v[174:177], v[90:93]
v_mfma_f32_16x16x32_bf16 v[142:145], v[96:99], v[72:75], v[142:145]
v_mfma_f32_16x16x32_bf16 v[90:93], a[228:231], v[178:181], v[90:93]
v_mfma_f32_16x16x32_bf16 v[170:173], a[248:251], v[174:177], v[170:173]
v_exp_f32 v142, v142
v_mfma_f32_16x16x32_bf16 v[170:173], a[252:255], v[178:181], v[170:173]
v_exp_f32 v143, v143
v_mfma_f32_16x16x32_bf16 v[146:149], a[64:67], v[182:185], v[146:149]
v_exp_f32 v144, v144
v_mfma_f32_16x16x32_bf16 v[146:149], a[68:71], v[186:189], v[146:149]
v_exp_f32 v145, v145
v_mfma_f32_16x16x32_bf16 v[220:223], v[240:243], v[174:177], v[220:223]
v_cvt_pk_bf16_f32 v174, v138, v139
v_cvt_pk_bf16_f32 v175, v140, v141
v_mfma_f32_16x16x32_bf16 v[220:223], v[244:247], v[178:181], v[220:223]
v_cvt_pk_bf16_f32 v106, v146, v147
v_cvt_pk_bf16_f32 v107, v148, v149
v_cvt_pk_bf16_f32 v176, v142, v143
v_cvt_pk_bf16_f32 v177, v144, v145
v_mfma_f32_16x16x16_bf16 v[146:149], v[106:107], v[76:77], 0
v_cvt_pk_bf16_f32 v180, v150, 0
v_mov_b32_e64 v181, 0
v_mfma_f32_16x16x16_bf16 v[162:165], v[106:107], v[88:89], 0
ds_read_b128 v[182:185], v210 offset:32768
ds_read_b128 v[186:189], v210 offset:33792
v_mfma_f32_16x16x32_bf16 v[146:149], v[102:105], v[72:75], v[146:149]
ds_read_b128 v[72:75], v215
ds_read_b64 v[76:77], v215 offset:16
v_mfma_f32_16x16x32_bf16 v[162:165], v[102:105], v[84:87], v[162:165]
v_mfma_f32_16x16x32_bf16 v[150:153], v[190:193], v[174:177], 0
v_exp_f32 v146, v146
v_mfma_f32_16x16x32_bf16 v[138:141], v[114:117], v[174:177], 0
v_exp_f32 v147, v147
v_mfma_f32_16x16x32_bf16 v[142:145], v[122:125], v[174:177], 0
s_waitcnt lgkmcnt(3)
v_exp_f32 v148, v148
v_mfma_f32_16x16x32_bf16 v[118:121], v[182:185], a[72:75], v[118:121]
s_waitcnt lgkmcnt(2)
v_exp_f32 v149, v149
v_mfma_f32_16x16x32_bf16 v[118:121], v[186:189], a[76:79], v[118:121]
v_exp_f32 v162, v162
v_mfma_f32_16x16x32_bf16 v[126:129], v[182:185], a[96:99], v[126:129]
v_exp_f32 v163, v163
v_mfma_f32_16x16x32_bf16 v[126:129], v[186:189], a[100:103], v[126:129]
v_cvt_pk_bf16_f32 v118, v118, v119
v_cvt_pk_bf16_f32 v119, v120, v121
v_mfma_f32_16x16x32_bf16 v[134:137], v[182:185], a[120:123], v[134:137]
ds_read_u16 v120, v205
v_cvt_pk_bf16_f32 v178, v146, v147
v_mfma_f32_16x16x32_bf16 v[134:137], v[186:189], a[124:127], v[134:137]
v_cvt_pk_bf16_f32 v126, v126, v127
v_cvt_pk_bf16_f32 v127, v128, v129
v_mfma_f32_16x16x32_bf16 v[90:93], a[216:219], v[182:185], v[90:93]
ds_read_u16 v128, v205 offset:32
v_cvt_pk_bf16_f32 v179, v148, v149
v_mfma_f32_16x16x32_bf16 v[90:93], a[220:223], v[186:189], v[90:93]
v_cvt_pk_bf16_f32 v134, v134, v135
v_cvt_pk_bf16_f32 v135, v136, v137
v_mfma_f32_16x16x32_bf16 v[170:173], a[240:243], v[182:185], v[170:173]
ds_read_u16 v136, v205 offset:64
v_mov_b32_e64 v121, 0
v_mfma_f32_16x16x32_bf16 v[170:173], a[244:247], v[186:189], v[170:173]
v_cvt_pk_bf16_f32 v90, v90, v91
v_cvt_pk_bf16_f32 v91, v92, v93
v_mfma_f32_16x16x32_bf16 v[220:223], v[232:235], v[182:185], v[220:223]
v_exp_f32_e64 v164, v164
v_mfma_f32_16x16x32_bf16 v[220:223], v[236:239], v[186:189], v[220:223]
v_cvt_pk_bf16_f32 v92, v170, v171
v_cvt_pk_bf16_f32 v93, v172, v173
v_mfma_f32_16x16x32_bf16 v[150:153], v[190:193], v[178:181], v[150:153]
s_waitcnt lgkmcnt(2)
v_exp_f32 v165, v165
v_mfma_f32_16x16x32_bf16 v[138:141], v[118:121], v[178:181], v[138:141]
v_mov_b32 v129, 0
v_mov_b32 v137, 0
v_mfma_f32_16x16x32_bf16 v[146:149], v[130:133], v[174:177], 0
s_waitcnt lgkmcnt(0)
v_rcp_f32 v151, v150
v_mfma_f32_16x16x32_bf16 v[146:149], v[134:137], v[178:181], v[146:149]
v_mul_f32 v152, s3, v151
v_mul_f32 v138, v138, v152
v_mfma_f32_16x16x32_bf16 v[142:145], v[126:129], v[178:181], v[142:145]
v_mul_f32 v139, v139, v152
v_mul_f32 v140, v140, v152
v_mul_f32_e64 v141, v141, v152
v_cvt_pk_bf16_f32 v138, v138, v139
v_cvt_pk_bf16_f32 v174, v154, v155
v_cvt_pk_bf16_f32 v175, v156, v157
v_cvt_pk_bf16_f32 v176, v158, v159
v_cvt_pk_bf16_f32 v177, v160, v161
v_mul_f32 v142, v142, v152
v_mul_f32 v143, v143, v152
v_mfma_f32_16x16x32_bf16 v[154:157], v[114:117], v[174:177], 0
v_mul_f32 v144, v144, v152
v_mul_f32 v145, v145, v152
v_mfma_f32_16x16x32_bf16 v[158:161], v[122:125], v[174:177], 0
v_cvt_pk_bf16_f32 v139, v140, v141
v_cvt_pk_bf16_f32 v140, v142, v143
v_cvt_pk_bf16_f32 v141, v144, v145
v_cvt_pk_bf16_f32 v180, v166, 0
v_mfma_f32_16x16x32_bf16 v[166:169], v[190:193], v[174:177], 0
ds_write_b128 v211, v[138:141] offset:38912
v_mfma_f32_16x16x32_bf16 v[138:141], v[78:81], v[90:93], 0
v_cvt_pk_bf16_f32 v178, v162, v163
v_cvt_pk_bf16_f32 v179, v164, v165
v_mfma_f32_16x16x32_bf16 v[162:165], v[130:133], v[174:177], 0
v_mul_f32 v146, v146, v152
v_mul_f32 v147, v147, v152
v_mfma_f32_16x16x32_bf16 v[166:169], v[190:193], v[178:181], v[166:169]
v_mul_f32 v148, v148, v152
v_mul_f32 v149, v149, v152
v_mfma_f32_16x16x32_bf16 v[154:157], v[118:121], v[178:181], v[154:157]
v_cvt_pk_bf16_f32 v142, v146, v147
v_cvt_pk_bf16_f32 v143, v148, v149
v_mfma_f32_16x16x32_bf16 v[158:161], v[126:129], v[178:181], v[158:161]
ds_write_b64 v212, v[142:143] offset:38912
v_mfma_f32_16x16x32_bf16 v[162:165], v[134:137], v[178:181], v[162:165]
v_rcp_f32 v167, v166
v_mfma_f32_16x16x32_bf16 v[142:145], v[96:99], v[90:93], 0
v_mul_f32 v168, s3, v167
v_mul_f32_e64 v154, v154, v168
v_mfma_f32_16x16x32_bf16 v[146:149], v[102:105], v[90:93], 0
v_mul_f32 v155, v155, v168
v_mul_f32 v156, v156, v168
v_mul_f32_e64 v157, v157, v168
v_cvt_pk_bf16_f32 v154, v154, v155
v_mul_f32 v158, v158, v168
v_mul_f32 v159, v159, v168
v_mul_f32 v160, v160, v168
v_mul_f32 v161, v161, v168
v_cvt_pk_bf16_f32 v155, v156, v157
v_cvt_pk_bf16_f32 v156, v158, v159
v_cvt_pk_bf16_f32 v157, v160, v161
v_mul_f32 v162, v162, v168
v_mul_f32 v163, v163, v168
v_mul_f32 v164, v164, v168
v_mul_f32 v165, v165, v168
v_max3_u32 v218, v218, v150, v151
v_mfma_f32_16x16x32_bf16 v[150:153], v[108:111], v[90:93], v[206:209]
ds_write_b128 v211, v[154:157] offset:45056
v_mfma_f32_16x16x32_bf16 v[154:157], v[72:75], v[78:81], 0
v_cvt_pk_bf16_f32 v158, v162, v163
v_cvt_pk_bf16_f32 v159, v164, v165
v_mfma_f32_16x16x32_bf16 v[162:165], v[72:75], v[102:105], 0
s_nop 0
v_cvt_pk_bf16_f32 v94, v220, v221
v_cvt_pk_bf16_f32 v95, v222, v223
v_max3_u32 v218, v218, v166, v167
s_nop 0
v_mfma_f32_16x16x16_bf16 v[138:141], v[82:83], v[94:95], v[138:141]
ds_write_b64 v212, v[158:159] offset:45056
v_mfma_f32_16x16x16_bf16 v[142:145], v[100:101], v[94:95], v[142:145]
v_add_u32 v205, 1424, v205
v_mfma_f32_16x16x16_bf16 v[150:153], v[112:113], v[94:95], v[150:153]
v_exp_f32_e64 v138, v138
v_mfma_f32_16x16x16_bf16 v[146:149], v[106:107], v[94:95], v[146:149]
v_exp_f32 v139, v139
s_nop 0
v_cvt_pk_bf16_f32 v174, v138, v139
v_mfma_f32_16x16x16_bf16 v[154:157], v[76:77], v[82:83], v[154:157]
v_exp_f32 v140, v140
v_exp_f32 v141, v141
v_mfma_f32_16x16x32_bf16 v[158:161], v[72:75], v[96:99], 0
v_exp_f32 v142, v142
v_exp_f32 v143, v143
v_mfma_f32_16x16x16_bf16 v[162:165], v[76:77], v[106:107], v[162:165]
v_exp_f32 v144, v144
v_cvt_pk_bf16_f32 v175, v140, v141
v_mfma_f32_16x16x16_bf16 v[158:161], v[76:77], v[100:101], v[158:161]
v_exp_f32 v145, v145
v_exp_f32 v150, v150
v_cvt_pk_bf16_f32 v176, v142, v143
v_cvt_pk_bf16_f32 v177, v144, v145
v_cvt_pk_bf16_f32 v180, v150, 0
s_nop 0
v_mfma_f32_16x16x32_bf16 v[150:153], v[190:193], v[174:177], 0
s_waitcnt lgkmcnt(0)
s_barrier
v_mfma_f32_16x16x32_bf16 v[138:141], v[114:117], v[174:177], 0
ds_read_b128 v[220:223], v210 offset:38912
ds_read_b128 v[110:113], v210 offset:39936
v_mfma_f32_16x16x32_bf16 v[142:145], v[122:125], v[174:177], 0
ds_read_b128 v[170:173], v210 offset:40960
ds_read_b128 v[182:185], v210 offset:41984
v_exp_f32 v146, v146
v_exp_f32 v147, v147
v_exp_f32 v148, v148
v_exp_f32 v149, v149
v_cvt_pk_bf16_f32 v178, v146, v147
v_cvt_pk_bf16_f32 v179, v148, v149
v_mfma_f32_16x16x32_bf16 v[146:149], v[130:133], v[174:177], 0
ds_read_b128 v[186:189], v210 offset:43008
ds_read_b32 v166, v215 offset:536
v_mfma_f32_16x16x32_bf16 v[150:153], v[190:193], v[178:181], v[150:153]
v_mov_b32_dpp v154, v158 quad_perm:[0,1,2,3] row_mask:0x2 bank_mask:0xf
v_mfma_f32_16x16x32_bf16 v[138:141], v[118:121], v[178:181], v[138:141]
v_mov_b32_dpp v154, v162 quad_perm:[0,1,2,3] row_mask:0x4 bank_mask:0xf
v_mfma_f32_16x16x32_bf16 v[142:145], v[126:129], v[178:181], v[142:145]
s_waitcnt lgkmcnt(5)
v_rcp_f32 v151, v150
v_mfma_f32_16x16x32_bf16 v[36:39], a[144:147], v[220:223], v[36:39]
s_waitcnt lgkmcnt(4)
v_mul_f32 v152, s3, v151
v_mul_f32_e64 v138, v138, v152
v_mfma_f32_16x16x32_bf16 v[36:39], a[148:151], v[110:113], v[36:39]
s_waitcnt lgkmcnt(3)
v_mul_f32 v139, v139, v152
v_mul_f32 v140, v140, v152
v_mfma_f32_16x16x32_bf16 v[36:39], a[152:155], v[170:173], v[36:39]
s_waitcnt lgkmcnt(0)
v_add_f32_dpp v154, v166, v207 quad_perm:[0,1,2,3] row_mask:0x8 bank_mask:0xf
v_mul_f32_e64 v141, v141, v152
v_mfma_f32_16x16x32_bf16 v[36:39], a[156:159], v[182:185], v[36:39]
v_exp_f32_e64 v166, v154
v_mfma_f32_16x16x32_bf16 v[40:43], a[168:171], v[220:223], v[40:43]
v_cvt_pk_bf16_f32 v154, v166, 0
v_add_f32_dpp v166, v166, v166 row_ror:8 row_mask:0xf bank_mask:0xf
v_mfma_f32_16x16x32_bf16 v[40:43], a[172:175], v[110:113], v[40:43]
ds_write_b16 v214, v154
v_mfma_f32_16x16x32_bf16 v[40:43], a[176:179], v[170:173], v[40:43]
ds_read_b128 v[84:87], v215
ds_read_b128 v[88:91], v215 offset:16
v_mfma_f32_16x16x32_bf16 v[40:43], a[180:183], v[182:185], v[40:43]
v_add_f32_dpp v166, v166, v166 row_ror:4 row_mask:0xf bank_mask:0xf
v_cvt_pk_bf16_f32 v138, v138, v139
v_mfma_f32_16x16x32_bf16 v[44:47], a[192:195], v[220:223], v[44:47]
ds_read_b128 v[220:223], v210 offset:44032
v_add_f32_dpp v166, v166, v166 row_ror:2 row_mask:0xf bank_mask:0xf
v_mfma_f32_16x16x32_bf16 v[44:47], a[196:199], v[110:113], v[44:47]
ds_read_b128 v[110:113], v210 offset:45056
v_add_f32_dpp v166, v166, v166 row_ror:1 row_mask:0xf bank_mask:0xf
v_mfma_f32_16x16x32_bf16 v[44:47], a[200:203], v[170:173], v[44:47]
ds_read_b128 v[170:173], v210 offset:46080
v_add_f32_dpp v166, v166, v166 row_bcast:15 row_mask:0xa bank_mask:0xf
v_mfma_f32_16x16x32_bf16 v[44:47], a[204:207], v[182:185], v[44:47]
ds_read_b128 v[182:185], v210 offset:47104
v_add_f32_dpp v166, v166, v166 row_bcast:31 row_mask:0xc bank_mask:0xf
v_mfma_f32_16x16x32_bf16 v[146:149], v[134:137], v[178:181], v[146:149]
v_readlane_b32 s72, v166, 63
v_mul_f32_e64 v142, v142, v152
v_mfma_f32_16x16x32_bf16 v[36:39], a[160:163], v[186:189], v[36:39]
v_mul_f32 v143, v143, v152
v_mul_f32 v144, v144, v152
v_mfma_f32_16x16x32_bf16 v[40:43], a[184:187], v[186:189], v[40:43]
s_waitcnt lgkmcnt(3)
v_mul_f32 v145, v145, v152
v_cvt_pk_bf16_f32 v139, v140, v141
v_mfma_f32_16x16x32_bf16 v[40:43], a[188:191], v[220:223], v[40:43]
v_rcp_f32 v167, s72
v_mfma_f32_16x16x32_bf16 v[36:39], a[164:167], v[220:223], v[36:39]
s_waitcnt lgkmcnt(2)
v_cvt_pk_bf16_f32 v140, v142, v143
v_cvt_pk_bf16_f32 v141, v144, v145
v_mfma_f32_16x16x32_bf16 v[48:51], a[144:147], v[110:113], v[48:51]
s_waitcnt lgkmcnt(1)
ds_write_b128 v211, v[138:141] offset:51200
v_mfma_f32_16x16x32_bf16 v[48:51], a[148:151], v[170:173], v[48:51]
s_waitcnt lgkmcnt(1)
v_max3_u32 v218, v218, s72, v167
v_max3_u32 v218, v218, v150, v151
v_mfma_f32_16x16x32_bf16 v[48:51], a[152:155], v[182:185], v[48:51]
v_cmp_lt_u32 vcc, 1602224128, v218
v_mul_f32_e64 v146, v146, v152
v_mfma_f32_16x16x32_bf16 v[52:55], a[168:171], v[110:113], v[52:55]
s_or_b32 s41, vcc_lo, vcc_hi
v_mul_f32 v147, v147, v152
v_mul_f32_e64 v148, v148, v152
v_mfma_f32_16x16x32_bf16 v[52:55], a[172:175], v[170:173], v[52:55]
v_mul_f32_e64 v149, v149, v152
v_cvt_pk_bf16_f32 v142, v146, v147
v_mfma_f32_16x16x32_bf16 v[52:55], a[176:179], v[182:185], v[52:55]
v_cvt_pk_bf16_f32 v143, v148, v149
v_mul_f32_e64 v168, s3, v167
v_mfma_f32_16x16x32_bf16 v[56:59], a[192:195], v[110:113], v[56:59]
ds_read_b128 v[110:113], v210 offset:50176
v_mov_b32_e64 v33, s41
v_mfma_f32_16x16x32_bf16 v[56:59], a[196:199], v[170:173], v[56:59]
ds_write_b64 v212, v[142:143] offset:51200
v_mfma_f32_16x16x32_bf16 v[56:59], a[200:203], v[182:185], v[56:59]
v_cvt_pk_bf16_f32 v40, v40, v41
v_cvt_pk_bf16_f32 v36, v36, v37
v_mfma_f32_16x16x32_bf16 v[44:47], a[208:211], v[186:189], v[44:47]
ds_read_b128 v[186:189], v210 offset:48128
v_cvt_pk_bf16_f32 v41, v42, v43
v_mfma_f32_16x16x32_bf16 v[44:47], a[212:215], v[220:223], v[44:47]
ds_read_b128 v[220:223], v210 offset:49152
v_cvt_pk_bf16_f32 v37, v38, v39
v_mfma_f32_16x16x32_bf16 v[154:157], v[84:87], v[114:117], 0
ds_write_b32 v209, v33
v_mfma_f32_16x16x32_bf16 v[154:157], v[88:91], v[118:121], v[154:157]
ds_write_b64 v203, v[40:41] offset:32
v_mfma_f32_16x16x32_bf16 v[158:161], v[84:87], v[122:125], 0
v_cvt_pk_bf16_f32 v44, v44, v45
v_cvt_pk_bf16_f32 v45, v46, v47
v_mfma_f32_16x16x32_bf16 v[158:161], v[88:91], v[126:129], v[158:161]
s_waitcnt lgkmcnt(3)
ds_write_b64 v203, v[36:37]
v_mfma_f32_16x16x32_bf16 v[48:51], a[156:159], v[186:189], v[48:51]
v_add_u32 v215, 1424, v215
s_waitcnt lgkmcnt(3)
v_mfma_f32_16x16x32_bf16 v[48:51], a[160:163], v[220:223], v[48:51]
v_mov_b32_dpp v154, v158 quad_perm:[0,1,2,3] row_mask:0x2 bank_mask:0xf
v_mfma_f32_16x16x32_bf16 v[48:51], a[164:167], v[110:113], v[48:51]
ds_write_b64 v203, v[44:45] offset:64
v_mfma_f32_16x16x32_bf16 v[52:55], a[180:183], v[186:189], v[52:55]
v_mfma_f32_16x16x32_bf16 v[52:55], a[184:187], v[220:223], v[52:55]
v_cvt_pk_bf16_f32 v48, v48, v49
v_cvt_pk_bf16_f32 v49, v50, v51
v_mfma_f32_16x16x32_bf16 v[52:55], a[188:191], v[110:113], v[52:55]
ds_write_b64 v203, v[48:49] offset:6272
v_mfma_f32_16x16x32_bf16 v[56:59], a[204:207], v[186:189], v[56:59]
v_mfma_f32_16x16x32_bf16 v[56:59], a[208:211], v[220:223], v[56:59]
v_cvt_pk_bf16_f32 v52, v52, v53
v_cvt_pk_bf16_f32 v53, v54, v55
v_mfma_f32_16x16x32_bf16 v[56:59], a[212:215], v[110:113], v[56:59]
ds_write_b64 v203, v[52:53] offset:6304
v_mfma_f32_16x16x32_bf16 v[162:165], v[84:87], v[130:133], 0
v_mfma_f32_16x16x32_bf16 v[162:165], v[88:91], v[134:137], v[162:165]
v_cvt_pk_bf16_f32 v56, v56, v57
v_cvt_pk_bf16_f32 v57, v58, v59
ds_write_b64 v203, v[56:57] offset:6336
s_nop 3
v_mov_b32_dpp v154, v162 quad_perm:[0,1,2,3] row_mask:0x4 bank_mask:0xf
v_mul_f32 v154, v154, v168
v_cvt_pk_bf16_f32 v154, v154, 0
ds_write_b16 v214, v154
v_add_u32 v214, 1424, v214
s_waitcnt lgkmcnt(0)
s_barrier
ds_read_b128 v[170:173], v210 offset:51200
ds_read_b128 v[182:185], v210 offset:52224
ds_read_b128 v[84:87], v27 offset:22784
ds_read_b128 v[88:91], v27 offset:22912
ds_read_b128 v[92:95], v27 offset:23040
ds_read_b128 v[96:99], v27 offset:23168
s_waitcnt lgkmcnt(5)
v_mfma_f32_16x16x32_bf16 v[60:63], a[144:147], v[170:173], v[60:63]
ds_read_b64 v[100:101], v27 offset:22800
ds_read_b64 v[102:103], v27 offset:22928
v_mfma_f32_16x16x32_bf16 v[64:67], a[168:171], v[170:173], v[64:67]
s_waitcnt lgkmcnt(6)
ds_read_b64 v[104:105], v27 offset:23056
ds_read_b64 v[106:107], v27 offset:23184
v_mfma_f32_16x16x32_bf16 v[64:67], a[172:175], v[182:185], v[64:67]
s_nop 0
ds_read_b128 v[186:189], v210 offset:53248
ds_read_b128 v[220:223], v210 offset:54272
v_mfma_f32_16x16x32_bf16 v[60:63], a[148:151], v[182:185], v[60:63]
s_waitcnt vmcnt(17) lgkmcnt(9)
ds_read_b128 v[110:113], v210 offset:55296
ds_read_b128 v[174:177], v210 offset:18432
v_mfma_f32_16x16x32_bf16 v[12:15], a[144:147], v[84:87], v[12:15]
s_waitcnt lgkmcnt(10)
v_mfma_f32_16x16x32_bf16 v[12:15], a[148:151], v[88:91], v[12:15]
s_waitcnt lgkmcnt(9)
v_mfma_f32_16x16x32_bf16 v[12:15], a[152:155], v[92:95], v[12:15]
s_waitcnt lgkmcnt(8)
v_mfma_f32_16x16x32_bf16 v[12:15], a[156:159], v[96:99], v[12:15]
s_waitcnt lgkmcnt(6)
v_mfma_f32_16x16x32_bf16 v[12:15], a[160:163], v[100:103], v[12:15]
s_waitcnt lgkmcnt(4)
v_mfma_f32_16x16x32_bf16 v[12:15], a[164:167], v[104:107], v[12:15]
v_mfma_f32_16x16x32_bf16 v[68:71], a[192:195], v[170:173], v[68:71]
ds_read_b128 v[170:173], v210 offset:56320
v_mfma_f32_16x16x32_bf16 v[68:71], a[196:199], v[182:185], v[68:71]
s_waitcnt lgkmcnt(1)
v_or3_b32 v174, v174, v175, v176
v_cvt_pk_bf16_f32 v12, v12, v13
v_mfma_f32_16x16x32_bf16 v[60:63], a[152:155], v[186:189], v[60:63]
v_or_b32 v174, v174, v177
v_cvt_pk_bf16_f32 v13, v14, v15
v_mfma_f32_16x16x32_bf16 v[60:63], a[156:159], v[220:223], v[60:63]
s_waitcnt vmcnt(16)
buffer_store_dwordx2 v[12:13], v30, s[8:11], 0 offen
v_readfirstlane_b32 s43, v174
v_mfma_f32_16x16x32_bf16 v[16:19], a[168:171], v[84:87], v[16:19]
v_mfma_f32_16x16x32_bf16 v[16:19], a[172:175], v[88:91], v[16:19]
v_mfma_f32_16x16x32_bf16 v[16:19], a[176:179], v[92:95], v[16:19]
v_mfma_f32_16x16x32_bf16 v[16:19], a[180:183], v[96:99], v[16:19]
v_mfma_f32_16x16x32_bf16 v[64:67], a[176:179], v[186:189], v[64:67]
v_mfma_f32_16x16x32_bf16 v[64:67], a[180:183], v[220:223], v[64:67]
v_mfma_f32_16x16x32_bf16 v[68:71], a[200:203], v[186:189], v[68:71]
v_mfma_f32_16x16x32_bf16 v[68:71], a[204:207], v[220:223], v[68:71]
v_mfma_f32_16x16x32_bf16 v[16:19], a[184:187], v[100:103], v[16:19]
v_mfma_f32_16x16x32_bf16 v[16:19], a[188:191], v[104:107], v[16:19]
s_waitcnt vmcnt(16)
v_mfma_f32_16x16x32_bf16 v[20:23], a[192:195], v[84:87], v[20:23]
v_mfma_f32_16x16x32_bf16 v[20:23], a[196:199], v[88:91], v[20:23]
v_cvt_pk_bf16_f32 v16, v16, v17
v_cvt_pk_bf16_f32 v17, v18, v19
v_mfma_f32_16x16x32_bf16 v[20:23], a[200:203], v[92:95], v[20:23]
buffer_store_dwordx2 v[16:17], v30, s[8:11], 0 offen offset:32
v_mfma_f32_16x16x32_bf16 v[20:23], a[204:207], v[96:99], v[20:23]
v_mfma_f32_16x16x32_bf16 v[20:23], a[208:211], v[100:103], v[20:23]
v_mfma_f32_16x16x32_bf16 v[20:23], a[212:215], v[104:107], v[20:23]
s_nop 0
v_mfma_f32_16x16x32_bf16 v[60:63], a[160:163], v[110:113], v[60:63]
s_waitcnt lgkmcnt(0)
v_mfma_f32_16x16x32_bf16 v[60:63], a[164:167], v[170:173], v[60:63]
v_cvt_pk_bf16_f32 v20, v20, v21
v_cvt_pk_bf16_f32 v21, v22, v23
v_mfma_f32_16x16x32_bf16 v[64:67], a[184:187], v[110:113], v[64:67]
buffer_store_dwordx2 v[20:21], v30, s[8:11], 0 offen offset:64
v_mfma_f32_16x16x32_bf16 v[64:67], a[188:191], v[170:173], v[64:67]
v_cvt_pk_bf16_f32 v60, v60, v61
v_cvt_pk_bf16_f32 v61, v62, v63
v_mfma_f32_16x16x32_bf16 v[68:71], a[208:211], v[110:113], v[68:71]
ds_write_b64 v203, v[60:61] offset:12544
v_mfma_f32_16x16x32_bf16 v[68:71], a[212:215], v[170:173], v[68:71]
s_nop 0
v_cvt_pk_bf16_f32 v64, v64, v65
v_cvt_pk_bf16_f32 v65, v66, v67
ds_write_b64 v203, v[64:65] offset:12576
s_nop 3
v_cvt_pk_bf16_f32 v68, v68, v69
v_cvt_pk_bf16_f32 v69, v70, v71
ds_write_b64 v203, v[68:69] offset:12608
s_waitcnt lgkmcnt(0)
s_barrier
ds_read_b64 v[120:121], v204
ds_read_b64 v[128:129], v204 offset:392
ds_read_b64 v[136:137], v204 offset:784
s_waitcnt lgkmcnt(2)
buffer_store_dwordx2 v[120:121], v204, s[8:11], s28 offen sc1
s_add_u32 s28, s39, s62
ds_read_b64 v[120:121], v204 offset:1176
s_waitcnt lgkmcnt(2)
buffer_store_dwordx2 v[128:129], v204, s[8:11], s29 offen sc1
s_add_u32 s29, s39, s63
ds_read_b64 v[128:129], v204 offset:6272
s_waitcnt lgkmcnt(2)
buffer_store_dwordx2 v[136:137], v204, s[8:11], s28 offen sc1
s_add_u32 s28, s39, s64
ds_read_b64 v[136:137], v204 offset:6664
s_waitcnt lgkmcnt(2)
buffer_store_dwordx2 v[120:121], v204, s[8:11], s29 offen sc1
s_add_u32 s29, s39, s65
ds_read_b64 v[120:121], v204 offset:7056
s_waitcnt lgkmcnt(2)
buffer_store_dwordx2 v[128:129], v204, s[8:11], s28 offen sc1
s_add_u32 s28, s39, s66
ds_read_b64 v[128:129], v204 offset:7448
s_waitcnt lgkmcnt(2)
buffer_store_dwordx2 v[136:137], v204, s[8:11], s29 offen sc1
s_add_u32 s29, s39, s67
ds_read_b64 v[136:137], v204 offset:12544
s_waitcnt lgkmcnt(2)
buffer_store_dwordx2 v[120:121], v204, s[8:11], s28 offen sc1
s_add_u32 s28, s39, s68
ds_read_b64 v[120:121], v204 offset:12936
s_waitcnt lgkmcnt(2)
buffer_store_dwordx2 v[128:129], v204, s[8:11], s29 offen sc1
s_add_u32 s29, s39, s69
ds_read_b64 v[128:129], v204 offset:13328
s_waitcnt lgkmcnt(2)
buffer_store_dwordx2 v[136:137], v204, s[8:11], s28 offen sc1
s_add_u32 s28, s39, s70
ds_read_b64 v[136:137], v204 offset:13720
s_waitcnt lgkmcnt(2)
buffer_store_dwordx2 v[120:121], v204, s[8:11], s29 offen sc1
s_add_u32 s29, s39, s71
s_waitcnt lgkmcnt(1)
buffer_store_dwordx2 v[128:129], v204, s[8:11], s28 offen sc1
s_waitcnt lgkmcnt(0)
buffer_store_dwordx2 v[136:137], v204, s[8:11], s29 offen sc1
s_branch L_fin
F_pf:
v_subrev_u32 v76, 37120, v211
s_mov_b32 s96, m0
s_mov_b32 m0, 3600
v_lshlrev_b32 v76, 3, v76
global_load_lds_dword v76, s[98:99]
s_mov_b32 m0, s96
s_nop 0
s_branch F_nopf
L_redo:
s_mov_b32 s47, 1
s_waitcnt vmcnt(0) lgkmcnt(0)
s_barrier
s_branch L_start
L_safe:
.p2align 3
s_add_u32 s28, s28, 32
s_cmp_ge_u32 s28, 73
s_cselect_b32 s21, 73, 0
s_cselect_b32 s22, 1177344, 0
s_sub_u32 s28, s28, s21
s_add_u32 s20, s20, s22
s_add_u32 s20, s20, 86016
s_add_u32 m0, s96, 71488
s_mov_b32 exec_hi, 4194303
buffer_load_dwordx4 v82, s[4:7], s20 offen nt lds
s_mov_b32 exec_hi, -1
s_add_u32 s28, s28, 32
s_cmp_ge_u32 s28, 73
s_cselect_b32 s21, 73, 0
s_cselect_b32 s22, 1177344, 0
s_sub_u32 s28, s28, s21
s_add_u32 s20, s20, s22
s_add_u32 s20, s20, 86016
s_add_u32 m0, s96, 74960
s_mov_b32 exec_hi, 4194303
buffer_load_dwordx4 v82, s[4:7], s20 offen nt lds
s_mov_b32 exec_hi, -1
s_add_u32 s28, s28, 32
s_cmp_ge_u32 s28, 73
s_cselect_b32 s21, 73, 0
s_cselect_b32 s22, 1177344, 0
s_sub_u32 s28, s28, s21
s_add_u32 s20, s20, s22
s_add_u32 s20, s20, 86016
s_add_u32 m0, s96, 78432
s_mov_b32 exec_hi, 4194303
buffer_load_dwordx4 v82, s[4:7], s20 offen nt lds
s_mov_b32 exec_hi, -1
s_add_u32 s28, s28, 32
s_cmp_ge_u32 s28, 73
s_cselect_b32 s21, 73, 0
s_cselect_b32 s22, 1177344, 0
s_sub_u32 s28, s28, s21
s_add_u32 s20, s20, s22
s_add_u32 s20, s20, 86016
s_add_u32 m0, s96, 81904
s_mov_b32 exec_hi, 4194303
buffer_load_dwordx4 v82, s[4:7], s20 offen nt lds
s_mov_b32 exec_hi, -1
s_add_u32 s28, s28, 32
s_cmp_ge_u32 s28, 73
s_cselect_b32 s21, 73, 0
s_cselect_b32 s22, 1177344, 0
s_sub_u32 s28, s28, s21
s_add_u32 s20, s20, s22
s_add_u32 s20, s20, 86016
s_add_u32 m0, s96, 85376
s_mov_b32 exec_hi, 4194303
buffer_load_dwordx4 v82, s[4:7], s20 offen nt lds
s_mov_b32 exec_hi, -1
s_add_u32 s28, s28, 32
s_cmp_ge_u32 s28, 73
s_cselect_b32 s21, 73, 0
s_cselect_b32 s22, 1177344, 0
s_sub_u32 s28, s28, s21
s_add_u32 s20, s20, s22
s_add_u32 s20, s20, 86016
s_add_u32 m0, s96, 88848
s_mov_b32 exec_hi, 4194303
buffer_load_dwordx4 v82, s[4:7], s20 offen nt lds
s_mov_b32 exec_hi, -1
s_add_u32 s28, s28, 32
s_cmp_ge_u32 s28, 73
s_cselect_b32 s21, 73, 0
s_cselect_b32 s22, 1177344, 0
s_sub_u32 s28, s28, s21
s_add_u32 s20, s20, s22
s_add_u32 s20, s20, 86016
s_add_u32 m0, s96, 92320
s_mov_b32 exec_hi, 4194303
buffer_load_dwordx4 v82, s[4:7], s20 offen nt lds
s_mov_b32 exec_hi, -1
s_add_u32 s28, s28, 32
s_cmp_ge_u32 s28, 73
s_cselect_b32 s21, 73, 0
s_cselect_b32 s22, 1177344, 0
s_sub_u32 s28, s28, s21
s_add_u32 s20, s20, s22
s_add_u32 s20, s20, 86016
s_add_u32 m0, s96, 95792
s_mov_b32 exec_hi, 4194303
buffer_load_dwordx4 v82, s[4:7], s20 offen nt lds
s_mov_b32 exec_hi, -1
s_add_u32 s28, s28, 32
s_cmp_ge_u32 s28, 73
s_cselect_b32 s21, 73, 0
s_cselect_b32 s22, 1177344, 0
s_sub_u32 s28, s28, s21
s_add_u32 s20, s20, s22
s_add_u32 s20, s20, 86016
s_add_u32 m0, s96, 99264
s_mov_b32 exec_hi, 4194303
buffer_load_dwordx4 v82, s[4:7], s20 offen nt lds
s_mov_b32 exec_hi, -1
s_add_u32 s28, s28, 32
s_cmp_ge_u32 s28, 73
s_cselect_b32 s21, 73, 0
s_cselect_b32 s22, 1177344, 0
s_sub_u32 s28, s28, s21
s_add_u32 s20, s20, s22
s_add_u32 s20, s20, 86016
s_add_u32 m0, s96, 102736
s_mov_b32 exec_hi, 4194303
buffer_load_dwordx4 v82, s[4:7], s20 offen nt lds
s_mov_b32 exec_hi, -1
s_add_u32 s28, s28, 32
s_cmp_ge_u32 s28, 73
s_cselect_b32 s21, 73, 0
s_cselect_b32 s22, 1177344, 0
s_sub_u32 s28, s28, s21
s_add_u32 s20, s20, s22
s_add_u32 s20, s20, 86016
s_add_u32 m0, s96, 106208
s_mov_b32 exec_hi, 4194303
buffer_load_dwordx4 v82, s[4:7], s20 offen nt lds
s_mov_b32 exec_hi, -1
s_add_u32 s28, s28, 32
s_cmp_ge_u32 s28, 73
s_cselect_b32 s21, 73, 0
s_cselect_b32 s22, 1177344, 0
s_sub_u32 s28, s28, s21
s_add_u32 s20, s20, s22
s_add_u32 s20, s20, 86016
s_add_u32 m0, s96, 109680
s_mov_b32 exec_hi, 4194303
buffer_load_dwordx4 v82, s[4:7], s20 offen nt lds
s_mov_b32 exec_hi, -1
s_add_u32 s28, s28, 32
s_cmp_ge_u32 s28, 73
s_cselect_b32 s21, 73, 0
s_cselect_b32 s22, 1177344, 0
s_sub_u32 s28, s28, s21
s_add_u32 s20, s20, s22
s_add_u32 s20, s20, 86016
s_add_u32 m0, s96, 113152
s_mov_b32 exec_hi, 4194303
buffer_load_dwordx4 v82, s[4:7], s20 offen nt lds
s_mov_b32 exec_hi, -1
s_add_u32 s28, s28, 32
s_cmp_ge_u32 s28, 73
s_cselect_b32 s21, 73, 0
s_cselect_b32 s22, 1177344, 0
s_sub_u32 s28, s28, s21
s_add_u32 s20, s20, s22
s_add_u32 s20, s20, 86016
s_add_u32 m0, s96, 116624
s_mov_b32 exec_hi, 4194303
buffer_load_dwordx4 v82, s[4:7], s20 offen nt lds
s_mov_b32 exec_hi, -1
s_add_u32 s28, s28, 32
s_cmp_ge_u32 s28, 73
s_cselect_b32 s21, 73, 0
s_cselect_b32 s22, 1177344, 0
s_sub_u32 s28, s28, s21
s_add_u32 s20, s20, s22
s_add_u32 s20, s20, 86016
s_add_u32 m0, s96, 120096
s_mov_b32 exec_hi, 4194303
buffer_load_dwordx4 v82, s[4:7], s20 offen nt lds
s_mov_b32 exec_hi, -1
s_add_u32 s28, s28, 32
s_cmp_ge_u32 s28, 73
s_cselect_b32 s21, 73, 0
s_cselect_b32 s22, 1177344, 0
s_sub_u32 s28, s28, s21
s_add_u32 s20, s20, s22
s_add_u32 s20, s20, 86016
s_add_u32 m0, s96, 123568
s_mov_b32 exec_hi, 4194303
buffer_load_dwordx4 v82, s[4:7], s20 offen nt lds
s_mov_b32 exec_hi, -1
s_add_u32 m0, s55, 131328
s_add_u32 s29, s54, 384
buffer_load_dwordx4 v72, s[12:15], s29 offen lds
s_add_u32 m0, s55, 132352
s_add_u32 s29, s54, 384
buffer_load_dwordx4 v73, s[12:15], s29 offen lds
s_add_u32 m0, s55, 133376
s_add_u32 s29, s54, 384
buffer_load_dwordx4 v74, s[12:15], s29 offen lds
ds_read_b128 v[84:87], v200
s_waitcnt lgkmcnt(0)
v_mfma_f32_16x16x32_bf16 v[0:3], v[138:141], v[84:87], 0
ds_read_b128 v[92:95], v201
s_waitcnt lgkmcnt(0)
v_mfma_f32_16x16x32_bf16 v[12:15], v[138:141], v[92:95], 0
ds_read_b128 v[100:103], v202
s_waitcnt lgkmcnt(0)
v_mfma_f32_16x16x32_bf16 v[24:27], v[138:141], v[100:103], 0
ds_read_b128 v[84:87], v194
ds_read_b128 v[88:91], v194 offset:16
s_waitcnt lgkmcnt(0)
v_smfmac_f32_16x16x64_bf16 v[0:3], v[142:145], v[84:91], v213
ds_read_b128 v[92:95], v195
ds_read_b128 v[96:99], v195 offset:16
s_waitcnt lgkmcnt(0)
v_smfmac_f32_16x16x64_bf16 v[12:15], v[142:145], v[92:99], v213
ds_read_b128 v[100:103], v196
ds_read_b128 v[104:107], v196 offset:16
s_waitcnt lgkmcnt(0)
v_smfmac_f32_16x16x64_bf16 v[24:27], v[142:145], v[100:107], v213
ds_read_b128 v[84:87], v197
ds_read_b128 v[88:91], v197 offset:16
s_waitcnt lgkmcnt(0)
v_smfmac_f32_16x16x64_bf16 v[0:3], v[146:149], v[84:91], v213
ds_read_b128 v[92:95], v198
ds_read_b128 v[96:99], v198 offset:16
s_waitcnt lgkmcnt(0)
v_smfmac_f32_16x16x64_bf16 v[12:15], v[146:149], v[92:99], v213
ds_read_b128 v[100:103], v199
ds_read_b128 v[104:107], v199 offset:16
s_waitcnt lgkmcnt(0)
v_smfmac_f32_16x16x64_bf16 v[24:27], v[146:149], v[100:107], v213
ds_read_b128 v[84:87], v200 offset:32
s_waitcnt lgkmcnt(0)
v_mfma_f32_16x16x32_bf16 v[4:7], v[150:153], v[84:87], 0
ds_read_b128 v[92:95], v201 offset:32
s_waitcnt lgkmcnt(0)
v_mfma_f32_16x16x32_bf16 v[16:19], v[150:153], v[92:95], 0
ds_read_b128 v[100:103], v202 offset:32
s_waitcnt lgkmcnt(0)
v_mfma_f32_16x16x32_bf16 v[28:31], v[150:153], v[100:103], 0
ds_read_b128 v[84:87], v194 offset:32
ds_read_b128 v[88:91], v194 offset:48
s_waitcnt lgkmcnt(0)
v_smfmac_f32_16x16x64_bf16 v[4:7], v[154:157], v[84:91], v213
ds_read_b128 v[92:95], v195 offset:32
ds_read_b128 v[96:99], v195 offset:48
s_waitcnt lgkmcnt(0)
v_smfmac_f32_16x16x64_bf16 v[16:19], v[154:157], v[92:99], v213
ds_read_b128 v[100:103], v196 offset:32
ds_read_b128 v[104:107], v196 offset:48
s_waitcnt lgkmcnt(0)
v_smfmac_f32_16x16x64_bf16 v[28:31], v[154:157], v[100:107], v213
ds_read_b128 v[84:87], v197 offset:32
ds_read_b128 v[88:91], v197 offset:48
s_waitcnt lgkmcnt(0)
v_smfmac_f32_16x16x64_bf16 v[4:7], v[158:161], v[84:91], v213
ds_read_b128 v[92:95], v198 offset:32
ds_read_b128 v[96:99], v198 offset:48
s_waitcnt lgkmcnt(0)
v_smfmac_f32_16x16x64_bf16 v[16:19], v[158:161], v[92:99], v213
ds_read_b128 v[100:103], v199 offset:32
ds_read_b128 v[104:107], v199 offset:48
s_waitcnt lgkmcnt(0)
v_smfmac_f32_16x16x64_bf16 v[28:31], v[158:161], v[100:107], v213
ds_read_b128 v[84:87], v200 offset:64
s_waitcnt lgkmcnt(0)
v_mfma_f32_16x16x32_bf16 v[8:11], v[162:165], v[84:87], 0
ds_read_b128 v[92:95], v201 offset:64
s_waitcnt lgkmcnt(0)
v_mfma_f32_16x16x32_bf16 v[20:23], v[162:165], v[92:95], 0
ds_read_b128 v[100:103], v202 offset:64
s_waitcnt lgkmcnt(0)
v_mfma_f32_16x16x32_bf16 v[32:35], v[162:165], v[100:103], 0
ds_read_b128 v[84:87], v194 offset:64
ds_read_b128 v[88:91], v194 offset:80
s_waitcnt lgkmcnt(0)
v_smfmac_f32_16x16x64_bf16 v[8:11], v[166:169], v[84:91], v213
ds_read_b128 v[92:95], v195 offset:64
ds_read_b128 v[96:99], v195 offset:80
s_waitcnt lgkmcnt(0)
v_smfmac_f32_16x16x64_bf16 v[20:23], v[166:169], v[92:99], v213
ds_read_b128 v[100:103], v196 offset:64
ds_read_b128 v[104:107], v196 offset:80
s_waitcnt lgkmcnt(0)
v_smfmac_f32_16x16x64_bf16 v[32:35], v[166:169], v[100:107], v213
ds_read_b128 v[84:87], v197 offset:64
ds_read_b128 v[88:91], v197 offset:80
s_waitcnt lgkmcnt(0)
v_smfmac_f32_16x16x64_bf16 v[8:11], v[170:173], v[84:91], v213
ds_read_b128 v[92:95], v198 offset:64
ds_read_b128 v[96:99], v198 offset:80
s_waitcnt lgkmcnt(0)
v_smfmac_f32_16x16x64_bf16 v[20:23], v[170:173], v[92:99], v213
ds_read_b128 v[100:103], v199 offset:64
ds_read_b128 v[104:107], v199 offset:80
s_waitcnt lgkmcnt(0)
v_smfmac_f32_16x16x64_bf16 v[32:35], v[170:173], v[100:107], v213
v_add_f32 v118, v0, v1
v_mul_f32 v119, v0, v0
v_add_f32 v118, v118, v2
v_fmac_f32 v119, v1, v1
v_add_f32 v118, v118, v3
v_fmac_f32 v119, v2, v2
v_fmac_f32 v119, v3, v3
v_add_f32 v126, v12, v13
v_mul_f32 v127, v12, v12
v_add_f32 v126, v126, v14
v_fmac_f32 v127, v13, v13
v_add_f32 v126, v126, v15
v_fmac_f32 v127, v14, v14
v_fmac_f32 v127, v15, v15
v_add_f32 v134, v24, v25
v_mul_f32 v135, v24, v24
v_add_f32 v134, v134, v26
v_fmac_f32 v135, v25, v25
v_add_f32 v134, v134, v27
v_fmac_f32 v135, v26, v26
v_fmac_f32 v135, v27, v27
v_add_f32 v118, v118, v4
v_fmac_f32 v119, v4, v4
v_add_f32 v118, v118, v5
v_fmac_f32 v119, v5, v5
v_add_f32 v118, v118, v6
v_fmac_f32 v119, v6, v6
v_add_f32 v118, v118, v7
v_fmac_f32 v119, v7, v7
v_add_f32 v126, v126, v16
v_fmac_f32 v127, v16, v16
v_add_f32 v126, v126, v17
v_fmac_f32 v127, v17, v17
v_add_f32 v126, v126, v18
v_fmac_f32 v127, v18, v18
v_add_f32 v126, v126, v19
v_fmac_f32 v127, v19, v19
v_add_f32 v134, v134, v28
v_fmac_f32 v135, v28, v28
v_add_f32 v134, v134, v29
v_fmac_f32 v135, v29, v29
v_add_f32 v134, v134, v30
v_fmac_f32 v135, v30, v30
v_add_f32 v134, v134, v31
v_fmac_f32 v135, v31, v31
v_add_f32 v118, v118, v8
v_fmac_f32 v119, v8, v8
v_add_f32 v118, v118, v9
v_fmac_f32 v119, v9, v9
v_add_f32 v118, v118, v10
v_fmac_f32 v119, v10, v10
v_add_f32 v118, v118, v11
v_fmac_f32 v119, v11, v11
v_add_f32 v126, v126, v20
v_fmac_f32 v127, v20, v20
v_add_f32 v126, v126, v21
v_fmac_f32 v127, v21, v21
v_add_f32 v126, v126, v22
v_fmac_f32 v127, v22, v22
v_add_f32 v126, v126, v23
v_fmac_f32 v127, v23, v23
v_add_f32 v134, v134, v32
v_fmac_f32 v135, v32, v32
v_add_f32 v134, v134, v33
v_fmac_f32 v135, v33, v33
v_add_f32 v134, v134, v34
v_fmac_f32 v135, v34, v34
v_add_f32 v134, v134, v35
v_fmac_f32 v135, v35, v35
v_permlane16_swap_b32 v118, v119
v_add_f32 v118, v118, v119
v_permlane16_swap_b32 v126, v127
v_add_f32 v126, v126, v127
v_permlane16_swap_b32 v134, v135
v_add_f32 v134, v134, v135
v_permlane32_swap_b32 v118, v126
v_add_f32 v118, v118, v126
ds_write_b32 v209, v118
v_mov_b32 v135, v134
s_nop 1
v_permlane32_swap_b32 v134, v135
v_add_f32 v134, v134, v135
ds_write_b32 v209, v134 offset:512
s_waitcnt lgkmcnt(0)
s_barrier
ds_read_b128 v[102:105], v210 offset:18432
ds_read_b128 v[106:109], v210 offset:19456
s_waitcnt lgkmcnt(1)
v_add_f32 v102, v102, v103
s_waitcnt lgkmcnt(0)
v_add_f32 v106, v106, v107
v_add_f32 v104, v104, v105
v_add_f32 v108, v108, v109
v_add_f32 v102, v102, v104
v_add_f32 v106, v106, v108
v_mul_f32 v103, s48, v102
v_mul_f32 v104, s73, v102
v_mul_f32 v106, s73, v106
v_fma_f32 v106, -v103, v104, v106
v_max_f32 v106, 0, v106
v_add_f32 v106, s49, v106
v_rsq_f32 v102, v106
s_nop 0
v_mul_f32_e64 v103, -v103, v102
ds_write_b64 v211, v[102:103]
ds_read_b64 v[118:119], v219
ds_read_b64 v[126:127], v219 offset:256
ds_read_b64 v[134:135], v219 offset:512
s_waitcnt lgkmcnt(2)
v_fma_f32 v220, v0, v118, v119
v_fma_f32 v221, v1, v118, v119
v_cvt_pk_bf16_f32 v174, v220, v221
v_fma_f32 v222, v2, v118, v119
v_fma_f32 v223, v3, v118, v119
v_cvt_pk_bf16_f32 v175, v222, v223
v_fma_f32 v220, v4, v118, v119
v_fma_f32 v221, v5, v118, v119
v_cvt_pk_bf16_f32 v176, v220, v221
v_fma_f32 v222, v6, v118, v119
v_fma_f32 v223, v7, v118, v119
v_cvt_pk_bf16_f32 v177, v222, v223
ds_write_b128 v211, v[174:177]
v_fma_f32 v220, v8, v118, v119
v_fma_f32 v221, v9, v118, v119
v_cvt_pk_bf16_f32 v178, v220, v221
v_fma_f32 v222, v10, v118, v119
v_fma_f32 v223, v11, v118, v119
v_cvt_pk_bf16_f32 v179, v222, v223
s_waitcnt lgkmcnt(2)
ds_write_b64 v212, v[178:179]
v_fma_f32 v220, v12, v126, v127
v_fma_f32 v221, v13, v126, v127
v_cvt_pk_bf16_f32 v90, v220, v221
v_fma_f32 v222, v14, v126, v127
v_fma_f32 v223, v15, v126, v127
v_cvt_pk_bf16_f32 v91, v222, v223
v_fma_f32 v220, v16, v126, v127
v_fma_f32 v221, v17, v126, v127
v_cvt_pk_bf16_f32 v92, v220, v221
v_fma_f32 v222, v18, v126, v127
v_fma_f32 v223, v19, v126, v127
v_cvt_pk_bf16_f32 v93, v222, v223
ds_write_b128 v211, v[90:93] offset:6144
v_fma_f32 v220, v20, v126, v127
v_fma_f32 v221, v21, v126, v127
v_cvt_pk_bf16_f32 v94, v220, v221
v_fma_f32 v222, v22, v126, v127
v_fma_f32 v223, v23, v126, v127
v_cvt_pk_bf16_f32 v95, v222, v223
s_waitcnt lgkmcnt(3)
ds_write_b64 v212, v[94:95] offset:6144
v_fma_f32 v220, v24, v134, v135
v_fma_f32 v221, v25, v134, v135
v_cvt_pk_bf16_f32 v90, v220, v221
v_fma_f32 v222, v26, v134, v135
v_fma_f32 v223, v27, v134, v135
v_cvt_pk_bf16_f32 v91, v222, v223
v_fma_f32 v220, v28, v134, v135
v_fma_f32 v221, v29, v134, v135
v_cvt_pk_bf16_f32 v92, v220, v221
v_fma_f32 v222, v30, v134, v135
v_fma_f32 v223, v31, v134, v135
v_cvt_pk_bf16_f32 v93, v222, v223
ds_write_b128 v211, v[90:93] offset:12288
v_fma_f32 v220, v32, v134, v135
v_fma_f32 v221, v33, v134, v135
v_cvt_pk_bf16_f32 v94, v220, v221
v_fma_f32 v222, v34, v134, v135
v_fma_f32 v223, v35, v134, v135
v_cvt_pk_bf16_f32 v95, v222, v223
ds_write_b64 v212, v[94:95] offset:12288
s_mov_b64 exec, s[30:31]
ds_write_b128 v217, v[138:141]
s_mov_b64 exec, -1
s_mov_b64 exec, s[30:31]
ds_write_b128 v217, v[142:145] offset:528
s_mov_b64 exec, -1
s_mov_b64 exec, s[30:31]
ds_write_b128 v217, v[146:149] offset:1056
s_mov_b64 exec, -1
s_mov_b64 exec, s[30:31]
ds_write_b128 v217, v[150:153] offset:1584
s_mov_b64 exec, -1
s_mov_b64 exec, s[30:31]
ds_write_b128 v217, v[154:157] offset:2112
s_mov_b64 exec, -1
s_mov_b64 exec, s[30:31]
ds_write_b128 v217, v[158:161] offset:2640
s_mov_b64 exec, -1
s_mov_b64 exec, s[30:31]
ds_write_b128 v217, v[162:165] offset:3168
s_mov_b64 exec, -1
s_mov_b64 exec, s[30:31]
ds_write_b128 v217, v[166:169] offset:3696
s_mov_b64 exec, -1
s_mov_b64 exec, s[30:31]
ds_write_b128 v217, v[170:173] offset:4224
s_mov_b64 exec, -1
s_add_u32 m0, s55, 0
s_add_u32 s29, s54, 37248
buffer_load_dwordx4 v72, s[12:15], s29 offen lds
s_add_u32 m0, s55, 1024
s_add_u32 s29, s54, 37248
buffer_load_dwordx4 v73, s[12:15], s29 offen lds
s_add_u32 m0, s55, 2048
s_add_u32 s29, s54, 37248
buffer_load_dwordx4 v74, s[12:15], s29 offen lds
s_add_u32 m0, s55, 12288
s_add_u32 s29, s54, 74112
buffer_load_dwordx4 v72, s[12:15], s29 offen lds
s_add_u32 m0, s55, 13312
s_add_u32 s29, s54, 74112
buffer_load_dwordx4 v73, s[12:15], s29 offen lds
s_add_u32 m0, s55, 14336
s_add_u32 s29, s54, 74112
buffer_load_dwordx4 v74, s[12:15], s29 offen lds
s_add_u32 m0, s55, 24576
s_add_u32 s29, s54, 110976
buffer_load_dwordx4 v72, s[12:15], s29 offen lds
s_add_u32 m0, s55, 25600
s_add_u32 s29, s54, 110976
buffer_load_dwordx4 v73, s[12:15], s29 offen lds
s_waitcnt vmcnt(11) lgkmcnt(9)
s_add_u32 m0, s55, 26624
s_add_u32 s29, s54, 110976
buffer_load_dwordx4 v74, s[12:15], s29 offen lds
s_barrier
ds_read_b128 v[84:87], v113
s_waitcnt lgkmcnt(0)
v_mfma_f32_16x16x32_bf16 v[36:39], v[138:141], v[84:87], 0
ds_read_b128 v[92:95], v113 offset:55552
s_waitcnt lgkmcnt(0)
v_mfma_f32_16x16x32_bf16 v[48:51], v[138:141], v[92:95], 0
ds_read_b128 v[100:103], v111
ds_read_b128 v[104:107], v111 offset:16
s_waitcnt lgkmcnt(0)
v_smfmac_f32_16x16x64_bf16 v[36:39], v[142:145], v[100:107], v213
ds_read_b128 v[84:87], v111 offset:55552
ds_read_b128 v[88:91], v111 offset:55568
s_waitcnt lgkmcnt(0)
v_smfmac_f32_16x16x64_bf16 v[48:51], v[142:145], v[84:91], v213
ds_read_b128 v[92:95], v112
ds_read_b128 v[96:99], v112 offset:16
s_waitcnt lgkmcnt(0)
v_smfmac_f32_16x16x64_bf16 v[36:39], v[146:149], v[92:99], v213
ds_read_b128 v[100:103], v112 offset:55552
ds_read_b128 v[104:107], v112 offset:55568
s_waitcnt lgkmcnt(0)
v_smfmac_f32_16x16x64_bf16 v[48:51], v[146:149], v[100:107], v213
ds_read_b128 v[84:87], v113 offset:32
s_waitcnt lgkmcnt(0)
v_mfma_f32_16x16x32_bf16 v[40:43], v[150:153], v[84:87], 0
ds_read_b128 v[92:95], v113 offset:55584
s_waitcnt lgkmcnt(0)
v_mfma_f32_16x16x32_bf16 v[52:55], v[150:153], v[92:95], 0
ds_read_b128 v[100:103], v111 offset:32
ds_read_b128 v[104:107], v111 offset:48
s_waitcnt lgkmcnt(0)
v_smfmac_f32_16x16x64_bf16 v[40:43], v[154:157], v[100:107], v213
ds_read_b128 v[84:87], v111 offset:55584
ds_read_b128 v[88:91], v111 offset:55600
s_waitcnt lgkmcnt(0)
v_smfmac_f32_16x16x64_bf16 v[52:55], v[154:157], v[84:91], v213
ds_read_b128 v[92:95], v112 offset:32
ds_read_b128 v[96:99], v112 offset:48
s_waitcnt lgkmcnt(0)
v_smfmac_f32_16x16x64_bf16 v[40:43], v[158:161], v[92:99], v213
ds_read_b128 v[100:103], v112 offset:55584
ds_read_b128 v[104:107], v112 offset:55600
s_waitcnt lgkmcnt(0)
v_smfmac_f32_16x16x64_bf16 v[52:55], v[158:161], v[100:107], v213
ds_read_b128 v[84:87], v113 offset:64
s_waitcnt lgkmcnt(0)
v_mfma_f32_16x16x32_bf16 v[44:47], v[162:165], v[84:87], 0
ds_read_b128 v[92:95], v113 offset:55616
s_waitcnt lgkmcnt(0)
v_mfma_f32_16x16x32_bf16 v[56:59], v[162:165], v[92:95], 0
ds_read_b128 v[100:103], v111 offset:64
ds_read_b128 v[104:107], v111 offset:80
s_waitcnt lgkmcnt(0)
v_smfmac_f32_16x16x64_bf16 v[44:47], v[166:169], v[100:107], v213
ds_read_b128 v[84:87], v111 offset:55616
ds_read_b128 v[88:91], v111 offset:55632
s_waitcnt lgkmcnt(0)
v_smfmac_f32_16x16x64_bf16 v[56:59], v[166:169], v[84:91], v213
ds_read_b128 v[92:95], v112 offset:64
ds_read_b128 v[96:99], v112 offset:80
s_waitcnt lgkmcnt(0)
v_smfmac_f32_16x16x64_bf16 v[44:47], v[170:173], v[92:99], v213
ds_read_b128 v[100:103], v112 offset:55616
ds_read_b128 v[104:107], v112 offset:55632
s_waitcnt lgkmcnt(0)
v_smfmac_f32_16x16x64_bf16 v[56:59], v[170:173], v[100:107], v213
s_barrier
v_add_f32 v118, v36, v37
v_mul_f32 v119, v36, v36
v_add_f32 v118, v118, v38
v_fmac_f32 v119, v37, v37
v_add_f32 v118, v118, v39
v_fmac_f32 v119, v38, v38
v_fmac_f32 v119, v39, v39
v_add_f32 v126, v48, v49
v_mul_f32 v127, v48, v48
v_add_f32 v126, v126, v50
v_fmac_f32 v127, v49, v49
v_add_f32 v126, v126, v51
v_fmac_f32 v127, v50, v50
v_fmac_f32 v127, v51, v51
v_add_f32 v118, v118, v40
v_fmac_f32 v119, v40, v40
v_add_f32 v118, v118, v41
v_fmac_f32 v119, v41, v41
v_add_f32 v118, v118, v42
v_fmac_f32 v119, v42, v42
v_add_f32 v118, v118, v43
v_fmac_f32 v119, v43, v43
v_add_f32 v126, v126, v52
v_fmac_f32 v127, v52, v52
v_add_f32 v126, v126, v53
v_fmac_f32 v127, v53, v53
v_add_f32 v126, v126, v54
v_fmac_f32 v127, v54, v54
v_add_f32 v126, v126, v55
v_fmac_f32 v127, v55, v55
v_add_f32 v118, v118, v44
v_fmac_f32 v119, v44, v44
v_add_f32 v118, v118, v45
v_fmac_f32 v119, v45, v45
v_add_f32 v118, v118, v46
v_fmac_f32 v119, v46, v46
v_add_f32 v118, v118, v47
v_fmac_f32 v119, v47, v47
v_add_f32 v126, v126, v56
v_fmac_f32 v127, v56, v56
v_add_f32 v126, v126, v57
v_fmac_f32 v127, v57, v57
v_add_f32 v126, v126, v58
v_fmac_f32 v127, v58, v58
v_add_f32 v126, v126, v59
v_fmac_f32 v127, v59, v59
v_permlane16_swap_b32 v118, v119
v_add_f32 v118, v118, v119
v_permlane16_swap_b32 v126, v127
v_add_f32 v126, v126, v127
s_nop 1
v_permlane32_swap_b32 v118, v126
v_add_f32 v118, v118, v126
ds_write_b32 v209, v118
s_add_u32 m0, s55, 94464
s_add_u32 s29, s54, 147840
buffer_load_dwordx4 v72, s[12:15], s29 offen lds
s_add_u32 m0, s55, 95488
s_add_u32 s29, s54, 147840
buffer_load_dwordx4 v73, s[12:15], s29 offen lds
s_add_u32 m0, s55, 96512
s_add_u32 s29, s54, 147840
buffer_load_dwordx4 v74, s[12:15], s29 offen lds
s_add_u32 m0, s55, 106752
s_add_u32 s29, s54, 184704
buffer_load_dwordx4 v72, s[12:15], s29 offen lds
s_add_u32 m0, s55, 107776
s_add_u32 s29, s54, 184704
buffer_load_dwordx4 v73, s[12:15], s29 offen lds
s_add_u32 m0, s55, 108800
s_add_u32 s29, s54, 184704
buffer_load_dwordx4 v74, s[12:15], s29 offen lds
s_add_u32 m0, s55, 119040
s_add_u32 s29, s54, 0
buffer_load_dwordx4 v72, s[12:15], s29 offen lds
s_add_u32 m0, s55, 120064
s_add_u32 s29, s54, 0
buffer_load_dwordx4 v73, s[12:15], s29 offen lds
s_add_u32 m0, s55, 121088
s_add_u32 s29, s54, 0
buffer_load_dwordx4 v74, s[12:15], s29 offen lds
s_add_u32 m0, s55, 69888
s_add_u32 s29, s54, 36864
buffer_load_dwordx4 v72, s[12:15], s29 offen lds
s_add_u32 m0, s55, 70912
s_add_u32 s29, s54, 36864
buffer_load_dwordx4 v73, s[12:15], s29 offen lds
s_add_u32 m0, s55, 71936
s_add_u32 s29, s54, 36864
buffer_load_dwordx4 v74, s[12:15], s29 offen lds
s_add_u32 m0, s55, 82176
s_add_u32 s29, s54, 73728
buffer_load_dwordx4 v72, s[12:15], s29 offen lds
s_add_u32 m0, s55, 83200
s_add_u32 s29, s54, 73728
buffer_load_dwordx4 v73, s[12:15], s29 offen lds
s_add_u32 m0, s55, 84224
s_add_u32 s29, s54, 73728
buffer_load_dwordx4 v74, s[12:15], s29 offen lds
s_waitcnt vmcnt(25)
ds_read_b64_tr_b16 a[0:1], v110 offset:36864
ds_read_b64_tr_b16 a[24:25], v110 offset:36896
ds_read_b64_tr_b16 a[48:49], v110 offset:36928
s_waitcnt vmcnt(24)
ds_read_b64_tr_b16 a[2:3], v110 offset:38400
ds_read_b64_tr_b16 a[26:27], v110 offset:38432
ds_read_b64_tr_b16 a[50:51], v110 offset:38464
s_waitcnt vmcnt(21)
ds_read_b64_tr_b16 a[4:5], v128 offset:1536
ds_read_b64_tr_b16 a[28:29], v128 offset:1568
ds_read_b64_tr_b16 a[52:53], v128 offset:1600
ds_read_b64_tr_b16 a[16:17], v128
ds_read_b64_tr_b16 a[40:41], v128 offset:32
ds_read_b64_tr_b16 a[64:65], v128 offset:64
s_waitcnt vmcnt(19)
ds_read_b64_tr_b16 a[6:7], v128 offset:12288
ds_read_b64_tr_b16 a[30:31], v128 offset:12320
ds_read_b64_tr_b16 a[54:55], v128 offset:12352
s_waitcnt vmcnt(18)
ds_read_b64_tr_b16 a[18:19], v128 offset:13824
ds_read_b64_tr_b16 a[42:43], v128 offset:13856
ds_read_b64_tr_b16 a[66:67], v128 offset:13888
s_waitcnt vmcnt(16)
ds_read_b64_tr_b16 a[8:9], v128 offset:24576
ds_read_b64_tr_b16 a[32:33], v128 offset:24608
ds_read_b64_tr_b16 a[56:57], v128 offset:24640
s_waitcnt vmcnt(15)
ds_read_b64_tr_b16 a[10:11], v128 offset:26112
ds_read_b64_tr_b16 a[34:35], v128 offset:26144
ds_read_b64_tr_b16 a[58:59], v128 offset:26176
v_mov_b32 v128, v83
s_waitcnt lgkmcnt(14)
s_add_u32 m0, s55, 131328
s_add_u32 s29, s54, 110592
buffer_load_dwordx4 v72, s[12:15], s29 offen lds
s_add_u32 m0, s55, 132352
s_add_u32 s29, s54, 110592
buffer_load_dwordx4 v73, s[12:15], s29 offen lds
s_add_u32 m0, s55, 133376
s_add_u32 s29, s54, 110592
buffer_load_dwordx4 v74, s[12:15], s29 offen lds
s_barrier
ds_read_b128 v[102:105], v210 offset:18432
ds_read_b128 v[106:109], v210 offset:19456
s_waitcnt lgkmcnt(1)
v_add_f32 v102, v102, v103
s_waitcnt lgkmcnt(0)
v_add_f32 v106, v106, v107
v_add_f32 v104, v104, v105
v_add_f32 v108, v108, v109
v_add_f32 v102, v102, v104
v_add_f32 v106, v106, v108
v_mul_f32 v103, s48, v102
v_mul_f32 v104, s73, v102
v_mul_f32 v106, s73, v106
v_fma_f32 v106, -v103, v104, v106
v_max_f32 v106, 0, v106
v_add_f32 v106, s49, v106
v_rsq_f32 v102, v106
s_nop 0
v_mul_f32_e64 v103, -v103, v102
ds_write_b64 v211, v[102:103] offset:20480
ds_read_b64 v[118:119], v219 offset:20480
ds_read_b64 v[126:127], v219 offset:20736
s_waitcnt lgkmcnt(1)
v_fma_f32 v220, v36, v118, v119
v_fma_f32 v221, v37, v118, v119
v_cvt_pk_bf16_f32 v174, v220, v221
v_fma_f32 v222, v38, v118, v119
v_fma_f32 v223, v39, v118, v119
v_cvt_pk_bf16_f32 v175, v222, v223
v_fma_f32 v220, v40, v118, v119
v_fma_f32 v221, v41, v118, v119
v_cvt_pk_bf16_f32 v176, v220, v221
v_fma_f32 v222, v42, v118, v119
v_fma_f32 v223, v43, v118, v119
v_cvt_pk_bf16_f32 v177, v222, v223
ds_write_b128 v211, v[174:177] offset:20480
v_fma_f32 v220, v44, v118, v119
v_fma_f32 v221, v45, v118, v119
v_cvt_pk_bf16_f32 v178, v220, v221
v_fma_f32 v222, v46, v118, v119
v_fma_f32 v223, v47, v118, v119
v_cvt_pk_bf16_f32 v179, v222, v223
s_waitcnt lgkmcnt(1)
ds_write_b64 v212, v[178:179] offset:20480
v_fma_f32 v220, v48, v126, v127
v_fma_f32 v221, v49, v126, v127
v_cvt_pk_bf16_f32 v90, v220, v221
v_fma_f32 v222, v50, v126, v127
v_fma_f32 v223, v51, v126, v127
v_cvt_pk_bf16_f32 v91, v222, v223
v_fma_f32 v220, v52, v126, v127
v_fma_f32 v221, v53, v126, v127
v_cvt_pk_bf16_f32 v92, v220, v221
v_fma_f32 v222, v54, v126, v127
v_fma_f32 v223, v55, v126, v127
v_cvt_pk_bf16_f32 v93, v222, v223
ds_write_b128 v211, v[90:93] offset:26624
v_fma_f32 v220, v56, v126, v127
v_fma_f32 v221, v57, v126, v127
v_cvt_pk_bf16_f32 v94, v220, v221
v_fma_f32 v222, v58, v126, v127
v_fma_f32 v223, v59, v126, v127
v_cvt_pk_bf16_f32 v95, v222, v223
ds_write_b64 v212, v[94:95] offset:26624
s_waitcnt vmcnt(15) lgkmcnt(0)
s_barrier
ds_read_b64_tr_b16 a[12:13], v110 offset:1536
ds_read_b64_tr_b16 a[36:37], v110 offset:1568
ds_read_b64_tr_b16 a[60:61], v110 offset:1600
ds_read_b64_tr_b16 a[20:21], v110
ds_read_b64_tr_b16 a[44:45], v110 offset:32
ds_read_b64_tr_b16 a[68:69], v110 offset:64
s_waitcnt lgkmcnt(0)
s_add_u32 m0, s55, 94464
s_add_u32 s29, s54, 147456
buffer_load_dwordx4 v72, s[12:15], s29 offen lds
s_add_u32 m0, s55, 95488
s_add_u32 s29, s54, 147456
buffer_load_dwordx4 v73, s[12:15], s29 offen lds
s_add_u32 m0, s55, 96512
s_add_u32 s29, s54, 147456
buffer_load_dwordx4 v74, s[12:15], s29 offen lds
s_waitcnt vmcnt(16)
ds_read_b64_tr_b16 a[14:15], v110 offset:12288
ds_read_b64_tr_b16 a[38:39], v110 offset:12320
ds_read_b64_tr_b16 a[62:63], v110 offset:12352
s_waitcnt vmcnt(15)
ds_read_b64_tr_b16 a[22:23], v110 offset:13824
ds_read_b64_tr_b16 a[46:47], v110 offset:13856
ds_read_b64_tr_b16 a[70:71], v110 offset:13888
s_waitcnt lgkmcnt(0)
s_add_u32 m0, s55, 106752
s_add_u32 s29, s54, 184320
buffer_load_dwordx4 v72, s[12:15], s29 offen lds
s_add_u32 m0, s55, 107776
s_add_u32 s29, s54, 184320
buffer_load_dwordx4 v73, s[12:15], s29 offen lds
s_add_u32 m0, s55, 108800
s_add_u32 s29, s54, 184320
buffer_load_dwordx4 v74, s[12:15], s29 offen lds
s_waitcnt vmcnt(16)
ds_read_b64_tr_b16 a[216:217], v110 offset:24576
ds_read_b64_tr_b16 a[240:241], v110 offset:24608
ds_read_b64_tr_b16 v[232:233], v110 offset:24640
s_waitcnt vmcnt(15)
ds_read_b64_tr_b16 a[218:219], v110 offset:26112
ds_read_b64_tr_b16 a[242:243], v110 offset:26144
ds_read_b64_tr_b16 v[234:235], v110 offset:26176
s_waitcnt lgkmcnt(0)
s_add_u32 m0, s55, 119040
s_add_u32 s29, s54, 768
buffer_load_dwordx4 v72, s[12:15], s29 offen lds
s_add_u32 m0, s55, 120064
s_add_u32 s29, s54, 768
buffer_load_dwordx4 v73, s[12:15], s29 offen lds
s_add_u32 m0, s55, 121088
s_add_u32 s29, s54, 768
buffer_load_dwordx4 v74, s[12:15], s29 offen lds
s_waitcnt vmcnt(15)
ds_read_b64_tr_b16 a[220:221], v129 offset:1536
ds_read_b64_tr_b16 a[244:245], v129 offset:1568
ds_read_b64_tr_b16 v[236:237], v129 offset:1600
ds_read_b64_tr_b16 a[232:233], v129
ds_read_b64_tr_b16 v[224:225], v129 offset:32
ds_read_b64_tr_b16 v[248:249], v129 offset:64
s_waitcnt lgkmcnt(0)
s_add_u32 m0, s55, 69888
s_add_u32 s29, s54, 37632
buffer_load_dwordx4 v72, s[12:15], s29 offen lds
s_add_u32 m0, s55, 70912
s_add_u32 s29, s54, 37632
buffer_load_dwordx4 v73, s[12:15], s29 offen lds
s_add_u32 m0, s55, 71936
s_add_u32 s29, s54, 37632
buffer_load_dwordx4 v74, s[12:15], s29 offen lds
s_waitcnt vmcnt(16)
ds_read_b64_tr_b16 a[222:223], v129 offset:12288
ds_read_b64_tr_b16 a[246:247], v129 offset:12320
ds_read_b64_tr_b16 v[238:239], v129 offset:12352
s_waitcnt vmcnt(15)
ds_read_b64_tr_b16 a[234:235], v129 offset:13824
ds_read_b64_tr_b16 v[226:227], v129 offset:13856
ds_read_b64_tr_b16 v[250:251], v129 offset:13888
s_waitcnt lgkmcnt(0)
s_add_u32 m0, s55, 82176
s_add_u32 s29, s54, 74496
buffer_load_dwordx4 v72, s[12:15], s29 offen lds
s_add_u32 m0, s55, 83200
s_add_u32 s29, s54, 74496
buffer_load_dwordx4 v73, s[12:15], s29 offen lds
s_add_u32 m0, s55, 84224
s_add_u32 s29, s54, 74496
buffer_load_dwordx4 v74, s[12:15], s29 offen lds
s_waitcnt vmcnt(16)
ds_read_b64_tr_b16 a[224:225], v110 offset:36864
ds_read_b64_tr_b16 a[248:249], v110 offset:36896
ds_read_b64_tr_b16 v[240:241], v110 offset:36928
s_waitcnt vmcnt(15)
ds_read_b64_tr_b16 a[226:227], v110 offset:38400
ds_read_b64_tr_b16 a[250:251], v110 offset:38432
ds_read_b64_tr_b16 v[242:243], v110 offset:38464
s_waitcnt lgkmcnt(0)
s_add_u32 m0, s55, 131328
s_add_u32 s29, s54, 111360
buffer_load_dwordx4 v72, s[12:15], s29 offen lds
s_add_u32 m0, s55, 132352
s_add_u32 s29, s54, 111360
buffer_load_dwordx4 v73, s[12:15], s29 offen lds
s_add_u32 m0, s55, 133376
s_add_u32 s29, s54, 111360
buffer_load_dwordx4 v74, s[12:15], s29 offen lds
s_waitcnt vmcnt(15)
ds_read_b64_tr_b16 a[228:229], v110 offset:1536
ds_read_b64_tr_b16 a[252:253], v110 offset:1568
ds_read_b64_tr_b16 v[244:245], v110 offset:1600
ds_read_b64_tr_b16 a[236:237], v110
ds_read_b64_tr_b16 v[228:229], v110 offset:32
ds_read_b64_tr_b16 v[252:253], v110 offset:64
s_waitcnt lgkmcnt(0)
s_add_u32 m0, s55, 94464
s_add_u32 s29, s54, 148224
buffer_load_dwordx4 v72, s[12:15], s29 offen lds
s_add_u32 m0, s55, 95488
s_add_u32 s29, s54, 148224
buffer_load_dwordx4 v73, s[12:15], s29 offen lds
s_add_u32 m0, s55, 96512
s_add_u32 s29, s54, 148224
buffer_load_dwordx4 v74, s[12:15], s29 offen lds
s_waitcnt vmcnt(16)
ds_read_b64_tr_b16 a[230:231], v110 offset:12288
ds_read_b64_tr_b16 a[254:255], v110 offset:12320
ds_read_b64_tr_b16 v[246:247], v110 offset:12352
s_waitcnt vmcnt(15)
ds_read_b64_tr_b16 a[238:239], v110 offset:13824
ds_read_b64_tr_b16 v[230:231], v110 offset:13856
ds_read_b64_tr_b16 v[254:255], v110 offset:13888
s_waitcnt lgkmcnt(0)
s_add_u32 m0, s55, 106752
s_add_u32 s29, s54, 185088
buffer_load_dwordx4 v72, s[12:15], s29 offen lds
s_add_u32 m0, s55, 107776
s_add_u32 s29, s54, 185088
buffer_load_dwordx4 v73, s[12:15], s29 offen lds
s_add_u32 m0, s55, 108800
s_add_u32 s29, s54, 185088
buffer_load_dwordx4 v74, s[12:15], s29 offen lds
s_mul_hi_u32 s41, s35, 58835169
s_mul_i32 s42, s41, 73
s_sub_u32 s42, s35, s42
s_mul_i32 s43, s41, 1373568
s_mul_i32 s51, s42, 2688
s_add_u32 s50, s43, s51
s_add_u32 s35, s35, 32
s_min_u32 s41, s41, 1
s_sub_u32 s41, 1, s41
s_lshl_b32 s41, s41, 30
s_add_u32 s52, s50, s41
s_min_u32 s43, s42, 1
s_lshl_b32 s43, s43, 27
s_sub_u32 s43, 536870911, s43
s_add_u32 s51, s42, 56
s_and_b32 s51, s51, 128
s_lshl_b32 s51, s51, 22
s_or_b32 s44, s43, s51
s_mov_b32 s37, s50
v_and_b32 v216, s44, v208
s_add_u32 m0, s45, 0
s_nop 0
buffer_load_dwordx4 v216, s[4:7], s52 offen nt lds
s_add_u32 m0, s45, 4112
s_add_u32 s40, s37, 196224
buffer_load_dwordx4 v216, s[4:7], s40 offen nt lds
s_add_u32 m0, s45, 8224
s_add_u32 s40, s37, 392448
buffer_load_dwordx4 v216, s[4:7], s40 offen nt lds
s_add_u32 m0, s45, 12336
s_add_u32 s40, s37, 588672
buffer_load_dwordx4 v216, s[4:7], s40 offen nt lds
s_add_u32 m0, s45, 16448
s_add_u32 s40, s37, 784896
buffer_load_dwordx4 v216, s[4:7], s40 offen nt lds
s_add_u32 m0, s45, 20560
s_add_u32 s40, s37, 981120
buffer_load_dwordx4 v216, s[4:7], s40 offen nt lds
s_add_u32 m0, s45, 24672
s_add_u32 s40, s37, 1177344
buffer_load_dwordx4 v216, s[4:7], s40 offen nt lds
s_add_u32 m0, s45, 28784
s_add_u32 s40, s37, 1373568
buffer_load_dwordx4 v216, s[4:7], s40 offen nt lds
s_add_u32 m0, s45, 32896
s_add_u32 s40, s37, 1569792
buffer_load_dwordx4 v216, s[4:7], s40 offen nt lds
s_waitcnt vmcnt(25)
ds_read_b64_tr_b16 a[72:73], v110 offset:24576
ds_read_b64_tr_b16 a[96:97], v110 offset:24608
ds_read_b64_tr_b16 a[120:121], v110 offset:24640
s_waitcnt vmcnt(24)
ds_read_b64_tr_b16 a[74:75], v110 offset:26112
ds_read_b64_tr_b16 a[98:99], v110 offset:26144
ds_read_b64_tr_b16 a[122:123], v110 offset:26176
s_waitcnt vmcnt(21)
ds_read_b64_tr_b16 a[76:77], v129 offset:1536
ds_read_b64_tr_b16 a[100:101], v129 offset:1568
ds_read_b64_tr_b16 a[124:125], v129 offset:1600
ds_read_b64_tr_b16 a[88:89], v129
ds_read_b64_tr_b16 a[112:113], v129 offset:32
ds_read_b64_tr_b16 a[136:137], v129 offset:64
s_waitcnt lgkmcnt(0)
s_add_u32 m0, s55, 69888
s_add_u32 s29, s54, 0
buffer_load_dwordx4 v136, s[16:19], s29 offen lds
s_add_u32 m0, s55, 70912
s_add_u32 s29, s54, 0
buffer_load_dwordx4 v137, s[16:19], s29 offen lds
s_add_u32 m0, s55, 71936
s_add_u32 s29, s54, 0
buffer_load_dwordx4 v128, s[16:19], s29 offen lds
s_waitcnt vmcnt(22)
ds_read_b64_tr_b16 a[78:79], v129 offset:12288
ds_read_b64_tr_b16 a[102:103], v129 offset:12320
ds_read_b64_tr_b16 a[126:127], v129 offset:12352
s_waitcnt vmcnt(21)
ds_read_b64_tr_b16 a[90:91], v129 offset:13824
ds_read_b64_tr_b16 a[114:115], v129 offset:13856
ds_read_b64_tr_b16 a[138:139], v129 offset:13888
s_waitcnt lgkmcnt(0)
s_add_u32 m0, s55, 82176
s_add_u32 s29, s54, 12288
buffer_load_dwordx4 v136, s[16:19], s29 offen lds
s_add_u32 m0, s55, 83200
s_add_u32 s29, s54, 12288
buffer_load_dwordx4 v137, s[16:19], s29 offen lds
s_add_u32 m0, s55, 84224
s_add_u32 s29, s54, 12288
buffer_load_dwordx4 v128, s[16:19], s29 offen lds
s_waitcnt vmcnt(22)
ds_read_b64_tr_b16 a[80:81], v110 offset:36864
ds_read_b64_tr_b16 a[104:105], v110 offset:36896
ds_read_b64_tr_b16 a[128:129], v110 offset:36928
s_waitcnt vmcnt(21)
ds_read_b64_tr_b16 a[82:83], v110 offset:38400
ds_read_b64_tr_b16 a[106:107], v110 offset:38432
ds_read_b64_tr_b16 a[130:131], v110 offset:38464
s_waitcnt vmcnt(18)
ds_read_b64_tr_b16 a[84:85], v110 offset:1536
ds_read_b64_tr_b16 a[108:109], v110 offset:1568
ds_read_b64_tr_b16 a[132:133], v110 offset:1600
ds_read_b64_tr_b16 a[92:93], v110
ds_read_b64_tr_b16 a[116:117], v110 offset:32
ds_read_b64_tr_b16 a[140:141], v110 offset:64
s_waitcnt vmcnt(16)
ds_read_b64_tr_b16 a[86:87], v110 offset:12288
ds_read_b64_tr_b16 a[110:111], v110 offset:12320
ds_read_b64_tr_b16 a[134:135], v110 offset:12352
s_waitcnt vmcnt(15)
ds_read_b64_tr_b16 a[94:95], v110 offset:13824
ds_read_b64_tr_b16 a[118:119], v110 offset:13856
ds_read_b64_tr_b16 a[142:143], v110 offset:13888
s_waitcnt vmcnt(4)
ds_read_b64_tr_b16 a[144:145], v129
ds_read_b64_tr_b16 a[168:169], v129 offset:32
ds_read_b64_tr_b16 a[192:193], v129 offset:64
s_waitcnt vmcnt(3)
ds_read_b64_tr_b16 a[146:147], v129 offset:1536
ds_read_b64_tr_b16 a[170:171], v129 offset:1568
ds_read_b64_tr_b16 a[194:195], v129 offset:1600
s_waitcnt lgkmcnt(0)
s_add_u32 m0, s55, 69888
s_add_u32 s29, s54, 24576
buffer_load_dwordx4 v136, s[16:19], s29 offen lds
s_add_u32 m0, s55, 70912
s_add_u32 s29, s54, 24576
buffer_load_dwordx4 v137, s[16:19], s29 offen lds
s_add_u32 m0, s55, 71936
s_add_u32 s29, s54, 24576
buffer_load_dwordx4 v128, s[16:19], s29 offen lds
s_waitcnt vmcnt(3)
ds_read_b64_tr_b16 a[148:149], v129 offset:13824
ds_read_b64_tr_b16 a[172:173], v129 offset:13856
ds_read_b64_tr_b16 a[196:197], v129 offset:13888
ds_read_b64_tr_b16 a[160:161], v129 offset:12288
ds_read_b64_tr_b16 a[184:185], v129 offset:12320
ds_read_b64_tr_b16 a[208:209], v129 offset:12352
s_waitcnt lgkmcnt(0)
s_add_u32 m0, s55, 82176
s_add_u32 s29, s54, 36864
buffer_load_dwordx4 v136, s[16:19], s29 offen lds
s_add_u32 m0, s55, 83200
s_add_u32 s29, s54, 36864
buffer_load_dwordx4 v137, s[16:19], s29 offen lds
s_add_u32 m0, s55, 84224
s_add_u32 s29, s54, 36864
buffer_load_dwordx4 v128, s[16:19], s29 offen lds
s_waitcnt vmcnt(4)
ds_read_b64_tr_b16 a[150:151], v129
ds_read_b64_tr_b16 a[174:175], v129 offset:32
ds_read_b64_tr_b16 a[198:199], v129 offset:64
s_waitcnt vmcnt(3)
ds_read_b64_tr_b16 a[162:163], v129 offset:1536
ds_read_b64_tr_b16 a[186:187], v129 offset:1568
ds_read_b64_tr_b16 a[210:211], v129 offset:1600
s_waitcnt lgkmcnt(0)
s_add_u32 m0, s55, 69888
s_add_u32 s29, s54, 49152
buffer_load_dwordx4 v136, s[16:19], s29 offen lds
s_add_u32 m0, s55, 70912
s_add_u32 s29, s54, 49152
buffer_load_dwordx4 v137, s[16:19], s29 offen lds
s_add_u32 m0, s55, 71936
s_add_u32 s29, s54, 49152
buffer_load_dwordx4 v128, s[16:19], s29 offen lds
s_waitcnt vmcnt(4)
ds_read_b64_tr_b16 a[152:153], v129 offset:12288
ds_read_b64_tr_b16 a[176:177], v129 offset:12320
ds_read_b64_tr_b16 a[200:201], v129 offset:12352
s_waitcnt vmcnt(3)
ds_read_b64_tr_b16 a[154:155], v129 offset:13824
ds_read_b64_tr_b16 a[178:179], v129 offset:13856
ds_read_b64_tr_b16 a[202:203], v129 offset:13888
s_waitcnt lgkmcnt(0)
s_add_u32 m0, s55, 82176
s_add_u32 s29, s54, 61440
buffer_load_dwordx4 v136, s[16:19], s29 offen lds
s_add_u32 m0, s55, 83200
s_add_u32 s29, s54, 61440
buffer_load_dwordx4 v137, s[16:19], s29 offen lds
s_add_u32 m0, s55, 84224
s_add_u32 s29, s54, 61440
buffer_load_dwordx4 v128, s[16:19], s29 offen lds
s_waitcnt vmcnt(3)
ds_read_b64_tr_b16 a[156:157], v129 offset:1536
ds_read_b64_tr_b16 a[180:181], v129 offset:1568
ds_read_b64_tr_b16 a[204:205], v129 offset:1600
ds_read_b64_tr_b16 a[164:165], v129
ds_read_b64_tr_b16 a[188:189], v129 offset:32
ds_read_b64_tr_b16 a[212:213], v129 offset:64
s_waitcnt vmcnt(1)
ds_read_b64_tr_b16 a[158:159], v129 offset:12288
ds_read_b64_tr_b16 a[182:183], v129 offset:12320
ds_read_b64_tr_b16 a[206:207], v129 offset:12352
s_waitcnt vmcnt(0)
ds_read_b64_tr_b16 a[166:167], v129 offset:13824
ds_read_b64_tr_b16 a[190:191], v129 offset:13856
ds_read_b64_tr_b16 a[214:215], v129 offset:13888
ds_read_b128 v[182:185], v210 offset:20480
s_waitcnt lgkmcnt(0)
v_mfma_f32_16x16x32_bf16 v[138:141], a[0:3], v[182:185], 0
v_mfma_f32_16x16x32_bf16 v[142:145], a[24:27], v[182:185], 0
v_mfma_f32_16x16x32_bf16 v[146:149], a[48:51], v[182:185], 0
ds_read_b128 v[186:189], v210 offset:26624
s_waitcnt lgkmcnt(0)
v_mfma_f32_16x16x32_bf16 v[150:153], a[0:3], v[186:189], 0
v_mfma_f32_16x16x32_bf16 v[154:157], a[24:27], v[186:189], 0
v_mfma_f32_16x16x32_bf16 v[158:161], a[48:51], v[186:189], 0
ds_read_b128 v[114:117], v210 offset:21504
s_waitcnt lgkmcnt(0)
v_mfma_f32_16x16x32_bf16 v[138:141], a[4:7], v[114:117], v[138:141]
v_mfma_f32_16x16x32_bf16 v[142:145], a[28:31], v[114:117], v[142:145]
v_mfma_f32_16x16x32_bf16 v[146:149], a[52:55], v[114:117], v[146:149]
ds_read_b128 v[122:125], v210 offset:27648
s_waitcnt lgkmcnt(0)
v_mfma_f32_16x16x32_bf16 v[150:153], a[4:7], v[122:125], v[150:153]
v_mfma_f32_16x16x32_bf16 v[154:157], a[28:31], v[122:125], v[154:157]
v_mfma_f32_16x16x32_bf16 v[158:161], a[52:55], v[122:125], v[158:161]
ds_read_b128 v[182:185], v210 offset:24576
s_waitcnt lgkmcnt(0)
v_mfma_f32_16x16x32_bf16 v[138:141], a[16:19], v[182:185], v[138:141]
v_mfma_f32_16x16x32_bf16 v[142:145], a[40:43], v[182:185], v[142:145]
v_mfma_f32_16x16x32_bf16 v[146:149], a[64:67], v[182:185], v[146:149]
ds_read_b128 v[186:189], v210 offset:30720
s_waitcnt lgkmcnt(0)
v_mfma_f32_16x16x32_bf16 v[150:153], a[16:19], v[186:189], v[150:153]
v_mfma_f32_16x16x32_bf16 v[154:157], a[40:43], v[186:189], v[154:157]
v_mfma_f32_16x16x32_bf16 v[158:161], a[64:67], v[186:189], v[158:161]
ds_read_b128 v[114:117], v210 offset:22528
s_waitcnt lgkmcnt(0)
v_mfma_f32_16x16x32_bf16 v[138:141], a[8:11], v[114:117], v[138:141]
v_mfma_f32_16x16x32_bf16 v[142:145], a[32:35], v[114:117], v[142:145]
v_mfma_f32_16x16x32_bf16 v[146:149], a[56:59], v[114:117], v[146:149]
ds_read_b128 v[122:125], v210 offset:28672
s_waitcnt lgkmcnt(0)
v_mfma_f32_16x16x32_bf16 v[150:153], a[8:11], v[122:125], v[150:153]
v_mfma_f32_16x16x32_bf16 v[154:157], a[32:35], v[122:125], v[154:157]
v_mfma_f32_16x16x32_bf16 v[158:161], a[56:59], v[122:125], v[158:161]
ds_read_b128 v[182:185], v210 offset:23552
s_waitcnt lgkmcnt(0)
v_mfma_f32_16x16x32_bf16 v[138:141], a[12:15], v[182:185], v[138:141]
v_mfma_f32_16x16x32_bf16 v[142:145], a[36:39], v[182:185], v[142:145]
v_mfma_f32_16x16x32_bf16 v[146:149], a[60:63], v[182:185], v[146:149]
ds_read_b128 v[186:189], v210 offset:29696
s_waitcnt lgkmcnt(0)
v_mfma_f32_16x16x32_bf16 v[150:153], a[12:15], v[186:189], v[150:153]
v_mfma_f32_16x16x32_bf16 v[154:157], a[36:39], v[186:189], v[154:157]
v_mfma_f32_16x16x32_bf16 v[158:161], a[60:63], v[186:189], v[158:161]
ds_read_b128 v[114:117], v210 offset:25600
s_waitcnt lgkmcnt(0)
v_mfma_f32_16x16x32_bf16 v[138:141], a[20:23], v[114:117], v[138:141]
v_mfma_f32_16x16x32_bf16 v[142:145], a[44:47], v[114:117], v[142:145]
v_mfma_f32_16x16x32_bf16 v[146:149], a[68:71], v[114:117], v[146:149]
ds_read_b128 v[122:125], v210 offset:31744
s_waitcnt lgkmcnt(0)
v_mfma_f32_16x16x32_bf16 v[150:153], a[20:23], v[122:125], v[150:153]
v_mfma_f32_16x16x32_bf16 v[154:157], a[44:47], v[122:125], v[154:157]
v_mfma_f32_16x16x32_bf16 v[158:161], a[68:71], v[122:125], v[158:161]
v_cvt_pk_bf16_f32 v60, v138, v139
v_cvt_pk_bf16_f32 v61, v140, v141
v_cvt_pk_bf16_f32 v62, v142, v143
v_cvt_pk_bf16_f32 v63, v144, v145
v_cvt_pk_bf16_f32 v64, v146, v147
v_cvt_pk_bf16_f32 v65, v148, v149
v_cvt_pk_bf16_f32 v66, v150, v151
v_cvt_pk_bf16_f32 v67, v152, v153
v_cvt_pk_bf16_f32 v68, v154, v155
v_cvt_pk_bf16_f32 v69, v156, v157
v_cvt_pk_bf16_f32 v70, v158, v159
v_cvt_pk_bf16_f32 v71, v160, v161
ds_read_b128 v[182:185], v210 offset:20480
s_waitcnt lgkmcnt(0)
v_mfma_f32_16x16x32_bf16 v[162:165], a[216:219], v[182:185], 0
v_mfma_f32_16x16x32_bf16 v[166:169], a[240:243], v[182:185], 0
v_mfma_f32_16x16x32_bf16 v[170:173], v[232:235], v[182:185], 0
ds_read_b128 v[186:189], v210 offset:26624
s_waitcnt lgkmcnt(0)
v_mfma_f32_16x16x32_bf16 v[138:141], a[216:219], v[186:189], 0
v_mfma_f32_16x16x32_bf16 v[142:145], a[240:243], v[186:189], 0
v_mfma_f32_16x16x32_bf16 v[146:149], v[232:235], v[186:189], 0
ds_read_b128 v[114:117], v210 offset:21504
s_waitcnt lgkmcnt(0)
v_mfma_f32_16x16x32_bf16 v[162:165], a[220:223], v[114:117], v[162:165]
v_mfma_f32_16x16x32_bf16 v[166:169], a[244:247], v[114:117], v[166:169]
v_mfma_f32_16x16x32_bf16 v[170:173], v[236:239], v[114:117], v[170:173]
ds_read_b128 v[122:125], v210 offset:27648
s_waitcnt lgkmcnt(0)
v_mfma_f32_16x16x32_bf16 v[138:141], a[220:223], v[122:125], v[138:141]
v_mfma_f32_16x16x32_bf16 v[142:145], a[244:247], v[122:125], v[142:145]
v_mfma_f32_16x16x32_bf16 v[146:149], v[236:239], v[122:125], v[146:149]
ds_read_b128 v[182:185], v210 offset:24576
s_waitcnt lgkmcnt(0)
v_mfma_f32_16x16x32_bf16 v[162:165], a[232:235], v[182:185], v[162:165]
v_mfma_f32_16x16x32_bf16 v[166:169], v[224:227], v[182:185], v[166:169]
v_mfma_f32_16x16x32_bf16 v[170:173], v[248:251], v[182:185], v[170:173]
ds_read_b128 v[186:189], v210 offset:30720
s_waitcnt lgkmcnt(0)
v_mfma_f32_16x16x32_bf16 v[138:141], a[232:235], v[186:189], v[138:141]
v_mfma_f32_16x16x32_bf16 v[142:145], v[224:227], v[186:189], v[142:145]
v_mfma_f32_16x16x32_bf16 v[146:149], v[248:251], v[186:189], v[146:149]
ds_read_b128 v[114:117], v210 offset:22528
s_waitcnt lgkmcnt(0)
v_mfma_f32_16x16x32_bf16 v[162:165], a[224:227], v[114:117], v[162:165]
v_mfma_f32_16x16x32_bf16 v[166:169], a[248:251], v[114:117], v[166:169]
v_mfma_f32_16x16x32_bf16 v[170:173], v[240:243], v[114:117], v[170:173]
ds_read_b128 v[122:125], v210 offset:28672
s_waitcnt lgkmcnt(0)
v_mfma_f32_16x16x32_bf16 v[138:141], a[224:227], v[122:125], v[138:141]
v_mfma_f32_16x16x32_bf16 v[142:145], a[248:251], v[122:125], v[142:145]
v_mfma_f32_16x16x32_bf16 v[146:149], v[240:243], v[122:125], v[146:149]
ds_read_b128 v[182:185], v210 offset:23552
s_waitcnt lgkmcnt(0)
v_mfma_f32_16x16x32_bf16 v[162:165], a[228:231], v[182:185], v[162:165]
v_mfma_f32_16x16x32_bf16 v[166:169], a[252:255], v[182:185], v[166:169]
v_mfma_f32_16x16x32_bf16 v[170:173], v[244:247], v[182:185], v[170:173]
ds_read_b128 v[186:189], v210 offset:29696
s_waitcnt lgkmcnt(0)
v_mfma_f32_16x16x32_bf16 v[138:141], a[228:231], v[186:189], v[138:141]
v_mfma_f32_16x16x32_bf16 v[142:145], a[252:255], v[186:189], v[142:145]
v_mfma_f32_16x16x32_bf16 v[146:149], v[244:247], v[186:189], v[146:149]
ds_read_b128 v[114:117], v210 offset:25600
s_waitcnt lgkmcnt(0)
v_mfma_f32_16x16x32_bf16 v[162:165], a[236:239], v[114:117], v[162:165]
v_mfma_f32_16x16x32_bf16 v[166:169], v[228:231], v[114:117], v[166:169]
v_mfma_f32_16x16x32_bf16 v[170:173], v[252:255], v[114:117], v[170:173]
ds_read_b128 v[122:125], v210 offset:31744
s_waitcnt lgkmcnt(0)
v_mfma_f32_16x16x32_bf16 v[138:141], a[236:239], v[122:125], v[138:141]
v_mfma_f32_16x16x32_bf16 v[142:145], v[228:231], v[122:125], v[142:145]
v_mfma_f32_16x16x32_bf16 v[146:149], v[252:255], v[122:125], v[146:149]
v_cvt_pk_bf16_f32 v84, v162, v163
v_cvt_pk_bf16_f32 v85, v164, v165
v_cvt_pk_bf16_f32 v86, v166, v167
v_cvt_pk_bf16_f32 v87, v168, v169
v_cvt_pk_bf16_f32 v88, v170, v171
v_cvt_pk_bf16_f32 v89, v172, v173
v_cvt_pk_bf16_f32 v96, v138, v139
v_cvt_pk_bf16_f32 v97, v140, v141
v_cvt_pk_bf16_f32 v98, v142, v143
v_cvt_pk_bf16_f32 v99, v144, v145
v_cvt_pk_bf16_f32 v100, v146, v147
v_cvt_pk_bf16_f32 v101, v148, v149
ds_read_b128 v[182:185], v210 offset:20480
s_waitcnt lgkmcnt(0)
v_mfma_f32_16x16x32_bf16 v[150:153], a[72:75], v[182:185], 0
v_mfma_f32_16x16x32_bf16 v[154:157], a[96:99], v[182:185], 0
v_mfma_f32_16x16x32_bf16 v[158:161], a[120:123], v[182:185], 0
ds_read_b128 v[186:189], v210 offset:26624
s_waitcnt lgkmcnt(0)
v_mfma_f32_16x16x32_bf16 v[162:165], a[72:75], v[186:189], 0
v_mfma_f32_16x16x32_bf16 v[166:169], a[96:99], v[186:189], 0
v_mfma_f32_16x16x32_bf16 v[170:173], a[120:123], v[186:189], 0
ds_read_b128 v[114:117], v210 offset:21504
s_waitcnt lgkmcnt(0)
v_mfma_f32_16x16x32_bf16 v[150:153], a[76:79], v[114:117], v[150:153]
v_mfma_f32_16x16x32_bf16 v[154:157], a[100:103], v[114:117], v[154:157]
v_mfma_f32_16x16x32_bf16 v[158:161], a[124:127], v[114:117], v[158:161]
ds_read_b128 v[122:125], v210 offset:27648
s_waitcnt lgkmcnt(0)
v_mfma_f32_16x16x32_bf16 v[162:165], a[76:79], v[122:125], v[162:165]
v_mfma_f32_16x16x32_bf16 v[166:169], a[100:103], v[122:125], v[166:169]
v_mfma_f32_16x16x32_bf16 v[170:173], a[124:127], v[122:125], v[170:173]
ds_read_b128 v[182:185], v210 offset:24576
s_waitcnt lgkmcnt(0)
v_mfma_f32_16x16x32_bf16 v[150:153], a[88:91], v[182:185], v[150:153]
v_mfma_f32_16x16x32_bf16 v[154:157], a[112:115], v[182:185], v[154:157]
v_mfma_f32_16x16x32_bf16 v[158:161], a[136:139], v[182:185], v[158:161]
ds_read_b128 v[186:189], v210 offset:30720
s_waitcnt lgkmcnt(0)
v_mfma_f32_16x16x32_bf16 v[162:165], a[88:91], v[186:189], v[162:165]
v_mfma_f32_16x16x32_bf16 v[166:169], a[112:115], v[186:189], v[166:169]
v_mfma_f32_16x16x32_bf16 v[170:173], a[136:139], v[186:189], v[170:173]
ds_read_b128 v[114:117], v210 offset:22528
s_waitcnt lgkmcnt(0)
v_mfma_f32_16x16x32_bf16 v[150:153], a[80:83], v[114:117], v[150:153]
v_mfma_f32_16x16x32_bf16 v[154:157], a[104:107], v[114:117], v[154:157]
v_mfma_f32_16x16x32_bf16 v[158:161], a[128:131], v[114:117], v[158:161]
ds_read_b128 v[122:125], v210 offset:28672
s_waitcnt lgkmcnt(0)
v_mfma_f32_16x16x32_bf16 v[162:165], a[80:83], v[122:125], v[162:165]
v_mfma_f32_16x16x32_bf16 v[166:169], a[104:107], v[122:125], v[166:169]
v_mfma_f32_16x16x32_bf16 v[170:173], a[128:131], v[122:125], v[170:173]
ds_read_b128 v[182:185], v210 offset:23552
s_waitcnt lgkmcnt(0)
v_mfma_f32_16x16x32_bf16 v[150:153], a[84:87], v[182:185], v[150:153]
v_mfma_f32_16x16x32_bf16 v[154:157], a[108:111], v[182:185], v[154:157]
v_mfma_f32_16x16x32_bf16 v[158:161], a[132:135], v[182:185], v[158:161]
ds_read_b128 v[186:189], v210 offset:29696
s_waitcnt lgkmcnt(0)
v_mfma_f32_16x16x32_bf16 v[162:165], a[84:87], v[186:189], v[162:165]
v_mfma_f32_16x16x32_bf16 v[166:169], a[108:111], v[186:189], v[166:169]
v_mfma_f32_16x16x32_bf16 v[170:173], a[132:135], v[186:189], v[170:173]
ds_read_b128 v[114:117], v210 offset:25600
s_waitcnt lgkmcnt(0)
v_mfma_f32_16x16x32_bf16 v[150:153], a[92:95], v[114:117], v[150:153]
v_mfma_f32_16x16x32_bf16 v[154:157], a[116:119], v[114:117], v[154:157]
v_mfma_f32_16x16x32_bf16 v[158:161], a[140:143], v[114:117], v[158:161]
ds_read_b128 v[122:125], v210 offset:31744
s_waitcnt lgkmcnt(0)
v_mfma_f32_16x16x32_bf16 v[162:165], a[92:95], v[122:125], v[162:165]
v_mfma_f32_16x16x32_bf16 v[166:169], a[116:119], v[122:125], v[166:169]
v_mfma_f32_16x16x32_bf16 v[170:173], a[140:143], v[122:125], v[170:173]
v_cvt_pk_bf16_f32 v90, v150, v151
v_cvt_pk_bf16_f32 v91, v152, v153
v_cvt_pk_bf16_f32 v92, v154, v155
v_cvt_pk_bf16_f32 v93, v156, v157
v_cvt_pk_bf16_f32 v94, v158, v159
v_cvt_pk_bf16_f32 v95, v160, v161
v_cvt_pk_bf16_f32 v102, v162, v163
v_cvt_pk_bf16_f32 v103, v164, v165
v_cvt_pk_bf16_f32 v104, v166, v167
v_cvt_pk_bf16_f32 v105, v168, v169
v_cvt_pk_bf16_f32 v106, v170, v171
v_cvt_pk_bf16_f32 v107, v172, v173
v_mfma_f32_16x16x32_bf16 v[174:177], v[84:87], v[60:63], 0
s_nop 5
v_mfma_f32_16x16x16_bf16 v[174:177], v[88:89], v[64:65], v[174:177]
v_mfma_f32_16x16x32_bf16 v[178:181], v[96:99], v[66:69], 0
s_nop 5
v_mfma_f32_16x16x16_bf16 v[178:181], v[100:101], v[70:71], v[178:181]
s_barrier
buffer_store_dwordx4 v[36:39], v210, s[24:27], s58 offen sc1
buffer_store_dwordx4 v[40:43], v210, s[24:27], s58 offen offset:1024 sc1
buffer_store_dwordx4 v[44:47], v210, s[24:27], s58 offen offset:2048 sc1
ds_write_b64 v121, v[90:91]
ds_write_b64 v121, v[92:93] offset:32
ds_write_b64 v121, v[94:95] offset:64
ds_write_b128 v120, v[84:87]
ds_write_b64 v120, v[88:89] offset:16
ds_write_b128 v120, v[60:63] offset:512
ds_write_b64 v120, v[64:65] offset:528
buffer_store_dwordx4 v[48:51], v210, s[24:27], s59 offen sc1
buffer_store_dwordx4 v[52:55], v210, s[24:27], s59 offen offset:1024 sc1
buffer_store_dwordx4 v[56:59], v210, s[24:27], s59 offen offset:2048 sc1
s_mov_b64 exec, s[56:57]
ds_write_b64 v121, v[102:103] offset:22784
s_mov_b64 exec, -1
s_mov_b64 exec, s[56:57]
ds_write_b64 v121, v[104:105] offset:22816
s_mov_b64 exec, -1
s_mov_b64 exec, s[56:57]
ds_write_b64 v121, v[106:107] offset:22848
s_mov_b64 exec, -1
s_mov_b64 exec, s[56:57]
ds_write_b128 v120, v[96:99] offset:22784
s_mov_b64 exec, -1
s_mov_b64 exec, s[56:57]
ds_write_b64 v120, v[100:101] offset:22800
s_mov_b64 exec, -1
s_mov_b64 exec, s[56:57]
ds_write_b128 v120, v[66:69] offset:23296
s_mov_b64 exec, -1
s_mov_b64 exec, s[56:57]
ds_write_b64 v120, v[70:71] offset:23312
s_mov_b64 exec, -1
s_mov_b32 exec_lo, 0x100001
s_mov_b32 exec_hi, 0x10000100
ds_write_b32 v132, v174
s_mov_b64 exec, -1
s_mov_b32 exec_lo, 0x200002
s_mov_b32 exec_hi, 0x20000200
ds_write_b32 v132, v175
s_mov_b64 exec, -1
s_mov_b32 exec_lo, 0x400004
s_mov_b32 exec_hi, 0x40000400
ds_write_b32 v132, v176
s_mov_b64 exec, -1
s_mov_b32 exec_lo, 0x800008
s_mov_b32 exec_hi, 0x80000800
ds_write_b32 v132, v177
s_mov_b64 exec, -1
s_mov_b32 exec_lo, 0x1
s_mov_b32 exec_hi, 0x0
ds_write_b32 v132, v178 offset:22784
s_mov_b64 exec, -1
s_mov_b32 exec_lo, 0x2
s_mov_b32 exec_hi, 0x0
ds_write_b32 v132, v179 offset:22784
s_mov_b64 exec, -1
s_mov_b32 exec_lo, 0x4
s_mov_b32 exec_hi, 0x0
ds_write_b32 v132, v180 offset:22784
s_mov_b64 exec, -1
s_mov_b32 exec_lo, 0x8
s_mov_b32 exec_hi, 0x0
ds_write_b32 v132, v181 offset:22784
s_mov_b64 exec, -1
s_nop 0
s_barrier
s_mov_b32 s38, s36
ds_read_b128 v[174:177], v217
ds_read_b128 v[84:87], v200
s_waitcnt lgkmcnt(0)
v_mfma_f32_16x16x32_bf16 v[36:39], v[174:177], v[84:87], 0
ds_read_b128 v[92:95], v201
s_waitcnt lgkmcnt(0)
v_mfma_f32_16x16x32_bf16 v[48:51], v[174:177], v[92:95], 0
ds_read_b128 v[100:103], v202
s_waitcnt lgkmcnt(0)
v_mfma_f32_16x16x32_bf16 v[60:63], v[174:177], v[100:103], 0
ds_read_b128 v[178:181], v217 offset:528
ds_read_b128 v[84:87], v194
ds_read_b128 v[88:91], v194 offset:16
s_waitcnt lgkmcnt(0)
v_smfmac_f32_16x16x64_bf16 v[36:39], v[178:181], v[84:91], v213
ds_read_b128 v[92:95], v195
ds_read_b128 v[96:99], v195 offset:16
s_waitcnt lgkmcnt(0)
v_smfmac_f32_16x16x64_bf16 v[48:51], v[178:181], v[92:99], v213
ds_read_b128 v[100:103], v196
ds_read_b128 v[104:107], v196 offset:16
s_waitcnt lgkmcnt(0)
v_smfmac_f32_16x16x64_bf16 v[60:63], v[178:181], v[100:107], v213
ds_read_b128 v[174:177], v217 offset:1056
ds_read_b128 v[84:87], v197
ds_read_b128 v[88:91], v197 offset:16
s_waitcnt lgkmcnt(0)
v_smfmac_f32_16x16x64_bf16 v[36:39], v[174:177], v[84:91], v213
ds_read_b128 v[92:95], v198
ds_read_b128 v[96:99], v198 offset:16
s_waitcnt lgkmcnt(0)
v_smfmac_f32_16x16x64_bf16 v[48:51], v[174:177], v[92:99], v213
ds_read_b128 v[100:103], v199
ds_read_b128 v[104:107], v199 offset:16
s_waitcnt lgkmcnt(0)
v_smfmac_f32_16x16x64_bf16 v[60:63], v[174:177], v[100:107], v213
ds_read_b128 v[178:181], v217 offset:1584
ds_read_b128 v[84:87], v200 offset:32
s_waitcnt lgkmcnt(0)
v_mfma_f32_16x16x32_bf16 v[40:43], v[178:181], v[84:87], 0
ds_read_b128 v[92:95], v201 offset:32
s_waitcnt lgkmcnt(0)
v_mfma_f32_16x16x32_bf16 v[52:55], v[178:181], v[92:95], 0
ds_read_b128 v[100:103], v202 offset:32
s_waitcnt lgkmcnt(0)
v_mfma_f32_16x16x32_bf16 v[64:67], v[178:181], v[100:103], 0
ds_read_b128 v[174:177], v217 offset:2112
ds_read_b128 v[84:87], v194 offset:32
ds_read_b128 v[88:91], v194 offset:48
s_waitcnt lgkmcnt(0)
v_smfmac_f32_16x16x64_bf16 v[40:43], v[174:177], v[84:91], v213
ds_read_b128 v[92:95], v195 offset:32
ds_read_b128 v[96:99], v195 offset:48
s_waitcnt lgkmcnt(0)
v_smfmac_f32_16x16x64_bf16 v[52:55], v[174:177], v[92:99], v213
ds_read_b128 v[100:103], v196 offset:32
ds_read_b128 v[104:107], v196 offset:48
s_waitcnt lgkmcnt(0)
v_smfmac_f32_16x16x64_bf16 v[64:67], v[174:177], v[100:107], v213
ds_read_b128 v[178:181], v217 offset:2640
ds_read_b128 v[84:87], v197 offset:32
ds_read_b128 v[88:91], v197 offset:48
s_waitcnt lgkmcnt(0)
v_smfmac_f32_16x16x64_bf16 v[40:43], v[178:181], v[84:91], v213
ds_read_b128 v[92:95], v198 offset:32
ds_read_b128 v[96:99], v198 offset:48
s_waitcnt lgkmcnt(0)
v_smfmac_f32_16x16x64_bf16 v[52:55], v[178:181], v[92:99], v213
ds_read_b128 v[100:103], v199 offset:32
ds_read_b128 v[104:107], v199 offset:48
s_waitcnt lgkmcnt(0)
v_smfmac_f32_16x16x64_bf16 v[64:67], v[178:181], v[100:107], v213
ds_read_b128 v[174:177], v217 offset:3168
ds_read_b128 v[84:87], v200 offset:64
s_waitcnt lgkmcnt(0)
v_mfma_f32_16x16x32_bf16 v[44:47], v[174:177], v[84:87], 0
ds_read_b128 v[92:95], v201 offset:64
s_waitcnt lgkmcnt(0)
v_mfma_f32_16x16x32_bf16 v[56:59], v[174:177], v[92:95], 0
ds_read_b128 v[100:103], v202 offset:64
s_waitcnt lgkmcnt(0)
v_mfma_f32_16x16x32_bf16 v[68:71], v[174:177], v[100:103], 0
ds_read_b128 v[178:181], v217 offset:3696
ds_read_b128 v[84:87], v194 offset:64
ds_read_b128 v[88:91], v194 offset:80
s_waitcnt lgkmcnt(0)
v_smfmac_f32_16x16x64_bf16 v[44:47], v[178:181], v[84:91], v213
ds_read_b128 v[92:95], v195 offset:64
ds_read_b128 v[96:99], v195 offset:80
s_waitcnt lgkmcnt(0)
v_smfmac_f32_16x16x64_bf16 v[56:59], v[178:181], v[92:99], v213
ds_read_b128 v[100:103], v196 offset:64
ds_read_b128 v[104:107], v196 offset:80
s_waitcnt lgkmcnt(0)
v_smfmac_f32_16x16x64_bf16 v[68:71], v[178:181], v[100:107], v213
ds_read_b128 v[174:177], v217 offset:4224
ds_read_b128 v[84:87], v197 offset:64
ds_read_b128 v[88:91], v197 offset:80
s_waitcnt lgkmcnt(0)
v_smfmac_f32_16x16x64_bf16 v[44:47], v[174:177], v[84:91], v213
ds_read_b128 v[92:95], v198 offset:64
ds_read_b128 v[96:99], v198 offset:80
s_waitcnt lgkmcnt(0)
v_smfmac_f32_16x16x64_bf16 v[56:59], v[174:177], v[92:99], v213
ds_read_b128 v[100:103], v199 offset:64
ds_read_b128 v[104:107], v199 offset:80
s_waitcnt lgkmcnt(0)
v_smfmac_f32_16x16x64_bf16 v[68:71], v[174:177], v[100:107], v213
v_add_f32 v118, v36, v37
v_mul_f32 v119, v36, v36
v_add_f32 v118, v118, v38
v_fmac_f32 v119, v37, v37
v_add_f32 v118, v118, v39
v_fmac_f32 v119, v38, v38
v_fmac_f32 v119, v39, v39
v_add_f32 v126, v48, v49
v_mul_f32 v127, v48, v48
v_add_f32 v126, v126, v50
v_fmac_f32 v127, v49, v49
v_add_f32 v126, v126, v51
v_fmac_f32 v127, v50, v50
v_fmac_f32 v127, v51, v51
v_add_f32 v134, v60, v61
v_mul_f32 v135, v60, v60
v_add_f32 v134, v134, v62
v_fmac_f32 v135, v61, v61
v_add_f32 v134, v134, v63
v_fmac_f32 v135, v62, v62
v_fmac_f32 v135, v63, v63
v_add_f32 v118, v118, v40
v_fmac_f32 v119, v40, v40
v_add_f32 v118, v118, v41
v_fmac_f32 v119, v41, v41
v_add_f32 v118, v118, v42
v_fmac_f32 v119, v42, v42
v_add_f32 v118, v118, v43
v_fmac_f32 v119, v43, v43
v_add_f32 v126, v126, v52
v_fmac_f32 v127, v52, v52
v_add_f32 v126, v126, v53
v_fmac_f32 v127, v53, v53
v_add_f32 v126, v126, v54
v_fmac_f32 v127, v54, v54
v_add_f32 v126, v126, v55
v_fmac_f32 v127, v55, v55
v_add_f32 v134, v134, v64
v_fmac_f32 v135, v64, v64
v_add_f32 v134, v134, v65
v_fmac_f32 v135, v65, v65
v_add_f32 v134, v134, v66
v_fmac_f32 v135, v66, v66
v_add_f32 v134, v134, v67
v_fmac_f32 v135, v67, v67
v_add_f32 v118, v118, v44
v_fmac_f32 v119, v44, v44
v_add_f32 v118, v118, v45
v_fmac_f32 v119, v45, v45
v_add_f32 v118, v118, v46
v_fmac_f32 v119, v46, v46
v_add_f32 v118, v118, v47
v_fmac_f32 v119, v47, v47
v_add_f32 v126, v126, v56
v_fmac_f32 v127, v56, v56
v_add_f32 v126, v126, v57
v_fmac_f32 v127, v57, v57
v_add_f32 v126, v126, v58
v_fmac_f32 v127, v58, v58
v_add_f32 v126, v126, v59
v_fmac_f32 v127, v59, v59
v_add_f32 v134, v134, v68
v_fmac_f32 v135, v68, v68
v_add_f32 v134, v134, v69
v_fmac_f32 v135, v69, v69
v_add_f32 v134, v134, v70
v_fmac_f32 v135, v70, v70
v_add_f32 v134, v134, v71
v_fmac_f32 v135, v71, v71
v_permlane16_swap_b32 v118, v119
v_add_f32 v118, v118, v119
v_permlane16_swap_b32 v126, v127
v_add_f32 v126, v126, v127
v_permlane16_swap_b32 v134, v135
v_add_f32 v134, v134, v135
v_permlane32_swap_b32 v118, v126
v_add_f32 v118, v118, v126
ds_write_b32 v209, v118
v_mov_b32 v135, v134
s_nop 1
v_permlane32_swap_b32 v134, v135
v_add_f32 v134, v134, v135
ds_write_b32 v209, v134 offset:512
s_waitcnt lgkmcnt(0)
s_barrier
s_mul_hi_u32 s41, s35, 58835169
s_mul_i32 s42, s41, 73
s_sub_u32 s42, s35, s42
s_mul_i32 s43, s41, 1373568
s_mul_i32 s51, s42, 2688
s_add_u32 s50, s43, s51
s_add_u32 s35, s35, 32
s_min_u32 s41, s41, 1
s_sub_u32 s41, 1, s41
s_lshl_b32 s41, s41, 30
s_add_u32 s52, s50, s41
s_min_u32 s43, s42, 1
s_lshl_b32 s43, s43, 27
s_sub_u32 s43, 536870911, s43
s_add_u32 s51, s42, 56
s_and_b32 s51, s51, 128
s_lshl_b32 s51, s51, 22
s_or_b32 s44, s43, s51
s_mov_b32 s36, s50
v_and_b32 v216, s44, v208
s_add_u32 m0, s45, 0
s_nop 0
buffer_load_dwordx4 v216, s[4:7], s52 offen nt lds
s_add_u32 m0, s45, 4112
s_add_u32 s40, s36, 196224
buffer_load_dwordx4 v216, s[4:7], s40 offen nt lds
s_add_u32 m0, s45, 8224
s_add_u32 s40, s36, 392448
buffer_load_dwordx4 v216, s[4:7], s40 offen nt lds
s_add_u32 m0, s45, 12336
s_add_u32 s40, s36, 588672
buffer_load_dwordx4 v216, s[4:7], s40 offen nt lds
s_add_u32 m0, s45, 16448
s_add_u32 s40, s36, 784896
buffer_load_dwordx4 v216, s[4:7], s40 offen nt lds
s_add_u32 m0, s45, 20560
s_add_u32 s40, s36, 981120
buffer_load_dwordx4 v216, s[4:7], s40 offen nt lds
s_add_u32 m0, s45, 24672
s_add_u32 s40, s36, 1177344
buffer_load_dwordx4 v216, s[4:7], s40 offen nt lds
s_add_u32 m0, s45, 28784
s_add_u32 s40, s36, 1373568
buffer_load_dwordx4 v216, s[4:7], s40 offen nt lds
s_add_u32 m0, s45, 32896
s_add_u32 s40, s36, 1569792
buffer_load_dwordx4 v216, s[4:7], s40 offen nt lds
ds_read_b128 v[182:185], v210
ds_read_b128 v[186:189], v210 offset:1024
s_waitcnt lgkmcnt(1)
v_mfma_f32_16x16x32_bf16 v[138:141], a[0:3], v[182:185], 0
s_waitcnt lgkmcnt(0)
v_mfma_f32_16x16x32_bf16 v[138:141], a[4:7], v[186:189], v[138:141]
v_mfma_f32_16x16x32_bf16 v[142:145], a[24:27], v[182:185], 0
v_mfma_f32_16x16x32_bf16 v[142:145], a[28:31], v[186:189], v[142:145]
v_mfma_f32_16x16x32_bf16 v[146:149], a[48:51], v[182:185], 0
v_mfma_f32_16x16x32_bf16 v[146:149], a[52:55], v[186:189], v[146:149]
v_mfma_f32_16x16x32_bf16 v[150:153], a[216:219], v[182:185], 0
v_mfma_f32_16x16x32_bf16 v[150:153], a[220:223], v[186:189], v[150:153]
v_mfma_f32_16x16x32_bf16 v[154:157], a[240:243], v[182:185], 0
v_mfma_f32_16x16x32_bf16 v[154:157], a[244:247], v[186:189], v[154:157]
v_mfma_f32_16x16x32_bf16 v[158:161], v[232:235], v[182:185], 0
v_mfma_f32_16x16x32_bf16 v[158:161], v[236:239], v[186:189], v[158:161]
v_mfma_f32_16x16x32_bf16 v[162:165], v[182:185], a[72:75], 0
v_mfma_f32_16x16x32_bf16 v[162:165], v[186:189], a[76:79], v[162:165]
v_mfma_f32_16x16x32_bf16 v[166:169], v[182:185], a[96:99], 0
v_mfma_f32_16x16x32_bf16 v[166:169], v[186:189], a[100:103], v[166:169]
v_mfma_f32_16x16x32_bf16 v[170:173], v[182:185], a[120:123], 0
v_mfma_f32_16x16x32_bf16 v[170:173], v[186:189], a[124:127], v[170:173]
ds_read_b128 v[110:113], v210 offset:2048
ds_read_b128 v[220:223], v210 offset:3072
s_waitcnt lgkmcnt(1)
v_mfma_f32_16x16x32_bf16 v[138:141], a[8:11], v[110:113], v[138:141]
s_waitcnt lgkmcnt(0)
v_mfma_f32_16x16x32_bf16 v[138:141], a[12:15], v[220:223], v[138:141]
v_mfma_f32_16x16x32_bf16 v[142:145], a[32:35], v[110:113], v[142:145]
v_mfma_f32_16x16x32_bf16 v[142:145], a[36:39], v[220:223], v[142:145]
v_mfma_f32_16x16x32_bf16 v[146:149], a[56:59], v[110:113], v[146:149]
v_mfma_f32_16x16x32_bf16 v[146:149], a[60:63], v[220:223], v[146:149]
v_mfma_f32_16x16x32_bf16 v[150:153], a[224:227], v[110:113], v[150:153]
v_mfma_f32_16x16x32_bf16 v[150:153], a[228:231], v[220:223], v[150:153]
v_mfma_f32_16x16x32_bf16 v[154:157], a[248:251], v[110:113], v[154:157]
v_mfma_f32_16x16x32_bf16 v[154:157], a[252:255], v[220:223], v[154:157]
v_mfma_f32_16x16x32_bf16 v[158:161], v[240:243], v[110:113], v[158:161]
v_mfma_f32_16x16x32_bf16 v[158:161], v[244:247], v[220:223], v[158:161]
v_mfma_f32_16x16x32_bf16 v[162:165], v[110:113], a[80:83], v[162:165]
v_mfma_f32_16x16x32_bf16 v[162:165], v[220:223], a[84:87], v[162:165]
v_mfma_f32_16x16x32_bf16 v[166:169], v[110:113], a[104:107], v[166:169]
v_mfma_f32_16x16x32_bf16 v[166:169], v[220:223], a[108:111], v[166:169]
v_mfma_f32_16x16x32_bf16 v[170:173], v[110:113], a[128:131], v[170:173]
v_mfma_f32_16x16x32_bf16 v[170:173], v[220:223], a[132:135], v[170:173]
ds_read_b128 v[182:185], v210 offset:4096
ds_read_b128 v[186:189], v210 offset:5120
s_waitcnt lgkmcnt(1)
v_mfma_f32_16x16x32_bf16 v[138:141], a[16:19], v[182:185], v[138:141]
s_waitcnt lgkmcnt(0)
v_mfma_f32_16x16x32_bf16 v[138:141], a[20:23], v[186:189], v[138:141]
v_mfma_f32_16x16x32_bf16 v[142:145], a[40:43], v[182:185], v[142:145]
v_mfma_f32_16x16x32_bf16 v[142:145], a[44:47], v[186:189], v[142:145]
v_mfma_f32_16x16x32_bf16 v[146:149], a[64:67], v[182:185], v[146:149]
v_mfma_f32_16x16x32_bf16 v[146:149], a[68:71], v[186:189], v[146:149]
v_mfma_f32_16x16x32_bf16 v[150:153], a[232:235], v[182:185], v[150:153]
v_mfma_f32_16x16x32_bf16 v[150:153], a[236:239], v[186:189], v[150:153]
v_mfma_f32_16x16x32_bf16 v[154:157], v[224:227], v[182:185], v[154:157]
v_mfma_f32_16x16x32_bf16 v[154:157], v[228:231], v[186:189], v[154:157]
v_mfma_f32_16x16x32_bf16 v[158:161], v[248:251], v[182:185], v[158:161]
v_mfma_f32_16x16x32_bf16 v[158:161], v[252:255], v[186:189], v[158:161]
v_mfma_f32_16x16x32_bf16 v[162:165], v[182:185], a[88:91], v[162:165]
v_mfma_f32_16x16x32_bf16 v[162:165], v[186:189], a[92:95], v[162:165]
v_mfma_f32_16x16x32_bf16 v[166:169], v[182:185], a[112:115], v[166:169]
v_mfma_f32_16x16x32_bf16 v[166:169], v[186:189], a[116:119], v[166:169]
v_mfma_f32_16x16x32_bf16 v[170:173], v[182:185], a[136:139], v[170:173]
v_mfma_f32_16x16x32_bf16 v[170:173], v[186:189], a[140:143], v[170:173]
v_cvt_pk_bf16_f32 v78, v138, v139
v_cvt_pk_bf16_f32 v79, v140, v141
v_cvt_pk_bf16_f32 v80, v142, v143
v_cvt_pk_bf16_f32 v81, v144, v145
v_cvt_pk_bf16_f32 v82, v146, v147
v_cvt_pk_bf16_f32 v83, v148, v149
v_cvt_pk_bf16_f32 v72, v150, v151
v_cvt_pk_bf16_f32 v73, v152, v153
v_cvt_pk_bf16_f32 v74, v154, v155
v_cvt_pk_bf16_f32 v75, v156, v157
v_cvt_pk_bf16_f32 v76, v158, v159
v_cvt_pk_bf16_f32 v77, v160, v161
v_cvt_pk_bf16_f32 v114, v162, v163
v_cvt_pk_bf16_f32 v115, v164, v165
v_cvt_pk_bf16_f32 v122, v166, v167
v_cvt_pk_bf16_f32 v123, v168, v169
v_cvt_pk_bf16_f32 v130, v170, v171
v_cvt_pk_bf16_f32 v131, v172, v173
ds_read_b128 v[110:113], v210 offset:6144
ds_read_b128 v[220:223], v210 offset:7168
s_waitcnt lgkmcnt(1)
v_mfma_f32_16x16x32_bf16 v[138:141], a[0:3], v[110:113], 0
s_waitcnt lgkmcnt(0)
v_mfma_f32_16x16x32_bf16 v[138:141], a[4:7], v[220:223], v[138:141]
v_mfma_f32_16x16x32_bf16 v[142:145], a[24:27], v[110:113], 0
v_mfma_f32_16x16x32_bf16 v[142:145], a[28:31], v[220:223], v[142:145]
v_mfma_f32_16x16x32_bf16 v[146:149], a[48:51], v[110:113], 0
v_mfma_f32_16x16x32_bf16 v[146:149], a[52:55], v[220:223], v[146:149]
v_mfma_f32_16x16x32_bf16 v[150:153], a[216:219], v[110:113], 0
v_mfma_f32_16x16x32_bf16 v[150:153], a[220:223], v[220:223], v[150:153]
v_mfma_f32_16x16x32_bf16 v[154:157], a[240:243], v[110:113], 0
v_mfma_f32_16x16x32_bf16 v[154:157], a[244:247], v[220:223], v[154:157]
v_mfma_f32_16x16x32_bf16 v[158:161], v[232:235], v[110:113], 0
v_mfma_f32_16x16x32_bf16 v[158:161], v[236:239], v[220:223], v[158:161]
v_mfma_f32_16x16x32_bf16 v[162:165], v[110:113], a[72:75], 0
v_mfma_f32_16x16x32_bf16 v[162:165], v[220:223], a[76:79], v[162:165]
v_mfma_f32_16x16x32_bf16 v[166:169], v[110:113], a[96:99], 0
v_mfma_f32_16x16x32_bf16 v[166:169], v[220:223], a[100:103], v[166:169]
v_mfma_f32_16x16x32_bf16 v[170:173], v[110:113], a[120:123], 0
v_mfma_f32_16x16x32_bf16 v[170:173], v[220:223], a[124:127], v[170:173]
ds_read_b128 v[102:105], v210 offset:18432
ds_read_b128 v[106:109], v210 offset:19456
s_waitcnt lgkmcnt(1)
v_add_f32 v102, v102, v103
s_waitcnt lgkmcnt(0)
v_add_f32 v106, v106, v107
v_add_f32 v104, v104, v105
v_add_f32 v108, v108, v109
v_add_f32 v102, v102, v104
v_add_f32 v106, v106, v108
v_mul_f32 v103, s48, v102
v_mul_f32 v104, s73, v102
v_mul_f32 v106, s73, v106
v_fma_f32 v106, -v103, v104, v106
v_max_f32 v106, 0, v106
v_add_f32 v106, s49, v106
v_rsq_f32 v102, v106
s_nop 0
v_mul_f32_e64 v103, -v103, v102
ds_write_b64 v211, v[102:103] offset:20480
ds_read_b64 v[118:119], v219 offset:20480
ds_read_b64 v[126:127], v219 offset:20736
ds_read_b64 v[134:135], v219 offset:20992
s_waitcnt lgkmcnt(2)
v_fma_f32 v220, v36, v118, v119
v_fma_f32 v221, v37, v118, v119
v_cvt_pk_bf16_f32 v174, v220, v221
v_fma_f32 v222, v38, v118, v119
v_fma_f32 v223, v39, v118, v119
v_cvt_pk_bf16_f32 v175, v222, v223
v_fma_f32 v220, v40, v118, v119
v_fma_f32 v221, v41, v118, v119
v_cvt_pk_bf16_f32 v176, v220, v221
v_fma_f32 v222, v42, v118, v119
v_fma_f32 v223, v43, v118, v119
v_cvt_pk_bf16_f32 v177, v222, v223
ds_write_b128 v211, v[174:177] offset:20480
v_fma_f32 v220, v44, v118, v119
v_fma_f32 v221, v45, v118, v119
v_cvt_pk_bf16_f32 v178, v220, v221
v_fma_f32 v222, v46, v118, v119
v_fma_f32 v223, v47, v118, v119
v_cvt_pk_bf16_f32 v179, v222, v223
s_waitcnt lgkmcnt(2)
ds_write_b64 v212, v[178:179] offset:20480
v_fma_f32 v220, v48, v126, v127
v_fma_f32 v221, v49, v126, v127
v_cvt_pk_bf16_f32 v90, v220, v221
v_fma_f32 v222, v50, v126, v127
v_fma_f32 v223, v51, v126, v127
v_cvt_pk_bf16_f32 v91, v222, v223
v_fma_f32 v220, v52, v126, v127
v_fma_f32 v221, v53, v126, v127
v_cvt_pk_bf16_f32 v92, v220, v221
v_fma_f32 v222, v54, v126, v127
v_fma_f32 v223, v55, v126, v127
v_cvt_pk_bf16_f32 v93, v222, v223
ds_write_b128 v211, v[90:93] offset:26624
v_fma_f32 v220, v56, v126, v127
v_fma_f32 v221, v57, v126, v127
v_cvt_pk_bf16_f32 v94, v220, v221
v_fma_f32 v222, v58, v126, v127
v_fma_f32 v223, v59, v126, v127
v_cvt_pk_bf16_f32 v95, v222, v223
s_waitcnt lgkmcnt(3)
ds_write_b64 v212, v[94:95] offset:26624
v_fma_f32 v220, v60, v134, v135
v_fma_f32 v221, v61, v134, v135
v_cvt_pk_bf16_f32 v90, v220, v221
v_fma_f32 v222, v62, v134, v135
v_fma_f32 v223, v63, v134, v135
v_cvt_pk_bf16_f32 v91, v222, v223
v_fma_f32 v220, v64, v134, v135
v_fma_f32 v221, v65, v134, v135
v_cvt_pk_bf16_f32 v92, v220, v221
v_fma_f32 v222, v66, v134, v135
v_fma_f32 v223, v67, v134, v135
v_cvt_pk_bf16_f32 v93, v222, v223
ds_write_b128 v211, v[90:93] offset:32768
v_fma_f32 v220, v68, v134, v135
v_fma_f32 v221, v69, v134, v135
v_cvt_pk_bf16_f32 v94, v220, v221
v_fma_f32 v222, v70, v134, v135
v_fma_f32 v223, v71, v134, v135
v_cvt_pk_bf16_f32 v95, v222, v223
ds_write_b64 v212, v[94:95] offset:32768
ds_read_b128 v[182:185], v210 offset:8192
ds_read_b128 v[186:189], v210 offset:9216
s_waitcnt lgkmcnt(1)
v_mfma_f32_16x16x32_bf16 v[138:141], a[8:11], v[182:185], v[138:141]
s_waitcnt lgkmcnt(0)
v_mfma_f32_16x16x32_bf16 v[138:141], a[12:15], v[186:189], v[138:141]
v_mfma_f32_16x16x32_bf16 v[142:145], a[32:35], v[182:185], v[142:145]
v_mfma_f32_16x16x32_bf16 v[142:145], a[36:39], v[186:189], v[142:145]
v_mfma_f32_16x16x32_bf16 v[146:149], a[56:59], v[182:185], v[146:149]
v_mfma_f32_16x16x32_bf16 v[146:149], a[60:63], v[186:189], v[146:149]
v_mfma_f32_16x16x32_bf16 v[150:153], a[224:227], v[182:185], v[150:153]
v_mfma_f32_16x16x32_bf16 v[150:153], a[228:231], v[186:189], v[150:153]
v_mfma_f32_16x16x32_bf16 v[154:157], a[248:251], v[182:185], v[154:157]
v_mfma_f32_16x16x32_bf16 v[154:157], a[252:255], v[186:189], v[154:157]
v_mfma_f32_16x16x32_bf16 v[158:161], v[240:243], v[182:185], v[158:161]
v_mfma_f32_16x16x32_bf16 v[158:161], v[244:247], v[186:189], v[158:161]
v_mfma_f32_16x16x32_bf16 v[162:165], v[182:185], a[80:83], v[162:165]
v_mfma_f32_16x16x32_bf16 v[162:165], v[186:189], a[84:87], v[162:165]
v_mfma_f32_16x16x32_bf16 v[166:169], v[182:185], a[104:107], v[166:169]
v_mfma_f32_16x16x32_bf16 v[166:169], v[186:189], a[108:111], v[166:169]
v_mfma_f32_16x16x32_bf16 v[170:173], v[182:185], a[128:131], v[170:173]
v_mfma_f32_16x16x32_bf16 v[170:173], v[186:189], a[132:135], v[170:173]
ds_read_b128 v[110:113], v210 offset:10240
ds_read_b128 v[106:109], v210 offset:11264
s_waitcnt lgkmcnt(1)
v_mfma_f32_16x16x32_bf16 v[138:141], a[16:19], v[110:113], v[138:141]
s_waitcnt lgkmcnt(0)
v_mfma_f32_16x16x32_bf16 v[138:141], a[20:23], v[106:109], v[138:141]
v_mfma_f32_16x16x32_bf16 v[142:145], a[40:43], v[110:113], v[142:145]
v_mfma_f32_16x16x32_bf16 v[142:145], a[44:47], v[106:109], v[142:145]
v_mfma_f32_16x16x32_bf16 v[146:149], a[64:67], v[110:113], v[146:149]
v_mfma_f32_16x16x32_bf16 v[146:149], a[68:71], v[106:109], v[146:149]
v_mfma_f32_16x16x32_bf16 v[150:153], a[232:235], v[110:113], v[150:153]
v_mfma_f32_16x16x32_bf16 v[150:153], a[236:239], v[106:109], v[150:153]
v_mfma_f32_16x16x32_bf16 v[154:157], v[224:227], v[110:113], v[154:157]
v_mfma_f32_16x16x32_bf16 v[154:157], v[228:231], v[106:109], v[154:157]
v_mfma_f32_16x16x32_bf16 v[158:161], v[248:251], v[110:113], v[158:161]
v_mfma_f32_16x16x32_bf16 v[158:161], v[252:255], v[106:109], v[158:161]
v_mfma_f32_16x16x32_bf16 v[162:165], v[110:113], a[88:91], v[162:165]
v_mfma_f32_16x16x32_bf16 v[162:165], v[106:109], a[92:95], v[162:165]
v_mfma_f32_16x16x32_bf16 v[166:169], v[110:113], a[112:115], v[166:169]
v_mfma_f32_16x16x32_bf16 v[166:169], v[106:109], a[116:119], v[166:169]
v_mfma_f32_16x16x32_bf16 v[170:173], v[110:113], a[136:139], v[170:173]
v_mfma_f32_16x16x32_bf16 v[170:173], v[106:109], a[140:143], v[170:173]
v_cvt_pk_bf16_f32 v96, v138, v139
v_cvt_pk_bf16_f32 v97, v140, v141
v_cvt_pk_bf16_f32 v98, v142, v143
v_cvt_pk_bf16_f32 v99, v144, v145
v_cvt_pk_bf16_f32 v100, v146, v147
v_cvt_pk_bf16_f32 v101, v148, v149
v_cvt_pk_bf16_f32 v84, v150, v151
v_cvt_pk_bf16_f32 v85, v152, v153
v_cvt_pk_bf16_f32 v86, v154, v155
v_cvt_pk_bf16_f32 v87, v156, v157
v_cvt_pk_bf16_f32 v88, v158, v159
v_cvt_pk_bf16_f32 v89, v160, v161
v_cvt_pk_bf16_f32 v116, v162, v163
v_cvt_pk_bf16_f32 v117, v164, v165
v_cvt_pk_bf16_f32 v124, v166, v167
v_cvt_pk_bf16_f32 v125, v168, v169
v_cvt_pk_bf16_f32 v132, v170, v171
v_cvt_pk_bf16_f32 v133, v172, v173
ds_read_b128 v[182:185], v210 offset:12288
ds_read_b128 v[186:189], v210 offset:13312
s_waitcnt lgkmcnt(1)
v_mfma_f32_16x16x32_bf16 v[138:141], a[0:3], v[182:185], 0
s_waitcnt lgkmcnt(0)
v_mfma_f32_16x16x32_bf16 v[138:141], a[4:7], v[186:189], v[138:141]
v_mfma_f32_16x16x32_bf16 v[142:145], a[24:27], v[182:185], 0
v_mfma_f32_16x16x32_bf16 v[142:145], a[28:31], v[186:189], v[142:145]
v_mfma_f32_16x16x32_bf16 v[146:149], a[48:51], v[182:185], 0
v_mfma_f32_16x16x32_bf16 v[146:149], a[52:55], v[186:189], v[146:149]
ds_read_b128 v[174:177], v210 offset:14336
ds_read_b128 v[178:181], v210 offset:15360
s_waitcnt lgkmcnt(1)
v_mfma_f32_16x16x32_bf16 v[138:141], a[8:11], v[174:177], v[138:141]
s_waitcnt lgkmcnt(0)
v_mfma_f32_16x16x32_bf16 v[138:141], a[12:15], v[178:181], v[138:141]
v_mfma_f32_16x16x32_bf16 v[142:145], a[32:35], v[174:177], v[142:145]
v_mfma_f32_16x16x32_bf16 v[142:145], a[36:39], v[178:181], v[142:145]
v_mfma_f32_16x16x32_bf16 v[146:149], a[56:59], v[174:177], v[146:149]
v_mfma_f32_16x16x32_bf16 v[146:149], a[60:63], v[178:181], v[146:149]
ds_read_b128 v[182:185], v210 offset:16384
ds_read_b128 v[186:189], v210 offset:17408
s_waitcnt lgkmcnt(1)
v_mfma_f32_16x16x32_bf16 v[138:141], a[16:19], v[182:185], v[138:141]
s_waitcnt lgkmcnt(0)
v_mfma_f32_16x16x32_bf16 v[138:141], a[20:23], v[186:189], v[138:141]
v_mfma_f32_16x16x32_bf16 v[142:145], a[40:43], v[182:185], v[142:145]
v_mfma_f32_16x16x32_bf16 v[142:145], a[44:47], v[186:189], v[142:145]
v_mfma_f32_16x16x32_bf16 v[146:149], a[64:67], v[182:185], v[146:149]
v_mfma_f32_16x16x32_bf16 v[146:149], a[68:71], v[186:189], v[146:149]
v_cvt_pk_bf16_f32 v102, v138, v139
v_cvt_pk_bf16_f32 v103, v140, v141
v_cvt_pk_bf16_f32 v104, v142, v143
v_cvt_pk_bf16_f32 v105, v144, v145
s_nop 2
v_cvt_pk_bf16_f32 v106, v146, v147
v_cvt_pk_bf16_f32 v107, v148, v149
ds_read_b128 v[108:111], v215 offset:512
ds_read_b64 v[112:113], v215 offset:528
v_mfma_f32_16x16x16_bf16 v[138:141], v[82:83], v[76:77], 0
v_mfma_f32_16x16x16_bf16 v[142:145], v[100:101], v[76:77], 0
s_waitcnt lgkmcnt(0)
v_mfma_f32_16x16x16_bf16 v[150:153], v[112:113], v[76:77], v[206:209]
v_mfma_f32_16x16x16_bf16 v[146:149], v[106:107], v[76:77], 0
v_mfma_f32_16x16x32_bf16 v[138:141], v[78:81], v[72:75], v[138:141]
v_mfma_f32_16x16x32_bf16 v[142:145], v[96:99], v[72:75], v[142:145]
v_mfma_f32_16x16x32_bf16 v[150:153], v[108:111], v[72:75], v[150:153]
v_mfma_f32_16x16x32_bf16 v[146:149], v[102:105], v[72:75], v[146:149]
ds_read_b128 v[72:75], v215
ds_read_b64 v[76:77], v215 offset:16
v_mfma_f32_16x16x16_bf16 v[154:157], v[82:83], v[88:89], 0
v_mfma_f32_16x16x16_bf16 v[158:161], v[100:101], v[88:89], 0
v_mfma_f32_16x16x16_bf16 v[166:169], v[112:113], v[88:89], v[206:209]
v_mfma_f32_16x16x16_bf16 v[162:165], v[106:107], v[88:89], 0
v_mfma_f32_16x16x32_bf16 v[154:157], v[78:81], v[84:87], v[154:157]
v_mfma_f32_16x16x32_bf16 v[158:161], v[96:99], v[84:87], v[158:161]
v_mfma_f32_16x16x32_bf16 v[166:169], v[108:111], v[84:87], v[166:169]
v_mfma_f32_16x16x32_bf16 v[162:165], v[102:105], v[84:87], v[162:165]
v_mfma_f32_16x16x32_bf16 v[118:121], v[182:185], a[88:91], 0
v_mfma_f32_16x16x32_bf16 v[118:121], v[186:189], a[92:95], v[118:121]
v_mfma_f32_16x16x32_bf16 v[126:129], v[182:185], a[112:115], 0
v_mfma_f32_16x16x32_bf16 v[126:129], v[186:189], a[116:119], v[126:129]
v_mfma_f32_16x16x32_bf16 v[134:137], v[182:185], a[136:139], 0
v_mfma_f32_16x16x32_bf16 v[134:137], v[186:189], a[140:143], v[134:137]
v_mfma_f32_16x16x32_bf16 v[90:93], a[232:235], v[182:185], 0
v_mfma_f32_16x16x32_bf16 v[90:93], a[236:239], v[186:189], v[90:93]
v_mfma_f32_16x16x32_bf16 v[170:173], v[224:227], v[182:185], 0
v_mfma_f32_16x16x32_bf16 v[170:173], v[228:231], v[186:189], v[170:173]
v_mfma_f32_16x16x32_bf16 v[220:223], v[248:251], v[182:185], 0
v_mfma_f32_16x16x32_bf16 v[220:223], v[252:255], v[186:189], v[220:223]
v_mfma_f32_16x16x32_bf16 v[118:121], v[174:177], a[80:83], v[118:121]
v_mfma_f32_16x16x32_bf16 v[118:121], v[178:181], a[84:87], v[118:121]
v_mfma_f32_16x16x32_bf16 v[126:129], v[174:177], a[104:107], v[126:129]
v_mfma_f32_16x16x32_bf16 v[126:129], v[178:181], a[108:111], v[126:129]
v_mfma_f32_16x16x32_bf16 v[134:137], v[174:177], a[128:131], v[134:137]
v_mfma_f32_16x16x32_bf16 v[134:137], v[178:181], a[132:135], v[134:137]
v_mfma_f32_16x16x32_bf16 v[90:93], a[224:227], v[174:177], v[90:93]
v_mfma_f32_16x16x32_bf16 v[90:93], a[228:231], v[178:181], v[90:93]
v_mfma_f32_16x16x32_bf16 v[170:173], a[248:251], v[174:177], v[170:173]
v_mfma_f32_16x16x32_bf16 v[170:173], a[252:255], v[178:181], v[170:173]
v_mfma_f32_16x16x32_bf16 v[220:223], v[240:243], v[174:177], v[220:223]
v_mfma_f32_16x16x32_bf16 v[220:223], v[244:247], v[178:181], v[220:223]
ds_read_b128 v[182:185], v210 offset:12288
ds_read_b128 v[186:189], v210 offset:13312
s_waitcnt lgkmcnt(1)
v_mfma_f32_16x16x32_bf16 v[118:121], v[182:185], a[72:75], v[118:121]
s_waitcnt lgkmcnt(0)
v_mfma_f32_16x16x32_bf16 v[118:121], v[186:189], a[76:79], v[118:121]
v_mfma_f32_16x16x32_bf16 v[126:129], v[182:185], a[96:99], v[126:129]
v_mfma_f32_16x16x32_bf16 v[126:129], v[186:189], a[100:103], v[126:129]
v_mfma_f32_16x16x32_bf16 v[134:137], v[182:185], a[120:123], v[134:137]
v_mfma_f32_16x16x32_bf16 v[134:137], v[186:189], a[124:127], v[134:137]
v_mfma_f32_16x16x32_bf16 v[90:93], a[216:219], v[182:185], v[90:93]
v_mfma_f32_16x16x32_bf16 v[90:93], a[220:223], v[186:189], v[90:93]
v_mfma_f32_16x16x32_bf16 v[170:173], a[240:243], v[182:185], v[170:173]
v_mfma_f32_16x16x32_bf16 v[170:173], a[244:247], v[186:189], v[170:173]
v_mfma_f32_16x16x32_bf16 v[220:223], v[232:235], v[182:185], v[220:223]
v_mfma_f32_16x16x32_bf16 v[220:223], v[236:239], v[186:189], v[220:223]
v_mov_b32 v181, 0
v_cvt_pk_bf16_f32 v118, v118, v119
v_cvt_pk_bf16_f32 v119, v120, v121
ds_read_u16 v120, v205
v_mov_b32 v121, 0
v_cvt_pk_bf16_f32 v126, v126, v127
v_cvt_pk_bf16_f32 v127, v128, v129
ds_read_u16 v128, v205 offset:32
v_mov_b32 v129, 0
v_cvt_pk_bf16_f32 v134, v134, v135
v_cvt_pk_bf16_f32 v135, v136, v137
ds_read_u16 v136, v205 offset:64
v_mov_b32 v137, 0
v_add_u32 v205, 1424, v205
v_cvt_pk_bf16_f32 v90, v90, v91
v_cvt_pk_bf16_f32 v91, v92, v93
v_cvt_pk_bf16_f32 v92, v170, v171
v_cvt_pk_bf16_f32 v93, v172, v173
v_cvt_pk_bf16_f32 v94, v220, v221
v_cvt_pk_bf16_f32 v95, v222, v223
v_max3_f32 v151, v138, v139, v140
v_max3_f32 v151, v151, v141, v142
v_max3_f32 v151, v151, v143, v144
v_max3_f32 v151, v151, v145, v146
v_max3_f32 v151, v151, v147, v148
v_max3_f32 v151, v151, v149, v150
v_mov_b32 v152, v151
s_nop 1
v_permlane16_swap_b32 v151, v152
v_max_f32 v151, v151, v152
v_mov_b32 v152, v151
s_nop 1
v_permlane32_swap_b32 v151, v152
v_max_f32 v151, v151, v152
v_sub_f32 v138, v138, v151
v_sub_f32 v139, v139, v151
v_sub_f32 v140, v140, v151
v_sub_f32 v141, v141, v151
v_sub_f32 v142, v142, v151
v_sub_f32 v143, v143, v151
v_sub_f32 v144, v144, v151
v_sub_f32 v145, v145, v151
v_sub_f32 v150, v150, v151
v_sub_f32 v146, v146, v151
v_sub_f32 v147, v147, v151
v_sub_f32 v148, v148, v151
v_sub_f32 v149, v149, v151
v_exp_f32 v138, v138
v_exp_f32 v139, v139
v_exp_f32 v140, v140
v_exp_f32 v141, v141
v_exp_f32 v142, v142
v_exp_f32 v143, v143
v_exp_f32 v144, v144
v_exp_f32 v145, v145
v_exp_f32 v150, v150
v_exp_f32 v146, v146
v_exp_f32 v147, v147
v_exp_f32 v148, v148
v_exp_f32 v149, v149
v_cvt_pk_bf16_f32 v174, v138, v139
v_cvt_pk_bf16_f32 v175, v140, v141
v_cvt_pk_bf16_f32 v176, v142, v143
v_cvt_pk_bf16_f32 v177, v144, v145
v_cvt_pk_bf16_f32 v178, v146, v147
v_cvt_pk_bf16_f32 v179, v148, v149
v_cvt_pk_bf16_f32 v180, v150, 0
v_mfma_f32_16x16x32_bf16 v[150:153], v[190:193], v[174:177], 0
v_mfma_f32_16x16x32_bf16 v[150:153], v[190:193], v[178:181], v[150:153]
v_mfma_f32_16x16x32_bf16 v[138:141], v[114:117], v[174:177], 0
s_waitcnt lgkmcnt(2)
v_mfma_f32_16x16x32_bf16 v[138:141], v[118:121], v[178:181], v[138:141]
v_mfma_f32_16x16x32_bf16 v[142:145], v[122:125], v[174:177], 0
s_waitcnt lgkmcnt(1)
v_mfma_f32_16x16x32_bf16 v[142:145], v[126:129], v[178:181], v[142:145]
v_mfma_f32_16x16x32_bf16 v[146:149], v[130:133], v[174:177], 0
s_waitcnt lgkmcnt(0)
v_mfma_f32_16x16x32_bf16 v[146:149], v[134:137], v[178:181], v[146:149]
v_max3_f32 v167, v154, v155, v156
v_max3_f32 v167, v167, v157, v158
v_max3_f32 v167, v167, v159, v160
v_max3_f32 v167, v167, v161, v162
v_max3_f32 v167, v167, v163, v164
v_max3_f32 v167, v167, v165, v166
v_mov_b32 v168, v167
s_nop 1
v_permlane16_swap_b32 v167, v168
v_max_f32 v167, v167, v168
v_mov_b32 v168, v167
s_nop 1
v_permlane32_swap_b32 v167, v168
v_max_f32 v167, v167, v168
v_sub_f32 v154, v154, v167
v_sub_f32 v155, v155, v167
v_sub_f32 v156, v156, v167
v_sub_f32 v157, v157, v167
v_sub_f32 v158, v158, v167
v_sub_f32 v159, v159, v167
v_sub_f32 v160, v160, v167
v_sub_f32 v161, v161, v167
v_sub_f32 v166, v166, v167
v_sub_f32 v162, v162, v167
v_sub_f32 v163, v163, v167
v_sub_f32 v164, v164, v167
v_sub_f32 v165, v165, v167
v_exp_f32 v154, v154
v_exp_f32 v155, v155
v_exp_f32 v156, v156
v_exp_f32 v157, v157
v_exp_f32 v158, v158
v_exp_f32 v159, v159
v_exp_f32 v160, v160
v_exp_f32 v161, v161
v_exp_f32 v166, v166
v_exp_f32 v162, v162
v_exp_f32 v163, v163
v_exp_f32 v164, v164
v_exp_f32 v165, v165
v_cvt_pk_bf16_f32 v174, v154, v155
v_cvt_pk_bf16_f32 v175, v156, v157
v_cvt_pk_bf16_f32 v176, v158, v159
v_cvt_pk_bf16_f32 v177, v160, v161
v_cvt_pk_bf16_f32 v178, v162, v163
v_cvt_pk_bf16_f32 v179, v164, v165
v_cvt_pk_bf16_f32 v180, v166, 0
v_mfma_f32_16x16x32_bf16 v[166:169], v[190:193], v[174:177], 0
v_mfma_f32_16x16x32_bf16 v[166:169], v[190:193], v[178:181], v[166:169]
v_mfma_f32_16x16x32_bf16 v[154:157], v[114:117], v[174:177], 0
v_mfma_f32_16x16x32_bf16 v[154:157], v[118:121], v[178:181], v[154:157]
v_mfma_f32_16x16x32_bf16 v[158:161], v[122:125], v[174:177], 0
v_mfma_f32_16x16x32_bf16 v[158:161], v[126:129], v[178:181], v[158:161]
v_mfma_f32_16x16x32_bf16 v[162:165], v[130:133], v[174:177], 0
v_mfma_f32_16x16x32_bf16 v[162:165], v[134:137], v[178:181], v[162:165]
v_rcp_f32 v151, v150
s_nop 0
v_mul_f32 v152, s3, v151
v_mul_f32 v138, v138, v152
v_mul_f32 v139, v139, v152
v_cvt_pk_bf16_f32 v138, v138, v139
v_mul_f32 v140, v140, v152
v_mul_f32 v141, v141, v152
v_cvt_pk_bf16_f32 v139, v140, v141
v_mul_f32 v142, v142, v152
v_mul_f32 v143, v143, v152
v_cvt_pk_bf16_f32 v140, v142, v143
v_mul_f32 v144, v144, v152
v_mul_f32 v145, v145, v152
v_cvt_pk_bf16_f32 v141, v144, v145
ds_write_b128 v211, v[138:141] offset:38912
v_mul_f32 v146, v146, v152
v_mul_f32 v147, v147, v152
v_cvt_pk_bf16_f32 v142, v146, v147
v_mul_f32 v148, v148, v152
v_mul_f32 v149, v149, v152
v_cvt_pk_bf16_f32 v143, v148, v149
ds_write_b64 v212, v[142:143] offset:38912
v_mfma_f32_16x16x32_bf16 v[138:141], v[78:81], v[90:93], 0
v_mfma_f32_16x16x32_bf16 v[142:145], v[96:99], v[90:93], 0
v_mfma_f32_16x16x32_bf16 v[150:153], v[108:111], v[90:93], v[206:209]
v_mfma_f32_16x16x32_bf16 v[146:149], v[102:105], v[90:93], 0
v_mfma_f32_16x16x16_bf16 v[138:141], v[82:83], v[94:95], v[138:141]
v_mfma_f32_16x16x16_bf16 v[142:145], v[100:101], v[94:95], v[142:145]
v_mfma_f32_16x16x16_bf16 v[150:153], v[112:113], v[94:95], v[150:153]
v_mfma_f32_16x16x16_bf16 v[146:149], v[106:107], v[94:95], v[146:149]
v_rcp_f32 v167, v166
s_nop 0
v_mul_f32 v168, s3, v167
v_mul_f32 v154, v154, v168
v_mul_f32 v155, v155, v168
v_cvt_pk_bf16_f32 v154, v154, v155
v_mul_f32 v156, v156, v168
v_mul_f32 v157, v157, v168
v_cvt_pk_bf16_f32 v155, v156, v157
v_mul_f32 v158, v158, v168
v_mul_f32 v159, v159, v168
v_cvt_pk_bf16_f32 v156, v158, v159
v_mul_f32 v160, v160, v168
v_mul_f32 v161, v161, v168
v_cvt_pk_bf16_f32 v157, v160, v161
ds_write_b128 v211, v[154:157] offset:45056
v_mul_f32 v162, v162, v168
v_mul_f32 v163, v163, v168
v_cvt_pk_bf16_f32 v158, v162, v163
v_mul_f32 v164, v164, v168
v_mul_f32 v165, v165, v168
v_cvt_pk_bf16_f32 v159, v164, v165
ds_write_b64 v212, v[158:159] offset:45056
v_mfma_f32_16x16x32_bf16 v[154:157], v[72:75], v[78:81], 0
v_mfma_f32_16x16x32_bf16 v[158:161], v[72:75], v[96:99], 0
v_mfma_f32_16x16x32_bf16 v[162:165], v[72:75], v[102:105], 0
v_mfma_f32_16x16x16_bf16 v[154:157], v[76:77], v[82:83], v[154:157]
v_mfma_f32_16x16x16_bf16 v[158:161], v[76:77], v[100:101], v[158:161]
v_mfma_f32_16x16x16_bf16 v[162:165], v[76:77], v[106:107], v[162:165]
ds_read_b32 v166, v215 offset:536
s_nop 2
v_mov_b32_dpp v154, v158 quad_perm:[0,1,2,3] row_mask:0x2 bank_mask:0xf
s_nop 2
v_mov_b32_dpp v154, v162 quad_perm:[0,1,2,3] row_mask:0x4 bank_mask:0xf
s_waitcnt lgkmcnt(0)
s_nop 0
v_add_f32_dpp v154, v166, v207 quad_perm:[0,1,2,3] row_mask:0x8 bank_mask:0xf
v_mov_b32 v155, v154
s_nop 1
v_max_f32_dpp v155, v155, v155 row_ror:8 row_mask:0xf bank_mask:0xf
s_nop 1
v_max_f32_dpp v155, v155, v155 row_ror:4 row_mask:0xf bank_mask:0xf
s_nop 1
v_max_f32_dpp v155, v155, v155 row_ror:2 row_mask:0xf bank_mask:0xf
s_nop 1
v_max_f32_dpp v155, v155, v155 row_ror:1 row_mask:0xf bank_mask:0xf
v_mov_b32 v156, v155
s_nop 1
v_permlane16_swap_b32 v155, v156
v_max_f32 v155, v155, v156
v_mov_b32 v156, v155
s_nop 1
v_permlane32_swap_b32 v155, v156
v_max_f32 v155, v155, v156
v_sub_f32 v154, v154, v155
v_exp_f32 v166, v154
s_nop 0
v_cvt_pk_bf16_f32 v154, v166, 0
ds_write_b16 v214, v154
v_add_f32_dpp v166, v166, v166 row_ror:8 row_mask:0xf bank_mask:0xf
s_nop 1
v_add_f32_dpp v166, v166, v166 row_ror:4 row_mask:0xf bank_mask:0xf
s_nop 1
v_add_f32_dpp v166, v166, v166 row_ror:2 row_mask:0xf bank_mask:0xf
s_nop 1
v_add_f32_dpp v166, v166, v166 row_ror:1 row_mask:0xf bank_mask:0xf
s_nop 1
v_add_f32_dpp v166, v166, v166 row_bcast:15 row_mask:0xa bank_mask:0xf
s_nop 1
v_add_f32_dpp v166, v166, v166 row_bcast:31 row_mask:0xc bank_mask:0xf
s_nop 0
v_readlane_b32 s72, v166, 63
s_nop 1
v_rcp_f32 v167, s72
s_nop 0
v_mul_f32 v168, s3, v167
ds_read_b128 v[84:87], v215
ds_read_b128 v[88:91], v215 offset:16
v_add_u32 v215, 1424, v215
s_barrier
ds_read_b128 v[220:223], v210 offset:38912
ds_read_b128 v[110:113], v210 offset:39936
s_waitcnt lgkmcnt(1)
v_mfma_f32_16x16x32_bf16 v[0:3], a[144:147], v[220:223], v[0:3]
s_waitcnt lgkmcnt(0)
v_mfma_f32_16x16x32_bf16 v[0:3], a[148:151], v[110:113], v[0:3]
v_mfma_f32_16x16x32_bf16 v[4:7], a[168:171], v[220:223], v[4:7]
v_mfma_f32_16x16x32_bf16 v[4:7], a[172:175], v[110:113], v[4:7]
v_mfma_f32_16x16x32_bf16 v[8:11], a[192:195], v[220:223], v[8:11]
v_mfma_f32_16x16x32_bf16 v[8:11], a[196:199], v[110:113], v[8:11]
ds_read_b128 v[170:173], v210 offset:40960
ds_read_b128 v[182:185], v210 offset:41984
s_waitcnt lgkmcnt(1)
v_mfma_f32_16x16x32_bf16 v[0:3], a[152:155], v[170:173], v[0:3]
s_waitcnt lgkmcnt(0)
v_mfma_f32_16x16x32_bf16 v[0:3], a[156:159], v[182:185], v[0:3]
v_mfma_f32_16x16x32_bf16 v[4:7], a[176:179], v[170:173], v[4:7]
v_mfma_f32_16x16x32_bf16 v[4:7], a[180:183], v[182:185], v[4:7]
v_mfma_f32_16x16x32_bf16 v[8:11], a[200:203], v[170:173], v[8:11]
v_mfma_f32_16x16x32_bf16 v[8:11], a[204:207], v[182:185], v[8:11]
ds_read_b128 v[186:189], v210 offset:43008
ds_read_b128 v[220:223], v210 offset:44032
s_waitcnt lgkmcnt(1)
v_mfma_f32_16x16x32_bf16 v[0:3], a[160:163], v[186:189], v[0:3]
s_waitcnt lgkmcnt(0)
v_mfma_f32_16x16x32_bf16 v[0:3], a[164:167], v[220:223], v[0:3]
v_mfma_f32_16x16x32_bf16 v[4:7], a[184:187], v[186:189], v[4:7]
v_mfma_f32_16x16x32_bf16 v[4:7], a[188:191], v[220:223], v[4:7]
v_mfma_f32_16x16x32_bf16 v[8:11], a[208:211], v[186:189], v[8:11]
v_mfma_f32_16x16x32_bf16 v[8:11], a[212:215], v[220:223], v[8:11]
v_cvt_pk_bf16_f32 v0, v0, v1
v_cvt_pk_bf16_f32 v1, v2, v3
ds_write_b64 v203, v[0:1]
v_cvt_pk_bf16_f32 v4, v4, v5
v_cvt_pk_bf16_f32 v5, v6, v7
ds_write_b64 v203, v[4:5] offset:32
v_cvt_pk_bf16_f32 v8, v8, v9
v_cvt_pk_bf16_f32 v9, v10, v11
ds_write_b64 v203, v[8:9] offset:64
v_max3_f32 v151, v138, v139, v140
v_max3_f32 v151, v151, v141, v142
v_max3_f32 v151, v151, v143, v144
v_max3_f32 v151, v151, v145, v146
v_max3_f32 v151, v151, v147, v148
v_max3_f32 v151, v151, v149, v150
v_mov_b32 v152, v151
s_nop 1
v_permlane16_swap_b32 v151, v152
v_max_f32 v151, v151, v152
v_mov_b32 v152, v151
s_nop 1
v_permlane32_swap_b32 v151, v152
v_max_f32 v151, v151, v152
v_sub_f32 v138, v138, v151
v_sub_f32 v139, v139, v151
v_sub_f32 v140, v140, v151
v_sub_f32 v141, v141, v151
v_sub_f32 v142, v142, v151
v_sub_f32 v143, v143, v151
v_sub_f32 v144, v144, v151
v_sub_f32 v145, v145, v151
v_sub_f32 v150, v150, v151
v_sub_f32 v146, v146, v151
v_sub_f32 v147, v147, v151
v_sub_f32 v148, v148, v151
v_sub_f32 v149, v149, v151
v_exp_f32 v138, v138
v_exp_f32 v139, v139
v_exp_f32 v140, v140
v_exp_f32 v141, v141
v_exp_f32 v142, v142
v_exp_f32 v143, v143
v_exp_f32 v144, v144
v_exp_f32 v145, v145
v_exp_f32 v150, v150
v_exp_f32 v146, v146
v_exp_f32 v147, v147
v_exp_f32 v148, v148
v_exp_f32 v149, v149
v_cvt_pk_bf16_f32 v174, v138, v139
v_cvt_pk_bf16_f32 v175, v140, v141
v_cvt_pk_bf16_f32 v176, v142, v143
v_cvt_pk_bf16_f32 v177, v144, v145
v_cvt_pk_bf16_f32 v178, v146, v147
v_cvt_pk_bf16_f32 v179, v148, v149
v_cvt_pk_bf16_f32 v180, v150, 0
v_mfma_f32_16x16x32_bf16 v[150:153], v[190:193], v[174:177], 0
v_mfma_f32_16x16x32_bf16 v[150:153], v[190:193], v[178:181], v[150:153]
v_mfma_f32_16x16x32_bf16 v[138:141], v[114:117], v[174:177], 0
v_mfma_f32_16x16x32_bf16 v[138:141], v[118:121], v[178:181], v[138:141]
v_mfma_f32_16x16x32_bf16 v[142:145], v[122:125], v[174:177], 0
v_mfma_f32_16x16x32_bf16 v[142:145], v[126:129], v[178:181], v[142:145]
v_mfma_f32_16x16x32_bf16 v[146:149], v[130:133], v[174:177], 0
v_mfma_f32_16x16x32_bf16 v[146:149], v[134:137], v[178:181], v[146:149]
v_rcp_f32 v151, v150
s_nop 0
v_mul_f32 v152, s3, v151
v_mul_f32 v138, v138, v152
v_mul_f32 v139, v139, v152
v_cvt_pk_bf16_f32 v138, v138, v139
v_mul_f32 v140, v140, v152
v_mul_f32 v141, v141, v152
v_cvt_pk_bf16_f32 v139, v140, v141
v_mul_f32 v142, v142, v152
v_mul_f32 v143, v143, v152
v_cvt_pk_bf16_f32 v140, v142, v143
v_mul_f32 v144, v144, v152
v_mul_f32 v145, v145, v152
v_cvt_pk_bf16_f32 v141, v144, v145
ds_write_b128 v211, v[138:141] offset:51200
v_mul_f32 v146, v146, v152
v_mul_f32 v147, v147, v152
v_cvt_pk_bf16_f32 v142, v146, v147
v_mul_f32 v148, v148, v152
v_mul_f32 v149, v149, v152
v_cvt_pk_bf16_f32 v143, v148, v149
ds_write_b64 v212, v[142:143] offset:51200
v_mfma_f32_16x16x32_bf16 v[154:157], v[84:87], v[114:117], 0
v_mfma_f32_16x16x32_bf16 v[154:157], v[88:91], v[118:121], v[154:157]
v_mfma_f32_16x16x32_bf16 v[158:161], v[84:87], v[122:125], 0
v_mfma_f32_16x16x32_bf16 v[158:161], v[88:91], v[126:129], v[158:161]
v_mfma_f32_16x16x32_bf16 v[162:165], v[84:87], v[130:133], 0
v_mfma_f32_16x16x32_bf16 v[162:165], v[88:91], v[134:137], v[162:165]
v_mov_b32_dpp v154, v158 quad_perm:[0,1,2,3] row_mask:0x2 bank_mask:0xf
s_nop 5
v_mov_b32_dpp v154, v162 quad_perm:[0,1,2,3] row_mask:0x4 bank_mask:0xf
v_mul_f32 v154, v154, v168
v_cvt_pk_bf16_f32 v154, v154, 0
ds_write_b16 v214, v154
v_add_u32 v214, 1424, v214
ds_read_b128 v[110:113], v210 offset:45056
ds_read_b128 v[170:173], v210 offset:46080
s_waitcnt lgkmcnt(1)
v_mfma_f32_16x16x32_bf16 v[12:15], a[144:147], v[110:113], v[12:15]
s_waitcnt lgkmcnt(0)
v_mfma_f32_16x16x32_bf16 v[12:15], a[148:151], v[170:173], v[12:15]
v_mfma_f32_16x16x32_bf16 v[16:19], a[168:171], v[110:113], v[16:19]
v_mfma_f32_16x16x32_bf16 v[16:19], a[172:175], v[170:173], v[16:19]
v_mfma_f32_16x16x32_bf16 v[20:23], a[192:195], v[110:113], v[20:23]
v_mfma_f32_16x16x32_bf16 v[20:23], a[196:199], v[170:173], v[20:23]
ds_read_b128 v[182:185], v210 offset:47104
ds_read_b128 v[186:189], v210 offset:48128
s_waitcnt lgkmcnt(1)
v_mfma_f32_16x16x32_bf16 v[12:15], a[152:155], v[182:185], v[12:15]
s_waitcnt lgkmcnt(0)
v_mfma_f32_16x16x32_bf16 v[12:15], a[156:159], v[186:189], v[12:15]
v_mfma_f32_16x16x32_bf16 v[16:19], a[176:179], v[182:185], v[16:19]
v_mfma_f32_16x16x32_bf16 v[16:19], a[180:183], v[186:189], v[16:19]
v_mfma_f32_16x16x32_bf16 v[20:23], a[200:203], v[182:185], v[20:23]
v_mfma_f32_16x16x32_bf16 v[20:23], a[204:207], v[186:189], v[20:23]
ds_read_b128 v[220:223], v210 offset:49152
ds_read_b128 v[110:113], v210 offset:50176
s_waitcnt lgkmcnt(1)
v_mfma_f32_16x16x32_bf16 v[12:15], a[160:163], v[220:223], v[12:15]
s_waitcnt lgkmcnt(0)
v_mfma_f32_16x16x32_bf16 v[12:15], a[164:167], v[110:113], v[12:15]
v_mfma_f32_16x16x32_bf16 v[16:19], a[184:187], v[220:223], v[16:19]
v_mfma_f32_16x16x32_bf16 v[16:19], a[188:191], v[110:113], v[16:19]
v_mfma_f32_16x16x32_bf16 v[20:23], a[208:211], v[220:223], v[20:23]
v_mfma_f32_16x16x32_bf16 v[20:23], a[212:215], v[110:113], v[20:23]
v_cvt_pk_bf16_f32 v12, v12, v13
v_cvt_pk_bf16_f32 v13, v14, v15
ds_write_b64 v203, v[12:13] offset:6272
v_cvt_pk_bf16_f32 v16, v16, v17
v_cvt_pk_bf16_f32 v17, v18, v19
ds_write_b64 v203, v[16:17] offset:6304
v_cvt_pk_bf16_f32 v20, v20, v21
v_cvt_pk_bf16_f32 v21, v22, v23
ds_write_b64 v203, v[20:21] offset:6336
s_mov_b32 s46, 7
.p2align 6
G_loop:
s_waitcnt vmcnt(0)
s_barrier
ds_read_b128 v[170:173], v210 offset:51200
ds_read_b128 v[182:185], v210 offset:52224
s_waitcnt lgkmcnt(1)
v_mfma_f32_16x16x32_bf16 v[24:27], a[144:147], v[170:173], v[24:27]
s_waitcnt lgkmcnt(0)
v_mfma_f32_16x16x32_bf16 v[24:27], a[148:151], v[182:185], v[24:27]
v_mfma_f32_16x16x32_bf16 v[28:31], a[168:171], v[170:173], v[28:31]
v_mfma_f32_16x16x32_bf16 v[28:31], a[172:175], v[182:185], v[28:31]
v_mfma_f32_16x16x32_bf16 v[32:35], a[192:195], v[170:173], v[32:35]
v_mfma_f32_16x16x32_bf16 v[32:35], a[196:199], v[182:185], v[32:35]
ds_read_b128 v[186:189], v210 offset:53248
ds_read_b128 v[220:223], v210 offset:54272
s_waitcnt lgkmcnt(1)
v_mfma_f32_16x16x32_bf16 v[24:27], a[152:155], v[186:189], v[24:27]
s_waitcnt lgkmcnt(0)
v_mfma_f32_16x16x32_bf16 v[24:27], a[156:159], v[220:223], v[24:27]
v_mfma_f32_16x16x32_bf16 v[28:31], a[176:179], v[186:189], v[28:31]
v_mfma_f32_16x16x32_bf16 v[28:31], a[180:183], v[220:223], v[28:31]
v_mfma_f32_16x16x32_bf16 v[32:35], a[200:203], v[186:189], v[32:35]
v_mfma_f32_16x16x32_bf16 v[32:35], a[204:207], v[220:223], v[32:35]
ds_read_b128 v[110:113], v210 offset:55296
ds_read_b128 v[170:173], v210 offset:56320
s_waitcnt lgkmcnt(1)
v_mfma_f32_16x16x32_bf16 v[24:27], a[160:163], v[110:113], v[24:27]
s_waitcnt lgkmcnt(0)
v_mfma_f32_16x16x32_bf16 v[24:27], a[164:167], v[170:173], v[24:27]
v_mfma_f32_16x16x32_bf16 v[28:31], a[184:187], v[110:113], v[28:31]
v_mfma_f32_16x16x32_bf16 v[28:31], a[188:191], v[170:173], v[28:31]
v_mfma_f32_16x16x32_bf16 v[32:35], a[208:211], v[110:113], v[32:35]
v_mfma_f32_16x16x32_bf16 v[32:35], a[212:215], v[170:173], v[32:35]
v_cvt_pk_bf16_f32 v24, v24, v25
v_cvt_pk_bf16_f32 v25, v26, v27
ds_write_b64 v203, v[24:25] offset:12544
v_cvt_pk_bf16_f32 v28, v28, v29
v_cvt_pk_bf16_f32 v29, v30, v31
ds_write_b64 v203, v[28:29] offset:12576
v_cvt_pk_bf16_f32 v32, v32, v33
v_cvt_pk_bf16_f32 v33, v34, v35
ds_write_b64 v203, v[32:33] offset:12608
s_waitcnt lgkmcnt(0)
s_barrier
ds_read_b64 v[120:121], v204
s_add_u32 s28, s38, s60
s_waitcnt lgkmcnt(0)
buffer_store_dwordx2 v[120:121], v204, s[8:11], s28 offen sc1
ds_read_b64 v[128:129], v204 offset:392
s_add_u32 s29, s38, s61
s_waitcnt lgkmcnt(0)
buffer_store_dwordx2 v[128:129], v204, s[8:11], s29 offen sc1
ds_read_b64 v[136:137], v204 offset:784
s_add_u32 s28, s38, s62
s_waitcnt lgkmcnt(0)
buffer_store_dwordx2 v[136:137], v204, s[8:11], s28 offen sc1
ds_read_b64 v[120:121], v204 offset:1176
s_add_u32 s29, s38, s63
s_waitcnt lgkmcnt(0)
buffer_store_dwordx2 v[120:121], v204, s[8:11], s29 offen sc1
ds_read_b64 v[128:129], v204 offset:6272
s_add_u32 s28, s38, s64
s_waitcnt lgkmcnt(0)
buffer_store_dwordx2 v[128:129], v204, s[8:11], s28 offen sc1
ds_read_b64 v[136:137], v204 offset:6664
s_add_u32 s29, s38, s65
s_waitcnt lgkmcnt(0)
buffer_store_dwordx2 v[136:137], v204, s[8:11], s29 offen sc1
ds_read_b64 v[120:121], v204 offset:7056
s_add_u32 s28, s38, s66
s_waitcnt lgkmcnt(0)
buffer_store_dwordx2 v[120:121], v204, s[8:11], s28 offen sc1
ds_read_b64 v[128:129], v204 offset:7448
s_add_u32 s29, s38, s67
s_waitcnt lgkmcnt(0)
buffer_store_dwordx2 v[128:129], v204, s[8:11], s29 offen sc1
ds_read_b64 v[136:137], v204 offset:12544
s_add_u32 s28, s38, s68
s_waitcnt lgkmcnt(0)
buffer_store_dwordx2 v[136:137], v204, s[8:11], s28 offen sc1
ds_read_b64 v[120:121], v204 offset:12936
s_add_u32 s29, s38, s69
s_waitcnt lgkmcnt(0)
buffer_store_dwordx2 v[120:121], v204, s[8:11], s29 offen sc1
ds_read_b64 v[128:129], v204 offset:13328
s_add_u32 s28, s38, s70
s_waitcnt lgkmcnt(0)
buffer_store_dwordx2 v[128:129], v204, s[8:11], s28 offen sc1
ds_read_b64 v[136:137], v204 offset:13720
s_add_u32 s29, s38, s71
s_waitcnt lgkmcnt(0)
buffer_store_dwordx2 v[136:137], v204, s[8:11], s29 offen sc1
s_mov_b32 s39, s37
ds_read_b128 v[174:177], v217
ds_read_b128 v[84:87], v200
s_waitcnt lgkmcnt(0)
v_mfma_f32_16x16x32_bf16 v[0:3], v[174:177], v[84:87], 0
ds_read_b128 v[92:95], v201
s_waitcnt lgkmcnt(0)
v_mfma_f32_16x16x32_bf16 v[12:15], v[174:177], v[92:95], 0
ds_read_b128 v[100:103], v202
s_waitcnt lgkmcnt(0)
v_mfma_f32_16x16x32_bf16 v[24:27], v[174:177], v[100:103], 0
ds_read_b128 v[178:181], v217 offset:528
ds_read_b128 v[84:87], v194
ds_read_b128 v[88:91], v194 offset:16
s_waitcnt lgkmcnt(0)
v_smfmac_f32_16x16x64_bf16 v[0:3], v[178:181], v[84:91], v213
ds_read_b128 v[92:95], v195
ds_read_b128 v[96:99], v195 offset:16
s_waitcnt lgkmcnt(0)
v_smfmac_f32_16x16x64_bf16 v[12:15], v[178:181], v[92:99], v213
ds_read_b128 v[100:103], v196
ds_read_b128 v[104:107], v196 offset:16
s_waitcnt lgkmcnt(0)
v_smfmac_f32_16x16x64_bf16 v[24:27], v[178:181], v[100:107], v213
ds_read_b128 v[174:177], v217 offset:1056
ds_read_b128 v[84:87], v197
ds_read_b128 v[88:91], v197 offset:16
s_waitcnt lgkmcnt(0)
v_smfmac_f32_16x16x64_bf16 v[0:3], v[174:177], v[84:91], v213
ds_read_b128 v[92:95], v198
ds_read_b128 v[96:99], v198 offset:16
s_waitcnt lgkmcnt(0)
v_smfmac_f32_16x16x64_bf16 v[12:15], v[174:177], v[92:99], v213
ds_read_b128 v[100:103], v199
ds_read_b128 v[104:107], v199 offset:16
s_waitcnt lgkmcnt(0)
v_smfmac_f32_16x16x64_bf16 v[24:27], v[174:177], v[100:107], v213
ds_read_b128 v[178:181], v217 offset:1584
ds_read_b128 v[84:87], v200 offset:32
s_waitcnt lgkmcnt(0)
v_mfma_f32_16x16x32_bf16 v[4:7], v[178:181], v[84:87], 0
ds_read_b128 v[92:95], v201 offset:32
s_waitcnt lgkmcnt(0)
v_mfma_f32_16x16x32_bf16 v[16:19], v[178:181], v[92:95], 0
ds_read_b128 v[100:103], v202 offset:32
s_waitcnt lgkmcnt(0)
v_mfma_f32_16x16x32_bf16 v[28:31], v[178:181], v[100:103], 0
ds_read_b128 v[174:177], v217 offset:2112
ds_read_b128 v[84:87], v194 offset:32
ds_read_b128 v[88:91], v194 offset:48
s_waitcnt lgkmcnt(0)
v_smfmac_f32_16x16x64_bf16 v[4:7], v[174:177], v[84:91], v213
ds_read_b128 v[92:95], v195 offset:32
ds_read_b128 v[96:99], v195 offset:48
s_waitcnt lgkmcnt(0)
v_smfmac_f32_16x16x64_bf16 v[16:19], v[174:177], v[92:99], v213
ds_read_b128 v[100:103], v196 offset:32
ds_read_b128 v[104:107], v196 offset:48
s_waitcnt lgkmcnt(0)
v_smfmac_f32_16x16x64_bf16 v[28:31], v[174:177], v[100:107], v213
ds_read_b128 v[178:181], v217 offset:2640
ds_read_b128 v[84:87], v197 offset:32
ds_read_b128 v[88:91], v197 offset:48
s_waitcnt lgkmcnt(0)
v_smfmac_f32_16x16x64_bf16 v[4:7], v[178:181], v[84:91], v213
ds_read_b128 v[92:95], v198 offset:32
ds_read_b128 v[96:99], v198 offset:48
s_waitcnt lgkmcnt(0)
v_smfmac_f32_16x16x64_bf16 v[16:19], v[178:181], v[92:99], v213
ds_read_b128 v[100:103], v199 offset:32
ds_read_b128 v[104:107], v199 offset:48
s_waitcnt lgkmcnt(0)
v_smfmac_f32_16x16x64_bf16 v[28:31], v[178:181], v[100:107], v213
ds_read_b128 v[174:177], v217 offset:3168
ds_read_b128 v[84:87], v200 offset:64
s_waitcnt lgkmcnt(0)
v_mfma_f32_16x16x32_bf16 v[8:11], v[174:177], v[84:87], 0
ds_read_b128 v[92:95], v201 offset:64
s_waitcnt lgkmcnt(0)
v_mfma_f32_16x16x32_bf16 v[20:23], v[174:177], v[92:95], 0
ds_read_b128 v[100:103], v202 offset:64
s_waitcnt lgkmcnt(0)
v_mfma_f32_16x16x32_bf16 v[32:35], v[174:177], v[100:103], 0
ds_read_b128 v[178:181], v217 offset:3696
ds_read_b128 v[84:87], v194 offset:64
ds_read_b128 v[88:91], v194 offset:80
s_waitcnt lgkmcnt(0)
v_smfmac_f32_16x16x64_bf16 v[8:11], v[178:181], v[84:91], v213
ds_read_b128 v[92:95], v195 offset:64
ds_read_b128 v[96:99], v195 offset:80
s_waitcnt lgkmcnt(0)
v_smfmac_f32_16x16x64_bf16 v[20:23], v[178:181], v[92:99], v213
ds_read_b128 v[100:103], v196 offset:64
ds_read_b128 v[104:107], v196 offset:80
s_waitcnt lgkmcnt(0)
v_smfmac_f32_16x16x64_bf16 v[32:35], v[178:181], v[100:107], v213
ds_read_b128 v[174:177], v217 offset:4224
ds_read_b128 v[84:87], v197 offset:64
ds_read_b128 v[88:91], v197 offset:80
s_waitcnt lgkmcnt(0)
v_smfmac_f32_16x16x64_bf16 v[8:11], v[174:177], v[84:91], v213
ds_read_b128 v[92:95], v198 offset:64
ds_read_b128 v[96:99], v198 offset:80
s_waitcnt lgkmcnt(0)
v_smfmac_f32_16x16x64_bf16 v[20:23], v[174:177], v[92:99], v213
ds_read_b128 v[100:103], v199 offset:64
ds_read_b128 v[104:107], v199 offset:80
s_waitcnt lgkmcnt(0)
v_smfmac_f32_16x16x64_bf16 v[32:35], v[174:177], v[100:107], v213
v_add_f32 v118, v0, v1
v_mul_f32 v119, v0, v0
v_add_f32 v118, v118, v2
v_fmac_f32 v119, v1, v1
v_add_f32 v118, v118, v3
v_fmac_f32 v119, v2, v2
v_fmac_f32 v119, v3, v3
v_add_f32 v126, v12, v13
v_mul_f32 v127, v12, v12
v_add_f32 v126, v126, v14
v_fmac_f32 v127, v13, v13
v_add_f32 v126, v126, v15
v_fmac_f32 v127, v14, v14
v_fmac_f32 v127, v15, v15
v_add_f32 v134, v24, v25
v_mul_f32 v135, v24, v24
v_add_f32 v134, v134, v26
v_fmac_f32 v135, v25, v25
v_add_f32 v134, v134, v27
v_fmac_f32 v135, v26, v26
v_fmac_f32 v135, v27, v27
v_add_f32 v118, v118, v4
v_fmac_f32 v119, v4, v4
v_add_f32 v118, v118, v5
v_fmac_f32 v119, v5, v5
v_add_f32 v118, v118, v6
v_fmac_f32 v119, v6, v6
v_add_f32 v118, v118, v7
v_fmac_f32 v119, v7, v7
v_add_f32 v126, v126, v16
v_fmac_f32 v127, v16, v16
v_add_f32 v126, v126, v17
v_fmac_f32 v127, v17, v17
v_add_f32 v126, v126, v18
v_fmac_f32 v127, v18, v18
v_add_f32 v126, v126, v19
v_fmac_f32 v127, v19, v19
v_add_f32 v134, v134, v28
v_fmac_f32 v135, v28, v28
v_add_f32 v134, v134, v29
v_fmac_f32 v135, v29, v29
v_add_f32 v134, v134, v30
v_fmac_f32 v135, v30, v30
v_add_f32 v134, v134, v31
v_fmac_f32 v135, v31, v31
v_add_f32 v118, v118, v8
v_fmac_f32 v119, v8, v8
v_add_f32 v118, v118, v9
v_fmac_f32 v119, v9, v9
v_add_f32 v118, v118, v10
v_fmac_f32 v119, v10, v10
v_add_f32 v118, v118, v11
v_fmac_f32 v119, v11, v11
v_add_f32 v126, v126, v20
v_fmac_f32 v127, v20, v20
v_add_f32 v126, v126, v21
v_fmac_f32 v127, v21, v21
v_add_f32 v126, v126, v22
v_fmac_f32 v127, v22, v22
v_add_f32 v126, v126, v23
v_fmac_f32 v127, v23, v23
v_add_f32 v134, v134, v32
v_fmac_f32 v135, v32, v32
v_add_f32 v134, v134, v33
v_fmac_f32 v135, v33, v33
v_add_f32 v134, v134, v34
v_fmac_f32 v135, v34, v34
v_add_f32 v134, v134, v35
v_fmac_f32 v135, v35, v35
v_permlane16_swap_b32 v118, v119
v_add_f32 v118, v118, v119
v_permlane16_swap_b32 v126, v127
v_add_f32 v126, v126, v127
v_permlane16_swap_b32 v134, v135
v_add_f32 v134, v134, v135
v_permlane32_swap_b32 v118, v126
v_add_f32 v118, v118, v126
ds_write_b32 v209, v118
v_mov_b32 v135, v134
s_nop 1
v_permlane32_swap_b32 v134, v135
v_add_f32 v134, v134, v135
ds_write_b32 v209, v134 offset:512
s_waitcnt lgkmcnt(0)
s_barrier
s_mul_hi_u32 s41, s35, 58835169
s_mul_i32 s42, s41, 73
s_sub_u32 s42, s35, s42
s_mul_i32 s43, s41, 1373568
s_mul_i32 s51, s42, 2688
s_add_u32 s50, s43, s51
s_add_u32 s35, s35, 32
s_min_u32 s41, s41, 1
s_sub_u32 s41, 1, s41
s_lshl_b32 s41, s41, 30
s_add_u32 s52, s50, s41
s_min_u32 s43, s42, 1
s_lshl_b32 s43, s43, 27
s_sub_u32 s43, 536870911, s43
s_add_u32 s51, s42, 56
s_and_b32 s51, s51, 128
s_lshl_b32 s51, s51, 22
s_or_b32 s44, s43, s51
s_mov_b32 s37, s50
v_and_b32 v216, s44, v208
s_add_u32 m0, s45, 0
s_nop 0
buffer_load_dwordx4 v216, s[4:7], s52 offen nt lds
s_add_u32 m0, s45, 4112
s_add_u32 s40, s37, 196224
buffer_load_dwordx4 v216, s[4:7], s40 offen nt lds
s_add_u32 m0, s45, 8224
s_add_u32 s40, s37, 392448
buffer_load_dwordx4 v216, s[4:7], s40 offen nt lds
s_add_u32 m0, s45, 12336
s_add_u32 s40, s37, 588672
buffer_load_dwordx4 v216, s[4:7], s40 offen nt lds
s_add_u32 m0, s45, 16448
s_add_u32 s40, s37, 784896
buffer_load_dwordx4 v216, s[4:7], s40 offen nt lds
s_add_u32 m0, s45, 20560
s_add_u32 s40, s37, 981120
buffer_load_dwordx4 v216, s[4:7], s40 offen nt lds
s_add_u32 m0, s45, 24672
s_add_u32 s40, s37, 1177344
buffer_load_dwordx4 v216, s[4:7], s40 offen nt lds
s_add_u32 m0, s45, 28784
s_add_u32 s40, s37, 1373568
buffer_load_dwordx4 v216, s[4:7], s40 offen nt lds
s_add_u32 m0, s45, 32896
s_add_u32 s40, s37, 1569792
buffer_load_dwordx4 v216, s[4:7], s40 offen nt lds
ds_read_b128 v[182:185], v210 offset:20480
ds_read_b128 v[186:189], v210 offset:21504
s_waitcnt lgkmcnt(1)
v_mfma_f32_16x16x32_bf16 v[138:141], a[0:3], v[182:185], 0
s_waitcnt lgkmcnt(0)
v_mfma_f32_16x16x32_bf16 v[138:141], a[4:7], v[186:189], v[138:141]
v_mfma_f32_16x16x32_bf16 v[142:145], a[24:27], v[182:185], 0
v_mfma_f32_16x16x32_bf16 v[142:145], a[28:31], v[186:189], v[142:145]
v_mfma_f32_16x16x32_bf16 v[146:149], a[48:51], v[182:185], 0
v_mfma_f32_16x16x32_bf16 v[146:149], a[52:55], v[186:189], v[146:149]
v_mfma_f32_16x16x32_bf16 v[150:153], a[216:219], v[182:185], 0
v_mfma_f32_16x16x32_bf16 v[150:153], a[220:223], v[186:189], v[150:153]
v_mfma_f32_16x16x32_bf16 v[154:157], a[240:243], v[182:185], 0
v_mfma_f32_16x16x32_bf16 v[154:157], a[244:247], v[186:189], v[154:157]
v_mfma_f32_16x16x32_bf16 v[158:161], v[232:235], v[182:185], 0
v_mfma_f32_16x16x32_bf16 v[158:161], v[236:239], v[186:189], v[158:161]
v_mfma_f32_16x16x32_bf16 v[162:165], v[182:185], a[72:75], 0
v_mfma_f32_16x16x32_bf16 v[162:165], v[186:189], a[76:79], v[162:165]
v_mfma_f32_16x16x32_bf16 v[166:169], v[182:185], a[96:99], 0
v_mfma_f32_16x16x32_bf16 v[166:169], v[186:189], a[100:103], v[166:169]
v_mfma_f32_16x16x32_bf16 v[170:173], v[182:185], a[120:123], 0
v_mfma_f32_16x16x32_bf16 v[170:173], v[186:189], a[124:127], v[170:173]
ds_read_b128 v[110:113], v210 offset:22528
ds_read_b128 v[220:223], v210 offset:23552
s_waitcnt lgkmcnt(1)
v_mfma_f32_16x16x32_bf16 v[138:141], a[8:11], v[110:113], v[138:141]
s_waitcnt lgkmcnt(0)
v_mfma_f32_16x16x32_bf16 v[138:141], a[12:15], v[220:223], v[138:141]
v_mfma_f32_16x16x32_bf16 v[142:145], a[32:35], v[110:113], v[142:145]
v_mfma_f32_16x16x32_bf16 v[142:145], a[36:39], v[220:223], v[142:145]
v_mfma_f32_16x16x32_bf16 v[146:149], a[56:59], v[110:113], v[146:149]
v_mfma_f32_16x16x32_bf16 v[146:149], a[60:63], v[220:223], v[146:149]
v_mfma_f32_16x16x32_bf16 v[150:153], a[224:227], v[110:113], v[150:153]
v_mfma_f32_16x16x32_bf16 v[150:153], a[228:231], v[220:223], v[150:153]
v_mfma_f32_16x16x32_bf16 v[154:157], a[248:251], v[110:113], v[154:157]
v_mfma_f32_16x16x32_bf16 v[154:157], a[252:255], v[220:223], v[154:157]
v_mfma_f32_16x16x32_bf16 v[158:161], v[240:243], v[110:113], v[158:161]
v_mfma_f32_16x16x32_bf16 v[158:161], v[244:247], v[220:223], v[158:161]
v_mfma_f32_16x16x32_bf16 v[162:165], v[110:113], a[80:83], v[162:165]
v_mfma_f32_16x16x32_bf16 v[162:165], v[220:223], a[84:87], v[162:165]
v_mfma_f32_16x16x32_bf16 v[166:169], v[110:113], a[104:107], v[166:169]
v_mfma_f32_16x16x32_bf16 v[166:169], v[220:223], a[108:111], v[166:169]
v_mfma_f32_16x16x32_bf16 v[170:173], v[110:113], a[128:131], v[170:173]
v_mfma_f32_16x16x32_bf16 v[170:173], v[220:223], a[132:135], v[170:173]
ds_read_b128 v[182:185], v210 offset:24576
ds_read_b128 v[186:189], v210 offset:25600
s_waitcnt lgkmcnt(1)
v_mfma_f32_16x16x32_bf16 v[138:141], a[16:19], v[182:185], v[138:141]
s_waitcnt lgkmcnt(0)
v_mfma_f32_16x16x32_bf16 v[138:141], a[20:23], v[186:189], v[138:141]
v_mfma_f32_16x16x32_bf16 v[142:145], a[40:43], v[182:185], v[142:145]
v_mfma_f32_16x16x32_bf16 v[142:145], a[44:47], v[186:189], v[142:145]
v_mfma_f32_16x16x32_bf16 v[146:149], a[64:67], v[182:185], v[146:149]
v_mfma_f32_16x16x32_bf16 v[146:149], a[68:71], v[186:189], v[146:149]
v_mfma_f32_16x16x32_bf16 v[150:153], a[232:235], v[182:185], v[150:153]
v_mfma_f32_16x16x32_bf16 v[150:153], a[236:239], v[186:189], v[150:153]
v_mfma_f32_16x16x32_bf16 v[154:157], v[224:227], v[182:185], v[154:157]
v_mfma_f32_16x16x32_bf16 v[154:157], v[228:231], v[186:189], v[154:157]
v_mfma_f32_16x16x32_bf16 v[158:161], v[248:251], v[182:185], v[158:161]
v_mfma_f32_16x16x32_bf16 v[158:161], v[252:255], v[186:189], v[158:161]
v_mfma_f32_16x16x32_bf16 v[162:165], v[182:185], a[88:91], v[162:165]
v_mfma_f32_16x16x32_bf16 v[162:165], v[186:189], a[92:95], v[162:165]
v_mfma_f32_16x16x32_bf16 v[166:169], v[182:185], a[112:115], v[166:169]
v_mfma_f32_16x16x32_bf16 v[166:169], v[186:189], a[116:119], v[166:169]
v_mfma_f32_16x16x32_bf16 v[170:173], v[182:185], a[136:139], v[170:173]
v_mfma_f32_16x16x32_bf16 v[170:173], v[186:189], a[140:143], v[170:173]
v_cvt_pk_bf16_f32 v78, v138, v139
v_cvt_pk_bf16_f32 v79, v140, v141
v_cvt_pk_bf16_f32 v80, v142, v143
v_cvt_pk_bf16_f32 v81, v144, v145
v_cvt_pk_bf16_f32 v82, v146, v147
v_cvt_pk_bf16_f32 v83, v148, v149
v_cvt_pk_bf16_f32 v72, v150, v151
v_cvt_pk_bf16_f32 v73, v152, v153
v_cvt_pk_bf16_f32 v74, v154, v155
v_cvt_pk_bf16_f32 v75, v156, v157
v_cvt_pk_bf16_f32 v76, v158, v159
v_cvt_pk_bf16_f32 v77, v160, v161
v_cvt_pk_bf16_f32 v114, v162, v163
v_cvt_pk_bf16_f32 v115, v164, v165
v_cvt_pk_bf16_f32 v122, v166, v167
v_cvt_pk_bf16_f32 v123, v168, v169
v_cvt_pk_bf16_f32 v130, v170, v171
v_cvt_pk_bf16_f32 v131, v172, v173
ds_read_b128 v[110:113], v210 offset:26624
ds_read_b128 v[220:223], v210 offset:27648
s_waitcnt lgkmcnt(1)
v_mfma_f32_16x16x32_bf16 v[138:141], a[0:3], v[110:113], 0
s_waitcnt lgkmcnt(0)
v_mfma_f32_16x16x32_bf16 v[138:141], a[4:7], v[220:223], v[138:141]
v_mfma_f32_16x16x32_bf16 v[142:145], a[24:27], v[110:113], 0
v_mfma_f32_16x16x32_bf16 v[142:145], a[28:31], v[220:223], v[142:145]
v_mfma_f32_16x16x32_bf16 v[146:149], a[48:51], v[110:113], 0
v_mfma_f32_16x16x32_bf16 v[146:149], a[52:55], v[220:223], v[146:149]
v_mfma_f32_16x16x32_bf16 v[150:153], a[216:219], v[110:113], 0
v_mfma_f32_16x16x32_bf16 v[150:153], a[220:223], v[220:223], v[150:153]
v_mfma_f32_16x16x32_bf16 v[154:157], a[240:243], v[110:113], 0
v_mfma_f32_16x16x32_bf16 v[154:157], a[244:247], v[220:223], v[154:157]
v_mfma_f32_16x16x32_bf16 v[158:161], v[232:235], v[110:113], 0
v_mfma_f32_16x16x32_bf16 v[158:161], v[236:239], v[220:223], v[158:161]
v_mfma_f32_16x16x32_bf16 v[162:165], v[110:113], a[72:75], 0
v_mfma_f32_16x16x32_bf16 v[162:165], v[220:223], a[76:79], v[162:165]
v_mfma_f32_16x16x32_bf16 v[166:169], v[110:113], a[96:99], 0
v_mfma_f32_16x16x32_bf16 v[166:169], v[220:223], a[100:103], v[166:169]
v_mfma_f32_16x16x32_bf16 v[170:173], v[110:113], a[120:123], 0
v_mfma_f32_16x16x32_bf16 v[170:173], v[220:223], a[124:127], v[170:173]
ds_read_b128 v[102:105], v210 offset:18432
ds_read_b128 v[106:109], v210 offset:19456
s_waitcnt lgkmcnt(1)
v_add_f32 v102, v102, v103
s_waitcnt lgkmcnt(0)
v_add_f32 v106, v106, v107
v_add_f32 v104, v104, v105
v_add_f32 v108, v108, v109
v_add_f32 v102, v102, v104
v_add_f32 v106, v106, v108
v_mul_f32 v103, s48, v102
v_mul_f32 v104, s73, v102
v_mul_f32 v106, s73, v106
v_fma_f32 v106, -v103, v104, v106
v_max_f32 v106, 0, v106
v_add_f32 v106, s49, v106
v_rsq_f32 v102, v106
s_nop 0
v_mul_f32_e64 v103, -v103, v102
ds_write_b64 v211, v[102:103]
ds_read_b64 v[118:119], v219
ds_read_b64 v[126:127], v219 offset:256
ds_read_b64 v[134:135], v219 offset:512
s_waitcnt lgkmcnt(2)
v_fma_f32 v220, v0, v118, v119
v_fma_f32 v221, v1, v118, v119
v_cvt_pk_bf16_f32 v174, v220, v221
v_fma_f32 v222, v2, v118, v119
v_fma_f32 v223, v3, v118, v119
v_cvt_pk_bf16_f32 v175, v222, v223
v_fma_f32 v220, v4, v118, v119
v_fma_f32 v221, v5, v118, v119
v_cvt_pk_bf16_f32 v176, v220, v221
v_fma_f32 v222, v6, v118, v119
v_fma_f32 v223, v7, v118, v119
v_cvt_pk_bf16_f32 v177, v222, v223
ds_write_b128 v211, v[174:177]
v_fma_f32 v220, v8, v118, v119
v_fma_f32 v221, v9, v118, v119
v_cvt_pk_bf16_f32 v178, v220, v221
v_fma_f32 v222, v10, v118, v119
v_fma_f32 v223, v11, v118, v119
v_cvt_pk_bf16_f32 v179, v222, v223
s_waitcnt lgkmcnt(2)
ds_write_b64 v212, v[178:179]
v_fma_f32 v220, v12, v126, v127
v_fma_f32 v221, v13, v126, v127
v_cvt_pk_bf16_f32 v90, v220, v221
v_fma_f32 v222, v14, v126, v127
v_fma_f32 v223, v15, v126, v127
v_cvt_pk_bf16_f32 v91, v222, v223
v_fma_f32 v220, v16, v126, v127
v_fma_f32 v221, v17, v126, v127
v_cvt_pk_bf16_f32 v92, v220, v221
v_fma_f32 v222, v18, v126, v127
v_fma_f32 v223, v19, v126, v127
v_cvt_pk_bf16_f32 v93, v222, v223
ds_write_b128 v211, v[90:93] offset:6144
v_fma_f32 v220, v20, v126, v127
v_fma_f32 v221, v21, v126, v127
v_cvt_pk_bf16_f32 v94, v220, v221
v_fma_f32 v222, v22, v126, v127
v_fma_f32 v223, v23, v126, v127
v_cvt_pk_bf16_f32 v95, v222, v223
s_waitcnt lgkmcnt(3)
ds_write_b64 v212, v[94:95] offset:6144
v_fma_f32 v220, v24, v134, v135
v_fma_f32 v221, v25, v134, v135
v_cvt_pk_bf16_f32 v90, v220, v221
v_fma_f32 v222, v26, v134, v135
v_fma_f32 v223, v27, v134, v135
v_cvt_pk_bf16_f32 v91, v222, v223
v_fma_f32 v220, v28, v134, v135
v_fma_f32 v221, v29, v134, v135
v_cvt_pk_bf16_f32 v92, v220, v221
v_fma_f32 v222, v30, v134, v135
v_fma_f32 v223, v31, v134, v135
v_cvt_pk_bf16_f32 v93, v222, v223
ds_write_b128 v211, v[90:93] offset:12288
v_fma_f32 v220, v32, v134, v135
v_fma_f32 v221, v33, v134, v135
v_cvt_pk_bf16_f32 v94, v220, v221
v_fma_f32 v222, v34, v134, v135
v_fma_f32 v223, v35, v134, v135
v_cvt_pk_bf16_f32 v95, v222, v223
ds_write_b64 v212, v[94:95] offset:12288
ds_read_b128 v[182:185], v210 offset:28672
ds_read_b128 v[186:189], v210 offset:29696
s_waitcnt lgkmcnt(1)
v_mfma_f32_16x16x32_bf16 v[138:141], a[8:11], v[182:185], v[138:141]
s_waitcnt lgkmcnt(0)
v_mfma_f32_16x16x32_bf16 v[138:141], a[12:15], v[186:189], v[138:141]
v_mfma_f32_16x16x32_bf16 v[142:145], a[32:35], v[182:185], v[142:145]
v_mfma_f32_16x16x32_bf16 v[142:145], a[36:39], v[186:189], v[142:145]
v_mfma_f32_16x16x32_bf16 v[146:149], a[56:59], v[182:185], v[146:149]
v_mfma_f32_16x16x32_bf16 v[146:149], a[60:63], v[186:189], v[146:149]
v_mfma_f32_16x16x32_bf16 v[150:153], a[224:227], v[182:185], v[150:153]
v_mfma_f32_16x16x32_bf16 v[150:153], a[228:231], v[186:189], v[150:153]
v_mfma_f32_16x16x32_bf16 v[154:157], a[248:251], v[182:185], v[154:157]
v_mfma_f32_16x16x32_bf16 v[154:157], a[252:255], v[186:189], v[154:157]
v_mfma_f32_16x16x32_bf16 v[158:161], v[240:243], v[182:185], v[158:161]
v_mfma_f32_16x16x32_bf16 v[158:161], v[244:247], v[186:189], v[158:161]
v_mfma_f32_16x16x32_bf16 v[162:165], v[182:185], a[80:83], v[162:165]
v_mfma_f32_16x16x32_bf16 v[162:165], v[186:189], a[84:87], v[162:165]
v_mfma_f32_16x16x32_bf16 v[166:169], v[182:185], a[104:107], v[166:169]
v_mfma_f32_16x16x32_bf16 v[166:169], v[186:189], a[108:111], v[166:169]
v_mfma_f32_16x16x32_bf16 v[170:173], v[182:185], a[128:131], v[170:173]
v_mfma_f32_16x16x32_bf16 v[170:173], v[186:189], a[132:135], v[170:173]
ds_read_b128 v[110:113], v210 offset:30720
ds_read_b128 v[106:109], v210 offset:31744
s_waitcnt lgkmcnt(1)
v_mfma_f32_16x16x32_bf16 v[138:141], a[16:19], v[110:113], v[138:141]
s_waitcnt lgkmcnt(0)
v_mfma_f32_16x16x32_bf16 v[138:141], a[20:23], v[106:109], v[138:141]
v_mfma_f32_16x16x32_bf16 v[142:145], a[40:43], v[110:113], v[142:145]
v_mfma_f32_16x16x32_bf16 v[142:145], a[44:47], v[106:109], v[142:145]
v_mfma_f32_16x16x32_bf16 v[146:149], a[64:67], v[110:113], v[146:149]
v_mfma_f32_16x16x32_bf16 v[146:149], a[68:71], v[106:109], v[146:149]
v_mfma_f32_16x16x32_bf16 v[150:153], a[232:235], v[110:113], v[150:153]
v_mfma_f32_16x16x32_bf16 v[150:153], a[236:239], v[106:109], v[150:153]
v_mfma_f32_16x16x32_bf16 v[154:157], v[224:227], v[110:113], v[154:157]
v_mfma_f32_16x16x32_bf16 v[154:157], v[228:231], v[106:109], v[154:157]
v_mfma_f32_16x16x32_bf16 v[158:161], v[248:251], v[110:113], v[158:161]
v_mfma_f32_16x16x32_bf16 v[158:161], v[252:255], v[106:109], v[158:161]
v_mfma_f32_16x16x32_bf16 v[162:165], v[110:113], a[88:91], v[162:165]
v_mfma_f32_16x16x32_bf16 v[162:165], v[106:109], a[92:95], v[162:165]
v_mfma_f32_16x16x32_bf16 v[166:169], v[110:113], a[112:115], v[166:169]
v_mfma_f32_16x16x32_bf16 v[166:169], v[106:109], a[116:119], v[166:169]
v_mfma_f32_16x16x32_bf16 v[170:173], v[110:113], a[136:139], v[170:173]
v_mfma_f32_16x16x32_bf16 v[170:173], v[106:109], a[140:143], v[170:173]
v_cvt_pk_bf16_f32 v96, v138, v139
v_cvt_pk_bf16_f32 v97, v140, v141
v_cvt_pk_bf16_f32 v98, v142, v143
v_cvt_pk_bf16_f32 v99, v144, v145
v_cvt_pk_bf16_f32 v100, v146, v147
v_cvt_pk_bf16_f32 v101, v148, v149
v_cvt_pk_bf16_f32 v84, v150, v151
v_cvt_pk_bf16_f32 v85, v152, v153
v_cvt_pk_bf16_f32 v86, v154, v155
v_cvt_pk_bf16_f32 v87, v156, v157
v_cvt_pk_bf16_f32 v88, v158, v159
v_cvt_pk_bf16_f32 v89, v160, v161
v_cvt_pk_bf16_f32 v116, v162, v163
v_cvt_pk_bf16_f32 v117, v164, v165
v_cvt_pk_bf16_f32 v124, v166, v167
v_cvt_pk_bf16_f32 v125, v168, v169
v_cvt_pk_bf16_f32 v132, v170, v171
v_cvt_pk_bf16_f32 v133, v172, v173
ds_read_b128 v[182:185], v210 offset:32768
ds_read_b128 v[186:189], v210 offset:33792
s_waitcnt lgkmcnt(1)
v_mfma_f32_16x16x32_bf16 v[138:141], a[0:3], v[182:185], 0
s_waitcnt lgkmcnt(0)
v_mfma_f32_16x16x32_bf16 v[138:141], a[4:7], v[186:189], v[138:141]
v_mfma_f32_16x16x32_bf16 v[142:145], a[24:27], v[182:185], 0
v_mfma_f32_16x16x32_bf16 v[142:145], a[28:31], v[186:189], v[142:145]
v_mfma_f32_16x16x32_bf16 v[146:149], a[48:51], v[182:185], 0
v_mfma_f32_16x16x32_bf16 v[146:149], a[52:55], v[186:189], v[146:149]
ds_read_b128 v[174:177], v210 offset:34816
ds_read_b128 v[178:181], v210 offset:35840
s_waitcnt lgkmcnt(1)
v_mfma_f32_16x16x32_bf16 v[138:141], a[8:11], v[174:177], v[138:141]
s_waitcnt lgkmcnt(0)
v_mfma_f32_16x16x32_bf16 v[138:141], a[12:15], v[178:181], v[138:141]
v_mfma_f32_16x16x32_bf16 v[142:145], a[32:35], v[174:177], v[142:145]
v_mfma_f32_16x16x32_bf16 v[142:145], a[36:39], v[178:181], v[142:145]
v_mfma_f32_16x16x32_bf16 v[146:149], a[56:59], v[174:177], v[146:149]
v_mfma_f32_16x16x32_bf16 v[146:149], a[60:63], v[178:181], v[146:149]
ds_read_b128 v[182:185], v210 offset:36864
ds_read_b128 v[186:189], v210 offset:37888
s_waitcnt lgkmcnt(1)
v_mfma_f32_16x16x32_bf16 v[138:141], a[16:19], v[182:185], v[138:141]
s_waitcnt lgkmcnt(0)
v_mfma_f32_16x16x32_bf16 v[138:141], a[20:23], v[186:189], v[138:141]
v_mfma_f32_16x16x32_bf16 v[142:145], a[40:43], v[182:185], v[142:145]
v_mfma_f32_16x16x32_bf16 v[142:145], a[44:47], v[186:189], v[142:145]
v_mfma_f32_16x16x32_bf16 v[146:149], a[64:67], v[182:185], v[146:149]
v_mfma_f32_16x16x32_bf16 v[146:149], a[68:71], v[186:189], v[146:149]
v_cvt_pk_bf16_f32 v102, v138, v139
v_cvt_pk_bf16_f32 v103, v140, v141
v_cvt_pk_bf16_f32 v104, v142, v143
v_cvt_pk_bf16_f32 v105, v144, v145
s_nop 2
v_cvt_pk_bf16_f32 v106, v146, v147
v_cvt_pk_bf16_f32 v107, v148, v149
ds_read_b128 v[108:111], v215 offset:512
ds_read_b64 v[112:113], v215 offset:528
v_mfma_f32_16x16x16_bf16 v[138:141], v[82:83], v[76:77], 0
v_mfma_f32_16x16x16_bf16 v[142:145], v[100:101], v[76:77], 0
s_waitcnt lgkmcnt(0)
v_mfma_f32_16x16x16_bf16 v[150:153], v[112:113], v[76:77], v[206:209]
v_mfma_f32_16x16x16_bf16 v[146:149], v[106:107], v[76:77], 0
v_mfma_f32_16x16x32_bf16 v[138:141], v[78:81], v[72:75], v[138:141]
v_mfma_f32_16x16x32_bf16 v[142:145], v[96:99], v[72:75], v[142:145]
v_mfma_f32_16x16x32_bf16 v[150:153], v[108:111], v[72:75], v[150:153]
v_mfma_f32_16x16x32_bf16 v[146:149], v[102:105], v[72:75], v[146:149]
ds_read_b128 v[72:75], v215
ds_read_b64 v[76:77], v215 offset:16
v_mfma_f32_16x16x16_bf16 v[154:157], v[82:83], v[88:89], 0
v_mfma_f32_16x16x16_bf16 v[158:161], v[100:101], v[88:89], 0
v_mfma_f32_16x16x16_bf16 v[166:169], v[112:113], v[88:89], v[206:209]
v_mfma_f32_16x16x16_bf16 v[162:165], v[106:107], v[88:89], 0
v_mfma_f32_16x16x32_bf16 v[154:157], v[78:81], v[84:87], v[154:157]
v_mfma_f32_16x16x32_bf16 v[158:161], v[96:99], v[84:87], v[158:161]
v_mfma_f32_16x16x32_bf16 v[166:169], v[108:111], v[84:87], v[166:169]
v_mfma_f32_16x16x32_bf16 v[162:165], v[102:105], v[84:87], v[162:165]
v_mfma_f32_16x16x32_bf16 v[118:121], v[182:185], a[88:91], 0
v_mfma_f32_16x16x32_bf16 v[118:121], v[186:189], a[92:95], v[118:121]
v_mfma_f32_16x16x32_bf16 v[126:129], v[182:185], a[112:115], 0
v_mfma_f32_16x16x32_bf16 v[126:129], v[186:189], a[116:119], v[126:129]
v_mfma_f32_16x16x32_bf16 v[134:137], v[182:185], a[136:139], 0
v_mfma_f32_16x16x32_bf16 v[134:137], v[186:189], a[140:143], v[134:137]
v_mfma_f32_16x16x32_bf16 v[90:93], a[232:235], v[182:185], 0
v_mfma_f32_16x16x32_bf16 v[90:93], a[236:239], v[186:189], v[90:93]
v_mfma_f32_16x16x32_bf16 v[170:173], v[224:227], v[182:185], 0
v_mfma_f32_16x16x32_bf16 v[170:173], v[228:231], v[186:189], v[170:173]
v_mfma_f32_16x16x32_bf16 v[220:223], v[248:251], v[182:185], 0
v_mfma_f32_16x16x32_bf16 v[220:223], v[252:255], v[186:189], v[220:223]
v_mfma_f32_16x16x32_bf16 v[118:121], v[174:177], a[80:83], v[118:121]
v_mfma_f32_16x16x32_bf16 v[118:121], v[178:181], a[84:87], v[118:121]
v_mfma_f32_16x16x32_bf16 v[126:129], v[174:177], a[104:107], v[126:129]
v_mfma_f32_16x16x32_bf16 v[126:129], v[178:181], a[108:111], v[126:129]
v_mfma_f32_16x16x32_bf16 v[134:137], v[174:177], a[128:131], v[134:137]
v_mfma_f32_16x16x32_bf16 v[134:137], v[178:181], a[132:135], v[134:137]
v_mfma_f32_16x16x32_bf16 v[90:93], a[224:227], v[174:177], v[90:93]
v_mfma_f32_16x16x32_bf16 v[90:93], a[228:231], v[178:181], v[90:93]
v_mfma_f32_16x16x32_bf16 v[170:173], a[248:251], v[174:177], v[170:173]
v_mfma_f32_16x16x32_bf16 v[170:173], a[252:255], v[178:181], v[170:173]
v_mfma_f32_16x16x32_bf16 v[220:223], v[240:243], v[174:177], v[220:223]
v_mfma_f32_16x16x32_bf16 v[220:223], v[244:247], v[178:181], v[220:223]
ds_read_b128 v[182:185], v210 offset:32768
ds_read_b128 v[186:189], v210 offset:33792
s_waitcnt lgkmcnt(1)
v_mfma_f32_16x16x32_bf16 v[118:121], v[182:185], a[72:75], v[118:121]
s_waitcnt lgkmcnt(0)
v_mfma_f32_16x16x32_bf16 v[118:121], v[186:189], a[76:79], v[118:121]
v_mfma_f32_16x16x32_bf16 v[126:129], v[182:185], a[96:99], v[126:129]
v_mfma_f32_16x16x32_bf16 v[126:129], v[186:189], a[100:103], v[126:129]
v_mfma_f32_16x16x32_bf16 v[134:137], v[182:185], a[120:123], v[134:137]
v_mfma_f32_16x16x32_bf16 v[134:137], v[186:189], a[124:127], v[134:137]
v_mfma_f32_16x16x32_bf16 v[90:93], a[216:219], v[182:185], v[90:93]
v_mfma_f32_16x16x32_bf16 v[90:93], a[220:223], v[186:189], v[90:93]
v_mfma_f32_16x16x32_bf16 v[170:173], a[240:243], v[182:185], v[170:173]
v_mfma_f32_16x16x32_bf16 v[170:173], a[244:247], v[186:189], v[170:173]
v_mfma_f32_16x16x32_bf16 v[220:223], v[232:235], v[182:185], v[220:223]
v_mfma_f32_16x16x32_bf16 v[220:223], v[236:239], v[186:189], v[220:223]
v_mov_b32 v181, 0
v_cvt_pk_bf16_f32 v118, v118, v119
v_cvt_pk_bf16_f32 v119, v120, v121
ds_read_u16 v120, v205
v_mov_b32 v121, 0
v_cvt_pk_bf16_f32 v126, v126, v127
v_cvt_pk_bf16_f32 v127, v128, v129
ds_read_u16 v128, v205 offset:32
v_mov_b32 v129, 0
v_cvt_pk_bf16_f32 v134, v134, v135
v_cvt_pk_bf16_f32 v135, v136, v137
ds_read_u16 v136, v205 offset:64
v_mov_b32 v137, 0
v_add_u32 v205, 1424, v205
v_cvt_pk_bf16_f32 v90, v90, v91
v_cvt_pk_bf16_f32 v91, v92, v93
v_cvt_pk_bf16_f32 v92, v170, v171
v_cvt_pk_bf16_f32 v93, v172, v173
v_cvt_pk_bf16_f32 v94, v220, v221
v_cvt_pk_bf16_f32 v95, v222, v223
v_max3_f32 v151, v138, v139, v140
v_max3_f32 v151, v151, v141, v142
v_max3_f32 v151, v151, v143, v144
v_max3_f32 v151, v151, v145, v146
v_max3_f32 v151, v151, v147, v148
v_max3_f32 v151, v151, v149, v150
v_mov_b32 v152, v151
s_nop 1
v_permlane16_swap_b32 v151, v152
v_max_f32 v151, v151, v152
v_mov_b32 v152, v151
s_nop 1
v_permlane32_swap_b32 v151, v152
v_max_f32 v151, v151, v152
v_sub_f32 v138, v138, v151
v_sub_f32 v139, v139, v151
v_sub_f32 v140, v140, v151
v_sub_f32 v141, v141, v151
v_sub_f32 v142, v142, v151
v_sub_f32 v143, v143, v151
v_sub_f32 v144, v144, v151
v_sub_f32 v145, v145, v151
v_sub_f32 v150, v150, v151
v_sub_f32 v146, v146, v151
v_sub_f32 v147, v147, v151
v_sub_f32 v148, v148, v151
v_sub_f32 v149, v149, v151
v_exp_f32 v138, v138
v_exp_f32 v139, v139
v_exp_f32 v140, v140
v_exp_f32 v141, v141
v_exp_f32 v142, v142
v_exp_f32 v143, v143
v_exp_f32 v144, v144
v_exp_f32 v145, v145
v_exp_f32 v150, v150
v_exp_f32 v146, v146
v_exp_f32 v147, v147
v_exp_f32 v148, v148
v_exp_f32 v149, v149
v_cvt_pk_bf16_f32 v174, v138, v139
v_cvt_pk_bf16_f32 v175, v140, v141
v_cvt_pk_bf16_f32 v176, v142, v143
v_cvt_pk_bf16_f32 v177, v144, v145
v_cvt_pk_bf16_f32 v178, v146, v147
v_cvt_pk_bf16_f32 v179, v148, v149
v_cvt_pk_bf16_f32 v180, v150, 0
v_mfma_f32_16x16x32_bf16 v[150:153], v[190:193], v[174:177], 0
v_mfma_f32_16x16x32_bf16 v[150:153], v[190:193], v[178:181], v[150:153]
v_mfma_f32_16x16x32_bf16 v[138:141], v[114:117], v[174:177], 0
s_waitcnt lgkmcnt(2)
v_mfma_f32_16x16x32_bf16 v[138:141], v[118:121], v[178:181], v[138:141]
v_mfma_f32_16x16x32_bf16 v[142:145], v[122:125], v[174:177], 0
s_waitcnt lgkmcnt(1)
v_mfma_f32_16x16x32_bf16 v[142:145], v[126:129], v[178:181], v[142:145]
v_mfma_f32_16x16x32_bf16 v[146:149], v[130:133], v[174:177], 0
s_waitcnt lgkmcnt(0)
v_mfma_f32_16x16x32_bf16 v[146:149], v[134:137], v[178:181], v[146:149]
v_max3_f32 v167, v154, v155, v156
v_max3_f32 v167, v167, v157, v158
v_max3_f32 v167, v167, v159, v160
v_max3_f32 v167, v167, v161, v162
v_max3_f32 v167, v167, v163, v164
v_max3_f32 v167, v167, v165, v166
v_mov_b32 v168, v167
s_nop 1
v_permlane16_swap_b32 v167, v168
v_max_f32 v167, v167, v168
v_mov_b32 v168, v167
s_nop 1
v_permlane32_swap_b32 v167, v168
v_max_f32 v167, v167, v168
v_sub_f32 v154, v154, v167
v_sub_f32 v155, v155, v167
v_sub_f32 v156, v156, v167
v_sub_f32 v157, v157, v167
v_sub_f32 v158, v158, v167
v_sub_f32 v159, v159, v167
v_sub_f32 v160, v160, v167
v_sub_f32 v161, v161, v167
v_sub_f32 v166, v166, v167
v_sub_f32 v162, v162, v167
v_sub_f32 v163, v163, v167
v_sub_f32 v164, v164, v167
v_sub_f32 v165, v165, v167
v_exp_f32 v154, v154
v_exp_f32 v155, v155
v_exp_f32 v156, v156
v_exp_f32 v157, v157
v_exp_f32 v158, v158
v_exp_f32 v159, v159
v_exp_f32 v160, v160
v_exp_f32 v161, v161
v_exp_f32 v166, v166
v_exp_f32 v162, v162
v_exp_f32 v163, v163
v_exp_f32 v164, v164
v_exp_f32 v165, v165
v_cvt_pk_bf16_f32 v174, v154, v155
v_cvt_pk_bf16_f32 v175, v156, v157
v_cvt_pk_bf16_f32 v176, v158, v159
v_cvt_pk_bf16_f32 v177, v160, v161
v_cvt_pk_bf16_f32 v178, v162, v163
v_cvt_pk_bf16_f32 v179, v164, v165
v_cvt_pk_bf16_f32 v180, v166, 0
v_mfma_f32_16x16x32_bf16 v[166:169], v[190:193], v[174:177], 0
v_mfma_f32_16x16x32_bf16 v[166:169], v[190:193], v[178:181], v[166:169]
v_mfma_f32_16x16x32_bf16 v[154:157], v[114:117], v[174:177], 0
v_mfma_f32_16x16x32_bf16 v[154:157], v[118:121], v[178:181], v[154:157]
v_mfma_f32_16x16x32_bf16 v[158:161], v[122:125], v[174:177], 0
v_mfma_f32_16x16x32_bf16 v[158:161], v[126:129], v[178:181], v[158:161]
v_mfma_f32_16x16x32_bf16 v[162:165], v[130:133], v[174:177], 0
v_mfma_f32_16x16x32_bf16 v[162:165], v[134:137], v[178:181], v[162:165]
v_rcp_f32 v151, v150
s_nop 0
v_mul_f32 v152, s3, v151
v_mul_f32 v138, v138, v152
v_mul_f32 v139, v139, v152
v_cvt_pk_bf16_f32 v138, v138, v139
v_mul_f32 v140, v140, v152
v_mul_f32 v141, v141, v152
v_cvt_pk_bf16_f32 v139, v140, v141
v_mul_f32 v142, v142, v152
v_mul_f32 v143, v143, v152
v_cvt_pk_bf16_f32 v140, v142, v143
v_mul_f32 v144, v144, v152
v_mul_f32 v145, v145, v152
v_cvt_pk_bf16_f32 v141, v144, v145
ds_write_b128 v211, v[138:141] offset:38912
v_mul_f32 v146, v146, v152
v_mul_f32 v147, v147, v152
v_cvt_pk_bf16_f32 v142, v146, v147
v_mul_f32 v148, v148, v152
v_mul_f32 v149, v149, v152
v_cvt_pk_bf16_f32 v143, v148, v149
ds_write_b64 v212, v[142:143] offset:38912
v_mfma_f32_16x16x32_bf16 v[138:141], v[78:81], v[90:93], 0
v_mfma_f32_16x16x32_bf16 v[142:145], v[96:99], v[90:93], 0
v_mfma_f32_16x16x32_bf16 v[150:153], v[108:111], v[90:93], v[206:209]
v_mfma_f32_16x16x32_bf16 v[146:149], v[102:105], v[90:93], 0
v_mfma_f32_16x16x16_bf16 v[138:141], v[82:83], v[94:95], v[138:141]
v_mfma_f32_16x16x16_bf16 v[142:145], v[100:101], v[94:95], v[142:145]
v_mfma_f32_16x16x16_bf16 v[150:153], v[112:113], v[94:95], v[150:153]
v_mfma_f32_16x16x16_bf16 v[146:149], v[106:107], v[94:95], v[146:149]
v_rcp_f32 v167, v166
s_nop 0
v_mul_f32 v168, s3, v167
v_mul_f32 v154, v154, v168
v_mul_f32 v155, v155, v168
v_cvt_pk_bf16_f32 v154, v154, v155
v_mul_f32 v156, v156, v168
v_mul_f32 v157, v157, v168
v_cvt_pk_bf16_f32 v155, v156, v157
v_mul_f32 v158, v158, v168
v_mul_f32 v159, v159, v168
v_cvt_pk_bf16_f32 v156, v158, v159
v_mul_f32 v160, v160, v168
v_mul_f32 v161, v161, v168
v_cvt_pk_bf16_f32 v157, v160, v161
ds_write_b128 v211, v[154:157] offset:45056
v_mul_f32 v162, v162, v168
v_mul_f32 v163, v163, v168
v_cvt_pk_bf16_f32 v158, v162, v163
v_mul_f32 v164, v164, v168
v_mul_f32 v165, v165, v168
v_cvt_pk_bf16_f32 v159, v164, v165
ds_write_b64 v212, v[158:159] offset:45056
v_mfma_f32_16x16x32_bf16 v[154:157], v[72:75], v[78:81], 0
v_mfma_f32_16x16x32_bf16 v[158:161], v[72:75], v[96:99], 0
v_mfma_f32_16x16x32_bf16 v[162:165], v[72:75], v[102:105], 0
v_mfma_f32_16x16x16_bf16 v[154:157], v[76:77], v[82:83], v[154:157]
v_mfma_f32_16x16x16_bf16 v[158:161], v[76:77], v[100:101], v[158:161]
v_mfma_f32_16x16x16_bf16 v[162:165], v[76:77], v[106:107], v[162:165]
ds_read_b32 v166, v215 offset:536
s_nop 2
v_mov_b32_dpp v154, v158 quad_perm:[0,1,2,3] row_mask:0x2 bank_mask:0xf
s_nop 2
v_mov_b32_dpp v154, v162 quad_perm:[0,1,2,3] row_mask:0x4 bank_mask:0xf
s_waitcnt lgkmcnt(0)
s_nop 0
v_add_f32_dpp v154, v166, v207 quad_perm:[0,1,2,3] row_mask:0x8 bank_mask:0xf
v_mov_b32 v155, v154
s_nop 1
v_max_f32_dpp v155, v155, v155 row_ror:8 row_mask:0xf bank_mask:0xf
s_nop 1
v_max_f32_dpp v155, v155, v155 row_ror:4 row_mask:0xf bank_mask:0xf
s_nop 1
v_max_f32_dpp v155, v155, v155 row_ror:2 row_mask:0xf bank_mask:0xf
s_nop 1
v_max_f32_dpp v155, v155, v155 row_ror:1 row_mask:0xf bank_mask:0xf
v_mov_b32 v156, v155
s_nop 1
v_permlane16_swap_b32 v155, v156
v_max_f32 v155, v155, v156
v_mov_b32 v156, v155
s_nop 1
v_permlane32_swap_b32 v155, v156
v_max_f32 v155, v155, v156
v_sub_f32 v154, v154, v155
v_exp_f32 v166, v154
s_nop 0
v_cvt_pk_bf16_f32 v154, v166, 0
ds_write_b16 v214, v154
v_add_f32_dpp v166, v166, v166 row_ror:8 row_mask:0xf bank_mask:0xf
s_nop 1
v_add_f32_dpp v166, v166, v166 row_ror:4 row_mask:0xf bank_mask:0xf
s_nop 1
v_add_f32_dpp v166, v166, v166 row_ror:2 row_mask:0xf bank_mask:0xf
s_nop 1
v_add_f32_dpp v166, v166, v166 row_ror:1 row_mask:0xf bank_mask:0xf
s_nop 1
v_add_f32_dpp v166, v166, v166 row_bcast:15 row_mask:0xa bank_mask:0xf
s_nop 1
v_add_f32_dpp v166, v166, v166 row_bcast:31 row_mask:0xc bank_mask:0xf
s_nop 0
v_readlane_b32 s72, v166, 63
s_nop 1
v_rcp_f32 v167, s72
s_nop 0
v_mul_f32 v168, s3, v167
ds_read_b128 v[84:87], v215
ds_read_b128 v[88:91], v215 offset:16
v_add_u32 v215, 1424, v215
s_barrier
ds_read_b128 v[220:223], v210 offset:38912
ds_read_b128 v[110:113], v210 offset:39936
s_waitcnt lgkmcnt(1)
v_mfma_f32_16x16x32_bf16 v[36:39], a[144:147], v[220:223], v[36:39]
s_waitcnt lgkmcnt(0)
v_mfma_f32_16x16x32_bf16 v[36:39], a[148:151], v[110:113], v[36:39]
v_mfma_f32_16x16x32_bf16 v[40:43], a[168:171], v[220:223], v[40:43]
v_mfma_f32_16x16x32_bf16 v[40:43], a[172:175], v[110:113], v[40:43]
v_mfma_f32_16x16x32_bf16 v[44:47], a[192:195], v[220:223], v[44:47]
v_mfma_f32_16x16x32_bf16 v[44:47], a[196:199], v[110:113], v[44:47]
ds_read_b128 v[170:173], v210 offset:40960
ds_read_b128 v[182:185], v210 offset:41984
s_waitcnt lgkmcnt(1)
v_mfma_f32_16x16x32_bf16 v[36:39], a[152:155], v[170:173], v[36:39]
s_waitcnt lgkmcnt(0)
v_mfma_f32_16x16x32_bf16 v[36:39], a[156:159], v[182:185], v[36:39]
v_mfma_f32_16x16x32_bf16 v[40:43], a[176:179], v[170:173], v[40:43]
v_mfma_f32_16x16x32_bf16 v[40:43], a[180:183], v[182:185], v[40:43]
v_mfma_f32_16x16x32_bf16 v[44:47], a[200:203], v[170:173], v[44:47]
v_mfma_f32_16x16x32_bf16 v[44:47], a[204:207], v[182:185], v[44:47]
ds_read_b128 v[186:189], v210 offset:43008
ds_read_b128 v[220:223], v210 offset:44032
s_waitcnt lgkmcnt(1)
v_mfma_f32_16x16x32_bf16 v[36:39], a[160:163], v[186:189], v[36:39]
s_waitcnt lgkmcnt(0)
v_mfma_f32_16x16x32_bf16 v[36:39], a[164:167], v[220:223], v[36:39]
v_mfma_f32_16x16x32_bf16 v[40:43], a[184:187], v[186:189], v[40:43]
v_mfma_f32_16x16x32_bf16 v[40:43], a[188:191], v[220:223], v[40:43]
v_mfma_f32_16x16x32_bf16 v[44:47], a[208:211], v[186:189], v[44:47]
v_mfma_f32_16x16x32_bf16 v[44:47], a[212:215], v[220:223], v[44:47]
v_cvt_pk_bf16_f32 v36, v36, v37
v_cvt_pk_bf16_f32 v37, v38, v39
ds_write_b64 v203, v[36:37]
v_cvt_pk_bf16_f32 v40, v40, v41
v_cvt_pk_bf16_f32 v41, v42, v43
ds_write_b64 v203, v[40:41] offset:32
v_cvt_pk_bf16_f32 v44, v44, v45
v_cvt_pk_bf16_f32 v45, v46, v47
ds_write_b64 v203, v[44:45] offset:64
v_max3_f32 v151, v138, v139, v140
v_max3_f32 v151, v151, v141, v142
v_max3_f32 v151, v151, v143, v144
v_max3_f32 v151, v151, v145, v146
v_max3_f32 v151, v151, v147, v148
v_max3_f32 v151, v151, v149, v150
v_mov_b32 v152, v151
s_nop 1
v_permlane16_swap_b32 v151, v152
v_max_f32 v151, v151, v152
v_mov_b32 v152, v151
s_nop 1
v_permlane32_swap_b32 v151, v152
v_max_f32 v151, v151, v152
v_sub_f32 v138, v138, v151
v_sub_f32 v139, v139, v151
v_sub_f32 v140, v140, v151
v_sub_f32 v141, v141, v151
v_sub_f32 v142, v142, v151
v_sub_f32 v143, v143, v151
v_sub_f32 v144, v144, v151
v_sub_f32 v145, v145, v151
v_sub_f32 v150, v150, v151
v_sub_f32 v146, v146, v151
v_sub_f32 v147, v147, v151
v_sub_f32 v148, v148, v151
v_sub_f32 v149, v149, v151
v_exp_f32 v138, v138
v_exp_f32 v139, v139
v_exp_f32 v140, v140
v_exp_f32 v141, v141
v_exp_f32 v142, v142
v_exp_f32 v143, v143
v_exp_f32 v144, v144
v_exp_f32 v145, v145
v_exp_f32 v150, v150
v_exp_f32 v146, v146
v_exp_f32 v147, v147
v_exp_f32 v148, v148
v_exp_f32 v149, v149
v_cvt_pk_bf16_f32 v174, v138, v139
v_cvt_pk_bf16_f32 v175, v140, v141
v_cvt_pk_bf16_f32 v176, v142, v143
v_cvt_pk_bf16_f32 v177, v144, v145
v_cvt_pk_bf16_f32 v178, v146, v147
v_cvt_pk_bf16_f32 v179, v148, v149
v_cvt_pk_bf16_f32 v180, v150, 0
v_mfma_f32_16x16x32_bf16 v[150:153], v[190:193], v[174:177], 0
v_mfma_f32_16x16x32_bf16 v[150:153], v[190:193], v[178:181], v[150:153]
v_mfma_f32_16x16x32_bf16 v[138:141], v[114:117], v[174:177], 0
v_mfma_f32_16x16x32_bf16 v[138:141], v[118:121], v[178:181], v[138:141]
v_mfma_f32_16x16x32_bf16 v[142:145], v[122:125], v[174:177], 0
v_mfma_f32_16x16x32_bf16 v[142:145], v[126:129], v[178:181], v[142:145]
v_mfma_f32_16x16x32_bf16 v[146:149], v[130:133], v[174:177], 0
v_mfma_f32_16x16x32_bf16 v[146:149], v[134:137], v[178:181], v[146:149]
v_rcp_f32 v151, v150
s_nop 0
v_mul_f32 v152, s3, v151
v_mul_f32 v138, v138, v152
v_mul_f32 v139, v139, v152
v_cvt_pk_bf16_f32 v138, v138, v139
v_mul_f32 v140, v140, v152
v_mul_f32 v141, v141, v152
v_cvt_pk_bf16_f32 v139, v140, v141
v_mul_f32 v142, v142, v152
v_mul_f32 v143, v143, v152
v_cvt_pk_bf16_f32 v140, v142, v143
v_mul_f32 v144, v144, v152
v_mul_f32 v145, v145, v152
v_cvt_pk_bf16_f32 v141, v144, v145
ds_write_b128 v211, v[138:141] offset:51200
v_mul_f32 v146, v146, v152
v_mul_f32 v147, v147, v152
v_cvt_pk_bf16_f32 v142, v146, v147
v_mul_f32 v148, v148, v152
v_mul_f32 v149, v149, v152
v_cvt_pk_bf16_f32 v143, v148, v149
ds_write_b64 v212, v[142:143] offset:51200
v_mfma_f32_16x16x32_bf16 v[154:157], v[84:87], v[114:117], 0
v_mfma_f32_16x16x32_bf16 v[154:157], v[88:91], v[118:121], v[154:157]
v_mfma_f32_16x16x32_bf16 v[158:161], v[84:87], v[122:125], 0
v_mfma_f32_16x16x32_bf16 v[158:161], v[88:91], v[126:129], v[158:161]
v_mfma_f32_16x16x32_bf16 v[162:165], v[84:87], v[130:133], 0
v_mfma_f32_16x16x32_bf16 v[162:165], v[88:91], v[134:137], v[162:165]
v_mov_b32_dpp v154, v158 quad_perm:[0,1,2,3] row_mask:0x2 bank_mask:0xf
s_nop 5
v_mov_b32_dpp v154, v162 quad_perm:[0,1,2,3] row_mask:0x4 bank_mask:0xf
v_mul_f32 v154, v154, v168
v_cvt_pk_bf16_f32 v154, v154, 0
ds_write_b16 v214, v154
v_add_u32 v214, 1424, v214
ds_read_b128 v[110:113], v210 offset:45056
ds_read_b128 v[170:173], v210 offset:46080
s_waitcnt lgkmcnt(1)
v_mfma_f32_16x16x32_bf16 v[48:51], a[144:147], v[110:113], v[48:51]
s_waitcnt lgkmcnt(0)
v_mfma_f32_16x16x32_bf16 v[48:51], a[148:151], v[170:173], v[48:51]
v_mfma_f32_16x16x32_bf16 v[52:55], a[168:171], v[110:113], v[52:55]
v_mfma_f32_16x16x32_bf16 v[52:55], a[172:175], v[170:173], v[52:55]
v_mfma_f32_16x16x32_bf16 v[56:59], a[192:195], v[110:113], v[56:59]
v_mfma_f32_16x16x32_bf16 v[56:59], a[196:199], v[170:173], v[56:59]
ds_read_b128 v[182:185], v210 offset:47104
ds_read_b128 v[186:189], v210 offset:48128
s_waitcnt lgkmcnt(1)
v_mfma_f32_16x16x32_bf16 v[48:51], a[152:155], v[182:185], v[48:51]
s_waitcnt lgkmcnt(0)
v_mfma_f32_16x16x32_bf16 v[48:51], a[156:159], v[186:189], v[48:51]
v_mfma_f32_16x16x32_bf16 v[52:55], a[176:179], v[182:185], v[52:55]
v_mfma_f32_16x16x32_bf16 v[52:55], a[180:183], v[186:189], v[52:55]
v_mfma_f32_16x16x32_bf16 v[56:59], a[200:203], v[182:185], v[56:59]
v_mfma_f32_16x16x32_bf16 v[56:59], a[204:207], v[186:189], v[56:59]
ds_read_b128 v[220:223], v210 offset:49152
ds_read_b128 v[110:113], v210 offset:50176
s_waitcnt lgkmcnt(1)
v_mfma_f32_16x16x32_bf16 v[48:51], a[160:163], v[220:223], v[48:51]
s_waitcnt lgkmcnt(0)
v_mfma_f32_16x16x32_bf16 v[48:51], a[164:167], v[110:113], v[48:51]
v_mfma_f32_16x16x32_bf16 v[52:55], a[184:187], v[220:223], v[52:55]
v_mfma_f32_16x16x32_bf16 v[52:55], a[188:191], v[110:113], v[52:55]
v_mfma_f32_16x16x32_bf16 v[56:59], a[208:211], v[220:223], v[56:59]
v_mfma_f32_16x16x32_bf16 v[56:59], a[212:215], v[110:113], v[56:59]
v_cvt_pk_bf16_f32 v48, v48, v49
v_cvt_pk_bf16_f32 v49, v50, v51
ds_write_b64 v203, v[48:49] offset:6272
v_cvt_pk_bf16_f32 v52, v52, v53
v_cvt_pk_bf16_f32 v53, v54, v55
ds_write_b64 v203, v[52:53] offset:6304
v_cvt_pk_bf16_f32 v56, v56, v57
v_cvt_pk_bf16_f32 v57, v58, v59
ds_write_b64 v203, v[56:57] offset:6336
s_waitcnt vmcnt(0)
s_barrier
ds_read_b128 v[170:173], v210 offset:51200
ds_read_b128 v[182:185], v210 offset:52224
s_waitcnt lgkmcnt(1)
v_mfma_f32_16x16x32_bf16 v[60:63], a[144:147], v[170:173], v[60:63]
s_waitcnt lgkmcnt(0)
v_mfma_f32_16x16x32_bf16 v[60:63], a[148:151], v[182:185], v[60:63]
v_mfma_f32_16x16x32_bf16 v[64:67], a[168:171], v[170:173], v[64:67]
v_mfma_f32_16x16x32_bf16 v[64:67], a[172:175], v[182:185], v[64:67]
v_mfma_f32_16x16x32_bf16 v[68:71], a[192:195], v[170:173], v[68:71]
v_mfma_f32_16x16x32_bf16 v[68:71], a[196:199], v[182:185], v[68:71]
ds_read_b128 v[186:189], v210 offset:53248
ds_read_b128 v[220:223], v210 offset:54272
s_waitcnt lgkmcnt(1)
v_mfma_f32_16x16x32_bf16 v[60:63], a[152:155], v[186:189], v[60:63]
s_waitcnt lgkmcnt(0)
v_mfma_f32_16x16x32_bf16 v[60:63], a[156:159], v[220:223], v[60:63]
v_mfma_f32_16x16x32_bf16 v[64:67], a[176:179], v[186:189], v[64:67]
v_mfma_f32_16x16x32_bf16 v[64:67], a[180:183], v[220:223], v[64:67]
v_mfma_f32_16x16x32_bf16 v[68:71], a[200:203], v[186:189], v[68:71]
v_mfma_f32_16x16x32_bf16 v[68:71], a[204:207], v[220:223], v[68:71]
ds_read_b128 v[110:113], v210 offset:55296
ds_read_b128 v[170:173], v210 offset:56320
s_waitcnt lgkmcnt(1)
v_mfma_f32_16x16x32_bf16 v[60:63], a[160:163], v[110:113], v[60:63]
s_waitcnt lgkmcnt(0)
v_mfma_f32_16x16x32_bf16 v[60:63], a[164:167], v[170:173], v[60:63]
v_mfma_f32_16x16x32_bf16 v[64:67], a[184:187], v[110:113], v[64:67]
v_mfma_f32_16x16x32_bf16 v[64:67], a[188:191], v[170:173], v[64:67]
v_mfma_f32_16x16x32_bf16 v[68:71], a[208:211], v[110:113], v[68:71]
v_mfma_f32_16x16x32_bf16 v[68:71], a[212:215], v[170:173], v[68:71]
v_cvt_pk_bf16_f32 v60, v60, v61
v_cvt_pk_bf16_f32 v61, v62, v63
ds_write_b64 v203, v[60:61] offset:12544
v_cvt_pk_bf16_f32 v64, v64, v65
v_cvt_pk_bf16_f32 v65, v66, v67
ds_write_b64 v203, v[64:65] offset:12576
v_cvt_pk_bf16_f32 v68, v68, v69
v_cvt_pk_bf16_f32 v69, v70, v71
ds_write_b64 v203, v[68:69] offset:12608
s_waitcnt lgkmcnt(0)
s_barrier
ds_read_b64 v[120:121], v204
s_add_u32 s28, s39, s60
s_waitcnt lgkmcnt(0)
buffer_store_dwordx2 v[120:121], v204, s[8:11], s28 offen sc1
ds_read_b64 v[128:129], v204 offset:392
s_add_u32 s29, s39, s61
s_waitcnt lgkmcnt(0)
buffer_store_dwordx2 v[128:129], v204, s[8:11], s29 offen sc1
ds_read_b64 v[136:137], v204 offset:784
s_add_u32 s28, s39, s62
s_waitcnt lgkmcnt(0)
buffer_store_dwordx2 v[136:137], v204, s[8:11], s28 offen sc1
ds_read_b64 v[120:121], v204 offset:1176
s_add_u32 s29, s39, s63
s_waitcnt lgkmcnt(0)
buffer_store_dwordx2 v[120:121], v204, s[8:11], s29 offen sc1
ds_read_b64 v[128:129], v204 offset:6272
s_add_u32 s28, s39, s64
s_waitcnt lgkmcnt(0)
buffer_store_dwordx2 v[128:129], v204, s[8:11], s28 offen sc1
ds_read_b64 v[136:137], v204 offset:6664
s_add_u32 s29, s39, s65
s_waitcnt lgkmcnt(0)
buffer_store_dwordx2 v[136:137], v204, s[8:11], s29 offen sc1
ds_read_b64 v[120:121], v204 offset:7056
s_add_u32 s28, s39, s66
s_waitcnt lgkmcnt(0)
buffer_store_dwordx2 v[120:121], v204, s[8:11], s28 offen sc1
ds_read_b64 v[128:129], v204 offset:7448
s_add_u32 s29, s39, s67
s_waitcnt lgkmcnt(0)
buffer_store_dwordx2 v[128:129], v204, s[8:11], s29 offen sc1
ds_read_b64 v[136:137], v204 offset:12544
s_add_u32 s28, s39, s68
s_waitcnt lgkmcnt(0)
buffer_store_dwordx2 v[136:137], v204, s[8:11], s28 offen sc1
ds_read_b64 v[120:121], v204 offset:12936
s_add_u32 s29, s39, s69
s_waitcnt lgkmcnt(0)
buffer_store_dwordx2 v[120:121], v204, s[8:11], s29 offen sc1
ds_read_b64 v[128:129], v204 offset:13328
s_add_u32 s28, s39, s70
s_waitcnt lgkmcnt(0)
buffer_store_dwordx2 v[128:129], v204, s[8:11], s28 offen sc1
ds_read_b64 v[136:137], v204 offset:13720
s_add_u32 s29, s39, s71
s_waitcnt lgkmcnt(0)
buffer_store_dwordx2 v[136:137], v204, s[8:11], s29 offen sc1
s_mov_b32 s38, s36
ds_read_b128 v[174:177], v217
ds_read_b128 v[84:87], v200
s_waitcnt lgkmcnt(0)
v_mfma_f32_16x16x32_bf16 v[36:39], v[174:177], v[84:87], 0
ds_read_b128 v[92:95], v201
s_waitcnt lgkmcnt(0)
v_mfma_f32_16x16x32_bf16 v[48:51], v[174:177], v[92:95], 0
ds_read_b128 v[100:103], v202
s_waitcnt lgkmcnt(0)
v_mfma_f32_16x16x32_bf16 v[60:63], v[174:177], v[100:103], 0
ds_read_b128 v[178:181], v217 offset:528
ds_read_b128 v[84:87], v194
ds_read_b128 v[88:91], v194 offset:16
s_waitcnt lgkmcnt(0)
v_smfmac_f32_16x16x64_bf16 v[36:39], v[178:181], v[84:91], v213
ds_read_b128 v[92:95], v195
ds_read_b128 v[96:99], v195 offset:16
s_waitcnt lgkmcnt(0)
v_smfmac_f32_16x16x64_bf16 v[48:51], v[178:181], v[92:99], v213
ds_read_b128 v[100:103], v196
ds_read_b128 v[104:107], v196 offset:16
s_waitcnt lgkmcnt(0)
v_smfmac_f32_16x16x64_bf16 v[60:63], v[178:181], v[100:107], v213
ds_read_b128 v[174:177], v217 offset:1056
ds_read_b128 v[84:87], v197
ds_read_b128 v[88:91], v197 offset:16
s_waitcnt lgkmcnt(0)
v_smfmac_f32_16x16x64_bf16 v[36:39], v[174:177], v[84:91], v213
ds_read_b128 v[92:95], v198
ds_read_b128 v[96:99], v198 offset:16
s_waitcnt lgkmcnt(0)
v_smfmac_f32_16x16x64_bf16 v[48:51], v[174:177], v[92:99], v213
ds_read_b128 v[100:103], v199
ds_read_b128 v[104:107], v199 offset:16
s_waitcnt lgkmcnt(0)
v_smfmac_f32_16x16x64_bf16 v[60:63], v[174:177], v[100:107], v213
ds_read_b128 v[178:181], v217 offset:1584
ds_read_b128 v[84:87], v200 offset:32
s_waitcnt lgkmcnt(0)
v_mfma_f32_16x16x32_bf16 v[40:43], v[178:181], v[84:87], 0
ds_read_b128 v[92:95], v201 offset:32
s_waitcnt lgkmcnt(0)
v_mfma_f32_16x16x32_bf16 v[52:55], v[178:181], v[92:95], 0
ds_read_b128 v[100:103], v202 offset:32
s_waitcnt lgkmcnt(0)
v_mfma_f32_16x16x32_bf16 v[64:67], v[178:181], v[100:103], 0
ds_read_b128 v[174:177], v217 offset:2112
ds_read_b128 v[84:87], v194 offset:32
ds_read_b128 v[88:91], v194 offset:48
s_waitcnt lgkmcnt(0)
v_smfmac_f32_16x16x64_bf16 v[40:43], v[174:177], v[84:91], v213
ds_read_b128 v[92:95], v195 offset:32
ds_read_b128 v[96:99], v195 offset:48
s_waitcnt lgkmcnt(0)
v_smfmac_f32_16x16x64_bf16 v[52:55], v[174:177], v[92:99], v213
ds_read_b128 v[100:103], v196 offset:32
ds_read_b128 v[104:107], v196 offset:48
s_waitcnt lgkmcnt(0)
v_smfmac_f32_16x16x64_bf16 v[64:67], v[174:177], v[100:107], v213
ds_read_b128 v[178:181], v217 offset:2640
ds_read_b128 v[84:87], v197 offset:32
ds_read_b128 v[88:91], v197 offset:48
s_waitcnt lgkmcnt(0)
v_smfmac_f32_16x16x64_bf16 v[40:43], v[178:181], v[84:91], v213
ds_read_b128 v[92:95], v198 offset:32
ds_read_b128 v[96:99], v198 offset:48
s_waitcnt lgkmcnt(0)
v_smfmac_f32_16x16x64_bf16 v[52:55], v[178:181], v[92:99], v213
ds_read_b128 v[100:103], v199 offset:32
ds_read_b128 v[104:107], v199 offset:48
s_waitcnt lgkmcnt(0)
v_smfmac_f32_16x16x64_bf16 v[64:67], v[178:181], v[100:107], v213
ds_read_b128 v[174:177], v217 offset:3168
ds_read_b128 v[84:87], v200 offset:64
s_waitcnt lgkmcnt(0)
v_mfma_f32_16x16x32_bf16 v[44:47], v[174:177], v[84:87], 0
ds_read_b128 v[92:95], v201 offset:64
s_waitcnt lgkmcnt(0)
v_mfma_f32_16x16x32_bf16 v[56:59], v[174:177], v[92:95], 0
ds_read_b128 v[100:103], v202 offset:64
s_waitcnt lgkmcnt(0)
v_mfma_f32_16x16x32_bf16 v[68:71], v[174:177], v[100:103], 0
ds_read_b128 v[178:181], v217 offset:3696
ds_read_b128 v[84:87], v194 offset:64
ds_read_b128 v[88:91], v194 offset:80
s_waitcnt lgkmcnt(0)
v_smfmac_f32_16x16x64_bf16 v[44:47], v[178:181], v[84:91], v213
ds_read_b128 v[92:95], v195 offset:64
ds_read_b128 v[96:99], v195 offset:80
s_waitcnt lgkmcnt(0)
v_smfmac_f32_16x16x64_bf16 v[56:59], v[178:181], v[92:99], v213
ds_read_b128 v[100:103], v196 offset:64
ds_read_b128 v[104:107], v196 offset:80
s_waitcnt lgkmcnt(0)
v_smfmac_f32_16x16x64_bf16 v[68:71], v[178:181], v[100:107], v213
ds_read_b128 v[174:177], v217 offset:4224
ds_read_b128 v[84:87], v197 offset:64
ds_read_b128 v[88:91], v197 offset:80
s_waitcnt lgkmcnt(0)
v_smfmac_f32_16x16x64_bf16 v[44:47], v[174:177], v[84:91], v213
ds_read_b128 v[92:95], v198 offset:64
ds_read_b128 v[96:99], v198 offset:80
s_waitcnt lgkmcnt(0)
v_smfmac_f32_16x16x64_bf16 v[56:59], v[174:177], v[92:99], v213
ds_read_b128 v[100:103], v199 offset:64
ds_read_b128 v[104:107], v199 offset:80
s_waitcnt lgkmcnt(0)
v_smfmac_f32_16x16x64_bf16 v[68:71], v[174:177], v[100:107], v213
v_add_f32 v118, v36, v37
v_mul_f32 v119, v36, v36
v_add_f32 v118, v118, v38
v_fmac_f32 v119, v37, v37
v_add_f32 v118, v118, v39
v_fmac_f32 v119, v38, v38
v_fmac_f32 v119, v39, v39
v_add_f32 v126, v48, v49
v_mul_f32 v127, v48, v48
v_add_f32 v126, v126, v50
v_fmac_f32 v127, v49, v49
v_add_f32 v126, v126, v51
v_fmac_f32 v127, v50, v50
v_fmac_f32 v127, v51, v51
v_add_f32 v134, v60, v61
v_mul_f32 v135, v60, v60
v_add_f32 v134, v134, v62
v_fmac_f32 v135, v61, v61
v_add_f32 v134, v134, v63
v_fmac_f32 v135, v62, v62
v_fmac_f32 v135, v63, v63
v_add_f32 v118, v118, v40
v_fmac_f32 v119, v40, v40
v_add_f32 v118, v118, v41
v_fmac_f32 v119, v41, v41
v_add_f32 v118, v118, v42
v_fmac_f32 v119, v42, v42
v_add_f32 v118, v118, v43
v_fmac_f32 v119, v43, v43
v_add_f32 v126, v126, v52
v_fmac_f32 v127, v52, v52
v_add_f32 v126, v126, v53
v_fmac_f32 v127, v53, v53
v_add_f32 v126, v126, v54
v_fmac_f32 v127, v54, v54
v_add_f32 v126, v126, v55
v_fmac_f32 v127, v55, v55
v_add_f32 v134, v134, v64
v_fmac_f32 v135, v64, v64
v_add_f32 v134, v134, v65
v_fmac_f32 v135, v65, v65
v_add_f32 v134, v134, v66
v_fmac_f32 v135, v66, v66
v_add_f32 v134, v134, v67
v_fmac_f32 v135, v67, v67
v_add_f32 v118, v118, v44
v_fmac_f32 v119, v44, v44
v_add_f32 v118, v118, v45
v_fmac_f32 v119, v45, v45
v_add_f32 v118, v118, v46
v_fmac_f32 v119, v46, v46
v_add_f32 v118, v118, v47
v_fmac_f32 v119, v47, v47
v_add_f32 v126, v126, v56
v_fmac_f32 v127, v56, v56
v_add_f32 v126, v126, v57
v_fmac_f32 v127, v57, v57
v_add_f32 v126, v126, v58
v_fmac_f32 v127, v58, v58
v_add_f32 v126, v126, v59
v_fmac_f32 v127, v59, v59
v_add_f32 v134, v134, v68
v_fmac_f32 v135, v68, v68
v_add_f32 v134, v134, v69
v_fmac_f32 v135, v69, v69
v_add_f32 v134, v134, v70
v_fmac_f32 v135, v70, v70
v_add_f32 v134, v134, v71
v_fmac_f32 v135, v71, v71
v_permlane16_swap_b32 v118, v119
v_add_f32 v118, v118, v119
v_permlane16_swap_b32 v126, v127
v_add_f32 v126, v126, v127
v_permlane16_swap_b32 v134, v135
v_add_f32 v134, v134, v135
v_permlane32_swap_b32 v118, v126
v_add_f32 v118, v118, v126
ds_write_b32 v209, v118
v_mov_b32 v135, v134
s_nop 1
v_permlane32_swap_b32 v134, v135
v_add_f32 v134, v134, v135
ds_write_b32 v209, v134 offset:512
s_waitcnt lgkmcnt(0)
s_barrier
s_mul_hi_u32 s41, s35, 58835169
s_mul_i32 s42, s41, 73
s_sub_u32 s42, s35, s42
s_mul_i32 s43, s41, 1373568
s_mul_i32 s51, s42, 2688
s_add_u32 s50, s43, s51
s_add_u32 s35, s35, 32
s_min_u32 s41, s41, 1
s_sub_u32 s41, 1, s41
s_lshl_b32 s41, s41, 30
s_add_u32 s52, s50, s41
s_min_u32 s43, s42, 1
s_lshl_b32 s43, s43, 27
s_sub_u32 s43, 536870911, s43
s_add_u32 s51, s42, 56
s_and_b32 s51, s51, 128
s_lshl_b32 s51, s51, 22
s_or_b32 s44, s43, s51
s_mov_b32 s36, s50
v_and_b32 v216, s44, v208
s_add_u32 m0, s45, 0
s_nop 0
buffer_load_dwordx4 v216, s[4:7], s52 offen nt lds
s_add_u32 m0, s45, 4112
s_add_u32 s40, s36, 196224
buffer_load_dwordx4 v216, s[4:7], s40 offen nt lds
s_add_u32 m0, s45, 8224
s_add_u32 s40, s36, 392448
buffer_load_dwordx4 v216, s[4:7], s40 offen nt lds
s_add_u32 m0, s45, 12336
s_add_u32 s40, s36, 588672
buffer_load_dwordx4 v216, s[4:7], s40 offen nt lds
s_add_u32 m0, s45, 16448
s_add_u32 s40, s36, 784896
buffer_load_dwordx4 v216, s[4:7], s40 offen nt lds
s_add_u32 m0, s45, 20560
s_add_u32 s40, s36, 981120
buffer_load_dwordx4 v216, s[4:7], s40 offen nt lds
s_add_u32 m0, s45, 24672
s_add_u32 s40, s36, 1177344
buffer_load_dwordx4 v216, s[4:7], s40 offen nt lds
s_add_u32 m0, s45, 28784
s_add_u32 s40, s36, 1373568
buffer_load_dwordx4 v216, s[4:7], s40 offen nt lds
s_add_u32 m0, s45, 32896
s_add_u32 s40, s36, 1569792
buffer_load_dwordx4 v216, s[4:7], s40 offen nt lds
ds_read_b128 v[182:185], v210
ds_read_b128 v[186:189], v210 offset:1024
s_waitcnt lgkmcnt(1)
v_mfma_f32_16x16x32_bf16 v[138:141], a[0:3], v[182:185], 0
s_waitcnt lgkmcnt(0)
v_mfma_f32_16x16x32_bf16 v[138:141], a[4:7], v[186:189], v[138:141]
v_mfma_f32_16x16x32_bf16 v[142:145], a[24:27], v[182:185], 0
v_mfma_f32_16x16x32_bf16 v[142:145], a[28:31], v[186:189], v[142:145]
v_mfma_f32_16x16x32_bf16 v[146:149], a[48:51], v[182:185], 0
v_mfma_f32_16x16x32_bf16 v[146:149], a[52:55], v[186:189], v[146:149]
v_mfma_f32_16x16x32_bf16 v[150:153], a[216:219], v[182:185], 0
v_mfma_f32_16x16x32_bf16 v[150:153], a[220:223], v[186:189], v[150:153]
v_mfma_f32_16x16x32_bf16 v[154:157], a[240:243], v[182:185], 0
v_mfma_f32_16x16x32_bf16 v[154:157], a[244:247], v[186:189], v[154:157]
v_mfma_f32_16x16x32_bf16 v[158:161], v[232:235], v[182:185], 0
v_mfma_f32_16x16x32_bf16 v[158:161], v[236:239], v[186:189], v[158:161]
v_mfma_f32_16x16x32_bf16 v[162:165], v[182:185], a[72:75], 0
v_mfma_f32_16x16x32_bf16 v[162:165], v[186:189], a[76:79], v[162:165]
v_mfma_f32_16x16x32_bf16 v[166:169], v[182:185], a[96:99], 0
v_mfma_f32_16x16x32_bf16 v[166:169], v[186:189], a[100:103], v[166:169]
v_mfma_f32_16x16x32_bf16 v[170:173], v[182:185], a[120:123], 0
v_mfma_f32_16x16x32_bf16 v[170:173], v[186:189], a[124:127], v[170:173]
ds_read_b128 v[110:113], v210 offset:2048
ds_read_b128 v[220:223], v210 offset:3072
s_waitcnt lgkmcnt(1)
v_mfma_f32_16x16x32_bf16 v[138:141], a[8:11], v[110:113], v[138:141]
s_waitcnt lgkmcnt(0)
v_mfma_f32_16x16x32_bf16 v[138:141], a[12:15], v[220:223], v[138:141]
v_mfma_f32_16x16x32_bf16 v[142:145], a[32:35], v[110:113], v[142:145]
v_mfma_f32_16x16x32_bf16 v[142:145], a[36:39], v[220:223], v[142:145]
v_mfma_f32_16x16x32_bf16 v[146:149], a[56:59], v[110:113], v[146:149]
v_mfma_f32_16x16x32_bf16 v[146:149], a[60:63], v[220:223], v[146:149]
v_mfma_f32_16x16x32_bf16 v[150:153], a[224:227], v[110:113], v[150:153]
v_mfma_f32_16x16x32_bf16 v[150:153], a[228:231], v[220:223], v[150:153]
v_mfma_f32_16x16x32_bf16 v[154:157], a[248:251], v[110:113], v[154:157]
v_mfma_f32_16x16x32_bf16 v[154:157], a[252:255], v[220:223], v[154:157]
v_mfma_f32_16x16x32_bf16 v[158:161], v[240:243], v[110:113], v[158:161]
v_mfma_f32_16x16x32_bf16 v[158:161], v[244:247], v[220:223], v[158:161]
v_mfma_f32_16x16x32_bf16 v[162:165], v[110:113], a[80:83], v[162:165]
v_mfma_f32_16x16x32_bf16 v[162:165], v[220:223], a[84:87], v[162:165]
v_mfma_f32_16x16x32_bf16 v[166:169], v[110:113], a[104:107], v[166:169]
v_mfma_f32_16x16x32_bf16 v[166:169], v[220:223], a[108:111], v[166:169]
v_mfma_f32_16x16x32_bf16 v[170:173], v[110:113], a[128:131], v[170:173]
v_mfma_f32_16x16x32_bf16 v[170:173], v[220:223], a[132:135], v[170:173]
ds_read_b128 v[182:185], v210 offset:4096
ds_read_b128 v[186:189], v210 offset:5120
s_waitcnt lgkmcnt(1)
v_mfma_f32_16x16x32_bf16 v[138:141], a[16:19], v[182:185], v[138:141]
s_waitcnt lgkmcnt(0)
v_mfma_f32_16x16x32_bf16 v[138:141], a[20:23], v[186:189], v[138:141]
v_mfma_f32_16x16x32_bf16 v[142:145], a[40:43], v[182:185], v[142:145]
v_mfma_f32_16x16x32_bf16 v[142:145], a[44:47], v[186:189], v[142:145]
v_mfma_f32_16x16x32_bf16 v[146:149], a[64:67], v[182:185], v[146:149]
v_mfma_f32_16x16x32_bf16 v[146:149], a[68:71], v[186:189], v[146:149]
v_mfma_f32_16x16x32_bf16 v[150:153], a[232:235], v[182:185], v[150:153]
v_mfma_f32_16x16x32_bf16 v[150:153], a[236:239], v[186:189], v[150:153]
v_mfma_f32_16x16x32_bf16 v[154:157], v[224:227], v[182:185], v[154:157]
v_mfma_f32_16x16x32_bf16 v[154:157], v[228:231], v[186:189], v[154:157]
v_mfma_f32_16x16x32_bf16 v[158:161], v[248:251], v[182:185], v[158:161]
v_mfma_f32_16x16x32_bf16 v[158:161], v[252:255], v[186:189], v[158:161]
v_mfma_f32_16x16x32_bf16 v[162:165], v[182:185], a[88:91], v[162:165]
v_mfma_f32_16x16x32_bf16 v[162:165], v[186:189], a[92:95], v[162:165]
v_mfma_f32_16x16x32_bf16 v[166:169], v[182:185], a[112:115], v[166:169]
v_mfma_f32_16x16x32_bf16 v[166:169], v[186:189], a[116:119], v[166:169]
v_mfma_f32_16x16x32_bf16 v[170:173], v[182:185], a[136:139], v[170:173]
v_mfma_f32_16x16x32_bf16 v[170:173], v[186:189], a[140:143], v[170:173]
v_cvt_pk_bf16_f32 v78, v138, v139
v_cvt_pk_bf16_f32 v79, v140, v141
v_cvt_pk_bf16_f32 v80, v142, v143
v_cvt_pk_bf16_f32 v81, v144, v145
v_cvt_pk_bf16_f32 v82, v146, v147
v_cvt_pk_bf16_f32 v83, v148, v149
v_cvt_pk_bf16_f32 v72, v150, v151
v_cvt_pk_bf16_f32 v73, v152, v153
v_cvt_pk_bf16_f32 v74, v154, v155
v_cvt_pk_bf16_f32 v75, v156, v157
v_cvt_pk_bf16_f32 v76, v158, v159
v_cvt_pk_bf16_f32 v77, v160, v161
v_cvt_pk_bf16_f32 v114, v162, v163
v_cvt_pk_bf16_f32 v115, v164, v165
v_cvt_pk_bf16_f32 v122, v166, v167
v_cvt_pk_bf16_f32 v123, v168, v169
v_cvt_pk_bf16_f32 v130, v170, v171
v_cvt_pk_bf16_f32 v131, v172, v173
ds_read_b128 v[110:113], v210 offset:6144
ds_read_b128 v[220:223], v210 offset:7168
s_waitcnt lgkmcnt(1)
v_mfma_f32_16x16x32_bf16 v[138:141], a[0:3], v[110:113], 0
s_waitcnt lgkmcnt(0)
v_mfma_f32_16x16x32_bf16 v[138:141], a[4:7], v[220:223], v[138:141]
v_mfma_f32_16x16x32_bf16 v[142:145], a[24:27], v[110:113], 0
v_mfma_f32_16x16x32_bf16 v[142:145], a[28:31], v[220:223], v[142:145]
v_mfma_f32_16x16x32_bf16 v[146:149], a[48:51], v[110:113], 0
v_mfma_f32_16x16x32_bf16 v[146:149], a[52:55], v[220:223], v[146:149]
v_mfma_f32_16x16x32_bf16 v[150:153], a[216:219], v[110:113], 0
v_mfma_f32_16x16x32_bf16 v[150:153], a[220:223], v[220:223], v[150:153]
v_mfma_f32_16x16x32_bf16 v[154:157], a[240:243], v[110:113], 0
v_mfma_f32_16x16x32_bf16 v[154:157], a[244:247], v[220:223], v[154:157]
v_mfma_f32_16x16x32_bf16 v[158:161], v[232:235], v[110:113], 0
v_mfma_f32_16x16x32_bf16 v[158:161], v[236:239], v[220:223], v[158:161]
v_mfma_f32_16x16x32_bf16 v[162:165], v[110:113], a[72:75], 0
v_mfma_f32_16x16x32_bf16 v[162:165], v[220:223], a[76:79], v[162:165]
v_mfma_f32_16x16x32_bf16 v[166:169], v[110:113], a[96:99], 0
v_mfma_f32_16x16x32_bf16 v[166:169], v[220:223], a[100:103], v[166:169]
v_mfma_f32_16x16x32_bf16 v[170:173], v[110:113], a[120:123], 0
v_mfma_f32_16x16x32_bf16 v[170:173], v[220:223], a[124:127], v[170:173]
ds_read_b128 v[102:105], v210 offset:18432
ds_read_b128 v[106:109], v210 offset:19456
s_waitcnt lgkmcnt(1)
v_add_f32 v102, v102, v103
s_waitcnt lgkmcnt(0)
v_add_f32 v106, v106, v107
v_add_f32 v104, v104, v105
v_add_f32 v108, v108, v109
v_add_f32 v102, v102, v104
v_add_f32 v106, v106, v108
v_mul_f32 v103, s48, v102
v_mul_f32 v104, s73, v102
v_mul_f32 v106, s73, v106
v_fma_f32 v106, -v103, v104, v106
v_max_f32 v106, 0, v106
v_add_f32 v106, s49, v106
v_rsq_f32 v102, v106
s_nop 0
v_mul_f32_e64 v103, -v103, v102
ds_write_b64 v211, v[102:103] offset:20480
ds_read_b64 v[118:119], v219 offset:20480
ds_read_b64 v[126:127], v219 offset:20736
ds_read_b64 v[134:135], v219 offset:20992
s_waitcnt lgkmcnt(2)
v_fma_f32 v220, v36, v118, v119
v_fma_f32 v221, v37, v118, v119
v_cvt_pk_bf16_f32 v174, v220, v221
v_fma_f32 v222, v38, v118, v119
v_fma_f32 v223, v39, v118, v119
v_cvt_pk_bf16_f32 v175, v222, v223
v_fma_f32 v220, v40, v118, v119
v_fma_f32 v221, v41, v118, v119
v_cvt_pk_bf16_f32 v176, v220, v221
v_fma_f32 v222, v42, v118, v119
v_fma_f32 v223, v43, v118, v119
v_cvt_pk_bf16_f32 v177, v222, v223
ds_write_b128 v211, v[174:177] offset:20480
v_fma_f32 v220, v44, v118, v119
v_fma_f32 v221, v45, v118, v119
v_cvt_pk_bf16_f32 v178, v220, v221
v_fma_f32 v222, v46, v118, v119
v_fma_f32 v223, v47, v118, v119
v_cvt_pk_bf16_f32 v179, v222, v223
s_waitcnt lgkmcnt(2)
ds_write_b64 v212, v[178:179] offset:20480
v_fma_f32 v220, v48, v126, v127
v_fma_f32 v221, v49, v126, v127
v_cvt_pk_bf16_f32 v90, v220, v221
v_fma_f32 v222, v50, v126, v127
v_fma_f32 v223, v51, v126, v127
v_cvt_pk_bf16_f32 v91, v222, v223
v_fma_f32 v220, v52, v126, v127
v_fma_f32 v221, v53, v126, v127
v_cvt_pk_bf16_f32 v92, v220, v221
v_fma_f32 v222, v54, v126, v127
v_fma_f32 v223, v55, v126, v127
v_cvt_pk_bf16_f32 v93, v222, v223
ds_write_b128 v211, v[90:93] offset:26624
v_fma_f32 v220, v56, v126, v127
v_fma_f32 v221, v57, v126, v127
v_cvt_pk_bf16_f32 v94, v220, v221
v_fma_f32 v222, v58, v126, v127
v_fma_f32 v223, v59, v126, v127
v_cvt_pk_bf16_f32 v95, v222, v223
s_waitcnt lgkmcnt(3)
ds_write_b64 v212, v[94:95] offset:26624
v_fma_f32 v220, v60, v134, v135
v_fma_f32 v221, v61, v134, v135
v_cvt_pk_bf16_f32 v90, v220, v221
v_fma_f32 v222, v62, v134, v135
v_fma_f32 v223, v63, v134, v135
v_cvt_pk_bf16_f32 v91, v222, v223
v_fma_f32 v220, v64, v134, v135
v_fma_f32 v221, v65, v134, v135
v_cvt_pk_bf16_f32 v92, v220, v221
v_fma_f32 v222, v66, v134, v135
v_fma_f32 v223, v67, v134, v135
v_cvt_pk_bf16_f32 v93, v222, v223
ds_write_b128 v211, v[90:93] offset:32768
v_fma_f32 v220, v68, v134, v135
v_fma_f32 v221, v69, v134, v135
v_cvt_pk_bf16_f32 v94, v220, v221
v_fma_f32 v222, v70, v134, v135
v_fma_f32 v223, v71, v134, v135
v_cvt_pk_bf16_f32 v95, v222, v223
ds_write_b64 v212, v[94:95] offset:32768
ds_read_b128 v[182:185], v210 offset:8192
ds_read_b128 v[186:189], v210 offset:9216
s_waitcnt lgkmcnt(1)
v_mfma_f32_16x16x32_bf16 v[138:141], a[8:11], v[182:185], v[138:141]
s_waitcnt lgkmcnt(0)
v_mfma_f32_16x16x32_bf16 v[138:141], a[12:15], v[186:189], v[138:141]
v_mfma_f32_16x16x32_bf16 v[142:145], a[32:35], v[182:185], v[142:145]
v_mfma_f32_16x16x32_bf16 v[142:145], a[36:39], v[186:189], v[142:145]
v_mfma_f32_16x16x32_bf16 v[146:149], a[56:59], v[182:185], v[146:149]
v_mfma_f32_16x16x32_bf16 v[146:149], a[60:63], v[186:189], v[146:149]
v_mfma_f32_16x16x32_bf16 v[150:153], a[224:227], v[182:185], v[150:153]
v_mfma_f32_16x16x32_bf16 v[150:153], a[228:231], v[186:189], v[150:153]
v_mfma_f32_16x16x32_bf16 v[154:157], a[248:251], v[182:185], v[154:157]
v_mfma_f32_16x16x32_bf16 v[154:157], a[252:255], v[186:189], v[154:157]
v_mfma_f32_16x16x32_bf16 v[158:161], v[240:243], v[182:185], v[158:161]
v_mfma_f32_16x16x32_bf16 v[158:161], v[244:247], v[186:189], v[158:161]
v_mfma_f32_16x16x32_bf16 v[162:165], v[182:185], a[80:83], v[162:165]
v_mfma_f32_16x16x32_bf16 v[162:165], v[186:189], a[84:87], v[162:165]
v_mfma_f32_16x16x32_bf16 v[166:169], v[182:185], a[104:107], v[166:169]
v_mfma_f32_16x16x32_bf16 v[166:169], v[186:189], a[108:111], v[166:169]
v_mfma_f32_16x16x32_bf16 v[170:173], v[182:185], a[128:131], v[170:173]
v_mfma_f32_16x16x32_bf16 v[170:173], v[186:189], a[132:135], v[170:173]
ds_read_b128 v[110:113], v210 offset:10240
ds_read_b128 v[106:109], v210 offset:11264
s_waitcnt lgkmcnt(1)
v_mfma_f32_16x16x32_bf16 v[138:141], a[16:19], v[110:113], v[138:141]
s_waitcnt lgkmcnt(0)
v_mfma_f32_16x16x32_bf16 v[138:141], a[20:23], v[106:109], v[138:141]
v_mfma_f32_16x16x32_bf16 v[142:145], a[40:43], v[110:113], v[142:145]
v_mfma_f32_16x16x32_bf16 v[142:145], a[44:47], v[106:109], v[142:145]
v_mfma_f32_16x16x32_bf16 v[146:149], a[64:67], v[110:113], v[146:149]
v_mfma_f32_16x16x32_bf16 v[146:149], a[68:71], v[106:109], v[146:149]
v_mfma_f32_16x16x32_bf16 v[150:153], a[232:235], v[110:113], v[150:153]
v_mfma_f32_16x16x32_bf16 v[150:153], a[236:239], v[106:109], v[150:153]
v_mfma_f32_16x16x32_bf16 v[154:157], v[224:227], v[110:113], v[154:157]
v_mfma_f32_16x16x32_bf16 v[154:157], v[228:231], v[106:109], v[154:157]
v_mfma_f32_16x16x32_bf16 v[158:161], v[248:251], v[110:113], v[158:161]
v_mfma_f32_16x16x32_bf16 v[158:161], v[252:255], v[106:109], v[158:161]
v_mfma_f32_16x16x32_bf16 v[162:165], v[110:113], a[88:91], v[162:165]
v_mfma_f32_16x16x32_bf16 v[162:165], v[106:109], a[92:95], v[162:165]
v_mfma_f32_16x16x32_bf16 v[166:169], v[110:113], a[112:115], v[166:169]
v_mfma_f32_16x16x32_bf16 v[166:169], v[106:109], a[116:119], v[166:169]
v_mfma_f32_16x16x32_bf16 v[170:173], v[110:113], a[136:139], v[170:173]
v_mfma_f32_16x16x32_bf16 v[170:173], v[106:109], a[140:143], v[170:173]
v_cvt_pk_bf16_f32 v96, v138, v139
v_cvt_pk_bf16_f32 v97, v140, v141
v_cvt_pk_bf16_f32 v98, v142, v143
v_cvt_pk_bf16_f32 v99, v144, v145
v_cvt_pk_bf16_f32 v100, v146, v147
v_cvt_pk_bf16_f32 v101, v148, v149
v_cvt_pk_bf16_f32 v84, v150, v151
v_cvt_pk_bf16_f32 v85, v152, v153
v_cvt_pk_bf16_f32 v86, v154, v155
v_cvt_pk_bf16_f32 v87, v156, v157
v_cvt_pk_bf16_f32 v88, v158, v159
v_cvt_pk_bf16_f32 v89, v160, v161
v_cvt_pk_bf16_f32 v116, v162, v163
v_cvt_pk_bf16_f32 v117, v164, v165
v_cvt_pk_bf16_f32 v124, v166, v167
v_cvt_pk_bf16_f32 v125, v168, v169
v_cvt_pk_bf16_f32 v132, v170, v171
v_cvt_pk_bf16_f32 v133, v172, v173
ds_read_b128 v[182:185], v210 offset:12288
ds_read_b128 v[186:189], v210 offset:13312
s_waitcnt lgkmcnt(1)
v_mfma_f32_16x16x32_bf16 v[138:141], a[0:3], v[182:185], 0
s_waitcnt lgkmcnt(0)
v_mfma_f32_16x16x32_bf16 v[138:141], a[4:7], v[186:189], v[138:141]
v_mfma_f32_16x16x32_bf16 v[142:145], a[24:27], v[182:185], 0
v_mfma_f32_16x16x32_bf16 v[142:145], a[28:31], v[186:189], v[142:145]
v_mfma_f32_16x16x32_bf16 v[146:149], a[48:51], v[182:185], 0
v_mfma_f32_16x16x32_bf16 v[146:149], a[52:55], v[186:189], v[146:149]
ds_read_b128 v[174:177], v210 offset:14336
ds_read_b128 v[178:181], v210 offset:15360
s_waitcnt lgkmcnt(1)
v_mfma_f32_16x16x32_bf16 v[138:141], a[8:11], v[174:177], v[138:141]
s_waitcnt lgkmcnt(0)
v_mfma_f32_16x16x32_bf16 v[138:141], a[12:15], v[178:181], v[138:141]
v_mfma_f32_16x16x32_bf16 v[142:145], a[32:35], v[174:177], v[142:145]
v_mfma_f32_16x16x32_bf16 v[142:145], a[36:39], v[178:181], v[142:145]
v_mfma_f32_16x16x32_bf16 v[146:149], a[56:59], v[174:177], v[146:149]
v_mfma_f32_16x16x32_bf16 v[146:149], a[60:63], v[178:181], v[146:149]
ds_read_b128 v[182:185], v210 offset:16384
ds_read_b128 v[186:189], v210 offset:17408
s_waitcnt lgkmcnt(1)
v_mfma_f32_16x16x32_bf16 v[138:141], a[16:19], v[182:185], v[138:141]
s_waitcnt lgkmcnt(0)
v_mfma_f32_16x16x32_bf16 v[138:141], a[20:23], v[186:189], v[138:141]
v_mfma_f32_16x16x32_bf16 v[142:145], a[40:43], v[182:185], v[142:145]
v_mfma_f32_16x16x32_bf16 v[142:145], a[44:47], v[186:189], v[142:145]
v_mfma_f32_16x16x32_bf16 v[146:149], a[64:67], v[182:185], v[146:149]
v_mfma_f32_16x16x32_bf16 v[146:149], a[68:71], v[186:189], v[146:149]
v_cvt_pk_bf16_f32 v102, v138, v139
v_cvt_pk_bf16_f32 v103, v140, v141
v_cvt_pk_bf16_f32 v104, v142, v143
v_cvt_pk_bf16_f32 v105, v144, v145
s_nop 2
v_cvt_pk_bf16_f32 v106, v146, v147
v_cvt_pk_bf16_f32 v107, v148, v149
ds_read_b128 v[108:111], v215 offset:512
ds_read_b64 v[112:113], v215 offset:528
v_mfma_f32_16x16x16_bf16 v[138:141], v[82:83], v[76:77], 0
v_mfma_f32_16x16x16_bf16 v[142:145], v[100:101], v[76:77], 0
s_waitcnt lgkmcnt(0)
v_mfma_f32_16x16x16_bf16 v[150:153], v[112:113], v[76:77], v[206:209]
v_mfma_f32_16x16x16_bf16 v[146:149], v[106:107], v[76:77], 0
v_mfma_f32_16x16x32_bf16 v[138:141], v[78:81], v[72:75], v[138:141]
v_mfma_f32_16x16x32_bf16 v[142:145], v[96:99], v[72:75], v[142:145]
v_mfma_f32_16x16x32_bf16 v[150:153], v[108:111], v[72:75], v[150:153]
v_mfma_f32_16x16x32_bf16 v[146:149], v[102:105], v[72:75], v[146:149]
ds_read_b128 v[72:75], v215
ds_read_b64 v[76:77], v215 offset:16
v_mfma_f32_16x16x16_bf16 v[154:157], v[82:83], v[88:89], 0
v_mfma_f32_16x16x16_bf16 v[158:161], v[100:101], v[88:89], 0
v_mfma_f32_16x16x16_bf16 v[166:169], v[112:113], v[88:89], v[206:209]
v_mfma_f32_16x16x16_bf16 v[162:165], v[106:107], v[88:89], 0
v_mfma_f32_16x16x32_bf16 v[154:157], v[78:81], v[84:87], v[154:157]
v_mfma_f32_16x16x32_bf16 v[158:161], v[96:99], v[84:87], v[158:161]
v_mfma_f32_16x16x32_bf16 v[166:169], v[108:111], v[84:87], v[166:169]
v_mfma_f32_16x16x32_bf16 v[162:165], v[102:105], v[84:87], v[162:165]
v_mfma_f32_16x16x32_bf16 v[118:121], v[182:185], a[88:91], 0
v_mfma_f32_16x16x32_bf16 v[118:121], v[186:189], a[92:95], v[118:121]
v_mfma_f32_16x16x32_bf16 v[126:129], v[182:185], a[112:115], 0
v_mfma_f32_16x16x32_bf16 v[126:129], v[186:189], a[116:119], v[126:129]
v_mfma_f32_16x16x32_bf16 v[134:137], v[182:185], a[136:139], 0
v_mfma_f32_16x16x32_bf16 v[134:137], v[186:189], a[140:143], v[134:137]
v_mfma_f32_16x16x32_bf16 v[90:93], a[232:235], v[182:185], 0
v_mfma_f32_16x16x32_bf16 v[90:93], a[236:239], v[186:189], v[90:93]
v_mfma_f32_16x16x32_bf16 v[170:173], v[224:227], v[182:185], 0
v_mfma_f32_16x16x32_bf16 v[170:173], v[228:231], v[186:189], v[170:173]
v_mfma_f32_16x16x32_bf16 v[220:223], v[248:251], v[182:185], 0
v_mfma_f32_16x16x32_bf16 v[220:223], v[252:255], v[186:189], v[220:223]
v_mfma_f32_16x16x32_bf16 v[118:121], v[174:177], a[80:83], v[118:121]
v_mfma_f32_16x16x32_bf16 v[118:121], v[178:181], a[84:87], v[118:121]
v_mfma_f32_16x16x32_bf16 v[126:129], v[174:177], a[104:107], v[126:129]
v_mfma_f32_16x16x32_bf16 v[126:129], v[178:181], a[108:111], v[126:129]
v_mfma_f32_16x16x32_bf16 v[134:137], v[174:177], a[128:131], v[134:137]
v_mfma_f32_16x16x32_bf16 v[134:137], v[178:181], a[132:135], v[134:137]
v_mfma_f32_16x16x32_bf16 v[90:93], a[224:227], v[174:177], v[90:93]
v_mfma_f32_16x16x32_bf16 v[90:93], a[228:231], v[178:181], v[90:93]
v_mfma_f32_16x16x32_bf16 v[170:173], a[248:251], v[174:177], v[170:173]
v_mfma_f32_16x16x32_bf16 v[170:173], a[252:255], v[178:181], v[170:173]
v_mfma_f32_16x16x32_bf16 v[220:223], v[240:243], v[174:177], v[220:223]
v_mfma_f32_16x16x32_bf16 v[220:223], v[244:247], v[178:181], v[220:223]
ds_read_b128 v[182:185], v210 offset:12288
ds_read_b128 v[186:189], v210 offset:13312
s_waitcnt lgkmcnt(1)
v_mfma_f32_16x16x32_bf16 v[118:121], v[182:185], a[72:75], v[118:121]
s_waitcnt lgkmcnt(0)
v_mfma_f32_16x16x32_bf16 v[118:121], v[186:189], a[76:79], v[118:121]
v_mfma_f32_16x16x32_bf16 v[126:129], v[182:185], a[96:99], v[126:129]
v_mfma_f32_16x16x32_bf16 v[126:129], v[186:189], a[100:103], v[126:129]
v_mfma_f32_16x16x32_bf16 v[134:137], v[182:185], a[120:123], v[134:137]
v_mfma_f32_16x16x32_bf16 v[134:137], v[186:189], a[124:127], v[134:137]
v_mfma_f32_16x16x32_bf16 v[90:93], a[216:219], v[182:185], v[90:93]
v_mfma_f32_16x16x32_bf16 v[90:93], a[220:223], v[186:189], v[90:93]
v_mfma_f32_16x16x32_bf16 v[170:173], a[240:243], v[182:185], v[170:173]
v_mfma_f32_16x16x32_bf16 v[170:173], a[244:247], v[186:189], v[170:173]
v_mfma_f32_16x16x32_bf16 v[220:223], v[232:235], v[182:185], v[220:223]
v_mfma_f32_16x16x32_bf16 v[220:223], v[236:239], v[186:189], v[220:223]
v_mov_b32 v181, 0
v_cvt_pk_bf16_f32 v118, v118, v119
v_cvt_pk_bf16_f32 v119, v120, v121
ds_read_u16 v120, v205
v_mov_b32 v121, 0
v_cvt_pk_bf16_f32 v126, v126, v127
v_cvt_pk_bf16_f32 v127, v128, v129
ds_read_u16 v128, v205 offset:32
v_mov_b32 v129, 0
v_cvt_pk_bf16_f32 v134, v134, v135
v_cvt_pk_bf16_f32 v135, v136, v137
ds_read_u16 v136, v205 offset:64
v_mov_b32 v137, 0
v_add_u32 v205, 1424, v205
v_cvt_pk_bf16_f32 v90, v90, v91
v_cvt_pk_bf16_f32 v91, v92, v93
v_cvt_pk_bf16_f32 v92, v170, v171
v_cvt_pk_bf16_f32 v93, v172, v173
v_cvt_pk_bf16_f32 v94, v220, v221
v_cvt_pk_bf16_f32 v95, v222, v223
v_max3_f32 v151, v138, v139, v140
v_max3_f32 v151, v151, v141, v142
v_max3_f32 v151, v151, v143, v144
v_max3_f32 v151, v151, v145, v146
v_max3_f32 v151, v151, v147, v148
v_max3_f32 v151, v151, v149, v150
v_mov_b32 v152, v151
s_nop 1
v_permlane16_swap_b32 v151, v152
v_max_f32 v151, v151, v152
v_mov_b32 v152, v151
s_nop 1
v_permlane32_swap_b32 v151, v152
v_max_f32 v151, v151, v152
v_sub_f32 v138, v138, v151
v_sub_f32 v139, v139, v151
v_sub_f32 v140, v140, v151
v_sub_f32 v141, v141, v151
v_sub_f32 v142, v142, v151
v_sub_f32 v143, v143, v151
v_sub_f32 v144, v144, v151
v_sub_f32 v145, v145, v151
v_sub_f32 v150, v150, v151
v_sub_f32 v146, v146, v151
v_sub_f32 v147, v147, v151
v_sub_f32 v148, v148, v151
v_sub_f32 v149, v149, v151
v_exp_f32 v138, v138
v_exp_f32 v139, v139
v_exp_f32 v140, v140
v_exp_f32 v141, v141
v_exp_f32 v142, v142
v_exp_f32 v143, v143
v_exp_f32 v144, v144
v_exp_f32 v145, v145
v_exp_f32 v150, v150
v_exp_f32 v146, v146
v_exp_f32 v147, v147
v_exp_f32 v148, v148
v_exp_f32 v149, v149
v_cvt_pk_bf16_f32 v174, v138, v139
v_cvt_pk_bf16_f32 v175, v140, v141
v_cvt_pk_bf16_f32 v176, v142, v143
v_cvt_pk_bf16_f32 v177, v144, v145
v_cvt_pk_bf16_f32 v178, v146, v147
v_cvt_pk_bf16_f32 v179, v148, v149
v_cvt_pk_bf16_f32 v180, v150, 0
v_mfma_f32_16x16x32_bf16 v[150:153], v[190:193], v[174:177], 0
v_mfma_f32_16x16x32_bf16 v[150:153], v[190:193], v[178:181], v[150:153]
v_mfma_f32_16x16x32_bf16 v[138:141], v[114:117], v[174:177], 0
s_waitcnt lgkmcnt(2)
v_mfma_f32_16x16x32_bf16 v[138:141], v[118:121], v[178:181], v[138:141]
v_mfma_f32_16x16x32_bf16 v[142:145], v[122:125], v[174:177], 0
s_waitcnt lgkmcnt(1)
v_mfma_f32_16x16x32_bf16 v[142:145], v[126:129], v[178:181], v[142:145]
v_mfma_f32_16x16x32_bf16 v[146:149], v[130:133], v[174:177], 0
s_waitcnt lgkmcnt(0)
v_mfma_f32_16x16x32_bf16 v[146:149], v[134:137], v[178:181], v[146:149]
v_max3_f32 v167, v154, v155, v156
v_max3_f32 v167, v167, v157, v158
v_max3_f32 v167, v167, v159, v160
v_max3_f32 v167, v167, v161, v162
v_max3_f32 v167, v167, v163, v164
v_max3_f32 v167, v167, v165, v166
v_mov_b32 v168, v167
s_nop 1
v_permlane16_swap_b32 v167, v168
v_max_f32 v167, v167, v168
v_mov_b32 v168, v167
s_nop 1
v_permlane32_swap_b32 v167, v168
v_max_f32 v167, v167, v168
v_sub_f32 v154, v154, v167
v_sub_f32 v155, v155, v167
v_sub_f32 v156, v156, v167
v_sub_f32 v157, v157, v167
v_sub_f32 v158, v158, v167
v_sub_f32 v159, v159, v167
v_sub_f32 v160, v160, v167
v_sub_f32 v161, v161, v167
v_sub_f32 v166, v166, v167
v_sub_f32 v162, v162, v167
v_sub_f32 v163, v163, v167
v_sub_f32 v164, v164, v167
v_sub_f32 v165, v165, v167
v_exp_f32 v154, v154
v_exp_f32 v155, v155
v_exp_f32 v156, v156
v_exp_f32 v157, v157
v_exp_f32 v158, v158
v_exp_f32 v159, v159
v_exp_f32 v160, v160
v_exp_f32 v161, v161
v_exp_f32 v166, v166
v_exp_f32 v162, v162
v_exp_f32 v163, v163
v_exp_f32 v164, v164
v_exp_f32 v165, v165
v_cvt_pk_bf16_f32 v174, v154, v155
v_cvt_pk_bf16_f32 v175, v156, v157
v_cvt_pk_bf16_f32 v176, v158, v159
v_cvt_pk_bf16_f32 v177, v160, v161
v_cvt_pk_bf16_f32 v178, v162, v163
v_cvt_pk_bf16_f32 v179, v164, v165
v_cvt_pk_bf16_f32 v180, v166, 0
v_mfma_f32_16x16x32_bf16 v[166:169], v[190:193], v[174:177], 0
v_mfma_f32_16x16x32_bf16 v[166:169], v[190:193], v[178:181], v[166:169]
v_mfma_f32_16x16x32_bf16 v[154:157], v[114:117], v[174:177], 0
v_mfma_f32_16x16x32_bf16 v[154:157], v[118:121], v[178:181], v[154:157]
v_mfma_f32_16x16x32_bf16 v[158:161], v[122:125], v[174:177], 0
v_mfma_f32_16x16x32_bf16 v[158:161], v[126:129], v[178:181], v[158:161]
v_mfma_f32_16x16x32_bf16 v[162:165], v[130:133], v[174:177], 0
v_mfma_f32_16x16x32_bf16 v[162:165], v[134:137], v[178:181], v[162:165]
v_rcp_f32 v151, v150
s_nop 0
v_mul_f32 v152, s3, v151
v_mul_f32 v138, v138, v152
v_mul_f32 v139, v139, v152
v_cvt_pk_bf16_f32 v138, v138, v139
v_mul_f32 v140, v140, v152
v_mul_f32 v141, v141, v152
v_cvt_pk_bf16_f32 v139, v140, v141
v_mul_f32 v142, v142, v152
v_mul_f32 v143, v143, v152
v_cvt_pk_bf16_f32 v140, v142, v143
v_mul_f32 v144, v144, v152
v_mul_f32 v145, v145, v152
v_cvt_pk_bf16_f32 v141, v144, v145
ds_write_b128 v211, v[138:141] offset:38912
v_mul_f32 v146, v146, v152
v_mul_f32 v147, v147, v152
v_cvt_pk_bf16_f32 v142, v146, v147
v_mul_f32 v148, v148, v152
v_mul_f32 v149, v149, v152
v_cvt_pk_bf16_f32 v143, v148, v149
ds_write_b64 v212, v[142:143] offset:38912
v_mfma_f32_16x16x32_bf16 v[138:141], v[78:81], v[90:93], 0
v_mfma_f32_16x16x32_bf16 v[142:145], v[96:99], v[90:93], 0
v_mfma_f32_16x16x32_bf16 v[150:153], v[108:111], v[90:93], v[206:209]
v_mfma_f32_16x16x32_bf16 v[146:149], v[102:105], v[90:93], 0
v_mfma_f32_16x16x16_bf16 v[138:141], v[82:83], v[94:95], v[138:141]
v_mfma_f32_16x16x16_bf16 v[142:145], v[100:101], v[94:95], v[142:145]
v_mfma_f32_16x16x16_bf16 v[150:153], v[112:113], v[94:95], v[150:153]
v_mfma_f32_16x16x16_bf16 v[146:149], v[106:107], v[94:95], v[146:149]
v_rcp_f32 v167, v166
s_nop 0
v_mul_f32 v168, s3, v167
v_mul_f32 v154, v154, v168
v_mul_f32 v155, v155, v168
v_cvt_pk_bf16_f32 v154, v154, v155
v_mul_f32 v156, v156, v168
v_mul_f32 v157, v157, v168
v_cvt_pk_bf16_f32 v155, v156, v157
v_mul_f32 v158, v158, v168
v_mul_f32 v159, v159, v168
v_cvt_pk_bf16_f32 v156, v158, v159
v_mul_f32 v160, v160, v168
v_mul_f32 v161, v161, v168
v_cvt_pk_bf16_f32 v157, v160, v161
ds_write_b128 v211, v[154:157] offset:45056
v_mul_f32 v162, v162, v168
v_mul_f32 v163, v163, v168
v_cvt_pk_bf16_f32 v158, v162, v163
v_mul_f32 v164, v164, v168
v_mul_f32 v165, v165, v168
v_cvt_pk_bf16_f32 v159, v164, v165
ds_write_b64 v212, v[158:159] offset:45056
v_mfma_f32_16x16x32_bf16 v[154:157], v[72:75], v[78:81], 0
v_mfma_f32_16x16x32_bf16 v[158:161], v[72:75], v[96:99], 0
v_mfma_f32_16x16x32_bf16 v[162:165], v[72:75], v[102:105], 0
v_mfma_f32_16x16x16_bf16 v[154:157], v[76:77], v[82:83], v[154:157]
v_mfma_f32_16x16x16_bf16 v[158:161], v[76:77], v[100:101], v[158:161]
v_mfma_f32_16x16x16_bf16 v[162:165], v[76:77], v[106:107], v[162:165]
ds_read_b32 v166, v215 offset:536
s_nop 2
v_mov_b32_dpp v154, v158 quad_perm:[0,1,2,3] row_mask:0x2 bank_mask:0xf
s_nop 2
v_mov_b32_dpp v154, v162 quad_perm:[0,1,2,3] row_mask:0x4 bank_mask:0xf
s_waitcnt lgkmcnt(0)
s_nop 0
v_add_f32_dpp v154, v166, v207 quad_perm:[0,1,2,3] row_mask:0x8 bank_mask:0xf
v_mov_b32 v155, v154
s_nop 1
v_max_f32_dpp v155, v155, v155 row_ror:8 row_mask:0xf bank_mask:0xf
s_nop 1
v_max_f32_dpp v155, v155, v155 row_ror:4 row_mask:0xf bank_mask:0xf
s_nop 1
v_max_f32_dpp v155, v155, v155 row_ror:2 row_mask:0xf bank_mask:0xf
s_nop 1
v_max_f32_dpp v155, v155, v155 row_ror:1 row_mask:0xf bank_mask:0xf
v_mov_b32 v156, v155
s_nop 1
v_permlane16_swap_b32 v155, v156
v_max_f32 v155, v155, v156
v_mov_b32 v156, v155
s_nop 1
v_permlane32_swap_b32 v155, v156
v_max_f32 v155, v155, v156
v_sub_f32 v154, v154, v155
v_exp_f32 v166, v154
s_nop 0
v_cvt_pk_bf16_f32 v154, v166, 0
ds_write_b16 v214, v154
v_add_f32_dpp v166, v166, v166 row_ror:8 row_mask:0xf bank_mask:0xf
s_nop 1
v_add_f32_dpp v166, v166, v166 row_ror:4 row_mask:0xf bank_mask:0xf
s_nop 1
v_add_f32_dpp v166, v166, v166 row_ror:2 row_mask:0xf bank_mask:0xf
s_nop 1
v_add_f32_dpp v166, v166, v166 row_ror:1 row_mask:0xf bank_mask:0xf
s_nop 1
v_add_f32_dpp v166, v166, v166 row_bcast:15 row_mask:0xa bank_mask:0xf
s_nop 1
v_add_f32_dpp v166, v166, v166 row_bcast:31 row_mask:0xc bank_mask:0xf
s_nop 0
v_readlane_b32 s72, v166, 63
s_nop 1
v_rcp_f32 v167, s72
s_nop 0
v_mul_f32 v168, s3, v167
ds_read_b128 v[84:87], v215
ds_read_b128 v[88:91], v215 offset:16
v_add_u32 v215, 1424, v215
s_barrier
ds_read_b128 v[220:223], v210 offset:38912
ds_read_b128 v[110:113], v210 offset:39936
s_waitcnt lgkmcnt(1)
v_mfma_f32_16x16x32_bf16 v[0:3], a[144:147], v[220:223], v[0:3]
s_waitcnt lgkmcnt(0)
v_mfma_f32_16x16x32_bf16 v[0:3], a[148:151], v[110:113], v[0:3]
v_mfma_f32_16x16x32_bf16 v[4:7], a[168:171], v[220:223], v[4:7]
v_mfma_f32_16x16x32_bf16 v[4:7], a[172:175], v[110:113], v[4:7]
v_mfma_f32_16x16x32_bf16 v[8:11], a[192:195], v[220:223], v[8:11]
v_mfma_f32_16x16x32_bf16 v[8:11], a[196:199], v[110:113], v[8:11]
ds_read_b128 v[170:173], v210 offset:40960
ds_read_b128 v[182:185], v210 offset:41984
s_waitcnt lgkmcnt(1)
v_mfma_f32_16x16x32_bf16 v[0:3], a[152:155], v[170:173], v[0:3]
s_waitcnt lgkmcnt(0)
v_mfma_f32_16x16x32_bf16 v[0:3], a[156:159], v[182:185], v[0:3]
v_mfma_f32_16x16x32_bf16 v[4:7], a[176:179], v[170:173], v[4:7]
v_mfma_f32_16x16x32_bf16 v[4:7], a[180:183], v[182:185], v[4:7]
v_mfma_f32_16x16x32_bf16 v[8:11], a[200:203], v[170:173], v[8:11]
v_mfma_f32_16x16x32_bf16 v[8:11], a[204:207], v[182:185], v[8:11]
ds_read_b128 v[186:189], v210 offset:43008
ds_read_b128 v[220:223], v210 offset:44032
s_waitcnt lgkmcnt(1)
v_mfma_f32_16x16x32_bf16 v[0:3], a[160:163], v[186:189], v[0:3]
s_waitcnt lgkmcnt(0)
v_mfma_f32_16x16x32_bf16 v[0:3], a[164:167], v[220:223], v[0:3]
v_mfma_f32_16x16x32_bf16 v[4:7], a[184:187], v[186:189], v[4:7]
v_mfma_f32_16x16x32_bf16 v[4:7], a[188:191], v[220:223], v[4:7]
v_mfma_f32_16x16x32_bf16 v[8:11], a[208:211], v[186:189], v[8:11]
v_mfma_f32_16x16x32_bf16 v[8:11], a[212:215], v[220:223], v[8:11]
v_cvt_pk_bf16_f32 v0, v0, v1
v_cvt_pk_bf16_f32 v1, v2, v3
ds_write_b64 v203, v[0:1]
v_cvt_pk_bf16_f32 v4, v4, v5
v_cvt_pk_bf16_f32 v5, v6, v7
ds_write_b64 v203, v[4:5] offset:32
v_cvt_pk_bf16_f32 v8, v8, v9
v_cvt_pk_bf16_f32 v9, v10, v11
ds_write_b64 v203, v[8:9] offset:64
v_max3_f32 v151, v138, v139, v140
v_max3_f32 v151, v151, v141, v142
v_max3_f32 v151, v151, v143, v144
v_max3_f32 v151, v151, v145, v146
v_max3_f32 v151, v151, v147, v148
v_max3_f32 v151, v151, v149, v150
v_mov_b32 v152, v151
s_nop 1
v_permlane16_swap_b32 v151, v152
v_max_f32 v151, v151, v152
v_mov_b32 v152, v151
s_nop 1
v_permlane32_swap_b32 v151, v152
v_max_f32 v151, v151, v152
v_sub_f32 v138, v138, v151
v_sub_f32 v139, v139, v151
v_sub_f32 v140, v140, v151
v_sub_f32 v141, v141, v151
v_sub_f32 v142, v142, v151
v_sub_f32 v143, v143, v151
v_sub_f32 v144, v144, v151
v_sub_f32 v145, v145, v151
v_sub_f32 v150, v150, v151
v_sub_f32 v146, v146, v151
v_sub_f32 v147, v147, v151
v_sub_f32 v148, v148, v151
v_sub_f32 v149, v149, v151
v_exp_f32 v138, v138
v_exp_f32 v139, v139
v_exp_f32 v140, v140
v_exp_f32 v141, v141
v_exp_f32 v142, v142
v_exp_f32 v143, v143
v_exp_f32 v144, v144
v_exp_f32 v145, v145
v_exp_f32 v150, v150
v_exp_f32 v146, v146
v_exp_f32 v147, v147
v_exp_f32 v148, v148
v_exp_f32 v149, v149
v_cvt_pk_bf16_f32 v174, v138, v139
v_cvt_pk_bf16_f32 v175, v140, v141
v_cvt_pk_bf16_f32 v176, v142, v143
v_cvt_pk_bf16_f32 v177, v144, v145
v_cvt_pk_bf16_f32 v178, v146, v147
v_cvt_pk_bf16_f32 v179, v148, v149
v_cvt_pk_bf16_f32 v180, v150, 0
v_mfma_f32_16x16x32_bf16 v[150:153], v[190:193], v[174:177], 0
v_mfma_f32_16x16x32_bf16 v[150:153], v[190:193], v[178:181], v[150:153]
v_mfma_f32_16x16x32_bf16 v[138:141], v[114:117], v[174:177], 0
v_mfma_f32_16x16x32_bf16 v[138:141], v[118:121], v[178:181], v[138:141]
v_mfma_f32_16x16x32_bf16 v[142:145], v[122:125], v[174:177], 0
v_mfma_f32_16x16x32_bf16 v[142:145], v[126:129], v[178:181], v[142:145]
v_mfma_f32_16x16x32_bf16 v[146:149], v[130:133], v[174:177], 0
v_mfma_f32_16x16x32_bf16 v[146:149], v[134:137], v[178:181], v[146:149]
v_rcp_f32 v151, v150
s_nop 0
v_mul_f32 v152, s3, v151
v_mul_f32 v138, v138, v152
v_mul_f32 v139, v139, v152
v_cvt_pk_bf16_f32 v138, v138, v139
v_mul_f32 v140, v140, v152
v_mul_f32 v141, v141, v152
v_cvt_pk_bf16_f32 v139, v140, v141
v_mul_f32 v142, v142, v152
v_mul_f32 v143, v143, v152
v_cvt_pk_bf16_f32 v140, v142, v143
v_mul_f32 v144, v144, v152
v_mul_f32 v145, v145, v152
v_cvt_pk_bf16_f32 v141, v144, v145
ds_write_b128 v211, v[138:141] offset:51200
v_mul_f32 v146, v146, v152
v_mul_f32 v147, v147, v152
v_cvt_pk_bf16_f32 v142, v146, v147
v_mul_f32 v148, v148, v152
v_mul_f32 v149, v149, v152
v_cvt_pk_bf16_f32 v143, v148, v149
ds_write_b64 v212, v[142:143] offset:51200
v_mfma_f32_16x16x32_bf16 v[154:157], v[84:87], v[114:117], 0
v_mfma_f32_16x16x32_bf16 v[154:157], v[88:91], v[118:121], v[154:157]
v_mfma_f32_16x16x32_bf16 v[158:161], v[84:87], v[122:125], 0
v_mfma_f32_16x16x32_bf16 v[158:161], v[88:91], v[126:129], v[158:161]
v_mfma_f32_16x16x32_bf16 v[162:165], v[84:87], v[130:133], 0
v_mfma_f32_16x16x32_bf16 v[162:165], v[88:91], v[134:137], v[162:165]
v_mov_b32_dpp v154, v158 quad_perm:[0,1,2,3] row_mask:0x2 bank_mask:0xf
s_nop 5
v_mov_b32_dpp v154, v162 quad_perm:[0,1,2,3] row_mask:0x4 bank_mask:0xf
v_mul_f32 v154, v154, v168
v_cvt_pk_bf16_f32 v154, v154, 0
ds_write_b16 v214, v154
v_add_u32 v214, 1424, v214
ds_read_b128 v[110:113], v210 offset:45056
ds_read_b128 v[170:173], v210 offset:46080
s_waitcnt lgkmcnt(1)
v_mfma_f32_16x16x32_bf16 v[12:15], a[144:147], v[110:113], v[12:15]
s_waitcnt lgkmcnt(0)
v_mfma_f32_16x16x32_bf16 v[12:15], a[148:151], v[170:173], v[12:15]
v_mfma_f32_16x16x32_bf16 v[16:19], a[168:171], v[110:113], v[16:19]
v_mfma_f32_16x16x32_bf16 v[16:19], a[172:175], v[170:173], v[16:19]
v_mfma_f32_16x16x32_bf16 v[20:23], a[192:195], v[110:113], v[20:23]
v_mfma_f32_16x16x32_bf16 v[20:23], a[196:199], v[170:173], v[20:23]
ds_read_b128 v[182:185], v210 offset:47104
ds_read_b128 v[186:189], v210 offset:48128
s_waitcnt lgkmcnt(1)
v_mfma_f32_16x16x32_bf16 v[12:15], a[152:155], v[182:185], v[12:15]
s_waitcnt lgkmcnt(0)
v_mfma_f32_16x16x32_bf16 v[12:15], a[156:159], v[186:189], v[12:15]
v_mfma_f32_16x16x32_bf16 v[16:19], a[176:179], v[182:185], v[16:19]
v_mfma_f32_16x16x32_bf16 v[16:19], a[180:183], v[186:189], v[16:19]
v_mfma_f32_16x16x32_bf16 v[20:23], a[200:203], v[182:185], v[20:23]
v_mfma_f32_16x16x32_bf16 v[20:23], a[204:207], v[186:189], v[20:23]
ds_read_b128 v[220:223], v210 offset:49152
ds_read_b128 v[110:113], v210 offset:50176
s_waitcnt lgkmcnt(1)
v_mfma_f32_16x16x32_bf16 v[12:15], a[160:163], v[220:223], v[12:15]
s_waitcnt lgkmcnt(0)
v_mfma_f32_16x16x32_bf16 v[12:15], a[164:167], v[110:113], v[12:15]
v_mfma_f32_16x16x32_bf16 v[16:19], a[184:187], v[220:223], v[16:19]
v_mfma_f32_16x16x32_bf16 v[16:19], a[188:191], v[110:113], v[16:19]
v_mfma_f32_16x16x32_bf16 v[20:23], a[208:211], v[220:223], v[20:23]
v_mfma_f32_16x16x32_bf16 v[20:23], a[212:215], v[110:113], v[20:23]
s_sub_u32 s46, s46, 1
v_cvt_pk_bf16_f32 v12, v12, v13
v_cvt_pk_bf16_f32 v13, v14, v15
ds_write_b64 v203, v[12:13] offset:6272
v_cvt_pk_bf16_f32 v16, v16, v17
v_cvt_pk_bf16_f32 v17, v18, v19
ds_write_b64 v203, v[16:17] offset:6304
v_cvt_pk_bf16_f32 v20, v20, v21
v_cvt_pk_bf16_f32 v21, v22, v23
ds_write_b64 v203, v[20:21] offset:6336
s_cbranch_scc0 G_loop
G_tail:
s_waitcnt vmcnt(0)
s_barrier
ds_read_b128 v[170:173], v210 offset:51200
ds_read_b128 v[182:185], v210 offset:52224
s_waitcnt lgkmcnt(1)
v_mfma_f32_16x16x32_bf16 v[24:27], a[144:147], v[170:173], v[24:27]
s_waitcnt lgkmcnt(0)
v_mfma_f32_16x16x32_bf16 v[24:27], a[148:151], v[182:185], v[24:27]
v_mfma_f32_16x16x32_bf16 v[28:31], a[168:171], v[170:173], v[28:31]
v_mfma_f32_16x16x32_bf16 v[28:31], a[172:175], v[182:185], v[28:31]
v_mfma_f32_16x16x32_bf16 v[32:35], a[192:195], v[170:173], v[32:35]
v_mfma_f32_16x16x32_bf16 v[32:35], a[196:199], v[182:185], v[32:35]
ds_read_b128 v[186:189], v210 offset:53248
ds_read_b128 v[220:223], v210 offset:54272
s_waitcnt lgkmcnt(1)
v_mfma_f32_16x16x32_bf16 v[24:27], a[152:155], v[186:189], v[24:27]
s_waitcnt lgkmcnt(0)
v_mfma_f32_16x16x32_bf16 v[24:27], a[156:159], v[220:223], v[24:27]
v_mfma_f32_16x16x32_bf16 v[28:31], a[176:179], v[186:189], v[28:31]
v_mfma_f32_16x16x32_bf16 v[28:31], a[180:183], v[220:223], v[28:31]
v_mfma_f32_16x16x32_bf16 v[32:35], a[200:203], v[186:189], v[32:35]
v_mfma_f32_16x16x32_bf16 v[32:35], a[204:207], v[220:223], v[32:35]
ds_read_b128 v[110:113], v210 offset:55296
ds_read_b128 v[170:173], v210 offset:56320
s_waitcnt lgkmcnt(1)
v_mfma_f32_16x16x32_bf16 v[24:27], a[160:163], v[110:113], v[24:27]
s_waitcnt lgkmcnt(0)
v_mfma_f32_16x16x32_bf16 v[24:27], a[164:167], v[170:173], v[24:27]
v_mfma_f32_16x16x32_bf16 v[28:31], a[184:187], v[110:113], v[28:31]
v_mfma_f32_16x16x32_bf16 v[28:31], a[188:191], v[170:173], v[28:31]
v_mfma_f32_16x16x32_bf16 v[32:35], a[208:211], v[110:113], v[32:35]
v_mfma_f32_16x16x32_bf16 v[32:35], a[212:215], v[170:173], v[32:35]
v_cvt_pk_bf16_f32 v24, v24, v25
v_cvt_pk_bf16_f32 v25, v26, v27
ds_write_b64 v203, v[24:25] offset:12544
v_cvt_pk_bf16_f32 v28, v28, v29
v_cvt_pk_bf16_f32 v29, v30, v31
ds_write_b64 v203, v[28:29] offset:12576
v_cvt_pk_bf16_f32 v32, v32, v33
v_cvt_pk_bf16_f32 v33, v34, v35
ds_write_b64 v203, v[32:33] offset:12608
s_waitcnt lgkmcnt(0)
s_barrier
ds_read_b64 v[120:121], v204
s_add_u32 s28, s38, s60
s_waitcnt lgkmcnt(0)
buffer_store_dwordx2 v[120:121], v204, s[8:11], s28 offen sc1
ds_read_b64 v[128:129], v204 offset:392
s_add_u32 s29, s38, s61
s_waitcnt lgkmcnt(0)
buffer_store_dwordx2 v[128:129], v204, s[8:11], s29 offen sc1
ds_read_b64 v[136:137], v204 offset:784
s_add_u32 s28, s38, s62
s_waitcnt lgkmcnt(0)
buffer_store_dwordx2 v[136:137], v204, s[8:11], s28 offen sc1
ds_read_b64 v[120:121], v204 offset:1176
s_add_u32 s29, s38, s63
s_waitcnt lgkmcnt(0)
buffer_store_dwordx2 v[120:121], v204, s[8:11], s29 offen sc1
ds_read_b64 v[128:129], v204 offset:6272
s_add_u32 s28, s38, s64
s_waitcnt lgkmcnt(0)
buffer_store_dwordx2 v[128:129], v204, s[8:11], s28 offen sc1
ds_read_b64 v[136:137], v204 offset:6664
s_add_u32 s29, s38, s65
s_waitcnt lgkmcnt(0)
buffer_store_dwordx2 v[136:137], v204, s[8:11], s29 offen sc1
ds_read_b64 v[120:121], v204 offset:7056
s_add_u32 s28, s38, s66
s_waitcnt lgkmcnt(0)
buffer_store_dwordx2 v[120:121], v204, s[8:11], s28 offen sc1
ds_read_b64 v[128:129], v204 offset:7448
s_add_u32 s29, s38, s67
s_waitcnt lgkmcnt(0)
buffer_store_dwordx2 v[128:129], v204, s[8:11], s29 offen sc1
ds_read_b64 v[136:137], v204 offset:12544
s_add_u32 s28, s38, s68
s_waitcnt lgkmcnt(0)
buffer_store_dwordx2 v[136:137], v204, s[8:11], s28 offen sc1
ds_read_b64 v[120:121], v204 offset:12936
s_add_u32 s29, s38, s69
s_waitcnt lgkmcnt(0)
buffer_store_dwordx2 v[120:121], v204, s[8:11], s29 offen sc1
ds_read_b64 v[128:129], v204 offset:13328
s_add_u32 s28, s38, s70
s_waitcnt lgkmcnt(0)
buffer_store_dwordx2 v[128:129], v204, s[8:11], s28 offen sc1
ds_read_b64 v[136:137], v204 offset:13720
s_add_u32 s29, s38, s71
s_waitcnt lgkmcnt(0)
buffer_store_dwordx2 v[136:137], v204, s[8:11], s29 offen sc1
s_mov_b32 s39, s37
ds_read_b128 v[174:177], v217
ds_read_b128 v[84:87], v200
s_waitcnt lgkmcnt(0)
v_mfma_f32_16x16x32_bf16 v[0:3], v[174:177], v[84:87], 0
ds_read_b128 v[92:95], v201
s_waitcnt lgkmcnt(0)
v_mfma_f32_16x16x32_bf16 v[12:15], v[174:177], v[92:95], 0
ds_read_b128 v[100:103], v202
s_waitcnt lgkmcnt(0)
v_mfma_f32_16x16x32_bf16 v[24:27], v[174:177], v[100:103], 0
ds_read_b128 v[178:181], v217 offset:528
ds_read_b128 v[84:87], v194
ds_read_b128 v[88:91], v194 offset:16
s_waitcnt lgkmcnt(0)
v_smfmac_f32_16x16x64_bf16 v[0:3], v[178:181], v[84:91], v213
ds_read_b128 v[92:95], v195
ds_read_b128 v[96:99], v195 offset:16
s_waitcnt lgkmcnt(0)
v_smfmac_f32_16x16x64_bf16 v[12:15], v[178:181], v[92:99], v213
ds_read_b128 v[100:103], v196
ds_read_b128 v[104:107], v196 offset:16
s_waitcnt lgkmcnt(0)
v_smfmac_f32_16x16x64_bf16 v[24:27], v[178:181], v[100:107], v213
ds_read_b128 v[174:177], v217 offset:1056
ds_read_b128 v[84:87], v197
ds_read_b128 v[88:91], v197 offset:16
s_waitcnt lgkmcnt(0)
v_smfmac_f32_16x16x64_bf16 v[0:3], v[174:177], v[84:91], v213
ds_read_b128 v[92:95], v198
ds_read_b128 v[96:99], v198 offset:16
s_waitcnt lgkmcnt(0)
v_smfmac_f32_16x16x64_bf16 v[12:15], v[174:177], v[92:99], v213
ds_read_b128 v[100:103], v199
ds_read_b128 v[104:107], v199 offset:16
s_waitcnt lgkmcnt(0)
v_smfmac_f32_16x16x64_bf16 v[24:27], v[174:177], v[100:107], v213
ds_read_b128 v[178:181], v217 offset:1584
ds_read_b128 v[84:87], v200 offset:32
s_waitcnt lgkmcnt(0)
v_mfma_f32_16x16x32_bf16 v[4:7], v[178:181], v[84:87], 0
ds_read_b128 v[92:95], v201 offset:32
s_waitcnt lgkmcnt(0)
v_mfma_f32_16x16x32_bf16 v[16:19], v[178:181], v[92:95], 0
ds_read_b128 v[100:103], v202 offset:32
s_waitcnt lgkmcnt(0)
v_mfma_f32_16x16x32_bf16 v[28:31], v[178:181], v[100:103], 0
ds_read_b128 v[174:177], v217 offset:2112
ds_read_b128 v[84:87], v194 offset:32
ds_read_b128 v[88:91], v194 offset:48
s_waitcnt lgkmcnt(0)
v_smfmac_f32_16x16x64_bf16 v[4:7], v[174:177], v[84:91], v213
ds_read_b128 v[92:95], v195 offset:32
ds_read_b128 v[96:99], v195 offset:48
s_waitcnt lgkmcnt(0)
v_smfmac_f32_16x16x64_bf16 v[16:19], v[174:177], v[92:99], v213
ds_read_b128 v[100:103], v196 offset:32
ds_read_b128 v[104:107], v196 offset:48
s_waitcnt lgkmcnt(0)
v_smfmac_f32_16x16x64_bf16 v[28:31], v[174:177], v[100:107], v213
ds_read_b128 v[178:181], v217 offset:2640
ds_read_b128 v[84:87], v197 offset:32
ds_read_b128 v[88:91], v197 offset:48
s_waitcnt lgkmcnt(0)
v_smfmac_f32_16x16x64_bf16 v[4:7], v[178:181], v[84:91], v213
ds_read_b128 v[92:95], v198 offset:32
ds_read_b128 v[96:99], v198 offset:48
s_waitcnt lgkmcnt(0)
v_smfmac_f32_16x16x64_bf16 v[16:19], v[178:181], v[92:99], v213
ds_read_b128 v[100:103], v199 offset:32
ds_read_b128 v[104:107], v199 offset:48
s_waitcnt lgkmcnt(0)
v_smfmac_f32_16x16x64_bf16 v[28:31], v[178:181], v[100:107], v213
ds_read_b128 v[174:177], v217 offset:3168
ds_read_b128 v[84:87], v200 offset:64
s_waitcnt lgkmcnt(0)
v_mfma_f32_16x16x32_bf16 v[8:11], v[174:177], v[84:87], 0
ds_read_b128 v[92:95], v201 offset:64
s_waitcnt lgkmcnt(0)
v_mfma_f32_16x16x32_bf16 v[20:23], v[174:177], v[92:95], 0
ds_read_b128 v[100:103], v202 offset:64
s_waitcnt lgkmcnt(0)
v_mfma_f32_16x16x32_bf16 v[32:35], v[174:177], v[100:103], 0
ds_read_b128 v[178:181], v217 offset:3696
ds_read_b128 v[84:87], v194 offset:64
ds_read_b128 v[88:91], v194 offset:80
s_waitcnt lgkmcnt(0)
v_smfmac_f32_16x16x64_bf16 v[8:11], v[178:181], v[84:91], v213
ds_read_b128 v[92:95], v195 offset:64
ds_read_b128 v[96:99], v195 offset:80
s_waitcnt lgkmcnt(0)
v_smfmac_f32_16x16x64_bf16 v[20:23], v[178:181], v[92:99], v213
ds_read_b128 v[100:103], v196 offset:64
ds_read_b128 v[104:107], v196 offset:80
s_waitcnt lgkmcnt(0)
v_smfmac_f32_16x16x64_bf16 v[32:35], v[178:181], v[100:107], v213
ds_read_b128 v[174:177], v217 offset:4224
ds_read_b128 v[84:87], v197 offset:64
ds_read_b128 v[88:91], v197 offset:80
s_waitcnt lgkmcnt(0)
v_smfmac_f32_16x16x64_bf16 v[8:11], v[174:177], v[84:91], v213
ds_read_b128 v[92:95], v198 offset:64
ds_read_b128 v[96:99], v198 offset:80
s_waitcnt lgkmcnt(0)
v_smfmac_f32_16x16x64_bf16 v[20:23], v[174:177], v[92:99], v213
ds_read_b128 v[100:103], v199 offset:64
ds_read_b128 v[104:107], v199 offset:80
s_waitcnt lgkmcnt(0)
v_smfmac_f32_16x16x64_bf16 v[32:35], v[174:177], v[100:107], v213
v_add_f32 v118, v0, v1
v_mul_f32 v119, v0, v0
v_add_f32 v118, v118, v2
v_fmac_f32 v119, v1, v1
v_add_f32 v118, v118, v3
v_fmac_f32 v119, v2, v2
v_fmac_f32 v119, v3, v3
v_add_f32 v126, v12, v13
v_mul_f32 v127, v12, v12
v_add_f32 v126, v126, v14
v_fmac_f32 v127, v13, v13
v_add_f32 v126, v126, v15
v_fmac_f32 v127, v14, v14
v_fmac_f32 v127, v15, v15
v_add_f32 v134, v24, v25
v_mul_f32 v135, v24, v24
v_add_f32 v134, v134, v26
v_fmac_f32 v135, v25, v25
v_add_f32 v134, v134, v27
v_fmac_f32 v135, v26, v26
v_fmac_f32 v135, v27, v27
v_add_f32 v118, v118, v4
v_fmac_f32 v119, v4, v4
v_add_f32 v118, v118, v5
v_fmac_f32 v119, v5, v5
v_add_f32 v118, v118, v6
v_fmac_f32 v119, v6, v6
v_add_f32 v118, v118, v7
v_fmac_f32 v119, v7, v7
v_add_f32 v126, v126, v16
v_fmac_f32 v127, v16, v16
v_add_f32 v126, v126, v17
v_fmac_f32 v127, v17, v17
v_add_f32 v126, v126, v18
v_fmac_f32 v127, v18, v18
v_add_f32 v126, v126, v19
v_fmac_f32 v127, v19, v19
v_add_f32 v134, v134, v28
v_fmac_f32 v135, v28, v28
v_add_f32 v134, v134, v29
v_fmac_f32 v135, v29, v29
v_add_f32 v134, v134, v30
v_fmac_f32 v135, v30, v30
v_add_f32 v134, v134, v31
v_fmac_f32 v135, v31, v31
v_add_f32 v118, v118, v8
v_fmac_f32 v119, v8, v8
v_add_f32 v118, v118, v9
v_fmac_f32 v119, v9, v9
v_add_f32 v118, v118, v10
v_fmac_f32 v119, v10, v10
v_add_f32 v118, v118, v11
v_fmac_f32 v119, v11, v11
v_add_f32 v126, v126, v20
v_fmac_f32 v127, v20, v20
v_add_f32 v126, v126, v21
v_fmac_f32 v127, v21, v21
v_add_f32 v126, v126, v22
v_fmac_f32 v127, v22, v22
v_add_f32 v126, v126, v23
v_fmac_f32 v127, v23, v23
v_add_f32 v134, v134, v32
v_fmac_f32 v135, v32, v32
v_add_f32 v134, v134, v33
v_fmac_f32 v135, v33, v33
v_add_f32 v134, v134, v34
v_fmac_f32 v135, v34, v34
v_add_f32 v134, v134, v35
v_fmac_f32 v135, v35, v35
v_permlane16_swap_b32 v118, v119
v_add_f32 v118, v118, v119
v_permlane16_swap_b32 v126, v127
v_add_f32 v126, v126, v127
v_permlane16_swap_b32 v134, v135
v_add_f32 v134, v134, v135
v_permlane32_swap_b32 v118, v126
v_add_f32 v118, v118, v126
ds_write_b32 v209, v118
v_mov_b32 v135, v134
s_nop 1
v_permlane32_swap_b32 v134, v135
v_add_f32 v134, v134, v135
ds_write_b32 v209, v134 offset:512
s_waitcnt lgkmcnt(0)
s_barrier
s_mul_hi_u32 s41, s35, 58835169
s_mul_i32 s42, s41, 73
s_sub_u32 s42, s35, s42
s_mul_i32 s43, s41, 1373568
s_mul_i32 s51, s42, 2688
s_add_u32 s50, s43, s51
s_add_u32 s35, s35, 32
s_min_u32 s41, s41, 1
s_sub_u32 s41, 1, s41
s_lshl_b32 s41, s41, 30
s_add_u32 s52, s50, s41
s_min_u32 s43, s42, 1
s_lshl_b32 s43, s43, 27
s_sub_u32 s43, 536870911, s43
s_add_u32 s51, s42, 56
s_and_b32 s51, s51, 128
s_lshl_b32 s51, s51, 22
s_or_b32 s44, s43, s51
s_mov_b32 s37, s50
v_and_b32 v216, s44, v208
s_add_u32 m0, s45, 0
s_nop 0
buffer_load_dwordx4 v216, s[4:7], s52 offen nt lds
s_add_u32 m0, s45, 4112
s_add_u32 s40, s37, 196224
buffer_load_dwordx4 v216, s[4:7], s40 offen nt lds
s_add_u32 m0, s45, 8224
s_add_u32 s40, s37, 392448
buffer_load_dwordx4 v216, s[4:7], s40 offen nt lds
s_add_u32 m0, s45, 12336
s_add_u32 s40, s37, 588672
buffer_load_dwordx4 v216, s[4:7], s40 offen nt lds
s_add_u32 m0, s45, 16448
s_add_u32 s40, s37, 784896
buffer_load_dwordx4 v216, s[4:7], s40 offen nt lds
s_add_u32 m0, s45, 20560
s_add_u32 s40, s37, 981120
buffer_load_dwordx4 v216, s[4:7], s40 offen nt lds
s_add_u32 m0, s45, 24672
s_add_u32 s40, s37, 1177344
buffer_load_dwordx4 v216, s[4:7], s40 offen nt lds
s_add_u32 m0, s45, 28784
s_add_u32 s40, s37, 1373568
buffer_load_dwordx4 v216, s[4:7], s40 offen nt lds
s_add_u32 m0, s45, 32896
s_add_u32 s40, s37, 1569792
buffer_load_dwordx4 v216, s[4:7], s40 offen nt lds
ds_read_b128 v[182:185], v210 offset:20480
ds_read_b128 v[186:189], v210 offset:21504
s_waitcnt lgkmcnt(1)
v_mfma_f32_16x16x32_bf16 v[138:141], a[0:3], v[182:185], 0
s_waitcnt lgkmcnt(0)
v_mfma_f32_16x16x32_bf16 v[138:141], a[4:7], v[186:189], v[138:141]
v_mfma_f32_16x16x32_bf16 v[142:145], a[24:27], v[182:185], 0
v_mfma_f32_16x16x32_bf16 v[142:145], a[28:31], v[186:189], v[142:145]
v_mfma_f32_16x16x32_bf16 v[146:149], a[48:51], v[182:185], 0
v_mfma_f32_16x16x32_bf16 v[146:149], a[52:55], v[186:189], v[146:149]
v_mfma_f32_16x16x32_bf16 v[150:153], a[216:219], v[182:185], 0
v_mfma_f32_16x16x32_bf16 v[150:153], a[220:223], v[186:189], v[150:153]
v_mfma_f32_16x16x32_bf16 v[154:157], a[240:243], v[182:185], 0
v_mfma_f32_16x16x32_bf16 v[154:157], a[244:247], v[186:189], v[154:157]
v_mfma_f32_16x16x32_bf16 v[158:161], v[232:235], v[182:185], 0
v_mfma_f32_16x16x32_bf16 v[158:161], v[236:239], v[186:189], v[158:161]
v_mfma_f32_16x16x32_bf16 v[162:165], v[182:185], a[72:75], 0
v_mfma_f32_16x16x32_bf16 v[162:165], v[186:189], a[76:79], v[162:165]
v_mfma_f32_16x16x32_bf16 v[166:169], v[182:185], a[96:99], 0
v_mfma_f32_16x16x32_bf16 v[166:169], v[186:189], a[100:103], v[166:169]
v_mfma_f32_16x16x32_bf16 v[170:173], v[182:185], a[120:123], 0
v_mfma_f32_16x16x32_bf16 v[170:173], v[186:189], a[124:127], v[170:173]
ds_read_b128 v[110:113], v210 offset:22528
ds_read_b128 v[220:223], v210 offset:23552
s_waitcnt lgkmcnt(1)
v_mfma_f32_16x16x32_bf16 v[138:141], a[8:11], v[110:113], v[138:141]
s_waitcnt lgkmcnt(0)
v_mfma_f32_16x16x32_bf16 v[138:141], a[12:15], v[220:223], v[138:141]
v_mfma_f32_16x16x32_bf16 v[142:145], a[32:35], v[110:113], v[142:145]
v_mfma_f32_16x16x32_bf16 v[142:145], a[36:39], v[220:223], v[142:145]
v_mfma_f32_16x16x32_bf16 v[146:149], a[56:59], v[110:113], v[146:149]
v_mfma_f32_16x16x32_bf16 v[146:149], a[60:63], v[220:223], v[146:149]
v_mfma_f32_16x16x32_bf16 v[150:153], a[224:227], v[110:113], v[150:153]
v_mfma_f32_16x16x32_bf16 v[150:153], a[228:231], v[220:223], v[150:153]
v_mfma_f32_16x16x32_bf16 v[154:157], a[248:251], v[110:113], v[154:157]
v_mfma_f32_16x16x32_bf16 v[154:157], a[252:255], v[220:223], v[154:157]
v_mfma_f32_16x16x32_bf16 v[158:161], v[240:243], v[110:113], v[158:161]
v_mfma_f32_16x16x32_bf16 v[158:161], v[244:247], v[220:223], v[158:161]
v_mfma_f32_16x16x32_bf16 v[162:165], v[110:113], a[80:83], v[162:165]
v_mfma_f32_16x16x32_bf16 v[162:165], v[220:223], a[84:87], v[162:165]
v_mfma_f32_16x16x32_bf16 v[166:169], v[110:113], a[104:107], v[166:169]
v_mfma_f32_16x16x32_bf16 v[166:169], v[220:223], a[108:111], v[166:169]
v_mfma_f32_16x16x32_bf16 v[170:173], v[110:113], a[128:131], v[170:173]
v_mfma_f32_16x16x32_bf16 v[170:173], v[220:223], a[132:135], v[170:173]
ds_read_b128 v[182:185], v210 offset:24576
ds_read_b128 v[186:189], v210 offset:25600
s_waitcnt lgkmcnt(1)
v_mfma_f32_16x16x32_bf16 v[138:141], a[16:19], v[182:185], v[138:141]
s_waitcnt lgkmcnt(0)
v_mfma_f32_16x16x32_bf16 v[138:141], a[20:23], v[186:189], v[138:141]
v_mfma_f32_16x16x32_bf16 v[142:145], a[40:43], v[182:185], v[142:145]
v_mfma_f32_16x16x32_bf16 v[142:145], a[44:47], v[186:189], v[142:145]
v_mfma_f32_16x16x32_bf16 v[146:149], a[64:67], v[182:185], v[146:149]
v_mfma_f32_16x16x32_bf16 v[146:149], a[68:71], v[186:189], v[146:149]
v_mfma_f32_16x16x32_bf16 v[150:153], a[232:235], v[182:185], v[150:153]
v_mfma_f32_16x16x32_bf16 v[150:153], a[236:239], v[186:189], v[150:153]
v_mfma_f32_16x16x32_bf16 v[154:157], v[224:227], v[182:185], v[154:157]
v_mfma_f32_16x16x32_bf16 v[154:157], v[228:231], v[186:189], v[154:157]
v_mfma_f32_16x16x32_bf16 v[158:161], v[248:251], v[182:185], v[158:161]
v_mfma_f32_16x16x32_bf16 v[158:161], v[252:255], v[186:189], v[158:161]
v_mfma_f32_16x16x32_bf16 v[162:165], v[182:185], a[88:91], v[162:165]
v_mfma_f32_16x16x32_bf16 v[162:165], v[186:189], a[92:95], v[162:165]
v_mfma_f32_16x16x32_bf16 v[166:169], v[182:185], a[112:115], v[166:169]
v_mfma_f32_16x16x32_bf16 v[166:169], v[186:189], a[116:119], v[166:169]
v_mfma_f32_16x16x32_bf16 v[170:173], v[182:185], a[136:139], v[170:173]
v_mfma_f32_16x16x32_bf16 v[170:173], v[186:189], a[140:143], v[170:173]
v_cvt_pk_bf16_f32 v78, v138, v139
v_cvt_pk_bf16_f32 v79, v140, v141
v_cvt_pk_bf16_f32 v80, v142, v143
v_cvt_pk_bf16_f32 v81, v144, v145
v_cvt_pk_bf16_f32 v82, v146, v147
v_cvt_pk_bf16_f32 v83, v148, v149
v_cvt_pk_bf16_f32 v72, v150, v151
v_cvt_pk_bf16_f32 v73, v152, v153
v_cvt_pk_bf16_f32 v74, v154, v155
v_cvt_pk_bf16_f32 v75, v156, v157
v_cvt_pk_bf16_f32 v76, v158, v159
v_cvt_pk_bf16_f32 v77, v160, v161
v_cvt_pk_bf16_f32 v114, v162, v163
v_cvt_pk_bf16_f32 v115, v164, v165
v_cvt_pk_bf16_f32 v122, v166, v167
v_cvt_pk_bf16_f32 v123, v168, v169
v_cvt_pk_bf16_f32 v130, v170, v171
v_cvt_pk_bf16_f32 v131, v172, v173
ds_read_b128 v[110:113], v210 offset:26624
ds_read_b128 v[220:223], v210 offset:27648
s_waitcnt lgkmcnt(1)
v_mfma_f32_16x16x32_bf16 v[138:141], a[0:3], v[110:113], 0
s_waitcnt lgkmcnt(0)
v_mfma_f32_16x16x32_bf16 v[138:141], a[4:7], v[220:223], v[138:141]
v_mfma_f32_16x16x32_bf16 v[142:145], a[24:27], v[110:113], 0
v_mfma_f32_16x16x32_bf16 v[142:145], a[28:31], v[220:223], v[142:145]
v_mfma_f32_16x16x32_bf16 v[146:149], a[48:51], v[110:113], 0
v_mfma_f32_16x16x32_bf16 v[146:149], a[52:55], v[220:223], v[146:149]
v_mfma_f32_16x16x32_bf16 v[150:153], a[216:219], v[110:113], 0
v_mfma_f32_16x16x32_bf16 v[150:153], a[220:223], v[220:223], v[150:153]
v_mfma_f32_16x16x32_bf16 v[154:157], a[240:243], v[110:113], 0
v_mfma_f32_16x16x32_bf16 v[154:157], a[244:247], v[220:223], v[154:157]
v_mfma_f32_16x16x32_bf16 v[158:161], v[232:235], v[110:113], 0
v_mfma_f32_16x16x32_bf16 v[158:161], v[236:239], v[220:223], v[158:161]
v_mfma_f32_16x16x32_bf16 v[162:165], v[110:113], a[72:75], 0
v_mfma_f32_16x16x32_bf16 v[162:165], v[220:223], a[76:79], v[162:165]
v_mfma_f32_16x16x32_bf16 v[166:169], v[110:113], a[96:99], 0
v_mfma_f32_16x16x32_bf16 v[166:169], v[220:223], a[100:103], v[166:169]
v_mfma_f32_16x16x32_bf16 v[170:173], v[110:113], a[120:123], 0
v_mfma_f32_16x16x32_bf16 v[170:173], v[220:223], a[124:127], v[170:173]
ds_read_b128 v[102:105], v210 offset:18432
ds_read_b128 v[106:109], v210 offset:19456
s_waitcnt lgkmcnt(1)
v_add_f32 v102, v102, v103
s_waitcnt lgkmcnt(0)
v_add_f32 v106, v106, v107
v_add_f32 v104, v104, v105
v_add_f32 v108, v108, v109
v_add_f32 v102, v102, v104
v_add_f32 v106, v106, v108
v_mul_f32 v103, s48, v102
v_mul_f32 v104, s73, v102
v_mul_f32 v106, s73, v106
v_fma_f32 v106, -v103, v104, v106
v_max_f32 v106, 0, v106
v_add_f32 v106, s49, v106
v_rsq_f32 v102, v106
s_nop 0
v_mul_f32_e64 v103, -v103, v102
ds_write_b64 v211, v[102:103]
ds_read_b64 v[118:119], v219
ds_read_b64 v[126:127], v219 offset:256
ds_read_b64 v[134:135], v219 offset:512
s_waitcnt lgkmcnt(2)
v_fma_f32 v220, v0, v118, v119
v_fma_f32 v221, v1, v118, v119
v_cvt_pk_bf16_f32 v174, v220, v221
v_fma_f32 v222, v2, v118, v119
v_fma_f32 v223, v3, v118, v119
v_cvt_pk_bf16_f32 v175, v222, v223
v_fma_f32 v220, v4, v118, v119
v_fma_f32 v221, v5, v118, v119
v_cvt_pk_bf16_f32 v176, v220, v221
v_fma_f32 v222, v6, v118, v119
v_fma_f32 v223, v7, v118, v119
v_cvt_pk_bf16_f32 v177, v222, v223
ds_write_b128 v211, v[174:177]
v_fma_f32 v220, v8, v118, v119
v_fma_f32 v221, v9, v118, v119
v_cvt_pk_bf16_f32 v178, v220, v221
v_fma_f32 v222, v10, v118, v119
v_fma_f32 v223, v11, v118, v119
v_cvt_pk_bf16_f32 v179, v222, v223
s_waitcnt lgkmcnt(2)
ds_write_b64 v212, v[178:179]
v_fma_f32 v220, v12, v126, v127
v_fma_f32 v221, v13, v126, v127
v_cvt_pk_bf16_f32 v90, v220, v221
v_fma_f32 v222, v14, v126, v127
v_fma_f32 v223, v15, v126, v127
v_cvt_pk_bf16_f32 v91, v222, v223
v_fma_f32 v220, v16, v126, v127
v_fma_f32 v221, v17, v126, v127
v_cvt_pk_bf16_f32 v92, v220, v221
v_fma_f32 v222, v18, v126, v127
v_fma_f32 v223, v19, v126, v127
v_cvt_pk_bf16_f32 v93, v222, v223
ds_write_b128 v211, v[90:93] offset:6144
v_fma_f32 v220, v20, v126, v127
v_fma_f32 v221, v21, v126, v127
v_cvt_pk_bf16_f32 v94, v220, v221
v_fma_f32 v222, v22, v126, v127
v_fma_f32 v223, v23, v126, v127
v_cvt_pk_bf16_f32 v95, v222, v223
s_waitcnt lgkmcnt(3)
ds_write_b64 v212, v[94:95] offset:6144
v_fma_f32 v220, v24, v134, v135
v_fma_f32 v221, v25, v134, v135
v_cvt_pk_bf16_f32 v90, v220, v221
v_fma_f32 v222, v26, v134, v135
v_fma_f32 v223, v27, v134, v135
v_cvt_pk_bf16_f32 v91, v222, v223
v_fma_f32 v220, v28, v134, v135
v_fma_f32 v221, v29, v134, v135
v_cvt_pk_bf16_f32 v92, v220, v221
v_fma_f32 v222, v30, v134, v135
v_fma_f32 v223, v31, v134, v135
v_cvt_pk_bf16_f32 v93, v222, v223
ds_write_b128 v211, v[90:93] offset:12288
v_fma_f32 v220, v32, v134, v135
v_fma_f32 v221, v33, v134, v135
v_cvt_pk_bf16_f32 v94, v220, v221
v_fma_f32 v222, v34, v134, v135
v_fma_f32 v223, v35, v134, v135
v_cvt_pk_bf16_f32 v95, v222, v223
ds_write_b64 v212, v[94:95] offset:12288
ds_read_b128 v[182:185], v210 offset:28672
ds_read_b128 v[186:189], v210 offset:29696
s_waitcnt lgkmcnt(1)
v_mfma_f32_16x16x32_bf16 v[138:141], a[8:11], v[182:185], v[138:141]
s_waitcnt lgkmcnt(0)
v_mfma_f32_16x16x32_bf16 v[138:141], a[12:15], v[186:189], v[138:141]
v_mfma_f32_16x16x32_bf16 v[142:145], a[32:35], v[182:185], v[142:145]
v_mfma_f32_16x16x32_bf16 v[142:145], a[36:39], v[186:189], v[142:145]
v_mfma_f32_16x16x32_bf16 v[146:149], a[56:59], v[182:185], v[146:149]
v_mfma_f32_16x16x32_bf16 v[146:149], a[60:63], v[186:189], v[146:149]
v_mfma_f32_16x16x32_bf16 v[150:153], a[224:227], v[182:185], v[150:153]
v_mfma_f32_16x16x32_bf16 v[150:153], a[228:231], v[186:189], v[150:153]
v_mfma_f32_16x16x32_bf16 v[154:157], a[248:251], v[182:185], v[154:157]
v_mfma_f32_16x16x32_bf16 v[154:157], a[252:255], v[186:189], v[154:157]
v_mfma_f32_16x16x32_bf16 v[158:161], v[240:243], v[182:185], v[158:161]
v_mfma_f32_16x16x32_bf16 v[158:161], v[244:247], v[186:189], v[158:161]
v_mfma_f32_16x16x32_bf16 v[162:165], v[182:185], a[80:83], v[162:165]
v_mfma_f32_16x16x32_bf16 v[162:165], v[186:189], a[84:87], v[162:165]
v_mfma_f32_16x16x32_bf16 v[166:169], v[182:185], a[104:107], v[166:169]
v_mfma_f32_16x16x32_bf16 v[166:169], v[186:189], a[108:111], v[166:169]
v_mfma_f32_16x16x32_bf16 v[170:173], v[182:185], a[128:131], v[170:173]
v_mfma_f32_16x16x32_bf16 v[170:173], v[186:189], a[132:135], v[170:173]
ds_read_b128 v[110:113], v210 offset:30720
ds_read_b128 v[106:109], v210 offset:31744
s_waitcnt lgkmcnt(1)
v_mfma_f32_16x16x32_bf16 v[138:141], a[16:19], v[110:113], v[138:141]
s_waitcnt lgkmcnt(0)
v_mfma_f32_16x16x32_bf16 v[138:141], a[20:23], v[106:109], v[138:141]
v_mfma_f32_16x16x32_bf16 v[142:145], a[40:43], v[110:113], v[142:145]
v_mfma_f32_16x16x32_bf16 v[142:145], a[44:47], v[106:109], v[142:145]
v_mfma_f32_16x16x32_bf16 v[146:149], a[64:67], v[110:113], v[146:149]
v_mfma_f32_16x16x32_bf16 v[146:149], a[68:71], v[106:109], v[146:149]
v_mfma_f32_16x16x32_bf16 v[150:153], a[232:235], v[110:113], v[150:153]
v_mfma_f32_16x16x32_bf16 v[150:153], a[236:239], v[106:109], v[150:153]
v_mfma_f32_16x16x32_bf16 v[154:157], v[224:227], v[110:113], v[154:157]
v_mfma_f32_16x16x32_bf16 v[154:157], v[228:231], v[106:109], v[154:157]
v_mfma_f32_16x16x32_bf16 v[158:161], v[248:251], v[110:113], v[158:161]
v_mfma_f32_16x16x32_bf16 v[158:161], v[252:255], v[106:109], v[158:161]
v_mfma_f32_16x16x32_bf16 v[162:165], v[110:113], a[88:91], v[162:165]
v_mfma_f32_16x16x32_bf16 v[162:165], v[106:109], a[92:95], v[162:165]
v_mfma_f32_16x16x32_bf16 v[166:169], v[110:113], a[112:115], v[166:169]
v_mfma_f32_16x16x32_bf16 v[166:169], v[106:109], a[116:119], v[166:169]
v_mfma_f32_16x16x32_bf16 v[170:173], v[110:113], a[136:139], v[170:173]
v_mfma_f32_16x16x32_bf16 v[170:173], v[106:109], a[140:143], v[170:173]
v_cvt_pk_bf16_f32 v96, v138, v139
v_cvt_pk_bf16_f32 v97, v140, v141
v_cvt_pk_bf16_f32 v98, v142, v143
v_cvt_pk_bf16_f32 v99, v144, v145
v_cvt_pk_bf16_f32 v100, v146, v147
v_cvt_pk_bf16_f32 v101, v148, v149
v_cvt_pk_bf16_f32 v84, v150, v151
v_cvt_pk_bf16_f32 v85, v152, v153
v_cvt_pk_bf16_f32 v86, v154, v155
v_cvt_pk_bf16_f32 v87, v156, v157
v_cvt_pk_bf16_f32 v88, v158, v159
v_cvt_pk_bf16_f32 v89, v160, v161
v_cvt_pk_bf16_f32 v116, v162, v163
v_cvt_pk_bf16_f32 v117, v164, v165
v_cvt_pk_bf16_f32 v124, v166, v167
v_cvt_pk_bf16_f32 v125, v168, v169
v_cvt_pk_bf16_f32 v132, v170, v171
v_cvt_pk_bf16_f32 v133, v172, v173
ds_read_b128 v[182:185], v210 offset:32768
ds_read_b128 v[186:189], v210 offset:33792
s_waitcnt lgkmcnt(1)
v_mfma_f32_16x16x32_bf16 v[138:141], a[0:3], v[182:185], 0
s_waitcnt lgkmcnt(0)
v_mfma_f32_16x16x32_bf16 v[138:141], a[4:7], v[186:189], v[138:141]
v_mfma_f32_16x16x32_bf16 v[142:145], a[24:27], v[182:185], 0
v_mfma_f32_16x16x32_bf16 v[142:145], a[28:31], v[186:189], v[142:145]
v_mfma_f32_16x16x32_bf16 v[146:149], a[48:51], v[182:185], 0
v_mfma_f32_16x16x32_bf16 v[146:149], a[52:55], v[186:189], v[146:149]
ds_read_b128 v[174:177], v210 offset:34816
ds_read_b128 v[178:181], v210 offset:35840
s_waitcnt lgkmcnt(1)
v_mfma_f32_16x16x32_bf16 v[138:141], a[8:11], v[174:177], v[138:141]
s_waitcnt lgkmcnt(0)
v_mfma_f32_16x16x32_bf16 v[138:141], a[12:15], v[178:181], v[138:141]
v_mfma_f32_16x16x32_bf16 v[142:145], a[32:35], v[174:177], v[142:145]
v_mfma_f32_16x16x32_bf16 v[142:145], a[36:39], v[178:181], v[142:145]
v_mfma_f32_16x16x32_bf16 v[146:149], a[56:59], v[174:177], v[146:149]
v_mfma_f32_16x16x32_bf16 v[146:149], a[60:63], v[178:181], v[146:149]
ds_read_b128 v[182:185], v210 offset:36864
ds_read_b128 v[186:189], v210 offset:37888
s_waitcnt lgkmcnt(1)
v_mfma_f32_16x16x32_bf16 v[138:141], a[16:19], v[182:185], v[138:141]
s_waitcnt lgkmcnt(0)
v_mfma_f32_16x16x32_bf16 v[138:141], a[20:23], v[186:189], v[138:141]
v_mfma_f32_16x16x32_bf16 v[142:145], a[40:43], v[182:185], v[142:145]
v_mfma_f32_16x16x32_bf16 v[142:145], a[44:47], v[186:189], v[142:145]
v_mfma_f32_16x16x32_bf16 v[146:149], a[64:67], v[182:185], v[146:149]
v_mfma_f32_16x16x32_bf16 v[146:149], a[68:71], v[186:189], v[146:149]
v_cvt_pk_bf16_f32 v102, v138, v139
v_cvt_pk_bf16_f32 v103, v140, v141
v_cvt_pk_bf16_f32 v104, v142, v143
v_cvt_pk_bf16_f32 v105, v144, v145
s_nop 2
v_cvt_pk_bf16_f32 v106, v146, v147
v_cvt_pk_bf16_f32 v107, v148, v149
ds_read_b128 v[108:111], v215 offset:512
ds_read_b64 v[112:113], v215 offset:528
v_mfma_f32_16x16x16_bf16 v[138:141], v[82:83], v[76:77], 0
v_mfma_f32_16x16x16_bf16 v[142:145], v[100:101], v[76:77], 0
s_waitcnt lgkmcnt(0)
v_mfma_f32_16x16x16_bf16 v[150:153], v[112:113], v[76:77], v[206:209]
v_mfma_f32_16x16x16_bf16 v[146:149], v[106:107], v[76:77], 0
v_mfma_f32_16x16x32_bf16 v[138:141], v[78:81], v[72:75], v[138:141]
v_mfma_f32_16x16x32_bf16 v[142:145], v[96:99], v[72:75], v[142:145]
v_mfma_f32_16x16x32_bf16 v[150:153], v[108:111], v[72:75], v[150:153]
v_mfma_f32_16x16x32_bf16 v[146:149], v[102:105], v[72:75], v[146:149]
ds_read_b128 v[72:75], v215
ds_read_b64 v[76:77], v215 offset:16
v_mfma_f32_16x16x16_bf16 v[154:157], v[82:83], v[88:89], 0
v_mfma_f32_16x16x16_bf16 v[158:161], v[100:101], v[88:89], 0
v_mfma_f32_16x16x16_bf16 v[166:169], v[112:113], v[88:89], v[206:209]
v_mfma_f32_16x16x16_bf16 v[162:165], v[106:107], v[88:89], 0
v_mfma_f32_16x16x32_bf16 v[154:157], v[78:81], v[84:87], v[154:157]
v_mfma_f32_16x16x32_bf16 v[158:161], v[96:99], v[84:87], v[158:161]
v_mfma_f32_16x16x32_bf16 v[166:169], v[108:111], v[84:87], v[166:169]
v_mfma_f32_16x16x32_bf16 v[162:165], v[102:105], v[84:87], v[162:165]
v_mfma_f32_16x16x32_bf16 v[118:121], v[182:185], a[88:91], 0
v_mfma_f32_16x16x32_bf16 v[118:121], v[186:189], a[92:95], v[118:121]
v_mfma_f32_16x16x32_bf16 v[126:129], v[182:185], a[112:115], 0
v_mfma_f32_16x16x32_bf16 v[126:129], v[186:189], a[116:119], v[126:129]
v_mfma_f32_16x16x32_bf16 v[134:137], v[182:185], a[136:139], 0
v_mfma_f32_16x16x32_bf16 v[134:137], v[186:189], a[140:143], v[134:137]
v_mfma_f32_16x16x32_bf16 v[90:93], a[232:235], v[182:185], 0
v_mfma_f32_16x16x32_bf16 v[90:93], a[236:239], v[186:189], v[90:93]
v_mfma_f32_16x16x32_bf16 v[170:173], v[224:227], v[182:185], 0
v_mfma_f32_16x16x32_bf16 v[170:173], v[228:231], v[186:189], v[170:173]
v_mfma_f32_16x16x32_bf16 v[220:223], v[248:251], v[182:185], 0
v_mfma_f32_16x16x32_bf16 v[220:223], v[252:255], v[186:189], v[220:223]
v_mfma_f32_16x16x32_bf16 v[118:121], v[174:177], a[80:83], v[118:121]
v_mfma_f32_16x16x32_bf16 v[118:121], v[178:181], a[84:87], v[118:121]
v_mfma_f32_16x16x32_bf16 v[126:129], v[174:177], a[104:107], v[126:129]
v_mfma_f32_16x16x32_bf16 v[126:129], v[178:181], a[108:111], v[126:129]
v_mfma_f32_16x16x32_bf16 v[134:137], v[174:177], a[128:131], v[134:137]
v_mfma_f32_16x16x32_bf16 v[134:137], v[178:181], a[132:135], v[134:137]
v_mfma_f32_16x16x32_bf16 v[90:93], a[224:227], v[174:177], v[90:93]
v_mfma_f32_16x16x32_bf16 v[90:93], a[228:231], v[178:181], v[90:93]
v_mfma_f32_16x16x32_bf16 v[170:173], a[248:251], v[174:177], v[170:173]
v_mfma_f32_16x16x32_bf16 v[170:173], a[252:255], v[178:181], v[170:173]
v_mfma_f32_16x16x32_bf16 v[220:223], v[240:243], v[174:177], v[220:223]
v_mfma_f32_16x16x32_bf16 v[220:223], v[244:247], v[178:181], v[220:223]
ds_read_b128 v[182:185], v210 offset:32768
ds_read_b128 v[186:189], v210 offset:33792
s_waitcnt lgkmcnt(1)
v_mfma_f32_16x16x32_bf16 v[118:121], v[182:185], a[72:75], v[118:121]
s_waitcnt lgkmcnt(0)
v_mfma_f32_16x16x32_bf16 v[118:121], v[186:189], a[76:79], v[118:121]
v_mfma_f32_16x16x32_bf16 v[126:129], v[182:185], a[96:99], v[126:129]
v_mfma_f32_16x16x32_bf16 v[126:129], v[186:189], a[100:103], v[126:129]
v_mfma_f32_16x16x32_bf16 v[134:137], v[182:185], a[120:123], v[134:137]
v_mfma_f32_16x16x32_bf16 v[134:137], v[186:189], a[124:127], v[134:137]
v_mfma_f32_16x16x32_bf16 v[90:93], a[216:219], v[182:185], v[90:93]
v_mfma_f32_16x16x32_bf16 v[90:93], a[220:223], v[186:189], v[90:93]
v_mfma_f32_16x16x32_bf16 v[170:173], a[240:243], v[182:185], v[170:173]
v_mfma_f32_16x16x32_bf16 v[170:173], a[244:247], v[186:189], v[170:173]
v_mfma_f32_16x16x32_bf16 v[220:223], v[232:235], v[182:185], v[220:223]
v_mfma_f32_16x16x32_bf16 v[220:223], v[236:239], v[186:189], v[220:223]
v_mov_b32 v181, 0
v_cvt_pk_bf16_f32 v118, v118, v119
v_cvt_pk_bf16_f32 v119, v120, v121
ds_read_u16 v120, v205
v_mov_b32 v121, 0
v_cvt_pk_bf16_f32 v126, v126, v127
v_cvt_pk_bf16_f32 v127, v128, v129
ds_read_u16 v128, v205 offset:32
v_mov_b32 v129, 0
v_cvt_pk_bf16_f32 v134, v134, v135
v_cvt_pk_bf16_f32 v135, v136, v137
ds_read_u16 v136, v205 offset:64
v_mov_b32 v137, 0
v_add_u32 v205, 1424, v205
v_cvt_pk_bf16_f32 v90, v90, v91
v_cvt_pk_bf16_f32 v91, v92, v93
v_cvt_pk_bf16_f32 v92, v170, v171
v_cvt_pk_bf16_f32 v93, v172, v173
v_cvt_pk_bf16_f32 v94, v220, v221
v_cvt_pk_bf16_f32 v95, v222, v223
v_max3_f32 v151, v138, v139, v140
v_max3_f32 v151, v151, v141, v142
v_max3_f32 v151, v151, v143, v144
v_max3_f32 v151, v151, v145, v146
v_max3_f32 v151, v151, v147, v148
v_max3_f32 v151, v151, v149, v150
v_mov_b32 v152, v151
s_nop 1
v_permlane16_swap_b32 v151, v152
v_max_f32 v151, v151, v152
v_mov_b32 v152, v151
s_nop 1
v_permlane32_swap_b32 v151, v152
v_max_f32 v151, v151, v152
v_sub_f32 v138, v138, v151
v_sub_f32 v139, v139, v151
v_sub_f32 v140, v140, v151
v_sub_f32 v141, v141, v151
v_sub_f32 v142, v142, v151
v_sub_f32 v143, v143, v151
v_sub_f32 v144, v144, v151
v_sub_f32 v145, v145, v151
v_sub_f32 v150, v150, v151
v_sub_f32 v146, v146, v151
v_sub_f32 v147, v147, v151
v_sub_f32 v148, v148, v151
v_sub_f32 v149, v149, v151
v_exp_f32 v138, v138
v_exp_f32 v139, v139
v_exp_f32 v140, v140
v_exp_f32 v141, v141
v_exp_f32 v142, v142
v_exp_f32 v143, v143
v_exp_f32 v144, v144
v_exp_f32 v145, v145
v_exp_f32 v150, v150
v_exp_f32 v146, v146
v_exp_f32 v147, v147
v_exp_f32 v148, v148
v_exp_f32 v149, v149
v_cvt_pk_bf16_f32 v174, v138, v139
v_cvt_pk_bf16_f32 v175, v140, v141
v_cvt_pk_bf16_f32 v176, v142, v143
v_cvt_pk_bf16_f32 v177, v144, v145
v_cvt_pk_bf16_f32 v178, v146, v147
v_cvt_pk_bf16_f32 v179, v148, v149
v_cvt_pk_bf16_f32 v180, v150, 0
v_mfma_f32_16x16x32_bf16 v[150:153], v[190:193], v[174:177], 0
v_mfma_f32_16x16x32_bf16 v[150:153], v[190:193], v[178:181], v[150:153]
v_mfma_f32_16x16x32_bf16 v[138:141], v[114:117], v[174:177], 0
s_waitcnt lgkmcnt(2)
v_mfma_f32_16x16x32_bf16 v[138:141], v[118:121], v[178:181], v[138:141]
v_mfma_f32_16x16x32_bf16 v[142:145], v[122:125], v[174:177], 0
s_waitcnt lgkmcnt(1)
v_mfma_f32_16x16x32_bf16 v[142:145], v[126:129], v[178:181], v[142:145]
v_mfma_f32_16x16x32_bf16 v[146:149], v[130:133], v[174:177], 0
s_waitcnt lgkmcnt(0)
v_mfma_f32_16x16x32_bf16 v[146:149], v[134:137], v[178:181], v[146:149]
v_max3_f32 v167, v154, v155, v156
v_max3_f32 v167, v167, v157, v158
v_max3_f32 v167, v167, v159, v160
v_max3_f32 v167, v167, v161, v162
v_max3_f32 v167, v167, v163, v164
v_max3_f32 v167, v167, v165, v166
v_mov_b32 v168, v167
s_nop 1
v_permlane16_swap_b32 v167, v168
v_max_f32 v167, v167, v168
v_mov_b32 v168, v167
s_nop 1
v_permlane32_swap_b32 v167, v168
v_max_f32 v167, v167, v168
v_sub_f32 v154, v154, v167
v_sub_f32 v155, v155, v167
v_sub_f32 v156, v156, v167
v_sub_f32 v157, v157, v167
v_sub_f32 v158, v158, v167
v_sub_f32 v159, v159, v167
v_sub_f32 v160, v160, v167
v_sub_f32 v161, v161, v167
v_sub_f32 v166, v166, v167
v_sub_f32 v162, v162, v167
v_sub_f32 v163, v163, v167
v_sub_f32 v164, v164, v167
v_sub_f32 v165, v165, v167
v_exp_f32 v154, v154
v_exp_f32 v155, v155
v_exp_f32 v156, v156
v_exp_f32 v157, v157
v_exp_f32 v158, v158
v_exp_f32 v159, v159
v_exp_f32 v160, v160
v_exp_f32 v161, v161
v_exp_f32 v166, v166
v_exp_f32 v162, v162
v_exp_f32 v163, v163
v_exp_f32 v164, v164
v_exp_f32 v165, v165
v_cvt_pk_bf16_f32 v174, v154, v155
v_cvt_pk_bf16_f32 v175, v156, v157
v_cvt_pk_bf16_f32 v176, v158, v159
v_cvt_pk_bf16_f32 v177, v160, v161
v_cvt_pk_bf16_f32 v178, v162, v163
v_cvt_pk_bf16_f32 v179, v164, v165
v_cvt_pk_bf16_f32 v180, v166, 0
v_mfma_f32_16x16x32_bf16 v[166:169], v[190:193], v[174:177], 0
v_mfma_f32_16x16x32_bf16 v[166:169], v[190:193], v[178:181], v[166:169]
v_mfma_f32_16x16x32_bf16 v[154:157], v[114:117], v[174:177], 0
v_mfma_f32_16x16x32_bf16 v[154:157], v[118:121], v[178:181], v[154:157]
v_mfma_f32_16x16x32_bf16 v[158:161], v[122:125], v[174:177], 0
v_mfma_f32_16x16x32_bf16 v[158:161], v[126:129], v[178:181], v[158:161]
v_mfma_f32_16x16x32_bf16 v[162:165], v[130:133], v[174:177], 0
v_mfma_f32_16x16x32_bf16 v[162:165], v[134:137], v[178:181], v[162:165]
v_rcp_f32 v151, v150
s_nop 0
v_mul_f32 v152, s3, v151
v_mul_f32 v138, v138, v152
v_mul_f32 v139, v139, v152
v_cvt_pk_bf16_f32 v138, v138, v139
v_mul_f32 v140, v140, v152
v_mul_f32 v141, v141, v152
v_cvt_pk_bf16_f32 v139, v140, v141
v_mul_f32 v142, v142, v152
v_mul_f32 v143, v143, v152
v_cvt_pk_bf16_f32 v140, v142, v143
v_mul_f32 v144, v144, v152
v_mul_f32 v145, v145, v152
v_cvt_pk_bf16_f32 v141, v144, v145
ds_write_b128 v211, v[138:141] offset:38912
v_mul_f32 v146, v146, v152
v_mul_f32 v147, v147, v152
v_cvt_pk_bf16_f32 v142, v146, v147
v_mul_f32 v148, v148, v152
v_mul_f32 v149, v149, v152
v_cvt_pk_bf16_f32 v143, v148, v149
ds_write_b64 v212, v[142:143] offset:38912
v_mfma_f32_16x16x32_bf16 v[138:141], v[78:81], v[90:93], 0
v_mfma_f32_16x16x32_bf16 v[142:145], v[96:99], v[90:93], 0
v_mfma_f32_16x16x32_bf16 v[150:153], v[108:111], v[90:93], v[206:209]
v_mfma_f32_16x16x32_bf16 v[146:149], v[102:105], v[90:93], 0
v_mfma_f32_16x16x16_bf16 v[138:141], v[82:83], v[94:95], v[138:141]
v_mfma_f32_16x16x16_bf16 v[142:145], v[100:101], v[94:95], v[142:145]
v_mfma_f32_16x16x16_bf16 v[150:153], v[112:113], v[94:95], v[150:153]
v_mfma_f32_16x16x16_bf16 v[146:149], v[106:107], v[94:95], v[146:149]
v_rcp_f32 v167, v166
s_nop 0
v_mul_f32 v168, s3, v167
v_mul_f32 v154, v154, v168
v_mul_f32 v155, v155, v168
v_cvt_pk_bf16_f32 v154, v154, v155
v_mul_f32 v156, v156, v168
v_mul_f32 v157, v157, v168
v_cvt_pk_bf16_f32 v155, v156, v157
v_mul_f32 v158, v158, v168
v_mul_f32 v159, v159, v168
v_cvt_pk_bf16_f32 v156, v158, v159
v_mul_f32 v160, v160, v168
v_mul_f32 v161, v161, v168
v_cvt_pk_bf16_f32 v157, v160, v161
ds_write_b128 v211, v[154:157] offset:45056
v_mul_f32 v162, v162, v168
v_mul_f32 v163, v163, v168
v_cvt_pk_bf16_f32 v158, v162, v163
v_mul_f32 v164, v164, v168
v_mul_f32 v165, v165, v168
v_cvt_pk_bf16_f32 v159, v164, v165
ds_write_b64 v212, v[158:159] offset:45056
v_mfma_f32_16x16x32_bf16 v[154:157], v[72:75], v[78:81], 0
v_mfma_f32_16x16x32_bf16 v[158:161], v[72:75], v[96:99], 0
v_mfma_f32_16x16x32_bf16 v[162:165], v[72:75], v[102:105], 0
v_mfma_f32_16x16x16_bf16 v[154:157], v[76:77], v[82:83], v[154:157]
v_mfma_f32_16x16x16_bf16 v[158:161], v[76:77], v[100:101], v[158:161]
v_mfma_f32_16x16x16_bf16 v[162:165], v[76:77], v[106:107], v[162:165]
ds_read_b32 v166, v215 offset:536
s_nop 2
v_mov_b32_dpp v154, v158 quad_perm:[0,1,2,3] row_mask:0x2 bank_mask:0xf
s_nop 2
v_mov_b32_dpp v154, v162 quad_perm:[0,1,2,3] row_mask:0x4 bank_mask:0xf
s_waitcnt lgkmcnt(0)
s_nop 0
v_add_f32_dpp v154, v166, v207 quad_perm:[0,1,2,3] row_mask:0x8 bank_mask:0xf
v_mov_b32 v155, v154
s_nop 1
v_max_f32_dpp v155, v155, v155 row_ror:8 row_mask:0xf bank_mask:0xf
s_nop 1
v_max_f32_dpp v155, v155, v155 row_ror:4 row_mask:0xf bank_mask:0xf
s_nop 1
v_max_f32_dpp v155, v155, v155 row_ror:2 row_mask:0xf bank_mask:0xf
s_nop 1
v_max_f32_dpp v155, v155, v155 row_ror:1 row_mask:0xf bank_mask:0xf
v_mov_b32 v156, v155
s_nop 1
v_permlane16_swap_b32 v155, v156
v_max_f32 v155, v155, v156
v_mov_b32 v156, v155
s_nop 1
v_permlane32_swap_b32 v155, v156
v_max_f32 v155, v155, v156
v_sub_f32 v154, v154, v155
v_exp_f32 v166, v154
s_nop 0
v_cvt_pk_bf16_f32 v154, v166, 0
ds_write_b16 v214, v154
v_add_f32_dpp v166, v166, v166 row_ror:8 row_mask:0xf bank_mask:0xf
s_nop 1
v_add_f32_dpp v166, v166, v166 row_ror:4 row_mask:0xf bank_mask:0xf
s_nop 1
v_add_f32_dpp v166, v166, v166 row_ror:2 row_mask:0xf bank_mask:0xf
s_nop 1
v_add_f32_dpp v166, v166, v166 row_ror:1 row_mask:0xf bank_mask:0xf
s_nop 1
v_add_f32_dpp v166, v166, v166 row_bcast:15 row_mask:0xa bank_mask:0xf
s_nop 1
v_add_f32_dpp v166, v166, v166 row_bcast:31 row_mask:0xc bank_mask:0xf
s_nop 0
v_readlane_b32 s72, v166, 63
s_nop 1
v_rcp_f32 v167, s72
s_nop 0
v_mul_f32 v168, s3, v167
ds_read_b128 v[84:87], v215
ds_read_b128 v[88:91], v215 offset:16
v_add_u32 v215, 1424, v215
s_barrier
ds_read_b128 v[220:223], v210 offset:38912
ds_read_b128 v[110:113], v210 offset:39936
s_waitcnt lgkmcnt(1)
v_mfma_f32_16x16x32_bf16 v[36:39], a[144:147], v[220:223], v[36:39]
s_waitcnt lgkmcnt(0)
v_mfma_f32_16x16x32_bf16 v[36:39], a[148:151], v[110:113], v[36:39]
v_mfma_f32_16x16x32_bf16 v[40:43], a[168:171], v[220:223], v[40:43]
v_mfma_f32_16x16x32_bf16 v[40:43], a[172:175], v[110:113], v[40:43]
v_mfma_f32_16x16x32_bf16 v[44:47], a[192:195], v[220:223], v[44:47]
v_mfma_f32_16x16x32_bf16 v[44:47], a[196:199], v[110:113], v[44:47]
ds_read_b128 v[170:173], v210 offset:40960
ds_read_b128 v[182:185], v210 offset:41984
s_waitcnt lgkmcnt(1)
v_mfma_f32_16x16x32_bf16 v[36:39], a[152:155], v[170:173], v[36:39]
s_waitcnt lgkmcnt(0)
v_mfma_f32_16x16x32_bf16 v[36:39], a[156:159], v[182:185], v[36:39]
v_mfma_f32_16x16x32_bf16 v[40:43], a[176:179], v[170:173], v[40:43]
v_mfma_f32_16x16x32_bf16 v[40:43], a[180:183], v[182:185], v[40:43]
v_mfma_f32_16x16x32_bf16 v[44:47], a[200:203], v[170:173], v[44:47]
v_mfma_f32_16x16x32_bf16 v[44:47], a[204:207], v[182:185], v[44:47]
ds_read_b128 v[186:189], v210 offset:43008
ds_read_b128 v[220:223], v210 offset:44032
s_waitcnt lgkmcnt(1)
v_mfma_f32_16x16x32_bf16 v[36:39], a[160:163], v[186:189], v[36:39]
s_waitcnt lgkmcnt(0)
v_mfma_f32_16x16x32_bf16 v[36:39], a[164:167], v[220:223], v[36:39]
v_mfma_f32_16x16x32_bf16 v[40:43], a[184:187], v[186:189], v[40:43]
v_mfma_f32_16x16x32_bf16 v[40:43], a[188:191], v[220:223], v[40:43]
v_mfma_f32_16x16x32_bf16 v[44:47], a[208:211], v[186:189], v[44:47]
v_mfma_f32_16x16x32_bf16 v[44:47], a[212:215], v[220:223], v[44:47]
v_cvt_pk_bf16_f32 v36, v36, v37
v_cvt_pk_bf16_f32 v37, v38, v39
ds_write_b64 v203, v[36:37]
v_cvt_pk_bf16_f32 v40, v40, v41
v_cvt_pk_bf16_f32 v41, v42, v43
ds_write_b64 v203, v[40:41] offset:32
v_cvt_pk_bf16_f32 v44, v44, v45
v_cvt_pk_bf16_f32 v45, v46, v47
ds_write_b64 v203, v[44:45] offset:64
v_max3_f32 v151, v138, v139, v140
v_max3_f32 v151, v151, v141, v142
v_max3_f32 v151, v151, v143, v144
v_max3_f32 v151, v151, v145, v146
v_max3_f32 v151, v151, v147, v148
v_max3_f32 v151, v151, v149, v150
v_mov_b32 v152, v151
s_nop 1
v_permlane16_swap_b32 v151, v152
v_max_f32 v151, v151, v152
v_mov_b32 v152, v151
s_nop 1
v_permlane32_swap_b32 v151, v152
v_max_f32 v151, v151, v152
v_sub_f32 v138, v138, v151
v_sub_f32 v139, v139, v151
v_sub_f32 v140, v140, v151
v_sub_f32 v141, v141, v151
v_sub_f32 v142, v142, v151
v_sub_f32 v143, v143, v151
v_sub_f32 v144, v144, v151
v_sub_f32 v145, v145, v151
v_sub_f32 v150, v150, v151
v_sub_f32 v146, v146, v151
v_sub_f32 v147, v147, v151
v_sub_f32 v148, v148, v151
v_sub_f32 v149, v149, v151
v_exp_f32 v138, v138
v_exp_f32 v139, v139
v_exp_f32 v140, v140
v_exp_f32 v141, v141
v_exp_f32 v142, v142
v_exp_f32 v143, v143
v_exp_f32 v144, v144
v_exp_f32 v145, v145
v_exp_f32 v150, v150
v_exp_f32 v146, v146
v_exp_f32 v147, v147
v_exp_f32 v148, v148
v_exp_f32 v149, v149
v_cvt_pk_bf16_f32 v174, v138, v139
v_cvt_pk_bf16_f32 v175, v140, v141
v_cvt_pk_bf16_f32 v176, v142, v143
v_cvt_pk_bf16_f32 v177, v144, v145
v_cvt_pk_bf16_f32 v178, v146, v147
v_cvt_pk_bf16_f32 v179, v148, v149
v_cvt_pk_bf16_f32 v180, v150, 0
v_mfma_f32_16x16x32_bf16 v[150:153], v[190:193], v[174:177], 0
v_mfma_f32_16x16x32_bf16 v[150:153], v[190:193], v[178:181], v[150:153]
v_mfma_f32_16x16x32_bf16 v[138:141], v[114:117], v[174:177], 0
v_mfma_f32_16x16x32_bf16 v[138:141], v[118:121], v[178:181], v[138:141]
v_mfma_f32_16x16x32_bf16 v[142:145], v[122:125], v[174:177], 0
v_mfma_f32_16x16x32_bf16 v[142:145], v[126:129], v[178:181], v[142:145]
v_mfma_f32_16x16x32_bf16 v[146:149], v[130:133], v[174:177], 0
v_mfma_f32_16x16x32_bf16 v[146:149], v[134:137], v[178:181], v[146:149]
v_rcp_f32 v151, v150
s_nop 0
v_mul_f32 v152, s3, v151
v_mul_f32 v138, v138, v152
v_mul_f32 v139, v139, v152
v_cvt_pk_bf16_f32 v138, v138, v139
v_mul_f32 v140, v140, v152
v_mul_f32 v141, v141, v152
v_cvt_pk_bf16_f32 v139, v140, v141
v_mul_f32 v142, v142, v152
v_mul_f32 v143, v143, v152
v_cvt_pk_bf16_f32 v140, v142, v143
v_mul_f32 v144, v144, v152
v_mul_f32 v145, v145, v152
v_cvt_pk_bf16_f32 v141, v144, v145
ds_write_b128 v211, v[138:141] offset:51200
v_mul_f32 v146, v146, v152
v_mul_f32 v147, v147, v152
v_cvt_pk_bf16_f32 v142, v146, v147
v_mul_f32 v148, v148, v152
v_mul_f32 v149, v149, v152
v_cvt_pk_bf16_f32 v143, v148, v149
ds_write_b64 v212, v[142:143] offset:51200
v_mfma_f32_16x16x32_bf16 v[154:157], v[84:87], v[114:117], 0
v_mfma_f32_16x16x32_bf16 v[154:157], v[88:91], v[118:121], v[154:157]
v_mfma_f32_16x16x32_bf16 v[158:161], v[84:87], v[122:125], 0
v_mfma_f32_16x16x32_bf16 v[158:161], v[88:91], v[126:129], v[158:161]
v_mfma_f32_16x16x32_bf16 v[162:165], v[84:87], v[130:133], 0
v_mfma_f32_16x16x32_bf16 v[162:165], v[88:91], v[134:137], v[162:165]
v_mov_b32_dpp v154, v158 quad_perm:[0,1,2,3] row_mask:0x2 bank_mask:0xf
s_nop 5
v_mov_b32_dpp v154, v162 quad_perm:[0,1,2,3] row_mask:0x4 bank_mask:0xf
v_mul_f32 v154, v154, v168
v_cvt_pk_bf16_f32 v154, v154, 0
ds_write_b16 v214, v154
v_add_u32 v214, 1424, v214
ds_read_b128 v[110:113], v210 offset:45056
ds_read_b128 v[170:173], v210 offset:46080
s_waitcnt lgkmcnt(1)
v_mfma_f32_16x16x32_bf16 v[48:51], a[144:147], v[110:113], v[48:51]
s_waitcnt lgkmcnt(0)
v_mfma_f32_16x16x32_bf16 v[48:51], a[148:151], v[170:173], v[48:51]
v_mfma_f32_16x16x32_bf16 v[52:55], a[168:171], v[110:113], v[52:55]
v_mfma_f32_16x16x32_bf16 v[52:55], a[172:175], v[170:173], v[52:55]
v_mfma_f32_16x16x32_bf16 v[56:59], a[192:195], v[110:113], v[56:59]
v_mfma_f32_16x16x32_bf16 v[56:59], a[196:199], v[170:173], v[56:59]
ds_read_b128 v[182:185], v210 offset:47104
ds_read_b128 v[186:189], v210 offset:48128
s_waitcnt lgkmcnt(1)
v_mfma_f32_16x16x32_bf16 v[48:51], a[152:155], v[182:185], v[48:51]
s_waitcnt lgkmcnt(0)
v_mfma_f32_16x16x32_bf16 v[48:51], a[156:159], v[186:189], v[48:51]
v_mfma_f32_16x16x32_bf16 v[52:55], a[176:179], v[182:185], v[52:55]
v_mfma_f32_16x16x32_bf16 v[52:55], a[180:183], v[186:189], v[52:55]
v_mfma_f32_16x16x32_bf16 v[56:59], a[200:203], v[182:185], v[56:59]
v_mfma_f32_16x16x32_bf16 v[56:59], a[204:207], v[186:189], v[56:59]
ds_read_b128 v[220:223], v210 offset:49152
ds_read_b128 v[110:113], v210 offset:50176
s_waitcnt lgkmcnt(1)
v_mfma_f32_16x16x32_bf16 v[48:51], a[160:163], v[220:223], v[48:51]
s_waitcnt lgkmcnt(0)
v_mfma_f32_16x16x32_bf16 v[48:51], a[164:167], v[110:113], v[48:51]
v_mfma_f32_16x16x32_bf16 v[52:55], a[184:187], v[220:223], v[52:55]
v_mfma_f32_16x16x32_bf16 v[52:55], a[188:191], v[110:113], v[52:55]
v_mfma_f32_16x16x32_bf16 v[56:59], a[208:211], v[220:223], v[56:59]
v_mfma_f32_16x16x32_bf16 v[56:59], a[212:215], v[110:113], v[56:59]
v_cvt_pk_bf16_f32 v48, v48, v49
v_cvt_pk_bf16_f32 v49, v50, v51
ds_write_b64 v203, v[48:49] offset:6272
v_cvt_pk_bf16_f32 v52, v52, v53
v_cvt_pk_bf16_f32 v53, v54, v55
ds_write_b64 v203, v[52:53] offset:6304
v_cvt_pk_bf16_f32 v56, v56, v57
v_cvt_pk_bf16_f32 v57, v58, v59
ds_write_b64 v203, v[56:57] offset:6336
s_waitcnt vmcnt(0)
s_barrier
ds_read_b128 v[170:173], v210 offset:51200
ds_read_b128 v[182:185], v210 offset:52224
s_waitcnt lgkmcnt(1)
v_mfma_f32_16x16x32_bf16 v[60:63], a[144:147], v[170:173], v[60:63]
s_waitcnt lgkmcnt(0)
v_mfma_f32_16x16x32_bf16 v[60:63], a[148:151], v[182:185], v[60:63]
v_mfma_f32_16x16x32_bf16 v[64:67], a[168:171], v[170:173], v[64:67]
v_mfma_f32_16x16x32_bf16 v[64:67], a[172:175], v[182:185], v[64:67]
v_mfma_f32_16x16x32_bf16 v[68:71], a[192:195], v[170:173], v[68:71]
v_mfma_f32_16x16x32_bf16 v[68:71], a[196:199], v[182:185], v[68:71]
ds_read_b128 v[186:189], v210 offset:53248
ds_read_b128 v[220:223], v210 offset:54272
s_waitcnt lgkmcnt(1)
v_mfma_f32_16x16x32_bf16 v[60:63], a[152:155], v[186:189], v[60:63]
s_waitcnt lgkmcnt(0)
v_mfma_f32_16x16x32_bf16 v[60:63], a[156:159], v[220:223], v[60:63]
v_mfma_f32_16x16x32_bf16 v[64:67], a[176:179], v[186:189], v[64:67]
v_mfma_f32_16x16x32_bf16 v[64:67], a[180:183], v[220:223], v[64:67]
v_mfma_f32_16x16x32_bf16 v[68:71], a[200:203], v[186:189], v[68:71]
v_mfma_f32_16x16x32_bf16 v[68:71], a[204:207], v[220:223], v[68:71]
ds_read_b128 v[110:113], v210 offset:55296
ds_read_b128 v[170:173], v210 offset:56320
s_waitcnt lgkmcnt(1)
v_mfma_f32_16x16x32_bf16 v[60:63], a[160:163], v[110:113], v[60:63]
s_waitcnt lgkmcnt(0)
v_mfma_f32_16x16x32_bf16 v[60:63], a[164:167], v[170:173], v[60:63]
v_mfma_f32_16x16x32_bf16 v[64:67], a[184:187], v[110:113], v[64:67]
v_mfma_f32_16x16x32_bf16 v[64:67], a[188:191], v[170:173], v[64:67]
v_mfma_f32_16x16x32_bf16 v[68:71], a[208:211], v[110:113], v[68:71]
v_mfma_f32_16x16x32_bf16 v[68:71], a[212:215], v[170:173], v[68:71]
v_cvt_pk_bf16_f32 v60, v60, v61
v_cvt_pk_bf16_f32 v61, v62, v63
ds_write_b64 v203, v[60:61] offset:12544
v_cvt_pk_bf16_f32 v64, v64, v65
v_cvt_pk_bf16_f32 v65, v66, v67
ds_write_b64 v203, v[64:65] offset:12576
v_cvt_pk_bf16_f32 v68, v68, v69
v_cvt_pk_bf16_f32 v69, v70, v71
ds_write_b64 v203, v[68:69] offset:12608
s_waitcnt lgkmcnt(0)
s_barrier
ds_read_b64 v[120:121], v204
s_add_u32 s28, s39, s60
s_waitcnt lgkmcnt(0)
buffer_store_dwordx2 v[120:121], v204, s[8:11], s28 offen sc1
ds_read_b64 v[128:129], v204 offset:392
s_add_u32 s29, s39, s61
s_waitcnt lgkmcnt(0)
buffer_store_dwordx2 v[128:129], v204, s[8:11], s29 offen sc1
ds_read_b64 v[136:137], v204 offset:784
s_add_u32 s28, s39, s62
s_waitcnt lgkmcnt(0)
buffer_store_dwordx2 v[136:137], v204, s[8:11], s28 offen sc1
ds_read_b64 v[120:121], v204 offset:1176
s_add_u32 s29, s39, s63
s_waitcnt lgkmcnt(0)
buffer_store_dwordx2 v[120:121], v204, s[8:11], s29 offen sc1
ds_read_b64 v[128:129], v204 offset:6272
s_add_u32 s28, s39, s64
s_waitcnt lgkmcnt(0)
buffer_store_dwordx2 v[128:129], v204, s[8:11], s28 offen sc1
ds_read_b64 v[136:137], v204 offset:6664
s_add_u32 s29, s39, s65
s_waitcnt lgkmcnt(0)
buffer_store_dwordx2 v[136:137], v204, s[8:11], s29 offen sc1
ds_read_b64 v[120:121], v204 offset:7056
s_add_u32 s28, s39, s66
s_waitcnt lgkmcnt(0)
buffer_store_dwordx2 v[120:121], v204, s[8:11], s28 offen sc1
ds_read_b64 v[128:129], v204 offset:7448
s_add_u32 s29, s39, s67
s_waitcnt lgkmcnt(0)
buffer_store_dwordx2 v[128:129], v204, s[8:11], s29 offen sc1
ds_read_b64 v[136:137], v204 offset:12544
s_add_u32 s28, s39, s68
s_waitcnt lgkmcnt(0)
buffer_store_dwordx2 v[136:137], v204, s[8:11], s28 offen sc1
ds_read_b64 v[120:121], v204 offset:12936
s_add_u32 s29, s39, s69
s_waitcnt lgkmcnt(0)
buffer_store_dwordx2 v[120:121], v204, s[8:11], s29 offen sc1
ds_read_b64 v[128:129], v204 offset:13328
s_add_u32 s28, s39, s70
s_waitcnt lgkmcnt(0)
buffer_store_dwordx2 v[128:129], v204, s[8:11], s28 offen sc1
ds_read_b64 v[136:137], v204 offset:13720
s_add_u32 s29, s39, s71
s_waitcnt lgkmcnt(0)
buffer_store_dwordx2 v[136:137], v204, s[8:11], s29 offen sc1
s_mov_b32 s38, s36
ds_read_b128 v[174:177], v217
ds_read_b128 v[84:87], v200
s_waitcnt lgkmcnt(0)
v_mfma_f32_16x16x32_bf16 v[36:39], v[174:177], v[84:87], 0
ds_read_b128 v[92:95], v201
s_waitcnt lgkmcnt(0)
v_mfma_f32_16x16x32_bf16 v[48:51], v[174:177], v[92:95], 0
ds_read_b128 v[100:103], v202
s_waitcnt lgkmcnt(0)
v_mfma_f32_16x16x32_bf16 v[60:63], v[174:177], v[100:103], 0
ds_read_b128 v[178:181], v217 offset:528
ds_read_b128 v[84:87], v194
ds_read_b128 v[88:91], v194 offset:16
s_waitcnt lgkmcnt(0)
v_smfmac_f32_16x16x64_bf16 v[36:39], v[178:181], v[84:91], v213
ds_read_b128 v[92:95], v195
ds_read_b128 v[96:99], v195 offset:16
s_waitcnt lgkmcnt(0)
v_smfmac_f32_16x16x64_bf16 v[48:51], v[178:181], v[92:99], v213
ds_read_b128 v[100:103], v196
ds_read_b128 v[104:107], v196 offset:16
s_waitcnt lgkmcnt(0)
v_smfmac_f32_16x16x64_bf16 v[60:63], v[178:181], v[100:107], v213
ds_read_b128 v[174:177], v217 offset:1056
ds_read_b128 v[84:87], v197
ds_read_b128 v[88:91], v197 offset:16
s_waitcnt lgkmcnt(0)
v_smfmac_f32_16x16x64_bf16 v[36:39], v[174:177], v[84:91], v213
ds_read_b128 v[92:95], v198
ds_read_b128 v[96:99], v198 offset:16
s_waitcnt lgkmcnt(0)
v_smfmac_f32_16x16x64_bf16 v[48:51], v[174:177], v[92:99], v213
ds_read_b128 v[100:103], v199
ds_read_b128 v[104:107], v199 offset:16
s_waitcnt lgkmcnt(0)
v_smfmac_f32_16x16x64_bf16 v[60:63], v[174:177], v[100:107], v213
ds_read_b128 v[178:181], v217 offset:1584
ds_read_b128 v[84:87], v200 offset:32
s_waitcnt lgkmcnt(0)
v_mfma_f32_16x16x32_bf16 v[40:43], v[178:181], v[84:87], 0
ds_read_b128 v[92:95], v201 offset:32
s_waitcnt lgkmcnt(0)
v_mfma_f32_16x16x32_bf16 v[52:55], v[178:181], v[92:95], 0
ds_read_b128 v[100:103], v202 offset:32
s_waitcnt lgkmcnt(0)
v_mfma_f32_16x16x32_bf16 v[64:67], v[178:181], v[100:103], 0
ds_read_b128 v[174:177], v217 offset:2112
ds_read_b128 v[84:87], v194 offset:32
ds_read_b128 v[88:91], v194 offset:48
s_waitcnt lgkmcnt(0)
v_smfmac_f32_16x16x64_bf16 v[40:43], v[174:177], v[84:91], v213
ds_read_b128 v[92:95], v195 offset:32
ds_read_b128 v[96:99], v195 offset:48
s_waitcnt lgkmcnt(0)
v_smfmac_f32_16x16x64_bf16 v[52:55], v[174:177], v[92:99], v213
ds_read_b128 v[100:103], v196 offset:32
ds_read_b128 v[104:107], v196 offset:48
s_waitcnt lgkmcnt(0)
v_smfmac_f32_16x16x64_bf16 v[64:67], v[174:177], v[100:107], v213
ds_read_b128 v[178:181], v217 offset:2640
ds_read_b128 v[84:87], v197 offset:32
ds_read_b128 v[88:91], v197 offset:48
s_waitcnt lgkmcnt(0)
v_smfmac_f32_16x16x64_bf16 v[40:43], v[178:181], v[84:91], v213
ds_read_b128 v[92:95], v198 offset:32
ds_read_b128 v[96:99], v198 offset:48
s_waitcnt lgkmcnt(0)
v_smfmac_f32_16x16x64_bf16 v[52:55], v[178:181], v[92:99], v213
ds_read_b128 v[100:103], v199 offset:32
ds_read_b128 v[104:107], v199 offset:48
s_waitcnt lgkmcnt(0)
v_smfmac_f32_16x16x64_bf16 v[64:67], v[178:181], v[100:107], v213
ds_read_b128 v[174:177], v217 offset:3168
ds_read_b128 v[84:87], v200 offset:64
s_waitcnt lgkmcnt(0)
v_mfma_f32_16x16x32_bf16 v[44:47], v[174:177], v[84:87], 0
ds_read_b128 v[92:95], v201 offset:64
s_waitcnt lgkmcnt(0)
v_mfma_f32_16x16x32_bf16 v[56:59], v[174:177], v[92:95], 0
ds_read_b128 v[100:103], v202 offset:64
s_waitcnt lgkmcnt(0)
v_mfma_f32_16x16x32_bf16 v[68:71], v[174:177], v[100:103], 0
ds_read_b128 v[178:181], v217 offset:3696
ds_read_b128 v[84:87], v194 offset:64
ds_read_b128 v[88:91], v194 offset:80
s_waitcnt lgkmcnt(0)
v_smfmac_f32_16x16x64_bf16 v[44:47], v[178:181], v[84:91], v213
ds_read_b128 v[92:95], v195 offset:64
ds_read_b128 v[96:99], v195 offset:80
s_waitcnt lgkmcnt(0)
v_smfmac_f32_16x16x64_bf16 v[56:59], v[178:181], v[92:99], v213
ds_read_b128 v[100:103], v196 offset:64
ds_read_b128 v[104:107], v196 offset:80
s_waitcnt lgkmcnt(0)
v_smfmac_f32_16x16x64_bf16 v[68:71], v[178:181], v[100:107], v213
ds_read_b128 v[174:177], v217 offset:4224
ds_read_b128 v[84:87], v197 offset:64
ds_read_b128 v[88:91], v197 offset:80
s_waitcnt lgkmcnt(0)
v_smfmac_f32_16x16x64_bf16 v[44:47], v[174:177], v[84:91], v213
ds_read_b128 v[92:95], v198 offset:64
ds_read_b128 v[96:99], v198 offset:80
s_waitcnt lgkmcnt(0)
v_smfmac_f32_16x16x64_bf16 v[56:59], v[174:177], v[92:99], v213
ds_read_b128 v[100:103], v199 offset:64
ds_read_b128 v[104:107], v199 offset:80
s_waitcnt lgkmcnt(0)
v_smfmac_f32_16x16x64_bf16 v[68:71], v[174:177], v[100:107], v213
v_add_f32 v118, v36, v37
v_mul_f32 v119, v36, v36
v_add_f32 v118, v118, v38
v_fmac_f32 v119, v37, v37
v_add_f32 v118, v118, v39
v_fmac_f32 v119, v38, v38
v_fmac_f32 v119, v39, v39
v_add_f32 v126, v48, v49
v_mul_f32 v127, v48, v48
v_add_f32 v126, v126, v50
v_fmac_f32 v127, v49, v49
v_add_f32 v126, v126, v51
v_fmac_f32 v127, v50, v50
v_fmac_f32 v127, v51, v51
v_add_f32 v134, v60, v61
v_mul_f32 v135, v60, v60
v_add_f32 v134, v134, v62
v_fmac_f32 v135, v61, v61
v_add_f32 v134, v134, v63
v_fmac_f32 v135, v62, v62
v_fmac_f32 v135, v63, v63
v_add_f32 v118, v118, v40
v_fmac_f32 v119, v40, v40
v_add_f32 v118, v118, v41
v_fmac_f32 v119, v41, v41
v_add_f32 v118, v118, v42
v_fmac_f32 v119, v42, v42
v_add_f32 v118, v118, v43
v_fmac_f32 v119, v43, v43
v_add_f32 v126, v126, v52
v_fmac_f32 v127, v52, v52
v_add_f32 v126, v126, v53
v_fmac_f32 v127, v53, v53
v_add_f32 v126, v126, v54
v_fmac_f32 v127, v54, v54
v_add_f32 v126, v126, v55
v_fmac_f32 v127, v55, v55
v_add_f32 v134, v134, v64
v_fmac_f32 v135, v64, v64
v_add_f32 v134, v134, v65
v_fmac_f32 v135, v65, v65
v_add_f32 v134, v134, v66
v_fmac_f32 v135, v66, v66
v_add_f32 v134, v134, v67
v_fmac_f32 v135, v67, v67
v_add_f32 v118, v118, v44
v_fmac_f32 v119, v44, v44
v_add_f32 v118, v118, v45
v_fmac_f32 v119, v45, v45
v_add_f32 v118, v118, v46
v_fmac_f32 v119, v46, v46
v_add_f32 v118, v118, v47
v_fmac_f32 v119, v47, v47
v_add_f32 v126, v126, v56
v_fmac_f32 v127, v56, v56
v_add_f32 v126, v126, v57
v_fmac_f32 v127, v57, v57
v_add_f32 v126, v126, v58
v_fmac_f32 v127, v58, v58
v_add_f32 v126, v126, v59
v_fmac_f32 v127, v59, v59
v_add_f32 v134, v134, v68
v_fmac_f32 v135, v68, v68
v_add_f32 v134, v134, v69
v_fmac_f32 v135, v69, v69
v_add_f32 v134, v134, v70
v_fmac_f32 v135, v70, v70
v_add_f32 v134, v134, v71
v_fmac_f32 v135, v71, v71
v_permlane16_swap_b32 v118, v119
v_add_f32 v118, v118, v119
v_permlane16_swap_b32 v126, v127
v_add_f32 v126, v126, v127
v_permlane16_swap_b32 v134, v135
v_add_f32 v134, v134, v135
v_permlane32_swap_b32 v118, v126
v_add_f32 v118, v118, v126
ds_write_b32 v209, v118
v_mov_b32 v135, v134
s_nop 1
v_permlane32_swap_b32 v134, v135
v_add_f32 v134, v134, v135
ds_write_b32 v209, v134 offset:512
s_waitcnt lgkmcnt(0)
s_barrier
s_mov_b32 s35, s97
s_mul_hi_u32 s41, s35, 58835169
s_mul_i32 s42, s41, 73
s_sub_u32 s42, s35, s42
s_mul_i32 s43, s41, 1373568
s_mul_i32 s51, s42, 2688
s_add_u32 s50, s43, s51
s_add_u32 s35, s35, 32
s_min_u32 s41, s41, 1
s_sub_u32 s41, 1, s41
s_lshl_b32 s41, s41, 30
s_add_u32 s52, s50, s41
s_min_u32 s43, s42, 1
s_lshl_b32 s43, s43, 27
s_sub_u32 s43, 536870911, s43
s_add_u32 s51, s42, 56
s_and_b32 s51, s51, 128
s_lshl_b32 s51, s51, 22
s_or_b32 s44, s43, s51
s_mov_b32 s36, s50
v_and_b32 v216, s44, v208
s_add_u32 m0, s45, 0
s_nop 0
buffer_load_dwordx4 v216, s[4:7], s52 offen nt lds
s_add_u32 m0, s45, 4112
s_add_u32 s40, s36, 196224
buffer_load_dwordx4 v216, s[4:7], s40 offen nt lds
s_add_u32 m0, s45, 8224
s_add_u32 s40, s36, 392448
buffer_load_dwordx4 v216, s[4:7], s40 offen nt lds
s_add_u32 m0, s45, 12336
s_add_u32 s40, s36, 588672
buffer_load_dwordx4 v216, s[4:7], s40 offen nt lds
s_add_u32 m0, s45, 16448
s_add_u32 s40, s36, 784896
buffer_load_dwordx4 v216, s[4:7], s40 offen nt lds
s_add_u32 m0, s45, 20560
s_add_u32 s40, s36, 981120
buffer_load_dwordx4 v216, s[4:7], s40 offen nt lds
s_add_u32 m0, s45, 24672
s_add_u32 s40, s36, 1177344
buffer_load_dwordx4 v216, s[4:7], s40 offen nt lds
s_add_u32 m0, s45, 28784
s_add_u32 s40, s36, 1373568
buffer_load_dwordx4 v216, s[4:7], s40 offen nt lds
s_add_u32 m0, s45, 32896
s_add_u32 s40, s36, 1569792
buffer_load_dwordx4 v216, s[4:7], s40 offen nt lds
ds_read_b128 v[182:185], v210
ds_read_b128 v[186:189], v210 offset:1024
s_waitcnt lgkmcnt(1)
v_mfma_f32_16x16x32_bf16 v[138:141], a[0:3], v[182:185], 0
s_waitcnt lgkmcnt(0)
v_mfma_f32_16x16x32_bf16 v[138:141], a[4:7], v[186:189], v[138:141]
v_mfma_f32_16x16x32_bf16 v[142:145], a[24:27], v[182:185], 0
v_mfma_f32_16x16x32_bf16 v[142:145], a[28:31], v[186:189], v[142:145]
v_mfma_f32_16x16x32_bf16 v[146:149], a[48:51], v[182:185], 0
v_mfma_f32_16x16x32_bf16 v[146:149], a[52:55], v[186:189], v[146:149]
v_mfma_f32_16x16x32_bf16 v[150:153], a[216:219], v[182:185], 0
v_mfma_f32_16x16x32_bf16 v[150:153], a[220:223], v[186:189], v[150:153]
v_mfma_f32_16x16x32_bf16 v[154:157], a[240:243], v[182:185], 0
v_mfma_f32_16x16x32_bf16 v[154:157], a[244:247], v[186:189], v[154:157]
v_mfma_f32_16x16x32_bf16 v[158:161], v[232:235], v[182:185], 0
v_mfma_f32_16x16x32_bf16 v[158:161], v[236:239], v[186:189], v[158:161]
v_mfma_f32_16x16x32_bf16 v[162:165], v[182:185], a[72:75], 0
v_mfma_f32_16x16x32_bf16 v[162:165], v[186:189], a[76:79], v[162:165]
v_mfma_f32_16x16x32_bf16 v[166:169], v[182:185], a[96:99], 0
v_mfma_f32_16x16x32_bf16 v[166:169], v[186:189], a[100:103], v[166:169]
v_mfma_f32_16x16x32_bf16 v[170:173], v[182:185], a[120:123], 0
v_mfma_f32_16x16x32_bf16 v[170:173], v[186:189], a[124:127], v[170:173]
ds_read_b128 v[110:113], v210 offset:2048
ds_read_b128 v[220:223], v210 offset:3072
s_waitcnt lgkmcnt(1)
v_mfma_f32_16x16x32_bf16 v[138:141], a[8:11], v[110:113], v[138:141]
s_waitcnt lgkmcnt(0)
v_mfma_f32_16x16x32_bf16 v[138:141], a[12:15], v[220:223], v[138:141]
v_mfma_f32_16x16x32_bf16 v[142:145], a[32:35], v[110:113], v[142:145]
v_mfma_f32_16x16x32_bf16 v[142:145], a[36:39], v[220:223], v[142:145]
v_mfma_f32_16x16x32_bf16 v[146:149], a[56:59], v[110:113], v[146:149]
v_mfma_f32_16x16x32_bf16 v[146:149], a[60:63], v[220:223], v[146:149]
v_mfma_f32_16x16x32_bf16 v[150:153], a[224:227], v[110:113], v[150:153]
v_mfma_f32_16x16x32_bf16 v[150:153], a[228:231], v[220:223], v[150:153]
v_mfma_f32_16x16x32_bf16 v[154:157], a[248:251], v[110:113], v[154:157]
v_mfma_f32_16x16x32_bf16 v[154:157], a[252:255], v[220:223], v[154:157]
v_mfma_f32_16x16x32_bf16 v[158:161], v[240:243], v[110:113], v[158:161]
v_mfma_f32_16x16x32_bf16 v[158:161], v[244:247], v[220:223], v[158:161]
v_mfma_f32_16x16x32_bf16 v[162:165], v[110:113], a[80:83], v[162:165]
v_mfma_f32_16x16x32_bf16 v[162:165], v[220:223], a[84:87], v[162:165]
v_mfma_f32_16x16x32_bf16 v[166:169], v[110:113], a[104:107], v[166:169]
v_mfma_f32_16x16x32_bf16 v[166:169], v[220:223], a[108:111], v[166:169]
v_mfma_f32_16x16x32_bf16 v[170:173], v[110:113], a[128:131], v[170:173]
v_mfma_f32_16x16x32_bf16 v[170:173], v[220:223], a[132:135], v[170:173]
ds_read_b128 v[182:185], v210 offset:4096
ds_read_b128 v[186:189], v210 offset:5120
s_waitcnt lgkmcnt(1)
v_mfma_f32_16x16x32_bf16 v[138:141], a[16:19], v[182:185], v[138:141]
s_waitcnt lgkmcnt(0)
v_mfma_f32_16x16x32_bf16 v[138:141], a[20:23], v[186:189], v[138:141]
v_mfma_f32_16x16x32_bf16 v[142:145], a[40:43], v[182:185], v[142:145]
v_mfma_f32_16x16x32_bf16 v[142:145], a[44:47], v[186:189], v[142:145]
v_mfma_f32_16x16x32_bf16 v[146:149], a[64:67], v[182:185], v[146:149]
v_mfma_f32_16x16x32_bf16 v[146:149], a[68:71], v[186:189], v[146:149]
v_mfma_f32_16x16x32_bf16 v[150:153], a[232:235], v[182:185], v[150:153]
v_mfma_f32_16x16x32_bf16 v[150:153], a[236:239], v[186:189], v[150:153]
v_mfma_f32_16x16x32_bf16 v[154:157], v[224:227], v[182:185], v[154:157]
v_mfma_f32_16x16x32_bf16 v[154:157], v[228:231], v[186:189], v[154:157]
v_mfma_f32_16x16x32_bf16 v[158:161], v[248:251], v[182:185], v[158:161]
v_mfma_f32_16x16x32_bf16 v[158:161], v[252:255], v[186:189], v[158:161]
v_mfma_f32_16x16x32_bf16 v[162:165], v[182:185], a[88:91], v[162:165]
v_mfma_f32_16x16x32_bf16 v[162:165], v[186:189], a[92:95], v[162:165]
v_mfma_f32_16x16x32_bf16 v[166:169], v[182:185], a[112:115], v[166:169]
v_mfma_f32_16x16x32_bf16 v[166:169], v[186:189], a[116:119], v[166:169]
v_mfma_f32_16x16x32_bf16 v[170:173], v[182:185], a[136:139], v[170:173]
v_mfma_f32_16x16x32_bf16 v[170:173], v[186:189], a[140:143], v[170:173]
v_cvt_pk_bf16_f32 v78, v138, v139
v_cvt_pk_bf16_f32 v79, v140, v141
v_cvt_pk_bf16_f32 v80, v142, v143
v_cvt_pk_bf16_f32 v81, v144, v145
v_cvt_pk_bf16_f32 v82, v146, v147
v_cvt_pk_bf16_f32 v83, v148, v149
v_cvt_pk_bf16_f32 v72, v150, v151
v_cvt_pk_bf16_f32 v73, v152, v153
v_cvt_pk_bf16_f32 v74, v154, v155
v_cvt_pk_bf16_f32 v75, v156, v157
v_cvt_pk_bf16_f32 v76, v158, v159
v_cvt_pk_bf16_f32 v77, v160, v161
v_cvt_pk_bf16_f32 v114, v162, v163
v_cvt_pk_bf16_f32 v115, v164, v165
v_cvt_pk_bf16_f32 v122, v166, v167
v_cvt_pk_bf16_f32 v123, v168, v169
v_cvt_pk_bf16_f32 v130, v170, v171
v_cvt_pk_bf16_f32 v131, v172, v173
ds_read_b128 v[110:113], v210 offset:6144
ds_read_b128 v[220:223], v210 offset:7168
s_waitcnt lgkmcnt(1)
v_mfma_f32_16x16x32_bf16 v[138:141], a[0:3], v[110:113], 0
s_waitcnt lgkmcnt(0)
v_mfma_f32_16x16x32_bf16 v[138:141], a[4:7], v[220:223], v[138:141]
v_mfma_f32_16x16x32_bf16 v[142:145], a[24:27], v[110:113], 0
v_mfma_f32_16x16x32_bf16 v[142:145], a[28:31], v[220:223], v[142:145]
v_mfma_f32_16x16x32_bf16 v[146:149], a[48:51], v[110:113], 0
v_mfma_f32_16x16x32_bf16 v[146:149], a[52:55], v[220:223], v[146:149]
v_mfma_f32_16x16x32_bf16 v[150:153], a[216:219], v[110:113], 0
v_mfma_f32_16x16x32_bf16 v[150:153], a[220:223], v[220:223], v[150:153]
v_mfma_f32_16x16x32_bf16 v[154:157], a[240:243], v[110:113], 0
v_mfma_f32_16x16x32_bf16 v[154:157], a[244:247], v[220:223], v[154:157]
v_mfma_f32_16x16x32_bf16 v[158:161], v[232:235], v[110:113], 0
v_mfma_f32_16x16x32_bf16 v[158:161], v[236:239], v[220:223], v[158:161]
v_mfma_f32_16x16x32_bf16 v[162:165], v[110:113], a[72:75], 0
v_mfma_f32_16x16x32_bf16 v[162:165], v[220:223], a[76:79], v[162:165]
v_mfma_f32_16x16x32_bf16 v[166:169], v[110:113], a[96:99], 0
v_mfma_f32_16x16x32_bf16 v[166:169], v[220:223], a[100:103], v[166:169]
v_mfma_f32_16x16x32_bf16 v[170:173], v[110:113], a[120:123], 0
v_mfma_f32_16x16x32_bf16 v[170:173], v[220:223], a[124:127], v[170:173]
ds_read_b128 v[102:105], v210 offset:18432
ds_read_b128 v[106:109], v210 offset:19456
s_waitcnt lgkmcnt(1)
v_add_f32 v102, v102, v103
s_waitcnt lgkmcnt(0)
v_add_f32 v106, v106, v107
v_add_f32 v104, v104, v105
v_add_f32 v108, v108, v109
v_add_f32 v102, v102, v104
v_add_f32 v106, v106, v108
v_mul_f32 v103, s48, v102
v_mul_f32 v104, s73, v102
v_mul_f32 v106, s73, v106
v_fma_f32 v106, -v103, v104, v106
v_max_f32 v106, 0, v106
v_add_f32 v106, s49, v106
v_rsq_f32 v102, v106
s_nop 0
v_mul_f32_e64 v103, -v103, v102
ds_write_b64 v211, v[102:103] offset:20480
ds_read_b64 v[118:119], v219 offset:20480
ds_read_b64 v[126:127], v219 offset:20736
ds_read_b64 v[134:135], v219 offset:20992
s_waitcnt lgkmcnt(2)
v_fma_f32 v220, v36, v118, v119
v_fma_f32 v221, v37, v118, v119
v_cvt_pk_bf16_f32 v174, v220, v221
v_fma_f32 v222, v38, v118, v119
v_fma_f32 v223, v39, v118, v119
v_cvt_pk_bf16_f32 v175, v222, v223
v_fma_f32 v220, v40, v118, v119
v_fma_f32 v221, v41, v118, v119
v_cvt_pk_bf16_f32 v176, v220, v221
v_fma_f32 v222, v42, v118, v119
v_fma_f32 v223, v43, v118, v119
v_cvt_pk_bf16_f32 v177, v222, v223
ds_write_b128 v211, v[174:177] offset:20480
v_fma_f32 v220, v44, v118, v119
v_fma_f32 v221, v45, v118, v119
v_cvt_pk_bf16_f32 v178, v220, v221
v_fma_f32 v222, v46, v118, v119
v_fma_f32 v223, v47, v118, v119
v_cvt_pk_bf16_f32 v179, v222, v223
s_waitcnt lgkmcnt(2)
ds_write_b64 v212, v[178:179] offset:20480
v_fma_f32 v220, v48, v126, v127
v_fma_f32 v221, v49, v126, v127
v_cvt_pk_bf16_f32 v90, v220, v221
v_fma_f32 v222, v50, v126, v127
v_fma_f32 v223, v51, v126, v127
v_cvt_pk_bf16_f32 v91, v222, v223
v_fma_f32 v220, v52, v126, v127
v_fma_f32 v221, v53, v126, v127
v_cvt_pk_bf16_f32 v92, v220, v221
v_fma_f32 v222, v54, v126, v127
v_fma_f32 v223, v55, v126, v127
v_cvt_pk_bf16_f32 v93, v222, v223
ds_write_b128 v211, v[90:93] offset:26624
v_fma_f32 v220, v56, v126, v127
v_fma_f32 v221, v57, v126, v127
v_cvt_pk_bf16_f32 v94, v220, v221
v_fma_f32 v222, v58, v126, v127
v_fma_f32 v223, v59, v126, v127
v_cvt_pk_bf16_f32 v95, v222, v223
s_waitcnt lgkmcnt(3)
ds_write_b64 v212, v[94:95] offset:26624
v_fma_f32 v220, v60, v134, v135
v_fma_f32 v221, v61, v134, v135
v_cvt_pk_bf16_f32 v90, v220, v221
v_fma_f32 v222, v62, v134, v135
v_fma_f32 v223, v63, v134, v135
v_cvt_pk_bf16_f32 v91, v222, v223
v_fma_f32 v220, v64, v134, v135
v_fma_f32 v221, v65, v134, v135
v_cvt_pk_bf16_f32 v92, v220, v221
v_fma_f32 v222, v66, v134, v135
v_fma_f32 v223, v67, v134, v135
v_cvt_pk_bf16_f32 v93, v222, v223
ds_write_b128 v211, v[90:93] offset:32768
v_fma_f32 v220, v68, v134, v135
v_fma_f32 v221, v69, v134, v135
v_cvt_pk_bf16_f32 v94, v220, v221
v_fma_f32 v222, v70, v134, v135
v_fma_f32 v223, v71, v134, v135
v_cvt_pk_bf16_f32 v95, v222, v223
ds_write_b64 v212, v[94:95] offset:32768
ds_read_b128 v[182:185], v210 offset:8192
ds_read_b128 v[186:189], v210 offset:9216
s_waitcnt lgkmcnt(1)
v_mfma_f32_16x16x32_bf16 v[138:141], a[8:11], v[182:185], v[138:141]
s_waitcnt lgkmcnt(0)
v_mfma_f32_16x16x32_bf16 v[138:141], a[12:15], v[186:189], v[138:141]
v_mfma_f32_16x16x32_bf16 v[142:145], a[32:35], v[182:185], v[142:145]
v_mfma_f32_16x16x32_bf16 v[142:145], a[36:39], v[186:189], v[142:145]
v_mfma_f32_16x16x32_bf16 v[146:149], a[56:59], v[182:185], v[146:149]
v_mfma_f32_16x16x32_bf16 v[146:149], a[60:63], v[186:189], v[146:149]
v_mfma_f32_16x16x32_bf16 v[150:153], a[224:227], v[182:185], v[150:153]
v_mfma_f32_16x16x32_bf16 v[150:153], a[228:231], v[186:189], v[150:153]
v_mfma_f32_16x16x32_bf16 v[154:157], a[248:251], v[182:185], v[154:157]
v_mfma_f32_16x16x32_bf16 v[154:157], a[252:255], v[186:189], v[154:157]
v_mfma_f32_16x16x32_bf16 v[158:161], v[240:243], v[182:185], v[158:161]
v_mfma_f32_16x16x32_bf16 v[158:161], v[244:247], v[186:189], v[158:161]
v_mfma_f32_16x16x32_bf16 v[162:165], v[182:185], a[80:83], v[162:165]
v_mfma_f32_16x16x32_bf16 v[162:165], v[186:189], a[84:87], v[162:165]
v_mfma_f32_16x16x32_bf16 v[166:169], v[182:185], a[104:107], v[166:169]
v_mfma_f32_16x16x32_bf16 v[166:169], v[186:189], a[108:111], v[166:169]
v_mfma_f32_16x16x32_bf16 v[170:173], v[182:185], a[128:131], v[170:173]
v_mfma_f32_16x16x32_bf16 v[170:173], v[186:189], a[132:135], v[170:173]
ds_read_b128 v[110:113], v210 offset:10240
ds_read_b128 v[106:109], v210 offset:11264
s_waitcnt lgkmcnt(1)
v_mfma_f32_16x16x32_bf16 v[138:141], a[16:19], v[110:113], v[138:141]
s_waitcnt lgkmcnt(0)
v_mfma_f32_16x16x32_bf16 v[138:141], a[20:23], v[106:109], v[138:141]
v_mfma_f32_16x16x32_bf16 v[142:145], a[40:43], v[110:113], v[142:145]
v_mfma_f32_16x16x32_bf16 v[142:145], a[44:47], v[106:109], v[142:145]
v_mfma_f32_16x16x32_bf16 v[146:149], a[64:67], v[110:113], v[146:149]
v_mfma_f32_16x16x32_bf16 v[146:149], a[68:71], v[106:109], v[146:149]
v_mfma_f32_16x16x32_bf16 v[150:153], a[232:235], v[110:113], v[150:153]
v_mfma_f32_16x16x32_bf16 v[150:153], a[236:239], v[106:109], v[150:153]
v_mfma_f32_16x16x32_bf16 v[154:157], v[224:227], v[110:113], v[154:157]
v_mfma_f32_16x16x32_bf16 v[154:157], v[228:231], v[106:109], v[154:157]
v_mfma_f32_16x16x32_bf16 v[158:161], v[248:251], v[110:113], v[158:161]
v_mfma_f32_16x16x32_bf16 v[158:161], v[252:255], v[106:109], v[158:161]
v_mfma_f32_16x16x32_bf16 v[162:165], v[110:113], a[88:91], v[162:165]
v_mfma_f32_16x16x32_bf16 v[162:165], v[106:109], a[92:95], v[162:165]
v_mfma_f32_16x16x32_bf16 v[166:169], v[110:113], a[112:115], v[166:169]
v_mfma_f32_16x16x32_bf16 v[166:169], v[106:109], a[116:119], v[166:169]
v_mfma_f32_16x16x32_bf16 v[170:173], v[110:113], a[136:139], v[170:173]
v_mfma_f32_16x16x32_bf16 v[170:173], v[106:109], a[140:143], v[170:173]
v_cvt_pk_bf16_f32 v96, v138, v139
v_cvt_pk_bf16_f32 v97, v140, v141
v_cvt_pk_bf16_f32 v98, v142, v143
v_cvt_pk_bf16_f32 v99, v144, v145
v_cvt_pk_bf16_f32 v100, v146, v147
v_cvt_pk_bf16_f32 v101, v148, v149
v_cvt_pk_bf16_f32 v84, v150, v151
v_cvt_pk_bf16_f32 v85, v152, v153
v_cvt_pk_bf16_f32 v86, v154, v155
v_cvt_pk_bf16_f32 v87, v156, v157
v_cvt_pk_bf16_f32 v88, v158, v159
v_cvt_pk_bf16_f32 v89, v160, v161
v_cvt_pk_bf16_f32 v116, v162, v163
v_cvt_pk_bf16_f32 v117, v164, v165
v_cvt_pk_bf16_f32 v124, v166, v167
v_cvt_pk_bf16_f32 v125, v168, v169
v_cvt_pk_bf16_f32 v132, v170, v171
v_cvt_pk_bf16_f32 v133, v172, v173
ds_read_b128 v[182:185], v210 offset:12288
ds_read_b128 v[186:189], v210 offset:13312
s_waitcnt lgkmcnt(1)
v_mfma_f32_16x16x32_bf16 v[138:141], a[0:3], v[182:185], 0
s_waitcnt lgkmcnt(0)
v_mfma_f32_16x16x32_bf16 v[138:141], a[4:7], v[186:189], v[138:141]
v_mfma_f32_16x16x32_bf16 v[142:145], a[24:27], v[182:185], 0
v_mfma_f32_16x16x32_bf16 v[142:145], a[28:31], v[186:189], v[142:145]
v_mfma_f32_16x16x32_bf16 v[146:149], a[48:51], v[182:185], 0
v_mfma_f32_16x16x32_bf16 v[146:149], a[52:55], v[186:189], v[146:149]
ds_read_b128 v[174:177], v210 offset:14336
ds_read_b128 v[178:181], v210 offset:15360
s_waitcnt lgkmcnt(1)
v_mfma_f32_16x16x32_bf16 v[138:141], a[8:11], v[174:177], v[138:141]
s_waitcnt lgkmcnt(0)
v_mfma_f32_16x16x32_bf16 v[138:141], a[12:15], v[178:181], v[138:141]
v_mfma_f32_16x16x32_bf16 v[142:145], a[32:35], v[174:177], v[142:145]
v_mfma_f32_16x16x32_bf16 v[142:145], a[36:39], v[178:181], v[142:145]
v_mfma_f32_16x16x32_bf16 v[146:149], a[56:59], v[174:177], v[146:149]
v_mfma_f32_16x16x32_bf16 v[146:149], a[60:63], v[178:181], v[146:149]
ds_read_b128 v[182:185], v210 offset:16384
ds_read_b128 v[186:189], v210 offset:17408
s_waitcnt lgkmcnt(1)
v_mfma_f32_16x16x32_bf16 v[138:141], a[16:19], v[182:185], v[138:141]
s_waitcnt lgkmcnt(0)
v_mfma_f32_16x16x32_bf16 v[138:141], a[20:23], v[186:189], v[138:141]
v_mfma_f32_16x16x32_bf16 v[142:145], a[40:43], v[182:185], v[142:145]
v_mfma_f32_16x16x32_bf16 v[142:145], a[44:47], v[186:189], v[142:145]
v_mfma_f32_16x16x32_bf16 v[146:149], a[64:67], v[182:185], v[146:149]
v_mfma_f32_16x16x32_bf16 v[146:149], a[68:71], v[186:189], v[146:149]
v_cvt_pk_bf16_f32 v102, v138, v139
v_cvt_pk_bf16_f32 v103, v140, v141
v_cvt_pk_bf16_f32 v104, v142, v143
v_cvt_pk_bf16_f32 v105, v144, v145
s_nop 2
v_cvt_pk_bf16_f32 v106, v146, v147
v_cvt_pk_bf16_f32 v107, v148, v149
ds_read_b128 v[108:111], v215 offset:512
ds_read_b64 v[112:113], v215 offset:528
v_mfma_f32_16x16x16_bf16 v[138:141], v[82:83], v[76:77], 0
v_mfma_f32_16x16x16_bf16 v[142:145], v[100:101], v[76:77], 0
s_waitcnt lgkmcnt(0)
v_mfma_f32_16x16x16_bf16 v[150:153], v[112:113], v[76:77], v[206:209]
v_mfma_f32_16x16x16_bf16 v[146:149], v[106:107], v[76:77], 0
v_mfma_f32_16x16x32_bf16 v[138:141], v[78:81], v[72:75], v[138:141]
v_mfma_f32_16x16x32_bf16 v[142:145], v[96:99], v[72:75], v[142:145]
v_mfma_f32_16x16x32_bf16 v[150:153], v[108:111], v[72:75], v[150:153]
v_mfma_f32_16x16x32_bf16 v[146:149], v[102:105], v[72:75], v[146:149]
ds_read_b128 v[72:75], v215
ds_read_b64 v[76:77], v215 offset:16
v_mfma_f32_16x16x16_bf16 v[154:157], v[82:83], v[88:89], 0
v_mfma_f32_16x16x16_bf16 v[158:161], v[100:101], v[88:89], 0
v_mfma_f32_16x16x16_bf16 v[166:169], v[112:113], v[88:89], v[206:209]
v_mfma_f32_16x16x16_bf16 v[162:165], v[106:107], v[88:89], 0
v_mfma_f32_16x16x32_bf16 v[154:157], v[78:81], v[84:87], v[154:157]
v_mfma_f32_16x16x32_bf16 v[158:161], v[96:99], v[84:87], v[158:161]
v_mfma_f32_16x16x32_bf16 v[166:169], v[108:111], v[84:87], v[166:169]
v_mfma_f32_16x16x32_bf16 v[162:165], v[102:105], v[84:87], v[162:165]
v_mfma_f32_16x16x32_bf16 v[118:121], v[182:185], a[88:91], 0
v_mfma_f32_16x16x32_bf16 v[118:121], v[186:189], a[92:95], v[118:121]
v_mfma_f32_16x16x32_bf16 v[126:129], v[182:185], a[112:115], 0
v_mfma_f32_16x16x32_bf16 v[126:129], v[186:189], a[116:119], v[126:129]
v_mfma_f32_16x16x32_bf16 v[134:137], v[182:185], a[136:139], 0
v_mfma_f32_16x16x32_bf16 v[134:137], v[186:189], a[140:143], v[134:137]
v_mfma_f32_16x16x32_bf16 v[90:93], a[232:235], v[182:185], 0
v_mfma_f32_16x16x32_bf16 v[90:93], a[236:239], v[186:189], v[90:93]
v_mfma_f32_16x16x32_bf16 v[170:173], v[224:227], v[182:185], 0
v_mfma_f32_16x16x32_bf16 v[170:173], v[228:231], v[186:189], v[170:173]
v_mfma_f32_16x16x32_bf16 v[220:223], v[248:251], v[182:185], 0
v_mfma_f32_16x16x32_bf16 v[220:223], v[252:255], v[186:189], v[220:223]
v_mfma_f32_16x16x32_bf16 v[118:121], v[174:177], a[80:83], v[118:121]
v_mfma_f32_16x16x32_bf16 v[118:121], v[178:181], a[84:87], v[118:121]
v_mfma_f32_16x16x32_bf16 v[126:129], v[174:177], a[104:107], v[126:129]
v_mfma_f32_16x16x32_bf16 v[126:129], v[178:181], a[108:111], v[126:129]
v_mfma_f32_16x16x32_bf16 v[134:137], v[174:177], a[128:131], v[134:137]
v_mfma_f32_16x16x32_bf16 v[134:137], v[178:181], a[132:135], v[134:137]
v_mfma_f32_16x16x32_bf16 v[90:93], a[224:227], v[174:177], v[90:93]
v_mfma_f32_16x16x32_bf16 v[90:93], a[228:231], v[178:181], v[90:93]
v_mfma_f32_16x16x32_bf16 v[170:173], a[248:251], v[174:177], v[170:173]
v_mfma_f32_16x16x32_bf16 v[170:173], a[252:255], v[178:181], v[170:173]
v_mfma_f32_16x16x32_bf16 v[220:223], v[240:243], v[174:177], v[220:223]
v_mfma_f32_16x16x32_bf16 v[220:223], v[244:247], v[178:181], v[220:223]
ds_read_b128 v[182:185], v210 offset:12288
ds_read_b128 v[186:189], v210 offset:13312
s_waitcnt lgkmcnt(1)
v_mfma_f32_16x16x32_bf16 v[118:121], v[182:185], a[72:75], v[118:121]
s_waitcnt lgkmcnt(0)
v_mfma_f32_16x16x32_bf16 v[118:121], v[186:189], a[76:79], v[118:121]
v_mfma_f32_16x16x32_bf16 v[126:129], v[182:185], a[96:99], v[126:129]
v_mfma_f32_16x16x32_bf16 v[126:129], v[186:189], a[100:103], v[126:129]
v_mfma_f32_16x16x32_bf16 v[134:137], v[182:185], a[120:123], v[134:137]
v_mfma_f32_16x16x32_bf16 v[134:137], v[186:189], a[124:127], v[134:137]
v_mfma_f32_16x16x32_bf16 v[90:93], a[216:219], v[182:185], v[90:93]
v_mfma_f32_16x16x32_bf16 v[90:93], a[220:223], v[186:189], v[90:93]
v_mfma_f32_16x16x32_bf16 v[170:173], a[240:243], v[182:185], v[170:173]
v_mfma_f32_16x16x32_bf16 v[170:173], a[244:247], v[186:189], v[170:173]
v_mfma_f32_16x16x32_bf16 v[220:223], v[232:235], v[182:185], v[220:223]
v_mfma_f32_16x16x32_bf16 v[220:223], v[236:239], v[186:189], v[220:223]
v_mov_b32 v181, 0
v_cvt_pk_bf16_f32 v118, v118, v119
v_cvt_pk_bf16_f32 v119, v120, v121
ds_read_u16 v120, v205
v_mov_b32 v121, 0
v_cvt_pk_bf16_f32 v126, v126, v127
v_cvt_pk_bf16_f32 v127, v128, v129
ds_read_u16 v128, v205 offset:32
v_mov_b32 v129, 0
v_cvt_pk_bf16_f32 v134, v134, v135
v_cvt_pk_bf16_f32 v135, v136, v137
ds_read_u16 v136, v205 offset:64
v_mov_b32 v137, 0
v_add_u32 v205, 1424, v205
v_cvt_pk_bf16_f32 v90, v90, v91
v_cvt_pk_bf16_f32 v91, v92, v93
v_cvt_pk_bf16_f32 v92, v170, v171
v_cvt_pk_bf16_f32 v93, v172, v173
v_cvt_pk_bf16_f32 v94, v220, v221
v_cvt_pk_bf16_f32 v95, v222, v223
v_max3_f32 v151, v138, v139, v140
v_max3_f32 v151, v151, v141, v142
v_max3_f32 v151, v151, v143, v144
v_max3_f32 v151, v151, v145, v146
v_max3_f32 v151, v151, v147, v148
v_max3_f32 v151, v151, v149, v150
v_mov_b32 v152, v151
s_nop 1
v_permlane16_swap_b32 v151, v152
v_max_f32 v151, v151, v152
v_mov_b32 v152, v151
s_nop 1
v_permlane32_swap_b32 v151, v152
v_max_f32 v151, v151, v152
v_sub_f32 v138, v138, v151
v_sub_f32 v139, v139, v151
v_sub_f32 v140, v140, v151
v_sub_f32 v141, v141, v151
v_sub_f32 v142, v142, v151
v_sub_f32 v143, v143, v151
v_sub_f32 v144, v144, v151
v_sub_f32 v145, v145, v151
v_sub_f32 v150, v150, v151
v_sub_f32 v146, v146, v151
v_sub_f32 v147, v147, v151
v_sub_f32 v148, v148, v151
v_sub_f32 v149, v149, v151
v_exp_f32 v138, v138
v_exp_f32 v139, v139
v_exp_f32 v140, v140
v_exp_f32 v141, v141
v_exp_f32 v142, v142
v_exp_f32 v143, v143
v_exp_f32 v144, v144
v_exp_f32 v145, v145
v_exp_f32 v150, v150
v_exp_f32 v146, v146
v_exp_f32 v147, v147
v_exp_f32 v148, v148
v_exp_f32 v149, v149
v_cvt_pk_bf16_f32 v174, v138, v139
v_cvt_pk_bf16_f32 v175, v140, v141
v_cvt_pk_bf16_f32 v176, v142, v143
v_cvt_pk_bf16_f32 v177, v144, v145
v_cvt_pk_bf16_f32 v178, v146, v147
v_cvt_pk_bf16_f32 v179, v148, v149
v_cvt_pk_bf16_f32 v180, v150, 0
v_mfma_f32_16x16x32_bf16 v[150:153], v[190:193], v[174:177], 0
v_mfma_f32_16x16x32_bf16 v[150:153], v[190:193], v[178:181], v[150:153]
v_mfma_f32_16x16x32_bf16 v[138:141], v[114:117], v[174:177], 0
s_waitcnt lgkmcnt(2)
v_mfma_f32_16x16x32_bf16 v[138:141], v[118:121], v[178:181], v[138:141]
v_mfma_f32_16x16x32_bf16 v[142:145], v[122:125], v[174:177], 0
s_waitcnt lgkmcnt(1)
v_mfma_f32_16x16x32_bf16 v[142:145], v[126:129], v[178:181], v[142:145]
v_mfma_f32_16x16x32_bf16 v[146:149], v[130:133], v[174:177], 0
s_waitcnt lgkmcnt(0)
v_mfma_f32_16x16x32_bf16 v[146:149], v[134:137], v[178:181], v[146:149]
v_max3_f32 v167, v154, v155, v156
v_max3_f32 v167, v167, v157, v158
v_max3_f32 v167, v167, v159, v160
v_max3_f32 v167, v167, v161, v162
v_max3_f32 v167, v167, v163, v164
v_max3_f32 v167, v167, v165, v166
v_mov_b32 v168, v167
s_nop 1
v_permlane16_swap_b32 v167, v168
v_max_f32 v167, v167, v168
v_mov_b32 v168, v167
s_nop 1
v_permlane32_swap_b32 v167, v168
v_max_f32 v167, v167, v168
v_sub_f32 v154, v154, v167
v_sub_f32 v155, v155, v167
v_sub_f32 v156, v156, v167
v_sub_f32 v157, v157, v167
v_sub_f32 v158, v158, v167
v_sub_f32 v159, v159, v167
v_sub_f32 v160, v160, v167
v_sub_f32 v161, v161, v167
v_sub_f32 v166, v166, v167
v_sub_f32 v162, v162, v167
v_sub_f32 v163, v163, v167
v_sub_f32 v164, v164, v167
v_sub_f32 v165, v165, v167
v_exp_f32 v154, v154
v_exp_f32 v155, v155
v_exp_f32 v156, v156
v_exp_f32 v157, v157
v_exp_f32 v158, v158
v_exp_f32 v159, v159
v_exp_f32 v160, v160
v_exp_f32 v161, v161
v_exp_f32 v166, v166
v_exp_f32 v162, v162
v_exp_f32 v163, v163
v_exp_f32 v164, v164
v_exp_f32 v165, v165
v_cvt_pk_bf16_f32 v174, v154, v155
v_cvt_pk_bf16_f32 v175, v156, v157
v_cvt_pk_bf16_f32 v176, v158, v159
v_cvt_pk_bf16_f32 v177, v160, v161
v_cvt_pk_bf16_f32 v178, v162, v163
v_cvt_pk_bf16_f32 v179, v164, v165
v_cvt_pk_bf16_f32 v180, v166, 0
v_mfma_f32_16x16x32_bf16 v[166:169], v[190:193], v[174:177], 0
v_mfma_f32_16x16x32_bf16 v[166:169], v[190:193], v[178:181], v[166:169]
v_mfma_f32_16x16x32_bf16 v[154:157], v[114:117], v[174:177], 0
v_mfma_f32_16x16x32_bf16 v[154:157], v[118:121], v[178:181], v[154:157]
v_mfma_f32_16x16x32_bf16 v[158:161], v[122:125], v[174:177], 0
v_mfma_f32_16x16x32_bf16 v[158:161], v[126:129], v[178:181], v[158:161]
v_mfma_f32_16x16x32_bf16 v[162:165], v[130:133], v[174:177], 0
v_mfma_f32_16x16x32_bf16 v[162:165], v[134:137], v[178:181], v[162:165]
v_rcp_f32 v151, v150
s_nop 0
v_mul_f32 v152, s3, v151
v_mul_f32 v138, v138, v152
v_mul_f32 v139, v139, v152
v_cvt_pk_bf16_f32 v138, v138, v139
v_mul_f32 v140, v140, v152
v_mul_f32 v141, v141, v152
v_cvt_pk_bf16_f32 v139, v140, v141
v_mul_f32 v142, v142, v152
v_mul_f32 v143, v143, v152
v_cvt_pk_bf16_f32 v140, v142, v143
v_mul_f32 v144, v144, v152
v_mul_f32 v145, v145, v152
v_cvt_pk_bf16_f32 v141, v144, v145
ds_write_b128 v211, v[138:141] offset:38912
v_mul_f32 v146, v146, v152
v_mul_f32 v147, v147, v152
v_cvt_pk_bf16_f32 v142, v146, v147
v_mul_f32 v148, v148, v152
v_mul_f32 v149, v149, v152
v_cvt_pk_bf16_f32 v143, v148, v149
ds_write_b64 v212, v[142:143] offset:38912
v_mfma_f32_16x16x32_bf16 v[138:141], v[78:81], v[90:93], 0
v_mfma_f32_16x16x32_bf16 v[142:145], v[96:99], v[90:93], 0
v_mfma_f32_16x16x32_bf16 v[150:153], v[108:111], v[90:93], v[206:209]
v_mfma_f32_16x16x32_bf16 v[146:149], v[102:105], v[90:93], 0
v_mfma_f32_16x16x16_bf16 v[138:141], v[82:83], v[94:95], v[138:141]
v_mfma_f32_16x16x16_bf16 v[142:145], v[100:101], v[94:95], v[142:145]
v_mfma_f32_16x16x16_bf16 v[150:153], v[112:113], v[94:95], v[150:153]
v_mfma_f32_16x16x16_bf16 v[146:149], v[106:107], v[94:95], v[146:149]
v_rcp_f32 v167, v166
s_nop 0
v_mul_f32 v168, s3, v167
v_mul_f32 v154, v154, v168
v_mul_f32 v155, v155, v168
v_cvt_pk_bf16_f32 v154, v154, v155
v_mul_f32 v156, v156, v168
v_mul_f32 v157, v157, v168
v_cvt_pk_bf16_f32 v155, v156, v157
v_mul_f32 v158, v158, v168
v_mul_f32 v159, v159, v168
v_cvt_pk_bf16_f32 v156, v158, v159
v_mul_f32 v160, v160, v168
v_mul_f32 v161, v161, v168
v_cvt_pk_bf16_f32 v157, v160, v161
ds_write_b128 v211, v[154:157] offset:45056
v_mul_f32 v162, v162, v168
v_mul_f32 v163, v163, v168
v_cvt_pk_bf16_f32 v158, v162, v163
v_mul_f32 v164, v164, v168
v_mul_f32 v165, v165, v168
v_cvt_pk_bf16_f32 v159, v164, v165
ds_write_b64 v212, v[158:159] offset:45056
v_mfma_f32_16x16x32_bf16 v[154:157], v[72:75], v[78:81], 0
v_mfma_f32_16x16x32_bf16 v[158:161], v[72:75], v[96:99], 0
v_mfma_f32_16x16x32_bf16 v[162:165], v[72:75], v[102:105], 0
v_mfma_f32_16x16x16_bf16 v[154:157], v[76:77], v[82:83], v[154:157]
v_mfma_f32_16x16x16_bf16 v[158:161], v[76:77], v[100:101], v[158:161]
v_mfma_f32_16x16x16_bf16 v[162:165], v[76:77], v[106:107], v[162:165]
ds_read_b32 v166, v215 offset:536
s_nop 2
v_mov_b32_dpp v154, v158 quad_perm:[0,1,2,3] row_mask:0x2 bank_mask:0xf
s_nop 2
v_mov_b32_dpp v154, v162 quad_perm:[0,1,2,3] row_mask:0x4 bank_mask:0xf
s_waitcnt lgkmcnt(0)
s_nop 0
v_add_f32_dpp v154, v166, v207 quad_perm:[0,1,2,3] row_mask:0x8 bank_mask:0xf
v_mov_b32 v155, v154
s_nop 1
v_max_f32_dpp v155, v155, v155 row_ror:8 row_mask:0xf bank_mask:0xf
s_nop 1
v_max_f32_dpp v155, v155, v155 row_ror:4 row_mask:0xf bank_mask:0xf
s_nop 1
v_max_f32_dpp v155, v155, v155 row_ror:2 row_mask:0xf bank_mask:0xf
s_nop 1
v_max_f32_dpp v155, v155, v155 row_ror:1 row_mask:0xf bank_mask:0xf
v_mov_b32 v156, v155
s_nop 1
v_permlane16_swap_b32 v155, v156
v_max_f32 v155, v155, v156
v_mov_b32 v156, v155
s_nop 1
v_permlane32_swap_b32 v155, v156
v_max_f32 v155, v155, v156
v_sub_f32 v154, v154, v155
v_exp_f32 v166, v154
s_nop 0
v_cvt_pk_bf16_f32 v154, v166, 0
ds_write_b16 v214, v154
v_add_f32_dpp v166, v166, v166 row_ror:8 row_mask:0xf bank_mask:0xf
s_nop 1
v_add_f32_dpp v166, v166, v166 row_ror:4 row_mask:0xf bank_mask:0xf
s_nop 1
v_add_f32_dpp v166, v166, v166 row_ror:2 row_mask:0xf bank_mask:0xf
s_nop 1
v_add_f32_dpp v166, v166, v166 row_ror:1 row_mask:0xf bank_mask:0xf
s_nop 1
v_add_f32_dpp v166, v166, v166 row_bcast:15 row_mask:0xa bank_mask:0xf
s_nop 1
v_add_f32_dpp v166, v166, v166 row_bcast:31 row_mask:0xc bank_mask:0xf
s_nop 0
v_readlane_b32 s72, v166, 63
s_nop 1
v_rcp_f32 v167, s72
s_nop 0
v_mul_f32 v168, s3, v167
ds_read_b128 v[84:87], v215
ds_read_b128 v[88:91], v215 offset:16
v_add_u32 v215, 1424, v215
s_barrier
ds_read_b128 v[220:223], v210 offset:38912
ds_read_b128 v[110:113], v210 offset:39936
s_waitcnt lgkmcnt(1)
v_mfma_f32_16x16x32_bf16 v[0:3], a[144:147], v[220:223], v[0:3]
s_waitcnt lgkmcnt(0)
v_mfma_f32_16x16x32_bf16 v[0:3], a[148:151], v[110:113], v[0:3]
v_mfma_f32_16x16x32_bf16 v[4:7], a[168:171], v[220:223], v[4:7]
v_mfma_f32_16x16x32_bf16 v[4:7], a[172:175], v[110:113], v[4:7]
v_mfma_f32_16x16x32_bf16 v[8:11], a[192:195], v[220:223], v[8:11]
v_mfma_f32_16x16x32_bf16 v[8:11], a[196:199], v[110:113], v[8:11]
ds_read_b128 v[170:173], v210 offset:40960
ds_read_b128 v[182:185], v210 offset:41984
s_waitcnt lgkmcnt(1)
v_mfma_f32_16x16x32_bf16 v[0:3], a[152:155], v[170:173], v[0:3]
s_waitcnt lgkmcnt(0)
v_mfma_f32_16x16x32_bf16 v[0:3], a[156:159], v[182:185], v[0:3]
v_mfma_f32_16x16x32_bf16 v[4:7], a[176:179], v[170:173], v[4:7]
v_mfma_f32_16x16x32_bf16 v[4:7], a[180:183], v[182:185], v[4:7]
v_mfma_f32_16x16x32_bf16 v[8:11], a[200:203], v[170:173], v[8:11]
v_mfma_f32_16x16x32_bf16 v[8:11], a[204:207], v[182:185], v[8:11]
ds_read_b128 v[186:189], v210 offset:43008
ds_read_b128 v[220:223], v210 offset:44032
s_waitcnt lgkmcnt(1)
v_mfma_f32_16x16x32_bf16 v[0:3], a[160:163], v[186:189], v[0:3]
s_waitcnt lgkmcnt(0)
v_mfma_f32_16x16x32_bf16 v[0:3], a[164:167], v[220:223], v[0:3]
v_mfma_f32_16x16x32_bf16 v[4:7], a[184:187], v[186:189], v[4:7]
v_mfma_f32_16x16x32_bf16 v[4:7], a[188:191], v[220:223], v[4:7]
v_mfma_f32_16x16x32_bf16 v[8:11], a[208:211], v[186:189], v[8:11]
v_mfma_f32_16x16x32_bf16 v[8:11], a[212:215], v[220:223], v[8:11]
v_cvt_pk_bf16_f32 v0, v0, v1
v_cvt_pk_bf16_f32 v1, v2, v3
ds_write_b64 v203, v[0:1]
v_cvt_pk_bf16_f32 v4, v4, v5
v_cvt_pk_bf16_f32 v5, v6, v7
ds_write_b64 v203, v[4:5] offset:32
v_cvt_pk_bf16_f32 v8, v8, v9
v_cvt_pk_bf16_f32 v9, v10, v11
ds_write_b64 v203, v[8:9] offset:64
v_max3_f32 v151, v138, v139, v140
v_max3_f32 v151, v151, v141, v142
v_max3_f32 v151, v151, v143, v144
v_max3_f32 v151, v151, v145, v146
v_max3_f32 v151, v151, v147, v148
v_max3_f32 v151, v151, v149, v150
v_mov_b32 v152, v151
s_nop 1
v_permlane16_swap_b32 v151, v152
v_max_f32 v151, v151, v152
v_mov_b32 v152, v151
s_nop 1
v_permlane32_swap_b32 v151, v152
v_max_f32 v151, v151, v152
v_sub_f32 v138, v138, v151
v_sub_f32 v139, v139, v151
v_sub_f32 v140, v140, v151
v_sub_f32 v141, v141, v151
v_sub_f32 v142, v142, v151
v_sub_f32 v143, v143, v151
v_sub_f32 v144, v144, v151
v_sub_f32 v145, v145, v151
v_sub_f32 v150, v150, v151
v_sub_f32 v146, v146, v151
v_sub_f32 v147, v147, v151
v_sub_f32 v148, v148, v151
v_sub_f32 v149, v149, v151
v_exp_f32 v138, v138
v_exp_f32 v139, v139
v_exp_f32 v140, v140
v_exp_f32 v141, v141
v_exp_f32 v142, v142
v_exp_f32 v143, v143
v_exp_f32 v144, v144
v_exp_f32 v145, v145
v_exp_f32 v150, v150
v_exp_f32 v146, v146
v_exp_f32 v147, v147
v_exp_f32 v148, v148
v_exp_f32 v149, v149
v_cvt_pk_bf16_f32 v174, v138, v139
v_cvt_pk_bf16_f32 v175, v140, v141
v_cvt_pk_bf16_f32 v176, v142, v143
v_cvt_pk_bf16_f32 v177, v144, v145
v_cvt_pk_bf16_f32 v178, v146, v147
v_cvt_pk_bf16_f32 v179, v148, v149
v_cvt_pk_bf16_f32 v180, v150, 0
v_mfma_f32_16x16x32_bf16 v[150:153], v[190:193], v[174:177], 0
v_mfma_f32_16x16x32_bf16 v[150:153], v[190:193], v[178:181], v[150:153]
v_mfma_f32_16x16x32_bf16 v[138:141], v[114:117], v[174:177], 0
v_mfma_f32_16x16x32_bf16 v[138:141], v[118:121], v[178:181], v[138:141]
v_mfma_f32_16x16x32_bf16 v[142:145], v[122:125], v[174:177], 0
v_mfma_f32_16x16x32_bf16 v[142:145], v[126:129], v[178:181], v[142:145]
v_mfma_f32_16x16x32_bf16 v[146:149], v[130:133], v[174:177], 0
v_mfma_f32_16x16x32_bf16 v[146:149], v[134:137], v[178:181], v[146:149]
v_rcp_f32 v151, v150
s_nop 0
v_mul_f32 v152, s3, v151
v_mul_f32 v138, v138, v152
v_mul_f32 v139, v139, v152
v_cvt_pk_bf16_f32 v138, v138, v139
v_mul_f32 v140, v140, v152
v_mul_f32 v141, v141, v152
v_cvt_pk_bf16_f32 v139, v140, v141
v_mul_f32 v142, v142, v152
v_mul_f32 v143, v143, v152
v_cvt_pk_bf16_f32 v140, v142, v143
v_mul_f32 v144, v144, v152
v_mul_f32 v145, v145, v152
v_cvt_pk_bf16_f32 v141, v144, v145
ds_write_b128 v211, v[138:141] offset:51200
v_mul_f32 v146, v146, v152
v_mul_f32 v147, v147, v152
v_cvt_pk_bf16_f32 v142, v146, v147
v_mul_f32 v148, v148, v152
v_mul_f32 v149, v149, v152
v_cvt_pk_bf16_f32 v143, v148, v149
ds_write_b64 v212, v[142:143] offset:51200
v_mfma_f32_16x16x32_bf16 v[154:157], v[84:87], v[114:117], 0
v_mfma_f32_16x16x32_bf16 v[154:157], v[88:91], v[118:121], v[154:157]
v_mfma_f32_16x16x32_bf16 v[158:161], v[84:87], v[122:125], 0
v_mfma_f32_16x16x32_bf16 v[158:161], v[88:91], v[126:129], v[158:161]
v_mfma_f32_16x16x32_bf16 v[162:165], v[84:87], v[130:133], 0
v_mfma_f32_16x16x32_bf16 v[162:165], v[88:91], v[134:137], v[162:165]
v_mov_b32_dpp v154, v158 quad_perm:[0,1,2,3] row_mask:0x2 bank_mask:0xf
s_nop 5
v_mov_b32_dpp v154, v162 quad_perm:[0,1,2,3] row_mask:0x4 bank_mask:0xf
v_mul_f32 v154, v154, v168
v_cvt_pk_bf16_f32 v154, v154, 0
ds_write_b16 v214, v154
v_add_u32 v214, 1424, v214
ds_read_b128 v[110:113], v210 offset:45056
ds_read_b128 v[170:173], v210 offset:46080
s_waitcnt lgkmcnt(1)
v_mfma_f32_16x16x32_bf16 v[12:15], a[144:147], v[110:113], v[12:15]
s_waitcnt lgkmcnt(0)
v_mfma_f32_16x16x32_bf16 v[12:15], a[148:151], v[170:173], v[12:15]
v_mfma_f32_16x16x32_bf16 v[16:19], a[168:171], v[110:113], v[16:19]
v_mfma_f32_16x16x32_bf16 v[16:19], a[172:175], v[170:173], v[16:19]
v_mfma_f32_16x16x32_bf16 v[20:23], a[192:195], v[110:113], v[20:23]
v_mfma_f32_16x16x32_bf16 v[20:23], a[196:199], v[170:173], v[20:23]
ds_read_b128 v[182:185], v210 offset:47104
ds_read_b128 v[186:189], v210 offset:48128
s_waitcnt lgkmcnt(1)
v_mfma_f32_16x16x32_bf16 v[12:15], a[152:155], v[182:185], v[12:15]
s_waitcnt lgkmcnt(0)
v_mfma_f32_16x16x32_bf16 v[12:15], a[156:159], v[186:189], v[12:15]
v_mfma_f32_16x16x32_bf16 v[16:19], a[176:179], v[182:185], v[16:19]
v_mfma_f32_16x16x32_bf16 v[16:19], a[180:183], v[186:189], v[16:19]
v_mfma_f32_16x16x32_bf16 v[20:23], a[200:203], v[182:185], v[20:23]
v_mfma_f32_16x16x32_bf16 v[20:23], a[204:207], v[186:189], v[20:23]
ds_read_b128 v[220:223], v210 offset:49152
ds_read_b128 v[110:113], v210 offset:50176
s_waitcnt lgkmcnt(1)
v_mfma_f32_16x16x32_bf16 v[12:15], a[160:163], v[220:223], v[12:15]
s_waitcnt lgkmcnt(0)
v_mfma_f32_16x16x32_bf16 v[12:15], a[164:167], v[110:113], v[12:15]
v_mfma_f32_16x16x32_bf16 v[16:19], a[184:187], v[220:223], v[16:19]
v_mfma_f32_16x16x32_bf16 v[16:19], a[188:191], v[110:113], v[16:19]
v_mfma_f32_16x16x32_bf16 v[20:23], a[208:211], v[220:223], v[20:23]
v_mfma_f32_16x16x32_bf16 v[20:23], a[212:215], v[110:113], v[20:23]
v_cvt_pk_bf16_f32 v12, v12, v13
v_cvt_pk_bf16_f32 v13, v14, v15
ds_write_b64 v203, v[12:13] offset:6272
v_cvt_pk_bf16_f32 v16, v16, v17
v_cvt_pk_bf16_f32 v17, v18, v19
ds_write_b64 v203, v[16:17] offset:6304
v_cvt_pk_bf16_f32 v20, v20, v21
v_cvt_pk_bf16_f32 v21, v22, v23
ds_write_b64 v203, v[20:21] offset:6336
s_waitcnt vmcnt(0)
s_barrier
ds_read_b128 v[170:173], v210 offset:51200
ds_read_b128 v[182:185], v210 offset:52224
s_waitcnt lgkmcnt(1)
v_mfma_f32_16x16x32_bf16 v[24:27], a[144:147], v[170:173], v[24:27]
s_waitcnt lgkmcnt(0)
v_mfma_f32_16x16x32_bf16 v[24:27], a[148:151], v[182:185], v[24:27]
v_mfma_f32_16x16x32_bf16 v[28:31], a[168:171], v[170:173], v[28:31]
v_mfma_f32_16x16x32_bf16 v[28:31], a[172:175], v[182:185], v[28:31]
v_mfma_f32_16x16x32_bf16 v[32:35], a[192:195], v[170:173], v[32:35]
v_mfma_f32_16x16x32_bf16 v[32:35], a[196:199], v[182:185], v[32:35]
ds_read_b128 v[186:189], v210 offset:53248
ds_read_b128 v[220:223], v210 offset:54272
s_waitcnt lgkmcnt(1)
v_mfma_f32_16x16x32_bf16 v[24:27], a[152:155], v[186:189], v[24:27]
s_waitcnt lgkmcnt(0)
v_mfma_f32_16x16x32_bf16 v[24:27], a[156:159], v[220:223], v[24:27]
v_mfma_f32_16x16x32_bf16 v[28:31], a[176:179], v[186:189], v[28:31]
v_mfma_f32_16x16x32_bf16 v[28:31], a[180:183], v[220:223], v[28:31]
v_mfma_f32_16x16x32_bf16 v[32:35], a[200:203], v[186:189], v[32:35]
v_mfma_f32_16x16x32_bf16 v[32:35], a[204:207], v[220:223], v[32:35]
ds_read_b128 v[110:113], v210 offset:55296
ds_read_b128 v[170:173], v210 offset:56320
s_waitcnt lgkmcnt(1)
v_mfma_f32_16x16x32_bf16 v[24:27], a[160:163], v[110:113], v[24:27]
s_waitcnt lgkmcnt(0)
v_mfma_f32_16x16x32_bf16 v[24:27], a[164:167], v[170:173], v[24:27]
v_mfma_f32_16x16x32_bf16 v[28:31], a[184:187], v[110:113], v[28:31]
v_mfma_f32_16x16x32_bf16 v[28:31], a[188:191], v[170:173], v[28:31]
v_mfma_f32_16x16x32_bf16 v[32:35], a[208:211], v[110:113], v[32:35]
v_mfma_f32_16x16x32_bf16 v[32:35], a[212:215], v[170:173], v[32:35]
v_cvt_pk_bf16_f32 v24, v24, v25
v_cvt_pk_bf16_f32 v25, v26, v27
ds_write_b64 v203, v[24:25] offset:12544
v_cvt_pk_bf16_f32 v28, v28, v29
v_cvt_pk_bf16_f32 v29, v30, v31
ds_write_b64 v203, v[28:29] offset:12576
v_cvt_pk_bf16_f32 v32, v32, v33
v_cvt_pk_bf16_f32 v33, v34, v35
ds_write_b64 v203, v[32:33] offset:12608
s_waitcnt lgkmcnt(0)
s_barrier
ds_read_b64 v[120:121], v204
s_add_u32 s28, s38, s60
s_waitcnt lgkmcnt(0)
buffer_store_dwordx2 v[120:121], v204, s[8:11], s28 offen sc1
ds_read_b64 v[128:129], v204 offset:392
s_add_u32 s29, s38, s61
s_waitcnt lgkmcnt(0)
buffer_store_dwordx2 v[128:129], v204, s[8:11], s29 offen sc1
ds_read_b64 v[136:137], v204 offset:784
s_add_u32 s28, s38, s62
s_waitcnt lgkmcnt(0)
buffer_store_dwordx2 v[136:137], v204, s[8:11], s28 offen sc1
ds_read_b64 v[120:121], v204 offset:1176
s_add_u32 s29, s38, s63
s_waitcnt lgkmcnt(0)
buffer_store_dwordx2 v[120:121], v204, s[8:11], s29 offen sc1
ds_read_b64 v[128:129], v204 offset:6272
s_add_u32 s28, s38, s64
s_waitcnt lgkmcnt(0)
buffer_store_dwordx2 v[128:129], v204, s[8:11], s28 offen sc1
ds_read_b64 v[136:137], v204 offset:6664
s_add_u32 s29, s38, s65
s_waitcnt lgkmcnt(0)
buffer_store_dwordx2 v[136:137], v204, s[8:11], s29 offen sc1
ds_read_b64 v[120:121], v204 offset:7056
s_add_u32 s28, s38, s66
s_waitcnt lgkmcnt(0)
buffer_store_dwordx2 v[120:121], v204, s[8:11], s28 offen sc1
ds_read_b64 v[128:129], v204 offset:7448
s_add_u32 s29, s38, s67
s_waitcnt lgkmcnt(0)
buffer_store_dwordx2 v[128:129], v204, s[8:11], s29 offen sc1
ds_read_b64 v[136:137], v204 offset:12544
s_add_u32 s28, s38, s68
s_waitcnt lgkmcnt(0)
buffer_store_dwordx2 v[136:137], v204, s[8:11], s28 offen sc1
ds_read_b64 v[120:121], v204 offset:12936
s_add_u32 s29, s38, s69
s_waitcnt lgkmcnt(0)
buffer_store_dwordx2 v[120:121], v204, s[8:11], s29 offen sc1
ds_read_b64 v[128:129], v204 offset:13328
s_add_u32 s28, s38, s70
s_waitcnt lgkmcnt(0)
buffer_store_dwordx2 v[128:129], v204, s[8:11], s28 offen sc1
ds_read_b64 v[136:137], v204 offset:13720
s_add_u32 s29, s38, s71
s_waitcnt lgkmcnt(0)
buffer_store_dwordx2 v[136:137], v204, s[8:11], s29 offen sc1
s_mov_b32 s39, s37
ds_read_b128 v[174:177], v217
ds_read_b128 v[84:87], v200
s_waitcnt lgkmcnt(0)
v_mfma_f32_16x16x32_bf16 v[0:3], v[174:177], v[84:87], 0
ds_read_b128 v[92:95], v201
s_waitcnt lgkmcnt(0)
v_mfma_f32_16x16x32_bf16 v[12:15], v[174:177], v[92:95], 0
ds_read_b128 v[100:103], v202
s_waitcnt lgkmcnt(0)
v_mfma_f32_16x16x32_bf16 v[24:27], v[174:177], v[100:103], 0
ds_read_b128 v[178:181], v217 offset:528
ds_read_b128 v[84:87], v194
ds_read_b128 v[88:91], v194 offset:16
s_waitcnt lgkmcnt(0)
v_smfmac_f32_16x16x64_bf16 v[0:3], v[178:181], v[84:91], v213
ds_read_b128 v[92:95], v195
ds_read_b128 v[96:99], v195 offset:16
s_waitcnt lgkmcnt(0)
v_smfmac_f32_16x16x64_bf16 v[12:15], v[178:181], v[92:99], v213
ds_read_b128 v[100:103], v196
ds_read_b128 v[104:107], v196 offset:16
s_waitcnt lgkmcnt(0)
v_smfmac_f32_16x16x64_bf16 v[24:27], v[178:181], v[100:107], v213
ds_read_b128 v[174:177], v217 offset:1056
ds_read_b128 v[84:87], v197
ds_read_b128 v[88:91], v197 offset:16
s_waitcnt lgkmcnt(0)
v_smfmac_f32_16x16x64_bf16 v[0:3], v[174:177], v[84:91], v213
ds_read_b128 v[92:95], v198
ds_read_b128 v[96:99], v198 offset:16
s_waitcnt lgkmcnt(0)
v_smfmac_f32_16x16x64_bf16 v[12:15], v[174:177], v[92:99], v213
ds_read_b128 v[100:103], v199
ds_read_b128 v[104:107], v199 offset:16
s_waitcnt lgkmcnt(0)
v_smfmac_f32_16x16x64_bf16 v[24:27], v[174:177], v[100:107], v213
ds_read_b128 v[178:181], v217 offset:1584
ds_read_b128 v[84:87], v200 offset:32
s_waitcnt lgkmcnt(0)
v_mfma_f32_16x16x32_bf16 v[4:7], v[178:181], v[84:87], 0
ds_read_b128 v[92:95], v201 offset:32
s_waitcnt lgkmcnt(0)
v_mfma_f32_16x16x32_bf16 v[16:19], v[178:181], v[92:95], 0
ds_read_b128 v[100:103], v202 offset:32
s_waitcnt lgkmcnt(0)
v_mfma_f32_16x16x32_bf16 v[28:31], v[178:181], v[100:103], 0
ds_read_b128 v[174:177], v217 offset:2112
ds_read_b128 v[84:87], v194 offset:32
ds_read_b128 v[88:91], v194 offset:48
s_waitcnt lgkmcnt(0)
v_smfmac_f32_16x16x64_bf16 v[4:7], v[174:177], v[84:91], v213
ds_read_b128 v[92:95], v195 offset:32
ds_read_b128 v[96:99], v195 offset:48
s_waitcnt lgkmcnt(0)
v_smfmac_f32_16x16x64_bf16 v[16:19], v[174:177], v[92:99], v213
ds_read_b128 v[100:103], v196 offset:32
ds_read_b128 v[104:107], v196 offset:48
s_waitcnt lgkmcnt(0)
v_smfmac_f32_16x16x64_bf16 v[28:31], v[174:177], v[100:107], v213
ds_read_b128 v[178:181], v217 offset:2640
ds_read_b128 v[84:87], v197 offset:32
ds_read_b128 v[88:91], v197 offset:48
s_waitcnt lgkmcnt(0)
v_smfmac_f32_16x16x64_bf16 v[4:7], v[178:181], v[84:91], v213
ds_read_b128 v[92:95], v198 offset:32
ds_read_b128 v[96:99], v198 offset:48
s_waitcnt lgkmcnt(0)
v_smfmac_f32_16x16x64_bf16 v[16:19], v[178:181], v[92:99], v213
ds_read_b128 v[100:103], v199 offset:32
ds_read_b128 v[104:107], v199 offset:48
s_waitcnt lgkmcnt(0)
v_smfmac_f32_16x16x64_bf16 v[28:31], v[178:181], v[100:107], v213
ds_read_b128 v[174:177], v217 offset:3168
ds_read_b128 v[84:87], v200 offset:64
s_waitcnt lgkmcnt(0)
v_mfma_f32_16x16x32_bf16 v[8:11], v[174:177], v[84:87], 0
ds_read_b128 v[92:95], v201 offset:64
s_waitcnt lgkmcnt(0)
v_mfma_f32_16x16x32_bf16 v[20:23], v[174:177], v[92:95], 0
ds_read_b128 v[100:103], v202 offset:64
s_waitcnt lgkmcnt(0)
v_mfma_f32_16x16x32_bf16 v[32:35], v[174:177], v[100:103], 0
ds_read_b128 v[178:181], v217 offset:3696
ds_read_b128 v[84:87], v194 offset:64
ds_read_b128 v[88:91], v194 offset:80
s_waitcnt lgkmcnt(0)
v_smfmac_f32_16x16x64_bf16 v[8:11], v[178:181], v[84:91], v213
ds_read_b128 v[92:95], v195 offset:64
ds_read_b128 v[96:99], v195 offset:80
s_waitcnt lgkmcnt(0)
v_smfmac_f32_16x16x64_bf16 v[20:23], v[178:181], v[92:99], v213
ds_read_b128 v[100:103], v196 offset:64
ds_read_b128 v[104:107], v196 offset:80
s_waitcnt lgkmcnt(0)
v_smfmac_f32_16x16x64_bf16 v[32:35], v[178:181], v[100:107], v213
ds_read_b128 v[174:177], v217 offset:4224
ds_read_b128 v[84:87], v197 offset:64
ds_read_b128 v[88:91], v197 offset:80
s_waitcnt lgkmcnt(0)
v_smfmac_f32_16x16x64_bf16 v[8:11], v[174:177], v[84:91], v213
ds_read_b128 v[92:95], v198 offset:64
ds_read_b128 v[96:99], v198 offset:80
s_waitcnt lgkmcnt(0)
v_smfmac_f32_16x16x64_bf16 v[20:23], v[174:177], v[92:99], v213
ds_read_b128 v[100:103], v199 offset:64
ds_read_b128 v[104:107], v199 offset:80
s_waitcnt lgkmcnt(0)
v_smfmac_f32_16x16x64_bf16 v[32:35], v[174:177], v[100:107], v213
v_add_f32 v118, v0, v1
v_mul_f32 v119, v0, v0
v_add_f32 v118, v118, v2
v_fmac_f32 v119, v1, v1
v_add_f32 v118, v118, v3
v_fmac_f32 v119, v2, v2
v_fmac_f32 v119, v3, v3
v_add_f32 v126, v12, v13
v_mul_f32 v127, v12, v12
v_add_f32 v126, v126, v14
v_fmac_f32 v127, v13, v13
v_add_f32 v126, v126, v15
v_fmac_f32 v127, v14, v14
v_fmac_f32 v127, v15, v15
v_add_f32 v134, v24, v25
v_mul_f32 v135, v24, v24
v_add_f32 v134, v134, v26
v_fmac_f32 v135, v25, v25
v_add_f32 v134, v134, v27
v_fmac_f32 v135, v26, v26
v_fmac_f32 v135, v27, v27
v_add_f32 v118, v118, v4
v_fmac_f32 v119, v4, v4
v_add_f32 v118, v118, v5
v_fmac_f32 v119, v5, v5
v_add_f32 v118, v118, v6
v_fmac_f32 v119, v6, v6
v_add_f32 v118, v118, v7
v_fmac_f32 v119, v7, v7
v_add_f32 v126, v126, v16
v_fmac_f32 v127, v16, v16
v_add_f32 v126, v126, v17
v_fmac_f32 v127, v17, v17
v_add_f32 v126, v126, v18
v_fmac_f32 v127, v18, v18
v_add_f32 v126, v126, v19
v_fmac_f32 v127, v19, v19
v_add_f32 v134, v134, v28
v_fmac_f32 v135, v28, v28
v_add_f32 v134, v134, v29
v_fmac_f32 v135, v29, v29
v_add_f32 v134, v134, v30
v_fmac_f32 v135, v30, v30
v_add_f32 v134, v134, v31
v_fmac_f32 v135, v31, v31
v_add_f32 v118, v118, v8
v_fmac_f32 v119, v8, v8
v_add_f32 v118, v118, v9
v_fmac_f32 v119, v9, v9
v_add_f32 v118, v118, v10
v_fmac_f32 v119, v10, v10
v_add_f32 v118, v118, v11
v_fmac_f32 v119, v11, v11
v_add_f32 v126, v126, v20
v_fmac_f32 v127, v20, v20
v_add_f32 v126, v126, v21
v_fmac_f32 v127, v21, v21
v_add_f32 v126, v126, v22
v_fmac_f32 v127, v22, v22
v_add_f32 v126, v126, v23
v_fmac_f32 v127, v23, v23
v_add_f32 v134, v134, v32
v_fmac_f32 v135, v32, v32
v_add_f32 v134, v134, v33
v_fmac_f32 v135, v33, v33
v_add_f32 v134, v134, v34
v_fmac_f32 v135, v34, v34
v_add_f32 v134, v134, v35
v_fmac_f32 v135, v35, v35
v_permlane16_swap_b32 v118, v119
v_add_f32 v118, v118, v119
v_permlane16_swap_b32 v126, v127
v_add_f32 v126, v126, v127
v_permlane16_swap_b32 v134, v135
v_add_f32 v134, v134, v135
v_permlane32_swap_b32 v118, v126
v_add_f32 v118, v118, v126
ds_write_b32 v209, v118
v_mov_b32 v135, v134
s_nop 1
v_permlane32_swap_b32 v134, v135
v_add_f32 v134, v134, v135
ds_write_b32 v209, v134 offset:512
s_waitcnt lgkmcnt(0)
s_barrier
ds_read_b128 v[182:185], v210 offset:20480
ds_read_b128 v[186:189], v210 offset:21504
s_waitcnt lgkmcnt(1)
v_mfma_f32_16x16x32_bf16 v[138:141], a[0:3], v[182:185], 0
s_waitcnt lgkmcnt(0)
v_mfma_f32_16x16x32_bf16 v[138:141], a[4:7], v[186:189], v[138:141]
v_mfma_f32_16x16x32_bf16 v[142:145], a[24:27], v[182:185], 0
v_mfma_f32_16x16x32_bf16 v[142:145], a[28:31], v[186:189], v[142:145]
v_mfma_f32_16x16x32_bf16 v[146:149], a[48:51], v[182:185], 0
v_mfma_f32_16x16x32_bf16 v[146:149], a[52:55], v[186:189], v[146:149]
v_mfma_f32_16x16x32_bf16 v[150:153], a[216:219], v[182:185], 0
v_mfma_f32_16x16x32_bf16 v[150:153], a[220:223], v[186:189], v[150:153]
v_mfma_f32_16x16x32_bf16 v[154:157], a[240:243], v[182:185], 0
v_mfma_f32_16x16x32_bf16 v[154:157], a[244:247], v[186:189], v[154:157]
v_mfma_f32_16x16x32_bf16 v[158:161], v[232:235], v[182:185], 0
v_mfma_f32_16x16x32_bf16 v[158:161], v[236:239], v[186:189], v[158:161]
v_mfma_f32_16x16x32_bf16 v[162:165], v[182:185], a[72:75], 0
v_mfma_f32_16x16x32_bf16 v[162:165], v[186:189], a[76:79], v[162:165]
v_mfma_f32_16x16x32_bf16 v[166:169], v[182:185], a[96:99], 0
v_mfma_f32_16x16x32_bf16 v[166:169], v[186:189], a[100:103], v[166:169]
v_mfma_f32_16x16x32_bf16 v[170:173], v[182:185], a[120:123], 0
v_mfma_f32_16x16x32_bf16 v[170:173], v[186:189], a[124:127], v[170:173]
ds_read_b128 v[110:113], v210 offset:22528
ds_read_b128 v[220:223], v210 offset:23552
s_waitcnt lgkmcnt(1)
v_mfma_f32_16x16x32_bf16 v[138:141], a[8:11], v[110:113], v[138:141]
s_waitcnt lgkmcnt(0)
v_mfma_f32_16x16x32_bf16 v[138:141], a[12:15], v[220:223], v[138:141]
v_mfma_f32_16x16x32_bf16 v[142:145], a[32:35], v[110:113], v[142:145]
v_mfma_f32_16x16x32_bf16 v[142:145], a[36:39], v[220:223], v[142:145]
v_mfma_f32_16x16x32_bf16 v[146:149], a[56:59], v[110:113], v[146:149]
v_mfma_f32_16x16x32_bf16 v[146:149], a[60:63], v[220:223], v[146:149]
v_mfma_f32_16x16x32_bf16 v[150:153], a[224:227], v[110:113], v[150:153]
v_mfma_f32_16x16x32_bf16 v[150:153], a[228:231], v[220:223], v[150:153]
v_mfma_f32_16x16x32_bf16 v[154:157], a[248:251], v[110:113], v[154:157]
v_mfma_f32_16x16x32_bf16 v[154:157], a[252:255], v[220:223], v[154:157]
v_mfma_f32_16x16x32_bf16 v[158:161], v[240:243], v[110:113], v[158:161]
v_mfma_f32_16x16x32_bf16 v[158:161], v[244:247], v[220:223], v[158:161]
v_mfma_f32_16x16x32_bf16 v[162:165], v[110:113], a[80:83], v[162:165]
v_mfma_f32_16x16x32_bf16 v[162:165], v[220:223], a[84:87], v[162:165]
v_mfma_f32_16x16x32_bf16 v[166:169], v[110:113], a[104:107], v[166:169]
v_mfma_f32_16x16x32_bf16 v[166:169], v[220:223], a[108:111], v[166:169]
v_mfma_f32_16x16x32_bf16 v[170:173], v[110:113], a[128:131], v[170:173]
v_mfma_f32_16x16x32_bf16 v[170:173], v[220:223], a[132:135], v[170:173]
ds_read_b128 v[182:185], v210 offset:24576
ds_read_b128 v[186:189], v210 offset:25600
s_waitcnt lgkmcnt(1)
v_mfma_f32_16x16x32_bf16 v[138:141], a[16:19], v[182:185], v[138:141]
s_waitcnt lgkmcnt(0)
v_mfma_f32_16x16x32_bf16 v[138:141], a[20:23], v[186:189], v[138:141]
v_mfma_f32_16x16x32_bf16 v[142:145], a[40:43], v[182:185], v[142:145]
v_mfma_f32_16x16x32_bf16 v[142:145], a[44:47], v[186:189], v[142:145]
v_mfma_f32_16x16x32_bf16 v[146:149], a[64:67], v[182:185], v[146:149]
v_mfma_f32_16x16x32_bf16 v[146:149], a[68:71], v[186:189], v[146:149]
v_mfma_f32_16x16x32_bf16 v[150:153], a[232:235], v[182:185], v[150:153]
v_mfma_f32_16x16x32_bf16 v[150:153], a[236:239], v[186:189], v[150:153]
v_mfma_f32_16x16x32_bf16 v[154:157], v[224:227], v[182:185], v[154:157]
v_mfma_f32_16x16x32_bf16 v[154:157], v[228:231], v[186:189], v[154:157]
v_mfma_f32_16x16x32_bf16 v[158:161], v[248:251], v[182:185], v[158:161]
v_mfma_f32_16x16x32_bf16 v[158:161], v[252:255], v[186:189], v[158:161]
v_mfma_f32_16x16x32_bf16 v[162:165], v[182:185], a[88:91], v[162:165]
v_mfma_f32_16x16x32_bf16 v[162:165], v[186:189], a[92:95], v[162:165]
v_mfma_f32_16x16x32_bf16 v[166:169], v[182:185], a[112:115], v[166:169]
v_mfma_f32_16x16x32_bf16 v[166:169], v[186:189], a[116:119], v[166:169]
v_mfma_f32_16x16x32_bf16 v[170:173], v[182:185], a[136:139], v[170:173]
v_mfma_f32_16x16x32_bf16 v[170:173], v[186:189], a[140:143], v[170:173]
v_cvt_pk_bf16_f32 v78, v138, v139
v_cvt_pk_bf16_f32 v79, v140, v141
v_cvt_pk_bf16_f32 v80, v142, v143
v_cvt_pk_bf16_f32 v81, v144, v145
v_cvt_pk_bf16_f32 v82, v146, v147
v_cvt_pk_bf16_f32 v83, v148, v149
v_cvt_pk_bf16_f32 v72, v150, v151
v_cvt_pk_bf16_f32 v73, v152, v153
v_cvt_pk_bf16_f32 v74, v154, v155
v_cvt_pk_bf16_f32 v75, v156, v157
v_cvt_pk_bf16_f32 v76, v158, v159
v_cvt_pk_bf16_f32 v77, v160, v161
v_cvt_pk_bf16_f32 v114, v162, v163
v_cvt_pk_bf16_f32 v115, v164, v165
v_cvt_pk_bf16_f32 v122, v166, v167
v_cvt_pk_bf16_f32 v123, v168, v169
v_cvt_pk_bf16_f32 v130, v170, v171
v_cvt_pk_bf16_f32 v131, v172, v173
ds_read_b128 v[110:113], v210 offset:26624
ds_read_b128 v[220:223], v210 offset:27648
s_waitcnt lgkmcnt(1)
v_mfma_f32_16x16x32_bf16 v[138:141], a[0:3], v[110:113], 0
s_waitcnt lgkmcnt(0)
v_mfma_f32_16x16x32_bf16 v[138:141], a[4:7], v[220:223], v[138:141]
v_mfma_f32_16x16x32_bf16 v[142:145], a[24:27], v[110:113], 0
v_mfma_f32_16x16x32_bf16 v[142:145], a[28:31], v[220:223], v[142:145]
v_mfma_f32_16x16x32_bf16 v[146:149], a[48:51], v[110:113], 0
v_mfma_f32_16x16x32_bf16 v[146:149], a[52:55], v[220:223], v[146:149]
v_mfma_f32_16x16x32_bf16 v[150:153], a[216:219], v[110:113], 0
v_mfma_f32_16x16x32_bf16 v[150:153], a[220:223], v[220:223], v[150:153]
v_mfma_f32_16x16x32_bf16 v[154:157], a[240:243], v[110:113], 0
v_mfma_f32_16x16x32_bf16 v[154:157], a[244:247], v[220:223], v[154:157]
v_mfma_f32_16x16x32_bf16 v[158:161], v[232:235], v[110:113], 0
v_mfma_f32_16x16x32_bf16 v[158:161], v[236:239], v[220:223], v[158:161]
v_mfma_f32_16x16x32_bf16 v[162:165], v[110:113], a[72:75], 0
v_mfma_f32_16x16x32_bf16 v[162:165], v[220:223], a[76:79], v[162:165]
v_mfma_f32_16x16x32_bf16 v[166:169], v[110:113], a[96:99], 0
v_mfma_f32_16x16x32_bf16 v[166:169], v[220:223], a[100:103], v[166:169]
v_mfma_f32_16x16x32_bf16 v[170:173], v[110:113], a[120:123], 0
v_mfma_f32_16x16x32_bf16 v[170:173], v[220:223], a[124:127], v[170:173]
ds_read_b128 v[102:105], v210 offset:18432
ds_read_b128 v[106:109], v210 offset:19456
s_waitcnt lgkmcnt(1)
v_add_f32 v102, v102, v103
s_waitcnt lgkmcnt(0)
v_add_f32 v106, v106, v107
v_add_f32 v104, v104, v105
v_add_f32 v108, v108, v109
v_add_f32 v102, v102, v104
v_add_f32 v106, v106, v108
v_mul_f32 v103, s48, v102
v_mul_f32 v104, s73, v102
v_mul_f32 v106, s73, v106
v_fma_f32 v106, -v103, v104, v106
v_max_f32 v106, 0, v106
v_add_f32 v106, s49, v106
v_rsq_f32 v102, v106
s_nop 0
v_mul_f32_e64 v103, -v103, v102
ds_write_b64 v211, v[102:103]
ds_read_b64 v[118:119], v219
ds_read_b64 v[126:127], v219 offset:256
ds_read_b64 v[134:135], v219 offset:512
s_waitcnt lgkmcnt(2)
v_fma_f32 v220, v0, v118, v119
v_fma_f32 v221, v1, v118, v119
v_cvt_pk_bf16_f32 v174, v220, v221
v_fma_f32 v222, v2, v118, v119
v_fma_f32 v223, v3, v118, v119
v_cvt_pk_bf16_f32 v175, v222, v223
v_fma_f32 v220, v4, v118, v119
v_fma_f32 v221, v5, v118, v119
v_cvt_pk_bf16_f32 v176, v220, v221
v_fma_f32 v222, v6, v118, v119
v_fma_f32 v223, v7, v118, v119
v_cvt_pk_bf16_f32 v177, v222, v223
ds_write_b128 v211, v[174:177]
v_fma_f32 v220, v8, v118, v119
v_fma_f32 v221, v9, v118, v119
v_cvt_pk_bf16_f32 v178, v220, v221
v_fma_f32 v222, v10, v118, v119
v_fma_f32 v223, v11, v118, v119
v_cvt_pk_bf16_f32 v179, v222, v223
s_waitcnt lgkmcnt(2)
ds_write_b64 v212, v[178:179]
v_fma_f32 v220, v12, v126, v127
v_fma_f32 v221, v13, v126, v127
v_cvt_pk_bf16_f32 v90, v220, v221
v_fma_f32 v222, v14, v126, v127
v_fma_f32 v223, v15, v126, v127
v_cvt_pk_bf16_f32 v91, v222, v223
v_fma_f32 v220, v16, v126, v127
v_fma_f32 v221, v17, v126, v127
v_cvt_pk_bf16_f32 v92, v220, v221
v_fma_f32 v222, v18, v126, v127
v_fma_f32 v223, v19, v126, v127
v_cvt_pk_bf16_f32 v93, v222, v223
ds_write_b128 v211, v[90:93] offset:6144
v_fma_f32 v220, v20, v126, v127
v_fma_f32 v221, v21, v126, v127
v_cvt_pk_bf16_f32 v94, v220, v221
v_fma_f32 v222, v22, v126, v127
v_fma_f32 v223, v23, v126, v127
v_cvt_pk_bf16_f32 v95, v222, v223
s_waitcnt lgkmcnt(3)
ds_write_b64 v212, v[94:95] offset:6144
v_fma_f32 v220, v24, v134, v135
v_fma_f32 v221, v25, v134, v135
v_cvt_pk_bf16_f32 v90, v220, v221
v_fma_f32 v222, v26, v134, v135
v_fma_f32 v223, v27, v134, v135
v_cvt_pk_bf16_f32 v91, v222, v223
v_fma_f32 v220, v28, v134, v135
v_fma_f32 v221, v29, v134, v135
v_cvt_pk_bf16_f32 v92, v220, v221
v_fma_f32 v222, v30, v134, v135
v_fma_f32 v223, v31, v134, v135
v_cvt_pk_bf16_f32 v93, v222, v223
ds_write_b128 v211, v[90:93] offset:12288
v_fma_f32 v220, v32, v134, v135
v_fma_f32 v221, v33, v134, v135
v_cvt_pk_bf16_f32 v94, v220, v221
v_fma_f32 v222, v34, v134, v135
v_fma_f32 v223, v35, v134, v135
v_cvt_pk_bf16_f32 v95, v222, v223
ds_write_b64 v212, v[94:95] offset:12288
ds_read_b128 v[182:185], v210 offset:28672
ds_read_b128 v[186:189], v210 offset:29696
s_waitcnt lgkmcnt(1)
v_mfma_f32_16x16x32_bf16 v[138:141], a[8:11], v[182:185], v[138:141]
s_waitcnt lgkmcnt(0)
v_mfma_f32_16x16x32_bf16 v[138:141], a[12:15], v[186:189], v[138:141]
v_mfma_f32_16x16x32_bf16 v[142:145], a[32:35], v[182:185], v[142:145]
v_mfma_f32_16x16x32_bf16 v[142:145], a[36:39], v[186:189], v[142:145]
v_mfma_f32_16x16x32_bf16 v[146:149], a[56:59], v[182:185], v[146:149]
v_mfma_f32_16x16x32_bf16 v[146:149], a[60:63], v[186:189], v[146:149]
v_mfma_f32_16x16x32_bf16 v[150:153], a[224:227], v[182:185], v[150:153]
v_mfma_f32_16x16x32_bf16 v[150:153], a[228:231], v[186:189], v[150:153]
v_mfma_f32_16x16x32_bf16 v[154:157], a[248:251], v[182:185], v[154:157]
v_mfma_f32_16x16x32_bf16 v[154:157], a[252:255], v[186:189], v[154:157]
v_mfma_f32_16x16x32_bf16 v[158:161], v[240:243], v[182:185], v[158:161]
v_mfma_f32_16x16x32_bf16 v[158:161], v[244:247], v[186:189], v[158:161]
v_mfma_f32_16x16x32_bf16 v[162:165], v[182:185], a[80:83], v[162:165]
v_mfma_f32_16x16x32_bf16 v[162:165], v[186:189], a[84:87], v[162:165]
v_mfma_f32_16x16x32_bf16 v[166:169], v[182:185], a[104:107], v[166:169]
v_mfma_f32_16x16x32_bf16 v[166:169], v[186:189], a[108:111], v[166:169]
v_mfma_f32_16x16x32_bf16 v[170:173], v[182:185], a[128:131], v[170:173]
v_mfma_f32_16x16x32_bf16 v[170:173], v[186:189], a[132:135], v[170:173]
ds_read_b128 v[110:113], v210 offset:30720
ds_read_b128 v[106:109], v210 offset:31744
s_waitcnt lgkmcnt(1)
v_mfma_f32_16x16x32_bf16 v[138:141], a[16:19], v[110:113], v[138:141]
s_waitcnt lgkmcnt(0)
v_mfma_f32_16x16x32_bf16 v[138:141], a[20:23], v[106:109], v[138:141]
v_mfma_f32_16x16x32_bf16 v[142:145], a[40:43], v[110:113], v[142:145]
v_mfma_f32_16x16x32_bf16 v[142:145], a[44:47], v[106:109], v[142:145]
v_mfma_f32_16x16x32_bf16 v[146:149], a[64:67], v[110:113], v[146:149]
v_mfma_f32_16x16x32_bf16 v[146:149], a[68:71], v[106:109], v[146:149]
v_mfma_f32_16x16x32_bf16 v[150:153], a[232:235], v[110:113], v[150:153]
v_mfma_f32_16x16x32_bf16 v[150:153], a[236:239], v[106:109], v[150:153]
v_mfma_f32_16x16x32_bf16 v[154:157], v[224:227], v[110:113], v[154:157]
v_mfma_f32_16x16x32_bf16 v[154:157], v[228:231], v[106:109], v[154:157]
v_mfma_f32_16x16x32_bf16 v[158:161], v[248:251], v[110:113], v[158:161]
v_mfma_f32_16x16x32_bf16 v[158:161], v[252:255], v[106:109], v[158:161]
v_mfma_f32_16x16x32_bf16 v[162:165], v[110:113], a[88:91], v[162:165]
v_mfma_f32_16x16x32_bf16 v[162:165], v[106:109], a[92:95], v[162:165]
v_mfma_f32_16x16x32_bf16 v[166:169], v[110:113], a[112:115], v[166:169]
v_mfma_f32_16x16x32_bf16 v[166:169], v[106:109], a[116:119], v[166:169]
v_mfma_f32_16x16x32_bf16 v[170:173], v[110:113], a[136:139], v[170:173]
v_mfma_f32_16x16x32_bf16 v[170:173], v[106:109], a[140:143], v[170:173]
v_cvt_pk_bf16_f32 v96, v138, v139
v_cvt_pk_bf16_f32 v97, v140, v141
v_cvt_pk_bf16_f32 v98, v142, v143
v_cvt_pk_bf16_f32 v99, v144, v145
v_cvt_pk_bf16_f32 v100, v146, v147
v_cvt_pk_bf16_f32 v101, v148, v149
v_cvt_pk_bf16_f32 v84, v150, v151
v_cvt_pk_bf16_f32 v85, v152, v153
v_cvt_pk_bf16_f32 v86, v154, v155
v_cvt_pk_bf16_f32 v87, v156, v157
v_cvt_pk_bf16_f32 v88, v158, v159
v_cvt_pk_bf16_f32 v89, v160, v161
v_cvt_pk_bf16_f32 v116, v162, v163
v_cvt_pk_bf16_f32 v117, v164, v165
v_cvt_pk_bf16_f32 v124, v166, v167
v_cvt_pk_bf16_f32 v125, v168, v169
v_cvt_pk_bf16_f32 v132, v170, v171
v_cvt_pk_bf16_f32 v133, v172, v173
ds_read_b128 v[182:185], v210 offset:32768
ds_read_b128 v[186:189], v210 offset:33792
s_waitcnt lgkmcnt(1)
v_mfma_f32_16x16x32_bf16 v[138:141], a[0:3], v[182:185], 0
s_waitcnt lgkmcnt(0)
v_mfma_f32_16x16x32_bf16 v[138:141], a[4:7], v[186:189], v[138:141]
v_mfma_f32_16x16x32_bf16 v[142:145], a[24:27], v[182:185], 0
v_mfma_f32_16x16x32_bf16 v[142:145], a[28:31], v[186:189], v[142:145]
v_mfma_f32_16x16x32_bf16 v[146:149], a[48:51], v[182:185], 0
v_mfma_f32_16x16x32_bf16 v[146:149], a[52:55], v[186:189], v[146:149]
ds_read_b128 v[174:177], v210 offset:34816
ds_read_b128 v[178:181], v210 offset:35840
s_waitcnt lgkmcnt(1)
v_mfma_f32_16x16x32_bf16 v[138:141], a[8:11], v[174:177], v[138:141]
s_waitcnt lgkmcnt(0)
v_mfma_f32_16x16x32_bf16 v[138:141], a[12:15], v[178:181], v[138:141]
v_mfma_f32_16x16x32_bf16 v[142:145], a[32:35], v[174:177], v[142:145]
v_mfma_f32_16x16x32_bf16 v[142:145], a[36:39], v[178:181], v[142:145]
v_mfma_f32_16x16x32_bf16 v[146:149], a[56:59], v[174:177], v[146:149]
v_mfma_f32_16x16x32_bf16 v[146:149], a[60:63], v[178:181], v[146:149]
ds_read_b128 v[182:185], v210 offset:36864
ds_read_b128 v[186:189], v210 offset:37888
s_waitcnt lgkmcnt(1)
v_mfma_f32_16x16x32_bf16 v[138:141], a[16:19], v[182:185], v[138:141]
s_waitcnt lgkmcnt(0)
v_mfma_f32_16x16x32_bf16 v[138:141], a[20:23], v[186:189], v[138:141]
v_mfma_f32_16x16x32_bf16 v[142:145], a[40:43], v[182:185], v[142:145]
v_mfma_f32_16x16x32_bf16 v[142:145], a[44:47], v[186:189], v[142:145]
v_mfma_f32_16x16x32_bf16 v[146:149], a[64:67], v[182:185], v[146:149]
v_mfma_f32_16x16x32_bf16 v[146:149], a[68:71], v[186:189], v[146:149]
v_cvt_pk_bf16_f32 v102, v138, v139
v_cvt_pk_bf16_f32 v103, v140, v141
v_cvt_pk_bf16_f32 v104, v142, v143
v_cvt_pk_bf16_f32 v105, v144, v145
s_nop 2
v_cvt_pk_bf16_f32 v106, v146, v147
v_cvt_pk_bf16_f32 v107, v148, v149
ds_read_b128 v[108:111], v215 offset:512
ds_read_b64 v[112:113], v215 offset:528
v_mfma_f32_16x16x16_bf16 v[138:141], v[82:83], v[76:77], 0
v_mfma_f32_16x16x16_bf16 v[142:145], v[100:101], v[76:77], 0
s_waitcnt lgkmcnt(0)
v_mfma_f32_16x16x16_bf16 v[150:153], v[112:113], v[76:77], v[206:209]
v_mfma_f32_16x16x16_bf16 v[146:149], v[106:107], v[76:77], 0
v_mfma_f32_16x16x32_bf16 v[138:141], v[78:81], v[72:75], v[138:141]
v_mfma_f32_16x16x32_bf16 v[142:145], v[96:99], v[72:75], v[142:145]
v_mfma_f32_16x16x32_bf16 v[150:153], v[108:111], v[72:75], v[150:153]
v_mfma_f32_16x16x32_bf16 v[146:149], v[102:105], v[72:75], v[146:149]
ds_read_b128 v[72:75], v215
ds_read_b64 v[76:77], v215 offset:16
v_mfma_f32_16x16x16_bf16 v[154:157], v[82:83], v[88:89], 0
v_mfma_f32_16x16x16_bf16 v[158:161], v[100:101], v[88:89], 0
v_mfma_f32_16x16x16_bf16 v[166:169], v[112:113], v[88:89], v[206:209]
v_mfma_f32_16x16x16_bf16 v[162:165], v[106:107], v[88:89], 0
v_mfma_f32_16x16x32_bf16 v[154:157], v[78:81], v[84:87], v[154:157]
v_mfma_f32_16x16x32_bf16 v[158:161], v[96:99], v[84:87], v[158:161]
v_mfma_f32_16x16x32_bf16 v[166:169], v[108:111], v[84:87], v[166:169]
v_mfma_f32_16x16x32_bf16 v[162:165], v[102:105], v[84:87], v[162:165]
v_mfma_f32_16x16x32_bf16 v[118:121], v[182:185], a[88:91], 0
v_mfma_f32_16x16x32_bf16 v[118:121], v[186:189], a[92:95], v[118:121]
v_mfma_f32_16x16x32_bf16 v[126:129], v[182:185], a[112:115], 0
v_mfma_f32_16x16x32_bf16 v[126:129], v[186:189], a[116:119], v[126:129]
v_mfma_f32_16x16x32_bf16 v[134:137], v[182:185], a[136:139], 0
v_mfma_f32_16x16x32_bf16 v[134:137], v[186:189], a[140:143], v[134:137]
v_mfma_f32_16x16x32_bf16 v[90:93], a[232:235], v[182:185], 0
v_mfma_f32_16x16x32_bf16 v[90:93], a[236:239], v[186:189], v[90:93]
v_mfma_f32_16x16x32_bf16 v[170:173], v[224:227], v[182:185], 0
v_mfma_f32_16x16x32_bf16 v[170:173], v[228:231], v[186:189], v[170:173]
v_mfma_f32_16x16x32_bf16 v[220:223], v[248:251], v[182:185], 0
v_mfma_f32_16x16x32_bf16 v[220:223], v[252:255], v[186:189], v[220:223]
v_mfma_f32_16x16x32_bf16 v[118:121], v[174:177], a[80:83], v[118:121]
v_mfma_f32_16x16x32_bf16 v[118:121], v[178:181], a[84:87], v[118:121]
v_mfma_f32_16x16x32_bf16 v[126:129], v[174:177], a[104:107], v[126:129]
v_mfma_f32_16x16x32_bf16 v[126:129], v[178:181], a[108:111], v[126:129]
v_mfma_f32_16x16x32_bf16 v[134:137], v[174:177], a[128:131], v[134:137]
v_mfma_f32_16x16x32_bf16 v[134:137], v[178:181], a[132:135], v[134:137]
v_mfma_f32_16x16x32_bf16 v[90:93], a[224:227], v[174:177], v[90:93]
v_mfma_f32_16x16x32_bf16 v[90:93], a[228:231], v[178:181], v[90:93]
v_mfma_f32_16x16x32_bf16 v[170:173], a[248:251], v[174:177], v[170:173]
v_mfma_f32_16x16x32_bf16 v[170:173], a[252:255], v[178:181], v[170:173]
v_mfma_f32_16x16x32_bf16 v[220:223], v[240:243], v[174:177], v[220:223]
v_mfma_f32_16x16x32_bf16 v[220:223], v[244:247], v[178:181], v[220:223]
ds_read_b128 v[182:185], v210 offset:32768
ds_read_b128 v[186:189], v210 offset:33792
s_waitcnt lgkmcnt(1)
v_mfma_f32_16x16x32_bf16 v[118:121], v[182:185], a[72:75], v[118:121]
s_waitcnt lgkmcnt(0)
v_mfma_f32_16x16x32_bf16 v[118:121], v[186:189], a[76:79], v[118:121]
v_mfma_f32_16x16x32_bf16 v[126:129], v[182:185], a[96:99], v[126:129]
v_mfma_f32_16x16x32_bf16 v[126:129], v[186:189], a[100:103], v[126:129]
v_mfma_f32_16x16x32_bf16 v[134:137], v[182:185], a[120:123], v[134:137]
v_mfma_f32_16x16x32_bf16 v[134:137], v[186:189], a[124:127], v[134:137]
v_mfma_f32_16x16x32_bf16 v[90:93], a[216:219], v[182:185], v[90:93]
v_mfma_f32_16x16x32_bf16 v[90:93], a[220:223], v[186:189], v[90:93]
v_mfma_f32_16x16x32_bf16 v[170:173], a[240:243], v[182:185], v[170:173]
v_mfma_f32_16x16x32_bf16 v[170:173], a[244:247], v[186:189], v[170:173]
v_mfma_f32_16x16x32_bf16 v[220:223], v[232:235], v[182:185], v[220:223]
v_mfma_f32_16x16x32_bf16 v[220:223], v[236:239], v[186:189], v[220:223]
v_mov_b32 v181, 0
v_cvt_pk_bf16_f32 v118, v118, v119
v_cvt_pk_bf16_f32 v119, v120, v121
ds_read_u16 v120, v205
v_mov_b32 v121, 0
v_cvt_pk_bf16_f32 v126, v126, v127
v_cvt_pk_bf16_f32 v127, v128, v129
ds_read_u16 v128, v205 offset:32
v_mov_b32 v129, 0
v_cvt_pk_bf16_f32 v134, v134, v135
v_cvt_pk_bf16_f32 v135, v136, v137
ds_read_u16 v136, v205 offset:64
v_mov_b32 v137, 0
v_add_u32 v205, 1424, v205
v_cvt_pk_bf16_f32 v90, v90, v91
v_cvt_pk_bf16_f32 v91, v92, v93
v_cvt_pk_bf16_f32 v92, v170, v171
v_cvt_pk_bf16_f32 v93, v172, v173
v_cvt_pk_bf16_f32 v94, v220, v221
v_cvt_pk_bf16_f32 v95, v222, v223
v_max3_f32 v151, v138, v139, v140
v_max3_f32 v151, v151, v141, v142
v_max3_f32 v151, v151, v143, v144
v_max3_f32 v151, v151, v145, v146
v_max3_f32 v151, v151, v147, v148
v_max3_f32 v151, v151, v149, v150
v_mov_b32 v152, v151
s_nop 1
v_permlane16_swap_b32 v151, v152
v_max_f32 v151, v151, v152
v_mov_b32 v152, v151
s_nop 1
v_permlane32_swap_b32 v151, v152
v_max_f32 v151, v151, v152
v_sub_f32 v138, v138, v151
v_sub_f32 v139, v139, v151
v_sub_f32 v140, v140, v151
v_sub_f32 v141, v141, v151
v_sub_f32 v142, v142, v151
v_sub_f32 v143, v143, v151
v_sub_f32 v144, v144, v151
v_sub_f32 v145, v145, v151
v_sub_f32 v150, v150, v151
v_sub_f32 v146, v146, v151
v_sub_f32 v147, v147, v151
v_sub_f32 v148, v148, v151
v_sub_f32 v149, v149, v151
v_exp_f32 v138, v138
v_exp_f32 v139, v139
v_exp_f32 v140, v140
v_exp_f32 v141, v141
v_exp_f32 v142, v142
v_exp_f32 v143, v143
v_exp_f32 v144, v144
v_exp_f32 v145, v145
v_exp_f32 v150, v150
v_exp_f32 v146, v146
v_exp_f32 v147, v147
v_exp_f32 v148, v148
v_exp_f32 v149, v149
v_cvt_pk_bf16_f32 v174, v138, v139
v_cvt_pk_bf16_f32 v175, v140, v141
v_cvt_pk_bf16_f32 v176, v142, v143
v_cvt_pk_bf16_f32 v177, v144, v145
v_cvt_pk_bf16_f32 v178, v146, v147
v_cvt_pk_bf16_f32 v179, v148, v149
v_cvt_pk_bf16_f32 v180, v150, 0
v_mfma_f32_16x16x32_bf16 v[150:153], v[190:193], v[174:177], 0
v_mfma_f32_16x16x32_bf16 v[150:153], v[190:193], v[178:181], v[150:153]
v_mfma_f32_16x16x32_bf16 v[138:141], v[114:117], v[174:177], 0
s_waitcnt lgkmcnt(2)
v_mfma_f32_16x16x32_bf16 v[138:141], v[118:121], v[178:181], v[138:141]
v_mfma_f32_16x16x32_bf16 v[142:145], v[122:125], v[174:177], 0
s_waitcnt lgkmcnt(1)
v_mfma_f32_16x16x32_bf16 v[142:145], v[126:129], v[178:181], v[142:145]
v_mfma_f32_16x16x32_bf16 v[146:149], v[130:133], v[174:177], 0
s_waitcnt lgkmcnt(0)
v_mfma_f32_16x16x32_bf16 v[146:149], v[134:137], v[178:181], v[146:149]
v_max3_f32 v167, v154, v155, v156
v_max3_f32 v167, v167, v157, v158
v_max3_f32 v167, v167, v159, v160
v_max3_f32 v167, v167, v161, v162
v_max3_f32 v167, v167, v163, v164
v_max3_f32 v167, v167, v165, v166
v_mov_b32 v168, v167
s_nop 1
v_permlane16_swap_b32 v167, v168
v_max_f32 v167, v167, v168
v_mov_b32 v168, v167
s_nop 1
v_permlane32_swap_b32 v167, v168
v_max_f32 v167, v167, v168
v_sub_f32 v154, v154, v167
v_sub_f32 v155, v155, v167
v_sub_f32 v156, v156, v167
v_sub_f32 v157, v157, v167
v_sub_f32 v158, v158, v167
v_sub_f32 v159, v159, v167
v_sub_f32 v160, v160, v167
v_sub_f32 v161, v161, v167
v_sub_f32 v166, v166, v167
v_sub_f32 v162, v162, v167
v_sub_f32 v163, v163, v167
v_sub_f32 v164, v164, v167
v_sub_f32 v165, v165, v167
v_exp_f32 v154, v154
v_exp_f32 v155, v155
v_exp_f32 v156, v156
v_exp_f32 v157, v157
v_exp_f32 v158, v158
v_exp_f32 v159, v159
v_exp_f32 v160, v160
v_exp_f32 v161, v161
v_exp_f32 v166, v166
v_exp_f32 v162, v162
v_exp_f32 v163, v163
v_exp_f32 v164, v164
v_exp_f32 v165, v165
v_cvt_pk_bf16_f32 v174, v154, v155
v_cvt_pk_bf16_f32 v175, v156, v157
v_cvt_pk_bf16_f32 v176, v158, v159
v_cvt_pk_bf16_f32 v177, v160, v161
v_cvt_pk_bf16_f32 v178, v162, v163
v_cvt_pk_bf16_f32 v179, v164, v165
v_cvt_pk_bf16_f32 v180, v166, 0
v_mfma_f32_16x16x32_bf16 v[166:169], v[190:193], v[174:177], 0
v_mfma_f32_16x16x32_bf16 v[166:169], v[190:193], v[178:181], v[166:169]
v_mfma_f32_16x16x32_bf16 v[154:157], v[114:117], v[174:177], 0
v_mfma_f32_16x16x32_bf16 v[154:157], v[118:121], v[178:181], v[154:157]
v_mfma_f32_16x16x32_bf16 v[158:161], v[122:125], v[174:177], 0
v_mfma_f32_16x16x32_bf16 v[158:161], v[126:129], v[178:181], v[158:161]
v_mfma_f32_16x16x32_bf16 v[162:165], v[130:133], v[174:177], 0
v_mfma_f32_16x16x32_bf16 v[162:165], v[134:137], v[178:181], v[162:165]
v_rcp_f32 v151, v150
s_nop 0
v_mul_f32 v152, s3, v151
v_mul_f32 v138, v138, v152
v_mul_f32 v139, v139, v152
v_cvt_pk_bf16_f32 v138, v138, v139
v_mul_f32 v140, v140, v152
v_mul_f32 v141, v141, v152
v_cvt_pk_bf16_f32 v139, v140, v141
v_mul_f32 v142, v142, v152
v_mul_f32 v143, v143, v152
v_cvt_pk_bf16_f32 v140, v142, v143
v_mul_f32 v144, v144, v152
v_mul_f32 v145, v145, v152
v_cvt_pk_bf16_f32 v141, v144, v145
ds_write_b128 v211, v[138:141] offset:38912
v_mul_f32 v146, v146, v152
v_mul_f32 v147, v147, v152
v_cvt_pk_bf16_f32 v142, v146, v147
v_mul_f32 v148, v148, v152
v_mul_f32 v149, v149, v152
v_cvt_pk_bf16_f32 v143, v148, v149
ds_write_b64 v212, v[142:143] offset:38912
v_mfma_f32_16x16x32_bf16 v[138:141], v[78:81], v[90:93], 0
v_mfma_f32_16x16x32_bf16 v[142:145], v[96:99], v[90:93], 0
v_mfma_f32_16x16x32_bf16 v[150:153], v[108:111], v[90:93], v[206:209]
v_mfma_f32_16x16x32_bf16 v[146:149], v[102:105], v[90:93], 0
v_mfma_f32_16x16x16_bf16 v[138:141], v[82:83], v[94:95], v[138:141]
v_mfma_f32_16x16x16_bf16 v[142:145], v[100:101], v[94:95], v[142:145]
v_mfma_f32_16x16x16_bf16 v[150:153], v[112:113], v[94:95], v[150:153]
v_mfma_f32_16x16x16_bf16 v[146:149], v[106:107], v[94:95], v[146:149]
v_rcp_f32 v167, v166
s_nop 0
v_mul_f32 v168, s3, v167
v_mul_f32 v154, v154, v168
v_mul_f32 v155, v155, v168
v_cvt_pk_bf16_f32 v154, v154, v155
v_mul_f32 v156, v156, v168
v_mul_f32 v157, v157, v168
v_cvt_pk_bf16_f32 v155, v156, v157
v_mul_f32 v158, v158, v168
v_mul_f32 v159, v159, v168
v_cvt_pk_bf16_f32 v156, v158, v159
v_mul_f32 v160, v160, v168
v_mul_f32 v161, v161, v168
v_cvt_pk_bf16_f32 v157, v160, v161
ds_write_b128 v211, v[154:157] offset:45056
v_mul_f32 v162, v162, v168
v_mul_f32 v163, v163, v168
v_cvt_pk_bf16_f32 v158, v162, v163
v_mul_f32 v164, v164, v168
v_mul_f32 v165, v165, v168
v_cvt_pk_bf16_f32 v159, v164, v165
ds_write_b64 v212, v[158:159] offset:45056
v_mfma_f32_16x16x32_bf16 v[154:157], v[72:75], v[78:81], 0
v_mfma_f32_16x16x32_bf16 v[158:161], v[72:75], v[96:99], 0
v_mfma_f32_16x16x32_bf16 v[162:165], v[72:75], v[102:105], 0
v_mfma_f32_16x16x16_bf16 v[154:157], v[76:77], v[82:83], v[154:157]
v_mfma_f32_16x16x16_bf16 v[158:161], v[76:77], v[100:101], v[158:161]
v_mfma_f32_16x16x16_bf16 v[162:165], v[76:77], v[106:107], v[162:165]
ds_read_b32 v166, v215 offset:536
s_nop 2
v_mov_b32_dpp v154, v158 quad_perm:[0,1,2,3] row_mask:0x2 bank_mask:0xf
s_nop 2
v_mov_b32_dpp v154, v162 quad_perm:[0,1,2,3] row_mask:0x4 bank_mask:0xf
s_waitcnt lgkmcnt(0)
s_nop 0
v_add_f32_dpp v154, v166, v207 quad_perm:[0,1,2,3] row_mask:0x8 bank_mask:0xf
v_mov_b32 v155, v154
s_nop 1
v_max_f32_dpp v155, v155, v155 row_ror:8 row_mask:0xf bank_mask:0xf
s_nop 1
v_max_f32_dpp v155, v155, v155 row_ror:4 row_mask:0xf bank_mask:0xf
s_nop 1
v_max_f32_dpp v155, v155, v155 row_ror:2 row_mask:0xf bank_mask:0xf
s_nop 1
v_max_f32_dpp v155, v155, v155 row_ror:1 row_mask:0xf bank_mask:0xf
v_mov_b32 v156, v155
s_nop 1
v_permlane16_swap_b32 v155, v156
v_max_f32 v155, v155, v156
v_mov_b32 v156, v155
s_nop 1
v_permlane32_swap_b32 v155, v156
v_max_f32 v155, v155, v156
v_sub_f32 v154, v154, v155
v_exp_f32 v166, v154
s_nop 0
v_cvt_pk_bf16_f32 v154, v166, 0
ds_write_b16 v214, v154
v_add_f32_dpp v166, v166, v166 row_ror:8 row_mask:0xf bank_mask:0xf
s_nop 1
v_add_f32_dpp v166, v166, v166 row_ror:4 row_mask:0xf bank_mask:0xf
s_nop 1
v_add_f32_dpp v166, v166, v166 row_ror:2 row_mask:0xf bank_mask:0xf
s_nop 1
v_add_f32_dpp v166, v166, v166 row_ror:1 row_mask:0xf bank_mask:0xf
s_nop 1
v_add_f32_dpp v166, v166, v166 row_bcast:15 row_mask:0xa bank_mask:0xf
s_nop 1
v_add_f32_dpp v166, v166, v166 row_bcast:31 row_mask:0xc bank_mask:0xf
s_nop 0
v_readlane_b32 s72, v166, 63
s_nop 1
v_rcp_f32 v167, s72
s_nop 0
v_mul_f32 v168, s3, v167
ds_read_b128 v[84:87], v215
ds_read_b128 v[88:91], v215 offset:16
v_add_u32 v215, 1424, v215
s_barrier
ds_read_b128 v[220:223], v210 offset:38912
ds_read_b128 v[110:113], v210 offset:39936
s_waitcnt lgkmcnt(1)
v_mfma_f32_16x16x32_bf16 v[36:39], a[144:147], v[220:223], v[36:39]
s_waitcnt lgkmcnt(0)
v_mfma_f32_16x16x32_bf16 v[36:39], a[148:151], v[110:113], v[36:39]
v_mfma_f32_16x16x32_bf16 v[40:43], a[168:171], v[220:223], v[40:43]
v_mfma_f32_16x16x32_bf16 v[40:43], a[172:175], v[110:113], v[40:43]
v_mfma_f32_16x16x32_bf16 v[44:47], a[192:195], v[220:223], v[44:47]
v_mfma_f32_16x16x32_bf16 v[44:47], a[196:199], v[110:113], v[44:47]
ds_read_b128 v[170:173], v210 offset:40960
ds_read_b128 v[182:185], v210 offset:41984
s_waitcnt lgkmcnt(1)
v_mfma_f32_16x16x32_bf16 v[36:39], a[152:155], v[170:173], v[36:39]
s_waitcnt lgkmcnt(0)
v_mfma_f32_16x16x32_bf16 v[36:39], a[156:159], v[182:185], v[36:39]
v_mfma_f32_16x16x32_bf16 v[40:43], a[176:179], v[170:173], v[40:43]
v_mfma_f32_16x16x32_bf16 v[40:43], a[180:183], v[182:185], v[40:43]
v_mfma_f32_16x16x32_bf16 v[44:47], a[200:203], v[170:173], v[44:47]
v_mfma_f32_16x16x32_bf16 v[44:47], a[204:207], v[182:185], v[44:47]
ds_read_b128 v[186:189], v210 offset:43008
ds_read_b128 v[220:223], v210 offset:44032
s_waitcnt lgkmcnt(1)
v_mfma_f32_16x16x32_bf16 v[36:39], a[160:163], v[186:189], v[36:39]
s_waitcnt lgkmcnt(0)
v_mfma_f32_16x16x32_bf16 v[36:39], a[164:167], v[220:223], v[36:39]
v_mfma_f32_16x16x32_bf16 v[40:43], a[184:187], v[186:189], v[40:43]
v_mfma_f32_16x16x32_bf16 v[40:43], a[188:191], v[220:223], v[40:43]
v_mfma_f32_16x16x32_bf16 v[44:47], a[208:211], v[186:189], v[44:47]
v_mfma_f32_16x16x32_bf16 v[44:47], a[212:215], v[220:223], v[44:47]
v_cvt_pk_bf16_f32 v36, v36, v37
v_cvt_pk_bf16_f32 v37, v38, v39
ds_write_b64 v203, v[36:37]
v_cvt_pk_bf16_f32 v40, v40, v41
v_cvt_pk_bf16_f32 v41, v42, v43
ds_write_b64 v203, v[40:41] offset:32
v_cvt_pk_bf16_f32 v44, v44, v45
v_cvt_pk_bf16_f32 v45, v46, v47
ds_write_b64 v203, v[44:45] offset:64
v_max3_f32 v151, v138, v139, v140
v_max3_f32 v151, v151, v141, v142
v_max3_f32 v151, v151, v143, v144
v_max3_f32 v151, v151, v145, v146
v_max3_f32 v151, v151, v147, v148
v_max3_f32 v151, v151, v149, v150
v_mov_b32 v152, v151
s_nop 1
v_permlane16_swap_b32 v151, v152
v_max_f32 v151, v151, v152
v_mov_b32 v152, v151
s_nop 1
v_permlane32_swap_b32 v151, v152
v_max_f32 v151, v151, v152
v_sub_f32 v138, v138, v151
v_sub_f32 v139, v139, v151
v_sub_f32 v140, v140, v151
v_sub_f32 v141, v141, v151
v_sub_f32 v142, v142, v151
v_sub_f32 v143, v143, v151
v_sub_f32 v144, v144, v151
v_sub_f32 v145, v145, v151
v_sub_f32 v150, v150, v151
v_sub_f32 v146, v146, v151
v_sub_f32 v147, v147, v151
v_sub_f32 v148, v148, v151
v_sub_f32 v149, v149, v151
v_exp_f32 v138, v138
v_exp_f32 v139, v139
v_exp_f32 v140, v140
v_exp_f32 v141, v141
v_exp_f32 v142, v142
v_exp_f32 v143, v143
v_exp_f32 v144, v144
v_exp_f32 v145, v145
v_exp_f32 v150, v150
v_exp_f32 v146, v146
v_exp_f32 v147, v147
v_exp_f32 v148, v148
v_exp_f32 v149, v149
v_cvt_pk_bf16_f32 v174, v138, v139
v_cvt_pk_bf16_f32 v175, v140, v141
v_cvt_pk_bf16_f32 v176, v142, v143
v_cvt_pk_bf16_f32 v177, v144, v145
v_cvt_pk_bf16_f32 v178, v146, v147
v_cvt_pk_bf16_f32 v179, v148, v149
v_cvt_pk_bf16_f32 v180, v150, 0
v_mfma_f32_16x16x32_bf16 v[150:153], v[190:193], v[174:177], 0
v_mfma_f32_16x16x32_bf16 v[150:153], v[190:193], v[178:181], v[150:153]
v_mfma_f32_16x16x32_bf16 v[138:141], v[114:117], v[174:177], 0
v_mfma_f32_16x16x32_bf16 v[138:141], v[118:121], v[178:181], v[138:141]
v_mfma_f32_16x16x32_bf16 v[142:145], v[122:125], v[174:177], 0
v_mfma_f32_16x16x32_bf16 v[142:145], v[126:129], v[178:181], v[142:145]
v_mfma_f32_16x16x32_bf16 v[146:149], v[130:133], v[174:177], 0
v_mfma_f32_16x16x32_bf16 v[146:149], v[134:137], v[178:181], v[146:149]
v_rcp_f32 v151, v150
s_nop 0
v_mul_f32 v152, s3, v151
v_mul_f32 v138, v138, v152
v_mul_f32 v139, v139, v152
v_cvt_pk_bf16_f32 v138, v138, v139
v_mul_f32 v140, v140, v152
v_mul_f32 v141, v141, v152
v_cvt_pk_bf16_f32 v139, v140, v141
v_mul_f32 v142, v142, v152
v_mul_f32 v143, v143, v152
v_cvt_pk_bf16_f32 v140, v142, v143
v_mul_f32 v144, v144, v152
v_mul_f32 v145, v145, v152
v_cvt_pk_bf16_f32 v141, v144, v145
ds_write_b128 v211, v[138:141] offset:51200
v_mul_f32 v146, v146, v152
v_mul_f32 v147, v147, v152
v_cvt_pk_bf16_f32 v142, v146, v147
v_mul_f32 v148, v148, v152
v_mul_f32 v149, v149, v152
v_cvt_pk_bf16_f32 v143, v148, v149
ds_write_b64 v212, v[142:143] offset:51200
v_mfma_f32_16x16x32_bf16 v[154:157], v[84:87], v[114:117], 0
v_mfma_f32_16x16x32_bf16 v[154:157], v[88:91], v[118:121], v[154:157]
v_mfma_f32_16x16x32_bf16 v[158:161], v[84:87], v[122:125], 0
v_mfma_f32_16x16x32_bf16 v[158:161], v[88:91], v[126:129], v[158:161]
v_mfma_f32_16x16x32_bf16 v[162:165], v[84:87], v[130:133], 0
v_mfma_f32_16x16x32_bf16 v[162:165], v[88:91], v[134:137], v[162:165]
v_mov_b32_dpp v154, v158 quad_perm:[0,1,2,3] row_mask:0x2 bank_mask:0xf
s_nop 5
v_mov_b32_dpp v154, v162 quad_perm:[0,1,2,3] row_mask:0x4 bank_mask:0xf
v_mul_f32 v154, v154, v168
v_cvt_pk_bf16_f32 v154, v154, 0
ds_write_b16 v214, v154
v_add_u32 v214, 1424, v214
ds_read_b128 v[110:113], v210 offset:45056
ds_read_b128 v[170:173], v210 offset:46080
s_waitcnt lgkmcnt(1)
v_mfma_f32_16x16x32_bf16 v[48:51], a[144:147], v[110:113], v[48:51]
s_waitcnt lgkmcnt(0)
v_mfma_f32_16x16x32_bf16 v[48:51], a[148:151], v[170:173], v[48:51]
v_mfma_f32_16x16x32_bf16 v[52:55], a[168:171], v[110:113], v[52:55]
v_mfma_f32_16x16x32_bf16 v[52:55], a[172:175], v[170:173], v[52:55]
v_mfma_f32_16x16x32_bf16 v[56:59], a[192:195], v[110:113], v[56:59]
v_mfma_f32_16x16x32_bf16 v[56:59], a[196:199], v[170:173], v[56:59]
ds_read_b128 v[182:185], v210 offset:47104
ds_read_b128 v[186:189], v210 offset:48128
s_waitcnt lgkmcnt(1)
v_mfma_f32_16x16x32_bf16 v[48:51], a[152:155], v[182:185], v[48:51]
s_waitcnt lgkmcnt(0)
v_mfma_f32_16x16x32_bf16 v[48:51], a[156:159], v[186:189], v[48:51]
v_mfma_f32_16x16x32_bf16 v[52:55], a[176:179], v[182:185], v[52:55]
v_mfma_f32_16x16x32_bf16 v[52:55], a[180:183], v[186:189], v[52:55]
v_mfma_f32_16x16x32_bf16 v[56:59], a[200:203], v[182:185], v[56:59]
v_mfma_f32_16x16x32_bf16 v[56:59], a[204:207], v[186:189], v[56:59]
ds_read_b128 v[220:223], v210 offset:49152
ds_read_b128 v[110:113], v210 offset:50176
s_waitcnt lgkmcnt(1)
v_mfma_f32_16x16x32_bf16 v[48:51], a[160:163], v[220:223], v[48:51]
s_waitcnt lgkmcnt(0)
v_mfma_f32_16x16x32_bf16 v[48:51], a[164:167], v[110:113], v[48:51]
v_mfma_f32_16x16x32_bf16 v[52:55], a[184:187], v[220:223], v[52:55]
v_mfma_f32_16x16x32_bf16 v[52:55], a[188:191], v[110:113], v[52:55]
v_mfma_f32_16x16x32_bf16 v[56:59], a[208:211], v[220:223], v[56:59]
v_mfma_f32_16x16x32_bf16 v[56:59], a[212:215], v[110:113], v[56:59]
v_cvt_pk_bf16_f32 v48, v48, v49
v_cvt_pk_bf16_f32 v49, v50, v51
ds_write_b64 v203, v[48:49] offset:6272
v_cvt_pk_bf16_f32 v52, v52, v53
v_cvt_pk_bf16_f32 v53, v54, v55
ds_write_b64 v203, v[52:53] offset:6304
v_cvt_pk_bf16_f32 v56, v56, v57
v_cvt_pk_bf16_f32 v57, v58, v59
ds_write_b64 v203, v[56:57] offset:6336
s_barrier
ds_read_b128 v[170:173], v210 offset:51200
ds_read_b128 v[182:185], v210 offset:52224
s_waitcnt lgkmcnt(1)
v_mfma_f32_16x16x32_bf16 v[60:63], a[144:147], v[170:173], v[60:63]
s_waitcnt lgkmcnt(0)
v_mfma_f32_16x16x32_bf16 v[60:63], a[148:151], v[182:185], v[60:63]
v_mfma_f32_16x16x32_bf16 v[64:67], a[168:171], v[170:173], v[64:67]
v_mfma_f32_16x16x32_bf16 v[64:67], a[172:175], v[182:185], v[64:67]
v_mfma_f32_16x16x32_bf16 v[68:71], a[192:195], v[170:173], v[68:71]
v_mfma_f32_16x16x32_bf16 v[68:71], a[196:199], v[182:185], v[68:71]
ds_read_b128 v[186:189], v210 offset:53248
ds_read_b128 v[220:223], v210 offset:54272
s_waitcnt lgkmcnt(1)
v_mfma_f32_16x16x32_bf16 v[60:63], a[152:155], v[186:189], v[60:63]
s_waitcnt lgkmcnt(0)
v_mfma_f32_16x16x32_bf16 v[60:63], a[156:159], v[220:223], v[60:63]
v_mfma_f32_16x16x32_bf16 v[64:67], a[176:179], v[186:189], v[64:67]
v_mfma_f32_16x16x32_bf16 v[64:67], a[180:183], v[220:223], v[64:67]
v_mfma_f32_16x16x32_bf16 v[68:71], a[200:203], v[186:189], v[68:71]
v_mfma_f32_16x16x32_bf16 v[68:71], a[204:207], v[220:223], v[68:71]
ds_read_b128 v[110:113], v210 offset:55296
ds_read_b128 v[170:173], v210 offset:56320
s_waitcnt lgkmcnt(1)
v_mfma_f32_16x16x32_bf16 v[60:63], a[160:163], v[110:113], v[60:63]
s_waitcnt lgkmcnt(0)
v_mfma_f32_16x16x32_bf16 v[60:63], a[164:167], v[170:173], v[60:63]
v_mfma_f32_16x16x32_bf16 v[64:67], a[184:187], v[110:113], v[64:67]
v_mfma_f32_16x16x32_bf16 v[64:67], a[188:191], v[170:173], v[64:67]
v_mfma_f32_16x16x32_bf16 v[68:71], a[208:211], v[110:113], v[68:71]
v_mfma_f32_16x16x32_bf16 v[68:71], a[212:215], v[170:173], v[68:71]
v_cvt_pk_bf16_f32 v60, v60, v61
v_cvt_pk_bf16_f32 v61, v62, v63
ds_write_b64 v203, v[60:61] offset:12544
v_cvt_pk_bf16_f32 v64, v64, v65
v_cvt_pk_bf16_f32 v65, v66, v67
ds_write_b64 v203, v[64:65] offset:12576
v_cvt_pk_bf16_f32 v68, v68, v69
v_cvt_pk_bf16_f32 v69, v70, v71
ds_write_b64 v203, v[68:69] offset:12608
s_waitcnt lgkmcnt(0)
s_barrier
ds_read_b64 v[120:121], v204
s_add_u32 s28, s39, s60
s_waitcnt lgkmcnt(0)
buffer_store_dwordx2 v[120:121], v204, s[8:11], s28 offen sc1
ds_read_b64 v[128:129], v204 offset:392
s_add_u32 s29, s39, s61
s_waitcnt lgkmcnt(0)
buffer_store_dwordx2 v[128:129], v204, s[8:11], s29 offen sc1
ds_read_b64 v[136:137], v204 offset:784
s_add_u32 s28, s39, s62
s_waitcnt lgkmcnt(0)
buffer_store_dwordx2 v[136:137], v204, s[8:11], s28 offen sc1
ds_read_b64 v[120:121], v204 offset:1176
s_add_u32 s29, s39, s63
s_waitcnt lgkmcnt(0)
buffer_store_dwordx2 v[120:121], v204, s[8:11], s29 offen sc1
ds_read_b64 v[128:129], v204 offset:6272
s_add_u32 s28, s39, s64
s_waitcnt lgkmcnt(0)
buffer_store_dwordx2 v[128:129], v204, s[8:11], s28 offen sc1
ds_read_b64 v[136:137], v204 offset:6664
s_add_u32 s29, s39, s65
s_waitcnt lgkmcnt(0)
buffer_store_dwordx2 v[136:137], v204, s[8:11], s29 offen sc1
ds_read_b64 v[120:121], v204 offset:7056
s_add_u32 s28, s39, s66
s_waitcnt lgkmcnt(0)
buffer_store_dwordx2 v[120:121], v204, s[8:11], s28 offen sc1
ds_read_b64 v[128:129], v204 offset:7448
s_add_u32 s29, s39, s67
s_waitcnt lgkmcnt(0)
buffer_store_dwordx2 v[128:129], v204, s[8:11], s29 offen sc1
ds_read_b64 v[136:137], v204 offset:12544
s_add_u32 s28, s39, s68
s_waitcnt lgkmcnt(0)
buffer_store_dwordx2 v[136:137], v204, s[8:11], s28 offen sc1
ds_read_b64 v[120:121], v204 offset:12936
s_add_u32 s29, s39, s69
s_waitcnt lgkmcnt(0)
buffer_store_dwordx2 v[120:121], v204, s[8:11], s29 offen sc1
ds_read_b64 v[128:129], v204 offset:13328
s_add_u32 s28, s39, s70
s_waitcnt lgkmcnt(0)
buffer_store_dwordx2 v[128:129], v204, s[8:11], s28 offen sc1
ds_read_b64 v[136:137], v204 offset:13720
s_add_u32 s29, s39, s71
s_waitcnt lgkmcnt(0)
buffer_store_dwordx2 v[136:137], v204, s[8:11], s29 offen sc1
v_subrev_u32 v60, 37120, v210
v_lshrrev_b32 v61, 4, v60
v_and_b32 v61, 15, v61
v_lshrrev_b32 v62, 8, v60
v_mul_u32_u24 v63, 1424, v61
v_lshl_add_u32 v63, v62, 5, v63
v_add_u32 v63, 94464, v63
v_lshl_add_u32 v64, v62, 3, v205
buffer_load_dwordx4 v[36:39], v210, s[24:27], s58 offen
buffer_load_dwordx4 v[40:43], v210, s[24:27], s58 offen offset:1024
buffer_load_dwordx4 v[44:47], v210, s[24:27], s58 offen offset:2048
v_lshlrev_b32 v67, 5, v61
s_add_u32 s41, s33, 0
v_add_u32 v67, s41, v67
s_mov_b32 s42, 58835169
v_mul_hi_u32 v68, v67, s42
v_mul_u32_u24 v65, 73, v68
v_sub_u32 v65, v67, v65
v_mul_u32_u24 v65, 2688, v65
s_mov_b32 s42, 1373568
v_mul_lo_u32 v68, v68, s42
s_mul_i32 s42, s32, 96
v_add3_u32 v65, v65, v68, s42
v_cmp_gt_u32 vcc, s34, v67
v_mov_b32 v68, 1879048192
s_nop 0
v_cndmask_b32 v65, v68, v65, vcc
v_lshl_add_u32 v65, v62, 3, v65
v_add_u32 v65, 1047808, v65
v_lshlrev_b32 v67, 5, v61
s_add_u32 s41, s33, 512
v_add_u32 v67, s41, v67
v_mov_b32 v68, s97
v_cmp_gt_u32 vcc, 4, v61
s_nop 1
v_cndmask_b32 v67, v68, v67, vcc
v_mov_b32 v68, 6000
v_cmp_gt_u32 vcc, 5, v61
s_nop 1
v_cndmask_b32 v67, v68, v67, vcc
s_mov_b32 s42, 58835169
v_mul_hi_u32 v68, v67, s42
v_mul_u32_u24 v66, 73, v68
v_sub_u32 v66, v67, v66
v_mul_u32_u24 v66, 2688, v66
s_mov_b32 s42, 1373568
v_mul_lo_u32 v68, v68, s42
s_mul_i32 s42, s32, 96
v_add3_u32 v66, v66, v68, s42
v_cmp_gt_u32 vcc, s34, v67
v_mov_b32 v68, 1879048192
s_nop 0
v_cndmask_b32 v66, v68, v66, vcc
v_lshl_add_u32 v66, v62, 3, v66
v_add_u32 v66, 1047808, v66
v_mov_b32_dpp v69, v194 row_newbcast:0 row_mask:0xf bank_mask:0xf
v_add_u32 v69, 17248, v69
v_mov_b32_dpp v70, v197 row_newbcast:0 row_mask:0xf bank_mask:0xf
v_add_u32 v70, 17248, v70
v_mov_b32_dpp v71, v200 row_newbcast:0 row_mask:0xf bank_mask:0xf
v_add_u32 v71, 17248, v71
ds_read_b128 v[174:177], v217
ds_read_b128 v[84:87], v71
s_waitcnt lgkmcnt(0)
v_mfma_f32_16x16x32_bf16 v[48:51], v[174:177], v[84:87], 0
ds_read_b128 v[178:181], v217 offset:528
ds_read_b128 v[92:95], v69
ds_read_b128 v[96:99], v69 offset:16
s_waitcnt lgkmcnt(0)
s_nop 0
v_smfmac_f32_16x16x64_bf16 v[48:51], v[178:181], v[92:99], v213
ds_read_b128 v[174:177], v217 offset:1056
ds_read_b128 v[100:103], v70
ds_read_b128 v[104:107], v70 offset:16
s_waitcnt lgkmcnt(0)
v_smfmac_f32_16x16x64_bf16 v[48:51], v[174:177], v[100:107], v213
ds_read_b128 v[178:181], v217 offset:1584
ds_read_b128 v[84:87], v71 offset:32
s_waitcnt lgkmcnt(0)
v_mfma_f32_16x16x32_bf16 v[52:55], v[178:181], v[84:87], 0
ds_read_b128 v[174:177], v217 offset:2112
ds_read_b128 v[92:95], v69 offset:32
ds_read_b128 v[96:99], v69 offset:48
s_waitcnt lgkmcnt(0)
s_nop 0
v_smfmac_f32_16x16x64_bf16 v[52:55], v[174:177], v[92:99], v213
ds_read_b128 v[178:181], v217 offset:2640
ds_read_b128 v[100:103], v70 offset:32
ds_read_b128 v[104:107], v70 offset:48
s_waitcnt lgkmcnt(0)
v_smfmac_f32_16x16x64_bf16 v[52:55], v[178:181], v[100:107], v213
ds_read_b128 v[174:177], v217 offset:3168
ds_read_b128 v[84:87], v71 offset:64
s_waitcnt lgkmcnt(0)
v_mfma_f32_16x16x32_bf16 v[56:59], v[174:177], v[84:87], 0
ds_read_b128 v[178:181], v217 offset:3696
ds_read_b128 v[92:95], v69 offset:64
ds_read_b128 v[96:99], v69 offset:80
s_waitcnt lgkmcnt(0)
s_nop 0
v_smfmac_f32_16x16x64_bf16 v[56:59], v[178:181], v[92:99], v213
ds_read_b128 v[174:177], v217 offset:4224
ds_read_b128 v[100:103], v70 offset:64
ds_read_b128 v[104:107], v70 offset:80
s_waitcnt lgkmcnt(0)
v_smfmac_f32_16x16x64_bf16 v[56:59], v[174:177], v[100:107], v213
v_add_f32 v118, v48, v49
v_mul_f32 v119, v48, v48
v_add_f32 v118, v118, v50
v_fmac_f32 v119, v49, v49
v_add_f32 v118, v118, v51
v_fmac_f32 v119, v50, v50
v_fmac_f32 v119, v51, v51
v_add_f32 v118, v118, v52
v_fmac_f32 v119, v52, v52
v_add_f32 v118, v118, v53
v_fmac_f32 v119, v53, v53
v_add_f32 v118, v118, v54
v_fmac_f32 v119, v54, v54
v_add_f32 v118, v118, v55
v_fmac_f32 v119, v55, v55
v_add_f32 v118, v118, v56
v_fmac_f32 v119, v56, v56
v_add_f32 v118, v118, v57
v_fmac_f32 v119, v57, v57
v_add_f32 v118, v118, v58
v_fmac_f32 v119, v58, v58
v_add_f32 v118, v118, v59
v_fmac_f32 v119, v59, v59
s_nop 1
v_permlane16_swap_b32 v118, v119
v_add_f32 v118, v118, v119
v_mov_b32 v126, v118
s_nop 1
v_permlane32_swap_b32 v118, v126
v_add_f32 v118, v118, v126
ds_write_b32 v209, v118
s_mov_b32 s38, s36
s_waitcnt lgkmcnt(0)
s_barrier
ds_read_b128 v[84:87], v63
ds_read_b128 v[88:91], v63 offset:128
ds_read_b128 v[92:95], v63 offset:256
ds_read_b128 v[96:99], v63 offset:384
ds_read_b64 v[100:101], v63 offset:16
ds_read_b64 v[102:103], v63 offset:144
ds_read_b64 v[104:105], v63 offset:272
s_waitcnt vmcnt(2) lgkmcnt(6)
ds_read_b64 v[106:107], v63 offset:400
v_mfma_f32_16x16x32_bf16 v[36:39], a[144:147], v[84:87], v[36:39]
s_waitcnt lgkmcnt(6)
v_mfma_f32_16x16x32_bf16 v[36:39], a[148:151], v[88:91], v[36:39]
s_waitcnt lgkmcnt(5)
v_mfma_f32_16x16x32_bf16 v[36:39], a[152:155], v[92:95], v[36:39]
s_waitcnt lgkmcnt(4)
v_mfma_f32_16x16x32_bf16 v[36:39], a[156:159], v[96:99], v[36:39]
s_waitcnt lgkmcnt(2)
v_mfma_f32_16x16x32_bf16 v[36:39], a[160:163], v[100:103], v[36:39]
s_waitcnt lgkmcnt(0)
v_mfma_f32_16x16x32_bf16 v[36:39], a[164:167], v[104:107], v[36:39]
s_nop 7
v_cvt_pk_bf16_f32 v36, v36, v37
v_cvt_pk_bf16_f32 v37, v38, v39
buffer_store_dwordx2 v[36:37], v65, s[8:11], 0 offen
s_waitcnt vmcnt(2)
v_mfma_f32_16x16x32_bf16 v[40:43], a[168:171], v[84:87], v[40:43]
v_mfma_f32_16x16x32_bf16 v[40:43], a[172:175], v[88:91], v[40:43]
v_mfma_f32_16x16x32_bf16 v[40:43], a[176:179], v[92:95], v[40:43]
v_mfma_f32_16x16x32_bf16 v[40:43], a[180:183], v[96:99], v[40:43]
v_mfma_f32_16x16x32_bf16 v[40:43], a[184:187], v[100:103], v[40:43]
v_mfma_f32_16x16x32_bf16 v[40:43], a[188:191], v[104:107], v[40:43]
s_nop 7
v_cvt_pk_bf16_f32 v40, v40, v41
v_cvt_pk_bf16_f32 v41, v42, v43
buffer_store_dwordx2 v[40:41], v65, s[8:11], 0 offen offset:32
s_waitcnt vmcnt(2)
v_mfma_f32_16x16x32_bf16 v[44:47], a[192:195], v[84:87], v[44:47]
v_mfma_f32_16x16x32_bf16 v[44:47], a[196:199], v[88:91], v[44:47]
v_mfma_f32_16x16x32_bf16 v[44:47], a[200:203], v[92:95], v[44:47]
v_mfma_f32_16x16x32_bf16 v[44:47], a[204:207], v[96:99], v[44:47]
v_mfma_f32_16x16x32_bf16 v[44:47], a[208:211], v[100:103], v[44:47]
v_mfma_f32_16x16x32_bf16 v[44:47], a[212:215], v[104:107], v[44:47]
s_nop 7
v_cvt_pk_bf16_f32 v44, v44, v45
v_cvt_pk_bf16_f32 v45, v46, v47
buffer_store_dwordx2 v[44:45], v65, s[8:11], 0 offen offset:64
ds_read_b128 v[182:185], v210
ds_read_b128 v[186:189], v210 offset:1024
s_waitcnt lgkmcnt(1)
v_mfma_f32_16x16x32_bf16 v[138:141], a[0:3], v[182:185], 0
s_waitcnt lgkmcnt(0)
v_mfma_f32_16x16x32_bf16 v[138:141], a[4:7], v[186:189], v[138:141]
v_mfma_f32_16x16x32_bf16 v[142:145], a[24:27], v[182:185], 0
v_mfma_f32_16x16x32_bf16 v[142:145], a[28:31], v[186:189], v[142:145]
v_mfma_f32_16x16x32_bf16 v[146:149], a[48:51], v[182:185], 0
v_mfma_f32_16x16x32_bf16 v[146:149], a[52:55], v[186:189], v[146:149]
v_mfma_f32_16x16x32_bf16 v[150:153], a[216:219], v[182:185], 0
v_mfma_f32_16x16x32_bf16 v[150:153], a[220:223], v[186:189], v[150:153]
v_mfma_f32_16x16x32_bf16 v[154:157], a[240:243], v[182:185], 0
v_mfma_f32_16x16x32_bf16 v[154:157], a[244:247], v[186:189], v[154:157]
v_mfma_f32_16x16x32_bf16 v[158:161], v[232:235], v[182:185], 0
v_mfma_f32_16x16x32_bf16 v[158:161], v[236:239], v[186:189], v[158:161]
v_mfma_f32_16x16x32_bf16 v[162:165], v[182:185], a[72:75], 0
v_mfma_f32_16x16x32_bf16 v[162:165], v[186:189], a[76:79], v[162:165]
v_mfma_f32_16x16x32_bf16 v[166:169], v[182:185], a[96:99], 0
v_mfma_f32_16x16x32_bf16 v[166:169], v[186:189], a[100:103], v[166:169]
v_mfma_f32_16x16x32_bf16 v[170:173], v[182:185], a[120:123], 0
v_mfma_f32_16x16x32_bf16 v[170:173], v[186:189], a[124:127], v[170:173]
ds_read_b128 v[110:113], v210 offset:2048
ds_read_b128 v[220:223], v210 offset:3072
s_waitcnt lgkmcnt(1)
v_mfma_f32_16x16x32_bf16 v[138:141], a[8:11], v[110:113], v[138:141]
s_waitcnt lgkmcnt(0)
v_mfma_f32_16x16x32_bf16 v[138:141], a[12:15], v[220:223], v[138:141]
v_mfma_f32_16x16x32_bf16 v[142:145], a[32:35], v[110:113], v[142:145]
v_mfma_f32_16x16x32_bf16 v[142:145], a[36:39], v[220:223], v[142:145]
v_mfma_f32_16x16x32_bf16 v[146:149], a[56:59], v[110:113], v[146:149]
v_mfma_f32_16x16x32_bf16 v[146:149], a[60:63], v[220:223], v[146:149]
v_mfma_f32_16x16x32_bf16 v[150:153], a[224:227], v[110:113], v[150:153]
v_mfma_f32_16x16x32_bf16 v[150:153], a[228:231], v[220:223], v[150:153]
v_mfma_f32_16x16x32_bf16 v[154:157], a[248:251], v[110:113], v[154:157]
v_mfma_f32_16x16x32_bf16 v[154:157], a[252:255], v[220:223], v[154:157]
v_mfma_f32_16x16x32_bf16 v[158:161], v[240:243], v[110:113], v[158:161]
v_mfma_f32_16x16x32_bf16 v[158:161], v[244:247], v[220:223], v[158:161]
v_mfma_f32_16x16x32_bf16 v[162:165], v[110:113], a[80:83], v[162:165]
v_mfma_f32_16x16x32_bf16 v[162:165], v[220:223], a[84:87], v[162:165]
v_mfma_f32_16x16x32_bf16 v[166:169], v[110:113], a[104:107], v[166:169]
v_mfma_f32_16x16x32_bf16 v[166:169], v[220:223], a[108:111], v[166:169]
v_mfma_f32_16x16x32_bf16 v[170:173], v[110:113], a[128:131], v[170:173]
v_mfma_f32_16x16x32_bf16 v[170:173], v[220:223], a[132:135], v[170:173]
ds_read_b128 v[182:185], v210 offset:4096
ds_read_b128 v[186:189], v210 offset:5120
s_waitcnt lgkmcnt(1)
v_mfma_f32_16x16x32_bf16 v[138:141], a[16:19], v[182:185], v[138:141]
s_waitcnt lgkmcnt(0)
v_mfma_f32_16x16x32_bf16 v[138:141], a[20:23], v[186:189], v[138:141]
v_mfma_f32_16x16x32_bf16 v[142:145], a[40:43], v[182:185], v[142:145]
v_mfma_f32_16x16x32_bf16 v[142:145], a[44:47], v[186:189], v[142:145]
v_mfma_f32_16x16x32_bf16 v[146:149], a[64:67], v[182:185], v[146:149]
v_mfma_f32_16x16x32_bf16 v[146:149], a[68:71], v[186:189], v[146:149]
v_mfma_f32_16x16x32_bf16 v[150:153], a[232:235], v[182:185], v[150:153]
v_mfma_f32_16x16x32_bf16 v[150:153], a[236:239], v[186:189], v[150:153]
v_mfma_f32_16x16x32_bf16 v[154:157], v[224:227], v[182:185], v[154:157]
v_mfma_f32_16x16x32_bf16 v[154:157], v[228:231], v[186:189], v[154:157]
v_mfma_f32_16x16x32_bf16 v[158:161], v[248:251], v[182:185], v[158:161]
v_mfma_f32_16x16x32_bf16 v[158:161], v[252:255], v[186:189], v[158:161]
v_mfma_f32_16x16x32_bf16 v[162:165], v[182:185], a[88:91], v[162:165]
v_mfma_f32_16x16x32_bf16 v[162:165], v[186:189], a[92:95], v[162:165]
v_mfma_f32_16x16x32_bf16 v[166:169], v[182:185], a[112:115], v[166:169]
v_mfma_f32_16x16x32_bf16 v[166:169], v[186:189], a[116:119], v[166:169]
v_mfma_f32_16x16x32_bf16 v[170:173], v[182:185], a[136:139], v[170:173]
v_mfma_f32_16x16x32_bf16 v[170:173], v[186:189], a[140:143], v[170:173]
v_cvt_pk_bf16_f32 v78, v138, v139
v_cvt_pk_bf16_f32 v79, v140, v141
v_cvt_pk_bf16_f32 v80, v142, v143
v_cvt_pk_bf16_f32 v81, v144, v145
v_cvt_pk_bf16_f32 v82, v146, v147
v_cvt_pk_bf16_f32 v83, v148, v149
v_cvt_pk_bf16_f32 v72, v150, v151
v_cvt_pk_bf16_f32 v73, v152, v153
v_cvt_pk_bf16_f32 v74, v154, v155
v_cvt_pk_bf16_f32 v75, v156, v157
v_cvt_pk_bf16_f32 v76, v158, v159
v_cvt_pk_bf16_f32 v77, v160, v161
v_cvt_pk_bf16_f32 v114, v162, v163
v_cvt_pk_bf16_f32 v115, v164, v165
v_cvt_pk_bf16_f32 v122, v166, v167
v_cvt_pk_bf16_f32 v123, v168, v169
v_cvt_pk_bf16_f32 v130, v170, v171
v_cvt_pk_bf16_f32 v131, v172, v173
ds_read_b128 v[110:113], v210 offset:6144
ds_read_b128 v[220:223], v210 offset:7168
s_waitcnt lgkmcnt(1)
v_mfma_f32_16x16x32_bf16 v[138:141], a[0:3], v[110:113], 0
s_waitcnt lgkmcnt(0)
v_mfma_f32_16x16x32_bf16 v[138:141], a[4:7], v[220:223], v[138:141]
v_mfma_f32_16x16x32_bf16 v[142:145], a[24:27], v[110:113], 0
v_mfma_f32_16x16x32_bf16 v[142:145], a[28:31], v[220:223], v[142:145]
v_mfma_f32_16x16x32_bf16 v[146:149], a[48:51], v[110:113], 0
v_mfma_f32_16x16x32_bf16 v[146:149], a[52:55], v[220:223], v[146:149]
v_mfma_f32_16x16x32_bf16 v[150:153], a[216:219], v[110:113], 0
v_mfma_f32_16x16x32_bf16 v[150:153], a[220:223], v[220:223], v[150:153]
v_mfma_f32_16x16x32_bf16 v[154:157], a[240:243], v[110:113], 0
v_mfma_f32_16x16x32_bf16 v[154:157], a[244:247], v[220:223], v[154:157]
v_mfma_f32_16x16x32_bf16 v[158:161], v[232:235], v[110:113], 0
v_mfma_f32_16x16x32_bf16 v[158:161], v[236:239], v[220:223], v[158:161]
v_mfma_f32_16x16x32_bf16 v[162:165], v[110:113], a[72:75], 0
v_mfma_f32_16x16x32_bf16 v[162:165], v[220:223], a[76:79], v[162:165]
v_mfma_f32_16x16x32_bf16 v[166:169], v[110:113], a[96:99], 0
v_mfma_f32_16x16x32_bf16 v[166:169], v[220:223], a[100:103], v[166:169]
v_mfma_f32_16x16x32_bf16 v[170:173], v[110:113], a[120:123], 0
v_mfma_f32_16x16x32_bf16 v[170:173], v[220:223], a[124:127], v[170:173]
ds_read_b128 v[102:105], v210 offset:18432
ds_read_b128 v[106:109], v210 offset:19456
s_waitcnt lgkmcnt(1)
v_add_f32 v102, v102, v103
s_waitcnt lgkmcnt(0)
v_add_f32 v106, v106, v107
v_add_f32 v104, v104, v105
v_add_f32 v108, v108, v109
v_add_f32 v102, v102, v104
v_add_f32 v106, v106, v108
v_mul_f32 v103, s48, v102
v_mul_f32 v104, s73, v102
v_mul_f32 v106, s73, v106
v_fma_f32 v106, -v103, v104, v106
v_max_f32 v106, 0, v106
v_add_f32 v106, s49, v106
v_rsq_f32 v102, v106
s_nop 0
v_mul_f32_e64 v103, -v103, v102
ds_write_b64 v211, v[102:103] offset:20480
ds_read_b64 v[118:119], v219 offset:20480
s_waitcnt lgkmcnt(0)
v_fma_f32 v220, v48, v118, v119
v_fma_f32 v221, v49, v118, v119
v_cvt_pk_bf16_f32 v174, v220, v221
v_fma_f32 v222, v50, v118, v119
v_fma_f32 v223, v51, v118, v119
v_cvt_pk_bf16_f32 v175, v222, v223
v_fma_f32 v220, v52, v118, v119
v_fma_f32 v221, v53, v118, v119
v_cvt_pk_bf16_f32 v176, v220, v221
v_fma_f32 v222, v54, v118, v119
v_fma_f32 v223, v55, v118, v119
v_cvt_pk_bf16_f32 v177, v222, v223
ds_write_b128 v211, v[174:177] offset:20480
v_fma_f32 v220, v56, v118, v119
v_fma_f32 v221, v57, v118, v119
v_cvt_pk_bf16_f32 v178, v220, v221
v_fma_f32 v222, v58, v118, v119
v_fma_f32 v223, v59, v118, v119
v_cvt_pk_bf16_f32 v179, v222, v223
ds_write_b64 v212, v[178:179] offset:20480
s_mov_b64 exec, s[56:57]
buffer_load_dwordx4 v[48:51], v210, s[24:27], s59 offen
s_mov_b64 exec, -1
s_mov_b64 exec, s[56:57]
buffer_load_dwordx4 v[52:55], v210, s[24:27], s59 offen offset:1024
s_mov_b64 exec, -1
s_mov_b64 exec, s[56:57]
buffer_load_dwordx4 v[56:59], v210, s[24:27], s59 offen offset:2048
s_mov_b64 exec, -1
s_waitcnt lgkmcnt(0)
s_barrier
ds_read_b128 v[182:185], v210 offset:8192
ds_read_b128 v[186:189], v210 offset:9216
s_waitcnt lgkmcnt(1)
v_mfma_f32_16x16x32_bf16 v[138:141], a[8:11], v[182:185], v[138:141]
s_waitcnt lgkmcnt(0)
v_mfma_f32_16x16x32_bf16 v[138:141], a[12:15], v[186:189], v[138:141]
v_mfma_f32_16x16x32_bf16 v[142:145], a[32:35], v[182:185], v[142:145]
v_mfma_f32_16x16x32_bf16 v[142:145], a[36:39], v[186:189], v[142:145]
v_mfma_f32_16x16x32_bf16 v[146:149], a[56:59], v[182:185], v[146:149]
v_mfma_f32_16x16x32_bf16 v[146:149], a[60:63], v[186:189], v[146:149]
v_mfma_f32_16x16x32_bf16 v[150:153], a[224:227], v[182:185], v[150:153]
v_mfma_f32_16x16x32_bf16 v[150:153], a[228:231], v[186:189], v[150:153]
v_mfma_f32_16x16x32_bf16 v[154:157], a[248:251], v[182:185], v[154:157]
v_mfma_f32_16x16x32_bf16 v[154:157], a[252:255], v[186:189], v[154:157]
v_mfma_f32_16x16x32_bf16 v[158:161], v[240:243], v[182:185], v[158:161]
v_mfma_f32_16x16x32_bf16 v[158:161], v[244:247], v[186:189], v[158:161]
v_mfma_f32_16x16x32_bf16 v[162:165], v[182:185], a[80:83], v[162:165]
v_mfma_f32_16x16x32_bf16 v[162:165], v[186:189], a[84:87], v[162:165]
v_mfma_f32_16x16x32_bf16 v[166:169], v[182:185], a[104:107], v[166:169]
v_mfma_f32_16x16x32_bf16 v[166:169], v[186:189], a[108:111], v[166:169]
v_mfma_f32_16x16x32_bf16 v[170:173], v[182:185], a[128:131], v[170:173]
v_mfma_f32_16x16x32_bf16 v[170:173], v[186:189], a[132:135], v[170:173]
ds_read_b128 v[110:113], v210 offset:10240
ds_read_b128 v[106:109], v210 offset:11264
s_waitcnt lgkmcnt(1)
v_mfma_f32_16x16x32_bf16 v[138:141], a[16:19], v[110:113], v[138:141]
s_waitcnt lgkmcnt(0)
v_mfma_f32_16x16x32_bf16 v[138:141], a[20:23], v[106:109], v[138:141]
v_mfma_f32_16x16x32_bf16 v[142:145], a[40:43], v[110:113], v[142:145]
v_mfma_f32_16x16x32_bf16 v[142:145], a[44:47], v[106:109], v[142:145]
v_mfma_f32_16x16x32_bf16 v[146:149], a[64:67], v[110:113], v[146:149]
v_mfma_f32_16x16x32_bf16 v[146:149], a[68:71], v[106:109], v[146:149]
v_mfma_f32_16x16x32_bf16 v[150:153], a[232:235], v[110:113], v[150:153]
v_mfma_f32_16x16x32_bf16 v[150:153], a[236:239], v[106:109], v[150:153]
v_mfma_f32_16x16x32_bf16 v[154:157], v[224:227], v[110:113], v[154:157]
v_mfma_f32_16x16x32_bf16 v[154:157], v[228:231], v[106:109], v[154:157]
v_mfma_f32_16x16x32_bf16 v[158:161], v[248:251], v[110:113], v[158:161]
v_mfma_f32_16x16x32_bf16 v[158:161], v[252:255], v[106:109], v[158:161]
v_mfma_f32_16x16x32_bf16 v[162:165], v[110:113], a[88:91], v[162:165]
v_mfma_f32_16x16x32_bf16 v[162:165], v[106:109], a[92:95], v[162:165]
v_mfma_f32_16x16x32_bf16 v[166:169], v[110:113], a[112:115], v[166:169]
v_mfma_f32_16x16x32_bf16 v[166:169], v[106:109], a[116:119], v[166:169]
v_mfma_f32_16x16x32_bf16 v[170:173], v[110:113], a[136:139], v[170:173]
v_mfma_f32_16x16x32_bf16 v[170:173], v[106:109], a[140:143], v[170:173]
v_cvt_pk_bf16_f32 v96, v138, v139
v_cvt_pk_bf16_f32 v97, v140, v141
v_cvt_pk_bf16_f32 v98, v142, v143
v_cvt_pk_bf16_f32 v99, v144, v145
v_cvt_pk_bf16_f32 v100, v146, v147
v_cvt_pk_bf16_f32 v101, v148, v149
v_cvt_pk_bf16_f32 v84, v150, v151
v_cvt_pk_bf16_f32 v85, v152, v153
v_cvt_pk_bf16_f32 v86, v154, v155
v_cvt_pk_bf16_f32 v87, v156, v157
v_cvt_pk_bf16_f32 v88, v158, v159
v_cvt_pk_bf16_f32 v89, v160, v161
v_cvt_pk_bf16_f32 v116, v162, v163
v_cvt_pk_bf16_f32 v117, v164, v165
v_cvt_pk_bf16_f32 v124, v166, v167
v_cvt_pk_bf16_f32 v125, v168, v169
v_cvt_pk_bf16_f32 v132, v170, v171
v_cvt_pk_bf16_f32 v133, v172, v173
ds_read_b128 v[182:185], v210 offset:20480
ds_read_b128 v[186:189], v210 offset:21504
s_waitcnt lgkmcnt(1)
v_mfma_f32_16x16x32_bf16 v[138:141], a[216:219], v[182:185], 0
s_waitcnt lgkmcnt(0)
v_mfma_f32_16x16x32_bf16 v[138:141], a[220:223], v[186:189], v[138:141]
v_mfma_f32_16x16x32_bf16 v[142:145], a[240:243], v[182:185], 0
v_mfma_f32_16x16x32_bf16 v[142:145], a[244:247], v[186:189], v[142:145]
v_mfma_f32_16x16x32_bf16 v[146:149], v[232:235], v[182:185], 0
v_mfma_f32_16x16x32_bf16 v[146:149], v[236:239], v[186:189], v[146:149]
v_mfma_f32_16x16x32_bf16 v[150:153], a[0:3], v[182:185], 0
v_mfma_f32_16x16x32_bf16 v[150:153], a[4:7], v[186:189], v[150:153]
v_mfma_f32_16x16x32_bf16 v[154:157], a[24:27], v[182:185], 0
v_mfma_f32_16x16x32_bf16 v[154:157], a[28:31], v[186:189], v[154:157]
v_mfma_f32_16x16x32_bf16 v[158:161], a[48:51], v[182:185], 0
v_mfma_f32_16x16x32_bf16 v[158:161], a[52:55], v[186:189], v[158:161]
v_mfma_f32_16x16x32_bf16 v[162:165], a[72:75], v[182:185], 0
v_mfma_f32_16x16x32_bf16 v[162:165], a[76:79], v[186:189], v[162:165]
v_mfma_f32_16x16x32_bf16 v[166:169], a[96:99], v[182:185], 0
v_mfma_f32_16x16x32_bf16 v[166:169], a[100:103], v[186:189], v[166:169]
v_mfma_f32_16x16x32_bf16 v[170:173], a[120:123], v[182:185], 0
v_mfma_f32_16x16x32_bf16 v[170:173], a[124:127], v[186:189], v[170:173]
ds_read_b128 v[174:177], v210 offset:22528
ds_read_b128 v[178:181], v210 offset:23552
s_waitcnt lgkmcnt(1)
v_mfma_f32_16x16x32_bf16 v[138:141], a[224:227], v[174:177], v[138:141]
s_waitcnt lgkmcnt(0)
v_mfma_f32_16x16x32_bf16 v[138:141], a[228:231], v[178:181], v[138:141]
v_mfma_f32_16x16x32_bf16 v[142:145], a[248:251], v[174:177], v[142:145]
v_mfma_f32_16x16x32_bf16 v[142:145], a[252:255], v[178:181], v[142:145]
v_mfma_f32_16x16x32_bf16 v[146:149], v[240:243], v[174:177], v[146:149]
v_mfma_f32_16x16x32_bf16 v[146:149], v[244:247], v[178:181], v[146:149]
v_mfma_f32_16x16x32_bf16 v[150:153], a[8:11], v[174:177], v[150:153]
v_mfma_f32_16x16x32_bf16 v[150:153], a[12:15], v[178:181], v[150:153]
v_mfma_f32_16x16x32_bf16 v[154:157], a[32:35], v[174:177], v[154:157]
v_mfma_f32_16x16x32_bf16 v[154:157], a[36:39], v[178:181], v[154:157]
v_mfma_f32_16x16x32_bf16 v[158:161], a[56:59], v[174:177], v[158:161]
v_mfma_f32_16x16x32_bf16 v[158:161], a[60:63], v[178:181], v[158:161]
v_mfma_f32_16x16x32_bf16 v[162:165], a[80:83], v[174:177], v[162:165]
v_mfma_f32_16x16x32_bf16 v[162:165], a[84:87], v[178:181], v[162:165]
v_mfma_f32_16x16x32_bf16 v[166:169], a[104:107], v[174:177], v[166:169]
v_mfma_f32_16x16x32_bf16 v[166:169], a[108:111], v[178:181], v[166:169]
v_mfma_f32_16x16x32_bf16 v[170:173], a[128:131], v[174:177], v[170:173]
v_mfma_f32_16x16x32_bf16 v[170:173], a[132:135], v[178:181], v[170:173]
ds_read_b128 v[220:223], v210 offset:24576
ds_read_b128 v[118:121], v210 offset:25600
s_waitcnt lgkmcnt(1)
v_mfma_f32_16x16x32_bf16 v[138:141], a[232:235], v[220:223], v[138:141]
s_waitcnt lgkmcnt(0)
v_mfma_f32_16x16x32_bf16 v[138:141], a[236:239], v[118:121], v[138:141]
v_mfma_f32_16x16x32_bf16 v[142:145], v[224:227], v[220:223], v[142:145]
v_mfma_f32_16x16x32_bf16 v[142:145], v[228:231], v[118:121], v[142:145]
v_mfma_f32_16x16x32_bf16 v[146:149], v[248:251], v[220:223], v[146:149]
v_mfma_f32_16x16x32_bf16 v[146:149], v[252:255], v[118:121], v[146:149]
v_mfma_f32_16x16x32_bf16 v[150:153], a[16:19], v[220:223], v[150:153]
v_mfma_f32_16x16x32_bf16 v[150:153], a[20:23], v[118:121], v[150:153]
v_mfma_f32_16x16x32_bf16 v[154:157], a[40:43], v[220:223], v[154:157]
v_mfma_f32_16x16x32_bf16 v[154:157], a[44:47], v[118:121], v[154:157]
v_mfma_f32_16x16x32_bf16 v[158:161], a[64:67], v[220:223], v[158:161]
v_mfma_f32_16x16x32_bf16 v[158:161], a[68:71], v[118:121], v[158:161]
v_mfma_f32_16x16x32_bf16 v[162:165], a[88:91], v[220:223], v[162:165]
v_mfma_f32_16x16x32_bf16 v[162:165], a[92:95], v[118:121], v[162:165]
v_mfma_f32_16x16x32_bf16 v[166:169], a[112:115], v[220:223], v[166:169]
v_mfma_f32_16x16x32_bf16 v[166:169], a[116:119], v[118:121], v[166:169]
v_mfma_f32_16x16x32_bf16 v[170:173], a[136:139], v[220:223], v[170:173]
v_mfma_f32_16x16x32_bf16 v[170:173], a[140:143], v[118:121], v[170:173]
s_mov_b32 s30, 65537
s_mov_b32 s31, 65537
v_cvt_pk_bf16_f32 v90, v138, v139
v_cvt_pk_bf16_f32 v91, v140, v141
v_cvt_pk_bf16_f32 v92, v142, v143
v_cvt_pk_bf16_f32 v93, v144, v145
v_cvt_pk_bf16_f32 v94, v146, v147
v_cvt_pk_bf16_f32 v95, v148, v149
s_mov_b64 exec, s[30:31]
ds_write_b128 v215, v[90:93]
s_mov_b64 exec, -1
s_mov_b64 exec, s[30:31]
ds_write_b64 v215, v[94:95] offset:16
s_mov_b64 exec, -1
v_cvt_pk_bf16_f32 v102, v150, v151
v_cvt_pk_bf16_f32 v103, v152, v153
v_cvt_pk_bf16_f32 v104, v154, v155
v_cvt_pk_bf16_f32 v105, v156, v157
v_cvt_pk_bf16_f32 v106, v158, v159
v_cvt_pk_bf16_f32 v107, v160, v161
s_mov_b64 exec, s[30:31]
ds_write_b128 v215, v[102:105] offset:512
s_mov_b64 exec, -1
s_mov_b64 exec, s[30:31]
ds_write_b64 v215, v[106:107] offset:528
s_mov_b64 exec, -1
v_cvt_pk_bf16_f32 v108, v162, v163
v_cvt_pk_bf16_f32 v109, v164, v165
v_cvt_pk_bf16_f32 v110, v166, v167
v_cvt_pk_bf16_f32 v111, v168, v169
v_cvt_pk_bf16_f32 v112, v170, v171
v_cvt_pk_bf16_f32 v113, v172, v173
v_mfma_f32_16x16x32_bf16 v[220:223], v[90:93], v[102:105], 0
s_nop 5
v_mfma_f32_16x16x16_bf16 v[220:223], v[94:95], v[106:107], v[220:223]
s_nop 7
s_mov_b64 exec, s[30:31]
ds_write_b32 v215, v220 offset:536
s_mov_b64 exec, -1
s_mov_b64 exec, s[30:31]
ds_write_b64 v64, v[108:109]
s_mov_b64 exec, -1
s_mov_b64 exec, s[30:31]
ds_write_b64 v64, v[110:111] offset:32
s_mov_b64 exec, -1
s_mov_b64 exec, s[30:31]
ds_write_b64 v64, v[112:113] offset:64
s_mov_b64 exec, -1
ds_read_b128 v[182:185], v210 offset:12288
ds_read_b128 v[186:189], v210 offset:13312
s_waitcnt lgkmcnt(1)
v_mfma_f32_16x16x32_bf16 v[138:141], a[0:3], v[182:185], 0
s_waitcnt lgkmcnt(0)
v_mfma_f32_16x16x32_bf16 v[138:141], a[4:7], v[186:189], v[138:141]
v_mfma_f32_16x16x32_bf16 v[142:145], a[24:27], v[182:185], 0
v_mfma_f32_16x16x32_bf16 v[142:145], a[28:31], v[186:189], v[142:145]
v_mfma_f32_16x16x32_bf16 v[146:149], a[48:51], v[182:185], 0
v_mfma_f32_16x16x32_bf16 v[146:149], a[52:55], v[186:189], v[146:149]
ds_read_b128 v[174:177], v210 offset:14336
ds_read_b128 v[178:181], v210 offset:15360
s_waitcnt lgkmcnt(1)
v_mfma_f32_16x16x32_bf16 v[138:141], a[8:11], v[174:177], v[138:141]
s_waitcnt lgkmcnt(0)
v_mfma_f32_16x16x32_bf16 v[138:141], a[12:15], v[178:181], v[138:141]
v_mfma_f32_16x16x32_bf16 v[142:145], a[32:35], v[174:177], v[142:145]
v_mfma_f32_16x16x32_bf16 v[142:145], a[36:39], v[178:181], v[142:145]
v_mfma_f32_16x16x32_bf16 v[146:149], a[56:59], v[174:177], v[146:149]
v_mfma_f32_16x16x32_bf16 v[146:149], a[60:63], v[178:181], v[146:149]
ds_read_b128 v[182:185], v210 offset:16384
ds_read_b128 v[186:189], v210 offset:17408
s_waitcnt lgkmcnt(1)
v_mfma_f32_16x16x32_bf16 v[138:141], a[16:19], v[182:185], v[138:141]
s_waitcnt lgkmcnt(0)
v_mfma_f32_16x16x32_bf16 v[138:141], a[20:23], v[186:189], v[138:141]
v_mfma_f32_16x16x32_bf16 v[142:145], a[40:43], v[182:185], v[142:145]
v_mfma_f32_16x16x32_bf16 v[142:145], a[44:47], v[186:189], v[142:145]
v_mfma_f32_16x16x32_bf16 v[146:149], a[64:67], v[182:185], v[146:149]
v_mfma_f32_16x16x32_bf16 v[146:149], a[68:71], v[186:189], v[146:149]
v_cvt_pk_bf16_f32 v102, v138, v139
v_cvt_pk_bf16_f32 v103, v140, v141
v_cvt_pk_bf16_f32 v104, v142, v143
v_cvt_pk_bf16_f32 v105, v144, v145
s_nop 2
v_cvt_pk_bf16_f32 v106, v146, v147
v_cvt_pk_bf16_f32 v107, v148, v149
ds_read_b128 v[108:111], v215 offset:512
ds_read_b64 v[112:113], v215 offset:528
v_mfma_f32_16x16x16_bf16 v[138:141], v[82:83], v[76:77], 0
v_mfma_f32_16x16x16_bf16 v[142:145], v[100:101], v[76:77], 0
s_waitcnt lgkmcnt(0)
v_mfma_f32_16x16x16_bf16 v[150:153], v[112:113], v[76:77], v[206:209]
v_mfma_f32_16x16x16_bf16 v[146:149], v[106:107], v[76:77], 0
v_mfma_f32_16x16x32_bf16 v[138:141], v[78:81], v[72:75], v[138:141]
v_mfma_f32_16x16x32_bf16 v[142:145], v[96:99], v[72:75], v[142:145]
v_mfma_f32_16x16x32_bf16 v[150:153], v[108:111], v[72:75], v[150:153]
v_mfma_f32_16x16x32_bf16 v[146:149], v[102:105], v[72:75], v[146:149]
ds_read_b128 v[72:75], v215
ds_read_b64 v[76:77], v215 offset:16
v_mfma_f32_16x16x16_bf16 v[154:157], v[82:83], v[88:89], 0
v_mfma_f32_16x16x16_bf16 v[158:161], v[100:101], v[88:89], 0
v_mfma_f32_16x16x16_bf16 v[166:169], v[112:113], v[88:89], v[206:209]
v_mfma_f32_16x16x16_bf16 v[162:165], v[106:107], v[88:89], 0
v_mfma_f32_16x16x32_bf16 v[154:157], v[78:81], v[84:87], v[154:157]
v_mfma_f32_16x16x32_bf16 v[158:161], v[96:99], v[84:87], v[158:161]
v_mfma_f32_16x16x32_bf16 v[166:169], v[108:111], v[84:87], v[166:169]
v_mfma_f32_16x16x32_bf16 v[162:165], v[102:105], v[84:87], v[162:165]
v_mfma_f32_16x16x32_bf16 v[118:121], v[182:185], a[88:91], 0
v_mfma_f32_16x16x32_bf16 v[118:121], v[186:189], a[92:95], v[118:121]
v_mfma_f32_16x16x32_bf16 v[126:129], v[182:185], a[112:115], 0
v_mfma_f32_16x16x32_bf16 v[126:129], v[186:189], a[116:119], v[126:129]
v_mfma_f32_16x16x32_bf16 v[134:137], v[182:185], a[136:139], 0
v_mfma_f32_16x16x32_bf16 v[134:137], v[186:189], a[140:143], v[134:137]
v_mfma_f32_16x16x32_bf16 v[90:93], a[232:235], v[182:185], 0
v_mfma_f32_16x16x32_bf16 v[90:93], a[236:239], v[186:189], v[90:93]
v_mfma_f32_16x16x32_bf16 v[170:173], v[224:227], v[182:185], 0
v_mfma_f32_16x16x32_bf16 v[170:173], v[228:231], v[186:189], v[170:173]
v_mfma_f32_16x16x32_bf16 v[220:223], v[248:251], v[182:185], 0
v_mfma_f32_16x16x32_bf16 v[220:223], v[252:255], v[186:189], v[220:223]
v_mfma_f32_16x16x32_bf16 v[118:121], v[174:177], a[80:83], v[118:121]
v_mfma_f32_16x16x32_bf16 v[118:121], v[178:181], a[84:87], v[118:121]
v_mfma_f32_16x16x32_bf16 v[126:129], v[174:177], a[104:107], v[126:129]
v_mfma_f32_16x16x32_bf16 v[126:129], v[178:181], a[108:111], v[126:129]
v_mfma_f32_16x16x32_bf16 v[134:137], v[174:177], a[128:131], v[134:137]
v_mfma_f32_16x16x32_bf16 v[134:137], v[178:181], a[132:135], v[134:137]
v_mfma_f32_16x16x32_bf16 v[90:93], a[224:227], v[174:177], v[90:93]
v_mfma_f32_16x16x32_bf16 v[90:93], a[228:231], v[178:181], v[90:93]
v_mfma_f32_16x16x32_bf16 v[170:173], a[248:251], v[174:177], v[170:173]
v_mfma_f32_16x16x32_bf16 v[170:173], a[252:255], v[178:181], v[170:173]
v_mfma_f32_16x16x32_bf16 v[220:223], v[240:243], v[174:177], v[220:223]
v_mfma_f32_16x16x32_bf16 v[220:223], v[244:247], v[178:181], v[220:223]
ds_read_b128 v[182:185], v210 offset:12288
ds_read_b128 v[186:189], v210 offset:13312
s_waitcnt lgkmcnt(1)
v_mfma_f32_16x16x32_bf16 v[118:121], v[182:185], a[72:75], v[118:121]
s_waitcnt lgkmcnt(0)
v_mfma_f32_16x16x32_bf16 v[118:121], v[186:189], a[76:79], v[118:121]
v_mfma_f32_16x16x32_bf16 v[126:129], v[182:185], a[96:99], v[126:129]
v_mfma_f32_16x16x32_bf16 v[126:129], v[186:189], a[100:103], v[126:129]
v_mfma_f32_16x16x32_bf16 v[134:137], v[182:185], a[120:123], v[134:137]
v_mfma_f32_16x16x32_bf16 v[134:137], v[186:189], a[124:127], v[134:137]
v_mfma_f32_16x16x32_bf16 v[90:93], a[216:219], v[182:185], v[90:93]
v_mfma_f32_16x16x32_bf16 v[90:93], a[220:223], v[186:189], v[90:93]
v_mfma_f32_16x16x32_bf16 v[170:173], a[240:243], v[182:185], v[170:173]
v_mfma_f32_16x16x32_bf16 v[170:173], a[244:247], v[186:189], v[170:173]
v_mfma_f32_16x16x32_bf16 v[220:223], v[232:235], v[182:185], v[220:223]
v_mfma_f32_16x16x32_bf16 v[220:223], v[236:239], v[186:189], v[220:223]
v_mov_b32 v181, 0
v_cvt_pk_bf16_f32 v118, v118, v119
v_cvt_pk_bf16_f32 v119, v120, v121
ds_read_u16 v120, v205
v_mov_b32 v121, 0
v_cvt_pk_bf16_f32 v126, v126, v127
v_cvt_pk_bf16_f32 v127, v128, v129
ds_read_u16 v128, v205 offset:32
v_mov_b32 v129, 0
v_cvt_pk_bf16_f32 v134, v134, v135
v_cvt_pk_bf16_f32 v135, v136, v137
ds_read_u16 v136, v205 offset:64
v_mov_b32 v137, 0
v_add_u32 v205, 1424, v205
v_cvt_pk_bf16_f32 v90, v90, v91
v_cvt_pk_bf16_f32 v91, v92, v93
v_cvt_pk_bf16_f32 v92, v170, v171
v_cvt_pk_bf16_f32 v93, v172, v173
v_cvt_pk_bf16_f32 v94, v220, v221
v_cvt_pk_bf16_f32 v95, v222, v223
v_max3_f32 v151, v138, v139, v140
v_max3_f32 v151, v151, v141, v142
v_max3_f32 v151, v151, v143, v144
v_max3_f32 v151, v151, v145, v146
v_max3_f32 v151, v151, v147, v148
v_max3_f32 v151, v151, v149, v150
v_mov_b32 v152, v151
s_nop 1
v_permlane16_swap_b32 v151, v152
v_max_f32 v151, v151, v152
v_mov_b32 v152, v151
s_nop 1
v_permlane32_swap_b32 v151, v152
v_max_f32 v151, v151, v152
v_sub_f32 v138, v138, v151
v_sub_f32 v139, v139, v151
v_sub_f32 v140, v140, v151
v_sub_f32 v141, v141, v151
v_sub_f32 v142, v142, v151
v_sub_f32 v143, v143, v151
v_sub_f32 v144, v144, v151
v_sub_f32 v145, v145, v151
v_sub_f32 v150, v150, v151
v_sub_f32 v146, v146, v151
v_sub_f32 v147, v147, v151
v_sub_f32 v148, v148, v151
v_sub_f32 v149, v149, v151
v_exp_f32 v138, v138
v_exp_f32 v139, v139
v_exp_f32 v140, v140
v_exp_f32 v141, v141
v_exp_f32 v142, v142
v_exp_f32 v143, v143
v_exp_f32 v144, v144
v_exp_f32 v145, v145
v_exp_f32 v150, v150
v_exp_f32 v146, v146
v_exp_f32 v147, v147
v_exp_f32 v148, v148
v_exp_f32 v149, v149
v_cvt_pk_bf16_f32 v174, v138, v139
v_cvt_pk_bf16_f32 v175, v140, v141
v_cvt_pk_bf16_f32 v176, v142, v143
v_cvt_pk_bf16_f32 v177, v144, v145
v_cvt_pk_bf16_f32 v178, v146, v147
v_cvt_pk_bf16_f32 v179, v148, v149
v_cvt_pk_bf16_f32 v180, v150, 0
v_mfma_f32_16x16x32_bf16 v[150:153], v[190:193], v[174:177], 0
v_mfma_f32_16x16x32_bf16 v[150:153], v[190:193], v[178:181], v[150:153]
v_mfma_f32_16x16x32_bf16 v[138:141], v[114:117], v[174:177], 0
s_waitcnt lgkmcnt(2)
v_mfma_f32_16x16x32_bf16 v[138:141], v[118:121], v[178:181], v[138:141]
v_mfma_f32_16x16x32_bf16 v[142:145], v[122:125], v[174:177], 0
s_waitcnt lgkmcnt(1)
v_mfma_f32_16x16x32_bf16 v[142:145], v[126:129], v[178:181], v[142:145]
v_mfma_f32_16x16x32_bf16 v[146:149], v[130:133], v[174:177], 0
s_waitcnt lgkmcnt(0)
v_mfma_f32_16x16x32_bf16 v[146:149], v[134:137], v[178:181], v[146:149]
v_max3_f32 v167, v154, v155, v156
v_max3_f32 v167, v167, v157, v158
v_max3_f32 v167, v167, v159, v160
v_max3_f32 v167, v167, v161, v162
v_max3_f32 v167, v167, v163, v164
v_max3_f32 v167, v167, v165, v166
v_mov_b32 v168, v167
s_nop 1
v_permlane16_swap_b32 v167, v168
v_max_f32 v167, v167, v168
v_mov_b32 v168, v167
s_nop 1
v_permlane32_swap_b32 v167, v168
v_max_f32 v167, v167, v168
v_sub_f32 v154, v154, v167
v_sub_f32 v155, v155, v167
v_sub_f32 v156, v156, v167
v_sub_f32 v157, v157, v167
v_sub_f32 v158, v158, v167
v_sub_f32 v159, v159, v167
v_sub_f32 v160, v160, v167
v_sub_f32 v161, v161, v167
v_sub_f32 v166, v166, v167
v_sub_f32 v162, v162, v167
v_sub_f32 v163, v163, v167
v_sub_f32 v164, v164, v167
v_sub_f32 v165, v165, v167
v_exp_f32 v154, v154
v_exp_f32 v155, v155
v_exp_f32 v156, v156
v_exp_f32 v157, v157
v_exp_f32 v158, v158
v_exp_f32 v159, v159
v_exp_f32 v160, v160
v_exp_f32 v161, v161
v_exp_f32 v166, v166
v_exp_f32 v162, v162
v_exp_f32 v163, v163
v_exp_f32 v164, v164
v_exp_f32 v165, v165
v_cvt_pk_bf16_f32 v174, v154, v155
v_cvt_pk_bf16_f32 v175, v156, v157
v_cvt_pk_bf16_f32 v176, v158, v159
v_cvt_pk_bf16_f32 v177, v160, v161
v_cvt_pk_bf16_f32 v178, v162, v163
v_cvt_pk_bf16_f32 v179, v164, v165
v_cvt_pk_bf16_f32 v180, v166, 0
v_mfma_f32_16x16x32_bf16 v[166:169], v[190:193], v[174:177], 0
v_mfma_f32_16x16x32_bf16 v[166:169], v[190:193], v[178:181], v[166:169]
v_mfma_f32_16x16x32_bf16 v[154:157], v[114:117], v[174:177], 0
v_mfma_f32_16x16x32_bf16 v[154:157], v[118:121], v[178:181], v[154:157]
v_mfma_f32_16x16x32_bf16 v[158:161], v[122:125], v[174:177], 0
v_mfma_f32_16x16x32_bf16 v[158:161], v[126:129], v[178:181], v[158:161]
v_mfma_f32_16x16x32_bf16 v[162:165], v[130:133], v[174:177], 0
v_mfma_f32_16x16x32_bf16 v[162:165], v[134:137], v[178:181], v[162:165]
v_rcp_f32 v151, v150
s_nop 0
v_mul_f32 v152, s3, v151
v_mul_f32 v138, v138, v152
v_mul_f32 v139, v139, v152
v_cvt_pk_bf16_f32 v138, v138, v139
v_mul_f32 v140, v140, v152
v_mul_f32 v141, v141, v152
v_cvt_pk_bf16_f32 v139, v140, v141
v_mul_f32 v142, v142, v152
v_mul_f32 v143, v143, v152
v_cvt_pk_bf16_f32 v140, v142, v143
v_mul_f32 v144, v144, v152
v_mul_f32 v145, v145, v152
v_cvt_pk_bf16_f32 v141, v144, v145
ds_write_b128 v211, v[138:141] offset:38912
v_mul_f32 v146, v146, v152
v_mul_f32 v147, v147, v152
v_cvt_pk_bf16_f32 v142, v146, v147
v_mul_f32 v148, v148, v152
v_mul_f32 v149, v149, v152
v_cvt_pk_bf16_f32 v143, v148, v149
ds_write_b64 v212, v[142:143] offset:38912
v_mfma_f32_16x16x32_bf16 v[138:141], v[78:81], v[90:93], 0
v_mfma_f32_16x16x32_bf16 v[142:145], v[96:99], v[90:93], 0
v_mfma_f32_16x16x32_bf16 v[150:153], v[108:111], v[90:93], v[206:209]
v_mfma_f32_16x16x32_bf16 v[146:149], v[102:105], v[90:93], 0
v_mfma_f32_16x16x16_bf16 v[138:141], v[82:83], v[94:95], v[138:141]
v_mfma_f32_16x16x16_bf16 v[142:145], v[100:101], v[94:95], v[142:145]
v_mfma_f32_16x16x16_bf16 v[150:153], v[112:113], v[94:95], v[150:153]
v_mfma_f32_16x16x16_bf16 v[146:149], v[106:107], v[94:95], v[146:149]
v_rcp_f32 v167, v166
s_nop 0
v_mul_f32 v168, s3, v167
v_mul_f32 v154, v154, v168
v_mul_f32 v155, v155, v168
v_cvt_pk_bf16_f32 v154, v154, v155
v_mul_f32 v156, v156, v168
v_mul_f32 v157, v157, v168
v_cvt_pk_bf16_f32 v155, v156, v157
v_mul_f32 v158, v158, v168
v_mul_f32 v159, v159, v168
v_cvt_pk_bf16_f32 v156, v158, v159
v_mul_f32 v160, v160, v168
v_mul_f32 v161, v161, v168
v_cvt_pk_bf16_f32 v157, v160, v161
ds_write_b128 v211, v[154:157] offset:45056
v_mul_f32 v162, v162, v168
v_mul_f32 v163, v163, v168
v_cvt_pk_bf16_f32 v158, v162, v163
v_mul_f32 v164, v164, v168
v_mul_f32 v165, v165, v168
v_cvt_pk_bf16_f32 v159, v164, v165
ds_write_b64 v212, v[158:159] offset:45056
v_mfma_f32_16x16x32_bf16 v[154:157], v[72:75], v[78:81], 0
v_mfma_f32_16x16x32_bf16 v[158:161], v[72:75], v[96:99], 0
v_mfma_f32_16x16x32_bf16 v[162:165], v[72:75], v[102:105], 0
v_mfma_f32_16x16x16_bf16 v[154:157], v[76:77], v[82:83], v[154:157]
v_mfma_f32_16x16x16_bf16 v[158:161], v[76:77], v[100:101], v[158:161]
v_mfma_f32_16x16x16_bf16 v[162:165], v[76:77], v[106:107], v[162:165]
ds_read_b32 v166, v215 offset:536
s_nop 2
v_mov_b32_dpp v154, v158 quad_perm:[0,1,2,3] row_mask:0x2 bank_mask:0xf
s_nop 2
v_mov_b32_dpp v154, v162 quad_perm:[0,1,2,3] row_mask:0x4 bank_mask:0xf
s_waitcnt lgkmcnt(0)
s_nop 0
v_add_f32_dpp v154, v166, v207 quad_perm:[0,1,2,3] row_mask:0x8 bank_mask:0xf
v_mov_b32 v155, v154
s_nop 1
v_max_f32_dpp v155, v155, v155 row_ror:8 row_mask:0xf bank_mask:0xf
s_nop 1
v_max_f32_dpp v155, v155, v155 row_ror:4 row_mask:0xf bank_mask:0xf
s_nop 1
v_max_f32_dpp v155, v155, v155 row_ror:2 row_mask:0xf bank_mask:0xf
s_nop 1
v_max_f32_dpp v155, v155, v155 row_ror:1 row_mask:0xf bank_mask:0xf
v_mov_b32 v156, v155
s_nop 1
v_permlane16_swap_b32 v155, v156
v_max_f32 v155, v155, v156
v_mov_b32 v156, v155
s_nop 1
v_permlane32_swap_b32 v155, v156
v_max_f32 v155, v155, v156
v_sub_f32 v154, v154, v155
v_exp_f32 v166, v154
s_nop 0
v_cvt_pk_bf16_f32 v154, v166, 0
ds_write_b16 v214, v154
v_add_f32_dpp v166, v166, v166 row_ror:8 row_mask:0xf bank_mask:0xf
s_nop 1
v_add_f32_dpp v166, v166, v166 row_ror:4 row_mask:0xf bank_mask:0xf
s_nop 1
v_add_f32_dpp v166, v166, v166 row_ror:2 row_mask:0xf bank_mask:0xf
s_nop 1
v_add_f32_dpp v166, v166, v166 row_ror:1 row_mask:0xf bank_mask:0xf
s_nop 1
v_add_f32_dpp v166, v166, v166 row_bcast:15 row_mask:0xa bank_mask:0xf
s_nop 1
v_add_f32_dpp v166, v166, v166 row_bcast:31 row_mask:0xc bank_mask:0xf
s_nop 0
v_readlane_b32 s72, v166, 63
s_nop 1
v_rcp_f32 v167, s72
s_nop 0
v_mul_f32 v168, s3, v167
ds_read_b128 v[84:87], v215
ds_read_b128 v[88:91], v215 offset:16
v_add_u32 v215, 1424, v215
s_barrier
ds_read_b128 v[220:223], v210 offset:38912
ds_read_b128 v[110:113], v210 offset:39936
s_waitcnt lgkmcnt(1)
v_mfma_f32_16x16x32_bf16 v[0:3], a[144:147], v[220:223], v[0:3]
s_waitcnt lgkmcnt(0)
v_mfma_f32_16x16x32_bf16 v[0:3], a[148:151], v[110:113], v[0:3]
v_mfma_f32_16x16x32_bf16 v[4:7], a[168:171], v[220:223], v[4:7]
v_mfma_f32_16x16x32_bf16 v[4:7], a[172:175], v[110:113], v[4:7]
v_mfma_f32_16x16x32_bf16 v[8:11], a[192:195], v[220:223], v[8:11]
v_mfma_f32_16x16x32_bf16 v[8:11], a[196:199], v[110:113], v[8:11]
ds_read_b128 v[170:173], v210 offset:40960
ds_read_b128 v[182:185], v210 offset:41984
s_waitcnt lgkmcnt(1)
v_mfma_f32_16x16x32_bf16 v[0:3], a[152:155], v[170:173], v[0:3]
s_waitcnt lgkmcnt(0)
v_mfma_f32_16x16x32_bf16 v[0:3], a[156:159], v[182:185], v[0:3]
v_mfma_f32_16x16x32_bf16 v[4:7], a[176:179], v[170:173], v[4:7]
v_mfma_f32_16x16x32_bf16 v[4:7], a[180:183], v[182:185], v[4:7]
v_mfma_f32_16x16x32_bf16 v[8:11], a[200:203], v[170:173], v[8:11]
v_mfma_f32_16x16x32_bf16 v[8:11], a[204:207], v[182:185], v[8:11]
ds_read_b128 v[186:189], v210 offset:43008
ds_read_b128 v[220:223], v210 offset:44032
s_waitcnt lgkmcnt(1)
v_mfma_f32_16x16x32_bf16 v[0:3], a[160:163], v[186:189], v[0:3]
s_waitcnt lgkmcnt(0)
v_mfma_f32_16x16x32_bf16 v[0:3], a[164:167], v[220:223], v[0:3]
v_mfma_f32_16x16x32_bf16 v[4:7], a[184:187], v[186:189], v[4:7]
v_mfma_f32_16x16x32_bf16 v[4:7], a[188:191], v[220:223], v[4:7]
v_mfma_f32_16x16x32_bf16 v[8:11], a[208:211], v[186:189], v[8:11]
v_mfma_f32_16x16x32_bf16 v[8:11], a[212:215], v[220:223], v[8:11]
v_cvt_pk_bf16_f32 v0, v0, v1
v_cvt_pk_bf16_f32 v1, v2, v3
ds_write_b64 v203, v[0:1]
v_cvt_pk_bf16_f32 v4, v4, v5
v_cvt_pk_bf16_f32 v5, v6, v7
ds_write_b64 v203, v[4:5] offset:32
v_cvt_pk_bf16_f32 v8, v8, v9
v_cvt_pk_bf16_f32 v9, v10, v11
ds_write_b64 v203, v[8:9] offset:64
v_max3_f32 v151, v138, v139, v140
v_max3_f32 v151, v151, v141, v142
v_max3_f32 v151, v151, v143, v144
v_max3_f32 v151, v151, v145, v146
v_max3_f32 v151, v151, v147, v148
v_max3_f32 v151, v151, v149, v150
v_mov_b32 v152, v151
s_nop 1
v_permlane16_swap_b32 v151, v152
v_max_f32 v151, v151, v152
v_mov_b32 v152, v151
s_nop 1
v_permlane32_swap_b32 v151, v152
v_max_f32 v151, v151, v152
v_sub_f32 v138, v138, v151
v_sub_f32 v139, v139, v151
v_sub_f32 v140, v140, v151
v_sub_f32 v141, v141, v151
v_sub_f32 v142, v142, v151
v_sub_f32 v143, v143, v151
v_sub_f32 v144, v144, v151
v_sub_f32 v145, v145, v151
v_sub_f32 v150, v150, v151
v_sub_f32 v146, v146, v151
v_sub_f32 v147, v147, v151
v_sub_f32 v148, v148, v151
v_sub_f32 v149, v149, v151
v_exp_f32 v138, v138
v_exp_f32 v139, v139
v_exp_f32 v140, v140
v_exp_f32 v141, v141
v_exp_f32 v142, v142
v_exp_f32 v143, v143
v_exp_f32 v144, v144
v_exp_f32 v145, v145
v_exp_f32 v150, v150
v_exp_f32 v146, v146
v_exp_f32 v147, v147
v_exp_f32 v148, v148
v_exp_f32 v149, v149
v_cvt_pk_bf16_f32 v174, v138, v139
v_cvt_pk_bf16_f32 v175, v140, v141
v_cvt_pk_bf16_f32 v176, v142, v143
v_cvt_pk_bf16_f32 v177, v144, v145
v_cvt_pk_bf16_f32 v178, v146, v147
v_cvt_pk_bf16_f32 v179, v148, v149
v_cvt_pk_bf16_f32 v180, v150, 0
v_mfma_f32_16x16x32_bf16 v[150:153], v[190:193], v[174:177], 0
v_mfma_f32_16x16x32_bf16 v[150:153], v[190:193], v[178:181], v[150:153]
v_mfma_f32_16x16x32_bf16 v[138:141], v[114:117], v[174:177], 0
v_mfma_f32_16x16x32_bf16 v[138:141], v[118:121], v[178:181], v[138:141]
v_mfma_f32_16x16x32_bf16 v[142:145], v[122:125], v[174:177], 0
v_mfma_f32_16x16x32_bf16 v[142:145], v[126:129], v[178:181], v[142:145]
v_mfma_f32_16x16x32_bf16 v[146:149], v[130:133], v[174:177], 0
v_mfma_f32_16x16x32_bf16 v[146:149], v[134:137], v[178:181], v[146:149]
v_rcp_f32 v151, v150
s_nop 0
v_mul_f32 v152, s3, v151
v_mul_f32 v138, v138, v152
v_mul_f32 v139, v139, v152
v_cvt_pk_bf16_f32 v138, v138, v139
v_mul_f32 v140, v140, v152
v_mul_f32 v141, v141, v152
v_cvt_pk_bf16_f32 v139, v140, v141
v_mul_f32 v142, v142, v152
v_mul_f32 v143, v143, v152
v_cvt_pk_bf16_f32 v140, v142, v143
v_mul_f32 v144, v144, v152
v_mul_f32 v145, v145, v152
v_cvt_pk_bf16_f32 v141, v144, v145
ds_write_b128 v211, v[138:141] offset:51200
v_mul_f32 v146, v146, v152
v_mul_f32 v147, v147, v152
v_cvt_pk_bf16_f32 v142, v146, v147
v_mul_f32 v148, v148, v152
v_mul_f32 v149, v149, v152
v_cvt_pk_bf16_f32 v143, v148, v149
ds_write_b64 v212, v[142:143] offset:51200
v_mfma_f32_16x16x32_bf16 v[154:157], v[84:87], v[114:117], 0
v_mfma_f32_16x16x32_bf16 v[154:157], v[88:91], v[118:121], v[154:157]
v_mfma_f32_16x16x32_bf16 v[158:161], v[84:87], v[122:125], 0
v_mfma_f32_16x16x32_bf16 v[158:161], v[88:91], v[126:129], v[158:161]
v_mfma_f32_16x16x32_bf16 v[162:165], v[84:87], v[130:133], 0
v_mfma_f32_16x16x32_bf16 v[162:165], v[88:91], v[134:137], v[162:165]
v_mov_b32_dpp v154, v158 quad_perm:[0,1,2,3] row_mask:0x2 bank_mask:0xf
s_nop 5
v_mov_b32_dpp v154, v162 quad_perm:[0,1,2,3] row_mask:0x4 bank_mask:0xf
v_mul_f32 v154, v154, v168
v_cvt_pk_bf16_f32 v154, v154, 0
ds_write_b16 v214, v154
v_add_u32 v214, 1424, v214
ds_read_b128 v[110:113], v210 offset:45056
ds_read_b128 v[170:173], v210 offset:46080
s_waitcnt lgkmcnt(1)
v_mfma_f32_16x16x32_bf16 v[12:15], a[144:147], v[110:113], v[12:15]
s_waitcnt lgkmcnt(0)
v_mfma_f32_16x16x32_bf16 v[12:15], a[148:151], v[170:173], v[12:15]
v_mfma_f32_16x16x32_bf16 v[16:19], a[168:171], v[110:113], v[16:19]
v_mfma_f32_16x16x32_bf16 v[16:19], a[172:175], v[170:173], v[16:19]
v_mfma_f32_16x16x32_bf16 v[20:23], a[192:195], v[110:113], v[20:23]
v_mfma_f32_16x16x32_bf16 v[20:23], a[196:199], v[170:173], v[20:23]
ds_read_b128 v[182:185], v210 offset:47104
ds_read_b128 v[186:189], v210 offset:48128
s_waitcnt lgkmcnt(1)
v_mfma_f32_16x16x32_bf16 v[12:15], a[152:155], v[182:185], v[12:15]
s_waitcnt lgkmcnt(0)
v_mfma_f32_16x16x32_bf16 v[12:15], a[156:159], v[186:189], v[12:15]
v_mfma_f32_16x16x32_bf16 v[16:19], a[176:179], v[182:185], v[16:19]
v_mfma_f32_16x16x32_bf16 v[16:19], a[180:183], v[186:189], v[16:19]
v_mfma_f32_16x16x32_bf16 v[20:23], a[200:203], v[182:185], v[20:23]
v_mfma_f32_16x16x32_bf16 v[20:23], a[204:207], v[186:189], v[20:23]
ds_read_b128 v[220:223], v210 offset:49152
ds_read_b128 v[110:113], v210 offset:50176
s_waitcnt lgkmcnt(1)
v_mfma_f32_16x16x32_bf16 v[12:15], a[160:163], v[220:223], v[12:15]
s_waitcnt lgkmcnt(0)
v_mfma_f32_16x16x32_bf16 v[12:15], a[164:167], v[110:113], v[12:15]
v_mfma_f32_16x16x32_bf16 v[16:19], a[184:187], v[220:223], v[16:19]
v_mfma_f32_16x16x32_bf16 v[16:19], a[188:191], v[110:113], v[16:19]
v_mfma_f32_16x16x32_bf16 v[20:23], a[208:211], v[220:223], v[20:23]
v_mfma_f32_16x16x32_bf16 v[20:23], a[212:215], v[110:113], v[20:23]
v_cvt_pk_bf16_f32 v12, v12, v13
v_cvt_pk_bf16_f32 v13, v14, v15
ds_write_b64 v203, v[12:13] offset:6272
v_cvt_pk_bf16_f32 v16, v16, v17
v_cvt_pk_bf16_f32 v17, v18, v19
ds_write_b64 v203, v[16:17] offset:6304
v_cvt_pk_bf16_f32 v20, v20, v21
v_cvt_pk_bf16_f32 v21, v22, v23
ds_write_b64 v203, v[20:21] offset:6336
v_cmp_lt_u32 vcc, 1602224128, v218
s_nop 0
s_or_b32 s41, vcc_lo, vcc_hi
v_mov_b32 v69, s41
ds_write_b32 v209, v69
s_waitcnt lgkmcnt(0)
s_barrier
ds_read_b128 v[170:173], v210 offset:51200
ds_read_b128 v[182:185], v210 offset:52224
s_waitcnt lgkmcnt(1)
v_mfma_f32_16x16x32_bf16 v[24:27], a[144:147], v[170:173], v[24:27]
s_waitcnt lgkmcnt(0)
v_mfma_f32_16x16x32_bf16 v[24:27], a[148:151], v[182:185], v[24:27]
v_mfma_f32_16x16x32_bf16 v[28:31], a[168:171], v[170:173], v[28:31]
v_mfma_f32_16x16x32_bf16 v[28:31], a[172:175], v[182:185], v[28:31]
v_mfma_f32_16x16x32_bf16 v[32:35], a[192:195], v[170:173], v[32:35]
v_mfma_f32_16x16x32_bf16 v[32:35], a[196:199], v[182:185], v[32:35]
ds_read_b128 v[186:189], v210 offset:53248
ds_read_b128 v[220:223], v210 offset:54272
s_waitcnt lgkmcnt(1)
v_mfma_f32_16x16x32_bf16 v[24:27], a[152:155], v[186:189], v[24:27]
s_waitcnt lgkmcnt(0)
v_mfma_f32_16x16x32_bf16 v[24:27], a[156:159], v[220:223], v[24:27]
v_mfma_f32_16x16x32_bf16 v[28:31], a[176:179], v[186:189], v[28:31]
v_mfma_f32_16x16x32_bf16 v[28:31], a[180:183], v[220:223], v[28:31]
v_mfma_f32_16x16x32_bf16 v[32:35], a[200:203], v[186:189], v[32:35]
v_mfma_f32_16x16x32_bf16 v[32:35], a[204:207], v[220:223], v[32:35]
ds_read_b128 v[110:113], v210 offset:55296
ds_read_b128 v[170:173], v210 offset:56320
s_waitcnt lgkmcnt(1)
v_mfma_f32_16x16x32_bf16 v[24:27], a[160:163], v[110:113], v[24:27]
s_waitcnt lgkmcnt(0)
v_mfma_f32_16x16x32_bf16 v[24:27], a[164:167], v[170:173], v[24:27]
v_mfma_f32_16x16x32_bf16 v[28:31], a[184:187], v[110:113], v[28:31]
v_mfma_f32_16x16x32_bf16 v[28:31], a[188:191], v[170:173], v[28:31]
v_mfma_f32_16x16x32_bf16 v[32:35], a[208:211], v[110:113], v[32:35]
v_mfma_f32_16x16x32_bf16 v[32:35], a[212:215], v[170:173], v[32:35]
v_cvt_pk_bf16_f32 v24, v24, v25
v_cvt_pk_bf16_f32 v25, v26, v27
ds_write_b64 v203, v[24:25] offset:12544
v_cvt_pk_bf16_f32 v28, v28, v29
v_cvt_pk_bf16_f32 v29, v30, v31
ds_write_b64 v203, v[28:29] offset:12576
v_cvt_pk_bf16_f32 v32, v32, v33
v_cvt_pk_bf16_f32 v33, v34, v35
ds_write_b64 v203, v[32:33] offset:12608
s_waitcnt lgkmcnt(0)
s_barrier
ds_read_b64 v[120:121], v204
s_add_u32 s28, s38, s60
s_waitcnt lgkmcnt(0)
buffer_store_dwordx2 v[120:121], v204, s[8:11], s28 offen sc1
ds_read_b64 v[128:129], v204 offset:392
s_add_u32 s29, s38, s61
s_waitcnt lgkmcnt(0)
buffer_store_dwordx2 v[128:129], v204, s[8:11], s29 offen sc1
ds_read_b64 v[136:137], v204 offset:784
s_add_u32 s28, s38, s62
s_waitcnt lgkmcnt(0)
buffer_store_dwordx2 v[136:137], v204, s[8:11], s28 offen sc1
ds_read_b64 v[120:121], v204 offset:1176
s_add_u32 s29, s38, s63
s_waitcnt lgkmcnt(0)
buffer_store_dwordx2 v[120:121], v204, s[8:11], s29 offen sc1
ds_read_b64 v[128:129], v204 offset:6272
s_add_u32 s28, s38, s64
s_waitcnt lgkmcnt(0)
buffer_store_dwordx2 v[128:129], v204, s[8:11], s28 offen sc1
ds_read_b64 v[136:137], v204 offset:6664
s_add_u32 s29, s38, s65
s_waitcnt lgkmcnt(0)
buffer_store_dwordx2 v[136:137], v204, s[8:11], s29 offen sc1
ds_read_b64 v[120:121], v204 offset:7056
s_add_u32 s28, s38, s66
s_waitcnt lgkmcnt(0)
buffer_store_dwordx2 v[120:121], v204, s[8:11], s28 offen sc1
ds_read_b64 v[128:129], v204 offset:7448
s_add_u32 s29, s38, s67
s_waitcnt lgkmcnt(0)
buffer_store_dwordx2 v[128:129], v204, s[8:11], s29 offen sc1
ds_read_b64 v[136:137], v204 offset:12544
s_add_u32 s28, s38, s68
s_waitcnt lgkmcnt(0)
buffer_store_dwordx2 v[136:137], v204, s[8:11], s28 offen sc1
ds_read_b64 v[120:121], v204 offset:12936
s_add_u32 s29, s38, s69
s_waitcnt lgkmcnt(0)
buffer_store_dwordx2 v[120:121], v204, s[8:11], s29 offen sc1
ds_read_b64 v[128:129], v204 offset:13328
s_add_u32 s28, s38, s70
s_waitcnt lgkmcnt(0)
buffer_store_dwordx2 v[128:129], v204, s[8:11], s28 offen sc1
ds_read_b64 v[136:137], v204 offset:13720
s_add_u32 s29, s38, s71
s_waitcnt lgkmcnt(0)
buffer_store_dwordx2 v[136:137], v204, s[8:11], s29 offen sc1
ds_read_b128 v[84:87], v63 offset:22784
ds_read_b128 v[88:91], v63 offset:22912
ds_read_b128 v[92:95], v63 offset:23040
ds_read_b128 v[96:99], v63 offset:23168
ds_read_b64 v[100:101], v63 offset:22800
ds_read_b64 v[102:103], v63 offset:22928
ds_read_b64 v[104:105], v63 offset:23056
s_waitcnt vmcnt(14) lgkmcnt(6)
ds_read_b64 v[106:107], v63 offset:23184
v_mfma_f32_16x16x32_bf16 v[48:51], a[144:147], v[84:87], v[48:51]
s_waitcnt lgkmcnt(6)
v_mfma_f32_16x16x32_bf16 v[48:51], a[148:151], v[88:91], v[48:51]
s_waitcnt lgkmcnt(5)
v_mfma_f32_16x16x32_bf16 v[48:51], a[152:155], v[92:95], v[48:51]
s_waitcnt lgkmcnt(4)
v_mfma_f32_16x16x32_bf16 v[48:51], a[156:159], v[96:99], v[48:51]
s_waitcnt lgkmcnt(2)
v_mfma_f32_16x16x32_bf16 v[48:51], a[160:163], v[100:103], v[48:51]
s_waitcnt lgkmcnt(0)
v_mfma_f32_16x16x32_bf16 v[48:51], a[164:167], v[104:107], v[48:51]
s_nop 7
v_cvt_pk_bf16_f32 v48, v48, v49
v_cvt_pk_bf16_f32 v49, v50, v51
buffer_store_dwordx2 v[48:49], v66, s[8:11], 0 offen
s_waitcnt vmcnt(14)
v_mfma_f32_16x16x32_bf16 v[52:55], a[168:171], v[84:87], v[52:55]
v_mfma_f32_16x16x32_bf16 v[52:55], a[172:175], v[88:91], v[52:55]
v_mfma_f32_16x16x32_bf16 v[52:55], a[176:179], v[92:95], v[52:55]
v_mfma_f32_16x16x32_bf16 v[52:55], a[180:183], v[96:99], v[52:55]
v_mfma_f32_16x16x32_bf16 v[52:55], a[184:187], v[100:103], v[52:55]
v_mfma_f32_16x16x32_bf16 v[52:55], a[188:191], v[104:107], v[52:55]
s_nop 7
v_cvt_pk_bf16_f32 v52, v52, v53
v_cvt_pk_bf16_f32 v53, v54, v55
buffer_store_dwordx2 v[52:53], v66, s[8:11], 0 offen offset:32
s_waitcnt vmcnt(14)
v_mfma_f32_16x16x32_bf16 v[56:59], a[192:195], v[84:87], v[56:59]
v_mfma_f32_16x16x32_bf16 v[56:59], a[196:199], v[88:91], v[56:59]
v_mfma_f32_16x16x32_bf16 v[56:59], a[200:203], v[92:95], v[56:59]
v_mfma_f32_16x16x32_bf16 v[56:59], a[204:207], v[96:99], v[56:59]
v_mfma_f32_16x16x32_bf16 v[56:59], a[208:211], v[100:103], v[56:59]
v_mfma_f32_16x16x32_bf16 v[56:59], a[212:215], v[104:107], v[56:59]
s_nop 7
v_cvt_pk_bf16_f32 v56, v56, v57
v_cvt_pk_bf16_f32 v57, v58, v59
buffer_store_dwordx2 v[56:57], v66, s[8:11], 0 offen offset:64
ds_read_b128 v[174:177], v210 offset:18432
s_waitcnt lgkmcnt(0)
v_or3_b32 v174, v174, v175, v176
v_or_b32 v174, v174, v177
s_nop 0
v_readfirstlane_b32 s43, v174
s_endpgm
.p2align 6
.type L_tab,@object
L_tab:
.long 0x0,0x3800,0x5500,0x190,0x320,0x2020,0x5820,0x4b0,0x640,0x2340,0x4040,0x7d0,0x960,0x2660,0x6060,0xaf0
.long 0x1010,0x4810,0x6510,0x11a0,0x1330,0x3030,0x6830,0x14c0,0x1650,0x3350,0x5050,0x17e0,0x1970,0x3670,0x5370,0x1b00
.long 0x190,0x3990,0x5690,0x320,0x4b0,0x21b0,0x59b0,0x640,0x7d0,0x24d0,0x41d0,0x960,0x27f0,0x44f0,0x61f0,0x2980
.long 0x2980,0x4680,0x6380,0x2b10,0x11a0,0x49a0,0x66a0,0x1330,0x14c0,0x31c0,0x69c0,0x1650,0x17e0,0x34e0,0x51e0,0x1970
.long 0x320,0x3b20,0x5820,0x1010,0x640,0x2340,0x5b40,0x1330,0x960,0x2660,0x4360,0x1650,0xc80,0x2980,0x6380,0x1970
.long 0x1330,0x4b30,0x6830,0x2020,0x1650,0x3350,0x6b50,0x2340,0x1970,0x3670,0x5370,0x2660,0x1c90,0x3990,0x5690,0x2980
.long 0x4b0,0x3cb0,0x59b0,0x11a0,0x7d0,0x24d0,0x5cd0,0x14c0,0xaf0,0x27f0,0x44f0,0x17e0,0x2b10,0x4810,0x6510,0x3800
.long 0x2ca0,0x49a0,0x66a0,0x3990,0x14c0,0x4cc0,0x69c0,0x21b0,0x17e0,0x34e0,0x6ce0,0x24d0,0x1b00,0x3800,0x5500,0x27f0
.long 0x2020,0x5820,0x7520,0x1330,0x2340,0x4040,0x7840,0x1650,0x2660,0x4360,0x6060,0x1970,0x2980,0x4680,0x8080,0x1c90
.long 0x3030,0x6830,0x8530,0x2340,0x3350,0x5050,0x8850,0x2660,0x3670,0x5370,0x7070,0x2980,0x3990,0x5690,0x7390,0x2ca0
.long 0x21b0,0x59b0,0x76b0,0x14c0,0x24d0,0x41d0,0x79d0,0x17e0,0x27f0,0x44f0,0x61f0,0x1b00,0x4810,0x6510,0x8210,0x3b20
.long 0x49a0,0x66a0,0x83a0,0x3cb0,0x31c0,0x69c0,0x86c0,0x24d0,0x34e0,0x51e0,0x89e0,0x27f0,0x3800,0x5500,0x7200,0x2b10
.long 0x2340,0x5b40,0x7840,0x21b0,0x2660,0x4360,0x7b60,0x24d0,0x2980,0x4680,0x6380,0x27f0,0x2ca0,0x49a0,0x83a0,0x2b10
.long 0x3350,0x6b50,0x8850,0x31c0,0x3670,0x5370,0x8b70,0x34e0,0x3990,0x5690,0x7390,0x3800,0x3cb0,0x59b0,0x76b0,0x3b20
.long 0x24d0,0x5cd0,0x79d0,0x2340,0x27f0,0x44f0,0x7cf0,0x2660,0x2b10,0x4810,0x6510,0x2980,0x4b30,0x6830,0x8530,0x49a0
.long 0x4cc0,0x69c0,0x86c0,0x4b30,0x34e0,0x6ce0,0x89e0,0x3350,0x3800,0x5500,0x8d00,0x3670,0x3b20,0x5820,0x7520,0x3990
.long 0x3990,0x5690,0x11a0,0x49a0,0x21b0,0x59b0,0x14c0,0x31c0,0x24d0,0x41d0,0x17e0,0x34e0,0x27f0,0x61f0,0x1b00,0x3800
.long 0x49a0,0x66a0,0x21b0,0x59b0,0x31c0,0x69c0,0x24d0,0x41d0,0x34e0,0x51e0,0x27f0,0x44f0,0x3800,0x5500,0x2b10,0x4810
.long 0x3b20,0x5820,0x1330,0x4b30,0x2340,0x5b40,0x1650,0x3350,0x2660,0x4360,0x1970,0x3670,0x4680,0x6380,0x3990,0x5690
.long 0x4810,0x6510,0x3b20,0x5820,0x4b30,0x6830,0x2340,0x5b40,0x3350,0x6b50,0x2660,0x4360,0x3670,0x5370,0x2980,0x4680
.long 0x4810,0x6510,0x11a0,0x49a0,0x3030,0x6830,0x14c0,0x31c0,0x3350,0x5050,0x17e0,0x34e0,0x3670,0x7070,0x1b00,0x3800
.long 0x5820,0x7520,0x21b0,0x59b0,0x4040,0x7840,0x24d0,0x41d0,0x4360,0x6060,0x27f0,0x44f0,0x4680,0x6380,0x2b10,0x4810
.long 0x49a0,0x66a0,0x1330,0x4b30,0x31c0,0x69c0,0x1650,0x3350,0x34e0,0x51e0,0x1970,0x3670,0x5500,0x7200,0x3990,0x5690
.long 0x5690,0x7390,0x3b20,0x5820,0x59b0,0x76b0,0x2340,0x5b40,0x41d0,0x79d0,0x2660,0x4360,0x44f0,0x61f0,0x2980,0x4680
.long 0x4b30,0x6830,0x11b0,0x49b0,0x3350,0x6b50,0x14d0,0x31d0,0x3670,0x5370,0x17f0,0x34f0,0x3990,0x7390,0x1b10,0x3810
.long 0x5b40,0x7840,0x21c0,0x59c0,0x4360,0x7b60,0x24e0,0x41e0,0x4680,0x6380,0x2800,0x4500,0x49a0,0x66a0,0x2b20,0x4820
.long 0x4cc0,0x69c0,0x1340,0x4b40,0x34e0,0x6ce0,0x1660,0x3360,0x3800,0x5500,0x1980,0x3680,0x5820,0x7520,0x39a0,0x56a0
.long 0x59b0,0x76b0,0x3b30,0x5830,0x5cd0,0x79d0,0x2350,0x5b50,0x44f0,0x7cf0,0x2670,0x4370,0x4810,0x6510,0x2990,0x4690
.long 0x59b0,0x76b0,0x11b0,0x49b0,0x41d0,0x79d0,0x14d0,0x31d0,0x44f0,0x61f0,0x17f0,0x34f0,0x4810,0x8210,0x1b10,0x3810
.long 0x69c0,0x86c0,0x21c0,0x59c0,0x51e0,0x89e0,0x24e0,0x41e0,0x5500,0x7200,0x2800,0x4500,0x5820,0x7520,0x2b20,0x4820
.long 0x5b40,0x7840,0x1340,0x4b40,0x4360,0x7b60,0x1660,0x3360,0x4680,0x6380,0x1980,0x3680,0x66a0,0x83a0,0x39a0,0x56a0
.long 0x6830,0x8530,0x3b30,0x5830,0x6b50,0x8850,0x2350,0x5b50,0x5370,0x8b70,0x2670,0x4370,0x5690,0x7390,0x2990,0x4690
.long 0x66a0,0x1e5d0,0x1e5d0,0x17500,0x69c0,0x1e758,0x1e5d8,0x17502,0x51e0,0x1e8e0,0x1e5e0,0x17504,0x7200,0x1ea68,0x1e5e8,0x17506
.long 0x76b0,0x1ebf0,0x1e5f0,0x17508,0x79d0,0x1ed78,0x1e5f8,0x1750a,0x61f0,0x1ef00,0x1e600,0x1750c,0x6510,0x1f088,0x1e608,0x1750e
.long 0x6830,0x1f210,0x1e610,0x17510,0x6b50,0x1f398,0x1e618,0x17512,0x5370,0x1f520,0x1e620,0x17514,0x7390,0x1f6a8,0x1e628,0x17516
.long 0x7520,0x1f830,0x1e630,0x17518,0x7840,0x1f9b8,0x1e638,0x1751a,0x7b60,0x1fb40,0x1e640,0x1751c,0x6380,0x1fcc8,0x1e648,0x1751e
.long 0x66a0,0x1e5d8,0x1e650,0x17500,0x69c0,0x1e760,0x1e658,0x17502,0x51e0,0x1e8e8,0x1e660,0x17504,0x7200,0x1ea70,0x1e668,0x17506
.long 0x76b0,0x1ebf8,0x1e670,0x17508,0x79d0,0x1ed80,0x1e678,0x1750a,0x61f0,0x1ef08,0x1e680,0x1750c,0x6510,0x1f090,0x1e688,0x1750e
.long 0x6830,0x1f218,0x1e690,0x17510,0x6b50,0x1f3a0,0x1e698,0x17512,0x5370,0x1f528,0x1e6a0,0x17514,0x7390,0x1f6b0,0x1e6a8,0x17516
.long 0x7520,0x1f838,0x1e6b0,0x17518,0x7840,0x1f9c0,0x1e6b8,0x1751a,0x7b60,0x1fb48,0x1e6c0,0x1751c,0x6380,0x1fcd0,0x1e6c8,0x1751e
.long 0x66b0,0x1e5e0,0x1e6d0,0x17500,0x69d0,0x1e768,0x1e6d8,0x17502,0x51f0,0x1e8f0,0x1e6e0,0x17504,0x7210,0x1ea78,0x1e6e8,0x17506
.long 0x76c0,0x1ec00,0x1e6f0,0x17508,0x79e0,0x1ed88,0x1e6f8,0x1750a,0x6200,0x1ef10,0x1e700,0x1750c,0x6520,0x1f098,0x1e708,0x1750e
.long 0x6840,0x1f220,0x1e710,0x17510,0x6b60,0x1f3a8,0x1e718,0x17512,0x5380,0x1f530,0x1e720,0x17514,0x73a0,0x1f6b8,0x1e728,0x17516
.long 0x7530,0x1f840,0x1e730,0x17518,0x7850,0x1f9c8,0x1e738,0x1751a,0x7b70,0x1fb50,0x1e740,0x1751c,0x6390,0x1fcd8,0x1e748,0x1751e
.long 0x66b0,0x1e5e8,0x10000000,0x17500,0x69d0,0x1e770,0x10000000,0x17502,0x51f0,0x1e8f8,0x10000000,0x17504,0x7210,0x1ea80,0x10000000,0x17506
.long 0x76c0,0x1ec08,0x10000000,0x17508,0x79e0,0x1ed90,0x10000000,0x1750a,0x6200,0x1ef18,0x10000000,0x1750c,0x6520,0x1f0a0,0x10000000,0x1750e
.long 0x6840,0x1f228,0x10000000,0x17510,0x6b60,0x1f3b0,0x10000000,0x17512,0x5380,0x1f538,0x10000000,0x17514,0x73a0,0x1f6c0,0x10000000,0x17516
.long 0x7530,0x1f848,0x10000000,0x17518,0x7850,0x1f9d0,0x10000000,0x1751a,0x7b70,0x1fb58,0x10000000,0x1751c,0x6390,0x1fce0,0x10000000,0x1751e
.long 0x0,0x0,0x9100,0xd900,0x0,0xff800000,0x9110,0xd910,0x0,0xff800000,0x9120,0xd920,0x0,0xff800000,0x9130,0xd930
.long 0x0,0xff800000,0x9140,0xd940,0x0,0xff800000,0x9150,0xd950,0x0,0xff800000,0x9160,0xd960,0x0,0xff800000,0x9170,0xd970
.long 0x0,0xff800000,0x9180,0xd980,0x0,0xff800000,0x9190,0xd990,0x0,0xff800000,0x91a0,0xd9a0,0x0,0xff800000,0x91b0,0xd9b0
.long 0x0,0xff800000,0x91c0,0xd9c0,0x0,0xff800000,0x91d0,0xd9d0,0x0,0xff800000,0x91e0,0xd9e0,0x0,0xff800000,0x91f0,0xd9f0
.long 0xff800000,0x0,0x9100,0xdd00,0xff800000,0xff800000,0x9110,0xdd10,0xff800000,0xff800000,0x9120,0xdd20,0xff800000,0xff800000,0x9130,0xdd30
.long 0xff800000,0xff800000,0x9140,0xdd40,0xff800000,0xff800000,0x9150,0xdd50,0xff800000,0xff800000,0x9160,0xdd60,0xff800000,0xff800000,0x9170,0xdd70
.long 0xff800000,0xff800000,0x9180,0xdd80,0xff800000,0xff800000,0x9190,0xdd90,0xff800000,0xff800000,0x91a0,0xdda0,0xff800000,0xff800000,0x91b0,0xddb0
.long 0xff800000,0xff800000,0x91c0,0xddc0,0xff800000,0xff800000,0x91d0,0xddd0,0xff800000,0xff800000,0x91e0,0xdde0,0xff800000,0xff800000,0x91f0,0xddf0
.long 0xff800000,0x0,0x9100,0xda00,0xff800000,0xff800000,0x9110,0xda10,0xff800000,0xff800000,0x9120,0xda20,0xff800000,0xff800000,0x9130,0xda30
.long 0xff800000,0xff800000,0x9140,0xda40,0xff800000,0xff800000,0x9150,0xda50,0xff800000,0xff800000,0x9160,0xda60,0xff800000,0xff800000,0x9170,0xda70
.long 0xff800000,0xff800000,0x9180,0xda80,0xff800000,0xff800000,0x9190,0xda90,0xff800000,0xff800000,0x91a0,0xdaa0,0xff800000,0xff800000,0x91b0,0xdab0
.long 0xff800000,0xff800000,0x91c0,0xdac0,0xff800000,0xff800000,0x91d0,0xdad0,0xff800000,0xff800000,0x91e0,0xdae0,0xff800000,0xff800000,0x91f0,0xdaf0
.long 0xff800000,0x0,0x9100,0xde00,0xff800000,0xff800000,0x9110,0xde10,0xff800000,0xff800000,0x9120,0xde20,0xff800000,0xff800000,0x9130,0xde30
.long 0xff800000,0xff800000,0x9140,0xde40,0xff800000,0xff800000,0x9150,0xde50,0xff800000,0xff800000,0x9160,0xde60,0xff800000,0xff800000,0x9170,0xde70
.long 0xff800000,0xff800000,0x9180,0xde80,0xff800000,0xff800000,0x9190,0xde90,0xff800000,0xff800000,0x91a0,0xdea0,0xff800000,0xff800000,0x91b0,0xdeb0
.long 0xff800000,0xff800000,0x91c0,0xdec0,0xff800000,0xff800000,0x91d0,0xded0,0xff800000,0xff800000,0x91e0,0xdee0,0xff800000,0xff800000,0x91f0,0xdef0
.long 0x9100,0x9100,0xa100,0x0,0x9110,0x9110,0xa110,0x55555555,0x9120,0x9120,0xa120,0xaaaaaaaa,0x9130,0x9130,0xa130,0xffffffff
.long 0x9140,0x9140,0xa140,0x0,0x9150,0x9150,0xa150,0x55555555,0x9160,0x9160,0xa160,0xaaaaaaaa,0x9170,0x9170,0xa170,0xffffffff
.long 0x9180,0x9180,0xa180,0x0,0x9190,0x9190,0xa190,0x55555555,0x91a0,0x91a0,0xa1a0,0xaaaaaaaa,0x91b0,0x91b0,0xa1b0,0xffffffff
.long 0x91c0,0x91c0,0xa1c0,0x0,0x91d0,0x91d0,0xa1d0,0x55555555,0x91e0,0x91e0,0xa1e0,0xaaaaaaaa,0x91f0,0x91f0,0xa1f0,0xffffffff
.long 0x9200,0x9200,0xa200,0x0,0x9210,0x9210,0xa210,0x55555555,0x9220,0x9220,0xa220,0xaaaaaaaa,0x9230,0x9230,0xa230,0xffffffff
.long 0x9240,0x9240,0xa240,0x0,0x9250,0x9250,0xa250,0x55555555,0x9260,0x9260,0xa260,0xaaaaaaaa,0x9270,0x9270,0xa270,0xffffffff
.long 0x9280,0x9280,0xa280,0x0,0x9290,0x9290,0xa290,0x55555555,0x92a0,0x92a0,0xa2a0,0xaaaaaaaa,0x92b0,0x92b0,0xa2b0,0xffffffff
.long 0x92c0,0x92c0,0xa2c0,0x0,0x92d0,0x92d0,0xa2d0,0x55555555,0x92e0,0x92e0,0xa2e0,0xaaaaaaaa,0x92f0,0x92f0,0xa2f0,0xffffffff
.long 0x9300,0x9300,0xa300,0x0,0x9310,0x9310,0xa310,0x55555555,0x9320,0x9320,0xa320,0xaaaaaaaa,0x9330,0x9330,0xa330,0xffffffff
.long 0x9340,0x9340,0xa340,0x0,0x9350,0x9350,0xa350,0x55555555,0x9360,0x9360,0xa360,0xaaaaaaaa,0x9370,0x9370,0xa370,0xffffffff
.long 0x9380,0x9380,0xa380,0x0,0x9390,0x9390,0xa390,0x55555555,0x93a0,0x93a0,0xa3a0,0xaaaaaaaa,0x93b0,0x93b0,0xa3b0,0xffffffff
.long 0x93c0,0x93c0,0xa3c0,0x0,0x93d0,0x93d0,0xa3d0,0x55555555,0x93e0,0x93e0,0xa3e0,0xaaaaaaaa,0x93f0,0x93f0,0xa3f0,0xffffffff
.long 0x9400,0x9400,0xa400,0x0,0x9410,0x9410,0xa410,0x55555555,0x9420,0x9420,0xa420,0xaaaaaaaa,0x9430,0x9430,0xa430,0xffffffff
.long 0x9440,0x9440,0xa440,0x0,0x9450,0x9450,0xa450,0x55555555,0x9460,0x9460,0xa460,0xaaaaaaaa,0x9470,0x9470,0xa470,0xffffffff
.long 0x9480,0x9480,0xa480,0x0,0x9490,0x9490,0xa490,0x55555555,0x94a0,0x94a0,0xa4a0,0xaaaaaaaa,0x94b0,0x94b0,0xa4b0,0xffffffff
.long 0x94c0,0x94c0,0xa4c0,0x0,0x94d0,0x94d0,0xa4d0,0x55555555,0x94e0,0x94e0,0xa4e0,0xaaaaaaaa,0x94f0,0x94f0,0xa4f0,0xffffffff
.long 0x17100,0x17100,0x0,0x23100,0x17102,0x17100,0x0,0x23110,0x17104,0x17100,0x0,0x23120,0x17106,0x17100,0x0,0x23130
.long 0x17120,0x17100,0x0,0x23140,0x17122,0x17100,0x0,0x23150,0x17124,0x17100,0x0,0x23160,0x17126,0x17100,0x0,0x23170
.long 0x17140,0x17100,0x0,0x23300,0x17142,0x17100,0x0,0x23300,0x17144,0x17100,0x0,0x23300,0x17146,0x17100,0x0,0x23300
.long 0x17160,0x17100,0x0,0x23300,0x17162,0x17100,0x0,0x23300,0x17164,0x17100,0x0,0x23300,0x17166,0x17100,0x0,0x23300
.long 0x17108,0x17120,0x0,0x23200,0x1710a,0x17120,0x0,0x23210,0x1710c,0x17120,0x0,0x23220,0x1710e,0x17120,0x0,0x23230
.long 0x17128,0x17120,0x0,0x23240,0x1712a,0x17120,0x0,0x23250,0x1712c,0x17120,0x0,0x23260,0x1712e,0x17120,0x0,0x23270
.long 0x17148,0x17120,0x0,0x23300,0x1714a,0x17120,0x0,0x23300,0x1714c,0x17120,0x0,0x23300,0x1714e,0x17120,0x0,0x23300
.long 0x17168,0x17120,0x0,0x23300,0x1716a,0x17120,0x0,0x23300,0x1716c,0x17120,0x0,0x23300,0x1716e,0x17120,0x0,0x23300
.long 0x17110,0x17140,0x0,0x23300,0x17112,0x17140,0x0,0x23300,0x17114,0x17140,0x0,0x23300,0x17116,0x17140,0x0,0x23300
.long 0x17130,0x17140,0x0,0x23300,0x17132,0x17140,0x0,0x23300,0x17134,0x17140,0x0,0x23300,0x17136,0x17140,0x0,0x23300
.long 0x17150,0x17140,0x0,0x23180,0x17152,0x17140,0x0,0x23190,0x17154,0x17140,0x0,0x231a0,0x17156,0x17140,0x0,0x231b0
.long 0x17170,0x17140,0x0,0x231c0,0x17172,0x17140,0x0,0x231d0,0x17174,0x17140,0x0,0x231e0,0x17176,0x17140,0x0,0x231f0
.long 0x17118,0x17160,0x0,0x23300,0x1711a,0x17160,0x0,0x23300,0x1711c,0x17160,0x0,0x23300,0x1711e,0x17160,0x0,0x23300
.long 0x17138,0x17160,0x0,0x23300,0x1713a,0x17160,0x0,0x23300,0x1713c,0x17160,0x0,0x23300,0x1713e,0x17160,0x0,0x23300
.long 0x17158,0x17160,0x0,0x23280,0x1715a,0x17160,0x0,0x23290,0x1715c,0x17160,0x0,0x232a0,0x1715e,0x17160,0x0,0x232b0
.long 0x17178,0x17160,0x0,0x232c0,0x1717a,0x17160,0x0,0x232d0,0x1717c,0x17160,0x0,0x232e0,0x1717e,0x17160,0x0,0x232f0
.long 0x17100,0xe100,0xe280,0xe700,0x17108,0xee90,0xf010,0xf490,0x17110,0xfc20,0xfda0,0x10220,0x17118,0x109b0,0x10b30,0x10fb0
.long 0x17160,0x11740,0x118c0,0x11d40,0x17168,0x124d0,0x12650,0x12ad0,0x17170,0x13260,0x133e0,0x13860,0x17178,0x13ff0,0x14170,0x145f0
.long 0x171c0,0x14d80,0x14f00,0x15380,0x171c8,0x15b10,0x15c90,0x16110,0x171d0,0x168a0,0x16a20,0x16ea0,0x171d8,0x17630,0x177b0,0x17c30
.long 0x17220,0x183c0,0x18540,0x189c0,0x17228,0x19150,0x192d0,0x19750,0x17230,0x19ee0,0x1a060,0x1a4e0,0x17238,0x1ac70,0x1adf0,0x1b270
.long 0x17280,0xe400,0xe580,0xe700,0x17288,0xf190,0xf310,0xf490,0x17290,0xff20,0x100a0,0x10220,0x17298,0x10cb0,0x10e30,0x10fb0
.long 0x172e0,0x11a40,0x11bc0,0x11d40,0x172e8,0x127d0,0x12950,0x12ad0,0x172f0,0x13560,0x136e0,0x13860,0x172f8,0x142f0,0x14470,0x145f0
.long 0x17340,0x15080,0x15200,0x15380,0x17348,0x15e10,0x15f90,0x16110,0x17350,0x16ba0,0x16d20,0x16ea0,0x17358,0x17930,0x17ab0,0x17c30
.long 0x173a0,0x186c0,0x18840,0x189c0,0x173a8,0x19450,0x195d0,0x19750,0x173b0,0x1a1e0,0x1a360,0x1a4e0,0x173b8,0x1af70,0x1b0f0,0x1b270
.long 0x17400,0xea00,0xe880,0xe710,0x17408,0xf790,0xf610,0xf4a0,0x17410,0x10520,0x103a0,0x10230,0x17418,0x112b0,0x11130,0x10fc0
.long 0x17460,0x12040,0x11ec0,0x11d50,0x17468,0x12dd0,0x12c50,0x12ae0,0x17470,0x13b60,0x139e0,0x13870,0x17478,0x148f0,0x14770,0x14600
.long 0x174c0,0x15680,0x15500,0x15390,0x174c8,0x16410,0x16290,0x16120,0x174d0,0x171a0,0x17020,0x16eb0,0x174d8,0x17f30,0x17db0,0x17c40
.long 0x17520,0x18cc0,0x18b40,0x189d0,0x17528,0x19a50,0x198d0,0x19760,0x17530,0x1a7e0,0x1a660,0x1a4f0,0x17538,0x1b570,0x1b3f0,0x1b280
.long 0x17580,0xed00,0xeb80,0xe710,0x17588,0xfa90,0xf910,0xf4a0,0x17590,0x10820,0x106a0,0x10230,0x17598,0x115b0,0x11430,0x10fc0
.long 0x175e0,0x12340,0x121c0,0x11d50,0x175e8,0x130d0,0x12f50,0x12ae0,0x175f0,0x13e60,0x13ce0,0x13870,0x175f8,0x14bf0,0x14a70,0x14600
.long 0x17640,0x15980,0x15800,0x15390,0x17648,0x16710,0x16590,0x16120,0x17650,0x174a0,0x17320,0x16eb0,0x17658,0x18230,0x180b0,0x17c40
.long 0x176a0,0x18fc0,0x18e40,0x189d0,0x176a8,0x19d50,0x19bd0,0x19760,0x176b0,0x1aae0,0x1a960,0x1a4f0,0x176b8,0x1b870,0x1b6f0,0x1b280
.long 0x17100,0x17500,0x17378,0x0,0x17690,0x17a90,0x17908,0x0,0x17c20,0x18020,0x17e98,0x0,0x181b0,0x185b0,0x18428,0x0
.long 0x18740,0x18b40,0x189b8,0x0,0x18cd0,0x190d0,0x18f48,0x0,0x19260,0x19660,0x194d8,0x0,0x197f0,0x19bf0,0x19a68,0x0
.long 0x19d80,0x1a180,0x19ff8,0x0,0x1a310,0x1a710,0x1a588,0x0,0x1a8a0,0x1aca0,0x1ab18,0x0,0x1ae30,0x1b230,0x1b0a8,0x0
.long 0x1b3c0,0x1b7c0,0x1b638,0x0,0x1b950,0x1bd50,0x1bbc8,0x0,0x1bee0,0x1c2e0,0x1c158,0x0,0x1c470,0x1c870,0x1c6e8,0x0
.long 0x17120,0x17508,0x17378,0x0,0x176b0,0x17a98,0x17908,0x0,0x17c40,0x18028,0x17e98,0x0,0x181d0,0x185b8,0x18428,0x0
.long 0x18760,0x18b48,0x189b8,0x0,0x18cf0,0x190d8,0x18f48,0x0,0x19280,0x19668,0x194d8,0x0,0x19810,0x19bf8,0x19a68,0x0
.long 0x19da0,0x1a188,0x19ff8,0x0,0x1a330,0x1a718,0x1a588,0x0,0x1a8c0,0x1aca8,0x1ab18,0x0,0x1ae50,0x1b238,0x1b0a8,0x0
.long 0x1b3e0,0x1b7c8,0x1b638,0x0,0x1b970,0x1bd58,0x1bbc8,0x0,0x1bf00,0x1c2e8,0x1c158,0x0,0x1c490,0x1c878,0x1c6e8,0x0
.long 0x17140,0x17510,0x17378,0x0,0x176d0,0x17aa0,0x17908,0x0,0x17c60,0x18030,0x17e98,0x0,0x181f0,0x185c0,0x18428,0x0
.long 0x18780,0x18b50,0x189b8,0x0,0x18d10,0x190e0,0x18f48,0x0,0x192a0,0x19670,0x194d8,0x0,0x19830,0x19c00,0x19a68,0x0
.long 0x19dc0,0x1a190,0x19ff8,0x0,0x1a350,0x1a720,0x1a588,0x0,0x1a8e0,0x1acb0,0x1ab18,0x0,0x1ae70,0x1b240,0x1b0a8,0x0
.long 0x1b400,0x1b7d0,0x1b638,0x0,0x1b990,0x1bd60,0x1bbc8,0x0,0x1bf20,0x1c2f0,0x1c158,0x0,0x1c4b0,0x1c880,0x1c6e8,0x0
.long 0x17160,0x17518,0x17378,0x0,0x176f0,0x17aa8,0x17908,0x0,0x17c80,0x18038,0x17e98,0x0,0x18210,0x185c8,0x18428,0x0
.long 0x187a0,0x18b58,0x189b8,0x0,0x18d30,0x190e8,0x18f48,0x0,0x192c0,0x19678,0x194d8,0x0,0x19850,0x19c08,0x19a68,0x0
.long 0x19de0,0x1a198,0x19ff8,0x0,0x1a370,0x1a728,0x1a588,0x0,0x1a900,0x1acb8,0x1ab18,0x0,0x1ae90,0x1b248,0x1b0a8,0x0
.long 0x1b420,0x1b7d8,0x1b638,0x0,0x1b9b0,0x1bd68,0x1bbc8,0x0,0x1bf40,0x1c2f8,0x1c158,0x0,0x1c4d0,0x1c888,0x1c6e8,0x0
.long 0x26100,0x26160,0x26280,0x0,0x26102,0x26162,0x26282,0x0,0x26104,0x26164,0x26284,0x0,0x26106,0x26166,0x26286,0x0
.long 0x26108,0x26168,0x26288,0x0,0x2610a,0x2616a,0x2628a,0x0,0x2610c,0x2616c,0x2628c,0x0,0x2610e,0x2616e,0x2628e,0x0
.long 0x26110,0x26170,0x26290,0x0,0x26112,0x26172,0x26292,0x0,0x26114,0x26174,0x26294,0x0,0x26116,0x26176,0x26296,0x0
.long 0x26118,0x26178,0x26298,0x0,0x2611a,0x2617a,0x2629a,0x0,0x2611c,0x2617c,0x2629c,0x0,0x2611e,0x2617e,0x2629e,0x0
.long 0x26340,0x262e0,0x26280,0x0,0x26342,0x262e2,0x26282,0x0,0x26344,0x262e4,0x26284,0x0,0x26346,0x262e6,0x26286,0x0
.long 0x26348,0x262e8,0x26288,0x0,0x2634a,0x262ea,0x2628a,0x0,0x2634c,0x262ec,0x2628c,0x0,0x2634e,0x262ee,0x2628e,0x0
.long 0x26350,0x262f0,0x26290,0x0,0x26352,0x262f2,0x26292,0x0,0x26354,0x262f4,0x26294,0x0,0x26356,0x262f6,0x26296,0x0
.long 0x26358,0x262f8,0x26298,0x0,0x2635a,0x262fa,0x2629a,0x0,0x2635c,0x262fc,0x2629c,0x0,0x2635e,0x262fe,0x2629e,0x0
.long 0x26100,0x26160,0x26280,0x0,0x26102,0x26162,0x26282,0x0,0x26104,0x26164,0x26284,0x0,0x26106,0x26166,0x26286,0x0
.long 0x26108,0x26168,0x26288,0x0,0x2610a,0x2616a,0x2628a,0x0,0x2610c,0x2616c,0x2628c,0x0,0x2610e,0x2616e,0x2628e,0x0
.long 0x26110,0x26170,0x26290,0x0,0x26112,0x26172,0x26292,0x0,0x26114,0x26174,0x26294,0x0,0x26116,0x26176,0x26296,0x0
.long 0x26118,0x26178,0x26298,0x0,0x2611a,0x2617a,0x2629a,0x0,0x2611c,0x2617c,0x2629c,0x0,0x2611e,0x2617e,0x2629e,0x0
.long 0x26340,0x262e0,0x26280,0x0,0x26342,0x262e2,0x26282,0x0,0x26344,0x262e4,0x26284,0x0,0x26346,0x262e6,0x26286,0x0
.long 0x26348,0x262e8,0x26288,0x0,0x2634a,0x262ea,0x2628a,0x0,0x2634c,0x262ec,0x2628c,0x0,0x2634e,0x262ee,0x2628e,0x0
.long 0x26350,0x262f0,0x26290,0x0,0x26352,0x262f2,0x26292,0x0,0x26354,0x262f4,0x26294,0x0,0x26356,0x262f6,0x26296,0x0
.long 0x26358,0x262f8,0x26298,0x0,0x2635a,0x262fa,0x2629a,0x0,0x2635c,0x262fc,0x2629c,0x0,0x2635e,0x262fe,0x2629e,0x0
.long 0xffffffff,0x0,0xffff,0x0,0xffffffff,0x0,0xffff,0x0,0xffffffff,0x0,0xffff,0x0,0xffffffff,0x0,0xffff,0x0
.long 0x0,0xffffffff,0xffff,0x0,0x0,0xffffffff,0xffff,0x0,0x0,0xffffffff,0xffff,0x0,0x0,0xffffffff,0xffff,0x0
.long 0x0,0x0,0xffff,0x0,0x0,0x0,0xffff,0x0,0x0,0x0,0xffff,0x0,0x0,0x0,0xffff,0x0
.long 0x0,0x0,0xffff,0x0,0x0,0x0,0xffff,0x0,0x0,0x0,0xffff,0x0,0x0,0x0,0xffff,0x0
.long 0xffffffff,0x0,0x0,0x3f80,0xffffffff,0x0,0x0,0x3f80,0xffffffff,0x0,0x0,0x3f80,0xffffffff,0x0,0x0,0x3f80
.long 0x0,0xffffffff,0x0,0x3f80,0x0,0xffffffff,0x0,0x3f80,0x0,0xffffffff,0x0,0x3f80,0x0,0xffffffff,0x0,0x3f80
.long 0x0,0x0,0x0,0x3f80,0x0,0x0,0x0,0x3f80,0x0,0x0,0x0,0x3f80,0x0,0x0,0x0,0x3f80
.long 0x0,0x0,0x0,0x3f80,0x0,0x0,0x0,0x3f80,0x0,0x0,0x0,0x3f80,0x0,0x0,0x0,0x3f80
.long 0x0,0x0,0xffff,0x0,0x0,0x0,0xffff,0x0,0x0,0x0,0xffff,0x0,0x0,0x0,0xffff,0x0
.long 0x0,0x0,0xffff,0x0,0x0,0x0,0xffff,0x0,0x0,0x0,0xffff,0x0,0x0,0x0,0xffff,0x0
.long 0xffffffff,0x0,0xffff,0x0,0xffffffff,0x0,0xffff,0x0,0xffffffff,0x0,0xffff,0x0,0xffffffff,0x0,0xffff,0x0
.long 0x0,0xffffffff,0xffff,0x0,0x0,0xffffffff,0xffff,0x0,0x0,0xffffffff,0xffff,0x0,0x0,0xffffffff,0xffff,0x0
.long 0x0,0x0,0x0,0x3f80,0x0,0x0,0x0,0x3f80,0x0,0x0,0x0,0x3f80,0x0,0x0,0x0,0x3f80
.long 0x0,0x0,0x0,0x3f80,0x0,0x0,0x0,0x3f80,0x0,0x0,0x0,0x3f80,0x0,0x0,0x0,0x3f80
.long 0xffffffff,0x0,0x0,0x3f80,0xffffffff,0x0,0x0,0x3f80,0xffffffff,0x0,0x0,0x3f80,0xffffffff,0x0,0x0,0x3f80
.long 0x0,0xffffffff,0x0,0x3f80,0x0,0xffffffff,0x0,0x3f80,0x0,0xffffffff,0x0,0x3f80,0x0,0xffffffff,0x0,0x3f80
.long 0xffff,0x0,0x0,0x0,0xffff0000,0x0,0x0,0x0,0x0,0xffff,0x0,0x0,0x0,0xffff0000,0x0,0x0
.long 0x0,0x0,0xffff,0x0,0x0,0x0,0xffff0000,0x0,0x0,0x0,0x0,0xffff,0x0,0x0,0x0,0xffff0000
.long 0x0,0x0,0x0,0x0,0x0,0x0,0x0,0x0,0x0,0x0,0x0,0x0,0x0,0x0,0x0,0x0
.long 0x0,0x0,0x0,0x0,0x0,0x0,0x0,0x0,0x0,0x0,0x0,0x0,0x0,0x0,0x0,0x0
.long 0xffff,0x0,0x0,0x0,0xffff0000,0x0,0x0,0x0,0x0,0xffff,0x0,0x0,0x0,0xffff0000,0x0,0x0
.long 0x0,0x0,0xffff,0x0,0x0,0x0,0xffff0000,0x0,0x0,0x0,0x0,0xffff,0x0,0x0,0x0,0xffff0000
.long 0x0,0x0,0x0,0x0,0x0,0x0,0x0,0x0,0x0,0x0,0x0,0x0,0x0,0x0,0x0,0x0
.long 0x0,0x0,0x0,0x0,0x0,0x0,0x0,0x0,0x0,0x0,0x0,0x0,0x0,0x0,0x0,0x0
.long 0x0,0x0,0x0,0x0,0x0,0x0,0x0,0x0,0x0,0x0,0x0,0x0,0x0,0x0,0x0,0x0
.long 0x0,0x0,0x0,0x0,0x0,0x0,0x0,0x0,0x0,0x0,0x0,0x0,0x0,0x0,0x0,0x0
.long 0xffff,0x0,0x0,0x0,0xffff0000,0x0,0x0,0x0,0x0,0xffff,0x0,0x0,0x0,0xffff0000,0x0,0x0
.long 0x0,0x0,0xffff,0x0,0x0,0x0,0xffff0000,0x0,0x0,0x0,0x0,0xffff,0x0,0x0,0x0,0xffff0000
.long 0x0,0x0,0x0,0x0,0x0,0x0,0x0,0x0,0x0,0x0,0x0,0x0,0x0,0x0,0x0,0x0
.long 0x0,0x0,0x0,0x0,0x0,0x0,0x0,0x0,0x0,0x0,0x0,0x0,0x0,0x0,0x0,0x0
.long 0xffff,0x0,0x0,0x0,0xffff0000,0x0,0x0,0x0,0x0,0xffff,0x0,0x0,0x0,0xffff0000,0x0,0x0
.long 0x0,0x0,0xffff,0x0,0x0,0x0,0xffff0000,0x0,0x0,0x0,0x0,0xffff,0x0,0x0,0x0,0xffff0000
.long 0x21a30,0x21d30,0x22030,0x22330,0xb1d30,0x81730,0x81a30,0x81d30,0x111730,0x111a30,0xe1430,0x141130,0x0,0x0,0x0,0x0
.long 0x51290,0x51590,0x51890,0x51b90,0xe1590,0xb0f90,0xb1290,0xb1590,0x140f90,0x141290,0x110c90,0x110f90,0x0,0x0,0x0,0x0
.long 0x20f70,0x21270,0x21570,0x81270,0xb1270,0x80c70,0x80f70,0xe0c70,0x110c70,0x110f70,0xe0970,0x140670,0x0,0x0,0x0,0x0
.long 0x80dd0,0x507d0,0x50ad0,0x50dd0,0xe07d0,0xe0ad0,0xb04d0,0xb07d0,0x1401d0,0x1404d0,0x1407d0,0x1101d0,0x0,0x0,0x0,0x0
.long 0x0,0x0,0x0,0x0,0x0,0x0,0x0,0x0,0x0,0x0,0x0,0x0,0x0,0x0,0x0,0x0
.long 0x0,0x0,0x0,0x0,0x0,0x0,0x0,0x0,0x0,0x0,0x0,0x0,0x0,0x0,0x0,0x0
.long 0x0,0x0,0x0,0x0,0x0,0x0,0x0,0x0,0x0,0x0,0x0,0x0,0x0,0x0,0x0,0x0
.long 0x0,0x0,0x0,0x0,0x0,0x0,0x0,0x0,0x0,0x0,0x0,0x0,0x0,0x0,0x0,0x0
.long 0x0,0x0,0x0,0x0,0x0,0x0,0x0,0x0,0x0,0x0,0x0,0x0,0x0,0x0,0x0,0x0
.long 0x0,0x0,0x0,0x0,0x0,0x0,0x0,0x0,0x0,0x0,0x0,0x0,0x0,0x0,0x0,0x0
.long 0x0,0x0,0x0,0x0,0x0,0x0,0x0,0x0,0x0,0x0,0x0,0x0,0x0,0x0,0x0,0x0
.long 0x0,0x0,0x0,0x0,0x0,0x0,0x0,0x0,0x0,0x0,0x0,0x0,0x0,0x0,0x0,0x0
.long 0x0,0x0,0x0,0x0,0x0,0x0,0x0,0x0,0x0,0x0,0x0,0x0,0x0,0x0,0x0,0x0
.long 0x0,0x0,0x0,0x0,0x0,0x0,0x0,0x0,0x0,0x0,0x0,0x0,0x0,0x0,0x0,0x0
.long 0x0,0x0,0x0,0x0,0x0,0x0,0x0,0x0,0x0,0x0,0x0,0x0,0x0,0x0,0x0,0x0
.long 0x0,0x0,0x0,0x0,0x0,0x0,0x0,0x0,0x0,0x0,0x0,0x0,0x0,0x0,0x0,0x0
.size L_tab, 12288
.section .rodata,"a"
.p2align 6
.amdhsa_kernel standalone__window_attn_davit__vision_kernel
  .amdhsa_next_free_vgpr 512
  .amdhsa_next_free_sgpr 102
  .amdhsa_accum_offset 256
  .amdhsa_group_segment_fixed_size 0
  .amdhsa_kernarg_size 56
  .amdhsa_user_sgpr_count 2
  .amdhsa_user_sgpr_kernarg_segment_ptr 1
  .amdhsa_system_sgpr_workgroup_id_x 1
.end_amdhsa_kernel
```
